```python
import torch

def _softmax(x, axis=-1):
    return torch.softmax(x, dim=axis)

def _gelu(x):
    return torch.nn.functional.gelu(x, approximate='tanh')

def _silu(x):
    return torch.nn.functional.silu(x)

def _sigmoid(x):
    return torch.sigmoid(x)

def _layernorm(x, axis=-1, eps=1e-05):
    m = x.mean(dim=axis, keepdim=True)
    v = x.var(dim=axis, keepdim=True, unbiased=False)
    return (x - m) / torch.sqrt(v + eps)

def _scatter_add(tgt, idx, src, axis=0):
    return tgt.clone().index_add_(axis, idx, src)

def _segment_sum(src, seg, n):
    out = torch.zeros((n,) + src.shape[1:], dtype=src.dtype)
    return out.index_add_(0, seg, src)

def _pad(x, pw):
    flat = tuple((v for pair in reversed(pw) for v in pair))
    return torch.nn.functional.pad(x, flat)
kernel_name = 'adaLN_cond__sliding_local_dilated__swiglu_ffn__prompt'

def setup_inputs():

    _w = lambda a: (lambda t: t.to(torch.bfloat16) if t.is_floating_point() else t)(torch.as_tensor(a))

    def _A_setup():
        B, S, D = (1, 2048, 1024)
        return {'x': _w((lambda *s: torch.randn(*s, dtype=torch.bfloat16) * 0.05)(B, S, D)), 'wqkv': _w((lambda *s: torch.randn(*s, dtype=torch.bfloat16) * 0.05)(D, 3 * D)), 'wo': _w((lambda *s: torch.randn(*s, dtype=torch.bfloat16) * 0.05)(D, D))}
    _A_in = _A_setup()

    def _B_setup():
        B, S, D, F = (1, 2048, 1024, 3584)
        return {'x': _w((lambda *s: torch.randn(*s, dtype=torch.bfloat16) * 0.05)(B, S, D)), 'w_gate': _w((lambda *s: torch.randn(*s, dtype=torch.bfloat16) * 0.05)(D, F)), 'w_up': _w((lambda *s: torch.randn(*s, dtype=torch.bfloat16) * 0.05)(D, F)), 'w_down': _w((lambda *s: torch.randn(*s, dtype=torch.bfloat16) * 0.05)(F, D))}
    _B_in = _B_setup()
    return {'A_x': _A_in['x'], 'A_wqkv': _A_in['wqkv'], 'A_wo': _A_in['wo'], 'B_x': _B_in['x'], 'B_w_gate': _B_in['w_gate'], 'B_w_up': _B_in['w_up'], 'B_w_down': _B_in['w_down'], 'c': _w((lambda *s: torch.randn(*s, dtype=torch.bfloat16) * 0.1)(1, 1024) * 8.0), 'w_mod': _w((lambda *s: torch.randn(*s, dtype=torch.bfloat16) * 0.1)(1024, 6 * 1024) * 1024 ** (-0.5) * 8.0)}

def reference(A_x, A_wqkv, A_wo, B_x, B_w_gate, B_w_up, B_w_down, c, w_mod):

    def _A_ref(x, wqkv, wo):
        B, S, D = x.shape
        H = 32
        Dh = D // H
        W, dil = (8, 2)
        qkv = (lambda x, *d: x.permute(*d))((x @ wqkv).reshape(B, S, 3, H, Dh), 2, 0, 3, 1, 4)
        q, k, v = (qkv[0], qkv[1], qkv[2])
        scale = Dh ** (-0.5)
        pos = torch.arange(S)
        off = torch.arange(W) * dil
        idx = pos[:, None] - off[None, :]
        mask = idx >= 0
        idx_c = torch.where(mask, idx, 0).reshape(-1)
        kg = k[:, :, idx_c, :].reshape(B, H, S, W, Dh)
        vg = v[:, :, idx_c, :].reshape(B, H, S, W, Dh)
        logits = torch.einsum('bhsd,bhswd->bhsw', q, kg) * scale
        logits = torch.where(mask[None, None, :, :], logits, -1000000000.0)
        attn = _softmax(logits, axis=-1)
        o = torch.einsum('bhsw,bhswd->bhsd', attn, vg)
        return (lambda x, *d: x.permute(*d))(o, 0, 2, 1, 3).reshape(B, S, D) @ wo

    def _B_ref(x, w_gate, w_up, w_down):
        g = _silu(x @ w_gate)
        u = x @ w_up
        return g * u @ w_down
    x = A_x
    mod = (_silu(c) @ w_mod).reshape(c.shape[0], 6, 1, -1)
    sa, ca, ga, sb, cb, gb = (mod[:, 0].clone(), mod[:, 1].clone(), mod[:, 2].clone(), mod[:, 3].clone(), mod[:, 4].clone(), mod[:, 5].clone())
    h = _layernorm(x, axis=-1) * (1 + ca) + sa
    x = x + ga * _A_ref(h, A_wqkv, A_wo)
    h = _layernorm(x, axis=-1) * (1 + cb) + sb
    x = x + gb * _B_ref(h, B_w_gate, B_w_up, B_w_down)
    return x
```

```asm
; @launch kernel=k1_mod_kernel grid=(256,1,1) block=(256,1,1) lds=1024
; @launch kernel=k3_qkv_kernel grid=(256,1,1) block=(512,1,1) lds=163840
; @launch kernel=k5_ffn_kernel grid=(256,1,1) block=(256,1,1) lds=163840
.amdgcn_target "amdgcn-amd-amdhsa--gfx950"
.text
.globl k1_mod_kernel
.type k1_mod_kernel,@function
.p2align 8
k1_mod_kernel:
  s_cmp_ge_u32 s2, 256
  s_cbranch_scc1 X_k1_mod_kernel
  s_load_dwordx2 s[4:5], s[0:1], 64
  s_load_dwordx2 s[8:9], s[0:1], 56
  s_load_dwordx2 s[12:13], s[0:1], 88
  s_load_dwordx2 s[16:17], s[0:1], 0
  s_load_dwordx2 s[20:21], s[0:1], 8
  s_load_dwordx2 s[24:25], s[0:1], 88
  v_lshrrev_b32 v11, 6, v0
  v_and_b32 v10, 63, v0
  v_readfirstlane_b32 s30, v11
  s_mov_b32 s31, s2
  s_mov_b32 s6, 12582912
  s_mov_b32 s7, 0x20000
  s_mov_b32 s10, 2048
  s_mov_b32 s11, 0x20000
  s_mov_b32 s14, 98304
  s_mov_b32 s15, 0x20000
  s_mov_b32 s18, 4194304
  s_mov_b32 s19, 0x20000
  s_mov_b32 s22, 6291456
  s_mov_b32 s23, 0x20000
  s_mov_b32 s26, 196608
  s_mov_b32 s27, 0x20000
  s_waitcnt lgkmcnt(0)
  s_add_u32 s24, s24, 655360
  s_addc_u32 s25, s25, 0
  s_cmp_lg_u32 s30, 2
  s_cbranch_scc1 F_zk1_mod_kernel
  s_lshl_b32 s28, s2, 7
  s_lshr_b32 s29, s2, 2
  s_lshl_b32 s29, s29, 7
  v_lshrrev_b32 v8, 3, v10
  v_mov_b32 v4, s28
  v_mov_b32 v5, s29
  v_cmp_eq_u32 vcc, 2, v8
  v_and_b32 v9, 7, v10
  v_lshlrev_b32 v8, 15, v8
  v_cndmask_b32 v4, v4, v5, vcc
  v_lshl_add_u32 v8, v9, 4, v8
  v_add_u32 v8, v8, v4
  v_mov_b32 v4, 0
  v_mov_b32 v5, 0
  v_mov_b32 v6, 0
  v_mov_b32 v7, 0
  buffer_store_dwordx4 v[4:7], v8, s[24:27], 0 offen
  s_nop 1
F_zk1_mod_kernel:
  s_cmp_ge_u32 s2, 128
  s_cbranch_scc1 T_k1_mod_kernel
  s_lshr_b32 s34, s31, 2
  s_add_u32 s34, s34, 0
  s_and_b32 s35, s31, 3
  s_lshl_b32 s32, s35, 8
  s_lshl_b32 s33, s30, 6
  s_add_u32 s32, s32, s33
  v_and_b32 v12, 0x38, v10
  v_add_u32 v12, s32, v12
  v_lshlrev_b32 v13, 1, v12
  v_mul_u32_u24 v16, 12288, v12
  v_and_b32 v14, 7, v10
  v_lshl_add_u32 v16, v14, 4, v16
  s_lshl_b32 s33, s34, 7
  buffer_load_dwordx4 v[20:23], v13, s[8:11], 0 offen
  buffer_load_dwordx4 v[32:35], v16, s[4:7], s33 offen nt
  s_add_u32 s33, s33, 12288
  buffer_load_dwordx4 v[36:39], v16, s[4:7], s33 offen nt
  s_add_u32 s33, s33, 12288
  buffer_load_dwordx4 v[40:43], v16, s[4:7], s33 offen nt
  s_add_u32 s33, s33, 12288
  buffer_load_dwordx4 v[44:47], v16, s[4:7], s33 offen nt
  s_add_u32 s33, s33, 12288
  buffer_load_dwordx4 v[48:51], v16, s[4:7], s33 offen nt
  s_add_u32 s33, s33, 12288
  buffer_load_dwordx4 v[52:55], v16, s[4:7], s33 offen nt
  s_add_u32 s33, s33, 12288
  buffer_load_dwordx4 v[56:59], v16, s[4:7], s33 offen nt
  s_add_u32 s33, s33, 12288
  buffer_load_dwordx4 v[60:63], v16, s[4:7], s33 offen nt
  s_lshr_b32 s38, s31, 3
  s_lshl_b32 s38, s38, 13
  s_cmp_lg_u32 s30, 3
  s_cbranch_scc1 TC1_k1_mod_kernel
  s_cmp_ge_u32 s38, code_end-k3_qkv_kernel
  s_cbranch_scc1 TC1_k1_mod_kernel
  s_getpc_b64 s[36:37]
TC1_k1_mod_kernelp:
  s_add_u32 s38, s38, k3_qkv_kernel-TC1_k1_mod_kernelp
  s_ashr_i32 vcc_hi, s38, 31
  s_add_u32 s36, s36, s38
  s_addc_u32 s37, s37, vcc_hi
  v_lshlrev_b32 v74, 7, v10
  v_mov_b32 v75, s37
  v_add_co_u32 v74, vcc, s36, v74
  s_nop 1
  v_addc_co_u32 v75, vcc, 0, v75, vcc
  global_load_dword v76, v[74:75], off
TC1_k1_mod_kernel:
  v_lshlrev_b32 v74, 7, v10
  s_lshl_b32 s36, s31, 1
  s_add_u32 s36, s36, s30
  s_lshl_b32 s36, s36, 13
  s_cmp_lt_u32 s30, 2
  s_cselect_b32 s36, s36, 0x40000000
  buffer_load_dword v76, v74, s[16:19], s36 offen
  v_lshlrev_b32 v74, 7, v10
  s_mul_i32 s36, s30, 256
  s_add_u32 s36, s36, s31
  s_lshl_b32 s36, s36, 13
  s_add_u32 s37, s36, 0
  s_cmp_lt_u32 s37, 2095104
  s_cselect_b32 s37, s37, 0x40000000
  buffer_load_dword v76, v74, s[20:23], s37 offen
  s_waitcnt vmcnt(10)
  v_lshlrev_b32 v24, 16, v20
  v_and_b32 v25, 0xffff0000, v20
  v_lshlrev_b32 v26, 16, v21
  v_and_b32 v27, 0xffff0000, v21
  v_lshlrev_b32 v28, 16, v22
  v_and_b32 v29, 0xffff0000, v22
  v_lshlrev_b32 v30, 16, v23
  v_and_b32 v31, 0xffff0000, v23
  v_mul_f32 v64, 0xbfb8aa3b, v24
  v_mul_f32 v65, 0xbfb8aa3b, v25
  v_mul_f32 v66, 0xbfb8aa3b, v26
  v_mul_f32 v67, 0xbfb8aa3b, v27
  v_mul_f32 v68, 0xbfb8aa3b, v28
  v_mul_f32 v69, 0xbfb8aa3b, v29
  v_mul_f32 v70, 0xbfb8aa3b, v30
  v_mul_f32 v71, 0xbfb8aa3b, v31
  v_exp_f32 v64, v64
  v_exp_f32 v65, v65
  v_exp_f32 v66, v66
  v_exp_f32 v67, v67
  v_exp_f32 v68, v68
  v_exp_f32 v69, v69
  v_exp_f32 v70, v70
  v_exp_f32 v71, v71
  v_add_f32 v64, 1.0, v64
  v_add_f32 v65, 1.0, v65
  v_add_f32 v66, 1.0, v66
  v_add_f32 v67, 1.0, v67
  v_add_f32 v68, 1.0, v68
  v_add_f32 v69, 1.0, v69
  v_add_f32 v70, 1.0, v70
  v_add_f32 v71, 1.0, v71
  v_rcp_f32 v64, v64
  v_rcp_f32 v65, v65
  v_rcp_f32 v66, v66
  v_rcp_f32 v67, v67
  v_rcp_f32 v68, v68
  v_rcp_f32 v69, v69
  v_rcp_f32 v70, v70
  v_rcp_f32 v71, v71
  v_mul_f32 v24, v24, v64
  v_mul_f32 v25, v25, v65
  v_mul_f32 v26, v26, v66
  v_mul_f32 v27, v27, v67
  v_mul_f32 v28, v28, v68
  v_mul_f32 v29, v29, v69
  v_mul_f32 v30, v30, v70
  v_mul_f32 v31, v31, v71
  v_cvt_pk_bf16_f32 v72, v24, v25
  v_lshlrev_b32 v24, 16, v72
  v_and_b32 v25, 0xffff0000, v72
  v_cvt_pk_bf16_f32 v72, v26, v27
  v_lshlrev_b32 v26, 16, v72
  v_and_b32 v27, 0xffff0000, v72
  v_cvt_pk_bf16_f32 v72, v28, v29
  v_lshlrev_b32 v28, 16, v72
  v_and_b32 v29, 0xffff0000, v72
  v_cvt_pk_bf16_f32 v72, v30, v31
  v_lshlrev_b32 v30, 16, v72
  v_and_b32 v31, 0xffff0000, v72
  v_and_b32 v12, 7, v10
  v_lshlrev_b32 v12, 5, v12
  v_lshrrev_b32 v13, 4, v10
  v_lshl_add_u32 v12, v13, 3, v12
  s_lshl_b32 s32, s30, 8
  v_add_u32 v12, s32, v12
  v_lshlrev_b32 v13, 2, v10
  s_mul_i32 s32, s35, 24576
  s_lshl_b32 s33, s34, 8
  s_add_u32 s32, s32, s33
  s_waitcnt vmcnt(9)
  v_lshlrev_b32 v72, 16, v32
  v_and_b32 v73, 0xffff0000, v32
  v_mul_f32 v64, v24, v72
  v_mul_f32 v65, v24, v73
  v_lshlrev_b32 v72, 16, v33
  v_and_b32 v73, 0xffff0000, v33
  v_mul_f32 v66, v24, v72
  v_mul_f32 v67, v24, v73
  v_lshlrev_b32 v72, 16, v34
  v_and_b32 v73, 0xffff0000, v34
  v_mul_f32 v68, v24, v72
  v_mul_f32 v69, v24, v73
  v_lshlrev_b32 v72, 16, v35
  v_and_b32 v73, 0xffff0000, v35
  v_mul_f32 v70, v24, v72
  v_mul_f32 v71, v24, v73
  s_waitcnt vmcnt(8)
  v_lshlrev_b32 v72, 16, v36
  v_and_b32 v73, 0xffff0000, v36
  v_fmac_f32 v64, v25, v72
  v_fmac_f32 v65, v25, v73
  v_lshlrev_b32 v72, 16, v37
  v_and_b32 v73, 0xffff0000, v37
  v_fmac_f32 v66, v25, v72
  v_fmac_f32 v67, v25, v73
  v_lshlrev_b32 v72, 16, v38
  v_and_b32 v73, 0xffff0000, v38
  v_fmac_f32 v68, v25, v72
  v_fmac_f32 v69, v25, v73
  v_lshlrev_b32 v72, 16, v39
  v_and_b32 v73, 0xffff0000, v39
  v_fmac_f32 v70, v25, v72
  v_fmac_f32 v71, v25, v73
  s_waitcnt vmcnt(7)
  v_lshlrev_b32 v72, 16, v40
  v_and_b32 v73, 0xffff0000, v40
  v_fmac_f32 v64, v26, v72
  v_fmac_f32 v65, v26, v73
  v_lshlrev_b32 v72, 16, v41
  v_and_b32 v73, 0xffff0000, v41
  v_fmac_f32 v66, v26, v72
  v_fmac_f32 v67, v26, v73
  v_lshlrev_b32 v72, 16, v42
  v_and_b32 v73, 0xffff0000, v42
  v_fmac_f32 v68, v26, v72
  v_fmac_f32 v69, v26, v73
  v_lshlrev_b32 v72, 16, v43
  v_and_b32 v73, 0xffff0000, v43
  v_fmac_f32 v70, v26, v72
  v_fmac_f32 v71, v26, v73
  s_waitcnt vmcnt(6)
  v_lshlrev_b32 v72, 16, v44
  v_and_b32 v73, 0xffff0000, v44
  v_fmac_f32 v64, v27, v72
  v_fmac_f32 v65, v27, v73
  v_lshlrev_b32 v72, 16, v45
  v_and_b32 v73, 0xffff0000, v45
  v_fmac_f32 v66, v27, v72
  v_fmac_f32 v67, v27, v73
  v_lshlrev_b32 v72, 16, v46
  v_and_b32 v73, 0xffff0000, v46
  v_fmac_f32 v68, v27, v72
  v_fmac_f32 v69, v27, v73
  v_lshlrev_b32 v72, 16, v47
  v_and_b32 v73, 0xffff0000, v47
  v_fmac_f32 v70, v27, v72
  v_fmac_f32 v71, v27, v73
  s_waitcnt vmcnt(5)
  v_lshlrev_b32 v72, 16, v48
  v_and_b32 v73, 0xffff0000, v48
  v_fmac_f32 v64, v28, v72
  v_fmac_f32 v65, v28, v73
  v_lshlrev_b32 v72, 16, v49
  v_and_b32 v73, 0xffff0000, v49
  v_fmac_f32 v66, v28, v72
  v_fmac_f32 v67, v28, v73
  v_lshlrev_b32 v72, 16, v50
  v_and_b32 v73, 0xffff0000, v50
  v_fmac_f32 v68, v28, v72
  v_fmac_f32 v69, v28, v73
  v_lshlrev_b32 v72, 16, v51
  v_and_b32 v73, 0xffff0000, v51
  v_fmac_f32 v70, v28, v72
  v_fmac_f32 v71, v28, v73
  s_waitcnt vmcnt(4)
  v_lshlrev_b32 v72, 16, v52
  v_and_b32 v73, 0xffff0000, v52
  v_fmac_f32 v64, v29, v72
  v_fmac_f32 v65, v29, v73
  v_lshlrev_b32 v72, 16, v53
  v_and_b32 v73, 0xffff0000, v53
  v_fmac_f32 v66, v29, v72
  v_fmac_f32 v67, v29, v73
  v_lshlrev_b32 v72, 16, v54
  v_and_b32 v73, 0xffff0000, v54
  v_fmac_f32 v68, v29, v72
  v_fmac_f32 v69, v29, v73
  v_lshlrev_b32 v72, 16, v55
  v_and_b32 v73, 0xffff0000, v55
  v_fmac_f32 v70, v29, v72
  v_fmac_f32 v71, v29, v73
  s_waitcnt vmcnt(3)
  v_lshlrev_b32 v72, 16, v56
  v_and_b32 v73, 0xffff0000, v56
  v_fmac_f32 v64, v30, v72
  v_fmac_f32 v65, v30, v73
  v_lshlrev_b32 v72, 16, v57
  v_and_b32 v73, 0xffff0000, v57
  v_fmac_f32 v66, v30, v72
  v_fmac_f32 v67, v30, v73
  v_lshlrev_b32 v72, 16, v58
  v_and_b32 v73, 0xffff0000, v58
  v_fmac_f32 v68, v30, v72
  v_fmac_f32 v69, v30, v73
  v_lshlrev_b32 v72, 16, v59
  v_and_b32 v73, 0xffff0000, v59
  v_fmac_f32 v70, v30, v72
  v_fmac_f32 v71, v30, v73
  s_waitcnt vmcnt(2)
  v_lshlrev_b32 v72, 16, v60
  v_and_b32 v73, 0xffff0000, v60
  v_fmac_f32 v64, v31, v72
  v_fmac_f32 v65, v31, v73
  v_lshlrev_b32 v72, 16, v61
  v_and_b32 v73, 0xffff0000, v61
  v_fmac_f32 v66, v31, v72
  v_fmac_f32 v67, v31, v73
  v_lshlrev_b32 v72, 16, v62
  v_and_b32 v73, 0xffff0000, v62
  v_fmac_f32 v68, v31, v72
  v_fmac_f32 v69, v31, v73
  v_lshlrev_b32 v72, 16, v63
  v_and_b32 v73, 0xffff0000, v63
  v_fmac_f32 v70, v31, v72
  v_fmac_f32 v71, v31, v73
  s_nop 1
  v_permlane32_swap_b32 v64, v68
  v_permlane32_swap_b32 v65, v69
  v_permlane32_swap_b32 v66, v70
  v_permlane32_swap_b32 v67, v71
  s_nop 0
  v_add_f32 v64, v64, v68
  v_add_f32 v65, v65, v69
  v_add_f32 v66, v66, v70
  v_add_f32 v67, v67, v71
  s_nop 1
  v_permlane16_swap_b32 v64, v66
  v_permlane16_swap_b32 v65, v67
  s_nop 0
  v_add_f32 v64, v64, v66
  v_add_f32 v65, v65, v67
  s_nop 1
  v_add_f32_dpp v64, v64, v64 row_ror:8 row_mask:0xf bank_mask:0xf
  v_add_f32_dpp v65, v65, v65 row_ror:8 row_mask:0xf bank_mask:0xf
  ds_write_b64 v12, v[64:65]
  s_waitcnt lgkmcnt(0)
  s_barrier
  s_cmp_lg_u32 s30, 0
  s_cbranch_scc1 E_k1_mod_kernel
  ds_read_b32 v64, v13 offset:0
  ds_read_b32 v65, v13 offset:256
  ds_read_b32 v66, v13 offset:512
  ds_read_b32 v67, v13 offset:768
  s_waitcnt lgkmcnt(0)
  v_add_f32 v64, v64, v65
  v_add_f32 v66, v66, v67
  v_add_f32 v64, v64, v66
  buffer_store_dword v64, v13, s[12:15], s32 offen
  s_branch E_k1_mod_kernel
T_k1_mod_kernel:
  s_lshr_b32 s38, s31, 3
  s_lshl_b32 s38, s38, 13
  s_cmp_lg_u32 s30, 3
  s_cbranch_scc1 TC2_k1_mod_kernel
  s_cmp_ge_u32 s38, code_end-k3_qkv_kernel
  s_cbranch_scc1 TC2_k1_mod_kernel
  s_getpc_b64 s[36:37]
TC2_k1_mod_kernelp:
  s_add_u32 s38, s38, k3_qkv_kernel-TC2_k1_mod_kernelp
  s_ashr_i32 vcc_hi, s38, 31
  s_add_u32 s36, s36, s38
  s_addc_u32 s37, s37, vcc_hi
  v_lshlrev_b32 v74, 7, v10
  v_mov_b32 v75, s37
  v_add_co_u32 v74, vcc, s36, v74
  s_nop 1
  v_addc_co_u32 v75, vcc, 0, v75, vcc
  global_load_dword v76, v[74:75], off
TC2_k1_mod_kernel:
  v_lshlrev_b32 v74, 7, v10
  s_lshl_b32 s36, s31, 1
  s_add_u32 s36, s36, s30
  s_lshl_b32 s36, s36, 13
  s_cmp_lt_u32 s30, 2
  s_cselect_b32 s36, s36, 0x40000000
  buffer_load_dword v76, v74, s[16:19], s36 offen
  v_lshlrev_b32 v74, 7, v10
  s_mul_i32 s36, s30, 256
  s_add_u32 s36, s36, s31
  s_lshl_b32 s36, s36, 13
  s_add_u32 s37, s36, 0
  s_cmp_lt_u32 s37, 2095104
  s_cselect_b32 s37, s37, 0x40000000
  buffer_load_dword v76, v74, s[20:23], s37 offen
E_k1_mod_kernel:
X_k1_mod_kernel:
  s_endpgm
.globl k3_qkv_kernel
.type k3_qkv_kernel,@function
.p2align 8
k3_qkv_kernel:
  s_cmp_ge_u32 s2, 256
  s_cbranch_scc1 X_k3_qkv_kernel
  s_load_dwordx2 s[4:5], s[0:1], 8
  s_load_dwordx2 s[8:9], s[0:1], 88
  s_load_dwordx2 s[12:13], s[0:1], 64
  s_load_dwordx2 s[16:17], s[0:1], 56
  s_load_dwordx2 s[20:21], s[0:1], 88
  s_load_dwordx2 s[24:25], s[0:1], 88
  s_load_dwordx2 s[28:29], s[0:1], 16
  s_load_dwordx2 s[32:33], s[0:1], 88
  s_load_dwordx2 s[40:41], s[0:1], 32
  s_load_dwordx2 s[42:43], s[0:1], 40
  s_load_dwordx2 s[44:45], s[0:1], 16
  s_mov_b32 s53, s2
  v_lshrrev_b32 v3, 6, v0
  v_and_b32 v1, 63, v0
  v_readfirstlane_b32 s46, v3
  s_load_dwordx2 s[72:73], s[0:1], 0
  s_branch BODY0
.p2align 12
BODY0:
  v_and_b32 v88, 7, v1
  v_lshrrev_b32 v89, 3, v1
  v_lshlrev_b32 v96, 11, v88
  v_lshl_add_u32 v96, v89, 4, v96
  s_lshl_b32 s49, s2, 14
  s_lshl_b32 s50, s46, 8
  s_add_u32 s49, s49, s50
  v_and_b32 v98, 31, v1
  v_lshlrev_b32 v98, 4, v98
  v_lshrrev_b32 v90, 5, v1
  v_lshl_add_u32 v98, v90, 12, v98
  s_lshl_b32 s50, s46, 9
  s_mov_b32 s6, 6291456
  s_mov_b32 s7, 0x20000
  s_mov_b32 s10, 4194304
  s_mov_b32 s11, 0x20000
  s_mov_b32 s14, 12582912
  s_mov_b32 s15, 0x20000
  s_mov_b32 s18, 2048
  s_mov_b32 s19, 0x20000
  s_mov_b32 s22, 98304
  s_mov_b32 s23, 0x20000
  s_mov_b32 s26, 4194304
  s_mov_b32 s27, 0x20000
  s_mov_b32 s30, 2097152
  s_mov_b32 s31, 0x20000
  s_mov_b32 s34, 196608
  s_mov_b32 s35, 0x20000
  s_mov_b32 s74, 4194304
  s_mov_b32 s75, 0x20000
  s_waitcnt lgkmcnt(0)
  s_add_u32 s8, s8, 1048576
  s_addc_u32 s9, s9, 0
  s_add_u32 s24, s24, 7340032
  s_addc_u32 s25, s25, 0
  s_add_u32 s32, s32, 655360
  s_addc_u32 s33, s33, 0
  buffer_load_dwordx4 v[16:19], v96, s[72:75], s49 offen offset:0
  buffer_load_dwordx4 v[20:23], v96, s[72:75], s49 offen offset:128
  buffer_load_dwordx4 v[40:43], v98, s[20:23], s50 offen
  s_add_u32 s50, s50, 24576
  buffer_load_dwordx4 v[44:47], v98, s[20:23], s50 offen
  s_add_u32 s50, s50, 24576
  buffer_load_dwordx4 v[48:51], v98, s[20:23], s50 offen
  s_add_u32 s50, s50, 24576
  buffer_load_dwordx4 v[52:55], v98, s[20:23], s50 offen
  s_mov_b64 exec, 0
  s_cmp_eq_u32 s46, 0
  s_cbranch_scc1 HOP0
  s_cmp_eq_u32 s46, 1
  s_cbranch_scc1 HOP1
  s_cmp_eq_u32 s46, 2
  s_cbranch_scc1 HOP2
  s_cmp_eq_u32 s46, 3
  s_cbranch_scc1 HOP3
  s_cmp_eq_u32 s46, 4
  s_cbranch_scc1 HOP4
  s_cmp_eq_u32 s46, 5
  s_cbranch_scc1 HOP5
  s_cmp_eq_u32 s46, 6
  s_cbranch_scc1 WRET0
  s_cmp_eq_u32 s46, 7
  s_cbranch_scc1 WRET0
WRET0:
  s_mov_b64 exec, -1
  s_and_b32 s49, s2, 7
  s_lshr_b32 s50, s2, 3
  s_and_b32 s48, s49, 3
  s_lshl_b32 s48, s48, 2
  s_and_b32 s47, s50, 3
  s_add_u32 s48, s48, s47
  s_lshr_b32 s47, s49, 2
  s_lshl_b32 s47, s47, 3
  s_lshr_b32 s50, s50, 2
  s_add_u32 s47, s47, s50
  s_add_u32 s65, s47, s48
  s_and_b32 s65, s65, 3
  s_and_b32 s52, s46, 3
  s_lshr_b32 s51, s46, 2
  s_lshl_b32 s50, s48, 7
  s_lshl_b32 s63, s46, 10
  v_lshrrev_b32 v3, 3, v1
  v_bfe_u32 v4, v3, 1, 2
  v_bfe_u32 v5, v1, 1, 2
  v_xor_b32 v4, v4, v5
  s_lshl_b32 s64, s46, 3
  v_add_u32 v3, s64, v3
  v_lshlrev_b32 v4, 5, v4
  v_and_b32 v5, 1, v1
  v_lshl_add_u32 v4, v5, 4, v4
  v_mul_u32_u24 v3, 6144, v3
  v_add3_u32 v176, v3, v4, s50
  v_add_u32 v177, 2048, v176
  v_add_u32 v178, 4096, v176
  v_lshlrev_b32 v2, 4, v1
  s_lshl_b32 s49, s47, 3
  s_lshl_b32 s50, s52, 1
  s_add_u32 s49, s49, s50
  s_mul_i32 s49, s49, 32768
  s_lshl_b32 s57, s51, 10
  s_add_u32 s57, s57, s49
  v_add_u32 v179, s57, v2
  v_add_u32 v180, 32768, v179
  s_lshl_b32 s59, s46, 8
  s_lshl_b32 s49, s47, 3
  s_max_u32 s49, s49, 1
  s_sub_u32 s49, s49, 1
  s_mul_i32 s49, s49, 32768
  s_add_u32 s49, s49, s59
  v_lshl_add_u32 v200, v1, 2, s49
  v_lshrrev_b32 v4, 2, v1
  v_bfe_u32 v3, v4, 1, 2
  v_lshlrev_b32 v3, 5, v3
  v_lshl_add_u32 v3, v4, 7, v3
  v_and_b32 v4, 3, v1
  v_lshl_add_u32 v3, v4, 3, v3
  s_mul_i32 s64, s51, 4096
  v_add_u32 v3, s64, v3
  s_lshl_b32 s49, s51, 6
  v_xor_b32 v152, s49, v3
  v_xor_b32 v153, 32, v152
  s_xor_b32 s49, s52, 0
  s_and_b32 s50, s49, 1
  s_lshl_b32 s50, s50, 5
  s_lshr_b32 s49, s49, 1
  s_add_u32 s49, s49, 1
  s_mul_i32 s49, s49, 8192
  v_xor_b32 v154, s50, v152
  v_add_u32 v154, s49, v154
  s_xor_b32 s49, s52, 1
  s_and_b32 s50, s49, 1
  s_lshl_b32 s50, s50, 5
  s_lshr_b32 s49, s49, 1
  s_add_u32 s49, s49, 1
  s_mul_i32 s49, s49, 8192
  v_xor_b32 v155, s50, v152
  v_add_u32 v155, s49, v155
  s_xor_b32 s49, s52, 2
  s_and_b32 s50, s49, 1
  s_lshl_b32 s50, s50, 5
  s_lshr_b32 s49, s49, 1
  s_add_u32 s49, s49, 1
  s_mul_i32 s49, s49, 8192
  v_xor_b32 v156, s50, v152
  v_add_u32 v156, s49, v156
  s_xor_b32 s49, s52, 3
  s_and_b32 s50, s49, 1
  s_lshl_b32 s50, s50, 5
  s_lshr_b32 s49, s49, 1
  s_add_u32 s49, s49, 1
  s_mul_i32 s49, s49, 8192
  v_xor_b32 v157, s50, v152
  v_add_u32 v157, s49, v157
  v_xor_b32 v158, 64, v152
  v_xor_b32 v159, 64, v153
  v_xor_b32 v160, 64, v154
  v_xor_b32 v161, 64, v155
  v_xor_b32 v162, 64, v156
  v_xor_b32 v163, 64, v157
  v_add_u32 v164, 65536, v152
  v_add_u32 v165, 65536, v153
  v_add_u32 v166, 65536, v154
  v_add_u32 v167, 65536, v155
  v_add_u32 v168, 65536, v156
  v_add_u32 v169, 65536, v157
  v_add_u32 v170, 65536, v158
  v_add_u32 v171, 65536, v159
  v_add_u32 v172, 65536, v160
  v_add_u32 v173, 65536, v161
  v_add_u32 v174, 65536, v162
  v_add_u32 v175, 65536, v163
  s_lshl_b32 s49, s51, 10
  s_add_u32 s49, s49, 98304
  v_add_u32 v201, s49, v2
  s_mov_b64 s[72:73], s[40:41]
  s_mov_b32 s74, 0
  s_mov_b32 s75, 0x20000
  s_mov_b32 s76, 0
  s_mov_b32 s64, 0
  s_cmp_eq_u32 s46, 0
  s_cselect_b32 s74, 6291456, s74
  s_cmp_eq_u32 s46, 1
  s_cselect_b64 s[72:73], s[42:43], s[72:73]
  s_cselect_b32 s74, 6291456, s74
  s_cmp_eq_u32 s46, 2
  s_cselect_b64 s[72:73], s[44:45], s[72:73]
  s_cselect_b32 s74, 2097152, s74
  s_cmp_eq_u32 s46, 3
  s_cselect_b32 s74, 1048576, s74
  s_cselect_b32 s64, 6291456, s64
  s_cselect_b32 s76, 4292870144, s76
  s_cmp_eq_u32 s46, 4
  s_cselect_b64 s[72:73], s[42:43], s[72:73]
  s_cselect_b32 s74, 1048576, s74
  s_cselect_b32 s64, 6291456, s64
  s_cselect_b32 s76, 4290772992, s76
  s_add_u32 s72, s72, s64
  s_addc_u32 s73, s73, 0
  s_lshl_b32 s64, s53, 13
  s_add_u32 s76, s76, s64
  v_lshlrev_b32 v202, 7, v1
  s_lshl_b32 s50, s46, 3
  v_lshlrev_b32 v91, 6, v88
  v_add_u32 v92, s50, v91
  s_lshl_b32 s50, s46, 10
  v_lshl_add_u32 v99, v1, 4, s50
  v_lshl_add_u32 v97, v89, 5, s50
  v_cvt_f32_u32 v90, v90
  v_bfe_u32 v93, v1, 3, 1
  v_lshlrev_b32 v96, 9, v93
  v_bfe_u32 v93, v1, 4, 1
  v_lshl_add_u32 v96, v93, 8, v96
  v_lshrrev_b32 v93, 5, v1
  v_lshl_add_u32 v96, v93, 10, v96
  v_lshl_add_u32 v96, v88, 4, v96
  s_lshr_b32 s64, s2, 1
  s_mul_i32 s64, s64, 32768
  s_and_b32 s50, s2, 1
  s_lshl_b32 s50, s50, 7
  s_add_u32 s64, s64, s50
  s_lshl_b32 s50, s46, 12
  s_add_u32 s64, s64, s50
  s_waitcnt vmcnt(5)
  v_lshlrev_b32 v24, 16, v16
  v_and_b32 v25, 0xffff0000, v16
  v_lshlrev_b32 v26, 16, v17
  v_and_b32 v27, 0xffff0000, v17
  v_lshlrev_b32 v28, 16, v18
  v_and_b32 v29, 0xffff0000, v18
  v_lshlrev_b32 v30, 16, v19
  v_and_b32 v31, 0xffff0000, v19
  s_waitcnt vmcnt(4)
  v_lshlrev_b32 v32, 16, v20
  v_and_b32 v33, 0xffff0000, v20
  v_lshlrev_b32 v34, 16, v21
  v_and_b32 v35, 0xffff0000, v21
  v_lshlrev_b32 v36, 16, v22
  v_and_b32 v37, 0xffff0000, v22
  v_lshlrev_b32 v38, 16, v23
  v_and_b32 v39, 0xffff0000, v23
  v_lshlrev_b32 v12, 7, v1
  s_mul_i32 s36, s46, 256
  s_add_u32 s36, s36, s53
  s_lshl_b32 s36, s36, 13
  s_add_u32 s37, s36, 0
  s_cmp_lt_u32 s37, 4196352
  s_cselect_b32 s37, s37, 0x40000000
  s_add_u32 s37, s37, 2095104
  buffer_load_dword v203, v12, s[4:7], s37 offen
  s_sub_u32 s49, s46, 4
  v_mul_u32_u24 v12, 6144, v1
  s_and_b32 s36, s53, 3
  s_lshl_b32 s36, s36, 9
  s_add_u32 s36, s36, 384
  s_lshl_b32 s38, s49, 5
  s_bfe_u32 s37, s53, 0x50003
  s_add_u32 s38, s38, s37
  s_mul_i32 s37, s38, 21846
  s_lshr_b32 s37, s37, 16
  s_mul_i32 vcc_lo, s37, 3
  s_sub_u32 vcc_lo, s38, vcc_lo
  s_mul_i32 vcc_lo, vcc_lo, 2048
  s_mul_i32 s37, s37, 393216
  s_add_u32 s37, s37, vcc_lo
  s_add_u32 s37, s37, s36
  s_cmp_lt_u32 s38, 48
  s_cselect_b32 s37, s37, 0x40000000
  s_bitcmp0_b32 s53, 0
  s_cselect_b32 s37, s37, 0x40000000
  buffer_load_dword v203, v12, s[4:7], s37 offen
  v_add_f32 v72, v24, v25
  v_mul_f32 v73, v24, v24
  v_add_f32 v74, v26, v27
  v_mul_f32 v75, v25, v25
  v_fmac_f32 v73, v26, v26
  v_fmac_f32 v75, v27, v27
  v_fmac_f32 v73, v28, v28
  v_add_f32 v72, v72, v28
  v_fmac_f32 v75, v29, v29
  v_add_f32 v74, v74, v29
  v_fmac_f32 v73, v30, v30
  v_add_f32 v72, v72, v30
  v_fmac_f32 v75, v31, v31
  v_add_f32 v74, v74, v31
  v_fmac_f32 v73, v32, v32
  v_add_f32 v72, v72, v32
  v_fmac_f32 v75, v33, v33
  v_add_f32 v74, v74, v33
  v_fmac_f32 v73, v34, v34
  v_add_f32 v72, v72, v34
  v_fmac_f32 v75, v35, v35
  v_add_f32 v74, v74, v35
  v_fmac_f32 v73, v36, v36
  v_add_f32 v72, v72, v36
  v_fmac_f32 v75, v37, v37
  v_add_f32 v74, v74, v37
  v_fmac_f32 v73, v38, v38
  v_add_f32 v72, v72, v38
  v_fmac_f32 v75, v39, v39
  v_add_f32 v74, v74, v39
  v_add_f32 v72, v72, v74
  v_add_f32 v73, v73, v75
  s_nop 0
  v_add_f32_dpp v94, v72, v72 row_ror:8 row_mask:0xf bank_mask:0xf
  v_add_f32_dpp v95, v73, v73 row_ror:8 row_mask:0xf bank_mask:0xf
  v_mov_b32 v72, v94
  v_mov_b32 v73, v95
  s_nop 0
  v_permlane16_swap_b32 v94, v72
  v_permlane16_swap_b32 v95, v73
  v_add_f32 v94, v94, v72
  v_add_f32 v95, v95, v73
  v_mov_b32 v72, v94
  v_mov_b32 v73, v95
  s_nop 0
  v_permlane32_swap_b32 v94, v72
  v_permlane32_swap_b32 v95, v73
  v_add_f32 v94, v94, v72
  v_add_f32 v95, v95, v73
  ds_write_b64 v92, v[94:95] offset:8192
  s_waitcnt vmcnt(2)
  v_add_f32 v40, v40, v48
  v_add_f32 v41, v41, v49
  v_add_f32 v42, v42, v50
  v_add_f32 v43, v43, v51
  v_add_f32 v44, v44, v52
  v_add_f32 v45, v45, v53
  v_add_f32 v46, v46, v54
  v_add_f32 v47, v47, v55
  v_add_f32 v40, v40, v44
  v_add_f32 v41, v41, v45
  v_add_f32 v42, v42, v46
  v_add_f32 v43, v43, v47
  v_cvt_pk_bf16_f32 v44, v40, v41
  v_lshlrev_b32 v40, 16, v44
  v_and_b32 v41, 0xffff0000, v44
  v_cvt_pk_bf16_f32 v44, v42, v43
  v_lshlrev_b32 v42, 16, v44
  v_and_b32 v43, 0xffff0000, v44
  v_add_f32 v40, v90, v40
  v_add_f32 v41, v90, v41
  v_add_f32 v42, v90, v42
  v_add_f32 v43, v90, v43
  v_cvt_pk_bf16_f32 v44, v40, v41
  v_lshlrev_b32 v40, 16, v44
  v_and_b32 v41, 0xffff0000, v44
  v_cvt_pk_bf16_f32 v44, v42, v43
  v_lshlrev_b32 v42, 16, v44
  v_and_b32 v43, 0xffff0000, v44
  ds_write_b128 v99, v[40:43] offset:0
  s_waitcnt lgkmcnt(0)
  s_barrier
  ds_read_b128 v[72:75], v91 offset:8192
  ds_read_b128 v[76:79], v91 offset:8208
  ds_read_b128 v[80:83], v91 offset:8224
  ds_read_b128 v[84:87], v91 offset:8240
  ds_read_b128 v[40:43], v97 offset:512
  ds_read_b128 v[56:59], v97 offset:0
  ds_read_b128 v[44:47], v97 offset:528
  ds_read_b128 v[60:63], v97 offset:16
  ds_read_b128 v[48:51], v97 offset:768
  ds_read_b128 v[64:67], v97 offset:256
  ds_read_b128 v[52:55], v97 offset:784
  ds_read_b128 v[68:71], v97 offset:272
  s_waitcnt lgkmcnt(8)
  v_add_f32 v72, v72, v80
  v_add_f32 v73, v73, v81
  v_add_f32 v74, v74, v82
  v_add_f32 v75, v75, v83
  v_add_f32 v76, v76, v84
  v_add_f32 v77, v77, v85
  v_add_f32 v78, v78, v86
  v_add_f32 v79, v79, v87
  v_add_f32 v72, v72, v76
  v_add_f32 v73, v73, v77
  v_add_f32 v74, v74, v78
  v_add_f32 v75, v75, v79
  v_add_f32 v72, v72, v74
  v_add_f32 v73, v73, v75
  v_mul_f32 v72, 0x3a800000, v72
  v_mul_f32 v73, 0x3a800000, v73
  v_fma_f32 v73, -v72, v72, v73
  v_max_f32 v73, 0, v73
  v_cvt_pk_bf16_f32 v73, v73, v73
  v_lshlrev_b32 v73, 16, v73
  v_add_f32 v73, 0x3727c5ac, v73
  v_cvt_pk_bf16_f32 v73, v73, v73
  v_lshlrev_b32 v73, 16, v73
  v_sqrt_f32 v73, v73
  v_cvt_pk_bf16_f32 v72, v72, v72
  v_lshlrev_b32 v72, 16, v72
  v_cvt_pk_bf16_f32 v73, v73, v73
  v_lshlrev_b32 v73, 16, v73
  v_rcp_f32 v73, v73
  s_nop 0
  v_mul_f32 v72, v72, v73
  s_waitcnt lgkmcnt(0)
  v_fma_f32 v24, v24, v73, -v72
  v_fma_f32 v25, v25, v73, -v72
  v_fma_f32 v26, v26, v73, -v72
  v_fma_f32 v27, v27, v73, -v72
  v_fma_f32 v28, v28, v73, -v72
  v_fma_f32 v29, v29, v73, -v72
  v_fma_f32 v30, v30, v73, -v72
  v_fma_f32 v31, v31, v73, -v72
  v_fma_f32 v24, v24, v40, v56
  v_fma_f32 v25, v25, v41, v57
  v_fma_f32 v26, v26, v42, v58
  v_fma_f32 v27, v27, v43, v59
  v_fma_f32 v28, v28, v44, v60
  v_fma_f32 v29, v29, v45, v61
  v_fma_f32 v30, v30, v46, v62
  v_fma_f32 v31, v31, v47, v63
  v_cvt_pk_bf16_f32 v16, v24, v25
  v_cvt_pk_bf16_f32 v17, v26, v27
  v_cvt_pk_bf16_f32 v18, v28, v29
  v_cvt_pk_bf16_f32 v19, v30, v31
  s_nop 1
  v_permlane16_swap_b32 v16, v18
  v_permlane16_swap_b32 v17, v19
  buffer_store_dwordx4 v[16:19], v96, s[8:11], s64 offen offset:0 sc1
  v_fma_f32 v32, v32, v73, -v72
  v_fma_f32 v33, v33, v73, -v72
  v_fma_f32 v34, v34, v73, -v72
  v_fma_f32 v35, v35, v73, -v72
  v_fma_f32 v36, v36, v73, -v72
  v_fma_f32 v37, v37, v73, -v72
  v_fma_f32 v38, v38, v73, -v72
  v_fma_f32 v39, v39, v73, -v72
  v_fma_f32 v32, v32, v48, v64
  v_fma_f32 v33, v33, v49, v65
  v_fma_f32 v34, v34, v50, v66
  v_fma_f32 v35, v35, v51, v67
  v_fma_f32 v36, v36, v52, v68
  v_fma_f32 v37, v37, v53, v69
  v_fma_f32 v38, v38, v54, v70
  v_fma_f32 v39, v39, v55, v71
  v_cvt_pk_bf16_f32 v20, v32, v33
  v_cvt_pk_bf16_f32 v21, v34, v35
  v_cvt_pk_bf16_f32 v22, v36, v37
  v_cvt_pk_bf16_f32 v23, v38, v39
  s_nop 1
  v_permlane16_swap_b32 v20, v22
  v_permlane16_swap_b32 v21, v23
  buffer_store_dwordx4 v[20:23], v96, s[8:11], s64 offen offset:2048 sc1
  s_lshl_b32 s54, s2, 7
  s_add_u32 s54, s54, 131072
  v_mov_b32 v8, 1
  v_mov_b32 v9, 0
  s_waitcnt vmcnt(0) lgkmcnt(0)
  s_barrier
  s_cmp_lg_u32 s46, 0
  s_cbranch_scc1 SM_g1fa
  s_mov_b64 exec, 1
  buffer_store_dword v8, v9, s[32:35], s54 offen sc1
  s_mov_b64 exec, -1
SM_g1fa:
  s_mov_b32 s66, 0
  s_mul_i32 s61, s66, 393216
  s_add_u32 m0, s63, 0
  s_nop 0
  buffer_load_dwordx4 v176, s[4:7], s61 offen  lds
  s_add_u32 m0, s63, 8192
  s_nop 0
  buffer_load_dwordx4 v177, s[4:7], s61 offen  lds
  s_add_u32 m0, s63, 16384
  s_nop 0
  buffer_load_dwordx4 v178, s[4:7], s61 offen  lds
  s_cmp_eq_u32 s65, 1
  s_cselect_b32 s67, 5, 1
  s_mul_i32 s61, s67, 393216
  s_add_u32 m0, s63, 24576
  s_nop 0
  buffer_load_dwordx4 v176, s[4:7], s61 offen  lds
  s_add_u32 m0, s63, 32768
  s_nop 0
  buffer_load_dwordx4 v177, s[4:7], s61 offen  lds
  s_add_u32 m0, s63, 40960
  s_nop 0
  buffer_load_dwordx4 v178, s[4:7], s61 offen  lds
  s_cmp_eq_u32 s65, 2
  s_cselect_b32 s68, 6, 2
  s_mul_i32 s61, s68, 393216
  s_add_u32 m0, s63, 49152
  s_nop 0
  buffer_load_dwordx4 v176, s[4:7], s61 offen  lds
  s_add_u32 m0, s63, 57344
  s_nop 0
  buffer_load_dwordx4 v177, s[4:7], s61 offen  lds
  s_add_u32 m0, s63, 65536
  s_nop 0
  buffer_load_dwordx4 v178, s[4:7], s61 offen  lds
  s_cmp_lg_u32 s46, 0
  s_cbranch_scc1 SM_g1fx
  s_mov_b32 s55, 131072
  s_lshl_b32 s49, s47, 4
  s_sub_u32 s49, s49, 2
  v_min_u32 v9, 17, v1
  v_add_u32 v9, s49, v9
  v_max_i32 v9, 0, v9
  v_lshlrev_b32 v9, 7, v9
  s_mov_b32 s56, 60000
SM_g1f:
  buffer_load_dword v8, v9, s[32:35], s55 offen sc1
  s_sub_u32 s56, s56, 1
  s_cmp_eq_u32 s56, 0
  s_waitcnt vmcnt(0)
  s_cbranch_scc1 SM_g1fx
  v_cmp_ne_u32 vcc, 1, v8
  s_nop 4
  s_cbranch_vccnz SM_g1f
SM_g1fx:
  s_barrier
  s_mul_i32 s60, s66, 2048
  s_add_u32 m0, s59, 98304
  s_nop 0
  buffer_load_dword v200, s[8:11], s60 offen sc1 lds
  s_mul_i32 s62, s66, 2048
  buffer_load_dwordx4 v[104:107], v179, s[8:11], s62 offen sc1
  buffer_load_dwordx4 v[108:111], v180, s[8:11], s62 offen sc1
  s_mul_i32 s60, s67, 2048
  s_add_u32 m0, s59, 100352
  s_nop 0
  buffer_load_dword v200, s[8:11], s60 offen sc1 lds
  s_mul_i32 s60, s68, 2048
  s_add_u32 m0, s59, 102400
  s_nop 0
  buffer_load_dword v200, s[8:11], s60 offen sc1 lds
  s_waitcnt vmcnt(4)
  s_barrier
  ds_read_b64_tr_b16 v[128:129], v152 offset:0
  ds_read_b64_tr_b16 v[130:131], v152 offset:2048
  ds_read_b64_tr_b16 v[132:133], v153 offset:0
  ds_read_b64_tr_b16 v[134:135], v153 offset:2048
  ds_read_b64_tr_b16 v[136:137], v154 offset:0
  ds_read_b64_tr_b16 v[138:139], v154 offset:2048
  ds_read_b64_tr_b16 v[140:141], v155 offset:0
  ds_read_b64_tr_b16 v[142:143], v155 offset:2048
  ds_read_b64_tr_b16 v[144:145], v156 offset:0
  ds_read_b64_tr_b16 v[146:147], v156 offset:2048
  ds_read_b128 v[192:195], v201 offset:0
  s_waitcnt vmcnt(2) lgkmcnt(7)
  v_mfma_f32_16x16x32_bf16 v[8:11], v[128:131], v[104:107], 0
  ds_read_b64_tr_b16 v[148:149], v157 offset:0
  s_mul_i32 s62, s67, 2048
  v_mfma_f32_16x16x32_bf16 v[12:15], v[128:131], v[108:111], 0
  ds_read_b64_tr_b16 v[150:151], v157 offset:2048
  buffer_load_dwordx4 v[112:115], v179, s[8:11], s62 offen sc1
  s_setprio 1
  v_mfma_f32_16x16x32_bf16 v[16:19], v[132:135], v[104:107], 0
  ds_read_b64_tr_b16 v[128:129], v158 offset:0
  v_mfma_f32_16x16x32_bf16 v[20:23], v[132:135], v[108:111], 0
  ds_read_b64_tr_b16 v[130:131], v158 offset:2048
  buffer_load_dwordx4 v[116:119], v180, s[8:11], s62 offen sc1
  s_waitcnt lgkmcnt(4)
  v_mfma_f32_16x16x32_bf16 v[24:27], v[136:139], v[104:107], 0
  ds_read_b64_tr_b16 v[132:133], v159 offset:0
  s_mul_i32 s62, s68, 2048
  v_mfma_f32_16x16x32_bf16 v[28:31], v[136:139], v[108:111], 0
  ds_read_b64_tr_b16 v[134:135], v159 offset:2048
  buffer_load_dwordx4 v[120:123], v179, s[8:11], s62 offen sc1
  v_mfma_f32_16x16x32_bf16 v[184:187], v[136:139], v[192:195], 0
  v_mfma_f32_16x16x32_bf16 v[32:35], v[140:143], v[104:107], 0
  ds_read_b64_tr_b16 v[136:137], v160 offset:0
  v_mfma_f32_16x16x32_bf16 v[36:39], v[140:143], v[108:111], 0
  ds_read_b64_tr_b16 v[138:139], v160 offset:2048
  buffer_load_dwordx4 v[124:127], v180, s[8:11], s62 offen sc1
  s_setprio 0
  s_waitcnt lgkmcnt(6)
  v_mfma_f32_16x16x32_bf16 v[40:43], v[144:147], v[104:107], 0
  ds_read_b64_tr_b16 v[140:141], v161 offset:0
  v_mfma_f32_16x16x32_bf16 v[44:47], v[144:147], v[108:111], 0
  ds_read_b64_tr_b16 v[142:143], v161 offset:2048
  v_mfma_f32_16x16x32_bf16 v[48:51], v[148:151], v[104:107], 0
  ds_read_b64_tr_b16 v[144:145], v162 offset:0
  v_mfma_f32_16x16x32_bf16 v[52:55], v[148:151], v[108:111], 0
  ds_read_b64_tr_b16 v[146:147], v162 offset:2048
  s_waitcnt lgkmcnt(6)
  v_mfma_f32_16x16x32_bf16 v[56:59], v[128:131], v[104:107], 0
  ds_read_b64_tr_b16 v[148:149], v163 offset:0
  v_mfma_f32_16x16x32_bf16 v[60:63], v[128:131], v[108:111], 0
  ds_read_b64_tr_b16 v[150:151], v163 offset:2048
  s_waitcnt vmcnt(5)
  s_barrier
  s_setprio 3
  v_mfma_f32_16x16x32_bf16 v[64:67], v[132:135], v[104:107], 0
  ds_read_b64_tr_b16 v[128:129], v152 offset:24576
  s_cmp_eq_u32 s65, 3
  s_cselect_b32 s69, 7, 3
  s_mul_i32 s61, s69, 393216
  s_add_u32 m0, s63, 73728
  v_mfma_f32_16x16x32_bf16 v[68:71], v[132:135], v[108:111], 0
  ds_read_b64_tr_b16 v[130:131], v152 offset:26624
  buffer_load_dwordx4 v176, s[4:7], s61 offen  lds
  s_waitcnt lgkmcnt(6)
  v_mfma_f32_16x16x32_bf16 v[72:75], v[136:139], v[104:107], 0
  ds_read_b64_tr_b16 v[132:133], v153 offset:24576
  v_mfma_f32_16x16x32_bf16 v[76:79], v[136:139], v[108:111], 0
  ds_read_b64_tr_b16 v[134:135], v153 offset:26624
  v_mfma_f32_16x16x32_bf16 v[188:191], v[136:139], v[192:195], 0
  v_mfma_f32_16x16x32_bf16 v[80:83], v[140:143], v[104:107], 0
  ds_read_b64_tr_b16 v[136:137], v154 offset:24576
  s_add_u32 m0, s63, 81920
  s_setprio 2
  v_mfma_f32_16x16x32_bf16 v[84:87], v[140:143], v[108:111], 0
  ds_read_b64_tr_b16 v[138:139], v154 offset:26624
  buffer_load_dwordx4 v177, s[4:7], s61 offen  lds
  ds_read_b128 v[196:199], v201 offset:2048
  s_waitcnt lgkmcnt(7)
  v_mfma_f32_16x16x32_bf16 v[88:91], v[144:147], v[104:107], 0
  ds_read_b64_tr_b16 v[140:141], v155 offset:24576
  v_mfma_f32_16x16x32_bf16 v[92:95], v[144:147], v[108:111], 0
  ds_read_b64_tr_b16 v[142:143], v155 offset:26624
  v_mfma_f32_16x16x32_bf16 v[96:99], v[148:151], v[104:107], 0
  ds_read_b64_tr_b16 v[144:145], v156 offset:24576
  s_add_u32 m0, s63, 90112
  v_mfma_f32_16x16x32_bf16 v[100:103], v[148:151], v[108:111], 0
  ds_read_b64_tr_b16 v[146:147], v156 offset:26624
  buffer_load_dwordx4 v178, s[4:7], s61 offen  lds
  s_waitcnt vmcnt(5) lgkmcnt(7)
  v_mfma_f32_16x16x32_bf16 v[8:11], v[128:131], v[112:115], v[8:11]
  ds_read_b64_tr_b16 v[148:149], v157 offset:24576
  v_mfma_f32_16x16x32_bf16 v[12:15], v[128:131], v[116:119], v[12:15]
  ds_read_b64_tr_b16 v[150:151], v157 offset:26624
  s_setprio 1
  v_mfma_f32_16x16x32_bf16 v[16:19], v[132:135], v[112:115], v[16:19]
  ds_read_b64_tr_b16 v[128:129], v158 offset:24576
  s_mul_i32 s62, s69, 2048
  v_mfma_f32_16x16x32_bf16 v[20:23], v[132:135], v[116:119], v[20:23]
  ds_read_b64_tr_b16 v[130:131], v158 offset:26624
  buffer_load_dwordx4 v[104:107], v179, s[8:11], s62 offen sc1
  s_waitcnt lgkmcnt(6)
  v_mfma_f32_16x16x32_bf16 v[24:27], v[136:139], v[112:115], v[24:27]
  ds_read_b64_tr_b16 v[132:133], v159 offset:24576
  v_mfma_f32_16x16x32_bf16 v[28:31], v[136:139], v[116:119], v[28:31]
  ds_read_b64_tr_b16 v[134:135], v159 offset:26624
  v_mfma_f32_16x16x32_bf16 v[184:187], v[136:139], v[196:199], v[184:187]
  v_mfma_f32_16x16x32_bf16 v[32:35], v[140:143], v[112:115], v[32:35]
  ds_read_b64_tr_b16 v[136:137], v160 offset:24576
  v_mfma_f32_16x16x32_bf16 v[36:39], v[140:143], v[116:119], v[36:39]
  ds_read_b64_tr_b16 v[138:139], v160 offset:26624
  buffer_load_dwordx4 v[108:111], v180, s[8:11], s62 offen sc1
  s_setprio 0
  s_waitcnt lgkmcnt(6)
  v_mfma_f32_16x16x32_bf16 v[40:43], v[144:147], v[112:115], v[40:43]
  ds_read_b64_tr_b16 v[140:141], v161 offset:24576
  v_mfma_f32_16x16x32_bf16 v[44:47], v[144:147], v[116:119], v[44:47]
  ds_read_b64_tr_b16 v[142:143], v161 offset:26624
  v_mfma_f32_16x16x32_bf16 v[48:51], v[148:151], v[112:115], v[48:51]
  ds_read_b64_tr_b16 v[144:145], v162 offset:24576
  s_mul_i32 s60, s69, 2048
  s_add_u32 m0, s59, 104448
  v_mfma_f32_16x16x32_bf16 v[52:55], v[148:151], v[116:119], v[52:55]
  ds_read_b64_tr_b16 v[146:147], v162 offset:26624
  buffer_load_dword v200, s[8:11], s60 offen sc1 lds
  s_waitcnt lgkmcnt(6)
  v_mfma_f32_16x16x32_bf16 v[56:59], v[128:131], v[112:115], v[56:59]
  ds_read_b64_tr_b16 v[148:149], v163 offset:24576
  v_mfma_f32_16x16x32_bf16 v[60:63], v[128:131], v[116:119], v[60:63]
  ds_read_b64_tr_b16 v[150:151], v163 offset:26624
  s_waitcnt vmcnt(10)
  s_barrier
  s_setprio 3
  v_mfma_f32_16x16x32_bf16 v[64:67], v[132:135], v[112:115], v[64:67]
  ds_read_b64_tr_b16 v[128:129], v152 offset:49152
  s_cmp_eq_u32 s65, 0
  s_cselect_b32 s66, 8, 4
  s_cbranch_scc0 PG1_g1
  buffer_load_dword v203, v202, s[72:75], s76 offen
  s_add_u32 s76, s76, 2097152
PG1_g1:
  s_mul_i32 s61, s66, 393216
  s_add_u32 m0, s63, 0
  v_mfma_f32_16x16x32_bf16 v[68:71], v[132:135], v[116:119], v[68:71]
  ds_read_b64_tr_b16 v[130:131], v152 offset:51200
  buffer_load_dwordx4 v176, s[4:7], s61 offen  lds
  s_waitcnt lgkmcnt(6)
  v_mfma_f32_16x16x32_bf16 v[72:75], v[136:139], v[112:115], v[72:75]
  ds_read_b64_tr_b16 v[132:133], v153 offset:49152
  v_mfma_f32_16x16x32_bf16 v[76:79], v[136:139], v[116:119], v[76:79]
  ds_read_b64_tr_b16 v[134:135], v153 offset:51200
  v_mfma_f32_16x16x32_bf16 v[188:191], v[136:139], v[196:199], v[188:191]
  v_mfma_f32_16x16x32_bf16 v[80:83], v[140:143], v[112:115], v[80:83]
  ds_read_b64_tr_b16 v[136:137], v154 offset:49152
  s_add_u32 m0, s63, 8192
  s_setprio 2
  v_mfma_f32_16x16x32_bf16 v[84:87], v[140:143], v[116:119], v[84:87]
  ds_read_b64_tr_b16 v[138:139], v154 offset:51200
  buffer_load_dwordx4 v177, s[4:7], s61 offen  lds
HOP0:
  s_cbranch_execz WRET0
  ds_read_b128 v[192:195], v201 offset:4096
  s_waitcnt lgkmcnt(7)
  v_mfma_f32_16x16x32_bf16 v[88:91], v[144:147], v[112:115], v[88:91]
  ds_read_b64_tr_b16 v[140:141], v155 offset:49152
  v_mfma_f32_16x16x32_bf16 v[92:95], v[144:147], v[116:119], v[92:95]
  ds_read_b64_tr_b16 v[142:143], v155 offset:51200
  v_mfma_f32_16x16x32_bf16 v[96:99], v[148:151], v[112:115], v[96:99]
  ds_read_b64_tr_b16 v[144:145], v156 offset:49152
  s_add_u32 m0, s63, 16384
  v_mfma_f32_16x16x32_bf16 v[100:103], v[148:151], v[116:119], v[100:103]
  ds_read_b64_tr_b16 v[146:147], v156 offset:51200
  buffer_load_dwordx4 v178, s[4:7], s61 offen  lds
  s_waitcnt vmcnt(9) lgkmcnt(7)
  v_mfma_f32_16x16x32_bf16 v[8:11], v[128:131], v[120:123], v[8:11]
  ds_read_b64_tr_b16 v[148:149], v157 offset:49152
  v_mfma_f32_16x16x32_bf16 v[12:15], v[128:131], v[124:127], v[12:15]
  ds_read_b64_tr_b16 v[150:151], v157 offset:51200
  s_setprio 1
  v_mfma_f32_16x16x32_bf16 v[16:19], v[132:135], v[120:123], v[16:19]
  ds_read_b64_tr_b16 v[128:129], v158 offset:49152
  s_mul_i32 s62, s66, 2048
  v_mfma_f32_16x16x32_bf16 v[20:23], v[132:135], v[124:127], v[20:23]
  ds_read_b64_tr_b16 v[130:131], v158 offset:51200
  buffer_load_dwordx4 v[112:115], v179, s[8:11], s62 offen sc1
  s_waitcnt lgkmcnt(6)
  v_mfma_f32_16x16x32_bf16 v[24:27], v[136:139], v[120:123], v[24:27]
  ds_read_b64_tr_b16 v[132:133], v159 offset:49152
  v_mfma_f32_16x16x32_bf16 v[28:31], v[136:139], v[124:127], v[28:31]
  ds_read_b64_tr_b16 v[134:135], v159 offset:51200
  v_mfma_f32_16x16x32_bf16 v[184:187], v[136:139], v[192:195], v[184:187]
  v_mfma_f32_16x16x32_bf16 v[32:35], v[140:143], v[120:123], v[32:35]
  ds_read_b64_tr_b16 v[136:137], v160 offset:49152
  v_mfma_f32_16x16x32_bf16 v[36:39], v[140:143], v[124:127], v[36:39]
  ds_read_b64_tr_b16 v[138:139], v160 offset:51200
  buffer_load_dwordx4 v[116:119], v180, s[8:11], s62 offen sc1
  s_setprio 0
  s_waitcnt lgkmcnt(6)
  v_mfma_f32_16x16x32_bf16 v[40:43], v[144:147], v[120:123], v[40:43]
  ds_read_b64_tr_b16 v[140:141], v161 offset:49152
  v_mfma_f32_16x16x32_bf16 v[44:47], v[144:147], v[124:127], v[44:47]
  ds_read_b64_tr_b16 v[142:143], v161 offset:51200
  v_mfma_f32_16x16x32_bf16 v[48:51], v[148:151], v[120:123], v[48:51]
  ds_read_b64_tr_b16 v[144:145], v162 offset:49152
  s_mul_i32 s60, s66, 2048
  s_add_u32 m0, s59, 98304
  v_mfma_f32_16x16x32_bf16 v[52:55], v[148:151], v[124:127], v[52:55]
  ds_read_b64_tr_b16 v[146:147], v162 offset:51200
  buffer_load_dword v200, s[8:11], s60 offen sc1 lds
  s_waitcnt lgkmcnt(6)
  v_mfma_f32_16x16x32_bf16 v[56:59], v[128:131], v[120:123], v[56:59]
  ds_read_b64_tr_b16 v[148:149], v163 offset:49152
  v_mfma_f32_16x16x32_bf16 v[60:63], v[128:131], v[124:127], v[60:63]
  ds_read_b64_tr_b16 v[150:151], v163 offset:51200
  s_waitcnt vmcnt(6)
  s_barrier
  s_setprio 3
  v_mfma_f32_16x16x32_bf16 v[64:67], v[132:135], v[120:123], v[64:67]
  ds_read_b64_tr_b16 v[128:129], v164 offset:8192
  s_cmp_eq_u32 s65, 1
  s_cselect_b32 s67, 9, 5
  s_cbranch_scc0 PG2_g1
  buffer_load_dword v203, v202, s[72:75], s76 offen
  s_add_u32 s76, s76, 2097152
PG2_g1:
  s_mul_i32 s61, s67, 393216
  s_add_u32 m0, s63, 24576
  v_mfma_f32_16x16x32_bf16 v[68:71], v[132:135], v[124:127], v[68:71]
  ds_read_b64_tr_b16 v[130:131], v164 offset:10240
  buffer_load_dwordx4 v176, s[4:7], s61 offen  lds
  s_waitcnt lgkmcnt(6)
  v_mfma_f32_16x16x32_bf16 v[72:75], v[136:139], v[120:123], v[72:75]
  ds_read_b64_tr_b16 v[132:133], v165 offset:8192
  v_mfma_f32_16x16x32_bf16 v[76:79], v[136:139], v[124:127], v[76:79]
  ds_read_b64_tr_b16 v[134:135], v165 offset:10240
  v_mfma_f32_16x16x32_bf16 v[188:191], v[136:139], v[192:195], v[188:191]
  v_mfma_f32_16x16x32_bf16 v[80:83], v[140:143], v[120:123], v[80:83]
  ds_read_b64_tr_b16 v[136:137], v166 offset:8192
  s_add_u32 m0, s63, 32768
  s_setprio 2
  v_mfma_f32_16x16x32_bf16 v[84:87], v[140:143], v[124:127], v[84:87]
  ds_read_b64_tr_b16 v[138:139], v166 offset:10240
  buffer_load_dwordx4 v177, s[4:7], s61 offen  lds
  ds_read_b128 v[196:199], v201 offset:6144
  s_waitcnt lgkmcnt(7)
  v_mfma_f32_16x16x32_bf16 v[88:91], v[144:147], v[120:123], v[88:91]
  ds_read_b64_tr_b16 v[140:141], v167 offset:8192
  v_mfma_f32_16x16x32_bf16 v[92:95], v[144:147], v[124:127], v[92:95]
  ds_read_b64_tr_b16 v[142:143], v167 offset:10240
  v_mfma_f32_16x16x32_bf16 v[96:99], v[148:151], v[120:123], v[96:99]
  ds_read_b64_tr_b16 v[144:145], v168 offset:8192
  s_add_u32 m0, s63, 40960
  v_mfma_f32_16x16x32_bf16 v[100:103], v[148:151], v[124:127], v[100:103]
  ds_read_b64_tr_b16 v[146:147], v168 offset:10240
  buffer_load_dwordx4 v178, s[4:7], s61 offen  lds
  s_waitcnt vmcnt(10) lgkmcnt(7)
  v_mfma_f32_16x16x32_bf16 v[8:11], v[128:131], v[104:107], v[8:11]
  ds_read_b64_tr_b16 v[148:149], v169 offset:8192
  v_mfma_f32_16x16x32_bf16 v[12:15], v[128:131], v[108:111], v[12:15]
  ds_read_b64_tr_b16 v[150:151], v169 offset:10240
  s_setprio 1
  v_mfma_f32_16x16x32_bf16 v[16:19], v[132:135], v[104:107], v[16:19]
  ds_read_b64_tr_b16 v[128:129], v170 offset:8192
  s_mul_i32 s62, s67, 2048
  v_mfma_f32_16x16x32_bf16 v[20:23], v[132:135], v[108:111], v[20:23]
  ds_read_b64_tr_b16 v[130:131], v170 offset:10240
  buffer_load_dwordx4 v[120:123], v179, s[8:11], s62 offen sc1
  s_waitcnt lgkmcnt(6)
  v_mfma_f32_16x16x32_bf16 v[24:27], v[136:139], v[104:107], v[24:27]
  ds_read_b64_tr_b16 v[132:133], v171 offset:8192
  s_mul_i32 s49, s52, 12288
  v_mfma_f32_16x16x32_bf16 v[28:31], v[136:139], v[108:111], v[28:31]
  ds_read_b64_tr_b16 v[134:135], v171 offset:10240
  s_mul_i32 s50, s51, 106496
  v_mfma_f32_16x16x32_bf16 v[184:187], v[136:139], v[196:199], v[184:187]
  v_mfma_f32_16x16x32_bf16 v[32:35], v[140:143], v[104:107], v[32:35]
  ds_read_b64_tr_b16 v[136:137], v172 offset:8192
  s_add_u32 s50, s50, s49
  v_mfma_f32_16x16x32_bf16 v[36:39], v[140:143], v[108:111], v[36:39]
  ds_read_b64_tr_b16 v[138:139], v172 offset:10240
  buffer_load_dwordx4 v[124:127], v180, s[8:11], s62 offen sc1
  s_setprio 0
  v_add_u32 v204, s50, v2
  s_waitcnt lgkmcnt(6)
  v_mfma_f32_16x16x32_bf16 v[40:43], v[144:147], v[104:107], v[40:43]
  ds_read_b64_tr_b16 v[140:141], v173 offset:8192
  s_xor_b32 s50, s51, 1
  v_mfma_f32_16x16x32_bf16 v[44:47], v[144:147], v[108:111], v[44:47]
  ds_read_b64_tr_b16 v[142:143], v173 offset:10240
  s_mul_i32 s50, s50, 106496
  v_mfma_f32_16x16x32_bf16 v[48:51], v[148:151], v[104:107], v[48:51]
  ds_read_b64_tr_b16 v[144:145], v174 offset:8192
  s_mul_i32 s60, s67, 2048
  s_add_u32 m0, s59, 100352
  s_add_u32 s50, s50, s49
  v_mfma_f32_16x16x32_bf16 v[52:55], v[148:151], v[108:111], v[52:55]
  ds_read_b64_tr_b16 v[146:147], v174 offset:10240
  buffer_load_dword v200, s[8:11], s60 offen sc1 lds
  v_add_u32 v205, s50, v2
  s_waitcnt lgkmcnt(6)
  v_mfma_f32_16x16x32_bf16 v[56:59], v[128:131], v[104:107], v[56:59]
  ds_read_b64_tr_b16 v[148:149], v175 offset:8192
  s_lshl_b32 s49, s46, 10
  v_mfma_f32_16x16x32_bf16 v[60:63], v[128:131], v[108:111], v[60:63]
  ds_read_b64_tr_b16 v[150:151], v175 offset:10240
  s_add_u32 s49, s49, 155648
  s_waitcnt vmcnt(6)
  s_barrier
  s_setprio 3
  v_mfma_f32_16x16x32_bf16 v[64:67], v[132:135], v[104:107], v[64:67]
  ds_read_b64_tr_b16 v[128:129], v152 offset:0
  s_cmp_eq_u32 s65, 2
  s_cselect_b32 s68, 10, 6
  s_cbranch_scc0 PG3_g1
  buffer_load_dword v203, v202, s[72:75], s76 offen
  s_add_u32 s76, s76, 2097152
PG3_g1:
  s_mul_i32 s61, s68, 393216
  s_add_u32 m0, s63, 49152
  v_add_u32 v213, s49, v2
  v_mfma_f32_16x16x32_bf16 v[68:71], v[132:135], v[108:111], v[68:71]
  ds_read_b64_tr_b16 v[130:131], v152 offset:2048
  buffer_load_dwordx4 v176, s[4:7], s61 offen  lds
  v_xor_b32 v214, 4096, v213
  s_waitcnt lgkmcnt(6)
  v_mfma_f32_16x16x32_bf16 v[72:75], v[136:139], v[104:107], v[72:75]
  ds_read_b64_tr_b16 v[132:133], v153 offset:0
  s_xor_b32 s49, s52, 0
  v_mfma_f32_16x16x32_bf16 v[76:79], v[136:139], v[108:111], v[76:79]
  ds_read_b64_tr_b16 v[134:135], v153 offset:2048
  s_lshr_b32 s50, s49, 1
  v_mfma_f32_16x16x32_bf16 v[188:191], v[136:139], v[196:199], v[188:191]
  v_mfma_f32_16x16x32_bf16 v[80:83], v[140:143], v[104:107], v[80:83]
  ds_read_b64_tr_b16 v[136:137], v154 offset:0
  s_add_u32 m0, s63, 57344
  s_setprio 2
  s_lshl_b32 s64, s51, 1
  v_mfma_f32_16x16x32_bf16 v[84:87], v[140:143], v[108:111], v[84:87]
  ds_read_b64_tr_b16 v[138:139], v154 offset:2048
  buffer_load_dwordx4 v177, s[4:7], s61 offen  lds
  ds_read_b128 v[192:195], v201 offset:0
  s_add_u32 s50, s50, s64
  s_waitcnt lgkmcnt(7)
  v_mfma_f32_16x16x32_bf16 v[88:91], v[144:147], v[104:107], v[88:91]
  ds_read_b64_tr_b16 v[140:141], v155 offset:0
  s_mul_i32 s50, s50, 9216
  v_mfma_f32_16x16x32_bf16 v[92:95], v[144:147], v[108:111], v[92:95]
  ds_read_b64_tr_b16 v[142:143], v155 offset:2048
  s_and_b32 s49, s49, 1
  v_mfma_f32_16x16x32_bf16 v[96:99], v[148:151], v[104:107], v[96:99]
  ds_read_b64_tr_b16 v[144:145], v156 offset:0
  s_add_u32 m0, s63, 65536
  s_lshl_b32 s49, s49, 3
  v_mfma_f32_16x16x32_bf16 v[100:103], v[148:151], v[108:111], v[100:103]
  ds_read_b64_tr_b16 v[146:147], v156 offset:2048
  buffer_load_dwordx4 v178, s[4:7], s61 offen  lds
  s_add_u32 s50, s50, s49
  s_waitcnt vmcnt(10) lgkmcnt(7)
  v_mfma_f32_16x16x32_bf16 v[8:11], v[128:131], v[112:115], v[8:11]
  ds_read_b64_tr_b16 v[148:149], v157 offset:0
  s_add_u32 s50, s50, 49152
  v_mfma_f32_16x16x32_bf16 v[12:15], v[128:131], v[116:119], v[12:15]
  ds_read_b64_tr_b16 v[150:151], v157 offset:2048
  s_setprio 1
  v_add_u32 v210, s50, v2
  v_mfma_f32_16x16x32_bf16 v[16:19], v[132:135], v[112:115], v[16:19]
  ds_read_b64_tr_b16 v[128:129], v158 offset:0
  s_mul_i32 s62, s68, 2048
  s_lshl_b32 s49, s52, 11
  v_mfma_f32_16x16x32_bf16 v[20:23], v[132:135], v[116:119], v[20:23]
  ds_read_b64_tr_b16 v[130:131], v158 offset:2048
  buffer_load_dwordx4 v[104:107], v179, s[8:11], s62 offen sc1
  s_add_u32 s50, s50, s49
  s_waitcnt lgkmcnt(6)
  v_mfma_f32_16x16x32_bf16 v[24:27], v[136:139], v[112:115], v[24:27]
  ds_read_b64_tr_b16 v[132:133], v159 offset:0
  v_add_u32 v206, s50, v2
  v_mfma_f32_16x16x32_bf16 v[28:31], v[136:139], v[116:119], v[28:31]
  ds_read_b64_tr_b16 v[134:135], v159 offset:2048
  s_xor_b32 s49, s52, 1
  v_mfma_f32_16x16x32_bf16 v[184:187], v[136:139], v[192:195], v[184:187]
  v_mfma_f32_16x16x32_bf16 v[32:35], v[140:143], v[112:115], v[32:35]
  ds_read_b64_tr_b16 v[136:137], v160 offset:0
  s_lshr_b32 s50, s49, 1
  v_mfma_f32_16x16x32_bf16 v[36:39], v[140:143], v[116:119], v[36:39]
  ds_read_b64_tr_b16 v[138:139], v160 offset:2048
  buffer_load_dwordx4 v[108:111], v180, s[8:11], s62 offen sc1
  s_setprio 0
  s_lshl_b32 s64, s51, 1
  s_waitcnt lgkmcnt(6)
  v_mfma_f32_16x16x32_bf16 v[40:43], v[144:147], v[112:115], v[40:43]
  ds_read_b64_tr_b16 v[140:141], v161 offset:0
  s_add_u32 s50, s50, s64
  v_mfma_f32_16x16x32_bf16 v[44:47], v[144:147], v[116:119], v[44:47]
  ds_read_b64_tr_b16 v[142:143], v161 offset:2048
  s_mul_i32 s50, s50, 9216
  v_mfma_f32_16x16x32_bf16 v[48:51], v[148:151], v[112:115], v[48:51]
  ds_read_b64_tr_b16 v[144:145], v162 offset:0
  s_mul_i32 s60, s68, 2048
  s_add_u32 m0, s59, 102400
  s_and_b32 s49, s49, 1
  v_mfma_f32_16x16x32_bf16 v[52:55], v[148:151], v[116:119], v[52:55]
  ds_read_b64_tr_b16 v[146:147], v162 offset:2048
  buffer_load_dword v200, s[8:11], s60 offen sc1 lds
  s_lshl_b32 s49, s49, 3
  s_waitcnt lgkmcnt(6)
  v_mfma_f32_16x16x32_bf16 v[56:59], v[128:131], v[112:115], v[56:59]
  ds_read_b64_tr_b16 v[148:149], v163 offset:0
  s_add_u32 s50, s50, s49
  v_mfma_f32_16x16x32_bf16 v[60:63], v[128:131], v[116:119], v[60:63]
  ds_read_b64_tr_b16 v[150:151], v163 offset:2048
  s_add_u32 s50, s50, 49152
  s_waitcnt vmcnt(6)
  s_barrier
  s_setprio 3
  v_mfma_f32_16x16x32_bf16 v[64:67], v[132:135], v[112:115], v[64:67]
  ds_read_b64_tr_b16 v[128:129], v152 offset:24576
  s_cmp_eq_u32 s65, 3
  s_cselect_b32 s69, 11, 7
  s_cbranch_scc0 PG4_g1
  buffer_load_dword v203, v202, s[72:75], s76 offen
  s_add_u32 s76, s76, 2097152
PG4_g1:
  s_mul_i32 s61, s69, 393216
  s_add_u32 m0, s63, 73728
  s_lshl_b32 s49, s52, 11
  v_mfma_f32_16x16x32_bf16 v[68:71], v[132:135], v[116:119], v[68:71]
  ds_read_b64_tr_b16 v[130:131], v152 offset:26624
  buffer_load_dwordx4 v176, s[4:7], s61 offen  lds
  s_add_u32 s50, s50, s49
  s_waitcnt lgkmcnt(6)
  v_mfma_f32_16x16x32_bf16 v[72:75], v[136:139], v[112:115], v[72:75]
  ds_read_b64_tr_b16 v[132:133], v153 offset:24576
  v_add_u32 v207, s50, v2
  v_mfma_f32_16x16x32_bf16 v[76:79], v[136:139], v[116:119], v[76:79]
  ds_read_b64_tr_b16 v[134:135], v153 offset:26624
  s_xor_b32 s49, s52, 2
  v_mfma_f32_16x16x32_bf16 v[188:191], v[136:139], v[192:195], v[188:191]
  v_mfma_f32_16x16x32_bf16 v[80:83], v[140:143], v[112:115], v[80:83]
  ds_read_b64_tr_b16 v[136:137], v154 offset:24576
  s_add_u32 m0, s63, 81920
  s_setprio 2
  s_lshr_b32 s50, s49, 1
  v_mfma_f32_16x16x32_bf16 v[84:87], v[140:143], v[116:119], v[84:87]
  ds_read_b64_tr_b16 v[138:139], v154 offset:26624
  buffer_load_dwordx4 v177, s[4:7], s61 offen  lds
  ds_read_b128 v[196:199], v201 offset:2048
  s_lshl_b32 s64, s51, 1
  s_waitcnt lgkmcnt(7)
  v_mfma_f32_16x16x32_bf16 v[88:91], v[144:147], v[112:115], v[88:91]
  ds_read_b64_tr_b16 v[140:141], v155 offset:24576
  s_add_u32 s50, s50, s64
  v_mfma_f32_16x16x32_bf16 v[92:95], v[144:147], v[116:119], v[92:95]
  ds_read_b64_tr_b16 v[142:143], v155 offset:26624
  s_mul_i32 s50, s50, 9216
  v_mfma_f32_16x16x32_bf16 v[96:99], v[148:151], v[112:115], v[96:99]
  ds_read_b64_tr_b16 v[144:145], v156 offset:24576
  s_add_u32 m0, s63, 90112
  s_and_b32 s49, s49, 1
  v_mfma_f32_16x16x32_bf16 v[100:103], v[148:151], v[116:119], v[100:103]
  ds_read_b64_tr_b16 v[146:147], v156 offset:26624
  buffer_load_dwordx4 v178, s[4:7], s61 offen  lds
  s_lshl_b32 s49, s49, 3
  s_waitcnt vmcnt(10) lgkmcnt(7)
  v_mfma_f32_16x16x32_bf16 v[8:11], v[128:131], v[120:123], v[8:11]
  ds_read_b64_tr_b16 v[148:149], v157 offset:24576
  s_add_u32 s50, s50, s49
  v_mfma_f32_16x16x32_bf16 v[12:15], v[128:131], v[124:127], v[12:15]
  ds_read_b64_tr_b16 v[150:151], v157 offset:26624
  s_setprio 1
  s_add_u32 s50, s50, 49152
  v_mfma_f32_16x16x32_bf16 v[16:19], v[132:135], v[120:123], v[16:19]
  ds_read_b64_tr_b16 v[128:129], v158 offset:24576
  s_mul_i32 s62, s69, 2048
  s_lshl_b32 s49, s52, 11
  v_mfma_f32_16x16x32_bf16 v[20:23], v[132:135], v[124:127], v[20:23]
  ds_read_b64_tr_b16 v[130:131], v158 offset:26624
  buffer_load_dwordx4 v[112:115], v179, s[8:11], s62 offen sc1
  s_add_u32 s50, s50, s49
  s_waitcnt lgkmcnt(6)
  v_mfma_f32_16x16x32_bf16 v[24:27], v[136:139], v[120:123], v[24:27]
  ds_read_b64_tr_b16 v[132:133], v159 offset:24576
  v_add_u32 v208, s50, v2
  v_mfma_f32_16x16x32_bf16 v[28:31], v[136:139], v[124:127], v[28:31]
  ds_read_b64_tr_b16 v[134:135], v159 offset:26624
  s_xor_b32 s49, s52, 3
  v_mfma_f32_16x16x32_bf16 v[184:187], v[136:139], v[196:199], v[184:187]
  v_mfma_f32_16x16x32_bf16 v[32:35], v[140:143], v[120:123], v[32:35]
  ds_read_b64_tr_b16 v[136:137], v160 offset:24576
  s_lshr_b32 s50, s49, 1
  v_mfma_f32_16x16x32_bf16 v[36:39], v[140:143], v[124:127], v[36:39]
  ds_read_b64_tr_b16 v[138:139], v160 offset:26624
  buffer_load_dwordx4 v[116:119], v180, s[8:11], s62 offen sc1
  s_setprio 0
  s_lshl_b32 s64, s51, 1
  s_waitcnt lgkmcnt(6)
  v_mfma_f32_16x16x32_bf16 v[40:43], v[144:147], v[120:123], v[40:43]
  ds_read_b64_tr_b16 v[140:141], v161 offset:24576
  s_add_u32 s50, s50, s64
  v_mfma_f32_16x16x32_bf16 v[44:47], v[144:147], v[124:127], v[44:47]
  ds_read_b64_tr_b16 v[142:143], v161 offset:26624
  s_mul_i32 s50, s50, 9216
  v_mfma_f32_16x16x32_bf16 v[48:51], v[148:151], v[120:123], v[48:51]
  ds_read_b64_tr_b16 v[144:145], v162 offset:24576
  s_mul_i32 s60, s69, 2048
  s_add_u32 m0, s59, 104448
  s_and_b32 s49, s49, 1
  v_mfma_f32_16x16x32_bf16 v[52:55], v[148:151], v[124:127], v[52:55]
  ds_read_b64_tr_b16 v[146:147], v162 offset:26624
  buffer_load_dword v200, s[8:11], s60 offen sc1 lds
  s_lshl_b32 s49, s49, 3
  s_waitcnt lgkmcnt(6)
  v_mfma_f32_16x16x32_bf16 v[56:59], v[128:131], v[120:123], v[56:59]
  ds_read_b64_tr_b16 v[148:149], v163 offset:24576
  s_add_u32 s50, s50, s49
  v_mfma_f32_16x16x32_bf16 v[60:63], v[128:131], v[124:127], v[60:63]
  ds_read_b64_tr_b16 v[150:151], v163 offset:26624
  s_add_u32 s50, s50, 49152
  s_waitcnt vmcnt(6)
  s_barrier
  s_setprio 3
  v_mfma_f32_16x16x32_bf16 v[64:67], v[132:135], v[120:123], v[64:67]
  ds_read_b64_tr_b16 v[128:129], v152 offset:49152
  s_cmp_eq_u32 s65, 0
  s_cselect_b32 s66, 12, 8
  s_cbranch_scc0 PG5_g1
  buffer_load_dword v203, v202, s[72:75], s76 offen
  s_add_u32 s76, s76, 2097152
PG5_g1:
  s_mul_i32 s61, s66, 393216
  s_add_u32 m0, s63, 0
  s_lshl_b32 s49, s52, 11
  v_mfma_f32_16x16x32_bf16 v[68:71], v[132:135], v[124:127], v[68:71]
  ds_read_b64_tr_b16 v[130:131], v152 offset:51200
  buffer_load_dwordx4 v176, s[4:7], s61 offen  lds
  s_add_u32 s50, s50, s49
  s_waitcnt lgkmcnt(6)
  v_mfma_f32_16x16x32_bf16 v[72:75], v[136:139], v[120:123], v[72:75]
  ds_read_b64_tr_b16 v[132:133], v153 offset:49152
  v_add_u32 v209, s50, v2
  v_mfma_f32_16x16x32_bf16 v[76:79], v[136:139], v[124:127], v[76:79]
  ds_read_b64_tr_b16 v[134:135], v153 offset:51200
  s_mul_i32 s50, s51, 18432
  v_mfma_f32_16x16x32_bf16 v[188:191], v[136:139], v[196:199], v[188:191]
  v_mfma_f32_16x16x32_bf16 v[80:83], v[140:143], v[120:123], v[80:83]
  ds_read_b64_tr_b16 v[136:137], v154 offset:49152
  s_add_u32 m0, s63, 8192
  s_setprio 2
  s_lshl_b32 s49, s52, 11
  v_mfma_f32_16x16x32_bf16 v[84:87], v[140:143], v[124:127], v[84:87]
  ds_read_b64_tr_b16 v[138:139], v154 offset:51200
  buffer_load_dwordx4 v177, s[4:7], s61 offen  lds
  ds_read_b128 v[192:195], v201 offset:4096
  s_add_u32 s50, s50, s49
  s_waitcnt lgkmcnt(7)
  v_mfma_f32_16x16x32_bf16 v[88:91], v[144:147], v[120:123], v[88:91]
  ds_read_b64_tr_b16 v[140:141], v155 offset:49152
  s_add_u32 s50, s50, 49152
  v_mfma_f32_16x16x32_bf16 v[92:95], v[144:147], v[124:127], v[92:95]
  ds_read_b64_tr_b16 v[142:143], v155 offset:51200
  v_add_u32 v211, s50, v2
  v_mfma_f32_16x16x32_bf16 v[96:99], v[148:151], v[120:123], v[96:99]
  ds_read_b64_tr_b16 v[144:145], v156 offset:49152
  s_add_u32 m0, s63, 16384
  v_lshrrev_b32 v5, 2, v1
  v_mfma_f32_16x16x32_bf16 v[100:103], v[148:151], v[124:127], v[100:103]
  ds_read_b64_tr_b16 v[146:147], v156 offset:51200
  buffer_load_dwordx4 v178, s[4:7], s61 offen  lds
  v_and_b32 v6, 3, v1
  s_waitcnt vmcnt(10) lgkmcnt(7)
  v_mfma_f32_16x16x32_bf16 v[8:11], v[128:131], v[104:107], v[8:11]
  ds_read_b64_tr_b16 v[148:149], v157 offset:49152
  v_lshl_add_u32 v5, v6, 4, v5
  v_mfma_f32_16x16x32_bf16 v[12:15], v[128:131], v[108:111], v[12:15]
  ds_read_b64_tr_b16 v[150:151], v157 offset:51200
  s_setprio 1
  s_add_u32 s50, s50, 9216
  v_mfma_f32_16x16x32_bf16 v[16:19], v[132:135], v[104:107], v[16:19]
  ds_read_b64_tr_b16 v[128:129], v158 offset:49152
  s_mul_i32 s62, s66, 2048
  v_lshl_add_u32 v212, v5, 4, s50
  v_mfma_f32_16x16x32_bf16 v[20:23], v[132:135], v[108:111], v[20:23]
  ds_read_b64_tr_b16 v[130:131], v158 offset:51200
  buffer_load_dwordx4 v[120:123], v179, s[8:11], s62 offen sc1
  v_mov_b32 v3, 0xffff
  s_waitcnt lgkmcnt(6)
  v_mfma_f32_16x16x32_bf16 v[24:27], v[136:139], v[104:107], v[24:27]
  ds_read_b64_tr_b16 v[132:133], v159 offset:49152
  v_mov_b32 v4, 0xffff0000
  v_mfma_f32_16x16x32_bf16 v[28:31], v[136:139], v[108:111], v[28:31]
  ds_read_b64_tr_b16 v[134:135], v159 offset:51200
  s_mov_b32 vcc_lo, 0xaaaaaaaa
  v_mfma_f32_16x16x32_bf16 v[184:187], v[136:139], v[192:195], v[184:187]
  v_mfma_f32_16x16x32_bf16 v[32:35], v[140:143], v[104:107], v[32:35]
  ds_read_b64_tr_b16 v[136:137], v160 offset:49152
  s_mov_b32 vcc_hi, 0xaaaaaaaa
  v_mfma_f32_16x16x32_bf16 v[36:39], v[140:143], v[108:111], v[36:39]
  ds_read_b64_tr_b16 v[138:139], v160 offset:51200
  buffer_load_dwordx4 v[124:127], v180, s[8:11], s62 offen sc1
  s_setprio 0
  v_cndmask_b32 v3, v3, v4, vcc
  s_waitcnt lgkmcnt(6)
  v_mfma_f32_16x16x32_bf16 v[40:43], v[144:147], v[104:107], v[40:43]
  ds_read_b64_tr_b16 v[140:141], v161 offset:49152
  s_mov_b32 vcc_lo, 0x000f0000
  v_mfma_f32_16x16x32_bf16 v[44:47], v[144:147], v[108:111], v[44:47]
  ds_read_b64_tr_b16 v[142:143], v161 offset:51200
  s_mov_b32 vcc_hi, 0x0fff00ff
  v_mfma_f32_16x16x32_bf16 v[48:51], v[148:151], v[104:107], v[48:51]
  ds_read_b64_tr_b16 v[144:145], v162 offset:49152
  s_mul_i32 s60, s66, 2048
  s_add_u32 m0, s59, 98304
  v_cndmask_b32 v215, 0, v3, vcc
  v_mfma_f32_16x16x32_bf16 v[52:55], v[148:151], v[108:111], v[52:55]
  ds_read_b64_tr_b16 v[146:147], v162 offset:51200
  buffer_load_dword v200, s[8:11], s60 offen sc1 lds
  s_mov_b32 vcc_lo, 0x003f0003
  s_waitcnt lgkmcnt(6)
  v_mfma_f32_16x16x32_bf16 v[56:59], v[128:131], v[104:107], v[56:59]
  ds_read_b64_tr_b16 v[148:149], v163 offset:49152
  s_mov_b32 vcc_hi, 0x3fff03ff
  v_mfma_f32_16x16x32_bf16 v[60:63], v[128:131], v[108:111], v[60:63]
  ds_read_b64_tr_b16 v[150:151], v163 offset:51200
  v_cndmask_b32 v216, 0, v3, vcc
  s_waitcnt vmcnt(6)
  s_barrier
  s_setprio 3
  v_mfma_f32_16x16x32_bf16 v[64:67], v[132:135], v[104:107], v[64:67]
  ds_read_b64_tr_b16 v[128:129], v164 offset:8192
  s_cmp_eq_u32 s65, 1
  s_cselect_b32 s67, 13, 9
  s_cbranch_scc0 PG6_g1
  buffer_load_dword v203, v202, s[72:75], s76 offen
  s_add_u32 s76, s76, 2097152
PG6_g1:
  s_mul_i32 s61, s67, 393216
  s_add_u32 m0, s63, 24576
  v_xor_b32 v217, v215, v3
  v_mfma_f32_16x16x32_bf16 v[68:71], v[132:135], v[108:111], v[68:71]
  ds_read_b64_tr_b16 v[130:131], v164 offset:10240
  buffer_load_dwordx4 v176, s[4:7], s61 offen  lds
  v_xor_b32 v218, v216, v3
  s_waitcnt lgkmcnt(6)
  v_mfma_f32_16x16x32_bf16 v[72:75], v[136:139], v[104:107], v[72:75]
  ds_read_b64_tr_b16 v[132:133], v165 offset:8192
  s_lshl_b32 s49, s48, 11
  v_mfma_f32_16x16x32_bf16 v[76:79], v[136:139], v[108:111], v[76:79]
  ds_read_b64_tr_b16 v[134:135], v165 offset:10240
  s_add_u32 s57, s57, s49
  v_mfma_f32_16x16x32_bf16 v[188:191], v[136:139], v[192:195], v[188:191]
  v_mfma_f32_16x16x32_bf16 v[80:83], v[140:143], v[104:107], v[80:83]
  ds_read_b64_tr_b16 v[136:137], v166 offset:8192
  s_add_u32 m0, s63, 32768
  s_setprio 2
  s_add_u32 s58, s57, 32768
  v_mfma_f32_16x16x32_bf16 v[84:87], v[140:143], v[108:111], v[84:87]
  ds_read_b64_tr_b16 v[138:139], v166 offset:10240
  buffer_load_dwordx4 v177, s[4:7], s61 offen  lds
  ds_read_b128 v[196:199], v201 offset:6144
  s_and_b32 s49, s2, 7
  s_lshr_b32 s50, s2, 3
  s_and_b32 s37, s49, 1
  s_lshl_b32 s37, s37, 3
  s_and_b32 s36, s50, 7
  s_add_u32 s37, s37, s36
  s_lshr_b32 s36, s49, 1
  s_lshl_b32 s36, s36, 2
  s_lshr_b32 s50, s50, 3
  s_add_u32 s36, s36, s50
  s_add_u32 s38, s36, s37
  s_and_b32 s38, s38, 3
  s_lshl_b32 s50, s37, 7
  v_lshrrev_b32 v4, 3, v1
  v_bfe_u32 v246, v4, 1, 2
  v_bfe_u32 v5, v1, 1, 2
  v_xor_b32 v246, v246, v5
  v_lshlrev_b32 v246, 5, v246
  v_and_b32 v5, 1, v1
  v_lshl_add_u32 v246, v5, 4, v246
  s_lshl_b32 s49, s46, 3
  v_add_u32 v4, s49, v4
  v_lshl_add_u32 v246, v4, 11, v246
  v_add_u32 v246, s50, v246
  s_waitcnt lgkmcnt(7)
  v_mfma_f32_16x16x32_bf16 v[88:91], v[144:147], v[104:107], v[88:91]
  ds_read_b64_tr_b16 v[140:141], v167 offset:8192
  s_and_b32 s49, s53, 3
  v_mfma_f32_16x16x32_bf16 v[92:95], v[144:147], v[108:111], v[92:95]
  ds_read_b64_tr_b16 v[142:143], v167 offset:10240
  s_lshl_b32 s49, s49, 8
  v_mfma_f32_16x16x32_bf16 v[96:99], v[148:151], v[104:107], v[96:99]
  ds_read_b64_tr_b16 v[144:145], v168 offset:8192
  s_add_u32 m0, s63, 40960
  s_lshl_b32 s50, s46, 5
  v_mfma_f32_16x16x32_bf16 v[100:103], v[148:151], v[108:111], v[100:103]
  ds_read_b64_tr_b16 v[146:147], v168 offset:10240
  buffer_load_dwordx4 v178, s[4:7], s61 offen  lds
  s_add_u32 s49, s49, s50
  s_waitcnt vmcnt(10) lgkmcnt(7)
  v_mfma_f32_16x16x32_bf16 v[8:11], v[128:131], v[112:115], v[8:11]
  ds_read_b64_tr_b16 v[148:149], v169 offset:8192
  v_lshrrev_b32 v3, 3, v1
  v_mfma_f32_16x16x32_bf16 v[12:15], v[128:131], v[116:119], v[12:15]
  ds_read_b64_tr_b16 v[150:151], v169 offset:10240
  s_setprio 1
  v_lshl_add_u32 v3, v3, 2, s49
  v_mfma_f32_16x16x32_bf16 v[16:19], v[132:135], v[112:115], v[16:19]
  ds_read_b64_tr_b16 v[128:129], v170 offset:8192
  s_mul_i32 s62, s67, 2048
  v_lshlrev_b32 v4, 1, v3
  v_mfma_f32_16x16x32_bf16 v[20:23], v[132:135], v[116:119], v[20:23]
  ds_read_b64_tr_b16 v[130:131], v170 offset:10240
  buffer_load_dwordx4 v[104:107], v179, s[8:11], s62 offen sc1
  buffer_load_dwordx2 v[220:221], v4, s[16:19], 0 offen
  s_waitcnt lgkmcnt(6)
  v_mfma_f32_16x16x32_bf16 v[24:27], v[136:139], v[112:115], v[24:27]
  ds_read_b64_tr_b16 v[132:133], v171 offset:8192
  v_mul_u32_u24 v3, 12288, v3
  v_mfma_f32_16x16x32_bf16 v[28:31], v[136:139], v[116:119], v[28:31]
  ds_read_b64_tr_b16 v[134:135], v171 offset:10240
  v_and_b32 v5, 7, v1
  v_mfma_f32_16x16x32_bf16 v[184:187], v[136:139], v[196:199], v[184:187]
  v_mfma_f32_16x16x32_bf16 v[32:35], v[140:143], v[112:115], v[32:35]
  ds_read_b64_tr_b16 v[136:137], v172 offset:8192
  v_lshl_add_u32 v240, v5, 4, v3
  v_mfma_f32_16x16x32_bf16 v[36:39], v[140:143], v[116:119], v[36:39]
  ds_read_b64_tr_b16 v[138:139], v172 offset:10240
  buffer_load_dwordx4 v[108:111], v180, s[8:11], s62 offen sc1
  s_setprio 0
  s_lshr_b32 s54, s53, 2
  s_waitcnt lgkmcnt(6)
  v_mfma_f32_16x16x32_bf16 v[40:43], v[144:147], v[112:115], v[40:43]
  ds_read_b64_tr_b16 v[140:141], v173 offset:8192
  s_add_u32 s54, s54, 32
  v_mfma_f32_16x16x32_bf16 v[44:47], v[144:147], v[116:119], v[44:47]
  ds_read_b64_tr_b16 v[142:143], v173 offset:10240
  s_lshl_b32 s55, s54, 7
  v_mfma_f32_16x16x32_bf16 v[48:51], v[148:151], v[112:115], v[48:51]
  ds_read_b64_tr_b16 v[144:145], v174 offset:8192
  s_mul_i32 s60, s67, 2048
  s_add_u32 m0, s59, 100352
  s_lshl_b32 s54, s54, 8
  v_mfma_f32_16x16x32_bf16 v[52:55], v[148:151], v[116:119], v[52:55]
  ds_read_b64_tr_b16 v[146:147], v174 offset:10240
  buffer_load_dword v200, s[8:11], s60 offen sc1 lds
  s_and_b32 s49, s53, 3
  s_waitcnt lgkmcnt(6)
  v_mfma_f32_16x16x32_bf16 v[56:59], v[128:131], v[112:115], v[56:59]
  ds_read_b64_tr_b16 v[148:149], v175 offset:8192
  s_mul_i32 s49, s49, 24576
  v_mfma_f32_16x16x32_bf16 v[60:63], v[128:131], v[116:119], v[60:63]
  ds_read_b64_tr_b16 v[150:151], v175 offset:10240
  s_add_u32 s54, s54, s49
  s_waitcnt vmcnt(7)
  s_barrier
  s_setprio 3
  v_mfma_f32_16x16x32_bf16 v[64:67], v[132:135], v[112:115], v[64:67]
  ds_read_b64_tr_b16 v[128:129], v152 offset:0
  s_cmp_eq_u32 s65, 2
  s_cselect_b32 s68, 14, 10
  s_cbranch_scc0 PG7_g1
  buffer_load_dword v203, v202, s[72:75], s76 offen
  s_add_u32 s76, s76, 2097152
PG7_g1:
  s_mul_i32 s61, s68, 393216
  s_add_u32 m0, s63, 49152
  v_lshlrev_b32 v5, 5, v5
  v_mfma_f32_16x16x32_bf16 v[68:71], v[132:135], v[116:119], v[68:71]
  ds_read_b64_tr_b16 v[130:131], v152 offset:2048
  buffer_load_dwordx4 v176, s[4:7], s61 offen  lds
HOP1:
  s_cbranch_execz WRET0
  v_lshrrev_b32 v4, 4, v1
  s_waitcnt lgkmcnt(6)
  v_mfma_f32_16x16x32_bf16 v[72:75], v[136:139], v[112:115], v[72:75]
  ds_read_b64_tr_b16 v[132:133], v153 offset:0
  v_lshl_add_u32 v5, v4, 3, v5
  v_mfma_f32_16x16x32_bf16 v[76:79], v[136:139], v[116:119], v[76:79]
  ds_read_b64_tr_b16 v[134:135], v153 offset:2048
  s_lshl_b32 s49, s46, 8
  v_mfma_f32_16x16x32_bf16 v[188:191], v[136:139], v[196:199], v[188:191]
  v_mfma_f32_16x16x32_bf16 v[80:83], v[140:143], v[112:115], v[80:83]
  ds_read_b64_tr_b16 v[136:137], v154 offset:0
  s_add_u32 m0, s63, 57344
  s_setprio 2
  s_add_u32 s49, s49, 159744
  v_mfma_f32_16x16x32_bf16 v[84:87], v[140:143], v[116:119], v[84:87]
  ds_read_b64_tr_b16 v[138:139], v154 offset:2048
  buffer_load_dwordx4 v177, s[4:7], s61 offen  lds
  ds_read_b128 v[192:195], v201 offset:0
  v_add_u32 v241, s49, v5
  s_waitcnt lgkmcnt(7)
  v_mfma_f32_16x16x32_bf16 v[88:91], v[144:147], v[112:115], v[88:91]
  ds_read_b64_tr_b16 v[140:141], v155 offset:0
  v_lshlrev_b32 v242, 2, v1
  v_mfma_f32_16x16x32_bf16 v[92:95], v[144:147], v[116:119], v[92:95]
  ds_read_b64_tr_b16 v[142:143], v155 offset:2048
  v_mfma_f32_16x16x32_bf16 v[96:99], v[148:151], v[112:115], v[96:99]
  ds_read_b64_tr_b16 v[144:145], v156 offset:0
  s_add_u32 m0, s63, 65536
  v_mfma_f32_16x16x32_bf16 v[100:103], v[148:151], v[116:119], v[100:103]
  ds_read_b64_tr_b16 v[146:147], v156 offset:2048
  buffer_load_dwordx4 v178, s[4:7], s61 offen  lds
  s_waitcnt vmcnt(11) lgkmcnt(7)
  v_mfma_f32_16x16x32_bf16 v[8:11], v[128:131], v[120:123], v[8:11]
  ds_read_b64_tr_b16 v[148:149], v157 offset:0
  v_mfma_f32_16x16x32_bf16 v[12:15], v[128:131], v[124:127], v[12:15]
  ds_read_b64_tr_b16 v[150:151], v157 offset:2048
  s_setprio 1
  v_mfma_f32_16x16x32_bf16 v[16:19], v[132:135], v[120:123], v[16:19]
  ds_read_b64_tr_b16 v[128:129], v158 offset:0
  s_mul_i32 s62, s68, 2048
  v_mfma_f32_16x16x32_bf16 v[20:23], v[132:135], v[124:127], v[20:23]
  ds_read_b64_tr_b16 v[130:131], v158 offset:2048
  buffer_load_dwordx4 v[112:115], v179, s[8:11], s62 offen sc1
  s_waitcnt lgkmcnt(6)
  v_mfma_f32_16x16x32_bf16 v[24:27], v[136:139], v[120:123], v[24:27]
  ds_read_b64_tr_b16 v[132:133], v159 offset:0
  v_mfma_f32_16x16x32_bf16 v[28:31], v[136:139], v[124:127], v[28:31]
  ds_read_b64_tr_b16 v[134:135], v159 offset:2048
  v_mfma_f32_16x16x32_bf16 v[184:187], v[136:139], v[192:195], v[184:187]
  v_mfma_f32_16x16x32_bf16 v[32:35], v[140:143], v[120:123], v[32:35]
  ds_read_b64_tr_b16 v[136:137], v160 offset:0
  v_mfma_f32_16x16x32_bf16 v[36:39], v[140:143], v[124:127], v[36:39]
  ds_read_b64_tr_b16 v[138:139], v160 offset:2048
  buffer_load_dwordx4 v[116:119], v180, s[8:11], s62 offen sc1
  s_setprio 0
  s_waitcnt lgkmcnt(6)
  v_mfma_f32_16x16x32_bf16 v[40:43], v[144:147], v[120:123], v[40:43]
  ds_read_b64_tr_b16 v[140:141], v161 offset:0
  v_mfma_f32_16x16x32_bf16 v[44:47], v[144:147], v[124:127], v[44:47]
  ds_read_b64_tr_b16 v[142:143], v161 offset:2048
  v_mfma_f32_16x16x32_bf16 v[48:51], v[148:151], v[120:123], v[48:51]
  ds_read_b64_tr_b16 v[144:145], v162 offset:0
  s_mul_i32 s60, s68, 2048
  s_add_u32 m0, s59, 102400
  v_mfma_f32_16x16x32_bf16 v[52:55], v[148:151], v[124:127], v[52:55]
  ds_read_b64_tr_b16 v[146:147], v162 offset:2048
  buffer_load_dword v200, s[8:11], s60 offen sc1 lds
  s_waitcnt lgkmcnt(6)
  v_mfma_f32_16x16x32_bf16 v[56:59], v[128:131], v[120:123], v[56:59]
  ds_read_b64_tr_b16 v[148:149], v163 offset:0
  v_mfma_f32_16x16x32_bf16 v[60:63], v[128:131], v[124:127], v[60:63]
  ds_read_b64_tr_b16 v[150:151], v163 offset:2048
  s_waitcnt vmcnt(6)
  s_barrier
  s_setprio 3
  v_mfma_f32_16x16x32_bf16 v[64:67], v[132:135], v[120:123], v[64:67]
  ds_read_b64_tr_b16 v[128:129], v152 offset:24576
  s_cmp_eq_u32 s65, 3
  s_cselect_b32 s69, 15, 11
  s_cbranch_scc0 PG8_g1
  buffer_load_dword v203, v202, s[72:75], s76 offen
  s_add_u32 s76, s76, 2097152
PG8_g1:
  s_mul_i32 s61, s69, 393216
  s_add_u32 m0, s63, 73728
  v_mfma_f32_16x16x32_bf16 v[68:71], v[132:135], v[124:127], v[68:71]
  ds_read_b64_tr_b16 v[130:131], v152 offset:26624
  buffer_load_dwordx4 v176, s[4:7], s61 offen  lds
  s_waitcnt lgkmcnt(6)
  v_mfma_f32_16x16x32_bf16 v[72:75], v[136:139], v[120:123], v[72:75]
  ds_read_b64_tr_b16 v[132:133], v153 offset:24576
  v_mfma_f32_16x16x32_bf16 v[76:79], v[136:139], v[124:127], v[76:79]
  ds_read_b64_tr_b16 v[134:135], v153 offset:26624
  v_mfma_f32_16x16x32_bf16 v[188:191], v[136:139], v[192:195], v[188:191]
  v_mfma_f32_16x16x32_bf16 v[80:83], v[140:143], v[120:123], v[80:83]
  ds_read_b64_tr_b16 v[136:137], v154 offset:24576
  s_add_u32 m0, s63, 81920
  s_setprio 2
  v_mfma_f32_16x16x32_bf16 v[84:87], v[140:143], v[124:127], v[84:87]
  ds_read_b64_tr_b16 v[138:139], v154 offset:26624
  buffer_load_dwordx4 v177, s[4:7], s61 offen  lds
  ds_read_b128 v[196:199], v201 offset:2048
  s_waitcnt lgkmcnt(7)
  v_mfma_f32_16x16x32_bf16 v[88:91], v[144:147], v[120:123], v[88:91]
  ds_read_b64_tr_b16 v[140:141], v155 offset:24576
  v_mfma_f32_16x16x32_bf16 v[92:95], v[144:147], v[124:127], v[92:95]
  ds_read_b64_tr_b16 v[142:143], v155 offset:26624
  v_mfma_f32_16x16x32_bf16 v[96:99], v[148:151], v[120:123], v[96:99]
  ds_read_b64_tr_b16 v[144:145], v156 offset:24576
  s_add_u32 m0, s63, 90112
  v_mfma_f32_16x16x32_bf16 v[100:103], v[148:151], v[124:127], v[100:103]
  ds_read_b64_tr_b16 v[146:147], v156 offset:26624
  buffer_load_dwordx4 v178, s[4:7], s61 offen  lds
  s_waitcnt vmcnt(10) lgkmcnt(7)
  v_mfma_f32_16x16x32_bf16 v[8:11], v[128:131], v[104:107], v[8:11]
  ds_read_b64_tr_b16 v[148:149], v157 offset:24576
  v_mfma_f32_16x16x32_bf16 v[12:15], v[128:131], v[108:111], v[12:15]
  ds_read_b64_tr_b16 v[150:151], v157 offset:26624
  s_setprio 1
  v_mfma_f32_16x16x32_bf16 v[16:19], v[132:135], v[104:107], v[16:19]
  ds_read_b64_tr_b16 v[128:129], v158 offset:24576
  s_mul_i32 s62, s69, 2048
  v_mfma_f32_16x16x32_bf16 v[20:23], v[132:135], v[108:111], v[20:23]
  ds_read_b64_tr_b16 v[130:131], v158 offset:26624
  buffer_load_dwordx4 v[120:123], v179, s[8:11], s62 offen sc1
  s_waitcnt lgkmcnt(6)
  v_mfma_f32_16x16x32_bf16 v[24:27], v[136:139], v[104:107], v[24:27]
  ds_read_b64_tr_b16 v[132:133], v159 offset:24576
  v_mfma_f32_16x16x32_bf16 v[28:31], v[136:139], v[108:111], v[28:31]
  ds_read_b64_tr_b16 v[134:135], v159 offset:26624
  v_mfma_f32_16x16x32_bf16 v[184:187], v[136:139], v[196:199], v[184:187]
  v_mfma_f32_16x16x32_bf16 v[32:35], v[140:143], v[104:107], v[32:35]
  ds_read_b64_tr_b16 v[136:137], v160 offset:24576
  v_mfma_f32_16x16x32_bf16 v[36:39], v[140:143], v[108:111], v[36:39]
  ds_read_b64_tr_b16 v[138:139], v160 offset:26624
  buffer_load_dwordx4 v[124:127], v180, s[8:11], s62 offen sc1
  s_setprio 0
  s_waitcnt lgkmcnt(6)
  v_mfma_f32_16x16x32_bf16 v[40:43], v[144:147], v[104:107], v[40:43]
  ds_read_b64_tr_b16 v[140:141], v161 offset:24576
  v_mfma_f32_16x16x32_bf16 v[44:47], v[144:147], v[108:111], v[44:47]
  ds_read_b64_tr_b16 v[142:143], v161 offset:26624
  v_mfma_f32_16x16x32_bf16 v[48:51], v[148:151], v[104:107], v[48:51]
  ds_read_b64_tr_b16 v[144:145], v162 offset:24576
  s_mul_i32 s60, s69, 2048
  s_add_u32 m0, s59, 104448
  v_mfma_f32_16x16x32_bf16 v[52:55], v[148:151], v[108:111], v[52:55]
  ds_read_b64_tr_b16 v[146:147], v162 offset:26624
  buffer_load_dword v200, s[8:11], s60 offen sc1 lds
  s_waitcnt lgkmcnt(6)
  v_mfma_f32_16x16x32_bf16 v[56:59], v[128:131], v[104:107], v[56:59]
  ds_read_b64_tr_b16 v[148:149], v163 offset:24576
  v_mfma_f32_16x16x32_bf16 v[60:63], v[128:131], v[108:111], v[60:63]
  ds_read_b64_tr_b16 v[150:151], v163 offset:26624
  s_waitcnt vmcnt(6)
  s_barrier
  s_setprio 3
  v_mfma_f32_16x16x32_bf16 v[64:67], v[132:135], v[104:107], v[64:67]
  ds_read_b64_tr_b16 v[128:129], v152 offset:49152
  s_cmp_eq_u32 s65, 0
  s_cselect_b32 s66, 4, 12
  s_cbranch_scc0 PG9_g1
  buffer_load_dword v203, v202, s[72:75], s76 offen
  s_add_u32 s76, s76, 2097152
PG9_g1:
  s_mul_i32 s61, s66, 393216
  s_add_u32 m0, s63, 0
  v_mfma_f32_16x16x32_bf16 v[68:71], v[132:135], v[108:111], v[68:71]
  ds_read_b64_tr_b16 v[130:131], v152 offset:51200
  buffer_load_dwordx4 v176, s[4:7], s61 offen  lds
  s_waitcnt lgkmcnt(6)
  v_mfma_f32_16x16x32_bf16 v[72:75], v[136:139], v[104:107], v[72:75]
  ds_read_b64_tr_b16 v[132:133], v153 offset:49152
  v_mfma_f32_16x16x32_bf16 v[76:79], v[136:139], v[108:111], v[76:79]
  ds_read_b64_tr_b16 v[134:135], v153 offset:51200
  v_mfma_f32_16x16x32_bf16 v[188:191], v[136:139], v[196:199], v[188:191]
  v_mfma_f32_16x16x32_bf16 v[80:83], v[140:143], v[104:107], v[80:83]
  ds_read_b64_tr_b16 v[136:137], v154 offset:49152
  s_add_u32 m0, s63, 8192
  s_setprio 2
  v_mfma_f32_16x16x32_bf16 v[84:87], v[140:143], v[108:111], v[84:87]
  ds_read_b64_tr_b16 v[138:139], v154 offset:51200
  buffer_load_dwordx4 v177, s[4:7], s61 offen  lds
  ds_read_b128 v[192:195], v201 offset:4096
  s_waitcnt lgkmcnt(7)
  v_mfma_f32_16x16x32_bf16 v[88:91], v[144:147], v[104:107], v[88:91]
  ds_read_b64_tr_b16 v[140:141], v155 offset:49152
  v_mfma_f32_16x16x32_bf16 v[92:95], v[144:147], v[108:111], v[92:95]
  ds_read_b64_tr_b16 v[142:143], v155 offset:51200
  v_mfma_f32_16x16x32_bf16 v[96:99], v[148:151], v[104:107], v[96:99]
  ds_read_b64_tr_b16 v[144:145], v156 offset:49152
  s_add_u32 m0, s63, 16384
  v_mfma_f32_16x16x32_bf16 v[100:103], v[148:151], v[108:111], v[100:103]
  ds_read_b64_tr_b16 v[146:147], v156 offset:51200
  buffer_load_dwordx4 v178, s[4:7], s61 offen  lds
  s_waitcnt vmcnt(10) lgkmcnt(7)
  v_mfma_f32_16x16x32_bf16 v[8:11], v[128:131], v[112:115], v[8:11]
  ds_read_b64_tr_b16 v[148:149], v157 offset:49152
  v_mfma_f32_16x16x32_bf16 v[12:15], v[128:131], v[116:119], v[12:15]
  ds_read_b64_tr_b16 v[150:151], v157 offset:51200
  s_setprio 1
  v_mfma_f32_16x16x32_bf16 v[16:19], v[132:135], v[112:115], v[16:19]
  ds_read_b64_tr_b16 v[128:129], v158 offset:49152
  s_mul_i32 s62, s66, 2048
  v_mfma_f32_16x16x32_bf16 v[20:23], v[132:135], v[116:119], v[20:23]
  ds_read_b64_tr_b16 v[130:131], v158 offset:51200
  buffer_load_dwordx4 v[104:107], v179, s[8:11], s62 offen sc1
  s_waitcnt lgkmcnt(6)
  v_mfma_f32_16x16x32_bf16 v[24:27], v[136:139], v[112:115], v[24:27]
  ds_read_b64_tr_b16 v[132:133], v159 offset:49152
  v_mfma_f32_16x16x32_bf16 v[28:31], v[136:139], v[116:119], v[28:31]
  ds_read_b64_tr_b16 v[134:135], v159 offset:51200
  v_mfma_f32_16x16x32_bf16 v[184:187], v[136:139], v[192:195], v[184:187]
  v_mfma_f32_16x16x32_bf16 v[32:35], v[140:143], v[112:115], v[32:35]
  ds_read_b64_tr_b16 v[136:137], v160 offset:49152
  v_mfma_f32_16x16x32_bf16 v[36:39], v[140:143], v[116:119], v[36:39]
  ds_read_b64_tr_b16 v[138:139], v160 offset:51200
  buffer_load_dwordx4 v[108:111], v180, s[8:11], s62 offen sc1
  s_setprio 0
  s_waitcnt lgkmcnt(6)
  v_mfma_f32_16x16x32_bf16 v[40:43], v[144:147], v[112:115], v[40:43]
  ds_read_b64_tr_b16 v[140:141], v161 offset:49152
  v_mfma_f32_16x16x32_bf16 v[44:47], v[144:147], v[116:119], v[44:47]
  ds_read_b64_tr_b16 v[142:143], v161 offset:51200
  v_mfma_f32_16x16x32_bf16 v[48:51], v[148:151], v[112:115], v[48:51]
  ds_read_b64_tr_b16 v[144:145], v162 offset:49152
  s_mul_i32 s60, s66, 2048
  s_add_u32 m0, s59, 98304
  v_mfma_f32_16x16x32_bf16 v[52:55], v[148:151], v[116:119], v[52:55]
  ds_read_b64_tr_b16 v[146:147], v162 offset:51200
  buffer_load_dword v200, s[8:11], s60 offen sc1 lds
  s_waitcnt lgkmcnt(6)
  v_mfma_f32_16x16x32_bf16 v[56:59], v[128:131], v[112:115], v[56:59]
  ds_read_b64_tr_b16 v[148:149], v163 offset:49152
  v_mfma_f32_16x16x32_bf16 v[60:63], v[128:131], v[116:119], v[60:63]
  ds_read_b64_tr_b16 v[150:151], v163 offset:51200
  s_waitcnt vmcnt(6)
  s_barrier
  s_setprio 3
  v_mfma_f32_16x16x32_bf16 v[64:67], v[132:135], v[112:115], v[64:67]
  ds_read_b64_tr_b16 v[128:129], v164 offset:8192
  s_cmp_eq_u32 s65, 1
  s_cselect_b32 s67, 1, 13
  s_cbranch_scc0 PG10_g1
  buffer_load_dword v203, v202, s[72:75], s76 offen
  s_add_u32 s76, s76, 2097152
PG10_g1:
  s_mul_i32 s61, s67, 393216
  s_add_u32 m0, s63, 24576
  v_mfma_f32_16x16x32_bf16 v[68:71], v[132:135], v[116:119], v[68:71]
  ds_read_b64_tr_b16 v[130:131], v164 offset:10240
  buffer_load_dwordx4 v176, s[4:7], s61 offen  lds
  s_waitcnt lgkmcnt(6)
  v_mfma_f32_16x16x32_bf16 v[72:75], v[136:139], v[112:115], v[72:75]
  ds_read_b64_tr_b16 v[132:133], v165 offset:8192
  v_mfma_f32_16x16x32_bf16 v[76:79], v[136:139], v[116:119], v[76:79]
  ds_read_b64_tr_b16 v[134:135], v165 offset:10240
  v_mfma_f32_16x16x32_bf16 v[188:191], v[136:139], v[192:195], v[188:191]
  v_mfma_f32_16x16x32_bf16 v[80:83], v[140:143], v[112:115], v[80:83]
  ds_read_b64_tr_b16 v[136:137], v166 offset:8192
  s_add_u32 m0, s63, 32768
  s_setprio 2
  v_mfma_f32_16x16x32_bf16 v[84:87], v[140:143], v[116:119], v[84:87]
  ds_read_b64_tr_b16 v[138:139], v166 offset:10240
  buffer_load_dwordx4 v177, s[4:7], s61 offen  lds
  ds_read_b128 v[196:199], v201 offset:6144
  s_waitcnt lgkmcnt(7)
  v_mfma_f32_16x16x32_bf16 v[88:91], v[144:147], v[112:115], v[88:91]
  ds_read_b64_tr_b16 v[140:141], v167 offset:8192
  v_mfma_f32_16x16x32_bf16 v[92:95], v[144:147], v[116:119], v[92:95]
  ds_read_b64_tr_b16 v[142:143], v167 offset:10240
  v_mfma_f32_16x16x32_bf16 v[96:99], v[148:151], v[112:115], v[96:99]
  ds_read_b64_tr_b16 v[144:145], v168 offset:8192
  s_add_u32 m0, s63, 40960
  v_mfma_f32_16x16x32_bf16 v[100:103], v[148:151], v[116:119], v[100:103]
  ds_read_b64_tr_b16 v[146:147], v168 offset:10240
  buffer_load_dwordx4 v178, s[4:7], s61 offen  lds
  s_waitcnt vmcnt(10) lgkmcnt(7)
  v_mfma_f32_16x16x32_bf16 v[8:11], v[128:131], v[120:123], v[8:11]
  ds_read_b64_tr_b16 v[148:149], v169 offset:8192
  v_mfma_f32_16x16x32_bf16 v[12:15], v[128:131], v[124:127], v[12:15]
  ds_read_b64_tr_b16 v[150:151], v169 offset:10240
  s_setprio 1
  v_mfma_f32_16x16x32_bf16 v[16:19], v[132:135], v[120:123], v[16:19]
  ds_read_b64_tr_b16 v[128:129], v170 offset:8192
  s_mul_i32 s62, s67, 2048
  v_mfma_f32_16x16x32_bf16 v[20:23], v[132:135], v[124:127], v[20:23]
  ds_read_b64_tr_b16 v[130:131], v170 offset:10240
  buffer_load_dwordx4 v[112:115], v179, s[8:11], s62 offen sc1
  s_waitcnt lgkmcnt(6)
  v_mfma_f32_16x16x32_bf16 v[24:27], v[136:139], v[120:123], v[24:27]
  ds_read_b64_tr_b16 v[132:133], v171 offset:8192
  v_mfma_f32_16x16x32_bf16 v[28:31], v[136:139], v[124:127], v[28:31]
  ds_read_b64_tr_b16 v[134:135], v171 offset:10240
  v_mfma_f32_16x16x32_bf16 v[184:187], v[136:139], v[196:199], v[184:187]
  v_mfma_f32_16x16x32_bf16 v[32:35], v[140:143], v[120:123], v[32:35]
  ds_read_b64_tr_b16 v[136:137], v172 offset:8192
  v_mfma_f32_16x16x32_bf16 v[36:39], v[140:143], v[124:127], v[36:39]
  ds_read_b64_tr_b16 v[138:139], v172 offset:10240
  buffer_load_dwordx4 v[116:119], v180, s[8:11], s62 offen sc1
  s_setprio 0
  s_waitcnt lgkmcnt(6)
  v_mfma_f32_16x16x32_bf16 v[40:43], v[144:147], v[120:123], v[40:43]
  ds_read_b64_tr_b16 v[140:141], v173 offset:8192
  v_mfma_f32_16x16x32_bf16 v[44:47], v[144:147], v[124:127], v[44:47]
  ds_read_b64_tr_b16 v[142:143], v173 offset:10240
  v_mfma_f32_16x16x32_bf16 v[48:51], v[148:151], v[120:123], v[48:51]
  ds_read_b64_tr_b16 v[144:145], v174 offset:8192
  s_mul_i32 s60, s67, 2048
  s_add_u32 m0, s59, 100352
  v_mfma_f32_16x16x32_bf16 v[52:55], v[148:151], v[124:127], v[52:55]
  ds_read_b64_tr_b16 v[146:147], v174 offset:10240
  buffer_load_dword v200, s[8:11], s60 offen sc1 lds
  s_waitcnt lgkmcnt(6)
  v_mfma_f32_16x16x32_bf16 v[56:59], v[128:131], v[120:123], v[56:59]
  ds_read_b64_tr_b16 v[148:149], v175 offset:8192
  s_waitcnt vmcnt(26)
  v_mfma_f32_16x16x32_bf16 v[60:63], v[128:131], v[124:127], v[60:63]
  ds_read_b64_tr_b16 v[150:151], v175 offset:10240
  v_lshlrev_b32 v236, 16, v220
  s_waitcnt vmcnt(6)
  s_barrier
  s_setprio 3
  v_mfma_f32_16x16x32_bf16 v[64:67], v[132:135], v[120:123], v[64:67]
  ds_read_b64_tr_b16 v[128:129], v152 offset:0
  s_cmp_eq_u32 s65, 2
  s_cselect_b32 s68, 2, 14
  s_cbranch_scc0 PG11_g1
  buffer_load_dword v203, v202, s[72:75], s76 offen
  s_add_u32 s76, s76, 2097152
PG11_g1:
  s_mul_i32 s61, s68, 393216
  s_add_u32 m0, s63, 49152
  v_and_b32 v237, 0xffff0000, v220
  v_mfma_f32_16x16x32_bf16 v[68:71], v[132:135], v[124:127], v[68:71]
  ds_read_b64_tr_b16 v[130:131], v152 offset:2048
  buffer_load_dwordx4 v176, s[4:7], s61 offen  lds
  v_lshlrev_b32 v238, 16, v221
  s_waitcnt lgkmcnt(6)
  v_mfma_f32_16x16x32_bf16 v[72:75], v[136:139], v[120:123], v[72:75]
  ds_read_b64_tr_b16 v[132:133], v153 offset:0
  v_and_b32 v239, 0xffff0000, v221
  v_mfma_f32_16x16x32_bf16 v[76:79], v[136:139], v[124:127], v[76:79]
  ds_read_b64_tr_b16 v[134:135], v153 offset:2048
  v_mul_f32 v224, 0xbfb8aa3b, v236
  v_mfma_f32_16x16x32_bf16 v[188:191], v[136:139], v[196:199], v[188:191]
  v_mfma_f32_16x16x32_bf16 v[80:83], v[140:143], v[120:123], v[80:83]
  ds_read_b64_tr_b16 v[136:137], v154 offset:0
  s_add_u32 m0, s63, 57344
  s_setprio 2
  v_mul_f32 v225, 0xbfb8aa3b, v237
  v_mfma_f32_16x16x32_bf16 v[84:87], v[140:143], v[124:127], v[84:87]
  ds_read_b64_tr_b16 v[138:139], v154 offset:2048
  buffer_load_dwordx4 v177, s[4:7], s61 offen  lds
  ds_read_b128 v[192:195], v201 offset:0
  v_mul_f32 v226, 0xbfb8aa3b, v238
  s_waitcnt lgkmcnt(7)
  v_mfma_f32_16x16x32_bf16 v[88:91], v[144:147], v[120:123], v[88:91]
  ds_read_b64_tr_b16 v[140:141], v155 offset:0
  v_mul_f32 v227, 0xbfb8aa3b, v239
  v_mfma_f32_16x16x32_bf16 v[92:95], v[144:147], v[124:127], v[92:95]
  ds_read_b64_tr_b16 v[142:143], v155 offset:2048
  v_exp_f32 v224, v224
  v_mfma_f32_16x16x32_bf16 v[96:99], v[148:151], v[120:123], v[96:99]
  ds_read_b64_tr_b16 v[144:145], v156 offset:0
  s_add_u32 m0, s63, 65536
  v_exp_f32 v225, v225
  v_mfma_f32_16x16x32_bf16 v[100:103], v[148:151], v[124:127], v[100:103]
  ds_read_b64_tr_b16 v[146:147], v156 offset:2048
  buffer_load_dwordx4 v178, s[4:7], s61 offen  lds
  v_exp_f32 v226, v226
  s_waitcnt vmcnt(10) lgkmcnt(7)
  v_mfma_f32_16x16x32_bf16 v[8:11], v[128:131], v[104:107], v[8:11]
  ds_read_b64_tr_b16 v[148:149], v157 offset:0
  v_exp_f32 v227, v227
  v_mfma_f32_16x16x32_bf16 v[12:15], v[128:131], v[108:111], v[12:15]
  ds_read_b64_tr_b16 v[150:151], v157 offset:2048
  s_setprio 1
  v_add_f32 v224, 1.0, v224
  v_mfma_f32_16x16x32_bf16 v[16:19], v[132:135], v[104:107], v[16:19]
  ds_read_b64_tr_b16 v[128:129], v158 offset:0
  s_mul_i32 s62, s68, 2048
  v_add_f32 v225, 1.0, v225
  v_mfma_f32_16x16x32_bf16 v[20:23], v[132:135], v[108:111], v[20:23]
  ds_read_b64_tr_b16 v[130:131], v158 offset:2048
  buffer_load_dwordx4 v[120:123], v179, s[8:11], s62 offen sc1
  v_add_f32 v226, 1.0, v226
  s_waitcnt lgkmcnt(6)
  v_mfma_f32_16x16x32_bf16 v[24:27], v[136:139], v[104:107], v[24:27]
  ds_read_b64_tr_b16 v[132:133], v159 offset:0
  v_add_f32 v227, 1.0, v227
  v_mfma_f32_16x16x32_bf16 v[28:31], v[136:139], v[108:111], v[28:31]
  ds_read_b64_tr_b16 v[134:135], v159 offset:2048
  v_rcp_f32 v224, v224
  v_mfma_f32_16x16x32_bf16 v[184:187], v[136:139], v[192:195], v[184:187]
  v_mfma_f32_16x16x32_bf16 v[32:35], v[140:143], v[104:107], v[32:35]
  ds_read_b64_tr_b16 v[136:137], v160 offset:0
  v_rcp_f32 v225, v225
  v_mfma_f32_16x16x32_bf16 v[36:39], v[140:143], v[108:111], v[36:39]
  ds_read_b64_tr_b16 v[138:139], v160 offset:2048
  buffer_load_dwordx4 v[124:127], v180, s[8:11], s62 offen sc1
  s_setprio 0
  v_rcp_f32 v226, v226
  s_waitcnt lgkmcnt(6)
  v_mfma_f32_16x16x32_bf16 v[40:43], v[144:147], v[104:107], v[40:43]
  ds_read_b64_tr_b16 v[140:141], v161 offset:0
  v_rcp_f32 v227, v227
  v_mfma_f32_16x16x32_bf16 v[44:47], v[144:147], v[108:111], v[44:47]
  ds_read_b64_tr_b16 v[142:143], v161 offset:2048
  v_mul_f32 v236, v236, v224
  v_mfma_f32_16x16x32_bf16 v[48:51], v[148:151], v[104:107], v[48:51]
  ds_read_b64_tr_b16 v[144:145], v162 offset:0
  s_mul_i32 s60, s68, 2048
  s_add_u32 m0, s59, 102400
  v_mul_f32 v237, v237, v225
  v_mfma_f32_16x16x32_bf16 v[52:55], v[148:151], v[108:111], v[52:55]
  ds_read_b64_tr_b16 v[146:147], v162 offset:2048
  buffer_load_dword v200, s[8:11], s60 offen sc1 lds
  v_mul_f32 v238, v238, v226
  s_waitcnt lgkmcnt(6)
  v_mfma_f32_16x16x32_bf16 v[56:59], v[128:131], v[104:107], v[56:59]
  ds_read_b64_tr_b16 v[148:149], v163 offset:0
  v_mul_f32 v239, v239, v227
  v_mfma_f32_16x16x32_bf16 v[60:63], v[128:131], v[108:111], v[60:63]
  ds_read_b64_tr_b16 v[150:151], v163 offset:2048
  v_cvt_pk_bf16_f32 v3, v236, v237
  s_waitcnt vmcnt(6)
  s_barrier
  s_setprio 3
  v_mfma_f32_16x16x32_bf16 v[64:67], v[132:135], v[104:107], v[64:67]
  ds_read_b64_tr_b16 v[128:129], v152 offset:24576
  s_cmp_eq_u32 s65, 3
  s_cselect_b32 s69, 3, 15
  s_cbranch_scc0 PG12_g1
  buffer_load_dword v203, v202, s[72:75], s76 offen
  s_add_u32 s76, s76, 2097152
PG12_g1:
  s_mul_i32 s61, s69, 393216
  s_add_u32 m0, s63, 73728
  v_lshlrev_b32 v236, 16, v3
  v_mfma_f32_16x16x32_bf16 v[68:71], v[132:135], v[108:111], v[68:71]
  ds_read_b64_tr_b16 v[130:131], v152 offset:26624
  buffer_load_dwordx4 v176, s[4:7], s61 offen  lds
  v_and_b32 v237, 0xffff0000, v3
  s_waitcnt lgkmcnt(6)
  v_mfma_f32_16x16x32_bf16 v[72:75], v[136:139], v[104:107], v[72:75]
  ds_read_b64_tr_b16 v[132:133], v153 offset:24576
  v_cvt_pk_bf16_f32 v3, v238, v239
  v_mfma_f32_16x16x32_bf16 v[76:79], v[136:139], v[108:111], v[76:79]
  ds_read_b64_tr_b16 v[134:135], v153 offset:26624
  v_lshlrev_b32 v238, 16, v3
  v_mfma_f32_16x16x32_bf16 v[188:191], v[136:139], v[192:195], v[188:191]
  v_mfma_f32_16x16x32_bf16 v[80:83], v[140:143], v[104:107], v[80:83]
  ds_read_b64_tr_b16 v[136:137], v154 offset:24576
  s_add_u32 m0, s63, 81920
  s_setprio 2
  v_and_b32 v239, 0xffff0000, v3
  v_mfma_f32_16x16x32_bf16 v[84:87], v[140:143], v[108:111], v[84:87]
  ds_read_b64_tr_b16 v[138:139], v154 offset:26624
  buffer_load_dwordx4 v177, s[4:7], s61 offen  lds
  ds_read_b128 v[196:199], v201 offset:2048
  s_waitcnt lgkmcnt(7)
  v_mfma_f32_16x16x32_bf16 v[88:91], v[144:147], v[104:107], v[88:91]
  ds_read_b64_tr_b16 v[140:141], v155 offset:24576
  v_mfma_f32_16x16x32_bf16 v[92:95], v[144:147], v[108:111], v[92:95]
  ds_read_b64_tr_b16 v[142:143], v155 offset:26624
  v_mfma_f32_16x16x32_bf16 v[96:99], v[148:151], v[104:107], v[96:99]
  ds_read_b64_tr_b16 v[144:145], v156 offset:24576
  s_add_u32 m0, s63, 90112
  v_mfma_f32_16x16x32_bf16 v[100:103], v[148:151], v[108:111], v[100:103]
  ds_read_b64_tr_b16 v[146:147], v156 offset:26624
  buffer_load_dwordx4 v178, s[4:7], s61 offen  lds
  s_waitcnt vmcnt(10) lgkmcnt(7)
  v_mfma_f32_16x16x32_bf16 v[8:11], v[128:131], v[112:115], v[8:11]
  ds_read_b64_tr_b16 v[148:149], v157 offset:24576
  v_mfma_f32_16x16x32_bf16 v[12:15], v[128:131], v[116:119], v[12:15]
  ds_read_b64_tr_b16 v[150:151], v157 offset:26624
  s_setprio 1
  v_mfma_f32_16x16x32_bf16 v[16:19], v[132:135], v[112:115], v[16:19]
  ds_read_b64_tr_b16 v[128:129], v158 offset:24576
  s_mul_i32 s62, s69, 2048
  v_mfma_f32_16x16x32_bf16 v[20:23], v[132:135], v[116:119], v[20:23]
  ds_read_b64_tr_b16 v[130:131], v158 offset:26624
  buffer_load_dwordx4 v[104:107], v179, s[8:11], s62 offen sc1
  s_waitcnt lgkmcnt(6)
  v_mfma_f32_16x16x32_bf16 v[24:27], v[136:139], v[112:115], v[24:27]
  ds_read_b64_tr_b16 v[132:133], v159 offset:24576
  v_mfma_f32_16x16x32_bf16 v[28:31], v[136:139], v[116:119], v[28:31]
  ds_read_b64_tr_b16 v[134:135], v159 offset:26624
  v_mfma_f32_16x16x32_bf16 v[184:187], v[136:139], v[196:199], v[184:187]
  v_mfma_f32_16x16x32_bf16 v[32:35], v[140:143], v[112:115], v[32:35]
  ds_read_b64_tr_b16 v[136:137], v160 offset:24576
  v_mfma_f32_16x16x32_bf16 v[36:39], v[140:143], v[116:119], v[36:39]
  ds_read_b64_tr_b16 v[138:139], v160 offset:26624
  buffer_load_dwordx4 v[108:111], v180, s[8:11], s62 offen sc1
  s_setprio 0
  s_waitcnt lgkmcnt(6)
  v_mfma_f32_16x16x32_bf16 v[40:43], v[144:147], v[112:115], v[40:43]
  ds_read_b64_tr_b16 v[140:141], v161 offset:24576
  v_mfma_f32_16x16x32_bf16 v[44:47], v[144:147], v[116:119], v[44:47]
  ds_read_b64_tr_b16 v[142:143], v161 offset:26624
  v_mfma_f32_16x16x32_bf16 v[48:51], v[148:151], v[112:115], v[48:51]
  ds_read_b64_tr_b16 v[144:145], v162 offset:24576
  s_mul_i32 s60, s69, 2048
  s_add_u32 m0, s59, 104448
  v_mfma_f32_16x16x32_bf16 v[52:55], v[148:151], v[116:119], v[52:55]
  ds_read_b64_tr_b16 v[146:147], v162 offset:26624
  buffer_load_dword v200, s[8:11], s60 offen sc1 lds
  s_waitcnt lgkmcnt(6)
  v_mfma_f32_16x16x32_bf16 v[56:59], v[128:131], v[112:115], v[56:59]
  ds_read_b64_tr_b16 v[148:149], v163 offset:24576
  v_mfma_f32_16x16x32_bf16 v[60:63], v[128:131], v[116:119], v[60:63]
  ds_read_b64_tr_b16 v[150:151], v163 offset:26624
  s_waitcnt vmcnt(6)
  s_barrier
  s_setprio 3
  v_mfma_f32_16x16x32_bf16 v[64:67], v[132:135], v[112:115], v[64:67]
  ds_read_b64_tr_b16 v[128:129], v158 offset:49152
  v_mfma_f32_16x16x32_bf16 v[68:71], v[132:135], v[116:119], v[68:71]
  ds_read_b64_tr_b16 v[130:131], v158 offset:51200
  s_waitcnt lgkmcnt(6)
  v_mfma_f32_16x16x32_bf16 v[72:75], v[136:139], v[112:115], v[72:75]
  ds_read_b64_tr_b16 v[132:133], v159 offset:49152
  v_mfma_f32_16x16x32_bf16 v[76:79], v[136:139], v[116:119], v[76:79]
  ds_read_b64_tr_b16 v[134:135], v159 offset:51200
  v_mfma_f32_16x16x32_bf16 v[188:191], v[136:139], v[196:199], v[188:191]
  v_mfma_f32_16x16x32_bf16 v[80:83], v[140:143], v[112:115], v[80:83]
  ds_read_b64_tr_b16 v[136:137], v160 offset:49152
  s_setprio 2
  v_mfma_f32_16x16x32_bf16 v[84:87], v[140:143], v[116:119], v[84:87]
  ds_read_b64_tr_b16 v[138:139], v160 offset:51200
  ds_read_b128 v[192:195], v201 offset:4096
  s_waitcnt lgkmcnt(7)
  v_mfma_f32_16x16x32_bf16 v[88:91], v[144:147], v[112:115], v[88:91]
  ds_read_b64_tr_b16 v[140:141], v161 offset:49152
  v_mfma_f32_16x16x32_bf16 v[92:95], v[144:147], v[116:119], v[92:95]
  ds_read_b64_tr_b16 v[142:143], v161 offset:51200
  v_mfma_f32_16x16x32_bf16 v[96:99], v[148:151], v[112:115], v[96:99]
  ds_read_b64_tr_b16 v[144:145], v162 offset:49152
  v_mfma_f32_16x16x32_bf16 v[100:103], v[148:151], v[116:119], v[100:103]
  ds_read_b64_tr_b16 v[146:147], v162 offset:51200
  s_waitcnt vmcnt(7) lgkmcnt(7)
  v_mfma_f32_16x16x32_bf16 v[56:59], v[128:131], v[120:123], v[56:59]
  ds_read_b64_tr_b16 v[148:149], v163 offset:49152
  v_mfma_f32_16x16x32_bf16 v[60:63], v[128:131], v[124:127], v[60:63]
  ds_read_b64_tr_b16 v[150:151], v163 offset:51200
  v_mfma_f32_16x16x32_bf16 v[64:67], v[132:135], v[120:123], v[64:67]
  ds_read_b64_tr_b16 v[128:129], v152 offset:49152
  v_mfma_f32_16x16x32_bf16 v[68:71], v[132:135], v[124:127], v[68:71]
  ds_read_b64_tr_b16 v[130:131], v152 offset:51200
  s_waitcnt lgkmcnt(6)
  v_mfma_f32_16x16x32_bf16 v[72:75], v[136:139], v[120:123], v[72:75]
  ds_read_b64_tr_b16 v[132:133], v153 offset:49152
  v_mfma_f32_16x16x32_bf16 v[76:79], v[136:139], v[124:127], v[76:79]
  ds_read_b64_tr_b16 v[134:135], v153 offset:51200
  v_mfma_f32_16x16x32_bf16 v[188:191], v[136:139], v[192:195], v[188:191]
  v_mfma_f32_16x16x32_bf16 v[80:83], v[140:143], v[120:123], v[80:83]
  ds_read_b64_tr_b16 v[136:137], v154 offset:49152
  v_mfma_f32_16x16x32_bf16 v[84:87], v[140:143], v[124:127], v[84:87]
  ds_read_b64_tr_b16 v[138:139], v154 offset:51200
  buffer_load_dwordx4 v[220:223], v240, s[12:15], s55 offen nt
  s_add_u32 s55, s55, 12288
  s_waitcnt lgkmcnt(6)
  v_mfma_f32_16x16x32_bf16 v[88:91], v[144:147], v[120:123], v[88:91]
  ds_read_b64_tr_b16 v[140:141], v155 offset:49152
  v_mfma_f32_16x16x32_bf16 v[92:95], v[144:147], v[124:127], v[92:95]
  ds_read_b64_tr_b16 v[142:143], v155 offset:51200
  buffer_load_dwordx4 v[224:227], v240, s[12:15], s55 offen nt
  s_add_u32 s55, s55, 12288
  s_waitcnt vmcnt(2)
  s_barrier
  v_mfma_f32_16x16x32_bf16 v[96:99], v[148:151], v[120:123], v[96:99]
  ds_read_b64_tr_b16 v[144:145], v170 offset:8192
  buffer_load_dwordx4 v[228:231], v240, s[12:15], s55 offen nt
  s_add_u32 s55, s55, 12288
  v_mfma_f32_16x16x32_bf16 v[100:103], v[148:151], v[124:127], v[100:103]
  ds_read_b64_tr_b16 v[146:147], v170 offset:10240
HOP2:
  s_cbranch_execz WRET0
  ds_read_b128 v[196:199], v201 offset:6144
  s_waitcnt lgkmcnt(7)
  v_mfma_f32_16x16x32_bf16 v[8:11], v[128:131], v[120:123], v[8:11]
  ds_read_b64_tr_b16 v[148:149], v171 offset:8192
  v_mfma_f32_16x16x32_bf16 v[12:15], v[128:131], v[124:127], v[12:15]
  ds_read_b64_tr_b16 v[150:151], v171 offset:10240
  buffer_load_dwordx4 v[232:235], v240, s[12:15], s55 offen nt
  v_mfma_f32_16x16x32_bf16 v[16:19], v[132:135], v[120:123], v[16:19]
  ds_read_b64_tr_b16 v[128:129], v172 offset:8192
  v_mfma_f32_16x16x32_bf16 v[20:23], v[132:135], v[124:127], v[20:23]
  ds_read_b64_tr_b16 v[130:131], v172 offset:10240
  s_waitcnt lgkmcnt(7)
  v_mfma_f32_16x16x32_bf16 v[24:27], v[136:139], v[120:123], v[24:27]
  ds_read_b64_tr_b16 v[132:133], v173 offset:8192
  v_mfma_f32_16x16x32_bf16 v[28:31], v[136:139], v[124:127], v[28:31]
  ds_read_b64_tr_b16 v[134:135], v173 offset:10240
  v_mfma_f32_16x16x32_bf16 v[184:187], v[136:139], v[192:195], v[184:187]
  v_mul_u32_u24 v244, 2048, v1
  s_lshr_b32 s74, s53, 3
  s_and_b32 s74, s74, 31
  s_mul_i32 s74, s74, 8
  s_add_u32 s74, s74, s46
  s_and_b32 s72, s53, 1
  s_mul_i32 s72, s72, 1024
  s_mul_i32 s73, s74, 4097
  s_lshr_b32 s73, s73, 16
  s_mul_i32 vcc_lo, s73, 16
  s_sub_u32 s74, s74, vcc_lo
  s_mul_i32 s74, s74, 131072
  s_add_u32 s72, s72, s74
  s_mul_i32 s74, s73, 1
  s_add_u32 s74, s74, 0
  s_cmp_lt_u32 s74, 8
  s_cselect_b32 vcc_hi, s72, 0x40000000
  s_lshl_b32 s74, s74, 7
  s_add_u32 s74, s74, vcc_hi
  buffer_load_dword v247, v244, s[28:31], s74 offen
  v_mfma_f32_16x16x32_bf16 v[32:35], v[140:143], v[120:123], v[32:35]
  ds_read_b64_tr_b16 v[136:137], v174 offset:8192
  v_mfma_f32_16x16x32_bf16 v[36:39], v[140:143], v[124:127], v[36:39]
  ds_read_b64_tr_b16 v[138:139], v174 offset:10240
  s_waitcnt vmcnt(6) lgkmcnt(6)
  v_mfma_f32_16x16x32_bf16 v[56:59], v[144:147], v[104:107], v[56:59]
  ds_read_b64_tr_b16 v[140:141], v175 offset:8192
  v_mfma_f32_16x16x32_bf16 v[60:63], v[144:147], v[108:111], v[60:63]
  ds_read_b64_tr_b16 v[142:143], v175 offset:10240
  v_mfma_f32_16x16x32_bf16 v[64:67], v[148:151], v[104:107], v[64:67]
  ds_read_b64_tr_b16 v[144:145], v156 offset:49152
  v_mfma_f32_16x16x32_bf16 v[68:71], v[148:151], v[108:111], v[68:71]
  ds_read_b64_tr_b16 v[146:147], v156 offset:51200
  s_waitcnt lgkmcnt(6)
  v_mfma_f32_16x16x32_bf16 v[72:75], v[128:131], v[104:107], v[72:75]
  ds_read_b64_tr_b16 v[148:149], v157 offset:49152
  ds_write_b128 v204, v[56:59] offset:0
  v_mfma_f32_16x16x32_bf16 v[76:79], v[128:131], v[108:111], v[76:79]
  ds_read_b64_tr_b16 v[150:151], v157 offset:51200
  ds_write_b128 v204, v[60:63] offset:1024
  v_mfma_f32_16x16x32_bf16 v[188:191], v[128:131], v[196:199], v[188:191]
  v_mfma_f32_16x16x32_bf16 v[80:83], v[132:135], v[104:107], v[80:83]
  ds_read_b64_tr_b16 v[128:129], v164 offset:8192
  ds_write_b128 v204, v[64:67] offset:2048
  v_mfma_f32_16x16x32_bf16 v[84:87], v[132:135], v[108:111], v[84:87]
  ds_read_b64_tr_b16 v[130:131], v164 offset:10240
  ds_write_b128 v204, v[68:71] offset:3072
  s_waitcnt lgkmcnt(10)
  v_mfma_f32_16x16x32_bf16 v[88:91], v[136:139], v[104:107], v[88:91]
  ds_read_b64_tr_b16 v[132:133], v165 offset:8192
  ds_write_b128 v204, v[72:75] offset:4096
  v_mfma_f32_16x16x32_bf16 v[92:95], v[136:139], v[108:111], v[92:95]
  ds_read_b64_tr_b16 v[134:135], v165 offset:10240
  ds_write_b128 v204, v[76:79] offset:5120
  v_mfma_f32_16x16x32_bf16 v[96:99], v[140:143], v[104:107], v[96:99]
  ds_read_b64_tr_b16 v[136:137], v166 offset:8192
  ds_write_b128 v213, v[188:191]
  v_mfma_f32_16x16x32_bf16 v[100:103], v[140:143], v[108:111], v[100:103]
  ds_read_b64_tr_b16 v[138:139], v166 offset:10240
  ds_write_b128 v204, v[80:83] offset:6144
  s_waitcnt lgkmcnt(13)
  v_mfma_f32_16x16x32_bf16 v[40:43], v[144:147], v[120:123], v[40:43]
  ds_read_b64_tr_b16 v[140:141], v167 offset:8192
  ds_write_b128 v204, v[84:87] offset:7168
  v_mfma_f32_16x16x32_bf16 v[44:47], v[144:147], v[124:127], v[44:47]
  ds_read_b64_tr_b16 v[142:143], v167 offset:10240
  ds_write_b128 v204, v[88:91] offset:8192
  v_mfma_f32_16x16x32_bf16 v[48:51], v[148:151], v[120:123], v[48:51]
  ds_read_b64_tr_b16 v[144:145], v168 offset:8192
  ds_write_b128 v204, v[92:95] offset:9216
  v_mfma_f32_16x16x32_bf16 v[52:55], v[148:151], v[124:127], v[52:55]
  ds_read_b64_tr_b16 v[146:147], v168 offset:10240
  ds_write_b128 v204, v[96:99] offset:10240
  s_waitcnt lgkmcnt(13)
  v_mfma_f32_16x16x32_bf16 v[8:11], v[128:131], v[104:107], v[8:11]
  ds_read_b64_tr_b16 v[148:149], v169 offset:8192
  ds_write_b128 v204, v[100:103] offset:11264
  v_mfma_f32_16x16x32_bf16 v[12:15], v[128:131], v[108:111], v[12:15]
  ds_read_b64_tr_b16 v[150:151], v169 offset:10240
  v_mfma_f32_16x16x32_bf16 v[16:19], v[132:135], v[104:107], v[16:19]
  v_mfma_f32_16x16x32_bf16 v[20:23], v[132:135], v[108:111], v[20:23]
  s_waitcnt lgkmcnt(8)
  v_mfma_f32_16x16x32_bf16 v[24:27], v[136:139], v[104:107], v[24:27]
  v_mfma_f32_16x16x32_bf16 v[28:31], v[136:139], v[108:111], v[28:31]
  v_mfma_f32_16x16x32_bf16 v[184:187], v[136:139], v[196:199], v[184:187]
  v_mfma_f32_16x16x32_bf16 v[32:35], v[140:143], v[104:107], v[32:35]
  v_mfma_f32_16x16x32_bf16 v[36:39], v[140:143], v[108:111], v[36:39]
  s_waitcnt lgkmcnt(0)
  v_mfma_f32_16x16x32_bf16 v[40:43], v[144:147], v[104:107], v[40:43]
  v_mfma_f32_16x16x32_bf16 v[44:47], v[144:147], v[108:111], v[44:47]
  v_mfma_f32_16x16x32_bf16 v[48:51], v[148:151], v[104:107], v[48:51]
  v_mfma_f32_16x16x32_bf16 v[52:55], v[148:151], v[108:111], v[52:55]
  s_setprio 0
  s_waitcnt lgkmcnt(0)
  s_barrier
  ds_read_b128 v[72:75], v205 offset:4096
  ds_read_b128 v[76:79], v205 offset:5120
  ds_read_b128 v[80:83], v205 offset:6144
  ds_read_b128 v[84:87], v205 offset:7168
  ds_read_b128 v[88:91], v205 offset:8192
  ds_read_b128 v[92:95], v205 offset:9216
  ds_read_b128 v[96:99], v205 offset:10240
  ds_read_b128 v[100:103], v205 offset:11264
  ds_read_b128 v[188:191], v214
  ds_read_b128 v[56:59], v205 offset:0
  ds_read_b128 v[60:63], v205 offset:1024
  ds_read_b128 v[64:67], v205 offset:2048
  ds_read_b128 v[68:71], v205 offset:3072
  s_mov_b32 s4, 0xfff0ffff
  s_mov_b32 s5, 0xf000ff00
  s_mov_b32 s6, 0xffe0fffe
  s_mov_b32 s7, 0xe000fe00
  s_mov_b32 s8, 0xffc0fffc
  s_mov_b32 s9, 0xc000fc00
  s_mov_b32 s10, 0xff80fff8
  s_mov_b32 s11, 0x8000f800
  s_mov_b32 s12, 0xaaaaaaaa
  s_mov_b32 s13, 0xaaaaaaaa
  s_mov_b32 s14, 0x000f0000
  s_mov_b32 s15, 0x0fff00ff
  s_mov_b32 s16, 0x003f0003
  s_mov_b32 s17, 0x3fff03ff
  s_or_b32 s49, s47, s52
  s_cmp_eq_u32 s49, 0
  s_cselect_b64 s[14:15], s[14:15], 0
  s_cselect_b64 s[16:17], s[16:17], 0
  s_waitcnt lgkmcnt(12)
  v_add_f32 v24, v24, v72
  v_add_f32 v25, v25, v73
  v_add_f32 v26, v26, v74
  v_add_f32 v27, v27, v75
  v_cvt_pk_bf16_f32 v24, v24, v25
  v_cvt_pk_bf16_f32 v25, v26, v27
  ds_write_b64 v206, v[24:25] offset:1024
  s_waitcnt lgkmcnt(12)
  v_add_f32 v28, v28, v76
  v_add_f32 v29, v29, v77
  v_add_f32 v30, v30, v78
  v_add_f32 v31, v31, v79
  v_cvt_pk_bf16_f32 v28, v28, v29
  v_cvt_pk_bf16_f32 v29, v30, v31
  ds_write_b64 v206, v[28:29] offset:2048
  s_waitcnt lgkmcnt(12)
  v_add_f32 v32, v32, v80
  v_add_f32 v33, v33, v81
  v_add_f32 v34, v34, v82
  v_add_f32 v35, v35, v83
  v_cvt_pk_bf16_f32 v32, v32, v33
  v_cvt_pk_bf16_f32 v33, v34, v35
  ds_write_b64 v207, v[32:33] offset:1024
  s_waitcnt lgkmcnt(12)
  v_add_f32 v36, v36, v84
  v_add_f32 v37, v37, v85
  v_add_f32 v38, v38, v86
  v_add_f32 v39, v39, v87
  v_cvt_pk_bf16_f32 v36, v36, v37
  v_cvt_pk_bf16_f32 v37, v38, v39
  ds_write_b64 v207, v[36:37] offset:2048
  s_waitcnt lgkmcnt(12)
  v_add_f32 v40, v40, v88
  v_add_f32 v41, v41, v89
  v_add_f32 v42, v42, v90
  v_add_f32 v43, v43, v91
  v_cvt_pk_bf16_f32 v40, v40, v41
  v_cvt_pk_bf16_f32 v41, v42, v43
  ds_write_b64 v208, v[40:41] offset:1024
  s_waitcnt lgkmcnt(12)
  v_add_f32 v44, v44, v92
  v_add_f32 v45, v45, v93
  v_add_f32 v46, v46, v94
  v_add_f32 v47, v47, v95
  v_cvt_pk_bf16_f32 v44, v44, v45
  v_cvt_pk_bf16_f32 v45, v46, v47
  ds_write_b64 v208, v[44:45] offset:2048
  s_waitcnt lgkmcnt(12)
  v_add_f32 v48, v48, v96
  v_add_f32 v49, v49, v97
  v_add_f32 v50, v50, v98
  v_add_f32 v51, v51, v99
  v_cvt_pk_bf16_f32 v48, v48, v49
  v_cvt_pk_bf16_f32 v49, v50, v51
  ds_write_b64 v209, v[48:49] offset:1024
  s_waitcnt lgkmcnt(12)
  v_add_f32 v52, v52, v100
  v_add_f32 v53, v53, v101
  v_add_f32 v54, v54, v102
  v_add_f32 v55, v55, v103
  v_cvt_pk_bf16_f32 v52, v52, v53
  v_cvt_pk_bf16_f32 v53, v54, v55
  ds_write_b64 v209, v[52:53] offset:2048
  s_waitcnt lgkmcnt(12)
  v_add_f32 v184, v184, v188
  v_add_f32 v185, v185, v189
  v_add_f32 v186, v186, v190
  v_add_f32 v187, v187, v191
  v_cvt_pk_bf16_f32 v184, v184, v185
  v_cvt_pk_bf16_f32 v185, v186, v187
  ds_write_b64 v210, v[184:185]
  s_waitcnt lgkmcnt(12)
  v_add_f32 v8, v8, v56
  v_add_f32 v9, v9, v57
  v_add_f32 v10, v10, v58
  v_add_f32 v11, v11, v59
  v_cvt_pk_bf16_f32 v104, v8, v9
  v_cvt_pk_bf16_f32 v105, v10, v11
  s_waitcnt lgkmcnt(11)
  v_add_f32 v12, v12, v60
  v_add_f32 v13, v13, v61
  v_add_f32 v14, v14, v62
  v_add_f32 v15, v15, v63
  v_cvt_pk_bf16_f32 v108, v12, v13
  v_cvt_pk_bf16_f32 v109, v14, v15
  s_waitcnt lgkmcnt(10)
  v_add_f32 v16, v16, v64
  v_add_f32 v17, v17, v65
  v_add_f32 v18, v18, v66
  v_add_f32 v19, v19, v67
  v_cvt_pk_bf16_f32 v106, v16, v17
  v_cvt_pk_bf16_f32 v107, v18, v19
  s_waitcnt lgkmcnt(9)
  v_add_f32 v20, v20, v68
  v_add_f32 v21, v21, v69
  v_add_f32 v22, v22, v70
  v_add_f32 v23, v23, v71
  v_cvt_pk_bf16_f32 v110, v20, v21
  v_cvt_pk_bf16_f32 v111, v22, v23
  s_waitcnt lgkmcnt(0)
  s_barrier
  ds_read_b128 v[8:11], v211 offset:0
  ds_read_b128 v[12:15], v211 offset:1024
  ds_read_b128 v[16:19], v211 offset:2048
  ds_read_b64_tr_b16 v[20:21], v212 offset:0
  ds_read_b64_tr_b16 v[26:27], v212 offset:8
  ds_read_b64_tr_b16 v[22:23], v212 offset:1024
  ds_read_b64_tr_b16 v[28:29], v212 offset:1032
  ds_read_b64_tr_b16 v[24:25], v212 offset:2048
  ds_read_b64_tr_b16 v[30:31], v212 offset:2056
  s_cmp_eq_u32 s38, 0
  s_cselect_b32 s39, 0, 0
  s_lshl_b32 s39, s39, 18
  s_add_u32 m0, s63, 0
  s_nop 0
  buffer_load_dwordx4 v246, s[28:31], s39 offen lds
  s_add_u32 m0, s63, 8192
  s_add_u32 s39, s39, 131072
  buffer_load_dwordx4 v246, s[28:31], s39 offen lds
  s_cmp_eq_u32 s38, 1
  s_cselect_b32 s39, 5, 1
  s_lshl_b32 s39, s39, 18
  s_add_u32 m0, s63, 16384
  s_nop 0
  buffer_load_dwordx4 v246, s[28:31], s39 offen lds
  s_add_u32 m0, s63, 24576
  s_add_u32 s39, s39, 131072
  buffer_load_dwordx4 v246, s[28:31], s39 offen lds
  s_cmp_eq_u32 s38, 2
  s_cselect_b32 s39, 6, 2
  s_lshl_b32 s39, s39, 18
  s_add_u32 m0, s63, 32768
  s_nop 0
  buffer_load_dwordx4 v246, s[28:31], s39 offen lds
  s_add_u32 m0, s63, 40960
  s_add_u32 s39, s39, 131072
  buffer_load_dwordx4 v246, s[28:31], s39 offen lds
  s_waitcnt lgkmcnt(7)
  v_mfma_f32_16x16x32_bf16 v[32:35], v[8:11], v[104:107], 0
  v_mfma_f32_16x16x32_bf16 v[36:39], v[12:15], v[104:107], 0
  s_waitcnt lgkmcnt(6)
  v_mfma_f32_16x16x32_bf16 v[40:43], v[12:15], v[108:111], 0
  v_mfma_f32_16x16x32_bf16 v[44:47], v[16:19], v[108:111], 0
  v_mov_b32 v3, 0xce6e6b28
  v_add_u32 v4, 159744, v242
  s_nop 5
  v_cndmask_b32 v72, v32, v36, s[4:5]
  v_cndmask_b32 v80, v40, v44, s[4:5]
  v_cndmask_b32 v73, v33, v37, s[6:7]
  v_cndmask_b32 v81, v41, v45, s[6:7]
  v_cndmask_b32 v74, v34, v38, s[8:9]
  v_cndmask_b32 v82, v42, v46, s[8:9]
  v_cndmask_b32 v75, v35, v39, s[10:11]
  v_cndmask_b32 v83, v43, v47, s[10:11]
  v_cndmask_b32 v72, v72, v73, s[12:13]
  v_cndmask_b32 v73, v74, v75, s[12:13]
  v_cndmask_b32 v80, v80, v81, s[12:13]
  v_cndmask_b32 v81, v82, v83, s[12:13]
  v_mul_f32 v72, 0x3e8293ee, v72
  v_mul_f32 v73, 0x3e8293ee, v73
  v_mul_f32 v80, 0x3e8293ee, v80
  v_mul_f32 v81, 0x3e8293ee, v81
  v_cndmask_b32 v72, v72, v3, s[14:15]
  v_cndmask_b32 v73, v73, v3, s[16:17]
  v_max_f32 v74, v72, v73
  v_max_f32 v82, v80, v81
  v_mov_b32 v75, v74
  v_mov_b32 v83, v82
  s_nop 0
  v_permlane16_swap_b32 v74, v75
  v_permlane16_swap_b32 v82, v83
  v_max_f32 v74, v74, v75
  v_max_f32 v82, v82, v83
  v_mov_b32 v75, v74
  v_mov_b32 v83, v82
  s_nop 0
  v_permlane32_swap_b32 v74, v75
  v_permlane32_swap_b32 v82, v83
  v_max_f32 v74, v74, v75
  v_max_f32 v82, v82, v83
  v_sub_f32 v72, v72, v74
  v_sub_f32 v73, v73, v74
  v_sub_f32 v80, v80, v82
  v_sub_f32 v81, v81, v82
  v_exp_f32 v72, v72
  v_exp_f32 v73, v73
  v_exp_f32 v80, v80
  v_exp_f32 v81, v81
  s_nop 0
  v_add_f32 v74, v72, v73
  v_add_f32 v82, v80, v81
  v_mov_b32 v75, v74
  v_mov_b32 v83, v82
  s_nop 0
  v_permlane16_swap_b32 v74, v75
  v_permlane16_swap_b32 v82, v83
  v_add_f32 v74, v74, v75
  v_add_f32 v82, v82, v83
  v_mov_b32 v75, v74
  v_mov_b32 v83, v82
  s_nop 0
  v_permlane32_swap_b32 v74, v75
  v_permlane32_swap_b32 v82, v83
  v_add_f32 v74, v74, v75
  v_add_f32 v82, v82, v83
  v_rcp_f32 v74, v74
  v_rcp_f32 v82, v82
  s_nop 0
  v_mul_f32 v72, v72, v74
  v_mul_f32 v73, v73, v74
  v_mul_f32 v80, v80, v82
  v_mul_f32 v81, v81, v82
  v_cvt_pk_bf16_f32 v72, v72, v72
  v_cvt_pk_bf16_f32 v73, v73, v73
  v_cvt_pk_bf16_f32 v80, v80, v80
  v_cvt_pk_bf16_f32 v81, v81, v81
  v_and_b32 v48, v215, v72
  v_and_b32 v49, v216, v73
  v_and_b32 v50, v217, v72
  v_and_b32 v51, v218, v73
  v_and_b32 v52, v215, v80
  v_and_b32 v53, v216, v81
  v_and_b32 v54, v217, v80
  v_and_b32 v55, v218, v81
  s_waitcnt lgkmcnt(0)
  s_nop 0
  v_mfma_f32_16x16x32_bf16 v[56:59], v[20:23], v[48:51], 0
  v_mfma_f32_16x16x32_bf16 v[60:63], v[26:29], v[48:51], 0
  v_mfma_f32_16x16x32_bf16 v[64:67], v[22:25], v[52:55], 0
  v_mfma_f32_16x16x32_bf16 v[68:71], v[28:31], v[52:55], 0
  s_nop 7
  v_cvt_pk_bf16_f32 v32, v56, v57
  v_cvt_pk_bf16_f32 v33, v58, v59
  v_cvt_pk_bf16_f32 v34, v60, v61
  v_cvt_pk_bf16_f32 v35, v62, v63
  buffer_store_dwordx4 v[32:35], v2, s[24:27], s57 offen sc1
  v_cvt_pk_bf16_f32 v36, v64, v65
  v_cvt_pk_bf16_f32 v37, v66, v67
  v_cvt_pk_bf16_f32 v38, v68, v69
  v_cvt_pk_bf16_f32 v39, v70, v71
  buffer_store_dwordx4 v[36:39], v2, s[24:27], s58 offen sc1
  s_waitcnt vmcnt(12)
  v_lshlrev_b32 v136, 16, v220
  v_and_b32 v137, 0xffff0000, v220
  v_mul_f32 v128, v236, v136
  v_mul_f32 v129, v236, v137
  v_lshlrev_b32 v136, 16, v221
  v_and_b32 v137, 0xffff0000, v221
  v_mul_f32 v130, v236, v136
  v_mul_f32 v131, v236, v137
  v_lshlrev_b32 v136, 16, v222
  v_and_b32 v137, 0xffff0000, v222
  v_mul_f32 v132, v236, v136
  v_mul_f32 v133, v236, v137
  v_lshlrev_b32 v136, 16, v223
  v_and_b32 v137, 0xffff0000, v223
  v_mul_f32 v134, v236, v136
  v_mul_f32 v135, v236, v137
  s_waitcnt vmcnt(11)
  v_lshlrev_b32 v136, 16, v224
  v_and_b32 v137, 0xffff0000, v224
  v_fmac_f32 v128, v237, v136
  v_fmac_f32 v129, v237, v137
  v_lshlrev_b32 v136, 16, v225
  v_and_b32 v137, 0xffff0000, v225
  v_fmac_f32 v130, v237, v136
  v_fmac_f32 v131, v237, v137
  v_lshlrev_b32 v136, 16, v226
  v_and_b32 v137, 0xffff0000, v226
  v_fmac_f32 v132, v237, v136
  v_fmac_f32 v133, v237, v137
  v_lshlrev_b32 v136, 16, v227
  v_and_b32 v137, 0xffff0000, v227
  v_fmac_f32 v134, v237, v136
  v_fmac_f32 v135, v237, v137
  s_waitcnt vmcnt(10)
  v_lshlrev_b32 v136, 16, v228
  v_and_b32 v137, 0xffff0000, v228
  v_fmac_f32 v128, v238, v136
  v_fmac_f32 v129, v238, v137
  v_lshlrev_b32 v136, 16, v229
  v_and_b32 v137, 0xffff0000, v229
  v_fmac_f32 v130, v238, v136
  v_fmac_f32 v131, v238, v137
  v_lshlrev_b32 v136, 16, v230
  v_and_b32 v137, 0xffff0000, v230
  v_fmac_f32 v132, v238, v136
  v_fmac_f32 v133, v238, v137
  v_lshlrev_b32 v136, 16, v231
  v_and_b32 v137, 0xffff0000, v231
  v_fmac_f32 v134, v238, v136
  v_fmac_f32 v135, v238, v137
  s_waitcnt vmcnt(9)
  v_lshlrev_b32 v136, 16, v232
  v_and_b32 v137, 0xffff0000, v232
  v_fmac_f32 v128, v239, v136
  v_fmac_f32 v129, v239, v137
  v_lshlrev_b32 v136, 16, v233
  v_and_b32 v137, 0xffff0000, v233
  v_fmac_f32 v130, v239, v136
  v_fmac_f32 v131, v239, v137
  v_lshlrev_b32 v136, 16, v234
  v_and_b32 v137, 0xffff0000, v234
  v_fmac_f32 v132, v239, v136
  v_fmac_f32 v133, v239, v137
  v_lshlrev_b32 v136, 16, v235
  v_and_b32 v137, 0xffff0000, v235
  v_fmac_f32 v134, v239, v136
  v_fmac_f32 v135, v239, v137
  s_nop 1
  v_permlane32_swap_b32 v128, v132
  v_permlane32_swap_b32 v129, v133
  v_permlane32_swap_b32 v130, v134
  v_permlane32_swap_b32 v131, v135
  s_nop 0
  v_add_f32 v128, v128, v132
  v_add_f32 v129, v129, v133
  v_add_f32 v130, v130, v134
  v_add_f32 v131, v131, v135
  s_nop 1
  v_permlane16_swap_b32 v128, v130
  v_permlane16_swap_b32 v129, v131
  s_nop 0
  v_add_f32 v128, v128, v130
  v_add_f32 v129, v129, v131
  s_nop 1
  v_add_f32_dpp v128, v128, v128 row_ror:8 row_mask:0xf bank_mask:0xf
  v_add_f32_dpp v129, v129, v129 row_ror:8 row_mask:0xf bank_mask:0xf
  ds_write_b64 v241, v[128:129]
  s_waitcnt vmcnt(8)
  s_cmp_lt_u32 s46, 4
  s_cbranch_scc1 P2_k3_qkv_kernel
  s_waitcnt vmcnt(0) lgkmcnt(0)
  s_barrier
  s_cmp_lg_u32 s46, 4
  s_cbranch_scc1 E_k3_qkv_kernel
  ds_read_b32 v128, v4 offset:0
  ds_read_b32 v129, v4 offset:256
  ds_read_b32 v130, v4 offset:512
  ds_read_b32 v131, v4 offset:768
  ds_read_b32 v132, v4 offset:1024
  ds_read_b32 v133, v4 offset:1280
  ds_read_b32 v134, v4 offset:1536
  ds_read_b32 v135, v4 offset:1792
  s_lshr_b32 s50, s2, 2
  s_lshl_b32 s50, s50, 7
  s_and_b32 s49, s2, 3
  s_lshl_b32 s49, s49, 2
  s_add_u32 s50, s50, s49
  s_add_u32 s50, s50, 65536
  s_waitcnt lgkmcnt(0)
  v_add_f32 v128, v128, v129
  v_add_f32 v130, v130, v131
  v_add_f32 v132, v132, v133
  v_add_f32 v134, v134, v135
  v_add_f32 v128, v128, v130
  v_add_f32 v132, v132, v134
  v_add_f32 v128, v128, v132
  buffer_store_dword v128, v242, s[20:23], s54 offen sc1
  v_mov_b32 v129, 1
  v_mov_b32 v130, 0
  s_mov_b64 exec, 1
  s_waitcnt vmcnt(0)
  buffer_store_dword v129, v130, s[32:35], s50 offen sc1
  s_mov_b64 exec, -1
  s_branch E_k3_qkv_kernel
P2_k3_qkv_kernel:
  s_waitcnt lgkmcnt(0)
  s_load_dwordx2 s[4:5], s[0:1], 88
  s_load_dwordx2 s[8:9], s[0:1], 16
  s_load_dwordx2 s[12:13], s[0:1], 88
  s_load_dwordx2 s[16:17], s[0:1], 0
  s_load_dwordx2 s[20:21], s[0:1], 88
  s_load_dwordx2 s[24:25], s[0:1], 88
  s_load_dwordx2 s[28:29], s[0:1], 88
  s_load_dwordx2 s[32:33], s[0:1], 88
  s_load_dwordx2 s[36:37], s[0:1], 32
  s_load_dwordx2 s[40:41], s[0:1], 40
  s_load_dwordx2 s[44:45], s[0:1], 88
  s_mov_b32 s51, s2
  v_lshrrev_b32 v3, 6, v0
  v_and_b32 v1, 63, v0
  v_readfirstlane_b32 s52, v3
  s_and_b32 s55, s2, 7
  s_lshr_b32 s56, s2, 3
  s_and_b32 s54, s55, 1
  s_lshl_b32 s54, s54, 3
  s_and_b32 s53, s56, 7
  s_add_u32 s54, s54, s53
  s_lshr_b32 s53, s55, 1
  s_lshl_b32 s53, s53, 2
  s_lshr_b32 s56, s56, 3
  s_add_u32 s53, s53, s56
  s_add_u32 s66, s53, s54
  s_and_b32 s66, s66, 3
  s_lshl_b32 s56, s54, 7
  s_lshl_b32 s64, s52, 10
  v_lshrrev_b32 v3, 3, v1
  v_bfe_u32 v4, v3, 1, 2
  v_bfe_u32 v5, v1, 1, 2
  v_xor_b32 v4, v4, v5
  s_lshl_b32 s65, s52, 3
  v_add_u32 v3, s65, v3
  v_lshlrev_b32 v4, 5, v4
  v_and_b32 v5, 1, v1
  v_lshl_add_u32 v4, v5, 4, v4
  v_mul_u32_u24 v3, 2048, v3
  v_add3_u32 v228, v3, v4, s56
  v_add_u32 v229, 65536, v228
  v_add_u32 v230, 131072, v228
  v_add_u32 v231, 196608, v228
  s_lshl_b32 s55, s53, 3
  s_lshl_b32 s57, s52, 1
  s_add_u32 s55, s55, s57
  s_lshl_b32 s57, s55, 15
  s_mul_i32 s59, s55, 32768
  s_mul_i32 s55, s55, 32768
  v_lshlrev_b32 v2, 4, v1
  v_add_u32 v232, s55, v2
  v_add_u32 v233, 32768, v232
  s_mov_b32 s6, 196608
  s_mov_b32 s7, 0x20000
  s_mov_b32 s10, 2097152
  s_mov_b32 s11, 0x20000
  s_mov_b32 s14, 4194304
  s_mov_b32 s15, 0x20000
  s_mov_b32 s18, 4194304
  s_mov_b32 s19, 0x20000
  s_mov_b32 s22, 4194304
  s_mov_b32 s23, 0x20000
  s_mov_b32 s26, 98304
  s_mov_b32 s27, 0x20000
  s_mov_b32 s30, 4227072
  s_mov_b32 s31, 0x20000
  s_mov_b32 s34, 262144
  s_mov_b32 s35, 0x20000
  s_mov_b32 s38, 7340032
  s_mov_b32 s39, 0x20000
  s_mov_b32 s42, 7340032
  s_mov_b32 s43, 0x20000
  s_mov_b32 s46, 114688
  s_mov_b32 s47, 0x20000
  s_waitcnt lgkmcnt(0)
  s_add_u32 s4, s4, 655360
  s_addc_u32 s5, s5, 0
  s_add_u32 s12, s12, 7340032
  s_addc_u32 s13, s13, 0
  s_add_u32 s20, s20, 13631488
  s_addc_u32 s21, s21, 0
  s_add_u32 s28, s28, 36700160
  s_addc_u32 s29, s29, 0
  s_add_u32 s32, s32, 262144
  s_addc_u32 s33, s33, 0
  s_add_u32 s44, s44, 524288
  s_addc_u32 s45, s45, 0
  v_lshrrev_b32 v4, 2, v1
  v_bfe_u32 v3, v4, 1, 2
  v_lshlrev_b32 v3, 5, v3
  v_lshl_add_u32 v3, v4, 7, v3
  v_and_b32 v4, 3, v1
  v_lshl_add_u32 v3, v4, 3, v3
  v_xor_b32 v220, 0, v3
  v_xor_b32 v221, 32, v3
  v_xor_b32 v222, 64, v3
  v_xor_b32 v223, 96, v3
  v_add_u32 v224, 65536, v220
  v_add_u32 v225, 65536, v221
  v_add_u32 v226, 65536, v222
  v_add_u32 v227, 65536, v223
  s_lshl_b32 s56, s54, 11
  s_add_u32 s59, s59, s56
  s_lshl_b32 s56, s54, 7
  s_add_u32 s57, s57, s56
  s_lshl_b32 s56, s54, 8
  s_add_u32 s56, s56, 8192
  s_add_u32 s60, s59, 32768
  s_add_u32 s58, s57, 32768
  s_lshl_b32 s61, s52, 12
  s_add_u32 s61, s61, 131072
  s_lshl_b32 s55, s52, 10
  s_add_u32 s55, s55, 147456
  v_lshrrev_b32 v4, 4, v1
  v_lshl_add_u32 v9, v4, 4, s55
  v_lshlrev_b32 v14, 2, v1
  v_add_u32 v15, s55, v14
  v_lshrrev_b32 v3, 3, v1
  v_and_b32 v5, 7, v1
  v_xor_b32 v5, v5, v4
  v_lshlrev_b32 v5, 4, v5
  v_lshl_add_u32 v7, v3, 11, v5
  v_xor_b32 v8, 64, v7
  v_add_u32 v8, 16384, v8
  v_and_b32 v3, 15, v1
  v_lshrrev_b32 v5, 1, v3
  v_lshrrev_b32 v6, 5, v1
  v_xor_b32 v5, v5, v6
  v_lshlrev_b32 v5, 4, v5
  v_lshl_add_u32 v5, v3, 7, v5
  v_and_b32 v4, 1, v4
  v_lshl_add_u32 v5, v4, 3, v5
  v_xor_b32 v10, 0, v5
  v_add_u32 v10, s61, v10
  v_xor_b32 v11, 32, v5
  v_add_u32 v11, s61, v11
  v_xor_b32 v12, 64, v5
  v_add_u32 v12, s61, v12
  v_xor_b32 v13, 96, v5
  v_add_u32 v13, s61, v13
  s_bitcmp1_b32 s51, 3
  s_cselect_b64 s[36:37], s[40:41], s[36:37]
  s_and_b32 s55, s51, 7
  s_mul_i32 s55, s55, 7
  s_lshr_b32 s50, s51, 5
  s_add_u32 s55, s55, s50
  s_bfe_u32 s49, s51, 0x20003
  s_mul_i32 s49, s49, 28672
  s_lshl_b32 s48, s55, 8
  s_add_u32 s49, s49, s48
  s_lshl_b32 s48, s52, 6
  s_add_u32 s49, s49, s48
  s_lshl_b32 s48, s55, 7
  s_bfe_u32 s55, s51, 0x10004
  s_mul_i32 s65, s55, 3670016
  s_add_u32 s48, s48, s65
  s_cmp_lt_u32 s50, 7
  s_cselect_b32 s48, s48, 0x40000000
  s_cselect_b32 s49, s49, 0x40000000
  s_lshl_b32 s50, s55, 11
  v_lshrrev_b32 v3, 3, v1
  v_bfe_u32 v4, v3, 1, 2
  v_bfe_u32 v5, v1, 1, 2
  v_xor_b32 v4, v4, v5
  v_lshlrev_b32 v4, 5, v4
  v_and_b32 v5, 1, v1
  v_lshl_add_u32 v4, v5, 4, v4
  s_lshl_b32 s55, s52, 3
  v_add_u32 v3, s55, v3
  v_mul_u32_u24 v3, 7168, v3
  v_add_u32 v236, v3, v4
  s_lshl_b32 s55, s52, 5
  v_xor_b32 v237, s55, v220
  v_add_u32 v237, 0, v237
  v_lshrrev_b32 v3, 4, v1
  v_lshlrev_b32 v3, 4, v3
  v_lshl_add_u32 v238, v5, 6, v3
  v_add_u32 v238, 151552, v238
  v_mul_u32_u24 v5, 14336, v5
  v_add_u32 v239, v5, v3
  s_lshl_b32 s76, s2, 7
  v_mov_b32 v240, 1
  v_mov_b32 v241, 0
  s_waitcnt vmcnt(0) lgkmcnt(0)
  s_barrier
  s_cmp_lg_u32 s52, 0
  s_cbranch_scc1 SM_g2fa
  s_mov_b64 exec, 1
  buffer_store_dword v240, v241, s[4:7], s76 offen sc1
HOP3:
  s_cbranch_execz WRET0
  s_mov_b64 exec, -1
SM_g2fa:
  s_cmp_eq_u32 s66, 3
  s_cselect_b32 s71, 7, 3
  s_mul_i32 s62, s71, 262144
  s_add_u32 m0, s64, 49152
  s_nop 0
  buffer_load_dwordx4 v228, s[8:11], s62 offen  lds
  s_add_u32 m0, s64, 53248
  s_nop 0
  buffer_load_dwordx4 v229, s[8:11], s62 offen  lds
  s_add_u32 m0, s64, 57344
  s_nop 0
  buffer_load_dwordx4 v230, s[8:11], s62 offen  lds
  s_add_u32 m0, s64, 61440
  s_nop 0
  buffer_load_dwordx4 v231, s[8:11], s62 offen  lds
  s_mov_b32 s72, 4
  s_mul_i32 s62, s72, 262144
  s_add_u32 m0, s64, 65536
  s_nop 0
  buffer_load_dwordx4 v228, s[8:11], s62 offen  lds
  s_add_u32 m0, s64, 69632
  s_nop 0
  buffer_load_dwordx4 v229, s[8:11], s62 offen  lds
  s_add_u32 m0, s64, 73728
  s_nop 0
  buffer_load_dwordx4 v230, s[8:11], s62 offen  lds
  s_add_u32 m0, s64, 77824
  s_nop 0
  buffer_load_dwordx4 v231, s[8:11], s62 offen  lds
  s_cmp_eq_u32 s66, 1
  s_cselect_b32 s73, 1, 5
  s_mul_i32 s62, s73, 262144
  s_add_u32 m0, s64, 81920
  s_nop 0
  buffer_load_dwordx4 v228, s[8:11], s62 offen  lds
  s_add_u32 m0, s64, 86016
  s_nop 0
  buffer_load_dwordx4 v229, s[8:11], s62 offen  lds
  s_add_u32 m0, s64, 90112
  s_nop 0
  buffer_load_dwordx4 v230, s[8:11], s62 offen  lds
  s_add_u32 m0, s64, 94208
  s_nop 0
  buffer_load_dwordx4 v231, s[8:11], s62 offen  lds
  s_cmp_eq_u32 s66, 2
  s_cselect_b32 s74, 2, 6
  s_mul_i32 s62, s74, 262144
  s_add_u32 m0, s64, 98304
  s_nop 0
  buffer_load_dwordx4 v228, s[8:11], s62 offen  lds
  s_add_u32 m0, s64, 102400
  s_nop 0
  buffer_load_dwordx4 v229, s[8:11], s62 offen  lds
  s_add_u32 m0, s64, 106496
  s_nop 0
  buffer_load_dwordx4 v230, s[8:11], s62 offen  lds
  s_add_u32 m0, s64, 110592
  s_nop 0
  buffer_load_dwordx4 v231, s[8:11], s62 offen  lds
  s_cmp_eq_u32 s66, 3
  s_cselect_b32 s75, 3, 7
  s_mul_i32 s62, s75, 262144
  s_add_u32 m0, s64, 114688
  s_nop 0
  buffer_load_dwordx4 v228, s[8:11], s62 offen  lds
  s_add_u32 m0, s64, 118784
  s_nop 0
  buffer_load_dwordx4 v229, s[8:11], s62 offen  lds
  s_add_u32 m0, s64, 122880
  s_nop 0
  buffer_load_dwordx4 v230, s[8:11], s62 offen  lds
  s_add_u32 m0, s64, 126976
  s_nop 0
  buffer_load_dwordx4 v231, s[8:11], s62 offen  lds
  s_add_u32 m0, s61, 0
  s_nop 0
  buffer_load_dwordx4 v7, s[16:19], s57 offen lds
  s_add_u32 m0, s61, 1024
  s_nop 0
  buffer_load_dwordx4 v8, s[16:19], s57 offen lds
  s_add_u32 m0, s61, 2048
  s_nop 0
  buffer_load_dwordx4 v7, s[16:19], s58 offen lds
  s_add_u32 m0, s61, 3072
  s_nop 0
  buffer_load_dwordx4 v8, s[16:19], s58 offen lds
  s_cmp_lg_u32 s52, 0
  s_cbranch_scc1 SM_g2fx
  s_and_b32 s77, s53, 7
  s_lshl_b32 s77, s77, 12
  s_lshr_b32 s78, s53, 3
  s_lshl_b32 s78, s78, 9
  s_add_u32 s77, s77, s78
  v_and_b32 v241, 3, v1
  v_bfe_u32 v240, v1, 2, 2
  v_lshl_add_u32 v241, v240, 3, v241
  v_lshlrev_b32 v241, 7, v241
  s_mov_b32 s78, 60000
SM_g2f:
  buffer_load_dword v240, v241, s[4:7], s77 offen sc1
  s_sub_u32 s78, s78, 1
  s_cmp_eq_u32 s78, 0
  s_waitcnt vmcnt(0)
  s_cbranch_scc1 SM_g2fx
  v_cmp_ne_u32 vcc, 1, v240
  s_nop 4
  s_cbranch_vccnz SM_g2f
SM_g2fx:
  s_barrier
  s_mov_b32 s68, 0
  s_mul_i32 s63, s68, 4096
  buffer_load_dwordx4 v[128:131], v232, s[12:15], s63 offen sc1
  buffer_load_dwordx4 v[132:135], v233, s[12:15], s63 offen sc1
  buffer_load_dwordx4 v[136:139], v232, s[12:15], s63 offen offset:1024 sc1
  buffer_load_dwordx4 v[140:143], v233, s[12:15], s63 offen offset:1024 sc1
  ds_read_b64_tr_b16 v[192:193], v220 offset:0
  ds_read_b64_tr_b16 v[194:195], v220 offset:2048
  ds_read_b64_tr_b16 v[196:197], v220 offset:4096
  ds_read_b64_tr_b16 v[198:199], v220 offset:6144
  ds_read_b64_tr_b16 v[200:201], v221 offset:0
  ds_read_b64_tr_b16 v[202:203], v221 offset:2048
  ds_read_b64_tr_b16 v[204:205], v221 offset:4096
  ds_read_b64_tr_b16 v[206:207], v221 offset:6144
  ds_read_b64_tr_b16 v[208:209], v222 offset:0
  ds_read_b64_tr_b16 v[210:211], v222 offset:2048
  s_waitcnt vmcnt(0) lgkmcnt(6)
  v_mfma_f32_16x16x32_bf16 v[96:99], v[192:195], v[128:131], 0
  ds_read_b64_tr_b16 v[212:213], v222 offset:4096
  v_mfma_f32_16x16x32_bf16 v[96:99], v[196:199], v[136:139], v[96:99]
  ds_read_b64_tr_b16 v[214:215], v222 offset:6144
  buffer_load_dwordx4 v[144:147], v232, s[12:15], s63 offen offset:2048 sc1
  v_mfma_f32_16x16x32_bf16 v[100:103], v[196:199], v[140:143], 0
  ds_read_b64_tr_b16 v[216:217], v223 offset:0
  v_mfma_f32_16x16x32_bf16 v[100:103], v[192:195], v[132:135], v[100:103]
  ds_read_b64_tr_b16 v[218:219], v223 offset:2048
  buffer_load_dwordx4 v[148:151], v233, s[12:15], s63 offen offset:2048 sc1
  buffer_load_dwordx4 v[152:155], v232, s[12:15], s63 offen offset:3072 sc1
  s_waitcnt lgkmcnt(6)
  v_mfma_f32_16x16x32_bf16 v[108:111], v[200:203], v[132:135], 0
  ds_read_b64_tr_b16 v[192:193], v223 offset:4096
  v_mfma_f32_16x16x32_bf16 v[108:111], v[204:207], v[140:143], v[108:111]
  ds_read_b64_tr_b16 v[194:195], v223 offset:6144
  buffer_load_dwordx4 v[156:159], v233, s[12:15], s63 offen offset:3072 sc1
  s_cmp_eq_u32 s66, 1
  s_cselect_b32 s69, 5, 1
  s_mul_i32 s63, s69, 4096
  buffer_load_dwordx4 v[160:163], v232, s[12:15], s63 offen sc1
  v_mfma_f32_16x16x32_bf16 v[104:107], v[204:207], v[136:139], 0
  ds_read_b64_tr_b16 v[196:197], v220 offset:8192
  v_mfma_f32_16x16x32_bf16 v[104:107], v[200:203], v[128:131], v[104:107]
  ds_read_b64_tr_b16 v[198:199], v220 offset:10240
  buffer_load_dwordx4 v[164:167], v233, s[12:15], s63 offen sc1
  buffer_load_dwordx4 v[168:171], v232, s[12:15], s63 offen offset:1024 sc1
  s_waitcnt lgkmcnt(6)
  v_mfma_f32_16x16x32_bf16 v[112:115], v[208:211], v[128:131], 0
  ds_read_b64_tr_b16 v[200:201], v220 offset:12288
  v_mfma_f32_16x16x32_bf16 v[112:115], v[212:215], v[136:139], v[112:115]
  ds_read_b64_tr_b16 v[202:203], v220 offset:14336
  buffer_load_dwordx4 v[172:175], v233, s[12:15], s63 offen offset:1024 sc1
  buffer_load_dwordx4 v[176:179], v232, s[12:15], s63 offen offset:2048 sc1
  v_mfma_f32_16x16x32_bf16 v[116:119], v[212:215], v[140:143], 0
  ds_read_b64_tr_b16 v[204:205], v221 offset:8192
  v_mfma_f32_16x16x32_bf16 v[116:119], v[208:211], v[132:135], v[116:119]
  ds_read_b64_tr_b16 v[206:207], v221 offset:10240
  buffer_load_dwordx4 v[180:183], v233, s[12:15], s63 offen offset:2048 sc1
  buffer_load_dwordx4 v[184:187], v232, s[12:15], s63 offen offset:3072 sc1
  s_waitcnt lgkmcnt(6)
  v_mfma_f32_16x16x32_bf16 v[124:127], v[216:219], v[132:135], 0
  ds_read_b64_tr_b16 v[208:209], v221 offset:12288
  v_mfma_f32_16x16x32_bf16 v[124:127], v[192:195], v[140:143], v[124:127]
  ds_read_b64_tr_b16 v[210:211], v221 offset:14336
  buffer_load_dwordx4 v[188:191], v233, s[12:15], s63 offen offset:3072 sc1
  v_mfma_f32_16x16x32_bf16 v[120:123], v[192:195], v[136:139], 0
  ds_read_b64_tr_b16 v[212:213], v222 offset:8192
  v_mfma_f32_16x16x32_bf16 v[120:123], v[216:219], v[128:131], v[120:123]
  ds_read_b64_tr_b16 v[214:215], v222 offset:10240
  s_waitcnt vmcnt(8) lgkmcnt(6)
  v_mfma_f32_16x16x32_bf16 v[96:99], v[196:199], v[144:147], v[96:99]
  ds_read_b64_tr_b16 v[216:217], v222 offset:12288
  s_cmp_eq_u32 s66, 2
  s_cselect_b32 s70, 6, 2
  s_mul_i32 s63, s70, 4096
  v_mfma_f32_16x16x32_bf16 v[96:99], v[200:203], v[152:155], v[96:99]
  ds_read_b64_tr_b16 v[218:219], v222 offset:14336
  buffer_load_dwordx4 v[128:131], v232, s[12:15], s63 offen sc1
  v_mfma_f32_16x16x32_bf16 v[100:103], v[200:203], v[156:159], v[100:103]
  ds_read_b64_tr_b16 v[192:193], v223 offset:8192
  v_mfma_f32_16x16x32_bf16 v[100:103], v[196:199], v[148:151], v[100:103]
  ds_read_b64_tr_b16 v[194:195], v223 offset:10240
  buffer_load_dwordx4 v[132:135], v233, s[12:15], s63 offen sc1
  s_waitcnt lgkmcnt(6)
  v_mfma_f32_16x16x32_bf16 v[108:111], v[204:207], v[148:151], v[108:111]
  ds_read_b64_tr_b16 v[196:197], v223 offset:12288
  v_mfma_f32_16x16x32_bf16 v[108:111], v[208:211], v[156:159], v[108:111]
  ds_read_b64_tr_b16 v[198:199], v223 offset:14336
  v_mfma_f32_16x16x32_bf16 v[104:107], v[208:211], v[152:155], v[104:107]
  ds_read_b64_tr_b16 v[200:201], v220 offset:16384
  v_mfma_f32_16x16x32_bf16 v[104:107], v[204:207], v[144:147], v[104:107]
  ds_read_b64_tr_b16 v[202:203], v220 offset:18432
  buffer_load_dwordx4 v[136:139], v232, s[12:15], s63 offen offset:1024 sc1
  s_waitcnt lgkmcnt(6)
  v_mfma_f32_16x16x32_bf16 v[112:115], v[212:215], v[144:147], v[112:115]
  ds_read_b64_tr_b16 v[204:205], v220 offset:20480
  v_mfma_f32_16x16x32_bf16 v[112:115], v[216:219], v[152:155], v[112:115]
  ds_read_b64_tr_b16 v[206:207], v220 offset:22528
  buffer_load_dwordx4 v[140:143], v233, s[12:15], s63 offen offset:1024 sc1
  v_mfma_f32_16x16x32_bf16 v[116:119], v[216:219], v[156:159], v[116:119]
  ds_read_b64_tr_b16 v[208:209], v221 offset:16384
  v_mfma_f32_16x16x32_bf16 v[116:119], v[212:215], v[148:151], v[116:119]
  ds_read_b64_tr_b16 v[210:211], v221 offset:18432
  s_waitcnt lgkmcnt(6)
  v_mfma_f32_16x16x32_bf16 v[124:127], v[192:195], v[148:151], v[124:127]
  ds_read_b64_tr_b16 v[212:213], v221 offset:20480
  v_mfma_f32_16x16x32_bf16 v[124:127], v[196:199], v[156:159], v[124:127]
  ds_read_b64_tr_b16 v[214:215], v221 offset:22528
  v_mfma_f32_16x16x32_bf16 v[120:123], v[196:199], v[152:155], v[120:123]
  ds_read_b64_tr_b16 v[216:217], v222 offset:16384
  v_mfma_f32_16x16x32_bf16 v[120:123], v[192:195], v[144:147], v[120:123]
  ds_read_b64_tr_b16 v[218:219], v222 offset:18432
  s_waitcnt vmcnt(8) lgkmcnt(6)
  v_mfma_f32_16x16x32_bf16 v[96:99], v[200:203], v[160:163], v[96:99]
  ds_read_b64_tr_b16 v[192:193], v222 offset:20480
  v_mfma_f32_16x16x32_bf16 v[96:99], v[204:207], v[168:171], v[96:99]
  ds_read_b64_tr_b16 v[194:195], v222 offset:22528
  buffer_load_dwordx4 v[144:147], v232, s[12:15], s63 offen offset:2048 sc1
  v_mfma_f32_16x16x32_bf16 v[100:103], v[204:207], v[172:175], v[100:103]
  ds_read_b64_tr_b16 v[196:197], v223 offset:16384
  v_mfma_f32_16x16x32_bf16 v[100:103], v[200:203], v[164:167], v[100:103]
  ds_read_b64_tr_b16 v[198:199], v223 offset:18432
  buffer_load_dwordx4 v[148:151], v233, s[12:15], s63 offen offset:2048 sc1
  s_waitcnt lgkmcnt(6)
  v_mfma_f32_16x16x32_bf16 v[108:111], v[208:211], v[164:167], v[108:111]
  ds_read_b64_tr_b16 v[200:201], v223 offset:20480
  v_mfma_f32_16x16x32_bf16 v[108:111], v[212:215], v[172:175], v[108:111]
  ds_read_b64_tr_b16 v[202:203], v223 offset:22528
  v_mfma_f32_16x16x32_bf16 v[104:107], v[212:215], v[168:171], v[104:107]
  ds_read_b64_tr_b16 v[204:205], v220 offset:24576
  v_mfma_f32_16x16x32_bf16 v[104:107], v[208:211], v[160:163], v[104:107]
  ds_read_b64_tr_b16 v[206:207], v220 offset:26624
  buffer_load_dwordx4 v[152:155], v232, s[12:15], s63 offen offset:3072 sc1
  s_waitcnt lgkmcnt(6)
  v_mfma_f32_16x16x32_bf16 v[112:115], v[216:219], v[160:163], v[112:115]
  ds_read_b64_tr_b16 v[208:209], v220 offset:28672
  v_mfma_f32_16x16x32_bf16 v[112:115], v[192:195], v[168:171], v[112:115]
  ds_read_b64_tr_b16 v[210:211], v220 offset:30720
  buffer_load_dwordx4 v[156:159], v233, s[12:15], s63 offen offset:3072 sc1
  v_mfma_f32_16x16x32_bf16 v[116:119], v[192:195], v[172:175], v[116:119]
  ds_read_b64_tr_b16 v[212:213], v221 offset:24576
  v_mfma_f32_16x16x32_bf16 v[116:119], v[216:219], v[164:167], v[116:119]
  ds_read_b64_tr_b16 v[214:215], v221 offset:26624
  s_cmp_lg_u32 s52, 0
  s_cbranch_scc1 CI_g2f
  s_bfe_u32 s76, s51, 0x10004
  s_lshl_b32 s76, s76, 3
  s_add_u32 s76, s76, 16
  v_and_b32 v240, 8, v1
  v_add3_u32 v241, v1, v240, s76
  s_add_u32 s76, s54, 32
  v_mov_b32 v240, s76
  v_writelane_b32 v240, s54, 16
  s_add_u32 s76, s54, 48
  v_writelane_b32 v240, s76, 17
  v_cmp_gt_u32 vcc, 16, v1
  s_nop 1
  v_cndmask_b32 v241, v240, v241, vcc
  v_lshlrev_b32 v241, 7, v241
  s_mov_b32 s76, 65536
  buffer_load_dwordx4 v[32:35], v241, s[4:7], s76 offen sc1
CI_g2f:
  s_waitcnt lgkmcnt(6)
  v_mfma_f32_16x16x32_bf16 v[124:127], v[196:199], v[164:167], v[124:127]
  ds_read_b64_tr_b16 v[216:217], v221 offset:28672
  v_mfma_f32_16x16x32_bf16 v[124:127], v[200:203], v[172:175], v[124:127]
  ds_read_b64_tr_b16 v[218:219], v221 offset:30720
  v_mfma_f32_16x16x32_bf16 v[120:123], v[200:203], v[168:171], v[120:123]
  ds_read_b64_tr_b16 v[192:193], v222 offset:24576
  v_mfma_f32_16x16x32_bf16 v[120:123], v[196:199], v[160:163], v[120:123]
  ds_read_b64_tr_b16 v[194:195], v222 offset:26624
  s_waitcnt vmcnt(8) lgkmcnt(6)
  v_mfma_f32_16x16x32_bf16 v[96:99], v[204:207], v[176:179], v[96:99]
  ds_read_b64_tr_b16 v[196:197], v222 offset:28672
  s_mul_i32 s63, s71, 4096
  v_mfma_f32_16x16x32_bf16 v[96:99], v[208:211], v[184:187], v[96:99]
  ds_read_b64_tr_b16 v[198:199], v222 offset:30720
  buffer_load_dwordx4 v[160:163], v232, s[12:15], s63 offen sc1
  v_mfma_f32_16x16x32_bf16 v[100:103], v[208:211], v[188:191], v[100:103]
  ds_read_b64_tr_b16 v[200:201], v223 offset:24576
  v_mfma_f32_16x16x32_bf16 v[100:103], v[204:207], v[180:183], v[100:103]
  ds_read_b64_tr_b16 v[202:203], v223 offset:26624
  buffer_load_dwordx4 v[164:167], v233, s[12:15], s63 offen sc1
  s_waitcnt lgkmcnt(6)
  v_mfma_f32_16x16x32_bf16 v[108:111], v[212:215], v[180:183], v[108:111]
  ds_read_b64_tr_b16 v[204:205], v223 offset:28672
  v_mfma_f32_16x16x32_bf16 v[108:111], v[216:219], v[188:191], v[108:111]
  ds_read_b64_tr_b16 v[206:207], v223 offset:30720
  v_mfma_f32_16x16x32_bf16 v[104:107], v[216:219], v[184:187], v[104:107]
  ds_read_b64_tr_b16 v[208:209], v220 offset:32768
  v_mfma_f32_16x16x32_bf16 v[104:107], v[212:215], v[176:179], v[104:107]
  ds_read_b64_tr_b16 v[210:211], v220 offset:34816
  buffer_load_dwordx4 v[168:171], v232, s[12:15], s63 offen offset:1024 sc1
  s_waitcnt lgkmcnt(6)
  v_mfma_f32_16x16x32_bf16 v[112:115], v[192:195], v[176:179], v[112:115]
  ds_read_b64_tr_b16 v[212:213], v220 offset:36864
  v_mfma_f32_16x16x32_bf16 v[112:115], v[196:199], v[184:187], v[112:115]
  ds_read_b64_tr_b16 v[214:215], v220 offset:38912
  buffer_load_dwordx4 v[172:175], v233, s[12:15], s63 offen offset:1024 sc1
  v_mfma_f32_16x16x32_bf16 v[116:119], v[196:199], v[188:191], v[116:119]
  ds_read_b64_tr_b16 v[216:217], v221 offset:32768
  v_mfma_f32_16x16x32_bf16 v[116:119], v[192:195], v[180:183], v[116:119]
  ds_read_b64_tr_b16 v[218:219], v221 offset:34816
  s_waitcnt lgkmcnt(6)
  v_mfma_f32_16x16x32_bf16 v[124:127], v[200:203], v[180:183], v[124:127]
  ds_read_b64_tr_b16 v[192:193], v221 offset:36864
  v_mfma_f32_16x16x32_bf16 v[124:127], v[204:207], v[188:191], v[124:127]
  ds_read_b64_tr_b16 v[194:195], v221 offset:38912
  v_mfma_f32_16x16x32_bf16 v[120:123], v[204:207], v[184:187], v[120:123]
  ds_read_b64_tr_b16 v[196:197], v222 offset:32768
  v_mfma_f32_16x16x32_bf16 v[120:123], v[200:203], v[176:179], v[120:123]
  ds_read_b64_tr_b16 v[198:199], v222 offset:34816
  s_waitcnt vmcnt(8) lgkmcnt(6)
  v_mfma_f32_16x16x32_bf16 v[96:99], v[208:211], v[128:131], v[96:99]
  ds_read_b64_tr_b16 v[200:201], v222 offset:36864
  v_mfma_f32_16x16x32_bf16 v[96:99], v[212:215], v[136:139], v[96:99]
  ds_read_b64_tr_b16 v[202:203], v222 offset:38912
  buffer_load_dwordx4 v[176:179], v232, s[12:15], s63 offen offset:2048 sc1
  v_mfma_f32_16x16x32_bf16 v[100:103], v[212:215], v[140:143], v[100:103]
  ds_read_b64_tr_b16 v[204:205], v223 offset:32768
  v_mfma_f32_16x16x32_bf16 v[100:103], v[208:211], v[132:135], v[100:103]
  ds_read_b64_tr_b16 v[206:207], v223 offset:34816
  buffer_load_dwordx4 v[180:183], v233, s[12:15], s63 offen offset:2048 sc1
  s_waitcnt lgkmcnt(6)
  v_mfma_f32_16x16x32_bf16 v[108:111], v[216:219], v[132:135], v[108:111]
  ds_read_b64_tr_b16 v[208:209], v223 offset:36864
  v_mfma_f32_16x16x32_bf16 v[108:111], v[192:195], v[140:143], v[108:111]
  ds_read_b64_tr_b16 v[210:211], v223 offset:38912
  v_mfma_f32_16x16x32_bf16 v[104:107], v[192:195], v[136:139], v[104:107]
  ds_read_b64_tr_b16 v[212:213], v220 offset:40960
  v_mfma_f32_16x16x32_bf16 v[104:107], v[216:219], v[128:131], v[104:107]
  ds_read_b64_tr_b16 v[214:215], v220 offset:43008
  buffer_load_dwordx4 v[184:187], v232, s[12:15], s63 offen offset:3072 sc1
  s_waitcnt lgkmcnt(6)
  v_mfma_f32_16x16x32_bf16 v[112:115], v[196:199], v[128:131], v[112:115]
  ds_read_b64_tr_b16 v[216:217], v220 offset:45056
  v_mfma_f32_16x16x32_bf16 v[112:115], v[200:203], v[136:139], v[112:115]
  ds_read_b64_tr_b16 v[218:219], v220 offset:47104
  buffer_load_dwordx4 v[188:191], v233, s[12:15], s63 offen offset:3072 sc1
  v_mfma_f32_16x16x32_bf16 v[116:119], v[200:203], v[140:143], v[116:119]
  ds_read_b64_tr_b16 v[192:193], v221 offset:40960
  v_mfma_f32_16x16x32_bf16 v[116:119], v[196:199], v[132:135], v[116:119]
  ds_read_b64_tr_b16 v[194:195], v221 offset:43008
  s_waitcnt lgkmcnt(6)
  v_mfma_f32_16x16x32_bf16 v[124:127], v[204:207], v[132:135], v[124:127]
  ds_read_b64_tr_b16 v[196:197], v221 offset:45056
  v_mfma_f32_16x16x32_bf16 v[124:127], v[208:211], v[140:143], v[124:127]
  ds_read_b64_tr_b16 v[198:199], v221 offset:47104
  v_mfma_f32_16x16x32_bf16 v[120:123], v[208:211], v[136:139], v[120:123]
  ds_read_b64_tr_b16 v[200:201], v222 offset:40960
  v_mfma_f32_16x16x32_bf16 v[120:123], v[204:207], v[128:131], v[120:123]
  ds_read_b64_tr_b16 v[202:203], v222 offset:43008
  s_waitcnt vmcnt(8) lgkmcnt(6)
  v_mfma_f32_16x16x32_bf16 v[96:99], v[212:215], v[144:147], v[96:99]
  ds_read_b64_tr_b16 v[204:205], v222 offset:45056
  s_mul_i32 s63, s72, 4096
  v_mfma_f32_16x16x32_bf16 v[96:99], v[216:219], v[152:155], v[96:99]
  ds_read_b64_tr_b16 v[206:207], v222 offset:47104
  buffer_load_dwordx4 v[128:131], v232, s[12:15], s63 offen sc1
  v_mfma_f32_16x16x32_bf16 v[100:103], v[216:219], v[156:159], v[100:103]
  ds_read_b64_tr_b16 v[208:209], v223 offset:40960
  v_mfma_f32_16x16x32_bf16 v[100:103], v[212:215], v[148:151], v[100:103]
  ds_read_b64_tr_b16 v[210:211], v223 offset:43008
  buffer_load_dwordx4 v[132:135], v233, s[12:15], s63 offen sc1
  s_cmp_lg_u32 s52, 0
  s_cbranch_scc1 CK_g2fx
  s_waitcnt vmcnt(10)
  v_and_b32 v32, v32, v33
  v_and_b32 v34, v34, v35
  v_and_b32 v32, v32, v34
  v_cmp_ne_u32 vcc, 1, v32
  s_nop 4
  s_cbranch_vccz CK_g2fx
  s_mov_b32 s78, 60000
CK_g2f:
  buffer_load_dwordx4 v[32:35], v241, s[4:7], s76 offen sc1
  s_sub_u32 s78, s78, 1
  s_cmp_eq_u32 s78, 0
  s_waitcnt vmcnt(0)
  s_cbranch_scc1 CK_g2fx
  v_and_b32 v32, v32, v33
  v_and_b32 v34, v34, v35
  v_and_b32 v32, v32, v34
  v_cmp_ne_u32 vcc, 1, v32
  s_nop 4
  s_cbranch_vccnz CK_g2f
CK_g2fx:
  s_waitcnt lgkmcnt(6)
  v_mfma_f32_16x16x32_bf16 v[108:111], v[192:195], v[148:151], v[108:111]
  ds_read_b64_tr_b16 v[212:213], v223 offset:45056
  v_mfma_f32_16x16x32_bf16 v[108:111], v[196:199], v[156:159], v[108:111]
  ds_read_b64_tr_b16 v[214:215], v223 offset:47104
  s_waitcnt vmcnt(54)
  s_barrier
  v_mfma_f32_16x16x32_bf16 v[104:107], v[196:199], v[152:155], v[104:107]
  ds_read_b64_tr_b16 v[216:217], v220 offset:49152
  v_mfma_f32_16x16x32_bf16 v[104:107], v[192:195], v[144:147], v[104:107]
  ds_read_b64_tr_b16 v[218:219], v220 offset:51200
  buffer_load_dwordx4 v[136:139], v232, s[12:15], s63 offen offset:1024 sc1
  s_waitcnt lgkmcnt(6)
  v_mfma_f32_16x16x32_bf16 v[112:115], v[200:203], v[144:147], v[112:115]
  ds_read_b64_tr_b16 v[192:193], v220 offset:53248
  v_mfma_f32_16x16x32_bf16 v[112:115], v[204:207], v[152:155], v[112:115]
  ds_read_b64_tr_b16 v[194:195], v220 offset:55296
  buffer_load_dwordx4 v[140:143], v233, s[12:15], s63 offen offset:1024 sc1
  v_mfma_f32_16x16x32_bf16 v[116:119], v[204:207], v[156:159], v[116:119]
  ds_read_b64_tr_b16 v[196:197], v221 offset:49152
  v_mfma_f32_16x16x32_bf16 v[116:119], v[200:203], v[148:151], v[116:119]
  ds_read_b64_tr_b16 v[198:199], v221 offset:51200
  s_waitcnt lgkmcnt(6)
  v_mfma_f32_16x16x32_bf16 v[124:127], v[208:211], v[148:151], v[124:127]
  ds_read_b64_tr_b16 v[200:201], v221 offset:53248
  v_mfma_f32_16x16x32_bf16 v[124:127], v[212:215], v[156:159], v[124:127]
  ds_read_b64_tr_b16 v[202:203], v221 offset:55296
  v_mfma_f32_16x16x32_bf16 v[120:123], v[212:215], v[152:155], v[120:123]
  ds_read_b64_tr_b16 v[204:205], v222 offset:49152
  v_mfma_f32_16x16x32_bf16 v[120:123], v[208:211], v[144:147], v[120:123]
  ds_read_b64_tr_b16 v[206:207], v222 offset:51200
  v_and_b32 v3, 127, v0
  v_lshlrev_b32 v3, 4, v3
  s_cmp_lt_u32 s52, 2
  s_cselect_b32 s55, 4, 3
  s_lshl_b32 s55, s55, 12
  s_add_u32 s55, s55, s50
  buffer_load_dwordx4 v[48:51], v3, s[24:27], s55 offen sc1
  s_add_u32 s55, s55, 24576
  buffer_load_dwordx4 v[52:55], v3, s[24:27], s55 offen sc1
  s_add_u32 s55, s55, 24576
  buffer_load_dwordx4 v[56:59], v3, s[24:27], s55 offen sc1
  s_add_u32 s55, s55, 24576
  buffer_load_dwordx4 v[60:63], v3, s[24:27], s55 offen sc1
  s_add_u32 s55, s56, 8192
  buffer_load_dword v80, v14, s[24:27], s55 offen sc1
  buffer_load_dword v32, v14, s[24:27], s56 offen sc1
  s_add_u32 s56, s56, 24576
  s_add_u32 s55, s56, 8192
  buffer_load_dword v81, v14, s[24:27], s55 offen sc1
  buffer_load_dword v33, v14, s[24:27], s56 offen sc1
  s_add_u32 s56, s56, 24576
  s_add_u32 s55, s56, 8192
  buffer_load_dword v82, v14, s[24:27], s55 offen sc1
  buffer_load_dword v34, v14, s[24:27], s56 offen sc1
  s_add_u32 s56, s56, 24576
  s_add_u32 s55, s56, 8192
  buffer_load_dword v83, v14, s[24:27], s55 offen sc1
  buffer_load_dword v35, v14, s[24:27], s56 offen sc1
  s_waitcnt vmcnt(20) lgkmcnt(6)
  v_mfma_f32_16x16x32_bf16 v[96:99], v[216:219], v[160:163], v[96:99]
  ds_read_b64_tr_b16 v[208:209], v222 offset:53248
  v_mfma_f32_16x16x32_bf16 v[96:99], v[192:195], v[168:171], v[96:99]
  ds_read_b64_tr_b16 v[210:211], v222 offset:55296
  buffer_load_dwordx4 v[144:147], v232, s[12:15], s63 offen offset:2048 sc1
  v_mfma_f32_16x16x32_bf16 v[100:103], v[192:195], v[172:175], v[100:103]
  ds_read_b64_tr_b16 v[212:213], v223 offset:49152
  v_mfma_f32_16x16x32_bf16 v[100:103], v[216:219], v[164:167], v[100:103]
  ds_read_b64_tr_b16 v[214:215], v223 offset:51200
  buffer_load_dwordx4 v[148:151], v233, s[12:15], s63 offen offset:2048 sc1
  s_waitcnt lgkmcnt(6)
  v_mfma_f32_16x16x32_bf16 v[108:111], v[196:199], v[164:167], v[108:111]
  ds_read_b64_tr_b16 v[216:217], v223 offset:53248
  v_mfma_f32_16x16x32_bf16 v[108:111], v[200:203], v[172:175], v[108:111]
  ds_read_b64_tr_b16 v[218:219], v223 offset:55296
  v_mfma_f32_16x16x32_bf16 v[104:107], v[200:203], v[168:171], v[104:107]
  ds_read_b64_tr_b16 v[192:193], v220 offset:57344
  v_mfma_f32_16x16x32_bf16 v[104:107], v[196:199], v[160:163], v[104:107]
  ds_read_b64_tr_b16 v[194:195], v220 offset:59392
  buffer_load_dwordx4 v[152:155], v232, s[12:15], s63 offen offset:3072 sc1
  s_waitcnt lgkmcnt(6)
  v_mfma_f32_16x16x32_bf16 v[112:115], v[204:207], v[160:163], v[112:115]
  ds_read_b64_tr_b16 v[196:197], v220 offset:61440
  v_mfma_f32_16x16x32_bf16 v[112:115], v[208:211], v[168:171], v[112:115]
  ds_read_b64_tr_b16 v[198:199], v220 offset:63488
  buffer_load_dwordx4 v[156:159], v233, s[12:15], s63 offen offset:3072 sc1
  v_mfma_f32_16x16x32_bf16 v[116:119], v[208:211], v[172:175], v[116:119]
  ds_read_b64_tr_b16 v[200:201], v221 offset:57344
  v_mfma_f32_16x16x32_bf16 v[116:119], v[204:207], v[164:167], v[116:119]
  ds_read_b64_tr_b16 v[202:203], v221 offset:59392
  s_waitcnt lgkmcnt(6)
  v_mfma_f32_16x16x32_bf16 v[124:127], v[212:215], v[164:167], v[124:127]
  ds_read_b64_tr_b16 v[204:205], v221 offset:61440
  v_mfma_f32_16x16x32_bf16 v[124:127], v[216:219], v[172:175], v[124:127]
  ds_read_b64_tr_b16 v[206:207], v221 offset:63488
  v_mfma_f32_16x16x32_bf16 v[120:123], v[216:219], v[168:171], v[120:123]
  ds_read_b64_tr_b16 v[208:209], v222 offset:57344
  v_mfma_f32_16x16x32_bf16 v[120:123], v[212:215], v[160:163], v[120:123]
  ds_read_b64_tr_b16 v[210:211], v222 offset:59392
  s_waitcnt vmcnt(20) lgkmcnt(6)
  v_mfma_f32_16x16x32_bf16 v[96:99], v[192:195], v[176:179], v[96:99]
  ds_read_b64_tr_b16 v[212:213], v222 offset:61440
  s_mul_i32 s63, s73, 4096
  v_mfma_f32_16x16x32_bf16 v[96:99], v[196:199], v[184:187], v[96:99]
  ds_read_b64_tr_b16 v[214:215], v222 offset:63488
  buffer_load_dwordx4 v[160:163], v232, s[12:15], s63 offen sc1
  v_mfma_f32_16x16x32_bf16 v[100:103], v[196:199], v[188:191], v[100:103]
  ds_read_b64_tr_b16 v[216:217], v223 offset:57344
  v_mfma_f32_16x16x32_bf16 v[100:103], v[192:195], v[180:183], v[100:103]
  ds_read_b64_tr_b16 v[218:219], v223 offset:59392
  buffer_load_dwordx4 v[164:167], v233, s[12:15], s63 offen sc1
  s_waitcnt lgkmcnt(6)
  v_mfma_f32_16x16x32_bf16 v[108:111], v[200:203], v[180:183], v[108:111]
  ds_read_b64_tr_b16 v[192:193], v223 offset:61440
  v_mfma_f32_16x16x32_bf16 v[108:111], v[204:207], v[188:191], v[108:111]
  ds_read_b64_tr_b16 v[194:195], v223 offset:63488
  s_waitcnt vmcnt(63)
  s_barrier
  v_mfma_f32_16x16x32_bf16 v[104:107], v[204:207], v[184:187], v[104:107]
  ds_read_b64_tr_b16 v[196:197], v224 offset:0
  v_mfma_f32_16x16x32_bf16 v[104:107], v[200:203], v[176:179], v[104:107]
  ds_read_b64_tr_b16 v[198:199], v224 offset:2048
  buffer_load_dwordx4 v[168:171], v232, s[12:15], s63 offen offset:1024 sc1
  s_waitcnt lgkmcnt(6)
  v_mfma_f32_16x16x32_bf16 v[112:115], v[208:211], v[176:179], v[112:115]
  ds_read_b64_tr_b16 v[200:201], v224 offset:4096
  v_mfma_f32_16x16x32_bf16 v[112:115], v[212:215], v[184:187], v[112:115]
  ds_read_b64_tr_b16 v[202:203], v224 offset:6144
  buffer_load_dwordx4 v[172:175], v233, s[12:15], s63 offen offset:1024 sc1
  v_mfma_f32_16x16x32_bf16 v[116:119], v[212:215], v[188:191], v[116:119]
  ds_read_b64_tr_b16 v[204:205], v225 offset:0
  v_mfma_f32_16x16x32_bf16 v[116:119], v[208:211], v[180:183], v[116:119]
  ds_read_b64_tr_b16 v[206:207], v225 offset:2048
  s_waitcnt lgkmcnt(6)
  v_mfma_f32_16x16x32_bf16 v[124:127], v[216:219], v[180:183], v[124:127]
  ds_read_b64_tr_b16 v[208:209], v225 offset:4096
  v_mfma_f32_16x16x32_bf16 v[124:127], v[192:195], v[188:191], v[124:127]
  ds_read_b64_tr_b16 v[210:211], v225 offset:6144
  v_mfma_f32_16x16x32_bf16 v[120:123], v[192:195], v[184:187], v[120:123]
  ds_read_b64_tr_b16 v[212:213], v226 offset:0
  v_mfma_f32_16x16x32_bf16 v[120:123], v[216:219], v[176:179], v[120:123]
  ds_read_b64_tr_b16 v[214:215], v226 offset:2048
  s_waitcnt vmcnt(20) lgkmcnt(6)
  v_mfma_f32_16x16x32_bf16 v[96:99], v[196:199], v[128:131], v[96:99]
  ds_read_b64_tr_b16 v[216:217], v226 offset:4096
  v_mfma_f32_16x16x32_bf16 v[96:99], v[200:203], v[136:139], v[96:99]
  ds_read_b64_tr_b16 v[218:219], v226 offset:6144
  buffer_load_dwordx4 v[176:179], v232, s[12:15], s63 offen offset:2048 sc1
  v_mfma_f32_16x16x32_bf16 v[100:103], v[200:203], v[140:143], v[100:103]
  ds_read_b64_tr_b16 v[192:193], v227 offset:0
  v_mfma_f32_16x16x32_bf16 v[100:103], v[196:199], v[132:135], v[100:103]
  ds_read_b64_tr_b16 v[194:195], v227 offset:2048
  buffer_load_dwordx4 v[180:183], v233, s[12:15], s63 offen offset:2048 sc1
  s_waitcnt lgkmcnt(6)
  v_mfma_f32_16x16x32_bf16 v[108:111], v[204:207], v[132:135], v[108:111]
  ds_read_b64_tr_b16 v[196:197], v227 offset:4096
  v_mfma_f32_16x16x32_bf16 v[108:111], v[208:211], v[140:143], v[108:111]
  ds_read_b64_tr_b16 v[198:199], v227 offset:6144
  v_mfma_f32_16x16x32_bf16 v[104:107], v[208:211], v[136:139], v[104:107]
  ds_read_b64_tr_b16 v[200:201], v224 offset:8192
  v_mfma_f32_16x16x32_bf16 v[104:107], v[204:207], v[128:131], v[104:107]
  ds_read_b64_tr_b16 v[202:203], v224 offset:10240
  buffer_load_dwordx4 v[184:187], v232, s[12:15], s63 offen offset:3072 sc1
  s_waitcnt lgkmcnt(6)
  v_mfma_f32_16x16x32_bf16 v[112:115], v[212:215], v[128:131], v[112:115]
  ds_read_b64_tr_b16 v[204:205], v224 offset:12288
  v_mfma_f32_16x16x32_bf16 v[112:115], v[216:219], v[136:139], v[112:115]
  ds_read_b64_tr_b16 v[206:207], v224 offset:14336
  buffer_load_dwordx4 v[188:191], v233, s[12:15], s63 offen offset:3072 sc1
  v_mfma_f32_16x16x32_bf16 v[116:119], v[216:219], v[140:143], v[116:119]
  ds_read_b64_tr_b16 v[208:209], v225 offset:8192
  v_mfma_f32_16x16x32_bf16 v[116:119], v[212:215], v[132:135], v[116:119]
  ds_read_b64_tr_b16 v[210:211], v225 offset:10240
  s_waitcnt lgkmcnt(6)
  v_mfma_f32_16x16x32_bf16 v[124:127], v[192:195], v[132:135], v[124:127]
  ds_read_b64_tr_b16 v[212:213], v225 offset:12288
  v_mfma_f32_16x16x32_bf16 v[124:127], v[196:199], v[140:143], v[124:127]
  ds_read_b64_tr_b16 v[214:215], v225 offset:14336
  v_mfma_f32_16x16x32_bf16 v[120:123], v[196:199], v[136:139], v[120:123]
  ds_read_b64_tr_b16 v[216:217], v226 offset:8192
  v_mfma_f32_16x16x32_bf16 v[120:123], v[192:195], v[128:131], v[120:123]
  ds_read_b64_tr_b16 v[218:219], v226 offset:10240
  s_waitcnt vmcnt(8) lgkmcnt(6)
  v_mfma_f32_16x16x32_bf16 v[96:99], v[200:203], v[144:147], v[96:99]
  ds_read_b64_tr_b16 v[192:193], v226 offset:12288
  s_mul_i32 s63, s74, 4096
  v_mfma_f32_16x16x32_bf16 v[96:99], v[204:207], v[152:155], v[96:99]
  ds_read_b64_tr_b16 v[194:195], v226 offset:14336
HOP4:
  s_cbranch_execz WRET0
  buffer_load_dwordx4 v[128:131], v232, s[12:15], s63 offen sc1
  v_mfma_f32_16x16x32_bf16 v[100:103], v[204:207], v[156:159], v[100:103]
  ds_read_b64_tr_b16 v[196:197], v227 offset:8192
  v_mfma_f32_16x16x32_bf16 v[100:103], v[200:203], v[148:151], v[100:103]
  ds_read_b64_tr_b16 v[198:199], v227 offset:10240
  buffer_load_dwordx4 v[132:135], v233, s[12:15], s63 offen sc1
  s_waitcnt lgkmcnt(6)
  v_mfma_f32_16x16x32_bf16 v[108:111], v[208:211], v[148:151], v[108:111]
  ds_read_b64_tr_b16 v[200:201], v227 offset:12288
  v_mfma_f32_16x16x32_bf16 v[108:111], v[212:215], v[156:159], v[108:111]
  ds_read_b64_tr_b16 v[202:203], v227 offset:14336
  s_waitcnt vmcnt(63)
  s_barrier
  v_mfma_f32_16x16x32_bf16 v[104:107], v[212:215], v[152:155], v[104:107]
  ds_read_b64_tr_b16 v[204:205], v224 offset:16384
  v_mfma_f32_16x16x32_bf16 v[104:107], v[208:211], v[144:147], v[104:107]
  ds_read_b64_tr_b16 v[206:207], v224 offset:18432
  buffer_load_dwordx4 v[136:139], v232, s[12:15], s63 offen offset:1024 sc1
  s_add_u32 m0, s64, 0
  s_add_u32 s65, s48, 0
  buffer_load_dwordx4 v236, s[36:39], s65 offen lds
  s_waitcnt lgkmcnt(6)
  v_mfma_f32_16x16x32_bf16 v[112:115], v[216:219], v[144:147], v[112:115]
  ds_read_b64_tr_b16 v[208:209], v224 offset:20480
  v_mfma_f32_16x16x32_bf16 v[112:115], v[192:195], v[152:155], v[112:115]
  ds_read_b64_tr_b16 v[210:211], v224 offset:22528
  buffer_load_dwordx4 v[140:143], v233, s[12:15], s63 offen offset:1024 sc1
  v_mfma_f32_16x16x32_bf16 v[116:119], v[192:195], v[156:159], v[116:119]
  ds_read_b64_tr_b16 v[212:213], v225 offset:16384
  v_mfma_f32_16x16x32_bf16 v[116:119], v[216:219], v[148:151], v[116:119]
  ds_read_b64_tr_b16 v[214:215], v225 offset:18432
  s_waitcnt lgkmcnt(6)
  v_mfma_f32_16x16x32_bf16 v[124:127], v[196:199], v[148:151], v[124:127]
  ds_read_b64_tr_b16 v[216:217], v225 offset:20480
  v_mfma_f32_16x16x32_bf16 v[124:127], v[200:203], v[156:159], v[124:127]
  ds_read_b64_tr_b16 v[218:219], v225 offset:22528
  s_add_u32 m0, s64, 4096
  s_add_u32 s65, s48, 229376
  buffer_load_dwordx4 v236, s[36:39], s65 offen lds
  v_mfma_f32_16x16x32_bf16 v[120:123], v[200:203], v[152:155], v[120:123]
  ds_read_b64_tr_b16 v[192:193], v226 offset:16384
  v_mfma_f32_16x16x32_bf16 v[120:123], v[196:199], v[144:147], v[120:123]
  ds_read_b64_tr_b16 v[194:195], v226 offset:18432
  s_waitcnt vmcnt(10) lgkmcnt(6)
  v_mfma_f32_16x16x32_bf16 v[96:99], v[204:207], v[160:163], v[96:99]
  ds_read_b64_tr_b16 v[196:197], v226 offset:20480
  s_waitcnt vmcnt(18)
  v_add_f32 v48, v48, v56
  v_mfma_f32_16x16x32_bf16 v[96:99], v[208:211], v[168:171], v[96:99]
  ds_read_b64_tr_b16 v[198:199], v226 offset:22528
  buffer_load_dwordx4 v[144:147], v232, s[12:15], s63 offen offset:2048 sc1
  v_add_f32 v49, v49, v57
  v_add_f32 v50, v50, v58
  v_mfma_f32_16x16x32_bf16 v[100:103], v[208:211], v[172:175], v[100:103]
  ds_read_b64_tr_b16 v[200:201], v227 offset:16384
  v_add_f32 v51, v51, v59
  v_add_f32 v52, v52, v60
  v_mfma_f32_16x16x32_bf16 v[100:103], v[204:207], v[164:167], v[100:103]
  ds_read_b64_tr_b16 v[202:203], v227 offset:18432
  buffer_load_dwordx4 v[148:151], v233, s[12:15], s63 offen offset:2048 sc1
  v_add_f32 v53, v53, v61
  v_add_f32 v54, v54, v62
  s_add_u32 m0, s64, 8192
  s_add_u32 s65, s48, 458752
  buffer_load_dwordx4 v236, s[36:39], s65 offen lds
  s_waitcnt lgkmcnt(6)
  v_mfma_f32_16x16x32_bf16 v[108:111], v[212:215], v[164:167], v[108:111]
  ds_read_b64_tr_b16 v[204:205], v227 offset:20480
  v_add_f32 v55, v55, v63
  v_add_f32 v48, v48, v52
  v_mfma_f32_16x16x32_bf16 v[108:111], v[216:219], v[172:175], v[108:111]
  ds_read_b64_tr_b16 v[206:207], v227 offset:22528
  v_add_f32 v49, v49, v53
  v_add_f32 v50, v50, v54
  v_mfma_f32_16x16x32_bf16 v[104:107], v[216:219], v[168:171], v[104:107]
  ds_read_b64_tr_b16 v[208:209], v224 offset:24576
  v_add_f32 v51, v51, v55
  s_cmp_lt_u32 s52, 2
  s_cselect_b32 s55, 1.0, 0
  v_mfma_f32_16x16x32_bf16 v[104:107], v[212:215], v[160:163], v[104:107]
  ds_read_b64_tr_b16 v[210:211], v224 offset:26624
  buffer_load_dwordx4 v[152:155], v232, s[12:15], s63 offen offset:3072 sc1
  v_cvt_pk_bf16_f32 v52, v48, v49
  v_lshlrev_b32 v48, 16, v52
  s_waitcnt lgkmcnt(6)
  v_mfma_f32_16x16x32_bf16 v[112:115], v[192:195], v[160:163], v[112:115]
  ds_read_b64_tr_b16 v[212:213], v224 offset:28672
  v_and_b32 v49, 0xffff0000, v52
  v_cvt_pk_bf16_f32 v52, v50, v51
  v_mfma_f32_16x16x32_bf16 v[112:115], v[196:199], v[168:171], v[112:115]
  ds_read_b64_tr_b16 v[214:215], v224 offset:30720
  buffer_load_dwordx4 v[156:159], v233, s[12:15], s63 offen offset:3072 sc1
  v_lshlrev_b32 v50, 16, v52
  v_and_b32 v51, 0xffff0000, v52
  s_add_u32 m0, s64, 12288
  s_add_u32 s65, s48, 688128
  buffer_load_dwordx4 v236, s[36:39], s65 offen lds
  v_mfma_f32_16x16x32_bf16 v[116:119], v[196:199], v[172:175], v[116:119]
  ds_read_b64_tr_b16 v[216:217], v225 offset:24576
  v_add_f32 v48, s55, v48
  v_add_f32 v49, s55, v49
  v_mfma_f32_16x16x32_bf16 v[116:119], v[192:195], v[164:167], v[116:119]
  ds_read_b64_tr_b16 v[218:219], v225 offset:26624
  v_add_f32 v50, s55, v50
  v_add_f32 v51, s55, v51
  s_waitcnt lgkmcnt(6)
  v_mfma_f32_16x16x32_bf16 v[124:127], v[200:203], v[164:167], v[124:127]
  ds_read_b64_tr_b16 v[192:193], v225 offset:28672
  v_cvt_pk_bf16_f32 v52, v48, v49
  v_cvt_pk_bf16_f32 v53, v50, v51
  v_mfma_f32_16x16x32_bf16 v[124:127], v[204:207], v[172:175], v[124:127]
  ds_read_b64_tr_b16 v[194:195], v225 offset:30720
  v_bfe_u32 v48, v0, 3, 4
  v_lshlrev_b32 v48, 7, v48
  v_mfma_f32_16x16x32_bf16 v[120:123], v[204:207], v[168:171], v[120:123]
  ds_read_b64_tr_b16 v[196:197], v226 offset:24576
  v_bfe_u32 v49, v0, 7, 1
  v_lshl_add_u32 v48, v49, 6, v48
  v_mfma_f32_16x16x32_bf16 v[120:123], v[200:203], v[160:163], v[120:123]
  ds_read_b64_tr_b16 v[198:199], v226 offset:26624
  v_and_b32 v49, 3, v0
  v_lshl_add_u32 v48, v49, 4, v48
  s_add_u32 m0, s64, 16384
  s_add_u32 s65, s48, 917504
  buffer_load_dwordx4 v236, s[36:39], s65 offen lds
  s_waitcnt vmcnt(13) lgkmcnt(6)
  v_mfma_f32_16x16x32_bf16 v[96:99], v[208:211], v[176:179], v[96:99]
  ds_read_b64_tr_b16 v[200:201], v226 offset:28672
  s_mul_i32 s63, s75, 4096
  v_bfe_u32 v49, v0, 2, 1
  v_lshl_add_u32 v48, v49, 3, v48
  v_mfma_f32_16x16x32_bf16 v[96:99], v[212:215], v[184:187], v[96:99]
  ds_read_b64_tr_b16 v[202:203], v226 offset:30720
  buffer_load_dwordx4 v[160:163], v232, s[12:15], s63 offen sc1
  v_add_u32 v48, 151552, v48
  ds_write_b64 v48, v[52:53]
  v_mfma_f32_16x16x32_bf16 v[100:103], v[212:215], v[188:191], v[100:103]
  ds_read_b64_tr_b16 v[204:205], v227 offset:24576
  v_add_f32 v32, v32, v33
  v_add_f32 v34, v34, v35
  v_mfma_f32_16x16x32_bf16 v[100:103], v[208:211], v[180:183], v[100:103]
  ds_read_b64_tr_b16 v[206:207], v227 offset:26624
  buffer_load_dwordx4 v[164:167], v233, s[12:15], s63 offen sc1
  v_add_f32 v32, v32, v34
  v_cvt_pk_bf16_f32 v3, v32, v32
  s_waitcnt lgkmcnt(7)
  v_mfma_f32_16x16x32_bf16 v[108:111], v[216:219], v[180:183], v[108:111]
  ds_read_b64_tr_b16 v[208:209], v227 offset:28672
  v_lshlrev_b32 v3, 16, v3
  ds_write_b32 v15, v3 offset:0
  v_mfma_f32_16x16x32_bf16 v[108:111], v[192:195], v[188:191], v[108:111]
  ds_read_b64_tr_b16 v[210:211], v227 offset:30720
  v_add_f32 v80, v80, v81
  v_add_f32 v82, v82, v83
  s_waitcnt vmcnt(63)
  s_barrier
  s_add_u32 m0, s64, 20480
  s_add_u32 s65, s48, 1146880
  buffer_load_dwordx4 v236, s[36:39], s65 offen lds
  v_mfma_f32_16x16x32_bf16 v[104:107], v[192:195], v[184:187], v[104:107]
  ds_read_b64_tr_b16 v[212:213], v224 offset:32768
  v_add_f32 v80, v80, v82
  v_cvt_pk_bf16_f32 v4, v80, v80
  v_mfma_f32_16x16x32_bf16 v[104:107], v[216:219], v[176:179], v[104:107]
  ds_read_b64_tr_b16 v[214:215], v224 offset:34816
  buffer_load_dwordx4 v[168:171], v232, s[12:15], s63 offen offset:1024 sc1
  v_lshlrev_b32 v4, 16, v4
  v_add_f32 v4, 1.0, v4
  s_waitcnt lgkmcnt(8)
  v_mfma_f32_16x16x32_bf16 v[112:115], v[196:199], v[176:179], v[112:115]
  ds_read_b64_tr_b16 v[216:217], v224 offset:36864
  v_cvt_pk_bf16_f32 v4, v4, v4
  v_lshlrev_b32 v4, 16, v4
  v_mfma_f32_16x16x32_bf16 v[112:115], v[200:203], v[184:187], v[112:115]
  ds_read_b64_tr_b16 v[218:219], v224 offset:38912
  buffer_load_dwordx4 v[172:175], v233, s[12:15], s63 offen offset:1024 sc1
  ds_write_b32 v15, v4 offset:256
  ds_read_b64 v[16:17], v10 offset:0
  v_mfma_f32_16x16x32_bf16 v[116:119], v[200:203], v[188:191], v[116:119]
  ds_read_b64_tr_b16 v[192:193], v225 offset:32768
  ds_read_b64 v[18:19], v11 offset:0
  ds_read_b64 v[20:21], v12 offset:0
  v_mfma_f32_16x16x32_bf16 v[116:119], v[196:199], v[180:183], v[116:119]
  ds_read_b64_tr_b16 v[194:195], v225 offset:34816
  ds_read_b64 v[22:23], v13 offset:0
  ds_read_b64 v[24:25], v10 offset:2048
  s_add_u32 m0, s64, 24576
  s_add_u32 s65, s48, 1376256
  buffer_load_dwordx4 v236, s[36:39], s65 offen lds
  s_waitcnt lgkmcnt(12)
  v_mfma_f32_16x16x32_bf16 v[124:127], v[204:207], v[180:183], v[124:127]
  ds_read_b64_tr_b16 v[196:197], v225 offset:36864
  ds_read_b64 v[26:27], v11 offset:2048
  ds_read_b64 v[28:29], v12 offset:2048
  v_mfma_f32_16x16x32_bf16 v[124:127], v[208:211], v[188:191], v[124:127]
  ds_read_b64_tr_b16 v[198:199], v225 offset:38912
  ds_read_b64 v[30:31], v13 offset:2048
  ds_read_b128 v[32:35], v9 offset:0
  v_mfma_f32_16x16x32_bf16 v[120:123], v[208:211], v[184:187], v[120:123]
  ds_read_b64_tr_b16 v[200:201], v226 offset:32768
  ds_read_b128 v[36:39], v9 offset:64
  ds_read_b128 v[40:43], v9 offset:128
  v_mfma_f32_16x16x32_bf16 v[120:123], v[204:207], v[176:179], v[120:123]
  ds_read_b64_tr_b16 v[202:203], v226 offset:34816
  ds_read_b128 v[44:47], v9 offset:192
  ds_read_b128 v[80:83], v9 offset:256
  s_waitcnt vmcnt(14) lgkmcnt(15)
  v_mfma_f32_16x16x32_bf16 v[96:99], v[212:215], v[128:131], v[96:99]
  ds_read_b64_tr_b16 v[204:205], v226 offset:36864
  ds_read_b128 v[84:87], v9 offset:320
  ds_read_b128 v[88:91], v9 offset:384
  v_mfma_f32_16x16x32_bf16 v[96:99], v[216:219], v[136:139], v[96:99]
  ds_read_b64_tr_b16 v[206:207], v226 offset:38912
  buffer_load_dwordx4 v[176:179], v232, s[12:15], s63 offen offset:2048 sc1
  ds_read_b128 v[92:95], v9 offset:448
  s_waitcnt lgkmcnt(12)
  s_add_u32 m0, s64, 28672
  s_add_u32 s65, s48, 1605632
  buffer_load_dwordx4 v236, s[36:39], s65 offen lds
  v_mfma_f32_16x16x32_bf16 v[100:103], v[216:219], v[140:143], v[100:103]
  ds_read_b64_tr_b16 v[208:209], v227 offset:32768
  v_lshlrev_b32 v48, 16, v16
  v_and_b32 v49, 0xffff0000, v16
  v_mfma_f32_16x16x32_bf16 v[100:103], v[212:215], v[132:135], v[100:103]
  ds_read_b64_tr_b16 v[210:211], v227 offset:34816
  buffer_load_dwordx4 v[180:183], v233, s[12:15], s63 offen offset:2048 sc1
  v_lshlrev_b32 v50, 16, v17
  v_and_b32 v51, 0xffff0000, v17
  s_waitcnt lgkmcnt(15)
  v_mfma_f32_16x16x32_bf16 v[108:111], v[192:195], v[132:135], v[108:111]
  ds_read_b64_tr_b16 v[212:213], v227 offset:36864
  v_lshlrev_b32 v52, 16, v18
  v_and_b32 v53, 0xffff0000, v18
  v_mfma_f32_16x16x32_bf16 v[108:111], v[196:199], v[140:143], v[108:111]
  ds_read_b64_tr_b16 v[214:215], v227 offset:38912
  v_lshlrev_b32 v54, 16, v19
  v_and_b32 v55, 0xffff0000, v19
  v_mfma_f32_16x16x32_bf16 v[104:107], v[196:199], v[136:139], v[104:107]
  ds_read_b64_tr_b16 v[216:217], v224 offset:40960
  v_lshlrev_b32 v56, 16, v20
  v_and_b32 v57, 0xffff0000, v20
  v_mfma_f32_16x16x32_bf16 v[104:107], v[192:195], v[128:131], v[104:107]
  ds_read_b64_tr_b16 v[218:219], v224 offset:43008
  buffer_load_dwordx4 v[184:187], v232, s[12:15], s63 offen offset:3072 sc1
  v_lshlrev_b32 v58, 16, v21
  v_and_b32 v59, 0xffff0000, v21
  s_waitcnt lgkmcnt(7)
  v_mfma_f32_16x16x32_bf16 v[112:115], v[200:203], v[128:131], v[112:115]
  ds_read_b64_tr_b16 v[192:193], v224 offset:45056
  v_lshlrev_b32 v60, 16, v22
  v_and_b32 v61, 0xffff0000, v22
  v_mfma_f32_16x16x32_bf16 v[112:115], v[204:207], v[136:139], v[112:115]
  ds_read_b64_tr_b16 v[194:195], v224 offset:47104
  buffer_load_dwordx4 v[188:191], v233, s[12:15], s63 offen offset:3072 sc1
  v_lshlrev_b32 v62, 16, v23
  v_and_b32 v63, 0xffff0000, v23
  v_mfma_f32_16x16x32_bf16 v[116:119], v[204:207], v[140:143], v[116:119]
  ds_read_b64_tr_b16 v[196:197], v225 offset:40960
  v_lshlrev_b32 v64, 16, v24
  v_and_b32 v65, 0xffff0000, v24
  v_mfma_f32_16x16x32_bf16 v[116:119], v[200:203], v[132:135], v[116:119]
  ds_read_b64_tr_b16 v[198:199], v225 offset:43008
  s_add_u32 m0, s64, 32768
  s_add_u32 s65, s48, 1835008
  buffer_load_dwordx4 v236, s[36:39], s65 offen lds
  v_lshlrev_b32 v66, 16, v25
  v_and_b32 v67, 0xffff0000, v25
  s_waitcnt lgkmcnt(6)
  v_mfma_f32_16x16x32_bf16 v[124:127], v[208:211], v[132:135], v[124:127]
  ds_read_b64_tr_b16 v[200:201], v225 offset:45056
  v_lshlrev_b32 v68, 16, v26
  v_and_b32 v69, 0xffff0000, v26
  v_mfma_f32_16x16x32_bf16 v[124:127], v[212:215], v[140:143], v[124:127]
  ds_read_b64_tr_b16 v[202:203], v225 offset:47104
  s_add_u32 m0, s64, 36864
  s_add_u32 s65, s48, 2064384
  buffer_load_dwordx4 v236, s[36:39], s65 offen lds
  v_lshlrev_b32 v70, 16, v27
  v_and_b32 v71, 0xffff0000, v27
  v_mfma_f32_16x16x32_bf16 v[120:123], v[212:215], v[136:139], v[120:123]
  ds_read_b64_tr_b16 v[204:205], v226 offset:40960
  v_lshlrev_b32 v72, 16, v28
  v_and_b32 v73, 0xffff0000, v28
  v_mfma_f32_16x16x32_bf16 v[120:123], v[208:211], v[128:131], v[120:123]
  ds_read_b64_tr_b16 v[206:207], v226 offset:43008
  s_add_u32 m0, s64, 40960
  s_add_u32 s65, s48, 2293760
  buffer_load_dwordx4 v236, s[36:39], s65 offen lds
  v_lshlrev_b32 v74, 16, v29
  v_and_b32 v75, 0xffff0000, v29
  s_waitcnt vmcnt(16) lgkmcnt(6)
  v_mfma_f32_16x16x32_bf16 v[96:99], v[216:219], v[144:147], v[96:99]
  ds_read_b64_tr_b16 v[208:209], v226 offset:45056
  v_lshlrev_b32 v76, 16, v30
  v_and_b32 v77, 0xffff0000, v30
  v_mfma_f32_16x16x32_bf16 v[96:99], v[192:195], v[152:155], v[96:99]
  ds_read_b64_tr_b16 v[210:211], v226 offset:47104
  s_add_u32 m0, s64, 45056
  s_add_u32 s65, s48, 2523136
  buffer_load_dwordx4 v236, s[36:39], s65 offen lds
  v_lshlrev_b32 v78, 16, v31
  v_and_b32 v79, 0xffff0000, v31
  v_mfma_f32_16x16x32_bf16 v[100:103], v[192:195], v[156:159], v[100:103]
  ds_read_b64_tr_b16 v[212:213], v227 offset:40960
  s_lshr_b32 s55, s57, 15
  s_lshl_b32 s55, s55, 11
  v_mfma_f32_16x16x32_bf16 v[100:103], v[216:219], v[148:151], v[100:103]
  ds_read_b64_tr_b16 v[214:215], v227 offset:43008
  s_add_u32 m0, s64, 49152
  s_add_u32 s65, s48, 2752512
  buffer_load_dwordx4 v236, s[36:39], s65 offen lds
  s_bfe_u32 s56, s54, 0x10001
  s_lshl_b32 s56, s56, 10
  s_waitcnt lgkmcnt(6)
  v_mfma_f32_16x16x32_bf16 v[108:111], v[196:199], v[148:151], v[108:111]
  ds_read_b64_tr_b16 v[216:217], v227 offset:45056
  s_add_u32 s55, s55, s56
  s_lshr_b32 s56, s54, 2
  v_mfma_f32_16x16x32_bf16 v[108:111], v[200:203], v[156:159], v[108:111]
  ds_read_b64_tr_b16 v[218:219], v227 offset:47104
  s_add_u32 m0, s64, 53248
  s_add_u32 s65, s48, 2981888
  buffer_load_dwordx4 v236, s[36:39], s65 offen lds
  s_lshl_b32 s56, s56, 8
  s_add_u32 s55, s55, s56
  s_waitcnt vmcnt(63)
  s_barrier
  v_mfma_f32_16x16x32_bf16 v[104:107], v[200:203], v[152:155], v[104:107]
  ds_read_b64_tr_b16 v[192:193], v224 offset:49152
  s_and_b32 s56, s54, 1
  s_lshl_b32 s56, s56, 3
  v_mfma_f32_16x16x32_bf16 v[104:107], v[196:199], v[144:147], v[104:107]
  ds_read_b64_tr_b16 v[194:195], v224 offset:51200
  s_add_u32 m0, s64, 57344
  s_add_u32 s65, s48, 3211264
  buffer_load_dwordx4 v236, s[36:39], s65 offen lds
  s_add_u32 s55, s55, s56
  s_waitcnt lgkmcnt(6)
  v_mfma_f32_16x16x32_bf16 v[112:115], v[204:207], v[144:147], v[112:115]
  ds_read_b64_tr_b16 v[196:197], v224 offset:53248
  v_mfma_f32_16x16x32_bf16 v[112:115], v[208:211], v[152:155], v[112:115]
  ds_read_b64_tr_b16 v[198:199], v224 offset:55296
  s_add_u32 m0, s64, 61440
  s_add_u32 s65, s48, 3440640
  buffer_load_dwordx4 v236, s[36:39], s65 offen lds
  v_mfma_f32_16x16x32_bf16 v[116:119], v[208:211], v[156:159], v[116:119]
  ds_read_b64_tr_b16 v[200:201], v225 offset:49152
  v_mfma_f32_16x16x32_bf16 v[116:119], v[204:207], v[148:151], v[116:119]
  ds_read_b64_tr_b16 v[202:203], v225 offset:51200
  s_waitcnt lgkmcnt(6)
  v_mfma_f32_16x16x32_bf16 v[124:127], v[212:215], v[148:151], v[124:127]
  ds_read_b64_tr_b16 v[204:205], v225 offset:53248
  v_mfma_f32_16x16x32_bf16 v[124:127], v[216:219], v[156:159], v[124:127]
  ds_read_b64_tr_b16 v[206:207], v225 offset:55296
  v_mfma_f32_16x16x32_bf16 v[120:123], v[216:219], v[152:155], v[120:123]
  ds_read_b64_tr_b16 v[208:209], v226 offset:49152
  v_mfma_f32_16x16x32_bf16 v[120:123], v[212:215], v[144:147], v[120:123]
  ds_read_b64_tr_b16 v[210:211], v226 offset:51200
  s_waitcnt vmcnt(14) lgkmcnt(6)
  v_mfma_f32_16x16x32_bf16 v[96:99], v[192:195], v[160:163], v[96:99]
  ds_read_b64_tr_b16 v[212:213], v226 offset:53248
  v_mfma_f32_16x16x32_bf16 v[96:99], v[196:199], v[168:171], v[96:99]
  ds_read_b64_tr_b16 v[214:215], v226 offset:55296
  v_mfma_f32_16x16x32_bf16 v[100:103], v[196:199], v[172:175], v[100:103]
  ds_read_b64_tr_b16 v[216:217], v227 offset:49152
  v_mfma_f32_16x16x32_bf16 v[100:103], v[192:195], v[164:167], v[100:103]
  ds_read_b64_tr_b16 v[218:219], v227 offset:51200
  s_waitcnt lgkmcnt(6)
  v_mfma_f32_16x16x32_bf16 v[108:111], v[200:203], v[164:167], v[108:111]
  ds_read_b64_tr_b16 v[192:193], v227 offset:53248
  v_mfma_f32_16x16x32_bf16 v[108:111], v[204:207], v[172:175], v[108:111]
  ds_read_b64_tr_b16 v[194:195], v227 offset:55296
  v_mfma_f32_16x16x32_bf16 v[104:107], v[204:207], v[168:171], v[104:107]
  ds_read_b64_tr_b16 v[196:197], v224 offset:57344
  v_mfma_f32_16x16x32_bf16 v[104:107], v[200:203], v[160:163], v[104:107]
  ds_read_b64_tr_b16 v[198:199], v224 offset:59392
  s_waitcnt lgkmcnt(6)
  v_mfma_f32_16x16x32_bf16 v[112:115], v[208:211], v[160:163], v[112:115]
  ds_read_b64_tr_b16 v[200:201], v224 offset:61440
  v_mfma_f32_16x16x32_bf16 v[112:115], v[212:215], v[168:171], v[112:115]
  ds_read_b64_tr_b16 v[202:203], v224 offset:63488
  v_mfma_f32_16x16x32_bf16 v[116:119], v[212:215], v[172:175], v[116:119]
  ds_read_b64_tr_b16 v[204:205], v225 offset:57344
  v_mfma_f32_16x16x32_bf16 v[116:119], v[208:211], v[164:167], v[116:119]
  ds_read_b64_tr_b16 v[206:207], v225 offset:59392
  s_waitcnt lgkmcnt(6)
  v_mfma_f32_16x16x32_bf16 v[124:127], v[216:219], v[164:167], v[124:127]
  ds_read_b64_tr_b16 v[208:209], v225 offset:61440
  v_mfma_f32_16x16x32_bf16 v[124:127], v[192:195], v[172:175], v[124:127]
  ds_read_b64_tr_b16 v[210:211], v225 offset:63488
  v_mfma_f32_16x16x32_bf16 v[120:123], v[192:195], v[168:171], v[120:123]
  ds_read_b64_tr_b16 v[212:213], v226 offset:57344
  v_mfma_f32_16x16x32_bf16 v[120:123], v[216:219], v[160:163], v[120:123]
  ds_read_b64_tr_b16 v[214:215], v226 offset:59392
  s_waitcnt vmcnt(8) lgkmcnt(6)
  v_mfma_f32_16x16x32_bf16 v[96:99], v[196:199], v[176:179], v[96:99]
  ds_read_b64_tr_b16 v[216:217], v226 offset:61440
  v_mfma_f32_16x16x32_bf16 v[96:99], v[200:203], v[184:187], v[96:99]
  ds_read_b64_tr_b16 v[218:219], v226 offset:63488
  v_mfma_f32_16x16x32_bf16 v[100:103], v[200:203], v[188:191], v[100:103]
  ds_read_b64_tr_b16 v[192:193], v227 offset:57344
  v_mfma_f32_16x16x32_bf16 v[100:103], v[196:199], v[180:183], v[100:103]
  ds_read_b64_tr_b16 v[194:195], v227 offset:59392
  s_waitcnt lgkmcnt(6)
  v_mfma_f32_16x16x32_bf16 v[108:111], v[204:207], v[180:183], v[108:111]
  ds_read_b64_tr_b16 v[196:197], v227 offset:61440
  v_mfma_f32_16x16x32_bf16 v[108:111], v[208:211], v[188:191], v[108:111]
  ds_read_b64_tr_b16 v[198:199], v227 offset:63488
  v_mfma_f32_16x16x32_bf16 v[104:107], v[208:211], v[184:187], v[104:107]
  v_mfma_f32_16x16x32_bf16 v[104:107], v[204:207], v[176:179], v[104:107]
  s_waitcnt lgkmcnt(4)
  v_mfma_f32_16x16x32_bf16 v[112:115], v[212:215], v[176:179], v[112:115]
  v_mfma_f32_16x16x32_bf16 v[112:115], v[216:219], v[184:187], v[112:115]
  v_mfma_f32_16x16x32_bf16 v[116:119], v[216:219], v[188:191], v[116:119]
  v_mfma_f32_16x16x32_bf16 v[116:119], v[212:215], v[180:183], v[116:119]
  s_waitcnt lgkmcnt(0)
  v_mfma_f32_16x16x32_bf16 v[124:127], v[192:195], v[180:183], v[124:127]
  v_mfma_f32_16x16x32_bf16 v[124:127], v[196:199], v[188:191], v[124:127]
  v_mfma_f32_16x16x32_bf16 v[120:123], v[196:199], v[184:187], v[120:123]
  v_mfma_f32_16x16x32_bf16 v[120:123], v[192:195], v[176:179], v[120:123]
  s_waitcnt lgkmcnt(0)
  s_nop 4
  v_fmac_f32 v48, v32, v96
  v_fmac_f32 v49, v33, v97
  v_fmac_f32 v50, v34, v98
  v_fmac_f32 v51, v35, v99
  v_mul_f32 v96, v48, v80
  v_mul_f32 v97, v49, v81
  v_mul_f32 v98, v50, v82
  v_mul_f32 v99, v51, v83
  v_cvt_pk_bf16_f32 v192, v96, v97
  v_cvt_pk_bf16_f32 v193, v98, v99
  v_fmac_f32 v52, v36, v104
  v_fmac_f32 v53, v37, v105
  v_fmac_f32 v54, v38, v106
  v_fmac_f32 v55, v39, v107
  v_mul_f32 v104, v52, v84
  v_mul_f32 v105, v53, v85
  v_mul_f32 v106, v54, v86
  v_mul_f32 v107, v55, v87
  v_cvt_pk_bf16_f32 v194, v104, v105
  v_cvt_pk_bf16_f32 v195, v106, v107
  buffer_store_dwordx4 v[192:195], v2, s[28:31], s59 offen offset:0 sc1
  v_fmac_f32 v56, v40, v112
  v_fmac_f32 v57, v41, v113
  v_fmac_f32 v58, v42, v114
  v_fmac_f32 v59, v43, v115
  v_mul_f32 v112, v56, v88
  v_mul_f32 v113, v57, v89
  v_mul_f32 v114, v58, v90
  v_mul_f32 v115, v59, v91
  v_cvt_pk_bf16_f32 v196, v112, v113
  v_cvt_pk_bf16_f32 v197, v114, v115
  v_fmac_f32 v60, v44, v120
  v_fmac_f32 v61, v45, v121
  v_fmac_f32 v62, v46, v122
  v_fmac_f32 v63, v47, v123
  v_mul_f32 v120, v60, v92
  v_mul_f32 v121, v61, v93
  v_mul_f32 v122, v62, v94
  v_mul_f32 v123, v63, v95
  v_cvt_pk_bf16_f32 v198, v120, v121
  v_cvt_pk_bf16_f32 v199, v122, v123
  buffer_store_dwordx4 v[196:199], v2, s[28:31], s59 offen offset:1024 sc1
  v_fmac_f32 v64, v32, v100
  v_fmac_f32 v65, v33, v101
  v_fmac_f32 v66, v34, v102
  v_fmac_f32 v67, v35, v103
  v_mul_f32 v100, v64, v80
  v_mul_f32 v101, v65, v81
  v_mul_f32 v102, v66, v82
  v_mul_f32 v103, v67, v83
  v_cvt_pk_bf16_f32 v200, v100, v101
  v_cvt_pk_bf16_f32 v201, v102, v103
  v_fmac_f32 v68, v36, v108
  v_fmac_f32 v69, v37, v109
  v_fmac_f32 v70, v38, v110
  v_fmac_f32 v71, v39, v111
  v_mul_f32 v108, v68, v84
  v_mul_f32 v109, v69, v85
  v_mul_f32 v110, v70, v86
  v_mul_f32 v111, v71, v87
  v_cvt_pk_bf16_f32 v202, v108, v109
  v_cvt_pk_bf16_f32 v203, v110, v111
  buffer_store_dwordx4 v[200:203], v2, s[28:31], s60 offen offset:0 sc1
  v_fmac_f32 v72, v40, v116
  v_fmac_f32 v73, v41, v117
  v_fmac_f32 v74, v42, v118
  v_fmac_f32 v75, v43, v119
  v_mul_f32 v116, v72, v88
  v_mul_f32 v117, v73, v89
  v_mul_f32 v118, v74, v90
  v_mul_f32 v119, v75, v91
  v_cvt_pk_bf16_f32 v204, v116, v117
  v_cvt_pk_bf16_f32 v205, v118, v119
  v_fmac_f32 v76, v44, v124
  v_fmac_f32 v77, v45, v125
  v_fmac_f32 v78, v46, v126
  v_fmac_f32 v79, v47, v127
  v_mul_f32 v124, v76, v92
  v_mul_f32 v125, v77, v93
  v_mul_f32 v126, v78, v94
  v_mul_f32 v127, v79, v95
  v_cvt_pk_bf16_f32 v206, v124, v125
  v_cvt_pk_bf16_f32 v207, v126, v127
  buffer_store_dwordx4 v[204:207], v2, s[28:31], s60 offen offset:1024 sc1
  v_cvt_pk_bf16_f32 v16, v48, v49
  v_cvt_pk_bf16_f32 v17, v50, v51
  v_cvt_pk_bf16_f32 v18, v52, v53
  v_cvt_pk_bf16_f32 v19, v54, v55
  buffer_store_dwordx4 v[16:19], v2, s[20:23], s59 offen offset:0 sc1
  v_cvt_pk_bf16_f32 v20, v56, v57
  v_cvt_pk_bf16_f32 v21, v58, v59
  v_cvt_pk_bf16_f32 v22, v60, v61
  v_cvt_pk_bf16_f32 v23, v62, v63
  buffer_store_dwordx4 v[20:23], v2, s[20:23], s59 offen offset:1024 sc1
  v_cvt_pk_bf16_f32 v24, v64, v65
  v_cvt_pk_bf16_f32 v25, v66, v67
  v_cvt_pk_bf16_f32 v26, v68, v69
  v_cvt_pk_bf16_f32 v27, v70, v71
  buffer_store_dwordx4 v[24:27], v2, s[20:23], s60 offen offset:0 sc1
  v_cvt_pk_bf16_f32 v28, v72, v73
  v_cvt_pk_bf16_f32 v29, v74, v75
  v_cvt_pk_bf16_f32 v30, v76, v77
  v_cvt_pk_bf16_f32 v31, v78, v79
  buffer_store_dwordx4 v[28:31], v2, s[20:23], s60 offen offset:1024 sc1
  v_add_f32 v96, v48, v49
  v_mul_f32 v97, v48, v48
  v_add_f32 v98, v50, v51
  v_mul_f32 v99, v49, v49
  v_fmac_f32 v97, v50, v50
  v_fmac_f32 v99, v51, v51
  v_fmac_f32 v97, v52, v52
  v_add_f32 v96, v96, v52
  v_fmac_f32 v99, v53, v53
  v_add_f32 v98, v98, v53
  v_fmac_f32 v97, v54, v54
  v_add_f32 v96, v96, v54
  v_fmac_f32 v99, v55, v55
  v_add_f32 v98, v98, v55
  v_fmac_f32 v97, v56, v56
  v_add_f32 v96, v96, v56
  v_fmac_f32 v99, v57, v57
  v_add_f32 v98, v98, v57
  v_fmac_f32 v97, v58, v58
  v_add_f32 v96, v96, v58
  v_fmac_f32 v99, v59, v59
  v_add_f32 v98, v98, v59
  v_fmac_f32 v97, v60, v60
  v_add_f32 v96, v96, v60
  v_fmac_f32 v99, v61, v61
  v_add_f32 v98, v98, v61
  v_fmac_f32 v97, v62, v62
  v_add_f32 v96, v96, v62
  v_fmac_f32 v99, v63, v63
  v_add_f32 v98, v98, v63
  v_add_f32 v96, v96, v98
  v_add_f32 v97, v97, v99
  v_add_f32 v100, v64, v65
  v_mul_f32 v101, v64, v64
  v_add_f32 v102, v66, v67
  v_mul_f32 v103, v65, v65
  v_fmac_f32 v101, v66, v66
  v_fmac_f32 v103, v67, v67
  v_fmac_f32 v101, v68, v68
  v_add_f32 v100, v100, v68
  v_fmac_f32 v103, v69, v69
  v_add_f32 v102, v102, v69
  v_fmac_f32 v101, v70, v70
  v_add_f32 v100, v100, v70
  v_fmac_f32 v103, v71, v71
  v_add_f32 v102, v102, v71
  v_fmac_f32 v101, v72, v72
  v_add_f32 v100, v100, v72
  v_fmac_f32 v103, v73, v73
  v_add_f32 v102, v102, v73
  v_fmac_f32 v101, v74, v74
  v_add_f32 v100, v100, v74
  v_fmac_f32 v103, v75, v75
  v_add_f32 v102, v102, v75
  v_fmac_f32 v101, v76, v76
  v_add_f32 v100, v100, v76
  v_fmac_f32 v103, v77, v77
  v_add_f32 v102, v102, v77
  v_fmac_f32 v101, v78, v78
  v_add_f32 v100, v100, v78
  v_fmac_f32 v103, v79, v79
  v_add_f32 v102, v102, v79
  v_add_f32 v100, v100, v102
  v_add_f32 v101, v101, v103
  v_mov_b32 v98, v96
  v_mov_b32 v99, v97
  v_mov_b32 v102, v100
  v_mov_b32 v103, v101
  s_nop 0
  v_permlane16_swap_b32 v96, v98
  v_permlane16_swap_b32 v97, v99
  v_permlane16_swap_b32 v100, v102
  v_permlane16_swap_b32 v101, v103
  v_add_f32 v96, v96, v98
  v_add_f32 v97, v97, v99
  v_add_f32 v100, v100, v102
  v_add_f32 v101, v101, v103
  v_mov_b32 v98, v96
  v_mov_b32 v99, v97
  v_mov_b32 v102, v100
  v_mov_b32 v103, v101
  s_nop 0
  v_permlane32_swap_b32 v96, v98
  v_permlane32_swap_b32 v97, v99
  v_permlane32_swap_b32 v100, v102
  v_permlane32_swap_b32 v101, v103
  v_add_f32 v96, v96, v98
  v_add_f32 v97, v97, v99
  v_add_f32 v100, v100, v102
  v_add_f32 v101, v101, v103
  s_mov_b64 exec, 0xffff
  buffer_store_dwordx2 v[96:97], v2, s[32:35], s55 offen offset:0
  buffer_store_dwordx2 v[100:101], v2, s[32:35], s55 offen offset:2048
  s_mov_b64 exec, -1
  s_waitcnt vmcnt(10) lgkmcnt(0)
  s_barrier
  ds_read_b64_tr_b16 v[128:129], v237 offset:0
  ds_read_b64_tr_b16 v[130:131], v237 offset:2048
  ds_read_b128 v[160:163], v238 offset:0
  ds_read_b64_tr_b16 v[132:133], v237 offset:4096
  ds_read_b64_tr_b16 v[134:135], v237 offset:6144
  ds_read_b128 v[164:167], v238 offset:128
  ds_read_b64_tr_b16 v[136:137], v237 offset:8192
  ds_read_b64_tr_b16 v[138:139], v237 offset:10240
  ds_read_b128 v[168:171], v238 offset:256
  ds_read_b64_tr_b16 v[140:141], v237 offset:12288
  ds_read_b64_tr_b16 v[142:143], v237 offset:14336
  ds_read_b128 v[172:175], v238 offset:384
  ds_read_b64_tr_b16 v[144:145], v237 offset:16384
  ds_read_b64_tr_b16 v[146:147], v237 offset:18432
  ds_read_b128 v[176:179], v238 offset:512
  s_waitcnt lgkmcnt(12)
  v_mfma_f32_16x16x32_bf16 v[80:83], v[128:131], v[160:163], 0
HOP5:
  s_cbranch_execz WRET0
  ds_read_b64_tr_b16 v[148:149], v237 offset:20480
  ds_read_b64_tr_b16 v[150:151], v237 offset:22528
  ds_read_b128 v[180:183], v238 offset:640
  s_waitcnt lgkmcnt(12)
  v_mfma_f32_16x16x32_bf16 v[80:83], v[132:135], v[164:167], v[80:83]
  ds_read_b64_tr_b16 v[152:153], v237 offset:24576
  ds_read_b64_tr_b16 v[154:155], v237 offset:26624
  ds_read_b128 v[184:187], v238 offset:768
  s_waitcnt lgkmcnt(12)
  v_mfma_f32_16x16x32_bf16 v[80:83], v[136:139], v[168:171], v[80:83]
  ds_read_b64_tr_b16 v[156:157], v237 offset:28672
  ds_read_b64_tr_b16 v[158:159], v237 offset:30720
  ds_read_b128 v[188:191], v238 offset:896
  s_waitcnt lgkmcnt(12)
  v_mfma_f32_16x16x32_bf16 v[80:83], v[140:143], v[172:175], v[80:83]
  ds_read_b64_tr_b16 v[128:129], v237 offset:32768
  ds_read_b64_tr_b16 v[130:131], v237 offset:34816
  ds_read_b128 v[160:163], v238 offset:1024
  s_waitcnt lgkmcnt(12)
  v_mfma_f32_16x16x32_bf16 v[80:83], v[144:147], v[176:179], v[80:83]
  ds_read_b64_tr_b16 v[132:133], v237 offset:36864
  ds_read_b64_tr_b16 v[134:135], v237 offset:38912
  ds_read_b128 v[164:167], v238 offset:1152
  s_waitcnt lgkmcnt(12)
  v_mfma_f32_16x16x32_bf16 v[80:83], v[148:151], v[180:183], v[80:83]
  ds_read_b64_tr_b16 v[136:137], v237 offset:40960
  ds_read_b64_tr_b16 v[138:139], v237 offset:43008
  ds_read_b128 v[168:171], v238 offset:1280
  s_waitcnt lgkmcnt(12)
  v_mfma_f32_16x16x32_bf16 v[80:83], v[152:155], v[184:187], v[80:83]
  ds_read_b64_tr_b16 v[140:141], v237 offset:45056
  ds_read_b64_tr_b16 v[142:143], v237 offset:47104
  ds_read_b128 v[172:175], v238 offset:1408
  s_waitcnt lgkmcnt(12)
  v_mfma_f32_16x16x32_bf16 v[80:83], v[156:159], v[188:191], v[80:83]
  ds_read_b64_tr_b16 v[144:145], v237 offset:49152
  ds_read_b64_tr_b16 v[146:147], v237 offset:51200
  ds_read_b128 v[176:179], v238 offset:1536
  s_waitcnt lgkmcnt(12)
  v_mfma_f32_16x16x32_bf16 v[80:83], v[128:131], v[160:163], v[80:83]
  ds_read_b64_tr_b16 v[148:149], v237 offset:53248
  ds_read_b64_tr_b16 v[150:151], v237 offset:55296
  ds_read_b128 v[180:183], v238 offset:1664
  s_waitcnt lgkmcnt(12)
  v_mfma_f32_16x16x32_bf16 v[80:83], v[132:135], v[164:167], v[80:83]
  ds_read_b64_tr_b16 v[152:153], v237 offset:57344
  ds_read_b64_tr_b16 v[154:155], v237 offset:59392
  ds_read_b128 v[184:187], v238 offset:1792
  s_waitcnt lgkmcnt(12)
  v_mfma_f32_16x16x32_bf16 v[80:83], v[136:139], v[168:171], v[80:83]
  ds_read_b64_tr_b16 v[156:157], v237 offset:61440
  ds_read_b64_tr_b16 v[158:159], v237 offset:63488
  ds_read_b128 v[188:191], v238 offset:1920
  s_waitcnt lgkmcnt(12)
  v_mfma_f32_16x16x32_bf16 v[80:83], v[140:143], v[172:175], v[80:83]
  s_waitcnt lgkmcnt(9)
  v_mfma_f32_16x16x32_bf16 v[80:83], v[144:147], v[176:179], v[80:83]
  s_waitcnt lgkmcnt(6)
  v_mfma_f32_16x16x32_bf16 v[80:83], v[148:151], v[180:183], v[80:83]
  s_waitcnt lgkmcnt(3)
  v_mfma_f32_16x16x32_bf16 v[80:83], v[152:155], v[184:187], v[80:83]
  s_waitcnt lgkmcnt(0)
  v_mfma_f32_16x16x32_bf16 v[80:83], v[156:159], v[188:191], v[80:83]
  s_mov_b32 exec_lo, 0x00030003
  s_mov_b32 exec_hi, 0x00030003
  s_nop 7
  buffer_store_dwordx4 v[80:83], v239, s[44:47], s49 offen
  s_mov_b64 exec, -1
E_k3_qkv_kernel:
X_k3_qkv_kernel:
  s_endpgm
.globl k5_ffn_kernel
.type k5_ffn_kernel,@function
.p2align 8
k5_ffn_kernel:
  s_cmp_ge_u32 s2, 256
  s_cbranch_scc1 X_k5_ffn_kernel
  s_load_dwordx2 s[4:5], s[0:1], 88
  s_load_dwordx2 s[8:9], s[0:1], 32
  s_load_dwordx2 s[12:13], s[0:1], 40
  s_load_dwordx2 s[16:17], s[0:1], 48
  s_load_dwordx2 s[20:21], s[0:1], 72
  s_branch BODY1
.p2align 12
BODY1:
  v_lshrrev_b32 v32, 6, v0
  v_and_b32 v9, 63, v0
  v_readfirstlane_b32 s24, v32
  s_and_b32 s27, s2, 7
  s_bfe_u32 s26, s2, 0x20003
  s_lshr_b32 s25, s2, 5
  s_lshl_b32 s31, s24, 10
  s_add_u32 s32, s25, s26
  s_and_b32 s32, s32, 3
  s_lshl_b32 s34, s26, 2
  s_lshr_b32 s28, 0xb762, s34
  s_and_b32 s35, s28, 15
  s_lshl_b32 s28, s26, 3
  s_lshr_b32 s28, 0x15140706, s28
  s_and_b32 s36, s28, 31
  v_lshrrev_b32 v32, 3, v9
  v_bfe_u32 v33, v32, 1, 2
  v_bfe_u32 v34, v9, 1, 2
  v_xor_b32 v33, v33, v34
  s_lshl_b32 s28, s24, 3
  v_add_u32 v32, s28, v32
  v_mul_u32_u24 v32, 7168, v32
  v_and_b32 v34, 1, v9
  v_lshl_add_u32 v32, v34, 4, v32
  s_mul_i32 s28, s27, 896
  v_add_u32 v32, s28, v32
  v_lshlrev_b32 v34, 5, v33
  s_lshl_b32 s28, s34, 6
  v_add3_u32 v10, v32, v34, s28
  s_lshl_b32 s28, s35, 6
  v_add_u32 v34, s28, v34
  s_lshl_b32 s28, s36, 5
  v_mov_b32 v35, s28
  v_cmp_gt_u32 vcc, 2, v33
  s_nop 1
  v_cndmask_b32 v34, v35, v34, vcc
  v_add_u32 v11, v32, v34
  v_lshlrev_b32 v1, 4, v9
  s_lshl_b32 s28, s25, 4
  s_lshr_b32 s29, s24, 1
  s_lshl_b32 s29, s29, 3
  s_add_u32 s28, s28, s29
  s_and_b32 s29, s24, 1
  s_add_u32 s39, s28, s29
  s_lshl_b32 s33, s39, 15
  s_add_u32 s33, s33, 36700160
  s_mov_b32 s6, 134217728
  s_mov_b32 s7, 0x20000
  s_mov_b32 s10, 7340032
  s_mov_b32 s11, 0x20000
  s_mov_b32 s14, 7340032
  s_mov_b32 s15, 0x20000
  s_mov_b32 s18, 7340032
  s_mov_b32 s19, 0x20000
  s_mov_b32 s22, 4194304
  s_mov_b32 s23, 0x20000
  s_waitcnt lgkmcnt(0)
  s_lshr_b32 s73, s2, 3
  s_lshl_b32 s73, s73, 2
  s_add_u32 s73, s73, s24
  s_lshl_b32 s73, s73, 11
  s_mov_b32 s40, 0
  s_add_u32 s48, s33, 0
  s_add_u32 m0, s31, 65536
  s_nop 0
  buffer_load_dwordx4 v11, s[8:11], s40 offen lds
  s_add_u32 m0, s31, 73728
  s_nop 0
  buffer_load_dwordx4 v11, s[12:15], s40 offen lds
  s_add_u32 m0, s31, 69632
  s_add_u32 s37, s40, 229376
  buffer_load_dwordx4 v11, s[8:11], s37 offen lds
  s_add_u32 m0, s31, 77824
  s_add_u32 s37, s40, 229376
  buffer_load_dwordx4 v11, s[12:15], s37 offen lds
  buffer_load_dwordx4 a[0:3], v1, s[4:7], s48 offen offset:0 sc1
  buffer_load_dwordx4 a[16:19], v1, s[4:7], s48 offen offset:1024 sc1
  s_add_u32 s48, s48, 65536
  buffer_load_dwordx4 a[4:7], v1, s[4:7], s48 offen offset:0 sc1
  buffer_load_dwordx4 a[20:23], v1, s[4:7], s48 offen offset:1024 sc1
  s_add_u32 s48, s48, 65536
  buffer_load_dwordx4 a[8:11], v1, s[4:7], s48 offen offset:0 sc1
  buffer_load_dwordx4 a[24:27], v1, s[4:7], s48 offen offset:1024 sc1
  s_add_u32 s48, s48, 65536
  buffer_load_dwordx4 a[12:15], v1, s[4:7], s48 offen offset:0 sc1
  buffer_load_dwordx4 a[28:31], v1, s[4:7], s48 offen offset:1024 sc1
  s_add_u32 m0, s31, 0
  s_nop 0
  buffer_load_dwordx4 v10, s[8:11], s40 offen lds
  s_add_u32 m0, s31, 8192
  s_nop 0
  buffer_load_dwordx4 v10, s[12:15], s40 offen lds
  s_add_u32 m0, s31, 4096
  s_add_u32 s37, s40, 229376
  buffer_load_dwordx4 v10, s[8:11], s37 offen lds
  s_add_u32 m0, s31, 12288
  s_add_u32 s37, s40, 229376
  buffer_load_dwordx4 v10, s[12:15], s37 offen lds
  v_lshrrev_b32 v33, 2, v9
  v_bfe_u32 v32, v33, 1, 2
  v_lshlrev_b32 v32, 5, v32
  v_lshl_add_u32 v32, v33, 7, v32
  v_and_b32 v33, 3, v9
  v_lshl_add_u32 v2, v33, 3, v32
  v_xor_b32 v3, 32, v2
  v_xor_b32 v4, 64, v2
  v_xor_b32 v5, 96, v2
  v_add_u32 v6, 65536, v2
  v_add_u32 v7, 65536, v3
  v_add_u32 v8, 65536, v4
  s_mov_b64 exec, 0
  s_cmp_eq_u32 s24, 0
  s_cbranch_scc1 HOP6
  s_cmp_eq_u32 s24, 1
  s_cbranch_scc1 HOP7
  s_cmp_eq_u32 s24, 2
  s_cbranch_scc1 HOP8
  s_cmp_eq_u32 s24, 3
  s_cbranch_scc1 HOP9
WRET1:
  s_mov_b64 exec, -1
  s_waitcnt vmcnt(0)
  s_barrier
  ds_read_b64_tr_b16 a[160:161], v6 offset:0
  ds_read_b64_tr_b16 a[162:163], v6 offset:2048
  ds_read_b64_tr_b16 a[164:165], v6 offset:4096
  ds_read_b64_tr_b16 a[166:167], v6 offset:6144
  ds_read_b64_tr_b16 a[168:169], v6 offset:8192
  ds_read_b64_tr_b16 a[170:171], v6 offset:10240
  ds_read_b64_tr_b16 a[172:173], v6 offset:12288
  ds_read_b64_tr_b16 a[174:175], v6 offset:14336
  ds_read_b64_tr_b16 a[176:177], v7 offset:0
  s_waitcnt vmcnt(4) lgkmcnt(5)
  v_mfma_f32_16x16x32_bf16 v[64:67], a[160:163], a[0:3], 0
  ds_read_b64_tr_b16 a[178:179], v7 offset:2048
  s_cmp_eq_u32 s32, 1
  s_cselect_b32 s49, 5, 1
  s_mul_i32 s41, s49, 458752
  s_lshl_b32 s49, s49, 11
  s_add_u32 s49, s49, s33
  s_add_u32 m0, s31, 81920
  v_mfma_f32_16x16x32_bf16 v[64:67], a[164:167], a[16:19], v[64:67]
  buffer_load_dwordx4 v11, s[8:11], s41 offen lds
  v_mfma_f32_16x16x32_bf16 v[68:71], a[164:167], a[20:23], 0
  ds_read_b64_tr_b16 a[180:181], v7 offset:4096
  v_mfma_f32_16x16x32_bf16 v[68:71], a[160:163], a[4:7], v[68:71]
  v_mfma_f32_16x16x32_bf16 v[72:75], a[160:163], a[8:11], 0
  ds_read_b64_tr_b16 a[182:183], v7 offset:6144
  s_add_u32 m0, s31, 90112
  v_mfma_f32_16x16x32_bf16 v[72:75], a[164:167], a[24:27], v[72:75]
  buffer_load_dwordx4 v11, s[12:15], s41 offen lds
  v_mfma_f32_16x16x32_bf16 v[76:79], a[164:167], a[28:31], 0
  ds_read_b64_tr_b16 a[184:185], v7 offset:8192
  v_mfma_f32_16x16x32_bf16 v[76:79], a[160:163], a[12:15], v[76:79]
  s_waitcnt lgkmcnt(5)
  v_mfma_f32_16x16x32_bf16 v[92:95], a[168:171], a[12:15], 0
  ds_read_b64_tr_b16 a[186:187], v7 offset:10240
  s_add_u32 m0, s31, 86016
  s_add_u32 s37, s41, 229376
  v_mfma_f32_16x16x32_bf16 v[92:95], a[172:175], a[28:31], v[92:95]
  buffer_load_dwordx4 v11, s[8:11], s37 offen lds
  v_mfma_f32_16x16x32_bf16 v[88:91], a[172:175], a[24:27], 0
  ds_read_b64_tr_b16 a[160:161], v7 offset:12288
  v_mfma_f32_16x16x32_bf16 v[88:91], a[168:171], a[8:11], v[88:91]
  v_mfma_f32_16x16x32_bf16 v[84:87], a[168:171], a[4:7], 0
  ds_read_b64_tr_b16 a[162:163], v7 offset:14336
  s_add_u32 m0, s31, 94208
  s_add_u32 s37, s41, 229376
  v_mfma_f32_16x16x32_bf16 v[84:87], a[172:175], a[20:23], v[84:87]
  buffer_load_dwordx4 v11, s[12:15], s37 offen lds
  v_mfma_f32_16x16x32_bf16 v[80:83], a[172:175], a[16:19], 0
  ds_read_b64_tr_b16 a[164:165], v8 offset:0
  v_mfma_f32_16x16x32_bf16 v[80:83], a[168:171], a[0:3], v[80:83]
  s_waitcnt lgkmcnt(5)
  v_mfma_f32_16x16x32_bf16 v[96:99], a[176:179], a[0:3], 0
  ds_read_b64_tr_b16 a[166:167], v8 offset:2048
  s_add_u32 m0, s31, 16384
  v_mfma_f32_16x16x32_bf16 v[96:99], a[180:183], a[16:19], v[96:99]
  buffer_load_dwordx4 v10, s[8:11], s41 offen lds
  v_mfma_f32_16x16x32_bf16 v[100:103], a[180:183], a[20:23], 0
  ds_read_b64_tr_b16 a[168:169], v8 offset:4096
  v_mfma_f32_16x16x32_bf16 v[100:103], a[176:179], a[4:7], v[100:103]
  v_mfma_f32_16x16x32_bf16 v[104:107], a[176:179], a[8:11], 0
  ds_read_b64_tr_b16 a[170:171], v8 offset:6144
  s_add_u32 m0, s31, 24576
  v_mfma_f32_16x16x32_bf16 v[104:107], a[180:183], a[24:27], v[104:107]
  buffer_load_dwordx4 v10, s[12:15], s41 offen lds
  v_mbcnt_lo_u32_b32 v13, -1, 0
  v_mfma_f32_16x16x32_bf16 v[108:111], a[180:183], a[28:31], 0
  ds_read_b64_tr_b16 a[172:173], v8 offset:8192
  v_mbcnt_hi_u32_b32 v13, -1, v13
  v_mfma_f32_16x16x32_bf16 v[108:111], a[176:179], a[12:15], v[108:111]
  v_min_u32 v13, 27, v13
  s_waitcnt lgkmcnt(5)
  v_mfma_f32_16x16x32_bf16 v[124:127], a[184:187], a[12:15], 0
  ds_read_b64_tr_b16 a[174:175], v8 offset:10240
  s_add_u32 m0, s31, 20480
  s_add_u32 s37, s41, 229376
  v_mfma_f32_16x16x32_bf16 v[124:127], a[160:163], a[28:31], v[124:127]
  buffer_load_dwordx4 v10, s[8:11], s37 offen lds
  v_lshlrev_b32 v13, 4, v13
  v_mfma_f32_16x16x32_bf16 v[120:123], a[160:163], a[24:27], 0
  ds_read_b64_tr_b16 a[176:177], v8 offset:12288
  s_lshl_b32 s28, s34, 7
  v_mfma_f32_16x16x32_bf16 v[120:123], a[184:187], a[8:11], v[120:123]
  v_mov_b32 v14, s28
  s_lshl_b32 s28, s35, 7
  v_mfma_f32_16x16x32_bf16 v[116:119], a[184:187], a[4:7], 0
  ds_read_b64_tr_b16 a[178:179], v8 offset:14336
  s_add_u32 m0, s31, 28672
  s_add_u32 s37, s41, 229376
  v_mfma_f32_16x16x32_bf16 v[116:119], a[160:163], a[20:23], v[116:119]
  buffer_load_dwordx4 v10, s[12:15], s37 offen lds
  s_sub_u32 s28, s28, 256
  v_mfma_f32_16x16x32_bf16 v[112:115], a[160:163], a[16:19], 0
  ds_read_b64_tr_b16 a[180:181], v2 offset:0
  v_mov_b32 v15, s28
  v_mfma_f32_16x16x32_bf16 v[112:115], a[184:187], a[0:3], v[112:115]
  v_cmp_gt_u32 vcc, 256, v13
  s_waitcnt lgkmcnt(5)
  v_mfma_f32_16x16x32_bf16 v[32:35], a[164:167], a[0:3], 0
  ds_read_b64_tr_b16 a[182:183], v2 offset:2048
  v_mfma_f32_16x16x32_bf16 v[32:35], a[168:171], a[16:19], v[32:35]
  buffer_load_dwordx4 a[32:35], v1, s[4:7], s49 offen offset:0 sc1
  v_cndmask_b32 v14, v15, v14, vcc
  v_mfma_f32_16x16x32_bf16 v[36:39], a[168:171], a[20:23], 0
  ds_read_b64_tr_b16 a[184:185], v2 offset:4096
  s_lshl_b32 s28, s36, 6
  v_mfma_f32_16x16x32_bf16 v[36:39], a[164:167], a[4:7], v[36:39]
  s_sub_u32 s28, s28, 384
  v_mov_b32 v15, s28
  v_mfma_f32_16x16x32_bf16 v[40:43], a[164:167], a[8:11], 0
  ds_read_b64_tr_b16 a[186:187], v2 offset:6144
  v_cmp_gt_u32 vcc, 384, v13
  v_mfma_f32_16x16x32_bf16 v[40:43], a[168:171], a[24:27], v[40:43]
  buffer_load_dwordx4 a[48:51], v1, s[4:7], s49 offen offset:1024 sc1
  v_cndmask_b32 v14, v15, v14, vcc
  v_mfma_f32_16x16x32_bf16 v[44:47], a[168:171], a[28:31], 0
  ds_read_b64_tr_b16 a[160:161], v2 offset:8192
  v_add_u32 v14, v13, v14
  v_mfma_f32_16x16x32_bf16 v[44:47], a[164:167], a[12:15], v[44:47]
  s_mul_i32 s28, s24, 14336
  s_waitcnt lgkmcnt(5)
  v_mfma_f32_16x16x32_bf16 v[60:63], a[172:175], a[12:15], 0
  ds_read_b64_tr_b16 a[162:163], v2 offset:10240
  s_add_u32 s49, s49, 65536
  v_mfma_f32_16x16x32_bf16 v[60:63], a[176:179], a[28:31], v[60:63]
  buffer_load_dwordx4 a[36:39], v1, s[4:7], s49 offen offset:0 sc1
  s_mul_i32 s29, s27, 1792
  v_mfma_f32_16x16x32_bf16 v[56:59], a[176:179], a[24:27], 0
  ds_read_b64_tr_b16 a[164:165], v2 offset:12288
  s_add_u32 s28, s28, s29
  v_mfma_f32_16x16x32_bf16 v[56:59], a[172:175], a[8:11], v[56:59]
  s_add_u32 s28, s28, 524288
  s_add_u32 s29, s28, 57344
  v_mfma_f32_16x16x32_bf16 v[52:55], a[172:175], a[4:7], 0
  ds_read_b64_tr_b16 a[166:167], v2 offset:14336
  s_mul_i32 s30, s24, 448
  v_mfma_f32_16x16x32_bf16 v[52:55], a[176:179], a[20:23], v[52:55]
  buffer_load_dwordx4 a[52:55], v1, s[4:7], s49 offen offset:1024 sc1
  s_add_u32 s30, s30, 131072
  v_mfma_f32_16x16x32_bf16 v[48:51], a[176:179], a[16:19], 0
  ds_read_b64_tr_b16 a[168:169], v3 offset:0
  v_add_u32 v13, s30, v13
  v_mfma_f32_16x16x32_bf16 v[48:51], a[172:175], a[0:3], v[48:51]
  v_lshrrev_b32 v12, 8, v1
  s_waitcnt lgkmcnt(5)
  v_mfma_f32_16x16x32_bf16 v[128:131], a[180:183], a[0:3], 0
  ds_read_b64_tr_b16 a[170:171], v3 offset:2048
  s_add_u32 s49, s49, 65536
  v_mfma_f32_16x16x32_bf16 v[128:131], a[184:187], a[16:19], v[128:131]
  buffer_load_dwordx4 a[40:43], v1, s[4:7], s49 offen offset:0 sc1
  v_lshlrev_b32 v12, 4, v12
  v_mfma_f32_16x16x32_bf16 v[132:135], a[184:187], a[20:23], 0
  ds_read_b64_tr_b16 a[172:173], v3 offset:4096
  v_add_u32 v12, 131072, v12
  v_mfma_f32_16x16x32_bf16 v[132:135], a[180:183], a[4:7], v[132:135]
  s_mul_i32 s30, s27, 14336
  s_lshl_b32 s34, s34, 10
  v_mfma_f32_16x16x32_bf16 v[136:139], a[180:183], a[8:11], 0
  ds_read_b64_tr_b16 a[174:175], v3 offset:6144
  s_lshl_b32 s35, s35, 10
  v_mfma_f32_16x16x32_bf16 v[136:139], a[184:187], a[24:27], v[136:139]
  buffer_load_dwordx4 a[56:59], v1, s[4:7], s49 offen offset:1024 sc1
  s_and_b32 s56, s36, 1
  v_mfma_f32_16x16x32_bf16 v[140:143], a[184:187], a[28:31], 0
  ds_read_b64_tr_b16 a[176:177], v3 offset:8192
  s_lshr_b32 s36, s36, 1
  v_mfma_f32_16x16x32_bf16 v[140:143], a[180:183], a[12:15], v[140:143]
  s_lshl_b32 s36, s36, 10
  s_waitcnt lgkmcnt(5)
  v_mfma_f32_16x16x32_bf16 v[156:159], a[160:163], a[12:15], 0
  ds_read_b64_tr_b16 a[178:179], v3 offset:10240
  s_add_u32 s49, s49, 65536
  v_mfma_f32_16x16x32_bf16 v[156:159], a[164:167], a[28:31], v[156:159]
  buffer_load_dwordx4 a[44:47], v1, s[4:7], s49 offen offset:0 sc1
  s_lshl_b32 s56, s56, 3
  v_mfma_f32_16x16x32_bf16 v[152:155], a[164:167], a[24:27], 0
  ds_read_b64_tr_b16 a[180:181], v3 offset:12288
  s_add_u32 s36, s36, s56
  v_mfma_f32_16x16x32_bf16 v[152:155], a[160:163], a[8:11], v[152:155]
  s_mul_i32 s56, s39, 131072
  s_add_u32 s30, s30, s56
  v_mfma_f32_16x16x32_bf16 v[148:151], a[160:163], a[4:7], 0
  ds_read_b64_tr_b16 a[182:183], v3 offset:14336
  s_add_u32 s30, s30, 19922944
  v_mfma_f32_16x16x32_bf16 v[148:151], a[164:167], a[20:23], v[148:151]
  buffer_load_dwordx4 a[60:63], v1, s[4:7], s49 offen offset:1024 sc1
  s_add_u32 s34, s34, s30
  v_mfma_f32_16x16x32_bf16 v[144:147], a[164:167], a[16:19], 0
  ds_read_b64_tr_b16 a[184:185], v4 offset:0
  s_add_u32 s35, s35, s30
  v_mfma_f32_16x16x32_bf16 v[144:147], a[160:163], a[0:3], v[144:147]
  s_add_u32 s36, s36, s30
  s_waitcnt lgkmcnt(5)
  v_mfma_f32_16x16x32_bf16 v[160:163], a[168:171], a[0:3], 0
  ds_read_b64_tr_b16 a[186:187], v4 offset:2048
  s_cmp_eq_u32 s32, 2
  s_cselect_b32 s50, 6, 2
  s_mul_i32 s42, s50, 458752
  s_lshl_b32 s50, s50, 11
  s_add_u32 s50, s50, s33
  s_add_u32 m0, s31, 98304
  v_mfma_f32_16x16x32_bf16 v[160:163], a[172:175], a[16:19], v[160:163]
  buffer_load_dwordx4 v11, s[8:11], s42 offen lds
  s_lshl_b32 s39, s39, 11
  v_mfma_f32_16x16x32_bf16 v[164:167], a[172:175], a[20:23], 0
  ds_read_b64_tr_b16 a[160:161], v4 offset:4096
  s_add_u32 s39, s39, 262144
  v_mfma_f32_16x16x32_bf16 v[164:167], a[168:171], a[4:7], v[164:167]
  s_lshl_b32 s56, s2, 7
  s_lshl_b32 s30, s24, 2
  v_mfma_f32_16x16x32_bf16 v[168:171], a[168:171], a[8:11], 0
  ds_read_b64_tr_b16 a[162:163], v4 offset:6144
  s_add_u32 m0, s31, 106496
  v_mfma_f32_16x16x32_bf16 v[168:171], a[172:175], a[24:27], v[168:171]
  buffer_load_dwordx4 v11, s[12:15], s42 offen lds
  s_add_u32 s56, s56, s30
  v_mfma_f32_16x16x32_bf16 v[172:175], a[172:175], a[28:31], 0
  ds_read_b64_tr_b16 a[164:165], v4 offset:8192
  s_add_u32 s57, s56, 819200
  v_mfma_f32_16x16x32_bf16 v[172:175], a[168:171], a[12:15], v[172:175]
  s_add_u32 s56, s56, 688128
  s_waitcnt lgkmcnt(5)
  v_mfma_f32_16x16x32_bf16 v[188:191], a[176:179], a[12:15], 0
  ds_read_b64_tr_b16 a[166:167], v4 offset:10240
  s_add_u32 m0, s31, 102400
  s_add_u32 s37, s42, 229376
  v_mfma_f32_16x16x32_bf16 v[188:191], a[180:183], a[28:31], v[188:191]
  buffer_load_dwordx4 v11, s[8:11], s37 offen lds
  v_mfma_f32_16x16x32_bf16 v[184:187], a[180:183], a[24:27], 0
  ds_read_b64_tr_b16 a[168:169], v4 offset:12288
  v_mfma_f32_16x16x32_bf16 v[184:187], a[176:179], a[8:11], v[184:187]
  v_mfma_f32_16x16x32_bf16 v[180:183], a[176:179], a[4:7], 0
  ds_read_b64_tr_b16 a[170:171], v4 offset:14336
  s_add_u32 m0, s31, 110592
  s_add_u32 s37, s42, 229376
  v_mfma_f32_16x16x32_bf16 v[180:183], a[180:183], a[20:23], v[180:183]
  buffer_load_dwordx4 v11, s[12:15], s37 offen lds
  v_mfma_f32_16x16x32_bf16 v[176:179], a[180:183], a[16:19], 0
  ds_read_b64_tr_b16 a[172:173], v5 offset:0
  v_mfma_f32_16x16x32_bf16 v[176:179], a[176:179], a[0:3], v[176:179]
  s_waitcnt lgkmcnt(5)
  v_mfma_f32_16x16x32_bf16 v[192:195], a[184:187], a[0:3], 0
  ds_read_b64_tr_b16 a[174:175], v5 offset:2048
  s_add_u32 m0, s31, 32768
  v_mfma_f32_16x16x32_bf16 v[192:195], a[160:163], a[16:19], v[192:195]
  buffer_load_dwordx4 v10, s[8:11], s42 offen lds
  v_mfma_f32_16x16x32_bf16 v[196:199], a[160:163], a[20:23], 0
  ds_read_b64_tr_b16 a[176:177], v5 offset:4096
  v_mfma_f32_16x16x32_bf16 v[196:199], a[184:187], a[4:7], v[196:199]
  v_mfma_f32_16x16x32_bf16 v[200:203], a[184:187], a[8:11], 0
  ds_read_b64_tr_b16 a[178:179], v5 offset:6144
  s_add_u32 m0, s31, 40960
  v_mfma_f32_16x16x32_bf16 v[200:203], a[160:163], a[24:27], v[200:203]
  buffer_load_dwordx4 v10, s[12:15], s42 offen lds
  v_mfma_f32_16x16x32_bf16 v[204:207], a[160:163], a[28:31], 0
  ds_read_b64_tr_b16 a[180:181], v5 offset:8192
  v_mfma_f32_16x16x32_bf16 v[204:207], a[184:187], a[12:15], v[204:207]
  s_waitcnt lgkmcnt(5)
  v_mfma_f32_16x16x32_bf16 v[220:223], a[164:167], a[12:15], 0
  ds_read_b64_tr_b16 a[182:183], v5 offset:10240
  s_add_u32 m0, s31, 36864
  s_add_u32 s37, s42, 229376
  v_mfma_f32_16x16x32_bf16 v[220:223], a[168:171], a[28:31], v[220:223]
  buffer_load_dwordx4 v10, s[8:11], s37 offen lds
  v_mfma_f32_16x16x32_bf16 v[216:219], a[168:171], a[24:27], 0
  ds_read_b64_tr_b16 a[184:185], v5 offset:12288
  v_mfma_f32_16x16x32_bf16 v[216:219], a[164:167], a[8:11], v[216:219]
  v_mfma_f32_16x16x32_bf16 v[212:215], a[164:167], a[4:7], 0
  ds_read_b64_tr_b16 a[186:187], v5 offset:14336
  s_add_u32 m0, s31, 45056
  s_add_u32 s37, s42, 229376
  v_mfma_f32_16x16x32_bf16 v[212:215], a[168:171], a[20:23], v[212:215]
  buffer_load_dwordx4 v10, s[12:15], s37 offen lds
  s_waitcnt vmcnt(16)
  s_barrier
  v_mfma_f32_16x16x32_bf16 v[208:211], a[168:171], a[16:19], 0
  ds_read_b64_tr_b16 a[160:161], v6 offset:16384
  v_mfma_f32_16x16x32_bf16 v[208:211], a[164:167], a[0:3], v[208:211]
  s_waitcnt lgkmcnt(5)
  v_mfma_f32_16x16x32_bf16 v[224:227], a[172:175], a[0:3], 0
  ds_read_b64_tr_b16 a[162:163], v6 offset:18432
  v_mfma_f32_16x16x32_bf16 v[224:227], a[176:179], a[16:19], v[224:227]
  buffer_load_dwordx4 a[64:67], v1, s[4:7], s50 offen offset:0 sc1
  v_mfma_f32_16x16x32_bf16 v[228:231], a[176:179], a[20:23], 0
  ds_read_b64_tr_b16 a[164:165], v6 offset:20480
  v_mfma_f32_16x16x32_bf16 v[228:231], a[172:175], a[4:7], v[228:231]
  v_mfma_f32_16x16x32_bf16 v[232:235], a[172:175], a[8:11], 0
  ds_read_b64_tr_b16 a[166:167], v6 offset:22528
  v_mfma_f32_16x16x32_bf16 v[232:235], a[176:179], a[24:27], v[232:235]
  buffer_load_dwordx4 a[80:83], v1, s[4:7], s50 offen offset:1024 sc1
  v_mfma_f32_16x16x32_bf16 v[236:239], a[176:179], a[28:31], 0
  ds_read_b64_tr_b16 a[168:169], v6 offset:24576
  v_mfma_f32_16x16x32_bf16 v[236:239], a[172:175], a[12:15], v[236:239]
  s_waitcnt lgkmcnt(5)
  v_mfma_f32_16x16x32_bf16 v[252:255], a[180:183], a[12:15], 0
  ds_read_b64_tr_b16 a[170:171], v6 offset:26624
  s_add_u32 s50, s50, 65536
  v_mfma_f32_16x16x32_bf16 v[252:255], a[184:187], a[28:31], v[252:255]
  buffer_load_dwordx4 a[68:71], v1, s[4:7], s50 offen offset:0 sc1
  v_mfma_f32_16x16x32_bf16 v[248:251], a[184:187], a[24:27], 0
  ds_read_b64_tr_b16 a[172:173], v6 offset:28672
  v_mfma_f32_16x16x32_bf16 v[248:251], a[180:183], a[8:11], v[248:251]
  v_mfma_f32_16x16x32_bf16 v[244:247], a[180:183], a[4:7], 0
  ds_read_b64_tr_b16 a[174:175], v6 offset:30720
  v_mfma_f32_16x16x32_bf16 v[244:247], a[184:187], a[20:23], v[244:247]
  buffer_load_dwordx4 a[84:87], v1, s[4:7], s50 offen offset:1024 sc1
  v_mfma_f32_16x16x32_bf16 v[240:243], a[184:187], a[16:19], 0
  ds_read_b64_tr_b16 a[176:177], v7 offset:16384
  v_mfma_f32_16x16x32_bf16 v[240:243], a[180:183], a[0:3], v[240:243]
  s_waitcnt vmcnt(12) lgkmcnt(5)
  v_mfma_f32_16x16x32_bf16 v[64:67], a[160:163], a[32:35], v[64:67]
  ds_read_b64_tr_b16 a[178:179], v7 offset:18432
  s_add_u32 s50, s50, 65536
  v_mfma_f32_16x16x32_bf16 v[64:67], a[164:167], a[48:51], v[64:67]
  buffer_load_dwordx4 a[72:75], v1, s[4:7], s50 offen offset:0 sc1
  v_mfma_f32_16x16x32_bf16 v[68:71], a[164:167], a[52:55], v[68:71]
  ds_read_b64_tr_b16 a[180:181], v7 offset:20480
  v_mfma_f32_16x16x32_bf16 v[68:71], a[160:163], a[36:39], v[68:71]
  v_mfma_f32_16x16x32_bf16 v[72:75], a[160:163], a[40:43], v[72:75]
  ds_read_b64_tr_b16 a[182:183], v7 offset:22528
  v_mfma_f32_16x16x32_bf16 v[72:75], a[164:167], a[56:59], v[72:75]
  v_mfma_f32_16x16x32_bf16 v[76:79], a[164:167], a[60:63], v[76:79]
  ds_read_b64_tr_b16 a[184:185], v7 offset:24576
  buffer_load_dwordx4 a[88:91], v1, s[4:7], s50 offen offset:1024 sc1
  v_mfma_f32_16x16x32_bf16 v[76:79], a[160:163], a[44:47], v[76:79]
  s_waitcnt lgkmcnt(5)
  v_mfma_f32_16x16x32_bf16 v[92:95], a[168:171], a[44:47], v[92:95]
  ds_read_b64_tr_b16 a[186:187], v7 offset:26624
  v_mfma_f32_16x16x32_bf16 v[92:95], a[172:175], a[60:63], v[92:95]
  v_mfma_f32_16x16x32_bf16 v[88:91], a[172:175], a[56:59], v[88:91]
  ds_read_b64_tr_b16 a[160:161], v7 offset:28672
  s_add_u32 s50, s50, 65536
  v_mfma_f32_16x16x32_bf16 v[88:91], a[168:171], a[40:43], v[88:91]
  buffer_load_dwordx4 a[76:79], v1, s[4:7], s50 offen offset:0 sc1
  v_mfma_f32_16x16x32_bf16 v[84:87], a[168:171], a[36:39], v[84:87]
  ds_read_b64_tr_b16 a[162:163], v7 offset:30720
  v_mfma_f32_16x16x32_bf16 v[84:87], a[172:175], a[52:55], v[84:87]
  v_mfma_f32_16x16x32_bf16 v[80:83], a[172:175], a[48:51], v[80:83]
  ds_read_b64_tr_b16 a[164:165], v8 offset:16384
  v_mfma_f32_16x16x32_bf16 v[80:83], a[168:171], a[32:35], v[80:83]
  s_waitcnt lgkmcnt(5)
  v_mfma_f32_16x16x32_bf16 v[96:99], a[176:179], a[32:35], v[96:99]
  ds_read_b64_tr_b16 a[166:167], v8 offset:18432
  buffer_load_dwordx4 a[92:95], v1, s[4:7], s50 offen offset:1024 sc1
  v_mfma_f32_16x16x32_bf16 v[96:99], a[180:183], a[48:51], v[96:99]
  v_mfma_f32_16x16x32_bf16 v[100:103], a[180:183], a[52:55], v[100:103]
  ds_read_b64_tr_b16 a[168:169], v8 offset:20480
  v_mfma_f32_16x16x32_bf16 v[100:103], a[176:179], a[36:39], v[100:103]
  v_mfma_f32_16x16x32_bf16 v[104:107], a[176:179], a[40:43], v[104:107]
  ds_read_b64_tr_b16 a[170:171], v8 offset:22528
  v_mfma_f32_16x16x32_bf16 v[104:107], a[180:183], a[56:59], v[104:107]
  buffer_load_dwordx4 v[24:27], v14, s[4:7], s28 offen sc1
  v_mfma_f32_16x16x32_bf16 v[108:111], a[180:183], a[60:63], v[108:111]
  ds_read_b64_tr_b16 a[172:173], v8 offset:24576
  v_mfma_f32_16x16x32_bf16 v[108:111], a[176:179], a[44:47], v[108:111]
  s_waitcnt lgkmcnt(5)
  v_mfma_f32_16x16x32_bf16 v[124:127], a[184:187], a[44:47], v[124:127]
  ds_read_b64_tr_b16 a[174:175], v8 offset:26624
  v_mfma_f32_16x16x32_bf16 v[124:127], a[160:163], a[60:63], v[124:127]
  v_mfma_f32_16x16x32_bf16 v[120:123], a[160:163], a[56:59], v[120:123]
  ds_read_b64_tr_b16 a[176:177], v8 offset:28672
  buffer_load_dwordx4 v[28:31], v14, s[4:7], s29 offen sc1
  v_mfma_f32_16x16x32_bf16 v[120:123], a[184:187], a[40:43], v[120:123]
  v_mfma_f32_16x16x32_bf16 v[116:119], a[184:187], a[36:39], v[116:119]
  ds_read_b64_tr_b16 a[178:179], v8 offset:30720
  v_mfma_f32_16x16x32_bf16 v[116:119], a[160:163], a[52:55], v[116:119]
  v_mfma_f32_16x16x32_bf16 v[112:115], a[160:163], a[48:51], v[112:115]
  ds_read_b64_tr_b16 a[180:181], v2 offset:16384
  s_add_u32 s38, s39, 0
  v_mfma_f32_16x16x32_bf16 v[112:115], a[184:187], a[32:35], v[112:115]
  buffer_load_dwordx4 a[188:191], v1, s[4:7], s38 offen offset:0 sc1
  s_waitcnt lgkmcnt(5)
  v_mfma_f32_16x16x32_bf16 v[32:35], a[164:167], a[32:35], v[32:35]
  ds_read_b64_tr_b16 a[182:183], v2 offset:18432
  v_mfma_f32_16x16x32_bf16 v[32:35], a[168:171], a[48:51], v[32:35]
  v_mfma_f32_16x16x32_bf16 v[36:39], a[168:171], a[52:55], v[36:39]
  ds_read_b64_tr_b16 a[184:185], v2 offset:20480
  v_mfma_f32_16x16x32_bf16 v[36:39], a[164:167], a[36:39], v[36:39]
  s_add_u32 s38, s39, 0
  v_mfma_f32_16x16x32_bf16 v[40:43], a[164:167], a[40:43], v[40:43]
  ds_read_b64_tr_b16 a[186:187], v2 offset:22528
  buffer_load_dwordx4 a[192:195], v1, s[4:7], s38 offen offset:1024 sc1
  v_mfma_f32_16x16x32_bf16 v[40:43], a[168:171], a[56:59], v[40:43]
  v_mfma_f32_16x16x32_bf16 v[44:47], a[168:171], a[60:63], v[44:47]
  ds_read_b64_tr_b16 a[160:161], v2 offset:24576
  v_mfma_f32_16x16x32_bf16 v[44:47], a[164:167], a[44:47], v[44:47]
  s_waitcnt lgkmcnt(5)
  v_mfma_f32_16x16x32_bf16 v[60:63], a[172:175], a[44:47], v[60:63]
  ds_read_b64_tr_b16 a[162:163], v2 offset:26624
  s_add_u32 s38, s39, 4096
  v_mfma_f32_16x16x32_bf16 v[60:63], a[176:179], a[60:63], v[60:63]
  buffer_load_dwordx4 a[196:199], v1, s[4:7], s38 offen offset:0 sc1
  v_mfma_f32_16x16x32_bf16 v[56:59], a[176:179], a[56:59], v[56:59]
  ds_read_b64_tr_b16 a[164:165], v2 offset:28672
  v_mfma_f32_16x16x32_bf16 v[56:59], a[172:175], a[40:43], v[56:59]
  v_mfma_f32_16x16x32_bf16 v[52:55], a[172:175], a[36:39], v[52:55]
  ds_read_b64_tr_b16 a[166:167], v2 offset:30720
  v_mfma_f32_16x16x32_bf16 v[52:55], a[176:179], a[52:55], v[52:55]
  s_add_u32 s38, s39, 4096
  v_mfma_f32_16x16x32_bf16 v[48:51], a[176:179], a[48:51], v[48:51]
  ds_read_b64_tr_b16 a[168:169], v3 offset:16384
  buffer_load_dwordx4 a[200:203], v1, s[4:7], s38 offen offset:1024 sc1
  v_mfma_f32_16x16x32_bf16 v[48:51], a[172:175], a[32:35], v[48:51]
  s_waitcnt lgkmcnt(5)
  v_mfma_f32_16x16x32_bf16 v[128:131], a[180:183], a[32:35], v[128:131]
  ds_read_b64_tr_b16 a[170:171], v3 offset:18432
  v_mfma_f32_16x16x32_bf16 v[128:131], a[184:187], a[48:51], v[128:131]
  v_mfma_f32_16x16x32_bf16 v[132:135], a[184:187], a[52:55], v[132:135]
  ds_read_b64_tr_b16 a[172:173], v3 offset:20480
  s_add_u32 s38, s39, 8192
  v_mfma_f32_16x16x32_bf16 v[132:135], a[180:183], a[36:39], v[132:135]
  buffer_load_dwordx4 a[204:207], v1, s[4:7], s38 offen offset:0 sc1
  v_mfma_f32_16x16x32_bf16 v[136:139], a[180:183], a[40:43], v[136:139]
  ds_read_b64_tr_b16 a[174:175], v3 offset:22528
  v_mfma_f32_16x16x32_bf16 v[136:139], a[184:187], a[56:59], v[136:139]
  v_mfma_f32_16x16x32_bf16 v[140:143], a[184:187], a[60:63], v[140:143]
  ds_read_b64_tr_b16 a[176:177], v3 offset:24576
  v_mfma_f32_16x16x32_bf16 v[140:143], a[180:183], a[44:47], v[140:143]
  s_add_u32 s38, s39, 8192
  s_waitcnt lgkmcnt(5)
  v_mfma_f32_16x16x32_bf16 v[156:159], a[160:163], a[44:47], v[156:159]
  ds_read_b64_tr_b16 a[178:179], v3 offset:26624
  buffer_load_dwordx4 a[208:211], v1, s[4:7], s38 offen offset:1024 sc1
  v_mfma_f32_16x16x32_bf16 v[156:159], a[164:167], a[60:63], v[156:159]
  v_mfma_f32_16x16x32_bf16 v[152:155], a[164:167], a[56:59], v[152:155]
  ds_read_b64_tr_b16 a[180:181], v3 offset:28672
  v_mfma_f32_16x16x32_bf16 v[152:155], a[160:163], a[40:43], v[152:155]
  v_mfma_f32_16x16x32_bf16 v[148:151], a[160:163], a[36:39], v[148:151]
  ds_read_b64_tr_b16 a[182:183], v3 offset:30720
  s_add_u32 s38, s39, 12288
  v_mfma_f32_16x16x32_bf16 v[148:151], a[164:167], a[52:55], v[148:151]
  buffer_load_dwordx4 a[212:215], v1, s[4:7], s38 offen offset:0 sc1
  v_mfma_f32_16x16x32_bf16 v[144:147], a[164:167], a[48:51], v[144:147]
  ds_read_b64_tr_b16 a[184:185], v4 offset:16384
  v_mfma_f32_16x16x32_bf16 v[144:147], a[160:163], a[32:35], v[144:147]
  s_waitcnt lgkmcnt(5)
  v_mfma_f32_16x16x32_bf16 v[160:163], a[168:171], a[32:35], v[160:163]
  ds_read_b64_tr_b16 a[186:187], v4 offset:18432
  v_mfma_f32_16x16x32_bf16 v[160:163], a[172:175], a[48:51], v[160:163]
  s_add_u32 s38, s39, 12288
  v_mfma_f32_16x16x32_bf16 v[164:167], a[172:175], a[52:55], v[164:167]
  ds_read_b64_tr_b16 a[160:161], v4 offset:20480
  buffer_load_dwordx4 a[216:219], v1, s[4:7], s38 offen offset:1024 sc1
  v_mfma_f32_16x16x32_bf16 v[164:167], a[168:171], a[36:39], v[164:167]
  v_mfma_f32_16x16x32_bf16 v[168:171], a[168:171], a[40:43], v[168:171]
  ds_read_b64_tr_b16 a[162:163], v4 offset:22528
  v_mfma_f32_16x16x32_bf16 v[168:171], a[172:175], a[56:59], v[168:171]
  v_mfma_f32_16x16x32_bf16 v[172:175], a[172:175], a[60:63], v[172:175]
  ds_read_b64_tr_b16 a[164:165], v4 offset:24576
  s_cmp_eq_u32 s32, 3
  s_cselect_b32 s51, 7, 3
  s_mul_i32 s43, s51, 458752
  s_lshl_b32 s51, s51, 11
  s_add_u32 s51, s51, s33
  s_add_u32 m0, s31, 114688
  v_mfma_f32_16x16x32_bf16 v[172:175], a[168:171], a[44:47], v[172:175]
  buffer_load_dwordx4 v11, s[8:11], s43 offen lds
  s_waitcnt lgkmcnt(5)
  v_mfma_f32_16x16x32_bf16 v[188:191], a[176:179], a[44:47], v[188:191]
HOP6:
  s_cbranch_execz HOP10
  ds_read_b64_tr_b16 a[166:167], v4 offset:26624
  v_mfma_f32_16x16x32_bf16 v[188:191], a[180:183], a[60:63], v[188:191]
  v_mfma_f32_16x16x32_bf16 v[184:187], a[180:183], a[56:59], v[184:187]
  ds_read_b64_tr_b16 a[168:169], v4 offset:28672
  v_mfma_f32_16x16x32_bf16 v[184:187], a[176:179], a[40:43], v[184:187]
  s_add_u32 m0, s31, 122880
  v_mfma_f32_16x16x32_bf16 v[180:183], a[176:179], a[36:39], v[180:183]
  ds_read_b64_tr_b16 a[170:171], v4 offset:30720
  buffer_load_dwordx4 v11, s[12:15], s43 offen lds
  v_mfma_f32_16x16x32_bf16 v[180:183], a[180:183], a[52:55], v[180:183]
  v_mfma_f32_16x16x32_bf16 v[176:179], a[180:183], a[48:51], v[176:179]
  ds_read_b64_tr_b16 a[172:173], v5 offset:16384
  v_mfma_f32_16x16x32_bf16 v[176:179], a[176:179], a[32:35], v[176:179]
  s_waitcnt lgkmcnt(5)
  v_mfma_f32_16x16x32_bf16 v[192:195], a[184:187], a[32:35], v[192:195]
  ds_read_b64_tr_b16 a[174:175], v5 offset:18432
  s_add_u32 m0, s31, 118784
  s_add_u32 s37, s43, 229376
  v_mfma_f32_16x16x32_bf16 v[192:195], a[160:163], a[48:51], v[192:195]
  buffer_load_dwordx4 v11, s[8:11], s37 offen lds
  v_mfma_f32_16x16x32_bf16 v[196:199], a[160:163], a[52:55], v[196:199]
  ds_read_b64_tr_b16 a[176:177], v5 offset:20480
  v_mfma_f32_16x16x32_bf16 v[196:199], a[184:187], a[36:39], v[196:199]
  v_mfma_f32_16x16x32_bf16 v[200:203], a[184:187], a[40:43], v[200:203]
  ds_read_b64_tr_b16 a[178:179], v5 offset:22528
  v_mfma_f32_16x16x32_bf16 v[200:203], a[160:163], a[56:59], v[200:203]
  s_add_u32 m0, s31, 126976
  s_add_u32 s37, s43, 229376
  v_mfma_f32_16x16x32_bf16 v[204:207], a[160:163], a[60:63], v[204:207]
  ds_read_b64_tr_b16 a[180:181], v5 offset:24576
  buffer_load_dwordx4 v11, s[12:15], s37 offen lds
  v_mfma_f32_16x16x32_bf16 v[204:207], a[184:187], a[44:47], v[204:207]
  s_waitcnt lgkmcnt(5)
  v_mfma_f32_16x16x32_bf16 v[220:223], a[164:167], a[44:47], v[220:223]
  ds_read_b64_tr_b16 a[182:183], v5 offset:26624
  v_mfma_f32_16x16x32_bf16 v[220:223], a[168:171], a[60:63], v[220:223]
  v_mfma_f32_16x16x32_bf16 v[216:219], a[168:171], a[56:59], v[216:219]
  ds_read_b64_tr_b16 a[184:185], v5 offset:28672
  s_add_u32 m0, s31, 49152
  v_mfma_f32_16x16x32_bf16 v[216:219], a[164:167], a[40:43], v[216:219]
  buffer_load_dwordx4 v10, s[8:11], s43 offen lds
  v_mfma_f32_16x16x32_bf16 v[212:215], a[164:167], a[36:39], v[212:215]
  ds_read_b64_tr_b16 a[186:187], v5 offset:30720
  v_mfma_f32_16x16x32_bf16 v[212:215], a[168:171], a[52:55], v[212:215]
  s_waitcnt vmcnt(23)
  s_barrier
  v_mfma_f32_16x16x32_bf16 v[208:211], a[168:171], a[48:51], v[208:211]
  ds_read_b64_tr_b16 a[160:161], v6 offset:32768
  v_mfma_f32_16x16x32_bf16 v[208:211], a[164:167], a[32:35], v[208:211]
  s_add_u32 m0, s31, 57344
  s_waitcnt lgkmcnt(5)
  v_mfma_f32_16x16x32_bf16 v[224:227], a[172:175], a[32:35], v[224:227]
  ds_read_b64_tr_b16 a[162:163], v6 offset:34816
  buffer_load_dwordx4 v10, s[12:15], s43 offen lds
  v_mfma_f32_16x16x32_bf16 v[224:227], a[176:179], a[48:51], v[224:227]
  v_mfma_f32_16x16x32_bf16 v[228:231], a[176:179], a[52:55], v[228:231]
  ds_read_b64_tr_b16 a[164:165], v6 offset:36864
  v_mfma_f32_16x16x32_bf16 v[228:231], a[172:175], a[36:39], v[228:231]
  v_mfma_f32_16x16x32_bf16 v[232:235], a[172:175], a[40:43], v[232:235]
  ds_read_b64_tr_b16 a[166:167], v6 offset:38912
  s_add_u32 m0, s31, 53248
  s_add_u32 s37, s43, 229376
  v_mfma_f32_16x16x32_bf16 v[232:235], a[176:179], a[56:59], v[232:235]
  buffer_load_dwordx4 v10, s[8:11], s37 offen lds
  v_mfma_f32_16x16x32_bf16 v[236:239], a[176:179], a[60:63], v[236:239]
  ds_read_b64_tr_b16 a[168:169], v6 offset:40960
  v_mfma_f32_16x16x32_bf16 v[236:239], a[172:175], a[44:47], v[236:239]
  s_waitcnt lgkmcnt(5)
  v_mfma_f32_16x16x32_bf16 v[252:255], a[180:183], a[44:47], v[252:255]
  ds_read_b64_tr_b16 a[170:171], v6 offset:43008
  v_mfma_f32_16x16x32_bf16 v[252:255], a[184:187], a[60:63], v[252:255]
  s_add_u32 m0, s31, 61440
  s_add_u32 s37, s43, 229376
  v_mfma_f32_16x16x32_bf16 v[248:251], a[184:187], a[56:59], v[248:251]
  ds_read_b64_tr_b16 a[172:173], v6 offset:45056
  buffer_load_dwordx4 v10, s[12:15], s37 offen lds
  v_mfma_f32_16x16x32_bf16 v[248:251], a[180:183], a[40:43], v[248:251]
  v_mfma_f32_16x16x32_bf16 v[244:247], a[180:183], a[36:39], v[244:247]
  ds_read_b64_tr_b16 a[174:175], v6 offset:47104
  v_mfma_f32_16x16x32_bf16 v[244:247], a[184:187], a[52:55], v[244:247]
  v_mfma_f32_16x16x32_bf16 v[240:243], a[184:187], a[48:51], v[240:243]
  ds_read_b64_tr_b16 a[176:177], v7 offset:32768
  v_mfma_f32_16x16x32_bf16 v[240:243], a[180:183], a[32:35], v[240:243]
  buffer_load_dwordx4 a[96:99], v1, s[4:7], s51 offen offset:0 sc1
  s_waitcnt vmcnt(19) lgkmcnt(5)
  v_mfma_f32_16x16x32_bf16 v[64:67], a[160:163], a[64:67], v[64:67]
  ds_read_b64_tr_b16 a[178:179], v7 offset:34816
  v_mfma_f32_16x16x32_bf16 v[64:67], a[164:167], a[80:83], v[64:67]
  v_mfma_f32_16x16x32_bf16 v[68:71], a[164:167], a[84:87], v[68:71]
  ds_read_b64_tr_b16 a[180:181], v7 offset:36864
  v_mfma_f32_16x16x32_bf16 v[68:71], a[160:163], a[68:71], v[68:71]
  v_mfma_f32_16x16x32_bf16 v[72:75], a[160:163], a[72:75], v[72:75]
  ds_read_b64_tr_b16 a[182:183], v7 offset:38912
  buffer_load_dwordx4 a[112:115], v1, s[4:7], s51 offen offset:1024 sc1
  v_mfma_f32_16x16x32_bf16 v[72:75], a[164:167], a[88:91], v[72:75]
  v_mfma_f32_16x16x32_bf16 v[76:79], a[164:167], a[92:95], v[76:79]
  ds_read_b64_tr_b16 a[184:185], v7 offset:40960
  v_mfma_f32_16x16x32_bf16 v[76:79], a[160:163], a[76:79], v[76:79]
  s_waitcnt lgkmcnt(5)
  v_mfma_f32_16x16x32_bf16 v[92:95], a[168:171], a[76:79], v[92:95]
  ds_read_b64_tr_b16 a[186:187], v7 offset:43008
  s_add_u32 s51, s51, 65536
  v_mfma_f32_16x16x32_bf16 v[92:95], a[172:175], a[92:95], v[92:95]
  buffer_load_dwordx4 a[100:103], v1, s[4:7], s51 offen offset:0 sc1
  v_mfma_f32_16x16x32_bf16 v[88:91], a[172:175], a[88:91], v[88:91]
  ds_read_b64_tr_b16 a[160:161], v7 offset:45056
  v_mfma_f32_16x16x32_bf16 v[88:91], a[168:171], a[72:75], v[88:91]
  v_mfma_f32_16x16x32_bf16 v[84:87], a[168:171], a[68:71], v[84:87]
  ds_read_b64_tr_b16 a[162:163], v7 offset:47104
  v_mfma_f32_16x16x32_bf16 v[84:87], a[172:175], a[84:87], v[84:87]
  v_mfma_f32_16x16x32_bf16 v[80:83], a[172:175], a[80:83], v[80:83]
  ds_read_b64_tr_b16 a[164:165], v8 offset:32768
  buffer_load_dwordx4 a[116:119], v1, s[4:7], s51 offen offset:1024 sc1
  v_mfma_f32_16x16x32_bf16 v[80:83], a[168:171], a[64:67], v[80:83]
  s_waitcnt lgkmcnt(5)
  v_mfma_f32_16x16x32_bf16 v[96:99], a[176:179], a[64:67], v[96:99]
  ds_read_b64_tr_b16 a[166:167], v8 offset:34816
  s_waitcnt vmcnt(20)
  v_mfma_f32_16x16x32_bf16 v[96:99], a[180:183], a[80:83], v[96:99]
  v_add_f32 v24, v24, v28
  v_add_f32 v25, v25, v29
  v_mfma_f32_16x16x32_bf16 v[100:103], a[180:183], a[84:87], v[100:103]
  ds_read_b64_tr_b16 a[168:169], v8 offset:36864
  s_add_u32 s51, s51, 65536
  v_mfma_f32_16x16x32_bf16 v[100:103], a[176:179], a[68:71], v[100:103]
  buffer_load_dwordx4 a[104:107], v1, s[4:7], s51 offen offset:0 sc1
  v_add_f32 v26, v26, v30
  v_mfma_f32_16x16x32_bf16 v[104:107], a[176:179], a[72:75], v[104:107]
  ds_read_b64_tr_b16 a[170:171], v8 offset:38912
  v_add_f32 v27, v27, v31
  v_mfma_f32_16x16x32_bf16 v[104:107], a[180:183], a[88:91], v[104:107]
  ds_write_b128 v13, v[24:27]
  s_waitcnt vmcnt(13) lgkmcnt(0)
  v_mfma_f32_16x16x32_bf16 v[108:111], a[180:183], a[92:95], v[108:111]
  ds_read_b64_tr_b16 a[172:173], v8 offset:40960
  v_accvgpr_read_b32 v24, a188
  v_mfma_f32_16x16x32_bf16 v[108:111], a[176:179], a[76:79], v[108:111]
  v_accvgpr_read_b32 v25, a189
  s_waitcnt lgkmcnt(6)
  v_mfma_f32_16x16x32_bf16 v[124:127], a[184:187], a[76:79], v[124:127]
  ds_read_b64_tr_b16 a[174:175], v8 offset:43008
  buffer_load_dwordx4 a[120:123], v1, s[4:7], s51 offen offset:1024 sc1
  v_mfma_f32_16x16x32_bf16 v[124:127], a[160:163], a[92:95], v[124:127]
  v_accvgpr_read_b32 v26, a190
  v_accvgpr_read_b32 v27, a191
  v_mfma_f32_16x16x32_bf16 v[120:123], a[160:163], a[88:91], v[120:123]
  ds_read_b64_tr_b16 a[176:177], v8 offset:45056
  v_accvgpr_read_b32 v28, a192
  v_mfma_f32_16x16x32_bf16 v[120:123], a[184:187], a[72:75], v[120:123]
  v_accvgpr_read_b32 v29, a193
  v_accvgpr_read_b32 v30, a194
  v_mfma_f32_16x16x32_bf16 v[116:119], a[184:187], a[68:71], v[116:119]
  ds_read_b64_tr_b16 a[178:179], v8 offset:47104
  s_add_u32 s51, s51, 65536
  v_mfma_f32_16x16x32_bf16 v[116:119], a[160:163], a[84:87], v[116:119]
  buffer_load_dwordx4 a[108:111], v1, s[4:7], s51 offen offset:0 sc1
  v_accvgpr_read_b32 v31, a195
  v_mfma_f32_16x16x32_bf16 v[112:115], a[160:163], a[80:83], v[112:115]
  ds_read_b64_tr_b16 a[180:181], v2 offset:32768
  v_add_f32 v24, v24, v26
  v_mfma_f32_16x16x32_bf16 v[112:115], a[184:187], a[64:67], v[112:115]
  v_add_f32 v25, v25, v27
  s_waitcnt lgkmcnt(6)
  v_mfma_f32_16x16x32_bf16 v[32:35], a[164:167], a[64:67], v[32:35]
  ds_read_b64_tr_b16 a[182:183], v2 offset:34816
  v_add_f32 v28, v28, v30
  v_mfma_f32_16x16x32_bf16 v[32:35], a[168:171], a[80:83], v[32:35]
  v_add_f32 v29, v29, v31
  v_add_f32 v24, v24, v28
  v_mfma_f32_16x16x32_bf16 v[36:39], a[168:171], a[84:87], v[36:39]
  ds_read_b64_tr_b16 a[184:185], v2 offset:36864
  buffer_load_dwordx4 a[124:127], v1, s[4:7], s51 offen offset:1024 sc1
  v_mfma_f32_16x16x32_bf16 v[36:39], a[164:167], a[68:71], v[36:39]
  v_add_f32 v25, v25, v29
  v_mov_b32 v26, v24
  v_mfma_f32_16x16x32_bf16 v[40:43], a[164:167], a[72:75], v[40:43]
  ds_read_b64_tr_b16 a[186:187], v2 offset:38912
  v_mov_b32 v27, v25
  v_mfma_f32_16x16x32_bf16 v[40:43], a[168:171], a[88:91], v[40:43]
  v_permlane16_swap_b32 v24, v26
  v_permlane16_swap_b32 v25, v27
  v_mfma_f32_16x16x32_bf16 v[44:47], a[168:171], a[92:95], v[44:47]
  ds_read_b64_tr_b16 a[160:161], v2 offset:40960
  s_cmp_eq_u32 s32, 0
  s_cselect_b32 s52, 8, 4
  s_mul_i32 s44, s52, 458752
  s_lshl_b32 s52, s52, 11
  s_add_u32 s52, s52, s33
  s_add_u32 m0, s31, 65536
  v_mfma_f32_16x16x32_bf16 v[44:47], a[164:167], a[76:79], v[44:47]
  buffer_load_dwordx4 v11, s[8:11], s44 offen lds
  s_waitcnt lgkmcnt(5)
  v_mfma_f32_16x16x32_bf16 v[60:63], a[172:175], a[76:79], v[60:63]
  ds_read_b64_tr_b16 a[162:163], v2 offset:43008
  v_add_f32 v24, v24, v26
  v_mfma_f32_16x16x32_bf16 v[60:63], a[176:179], a[92:95], v[60:63]
  v_add_f32 v25, v25, v27
  v_mov_b32 v26, v24
  v_mfma_f32_16x16x32_bf16 v[56:59], a[176:179], a[88:91], v[56:59]
  ds_read_b64_tr_b16 a[164:165], v2 offset:45056
  v_mov_b32 v27, v25
  v_mfma_f32_16x16x32_bf16 v[56:59], a[172:175], a[72:75], v[56:59]
  s_add_u32 m0, s31, 73728
  v_permlane32_swap_b32 v24, v26
  v_mfma_f32_16x16x32_bf16 v[52:55], a[172:175], a[68:71], v[52:55]
  ds_read_b64_tr_b16 a[166:167], v2 offset:47104
  buffer_load_dwordx4 v11, s[12:15], s44 offen lds
  v_mfma_f32_16x16x32_bf16 v[52:55], a[176:179], a[84:87], v[52:55]
  v_permlane32_swap_b32 v25, v27
  v_add_f32 v24, v24, v26
  v_mfma_f32_16x16x32_bf16 v[48:51], a[176:179], a[80:83], v[48:51]
  ds_read_b64_tr_b16 a[168:169], v3 offset:32768
  v_add_f32 v25, v25, v27
  v_mfma_f32_16x16x32_bf16 v[48:51], a[172:175], a[64:67], v[48:51]
  v_mul_f32 v24, 0x3a800000, v24
  s_waitcnt lgkmcnt(5)
  v_mfma_f32_16x16x32_bf16 v[128:131], a[180:183], a[64:67], v[128:131]
  ds_read_b64_tr_b16 a[170:171], v3 offset:34816
  s_add_u32 m0, s31, 69632
  s_add_u32 s37, s44, 229376
  v_mfma_f32_16x16x32_bf16 v[128:131], a[184:187], a[80:83], v[128:131]
  buffer_load_dwordx4 v11, s[8:11], s37 offen lds
  v_mul_f32 v25, 0x3a800000, v25
  v_mfma_f32_16x16x32_bf16 v[132:135], a[184:187], a[84:87], v[132:135]
  ds_read_b64_tr_b16 a[172:173], v3 offset:36864
  v_fma_f32 v25, -v24, v24, v25
  v_mfma_f32_16x16x32_bf16 v[132:135], a[180:183], a[68:71], v[132:135]
  v_max_f32 v25, 0, v25
  v_cvt_pk_bf16_f32 v25, v25, v25
  v_mfma_f32_16x16x32_bf16 v[136:139], a[180:183], a[72:75], v[136:139]
  ds_read_b64_tr_b16 a[174:175], v3 offset:38912
  v_lshlrev_b32 v25, 16, v25
  v_mfma_f32_16x16x32_bf16 v[136:139], a[184:187], a[88:91], v[136:139]
  s_add_u32 m0, s31, 77824
  s_add_u32 s37, s44, 229376
  v_mfma_f32_16x16x32_bf16 v[140:143], a[184:187], a[92:95], v[140:143]
  ds_read_b64_tr_b16 a[176:177], v3 offset:40960
  buffer_load_dwordx4 v11, s[12:15], s37 offen lds
  v_mfma_f32_16x16x32_bf16 v[140:143], a[180:183], a[76:79], v[140:143]
  v_add_f32 v25, 0x3727c5ac, v25
  s_waitcnt lgkmcnt(5)
  v_mfma_f32_16x16x32_bf16 v[156:159], a[160:163], a[76:79], v[156:159]
  ds_read_b64_tr_b16 a[178:179], v3 offset:43008
  v_cvt_pk_bf16_f32 v25, v25, v25
  v_mfma_f32_16x16x32_bf16 v[156:159], a[164:167], a[92:95], v[156:159]
  v_lshlrev_b32 v25, 16, v25
  v_mfma_f32_16x16x32_bf16 v[152:155], a[164:167], a[88:91], v[152:155]
  ds_read_b64_tr_b16 a[180:181], v3 offset:45056
  s_add_u32 m0, s31, 0
  v_mfma_f32_16x16x32_bf16 v[152:155], a[160:163], a[72:75], v[152:155]
  buffer_load_dwordx4 v10, s[8:11], s44 offen lds
  v_mfma_f32_16x16x32_bf16 v[148:151], a[160:163], a[68:71], v[148:151]
  ds_read_b64_tr_b16 a[182:183], v3 offset:47104
  v_sqrt_f32 v25, v25
  v_mfma_f32_16x16x32_bf16 v[148:151], a[164:167], a[84:87], v[148:151]
  v_cvt_pk_bf16_f32 v24, v24, v24
  v_lshlrev_b32 v24, 16, v24
  v_mfma_f32_16x16x32_bf16 v[144:147], a[164:167], a[80:83], v[144:147]
  ds_read_b64_tr_b16 a[184:185], v4 offset:32768
  v_cvt_pk_bf16_f32 v25, v25, v25
  v_mfma_f32_16x16x32_bf16 v[144:147], a[160:163], a[64:67], v[144:147]
  s_add_u32 m0, s31, 8192
  s_waitcnt lgkmcnt(5)
  v_mfma_f32_16x16x32_bf16 v[160:163], a[168:171], a[64:67], v[160:163]
  ds_read_b64_tr_b16 a[186:187], v4 offset:34816
  buffer_load_dwordx4 v10, s[12:15], s44 offen lds
  v_mfma_f32_16x16x32_bf16 v[160:163], a[172:175], a[80:83], v[160:163]
  v_lshlrev_b32 v17, 16, v25
  v_sub_f32 v16, 0, v24
  v_mfma_f32_16x16x32_bf16 v[164:167], a[172:175], a[84:87], v[164:167]
  ds_read_b64_tr_b16 a[160:161], v4 offset:36864
  v_accvgpr_read_b32 v24, a196
  v_mfma_f32_16x16x32_bf16 v[164:167], a[168:171], a[68:71], v[164:167]
  v_accvgpr_read_b32 v25, a197
  v_accvgpr_read_b32 v26, a198
  v_mfma_f32_16x16x32_bf16 v[168:171], a[168:171], a[72:75], v[168:171]
  ds_read_b64_tr_b16 a[162:163], v4 offset:38912
  s_add_u32 m0, s31, 4096
  s_add_u32 s37, s44, 229376
  v_mfma_f32_16x16x32_bf16 v[168:171], a[172:175], a[88:91], v[168:171]
  buffer_load_dwordx4 v10, s[8:11], s37 offen lds
  v_accvgpr_read_b32 v27, a199
  v_mfma_f32_16x16x32_bf16 v[172:175], a[172:175], a[92:95], v[172:175]
  ds_read_b64_tr_b16 a[164:165], v4 offset:40960
  v_accvgpr_read_b32 v28, a200
  v_mfma_f32_16x16x32_bf16 v[172:175], a[168:171], a[76:79], v[172:175]
  v_accvgpr_read_b32 v29, a201
  s_waitcnt lgkmcnt(5)
  v_mfma_f32_16x16x32_bf16 v[188:191], a[176:179], a[76:79], v[188:191]
  ds_read_b64_tr_b16 a[166:167], v4 offset:43008
  v_accvgpr_read_b32 v30, a202
  v_mfma_f32_16x16x32_bf16 v[188:191], a[180:183], a[92:95], v[188:191]
  s_add_u32 m0, s31, 12288
  s_add_u32 s37, s44, 229376
  v_mfma_f32_16x16x32_bf16 v[184:187], a[180:183], a[88:91], v[184:187]
  ds_read_b64_tr_b16 a[168:169], v4 offset:45056
  buffer_load_dwordx4 v10, s[12:15], s37 offen lds
  v_mfma_f32_16x16x32_bf16 v[184:187], a[176:179], a[72:75], v[184:187]
  v_accvgpr_read_b32 v31, a203
  v_add_f32 v24, v24, v26
  v_mfma_f32_16x16x32_bf16 v[180:183], a[176:179], a[68:71], v[180:183]
  ds_read_b64_tr_b16 a[170:171], v4 offset:47104
  v_add_f32 v25, v25, v27
  v_mfma_f32_16x16x32_bf16 v[180:183], a[180:183], a[84:87], v[180:183]
  v_add_f32 v28, v28, v30
  v_add_f32 v29, v29, v31
  v_mfma_f32_16x16x32_bf16 v[176:179], a[180:183], a[80:83], v[176:179]
  ds_read_b64_tr_b16 a[172:173], v5 offset:32768
  v_mfma_f32_16x16x32_bf16 v[176:179], a[176:179], a[64:67], v[176:179]
  buffer_load_dwordx4 a[128:131], v1, s[4:7], s52 offen offset:0 sc1
  s_waitcnt lgkmcnt(5)
  v_mfma_f32_16x16x32_bf16 v[192:195], a[184:187], a[64:67], v[192:195]
  ds_read_b64_tr_b16 a[174:175], v5 offset:34816
  v_add_f32 v24, v24, v28
  v_mfma_f32_16x16x32_bf16 v[192:195], a[160:163], a[80:83], v[192:195]
  v_add_f32 v25, v25, v29
  v_mov_b32 v26, v24
  v_mfma_f32_16x16x32_bf16 v[196:199], a[160:163], a[84:87], v[196:199]
  ds_read_b64_tr_b16 a[176:177], v5 offset:36864
  v_mov_b32 v27, v25
  v_mfma_f32_16x16x32_bf16 v[196:199], a[184:187], a[68:71], v[196:199]
  v_permlane16_swap_b32 v24, v26
  v_permlane16_swap_b32 v25, v27
  v_mfma_f32_16x16x32_bf16 v[200:203], a[184:187], a[72:75], v[200:203]
  ds_read_b64_tr_b16 a[178:179], v5 offset:38912
  buffer_load_dwordx4 a[144:147], v1, s[4:7], s52 offen offset:1024 sc1
  v_mfma_f32_16x16x32_bf16 v[200:203], a[160:163], a[88:91], v[200:203]
  v_add_f32 v24, v24, v26
  v_add_f32 v25, v25, v27
  v_mfma_f32_16x16x32_bf16 v[204:207], a[160:163], a[92:95], v[204:207]
  ds_read_b64_tr_b16 a[180:181], v5 offset:40960
  v_mov_b32 v26, v24
  v_mfma_f32_16x16x32_bf16 v[204:207], a[184:187], a[76:79], v[204:207]
  v_mov_b32 v27, v25
  s_waitcnt lgkmcnt(5)
  v_mfma_f32_16x16x32_bf16 v[220:223], a[164:167], a[76:79], v[220:223]
  ds_read_b64_tr_b16 a[182:183], v5 offset:43008
  s_add_u32 s52, s52, 65536
  v_mfma_f32_16x16x32_bf16 v[220:223], a[168:171], a[92:95], v[220:223]
  buffer_load_dwordx4 a[132:135], v1, s[4:7], s52 offen offset:0 sc1
  v_permlane32_swap_b32 v24, v26
  v_mfma_f32_16x16x32_bf16 v[216:219], a[168:171], a[88:91], v[216:219]
  ds_read_b64_tr_b16 a[184:185], v5 offset:45056
  v_permlane32_swap_b32 v25, v27
  v_mfma_f32_16x16x32_bf16 v[216:219], a[164:167], a[72:75], v[216:219]
  v_add_f32 v24, v24, v26
  v_add_f32 v25, v25, v27
  v_mfma_f32_16x16x32_bf16 v[212:215], a[164:167], a[68:71], v[212:215]
  ds_read_b64_tr_b16 a[186:187], v5 offset:47104
  v_mul_f32 v24, 0x3a800000, v24
  v_mfma_f32_16x16x32_bf16 v[212:215], a[168:171], a[84:87], v[212:215]
  s_waitcnt vmcnt(19)
  s_barrier
  v_mfma_f32_16x16x32_bf16 v[208:211], a[168:171], a[80:83], v[208:211]
  ds_read_b64_tr_b16 a[160:161], v6 offset:49152
  buffer_load_dwordx4 a[148:151], v1, s[4:7], s52 offen offset:1024 sc1
  v_mfma_f32_16x16x32_bf16 v[208:211], a[164:167], a[64:67], v[208:211]
  v_mul_f32 v25, 0x3a800000, v25
  s_waitcnt lgkmcnt(5)
  v_mfma_f32_16x16x32_bf16 v[224:227], a[172:175], a[64:67], v[224:227]
  ds_read_b64_tr_b16 a[162:163], v6 offset:51200
  v_fma_f32 v25, -v24, v24, v25
  v_mfma_f32_16x16x32_bf16 v[224:227], a[176:179], a[80:83], v[224:227]
  v_max_f32 v25, 0, v25
  v_cvt_pk_bf16_f32 v25, v25, v25
  v_mfma_f32_16x16x32_bf16 v[228:231], a[176:179], a[84:87], v[228:231]
  ds_read_b64_tr_b16 a[164:165], v6 offset:53248
  s_add_u32 s52, s52, 65536
  v_mfma_f32_16x16x32_bf16 v[228:231], a[172:175], a[68:71], v[228:231]
  buffer_load_dwordx4 a[136:139], v1, s[4:7], s52 offen offset:0 sc1
  v_lshlrev_b32 v25, 16, v25
  v_mfma_f32_16x16x32_bf16 v[232:235], a[172:175], a[72:75], v[232:235]
  ds_read_b64_tr_b16 a[166:167], v6 offset:55296
  v_add_f32 v25, 0x3727c5ac, v25
  v_mfma_f32_16x16x32_bf16 v[232:235], a[176:179], a[88:91], v[232:235]
  v_cvt_pk_bf16_f32 v25, v25, v25
  v_lshlrev_b32 v25, 16, v25
  v_mfma_f32_16x16x32_bf16 v[236:239], a[176:179], a[92:95], v[236:239]
  ds_read_b64_tr_b16 a[168:169], v6 offset:57344
  v_mfma_f32_16x16x32_bf16 v[236:239], a[172:175], a[76:79], v[236:239]
  v_sqrt_f32 v25, v25
  s_waitcnt lgkmcnt(5)
  v_mfma_f32_16x16x32_bf16 v[252:255], a[180:183], a[76:79], v[252:255]
  ds_read_b64_tr_b16 a[170:171], v6 offset:59392
  buffer_load_dwordx4 a[152:155], v1, s[4:7], s52 offen offset:1024 sc1
  v_mfma_f32_16x16x32_bf16 v[252:255], a[184:187], a[92:95], v[252:255]
  v_cvt_pk_bf16_f32 v24, v24, v24
  v_lshlrev_b32 v24, 16, v24
  v_mfma_f32_16x16x32_bf16 v[248:251], a[184:187], a[88:91], v[248:251]
  ds_read_b64_tr_b16 a[172:173], v6 offset:61440
  v_cvt_pk_bf16_f32 v25, v25, v25
  v_mfma_f32_16x16x32_bf16 v[248:251], a[180:183], a[72:75], v[248:251]
  v_lshlrev_b32 v19, 16, v25
  v_sub_f32 v18, 0, v24
  v_mfma_f32_16x16x32_bf16 v[244:247], a[180:183], a[68:71], v[244:247]
  ds_read_b64_tr_b16 a[174:175], v6 offset:63488
  s_add_u32 s52, s52, 65536
  v_mfma_f32_16x16x32_bf16 v[244:247], a[184:187], a[84:87], v[244:247]
  buffer_load_dwordx4 a[140:143], v1, s[4:7], s52 offen offset:0 sc1
  v_accvgpr_read_b32 v24, a204
  v_mfma_f32_16x16x32_bf16 v[240:243], a[184:187], a[80:83], v[240:243]
  ds_read_b64_tr_b16 a[176:177], v7 offset:49152
  v_accvgpr_read_b32 v25, a205
  v_mfma_f32_16x16x32_bf16 v[240:243], a[180:183], a[64:67], v[240:243]
  v_accvgpr_read_b32 v26, a206
  s_waitcnt vmcnt(15) lgkmcnt(5)
  v_mfma_f32_16x16x32_bf16 v[64:67], a[160:163], a[96:99], v[64:67]
  ds_read_b64_tr_b16 a[178:179], v7 offset:51200
  v_accvgpr_read_b32 v27, a207
  v_mfma_f32_16x16x32_bf16 v[64:67], a[164:167], a[112:115], v[64:67]
  v_accvgpr_read_b32 v28, a208
  v_accvgpr_read_b32 v29, a209
  v_mfma_f32_16x16x32_bf16 v[68:71], a[164:167], a[116:119], v[68:71]
  ds_read_b64_tr_b16 a[180:181], v7 offset:53248
  buffer_load_dwordx4 a[156:159], v1, s[4:7], s52 offen offset:1024 sc1
  v_mfma_f32_16x16x32_bf16 v[68:71], a[160:163], a[100:103], v[68:71]
  v_accvgpr_read_b32 v30, a210
  v_accvgpr_read_b32 v31, a211
  v_mfma_f32_16x16x32_bf16 v[72:75], a[160:163], a[104:107], v[72:75]
  ds_read_b64_tr_b16 a[182:183], v7 offset:55296
  v_add_f32 v24, v24, v26
  v_mfma_f32_16x16x32_bf16 v[72:75], a[164:167], a[120:123], v[72:75]
  v_add_f32 v25, v25, v27
  v_add_f32 v28, v28, v30
  v_mfma_f32_16x16x32_bf16 v[76:79], a[164:167], a[124:127], v[76:79]
  ds_read_b64_tr_b16 a[184:185], v7 offset:57344
  s_cmp_eq_u32 s32, 1
  s_cselect_b32 s53, 9, 5
  s_mul_i32 s45, s53, 458752
  s_lshl_b32 s53, s53, 11
  s_add_u32 s53, s53, s33
  s_add_u32 m0, s31, 81920
  v_mfma_f32_16x16x32_bf16 v[76:79], a[160:163], a[108:111], v[76:79]
  buffer_load_dwordx4 v11, s[8:11], s45 offen lds
  s_waitcnt lgkmcnt(5)
  v_mfma_f32_16x16x32_bf16 v[92:95], a[168:171], a[108:111], v[92:95]
  ds_read_b64_tr_b16 a[186:187], v7 offset:59392
  v_add_f32 v29, v29, v31
  v_mfma_f32_16x16x32_bf16 v[92:95], a[172:175], a[124:127], v[92:95]
  v_add_f32 v24, v24, v28
  v_add_f32 v25, v25, v29
  v_mfma_f32_16x16x32_bf16 v[88:91], a[172:175], a[120:123], v[88:91]
  ds_read_b64_tr_b16 a[160:161], v7 offset:61440
  v_mov_b32 v26, v24
  v_mfma_f32_16x16x32_bf16 v[88:91], a[168:171], a[104:107], v[88:91]
  s_add_u32 m0, s31, 90112
  v_mov_b32 v27, v25
  v_mfma_f32_16x16x32_bf16 v[84:87], a[168:171], a[100:103], v[84:87]
  ds_read_b64_tr_b16 a[162:163], v7 offset:63488
  buffer_load_dwordx4 v11, s[12:15], s45 offen lds
  v_mfma_f32_16x16x32_bf16 v[84:87], a[172:175], a[116:119], v[84:87]
  v_permlane16_swap_b32 v24, v26
  v_permlane16_swap_b32 v25, v27
  v_mfma_f32_16x16x32_bf16 v[80:83], a[172:175], a[112:115], v[80:83]
  ds_read_b64_tr_b16 a[164:165], v8 offset:49152
  v_add_f32 v24, v24, v26
  v_mfma_f32_16x16x32_bf16 v[80:83], a[168:171], a[96:99], v[80:83]
  v_add_f32 v25, v25, v27
  s_waitcnt lgkmcnt(5)
  v_mfma_f32_16x16x32_bf16 v[96:99], a[176:179], a[96:99], v[96:99]
  ds_read_b64_tr_b16 a[166:167], v8 offset:51200
  s_add_u32 m0, s31, 86016
  s_add_u32 s37, s45, 229376
  v_mfma_f32_16x16x32_bf16 v[96:99], a[180:183], a[112:115], v[96:99]
  buffer_load_dwordx4 v11, s[8:11], s37 offen lds
  v_mov_b32 v26, v24
  v_mfma_f32_16x16x32_bf16 v[100:103], a[180:183], a[116:119], v[100:103]
  ds_read_b64_tr_b16 a[168:169], v8 offset:53248
  v_mov_b32 v27, v25
  v_mfma_f32_16x16x32_bf16 v[100:103], a[176:179], a[100:103], v[100:103]
  v_permlane32_swap_b32 v24, v26
  v_permlane32_swap_b32 v25, v27
  v_mfma_f32_16x16x32_bf16 v[104:107], a[176:179], a[104:107], v[104:107]
  ds_read_b64_tr_b16 a[170:171], v8 offset:55296
  v_add_f32 v24, v24, v26
  v_mfma_f32_16x16x32_bf16 v[104:107], a[180:183], a[120:123], v[104:107]
  s_add_u32 m0, s31, 94208
  s_add_u32 s37, s45, 229376
  v_mfma_f32_16x16x32_bf16 v[108:111], a[180:183], a[124:127], v[108:111]
  ds_read_b64_tr_b16 a[172:173], v8 offset:57344
  buffer_load_dwordx4 v11, s[12:15], s37 offen lds
  v_mfma_f32_16x16x32_bf16 v[108:111], a[176:179], a[108:111], v[108:111]
  v_add_f32 v25, v25, v27
  s_waitcnt lgkmcnt(5)
  v_mfma_f32_16x16x32_bf16 v[124:127], a[184:187], a[108:111], v[124:127]
  ds_read_b64_tr_b16 a[174:175], v8 offset:59392
  v_mul_f32 v24, 0x3a800000, v24
  v_mfma_f32_16x16x32_bf16 v[124:127], a[160:163], a[124:127], v[124:127]
  v_mul_f32 v25, 0x3a800000, v25
  v_fma_f32 v25, -v24, v24, v25
  v_mfma_f32_16x16x32_bf16 v[120:123], a[160:163], a[120:123], v[120:123]
  ds_read_b64_tr_b16 a[176:177], v8 offset:61440
  s_add_u32 m0, s31, 16384
  v_mfma_f32_16x16x32_bf16 v[120:123], a[184:187], a[104:107], v[120:123]
  buffer_load_dwordx4 v10, s[8:11], s45 offen lds
  v_max_f32 v25, 0, v25
  v_mfma_f32_16x16x32_bf16 v[116:119], a[184:187], a[100:103], v[116:119]
  ds_read_b64_tr_b16 a[178:179], v8 offset:63488
  v_cvt_pk_bf16_f32 v25, v25, v25
  v_mfma_f32_16x16x32_bf16 v[116:119], a[160:163], a[116:119], v[116:119]
  v_lshlrev_b32 v25, 16, v25
  v_add_f32 v25, 0x3727c5ac, v25
  v_mfma_f32_16x16x32_bf16 v[112:115], a[160:163], a[112:115], v[112:115]
  ds_read_b64_tr_b16 a[180:181], v2 offset:49152
  v_cvt_pk_bf16_f32 v25, v25, v25
  v_mfma_f32_16x16x32_bf16 v[112:115], a[184:187], a[96:99], v[112:115]
  s_add_u32 m0, s31, 24576
  s_waitcnt lgkmcnt(5)
  v_mfma_f32_16x16x32_bf16 v[32:35], a[164:167], a[96:99], v[32:35]
  ds_read_b64_tr_b16 a[182:183], v2 offset:51200
  buffer_load_dwordx4 v10, s[12:15], s45 offen lds
  v_mfma_f32_16x16x32_bf16 v[32:35], a[168:171], a[112:115], v[32:35]
  v_lshlrev_b32 v25, 16, v25
  v_mfma_f32_16x16x32_bf16 v[36:39], a[168:171], a[116:119], v[36:39]
  ds_read_b64_tr_b16 a[184:185], v2 offset:53248
  v_sqrt_f32 v25, v25
  v_mfma_f32_16x16x32_bf16 v[36:39], a[164:167], a[100:103], v[36:39]
  v_cvt_pk_bf16_f32 v24, v24, v24
  v_lshlrev_b32 v24, 16, v24
  v_mfma_f32_16x16x32_bf16 v[40:43], a[164:167], a[104:107], v[40:43]
  ds_read_b64_tr_b16 a[186:187], v2 offset:55296
  s_add_u32 m0, s31, 20480
  s_add_u32 s37, s45, 229376
  v_mfma_f32_16x16x32_bf16 v[40:43], a[168:171], a[120:123], v[40:43]
  buffer_load_dwordx4 v10, s[8:11], s37 offen lds
  v_cvt_pk_bf16_f32 v25, v25, v25
  v_mfma_f32_16x16x32_bf16 v[44:47], a[168:171], a[124:127], v[44:47]
  ds_read_b64_tr_b16 a[160:161], v2 offset:57344
  v_lshlrev_b32 v21, 16, v25
  v_mfma_f32_16x16x32_bf16 v[44:47], a[164:167], a[108:111], v[44:47]
  v_sub_f32 v20, 0, v24
  s_waitcnt lgkmcnt(5)
  v_mfma_f32_16x16x32_bf16 v[60:63], a[172:175], a[108:111], v[60:63]
  ds_read_b64_tr_b16 a[162:163], v2 offset:59392
  v_accvgpr_read_b32 v24, a212
  v_mfma_f32_16x16x32_bf16 v[60:63], a[176:179], a[124:127], v[60:63]
  s_add_u32 m0, s31, 28672
  s_add_u32 s37, s45, 229376
  v_mfma_f32_16x16x32_bf16 v[56:59], a[176:179], a[120:123], v[56:59]
  ds_read_b64_tr_b16 a[164:165], v2 offset:61440
  buffer_load_dwordx4 v10, s[12:15], s37 offen lds
  v_mfma_f32_16x16x32_bf16 v[56:59], a[172:175], a[104:107], v[56:59]
  v_accvgpr_read_b32 v25, a213
  v_accvgpr_read_b32 v26, a214
  v_mfma_f32_16x16x32_bf16 v[52:55], a[172:175], a[100:103], v[52:55]
  ds_read_b64_tr_b16 a[166:167], v2 offset:63488
  v_accvgpr_read_b32 v27, a215
  v_mfma_f32_16x16x32_bf16 v[52:55], a[176:179], a[116:119], v[52:55]
  v_accvgpr_read_b32 v28, a216
  v_accvgpr_read_b32 v29, a217
  v_mfma_f32_16x16x32_bf16 v[48:51], a[176:179], a[112:115], v[48:51]
  ds_read_b64_tr_b16 a[168:169], v3 offset:49152
  v_mfma_f32_16x16x32_bf16 v[48:51], a[172:175], a[96:99], v[48:51]
  buffer_load_dwordx4 a[0:3], v1, s[4:7], s53 offen offset:0 sc1
  s_waitcnt lgkmcnt(5)
  v_mfma_f32_16x16x32_bf16 v[128:131], a[180:183], a[96:99], v[128:131]
  ds_read_b64_tr_b16 a[170:171], v3 offset:51200
  v_accvgpr_read_b32 v30, a218
  v_mfma_f32_16x16x32_bf16 v[128:131], a[184:187], a[112:115], v[128:131]
  v_accvgpr_read_b32 v31, a219
  v_add_f32 v24, v24, v26
  v_mfma_f32_16x16x32_bf16 v[132:135], a[184:187], a[116:119], v[132:135]
  ds_read_b64_tr_b16 a[172:173], v3 offset:53248
  v_add_f32 v25, v25, v27
  v_mfma_f32_16x16x32_bf16 v[132:135], a[180:183], a[100:103], v[132:135]
  v_add_f32 v28, v28, v30
  v_add_f32 v29, v29, v31
  v_mfma_f32_16x16x32_bf16 v[136:139], a[180:183], a[104:107], v[136:139]
  ds_read_b64_tr_b16 a[174:175], v3 offset:55296
  buffer_load_dwordx4 a[16:19], v1, s[4:7], s53 offen offset:1024 sc1
  v_mfma_f32_16x16x32_bf16 v[136:139], a[184:187], a[120:123], v[136:139]
  v_add_f32 v24, v24, v28
  v_add_f32 v25, v25, v29
  v_mfma_f32_16x16x32_bf16 v[140:143], a[184:187], a[124:127], v[140:143]
HOP7:
  s_cbranch_execz HOP11
  ds_read_b64_tr_b16 a[176:177], v3 offset:57344
  v_mov_b32 v26, v24
  v_mfma_f32_16x16x32_bf16 v[140:143], a[180:183], a[108:111], v[140:143]
  v_mov_b32 v27, v25
  s_waitcnt lgkmcnt(5)
  v_mfma_f32_16x16x32_bf16 v[156:159], a[160:163], a[108:111], v[156:159]
  ds_read_b64_tr_b16 a[178:179], v3 offset:59392
  s_add_u32 s53, s53, 65536
  v_mfma_f32_16x16x32_bf16 v[156:159], a[164:167], a[124:127], v[156:159]
  buffer_load_dwordx4 a[4:7], v1, s[4:7], s53 offen offset:0 sc1
  v_permlane16_swap_b32 v24, v26
  v_mfma_f32_16x16x32_bf16 v[152:155], a[164:167], a[120:123], v[152:155]
  ds_read_b64_tr_b16 a[180:181], v3 offset:61440
  v_permlane16_swap_b32 v25, v27
  v_mfma_f32_16x16x32_bf16 v[152:155], a[160:163], a[104:107], v[152:155]
  v_add_f32 v24, v24, v26
  v_add_f32 v25, v25, v27
  v_mfma_f32_16x16x32_bf16 v[148:151], a[160:163], a[100:103], v[148:151]
  ds_read_b64_tr_b16 a[182:183], v3 offset:63488
  v_mov_b32 v26, v24
  v_mfma_f32_16x16x32_bf16 v[148:151], a[164:167], a[116:119], v[148:151]
  v_mov_b32 v27, v25
  v_mfma_f32_16x16x32_bf16 v[144:147], a[164:167], a[112:115], v[144:147]
  ds_read_b64_tr_b16 a[184:185], v4 offset:49152
  buffer_load_dwordx4 a[20:23], v1, s[4:7], s53 offen offset:1024 sc1
  v_mfma_f32_16x16x32_bf16 v[144:147], a[160:163], a[96:99], v[144:147]
  v_permlane32_swap_b32 v24, v26
  s_waitcnt lgkmcnt(5)
  v_mfma_f32_16x16x32_bf16 v[160:163], a[168:171], a[96:99], v[160:163]
  ds_read_b64_tr_b16 a[186:187], v4 offset:51200
  v_permlane32_swap_b32 v25, v27
  v_mfma_f32_16x16x32_bf16 v[160:163], a[172:175], a[112:115], v[160:163]
  v_add_f32 v24, v24, v26
  v_add_f32 v25, v25, v27
  v_mfma_f32_16x16x32_bf16 v[164:167], a[172:175], a[116:119], v[164:167]
  ds_read_b64_tr_b16 a[160:161], v4 offset:53248
  s_add_u32 s53, s53, 65536
  v_mfma_f32_16x16x32_bf16 v[164:167], a[168:171], a[100:103], v[164:167]
  buffer_load_dwordx4 a[8:11], v1, s[4:7], s53 offen offset:0 sc1
  v_mul_f32 v24, 0x3a800000, v24
  v_mfma_f32_16x16x32_bf16 v[168:171], a[168:171], a[104:107], v[168:171]
  ds_read_b64_tr_b16 a[162:163], v4 offset:55296
  v_mul_f32 v25, 0x3a800000, v25
  v_mfma_f32_16x16x32_bf16 v[168:171], a[172:175], a[120:123], v[168:171]
  v_fma_f32 v25, -v24, v24, v25
  v_max_f32 v25, 0, v25
  v_mfma_f32_16x16x32_bf16 v[172:175], a[172:175], a[124:127], v[172:175]
  ds_read_b64_tr_b16 a[164:165], v4 offset:57344
  v_cvt_pk_bf16_f32 v25, v25, v25
  v_mfma_f32_16x16x32_bf16 v[172:175], a[168:171], a[108:111], v[172:175]
  v_lshlrev_b32 v25, 16, v25
  s_waitcnt lgkmcnt(5)
  v_mfma_f32_16x16x32_bf16 v[188:191], a[176:179], a[108:111], v[188:191]
  ds_read_b64_tr_b16 a[166:167], v4 offset:59392
  buffer_load_dwordx4 a[24:27], v1, s[4:7], s53 offen offset:1024 sc1
  v_mfma_f32_16x16x32_bf16 v[188:191], a[180:183], a[124:127], v[188:191]
  v_add_f32 v25, 0x3727c5ac, v25
  v_cvt_pk_bf16_f32 v25, v25, v25
  v_mfma_f32_16x16x32_bf16 v[184:187], a[180:183], a[120:123], v[184:187]
  ds_read_b64_tr_b16 a[168:169], v4 offset:61440
  v_lshlrev_b32 v25, 16, v25
  v_mfma_f32_16x16x32_bf16 v[184:187], a[176:179], a[104:107], v[184:187]
  v_sqrt_f32 v25, v25
  v_mfma_f32_16x16x32_bf16 v[180:183], a[176:179], a[100:103], v[180:183]
  ds_read_b64_tr_b16 a[170:171], v4 offset:63488
  s_add_u32 s53, s53, 65536
  v_mfma_f32_16x16x32_bf16 v[180:183], a[180:183], a[116:119], v[180:183]
  buffer_load_dwordx4 a[12:15], v1, s[4:7], s53 offen offset:0 sc1
  v_cvt_pk_bf16_f32 v24, v24, v24
  v_mfma_f32_16x16x32_bf16 v[176:179], a[180:183], a[112:115], v[176:179]
  ds_read_b64_tr_b16 a[172:173], v5 offset:49152
  v_lshlrev_b32 v24, 16, v24
  v_mfma_f32_16x16x32_bf16 v[176:179], a[176:179], a[96:99], v[176:179]
  v_cvt_pk_bf16_f32 v25, v25, v25
  s_waitcnt lgkmcnt(5)
  v_mfma_f32_16x16x32_bf16 v[192:195], a[184:187], a[96:99], v[192:195]
  ds_read_b64_tr_b16 a[174:175], v5 offset:51200
  v_lshlrev_b32 v23, 16, v25
  v_mfma_f32_16x16x32_bf16 v[192:195], a[160:163], a[112:115], v[192:195]
  v_sub_f32 v22, 0, v24
  s_and_b32 s25, s2, 4
  v_mfma_f32_16x16x32_bf16 v[196:199], a[160:163], a[116:119], v[196:199]
  ds_read_b64_tr_b16 a[176:177], v5 offset:53248
  buffer_load_dwordx4 a[28:31], v1, s[4:7], s53 offen offset:1024 sc1
  v_mfma_f32_16x16x32_bf16 v[196:199], a[184:187], a[100:103], v[196:199]
  s_lshr_b32 s28, s2, 6
  s_add_u32 s25, s25, s28
  v_mfma_f32_16x16x32_bf16 v[200:203], a[184:187], a[104:107], v[200:203]
  ds_read_b64_tr_b16 a[178:179], v5 offset:55296
  s_bfe_u32 s26, s2, 0x30003
  v_mfma_f32_16x16x32_bf16 v[200:203], a[160:163], a[120:123], v[200:203]
  s_and_b32 s27, s2, 3
  s_add_u32 s67, s25, s26
  v_mfma_f32_16x16x32_bf16 v[204:207], a[160:163], a[124:127], v[204:207]
  ds_read_b64_tr_b16 a[180:181], v5 offset:57344
  s_cmp_eq_u32 s32, 2
  s_cselect_b32 s54, 10, 6
  s_mul_i32 s46, s54, 458752
  s_lshl_b32 s54, s54, 11
  s_add_u32 s54, s54, s33
  s_add_u32 m0, s31, 98304
  v_mfma_f32_16x16x32_bf16 v[204:207], a[184:187], a[108:111], v[204:207]
  buffer_load_dwordx4 v11, s[8:11], s46 offen lds
  s_waitcnt lgkmcnt(5)
  v_mfma_f32_16x16x32_bf16 v[220:223], a[164:167], a[108:111], v[220:223]
  ds_read_b64_tr_b16 a[182:183], v5 offset:59392
  s_and_b32 s67, s67, 3
  v_mfma_f32_16x16x32_bf16 v[220:223], a[168:171], a[124:127], v[220:223]
  s_lshl_b32 s28, s25, 4
  s_lshr_b32 s29, s24, 1
  v_mfma_f32_16x16x32_bf16 v[216:219], a[168:171], a[120:123], v[216:219]
  ds_read_b64_tr_b16 a[184:185], v5 offset:61440
  s_lshl_b32 s29, s29, 3
  v_mfma_f32_16x16x32_bf16 v[216:219], a[164:167], a[104:107], v[216:219]
  s_add_u32 m0, s31, 106496
  s_add_u32 s28, s28, s29
  v_mfma_f32_16x16x32_bf16 v[212:215], a[164:167], a[100:103], v[212:215]
  ds_read_b64_tr_b16 a[186:187], v5 offset:63488
  buffer_load_dwordx4 v11, s[12:15], s46 offen lds
  v_mfma_f32_16x16x32_bf16 v[212:215], a[168:171], a[116:119], v[212:215]
  s_waitcnt vmcnt(26)
  s_barrier
  v_mfma_f32_16x16x32_bf16 v[208:211], a[168:171], a[112:115], v[208:211]
  ds_read_b64_tr_b16 a[160:161], v6 offset:0
  s_and_b32 s29, s24, 1
  v_mfma_f32_16x16x32_bf16 v[208:211], a[164:167], a[96:99], v[208:211]
  s_add_u32 s28, s28, s29
  s_waitcnt lgkmcnt(5)
  v_mfma_f32_16x16x32_bf16 v[224:227], a[172:175], a[96:99], v[224:227]
  ds_read_b64_tr_b16 a[162:163], v6 offset:2048
  s_add_u32 m0, s31, 102400
  s_add_u32 s37, s46, 229376
  v_mfma_f32_16x16x32_bf16 v[224:227], a[176:179], a[112:115], v[224:227]
  buffer_load_dwordx4 v11, s[8:11], s37 offen lds
  s_mul_i32 s60, s28, 131072
  v_mfma_f32_16x16x32_bf16 v[228:231], a[176:179], a[116:119], v[228:231]
  ds_read_b64_tr_b16 a[164:165], v6 offset:4096
  s_mul_i32 s29, s27, 28672
  v_mfma_f32_16x16x32_bf16 v[228:231], a[172:175], a[100:103], v[228:231]
  s_add_u32 s60, s60, s29
  s_add_u32 s60, s60, 19922944
  v_mfma_f32_16x16x32_bf16 v[232:235], a[172:175], a[104:107], v[232:235]
  ds_read_b64_tr_b16 a[166:167], v6 offset:6144
  s_lshl_b32 s61, s28, 15
  v_mfma_f32_16x16x32_bf16 v[232:235], a[176:179], a[120:123], v[232:235]
  s_add_u32 m0, s31, 110592
  s_add_u32 s37, s46, 229376
  v_mfma_f32_16x16x32_bf16 v[236:239], a[176:179], a[124:127], v[236:239]
  ds_read_b64_tr_b16 a[168:169], v6 offset:8192
  buffer_load_dwordx4 v11, s[12:15], s37 offen lds
  v_mfma_f32_16x16x32_bf16 v[236:239], a[172:175], a[108:111], v[236:239]
  s_lshl_b32 s29, s26, 2
  s_waitcnt lgkmcnt(5)
  v_mfma_f32_16x16x32_bf16 v[252:255], a[180:183], a[108:111], v[252:255]
  ds_read_b64_tr_b16 a[170:171], v6 offset:10240
  s_add_u32 s29, s29, s27
  v_mfma_f32_16x16x32_bf16 v[252:255], a[184:187], a[124:127], v[252:255]
  s_lshl_b32 s28, s29, 10
  s_add_u32 s65, s61, s28
  v_mfma_f32_16x16x32_bf16 v[248:251], a[184:187], a[120:123], v[248:251]
  ds_read_b64_tr_b16 a[172:173], v6 offset:12288
  s_add_u32 m0, s31, 32768
  v_mfma_f32_16x16x32_bf16 v[248:251], a[180:183], a[104:107], v[248:251]
  buffer_load_dwordx4 v10, s[8:11], s46 offen lds
  s_add_u32 s65, s65, 13631488
  v_mfma_f32_16x16x32_bf16 v[244:247], a[180:183], a[100:103], v[244:247]
  ds_read_b64_tr_b16 a[174:175], v6 offset:14336
  s_lshl_b32 s28, s29, 6
  v_mfma_f32_16x16x32_bf16 v[244:247], a[184:187], a[116:119], v[244:247]
  s_add_u32 s61, s61, s28
  s_lshl_b32 s64, s29, 7
  v_mfma_f32_16x16x32_bf16 v[240:243], a[184:187], a[112:115], v[240:243]
  ds_read_b64_tr_b16 a[176:177], v7 offset:0
  s_add_u32 s64, s64, 20480
  v_mfma_f32_16x16x32_bf16 v[240:243], a[180:183], a[96:99], v[240:243]
  s_add_u32 m0, s31, 40960
  s_waitcnt vmcnt(21) lgkmcnt(5)
  v_mfma_f32_16x16x32_bf16 v[64:67], a[160:163], a[128:131], v[64:67]
  ds_read_b64_tr_b16 a[178:179], v7 offset:2048
  buffer_load_dwordx4 v10, s[12:15], s46 offen lds
  v_mfma_f32_16x16x32_bf16 v[64:67], a[164:167], a[144:147], v[64:67]
  s_lshl_b32 s28, s25, 12
  s_lshl_b32 s29, s27, 8
  v_mfma_f32_16x16x32_bf16 v[68:71], a[164:167], a[148:151], v[68:71]
  ds_read_b64_tr_b16 a[180:181], v7 offset:4096
  s_add_u32 s28, s28, s29
  v_mfma_f32_16x16x32_bf16 v[68:71], a[160:163], a[132:135], v[68:71]
  s_lshl_b32 s29, s24, 2
  s_add_u32 s28, s28, s29
  v_mfma_f32_16x16x32_bf16 v[72:75], a[160:163], a[136:139], v[72:75]
  ds_read_b64_tr_b16 a[182:183], v7 offset:6144
  s_add_u32 m0, s31, 36864
  s_add_u32 s37, s46, 229376
  v_mfma_f32_16x16x32_bf16 v[72:75], a[164:167], a[152:155], v[72:75]
  buffer_load_dwordx4 v10, s[8:11], s37 offen lds
  s_add_u32 s58, s28, 688128
  v_mfma_f32_16x16x32_bf16 v[76:79], a[164:167], a[156:159], v[76:79]
  ds_read_b64_tr_b16 a[184:185], v7 offset:8192
  s_lshl_b32 s66, s24, 12
  v_mfma_f32_16x16x32_bf16 v[76:79], a[160:163], a[140:143], v[76:79]
  s_add_u32 s66, s66, 147456
  s_waitcnt lgkmcnt(5)
  v_mfma_f32_16x16x32_bf16 v[92:95], a[168:171], a[140:143], v[92:95]
  ds_read_b64_tr_b16 a[186:187], v7 offset:10240
  s_lshl_b32 s62, s2, 16
  v_mfma_f32_16x16x32_bf16 v[92:95], a[172:175], a[156:159], v[92:95]
  s_add_u32 m0, s31, 45056
  s_add_u32 s37, s46, 229376
  v_mfma_f32_16x16x32_bf16 v[88:91], a[172:175], a[152:155], v[88:91]
  ds_read_b64_tr_b16 a[160:161], v7 offset:12288
  buffer_load_dwordx4 v10, s[12:15], s37 offen lds
  v_mfma_f32_16x16x32_bf16 v[88:91], a[168:171], a[136:139], v[88:91]
  s_lshl_b32 s28, s24, 14
  s_add_u32 s62, s62, s28
  v_mfma_f32_16x16x32_bf16 v[84:87], a[168:171], a[132:135], v[84:87]
  ds_read_b64_tr_b16 a[162:163], v7 offset:14336
  s_add_u32 s62, s62, 67108864
  v_mfma_f32_16x16x32_bf16 v[84:87], a[172:175], a[148:151], v[84:87]
  s_lshr_b32 s28, s2, 3
  s_lshl_b32 s28, s28, 2
  v_mfma_f32_16x16x32_bf16 v[80:83], a[172:175], a[144:147], v[80:83]
  ds_read_b64_tr_b16 a[164:165], v8 offset:0
  v_mfma_f32_16x16x32_bf16 v[80:83], a[168:171], a[128:131], v[80:83]
  buffer_load_dwordx4 a[32:35], v1, s[4:7], s54 offen offset:0 sc1
  s_waitcnt lgkmcnt(5)
  v_mfma_f32_16x16x32_bf16 v[96:99], a[176:179], a[128:131], v[96:99]
  ds_read_b64_tr_b16 a[166:167], v8 offset:2048
  s_add_u32 s28, s28, s24
  v_mfma_f32_16x16x32_bf16 v[96:99], a[180:183], a[144:147], v[96:99]
  s_mul_i32 s68, s28, 14336
  s_mul_i32 s28, s27, 1835008
  v_mfma_f32_16x16x32_bf16 v[100:103], a[180:183], a[148:151], v[100:103]
  ds_read_b64_tr_b16 a[168:169], v8 offset:4096
  s_add_u32 s68, s68, s28
  v_mfma_f32_16x16x32_bf16 v[100:103], a[176:179], a[132:135], v[100:103]
  v_xor_b32 v9, 96, v6
  v_lshrrev_b32 v13, 8, v1
  v_mfma_f32_16x16x32_bf16 v[104:107], a[176:179], a[136:139], v[104:107]
  ds_read_b64_tr_b16 a[170:171], v8 offset:6144
  buffer_load_dwordx4 a[48:51], v1, s[4:7], s54 offen offset:1024 sc1
  v_mfma_f32_16x16x32_bf16 v[104:107], a[180:183], a[152:155], v[104:107]
  v_lshlrev_b32 v13, 28, v13
  v_lshl_add_u32 v13, v1, 3, v13
  v_mfma_f32_16x16x32_bf16 v[108:111], a[180:183], a[156:159], v[108:111]
  ds_read_b64_tr_b16 a[172:173], v8 offset:8192
  v_mfma_f32_16x16x32_bf16 v[108:111], a[176:179], a[140:143], v[108:111]
  s_waitcnt lgkmcnt(5)
  v_mfma_f32_16x16x32_bf16 v[124:127], a[184:187], a[140:143], v[124:127]
  ds_read_b64_tr_b16 a[174:175], v8 offset:10240
  s_add_u32 s54, s54, 65536
  v_mfma_f32_16x16x32_bf16 v[124:127], a[160:163], a[156:159], v[124:127]
  buffer_load_dwordx4 a[36:39], v1, s[4:7], s54 offen offset:0 sc1
  v_mfma_f32_16x16x32_bf16 v[120:123], a[160:163], a[152:155], v[120:123]
  ds_read_b64_tr_b16 a[176:177], v8 offset:12288
  v_mfma_f32_16x16x32_bf16 v[120:123], a[184:187], a[136:139], v[120:123]
  v_mfma_f32_16x16x32_bf16 v[116:119], a[184:187], a[132:135], v[116:119]
  ds_read_b64_tr_b16 a[178:179], v8 offset:14336
  v_mfma_f32_16x16x32_bf16 v[116:119], a[160:163], a[148:151], v[116:119]
  v_mfma_f32_16x16x32_bf16 v[112:115], a[160:163], a[144:147], v[112:115]
  ds_read_b64_tr_b16 a[180:181], v2 offset:0
  buffer_load_dwordx4 a[52:55], v1, s[4:7], s54 offen offset:1024 sc1
  v_mfma_f32_16x16x32_bf16 v[112:115], a[184:187], a[128:131], v[112:115]
  s_waitcnt lgkmcnt(5)
  v_mfma_f32_16x16x32_bf16 v[32:35], a[164:167], a[128:131], v[32:35]
  ds_read_b64_tr_b16 a[182:183], v2 offset:2048
  v_mfma_f32_16x16x32_bf16 v[32:35], a[168:171], a[144:147], v[32:35]
  v_mfma_f32_16x16x32_bf16 v[36:39], a[168:171], a[148:151], v[36:39]
  ds_read_b64_tr_b16 a[184:185], v2 offset:4096
  s_add_u32 s54, s54, 65536
  v_mfma_f32_16x16x32_bf16 v[36:39], a[164:167], a[132:135], v[36:39]
  buffer_load_dwordx4 a[40:43], v1, s[4:7], s54 offen offset:0 sc1
  v_mfma_f32_16x16x32_bf16 v[40:43], a[164:167], a[136:139], v[40:43]
  ds_read_b64_tr_b16 a[186:187], v2 offset:6144
  v_mfma_f32_16x16x32_bf16 v[40:43], a[168:171], a[152:155], v[40:43]
  v_mfma_f32_16x16x32_bf16 v[44:47], a[168:171], a[156:159], v[44:47]
  ds_read_b64_tr_b16 a[160:161], v2 offset:8192
  v_mfma_f32_16x16x32_bf16 v[44:47], a[164:167], a[140:143], v[44:47]
  s_waitcnt lgkmcnt(5)
  v_mfma_f32_16x16x32_bf16 v[60:63], a[172:175], a[140:143], v[60:63]
  ds_read_b64_tr_b16 a[162:163], v2 offset:10240
  buffer_load_dwordx4 a[56:59], v1, s[4:7], s54 offen offset:1024 sc1
  v_mfma_f32_16x16x32_bf16 v[60:63], a[176:179], a[156:159], v[60:63]
  v_mfma_f32_16x16x32_bf16 v[56:59], a[176:179], a[152:155], v[56:59]
  ds_read_b64_tr_b16 a[164:165], v2 offset:12288
  v_mfma_f32_16x16x32_bf16 v[56:59], a[172:175], a[136:139], v[56:59]
  v_mfma_f32_16x16x32_bf16 v[52:55], a[172:175], a[132:135], v[52:55]
  ds_read_b64_tr_b16 a[166:167], v2 offset:14336
  s_add_u32 s54, s54, 65536
  v_mfma_f32_16x16x32_bf16 v[52:55], a[176:179], a[148:151], v[52:55]
  buffer_load_dwordx4 a[44:47], v1, s[4:7], s54 offen offset:0 sc1
  v_mfma_f32_16x16x32_bf16 v[48:51], a[176:179], a[144:147], v[48:51]
  ds_read_b64_tr_b16 a[168:169], v3 offset:0
  v_mfma_f32_16x16x32_bf16 v[48:51], a[172:175], a[128:131], v[48:51]
  s_waitcnt lgkmcnt(5)
  v_mfma_f32_16x16x32_bf16 v[128:131], a[180:183], a[128:131], v[128:131]
  ds_read_b64_tr_b16 a[170:171], v3 offset:2048
  v_mfma_f32_16x16x32_bf16 v[128:131], a[184:187], a[144:147], v[128:131]
  v_mfma_f32_16x16x32_bf16 v[132:135], a[184:187], a[148:151], v[132:135]
  ds_read_b64_tr_b16 a[172:173], v3 offset:4096
  buffer_load_dwordx4 a[60:63], v1, s[4:7], s54 offen offset:1024 sc1
  v_mfma_f32_16x16x32_bf16 v[132:135], a[180:183], a[132:135], v[132:135]
  v_mfma_f32_16x16x32_bf16 v[136:139], a[180:183], a[136:139], v[136:139]
  ds_read_b64_tr_b16 a[174:175], v3 offset:6144
  v_mfma_f32_16x16x32_bf16 v[136:139], a[184:187], a[152:155], v[136:139]
  v_mfma_f32_16x16x32_bf16 v[140:143], a[184:187], a[156:159], v[140:143]
  ds_read_b64_tr_b16 a[176:177], v3 offset:8192
  s_cmp_eq_u32 s32, 3
  s_cselect_b32 s55, 11, 7
  s_mul_i32 s47, s55, 458752
  s_lshl_b32 s55, s55, 11
  s_add_u32 s55, s55, s33
  s_add_u32 m0, s31, 114688
  v_mfma_f32_16x16x32_bf16 v[140:143], a[180:183], a[140:143], v[140:143]
  buffer_load_dwordx4 v11, s[8:11], s47 offen lds
  s_waitcnt lgkmcnt(5)
  v_mfma_f32_16x16x32_bf16 v[156:159], a[160:163], a[140:143], v[156:159]
  ds_read_b64_tr_b16 a[178:179], v3 offset:10240
  v_mfma_f32_16x16x32_bf16 v[156:159], a[164:167], a[156:159], v[156:159]
  v_mfma_f32_16x16x32_bf16 v[152:155], a[164:167], a[152:155], v[152:155]
  ds_read_b64_tr_b16 a[180:181], v3 offset:12288
  v_mfma_f32_16x16x32_bf16 v[152:155], a[160:163], a[136:139], v[152:155]
  s_add_u32 m0, s31, 122880
  v_mfma_f32_16x16x32_bf16 v[148:151], a[160:163], a[132:135], v[148:151]
  ds_read_b64_tr_b16 a[182:183], v3 offset:14336
  buffer_load_dwordx4 v11, s[12:15], s47 offen lds
  v_mfma_f32_16x16x32_bf16 v[148:151], a[164:167], a[148:151], v[148:151]
  v_mfma_f32_16x16x32_bf16 v[144:147], a[164:167], a[144:147], v[144:147]
  ds_read_b64_tr_b16 a[184:185], v4 offset:0
  v_mfma_f32_16x16x32_bf16 v[144:147], a[160:163], a[128:131], v[144:147]
  s_waitcnt lgkmcnt(5)
  v_mfma_f32_16x16x32_bf16 v[160:163], a[168:171], a[128:131], v[160:163]
  ds_read_b64_tr_b16 a[186:187], v4 offset:2048
  s_add_u32 m0, s31, 118784
  s_add_u32 s37, s47, 229376
  v_mfma_f32_16x16x32_bf16 v[160:163], a[172:175], a[144:147], v[160:163]
  buffer_load_dwordx4 v11, s[8:11], s37 offen lds
  v_mfma_f32_16x16x32_bf16 v[164:167], a[172:175], a[148:151], v[164:167]
  ds_read_b64_tr_b16 a[160:161], v4 offset:4096
  v_mfma_f32_16x16x32_bf16 v[164:167], a[168:171], a[132:135], v[164:167]
  v_mfma_f32_16x16x32_bf16 v[168:171], a[168:171], a[136:139], v[168:171]
  ds_read_b64_tr_b16 a[162:163], v4 offset:6144
  v_mfma_f32_16x16x32_bf16 v[168:171], a[172:175], a[152:155], v[168:171]
  s_add_u32 m0, s31, 126976
  s_add_u32 s37, s47, 229376
  v_mfma_f32_16x16x32_bf16 v[172:175], a[172:175], a[156:159], v[172:175]
  ds_read_b64_tr_b16 a[164:165], v4 offset:8192
  buffer_load_dwordx4 v11, s[12:15], s37 offen lds
  v_mfma_f32_16x16x32_bf16 v[172:175], a[168:171], a[140:143], v[172:175]
  s_waitcnt lgkmcnt(5)
  v_mfma_f32_16x16x32_bf16 v[188:191], a[176:179], a[140:143], v[188:191]
  ds_read_b64_tr_b16 a[166:167], v4 offset:10240
  v_mfma_f32_16x16x32_bf16 v[188:191], a[180:183], a[156:159], v[188:191]
  v_mfma_f32_16x16x32_bf16 v[184:187], a[180:183], a[152:155], v[184:187]
  ds_read_b64_tr_b16 a[168:169], v4 offset:12288
  v_mfma_f32_16x16x32_bf16 v[184:187], a[176:179], a[136:139], v[184:187]
  buffer_load_dwordx4 a[64:67], v1, s[4:7], s55 offen offset:0 sc1
  v_mfma_f32_16x16x32_bf16 v[180:183], a[176:179], a[132:135], v[180:183]
  ds_read_b64_tr_b16 a[170:171], v4 offset:14336
  v_mfma_f32_16x16x32_bf16 v[180:183], a[180:183], a[148:151], v[180:183]
  v_mfma_f32_16x16x32_bf16 v[176:179], a[180:183], a[144:147], v[176:179]
  ds_read_b64_tr_b16 a[172:173], v5 offset:0
  v_mfma_f32_16x16x32_bf16 v[176:179], a[176:179], a[128:131], v[176:179]
  s_waitcnt lgkmcnt(5)
  v_mfma_f32_16x16x32_bf16 v[192:195], a[184:187], a[128:131], v[192:195]
  ds_read_b64_tr_b16 a[174:175], v5 offset:2048
  buffer_load_dwordx4 a[80:83], v1, s[4:7], s55 offen offset:1024 sc1
  v_mfma_f32_16x16x32_bf16 v[192:195], a[160:163], a[144:147], v[192:195]
  v_mfma_f32_16x16x32_bf16 v[196:199], a[160:163], a[148:151], v[196:199]
  ds_read_b64_tr_b16 a[176:177], v5 offset:4096
  v_mfma_f32_16x16x32_bf16 v[196:199], a[184:187], a[132:135], v[196:199]
  v_mfma_f32_16x16x32_bf16 v[200:203], a[184:187], a[136:139], v[200:203]
  ds_read_b64_tr_b16 a[178:179], v5 offset:6144
  s_add_u32 s55, s55, 65536
  v_mfma_f32_16x16x32_bf16 v[200:203], a[160:163], a[152:155], v[200:203]
  buffer_load_dwordx4 a[68:71], v1, s[4:7], s55 offen offset:0 sc1
  v_mfma_f32_16x16x32_bf16 v[204:207], a[160:163], a[156:159], v[204:207]
  ds_read_b64_tr_b16 a[180:181], v5 offset:8192
  v_mfma_f32_16x16x32_bf16 v[204:207], a[184:187], a[140:143], v[204:207]
  s_waitcnt lgkmcnt(5)
  v_mfma_f32_16x16x32_bf16 v[220:223], a[164:167], a[140:143], v[220:223]
  ds_read_b64_tr_b16 a[182:183], v5 offset:10240
  v_mfma_f32_16x16x32_bf16 v[220:223], a[168:171], a[156:159], v[220:223]
  v_mfma_f32_16x16x32_bf16 v[216:219], a[168:171], a[152:155], v[216:219]
  ds_read_b64_tr_b16 a[184:185], v5 offset:12288
  buffer_load_dwordx4 a[84:87], v1, s[4:7], s55 offen offset:1024 sc1
  v_mfma_f32_16x16x32_bf16 v[216:219], a[164:167], a[136:139], v[216:219]
  v_mfma_f32_16x16x32_bf16 v[212:215], a[164:167], a[132:135], v[212:215]
  ds_read_b64_tr_b16 a[186:187], v5 offset:14336
  v_mfma_f32_16x16x32_bf16 v[212:215], a[168:171], a[148:151], v[212:215]
  s_waitcnt vmcnt(32)
  s_barrier
  v_mfma_f32_16x16x32_bf16 v[208:211], a[168:171], a[144:147], v[208:211]
  ds_read_b64_tr_b16 a[160:161], v6 offset:16384
  s_add_u32 m0, s31, 49152
  v_mfma_f32_16x16x32_bf16 v[208:211], a[164:167], a[128:131], v[208:211]
  buffer_load_dwordx4 v10, s[8:11], s47 offen lds
  s_waitcnt lgkmcnt(5)
  v_mfma_f32_16x16x32_bf16 v[224:227], a[172:175], a[128:131], v[224:227]
  ds_read_b64_tr_b16 a[162:163], v6 offset:18432
  ds_read_b128 v[24:27], v12 offset:0
  v_mfma_f32_16x16x32_bf16 v[224:227], a[176:179], a[144:147], v[224:227]
  ds_read_b128 v[28:31], v12 offset:448
  v_mfma_f32_16x16x32_bf16 v[228:231], a[176:179], a[148:151], v[228:231]
  ds_read_b64_tr_b16 a[164:165], v6 offset:20480
  v_mfma_f32_16x16x32_bf16 v[228:231], a[172:175], a[132:135], v[228:231]
  s_add_u32 m0, s31, 57344
  v_mfma_f32_16x16x32_bf16 v[232:235], a[172:175], a[136:139], v[232:235]
  ds_read_b64_tr_b16 a[166:167], v6 offset:22528
  buffer_load_dwordx4 v10, s[12:15], s47 offen lds
  v_mfma_f32_16x16x32_bf16 v[232:235], a[176:179], a[152:155], v[232:235]
  v_mfma_f32_16x16x32_bf16 v[236:239], a[176:179], a[156:159], v[236:239]
  ds_read_b64_tr_b16 a[168:169], v6 offset:24576
  v_mfma_f32_16x16x32_bf16 v[236:239], a[172:175], a[140:143], v[236:239]
  s_waitcnt lgkmcnt(7)
  v_mfma_f32_16x16x32_bf16 v[252:255], a[180:183], a[140:143], v[252:255]
  ds_read_b64_tr_b16 a[170:171], v6 offset:26624
  s_add_u32 m0, s31, 53248
  s_add_u32 s37, s47, 229376
  v_mfma_f32_16x16x32_bf16 v[252:255], a[184:187], a[156:159], v[252:255]
  buffer_load_dwordx4 v10, s[8:11], s37 offen lds
  s_waitcnt lgkmcnt(4)
  v_mfma_f32_16x16x32_bf16 v[248:251], a[184:187], a[152:155], v[248:251]
  ds_read_b64_tr_b16 a[172:173], v6 offset:28672
  v_fmac_f32 v128, v16, v24
  v_mfma_f32_16x16x32_bf16 v[248:251], a[180:183], a[136:139], v[248:251]
  v_fmac_f32 v129, v16, v25
  v_fmac_f32 v130, v16, v26
  v_mfma_f32_16x16x32_bf16 v[244:247], a[180:183], a[132:135], v[244:247]
  ds_read_b64_tr_b16 a[174:175], v6 offset:30720
  v_fmac_f32 v131, v16, v27
  v_mfma_f32_16x16x32_bf16 v[244:247], a[184:187], a[148:151], v[244:247]
  s_add_u32 m0, s31, 61440
  s_add_u32 s37, s47, 229376
  v_mfma_f32_16x16x32_bf16 v[240:243], a[184:187], a[144:147], v[240:243]
  ds_read_b64_tr_b16 a[176:177], v7 offset:16384
  buffer_load_dwordx4 v10, s[12:15], s37 offen lds
  v_mfma_f32_16x16x32_bf16 v[240:243], a[180:183], a[128:131], v[240:243]
  v_fmac_f32 v132, v18, v24
  s_waitcnt vmcnt(28) lgkmcnt(5)
  v_mfma_f32_16x16x32_bf16 v[64:67], a[160:163], a[0:3], v[64:67]
  ds_read_b64_tr_b16 a[178:179], v7 offset:18432
  v_fmac_f32 v133, v18, v25
  v_mfma_f32_16x16x32_bf16 v[64:67], a[164:167], a[16:19], v[64:67]
  v_fmac_f32 v134, v18, v26
  v_fmac_f32 v135, v18, v27
  v_mfma_f32_16x16x32_bf16 v[68:71], a[164:167], a[20:23], v[68:71]
  ds_read_b64_tr_b16 a[180:181], v7 offset:20480
  s_add_u32 s55, s55, 65536
  v_mfma_f32_16x16x32_bf16 v[68:71], a[160:163], a[4:7], v[68:71]
  buffer_load_dwordx4 a[72:75], v1, s[4:7], s55 offen offset:0 sc1
  v_fmac_f32 v136, v20, v24
  v_mfma_f32_16x16x32_bf16 v[72:75], a[160:163], a[8:11], v[72:75]
  ds_read_b64_tr_b16 a[182:183], v7 offset:22528
  v_fmac_f32 v137, v20, v25
  v_mfma_f32_16x16x32_bf16 v[72:75], a[164:167], a[24:27], v[72:75]
  v_fmac_f32 v138, v20, v26
  v_fmac_f32 v139, v20, v27
  v_mfma_f32_16x16x32_bf16 v[76:79], a[164:167], a[28:31], v[76:79]
  ds_read_b64_tr_b16 a[184:185], v7 offset:24576
  v_fmac_f32 v140, v22, v24
  v_mfma_f32_16x16x32_bf16 v[76:79], a[160:163], a[12:15], v[76:79]
  v_fmac_f32 v141, v22, v25
  s_waitcnt lgkmcnt(5)
  v_mfma_f32_16x16x32_bf16 v[92:95], a[168:171], a[12:15], v[92:95]
  ds_read_b64_tr_b16 a[186:187], v7 offset:26624
  buffer_load_dwordx4 a[88:91], v1, s[4:7], s55 offen offset:1024 sc1
  v_mfma_f32_16x16x32_bf16 v[92:95], a[172:175], a[28:31], v[92:95]
  v_fmac_f32 v142, v22, v26
  v_fmac_f32 v143, v22, v27
  v_mfma_f32_16x16x32_bf16 v[88:91], a[172:175], a[24:27], v[88:91]
  ds_read_b64_tr_b16 a[160:161], v7 offset:28672
  v_fmac_f32 v128, v17, v28
  v_mfma_f32_16x16x32_bf16 v[88:91], a[168:171], a[8:11], v[88:91]
  v_fmac_f32 v129, v17, v29
  v_fmac_f32 v130, v17, v30
  v_mfma_f32_16x16x32_bf16 v[84:87], a[168:171], a[4:7], v[84:87]
  ds_read_b64_tr_b16 a[162:163], v7 offset:30720
  s_add_u32 s55, s55, 65536
  v_mfma_f32_16x16x32_bf16 v[84:87], a[172:175], a[20:23], v[84:87]
  buffer_load_dwordx4 a[76:79], v1, s[4:7], s55 offen offset:0 sc1
  v_fmac_f32 v131, v17, v31
  v_mfma_f32_16x16x32_bf16 v[80:83], a[172:175], a[16:19], v[80:83]
  ds_read_b64_tr_b16 a[164:165], v8 offset:16384
  v_fmac_f32 v132, v19, v28
  v_mfma_f32_16x16x32_bf16 v[80:83], a[168:171], a[0:3], v[80:83]
  v_fmac_f32 v133, v19, v29
  s_waitcnt lgkmcnt(5)
  v_mfma_f32_16x16x32_bf16 v[96:99], a[176:179], a[0:3], v[96:99]
  ds_read_b64_tr_b16 a[166:167], v8 offset:18432
  v_fmac_f32 v134, v19, v30
  v_mfma_f32_16x16x32_bf16 v[96:99], a[180:183], a[16:19], v[96:99]
  v_fmac_f32 v135, v19, v31
  v_fmac_f32 v136, v21, v28
  v_mfma_f32_16x16x32_bf16 v[100:103], a[180:183], a[20:23], v[100:103]
  ds_read_b64_tr_b16 a[168:169], v8 offset:20480
  buffer_load_dwordx4 a[92:95], v1, s[4:7], s55 offen offset:1024 sc1
  v_mfma_f32_16x16x32_bf16 v[100:103], a[176:179], a[4:7], v[100:103]
  v_fmac_f32 v137, v21, v29
  v_fmac_f32 v138, v21, v30
  v_mfma_f32_16x16x32_bf16 v[104:107], a[176:179], a[8:11], v[104:107]
  ds_read_b64_tr_b16 a[170:171], v8 offset:22528
  v_fmac_f32 v139, v21, v31
  v_mfma_f32_16x16x32_bf16 v[104:107], a[180:183], a[24:27], v[104:107]
  v_fmac_f32 v140, v23, v28
  v_fmac_f32 v141, v23, v29
  v_mfma_f32_16x16x32_bf16 v[108:111], a[180:183], a[28:31], v[108:111]
  ds_read_b64_tr_b16 a[172:173], v8 offset:24576
  s_cmp_eq_u32 s32, 0
  s_cselect_b32 s48, 12, 8
  s_mul_i32 s40, s48, 458752
  s_lshl_b32 s48, s48, 11
  s_add_u32 s48, s48, s33
  s_add_u32 m0, s31, 65536
  v_mfma_f32_16x16x32_bf16 v[108:111], a[176:179], a[12:15], v[108:111]
  buffer_load_dwordx4 v11, s[8:11], s40 offen lds
  s_waitcnt lgkmcnt(5)
  v_mfma_f32_16x16x32_bf16 v[124:127], a[184:187], a[12:15], v[124:127]
  ds_read_b64_tr_b16 a[174:175], v8 offset:26624
  v_fmac_f32 v142, v23, v30
  v_mfma_f32_16x16x32_bf16 v[124:127], a[160:163], a[28:31], v[124:127]
  v_fmac_f32 v143, v23, v31
  v_mfma_f32_16x16x32_bf16 v[120:123], a[160:163], a[24:27], v[120:123]
  ds_read_b64_tr_b16 a[176:177], v8 offset:28672
  ds_read_b128 v[24:27], v12 offset:128
  v_mfma_f32_16x16x32_bf16 v[120:123], a[184:187], a[8:11], v[120:123]
  s_add_u32 m0, s31, 73728
  ds_read_b128 v[28:31], v12 offset:576
  v_mfma_f32_16x16x32_bf16 v[116:119], a[184:187], a[4:7], v[116:119]
  ds_read_b64_tr_b16 a[178:179], v8 offset:30720
  buffer_load_dwordx4 v11, s[12:15], s40 offen lds
  v_mfma_f32_16x16x32_bf16 v[116:119], a[160:163], a[20:23], v[116:119]
  v_mfma_f32_16x16x32_bf16 v[112:115], a[160:163], a[16:19], v[112:115]
  ds_read_b64_tr_b16 a[180:181], v2 offset:16384
  v_mfma_f32_16x16x32_bf16 v[112:115], a[184:187], a[0:3], v[112:115]
  s_waitcnt lgkmcnt(7)
  v_mfma_f32_16x16x32_bf16 v[32:35], a[164:167], a[0:3], v[32:35]
  ds_read_b64_tr_b16 a[182:183], v2 offset:18432
  s_add_u32 m0, s31, 69632
  s_add_u32 s37, s40, 229376
  v_mfma_f32_16x16x32_bf16 v[32:35], a[168:171], a[16:19], v[32:35]
  buffer_load_dwordx4 v11, s[8:11], s37 offen lds
  v_mfma_f32_16x16x32_bf16 v[36:39], a[168:171], a[20:23], v[36:39]
  ds_read_b64_tr_b16 a[184:185], v2 offset:20480
  s_waitcnt lgkmcnt(4)
  v_mfma_f32_16x16x32_bf16 v[36:39], a[164:167], a[4:7], v[36:39]
  v_fmac_f32 v192, v16, v24
  v_fmac_f32 v193, v16, v25
  v_mfma_f32_16x16x32_bf16 v[40:43], a[164:167], a[8:11], v[40:43]
  ds_read_b64_tr_b16 a[186:187], v2 offset:22528
  v_fmac_f32 v194, v16, v26
  v_mfma_f32_16x16x32_bf16 v[40:43], a[168:171], a[24:27], v[40:43]
  s_add_u32 m0, s31, 77824
  s_add_u32 s37, s40, 229376
  v_mfma_f32_16x16x32_bf16 v[44:47], a[168:171], a[28:31], v[44:47]
  ds_read_b64_tr_b16 a[160:161], v2 offset:24576
  buffer_load_dwordx4 v11, s[12:15], s37 offen lds
  v_mfma_f32_16x16x32_bf16 v[44:47], a[164:167], a[12:15], v[44:47]
  v_fmac_f32 v195, v16, v27
  s_waitcnt lgkmcnt(5)
  v_mfma_f32_16x16x32_bf16 v[60:63], a[172:175], a[12:15], v[60:63]
  ds_read_b64_tr_b16 a[162:163], v2 offset:26624
  v_fmac_f32 v196, v18, v24
  v_mfma_f32_16x16x32_bf16 v[60:63], a[176:179], a[28:31], v[60:63]
  v_fmac_f32 v197, v18, v25
  v_fmac_f32 v198, v18, v26
  v_mfma_f32_16x16x32_bf16 v[56:59], a[176:179], a[24:27], v[56:59]
  ds_read_b64_tr_b16 a[164:165], v2 offset:28672
  v_mfma_f32_16x16x32_bf16 v[56:59], a[172:175], a[8:11], v[56:59]
  buffer_load_dwordx4 a[96:99], v1, s[4:7], s48 offen offset:0 sc1
  v_fmac_f32 v199, v18, v27
  v_mfma_f32_16x16x32_bf16 v[52:55], a[172:175], a[4:7], v[52:55]
  ds_read_b64_tr_b16 a[166:167], v2 offset:30720
  v_fmac_f32 v200, v20, v24
  v_mfma_f32_16x16x32_bf16 v[52:55], a[176:179], a[20:23], v[52:55]
  v_fmac_f32 v201, v20, v25
  v_fmac_f32 v202, v20, v26
  v_mfma_f32_16x16x32_bf16 v[48:51], a[176:179], a[16:19], v[48:51]
  ds_read_b64_tr_b16 a[168:169], v3 offset:16384
  v_fmac_f32 v203, v20, v27
  v_mfma_f32_16x16x32_bf16 v[48:51], a[172:175], a[0:3], v[48:51]
  v_fmac_f32 v204, v22, v24
  s_waitcnt lgkmcnt(5)
  v_mfma_f32_16x16x32_bf16 v[128:131], a[180:183], a[0:3], v[128:131]
  ds_read_b64_tr_b16 a[170:171], v3 offset:18432
HOP8:
  s_cbranch_execz HOP12
  buffer_load_dwordx4 a[112:115], v1, s[4:7], s48 offen offset:1024 sc1
  v_mfma_f32_16x16x32_bf16 v[128:131], a[184:187], a[16:19], v[128:131]
  v_fmac_f32 v205, v22, v25
  v_fmac_f32 v206, v22, v26
  v_mfma_f32_16x16x32_bf16 v[132:135], a[184:187], a[20:23], v[132:135]
  ds_read_b64_tr_b16 a[172:173], v3 offset:20480
  v_fmac_f32 v207, v22, v27
  v_mfma_f32_16x16x32_bf16 v[132:135], a[180:183], a[4:7], v[132:135]
  v_fmac_f32 v192, v17, v28
  v_fmac_f32 v193, v17, v29
  v_mfma_f32_16x16x32_bf16 v[136:139], a[180:183], a[8:11], v[136:139]
  ds_read_b64_tr_b16 a[174:175], v3 offset:22528
  s_add_u32 s48, s48, 65536
  v_mfma_f32_16x16x32_bf16 v[136:139], a[184:187], a[24:27], v[136:139]
  buffer_load_dwordx4 a[100:103], v1, s[4:7], s48 offen offset:0 sc1
  v_fmac_f32 v194, v17, v30
  v_mfma_f32_16x16x32_bf16 v[140:143], a[184:187], a[28:31], v[140:143]
  ds_read_b64_tr_b16 a[176:177], v3 offset:24576
  v_fmac_f32 v195, v17, v31
  v_mfma_f32_16x16x32_bf16 v[140:143], a[180:183], a[12:15], v[140:143]
  v_fmac_f32 v196, v19, v28
  s_waitcnt lgkmcnt(5)
  v_mfma_f32_16x16x32_bf16 v[156:159], a[160:163], a[12:15], v[156:159]
  ds_read_b64_tr_b16 a[178:179], v3 offset:26624
  v_fmac_f32 v197, v19, v29
  v_mfma_f32_16x16x32_bf16 v[156:159], a[164:167], a[28:31], v[156:159]
  v_fmac_f32 v198, v19, v30
  v_fmac_f32 v199, v19, v31
  v_mfma_f32_16x16x32_bf16 v[152:155], a[164:167], a[24:27], v[152:155]
  ds_read_b64_tr_b16 a[180:181], v3 offset:28672
  buffer_load_dwordx4 a[116:119], v1, s[4:7], s48 offen offset:1024 sc1
  v_mfma_f32_16x16x32_bf16 v[152:155], a[160:163], a[8:11], v[152:155]
  v_fmac_f32 v200, v21, v28
  v_fmac_f32 v201, v21, v29
  v_mfma_f32_16x16x32_bf16 v[148:151], a[160:163], a[4:7], v[148:151]
  ds_read_b64_tr_b16 a[182:183], v3 offset:30720
  v_fmac_f32 v202, v21, v30
  v_mfma_f32_16x16x32_bf16 v[148:151], a[164:167], a[20:23], v[148:151]
  v_fmac_f32 v203, v21, v31
  v_fmac_f32 v204, v23, v28
  v_mfma_f32_16x16x32_bf16 v[144:147], a[164:167], a[16:19], v[144:147]
  ds_read_b64_tr_b16 a[184:185], v4 offset:16384
  s_add_u32 s48, s48, 65536
  v_mfma_f32_16x16x32_bf16 v[144:147], a[160:163], a[0:3], v[144:147]
  buffer_load_dwordx4 a[104:107], v1, s[4:7], s48 offen offset:0 sc1
  s_waitcnt lgkmcnt(5)
  v_mfma_f32_16x16x32_bf16 v[160:163], a[168:171], a[0:3], v[160:163]
  ds_read_b64_tr_b16 a[186:187], v4 offset:18432
  v_fmac_f32 v205, v23, v29
  v_mfma_f32_16x16x32_bf16 v[160:163], a[172:175], a[16:19], v[160:163]
  v_fmac_f32 v206, v23, v30
  v_fmac_f32 v207, v23, v31
  v_mfma_f32_16x16x32_bf16 v[164:167], a[172:175], a[20:23], v[164:167]
  ds_read_b64_tr_b16 a[160:161], v4 offset:20480
  ds_read_b128 v[24:27], v12 offset:896
  v_mfma_f32_16x16x32_bf16 v[164:167], a[168:171], a[4:7], v[164:167]
  ds_read_b128 v[28:31], v12 offset:1344
  v_mfma_f32_16x16x32_bf16 v[168:171], a[168:171], a[8:11], v[168:171]
  ds_read_b64_tr_b16 a[162:163], v4 offset:22528
  buffer_load_dwordx4 a[120:123], v1, s[4:7], s48 offen offset:1024 sc1
  v_mfma_f32_16x16x32_bf16 v[168:171], a[172:175], a[24:27], v[168:171]
  v_mfma_f32_16x16x32_bf16 v[172:175], a[172:175], a[28:31], v[172:175]
  ds_read_b64_tr_b16 a[164:165], v4 offset:24576
  v_mfma_f32_16x16x32_bf16 v[172:175], a[168:171], a[12:15], v[172:175]
  s_waitcnt lgkmcnt(7)
  v_mfma_f32_16x16x32_bf16 v[188:191], a[176:179], a[12:15], v[188:191]
  ds_read_b64_tr_b16 a[166:167], v4 offset:26624
  s_add_u32 s48, s48, 65536
  v_mfma_f32_16x16x32_bf16 v[188:191], a[180:183], a[28:31], v[188:191]
  buffer_load_dwordx4 a[108:111], v1, s[4:7], s48 offen offset:0 sc1
  v_mfma_f32_16x16x32_bf16 v[184:187], a[180:183], a[24:27], v[184:187]
  ds_read_b64_tr_b16 a[168:169], v4 offset:28672
  s_waitcnt lgkmcnt(4)
  v_mfma_f32_16x16x32_bf16 v[184:187], a[176:179], a[8:11], v[184:187]
  v_fmac_f32 v144, v16, v24
  v_fmac_f32 v145, v16, v25
  v_mfma_f32_16x16x32_bf16 v[180:183], a[176:179], a[4:7], v[180:183]
  ds_read_b64_tr_b16 a[170:171], v4 offset:30720
  v_fmac_f32 v146, v16, v26
  v_mfma_f32_16x16x32_bf16 v[180:183], a[180:183], a[20:23], v[180:183]
  v_fmac_f32 v147, v16, v27
  v_fmac_f32 v148, v18, v24
  v_mfma_f32_16x16x32_bf16 v[176:179], a[180:183], a[16:19], v[176:179]
  ds_read_b64_tr_b16 a[172:173], v5 offset:16384
  buffer_load_dwordx4 a[124:127], v1, s[4:7], s48 offen offset:1024 sc1
  v_mfma_f32_16x16x32_bf16 v[176:179], a[176:179], a[0:3], v[176:179]
  v_fmac_f32 v149, v18, v25
  s_waitcnt lgkmcnt(5)
  v_mfma_f32_16x16x32_bf16 v[192:195], a[184:187], a[0:3], v[192:195]
  ds_read_b64_tr_b16 a[174:175], v5 offset:18432
  v_fmac_f32 v150, v18, v26
  v_mfma_f32_16x16x32_bf16 v[192:195], a[160:163], a[16:19], v[192:195]
  v_fmac_f32 v151, v18, v27
  v_fmac_f32 v152, v20, v24
  v_mfma_f32_16x16x32_bf16 v[196:199], a[160:163], a[20:23], v[196:199]
  ds_read_b64_tr_b16 a[176:177], v5 offset:20480
  s_cmp_eq_u32 s32, 1
  s_cselect_b32 s49, 13, 9
  s_mul_i32 s41, s49, 458752
  s_lshl_b32 s49, s49, 11
  s_add_u32 s49, s49, s33
  v_mfma_f32_16x16x32_bf16 v[196:199], a[184:187], a[4:7], v[196:199]
  buffer_load_dwordx4 a[128:131], v1, s[4:7], s49 offen offset:0 sc1
  v_fmac_f32 v153, v20, v25
  v_mfma_f32_16x16x32_bf16 v[200:203], a[184:187], a[8:11], v[200:203]
  ds_read_b64_tr_b16 a[178:179], v5 offset:22528
  v_fmac_f32 v154, v20, v26
  v_mfma_f32_16x16x32_bf16 v[200:203], a[160:163], a[24:27], v[200:203]
  v_fmac_f32 v155, v20, v27
  v_fmac_f32 v156, v22, v24
  v_mfma_f32_16x16x32_bf16 v[204:207], a[160:163], a[28:31], v[204:207]
  ds_read_b64_tr_b16 a[180:181], v5 offset:24576
  v_fmac_f32 v157, v22, v25
  v_mfma_f32_16x16x32_bf16 v[204:207], a[184:187], a[12:15], v[204:207]
  v_fmac_f32 v158, v22, v26
  s_waitcnt lgkmcnt(5)
  v_mfma_f32_16x16x32_bf16 v[220:223], a[164:167], a[12:15], v[220:223]
  ds_read_b64_tr_b16 a[182:183], v5 offset:26624
  buffer_load_dwordx4 a[144:147], v1, s[4:7], s49 offen offset:1024 sc1
  v_mfma_f32_16x16x32_bf16 v[220:223], a[168:171], a[28:31], v[220:223]
  v_fmac_f32 v159, v22, v27
  v_fmac_f32 v144, v17, v28
  v_mfma_f32_16x16x32_bf16 v[216:219], a[168:171], a[24:27], v[216:219]
  ds_read_b64_tr_b16 a[184:185], v5 offset:28672
  v_fmac_f32 v145, v17, v29
  v_mfma_f32_16x16x32_bf16 v[216:219], a[164:167], a[8:11], v[216:219]
  v_fmac_f32 v146, v17, v30
  v_fmac_f32 v147, v17, v31
  v_mfma_f32_16x16x32_bf16 v[212:215], a[164:167], a[4:7], v[212:215]
  ds_read_b64_tr_b16 a[186:187], v5 offset:30720
  s_add_u32 s49, s49, 65536
  v_mfma_f32_16x16x32_bf16 v[212:215], a[168:171], a[20:23], v[212:215]
  buffer_load_dwordx4 a[132:135], v1, s[4:7], s49 offen offset:0 sc1
  s_waitcnt vmcnt(39)
  s_barrier
  v_mfma_f32_16x16x32_bf16 v[208:211], a[168:171], a[16:19], v[208:211]
  ds_read_b64_tr_b16 a[160:161], v6 offset:32768
  v_fmac_f32 v148, v19, v28
  v_mfma_f32_16x16x32_bf16 v[208:211], a[164:167], a[0:3], v[208:211]
  v_fmac_f32 v149, v19, v29
  s_waitcnt lgkmcnt(5)
  v_mfma_f32_16x16x32_bf16 v[224:227], a[172:175], a[0:3], v[224:227]
  ds_read_b64_tr_b16 a[162:163], v6 offset:34816
  v_fmac_f32 v150, v19, v30
  v_mfma_f32_16x16x32_bf16 v[224:227], a[176:179], a[16:19], v[224:227]
  s_add_u32 m0, s31, 0
  v_fmac_f32 v151, v19, v31
  v_mfma_f32_16x16x32_bf16 v[228:231], a[176:179], a[20:23], v[228:231]
  ds_read_b64_tr_b16 a[164:165], v6 offset:36864
  buffer_load_dwordx4 v10, s[8:11], s40 offen lds
  v_mfma_f32_16x16x32_bf16 v[228:231], a[172:175], a[4:7], v[228:231]
  v_fmac_f32 v152, v21, v28
  v_fmac_f32 v153, v21, v29
  v_mfma_f32_16x16x32_bf16 v[232:235], a[172:175], a[8:11], v[232:235]
  ds_read_b64_tr_b16 a[166:167], v6 offset:38912
  v_fmac_f32 v154, v21, v30
  v_mfma_f32_16x16x32_bf16 v[232:235], a[176:179], a[24:27], v[232:235]
  v_fmac_f32 v155, v21, v31
  v_fmac_f32 v156, v23, v28
  v_mfma_f32_16x16x32_bf16 v[236:239], a[176:179], a[28:31], v[236:239]
  ds_read_b64_tr_b16 a[168:169], v6 offset:40960
  s_add_u32 m0, s31, 8192
  v_mfma_f32_16x16x32_bf16 v[236:239], a[172:175], a[12:15], v[236:239]
  buffer_load_dwordx4 v10, s[12:15], s40 offen lds
  s_waitcnt lgkmcnt(5)
  v_mfma_f32_16x16x32_bf16 v[252:255], a[180:183], a[12:15], v[252:255]
  ds_read_b64_tr_b16 a[170:171], v6 offset:43008
  v_fmac_f32 v157, v23, v29
  v_mfma_f32_16x16x32_bf16 v[252:255], a[184:187], a[28:31], v[252:255]
  v_fmac_f32 v158, v23, v30
  v_fmac_f32 v159, v23, v31
  v_mfma_f32_16x16x32_bf16 v[248:251], a[184:187], a[24:27], v[248:251]
  ds_read_b64_tr_b16 a[172:173], v6 offset:45056
  ds_read_b128 v[24:27], v12 offset:64
  v_mfma_f32_16x16x32_bf16 v[248:251], a[180:183], a[8:11], v[248:251]
  s_add_u32 m0, s31, 4096
  s_add_u32 s37, s40, 229376
  v_mfma_f32_16x16x32_bf16 v[244:247], a[180:183], a[4:7], v[244:247]
  ds_read_b64_tr_b16 a[174:175], v6 offset:47104
  buffer_load_dwordx4 v10, s[8:11], s37 offen lds
  v_mfma_f32_16x16x32_bf16 v[244:247], a[184:187], a[20:23], v[244:247]
  ds_read_b128 v[28:31], v12 offset:512
  v_mfma_f32_16x16x32_bf16 v[240:243], a[184:187], a[16:19], v[240:243]
  ds_read_b64_tr_b16 a[176:177], v7 offset:32768
  v_mfma_f32_16x16x32_bf16 v[240:243], a[180:183], a[0:3], v[240:243]
  s_waitcnt vmcnt(34) lgkmcnt(7)
  v_mfma_f32_16x16x32_bf16 v[64:67], a[160:163], a[32:35], v[64:67]
  ds_read_b64_tr_b16 a[178:179], v7 offset:34816
  s_add_u32 m0, s31, 12288
  s_add_u32 s37, s40, 229376
  v_mfma_f32_16x16x32_bf16 v[64:67], a[164:167], a[48:51], v[64:67]
  buffer_load_dwordx4 v10, s[12:15], s37 offen lds
  v_mfma_f32_16x16x32_bf16 v[68:71], a[164:167], a[52:55], v[68:71]
  ds_read_b64_tr_b16 a[180:181], v7 offset:36864
  v_mfma_f32_16x16x32_bf16 v[68:71], a[160:163], a[36:39], v[68:71]
  v_mfma_f32_16x16x32_bf16 v[72:75], a[160:163], a[40:43], v[72:75]
  ds_read_b64_tr_b16 a[182:183], v7 offset:38912
  s_waitcnt lgkmcnt(4)
  v_mfma_f32_16x16x32_bf16 v[72:75], a[164:167], a[56:59], v[72:75]
  s_add_u32 m0, s31, 81920
  v_fmac_f32 v160, v16, v24
  v_mfma_f32_16x16x32_bf16 v[76:79], a[164:167], a[60:63], v[76:79]
  ds_read_b64_tr_b16 a[184:185], v7 offset:40960
  buffer_load_dwordx4 v11, s[8:11], s41 offen lds
  v_mfma_f32_16x16x32_bf16 v[76:79], a[160:163], a[44:47], v[76:79]
  v_fmac_f32 v161, v16, v25
  s_waitcnt lgkmcnt(6)
  v_mfma_f32_16x16x32_bf16 v[92:95], a[168:171], a[44:47], v[92:95]
  ds_read_b64_tr_b16 a[186:187], v7 offset:43008
  v_fmac_f32 v162, v16, v26
  v_mfma_f32_16x16x32_bf16 v[92:95], a[172:175], a[60:63], v[92:95]
  v_fmac_f32 v163, v16, v27
  v_fmac_f32 v164, v18, v24
  v_mfma_f32_16x16x32_bf16 v[88:91], a[172:175], a[56:59], v[88:91]
  ds_read_b64_tr_b16 a[160:161], v7 offset:45056
  s_add_u32 m0, s31, 90112
  v_mfma_f32_16x16x32_bf16 v[88:91], a[168:171], a[40:43], v[88:91]
  buffer_load_dwordx4 v11, s[12:15], s41 offen lds
  v_fmac_f32 v165, v18, v25
  v_mfma_f32_16x16x32_bf16 v[84:87], a[168:171], a[36:39], v[84:87]
  ds_read_b64_tr_b16 a[162:163], v7 offset:47104
  v_fmac_f32 v166, v18, v26
  v_mfma_f32_16x16x32_bf16 v[84:87], a[172:175], a[52:55], v[84:87]
  v_fmac_f32 v167, v18, v27
  v_fmac_f32 v168, v20, v24
  v_mfma_f32_16x16x32_bf16 v[80:83], a[172:175], a[48:51], v[80:83]
  ds_read_b64_tr_b16 a[164:165], v8 offset:32768
  v_fmac_f32 v169, v20, v25
  v_mfma_f32_16x16x32_bf16 v[80:83], a[168:171], a[32:35], v[80:83]
  s_add_u32 m0, s31, 86016
  s_add_u32 s37, s41, 229376
  s_waitcnt lgkmcnt(5)
  v_mfma_f32_16x16x32_bf16 v[96:99], a[176:179], a[32:35], v[96:99]
  ds_read_b64_tr_b16 a[166:167], v8 offset:34816
  buffer_load_dwordx4 v11, s[8:11], s37 offen lds
  v_mfma_f32_16x16x32_bf16 v[96:99], a[180:183], a[48:51], v[96:99]
  v_fmac_f32 v170, v20, v26
  v_fmac_f32 v171, v20, v27
  v_mfma_f32_16x16x32_bf16 v[100:103], a[180:183], a[52:55], v[100:103]
  ds_read_b64_tr_b16 a[168:169], v8 offset:36864
  v_fmac_f32 v172, v22, v24
  v_mfma_f32_16x16x32_bf16 v[100:103], a[176:179], a[36:39], v[100:103]
  v_fmac_f32 v173, v22, v25
  v_fmac_f32 v174, v22, v26
  v_mfma_f32_16x16x32_bf16 v[104:107], a[176:179], a[40:43], v[104:107]
  ds_read_b64_tr_b16 a[170:171], v8 offset:38912
  s_add_u32 m0, s31, 94208
  s_add_u32 s37, s41, 229376
  v_mfma_f32_16x16x32_bf16 v[104:107], a[180:183], a[56:59], v[104:107]
  buffer_load_dwordx4 v11, s[12:15], s37 offen lds
  v_fmac_f32 v175, v22, v27
  v_mfma_f32_16x16x32_bf16 v[108:111], a[180:183], a[60:63], v[108:111]
  ds_read_b64_tr_b16 a[172:173], v8 offset:40960
  v_fmac_f32 v160, v17, v28
  v_mfma_f32_16x16x32_bf16 v[108:111], a[176:179], a[44:47], v[108:111]
  v_fmac_f32 v161, v17, v29
  s_waitcnt lgkmcnt(5)
  v_mfma_f32_16x16x32_bf16 v[124:127], a[184:187], a[44:47], v[124:127]
  ds_read_b64_tr_b16 a[174:175], v8 offset:43008
  v_fmac_f32 v162, v17, v30
  v_mfma_f32_16x16x32_bf16 v[124:127], a[160:163], a[60:63], v[124:127]
  v_fmac_f32 v163, v17, v31
  v_fmac_f32 v164, v19, v28
  v_mfma_f32_16x16x32_bf16 v[120:123], a[160:163], a[56:59], v[120:123]
  ds_read_b64_tr_b16 a[176:177], v8 offset:45056
  buffer_load_dwordx4 a[148:151], v1, s[4:7], s49 offen offset:1024 sc1
  v_mfma_f32_16x16x32_bf16 v[120:123], a[184:187], a[40:43], v[120:123]
  v_fmac_f32 v165, v19, v29
  v_fmac_f32 v166, v19, v30
  v_mfma_f32_16x16x32_bf16 v[116:119], a[184:187], a[36:39], v[116:119]
  ds_read_b64_tr_b16 a[178:179], v8 offset:47104
  v_fmac_f32 v167, v19, v31
  v_mfma_f32_16x16x32_bf16 v[116:119], a[160:163], a[52:55], v[116:119]
  v_fmac_f32 v168, v21, v28
  v_fmac_f32 v169, v21, v29
  v_mfma_f32_16x16x32_bf16 v[112:115], a[160:163], a[48:51], v[112:115]
  ds_read_b64_tr_b16 a[180:181], v2 offset:32768
  s_add_u32 s49, s49, 65536
  v_mfma_f32_16x16x32_bf16 v[112:115], a[184:187], a[32:35], v[112:115]
  buffer_load_dwordx4 a[136:139], v1, s[4:7], s49 offen offset:0 sc1
  s_waitcnt lgkmcnt(5)
  v_mfma_f32_16x16x32_bf16 v[32:35], a[164:167], a[32:35], v[32:35]
  ds_read_b64_tr_b16 a[182:183], v2 offset:34816
  v_fmac_f32 v170, v21, v30
  v_mfma_f32_16x16x32_bf16 v[32:35], a[168:171], a[48:51], v[32:35]
  v_fmac_f32 v171, v21, v31
  v_fmac_f32 v172, v23, v28
  v_mfma_f32_16x16x32_bf16 v[36:39], a[168:171], a[52:55], v[36:39]
  ds_read_b64_tr_b16 a[184:185], v2 offset:36864
  v_fmac_f32 v173, v23, v29
  v_mfma_f32_16x16x32_bf16 v[36:39], a[164:167], a[36:39], v[36:39]
  v_fmac_f32 v174, v23, v30
  v_fmac_f32 v175, v23, v31
  v_mfma_f32_16x16x32_bf16 v[40:43], a[164:167], a[40:43], v[40:43]
  ds_read_b64_tr_b16 a[186:187], v2 offset:38912
  buffer_load_dwordx4 a[152:155], v1, s[4:7], s49 offen offset:1024 sc1
  v_mfma_f32_16x16x32_bf16 v[40:43], a[168:171], a[56:59], v[40:43]
  ds_read_b128 v[24:27], v12 offset:1024
  ds_read_b128 v[28:31], v12 offset:1472
  v_mfma_f32_16x16x32_bf16 v[44:47], a[168:171], a[60:63], v[44:47]
  ds_read_b64_tr_b16 a[160:161], v2 offset:40960
  v_mfma_f32_16x16x32_bf16 v[44:47], a[164:167], a[44:47], v[44:47]
  s_waitcnt lgkmcnt(7)
  v_mfma_f32_16x16x32_bf16 v[60:63], a[172:175], a[44:47], v[60:63]
  ds_read_b64_tr_b16 a[162:163], v2 offset:43008
  s_add_u32 s49, s49, 65536
  v_mfma_f32_16x16x32_bf16 v[60:63], a[176:179], a[60:63], v[60:63]
  buffer_load_dwordx4 a[140:143], v1, s[4:7], s49 offen offset:0 sc1
  v_mfma_f32_16x16x32_bf16 v[56:59], a[176:179], a[56:59], v[56:59]
  ds_read_b64_tr_b16 a[164:165], v2 offset:45056
  v_mfma_f32_16x16x32_bf16 v[56:59], a[172:175], a[40:43], v[56:59]
  v_mfma_f32_16x16x32_bf16 v[52:55], a[172:175], a[36:39], v[52:55]
  ds_read_b64_tr_b16 a[166:167], v2 offset:47104
  s_waitcnt lgkmcnt(4)
  v_mfma_f32_16x16x32_bf16 v[52:55], a[176:179], a[52:55], v[52:55]
  v_fmac_f32 v208, v16, v24
  v_fmac_f32 v209, v16, v25
  v_mfma_f32_16x16x32_bf16 v[48:51], a[176:179], a[48:51], v[48:51]
  ds_read_b64_tr_b16 a[168:169], v3 offset:32768
  buffer_load_dwordx4 a[156:159], v1, s[4:7], s49 offen offset:1024 sc1
  v_mfma_f32_16x16x32_bf16 v[48:51], a[172:175], a[32:35], v[48:51]
  v_fmac_f32 v210, v16, v26
  s_waitcnt lgkmcnt(7)
  v_mfma_f32_16x16x32_bf16 v[128:131], a[180:183], a[32:35], v[128:131]
  ds_read_b64_tr_b16 a[170:171], v3 offset:34816
  v_fmac_f32 v211, v16, v27
  v_mfma_f32_16x16x32_bf16 v[128:131], a[184:187], a[48:51], v[128:131]
  v_fmac_f32 v212, v18, v24
  v_fmac_f32 v213, v18, v25
  v_mfma_f32_16x16x32_bf16 v[132:135], a[184:187], a[52:55], v[132:135]
  ds_read_b64_tr_b16 a[172:173], v3 offset:36864
  s_cmp_eq_u32 s32, 2
  s_cselect_b32 s50, 14, 10
  s_mul_i32 s42, s50, 458752
  s_lshl_b32 s50, s50, 11
  s_add_u32 s50, s50, s33
  v_mfma_f32_16x16x32_bf16 v[132:135], a[180:183], a[36:39], v[132:135]
  buffer_load_dwordx4 a[0:3], v1, s[4:7], s50 offen offset:0 sc1
  v_fmac_f32 v214, v18, v26
  v_mfma_f32_16x16x32_bf16 v[136:139], a[180:183], a[40:43], v[136:139]
  ds_read_b64_tr_b16 a[174:175], v3 offset:38912
  v_fmac_f32 v215, v18, v27
  v_mfma_f32_16x16x32_bf16 v[136:139], a[184:187], a[56:59], v[136:139]
  v_fmac_f32 v216, v20, v24
  v_fmac_f32 v217, v20, v25
  v_mfma_f32_16x16x32_bf16 v[140:143], a[184:187], a[60:63], v[140:143]
  ds_read_b64_tr_b16 a[176:177], v3 offset:40960
  v_fmac_f32 v218, v20, v26
  v_mfma_f32_16x16x32_bf16 v[140:143], a[180:183], a[44:47], v[140:143]
  v_fmac_f32 v219, v20, v27
  s_waitcnt lgkmcnt(5)
  v_mfma_f32_16x16x32_bf16 v[156:159], a[160:163], a[44:47], v[156:159]
  ds_read_b64_tr_b16 a[178:179], v3 offset:43008
  buffer_load_dwordx4 a[16:19], v1, s[4:7], s50 offen offset:1024 sc1
  v_mfma_f32_16x16x32_bf16 v[156:159], a[164:167], a[60:63], v[156:159]
  v_fmac_f32 v220, v22, v24
  v_fmac_f32 v221, v22, v25
  v_mfma_f32_16x16x32_bf16 v[152:155], a[164:167], a[56:59], v[152:155]
  ds_read_b64_tr_b16 a[180:181], v3 offset:45056
  v_fmac_f32 v222, v22, v26
  v_mfma_f32_16x16x32_bf16 v[152:155], a[160:163], a[40:43], v[152:155]
  v_fmac_f32 v223, v22, v27
  v_fmac_f32 v208, v17, v28
  v_mfma_f32_16x16x32_bf16 v[148:151], a[160:163], a[36:39], v[148:151]
  ds_read_b64_tr_b16 a[182:183], v3 offset:47104
  s_add_u32 s50, s50, 65536
  v_mfma_f32_16x16x32_bf16 v[148:151], a[164:167], a[52:55], v[148:151]
  buffer_load_dwordx4 a[4:7], v1, s[4:7], s50 offen offset:0 sc1
  v_fmac_f32 v209, v17, v29
  v_mfma_f32_16x16x32_bf16 v[144:147], a[164:167], a[48:51], v[144:147]
  ds_read_b64_tr_b16 a[184:185], v4 offset:32768
  v_fmac_f32 v210, v17, v30
  v_mfma_f32_16x16x32_bf16 v[144:147], a[160:163], a[32:35], v[144:147]
  v_fmac_f32 v211, v17, v31
  s_waitcnt lgkmcnt(5)
  v_mfma_f32_16x16x32_bf16 v[160:163], a[168:171], a[32:35], v[160:163]
  ds_read_b64_tr_b16 a[186:187], v4 offset:34816
  v_fmac_f32 v212, v19, v28
  v_mfma_f32_16x16x32_bf16 v[160:163], a[172:175], a[48:51], v[160:163]
  v_fmac_f32 v213, v19, v29
  v_fmac_f32 v214, v19, v30
  v_mfma_f32_16x16x32_bf16 v[164:167], a[172:175], a[52:55], v[164:167]
  ds_read_b64_tr_b16 a[160:161], v4 offset:36864
  buffer_load_dwordx4 a[20:23], v1, s[4:7], s50 offen offset:1024 sc1
  v_mfma_f32_16x16x32_bf16 v[164:167], a[168:171], a[36:39], v[164:167]
  v_fmac_f32 v215, v19, v31
  v_fmac_f32 v216, v21, v28
  v_mfma_f32_16x16x32_bf16 v[168:171], a[168:171], a[40:43], v[168:171]
  ds_read_b64_tr_b16 a[162:163], v4 offset:38912
  v_fmac_f32 v217, v21, v29
  v_mfma_f32_16x16x32_bf16 v[168:171], a[172:175], a[56:59], v[168:171]
  v_fmac_f32 v218, v21, v30
  v_fmac_f32 v219, v21, v31
  v_mfma_f32_16x16x32_bf16 v[172:175], a[172:175], a[60:63], v[172:175]
  ds_read_b64_tr_b16 a[164:165], v4 offset:40960
  s_add_u32 s50, s50, 65536
  v_mfma_f32_16x16x32_bf16 v[172:175], a[168:171], a[44:47], v[172:175]
  buffer_load_dwordx4 a[8:11], v1, s[4:7], s50 offen offset:0 sc1
  s_waitcnt lgkmcnt(5)
  v_mfma_f32_16x16x32_bf16 v[188:191], a[176:179], a[44:47], v[188:191]
  ds_read_b64_tr_b16 a[166:167], v4 offset:43008
  v_fmac_f32 v220, v23, v28
  v_mfma_f32_16x16x32_bf16 v[188:191], a[180:183], a[60:63], v[188:191]
  v_fmac_f32 v221, v23, v29
  v_fmac_f32 v222, v23, v30
  v_mfma_f32_16x16x32_bf16 v[184:187], a[180:183], a[56:59], v[184:187]
  ds_read_b64_tr_b16 a[168:169], v4 offset:45056
  v_fmac_f32 v223, v23, v31
  v_mfma_f32_16x16x32_bf16 v[184:187], a[176:179], a[40:43], v[184:187]
  ds_read_b128 v[24:27], v12 offset:960
  ds_read_b128 v[28:31], v12 offset:1408
  v_mfma_f32_16x16x32_bf16 v[180:183], a[176:179], a[36:39], v[180:183]
  ds_read_b64_tr_b16 a[170:171], v4 offset:47104
  buffer_load_dwordx4 a[24:27], v1, s[4:7], s50 offen offset:1024 sc1
  v_mfma_f32_16x16x32_bf16 v[180:183], a[180:183], a[52:55], v[180:183]
  v_mfma_f32_16x16x32_bf16 v[176:179], a[180:183], a[48:51], v[176:179]
  ds_read_b64_tr_b16 a[172:173], v5 offset:32768
  v_mfma_f32_16x16x32_bf16 v[176:179], a[176:179], a[32:35], v[176:179]
  s_waitcnt lgkmcnt(7)
  v_mfma_f32_16x16x32_bf16 v[192:195], a[184:187], a[32:35], v[192:195]
  ds_read_b64_tr_b16 a[174:175], v5 offset:34816
  s_add_u32 s50, s50, 65536
  v_mfma_f32_16x16x32_bf16 v[192:195], a[160:163], a[48:51], v[192:195]
  buffer_load_dwordx4 a[12:15], v1, s[4:7], s50 offen offset:0 sc1
  v_mfma_f32_16x16x32_bf16 v[196:199], a[160:163], a[52:55], v[196:199]
  ds_read_b64_tr_b16 a[176:177], v5 offset:36864
  s_waitcnt lgkmcnt(4)
  v_mfma_f32_16x16x32_bf16 v[196:199], a[184:187], a[36:39], v[196:199]
  v_fmac_f32 v176, v16, v24
  v_fmac_f32 v177, v16, v25
  v_mfma_f32_16x16x32_bf16 v[200:203], a[184:187], a[40:43], v[200:203]
  ds_read_b64_tr_b16 a[178:179], v5 offset:38912
  v_fmac_f32 v178, v16, v26
  v_mfma_f32_16x16x32_bf16 v[200:203], a[160:163], a[56:59], v[200:203]
  v_fmac_f32 v179, v16, v27
  v_fmac_f32 v180, v18, v24
  v_mfma_f32_16x16x32_bf16 v[204:207], a[160:163], a[60:63], v[204:207]
  ds_read_b64_tr_b16 a[180:181], v5 offset:40960
  buffer_load_dwordx4 a[28:31], v1, s[4:7], s50 offen offset:1024 sc1
  v_mfma_f32_16x16x32_bf16 v[204:207], a[184:187], a[44:47], v[204:207]
  v_fmac_f32 v181, v18, v25
  s_waitcnt lgkmcnt(5)
  v_mfma_f32_16x16x32_bf16 v[220:223], a[164:167], a[44:47], v[220:223]
  ds_read_b64_tr_b16 a[182:183], v5 offset:43008
  v_fmac_f32 v182, v18, v26
  v_mfma_f32_16x16x32_bf16 v[220:223], a[168:171], a[60:63], v[220:223]
  v_fmac_f32 v183, v18, v27
  v_fmac_f32 v184, v20, v24
  v_mfma_f32_16x16x32_bf16 v[216:219], a[168:171], a[56:59], v[216:219]
  ds_read_b64_tr_b16 a[184:185], v5 offset:45056
  v_fmac_f32 v185, v20, v25
  v_mfma_f32_16x16x32_bf16 v[216:219], a[164:167], a[40:43], v[216:219]
  v_fmac_f32 v186, v20, v26
  v_fmac_f32 v187, v20, v27
  v_mfma_f32_16x16x32_bf16 v[212:215], a[164:167], a[36:39], v[212:215]
  ds_read_b64_tr_b16 a[186:187], v5 offset:47104
  v_fmac_f32 v188, v22, v24
  v_mfma_f32_16x16x32_bf16 v[212:215], a[168:171], a[52:55], v[212:215]
  s_waitcnt vmcnt(40)
  s_barrier
  v_mfma_f32_16x16x32_bf16 v[208:211], a[168:171], a[48:51], v[208:211]
  ds_read_b64_tr_b16 a[160:161], v6 offset:49152
  s_add_u32 m0, s31, 16384
  v_mfma_f32_16x16x32_bf16 v[208:211], a[164:167], a[32:35], v[208:211]
  buffer_load_dwordx4 v10, s[8:11], s41 offen lds
  s_waitcnt lgkmcnt(5)
  v_mfma_f32_16x16x32_bf16 v[224:227], a[172:175], a[32:35], v[224:227]
  ds_read_b64_tr_b16 a[162:163], v6 offset:51200
  v_fmac_f32 v189, v22, v25
  v_mfma_f32_16x16x32_bf16 v[224:227], a[176:179], a[48:51], v[224:227]
  v_fmac_f32 v190, v22, v26
  v_fmac_f32 v191, v22, v27
  v_mfma_f32_16x16x32_bf16 v[228:231], a[176:179], a[52:55], v[228:231]
  ds_read_b64_tr_b16 a[164:165], v6 offset:53248
  v_fmac_f32 v176, v17, v28
  v_mfma_f32_16x16x32_bf16 v[228:231], a[172:175], a[36:39], v[228:231]
  s_add_u32 m0, s31, 24576
  v_fmac_f32 v177, v17, v29
  v_mfma_f32_16x16x32_bf16 v[232:235], a[172:175], a[40:43], v[232:235]
  ds_read_b64_tr_b16 a[166:167], v6 offset:55296
  buffer_load_dwordx4 v10, s[12:15], s41 offen lds
  v_mfma_f32_16x16x32_bf16 v[232:235], a[176:179], a[56:59], v[232:235]
  v_fmac_f32 v178, v17, v30
  v_fmac_f32 v179, v17, v31
  v_mfma_f32_16x16x32_bf16 v[236:239], a[176:179], a[60:63], v[236:239]
  ds_read_b64_tr_b16 a[168:169], v6 offset:57344
  v_fmac_f32 v180, v19, v28
  v_mfma_f32_16x16x32_bf16 v[236:239], a[172:175], a[44:47], v[236:239]
  v_fmac_f32 v181, v19, v29
  s_waitcnt lgkmcnt(5)
  v_mfma_f32_16x16x32_bf16 v[252:255], a[180:183], a[44:47], v[252:255]
  ds_read_b64_tr_b16 a[170:171], v6 offset:59392
  s_add_u32 m0, s31, 20480
  s_add_u32 s37, s41, 229376
  v_mfma_f32_16x16x32_bf16 v[252:255], a[184:187], a[60:63], v[252:255]
  buffer_load_dwordx4 v10, s[8:11], s37 offen lds
  v_fmac_f32 v182, v19, v30
  v_mfma_f32_16x16x32_bf16 v[248:251], a[184:187], a[56:59], v[248:251]
  ds_read_b64_tr_b16 a[172:173], v6 offset:61440
  v_fmac_f32 v183, v19, v31
  v_mfma_f32_16x16x32_bf16 v[248:251], a[180:183], a[40:43], v[248:251]
  v_fmac_f32 v184, v21, v28
  v_fmac_f32 v185, v21, v29
  v_mfma_f32_16x16x32_bf16 v[244:247], a[180:183], a[36:39], v[244:247]
  ds_read_b64_tr_b16 a[174:175], v6 offset:63488
  v_fmac_f32 v186, v21, v30
  v_mfma_f32_16x16x32_bf16 v[244:247], a[184:187], a[52:55], v[244:247]
  s_add_u32 m0, s31, 28672
  s_add_u32 s37, s41, 229376
  v_mfma_f32_16x16x32_bf16 v[240:243], a[184:187], a[48:51], v[240:243]
  ds_read_b64_tr_b16 a[176:177], v7 offset:49152
  buffer_load_dwordx4 v10, s[12:15], s37 offen lds
  v_mfma_f32_16x16x32_bf16 v[240:243], a[180:183], a[32:35], v[240:243]
  v_fmac_f32 v187, v21, v31
  s_waitcnt vmcnt(40) lgkmcnt(5)
  v_mfma_f32_16x16x32_bf16 v[64:67], a[160:163], a[64:67], v[64:67]
  ds_read_b64_tr_b16 a[178:179], v7 offset:51200
  v_fmac_f32 v188, v23, v28
  v_mfma_f32_16x16x32_bf16 v[64:67], a[164:167], a[80:83], v[64:67]
  v_fmac_f32 v189, v23, v29
  v_fmac_f32 v190, v23, v30
  v_mfma_f32_16x16x32_bf16 v[68:71], a[164:167], a[84:87], v[68:71]
  ds_read_b64_tr_b16 a[180:181], v7 offset:53248
  s_add_u32 m0, s31, 98304
  v_mfma_f32_16x16x32_bf16 v[68:71], a[160:163], a[68:71], v[68:71]
  buffer_load_dwordx4 v11, s[8:11], s42 offen lds
  v_fmac_f32 v191, v23, v31
  v_mfma_f32_16x16x32_bf16 v[72:75], a[160:163], a[72:75], v[72:75]
  ds_read_b64_tr_b16 a[182:183], v7 offset:55296
  ds_read_b128 v[24:27], v12 offset:192
  v_mfma_f32_16x16x32_bf16 v[72:75], a[164:167], a[88:91], v[72:75]
  ds_read_b128 v[28:31], v12 offset:640
  v_mfma_f32_16x16x32_bf16 v[76:79], a[164:167], a[92:95], v[76:79]
  ds_read_b64_tr_b16 a[184:185], v7 offset:57344
  v_mfma_f32_16x16x32_bf16 v[76:79], a[160:163], a[76:79], v[76:79]
  s_add_u32 m0, s31, 106496
  s_waitcnt lgkmcnt(7)
  v_mfma_f32_16x16x32_bf16 v[92:95], a[168:171], a[76:79], v[92:95]
  ds_read_b64_tr_b16 a[186:187], v7 offset:59392
  buffer_load_dwordx4 v11, s[12:15], s42 offen lds
  v_mfma_f32_16x16x32_bf16 v[92:95], a[172:175], a[92:95], v[92:95]
  v_mfma_f32_16x16x32_bf16 v[88:91], a[172:175], a[88:91], v[88:91]
  ds_read_b64_tr_b16 a[160:161], v7 offset:61440
  v_mfma_f32_16x16x32_bf16 v[88:91], a[168:171], a[72:75], v[88:91]
  v_mfma_f32_16x16x32_bf16 v[84:87], a[168:171], a[68:71], v[84:87]
  ds_read_b64_tr_b16 a[162:163], v7 offset:63488
  s_add_u32 m0, s31, 102400
  s_add_u32 s37, s42, 229376
  v_mfma_f32_16x16x32_bf16 v[84:87], a[172:175], a[84:87], v[84:87]
  buffer_load_dwordx4 v11, s[8:11], s37 offen lds
  s_waitcnt lgkmcnt(4)
  v_mfma_f32_16x16x32_bf16 v[80:83], a[172:175], a[80:83], v[80:83]
  ds_read_b64_tr_b16 a[164:165], v8 offset:49152
  v_fmac_f32 v224, v16, v24
  v_mfma_f32_16x16x32_bf16 v[80:83], a[168:171], a[64:67], v[80:83]
  v_fmac_f32 v225, v16, v25
  s_waitcnt lgkmcnt(7)
  v_mfma_f32_16x16x32_bf16 v[96:99], a[176:179], a[64:67], v[96:99]
  ds_read_b64_tr_b16 a[166:167], v8 offset:51200
  v_fmac_f32 v226, v16, v26
  v_mfma_f32_16x16x32_bf16 v[96:99], a[180:183], a[80:83], v[96:99]
  s_add_u32 m0, s31, 110592
  s_add_u32 s37, s42, 229376
  v_mfma_f32_16x16x32_bf16 v[100:103], a[180:183], a[84:87], v[100:103]
  ds_read_b64_tr_b16 a[168:169], v8 offset:53248
  buffer_load_dwordx4 v11, s[12:15], s37 offen lds
  v_mfma_f32_16x16x32_bf16 v[100:103], a[176:179], a[68:71], v[100:103]
  v_fmac_f32 v227, v16, v27
  v_fmac_f32 v228, v18, v24
  v_mfma_f32_16x16x32_bf16 v[104:107], a[176:179], a[72:75], v[104:107]
  ds_read_b64_tr_b16 a[170:171], v8 offset:55296
  v_fmac_f32 v229, v18, v25
  v_mfma_f32_16x16x32_bf16 v[104:107], a[180:183], a[88:91], v[104:107]
  v_fmac_f32 v230, v18, v26
  v_fmac_f32 v231, v18, v27
  v_mfma_f32_16x16x32_bf16 v[108:111], a[180:183], a[92:95], v[108:111]
  ds_read_b64_tr_b16 a[172:173], v8 offset:57344
  s_cmp_eq_u32 s32, 3
  s_cselect_b32 s51, 15, 11
  s_mul_i32 s43, s51, 458752
  s_lshl_b32 s51, s51, 11
  s_add_u32 s51, s51, s33
  v_mfma_f32_16x16x32_bf16 v[108:111], a[176:179], a[76:79], v[108:111]
  buffer_load_dwordx4 a[32:35], v1, s[4:7], s51 offen offset:0 sc1
  s_waitcnt lgkmcnt(5)
  v_mfma_f32_16x16x32_bf16 v[124:127], a[184:187], a[76:79], v[124:127]
  ds_read_b64_tr_b16 a[174:175], v8 offset:59392
  v_fmac_f32 v232, v20, v24
  v_mfma_f32_16x16x32_bf16 v[124:127], a[160:163], a[92:95], v[124:127]
  v_fmac_f32 v233, v20, v25
  v_fmac_f32 v234, v20, v26
  v_mfma_f32_16x16x32_bf16 v[120:123], a[160:163], a[88:91], v[120:123]
  ds_read_b64_tr_b16 a[176:177], v8 offset:61440
  v_fmac_f32 v235, v20, v27
  v_mfma_f32_16x16x32_bf16 v[120:123], a[184:187], a[72:75], v[120:123]
  v_fmac_f32 v236, v22, v24
  v_fmac_f32 v237, v22, v25
  v_mfma_f32_16x16x32_bf16 v[116:119], a[184:187], a[68:71], v[116:119]
  ds_read_b64_tr_b16 a[178:179], v8 offset:63488
  buffer_load_dwordx4 a[48:51], v1, s[4:7], s51 offen offset:1024 sc1
  v_mfma_f32_16x16x32_bf16 v[116:119], a[160:163], a[84:87], v[116:119]
  v_fmac_f32 v238, v22, v26
  v_fmac_f32 v239, v22, v27
  v_mfma_f32_16x16x32_bf16 v[112:115], a[160:163], a[80:83], v[112:115]
  ds_read_b64_tr_b16 a[180:181], v2 offset:49152
  v_fmac_f32 v224, v17, v28
  v_mfma_f32_16x16x32_bf16 v[112:115], a[184:187], a[64:67], v[112:115]
  v_fmac_f32 v225, v17, v29
  s_waitcnt lgkmcnt(5)
  v_mfma_f32_16x16x32_bf16 v[32:35], a[164:167], a[64:67], v[32:35]
  ds_read_b64_tr_b16 a[182:183], v2 offset:51200
  s_add_u32 s51, s51, 65536
  v_mfma_f32_16x16x32_bf16 v[32:35], a[168:171], a[80:83], v[32:35]
  buffer_load_dwordx4 a[36:39], v1, s[4:7], s51 offen offset:0 sc1
  v_fmac_f32 v226, v17, v30
  v_mfma_f32_16x16x32_bf16 v[36:39], a[168:171], a[84:87], v[36:39]
  ds_read_b64_tr_b16 a[184:185], v2 offset:53248
  v_fmac_f32 v227, v17, v31
  v_mfma_f32_16x16x32_bf16 v[36:39], a[164:167], a[68:71], v[36:39]
HOP9:
  s_cbranch_execz HOP13
  v_fmac_f32 v228, v19, v28
  v_fmac_f32 v229, v19, v29
  v_mfma_f32_16x16x32_bf16 v[40:43], a[164:167], a[72:75], v[40:43]
  ds_read_b64_tr_b16 a[186:187], v2 offset:55296
  v_fmac_f32 v230, v19, v30
  v_mfma_f32_16x16x32_bf16 v[40:43], a[168:171], a[88:91], v[40:43]
  v_fmac_f32 v231, v19, v31
  v_fmac_f32 v232, v21, v28
  v_mfma_f32_16x16x32_bf16 v[44:47], a[168:171], a[92:95], v[44:47]
  ds_read_b64_tr_b16 a[160:161], v2 offset:57344
  buffer_load_dwordx4 a[52:55], v1, s[4:7], s51 offen offset:1024 sc1
  v_mfma_f32_16x16x32_bf16 v[44:47], a[164:167], a[76:79], v[44:47]
  v_fmac_f32 v233, v21, v29
  s_waitcnt lgkmcnt(5)
  v_mfma_f32_16x16x32_bf16 v[60:63], a[172:175], a[76:79], v[60:63]
  ds_read_b64_tr_b16 a[162:163], v2 offset:59392
  v_fmac_f32 v234, v21, v30
  v_mfma_f32_16x16x32_bf16 v[60:63], a[176:179], a[92:95], v[60:63]
  v_fmac_f32 v235, v21, v31
  v_fmac_f32 v236, v23, v28
  v_mfma_f32_16x16x32_bf16 v[56:59], a[176:179], a[88:91], v[56:59]
  ds_read_b64_tr_b16 a[164:165], v2 offset:61440
  s_add_u32 s51, s51, 65536
  v_mfma_f32_16x16x32_bf16 v[56:59], a[172:175], a[72:75], v[56:59]
  buffer_load_dwordx4 a[40:43], v1, s[4:7], s51 offen offset:0 sc1
  v_fmac_f32 v237, v23, v29
  v_mfma_f32_16x16x32_bf16 v[52:55], a[172:175], a[68:71], v[52:55]
  ds_read_b64_tr_b16 a[166:167], v2 offset:63488
  v_fmac_f32 v238, v23, v30
  v_mfma_f32_16x16x32_bf16 v[52:55], a[176:179], a[84:87], v[52:55]
  v_fmac_f32 v239, v23, v31
  v_mfma_f32_16x16x32_bf16 v[48:51], a[176:179], a[80:83], v[48:51]
  ds_read_b64_tr_b16 a[168:169], v3 offset:49152
  ds_read_b128 v[24:27], v12 offset:1088
  v_mfma_f32_16x16x32_bf16 v[48:51], a[172:175], a[64:67], v[48:51]
  ds_read_b128 v[28:31], v12 offset:1536
  s_waitcnt lgkmcnt(7)
  v_mfma_f32_16x16x32_bf16 v[128:131], a[180:183], a[64:67], v[128:131]
  ds_read_b64_tr_b16 a[170:171], v3 offset:51200
  buffer_load_dwordx4 a[56:59], v1, s[4:7], s51 offen offset:1024 sc1
  v_mfma_f32_16x16x32_bf16 v[128:131], a[184:187], a[80:83], v[128:131]
  v_mfma_f32_16x16x32_bf16 v[132:135], a[184:187], a[84:87], v[132:135]
  ds_read_b64_tr_b16 a[172:173], v3 offset:53248
  v_mfma_f32_16x16x32_bf16 v[132:135], a[180:183], a[68:71], v[132:135]
  v_mfma_f32_16x16x32_bf16 v[136:139], a[180:183], a[72:75], v[136:139]
  ds_read_b64_tr_b16 a[174:175], v3 offset:55296
  s_add_u32 s51, s51, 65536
  v_mfma_f32_16x16x32_bf16 v[136:139], a[184:187], a[88:91], v[136:139]
  buffer_load_dwordx4 a[44:47], v1, s[4:7], s51 offen offset:0 sc1
  v_mfma_f32_16x16x32_bf16 v[140:143], a[184:187], a[92:95], v[140:143]
  ds_read_b64_tr_b16 a[176:177], v3 offset:57344
  s_waitcnt lgkmcnt(4)
  v_mfma_f32_16x16x32_bf16 v[140:143], a[180:183], a[76:79], v[140:143]
  v_fmac_f32 v240, v16, v24
  s_waitcnt lgkmcnt(7)
  v_mfma_f32_16x16x32_bf16 v[156:159], a[160:163], a[76:79], v[156:159]
  ds_read_b64_tr_b16 a[178:179], v3 offset:59392
  v_fmac_f32 v241, v16, v25
  v_mfma_f32_16x16x32_bf16 v[156:159], a[164:167], a[92:95], v[156:159]
  v_fmac_f32 v242, v16, v26
  v_fmac_f32 v243, v16, v27
  v_mfma_f32_16x16x32_bf16 v[152:155], a[164:167], a[88:91], v[152:155]
  ds_read_b64_tr_b16 a[180:181], v3 offset:61440
  buffer_load_dwordx4 a[60:63], v1, s[4:7], s51 offen offset:1024 sc1
  v_mfma_f32_16x16x32_bf16 v[152:155], a[160:163], a[72:75], v[152:155]
  v_fmac_f32 v244, v18, v24
  v_fmac_f32 v245, v18, v25
  v_mfma_f32_16x16x32_bf16 v[148:151], a[160:163], a[68:71], v[148:151]
  ds_read_b64_tr_b16 a[182:183], v3 offset:63488
  v_fmac_f32 v246, v18, v26
  v_mfma_f32_16x16x32_bf16 v[148:151], a[164:167], a[84:87], v[148:151]
  v_fmac_f32 v247, v18, v27
  v_fmac_f32 v248, v20, v24
  v_mfma_f32_16x16x32_bf16 v[144:147], a[164:167], a[80:83], v[144:147]
  ds_read_b64_tr_b16 a[184:185], v4 offset:49152
  v_fmac_f32 v249, v20, v25
  v_mfma_f32_16x16x32_bf16 v[144:147], a[160:163], a[64:67], v[144:147]
  v_fmac_f32 v250, v20, v26
  s_waitcnt lgkmcnt(5)
  v_mfma_f32_16x16x32_bf16 v[160:163], a[168:171], a[64:67], v[160:163]
  ds_read_b64_tr_b16 a[186:187], v4 offset:51200
  v_fmac_f32 v251, v20, v27
  v_mfma_f32_16x16x32_bf16 v[160:163], a[172:175], a[80:83], v[160:163]
  v_fmac_f32 v252, v22, v24
  v_fmac_f32 v253, v22, v25
  v_mfma_f32_16x16x32_bf16 v[164:167], a[172:175], a[84:87], v[164:167]
  ds_read_b64_tr_b16 a[160:161], v4 offset:53248
  s_add_u32 s38, s68, 0
  v_mfma_f32_16x16x32_bf16 v[164:167], a[168:171], a[68:71], v[164:167]
  buffer_load_dword v14, v13, s[16:19], s38 offen
  v_fmac_f32 v254, v22, v26
  v_mfma_f32_16x16x32_bf16 v[168:171], a[168:171], a[72:75], v[168:171]
  ds_read_b64_tr_b16 a[162:163], v4 offset:55296
  v_fmac_f32 v255, v22, v27
  v_mfma_f32_16x16x32_bf16 v[168:171], a[172:175], a[88:91], v[168:171]
  v_fmac_f32 v240, v17, v28
  v_fmac_f32 v241, v17, v29
  v_mfma_f32_16x16x32_bf16 v[172:175], a[172:175], a[92:95], v[172:175]
  ds_read_b64_tr_b16 a[164:165], v4 offset:57344
  v_fmac_f32 v242, v17, v30
  v_mfma_f32_16x16x32_bf16 v[172:175], a[168:171], a[76:79], v[172:175]
  v_fmac_f32 v243, v17, v31
  s_waitcnt lgkmcnt(5)
  v_mfma_f32_16x16x32_bf16 v[188:191], a[176:179], a[76:79], v[188:191]
  ds_read_b64_tr_b16 a[166:167], v4 offset:59392
  v_fmac_f32 v244, v19, v28
  v_mfma_f32_16x16x32_bf16 v[188:191], a[180:183], a[92:95], v[188:191]
  v_fmac_f32 v245, v19, v29
  v_fmac_f32 v246, v19, v30
  v_mfma_f32_16x16x32_bf16 v[184:187], a[180:183], a[88:91], v[184:187]
  ds_read_b64_tr_b16 a[168:169], v4 offset:61440
  v_fmac_f32 v247, v19, v31
  v_mfma_f32_16x16x32_bf16 v[184:187], a[176:179], a[72:75], v[184:187]
  v_fmac_f32 v248, v21, v28
  v_fmac_f32 v249, v21, v29
  v_mfma_f32_16x16x32_bf16 v[180:183], a[176:179], a[68:71], v[180:183]
  ds_read_b64_tr_b16 a[170:171], v4 offset:63488
  v_fmac_f32 v250, v21, v30
  v_mfma_f32_16x16x32_bf16 v[180:183], a[180:183], a[84:87], v[180:183]
  v_fmac_f32 v251, v21, v31
  v_fmac_f32 v252, v23, v28
  v_mfma_f32_16x16x32_bf16 v[176:179], a[180:183], a[80:83], v[176:179]
  ds_read_b64_tr_b16 a[172:173], v5 offset:49152
  v_fmac_f32 v253, v23, v29
  v_mfma_f32_16x16x32_bf16 v[176:179], a[176:179], a[64:67], v[176:179]
  v_fmac_f32 v254, v23, v30
  s_waitcnt lgkmcnt(5)
  v_mfma_f32_16x16x32_bf16 v[192:195], a[184:187], a[64:67], v[192:195]
  ds_read_b64_tr_b16 a[174:175], v5 offset:51200
  v_fmac_f32 v255, v23, v31
  v_mfma_f32_16x16x32_bf16 v[192:195], a[160:163], a[80:83], v[192:195]
  ds_read_b128 v[24:27], v12 offset:1216
  ds_read_b128 v[28:31], v12 offset:1664
  v_mfma_f32_16x16x32_bf16 v[196:199], a[160:163], a[84:87], v[196:199]
  ds_read_b64_tr_b16 a[176:177], v5 offset:53248
  v_mfma_f32_16x16x32_bf16 v[196:199], a[184:187], a[68:71], v[196:199]
  v_mfma_f32_16x16x32_bf16 v[200:203], a[184:187], a[72:75], v[200:203]
  ds_read_b64_tr_b16 a[178:179], v5 offset:55296
  v_mfma_f32_16x16x32_bf16 v[200:203], a[160:163], a[88:91], v[200:203]
  v_mfma_f32_16x16x32_bf16 v[204:207], a[160:163], a[92:95], v[204:207]
  ds_read_b64_tr_b16 a[180:181], v5 offset:57344
  v_mfma_f32_16x16x32_bf16 v[204:207], a[184:187], a[76:79], v[204:207]
  s_waitcnt lgkmcnt(7)
  v_mfma_f32_16x16x32_bf16 v[220:223], a[164:167], a[76:79], v[220:223]
  ds_read_b64_tr_b16 a[182:183], v5 offset:59392
  s_waitcnt lgkmcnt(4)
  v_mfma_f32_16x16x32_bf16 v[220:223], a[168:171], a[92:95], v[220:223]
  v_fmac_f32 v112, v16, v24
  v_fmac_f32 v113, v16, v25
  v_mfma_f32_16x16x32_bf16 v[216:219], a[168:171], a[88:91], v[216:219]
  ds_read_b64_tr_b16 a[184:185], v5 offset:61440
  v_fmac_f32 v114, v16, v26
  v_mfma_f32_16x16x32_bf16 v[216:219], a[164:167], a[72:75], v[216:219]
  v_fmac_f32 v115, v16, v27
  v_fmac_f32 v116, v18, v24
  v_mfma_f32_16x16x32_bf16 v[212:215], a[164:167], a[68:71], v[212:215]
  ds_read_b64_tr_b16 a[186:187], v5 offset:63488
  v_fmac_f32 v117, v18, v25
  v_mfma_f32_16x16x32_bf16 v[212:215], a[168:171], a[84:87], v[212:215]
  s_waitcnt vmcnt(34)
  s_barrier
  v_mfma_f32_16x16x32_bf16 v[208:211], a[168:171], a[80:83], v[208:211]
  ds_read_b64_tr_b16 a[160:161], v6 offset:0
  s_add_u32 m0, s31, 32768
  v_mfma_f32_16x16x32_bf16 v[208:211], a[164:167], a[64:67], v[208:211]
  buffer_load_dwordx4 v10, s[8:11], s42 offen lds
  s_waitcnt lgkmcnt(5)
  v_mfma_f32_16x16x32_bf16 v[224:227], a[172:175], a[64:67], v[224:227]
  ds_read_b64_tr_b16 a[162:163], v6 offset:2048
  v_fmac_f32 v118, v18, v26
  v_mfma_f32_16x16x32_bf16 v[224:227], a[176:179], a[80:83], v[224:227]
  v_fmac_f32 v119, v18, v27
  v_fmac_f32 v120, v20, v24
  v_mfma_f32_16x16x32_bf16 v[228:231], a[176:179], a[84:87], v[228:231]
  ds_read_b64_tr_b16 a[164:165], v6 offset:4096
  v_fmac_f32 v121, v20, v25
  v_mfma_f32_16x16x32_bf16 v[228:231], a[172:175], a[68:71], v[228:231]
  s_add_u32 m0, s31, 40960
  v_fmac_f32 v122, v20, v26
  v_mfma_f32_16x16x32_bf16 v[232:235], a[172:175], a[72:75], v[232:235]
  ds_read_b64_tr_b16 a[166:167], v6 offset:6144
  buffer_load_dwordx4 v10, s[12:15], s42 offen lds
  v_mfma_f32_16x16x32_bf16 v[232:235], a[176:179], a[88:91], v[232:235]
  v_fmac_f32 v123, v20, v27
  v_fmac_f32 v124, v22, v24
  v_mfma_f32_16x16x32_bf16 v[236:239], a[176:179], a[92:95], v[236:239]
  ds_read_b64_tr_b16 a[168:169], v6 offset:8192
  v_fmac_f32 v125, v22, v25
  v_mfma_f32_16x16x32_bf16 v[236:239], a[172:175], a[76:79], v[236:239]
  v_fmac_f32 v126, v22, v26
  s_waitcnt lgkmcnt(5)
  v_mfma_f32_16x16x32_bf16 v[252:255], a[180:183], a[76:79], v[252:255]
  ds_read_b64_tr_b16 a[170:171], v6 offset:10240
  s_add_u32 m0, s31, 36864
  s_add_u32 s37, s42, 229376
  v_mfma_f32_16x16x32_bf16 v[252:255], a[184:187], a[92:95], v[252:255]
  buffer_load_dwordx4 v10, s[8:11], s37 offen lds
  v_fmac_f32 v127, v22, v27
  v_mfma_f32_16x16x32_bf16 v[248:251], a[184:187], a[88:91], v[248:251]
  ds_read_b64_tr_b16 a[172:173], v6 offset:12288
  v_fmac_f32 v112, v17, v28
  v_mfma_f32_16x16x32_bf16 v[248:251], a[180:183], a[72:75], v[248:251]
  v_fmac_f32 v113, v17, v29
  v_fmac_f32 v114, v17, v30
  v_mfma_f32_16x16x32_bf16 v[244:247], a[180:183], a[68:71], v[244:247]
  ds_read_b64_tr_b16 a[174:175], v6 offset:14336
  v_fmac_f32 v115, v17, v31
  v_mfma_f32_16x16x32_bf16 v[244:247], a[184:187], a[84:87], v[244:247]
  s_add_u32 m0, s31, 45056
  s_add_u32 s37, s42, 229376
  v_mfma_f32_16x16x32_bf16 v[240:243], a[184:187], a[80:83], v[240:243]
  ds_read_b64_tr_b16 a[176:177], v7 offset:0
  buffer_load_dwordx4 v10, s[12:15], s37 offen lds
  v_mfma_f32_16x16x32_bf16 v[240:243], a[180:183], a[64:67], v[240:243]
  v_fmac_f32 v116, v19, v28
  s_waitcnt vmcnt(45) lgkmcnt(5)
  v_mfma_f32_16x16x32_bf16 v[64:67], a[160:163], a[96:99], v[64:67]
  ds_read_b64_tr_b16 a[178:179], v7 offset:2048
  v_fmac_f32 v117, v19, v29
  v_mfma_f32_16x16x32_bf16 v[64:67], a[164:167], a[112:115], v[64:67]
  v_fmac_f32 v118, v19, v30
  v_fmac_f32 v119, v19, v31
  v_mfma_f32_16x16x32_bf16 v[68:71], a[164:167], a[116:119], v[68:71]
  ds_read_b64_tr_b16 a[180:181], v7 offset:4096
  s_add_u32 m0, s31, 114688
  v_mfma_f32_16x16x32_bf16 v[68:71], a[160:163], a[100:103], v[68:71]
  buffer_load_dwordx4 v11, s[8:11], s43 offen lds
  v_fmac_f32 v120, v21, v28
  v_mfma_f32_16x16x32_bf16 v[72:75], a[160:163], a[104:107], v[72:75]
  ds_read_b64_tr_b16 a[182:183], v7 offset:6144
  v_fmac_f32 v121, v21, v29
  v_mfma_f32_16x16x32_bf16 v[72:75], a[164:167], a[120:123], v[72:75]
  v_fmac_f32 v122, v21, v30
  v_fmac_f32 v123, v21, v31
  v_mfma_f32_16x16x32_bf16 v[76:79], a[164:167], a[124:127], v[76:79]
  ds_read_b64_tr_b16 a[184:185], v7 offset:8192
  v_fmac_f32 v124, v23, v28
  v_mfma_f32_16x16x32_bf16 v[76:79], a[160:163], a[108:111], v[76:79]
  s_add_u32 m0, s31, 122880
  s_waitcnt lgkmcnt(5)
  v_mfma_f32_16x16x32_bf16 v[92:95], a[168:171], a[108:111], v[92:95]
  ds_read_b64_tr_b16 a[186:187], v7 offset:10240
  buffer_load_dwordx4 v11, s[12:15], s43 offen lds
  v_mfma_f32_16x16x32_bf16 v[92:95], a[172:175], a[124:127], v[92:95]
  v_fmac_f32 v125, v23, v29
  v_fmac_f32 v126, v23, v30
  v_mfma_f32_16x16x32_bf16 v[88:91], a[172:175], a[120:123], v[88:91]
  ds_read_b64_tr_b16 a[160:161], v7 offset:12288
  v_fmac_f32 v127, v23, v31
  v_mfma_f32_16x16x32_bf16 v[88:91], a[168:171], a[104:107], v[88:91]
  ds_read_b128 v[24:27], v12 offset:256
  ds_read_b128 v[28:31], v12 offset:704
  v_mfma_f32_16x16x32_bf16 v[84:87], a[168:171], a[100:103], v[84:87]
  ds_read_b64_tr_b16 a[162:163], v7 offset:14336
  s_add_u32 m0, s31, 118784
  s_add_u32 s37, s43, 229376
  v_mfma_f32_16x16x32_bf16 v[84:87], a[172:175], a[116:119], v[84:87]
  buffer_load_dwordx4 v11, s[8:11], s37 offen lds
  v_mfma_f32_16x16x32_bf16 v[80:83], a[172:175], a[112:115], v[80:83]
  ds_read_b64_tr_b16 a[164:165], v8 offset:0
  v_mfma_f32_16x16x32_bf16 v[80:83], a[168:171], a[96:99], v[80:83]
  s_waitcnt lgkmcnt(7)
  v_mfma_f32_16x16x32_bf16 v[96:99], a[176:179], a[96:99], v[96:99]
  ds_read_b64_tr_b16 a[166:167], v8 offset:2048
  v_mfma_f32_16x16x32_bf16 v[96:99], a[180:183], a[112:115], v[96:99]
  s_add_u32 m0, s31, 126976
  s_add_u32 s37, s43, 229376
  v_mfma_f32_16x16x32_bf16 v[100:103], a[180:183], a[116:119], v[100:103]
  ds_read_b64_tr_b16 a[168:169], v8 offset:4096
  buffer_load_dwordx4 v11, s[12:15], s37 offen lds
  v_mfma_f32_16x16x32_bf16 v[100:103], a[176:179], a[100:103], v[100:103]
  s_waitcnt lgkmcnt(4)
  v_fmac_f32 v64, v16, v24
  v_mfma_f32_16x16x32_bf16 v[104:107], a[176:179], a[104:107], v[104:107]
  ds_read_b64_tr_b16 a[170:171], v8 offset:6144
  v_fmac_f32 v65, v16, v25
  v_mfma_f32_16x16x32_bf16 v[104:107], a[180:183], a[120:123], v[104:107]
  v_fmac_f32 v66, v16, v26
  v_fmac_f32 v67, v16, v27
  v_mfma_f32_16x16x32_bf16 v[108:111], a[180:183], a[124:127], v[108:111]
  ds_read_b64_tr_b16 a[172:173], v8 offset:8192
  s_cmp_eq_u32 s32, 0
  s_cselect_b32 s52, 4, 12
  s_mul_i32 s44, s52, 458752
  s_lshl_b32 s52, s52, 11
  s_add_u32 s52, s52, s33
  v_mfma_f32_16x16x32_bf16 v[108:111], a[176:179], a[108:111], v[108:111]
  buffer_load_dwordx4 a[64:67], v1, s[4:7], s52 offen offset:0 sc1
  s_waitcnt lgkmcnt(5)
  v_mfma_f32_16x16x32_bf16 v[124:127], a[184:187], a[108:111], v[124:127]
  ds_read_b64_tr_b16 a[174:175], v8 offset:10240
  v_fmac_f32 v68, v18, v24
  v_mfma_f32_16x16x32_bf16 v[124:127], a[160:163], a[124:127], v[124:127]
  v_fmac_f32 v69, v18, v25
  v_fmac_f32 v70, v18, v26
  v_mfma_f32_16x16x32_bf16 v[120:123], a[160:163], a[120:123], v[120:123]
  ds_read_b64_tr_b16 a[176:177], v8 offset:12288
  v_fmac_f32 v71, v18, v27
  v_mfma_f32_16x16x32_bf16 v[120:123], a[184:187], a[104:107], v[120:123]
  v_fmac_f32 v72, v20, v24
  v_fmac_f32 v73, v20, v25
  v_mfma_f32_16x16x32_bf16 v[116:119], a[184:187], a[100:103], v[116:119]
  ds_read_b64_tr_b16 a[178:179], v8 offset:14336
  buffer_load_dwordx4 a[80:83], v1, s[4:7], s52 offen offset:1024 sc1
  v_mfma_f32_16x16x32_bf16 v[116:119], a[160:163], a[116:119], v[116:119]
  v_fmac_f32 v74, v20, v26
  v_fmac_f32 v75, v20, v27
  v_mfma_f32_16x16x32_bf16 v[112:115], a[160:163], a[112:115], v[112:115]
  ds_read_b64_tr_b16 a[180:181], v2 offset:0
  v_fmac_f32 v76, v22, v24
  v_mfma_f32_16x16x32_bf16 v[112:115], a[184:187], a[96:99], v[112:115]
  v_fmac_f32 v77, v22, v25
  s_waitcnt lgkmcnt(5)
  v_mfma_f32_16x16x32_bf16 v[32:35], a[164:167], a[96:99], v[32:35]
  ds_read_b64_tr_b16 a[182:183], v2 offset:2048
  s_add_u32 s52, s52, 65536
  v_mfma_f32_16x16x32_bf16 v[32:35], a[168:171], a[112:115], v[32:35]
  buffer_load_dwordx4 a[68:71], v1, s[4:7], s52 offen offset:0 sc1
  v_fmac_f32 v78, v22, v26
  v_mfma_f32_16x16x32_bf16 v[36:39], a[168:171], a[116:119], v[36:39]
  ds_read_b64_tr_b16 a[184:185], v2 offset:4096
  v_fmac_f32 v79, v22, v27
  v_mfma_f32_16x16x32_bf16 v[36:39], a[164:167], a[100:103], v[36:39]
  v_fmac_f32 v64, v17, v28
  v_fmac_f32 v65, v17, v29
  v_mfma_f32_16x16x32_bf16 v[40:43], a[164:167], a[104:107], v[40:43]
  ds_read_b64_tr_b16 a[186:187], v2 offset:6144
  v_fmac_f32 v66, v17, v30
  v_mfma_f32_16x16x32_bf16 v[40:43], a[168:171], a[120:123], v[40:43]
  v_fmac_f32 v67, v17, v31
  v_fmac_f32 v68, v19, v28
  v_mfma_f32_16x16x32_bf16 v[44:47], a[168:171], a[124:127], v[44:47]
  ds_read_b64_tr_b16 a[160:161], v2 offset:8192
  buffer_load_dwordx4 a[84:87], v1, s[4:7], s52 offen offset:1024 sc1
  v_mfma_f32_16x16x32_bf16 v[44:47], a[164:167], a[108:111], v[44:47]
  v_fmac_f32 v69, v19, v29
  s_waitcnt lgkmcnt(5)
  v_mfma_f32_16x16x32_bf16 v[60:63], a[172:175], a[108:111], v[60:63]
  ds_read_b64_tr_b16 a[162:163], v2 offset:10240
  v_fmac_f32 v70, v19, v30
  v_mfma_f32_16x16x32_bf16 v[60:63], a[176:179], a[124:127], v[60:63]
  v_fmac_f32 v71, v19, v31
  v_fmac_f32 v72, v21, v28
  v_mfma_f32_16x16x32_bf16 v[56:59], a[176:179], a[120:123], v[56:59]
  ds_read_b64_tr_b16 a[164:165], v2 offset:12288
  s_add_u32 s52, s52, 65536
  v_mfma_f32_16x16x32_bf16 v[56:59], a[172:175], a[104:107], v[56:59]
  buffer_load_dwordx4 a[72:75], v1, s[4:7], s52 offen offset:0 sc1
  v_fmac_f32 v73, v21, v29
  v_mfma_f32_16x16x32_bf16 v[52:55], a[172:175], a[100:103], v[52:55]
  ds_read_b64_tr_b16 a[166:167], v2 offset:14336
  v_fmac_f32 v74, v21, v30
  v_mfma_f32_16x16x32_bf16 v[52:55], a[176:179], a[116:119], v[52:55]
  v_fmac_f32 v75, v21, v31
  v_fmac_f32 v76, v23, v28
  v_mfma_f32_16x16x32_bf16 v[48:51], a[176:179], a[112:115], v[48:51]
  ds_read_b64_tr_b16 a[168:169], v3 offset:0
  v_fmac_f32 v77, v23, v29
  v_mfma_f32_16x16x32_bf16 v[48:51], a[172:175], a[96:99], v[48:51]
  s_add_u32 s38, s68, 2048
  s_waitcnt lgkmcnt(5)
  v_mfma_f32_16x16x32_bf16 v[128:131], a[180:183], a[96:99], v[128:131]
  ds_read_b64_tr_b16 a[170:171], v3 offset:2048
  buffer_load_dword v14, v13, s[16:19], s38 offen
  v_mfma_f32_16x16x32_bf16 v[128:131], a[184:187], a[112:115], v[128:131]
  v_fmac_f32 v78, v23, v30
  v_fmac_f32 v79, v23, v31
  v_mfma_f32_16x16x32_bf16 v[132:135], a[184:187], a[116:119], v[132:135]
  ds_read_b64_tr_b16 a[172:173], v3 offset:4096
  ds_read_b128 v[24:27], v12 offset:1152
  v_mfma_f32_16x16x32_bf16 v[132:135], a[180:183], a[100:103], v[132:135]
  ds_read_b128 v[28:31], v12 offset:1600
  v_mfma_f32_16x16x32_bf16 v[136:139], a[180:183], a[104:107], v[136:139]
  ds_read_b64_tr_b16 a[174:175], v3 offset:6144
  v_mfma_f32_16x16x32_bf16 v[136:139], a[184:187], a[120:123], v[136:139]
  v_mfma_f32_16x16x32_bf16 v[140:143], a[184:187], a[124:127], v[140:143]
  ds_read_b64_tr_b16 a[176:177], v3 offset:8192
  v_mfma_f32_16x16x32_bf16 v[140:143], a[180:183], a[108:111], v[140:143]
  s_waitcnt lgkmcnt(7)
  v_mfma_f32_16x16x32_bf16 v[156:159], a[160:163], a[108:111], v[156:159]
  ds_read_b64_tr_b16 a[178:179], v3 offset:10240
  v_mfma_f32_16x16x32_bf16 v[156:159], a[164:167], a[124:127], v[156:159]
  v_mfma_f32_16x16x32_bf16 v[152:155], a[164:167], a[120:123], v[152:155]
  ds_read_b64_tr_b16 a[180:181], v3 offset:12288
  buffer_load_dwordx4 a[88:91], v1, s[4:7], s52 offen offset:1024 sc1
  v_mfma_f32_16x16x32_bf16 v[152:155], a[160:163], a[104:107], v[152:155]
  s_waitcnt lgkmcnt(4)
  v_fmac_f32 v80, v16, v24
  v_mfma_f32_16x16x32_bf16 v[148:151], a[160:163], a[100:103], v[148:151]
  ds_read_b64_tr_b16 a[182:183], v3 offset:14336
  v_fmac_f32 v81, v16, v25
  v_mfma_f32_16x16x32_bf16 v[148:151], a[164:167], a[116:119], v[148:151]
  v_fmac_f32 v82, v16, v26
  v_fmac_f32 v83, v16, v27
  v_mfma_f32_16x16x32_bf16 v[144:147], a[164:167], a[112:115], v[144:147]
  ds_read_b64_tr_b16 a[184:185], v4 offset:0
  s_add_u32 s52, s52, 65536
  v_mfma_f32_16x16x32_bf16 v[144:147], a[160:163], a[96:99], v[144:147]
  buffer_load_dwordx4 a[76:79], v1, s[4:7], s52 offen offset:0 sc1
  s_waitcnt lgkmcnt(5)
  v_mfma_f32_16x16x32_bf16 v[160:163], a[168:171], a[96:99], v[160:163]
  ds_read_b64_tr_b16 a[186:187], v4 offset:2048
  v_fmac_f32 v84, v18, v24
  v_mfma_f32_16x16x32_bf16 v[160:163], a[172:175], a[112:115], v[160:163]
  v_fmac_f32 v85, v18, v25
  v_fmac_f32 v86, v18, v26
  v_mfma_f32_16x16x32_bf16 v[164:167], a[172:175], a[116:119], v[164:167]
  ds_read_b64_tr_b16 a[160:161], v4 offset:4096
  v_fmac_f32 v87, v18, v27
  v_mfma_f32_16x16x32_bf16 v[164:167], a[168:171], a[100:103], v[164:167]
  v_fmac_f32 v88, v20, v24
  v_fmac_f32 v89, v20, v25
  v_mfma_f32_16x16x32_bf16 v[168:171], a[168:171], a[104:107], v[168:171]
  ds_read_b64_tr_b16 a[162:163], v4 offset:6144
  buffer_load_dwordx4 a[92:95], v1, s[4:7], s52 offen offset:1024 sc1
  v_mfma_f32_16x16x32_bf16 v[168:171], a[172:175], a[120:123], v[168:171]
  v_fmac_f32 v90, v20, v26
  v_fmac_f32 v91, v20, v27
  v_mfma_f32_16x16x32_bf16 v[172:175], a[172:175], a[124:127], v[172:175]
  ds_read_b64_tr_b16 a[164:165], v4 offset:8192
  v_fmac_f32 v92, v22, v24
  v_mfma_f32_16x16x32_bf16 v[172:175], a[168:171], a[108:111], v[172:175]
  v_fmac_f32 v93, v22, v25
  s_waitcnt lgkmcnt(5)
  v_mfma_f32_16x16x32_bf16 v[188:191], a[176:179], a[108:111], v[188:191]
  ds_read_b64_tr_b16 a[166:167], v4 offset:10240
  v_fmac_f32 v94, v22, v26
  v_mfma_f32_16x16x32_bf16 v[188:191], a[180:183], a[124:127], v[188:191]
  v_fmac_f32 v95, v22, v27
  v_fmac_f32 v80, v17, v28
  v_mfma_f32_16x16x32_bf16 v[184:187], a[180:183], a[120:123], v[184:187]
  ds_read_b64_tr_b16 a[168:169], v4 offset:12288
  v_fmac_f32 v81, v17, v29
  v_mfma_f32_16x16x32_bf16 v[184:187], a[176:179], a[104:107], v[184:187]
  v_fmac_f32 v82, v17, v30
  v_fmac_f32 v83, v17, v31
  v_mfma_f32_16x16x32_bf16 v[180:183], a[176:179], a[100:103], v[180:183]
  ds_read_b64_tr_b16 a[170:171], v4 offset:14336
  v_fmac_f32 v84, v19, v28
  v_mfma_f32_16x16x32_bf16 v[180:183], a[180:183], a[116:119], v[180:183]
  v_fmac_f32 v85, v19, v29
  v_fmac_f32 v86, v19, v30
  v_mfma_f32_16x16x32_bf16 v[176:179], a[180:183], a[112:115], v[176:179]
  ds_read_b64_tr_b16 a[172:173], v5 offset:0
  v_fmac_f32 v87, v19, v31
  v_mfma_f32_16x16x32_bf16 v[176:179], a[176:179], a[96:99], v[176:179]
  v_fmac_f32 v88, v21, v28
  s_waitcnt lgkmcnt(5)
  v_mfma_f32_16x16x32_bf16 v[192:195], a[184:187], a[96:99], v[192:195]
  ds_read_b64_tr_b16 a[174:175], v5 offset:2048
  v_fmac_f32 v89, v21, v29
  v_mfma_f32_16x16x32_bf16 v[192:195], a[160:163], a[112:115], v[192:195]
  v_fmac_f32 v90, v21, v30
  v_fmac_f32 v91, v21, v31
  v_mfma_f32_16x16x32_bf16 v[196:199], a[160:163], a[116:119], v[196:199]
  ds_read_b64_tr_b16 a[176:177], v5 offset:4096
  v_fmac_f32 v92, v23, v28
  v_mfma_f32_16x16x32_bf16 v[196:199], a[184:187], a[100:103], v[196:199]
  v_fmac_f32 v93, v23, v29
  v_fmac_f32 v94, v23, v30
  v_mfma_f32_16x16x32_bf16 v[200:203], a[184:187], a[104:107], v[200:203]
  ds_read_b64_tr_b16 a[178:179], v5 offset:6144
  v_fmac_f32 v95, v23, v31
  v_mfma_f32_16x16x32_bf16 v[200:203], a[160:163], a[120:123], v[200:203]
  ds_read_b128 v[24:27], v12 offset:384
  ds_read_b128 v[28:31], v12 offset:832
  v_mfma_f32_16x16x32_bf16 v[204:207], a[160:163], a[124:127], v[204:207]
  ds_read_b64_tr_b16 a[180:181], v5 offset:8192
  v_mfma_f32_16x16x32_bf16 v[204:207], a[184:187], a[108:111], v[204:207]
  s_waitcnt lgkmcnt(7)
  v_mfma_f32_16x16x32_bf16 v[220:223], a[164:167], a[108:111], v[220:223]
  ds_read_b64_tr_b16 a[182:183], v5 offset:10240
  v_mfma_f32_16x16x32_bf16 v[220:223], a[168:171], a[124:127], v[220:223]
  v_mfma_f32_16x16x32_bf16 v[216:219], a[168:171], a[120:123], v[216:219]
  ds_read_b64_tr_b16 a[184:185], v5 offset:12288
  v_mfma_f32_16x16x32_bf16 v[216:219], a[164:167], a[104:107], v[216:219]
  v_mfma_f32_16x16x32_bf16 v[212:215], a[164:167], a[100:103], v[212:215]
  ds_read_b64_tr_b16 a[186:187], v5 offset:14336
  s_waitcnt lgkmcnt(4)
  v_mfma_f32_16x16x32_bf16 v[212:215], a[168:171], a[116:119], v[212:215]
  s_waitcnt vmcnt(30)
  s_barrier
  v_mfma_f32_16x16x32_bf16 v[208:211], a[168:171], a[112:115], v[208:211]
  ds_read_b64_tr_b16 a[160:161], v6 offset:16384
  s_add_u32 m0, s31, 65536
  v_mfma_f32_16x16x32_bf16 v[208:211], a[164:167], a[96:99], v[208:211]
  buffer_load_dwordx4 v11, s[8:11], s44 offen lds
  s_waitcnt lgkmcnt(7)
  v_mfma_f32_16x16x32_bf16 v[224:227], a[172:175], a[96:99], v[224:227]
  ds_read_b64_tr_b16 a[162:163], v6 offset:18432
  v_fmac_f32 v32, v16, v24
  v_mfma_f32_16x16x32_bf16 v[224:227], a[176:179], a[112:115], v[224:227]
  v_fmac_f32 v33, v16, v25
  v_fmac_f32 v34, v16, v26
  v_mfma_f32_16x16x32_bf16 v[228:231], a[176:179], a[116:119], v[228:231]
  ds_read_b64_tr_b16 a[164:165], v6 offset:20480
  v_fmac_f32 v35, v16, v27
  v_mfma_f32_16x16x32_bf16 v[228:231], a[172:175], a[100:103], v[228:231]
  s_add_u32 m0, s31, 73728
  v_fmac_f32 v36, v18, v24
  v_mfma_f32_16x16x32_bf16 v[232:235], a[172:175], a[104:107], v[232:235]
  ds_read_b64_tr_b16 a[166:167], v6 offset:22528
  buffer_load_dwordx4 v11, s[12:15], s44 offen lds
  v_mfma_f32_16x16x32_bf16 v[232:235], a[176:179], a[120:123], v[232:235]
  v_fmac_f32 v37, v18, v25
  v_fmac_f32 v38, v18, v26
  v_mfma_f32_16x16x32_bf16 v[236:239], a[176:179], a[124:127], v[236:239]
  ds_read_b64_tr_b16 a[168:169], v6 offset:24576
  v_fmac_f32 v39, v18, v27
  v_mfma_f32_16x16x32_bf16 v[236:239], a[172:175], a[108:111], v[236:239]
  v_fmac_f32 v40, v20, v24
  s_waitcnt lgkmcnt(5)
  v_mfma_f32_16x16x32_bf16 v[252:255], a[180:183], a[108:111], v[252:255]
  ds_read_b64_tr_b16 a[170:171], v6 offset:26624
  s_add_u32 m0, s31, 69632
  s_add_u32 s37, s44, 229376
  v_mfma_f32_16x16x32_bf16 v[252:255], a[184:187], a[124:127], v[252:255]
  buffer_load_dwordx4 v11, s[8:11], s37 offen lds
  v_fmac_f32 v41, v20, v25
  v_mfma_f32_16x16x32_bf16 v[248:251], a[184:187], a[120:123], v[248:251]
  ds_read_b64_tr_b16 a[172:173], v6 offset:28672
  v_fmac_f32 v42, v20, v26
  v_mfma_f32_16x16x32_bf16 v[248:251], a[180:183], a[104:107], v[248:251]
  v_fmac_f32 v43, v20, v27
  v_fmac_f32 v44, v22, v24
  v_mfma_f32_16x16x32_bf16 v[244:247], a[180:183], a[100:103], v[244:247]
  ds_read_b64_tr_b16 a[174:175], v6 offset:30720
  v_fmac_f32 v45, v22, v25
  v_mfma_f32_16x16x32_bf16 v[244:247], a[184:187], a[116:119], v[244:247]
  s_add_u32 m0, s31, 77824
  s_add_u32 s37, s44, 229376
  v_mfma_f32_16x16x32_bf16 v[240:243], a[184:187], a[112:115], v[240:243]
  ds_read_b64_tr_b16 a[176:177], v7 offset:16384
  buffer_load_dwordx4 v11, s[12:15], s37 offen lds
  v_mfma_f32_16x16x32_bf16 v[240:243], a[180:183], a[96:99], v[240:243]
  v_fmac_f32 v46, v22, v26
  s_waitcnt vmcnt(46) lgkmcnt(5)
  v_mfma_f32_16x16x32_bf16 v[64:67], a[160:163], a[128:131], v[64:67]
  ds_read_b64_tr_b16 a[178:179], v7 offset:18432
  v_fmac_f32 v47, v22, v27
  v_mfma_f32_16x16x32_bf16 v[64:67], a[164:167], a[144:147], v[64:67]
  v_fmac_f32 v32, v17, v28
  v_fmac_f32 v33, v17, v29
  v_mfma_f32_16x16x32_bf16 v[68:71], a[164:167], a[148:151], v[68:71]
  ds_read_b64_tr_b16 a[180:181], v7 offset:20480
  s_cmp_eq_u32 s32, 1
  s_cselect_b32 s53, 1, 13
  s_mul_i32 s45, s53, 458752
  s_lshl_b32 s53, s53, 11
  s_add_u32 s53, s53, s33
  v_mfma_f32_16x16x32_bf16 v[68:71], a[160:163], a[132:135], v[68:71]
  buffer_load_dwordx4 a[96:99], v1, s[4:7], s53 offen offset:0 sc1
  v_fmac_f32 v34, v17, v30
  v_mfma_f32_16x16x32_bf16 v[72:75], a[160:163], a[136:139], v[72:75]
  ds_read_b64_tr_b16 a[182:183], v7 offset:22528
  v_fmac_f32 v35, v17, v31
  v_mfma_f32_16x16x32_bf16 v[72:75], a[164:167], a[152:155], v[72:75]
  v_fmac_f32 v36, v19, v28
  v_fmac_f32 v37, v19, v29
  v_mfma_f32_16x16x32_bf16 v[76:79], a[164:167], a[156:159], v[76:79]
  ds_read_b64_tr_b16 a[184:185], v7 offset:24576
  v_fmac_f32 v38, v19, v30
  v_mfma_f32_16x16x32_bf16 v[76:79], a[160:163], a[140:143], v[76:79]
  v_fmac_f32 v39, v19, v31
  s_waitcnt lgkmcnt(5)
  v_mfma_f32_16x16x32_bf16 v[92:95], a[168:171], a[140:143], v[92:95]
  ds_read_b64_tr_b16 a[186:187], v7 offset:26624
  buffer_load_dwordx4 a[112:115], v1, s[4:7], s53 offen offset:1024 sc1
  v_mfma_f32_16x16x32_bf16 v[92:95], a[172:175], a[156:159], v[92:95]
  v_fmac_f32 v40, v21, v28
  v_fmac_f32 v41, v21, v29
  v_mfma_f32_16x16x32_bf16 v[88:91], a[172:175], a[152:155], v[88:91]
  ds_read_b64_tr_b16 a[160:161], v7 offset:28672
  v_fmac_f32 v42, v21, v30
  v_mfma_f32_16x16x32_bf16 v[88:91], a[168:171], a[136:139], v[88:91]
  v_fmac_f32 v43, v21, v31
  v_fmac_f32 v44, v23, v28
  v_mfma_f32_16x16x32_bf16 v[84:87], a[168:171], a[132:135], v[84:87]
  ds_read_b64_tr_b16 a[162:163], v7 offset:30720
  s_add_u32 s53, s53, 65536
  v_mfma_f32_16x16x32_bf16 v[84:87], a[172:175], a[148:151], v[84:87]
  buffer_load_dwordx4 a[100:103], v1, s[4:7], s53 offen offset:0 sc1
  v_fmac_f32 v45, v23, v29
  v_mfma_f32_16x16x32_bf16 v[80:83], a[172:175], a[144:147], v[80:83]
  ds_read_b64_tr_b16 a[164:165], v8 offset:16384
  v_fmac_f32 v46, v23, v30
  v_mfma_f32_16x16x32_bf16 v[80:83], a[168:171], a[128:131], v[80:83]
  v_fmac_f32 v47, v23, v31
  s_waitcnt lgkmcnt(5)
  v_mfma_f32_16x16x32_bf16 v[96:99], a[176:179], a[128:131], v[96:99]
  ds_read_b64_tr_b16 a[166:167], v8 offset:18432
  v_mfma_f32_16x16x32_bf16 v[96:99], a[180:183], a[144:147], v[96:99]
  v_mfma_f32_16x16x32_bf16 v[100:103], a[180:183], a[148:151], v[100:103]
  ds_read_b64_tr_b16 a[168:169], v8 offset:20480
  buffer_load_dwordx4 a[116:119], v1, s[4:7], s53 offen offset:1024 sc1
  v_mfma_f32_16x16x32_bf16 v[100:103], a[176:179], a[132:135], v[100:103]
  ds_read_b128 v[24:27], v12 offset:320
  ds_read_b128 v[28:31], v12 offset:768
  v_mfma_f32_16x16x32_bf16 v[104:107], a[176:179], a[136:139], v[104:107]
  ds_read_b64_tr_b16 a[170:171], v8 offset:22528
  v_mfma_f32_16x16x32_bf16 v[104:107], a[180:183], a[152:155], v[104:107]
  v_mfma_f32_16x16x32_bf16 v[108:111], a[180:183], a[156:159], v[108:111]
  ds_read_b64_tr_b16 a[172:173], v8 offset:24576
  s_add_u32 s38, s68, 4096
  v_mfma_f32_16x16x32_bf16 v[108:111], a[176:179], a[140:143], v[108:111]
  buffer_load_dword v14, v13, s[16:19], s38 offen
  s_waitcnt lgkmcnt(7)
  v_mfma_f32_16x16x32_bf16 v[124:127], a[184:187], a[140:143], v[124:127]
  ds_read_b64_tr_b16 a[174:175], v8 offset:26624
  v_mfma_f32_16x16x32_bf16 v[124:127], a[160:163], a[156:159], v[124:127]
  v_mfma_f32_16x16x32_bf16 v[120:123], a[160:163], a[152:155], v[120:123]
  ds_read_b64_tr_b16 a[176:177], v8 offset:28672
  s_waitcnt lgkmcnt(4)
  v_mfma_f32_16x16x32_bf16 v[120:123], a[184:187], a[136:139], v[120:123]
  v_fmac_f32 v96, v16, v24
  v_fmac_f32 v97, v16, v25
  v_mfma_f32_16x16x32_bf16 v[116:119], a[184:187], a[132:135], v[116:119]
  ds_read_b64_tr_b16 a[178:179], v8 offset:30720
  v_fmac_f32 v98, v16, v26
  v_mfma_f32_16x16x32_bf16 v[116:119], a[160:163], a[148:151], v[116:119]
  v_fmac_f32 v99, v16, v27
  v_fmac_f32 v100, v18, v24
  v_mfma_f32_16x16x32_bf16 v[112:115], a[160:163], a[144:147], v[112:115]
HOP10:
  s_cbranch_execz HOP14
  ds_read_b64_tr_b16 a[180:181], v2 offset:16384
  v_fmac_f32 v101, v18, v25
  v_mfma_f32_16x16x32_bf16 v[112:115], a[184:187], a[128:131], v[112:115]
  v_fmac_f32 v102, v18, v26
  s_waitcnt lgkmcnt(5)
  v_mfma_f32_16x16x32_bf16 v[32:35], a[164:167], a[128:131], v[32:35]
  ds_read_b64_tr_b16 a[182:183], v2 offset:18432
  s_add_u32 s53, s53, 65536
  v_mfma_f32_16x16x32_bf16 v[32:35], a[168:171], a[144:147], v[32:35]
  buffer_load_dwordx4 a[104:107], v1, s[4:7], s53 offen offset:0 sc1
  v_fmac_f32 v103, v18, v27
  v_mfma_f32_16x16x32_bf16 v[36:39], a[168:171], a[148:151], v[36:39]
  ds_read_b64_tr_b16 a[184:185], v2 offset:20480
  v_fmac_f32 v104, v20, v24
  v_mfma_f32_16x16x32_bf16 v[36:39], a[164:167], a[132:135], v[36:39]
  v_fmac_f32 v105, v20, v25
  v_fmac_f32 v106, v20, v26
  v_mfma_f32_16x16x32_bf16 v[40:43], a[164:167], a[136:139], v[40:43]
  ds_read_b64_tr_b16 a[186:187], v2 offset:22528
  v_fmac_f32 v107, v20, v27
  v_mfma_f32_16x16x32_bf16 v[40:43], a[168:171], a[152:155], v[40:43]
  v_fmac_f32 v108, v22, v24
  v_fmac_f32 v109, v22, v25
  v_mfma_f32_16x16x32_bf16 v[44:47], a[168:171], a[156:159], v[44:47]
  ds_read_b64_tr_b16 a[160:161], v2 offset:24576
  buffer_load_dwordx4 a[120:123], v1, s[4:7], s53 offen offset:1024 sc1
  v_mfma_f32_16x16x32_bf16 v[44:47], a[164:167], a[140:143], v[44:47]
  v_fmac_f32 v110, v22, v26
  s_waitcnt lgkmcnt(5)
  v_mfma_f32_16x16x32_bf16 v[60:63], a[172:175], a[140:143], v[60:63]
  ds_read_b64_tr_b16 a[162:163], v2 offset:26624
  v_fmac_f32 v111, v22, v27
  v_mfma_f32_16x16x32_bf16 v[60:63], a[176:179], a[156:159], v[60:63]
  v_fmac_f32 v96, v17, v28
  v_fmac_f32 v97, v17, v29
  v_mfma_f32_16x16x32_bf16 v[56:59], a[176:179], a[152:155], v[56:59]
  ds_read_b64_tr_b16 a[164:165], v2 offset:28672
  s_add_u32 s53, s53, 65536
  v_mfma_f32_16x16x32_bf16 v[56:59], a[172:175], a[136:139], v[56:59]
  buffer_load_dwordx4 a[108:111], v1, s[4:7], s53 offen offset:0 sc1
  v_fmac_f32 v98, v17, v30
  v_mfma_f32_16x16x32_bf16 v[52:55], a[172:175], a[132:135], v[52:55]
  ds_read_b64_tr_b16 a[166:167], v2 offset:30720
  v_fmac_f32 v99, v17, v31
  v_mfma_f32_16x16x32_bf16 v[52:55], a[176:179], a[148:151], v[52:55]
  v_fmac_f32 v100, v19, v28
  v_fmac_f32 v101, v19, v29
  v_mfma_f32_16x16x32_bf16 v[48:51], a[176:179], a[144:147], v[48:51]
  ds_read_b64_tr_b16 a[168:169], v3 offset:16384
  v_fmac_f32 v102, v19, v30
  v_mfma_f32_16x16x32_bf16 v[48:51], a[172:175], a[128:131], v[48:51]
  v_fmac_f32 v103, v19, v31
  s_waitcnt lgkmcnt(5)
  v_mfma_f32_16x16x32_bf16 v[128:131], a[180:183], a[128:131], v[128:131]
  ds_read_b64_tr_b16 a[170:171], v3 offset:18432
  buffer_load_dwordx4 a[124:127], v1, s[4:7], s53 offen offset:1024 sc1
  v_mfma_f32_16x16x32_bf16 v[128:131], a[184:187], a[144:147], v[128:131]
  v_fmac_f32 v104, v21, v28
  v_fmac_f32 v105, v21, v29
  v_mfma_f32_16x16x32_bf16 v[132:135], a[184:187], a[148:151], v[132:135]
  ds_read_b64_tr_b16 a[172:173], v3 offset:20480
  v_fmac_f32 v106, v21, v30
  v_mfma_f32_16x16x32_bf16 v[132:135], a[180:183], a[132:135], v[132:135]
  v_fmac_f32 v107, v21, v31
  v_fmac_f32 v108, v23, v28
  v_mfma_f32_16x16x32_bf16 v[136:139], a[180:183], a[136:139], v[136:139]
  ds_read_b64_tr_b16 a[174:175], v3 offset:22528
  s_add_u32 m0, s31, 49152
  v_mfma_f32_16x16x32_bf16 v[136:139], a[184:187], a[152:155], v[136:139]
  buffer_load_dwordx4 v10, s[8:11], s43 offen lds
  v_fmac_f32 v109, v23, v29
  v_mfma_f32_16x16x32_bf16 v[140:143], a[184:187], a[156:159], v[140:143]
  ds_read_b64_tr_b16 a[176:177], v3 offset:24576
  v_fmac_f32 v110, v23, v30
  v_mfma_f32_16x16x32_bf16 v[140:143], a[180:183], a[140:143], v[140:143]
  v_fmac_f32 v111, v23, v31
  s_waitcnt lgkmcnt(5)
  v_mfma_f32_16x16x32_bf16 v[156:159], a[160:163], a[140:143], v[156:159]
  ds_read_b64_tr_b16 a[178:179], v3 offset:26624
  ds_read_b128 v[24:27], v12 offset:1280
  v_mfma_f32_16x16x32_bf16 v[156:159], a[164:167], a[156:159], v[156:159]
  s_add_u32 m0, s31, 57344
  ds_read_b128 v[28:31], v12 offset:1728
  v_mfma_f32_16x16x32_bf16 v[152:155], a[164:167], a[152:155], v[152:155]
  ds_read_b64_tr_b16 a[180:181], v3 offset:28672
  buffer_load_dwordx4 v10, s[12:15], s43 offen lds
  v_mfma_f32_16x16x32_bf16 v[152:155], a[160:163], a[136:139], v[152:155]
  v_mfma_f32_16x16x32_bf16 v[148:151], a[160:163], a[132:135], v[148:151]
  ds_read_b64_tr_b16 a[182:183], v3 offset:30720
  v_mfma_f32_16x16x32_bf16 v[148:151], a[164:167], a[148:151], v[148:151]
  v_mfma_f32_16x16x32_bf16 v[144:147], a[164:167], a[144:147], v[144:147]
  ds_read_b64_tr_b16 a[184:185], v4 offset:16384
  s_add_u32 m0, s31, 53248
  s_add_u32 s37, s43, 229376
  v_mfma_f32_16x16x32_bf16 v[144:147], a[160:163], a[128:131], v[144:147]
  buffer_load_dwordx4 v10, s[8:11], s37 offen lds
  s_waitcnt lgkmcnt(7)
  v_mfma_f32_16x16x32_bf16 v[160:163], a[168:171], a[128:131], v[160:163]
  ds_read_b64_tr_b16 a[186:187], v4 offset:18432
  s_waitcnt lgkmcnt(4)
  v_mfma_f32_16x16x32_bf16 v[160:163], a[172:175], a[144:147], v[160:163]
  v_fmac_f32 v48, v16, v24
  v_fmac_f32 v49, v16, v25
  v_mfma_f32_16x16x32_bf16 v[164:167], a[172:175], a[148:151], v[164:167]
  ds_read_b64_tr_b16 a[160:161], v4 offset:20480
  v_fmac_f32 v50, v16, v26
  v_mfma_f32_16x16x32_bf16 v[164:167], a[168:171], a[132:135], v[164:167]
  s_add_u32 m0, s31, 61440
  s_add_u32 s37, s43, 229376
  v_mfma_f32_16x16x32_bf16 v[168:171], a[168:171], a[136:139], v[168:171]
  ds_read_b64_tr_b16 a[162:163], v4 offset:22528
  buffer_load_dwordx4 v10, s[12:15], s37 offen lds
  v_mfma_f32_16x16x32_bf16 v[168:171], a[172:175], a[152:155], v[168:171]
  v_fmac_f32 v51, v16, v27
  v_fmac_f32 v52, v18, v24
  v_mfma_f32_16x16x32_bf16 v[172:175], a[172:175], a[156:159], v[172:175]
  ds_read_b64_tr_b16 a[164:165], v4 offset:24576
  v_fmac_f32 v53, v18, v25
  v_mfma_f32_16x16x32_bf16 v[172:175], a[168:171], a[140:143], v[172:175]
  v_fmac_f32 v54, v18, v26
  s_waitcnt lgkmcnt(5)
  v_mfma_f32_16x16x32_bf16 v[188:191], a[176:179], a[140:143], v[188:191]
  ds_read_b64_tr_b16 a[166:167], v4 offset:26624
  v_fmac_f32 v55, v18, v27
  v_mfma_f32_16x16x32_bf16 v[188:191], a[180:183], a[156:159], v[188:191]
  v_fmac_f32 v56, v20, v24
  v_fmac_f32 v57, v20, v25
  v_mfma_f32_16x16x32_bf16 v[184:187], a[180:183], a[152:155], v[184:187]
  ds_read_b64_tr_b16 a[168:169], v4 offset:28672
  v_fmac_f32 v58, v20, v26
  v_mfma_f32_16x16x32_bf16 v[184:187], a[176:179], a[136:139], v[184:187]
  v_fmac_f32 v59, v20, v27
  v_fmac_f32 v60, v22, v24
  v_mfma_f32_16x16x32_bf16 v[180:183], a[176:179], a[132:135], v[180:183]
  ds_read_b64_tr_b16 a[170:171], v4 offset:30720
  v_fmac_f32 v61, v22, v25
  v_mfma_f32_16x16x32_bf16 v[180:183], a[180:183], a[148:151], v[180:183]
  v_fmac_f32 v62, v22, v26
  v_fmac_f32 v63, v22, v27
  v_mfma_f32_16x16x32_bf16 v[176:179], a[180:183], a[144:147], v[176:179]
  ds_read_b64_tr_b16 a[172:173], v5 offset:16384
  v_fmac_f32 v48, v17, v28
  v_mfma_f32_16x16x32_bf16 v[176:179], a[176:179], a[128:131], v[176:179]
  v_fmac_f32 v49, v17, v29
  s_waitcnt lgkmcnt(5)
  v_mfma_f32_16x16x32_bf16 v[192:195], a[184:187], a[128:131], v[192:195]
  ds_read_b64_tr_b16 a[174:175], v5 offset:18432
  v_fmac_f32 v50, v17, v30
  v_mfma_f32_16x16x32_bf16 v[192:195], a[160:163], a[144:147], v[192:195]
  v_fmac_f32 v51, v17, v31
  v_fmac_f32 v52, v19, v28
  v_mfma_f32_16x16x32_bf16 v[196:199], a[160:163], a[148:151], v[196:199]
  ds_read_b64_tr_b16 a[176:177], v5 offset:20480
  v_fmac_f32 v53, v19, v29
  v_mfma_f32_16x16x32_bf16 v[196:199], a[184:187], a[132:135], v[196:199]
  v_fmac_f32 v54, v19, v30
  v_fmac_f32 v55, v19, v31
  v_mfma_f32_16x16x32_bf16 v[200:203], a[184:187], a[136:139], v[200:203]
  ds_read_b64_tr_b16 a[178:179], v5 offset:22528
  v_fmac_f32 v56, v21, v28
  v_mfma_f32_16x16x32_bf16 v[200:203], a[160:163], a[152:155], v[200:203]
  v_fmac_f32 v57, v21, v29
  v_fmac_f32 v58, v21, v30
  v_mfma_f32_16x16x32_bf16 v[204:207], a[160:163], a[156:159], v[204:207]
  ds_read_b64_tr_b16 a[180:181], v5 offset:24576
  v_fmac_f32 v59, v21, v31
  v_mfma_f32_16x16x32_bf16 v[204:207], a[184:187], a[140:143], v[204:207]
  v_fmac_f32 v60, v23, v28
  s_waitcnt lgkmcnt(5)
  v_mfma_f32_16x16x32_bf16 v[220:223], a[164:167], a[140:143], v[220:223]
  ds_read_b64_tr_b16 a[182:183], v5 offset:26624
  v_fmac_f32 v61, v23, v29
  v_mfma_f32_16x16x32_bf16 v[220:223], a[168:171], a[156:159], v[220:223]
  v_fmac_f32 v62, v23, v30
  v_fmac_f32 v63, v23, v31
  v_mfma_f32_16x16x32_bf16 v[216:219], a[168:171], a[152:155], v[216:219]
  ds_read_b64_tr_b16 a[184:185], v5 offset:28672
  v_mfma_f32_16x16x32_bf16 v[216:219], a[164:167], a[136:139], v[216:219]
  v_rcp_f32 v16, v17
  v_mfma_f32_16x16x32_bf16 v[212:215], a[164:167], a[132:135], v[212:215]
  ds_read_b64_tr_b16 a[186:187], v5 offset:30720
  v_mfma_f32_16x16x32_bf16 v[212:215], a[168:171], a[148:151], v[212:215]
  s_waitcnt vmcnt(30)
  s_barrier
  v_mfma_f32_16x16x32_bf16 v[208:211], a[168:171], a[144:147], v[208:211]
  ds_read_b64_tr_b16 a[160:161], v6 offset:32768
  s_add_u32 m0, s31, 81920
  v_mfma_f32_16x16x32_bf16 v[208:211], a[164:167], a[128:131], v[208:211]
  buffer_load_dwordx4 v11, s[8:11], s45 offen lds
  s_waitcnt lgkmcnt(5)
  v_mfma_f32_16x16x32_bf16 v[224:227], a[172:175], a[128:131], v[224:227]
  ds_read_b64_tr_b16 a[162:163], v6 offset:34816
  v_mfma_f32_16x16x32_bf16 v[224:227], a[176:179], a[144:147], v[224:227]
  v_rcp_f32 v18, v19
  v_mfma_f32_16x16x32_bf16 v[228:231], a[176:179], a[148:151], v[228:231]
  ds_read_b64_tr_b16 a[164:165], v6 offset:36864
  v_mfma_f32_16x16x32_bf16 v[228:231], a[172:175], a[132:135], v[228:231]
  s_add_u32 m0, s31, 90112
  v_rcp_f32 v20, v21
  v_mfma_f32_16x16x32_bf16 v[232:235], a[172:175], a[136:139], v[232:235]
  ds_read_b64_tr_b16 a[166:167], v6 offset:38912
  buffer_load_dwordx4 v11, s[12:15], s45 offen lds
  v_mfma_f32_16x16x32_bf16 v[232:235], a[176:179], a[152:155], v[232:235]
  v_rcp_f32 v22, v23
  v_mfma_f32_16x16x32_bf16 v[236:239], a[176:179], a[156:159], v[236:239]
  ds_read_b64_tr_b16 a[168:169], v6 offset:40960
  v_mul_f32 v17, v17, v17
  v_mfma_f32_16x16x32_bf16 v[236:239], a[172:175], a[140:143], v[236:239]
  v_mul_f32 v19, v19, v19
  s_waitcnt lgkmcnt(5)
  v_mfma_f32_16x16x32_bf16 v[252:255], a[180:183], a[140:143], v[252:255]
  ds_read_b64_tr_b16 a[170:171], v6 offset:43008
  s_add_u32 m0, s31, 86016
  s_add_u32 s37, s45, 229376
  v_mfma_f32_16x16x32_bf16 v[252:255], a[184:187], a[156:159], v[252:255]
  buffer_load_dwordx4 v11, s[8:11], s37 offen lds
  v_mul_f32 v21, v21, v21
  v_mfma_f32_16x16x32_bf16 v[248:251], a[184:187], a[152:155], v[248:251]
  ds_read_b64_tr_b16 a[172:173], v6 offset:45056
  v_mul_f32 v23, v23, v23
  v_mfma_f32_16x16x32_bf16 v[248:251], a[180:183], a[136:139], v[248:251]
  v_mul_f32 v16, 0xbfb8aa3b, v16
  v_mul_f32 v18, 0xbfb8aa3b, v18
  v_mfma_f32_16x16x32_bf16 v[244:247], a[180:183], a[132:135], v[244:247]
  ds_read_b64_tr_b16 a[174:175], v6 offset:47104
  v_mul_f32 v20, 0xbfb8aa3b, v20
  v_mfma_f32_16x16x32_bf16 v[244:247], a[184:187], a[148:151], v[244:247]
  s_add_u32 m0, s31, 94208
  s_add_u32 s37, s45, 229376
  v_mfma_f32_16x16x32_bf16 v[240:243], a[184:187], a[144:147], v[240:243]
  ds_read_b64_tr_b16 a[176:177], v7 offset:32768
  buffer_load_dwordx4 v11, s[12:15], s37 offen lds
  v_mfma_f32_16x16x32_bf16 v[240:243], a[180:183], a[128:131], v[240:243]
  v_mul_f32 v22, 0xbfb8aa3b, v22
  s_waitcnt vmcnt(55) lgkmcnt(5)
  v_mfma_f32_16x16x32_bf16 v[64:67], a[160:163], a[0:3], v[64:67]
  ds_read_b64_tr_b16 a[178:179], v7 offset:34816
  v_mfma_f32_16x16x32_bf16 v[64:67], a[164:167], a[16:19], v[64:67]
  v_mfma_f32_16x16x32_bf16 v[68:71], a[164:167], a[20:23], v[68:71]
  ds_read_b64_tr_b16 a[180:181], v7 offset:36864
  s_add_u32 s38, s68, 6144
  v_mfma_f32_16x16x32_bf16 v[68:71], a[160:163], a[4:7], v[68:71]
  buffer_load_dword v14, v13, s[16:19], s38 offen
  v_mfma_f32_16x16x32_bf16 v[72:75], a[160:163], a[8:11], v[72:75]
  ds_read_b64_tr_b16 a[182:183], v7 offset:38912
  v_mfma_f32_16x16x32_bf16 v[72:75], a[164:167], a[24:27], v[72:75]
  v_mfma_f32_16x16x32_bf16 v[76:79], a[164:167], a[28:31], v[76:79]
  ds_read_b64_tr_b16 a[184:185], v7 offset:40960
  v_mfma_f32_16x16x32_bf16 v[76:79], a[160:163], a[12:15], v[76:79]
  s_waitcnt lgkmcnt(5)
  v_mfma_f32_16x16x32_bf16 v[92:95], a[168:171], a[12:15], v[92:95]
  ds_read_b64_tr_b16 a[186:187], v7 offset:43008
  v_mfma_f32_16x16x32_bf16 v[92:95], a[172:175], a[28:31], v[92:95]
  v_mfma_f32_16x16x32_bf16 v[88:91], a[172:175], a[24:27], v[88:91]
  ds_read_b64_tr_b16 a[160:161], v7 offset:45056
  v_mfma_f32_16x16x32_bf16 v[88:91], a[168:171], a[8:11], v[88:91]
  v_mfma_f32_16x16x32_bf16 v[84:87], a[168:171], a[4:7], v[84:87]
  ds_read_b64_tr_b16 a[162:163], v7 offset:47104
  s_cmp_eq_u32 s32, 2
  s_cselect_b32 s54, 2, 14
  s_mul_i32 s46, s54, 458752
  s_lshl_b32 s54, s54, 11
  s_add_u32 s54, s54, s33
  v_mfma_f32_16x16x32_bf16 v[84:87], a[172:175], a[20:23], v[84:87]
  buffer_load_dwordx4 a[128:131], v1, s[4:7], s54 offen offset:0 sc1
  v_mfma_f32_16x16x32_bf16 v[80:83], a[172:175], a[16:19], v[80:83]
  ds_read_b64_tr_b16 a[164:165], v8 offset:32768
  v_mfma_f32_16x16x32_bf16 v[80:83], a[168:171], a[0:3], v[80:83]
  s_waitcnt lgkmcnt(5)
  v_mfma_f32_16x16x32_bf16 v[96:99], a[176:179], a[0:3], v[96:99]
  ds_read_b64_tr_b16 a[166:167], v8 offset:34816
  v_mfma_f32_16x16x32_bf16 v[96:99], a[180:183], a[16:19], v[96:99]
  v_mfma_f32_16x16x32_bf16 v[100:103], a[180:183], a[20:23], v[100:103]
  ds_read_b64_tr_b16 a[168:169], v8 offset:36864
  buffer_load_dwordx4 a[144:147], v1, s[4:7], s54 offen offset:1024 sc1
  v_mfma_f32_16x16x32_bf16 v[100:103], a[176:179], a[4:7], v[100:103]
  v_mfma_f32_16x16x32_bf16 v[104:107], a[176:179], a[8:11], v[104:107]
  ds_read_b64_tr_b16 a[170:171], v8 offset:38912
  v_mfma_f32_16x16x32_bf16 v[104:107], a[180:183], a[24:27], v[104:107]
  v_mfma_f32_16x16x32_bf16 v[108:111], a[180:183], a[28:31], v[108:111]
  ds_read_b64_tr_b16 a[172:173], v8 offset:40960
  s_add_u32 s54, s54, 65536
  v_mfma_f32_16x16x32_bf16 v[108:111], a[176:179], a[12:15], v[108:111]
  buffer_load_dwordx4 a[132:135], v1, s[4:7], s54 offen offset:0 sc1
  s_waitcnt lgkmcnt(5)
  v_mfma_f32_16x16x32_bf16 v[124:127], a[184:187], a[12:15], v[124:127]
  ds_read_b64_tr_b16 a[174:175], v8 offset:43008
  v_mfma_f32_16x16x32_bf16 v[124:127], a[160:163], a[28:31], v[124:127]
  v_mfma_f32_16x16x32_bf16 v[120:123], a[160:163], a[24:27], v[120:123]
  ds_read_b64_tr_b16 a[176:177], v8 offset:45056
  v_mfma_f32_16x16x32_bf16 v[120:123], a[184:187], a[8:11], v[120:123]
  v_mfma_f32_16x16x32_bf16 v[116:119], a[184:187], a[4:7], v[116:119]
  ds_read_b64_tr_b16 a[178:179], v8 offset:47104
  buffer_load_dwordx4 a[148:151], v1, s[4:7], s54 offen offset:1024 sc1
  v_mfma_f32_16x16x32_bf16 v[116:119], a[160:163], a[20:23], v[116:119]
  v_mfma_f32_16x16x32_bf16 v[112:115], a[160:163], a[16:19], v[112:115]
  ds_read_b64_tr_b16 a[180:181], v2 offset:32768
  v_mfma_f32_16x16x32_bf16 v[112:115], a[184:187], a[0:3], v[112:115]
  s_waitcnt lgkmcnt(5)
  v_mfma_f32_16x16x32_bf16 v[32:35], a[164:167], a[0:3], v[32:35]
  ds_read_b64_tr_b16 a[182:183], v2 offset:34816
  s_add_u32 s54, s54, 65536
  v_mfma_f32_16x16x32_bf16 v[32:35], a[168:171], a[16:19], v[32:35]
  buffer_load_dwordx4 a[136:139], v1, s[4:7], s54 offen offset:0 sc1
  v_mfma_f32_16x16x32_bf16 v[36:39], a[168:171], a[20:23], v[36:39]
  ds_read_b64_tr_b16 a[184:185], v2 offset:36864
  v_mfma_f32_16x16x32_bf16 v[36:39], a[164:167], a[4:7], v[36:39]
  v_mfma_f32_16x16x32_bf16 v[40:43], a[164:167], a[8:11], v[40:43]
  ds_read_b64_tr_b16 a[186:187], v2 offset:38912
  v_mfma_f32_16x16x32_bf16 v[40:43], a[168:171], a[24:27], v[40:43]
  v_mfma_f32_16x16x32_bf16 v[44:47], a[168:171], a[28:31], v[44:47]
  ds_read_b64_tr_b16 a[160:161], v2 offset:40960
  buffer_load_dwordx4 a[152:155], v1, s[4:7], s54 offen offset:1024 sc1
  v_mfma_f32_16x16x32_bf16 v[44:47], a[164:167], a[12:15], v[44:47]
  s_waitcnt lgkmcnt(5)
  v_mfma_f32_16x16x32_bf16 v[60:63], a[172:175], a[12:15], v[60:63]
  ds_read_b64_tr_b16 a[162:163], v2 offset:43008
  v_mfma_f32_16x16x32_bf16 v[60:63], a[176:179], a[28:31], v[60:63]
  v_mfma_f32_16x16x32_bf16 v[56:59], a[176:179], a[24:27], v[56:59]
  ds_read_b64_tr_b16 a[164:165], v2 offset:45056
  s_add_u32 s54, s54, 65536
  v_mfma_f32_16x16x32_bf16 v[56:59], a[172:175], a[8:11], v[56:59]
  buffer_load_dwordx4 a[140:143], v1, s[4:7], s54 offen offset:0 sc1
  v_mfma_f32_16x16x32_bf16 v[52:55], a[172:175], a[4:7], v[52:55]
  ds_read_b64_tr_b16 a[166:167], v2 offset:47104
  v_mfma_f32_16x16x32_bf16 v[52:55], a[176:179], a[20:23], v[52:55]
  v_mfma_f32_16x16x32_bf16 v[48:51], a[176:179], a[16:19], v[48:51]
  ds_read_b64_tr_b16 a[168:169], v3 offset:32768
  v_mfma_f32_16x16x32_bf16 v[48:51], a[172:175], a[0:3], v[48:51]
  s_waitcnt lgkmcnt(5)
  v_mfma_f32_16x16x32_bf16 v[128:131], a[180:183], a[0:3], v[128:131]
  ds_read_b64_tr_b16 a[170:171], v3 offset:34816
  buffer_load_dwordx4 a[156:159], v1, s[4:7], s54 offen offset:1024 sc1
  v_mfma_f32_16x16x32_bf16 v[128:131], a[184:187], a[16:19], v[128:131]
  v_mfma_f32_16x16x32_bf16 v[132:135], a[184:187], a[20:23], v[132:135]
  ds_read_b64_tr_b16 a[172:173], v3 offset:36864
  v_mfma_f32_16x16x32_bf16 v[132:135], a[180:183], a[4:7], v[132:135]
  v_mfma_f32_16x16x32_bf16 v[136:139], a[180:183], a[8:11], v[136:139]
  ds_read_b64_tr_b16 a[174:175], v3 offset:38912
  s_add_u32 m0, s31, 0
  v_mfma_f32_16x16x32_bf16 v[136:139], a[184:187], a[24:27], v[136:139]
  buffer_load_dwordx4 v10, s[8:11], s44 offen lds
  v_mfma_f32_16x16x32_bf16 v[140:143], a[184:187], a[28:31], v[140:143]
  ds_read_b64_tr_b16 a[176:177], v3 offset:40960
  v_mfma_f32_16x16x32_bf16 v[140:143], a[180:183], a[12:15], v[140:143]
  s_waitcnt lgkmcnt(5)
  v_mfma_f32_16x16x32_bf16 v[156:159], a[160:163], a[12:15], v[156:159]
  ds_read_b64_tr_b16 a[178:179], v3 offset:43008
  v_mfma_f32_16x16x32_bf16 v[156:159], a[164:167], a[28:31], v[156:159]
  s_add_u32 m0, s31, 8192
  v_mfma_f32_16x16x32_bf16 v[152:155], a[164:167], a[24:27], v[152:155]
  ds_read_b64_tr_b16 a[180:181], v3 offset:45056
  buffer_load_dwordx4 v10, s[12:15], s44 offen lds
  v_mfma_f32_16x16x32_bf16 v[152:155], a[160:163], a[8:11], v[152:155]
  v_mfma_f32_16x16x32_bf16 v[148:151], a[160:163], a[4:7], v[148:151]
  ds_read_b64_tr_b16 a[182:183], v3 offset:47104
  v_mfma_f32_16x16x32_bf16 v[148:151], a[164:167], a[20:23], v[148:151]
  v_mfma_f32_16x16x32_bf16 v[144:147], a[164:167], a[16:19], v[144:147]
  ds_read_b64_tr_b16 a[184:185], v4 offset:32768
  s_add_u32 m0, s31, 4096
  s_add_u32 s37, s44, 229376
  v_mfma_f32_16x16x32_bf16 v[144:147], a[160:163], a[0:3], v[144:147]
  buffer_load_dwordx4 v10, s[8:11], s37 offen lds
  s_waitcnt lgkmcnt(5)
  v_mfma_f32_16x16x32_bf16 v[160:163], a[168:171], a[0:3], v[160:163]
  ds_read_b64_tr_b16 a[186:187], v4 offset:34816
  v_mfma_f32_16x16x32_bf16 v[160:163], a[172:175], a[16:19], v[160:163]
  v_mfma_f32_16x16x32_bf16 v[164:167], a[172:175], a[20:23], v[164:167]
  ds_read_b64_tr_b16 a[160:161], v4 offset:36864
  v_mfma_f32_16x16x32_bf16 v[164:167], a[168:171], a[4:7], v[164:167]
  s_add_u32 m0, s31, 12288
  s_add_u32 s37, s44, 229376
  v_mfma_f32_16x16x32_bf16 v[168:171], a[168:171], a[8:11], v[168:171]
  ds_read_b64_tr_b16 a[162:163], v4 offset:38912
  buffer_load_dwordx4 v10, s[12:15], s37 offen lds
  v_mfma_f32_16x16x32_bf16 v[168:171], a[172:175], a[24:27], v[168:171]
  v_mfma_f32_16x16x32_bf16 v[172:175], a[172:175], a[28:31], v[172:175]
  ds_read_b64_tr_b16 a[164:165], v4 offset:40960
  v_mfma_f32_16x16x32_bf16 v[172:175], a[168:171], a[12:15], v[172:175]
  s_waitcnt lgkmcnt(5)
  v_mfma_f32_16x16x32_bf16 v[188:191], a[176:179], a[12:15], v[188:191]
  ds_read_b64_tr_b16 a[166:167], v4 offset:43008
  v_mfma_f32_16x16x32_bf16 v[188:191], a[180:183], a[28:31], v[188:191]
  v_mfma_f32_16x16x32_bf16 v[184:187], a[180:183], a[24:27], v[184:187]
  ds_read_b64_tr_b16 a[168:169], v4 offset:45056
  v_mfma_f32_16x16x32_bf16 v[184:187], a[176:179], a[8:11], v[184:187]
  v_mfma_f32_16x16x32_bf16 v[180:183], a[176:179], a[4:7], v[180:183]
  ds_read_b64_tr_b16 a[170:171], v4 offset:47104
  v_mfma_f32_16x16x32_bf16 v[180:183], a[180:183], a[20:23], v[180:183]
  v_mfma_f32_16x16x32_bf16 v[176:179], a[180:183], a[16:19], v[176:179]
  ds_read_b64_tr_b16 a[172:173], v5 offset:32768
  v_mfma_f32_16x16x32_bf16 v[176:179], a[176:179], a[0:3], v[176:179]
  s_waitcnt lgkmcnt(5)
  v_mfma_f32_16x16x32_bf16 v[192:195], a[184:187], a[0:3], v[192:195]
  ds_read_b64_tr_b16 a[174:175], v5 offset:34816
  v_mfma_f32_16x16x32_bf16 v[192:195], a[160:163], a[16:19], v[192:195]
  v_mfma_f32_16x16x32_bf16 v[196:199], a[160:163], a[20:23], v[196:199]
  ds_read_b64_tr_b16 a[176:177], v5 offset:36864
  v_mfma_f32_16x16x32_bf16 v[196:199], a[184:187], a[4:7], v[196:199]
  v_mfma_f32_16x16x32_bf16 v[200:203], a[184:187], a[8:11], v[200:203]
  ds_read_b64_tr_b16 a[178:179], v5 offset:38912
  v_mfma_f32_16x16x32_bf16 v[200:203], a[160:163], a[24:27], v[200:203]
  v_mfma_f32_16x16x32_bf16 v[204:207], a[160:163], a[28:31], v[204:207]
  ds_read_b64_tr_b16 a[180:181], v5 offset:40960
  v_mfma_f32_16x16x32_bf16 v[204:207], a[184:187], a[12:15], v[204:207]
  s_waitcnt lgkmcnt(5)
  v_mfma_f32_16x16x32_bf16 v[220:223], a[164:167], a[12:15], v[220:223]
  ds_read_b64_tr_b16 a[182:183], v5 offset:43008
  v_mfma_f32_16x16x32_bf16 v[220:223], a[168:171], a[28:31], v[220:223]
  v_mfma_f32_16x16x32_bf16 v[216:219], a[168:171], a[24:27], v[216:219]
  ds_read_b64_tr_b16 a[184:185], v5 offset:45056
  s_add_u32 s38, s68, 8192
  v_mfma_f32_16x16x32_bf16 v[216:219], a[164:167], a[8:11], v[216:219]
  buffer_load_dword v14, v13, s[16:19], s38 offen
  v_mfma_f32_16x16x32_bf16 v[212:215], a[164:167], a[4:7], v[212:215]
  ds_read_b64_tr_b16 a[186:187], v5 offset:47104
  v_mfma_f32_16x16x32_bf16 v[212:215], a[168:171], a[20:23], v[212:215]
  s_waitcnt vmcnt(14)
  s_barrier
  v_mfma_f32_16x16x32_bf16 v[208:211], a[168:171], a[16:19], v[208:211]
  ds_read_b64_tr_b16 a[160:161], v6 offset:49152
  v_mfma_f32_16x16x32_bf16 v[208:211], a[164:167], a[0:3], v[208:211]
  s_waitcnt lgkmcnt(5)
  v_mfma_f32_16x16x32_bf16 v[224:227], a[172:175], a[0:3], v[224:227]
  ds_read_b64_tr_b16 a[162:163], v6 offset:51200
  v_mfma_f32_16x16x32_bf16 v[224:227], a[176:179], a[16:19], v[224:227]
  v_mfma_f32_16x16x32_bf16 v[228:231], a[176:179], a[20:23], v[228:231]
  ds_read_b64_tr_b16 a[164:165], v6 offset:53248
  v_mfma_f32_16x16x32_bf16 v[228:231], a[172:175], a[4:7], v[228:231]
  v_mfma_f32_16x16x32_bf16 v[232:235], a[172:175], a[8:11], v[232:235]
  ds_read_b64_tr_b16 a[166:167], v6 offset:55296
  s_add_u32 m0, s31, 98304
  v_mfma_f32_16x16x32_bf16 v[232:235], a[176:179], a[24:27], v[232:235]
  buffer_load_dwordx4 v11, s[8:11], s46 offen lds
  v_mfma_f32_16x16x32_bf16 v[236:239], a[176:179], a[28:31], v[236:239]
  ds_read_b64_tr_b16 a[168:169], v6 offset:57344
  v_mfma_f32_16x16x32_bf16 v[236:239], a[172:175], a[12:15], v[236:239]
  s_waitcnt lgkmcnt(5)
  v_mfma_f32_16x16x32_bf16 v[252:255], a[180:183], a[12:15], v[252:255]
  ds_read_b64_tr_b16 a[170:171], v6 offset:59392
  v_mfma_f32_16x16x32_bf16 v[252:255], a[184:187], a[28:31], v[252:255]
  s_add_u32 m0, s31, 106496
  v_mfma_f32_16x16x32_bf16 v[248:251], a[184:187], a[24:27], v[248:251]
  ds_read_b64_tr_b16 a[172:173], v6 offset:61440
  buffer_load_dwordx4 v11, s[12:15], s46 offen lds
  v_mfma_f32_16x16x32_bf16 v[248:251], a[180:183], a[8:11], v[248:251]
  v_mfma_f32_16x16x32_bf16 v[244:247], a[180:183], a[4:7], v[244:247]
  ds_read_b64_tr_b16 a[174:175], v6 offset:63488
  v_mfma_f32_16x16x32_bf16 v[244:247], a[184:187], a[20:23], v[244:247]
  v_mfma_f32_16x16x32_bf16 v[240:243], a[184:187], a[16:19], v[240:243]
  ds_read_b64_tr_b16 a[176:177], v7 offset:49152
  s_add_u32 m0, s31, 102400
  s_add_u32 s37, s46, 229376
  v_mfma_f32_16x16x32_bf16 v[240:243], a[180:183], a[0:3], v[240:243]
  buffer_load_dwordx4 v11, s[8:11], s37 offen lds
  s_waitcnt vmcnt(56) lgkmcnt(5)
  v_mfma_f32_16x16x32_bf16 v[64:67], a[160:163], a[32:35], v[64:67]
  ds_read_b64_tr_b16 a[178:179], v7 offset:51200
  v_mfma_f32_16x16x32_bf16 v[64:67], a[164:167], a[48:51], v[64:67]
  v_mfma_f32_16x16x32_bf16 v[68:71], a[164:167], a[52:55], v[68:71]
  ds_read_b64_tr_b16 a[180:181], v7 offset:53248
  v_mfma_f32_16x16x32_bf16 v[68:71], a[160:163], a[36:39], v[68:71]
  s_add_u32 m0, s31, 110592
  s_add_u32 s37, s46, 229376
  v_mfma_f32_16x16x32_bf16 v[72:75], a[160:163], a[40:43], v[72:75]
  ds_read_b64_tr_b16 a[182:183], v7 offset:55296
  buffer_load_dwordx4 v11, s[12:15], s37 offen lds
  v_mfma_f32_16x16x32_bf16 v[72:75], a[164:167], a[56:59], v[72:75]
  v_mfma_f32_16x16x32_bf16 v[76:79], a[164:167], a[60:63], v[76:79]
  ds_read_b64_tr_b16 a[184:185], v7 offset:57344
  v_mfma_f32_16x16x32_bf16 v[76:79], a[160:163], a[44:47], v[76:79]
  s_waitcnt lgkmcnt(5)
  v_mfma_f32_16x16x32_bf16 v[92:95], a[168:171], a[44:47], v[92:95]
  ds_read_b64_tr_b16 a[186:187], v7 offset:59392
  s_cmp_eq_u32 s32, 3
  s_cselect_b32 s55, 3, 15
  s_mul_i32 s47, s55, 458752
  s_lshl_b32 s55, s55, 11
  s_add_u32 s55, s55, s33
  v_mfma_f32_16x16x32_bf16 v[92:95], a[172:175], a[60:63], v[92:95]
  buffer_load_dwordx4 a[0:3], v1, s[4:7], s55 offen offset:0 sc1
  v_mfma_f32_16x16x32_bf16 v[88:91], a[172:175], a[56:59], v[88:91]
  ds_read_b64_tr_b16 a[160:161], v7 offset:61440
  v_mfma_f32_16x16x32_bf16 v[88:91], a[168:171], a[40:43], v[88:91]
  v_mfma_f32_16x16x32_bf16 v[84:87], a[168:171], a[36:39], v[84:87]
  ds_read_b64_tr_b16 a[162:163], v7 offset:63488
  v_mfma_f32_16x16x32_bf16 v[84:87], a[172:175], a[52:55], v[84:87]
  v_mfma_f32_16x16x32_bf16 v[80:83], a[172:175], a[48:51], v[80:83]
  ds_read_b64_tr_b16 a[164:165], v8 offset:49152
  buffer_load_dwordx4 a[16:19], v1, s[4:7], s55 offen offset:1024 sc1
  v_mfma_f32_16x16x32_bf16 v[80:83], a[168:171], a[32:35], v[80:83]
  s_waitcnt lgkmcnt(5)
  v_mfma_f32_16x16x32_bf16 v[96:99], a[176:179], a[32:35], v[96:99]
  ds_read_b64_tr_b16 a[166:167], v8 offset:51200
  v_mfma_f32_16x16x32_bf16 v[96:99], a[180:183], a[48:51], v[96:99]
  v_mfma_f32_16x16x32_bf16 v[100:103], a[180:183], a[52:55], v[100:103]
  ds_read_b64_tr_b16 a[168:169], v8 offset:53248
  s_add_u32 s55, s55, 65536
  v_mfma_f32_16x16x32_bf16 v[100:103], a[176:179], a[36:39], v[100:103]
  buffer_load_dwordx4 a[4:7], v1, s[4:7], s55 offen offset:0 sc1
  v_mfma_f32_16x16x32_bf16 v[104:107], a[176:179], a[40:43], v[104:107]
  ds_read_b64_tr_b16 a[170:171], v8 offset:55296
  v_mfma_f32_16x16x32_bf16 v[104:107], a[180:183], a[56:59], v[104:107]
  v_mfma_f32_16x16x32_bf16 v[108:111], a[180:183], a[60:63], v[108:111]
  ds_read_b64_tr_b16 a[172:173], v8 offset:57344
  v_mfma_f32_16x16x32_bf16 v[108:111], a[176:179], a[44:47], v[108:111]
  s_waitcnt lgkmcnt(5)
  v_mfma_f32_16x16x32_bf16 v[124:127], a[184:187], a[44:47], v[124:127]
  ds_read_b64_tr_b16 a[174:175], v8 offset:59392
  buffer_load_dwordx4 a[20:23], v1, s[4:7], s55 offen offset:1024 sc1
  v_mfma_f32_16x16x32_bf16 v[124:127], a[160:163], a[60:63], v[124:127]
  v_mfma_f32_16x16x32_bf16 v[120:123], a[160:163], a[56:59], v[120:123]
  ds_read_b64_tr_b16 a[176:177], v8 offset:61440
  v_mfma_f32_16x16x32_bf16 v[120:123], a[184:187], a[40:43], v[120:123]
  v_mfma_f32_16x16x32_bf16 v[116:119], a[184:187], a[36:39], v[116:119]
  ds_read_b64_tr_b16 a[178:179], v8 offset:63488
  s_add_u32 s55, s55, 65536
  v_mfma_f32_16x16x32_bf16 v[116:119], a[160:163], a[52:55], v[116:119]
  buffer_load_dwordx4 a[8:11], v1, s[4:7], s55 offen offset:0 sc1
  v_mfma_f32_16x16x32_bf16 v[112:115], a[160:163], a[48:51], v[112:115]
  ds_read_b64_tr_b16 a[180:181], v8 offset:0
  v_mfma_f32_16x16x32_bf16 v[112:115], a[184:187], a[32:35], v[112:115]
  s_waitcnt lgkmcnt(5)
  v_mfma_f32_16x16x32_bf16 v[32:35], a[164:167], a[32:35], v[32:35]
  ds_read_b64_tr_b16 a[182:183], v8 offset:2048
  v_mfma_f32_16x16x32_bf16 v[32:35], a[168:171], a[48:51], v[32:35]
  v_mfma_f32_16x16x32_bf16 v[36:39], a[168:171], a[52:55], v[36:39]
  ds_read_b64_tr_b16 a[184:185], v8 offset:4096
  buffer_load_dwordx4 a[24:27], v1, s[4:7], s55 offen offset:1024 sc1
  v_mfma_f32_16x16x32_bf16 v[36:39], a[164:167], a[36:39], v[36:39]
  v_mfma_f32_16x16x32_bf16 v[40:43], a[164:167], a[40:43], v[40:43]
  ds_read_b64_tr_b16 a[186:187], v8 offset:6144
  v_mfma_f32_16x16x32_bf16 v[40:43], a[168:171], a[56:59], v[40:43]
  v_mfma_f32_16x16x32_bf16 v[44:47], a[168:171], a[60:63], v[44:47]
  ds_read_b64_tr_b16 a[160:161], v8 offset:8192
  s_add_u32 s55, s55, 65536
  v_mfma_f32_16x16x32_bf16 v[44:47], a[164:167], a[44:47], v[44:47]
  buffer_load_dwordx4 a[12:15], v1, s[4:7], s55 offen offset:0 sc1
  s_waitcnt lgkmcnt(5)
  v_mfma_f32_16x16x32_bf16 v[60:63], a[172:175], a[44:47], v[60:63]
  ds_read_b64_tr_b16 a[162:163], v8 offset:10240
  v_mfma_f32_16x16x32_bf16 v[60:63], a[176:179], a[60:63], v[60:63]
  v_mfma_f32_16x16x32_bf16 v[56:59], a[176:179], a[56:59], v[56:59]
  ds_read_b64_tr_b16 a[164:165], v8 offset:12288
  v_mfma_f32_16x16x32_bf16 v[56:59], a[172:175], a[40:43], v[56:59]
  v_mfma_f32_16x16x32_bf16 v[52:55], a[172:175], a[36:39], v[52:55]
  ds_read_b64_tr_b16 a[166:167], v8 offset:14336
  buffer_load_dwordx4 a[28:31], v1, s[4:7], s55 offen offset:1024 sc1
  v_mfma_f32_16x16x32_bf16 v[52:55], a[176:179], a[52:55], v[52:55]
  v_mfma_f32_16x16x32_bf16 v[48:51], a[176:179], a[48:51], v[48:51]
  ds_read_b64_tr_b16 a[168:169], v8 offset:16384
  v_mfma_f32_16x16x32_bf16 v[48:51], a[172:175], a[32:35], v[48:51]
  s_waitcnt vmcnt(47) lgkmcnt(5)
  v_mfma_f32_16x16x32_bf16 v[32:35], a[180:183], a[64:67], v[32:35]
  ds_read_b64_tr_b16 a[170:171], v8 offset:18432
  s_add_u32 m0, s31, 16384
  s_waitcnt vmcnt(8)
  s_barrier
  v_mfma_f32_16x16x32_bf16 v[32:35], a[184:187], a[80:83], v[32:35]
  buffer_load_dwordx4 v10, s[8:11], s45 offen lds
  v_mfma_f32_16x16x32_bf16 v[36:39], a[184:187], a[84:87], v[36:39]
  ds_read_b64_tr_b16 a[172:173], v8 offset:20480
  v_mfma_f32_16x16x32_bf16 v[36:39], a[180:183], a[68:71], v[36:39]
  v_mfma_f32_16x16x32_bf16 v[40:43], a[180:183], a[72:75], v[40:43]
  ds_read_b64_tr_b16 a[174:175], v8 offset:22528
  s_add_u32 m0, s31, 114688
  v_mfma_f32_16x16x32_bf16 v[40:43], a[184:187], a[88:91], v[40:43]
  buffer_load_dwordx4 v11, s[8:11], s47 offen lds
  v_mfma_f32_16x16x32_bf16 v[44:47], a[184:187], a[92:95], v[44:47]
HOP11:
  s_cbranch_execz HOP15
  ds_read_b64_tr_b16 a[176:177], v8 offset:24576
  v_mfma_f32_16x16x32_bf16 v[44:47], a[180:183], a[76:79], v[44:47]
  s_waitcnt lgkmcnt(5)
  v_mfma_f32_16x16x32_bf16 v[60:63], a[160:163], a[76:79], v[60:63]
  ds_read_b64_tr_b16 a[178:179], v8 offset:26624
  s_add_u32 m0, s31, 122880
  v_mfma_f32_16x16x32_bf16 v[60:63], a[164:167], a[92:95], v[60:63]
  buffer_load_dwordx4 v11, s[12:15], s47 offen lds
  v_mfma_f32_16x16x32_bf16 v[56:59], a[164:167], a[88:91], v[56:59]
  ds_read_b64_tr_b16 a[180:181], v8 offset:28672
  v_mfma_f32_16x16x32_bf16 v[56:59], a[160:163], a[72:75], v[56:59]
  v_mfma_f32_16x16x32_bf16 v[52:55], a[160:163], a[68:71], v[52:55]
  ds_read_b64_tr_b16 a[182:183], v8 offset:30720
  s_add_u32 m0, s31, 118784
  s_add_u32 s37, s47, 229376
  v_mfma_f32_16x16x32_bf16 v[52:55], a[164:167], a[84:87], v[52:55]
  buffer_load_dwordx4 v11, s[8:11], s37 offen lds
  v_mfma_f32_16x16x32_bf16 v[48:51], a[164:167], a[80:83], v[48:51]
  ds_read_b64_tr_b16 a[184:185], v8 offset:32768
  v_mfma_f32_16x16x32_bf16 v[48:51], a[160:163], a[64:67], v[48:51]
  s_waitcnt vmcnt(38) lgkmcnt(5)
  v_mfma_f32_16x16x32_bf16 v[32:35], a[168:171], a[96:99], v[32:35]
  ds_read_b64_tr_b16 a[186:187], v8 offset:34816
  s_add_u32 m0, s31, 126976
  s_add_u32 s37, s47, 229376
  v_mfma_f32_16x16x32_bf16 v[32:35], a[172:175], a[112:115], v[32:35]
  buffer_load_dwordx4 v11, s[12:15], s37 offen lds
  v_mfma_f32_16x16x32_bf16 v[36:39], a[172:175], a[116:119], v[36:39]
  ds_read_b64_tr_b16 a[160:161], v8 offset:36864
  v_mfma_f32_16x16x32_bf16 v[36:39], a[168:171], a[100:103], v[36:39]
  v_mfma_f32_16x16x32_bf16 v[40:43], a[168:171], a[104:107], v[40:43]
  ds_read_b64_tr_b16 a[162:163], v8 offset:38912
  s_add_u32 s38, s68, 10240
  v_mfma_f32_16x16x32_bf16 v[40:43], a[172:175], a[120:123], v[40:43]
  buffer_load_dword v14, v13, s[16:19], s38 offen
  v_mfma_f32_16x16x32_bf16 v[44:47], a[172:175], a[124:127], v[44:47]
  ds_read_b64_tr_b16 a[164:165], v8 offset:40960
  v_mfma_f32_16x16x32_bf16 v[44:47], a[168:171], a[108:111], v[44:47]
  s_waitcnt lgkmcnt(5)
  v_mfma_f32_16x16x32_bf16 v[60:63], a[176:179], a[108:111], v[60:63]
  ds_read_b64_tr_b16 a[166:167], v8 offset:43008
  v_mfma_f32_16x16x32_bf16 v[60:63], a[180:183], a[124:127], v[60:63]
  v_mfma_f32_16x16x32_bf16 v[56:59], a[180:183], a[120:123], v[56:59]
  ds_read_b64_tr_b16 a[168:169], v8 offset:45056
  v_mfma_f32_16x16x32_bf16 v[56:59], a[176:179], a[104:107], v[56:59]
  v_mfma_f32_16x16x32_bf16 v[52:55], a[176:179], a[100:103], v[52:55]
  ds_read_b64_tr_b16 a[170:171], v8 offset:47104
  s_add_u32 m0, s31, 24576
  v_mfma_f32_16x16x32_bf16 v[52:55], a[180:183], a[116:119], v[52:55]
  buffer_load_dwordx4 v10, s[12:15], s45 offen lds
  v_mfma_f32_16x16x32_bf16 v[48:51], a[180:183], a[112:115], v[48:51]
  ds_read_b64_tr_b16 a[172:173], v6 offset:0
  v_mfma_f32_16x16x32_bf16 v[48:51], a[176:179], a[96:99], v[48:51]
  s_waitcnt vmcnt(24) lgkmcnt(5)
  v_mfma_f32_16x16x32_bf16 v[32:35], a[184:187], a[128:131], v[32:35]
  ds_read_b64_tr_b16 a[174:175], v6 offset:2048
  s_add_u32 m0, s31, 20480
  s_add_u32 s37, s45, 229376
  v_mfma_f32_16x16x32_bf16 v[32:35], a[160:163], a[144:147], v[32:35]
  buffer_load_dwordx4 v10, s[8:11], s37 offen lds
  v_mfma_f32_16x16x32_bf16 v[36:39], a[160:163], a[148:151], v[36:39]
  ds_read_b64_tr_b16 a[176:177], v6 offset:4096
  v_mfma_f32_16x16x32_bf16 v[36:39], a[184:187], a[132:135], v[36:39]
  v_mfma_f32_16x16x32_bf16 v[40:43], a[184:187], a[136:139], v[40:43]
  ds_read_b64_tr_b16 a[178:179], v6 offset:6144
  s_add_u32 m0, s31, 28672
  s_add_u32 s37, s45, 229376
  v_mfma_f32_16x16x32_bf16 v[40:43], a[160:163], a[152:155], v[40:43]
  buffer_load_dwordx4 v10, s[12:15], s37 offen lds
  v_mfma_f32_16x16x32_bf16 v[44:47], a[160:163], a[156:159], v[44:47]
  ds_read_b64_tr_b16 a[180:181], v6 offset:8192
  v_mfma_f32_16x16x32_bf16 v[44:47], a[184:187], a[140:143], v[44:47]
  s_waitcnt lgkmcnt(5)
  v_mfma_f32_16x16x32_bf16 v[60:63], a[164:167], a[140:143], v[60:63]
  ds_read_b64_tr_b16 a[182:183], v6 offset:10240
  s_add_u32 m0, s31, 32768
  v_mfma_f32_16x16x32_bf16 v[60:63], a[168:171], a[156:159], v[60:63]
  buffer_load_dwordx4 v10, s[8:11], s46 offen lds
  v_mfma_f32_16x16x32_bf16 v[56:59], a[168:171], a[152:155], v[56:59]
  ds_read_b64_tr_b16 a[184:185], v6 offset:12288
  v_mfma_f32_16x16x32_bf16 v[56:59], a[164:167], a[136:139], v[56:59]
  v_mfma_f32_16x16x32_bf16 v[52:55], a[164:167], a[132:135], v[52:55]
  ds_read_b64_tr_b16 a[186:187], v6 offset:14336
  s_add_u32 m0, s31, 40960
  v_mfma_f32_16x16x32_bf16 v[52:55], a[168:171], a[148:151], v[52:55]
  buffer_load_dwordx4 v10, s[12:15], s46 offen lds
  v_mfma_f32_16x16x32_bf16 v[48:51], a[168:171], a[144:147], v[48:51]
  ds_read_b64_tr_b16 a[160:161], v6 offset:16384
  v_mfma_f32_16x16x32_bf16 v[48:51], a[164:167], a[128:131], v[48:51]
  s_waitcnt lgkmcnt(5)
  v_mfma_f32_16x16x32_bf16 v[64:67], a[172:175], a[64:67], v[64:67]
  ds_read_b64_tr_b16 a[162:163], v6 offset:18432
  s_add_u32 m0, s31, 36864
  s_add_u32 s37, s46, 229376
  v_mfma_f32_16x16x32_bf16 v[64:67], a[176:179], a[80:83], v[64:67]
  buffer_load_dwordx4 v10, s[8:11], s37 offen lds
  v_mfma_f32_16x16x32_bf16 v[68:71], a[176:179], a[84:87], v[68:71]
  ds_read_b64_tr_b16 a[164:165], v6 offset:20480
  v_mfma_f32_16x16x32_bf16 v[68:71], a[172:175], a[68:71], v[68:71]
  v_mfma_f32_16x16x32_bf16 v[72:75], a[172:175], a[72:75], v[72:75]
  ds_read_b64_tr_b16 a[166:167], v6 offset:22528
  s_add_u32 m0, s31, 45056
  s_add_u32 s37, s46, 229376
  v_mfma_f32_16x16x32_bf16 v[72:75], a[176:179], a[88:91], v[72:75]
  buffer_load_dwordx4 v10, s[12:15], s37 offen lds
  v_mfma_f32_16x16x32_bf16 v[76:79], a[176:179], a[92:95], v[76:79]
  ds_read_b64_tr_b16 a[168:169], v6 offset:24576
  v_mfma_f32_16x16x32_bf16 v[76:79], a[172:175], a[76:79], v[76:79]
  s_waitcnt lgkmcnt(5)
  v_mfma_f32_16x16x32_bf16 v[92:95], a[180:183], a[76:79], v[92:95]
  ds_read_b64_tr_b16 a[170:171], v6 offset:26624
  v_mfma_f32_16x16x32_bf16 v[92:95], a[184:187], a[92:95], v[92:95]
  v_mfma_f32_16x16x32_bf16 v[88:91], a[184:187], a[88:91], v[88:91]
  ds_read_b64_tr_b16 a[172:173], v6 offset:28672
  v_mfma_f32_16x16x32_bf16 v[88:91], a[180:183], a[72:75], v[88:91]
  v_mfma_f32_16x16x32_bf16 v[84:87], a[180:183], a[68:71], v[84:87]
  ds_read_b64_tr_b16 a[174:175], v6 offset:30720
  v_mfma_f32_16x16x32_bf16 v[84:87], a[184:187], a[84:87], v[84:87]
  v_mfma_f32_16x16x32_bf16 v[80:83], a[184:187], a[80:83], v[80:83]
  ds_read_b64_tr_b16 a[176:177], v6 offset:32768
  v_mfma_f32_16x16x32_bf16 v[80:83], a[180:183], a[64:67], v[80:83]
  s_waitcnt lgkmcnt(5)
  v_mfma_f32_16x16x32_bf16 v[64:67], a[160:163], a[96:99], v[64:67]
  ds_read_b64_tr_b16 a[178:179], v6 offset:34816
  v_mfma_f32_16x16x32_bf16 v[64:67], a[164:167], a[112:115], v[64:67]
  v_mfma_f32_16x16x32_bf16 v[68:71], a[164:167], a[116:119], v[68:71]
  ds_read_b64_tr_b16 a[180:181], v6 offset:36864
  v_mfma_f32_16x16x32_bf16 v[68:71], a[160:163], a[100:103], v[68:71]
  v_mfma_f32_16x16x32_bf16 v[72:75], a[160:163], a[104:107], v[72:75]
  ds_read_b64_tr_b16 a[182:183], v6 offset:38912
  v_mfma_f32_16x16x32_bf16 v[72:75], a[164:167], a[120:123], v[72:75]
  v_mfma_f32_16x16x32_bf16 v[76:79], a[164:167], a[124:127], v[76:79]
  ds_read_b64_tr_b16 a[184:185], v6 offset:40960
  v_mfma_f32_16x16x32_bf16 v[76:79], a[160:163], a[108:111], v[76:79]
  s_waitcnt lgkmcnt(5)
  v_mfma_f32_16x16x32_bf16 v[92:95], a[168:171], a[108:111], v[92:95]
  ds_read_b64_tr_b16 a[186:187], v6 offset:43008
  v_mfma_f32_16x16x32_bf16 v[92:95], a[172:175], a[124:127], v[92:95]
  v_mfma_f32_16x16x32_bf16 v[88:91], a[172:175], a[120:123], v[88:91]
  ds_read_b64_tr_b16 a[160:161], v6 offset:45056
  v_mfma_f32_16x16x32_bf16 v[88:91], a[168:171], a[104:107], v[88:91]
  v_mfma_f32_16x16x32_bf16 v[84:87], a[168:171], a[100:103], v[84:87]
  ds_read_b64_tr_b16 a[162:163], v6 offset:47104
  v_mfma_f32_16x16x32_bf16 v[84:87], a[172:175], a[116:119], v[84:87]
  s_waitcnt vmcnt(8)
  s_barrier
  v_mfma_f32_16x16x32_bf16 v[80:83], a[172:175], a[112:115], v[80:83]
  ds_read_b64_tr_b16 a[164:165], v8 offset:49152
  v_mfma_f32_16x16x32_bf16 v[80:83], a[168:171], a[96:99], v[80:83]
  s_waitcnt lgkmcnt(5)
  v_mfma_f32_16x16x32_bf16 v[64:67], a[176:179], a[128:131], v[64:67]
  ds_read_b64_tr_b16 a[166:167], v8 offset:51200
  v_mfma_f32_16x16x32_bf16 v[64:67], a[180:183], a[144:147], v[64:67]
  v_mfma_f32_16x16x32_bf16 v[68:71], a[180:183], a[148:151], v[68:71]
  ds_read_b64_tr_b16 a[168:169], v8 offset:53248
  v_mfma_f32_16x16x32_bf16 v[68:71], a[176:179], a[132:135], v[68:71]
  v_mfma_f32_16x16x32_bf16 v[72:75], a[176:179], a[136:139], v[72:75]
  ds_read_b64_tr_b16 a[170:171], v8 offset:55296
  v_mfma_f32_16x16x32_bf16 v[72:75], a[180:183], a[152:155], v[72:75]
  v_mfma_f32_16x16x32_bf16 v[76:79], a[180:183], a[156:159], v[76:79]
  ds_read_b64_tr_b16 a[172:173], v8 offset:57344
  v_mfma_f32_16x16x32_bf16 v[76:79], a[176:179], a[140:143], v[76:79]
  s_waitcnt lgkmcnt(5)
  v_mfma_f32_16x16x32_bf16 v[92:95], a[184:187], a[140:143], v[92:95]
  ds_read_b64_tr_b16 a[174:175], v8 offset:59392
  v_mfma_f32_16x16x32_bf16 v[92:95], a[160:163], a[156:159], v[92:95]
  v_mfma_f32_16x16x32_bf16 v[88:91], a[160:163], a[152:155], v[88:91]
  ds_read_b64_tr_b16 a[176:177], v8 offset:61440
  v_mfma_f32_16x16x32_bf16 v[88:91], a[184:187], a[136:139], v[88:91]
  v_mfma_f32_16x16x32_bf16 v[84:87], a[184:187], a[132:135], v[84:87]
  ds_read_b64_tr_b16 a[178:179], v8 offset:63488
  v_mfma_f32_16x16x32_bf16 v[84:87], a[160:163], a[148:151], v[84:87]
  v_mfma_f32_16x16x32_bf16 v[80:83], a[160:163], a[144:147], v[80:83]
  ds_read_b64_tr_b16 a[180:181], v6 offset:49152
  v_mfma_f32_16x16x32_bf16 v[80:83], a[184:187], a[128:131], v[80:83]
  s_waitcnt vmcnt(13) lgkmcnt(5)
  v_mfma_f32_16x16x32_bf16 v[32:35], a[164:167], a[0:3], v[32:35]
  ds_read_b64_tr_b16 a[182:183], v6 offset:51200
  v_mfma_f32_16x16x32_bf16 v[32:35], a[168:171], a[16:19], v[32:35]
  v_mfma_f32_16x16x32_bf16 v[36:39], a[168:171], a[20:23], v[36:39]
  ds_read_b64_tr_b16 a[184:185], v6 offset:53248
  v_mfma_f32_16x16x32_bf16 v[36:39], a[164:167], a[4:7], v[36:39]
  v_mfma_f32_16x16x32_bf16 v[40:43], a[164:167], a[8:11], v[40:43]
  ds_read_b64_tr_b16 a[186:187], v6 offset:55296
  v_mfma_f32_16x16x32_bf16 v[40:43], a[168:171], a[24:27], v[40:43]
  v_mfma_f32_16x16x32_bf16 v[44:47], a[168:171], a[28:31], v[44:47]
  ds_read_b64_tr_b16 a[160:161], v6 offset:57344
  v_mfma_f32_16x16x32_bf16 v[44:47], a[164:167], a[12:15], v[44:47]
  s_waitcnt lgkmcnt(5)
  v_mfma_f32_16x16x32_bf16 v[60:63], a[172:175], a[12:15], v[60:63]
  ds_read_b64_tr_b16 a[162:163], v6 offset:59392
  v_mfma_f32_16x16x32_bf16 v[60:63], a[176:179], a[28:31], v[60:63]
  v_mfma_f32_16x16x32_bf16 v[56:59], a[176:179], a[24:27], v[56:59]
  ds_read_b64_tr_b16 a[164:165], v6 offset:61440
  v_mfma_f32_16x16x32_bf16 v[56:59], a[172:175], a[8:11], v[56:59]
  v_mfma_f32_16x16x32_bf16 v[52:55], a[172:175], a[4:7], v[52:55]
  ds_read_b64_tr_b16 a[166:167], v6 offset:63488
  v_mfma_f32_16x16x32_bf16 v[52:55], a[176:179], a[20:23], v[52:55]
  v_mfma_f32_16x16x32_bf16 v[48:51], a[176:179], a[16:19], v[48:51]
  ds_read_b64_tr_b16 a[168:169], v7 offset:0
  s_add_u32 s38, s68, 12288
  v_mfma_f32_16x16x32_bf16 v[48:51], a[172:175], a[0:3], v[48:51]
  buffer_load_dword v14, v13, s[16:19], s38 offen
  s_waitcnt lgkmcnt(5)
  v_mfma_f32_16x16x32_bf16 v[64:67], a[180:183], a[0:3], v[64:67]
  ds_read_b64_tr_b16 a[170:171], v7 offset:2048
  v_mfma_f32_16x16x32_bf16 v[64:67], a[184:187], a[16:19], v[64:67]
  v_mfma_f32_16x16x32_bf16 v[68:71], a[184:187], a[20:23], v[68:71]
  ds_read_b64_tr_b16 a[172:173], v7 offset:4096
  v_mul_f32 v24, v16, v32
  v_mul_f32 v25, v16, v33
  v_mul_f32 v26, v16, v34
  v_mfma_f32_16x16x32_bf16 v[68:71], a[180:183], a[4:7], v[68:71]
  v_mul_f32 v27, v16, v35
  v_mul_f32 v28, v18, v36
  v_mul_f32 v29, v18, v37
  v_mfma_f32_16x16x32_bf16 v[72:75], a[180:183], a[8:11], v[72:75]
  ds_read_b64_tr_b16 a[174:175], v7 offset:6144
  v_mul_f32 v30, v18, v38
  v_mul_f32 v31, v18, v39
  v_mfma_f32_16x16x32_bf16 v[72:75], a[184:187], a[24:27], v[72:75]
  v_exp_f32 v24, v24
  v_mul_f32 v48, v32, v48
  v_mfma_f32_16x16x32_bf16 v[76:79], a[184:187], a[28:31], v[76:79]
  ds_read_b64_tr_b16 a[176:177], v7 offset:8192
  v_exp_f32 v25, v25
  v_mul_f32 v49, v33, v49
  v_mfma_f32_16x16x32_bf16 v[76:79], a[180:183], a[12:15], v[76:79]
  v_exp_f32 v26, v26
  v_mul_f32 v50, v34, v50
  s_waitcnt lgkmcnt(5)
  v_mfma_f32_16x16x32_bf16 v[92:95], a[160:163], a[12:15], v[92:95]
  ds_read_b64_tr_b16 a[178:179], v7 offset:10240
  v_exp_f32 v27, v27
  v_mul_f32 v51, v35, v51
  v_mfma_f32_16x16x32_bf16 v[92:95], a[164:167], a[28:31], v[92:95]
  v_exp_f32 v28, v28
  v_mul_f32 v52, v36, v52
  v_mfma_f32_16x16x32_bf16 v[88:91], a[164:167], a[24:27], v[88:91]
  ds_read_b64_tr_b16 a[180:181], v7 offset:12288
  v_exp_f32 v29, v29
  v_mul_f32 v53, v37, v53
  v_mfma_f32_16x16x32_bf16 v[88:91], a[160:163], a[8:11], v[88:91]
  v_exp_f32 v30, v30
  v_mul_f32 v54, v38, v54
  v_mfma_f32_16x16x32_bf16 v[84:87], a[160:163], a[4:7], v[84:87]
  ds_read_b64_tr_b16 a[182:183], v7 offset:14336
  v_exp_f32 v31, v31
  v_mul_f32 v55, v39, v55
  v_mfma_f32_16x16x32_bf16 v[84:87], a[164:167], a[20:23], v[84:87]
  v_fma_f32 v24, v24, v17, v17
  v_fma_f32 v25, v25, v17, v17
  v_fma_f32 v26, v26, v17, v17
  v_mfma_f32_16x16x32_bf16 v[80:83], a[164:167], a[16:19], v[80:83]
  ds_read_b64_tr_b16 a[184:185], v7 offset:16384
  v_fma_f32 v27, v27, v17, v17
  v_fma_f32 v28, v28, v19, v19
  v_fma_f32 v29, v29, v19, v19
  v_mfma_f32_16x16x32_bf16 v[80:83], a[160:163], a[0:3], v[80:83]
  v_fma_f32 v30, v30, v19, v19
  v_fma_f32 v31, v31, v19, v19
  s_waitcnt lgkmcnt(5)
  v_mfma_f32_16x16x32_bf16 v[96:99], a[168:171], a[64:67], v[96:99]
  ds_read_b64_tr_b16 a[186:187], v7 offset:18432
  v_rcp_f32 v24, v24
  v_mfma_f32_16x16x32_bf16 v[96:99], a[172:175], a[80:83], v[96:99]
  v_rcp_f32 v25, v25
  v_rcp_f32 v26, v26
  v_mfma_f32_16x16x32_bf16 v[100:103], a[172:175], a[84:87], v[100:103]
  ds_read_b64_tr_b16 a[160:161], v7 offset:20480
  v_rcp_f32 v27, v27
  v_mfma_f32_16x16x32_bf16 v[100:103], a[168:171], a[68:71], v[100:103]
  v_rcp_f32 v28, v28
  v_rcp_f32 v29, v29
  v_mfma_f32_16x16x32_bf16 v[104:107], a[168:171], a[72:75], v[104:107]
  ds_read_b64_tr_b16 a[162:163], v7 offset:22528
  v_rcp_f32 v30, v30
  v_mfma_f32_16x16x32_bf16 v[104:107], a[172:175], a[88:91], v[104:107]
  v_rcp_f32 v31, v31
  v_mul_f32 v48, v48, v24
  v_mul_f32 v49, v49, v25
  v_mfma_f32_16x16x32_bf16 v[108:111], a[172:175], a[92:95], v[108:111]
  ds_read_b64_tr_b16 a[164:165], v7 offset:24576
  v_mul_f32 v50, v50, v26
  v_mul_f32 v51, v51, v27
  v_mul_f32 v52, v52, v28
  v_mfma_f32_16x16x32_bf16 v[108:111], a[168:171], a[76:79], v[108:111]
  v_mul_f32 v53, v53, v29
  v_mul_f32 v54, v54, v30
  s_waitcnt lgkmcnt(5)
  v_mfma_f32_16x16x32_bf16 v[124:127], a[176:179], a[76:79], v[124:127]
  ds_read_b64_tr_b16 a[166:167], v7 offset:26624
  v_mul_f32 v55, v55, v31
  v_cvt_pk_bf16_f32 v32, v48, v49
  v_cvt_pk_bf16_f32 v33, v50, v51
  v_mfma_f32_16x16x32_bf16 v[124:127], a[180:183], a[92:95], v[124:127]
  buffer_store_dwordx2 v[32:33], v1, s[4:7], s36 offen sc1
  v_cvt_pk_bf16_f32 v36, v52, v53
  v_mfma_f32_16x16x32_bf16 v[120:123], a[180:183], a[88:91], v[120:123]
  ds_read_b64_tr_b16 a[168:169], v7 offset:28672
  v_cvt_pk_bf16_f32 v37, v54, v55
  s_add_u32 s30, s36, 262144
  buffer_store_dwordx2 v[36:37], v1, s[4:7], s30 offen sc1
  v_mfma_f32_16x16x32_bf16 v[120:123], a[176:179], a[72:75], v[120:123]
  v_mul_f32 v24, v20, v40
  v_mul_f32 v25, v20, v41
  v_mul_f32 v26, v20, v42
  v_mfma_f32_16x16x32_bf16 v[116:119], a[176:179], a[68:71], v[116:119]
  ds_read_b64_tr_b16 a[170:171], v7 offset:30720
  v_mul_f32 v27, v20, v43
  v_mul_f32 v28, v22, v44
  v_mul_f32 v29, v22, v45
  v_mfma_f32_16x16x32_bf16 v[116:119], a[180:183], a[84:87], v[116:119]
  v_mul_f32 v30, v22, v46
  v_mul_f32 v31, v22, v47
  v_mfma_f32_16x16x32_bf16 v[112:115], a[180:183], a[80:83], v[112:115]
  ds_read_b64_tr_b16 a[172:173], v7 offset:32768
  v_exp_f32 v24, v24
  v_mul_f32 v56, v40, v56
  v_mfma_f32_16x16x32_bf16 v[112:115], a[176:179], a[64:67], v[112:115]
  v_exp_f32 v25, v25
  v_mul_f32 v57, v41, v57
  s_waitcnt lgkmcnt(5)
  v_mfma_f32_16x16x32_bf16 v[96:99], a[184:187], a[96:99], v[96:99]
  ds_read_b64_tr_b16 a[174:175], v7 offset:34816
  v_exp_f32 v26, v26
  v_mul_f32 v58, v42, v58
  v_mfma_f32_16x16x32_bf16 v[96:99], a[160:163], a[112:115], v[96:99]
  v_exp_f32 v27, v27
  v_mul_f32 v59, v43, v59
  v_mfma_f32_16x16x32_bf16 v[100:103], a[160:163], a[116:119], v[100:103]
  ds_read_b64_tr_b16 a[176:177], v7 offset:36864
  v_exp_f32 v28, v28
  v_mul_f32 v60, v44, v60
  v_mfma_f32_16x16x32_bf16 v[100:103], a[184:187], a[100:103], v[100:103]
  v_exp_f32 v29, v29
  v_mul_f32 v61, v45, v61
  v_mfma_f32_16x16x32_bf16 v[104:107], a[184:187], a[104:107], v[104:107]
  ds_read_b64_tr_b16 a[178:179], v7 offset:38912
  v_exp_f32 v30, v30
  v_mul_f32 v62, v46, v62
  v_mfma_f32_16x16x32_bf16 v[104:107], a[160:163], a[120:123], v[104:107]
  v_exp_f32 v31, v31
  v_mul_f32 v63, v47, v63
  v_mfma_f32_16x16x32_bf16 v[108:111], a[160:163], a[124:127], v[108:111]
  ds_read_b64_tr_b16 a[180:181], v7 offset:40960
  v_fma_f32 v24, v24, v21, v21
  v_fma_f32 v25, v25, v21, v21
  v_fma_f32 v26, v26, v21, v21
  v_mfma_f32_16x16x32_bf16 v[108:111], a[184:187], a[108:111], v[108:111]
  v_fma_f32 v27, v27, v21, v21
  v_fma_f32 v28, v28, v23, v23
  s_waitcnt lgkmcnt(5)
  v_mfma_f32_16x16x32_bf16 v[124:127], a[164:167], a[108:111], v[124:127]
  ds_read_b64_tr_b16 a[182:183], v7 offset:43008
  v_fma_f32 v29, v29, v23, v23
  v_fma_f32 v30, v30, v23, v23
  v_fma_f32 v31, v31, v23, v23
  v_mfma_f32_16x16x32_bf16 v[124:127], a[168:171], a[124:127], v[124:127]
  v_rcp_f32 v24, v24
  v_mfma_f32_16x16x32_bf16 v[120:123], a[168:171], a[120:123], v[120:123]
  ds_read_b64_tr_b16 a[184:185], v7 offset:45056
  v_rcp_f32 v25, v25
  v_rcp_f32 v26, v26
  v_mfma_f32_16x16x32_bf16 v[120:123], a[164:167], a[104:107], v[120:123]
  v_rcp_f32 v27, v27
  v_mfma_f32_16x16x32_bf16 v[116:119], a[164:167], a[100:103], v[116:119]
  ds_read_b64_tr_b16 a[186:187], v7 offset:47104
  v_rcp_f32 v28, v28
  v_rcp_f32 v29, v29
  v_mfma_f32_16x16x32_bf16 v[116:119], a[168:171], a[116:119], v[116:119]
  v_rcp_f32 v30, v30
  v_mfma_f32_16x16x32_bf16 v[112:115], a[168:171], a[112:115], v[112:115]
  ds_read_b64_tr_b16 a[160:161], v7 offset:49152
  v_rcp_f32 v31, v31
  v_mul_f32 v56, v56, v24
  v_mul_f32 v57, v57, v25
  v_mfma_f32_16x16x32_bf16 v[112:115], a[164:167], a[96:99], v[112:115]
  v_mul_f32 v58, v58, v26
  v_mul_f32 v59, v59, v27
  s_waitcnt lgkmcnt(5)
  v_mfma_f32_16x16x32_bf16 v[96:99], a[172:175], a[128:131], v[96:99]
  ds_read_b64_tr_b16 a[162:163], v7 offset:51200
  v_mul_f32 v60, v60, v28
  v_mul_f32 v61, v61, v29
  v_mul_f32 v62, v62, v30
  v_mfma_f32_16x16x32_bf16 v[96:99], a[176:179], a[144:147], v[96:99]
  v_mul_f32 v63, v63, v31
  v_cvt_pk_bf16_f32 v40, v56, v57
  v_cvt_pk_bf16_f32 v41, v58, v59
  v_mfma_f32_16x16x32_bf16 v[100:103], a[176:179], a[148:151], v[100:103]
  ds_read_b64_tr_b16 a[164:165], v7 offset:53248
  s_add_u32 s30, s36, 524288
  buffer_store_dwordx2 v[40:41], v1, s[4:7], s30 offen sc1
  v_cvt_pk_bf16_f32 v44, v60, v61
  v_mfma_f32_16x16x32_bf16 v[100:103], a[172:175], a[132:135], v[100:103]
  v_cvt_pk_bf16_f32 v45, v62, v63
  s_add_u32 s30, s36, 786432
  buffer_store_dwordx2 v[44:45], v1, s[4:7], s30 offen sc1
  v_mfma_f32_16x16x32_bf16 v[104:107], a[172:175], a[136:139], v[104:107]
  ds_read_b64_tr_b16 a[166:167], v7 offset:55296
  v_mul_f32 v24, v16, v64
  v_mul_f32 v25, v16, v65
  v_mul_f32 v26, v16, v66
  v_mfma_f32_16x16x32_bf16 v[104:107], a[176:179], a[152:155], v[104:107]
  v_mul_f32 v27, v16, v67
  v_mul_f32 v28, v18, v68
  v_mul_f32 v29, v18, v69
  v_mfma_f32_16x16x32_bf16 v[108:111], a[176:179], a[156:159], v[108:111]
  ds_read_b64_tr_b16 a[168:169], v7 offset:57344
  v_mul_f32 v30, v18, v70
  v_mul_f32 v31, v18, v71
  v_mfma_f32_16x16x32_bf16 v[108:111], a[172:175], a[140:143], v[108:111]
  v_exp_f32 v24, v24
  v_mul_f32 v80, v64, v80
  s_waitcnt lgkmcnt(5)
  v_mfma_f32_16x16x32_bf16 v[124:127], a[180:183], a[140:143], v[124:127]
  ds_read_b64_tr_b16 a[170:171], v7 offset:59392
  v_exp_f32 v25, v25
  v_mul_f32 v81, v65, v81
  v_mfma_f32_16x16x32_bf16 v[124:127], a[184:187], a[156:159], v[124:127]
  v_exp_f32 v26, v26
  v_mul_f32 v82, v66, v82
  v_mfma_f32_16x16x32_bf16 v[120:123], a[184:187], a[152:155], v[120:123]
  ds_read_b64_tr_b16 a[172:173], v7 offset:61440
  v_exp_f32 v27, v27
  v_mul_f32 v83, v67, v83
  v_mfma_f32_16x16x32_bf16 v[120:123], a[180:183], a[136:139], v[120:123]
  v_exp_f32 v28, v28
  v_mul_f32 v84, v68, v84
  v_mfma_f32_16x16x32_bf16 v[116:119], a[180:183], a[132:135], v[116:119]
  ds_read_b64_tr_b16 a[174:175], v7 offset:63488
  v_exp_f32 v29, v29
  v_mul_f32 v85, v69, v85
  v_mfma_f32_16x16x32_bf16 v[116:119], a[184:187], a[148:151], v[116:119]
  v_lshrrev_b32 v52, 4, v1
  v_lshrrev_b32 v48, 3, v52
  v_bfe_u32 v49, v48, 1, 2
  v_mfma_f32_16x16x32_bf16 v[112:115], a[184:187], a[144:147], v[112:115]
  ds_read_b64_tr_b16 a[176:177], v2 offset:49152
  v_bfe_u32 v50, v52, 1, 2
  v_xor_b32 v49, v49, v50
  v_lshlrev_b32 v49, 5, v49
  v_mfma_f32_16x16x32_bf16 v[112:115], a[180:183], a[128:131], v[112:115]
  v_and_b32 v50, 1, v52
  v_lshl_add_u32 v49, v50, 4, v49
  s_waitcnt lgkmcnt(5)
  v_mfma_f32_16x16x32_bf16 v[96:99], a[160:163], a[0:3], v[96:99]
  ds_read_b64_tr_b16 a[178:179], v2 offset:51200
  s_lshl_b32 s28, s27, 6
  v_xor_b32 v49, s28, v49
  s_lshl_b32 s28, s24, 3
  v_mfma_f32_16x16x32_bf16 v[96:99], a[164:167], a[16:19], v[96:99]
  v_add_u32 v48, s28, v48
  v_lshl_add_u32 v48, v48, 11, v49
  s_mul_i32 s28, s27, 1835008
  v_mfma_f32_16x16x32_bf16 v[100:103], a[164:167], a[20:23], v[100:103]
  ds_read_b64_tr_b16 a[180:181], v2 offset:53248
  s_lshl_b32 s29, s26, 8
  s_add_u32 s28, s28, s29
  v_add_u32 v33, s28, v48
  v_mfma_f32_16x16x32_bf16 v[100:103], a[160:163], a[4:7], v[100:103]
  v_xor_b32 v32, 128, v33
  v_and_b32 v48, 3, v52
  v_bfe_u32 v49, v52, 2, 1
  v_mfma_f32_16x16x32_bf16 v[104:107], a[160:163], a[8:11], v[104:107]
  ds_read_b64_tr_b16 a[182:183], v2 offset:55296
  v_lshl_add_u32 v48, v48, 3, v49
  v_lshlrev_b32 v37, 7, v48
  v_mfma_f32_16x16x32_bf16 v[104:107], a[164:167], a[24:27], v[104:107]
  v_exp_f32 v30, v30
  v_mul_f32 v86, v70, v86
  v_mfma_f32_16x16x32_bf16 v[108:111], a[164:167], a[28:31], v[108:111]
  ds_read_b64_tr_b16 a[184:185], v2 offset:57344
  v_exp_f32 v31, v31
  v_mul_f32 v87, v71, v87
  v_fma_f32 v24, v24, v17, v17
  v_mfma_f32_16x16x32_bf16 v[108:111], a[160:163], a[12:15], v[108:111]
  v_fma_f32 v25, v25, v17, v17
  v_fma_f32 v26, v26, v17, v17
  s_waitcnt lgkmcnt(5)
  v_mfma_f32_16x16x32_bf16 v[124:127], a[168:171], a[12:15], v[124:127]
  ds_read_b64_tr_b16 a[186:187], v2 offset:59392
  v_fma_f32 v27, v27, v17, v17
  v_fma_f32 v28, v28, v19, v19
  v_fma_f32 v29, v29, v19, v19
  v_mfma_f32_16x16x32_bf16 v[124:127], a[172:175], a[28:31], v[124:127]
  v_fma_f32 v30, v30, v19, v19
  v_fma_f32 v31, v31, v19, v19
  v_mfma_f32_16x16x32_bf16 v[120:123], a[172:175], a[24:27], v[120:123]
  ds_read_b64_tr_b16 a[160:161], v2 offset:61440
  v_rcp_f32 v24, v24
  v_rcp_f32 v25, v25
  v_mfma_f32_16x16x32_bf16 v[120:123], a[168:171], a[8:11], v[120:123]
  v_rcp_f32 v26, v26
  v_mfma_f32_16x16x32_bf16 v[116:119], a[168:171], a[4:7], v[116:119]
  ds_read_b64_tr_b16 a[162:163], v2 offset:63488
  v_rcp_f32 v27, v27
  v_rcp_f32 v28, v28
  v_mfma_f32_16x16x32_bf16 v[116:119], a[172:175], a[20:23], v[116:119]
  v_rcp_f32 v29, v29
  v_mfma_f32_16x16x32_bf16 v[112:115], a[172:175], a[16:19], v[112:115]
  ds_read_b64_tr_b16 a[164:165], v3 offset:49152
  v_rcp_f32 v30, v30
  v_rcp_f32 v31, v31
  v_mfma_f32_16x16x32_bf16 v[112:115], a[168:171], a[0:3], v[112:115]
  v_mul_f32 v80, v80, v24
  v_mul_f32 v81, v81, v25
  s_waitcnt lgkmcnt(5)
  v_mfma_f32_16x16x32_bf16 v[128:131], a[176:179], a[32:35], v[128:131]
  ds_read_b64_tr_b16 a[166:167], v3 offset:51200
  v_mul_f32 v82, v82, v26
  s_waitcnt vmcnt(9)
  s_barrier
  v_mfma_f32_16x16x32_bf16 v[128:131], a[180:183], a[48:51], v[128:131]
  v_mul_f32 v83, v83, v27
  v_mul_f32 v84, v84, v28
  v_mul_f32 v85, v85, v29
  v_mfma_f32_16x16x32_bf16 v[132:135], a[180:183], a[52:55], v[132:135]
  ds_read_b64_tr_b16 a[168:169], v3 offset:53248
  v_mul_f32 v86, v86, v30
  v_mul_f32 v87, v87, v31
  v_cvt_pk_bf16_f32 v64, v80, v81
  v_mfma_f32_16x16x32_bf16 v[132:135], a[176:179], a[36:39], v[132:135]
  v_cvt_pk_bf16_f32 v65, v82, v83
  v_cvt_pk_bf16_f32 v68, v84, v85
  v_cvt_pk_bf16_f32 v69, v86, v87
  v_mfma_f32_16x16x32_bf16 v[136:139], a[176:179], a[40:43], v[136:139]
  ds_read_b64_tr_b16 a[170:171], v3 offset:55296
  v_mul_f32 v24, v20, v72
  v_mul_f32 v25, v20, v73
  v_mul_f32 v26, v20, v74
  v_mfma_f32_16x16x32_bf16 v[136:139], a[180:183], a[56:59], v[136:139]
  v_mul_f32 v27, v20, v75
  v_mul_f32 v28, v22, v76
  v_mul_f32 v29, v22, v77
  v_mfma_f32_16x16x32_bf16 v[140:143], a[180:183], a[60:63], v[140:143]
  ds_read_b64_tr_b16 a[172:173], v3 offset:57344
  v_mul_f32 v30, v22, v78
  v_mul_f32 v31, v22, v79
  v_mfma_f32_16x16x32_bf16 v[140:143], a[176:179], a[44:47], v[140:143]
  v_exp_f32 v24, v24
  v_mul_f32 v88, v72, v88
  s_waitcnt lgkmcnt(5)
  v_mfma_f32_16x16x32_bf16 v[156:159], a[184:187], a[44:47], v[156:159]
  ds_read_b64_tr_b16 a[174:175], v3 offset:59392
  s_add_u32 s38, s68, 14336
  v_exp_f32 v25, v25
  v_mfma_f32_16x16x32_bf16 v[156:159], a[160:163], a[60:63], v[156:159]
  buffer_load_dword v14, v13, s[16:19], s38 offen
  v_mul_f32 v89, v73, v89
  v_mfma_f32_16x16x32_bf16 v[152:155], a[160:163], a[56:59], v[152:155]
  ds_read_b64_tr_b16 a[176:177], v3 offset:61440
  v_exp_f32 v26, v26
  v_mul_f32 v90, v74, v90
  v_mfma_f32_16x16x32_bf16 v[152:155], a[184:187], a[40:43], v[152:155]
  v_exp_f32 v27, v27
  v_mul_f32 v91, v75, v91
  v_mfma_f32_16x16x32_bf16 v[148:151], a[184:187], a[36:39], v[148:151]
  ds_read_b64_tr_b16 a[178:179], v3 offset:63488
  v_exp_f32 v28, v28
  v_mul_f32 v92, v76, v92
  v_mfma_f32_16x16x32_bf16 v[148:151], a[160:163], a[52:55], v[148:151]
  v_exp_f32 v29, v29
  v_mul_f32 v93, v77, v93
  v_mfma_f32_16x16x32_bf16 v[144:147], a[160:163], a[48:51], v[144:147]
  ds_read_b64_tr_b16 a[180:181], v4 offset:49152
  v_exp_f32 v30, v30
  v_mul_f32 v94, v78, v94
  v_mfma_f32_16x16x32_bf16 v[144:147], a[184:187], a[32:35], v[144:147]
  v_exp_f32 v31, v31
  v_mul_f32 v95, v79, v95
  s_waitcnt lgkmcnt(5)
  v_mfma_f32_16x16x32_bf16 v[160:163], a[164:167], a[32:35], v[160:163]
  ds_read_b64_tr_b16 a[182:183], v4 offset:51200
  v_fma_f32 v24, v24, v21, v21
  v_fma_f32 v25, v25, v21, v21
  v_fma_f32 v26, v26, v21, v21
  v_mfma_f32_16x16x32_bf16 v[160:163], a[168:171], a[48:51], v[160:163]
  v_fma_f32 v27, v27, v21, v21
  v_fma_f32 v28, v28, v23, v23
  v_fma_f32 v29, v29, v23, v23
  v_mfma_f32_16x16x32_bf16 v[164:167], a[168:171], a[52:55], v[164:167]
  ds_read_b64_tr_b16 a[184:185], v4 offset:53248
  v_fma_f32 v30, v30, v23, v23
  v_fma_f32 v31, v31, v23, v23
  v_mfma_f32_16x16x32_bf16 v[164:167], a[164:167], a[36:39], v[164:167]
  v_rcp_f32 v24, v24
  v_rcp_f32 v25, v25
  v_mfma_f32_16x16x32_bf16 v[168:171], a[164:167], a[40:43], v[168:171]
  ds_read_b64_tr_b16 a[186:187], v4 offset:55296
  v_rcp_f32 v26, v26
  v_mfma_f32_16x16x32_bf16 v[168:171], a[168:171], a[56:59], v[168:171]
  v_rcp_f32 v27, v27
  v_rcp_f32 v28, v28
  v_mfma_f32_16x16x32_bf16 v[172:175], a[168:171], a[60:63], v[172:175]
  ds_read_b64_tr_b16 a[160:161], v4 offset:57344
  v_rcp_f32 v29, v29
  v_mfma_f32_16x16x32_bf16 v[172:175], a[164:167], a[44:47], v[172:175]
  v_rcp_f32 v30, v30
  s_waitcnt lgkmcnt(5)
  v_mfma_f32_16x16x32_bf16 v[188:191], a[172:175], a[44:47], v[188:191]
  ds_read_b64_tr_b16 a[162:163], v4 offset:59392
  v_rcp_f32 v31, v31
  v_mul_f32 v88, v88, v24
  v_mul_f32 v89, v89, v25
  v_mfma_f32_16x16x32_bf16 v[188:191], a[176:179], a[60:63], v[188:191]
  v_mul_f32 v90, v90, v26
  v_mul_f32 v91, v91, v27
  v_mul_f32 v92, v92, v28
  v_mfma_f32_16x16x32_bf16 v[184:187], a[176:179], a[56:59], v[184:187]
  ds_read_b64_tr_b16 a[164:165], v4 offset:61440
HOP12:
  s_cbranch_execz HOP16
  v_mul_f32 v93, v93, v29
  v_mul_f32 v94, v94, v30
  v_mul_f32 v95, v95, v31
  v_mfma_f32_16x16x32_bf16 v[184:187], a[172:175], a[40:43], v[184:187]
  v_cvt_pk_bf16_f32 v72, v88, v89
  v_cvt_pk_bf16_f32 v73, v90, v91
  v_cvt_pk_bf16_f32 v76, v92, v93
  v_cvt_pk_bf16_f32 v77, v94, v95
  v_mfma_f32_16x16x32_bf16 v[180:183], a[172:175], a[36:39], v[180:183]
  ds_read_b64_tr_b16 a[166:167], v4 offset:63488
  s_cmp_eq_u32 s67, 0
  s_cselect_b32 s48, 8, 1
  s_lshl_b32 s40, s48, 17
  s_lshl_b32 s48, s48, 11
  s_add_u32 s48, s48, s60
  s_add_u32 m0, s31, 65536
  v_mul_f32 v24, v16, v96
  v_mul_f32 v25, v16, v97
  v_mfma_f32_16x16x32_bf16 v[180:183], a[176:179], a[52:55], v[180:183]
  buffer_load_dwordx4 v32, s[16:19], s40 offen lds
  v_mul_f32 v26, v16, v98
  v_mul_f32 v27, v16, v99
  v_mul_f32 v28, v18, v100
  v_mfma_f32_16x16x32_bf16 v[176:179], a[176:179], a[48:51], v[176:179]
  ds_read_b64_tr_b16 a[168:169], v5 offset:49152
  v_mul_f32 v29, v18, v101
  v_mul_f32 v30, v18, v102
  v_mul_f32 v31, v18, v103
  v_mfma_f32_16x16x32_bf16 v[176:179], a[172:175], a[32:35], v[176:179]
  v_exp_f32 v24, v24
  v_mul_f32 v112, v96, v112
  s_waitcnt lgkmcnt(5)
  v_mfma_f32_16x16x32_bf16 v[192:195], a[180:183], a[32:35], v[192:195]
  ds_read_b64_tr_b16 a[170:171], v5 offset:51200
  s_add_u32 m0, s31, 69632
  s_add_u32 s37, s40, 65536
  v_exp_f32 v25, v25
  v_mfma_f32_16x16x32_bf16 v[192:195], a[184:187], a[48:51], v[192:195]
  buffer_load_dwordx4 v32, s[16:19], s37 offen lds
  v_mul_f32 v113, v97, v113
  v_exp_f32 v26, v26
  v_mfma_f32_16x16x32_bf16 v[196:199], a[184:187], a[52:55], v[196:199]
  ds_read_b64_tr_b16 a[172:173], v5 offset:53248
  v_mul_f32 v114, v98, v114
  v_exp_f32 v27, v27
  v_mfma_f32_16x16x32_bf16 v[196:199], a[180:183], a[36:39], v[196:199]
  v_mul_f32 v115, v99, v115
  v_exp_f32 v28, v28
  v_mul_f32 v116, v100, v116
  v_mfma_f32_16x16x32_bf16 v[200:203], a[180:183], a[40:43], v[200:203]
  ds_read_b64_tr_b16 a[174:175], v5 offset:55296
  s_add_u32 m0, s31, 73728
  v_exp_f32 v29, v29
  v_mul_f32 v117, v101, v117
  v_mfma_f32_16x16x32_bf16 v[200:203], a[184:187], a[56:59], v[200:203]
  buffer_load_dwordx4 v33, s[16:19], s40 offen lds
  v_exp_f32 v30, v30
  v_mul_f32 v118, v102, v118
  v_mfma_f32_16x16x32_bf16 v[204:207], a[184:187], a[60:63], v[204:207]
  ds_read_b64_tr_b16 a[176:177], v5 offset:57344
  v_exp_f32 v31, v31
  v_mul_f32 v119, v103, v119
  v_mfma_f32_16x16x32_bf16 v[204:207], a[180:183], a[44:47], v[204:207]
  v_fma_f32 v24, v24, v17, v17
  v_fma_f32 v25, v25, v17, v17
  v_fma_f32 v26, v26, v17, v17
  s_waitcnt lgkmcnt(5)
  v_mfma_f32_16x16x32_bf16 v[220:223], a[160:163], a[44:47], v[220:223]
  ds_read_b64_tr_b16 a[178:179], v5 offset:59392
  s_add_u32 m0, s31, 77824
  s_add_u32 s37, s40, 65536
  v_fma_f32 v27, v27, v17, v17
  v_mfma_f32_16x16x32_bf16 v[220:223], a[164:167], a[60:63], v[220:223]
  buffer_load_dwordx4 v33, s[16:19], s37 offen lds
  v_fma_f32 v28, v28, v19, v19
  v_fma_f32 v29, v29, v19, v19
  v_fma_f32 v30, v30, v19, v19
  v_fma_f32 v31, v31, v19, v19
  v_mfma_f32_16x16x32_bf16 v[216:219], a[164:167], a[56:59], v[216:219]
  ds_read_b64_tr_b16 a[180:181], v5 offset:61440
  v_rcp_f32 v24, v24
  v_mfma_f32_16x16x32_bf16 v[216:219], a[160:163], a[40:43], v[216:219]
  v_rcp_f32 v25, v25
  v_rcp_f32 v26, v26
  v_mfma_f32_16x16x32_bf16 v[212:215], a[160:163], a[36:39], v[212:215]
  ds_read_b64_tr_b16 a[182:183], v5 offset:63488
  s_cmp_eq_u32 s67, 1
  s_cselect_b32 s49, 10, 3
  s_lshl_b32 s41, s49, 17
  s_lshl_b32 s49, s49, 11
  s_add_u32 s49, s49, s60
  s_add_u32 m0, s31, 81920
  v_rcp_f32 v27, v27
  v_mfma_f32_16x16x32_bf16 v[212:215], a[164:167], a[52:55], v[212:215]
  buffer_load_dwordx4 v32, s[16:19], s41 offen lds
  v_rcp_f32 v28, v28
  v_rcp_f32 v29, v29
  v_mfma_f32_16x16x32_bf16 v[208:211], a[164:167], a[48:51], v[208:211]
  ds_read_b64_tr_b16 a[184:185], v2 offset:0
  v_rcp_f32 v30, v30
  v_mfma_f32_16x16x32_bf16 v[208:211], a[160:163], a[32:35], v[208:211]
  v_rcp_f32 v31, v31
  v_mul_f32 v112, v112, v24
  v_mul_f32 v113, v113, v25
  s_waitcnt lgkmcnt(5)
  v_mfma_f32_16x16x32_bf16 v[224:227], a[168:171], a[32:35], v[224:227]
  ds_read_b64_tr_b16 a[186:187], v2 offset:2048
  s_add_u32 m0, s31, 86016
  s_add_u32 s37, s41, 65536
  v_mul_f32 v114, v114, v26
  v_mfma_f32_16x16x32_bf16 v[224:227], a[172:175], a[48:51], v[224:227]
  buffer_load_dwordx4 v32, s[16:19], s37 offen lds
  v_mul_f32 v115, v115, v27
  v_mul_f32 v116, v116, v28
  v_mul_f32 v117, v117, v29
  v_mul_f32 v118, v118, v30
  v_mfma_f32_16x16x32_bf16 v[228:231], a[172:175], a[52:55], v[228:231]
  ds_read_b64_tr_b16 a[160:161], v2 offset:4096
  v_mul_f32 v119, v119, v31
  v_cvt_pk_bf16_f32 v66, v112, v113
  v_cvt_pk_bf16_f32 v67, v114, v115
  v_mfma_f32_16x16x32_bf16 v[228:231], a[168:171], a[36:39], v[228:231]
  buffer_store_dwordx4 v[64:67], v1, s[4:7], s35 offen offset:0 sc1
  v_cvt_pk_bf16_f32 v70, v116, v117
  v_cvt_pk_bf16_f32 v71, v118, v119
  v_mfma_f32_16x16x32_bf16 v[232:235], a[168:171], a[40:43], v[232:235]
  ds_read_b64_tr_b16 a[162:163], v2 offset:6144
  s_add_u32 m0, s31, 90112
  s_add_u32 s30, s35, 262144
  buffer_store_dwordx4 v[68:71], v1, s[4:7], s30 offen offset:0 sc1
  v_mfma_f32_16x16x32_bf16 v[232:235], a[172:175], a[56:59], v[232:235]
  buffer_load_dwordx4 v33, s[16:19], s41 offen lds
  v_mul_f32 v24, v20, v104
  v_mul_f32 v25, v20, v105
  v_mul_f32 v26, v20, v106
  v_mfma_f32_16x16x32_bf16 v[236:239], a[172:175], a[60:63], v[236:239]
  ds_read_b64_tr_b16 a[164:165], v2 offset:8192
  v_mul_f32 v27, v20, v107
  v_mul_f32 v28, v22, v108
  v_mul_f32 v29, v22, v109
  v_mfma_f32_16x16x32_bf16 v[236:239], a[168:171], a[44:47], v[236:239]
  v_mul_f32 v30, v22, v110
  v_mul_f32 v31, v22, v111
  v_exp_f32 v24, v24
  s_waitcnt lgkmcnt(5)
  v_mfma_f32_16x16x32_bf16 v[252:255], a[176:179], a[44:47], v[252:255]
  ds_read_b64_tr_b16 a[166:167], v2 offset:10240
  s_add_u32 m0, s31, 94208
  s_add_u32 s37, s41, 65536
  v_mul_f32 v120, v104, v120
  v_mfma_f32_16x16x32_bf16 v[252:255], a[180:183], a[60:63], v[252:255]
  buffer_load_dwordx4 v33, s[16:19], s37 offen lds
  v_exp_f32 v25, v25
  v_mul_f32 v121, v105, v121
  v_mfma_f32_16x16x32_bf16 v[248:251], a[180:183], a[56:59], v[248:251]
  ds_read_b64_tr_b16 a[168:169], v2 offset:12288
  v_exp_f32 v26, v26
  v_mul_f32 v122, v106, v122
  v_mfma_f32_16x16x32_bf16 v[248:251], a[176:179], a[40:43], v[248:251]
  v_exp_f32 v27, v27
  v_mul_f32 v123, v107, v123
  v_mfma_f32_16x16x32_bf16 v[244:247], a[176:179], a[36:39], v[244:247]
  ds_read_b64_tr_b16 a[170:171], v2 offset:14336
  s_cmp_eq_u32 s67, 2
  s_cselect_b32 s50, 12, 5
  s_lshl_b32 s42, s50, 17
  s_lshl_b32 s50, s50, 11
  s_add_u32 s50, s50, s60
  s_add_u32 m0, s31, 98304
  v_exp_f32 v28, v28
  v_mul_f32 v124, v108, v124
  v_mfma_f32_16x16x32_bf16 v[244:247], a[180:183], a[52:55], v[244:247]
  buffer_load_dwordx4 v32, s[16:19], s42 offen lds
  v_exp_f32 v29, v29
  v_mul_f32 v125, v109, v125
  v_mfma_f32_16x16x32_bf16 v[240:243], a[180:183], a[48:51], v[240:243]
  ds_read_b64_tr_b16 a[172:173], v2 offset:16384
  v_exp_f32 v30, v30
  v_mul_f32 v126, v110, v126
  v_mfma_f32_16x16x32_bf16 v[240:243], a[176:179], a[32:35], v[240:243]
  v_exp_f32 v31, v31
  v_mul_f32 v127, v111, v127
  v_fma_f32 v24, v24, v21, v21
  s_waitcnt lgkmcnt(5)
  v_mfma_f32_16x16x32_bf16 v[128:131], a[184:187], a[64:67], v[128:131]
  ds_read_b64_tr_b16 a[174:175], v2 offset:18432
  s_add_u32 m0, s31, 102400
  s_add_u32 s37, s42, 65536
  s_waitcnt vmcnt(17)
  s_barrier
  v_mfma_f32_16x16x32_bf16 v[128:131], a[160:163], a[80:83], v[128:131]
  buffer_load_dwordx4 v32, s[16:19], s37 offen lds
  v_fma_f32 v25, v25, v21, v21
  v_fma_f32 v26, v26, v21, v21
  v_mfma_f32_16x16x32_bf16 v[132:135], a[160:163], a[84:87], v[132:135]
  ds_read_b64_tr_b16 a[176:177], v2 offset:20480
  v_fma_f32 v27, v27, v21, v21
  v_fma_f32 v28, v28, v23, v23
  v_fma_f32 v29, v29, v23, v23
  v_mfma_f32_16x16x32_bf16 v[132:135], a[184:187], a[68:71], v[132:135]
  v_fma_f32 v30, v30, v23, v23
  v_fma_f32 v31, v31, v23, v23
  v_rcp_f32 v24, v24
  v_mfma_f32_16x16x32_bf16 v[136:139], a[184:187], a[72:75], v[136:139]
  ds_read_b64_tr_b16 a[178:179], v2 offset:22528
  s_add_u32 m0, s31, 49152
  v_rcp_f32 v25, v25
  v_mfma_f32_16x16x32_bf16 v[136:139], a[160:163], a[88:91], v[136:139]
  buffer_load_dwordx4 v10, s[8:11], s47 offen lds
  v_rcp_f32 v26, v26
  v_rcp_f32 v27, v27
  v_mfma_f32_16x16x32_bf16 v[140:143], a[160:163], a[92:95], v[140:143]
  ds_read_b64_tr_b16 a[180:181], v2 offset:24576
  v_rcp_f32 v28, v28
  v_mfma_f32_16x16x32_bf16 v[140:143], a[184:187], a[76:79], v[140:143]
  v_rcp_f32 v29, v29
  v_rcp_f32 v30, v30
  s_waitcnt lgkmcnt(5)
  v_mfma_f32_16x16x32_bf16 v[156:159], a[164:167], a[76:79], v[156:159]
  ds_read_b64_tr_b16 a[182:183], v2 offset:26624
  s_add_u32 m0, s31, 57344
  v_rcp_f32 v31, v31
  v_mfma_f32_16x16x32_bf16 v[156:159], a[168:171], a[92:95], v[156:159]
  buffer_load_dwordx4 v10, s[12:15], s47 offen lds
  v_mul_f32 v120, v120, v24
  v_mul_f32 v121, v121, v25
  v_mul_f32 v122, v122, v26
  v_mul_f32 v123, v123, v27
  v_mfma_f32_16x16x32_bf16 v[152:155], a[168:171], a[88:91], v[152:155]
  ds_read_b64_tr_b16 a[184:185], v2 offset:28672
  v_mul_f32 v124, v124, v28
  v_mul_f32 v125, v125, v29
  v_mul_f32 v126, v126, v30
  v_mfma_f32_16x16x32_bf16 v[152:155], a[164:167], a[72:75], v[152:155]
  v_mul_f32 v127, v127, v31
  v_cvt_pk_bf16_f32 v74, v120, v121
  v_cvt_pk_bf16_f32 v75, v122, v123
  v_mfma_f32_16x16x32_bf16 v[148:151], a[164:167], a[68:71], v[148:151]
  ds_read_b64_tr_b16 a[186:187], v2 offset:30720
  s_add_u32 m0, s31, 53248
  s_add_u32 s37, s47, 229376
  s_add_u32 s30, s35, 524288
  buffer_store_dwordx4 v[72:75], v1, s[4:7], s30 offen offset:0 sc1
  v_mfma_f32_16x16x32_bf16 v[148:151], a[168:171], a[84:87], v[148:151]
  buffer_load_dwordx4 v10, s[8:11], s37 offen lds
  v_cvt_pk_bf16_f32 v78, v124, v125
  v_cvt_pk_bf16_f32 v79, v126, v127
  s_add_u32 s30, s35, 786432
  buffer_store_dwordx4 v[76:79], v1, s[4:7], s30 offen offset:0 sc1
  v_mfma_f32_16x16x32_bf16 v[144:147], a[168:171], a[80:83], v[144:147]
  ds_read_b64_tr_b16 a[160:161], v2 offset:32768
  v_mfma_f32_16x16x32_bf16 v[144:147], a[164:167], a[64:67], v[144:147]
  s_waitcnt lgkmcnt(5)
  v_mfma_f32_16x16x32_bf16 v[128:131], a[172:175], a[96:99], v[128:131]
  ds_read_b64_tr_b16 a[162:163], v2 offset:34816
  s_add_u32 m0, s31, 61440
  s_add_u32 s37, s47, 229376
  v_mfma_f32_16x16x32_bf16 v[128:131], a[176:179], a[112:115], v[128:131]
  buffer_load_dwordx4 v10, s[12:15], s37 offen lds
  v_mfma_f32_16x16x32_bf16 v[132:135], a[176:179], a[116:119], v[132:135]
  ds_read_b64_tr_b16 a[164:165], v2 offset:36864
  v_mfma_f32_16x16x32_bf16 v[132:135], a[172:175], a[100:103], v[132:135]
  v_mfma_f32_16x16x32_bf16 v[136:139], a[172:175], a[104:107], v[136:139]
  ds_read_b64_tr_b16 a[166:167], v2 offset:38912
  s_add_u32 m0, s31, 106496
  v_mfma_f32_16x16x32_bf16 v[136:139], a[176:179], a[120:123], v[136:139]
  buffer_load_dwordx4 v33, s[16:19], s42 offen lds
  v_mfma_f32_16x16x32_bf16 v[140:143], a[176:179], a[124:127], v[140:143]
  ds_read_b64_tr_b16 a[168:169], v2 offset:40960
  v_mfma_f32_16x16x32_bf16 v[140:143], a[172:175], a[108:111], v[140:143]
  s_waitcnt lgkmcnt(5)
  v_mfma_f32_16x16x32_bf16 v[156:159], a[180:183], a[108:111], v[156:159]
  ds_read_b64_tr_b16 a[170:171], v2 offset:43008
  s_add_u32 m0, s31, 110592
  s_add_u32 s37, s42, 65536
  v_mfma_f32_16x16x32_bf16 v[156:159], a[184:187], a[124:127], v[156:159]
  buffer_load_dwordx4 v33, s[16:19], s37 offen lds
  v_mfma_f32_16x16x32_bf16 v[152:155], a[184:187], a[120:123], v[152:155]
  ds_read_b64_tr_b16 a[172:173], v2 offset:45056
  v_mfma_f32_16x16x32_bf16 v[152:155], a[180:183], a[104:107], v[152:155]
  v_mfma_f32_16x16x32_bf16 v[148:151], a[180:183], a[100:103], v[148:151]
  ds_read_b64_tr_b16 a[174:175], v2 offset:47104
  s_cmp_eq_u32 s67, 0
  s_cselect_b32 s51, 1, 8
  s_lshl_b32 s43, s51, 17
  s_lshl_b32 s51, s51, 11
  s_add_u32 s51, s51, s60
  s_add_u32 m0, s31, 114688
  v_mfma_f32_16x16x32_bf16 v[148:151], a[184:187], a[116:119], v[148:151]
  buffer_load_dwordx4 v32, s[16:19], s43 offen lds
  v_mfma_f32_16x16x32_bf16 v[144:147], a[184:187], a[112:115], v[144:147]
  ds_read_b64_tr_b16 a[176:177], v3 offset:0
  v_mfma_f32_16x16x32_bf16 v[144:147], a[180:183], a[96:99], v[144:147]
  s_waitcnt lgkmcnt(5)
  v_mfma_f32_16x16x32_bf16 v[128:131], a[160:163], a[128:131], v[128:131]
  ds_read_b64_tr_b16 a[178:179], v3 offset:2048
  s_add_u32 m0, s31, 118784
  s_add_u32 s37, s43, 65536
  v_mfma_f32_16x16x32_bf16 v[128:131], a[164:167], a[144:147], v[128:131]
  buffer_load_dwordx4 v32, s[16:19], s37 offen lds
  v_mfma_f32_16x16x32_bf16 v[132:135], a[164:167], a[148:151], v[132:135]
  ds_read_b64_tr_b16 a[180:181], v3 offset:4096
  v_mfma_f32_16x16x32_bf16 v[132:135], a[160:163], a[132:135], v[132:135]
  v_mfma_f32_16x16x32_bf16 v[136:139], a[160:163], a[136:139], v[136:139]
  ds_read_b64_tr_b16 a[182:183], v3 offset:6144
  s_add_u32 m0, s31, 122880
  v_mfma_f32_16x16x32_bf16 v[136:139], a[164:167], a[152:155], v[136:139]
  buffer_load_dwordx4 v33, s[16:19], s43 offen lds
  v_mfma_f32_16x16x32_bf16 v[140:143], a[164:167], a[156:159], v[140:143]
  ds_read_b64_tr_b16 a[184:185], v3 offset:8192
  v_mfma_f32_16x16x32_bf16 v[140:143], a[160:163], a[140:143], v[140:143]
  s_waitcnt lgkmcnt(5)
  v_mfma_f32_16x16x32_bf16 v[156:159], a[168:171], a[140:143], v[156:159]
  ds_read_b64_tr_b16 a[186:187], v3 offset:10240
  s_add_u32 m0, s31, 126976
  s_add_u32 s37, s43, 65536
  v_mfma_f32_16x16x32_bf16 v[156:159], a[172:175], a[156:159], v[156:159]
  buffer_load_dwordx4 v33, s[16:19], s37 offen lds
  v_mfma_f32_16x16x32_bf16 v[152:155], a[172:175], a[152:155], v[152:155]
  ds_read_b64_tr_b16 a[160:161], v3 offset:12288
  v_mfma_f32_16x16x32_bf16 v[152:155], a[168:171], a[136:139], v[152:155]
  v_mfma_f32_16x16x32_bf16 v[148:151], a[168:171], a[132:135], v[148:151]
  ds_read_b64_tr_b16 a[162:163], v3 offset:14336
  v_mfma_f32_16x16x32_bf16 v[148:151], a[172:175], a[148:151], v[148:151]
  v_mfma_f32_16x16x32_bf16 v[144:147], a[172:175], a[144:147], v[144:147]
  ds_read_b64_tr_b16 a[164:165], v3 offset:16384
  v_mfma_f32_16x16x32_bf16 v[144:147], a[168:171], a[128:131], v[144:147]
  s_waitcnt lgkmcnt(5)
  v_mfma_f32_16x16x32_bf16 v[160:163], a[176:179], a[64:67], v[160:163]
  ds_read_b64_tr_b16 a[166:167], v3 offset:18432
  v_mfma_f32_16x16x32_bf16 v[160:163], a[180:183], a[80:83], v[160:163]
  v_mfma_f32_16x16x32_bf16 v[164:167], a[180:183], a[84:87], v[164:167]
  ds_read_b64_tr_b16 a[168:169], v3 offset:20480
  v_mfma_f32_16x16x32_bf16 v[164:167], a[176:179], a[68:71], v[164:167]
  v_mfma_f32_16x16x32_bf16 v[168:171], a[176:179], a[72:75], v[168:171]
  ds_read_b64_tr_b16 a[170:171], v3 offset:22528
  v_mfma_f32_16x16x32_bf16 v[168:171], a[180:183], a[88:91], v[168:171]
  v_mfma_f32_16x16x32_bf16 v[172:175], a[180:183], a[92:95], v[172:175]
  ds_read_b64_tr_b16 a[172:173], v3 offset:24576
  v_mfma_f32_16x16x32_bf16 v[172:175], a[176:179], a[76:79], v[172:175]
  s_waitcnt lgkmcnt(5)
  v_mfma_f32_16x16x32_bf16 v[188:191], a[184:187], a[76:79], v[188:191]
  ds_read_b64_tr_b16 a[174:175], v3 offset:26624
  v_mfma_f32_16x16x32_bf16 v[188:191], a[160:163], a[92:95], v[188:191]
  v_mfma_f32_16x16x32_bf16 v[184:187], a[160:163], a[88:91], v[184:187]
  ds_read_b64_tr_b16 a[176:177], v3 offset:28672
  v_mfma_f32_16x16x32_bf16 v[184:187], a[184:187], a[72:75], v[184:187]
  v_mfma_f32_16x16x32_bf16 v[180:183], a[184:187], a[68:71], v[180:183]
  ds_read_b64_tr_b16 a[178:179], v3 offset:30720
  v_mfma_f32_16x16x32_bf16 v[180:183], a[160:163], a[84:87], v[180:183]
  v_mfma_f32_16x16x32_bf16 v[176:179], a[160:163], a[80:83], v[176:179]
  ds_read_b64_tr_b16 a[180:181], v3 offset:32768
  v_mfma_f32_16x16x32_bf16 v[176:179], a[184:187], a[64:67], v[176:179]
  s_waitcnt lgkmcnt(5)
  v_mfma_f32_16x16x32_bf16 v[160:163], a[164:167], a[96:99], v[160:163]
  ds_read_b64_tr_b16 a[182:183], v3 offset:34816
  v_mfma_f32_16x16x32_bf16 v[160:163], a[168:171], a[112:115], v[160:163]
  v_mfma_f32_16x16x32_bf16 v[164:167], a[168:171], a[116:119], v[164:167]
  ds_read_b64_tr_b16 a[184:185], v3 offset:36864
  v_mfma_f32_16x16x32_bf16 v[164:167], a[164:167], a[100:103], v[164:167]
  v_mfma_f32_16x16x32_bf16 v[168:171], a[164:167], a[104:107], v[168:171]
  ds_read_b64_tr_b16 a[186:187], v3 offset:38912
  v_mov_b32 v38, 1
  v_mov_b32 v39, 0
  s_waitcnt vmcnt(7)
  s_mov_b64 exec, 1
  buffer_store_dword v38, v39, s[4:7], s56 offen offset:0 sc1
  s_mov_b64 exec, -1
  v_mfma_f32_16x16x32_bf16 v[168:171], a[168:171], a[120:123], v[168:171]
  v_mfma_f32_16x16x32_bf16 v[172:175], a[168:171], a[124:127], v[172:175]
  ds_read_b64_tr_b16 a[160:161], v3 offset:40960
  v_mfma_f32_16x16x32_bf16 v[172:175], a[164:167], a[108:111], v[172:175]
  s_waitcnt lgkmcnt(5)
  v_mfma_f32_16x16x32_bf16 v[188:191], a[172:175], a[108:111], v[188:191]
  ds_read_b64_tr_b16 a[162:163], v3 offset:43008
  v_mfma_f32_16x16x32_bf16 v[188:191], a[176:179], a[124:127], v[188:191]
  v_mfma_f32_16x16x32_bf16 v[184:187], a[176:179], a[120:123], v[184:187]
  ds_read_b64_tr_b16 a[164:165], v3 offset:45056
  v_mfma_f32_16x16x32_bf16 v[184:187], a[172:175], a[104:107], v[184:187]
  v_mfma_f32_16x16x32_bf16 v[180:183], a[172:175], a[100:103], v[180:183]
  ds_read_b64_tr_b16 a[166:167], v3 offset:47104
  v_mfma_f32_16x16x32_bf16 v[180:183], a[176:179], a[116:119], v[180:183]
  s_waitcnt vmcnt(7)
  s_barrier
  v_mfma_f32_16x16x32_bf16 v[176:179], a[176:179], a[112:115], v[176:179]
  ds_read_b64_tr_b16 a[168:169], v2 offset:49152
  v_mfma_f32_16x16x32_bf16 v[176:179], a[172:175], a[96:99], v[176:179]
  s_waitcnt lgkmcnt(5)
  v_mfma_f32_16x16x32_bf16 v[160:163], a[180:183], a[128:131], v[160:163]
  ds_read_b64_tr_b16 a[170:171], v2 offset:51200
  v_mfma_f32_16x16x32_bf16 v[160:163], a[184:187], a[144:147], v[160:163]
  v_mfma_f32_16x16x32_bf16 v[164:167], a[184:187], a[148:151], v[164:167]
  ds_read_b64_tr_b16 a[172:173], v2 offset:53248
  v_mfma_f32_16x16x32_bf16 v[164:167], a[180:183], a[132:135], v[164:167]
  v_mfma_f32_16x16x32_bf16 v[168:171], a[180:183], a[136:139], v[168:171]
  ds_read_b64_tr_b16 a[174:175], v2 offset:55296
  v_mfma_f32_16x16x32_bf16 v[168:171], a[184:187], a[152:155], v[168:171]
  v_mfma_f32_16x16x32_bf16 v[172:175], a[184:187], a[156:159], v[172:175]
  ds_read_b64_tr_b16 a[176:177], v2 offset:57344
  v_mfma_f32_16x16x32_bf16 v[172:175], a[180:183], a[140:143], v[172:175]
  s_waitcnt lgkmcnt(5)
  v_mfma_f32_16x16x32_bf16 v[188:191], a[160:163], a[140:143], v[188:191]
  ds_read_b64_tr_b16 a[178:179], v2 offset:59392
  v_mfma_f32_16x16x32_bf16 v[188:191], a[164:167], a[156:159], v[188:191]
  v_mfma_f32_16x16x32_bf16 v[184:187], a[164:167], a[152:155], v[184:187]
  ds_read_b64_tr_b16 a[180:181], v2 offset:61440
  v_mfma_f32_16x16x32_bf16 v[184:187], a[160:163], a[136:139], v[184:187]
  v_mfma_f32_16x16x32_bf16 v[180:183], a[160:163], a[132:135], v[180:183]
  ds_read_b64_tr_b16 a[182:183], v2 offset:63488
  v_mfma_f32_16x16x32_bf16 v[180:183], a[164:167], a[148:151], v[180:183]
  v_mfma_f32_16x16x32_bf16 v[176:179], a[164:167], a[144:147], v[176:179]
  ds_read_b64_tr_b16 a[184:185], v3 offset:49152
  v_mfma_f32_16x16x32_bf16 v[176:179], a[160:163], a[128:131], v[176:179]
  s_waitcnt lgkmcnt(5)
  v_mfma_f32_16x16x32_bf16 v[128:131], a[168:171], a[0:3], v[128:131]
  ds_read_b64_tr_b16 a[186:187], v3 offset:51200
  v_mfma_f32_16x16x32_bf16 v[128:131], a[172:175], a[16:19], v[128:131]
  v_mfma_f32_16x16x32_bf16 v[132:135], a[172:175], a[20:23], v[132:135]
  ds_read_b64_tr_b16 a[160:161], v3 offset:53248
  v_mfma_f32_16x16x32_bf16 v[132:135], a[168:171], a[4:7], v[132:135]
  v_mfma_f32_16x16x32_bf16 v[136:139], a[168:171], a[8:11], v[136:139]
  ds_read_b64_tr_b16 a[162:163], v3 offset:55296
  v_mfma_f32_16x16x32_bf16 v[136:139], a[172:175], a[24:27], v[136:139]
  v_mfma_f32_16x16x32_bf16 v[140:143], a[172:175], a[28:31], v[140:143]
  ds_read_b64_tr_b16 a[164:165], v3 offset:57344
  v_mfma_f32_16x16x32_bf16 v[140:143], a[168:171], a[12:15], v[140:143]
  s_waitcnt lgkmcnt(5)
  v_mfma_f32_16x16x32_bf16 v[156:159], a[176:179], a[12:15], v[156:159]
  ds_read_b64_tr_b16 a[166:167], v3 offset:59392
  v_mfma_f32_16x16x32_bf16 v[156:159], a[180:183], a[28:31], v[156:159]
  v_mfma_f32_16x16x32_bf16 v[152:155], a[180:183], a[24:27], v[152:155]
  ds_read_b64_tr_b16 a[168:169], v3 offset:61440
  v_mfma_f32_16x16x32_bf16 v[152:155], a[176:179], a[8:11], v[152:155]
  v_mfma_f32_16x16x32_bf16 v[148:151], a[176:179], a[4:7], v[148:151]
  ds_read_b64_tr_b16 a[170:171], v3 offset:63488
  v_mfma_f32_16x16x32_bf16 v[148:151], a[180:183], a[20:23], v[148:151]
  v_mfma_f32_16x16x32_bf16 v[144:147], a[180:183], a[16:19], v[144:147]
  ds_read_b64_tr_b16 a[172:173], v4 offset:0
  v_mfma_f32_16x16x32_bf16 v[144:147], a[176:179], a[0:3], v[144:147]
  s_waitcnt lgkmcnt(5)
  v_mfma_f32_16x16x32_bf16 v[160:163], a[184:187], a[0:3], v[160:163]
  ds_read_b64_tr_b16 a[174:175], v4 offset:2048
  v_mfma_f32_16x16x32_bf16 v[160:163], a[160:163], a[16:19], v[160:163]
  v_mfma_f32_16x16x32_bf16 v[164:167], a[160:163], a[20:23], v[164:167]
  ds_read_b64_tr_b16 a[176:177], v4 offset:4096
  v_mul_f32 v24, v16, v128
  v_mul_f32 v25, v16, v129
  v_mfma_f32_16x16x32_bf16 v[164:167], a[184:187], a[4:7], v[164:167]
  v_mul_f32 v26, v16, v130
  v_mul_f32 v27, v16, v131
  v_mul_f32 v28, v18, v132
  v_mfma_f32_16x16x32_bf16 v[168:171], a[184:187], a[8:11], v[168:171]
  ds_read_b64_tr_b16 a[178:179], v4 offset:6144
  v_mul_f32 v29, v18, v133
  v_mul_f32 v30, v18, v134
  v_mfma_f32_16x16x32_bf16 v[168:171], a[160:163], a[24:27], v[168:171]
  v_mul_f32 v31, v18, v135
  v_exp_f32 v24, v24
  v_mfma_f32_16x16x32_bf16 v[172:175], a[160:163], a[28:31], v[172:175]
  ds_read_b64_tr_b16 a[180:181], v4 offset:8192
  v_mul_f32 v144, v128, v144
  v_mfma_f32_16x16x32_bf16 v[172:175], a[184:187], a[12:15], v[172:175]
  v_exp_f32 v25, v25
  s_waitcnt lgkmcnt(5)
  v_mfma_f32_16x16x32_bf16 v[188:191], a[164:167], a[12:15], v[188:191]
  ds_read_b64_tr_b16 a[182:183], v4 offset:10240
  v_mul_f32 v145, v129, v145
  v_mfma_f32_16x16x32_bf16 v[188:191], a[168:171], a[28:31], v[188:191]
  v_exp_f32 v26, v26
  v_mul_f32 v146, v130, v146
  v_mfma_f32_16x16x32_bf16 v[184:187], a[168:171], a[24:27], v[184:187]
  ds_read_b64_tr_b16 a[184:185], v4 offset:12288
  v_exp_f32 v27, v27
  v_mul_f32 v147, v131, v147
  v_mfma_f32_16x16x32_bf16 v[184:187], a[164:167], a[8:11], v[184:187]
  v_exp_f32 v28, v28
  v_mul_f32 v148, v132, v148
  v_mfma_f32_16x16x32_bf16 v[180:183], a[164:167], a[4:7], v[180:183]
  ds_read_b64_tr_b16 a[186:187], v4 offset:14336
  v_exp_f32 v29, v29
  v_mfma_f32_16x16x32_bf16 v[180:183], a[168:171], a[20:23], v[180:183]
  v_mul_f32 v149, v133, v149
  v_exp_f32 v30, v30
  v_mfma_f32_16x16x32_bf16 v[176:179], a[168:171], a[16:19], v[176:179]
  ds_read_b64_tr_b16 a[160:161], v4 offset:16384
  buffer_load_dword v36, v37, s[4:7], s58 offen sc1
  v_mfma_f32_16x16x32_bf16 v[176:179], a[164:167], a[0:3], v[176:179]
  v_mul_f32 v150, v134, v150
  s_waitcnt lgkmcnt(5)
  v_mfma_f32_16x16x32_bf16 v[192:195], a[172:175], a[64:67], v[192:195]
  ds_read_b64_tr_b16 a[162:163], v4 offset:18432
  v_exp_f32 v31, v31
  v_mul_f32 v151, v135, v151
  v_mfma_f32_16x16x32_bf16 v[192:195], a[176:179], a[80:83], v[192:195]
  v_fma_f32 v24, v24, v17, v17
  v_fma_f32 v25, v25, v17, v17
  v_fma_f32 v26, v26, v17, v17
  v_mfma_f32_16x16x32_bf16 v[196:199], a[176:179], a[84:87], v[196:199]
  ds_read_b64_tr_b16 a[164:165], v4 offset:20480
  v_fma_f32 v27, v27, v17, v17
  v_fma_f32 v28, v28, v19, v19
  v_mfma_f32_16x16x32_bf16 v[196:199], a[172:175], a[68:71], v[196:199]
  v_fma_f32 v29, v29, v19, v19
  v_fma_f32 v30, v30, v19, v19
  v_fma_f32 v31, v31, v19, v19
  v_mfma_f32_16x16x32_bf16 v[200:203], a[172:175], a[72:75], v[200:203]
  ds_read_b64_tr_b16 a[166:167], v4 offset:22528
  v_rcp_f32 v24, v24
  v_mfma_f32_16x16x32_bf16 v[200:203], a[176:179], a[88:91], v[200:203]
  v_rcp_f32 v25, v25
  v_mfma_f32_16x16x32_bf16 v[204:207], a[176:179], a[92:95], v[204:207]
  ds_read_b64_tr_b16 a[168:169], v4 offset:24576
  v_rcp_f32 v26, v26
  v_mfma_f32_16x16x32_bf16 v[204:207], a[172:175], a[76:79], v[204:207]
  v_rcp_f32 v27, v27
  s_waitcnt lgkmcnt(5)
  v_mfma_f32_16x16x32_bf16 v[220:223], a[180:183], a[76:79], v[220:223]
  ds_read_b64_tr_b16 a[170:171], v4 offset:26624
  v_rcp_f32 v28, v28
  v_mfma_f32_16x16x32_bf16 v[220:223], a[184:187], a[92:95], v[220:223]
  v_rcp_f32 v29, v29
  v_mfma_f32_16x16x32_bf16 v[216:219], a[184:187], a[88:91], v[216:219]
  ds_read_b64_tr_b16 a[172:173], v4 offset:28672
  v_rcp_f32 v30, v30
  v_mfma_f32_16x16x32_bf16 v[216:219], a[180:183], a[72:75], v[216:219]
  v_rcp_f32 v31, v31
  v_mul_f32 v144, v144, v24
  v_mul_f32 v145, v145, v25
  v_mfma_f32_16x16x32_bf16 v[212:215], a[180:183], a[68:71], v[212:215]
  ds_read_b64_tr_b16 a[174:175], v4 offset:30720
  v_mul_f32 v146, v146, v26
  v_mul_f32 v147, v147, v27
  v_mfma_f32_16x16x32_bf16 v[212:215], a[184:187], a[84:87], v[212:215]
  v_mul_f32 v148, v148, v28
  v_mul_f32 v149, v149, v29
  v_mul_f32 v150, v150, v30
  v_mfma_f32_16x16x32_bf16 v[208:211], a[184:187], a[80:83], v[208:211]
  ds_read_b64_tr_b16 a[176:177], v4 offset:32768
  v_mul_f32 v151, v151, v31
  v_cvt_pk_bf16_f32 v128, v144, v145
  v_mfma_f32_16x16x32_bf16 v[208:211], a[180:183], a[64:67], v[208:211]
  v_cvt_pk_bf16_f32 v129, v146, v147
  s_waitcnt lgkmcnt(5)
  v_mfma_f32_16x16x32_bf16 v[192:195], a[160:163], a[96:99], v[192:195]
  ds_read_b64_tr_b16 a[178:179], v4 offset:34816
  v_cvt_pk_bf16_f32 v132, v148, v149
  v_cvt_pk_bf16_f32 v133, v150, v151
  v_mfma_f32_16x16x32_bf16 v[192:195], a[164:167], a[112:115], v[192:195]
  v_mul_f32 v24, v20, v136
  v_mul_f32 v25, v20, v137
  v_mul_f32 v26, v20, v138
  v_mfma_f32_16x16x32_bf16 v[196:199], a[164:167], a[116:119], v[196:199]
  ds_read_b64_tr_b16 a[180:181], v4 offset:36864
  v_mul_f32 v27, v20, v139
  v_mul_f32 v28, v22, v140
  v_mfma_f32_16x16x32_bf16 v[196:199], a[160:163], a[100:103], v[196:199]
  v_mul_f32 v29, v22, v141
  v_mul_f32 v30, v22, v142
  v_mul_f32 v31, v22, v143
  v_mfma_f32_16x16x32_bf16 v[200:203], a[160:163], a[104:107], v[200:203]
  ds_read_b64_tr_b16 a[182:183], v4 offset:38912
  v_exp_f32 v24, v24
  v_mfma_f32_16x16x32_bf16 v[200:203], a[164:167], a[120:123], v[200:203]
  v_mul_f32 v152, v136, v152
  v_exp_f32 v25, v25
  v_mfma_f32_16x16x32_bf16 v[204:207], a[164:167], a[124:127], v[204:207]
  ds_read_b64_tr_b16 a[184:185], v4 offset:40960
  v_mul_f32 v153, v137, v153
  v_mfma_f32_16x16x32_bf16 v[204:207], a[160:163], a[108:111], v[204:207]
  v_exp_f32 v26, v26
  v_mul_f32 v154, v138, v154
  s_waitcnt lgkmcnt(5)
  v_mfma_f32_16x16x32_bf16 v[220:223], a[168:171], a[108:111], v[220:223]
  ds_read_b64_tr_b16 a[186:187], v4 offset:43008
  v_exp_f32 v27, v27
  v_mfma_f32_16x16x32_bf16 v[220:223], a[172:175], a[124:127], v[220:223]
  v_mul_f32 v155, v139, v155
  v_exp_f32 v28, v28
  v_mfma_f32_16x16x32_bf16 v[216:219], a[172:175], a[120:123], v[216:219]
  ds_read_b64_tr_b16 a[160:161], v4 offset:45056
  v_mul_f32 v156, v140, v156
  v_mfma_f32_16x16x32_bf16 v[216:219], a[168:171], a[104:107], v[216:219]
  v_exp_f32 v29, v29
  v_mul_f32 v157, v141, v157
  v_mfma_f32_16x16x32_bf16 v[212:215], a[168:171], a[100:103], v[212:215]
  ds_read_b64_tr_b16 a[162:163], v4 offset:47104
  v_exp_f32 v30, v30
  v_mfma_f32_16x16x32_bf16 v[212:215], a[172:175], a[116:119], v[212:215]
  v_mul_f32 v158, v142, v158
  v_exp_f32 v31, v31
  v_mfma_f32_16x16x32_bf16 v[208:211], a[172:175], a[112:115], v[208:211]
  ds_read_b64_tr_b16 a[164:165], v4 offset:49152
  v_mul_f32 v159, v143, v159
  v_fma_f32 v24, v24, v21, v21
  v_mfma_f32_16x16x32_bf16 v[208:211], a[168:171], a[96:99], v[208:211]
  v_fma_f32 v25, v25, v21, v21
  v_fma_f32 v26, v26, v21, v21
  s_waitcnt lgkmcnt(5)
  v_mfma_f32_16x16x32_bf16 v[192:195], a[176:179], a[128:131], v[192:195]
  ds_read_b64_tr_b16 a[166:167], v4 offset:51200
  v_fma_f32 v27, v27, v21, v21
  v_fma_f32 v28, v28, v23, v23
  v_mfma_f32_16x16x32_bf16 v[192:195], a[180:183], a[144:147], v[192:195]
  v_fma_f32 v29, v29, v23, v23
  v_fma_f32 v30, v30, v23, v23
  v_fma_f32 v31, v31, v23, v23
  v_mfma_f32_16x16x32_bf16 v[196:199], a[180:183], a[148:151], v[196:199]
  ds_read_b64_tr_b16 a[168:169], v4 offset:53248
  v_rcp_f32 v24, v24
  v_mfma_f32_16x16x32_bf16 v[196:199], a[176:179], a[132:135], v[196:199]
  v_rcp_f32 v25, v25
  v_mfma_f32_16x16x32_bf16 v[200:203], a[176:179], a[136:139], v[200:203]
  ds_read_b64_tr_b16 a[170:171], v4 offset:55296
HOP13:
  s_cbranch_execz HOP17
  v_rcp_f32 v26, v26
  v_mfma_f32_16x16x32_bf16 v[200:203], a[180:183], a[152:155], v[200:203]
  v_rcp_f32 v27, v27
  v_mfma_f32_16x16x32_bf16 v[204:207], a[180:183], a[156:159], v[204:207]
  ds_read_b64_tr_b16 a[172:173], v4 offset:57344
  s_waitcnt vmcnt(0)
  v_cmp_ne_u32 vcc, 1, v36
  s_nop 4
  s_cbranch_vccz PL1_k5_ffn_kernelx
  s_mov_b32 s59, 60000
PL1_k5_ffn_kernel:
  buffer_load_dword v36, v37, s[4:7], s58 offen sc1
  s_sub_u32 s59, s59, 1
  s_cmp_eq_u32 s59, 0
  s_waitcnt vmcnt(0)
  s_cbranch_scc1 PL1_k5_ffn_kernelx
  v_cmp_ne_u32 vcc, 1, v36
  s_nop 4
  s_cbranch_vccnz PL1_k5_ffn_kernel
PL1_k5_ffn_kernelx:
  v_mfma_f32_16x16x32_bf16 v[204:207], a[176:179], a[140:143], v[204:207]
  s_waitcnt lgkmcnt(5)
  v_mfma_f32_16x16x32_bf16 v[220:223], a[184:187], a[140:143], v[220:223]
  ds_read_b64_tr_b16 a[174:175], v4 offset:59392
  buffer_load_dwordx4 a[188:191], v1, s[4:7], s48 offen offset:0 sc1
  v_mfma_f32_16x16x32_bf16 v[220:223], a[160:163], a[156:159], v[220:223]
  v_rcp_f32 v28, v28
  v_rcp_f32 v29, v29
  v_mfma_f32_16x16x32_bf16 v[216:219], a[160:163], a[152:155], v[216:219]
  ds_read_b64_tr_b16 a[176:177], v4 offset:61440
  v_rcp_f32 v30, v30
  v_mfma_f32_16x16x32_bf16 v[216:219], a[184:187], a[136:139], v[216:219]
  v_rcp_f32 v31, v31
  v_mfma_f32_16x16x32_bf16 v[212:215], a[184:187], a[132:135], v[212:215]
  ds_read_b64_tr_b16 a[178:179], v4 offset:63488
  buffer_load_dwordx4 a[204:207], v1, s[4:7], s48 offen offset:1024 sc1
  v_mul_f32 v152, v152, v24
  v_mfma_f32_16x16x32_bf16 v[212:215], a[160:163], a[148:151], v[212:215]
  v_mul_f32 v153, v153, v25
  v_mul_f32 v154, v154, v26
  v_mul_f32 v155, v155, v27
  v_mfma_f32_16x16x32_bf16 v[208:211], a[160:163], a[144:147], v[208:211]
  ds_read_b64_tr_b16 a[180:181], v5 offset:0
  v_mul_f32 v156, v156, v28
  v_mul_f32 v157, v157, v29
  v_mfma_f32_16x16x32_bf16 v[208:211], a[184:187], a[128:131], v[208:211]
  s_add_u32 s48, s48, 262144
  v_mul_f32 v158, v158, v30
  s_waitcnt lgkmcnt(5)
  v_mfma_f32_16x16x32_bf16 v[192:195], a[164:167], a[0:3], v[192:195]
  ds_read_b64_tr_b16 a[182:183], v5 offset:2048
  buffer_load_dwordx4 a[192:195], v1, s[4:7], s48 offen offset:0 sc1
  v_mul_f32 v159, v159, v31
  v_mfma_f32_16x16x32_bf16 v[192:195], a[168:171], a[16:19], v[192:195]
  v_cvt_pk_bf16_f32 v136, v152, v153
  v_cvt_pk_bf16_f32 v137, v154, v155
  v_cvt_pk_bf16_f32 v140, v156, v157
  v_cvt_pk_bf16_f32 v141, v158, v159
  v_mfma_f32_16x16x32_bf16 v[196:199], a[168:171], a[20:23], v[196:199]
  ds_read_b64_tr_b16 a[184:185], v5 offset:4096
  v_mul_f32 v24, v16, v160
  v_mul_f32 v25, v16, v161
  v_mfma_f32_16x16x32_bf16 v[196:199], a[164:167], a[4:7], v[196:199]
  v_mul_f32 v26, v16, v162
  v_mul_f32 v27, v16, v163
  v_mul_f32 v28, v18, v164
  v_mul_f32 v29, v18, v165
  v_mfma_f32_16x16x32_bf16 v[200:203], a[164:167], a[8:11], v[200:203]
  ds_read_b64_tr_b16 a[186:187], v5 offset:6144
  buffer_load_dwordx4 a[208:211], v1, s[4:7], s48 offen offset:1024 sc1
  v_mul_f32 v30, v18, v166
  v_mfma_f32_16x16x32_bf16 v[200:203], a[168:171], a[24:27], v[200:203]
  v_mul_f32 v31, v18, v167
  v_exp_f32 v24, v24
  v_mfma_f32_16x16x32_bf16 v[204:207], a[168:171], a[28:31], v[204:207]
  ds_read_b64_tr_b16 a[160:161], v5 offset:8192
  v_mul_f32 v176, v160, v176
  v_mfma_f32_16x16x32_bf16 v[204:207], a[164:167], a[12:15], v[204:207]
  s_add_u32 s48, s48, 262144
  v_exp_f32 v25, v25
  s_waitcnt lgkmcnt(5)
  v_mfma_f32_16x16x32_bf16 v[220:223], a[172:175], a[12:15], v[220:223]
  ds_read_b64_tr_b16 a[162:163], v5 offset:10240
  buffer_load_dwordx4 a[196:199], v1, s[4:7], s48 offen offset:0 sc1
  v_mul_f32 v177, v161, v177
  v_mfma_f32_16x16x32_bf16 v[220:223], a[176:179], a[28:31], v[220:223]
  v_exp_f32 v26, v26
  v_mul_f32 v178, v162, v178
  v_mfma_f32_16x16x32_bf16 v[216:219], a[176:179], a[24:27], v[216:219]
  ds_read_b64_tr_b16 a[164:165], v5 offset:12288
  v_exp_f32 v27, v27
  v_mul_f32 v179, v163, v179
  v_mfma_f32_16x16x32_bf16 v[216:219], a[172:175], a[8:11], v[216:219]
  v_exp_f32 v28, v28
  v_mul_f32 v180, v164, v180
  v_mfma_f32_16x16x32_bf16 v[212:215], a[172:175], a[4:7], v[212:215]
  ds_read_b64_tr_b16 a[166:167], v5 offset:14336
  buffer_load_dwordx4 a[212:215], v1, s[4:7], s48 offen offset:1024 sc1
  v_exp_f32 v29, v29
  v_mfma_f32_16x16x32_bf16 v[212:215], a[176:179], a[20:23], v[212:215]
  v_mul_f32 v181, v165, v181
  v_exp_f32 v30, v30
  v_mfma_f32_16x16x32_bf16 v[208:211], a[176:179], a[16:19], v[208:211]
  ds_read_b64_tr_b16 a[168:169], v5 offset:16384
  v_mul_f32 v182, v166, v182
  v_mfma_f32_16x16x32_bf16 v[208:211], a[172:175], a[0:3], v[208:211]
  s_add_u32 s48, s48, 262144
  v_exp_f32 v31, v31
  s_waitcnt lgkmcnt(5)
  v_mfma_f32_16x16x32_bf16 v[224:227], a[180:183], a[64:67], v[224:227]
  ds_read_b64_tr_b16 a[170:171], v5 offset:18432
  buffer_load_dwordx4 a[200:203], v1, s[4:7], s48 offen offset:0 sc1
  v_mul_f32 v183, v167, v183
  v_fma_f32 v24, v24, v17, v17
  v_mfma_f32_16x16x32_bf16 v[224:227], a[184:187], a[80:83], v[224:227]
  v_fma_f32 v25, v25, v17, v17
  v_fma_f32 v26, v26, v17, v17
  v_fma_f32 v27, v27, v17, v17
  v_mfma_f32_16x16x32_bf16 v[228:231], a[184:187], a[84:87], v[228:231]
  ds_read_b64_tr_b16 a[172:173], v5 offset:20480
  v_fma_f32 v28, v28, v19, v19
  v_fma_f32 v29, v29, v19, v19
  v_mfma_f32_16x16x32_bf16 v[228:231], a[180:183], a[68:71], v[228:231]
  v_fma_f32 v30, v30, v19, v19
  v_fma_f32 v31, v31, v19, v19
  v_mfma_f32_16x16x32_bf16 v[232:235], a[180:183], a[72:75], v[232:235]
  ds_read_b64_tr_b16 a[174:175], v5 offset:22528
  buffer_load_dwordx4 a[216:219], v1, s[4:7], s48 offen offset:1024 sc1
  v_rcp_f32 v24, v24
  v_mfma_f32_16x16x32_bf16 v[232:235], a[184:187], a[88:91], v[232:235]
  v_rcp_f32 v25, v25
  v_rcp_f32 v26, v26
  v_mfma_f32_16x16x32_bf16 v[236:239], a[184:187], a[92:95], v[236:239]
  ds_read_b64_tr_b16 a[176:177], v5 offset:24576
  v_rcp_f32 v27, v27
  v_mfma_f32_16x16x32_bf16 v[236:239], a[180:183], a[76:79], v[236:239]
  s_waitcnt lgkmcnt(5)
  v_mfma_f32_16x16x32_bf16 v[252:255], a[160:163], a[76:79], v[252:255]
  ds_read_b64_tr_b16 a[178:179], v5 offset:26624
  buffer_load_dwordx4 a[220:223], v1, s[4:7], s49 offen offset:0 sc1
  v_rcp_f32 v28, v28
  v_mfma_f32_16x16x32_bf16 v[252:255], a[164:167], a[92:95], v[252:255]
  v_rcp_f32 v29, v29
  v_rcp_f32 v30, v30
  v_mfma_f32_16x16x32_bf16 v[248:251], a[164:167], a[88:91], v[248:251]
  ds_read_b64_tr_b16 a[180:181], v5 offset:28672
  v_rcp_f32 v31, v31
  v_mfma_f32_16x16x32_bf16 v[248:251], a[160:163], a[72:75], v[248:251]
  v_mul_f32 v176, v176, v24
  v_mul_f32 v177, v177, v25
  v_mul_f32 v178, v178, v26
  v_mfma_f32_16x16x32_bf16 v[244:247], a[160:163], a[68:71], v[244:247]
  ds_read_b64_tr_b16 a[182:183], v5 offset:30720
  buffer_load_dwordx4 a[236:239], v1, s[4:7], s49 offen offset:1024 sc1
  v_mul_f32 v179, v179, v27
  v_mfma_f32_16x16x32_bf16 v[244:247], a[164:167], a[84:87], v[244:247]
  v_mul_f32 v180, v180, v28
  v_mul_f32 v181, v181, v29
  v_mul_f32 v182, v182, v30
  v_mul_f32 v183, v183, v31
  v_mfma_f32_16x16x32_bf16 v[240:243], a[164:167], a[80:83], v[240:243]
  ds_read_b64_tr_b16 a[184:185], v5 offset:32768
  v_cvt_pk_bf16_f32 v130, v176, v177
  v_cvt_pk_bf16_f32 v131, v178, v179
  v_mfma_f32_16x16x32_bf16 v[240:243], a[160:163], a[64:67], v[240:243]
  s_add_u32 s49, s49, 262144
  s_waitcnt lgkmcnt(5)
  v_mfma_f32_16x16x32_bf16 v[224:227], a[168:171], a[96:99], v[224:227]
  ds_read_b64_tr_b16 a[186:187], v5 offset:34816
  buffer_load_dwordx4 a[224:227], v1, s[4:7], s49 offen offset:0 sc1
  buffer_store_dwordx4 v[128:131], v1, s[4:7], s34 offen offset:0 sc1
  v_mfma_f32_16x16x32_bf16 v[224:227], a[172:175], a[112:115], v[224:227]
  v_cvt_pk_bf16_f32 v134, v180, v181
  v_cvt_pk_bf16_f32 v135, v182, v183
  s_add_u32 s30, s34, 262144
  buffer_store_dwordx4 v[132:135], v1, s[4:7], s30 offen offset:0 sc1
  v_mfma_f32_16x16x32_bf16 v[228:231], a[172:175], a[116:119], v[228:231]
  ds_read_b64_tr_b16 a[160:161], v5 offset:36864
  v_mul_f32 v24, v20, v168
  v_mul_f32 v25, v20, v169
  v_mfma_f32_16x16x32_bf16 v[228:231], a[168:171], a[100:103], v[228:231]
  v_mul_f32 v26, v20, v170
  v_mul_f32 v27, v20, v171
  v_mul_f32 v28, v22, v172
  v_mfma_f32_16x16x32_bf16 v[232:235], a[168:171], a[104:107], v[232:235]
  ds_read_b64_tr_b16 a[162:163], v5 offset:38912
  buffer_load_dwordx4 a[240:243], v1, s[4:7], s49 offen offset:1024 sc1
  v_mul_f32 v29, v22, v173
  v_mfma_f32_16x16x32_bf16 v[232:235], a[172:175], a[120:123], v[232:235]
  v_mul_f32 v30, v22, v174
  v_mul_f32 v31, v22, v175
  v_exp_f32 v24, v24
  v_mfma_f32_16x16x32_bf16 v[236:239], a[172:175], a[124:127], v[236:239]
  ds_read_b64_tr_b16 a[164:165], v5 offset:40960
  v_mul_f32 v184, v168, v184
  v_mfma_f32_16x16x32_bf16 v[236:239], a[168:171], a[108:111], v[236:239]
  s_add_u32 s49, s49, 262144
  v_exp_f32 v25, v25
  s_waitcnt lgkmcnt(5)
  v_mfma_f32_16x16x32_bf16 v[252:255], a[176:179], a[108:111], v[252:255]
  ds_read_b64_tr_b16 a[166:167], v5 offset:43008
  buffer_load_dwordx4 a[228:231], v1, s[4:7], s49 offen offset:0 sc1
  v_mul_f32 v185, v169, v185
  v_mfma_f32_16x16x32_bf16 v[252:255], a[180:183], a[124:127], v[252:255]
  v_exp_f32 v26, v26
  v_mul_f32 v186, v170, v186
  v_mfma_f32_16x16x32_bf16 v[248:251], a[180:183], a[120:123], v[248:251]
  ds_read_b64_tr_b16 a[168:169], v5 offset:45056
  v_exp_f32 v27, v27
  v_mul_f32 v187, v171, v187
  v_mfma_f32_16x16x32_bf16 v[248:251], a[176:179], a[104:107], v[248:251]
  v_exp_f32 v28, v28
  v_mul_f32 v188, v172, v188
  v_mfma_f32_16x16x32_bf16 v[244:247], a[176:179], a[100:103], v[244:247]
  ds_read_b64_tr_b16 a[170:171], v5 offset:47104
  buffer_load_dwordx4 a[244:247], v1, s[4:7], s49 offen offset:1024 sc1
  v_exp_f32 v29, v29
  v_mfma_f32_16x16x32_bf16 v[244:247], a[180:183], a[116:119], v[244:247]
  v_mul_f32 v189, v173, v189
  v_exp_f32 v30, v30
  v_mfma_f32_16x16x32_bf16 v[240:243], a[180:183], a[112:115], v[240:243]
  ds_read_b64_tr_b16 a[172:173], v5 offset:49152
  v_mul_f32 v190, v174, v190
  v_mfma_f32_16x16x32_bf16 v[240:243], a[176:179], a[96:99], v[240:243]
  s_add_u32 s49, s49, 262144
  v_exp_f32 v31, v31
  s_waitcnt lgkmcnt(5)
  v_mfma_f32_16x16x32_bf16 v[224:227], a[184:187], a[128:131], v[224:227]
  ds_read_b64_tr_b16 a[174:175], v5 offset:51200
  buffer_load_dwordx4 a[232:235], v1, s[4:7], s49 offen offset:0 sc1
  v_mul_f32 v191, v175, v191
  v_fma_f32 v24, v24, v21, v21
  v_mfma_f32_16x16x32_bf16 v[224:227], a[160:163], a[144:147], v[224:227]
  v_fma_f32 v25, v25, v21, v21
  v_fma_f32 v26, v26, v21, v21
  v_fma_f32 v27, v27, v21, v21
  v_mfma_f32_16x16x32_bf16 v[228:231], a[160:163], a[148:151], v[228:231]
  ds_read_b64_tr_b16 a[176:177], v5 offset:53248
  v_fma_f32 v28, v28, v23, v23
  v_fma_f32 v29, v29, v23, v23
  v_mfma_f32_16x16x32_bf16 v[228:231], a[184:187], a[132:135], v[228:231]
  v_fma_f32 v30, v30, v23, v23
  v_fma_f32 v31, v31, v23, v23
  v_mfma_f32_16x16x32_bf16 v[232:235], a[184:187], a[136:139], v[232:235]
  ds_read_b64_tr_b16 a[178:179], v5 offset:55296
  buffer_load_dwordx4 a[248:251], v1, s[4:7], s49 offen offset:1024 sc1
  v_rcp_f32 v24, v24
  v_mfma_f32_16x16x32_bf16 v[232:235], a[160:163], a[152:155], v[232:235]
  v_rcp_f32 v25, v25
  v_rcp_f32 v26, v26
  v_mfma_f32_16x16x32_bf16 v[236:239], a[160:163], a[156:159], v[236:239]
  ds_read_b64_tr_b16 a[180:181], v5 offset:57344
  v_rcp_f32 v27, v27
  v_mfma_f32_16x16x32_bf16 v[236:239], a[184:187], a[140:143], v[236:239]
  s_waitcnt lgkmcnt(5)
  v_mfma_f32_16x16x32_bf16 v[252:255], a[164:167], a[140:143], v[252:255]
  ds_read_b64_tr_b16 a[182:183], v5 offset:59392
  buffer_load_dwordx4 a[32:35], v1, s[4:7], s50 offen offset:0 sc1
  v_rcp_f32 v28, v28
  v_mfma_f32_16x16x32_bf16 v[252:255], a[168:171], a[156:159], v[252:255]
  v_rcp_f32 v29, v29
  v_rcp_f32 v30, v30
  v_mfma_f32_16x16x32_bf16 v[248:251], a[168:171], a[152:155], v[248:251]
  ds_read_b64_tr_b16 a[184:185], v5 offset:61440
  v_rcp_f32 v31, v31
  v_mfma_f32_16x16x32_bf16 v[248:251], a[164:167], a[136:139], v[248:251]
  v_mul_f32 v184, v184, v24
  v_mul_f32 v185, v185, v25
  v_mul_f32 v186, v186, v26
  v_mfma_f32_16x16x32_bf16 v[244:247], a[164:167], a[132:135], v[244:247]
  ds_read_b64_tr_b16 a[186:187], v5 offset:63488
  buffer_load_dwordx4 a[48:51], v1, s[4:7], s50 offen offset:1024 sc1
  v_mul_f32 v187, v187, v27
  v_mfma_f32_16x16x32_bf16 v[244:247], a[168:171], a[148:151], v[244:247]
  v_mul_f32 v188, v188, v28
  v_mul_f32 v189, v189, v29
  s_waitcnt vmcnt(44)
  s_barrier
  v_mfma_f32_16x16x32_bf16 v[240:243], a[168:171], a[144:147], v[240:243]
  ds_read_b64_tr_b16 a[160:161], v6 offset:0
  v_mul_f32 v190, v190, v30
  v_mul_f32 v191, v191, v31
  v_mfma_f32_16x16x32_bf16 v[240:243], a[164:167], a[128:131], v[240:243]
  s_add_u32 s50, s50, 262144
  v_cvt_pk_bf16_f32 v138, v184, v185
  s_waitcnt lgkmcnt(5)
  v_mfma_f32_16x16x32_bf16 v[224:227], a[172:175], a[0:3], v[224:227]
  ds_read_b64_tr_b16 a[162:163], v6 offset:2048
  buffer_load_dwordx4 a[36:39], v1, s[4:7], s50 offen offset:0 sc1
  v_cvt_pk_bf16_f32 v139, v186, v187
  v_mfma_f32_16x16x32_bf16 v[224:227], a[176:179], a[16:19], v[224:227]
  s_add_u32 s30, s34, 524288
  buffer_store_dwordx4 v[136:139], v1, s[4:7], s30 offen offset:0 sc1
  v_cvt_pk_bf16_f32 v142, v188, v189
  v_cvt_pk_bf16_f32 v143, v190, v191
  s_add_u32 s30, s34, 786432
  buffer_store_dwordx4 v[140:143], v1, s[4:7], s30 offen offset:0 sc1
  v_mfma_f32_16x16x32_bf16 v[228:231], a[176:179], a[20:23], v[228:231]
  ds_read_b64_tr_b16 a[164:165], v6 offset:4096
  v_mul_f32 v24, v16, v192
  v_mul_f32 v25, v16, v193
  v_mfma_f32_16x16x32_bf16 v[228:231], a[172:175], a[4:7], v[228:231]
  v_mul_f32 v26, v16, v194
  v_mul_f32 v27, v16, v195
  v_mul_f32 v28, v18, v196
  v_mfma_f32_16x16x32_bf16 v[232:235], a[172:175], a[8:11], v[232:235]
  ds_read_b64_tr_b16 a[166:167], v6 offset:6144
  buffer_load_dwordx4 a[52:55], v1, s[4:7], s50 offen offset:1024 sc1
  v_mul_f32 v29, v18, v197
  v_mfma_f32_16x16x32_bf16 v[232:235], a[176:179], a[24:27], v[232:235]
  v_mul_f32 v30, v18, v198
  v_mul_f32 v31, v18, v199
  v_exp_f32 v24, v24
  v_mfma_f32_16x16x32_bf16 v[236:239], a[176:179], a[28:31], v[236:239]
  ds_read_b64_tr_b16 a[168:169], v7 offset:0
  v_mul_f32 v208, v192, v208
  v_mfma_f32_16x16x32_bf16 v[236:239], a[172:175], a[12:15], v[236:239]
  s_add_u32 s50, s50, 262144
  v_exp_f32 v25, v25
  s_waitcnt lgkmcnt(5)
  v_mfma_f32_16x16x32_bf16 v[252:255], a[180:183], a[12:15], v[252:255]
  ds_read_b64_tr_b16 a[170:171], v7 offset:2048
  buffer_load_dwordx4 a[40:43], v1, s[4:7], s50 offen offset:0 sc1
  v_mul_f32 v209, v193, v209
  v_mfma_f32_16x16x32_bf16 v[252:255], a[184:187], a[28:31], v[252:255]
  v_exp_f32 v26, v26
  v_mul_f32 v210, v194, v210
  v_mfma_f32_16x16x32_bf16 v[248:251], a[184:187], a[24:27], v[248:251]
  ds_read_b64_tr_b16 a[172:173], v7 offset:4096
  v_exp_f32 v27, v27
  v_mfma_f32_16x16x32_bf16 v[248:251], a[180:183], a[8:11], v[248:251]
  v_mul_f32 v211, v195, v211
  v_exp_f32 v28, v28
  v_mul_f32 v212, v196, v212
  v_mfma_f32_16x16x32_bf16 v[244:247], a[180:183], a[4:7], v[244:247]
  ds_read_b64_tr_b16 a[174:175], v7 offset:6144
  buffer_load_dwordx4 a[56:59], v1, s[4:7], s50 offen offset:1024 sc1
  v_mfma_f32_16x16x32_bf16 v[244:247], a[184:187], a[20:23], v[244:247]
  v_exp_f32 v29, v29
  v_mul_f32 v213, v197, v213
  v_mfma_f32_16x16x32_bf16 v[240:243], a[184:187], a[16:19], v[240:243]
  ds_read_b64_tr_b16 a[176:177], v8 offset:0
  v_exp_f32 v30, v30
  v_mul_f32 v214, v198, v214
  v_mfma_f32_16x16x32_bf16 v[240:243], a[180:183], a[0:3], v[240:243]
  s_add_u32 s50, s50, 262144
  s_waitcnt vmcnt(18) lgkmcnt(5)
  v_mfma_f32_16x16x32_bf16 v[64:67], a[160:163], a[188:191], 0
  ds_read_b64_tr_b16 a[178:179], v8 offset:2048
  buffer_load_dwordx4 a[44:47], v1, s[4:7], s50 offen offset:0 sc1
  v_exp_f32 v31, v31
  v_mfma_f32_16x16x32_bf16 v[64:67], a[164:167], a[204:207], v[64:67]
  v_mul_f32 v215, v199, v215
  s_waitcnt vmcnt(43)
  s_barrier
  v_mfma_f32_16x16x32_bf16 v[68:71], a[164:167], a[208:211], 0
  ds_read_b64_tr_b16 a[180:181], v8 offset:4096
  v_fma_f32 v24, v24, v17, v17
  v_fma_f32 v25, v25, v17, v17
  v_mfma_f32_16x16x32_bf16 v[68:71], a[160:163], a[192:195], v[68:71]
  v_fma_f32 v26, v26, v17, v17
  v_fma_f32 v27, v27, v17, v17
  v_fma_f32 v28, v28, v19, v19
  v_fma_f32 v29, v29, v19, v19
  v_mfma_f32_16x16x32_bf16 v[72:75], a[160:163], a[196:199], 0
  ds_read_b64_tr_b16 a[182:183], v8 offset:6144
  buffer_load_dwordx4 a[60:63], v1, s[4:7], s50 offen offset:1024 sc1
  v_fma_f32 v30, v30, v19, v19
  v_mfma_f32_16x16x32_bf16 v[72:75], a[164:167], a[212:215], v[72:75]
  v_fma_f32 v31, v31, v19, v19
  v_rcp_f32 v24, v24
  v_mfma_f32_16x16x32_bf16 v[76:79], a[164:167], a[216:219], 0
  ds_read_b64_tr_b16 a[184:185], v9 offset:0
  v_rcp_f32 v25, v25
  v_mfma_f32_16x16x32_bf16 v[76:79], a[160:163], a[200:203], v[76:79]
  v_rcp_f32 v26, v26
  s_waitcnt lgkmcnt(5)
  v_mfma_f32_16x16x32_bf16 v[92:95], a[168:171], a[200:203], 0
  ds_read_b64_tr_b16 a[186:187], v9 offset:2048
  v_mfma_f32_16x16x32_bf16 v[92:95], a[172:175], a[216:219], v[92:95]
  buffer_load_dwordx4 a[64:67], v1, s[4:7], s51 offen offset:0 sc1
  v_rcp_f32 v27, v27
  v_mfma_f32_16x16x32_bf16 v[88:91], a[172:175], a[212:215], 0
  ds_read_b64_tr_b16 a[160:161], v9 offset:4096
  v_rcp_f32 v28, v28
  v_mfma_f32_16x16x32_bf16 v[88:91], a[168:171], a[196:199], v[88:91]
  v_rcp_f32 v29, v29
  v_rcp_f32 v30, v30
  v_mfma_f32_16x16x32_bf16 v[84:87], a[168:171], a[192:195], 0
  ds_read_b64_tr_b16 a[162:163], v9 offset:6144
  v_rcp_f32 v31, v31
  v_mfma_f32_16x16x32_bf16 v[84:87], a[172:175], a[208:211], v[84:87]
  buffer_load_dwordx4 a[80:83], v1, s[4:7], s51 offen offset:1024 sc1
  v_mul_f32 v208, v208, v24
  v_mul_f32 v209, v209, v25
  v_mfma_f32_16x16x32_bf16 v[80:83], a[172:175], a[204:207], 0
  ds_read_b64_tr_b16 a[164:165], v6 offset:8192
  v_mul_f32 v210, v210, v26
  v_mul_f32 v211, v211, v27
  v_mul_f32 v212, v212, v28
  v_mfma_f32_16x16x32_bf16 v[80:83], a[168:171], a[188:191], v[80:83]
  v_mul_f32 v213, v213, v29
  v_mul_f32 v214, v214, v30
  s_waitcnt lgkmcnt(5)
  v_mfma_f32_16x16x32_bf16 v[96:99], a[176:179], a[188:191], 0
  ds_read_b64_tr_b16 a[166:167], v6 offset:10240
  v_mul_f32 v215, v215, v31
  v_cvt_pk_bf16_f32 v192, v208, v209
  v_mfma_f32_16x16x32_bf16 v[96:99], a[180:183], a[204:207], v[96:99]
  s_add_u32 s51, s51, 262144
  v_cvt_pk_bf16_f32 v193, v210, v211
  v_cvt_pk_bf16_f32 v196, v212, v213
  v_mfma_f32_16x16x32_bf16 v[100:103], a[180:183], a[208:211], 0
  ds_read_b64_tr_b16 a[168:169], v6 offset:12288
  buffer_load_dwordx4 a[68:71], v1, s[4:7], s51 offen offset:0 sc1
  v_cvt_pk_bf16_f32 v197, v214, v215
  v_mfma_f32_16x16x32_bf16 v[100:103], a[176:179], a[192:195], v[100:103]
  v_mul_f32 v24, v20, v200
  v_mul_f32 v25, v20, v201
  v_mul_f32 v26, v20, v202
  v_mfma_f32_16x16x32_bf16 v[104:107], a[176:179], a[196:199], 0
  ds_read_b64_tr_b16 a[170:171], v6 offset:14336
  v_mul_f32 v27, v20, v203
  v_mul_f32 v28, v22, v204
  v_mul_f32 v29, v22, v205
  v_mfma_f32_16x16x32_bf16 v[104:107], a[180:183], a[212:215], v[104:107]
  v_mul_f32 v30, v22, v206
  v_mul_f32 v31, v22, v207
  v_mfma_f32_16x16x32_bf16 v[108:111], a[180:183], a[216:219], 0
  ds_read_b64_tr_b16 a[172:173], v7 offset:8192
  buffer_load_dwordx4 a[84:87], v1, s[4:7], s51 offen offset:1024 sc1
  v_exp_f32 v24, v24
  v_mfma_f32_16x16x32_bf16 v[108:111], a[176:179], a[200:203], v[108:111]
  v_mul_f32 v216, v200, v216
  s_waitcnt lgkmcnt(5)
  v_mfma_f32_16x16x32_bf16 v[124:127], a[184:187], a[200:203], 0
  ds_read_b64_tr_b16 a[174:175], v7 offset:10240
  v_exp_f32 v25, v25
  v_mul_f32 v217, v201, v217
  v_mfma_f32_16x16x32_bf16 v[124:127], a[160:163], a[216:219], v[124:127]
  v_exp_f32 v26, v26
  v_mul_f32 v218, v202, v218
  v_mfma_f32_16x16x32_bf16 v[120:123], a[160:163], a[212:215], 0
  ds_read_b64_tr_b16 a[176:177], v7 offset:12288
  s_add_u32 s51, s51, 262144
  v_mfma_f32_16x16x32_bf16 v[120:123], a[184:187], a[196:199], v[120:123]
  buffer_load_dwordx4 a[72:75], v1, s[4:7], s51 offen offset:0 sc1
  v_exp_f32 v27, v27
  v_mul_f32 v219, v203, v219
  v_mfma_f32_16x16x32_bf16 v[116:119], a[184:187], a[192:195], 0
  ds_read_b64_tr_b16 a[178:179], v7 offset:14336
  v_exp_f32 v28, v28
  v_mfma_f32_16x16x32_bf16 v[116:119], a[160:163], a[208:211], v[116:119]
  v_mul_f32 v220, v204, v220
  v_exp_f32 v29, v29
  v_mfma_f32_16x16x32_bf16 v[112:115], a[160:163], a[204:207], 0
  ds_read_b64_tr_b16 a[180:181], v8 offset:8192
  v_mul_f32 v221, v205, v221
  v_exp_f32 v30, v30
  v_mfma_f32_16x16x32_bf16 v[112:115], a[184:187], a[188:191], v[112:115]
  buffer_load_dwordx4 a[88:91], v1, s[4:7], s51 offen offset:1024 sc1
  v_mul_f32 v222, v206, v222
  s_waitcnt lgkmcnt(5)
  v_mfma_f32_16x16x32_bf16 v[128:131], a[164:167], a[188:191], 0
  ds_read_b64_tr_b16 a[182:183], v8 offset:10240
  v_exp_f32 v31, v31
  v_mfma_f32_16x16x32_bf16 v[128:131], a[168:171], a[204:207], v[128:131]
  v_mul_f32 v223, v207, v223
  v_fma_f32 v24, v24, v21, v21
  v_fma_f32 v25, v25, v21, v21
  v_mfma_f32_16x16x32_bf16 v[132:135], a[168:171], a[208:211], 0
  ds_read_b64_tr_b16 a[184:185], v8 offset:12288
  v_fma_f32 v26, v26, v21, v21
  v_fma_f32 v27, v27, v21, v21
  v_mfma_f32_16x16x32_bf16 v[132:135], a[164:167], a[192:195], v[132:135]
  s_add_u32 s51, s51, 262144
  v_fma_f32 v28, v28, v23, v23
  v_fma_f32 v29, v29, v23, v23
  v_mfma_f32_16x16x32_bf16 v[136:139], a[164:167], a[196:199], 0
  ds_read_b64_tr_b16 a[186:187], v8 offset:14336
  buffer_load_dwordx4 a[76:79], v1, s[4:7], s51 offen offset:0 sc1
  v_fma_f32 v30, v30, v23, v23
  v_fma_f32 v31, v31, v23, v23
  v_mfma_f32_16x16x32_bf16 v[136:139], a[168:171], a[212:215], v[136:139]
  v_rcp_f32 v24, v24
  v_mfma_f32_16x16x32_bf16 v[140:143], a[168:171], a[216:219], 0
  ds_read_b64_tr_b16 a[160:161], v9 offset:8192
  v_rcp_f32 v25, v25
  v_mfma_f32_16x16x32_bf16 v[140:143], a[164:167], a[200:203], v[140:143]
  v_rcp_f32 v26, v26
  s_waitcnt lgkmcnt(5)
  v_mfma_f32_16x16x32_bf16 v[156:159], a[172:175], a[200:203], 0
  ds_read_b64_tr_b16 a[162:163], v9 offset:10240
  buffer_load_dwordx4 a[92:95], v1, s[4:7], s51 offen offset:1024 sc1
  v_rcp_f32 v27, v27
  v_mfma_f32_16x16x32_bf16 v[156:159], a[176:179], a[216:219], v[156:159]
  v_rcp_f32 v28, v28
  v_mfma_f32_16x16x32_bf16 v[152:155], a[176:179], a[212:215], 0
  ds_read_b64_tr_b16 a[164:165], v9 offset:12288
  v_rcp_f32 v29, v29
  v_mfma_f32_16x16x32_bf16 v[152:155], a[172:175], a[196:199], v[152:155]
  v_rcp_f32 v30, v30
  v_rcp_f32 v31, v31
  v_mfma_f32_16x16x32_bf16 v[148:151], a[172:175], a[192:195], 0
  ds_read_b64_tr_b16 a[166:167], v9 offset:14336
  s_cmp_eq_u32 s67, 1
  s_cselect_b32 s52, 3, 10
  s_lshl_b32 s44, s52, 17
  s_lshl_b32 s52, s52, 11
  s_add_u32 s52, s52, s60
  s_add_u32 m0, s31, 0
  v_mul_f32 v216, v216, v24
  v_mfma_f32_16x16x32_bf16 v[148:151], a[176:179], a[208:211], v[148:151]
  buffer_load_dwordx4 v32, s[16:19], s44 offen lds
  v_mul_f32 v217, v217, v25
  v_mul_f32 v218, v218, v26
  v_mfma_f32_16x16x32_bf16 v[144:147], a[176:179], a[204:207], 0
  ds_read_b64_tr_b16 a[168:169], v6 offset:16384
  v_mul_f32 v219, v219, v27
  v_mul_f32 v220, v220, v28
  v_mul_f32 v221, v221, v29
  v_mfma_f32_16x16x32_bf16 v[144:147], a[172:175], a[188:191], v[144:147]
  v_mul_f32 v222, v222, v30
  v_mul_f32 v223, v223, v31
  s_waitcnt lgkmcnt(5)
  v_mfma_f32_16x16x32_bf16 v[160:163], a[180:183], a[188:191], 0
  ds_read_b64_tr_b16 a[170:171], v6 offset:18432
  s_add_u32 m0, s31, 4096
  s_add_u32 s37, s44, 65536
  v_mfma_f32_16x16x32_bf16 v[160:163], a[184:187], a[204:207], v[160:163]
  buffer_load_dwordx4 v32, s[16:19], s37 offen lds
  v_cvt_pk_bf16_f32 v200, v216, v217
  v_cvt_pk_bf16_f32 v201, v218, v219
  v_cvt_pk_bf16_f32 v204, v220, v221
  v_cvt_pk_bf16_f32 v205, v222, v223
  v_mfma_f32_16x16x32_bf16 v[164:167], a[184:187], a[208:211], 0
  ds_read_b64_tr_b16 a[172:173], v6 offset:20480
  v_mul_f32 v24, v16, v224
  v_mul_f32 v25, v16, v225
  v_mfma_f32_16x16x32_bf16 v[164:167], a[180:183], a[192:195], v[164:167]
  v_mul_f32 v26, v16, v226
  v_mul_f32 v27, v16, v227
  v_mul_f32 v28, v18, v228
  v_mul_f32 v29, v18, v229
  v_mfma_f32_16x16x32_bf16 v[168:171], a[180:183], a[196:199], 0
  ds_read_b64_tr_b16 a[174:175], v6 offset:22528
  v_mul_f32 v30, v18, v230
  v_mul_f32 v31, v18, v231
  v_mfma_f32_16x16x32_bf16 v[168:171], a[184:187], a[212:215], v[168:171]
  s_add_u32 m0, s31, 8192
  v_exp_f32 v24, v24
  v_mfma_f32_16x16x32_bf16 v[172:175], a[184:187], a[216:219], 0
  ds_read_b64_tr_b16 a[176:177], v7 offset:16384
  buffer_load_dwordx4 v33, s[16:19], s44 offen lds
  v_mul_f32 v240, v224, v240
  v_mfma_f32_16x16x32_bf16 v[172:175], a[180:183], a[200:203], v[172:175]
  v_exp_f32 v25, v25
  v_mul_f32 v241, v225, v241
  s_waitcnt lgkmcnt(5)
  v_mfma_f32_16x16x32_bf16 v[188:191], a[160:163], a[200:203], 0
  ds_read_b64_tr_b16 a[178:179], v7 offset:18432
  v_exp_f32 v26, v26
  v_mfma_f32_16x16x32_bf16 v[188:191], a[164:167], a[216:219], v[188:191]
  s_add_u32 m0, s31, 12288
  s_add_u32 s37, s44, 65536
  v_mul_f32 v242, v226, v242
  v_mfma_f32_16x16x32_bf16 v[184:187], a[164:167], a[212:215], 0
  ds_read_b64_tr_b16 a[180:181], v7 offset:20480
  buffer_load_dwordx4 v33, s[16:19], s37 offen lds
  v_exp_f32 v27, v27
  v_mfma_f32_16x16x32_bf16 v[184:187], a[160:163], a[196:199], v[184:187]
  v_mul_f32 v243, v227, v243
  v_exp_f32 v28, v28
  v_mfma_f32_16x16x32_bf16 v[180:183], a[160:163], a[192:195], 0
  ds_read_b64_tr_b16 a[182:183], v7 offset:22528
  v_mul_f32 v244, v228, v244
  v_exp_f32 v29, v29
  v_mfma_f32_16x16x32_bf16 v[180:183], a[164:167], a[208:211], v[180:183]
  v_mul_f32 v245, v229, v245
  v_exp_f32 v30, v30
  v_mfma_f32_16x16x32_bf16 v[176:179], a[164:167], a[204:207], 0
  ds_read_b64_tr_b16 a[184:185], v8 offset:16384
  s_cmp_eq_u32 s67, 2
  s_cselect_b32 s53, 5, 12
  s_lshl_b32 s45, s53, 17
  s_lshl_b32 s53, s53, 11
  s_add_u32 s53, s53, s60
  s_add_u32 m0, s31, 16384
  v_mul_f32 v246, v230, v246
  v_mfma_f32_16x16x32_bf16 v[176:179], a[160:163], a[188:191], v[176:179]
  buffer_load_dwordx4 v32, s[16:19], s45 offen lds
  v_exp_f32 v31, v31
  s_waitcnt vmcnt(23) lgkmcnt(5)
  v_mfma_f32_16x16x32_bf16 v[64:67], a[168:171], a[220:223], v[64:67]
  ds_read_b64_tr_b16 a[186:187], v8 offset:18432
  v_mul_f32 v247, v231, v247
  v_fma_f32 v24, v24, v17, v17
  v_mfma_f32_16x16x32_bf16 v[64:67], a[172:175], a[236:239], v[64:67]
  v_fma_f32 v25, v25, v17, v17
  v_fma_f32 v26, v26, v17, v17
  v_fma_f32 v27, v27, v17, v17
  v_mfma_f32_16x16x32_bf16 v[68:71], a[172:175], a[240:243], v[68:71]
  ds_read_b64_tr_b16 a[160:161], v8 offset:20480
  s_add_u32 m0, s31, 20480
  s_add_u32 s37, s45, 65536
  v_fma_f32 v28, v28, v19, v19
  v_mfma_f32_16x16x32_bf16 v[68:71], a[168:171], a[224:227], v[68:71]
  buffer_load_dwordx4 v32, s[16:19], s37 offen lds
  v_fma_f32 v29, v29, v19, v19
  v_fma_f32 v30, v30, v19, v19
  v_mfma_f32_16x16x32_bf16 v[72:75], a[168:171], a[228:231], v[72:75]
  ds_read_b64_tr_b16 a[162:163], v8 offset:22528
  v_fma_f32 v31, v31, v19, v19
  v_mfma_f32_16x16x32_bf16 v[72:75], a[172:175], a[244:247], v[72:75]
  v_rcp_f32 v24, v24
  v_rcp_f32 v25, v25
  v_mfma_f32_16x16x32_bf16 v[76:79], a[172:175], a[248:251], v[76:79]
  ds_read_b64_tr_b16 a[164:165], v9 offset:16384
  v_rcp_f32 v26, v26
  v_mfma_f32_16x16x32_bf16 v[76:79], a[168:171], a[232:235], v[76:79]
  s_add_u32 m0, s31, 24576
  v_rcp_f32 v27, v27
  s_waitcnt lgkmcnt(5)
  v_mfma_f32_16x16x32_bf16 v[92:95], a[176:179], a[232:235], v[92:95]
  ds_read_b64_tr_b16 a[166:167], v9 offset:18432
  buffer_load_dwordx4 v33, s[16:19], s45 offen lds
  v_mfma_f32_16x16x32_bf16 v[92:95], a[180:183], a[248:251], v[92:95]
  v_rcp_f32 v28, v28
  v_rcp_f32 v29, v29
  v_mfma_f32_16x16x32_bf16 v[88:91], a[180:183], a[244:247], v[88:91]
  ds_read_b64_tr_b16 a[168:169], v9 offset:20480
  v_rcp_f32 v30, v30
  v_mfma_f32_16x16x32_bf16 v[88:91], a[176:179], a[228:231], v[88:91]
  s_add_u32 m0, s31, 28672
  s_add_u32 s37, s45, 65536
  v_rcp_f32 v31, v31
  v_mfma_f32_16x16x32_bf16 v[84:87], a[176:179], a[224:227], v[84:87]
  ds_read_b64_tr_b16 a[170:171], v9 offset:22528
  buffer_load_dwordx4 v33, s[16:19], s37 offen lds
  v_mul_f32 v240, v240, v24
  v_mfma_f32_16x16x32_bf16 v[84:87], a[180:183], a[240:243], v[84:87]
HOP14:
  s_cbranch_execz WRET1
  v_mul_f32 v241, v241, v25
  v_mul_f32 v242, v242, v26
  v_mul_f32 v243, v243, v27
  v_mul_f32 v244, v244, v28
  v_mfma_f32_16x16x32_bf16 v[80:83], a[180:183], a[236:239], v[80:83]
  ds_read_b64_tr_b16 a[172:173], v6 offset:24576
  v_mul_f32 v245, v245, v29
  v_mul_f32 v246, v246, v30
  v_mfma_f32_16x16x32_bf16 v[80:83], a[176:179], a[220:223], v[80:83]
  v_mul_f32 v247, v247, v31
  v_cvt_pk_bf16_f32 v194, v240, v241
  s_waitcnt lgkmcnt(5)
  v_mfma_f32_16x16x32_bf16 v[96:99], a[184:187], a[220:223], v[96:99]
  ds_read_b64_tr_b16 a[174:175], v6 offset:26624
  v_cvt_pk_bf16_f32 v195, v242, v243
  v_mfma_f32_16x16x32_bf16 v[96:99], a[160:163], a[236:239], v[96:99]
  buffer_load_dwordx4 a[96:99], v1, s[4:7], s52 offen offset:0 sc1
  buffer_store_dwordx4 v[192:195], v1, s[4:7], s34 offen offset:1024 sc1
  v_cvt_pk_bf16_f32 v198, v244, v245
  v_mfma_f32_16x16x32_bf16 v[100:103], a[160:163], a[240:243], v[100:103]
  ds_read_b64_tr_b16 a[176:177], v6 offset:28672
  v_cvt_pk_bf16_f32 v199, v246, v247
  v_mfma_f32_16x16x32_bf16 v[100:103], a[184:187], a[224:227], v[100:103]
  s_add_u32 s30, s34, 262144
  buffer_store_dwordx4 v[196:199], v1, s[4:7], s30 offen offset:1024 sc1
  v_mul_f32 v24, v20, v232
  v_mul_f32 v25, v20, v233
  v_mfma_f32_16x16x32_bf16 v[104:107], a[184:187], a[228:231], v[104:107]
  ds_read_b64_tr_b16 a[178:179], v6 offset:30720
  v_mul_f32 v26, v20, v234
  v_mul_f32 v27, v20, v235
  v_mul_f32 v28, v22, v236
  v_mfma_f32_16x16x32_bf16 v[104:107], a[160:163], a[244:247], v[104:107]
  buffer_load_dwordx4 a[112:115], v1, s[4:7], s52 offen offset:1024 sc1
  v_mul_f32 v29, v22, v237
  v_mul_f32 v30, v22, v238
  v_mfma_f32_16x16x32_bf16 v[108:111], a[160:163], a[248:251], v[108:111]
  ds_read_b64_tr_b16 a[180:181], v7 offset:24576
  v_mul_f32 v31, v22, v239
  v_mfma_f32_16x16x32_bf16 v[108:111], a[184:187], a[232:235], v[108:111]
  v_exp_f32 v24, v24
  v_mul_f32 v248, v232, v248
  s_waitcnt lgkmcnt(5)
  v_mfma_f32_16x16x32_bf16 v[124:127], a[164:167], a[232:235], v[124:127]
  ds_read_b64_tr_b16 a[182:183], v7 offset:26624
  v_exp_f32 v25, v25
  v_mul_f32 v249, v233, v249
  v_mfma_f32_16x16x32_bf16 v[124:127], a[168:171], a[248:251], v[124:127]
  s_add_u32 s52, s52, 262144
  v_exp_f32 v26, v26
  v_mfma_f32_16x16x32_bf16 v[120:123], a[168:171], a[244:247], v[120:123]
  ds_read_b64_tr_b16 a[184:185], v7 offset:28672
  buffer_load_dwordx4 a[100:103], v1, s[4:7], s52 offen offset:0 sc1
  v_mul_f32 v250, v234, v250
  v_mfma_f32_16x16x32_bf16 v[120:123], a[164:167], a[228:231], v[120:123]
  v_exp_f32 v27, v27
  v_mul_f32 v251, v235, v251
  v_mfma_f32_16x16x32_bf16 v[116:119], a[164:167], a[224:227], v[116:119]
  ds_read_b64_tr_b16 a[186:187], v7 offset:30720
  v_exp_f32 v28, v28
  v_mul_f32 v252, v236, v252
  v_mfma_f32_16x16x32_bf16 v[116:119], a[168:171], a[240:243], v[116:119]
  v_exp_f32 v29, v29
  v_mul_f32 v253, v237, v253
  v_mfma_f32_16x16x32_bf16 v[112:115], a[168:171], a[236:239], v[112:115]
  ds_read_b64_tr_b16 a[160:161], v8 offset:24576
  buffer_load_dwordx4 a[116:119], v1, s[4:7], s52 offen offset:1024 sc1
  v_exp_f32 v30, v30
  v_mfma_f32_16x16x32_bf16 v[112:115], a[164:167], a[220:223], v[112:115]
  v_mul_f32 v254, v238, v254
  s_waitcnt lgkmcnt(5)
  v_mfma_f32_16x16x32_bf16 v[128:131], a[172:175], a[220:223], v[128:131]
  ds_read_b64_tr_b16 a[162:163], v8 offset:26624
  v_exp_f32 v31, v31
  v_mul_f32 v255, v239, v255
  v_mfma_f32_16x16x32_bf16 v[128:131], a[176:179], a[236:239], v[128:131]
  v_fma_f32 v24, v24, v21, v21
  v_fma_f32 v25, v25, v21, v21
  v_fma_f32 v26, v26, v21, v21
  v_fma_f32 v27, v27, v21, v21
  v_mfma_f32_16x16x32_bf16 v[132:135], a[176:179], a[240:243], v[132:135]
  ds_read_b64_tr_b16 a[164:165], v8 offset:28672
  s_add_u32 s52, s52, 262144
  v_fma_f32 v28, v28, v23, v23
  v_mfma_f32_16x16x32_bf16 v[132:135], a[172:175], a[224:227], v[132:135]
  buffer_load_dwordx4 a[104:107], v1, s[4:7], s52 offen offset:0 sc1
  v_fma_f32 v29, v29, v23, v23
  v_fma_f32 v30, v30, v23, v23
  v_mfma_f32_16x16x32_bf16 v[136:139], a[172:175], a[228:231], v[136:139]
  ds_read_b64_tr_b16 a[166:167], v8 offset:30720
  v_fma_f32 v31, v31, v23, v23
  v_rcp_f32 v24, v24
  v_mfma_f32_16x16x32_bf16 v[136:139], a[176:179], a[244:247], v[136:139]
  v_rcp_f32 v25, v25
  v_mfma_f32_16x16x32_bf16 v[140:143], a[176:179], a[248:251], v[140:143]
  ds_read_b64_tr_b16 a[168:169], v9 offset:24576
  v_rcp_f32 v26, v26
  v_mfma_f32_16x16x32_bf16 v[140:143], a[172:175], a[232:235], v[140:143]
  buffer_load_dwordx4 a[120:123], v1, s[4:7], s52 offen offset:1024 sc1
  v_rcp_f32 v27, v27
  s_waitcnt lgkmcnt(5)
  v_mfma_f32_16x16x32_bf16 v[156:159], a[180:183], a[232:235], v[156:159]
  ds_read_b64_tr_b16 a[170:171], v9 offset:26624
  v_rcp_f32 v28, v28
  v_mfma_f32_16x16x32_bf16 v[156:159], a[184:187], a[248:251], v[156:159]
  v_rcp_f32 v29, v29
  v_rcp_f32 v30, v30
  v_mfma_f32_16x16x32_bf16 v[152:155], a[184:187], a[244:247], v[152:155]
  ds_read_b64_tr_b16 a[172:173], v9 offset:28672
  v_rcp_f32 v31, v31
  v_mfma_f32_16x16x32_bf16 v[152:155], a[180:183], a[228:231], v[152:155]
  s_add_u32 s52, s52, 262144
  v_mul_f32 v248, v248, v24
  v_mul_f32 v249, v249, v25
  v_mul_f32 v250, v250, v26
  v_mfma_f32_16x16x32_bf16 v[148:151], a[180:183], a[224:227], v[148:151]
  ds_read_b64_tr_b16 a[174:175], v9 offset:30720
  buffer_load_dwordx4 a[108:111], v1, s[4:7], s52 offen offset:0 sc1
  v_mul_f32 v251, v251, v27
  v_mfma_f32_16x16x32_bf16 v[148:151], a[184:187], a[240:243], v[148:151]
  v_mul_f32 v252, v252, v28
  s_waitcnt vmcnt(55)
  s_barrier
  v_mfma_f32_16x16x32_bf16 v[144:147], a[184:187], a[236:239], v[144:147]
  ds_read_b64_tr_b16 a[176:177], v6 offset:32768
  v_mul_f32 v253, v253, v29
  v_mul_f32 v254, v254, v30
  v_mul_f32 v255, v255, v31
  v_mfma_f32_16x16x32_bf16 v[144:147], a[180:183], a[220:223], v[144:147]
  v_cvt_pk_bf16_f32 v202, v248, v249
  v_cvt_pk_bf16_f32 v203, v250, v251
  s_waitcnt lgkmcnt(5)
  v_mfma_f32_16x16x32_bf16 v[160:163], a[160:163], a[220:223], v[160:163]
  ds_read_b64_tr_b16 a[178:179], v6 offset:34816
  buffer_load_dwordx4 a[124:127], v1, s[4:7], s52 offen offset:1024 sc1
  v_mfma_f32_16x16x32_bf16 v[160:163], a[164:167], a[236:239], v[160:163]
  s_add_u32 s30, s34, 524288
  buffer_store_dwordx4 v[200:203], v1, s[4:7], s30 offen offset:1024 sc1
  v_cvt_pk_bf16_f32 v206, v252, v253
  v_cvt_pk_bf16_f32 v207, v254, v255
  s_add_u32 s30, s34, 786432
  buffer_store_dwordx4 v[204:207], v1, s[4:7], s30 offen offset:1024 sc1
  v_mfma_f32_16x16x32_bf16 v[164:167], a[164:167], a[240:243], v[164:167]
  ds_read_b64_tr_b16 a[180:181], v6 offset:36864
  v_mfma_f32_16x16x32_bf16 v[164:167], a[160:163], a[224:227], v[164:167]
  v_mfma_f32_16x16x32_bf16 v[168:171], a[160:163], a[228:231], v[168:171]
  ds_read_b64_tr_b16 a[182:183], v6 offset:38912
  v_mfma_f32_16x16x32_bf16 v[168:171], a[164:167], a[244:247], v[168:171]
  buffer_load_dwordx4 a[128:131], v1, s[4:7], s53 offen offset:0 sc1
  v_mfma_f32_16x16x32_bf16 v[172:175], a[164:167], a[248:251], v[172:175]
  ds_read_b64_tr_b16 a[184:185], v7 offset:32768
  v_mfma_f32_16x16x32_bf16 v[172:175], a[160:163], a[232:235], v[172:175]
  s_waitcnt lgkmcnt(5)
  v_mfma_f32_16x16x32_bf16 v[188:191], a[168:171], a[232:235], v[188:191]
  ds_read_b64_tr_b16 a[186:187], v7 offset:34816
  v_mfma_f32_16x16x32_bf16 v[188:191], a[172:175], a[248:251], v[188:191]
  buffer_load_dwordx4 a[144:147], v1, s[4:7], s53 offen offset:1024 sc1
  v_mfma_f32_16x16x32_bf16 v[184:187], a[172:175], a[244:247], v[184:187]
  ds_read_b64_tr_b16 a[160:161], v7 offset:36864
  v_mfma_f32_16x16x32_bf16 v[184:187], a[168:171], a[228:231], v[184:187]
  v_mfma_f32_16x16x32_bf16 v[180:183], a[168:171], a[224:227], v[180:183]
  ds_read_b64_tr_b16 a[162:163], v7 offset:38912
  v_mfma_f32_16x16x32_bf16 v[180:183], a[172:175], a[240:243], v[180:183]
  s_add_u32 s53, s53, 262144
  v_mfma_f32_16x16x32_bf16 v[176:179], a[172:175], a[236:239], v[176:179]
  ds_read_b64_tr_b16 a[164:165], v8 offset:32768
  buffer_load_dwordx4 a[132:135], v1, s[4:7], s53 offen offset:0 sc1
  v_mfma_f32_16x16x32_bf16 v[176:179], a[168:171], a[220:223], v[176:179]
  s_waitcnt vmcnt(31) lgkmcnt(5)
  v_mfma_f32_16x16x32_bf16 v[64:67], a[176:179], a[32:35], v[64:67]
  ds_read_b64_tr_b16 a[166:167], v8 offset:34816
  v_mfma_f32_16x16x32_bf16 v[64:67], a[180:183], a[48:51], v[64:67]
  v_mfma_f32_16x16x32_bf16 v[68:71], a[180:183], a[52:55], v[68:71]
  ds_read_b64_tr_b16 a[168:169], v8 offset:36864
  buffer_load_dwordx4 a[148:151], v1, s[4:7], s53 offen offset:1024 sc1
  v_mfma_f32_16x16x32_bf16 v[68:71], a[176:179], a[36:39], v[68:71]
  v_mfma_f32_16x16x32_bf16 v[72:75], a[176:179], a[40:43], v[72:75]
  ds_read_b64_tr_b16 a[170:171], v8 offset:38912
  v_mfma_f32_16x16x32_bf16 v[72:75], a[180:183], a[56:59], v[72:75]
  v_mfma_f32_16x16x32_bf16 v[76:79], a[180:183], a[60:63], v[76:79]
  ds_read_b64_tr_b16 a[172:173], v9 offset:32768
  s_add_u32 s53, s53, 262144
  v_mfma_f32_16x16x32_bf16 v[76:79], a[176:179], a[44:47], v[76:79]
  buffer_load_dwordx4 a[136:139], v1, s[4:7], s53 offen offset:0 sc1
  s_waitcnt lgkmcnt(5)
  v_mfma_f32_16x16x32_bf16 v[92:95], a[184:187], a[44:47], v[92:95]
  ds_read_b64_tr_b16 a[174:175], v9 offset:34816
  v_mfma_f32_16x16x32_bf16 v[92:95], a[160:163], a[60:63], v[92:95]
  v_mfma_f32_16x16x32_bf16 v[88:91], a[160:163], a[56:59], v[88:91]
  ds_read_b64_tr_b16 a[176:177], v9 offset:36864
  v_mfma_f32_16x16x32_bf16 v[88:91], a[184:187], a[40:43], v[88:91]
  buffer_load_dwordx4 a[152:155], v1, s[4:7], s53 offen offset:1024 sc1
  v_mfma_f32_16x16x32_bf16 v[84:87], a[184:187], a[36:39], v[84:87]
  ds_read_b64_tr_b16 a[178:179], v9 offset:38912
  v_mfma_f32_16x16x32_bf16 v[84:87], a[160:163], a[52:55], v[84:87]
  v_mfma_f32_16x16x32_bf16 v[80:83], a[160:163], a[48:51], v[80:83]
  ds_read_b64_tr_b16 a[180:181], v6 offset:40960
  v_mfma_f32_16x16x32_bf16 v[80:83], a[184:187], a[32:35], v[80:83]
  s_add_u32 s53, s53, 262144
  s_waitcnt lgkmcnt(5)
  v_mfma_f32_16x16x32_bf16 v[96:99], a[164:167], a[32:35], v[96:99]
  ds_read_b64_tr_b16 a[182:183], v6 offset:43008
  buffer_load_dwordx4 a[140:143], v1, s[4:7], s53 offen offset:0 sc1
  v_mfma_f32_16x16x32_bf16 v[96:99], a[168:171], a[48:51], v[96:99]
  v_mfma_f32_16x16x32_bf16 v[100:103], a[168:171], a[52:55], v[100:103]
  ds_read_b64_tr_b16 a[184:185], v6 offset:45056
  v_mfma_f32_16x16x32_bf16 v[100:103], a[164:167], a[36:39], v[100:103]
  v_mfma_f32_16x16x32_bf16 v[104:107], a[164:167], a[40:43], v[104:107]
  ds_read_b64_tr_b16 a[186:187], v6 offset:47104
  buffer_load_dwordx4 a[156:159], v1, s[4:7], s53 offen offset:1024 sc1
  v_mfma_f32_16x16x32_bf16 v[104:107], a[168:171], a[56:59], v[104:107]
  v_mfma_f32_16x16x32_bf16 v[108:111], a[168:171], a[60:63], v[108:111]
  ds_read_b64_tr_b16 a[160:161], v7 offset:40960
  v_mfma_f32_16x16x32_bf16 v[108:111], a[164:167], a[44:47], v[108:111]
  s_waitcnt lgkmcnt(5)
  v_mfma_f32_16x16x32_bf16 v[124:127], a[172:175], a[44:47], v[124:127]
  ds_read_b64_tr_b16 a[162:163], v7 offset:43008
  s_cmp_eq_u32 s67, 0
  s_cselect_b32 s54, 7, 0
  s_lshl_b32 s46, s54, 17
  s_lshl_b32 s54, s54, 11
  s_add_u32 s54, s54, s60
  s_add_u32 m0, s31, 32768
  v_mfma_f32_16x16x32_bf16 v[124:127], a[176:179], a[60:63], v[124:127]
  buffer_load_dwordx4 v32, s[16:19], s46 offen lds
  v_mfma_f32_16x16x32_bf16 v[120:123], a[176:179], a[56:59], v[120:123]
  ds_read_b64_tr_b16 a[164:165], v7 offset:45056
  v_mfma_f32_16x16x32_bf16 v[120:123], a[172:175], a[40:43], v[120:123]
  v_mfma_f32_16x16x32_bf16 v[116:119], a[172:175], a[36:39], v[116:119]
  ds_read_b64_tr_b16 a[166:167], v7 offset:47104
  s_add_u32 m0, s31, 36864
  s_add_u32 s37, s46, 65536
  v_mfma_f32_16x16x32_bf16 v[116:119], a[176:179], a[52:55], v[116:119]
  buffer_load_dwordx4 v32, s[16:19], s37 offen lds
  v_mfma_f32_16x16x32_bf16 v[112:115], a[176:179], a[48:51], v[112:115]
  ds_read_b64_tr_b16 a[168:169], v8 offset:40960
  v_mfma_f32_16x16x32_bf16 v[112:115], a[172:175], a[32:35], v[112:115]
  s_waitcnt lgkmcnt(5)
  v_mfma_f32_16x16x32_bf16 v[128:131], a[180:183], a[32:35], v[128:131]
  ds_read_b64_tr_b16 a[170:171], v8 offset:43008
  v_mfma_f32_16x16x32_bf16 v[128:131], a[184:187], a[48:51], v[128:131]
  s_add_u32 m0, s31, 40960
  v_mfma_f32_16x16x32_bf16 v[132:135], a[184:187], a[52:55], v[132:135]
  ds_read_b64_tr_b16 a[172:173], v8 offset:45056
  buffer_load_dwordx4 v33, s[16:19], s46 offen lds
  v_mfma_f32_16x16x32_bf16 v[132:135], a[180:183], a[36:39], v[132:135]
  v_mfma_f32_16x16x32_bf16 v[136:139], a[180:183], a[40:43], v[136:139]
  ds_read_b64_tr_b16 a[174:175], v8 offset:47104
  v_mfma_f32_16x16x32_bf16 v[136:139], a[184:187], a[56:59], v[136:139]
  s_add_u32 m0, s31, 45056
  s_add_u32 s37, s46, 65536
  v_mfma_f32_16x16x32_bf16 v[140:143], a[184:187], a[60:63], v[140:143]
  ds_read_b64_tr_b16 a[176:177], v9 offset:40960
  buffer_load_dwordx4 v33, s[16:19], s37 offen lds
  v_mfma_f32_16x16x32_bf16 v[140:143], a[180:183], a[44:47], v[140:143]
  s_waitcnt lgkmcnt(5)
  v_mfma_f32_16x16x32_bf16 v[156:159], a[160:163], a[44:47], v[156:159]
  ds_read_b64_tr_b16 a[178:179], v9 offset:43008
  v_mfma_f32_16x16x32_bf16 v[156:159], a[164:167], a[60:63], v[156:159]
  v_mfma_f32_16x16x32_bf16 v[152:155], a[164:167], a[56:59], v[152:155]
  ds_read_b64_tr_b16 a[180:181], v9 offset:45056
  s_cmp_eq_u32 s67, 1
  s_cselect_b32 s55, 9, 2
  s_lshl_b32 s47, s55, 17
  s_lshl_b32 s55, s55, 11
  s_add_u32 s55, s55, s60
  s_add_u32 m0, s31, 49152
  v_mfma_f32_16x16x32_bf16 v[152:155], a[160:163], a[40:43], v[152:155]
  buffer_load_dwordx4 v32, s[16:19], s47 offen lds
  v_mfma_f32_16x16x32_bf16 v[148:151], a[160:163], a[36:39], v[148:151]
  ds_read_b64_tr_b16 a[182:183], v9 offset:47104
  v_mfma_f32_16x16x32_bf16 v[148:151], a[164:167], a[52:55], v[148:151]
  v_mfma_f32_16x16x32_bf16 v[144:147], a[164:167], a[48:51], v[144:147]
  ds_read_b64_tr_b16 a[184:185], v6 offset:49152
  s_add_u32 m0, s31, 53248
  s_add_u32 s37, s47, 65536
  v_mfma_f32_16x16x32_bf16 v[144:147], a[160:163], a[32:35], v[144:147]
  buffer_load_dwordx4 v32, s[16:19], s37 offen lds
  s_waitcnt lgkmcnt(5)
  v_mfma_f32_16x16x32_bf16 v[160:163], a[168:171], a[32:35], v[160:163]
  ds_read_b64_tr_b16 a[186:187], v6 offset:51200
  v_mfma_f32_16x16x32_bf16 v[160:163], a[172:175], a[48:51], v[160:163]
  v_mov_b32 v38, 1
  v_mov_b32 v39, 0
  s_waitcnt vmcnt(14)
  s_mov_b64 exec, 1
  buffer_store_dword v38, v39, s[4:7], s56 offen offset:16 sc1
  s_mov_b64 exec, -1
  v_mfma_f32_16x16x32_bf16 v[164:167], a[172:175], a[52:55], v[164:167]
  ds_read_b64_tr_b16 a[160:161], v6 offset:53248
  v_lshrrev_b32 v52, 4, v1
  v_mfma_f32_16x16x32_bf16 v[164:167], a[168:171], a[36:39], v[164:167]
  s_add_u32 m0, s31, 57344
  s_lshl_b32 s28, s24, 8
  v_mfma_f32_16x16x32_bf16 v[168:171], a[168:171], a[40:43], v[168:171]
  ds_read_b64_tr_b16 a[162:163], v6 offset:55296
  buffer_load_dwordx4 v33, s[16:19], s47 offen lds
  v_mfma_f32_16x16x32_bf16 v[168:171], a[172:175], a[56:59], v[168:171]
  s_add_u32 s28, s28, 135168
  v_lshrrev_b32 v49, 4, v52
  v_mfma_f32_16x16x32_bf16 v[172:175], a[172:175], a[60:63], v[172:175]
  ds_read_b64_tr_b16 a[164:165], v7 offset:49152
  v_lshl_add_u32 v46, v49, 4, s28
  v_mfma_f32_16x16x32_bf16 v[172:175], a[168:171], a[44:47], v[172:175]
  s_add_u32 m0, s31, 61440
  s_add_u32 s37, s47, 65536
  s_waitcnt lgkmcnt(5)
  v_mfma_f32_16x16x32_bf16 v[188:191], a[176:179], a[44:47], v[188:191]
  ds_read_b64_tr_b16 a[166:167], v7 offset:51200
  buffer_load_dwordx4 v33, s[16:19], s37 offen lds
  v_mfma_f32_16x16x32_bf16 v[188:191], a[180:183], a[60:63], v[188:191]
  v_and_b32 v47, 31, v52
  v_lshlrev_b32 v47, 2, v47
  v_mfma_f32_16x16x32_bf16 v[184:187], a[180:183], a[56:59], v[184:187]
  ds_read_b64_tr_b16 a[168:169], v7 offset:53248
  v_add_u32 v45, s28, v47
  v_mfma_f32_16x16x32_bf16 v[184:187], a[176:179], a[40:43], v[184:187]
  v_lshrrev_b32 v48, 2, v52
  v_bfe_u32 v50, v52, 3, 2
  v_mfma_f32_16x16x32_bf16 v[180:183], a[176:179], a[36:39], v[180:183]
  ds_read_b64_tr_b16 a[170:171], v7 offset:55296
  s_cmp_eq_u32 s67, 2
  s_cselect_b32 s48, 11, 4
  s_lshl_b32 s40, s48, 17
  s_lshl_b32 s48, s48, 11
  s_add_u32 s48, s48, s60
  s_add_u32 m0, s31, 65536
  v_mfma_f32_16x16x32_bf16 v[180:183], a[180:183], a[52:55], v[180:183]
  buffer_load_dwordx4 v32, s[16:19], s40 offen lds
  v_and_b32 v51, 3, v52
  v_mfma_f32_16x16x32_bf16 v[176:179], a[180:183], a[48:51], v[176:179]
  ds_read_b64_tr_b16 a[172:173], v8 offset:49152
  v_xor_b32 v50, v50, v51
  v_mfma_f32_16x16x32_bf16 v[176:179], a[176:179], a[32:35], v[176:179]
  v_lshlrev_b32 v50, 4, v50
  s_waitcnt vmcnt(38) lgkmcnt(5)
  v_mfma_f32_16x16x32_bf16 v[64:67], a[184:187], a[64:67], v[64:67]
  ds_read_b64_tr_b16 a[174:175], v8 offset:51200
  s_add_u32 m0, s31, 69632
  s_add_u32 s37, s40, 65536
  v_mfma_f32_16x16x32_bf16 v[64:67], a[160:163], a[80:83], v[64:67]
  buffer_load_dwordx4 v32, s[16:19], s37 offen lds
  v_lshl_add_u32 v40, v48, 11, v50
  v_mfma_f32_16x16x32_bf16 v[68:71], a[160:163], a[84:87], v[68:71]
  ds_read_b64_tr_b16 a[176:177], v8 offset:53248
  v_bfe_u32 v48, v52, 4, 1
  v_mfma_f32_16x16x32_bf16 v[68:71], a[184:187], a[68:71], v[68:71]
  v_lshrrev_b32 v50, 5, v52
  v_lshl_add_u32 v48, v48, 1, v50
  v_mfma_f32_16x16x32_bf16 v[72:75], a[184:187], a[72:75], v[72:75]
  ds_read_b64_tr_b16 a[178:179], v8 offset:55296
  v_bfe_u32 v50, v52, 1, 2
  v_mfma_f32_16x16x32_bf16 v[72:75], a[160:163], a[88:91], v[72:75]
  s_cmp_eq_u32 s67, 3
  s_cselect_b32 s49, 13, 6
  s_lshl_b32 s41, s49, 17
  s_lshl_b32 s49, s49, 11
  s_add_u32 s49, s49, s60
  s_add_u32 m0, s31, 81920
  v_xor_b32 v48, v48, v50
  v_mfma_f32_16x16x32_bf16 v[76:79], a[160:163], a[92:95], v[76:79]
  ds_read_b64_tr_b16 a[180:181], v9 offset:49152
  buffer_load_dwordx4 v32, s[16:19], s41 offen lds
  v_mfma_f32_16x16x32_bf16 v[76:79], a[184:187], a[76:79], v[76:79]
  v_lshlrev_b32 v48, 4, v48
  s_waitcnt lgkmcnt(5)
  v_mfma_f32_16x16x32_bf16 v[92:95], a[164:167], a[76:79], v[92:95]
  ds_read_b64_tr_b16 a[182:183], v9 offset:51200
  v_and_b32 v50, 15, v52
  v_mfma_f32_16x16x32_bf16 v[92:95], a[168:171], a[92:95], v[92:95]
  s_add_u32 m0, s31, 86016
  s_add_u32 s37, s41, 65536
  v_mfma_f32_16x16x32_bf16 v[88:91], a[168:171], a[88:91], v[88:91]
  ds_read_b64_tr_b16 a[184:185], v9 offset:53248
  buffer_load_dwordx4 v32, s[16:19], s37 offen lds
  v_mfma_f32_16x16x32_bf16 v[88:91], a[164:167], a[72:75], v[88:91]
  v_lshl_add_u32 v48, v50, 6, v48
  v_add_u32 v42, s66, v48
  v_mfma_f32_16x16x32_bf16 v[84:87], a[164:167], a[68:71], v[84:87]
  ds_read_b64_tr_b16 a[186:187], v9 offset:55296
  v_add_u32 v43, s66, v1
  v_mfma_f32_16x16x32_bf16 v[84:87], a[168:171], a[84:87], v[84:87]
  v_bfe_u32 v48, v52, 2, 2
  v_lshrrev_b32 v49, 4, v52
  v_mfma_f32_16x16x32_bf16 v[80:83], a[168:171], a[80:83], v[80:83]
  ds_read_b64_tr_b16 a[160:161], v6 offset:57344
  s_add_u32 m0, s31, 73728
  v_mfma_f32_16x16x32_bf16 v[80:83], a[164:167], a[64:67], v[80:83]
  buffer_load_dwordx4 v33, s[16:19], s40 offen lds
  s_waitcnt lgkmcnt(5)
  v_mfma_f32_16x16x32_bf16 v[96:99], a[172:175], a[64:67], v[96:99]
  ds_read_b64_tr_b16 a[162:163], v6 offset:59392
  v_cmp_eq_u32 vcc, v48, v49
  v_mfma_f32_16x16x32_bf16 v[96:99], a[176:179], a[80:83], v[96:99]
  v_and_b32 v48, 1, v52
  v_lshlrev_b32 v48, 4, v48
  v_mfma_f32_16x16x32_bf16 v[100:103], a[176:179], a[84:87], v[100:103]
  ds_read_b64_tr_b16 a[164:165], v6 offset:61440
  s_add_u32 m0, s31, 77824
  s_add_u32 s37, s40, 65536
  v_mfma_f32_16x16x32_bf16 v[100:103], a[172:175], a[68:71], v[100:103]
  buffer_load_dwordx4 v33, s[16:19], s37 offen lds
  v_mov_b32 v49, 0x3f80
  v_mfma_f32_16x16x32_bf16 v[104:107], a[172:175], a[72:75], v[104:107]
  ds_read_b64_tr_b16 a[166:167], v6 offset:63488
  v_lshlrev_b32 v48, v48, v49
  v_mfma_f32_16x16x32_bf16 v[104:107], a[176:179], a[88:91], v[104:107]
  v_cndmask_b32 v48, 0, v48, vcc
  v_and_b32 v49, 2, v52
  v_mfma_f32_16x16x32_bf16 v[108:111], a[176:179], a[92:95], v[108:111]
  ds_read_b64_tr_b16 a[168:169], v7 offset:57344
  v_cmp_eq_u32 vcc, 0, v49
  v_mfma_f32_16x16x32_bf16 v[108:111], a[172:175], a[76:79], v[108:111]
  v_mov_b32 v56, 0
  s_waitcnt lgkmcnt(5)
  v_mfma_f32_16x16x32_bf16 v[124:127], a[180:183], a[76:79], v[124:127]
  ds_read_b64_tr_b16 a[170:171], v7 offset:59392
  v_mov_b32 v57, 0
  v_mfma_f32_16x16x32_bf16 v[124:127], a[184:187], a[92:95], v[124:127]
  v_cndmask_b32 v58, 0, v48, vcc
  v_sub_u32 v59, v48, v58
  v_mfma_f32_16x16x32_bf16 v[120:123], a[184:187], a[88:91], v[120:123]
  ds_read_b64_tr_b16 a[172:173], v7 offset:61440
  v_mov_b32 v60, 0
  v_mfma_f32_16x16x32_bf16 v[120:123], a[180:183], a[72:75], v[120:123]
  v_mov_b32 v61, 0
  v_mfma_f32_16x16x32_bf16 v[116:119], a[180:183], a[68:71], v[116:119]
  ds_read_b64_tr_b16 a[174:175], v7 offset:63488
  v_mfma_f32_16x16x32_bf16 v[116:119], a[184:187], a[84:87], v[116:119]
  v_mfma_f32_16x16x32_bf16 v[112:115], a[184:187], a[80:83], v[112:115]
  ds_read_b64_tr_b16 a[176:177], v8 offset:57344
  v_mfma_f32_16x16x32_bf16 v[112:115], a[180:183], a[64:67], v[112:115]
  s_add_u32 s38, s64, 0
  s_waitcnt lgkmcnt(5)
  v_mfma_f32_16x16x32_bf16 v[128:131], a[160:163], a[64:67], v[128:131]
  ds_read_b64_tr_b16 a[178:179], v8 offset:59392
  buffer_load_dword v48, v47, s[4:7], s38 offen sc1
  v_mfma_f32_16x16x32_bf16 v[128:131], a[164:167], a[80:83], v[128:131]
  v_mfma_f32_16x16x32_bf16 v[132:135], a[164:167], a[84:87], v[132:135]
  ds_read_b64_tr_b16 a[180:181], v8 offset:61440
  v_mfma_f32_16x16x32_bf16 v[132:135], a[160:163], a[68:71], v[132:135]
  v_mfma_f32_16x16x32_bf16 v[136:139], a[160:163], a[72:75], v[136:139]
  ds_read_b64_tr_b16 a[182:183], v8 offset:63488
  s_add_u32 s38, s64, 24576
  v_mfma_f32_16x16x32_bf16 v[136:139], a[164:167], a[88:91], v[136:139]
  buffer_load_dword v49, v47, s[4:7], s38 offen sc1
  v_mfma_f32_16x16x32_bf16 v[140:143], a[164:167], a[92:95], v[140:143]
  ds_read_b64_tr_b16 a[184:185], v9 offset:57344
  v_mfma_f32_16x16x32_bf16 v[140:143], a[160:163], a[76:79], v[140:143]
  s_waitcnt lgkmcnt(5)
  v_mfma_f32_16x16x32_bf16 v[156:159], a[168:171], a[76:79], v[156:159]
  ds_read_b64_tr_b16 a[186:187], v9 offset:59392
  s_add_u32 s38, s64, 49152
  v_mfma_f32_16x16x32_bf16 v[156:159], a[172:175], a[92:95], v[156:159]
  s_add_u32 s58, s58, 16
  buffer_load_dword v50, v47, s[4:7], s38 offen sc1
  v_mfma_f32_16x16x32_bf16 v[152:155], a[172:175], a[88:91], v[152:155]
  ds_read_b64_tr_b16 a[160:161], v9 offset:61440
  buffer_load_dword v36, v37, s[4:7], s58 offen sc1
  v_mfma_f32_16x16x32_bf16 v[152:155], a[168:171], a[72:75], v[152:155]
  v_mfma_f32_16x16x32_bf16 v[148:151], a[168:171], a[68:71], v[148:151]
  ds_read_b64_tr_b16 a[162:163], v9 offset:63488
  v_mfma_f32_16x16x32_bf16 v[148:151], a[172:175], a[84:87], v[148:151]
  s_add_u32 s38, s64, 73728
  s_waitcnt vmcnt(39)
  s_barrier
  v_mfma_f32_16x16x32_bf16 v[144:147], a[172:175], a[80:83], v[144:147]
  ds_read_b64_tr_b16 a[164:165], v2 offset:0
  buffer_load_dword v51, v47, s[4:7], s38 offen sc1
  v_mfma_f32_16x16x32_bf16 v[144:147], a[168:171], a[64:67], v[144:147]
  s_waitcnt lgkmcnt(5)
  v_mfma_f32_16x16x32_bf16 v[160:163], a[176:179], a[64:67], v[160:163]
  ds_read_b64_tr_b16 a[166:167], v2 offset:2048
  v_mfma_f32_16x16x32_bf16 v[160:163], a[180:183], a[80:83], v[160:163]
  s_add_u32 s38, s65, 0
  v_mfma_f32_16x16x32_bf16 v[164:167], a[180:183], a[84:87], v[164:167]
  ds_read_b64_tr_b16 a[168:169], v2 offset:4096
  buffer_load_dwordx4 v[192:195], v1, s[4:7], s38 offen sc1
  v_mfma_f32_16x16x32_bf16 v[164:167], a[176:179], a[68:71], v[164:167]
  v_mfma_f32_16x16x32_bf16 v[168:171], a[176:179], a[72:75], v[168:171]
  ds_read_b64_tr_b16 a[170:171], v2 offset:6144
  v_mfma_f32_16x16x32_bf16 v[168:171], a[180:183], a[88:91], v[168:171]
  v_mfma_f32_16x16x32_bf16 v[172:175], a[180:183], a[92:95], v[172:175]
  ds_read_b64_tr_b16 a[172:173], v3 offset:0
  s_add_u32 s38, s65, 65536
  v_mfma_f32_16x16x32_bf16 v[172:175], a[176:179], a[76:79], v[172:175]
  buffer_load_dwordx4 v[196:199], v1, s[4:7], s38 offen sc1
  s_waitcnt lgkmcnt(5)
  v_mfma_f32_16x16x32_bf16 v[188:191], a[184:187], a[76:79], v[188:191]
  ds_read_b64_tr_b16 a[174:175], v3 offset:2048
  v_mfma_f32_16x16x32_bf16 v[188:191], a[160:163], a[92:95], v[188:191]
  v_mfma_f32_16x16x32_bf16 v[184:187], a[160:163], a[88:91], v[184:187]
  ds_read_b64_tr_b16 a[176:177], v3 offset:4096
  s_add_u32 s38, s65, 131072
  v_mfma_f32_16x16x32_bf16 v[184:187], a[184:187], a[72:75], v[184:187]
  buffer_load_dwordx4 v[200:203], v1, s[4:7], s38 offen sc1
  v_mfma_f32_16x16x32_bf16 v[180:183], a[184:187], a[68:71], v[180:183]
  ds_read_b64_tr_b16 a[178:179], v3 offset:6144
  v_mfma_f32_16x16x32_bf16 v[180:183], a[160:163], a[84:87], v[180:183]
  v_mfma_f32_16x16x32_bf16 v[176:179], a[160:163], a[80:83], v[176:179]
  ds_read_b64_tr_b16 a[180:181], v4 offset:0
  v_mfma_f32_16x16x32_bf16 v[176:179], a[184:187], a[64:67], v[176:179]
  s_add_u32 s38, s65, 196608
  s_waitcnt vmcnt(33) lgkmcnt(5)
  v_mfma_f32_16x16x32_bf16 v[64:67], a[164:167], a[96:99], v[64:67]
  ds_read_b64_tr_b16 a[182:183], v4 offset:2048
  buffer_load_dwordx4 v[204:207], v1, s[4:7], s38 offen sc1
  v_mfma_f32_16x16x32_bf16 v[64:67], a[168:171], a[112:115], v[64:67]
  v_mfma_f32_16x16x32_bf16 v[68:71], a[168:171], a[116:119], v[68:71]
  ds_read_b64_tr_b16 a[184:185], v4 offset:4096
  v_mfma_f32_16x16x32_bf16 v[68:71], a[164:167], a[100:103], v[68:71]
  s_cmp_eq_u32 s67, 0
  s_cselect_b32 s50, 0, 7
  s_lshl_b32 s42, s50, 17
  s_lshl_b32 s50, s50, 11
  s_add_u32 s50, s50, s60
  s_add_u32 m0, s31, 98304
  v_mfma_f32_16x16x32_bf16 v[72:75], a[164:167], a[104:107], v[72:75]
  ds_read_b64_tr_b16 a[186:187], v4 offset:6144
  buffer_load_dwordx4 v32, s[16:19], s42 offen lds
  v_mfma_f32_16x16x32_bf16 v[72:75], a[168:171], a[120:123], v[72:75]
  v_mfma_f32_16x16x32_bf16 v[76:79], a[168:171], a[124:127], v[76:79]
  ds_read_b64_tr_b16 a[160:161], v5 offset:0
  v_mfma_f32_16x16x32_bf16 v[76:79], a[164:167], a[108:111], v[76:79]
  s_waitcnt lgkmcnt(5)
  v_mfma_f32_16x16x32_bf16 v[92:95], a[172:175], a[108:111], v[92:95]
  ds_read_b64_tr_b16 a[162:163], v5 offset:2048
  s_add_u32 m0, s31, 102400
  s_add_u32 s37, s42, 65536
  v_mfma_f32_16x16x32_bf16 v[92:95], a[176:179], a[124:127], v[92:95]
  buffer_load_dwordx4 v32, s[16:19], s37 offen lds
  v_mfma_f32_16x16x32_bf16 v[88:91], a[176:179], a[120:123], v[88:91]
  ds_read_b64_tr_b16 a[164:165], v5 offset:4096
  v_mfma_f32_16x16x32_bf16 v[88:91], a[172:175], a[104:107], v[88:91]
  v_mfma_f32_16x16x32_bf16 v[84:87], a[172:175], a[100:103], v[84:87]
  ds_read_b64_tr_b16 a[166:167], v5 offset:6144
  s_cmp_eq_u32 s67, 1
  s_cselect_b32 s51, 2, 9
  s_lshl_b32 s43, s51, 17
  s_lshl_b32 s51, s51, 11
  s_add_u32 s51, s51, s60
  s_add_u32 m0, s31, 114688
  v_mfma_f32_16x16x32_bf16 v[84:87], a[176:179], a[116:119], v[84:87]
  buffer_load_dwordx4 v32, s[16:19], s43 offen lds
  v_mfma_f32_16x16x32_bf16 v[80:83], a[176:179], a[112:115], v[80:83]
  ds_read_b64_tr_b16 a[168:169], v2 offset:8192
  v_mfma_f32_16x16x32_bf16 v[80:83], a[172:175], a[96:99], v[80:83]
  s_waitcnt lgkmcnt(5)
  v_mfma_f32_16x16x32_bf16 v[96:99], a[180:183], a[96:99], v[96:99]
  ds_read_b64_tr_b16 a[170:171], v2 offset:10240
  v_mfma_f32_16x16x32_bf16 v[96:99], a[184:187], a[112:115], v[96:99]
  s_add_u32 m0, s31, 118784
  s_add_u32 s37, s43, 65536
  v_mfma_f32_16x16x32_bf16 v[100:103], a[184:187], a[116:119], v[100:103]
  ds_read_b64_tr_b16 a[172:173], v2 offset:12288
  s_waitcnt vmcnt(8)
  v_cmp_ne_u32 vcc, 1, v36
  s_nop 4
  s_cbranch_vccz PL2_k5_ffn_kernelx
  s_mov_b32 s59, 60000
PL2_k5_ffn_kernel:
  buffer_load_dword v36, v37, s[4:7], s58 offen sc1
  s_sub_u32 s59, s59, 1
  s_cmp_eq_u32 s59, 0
  s_waitcnt vmcnt(0)
  s_cbranch_scc1 PL2_k5_ffn_kernelx
  v_cmp_ne_u32 vcc, 1, v36
  s_nop 4
  s_cbranch_vccnz PL2_k5_ffn_kernel
PL2_k5_ffn_kernelx:
  buffer_load_dwordx4 v32, s[16:19], s37 offen lds
  v_mfma_f32_16x16x32_bf16 v[100:103], a[180:183], a[100:103], v[100:103]
  v_mfma_f32_16x16x32_bf16 v[104:107], a[180:183], a[104:107], v[104:107]
  ds_read_b64_tr_b16 a[174:175], v2 offset:14336
  v_mfma_f32_16x16x32_bf16 v[104:107], a[184:187], a[120:123], v[104:107]
  v_mfma_f32_16x16x32_bf16 v[108:111], a[184:187], a[124:127], v[108:111]
  ds_read_b64_tr_b16 a[176:177], v3 offset:8192
  buffer_load_dwordx4 a[0:3], v1, s[4:7], s54 offen offset:0 sc1
  v_mfma_f32_16x16x32_bf16 v[108:111], a[180:183], a[108:111], v[108:111]
  s_waitcnt lgkmcnt(5)
  v_mfma_f32_16x16x32_bf16 v[124:127], a[160:163], a[108:111], v[124:127]
  ds_read_b64_tr_b16 a[178:179], v3 offset:10240
  v_mfma_f32_16x16x32_bf16 v[124:127], a[164:167], a[124:127], v[124:127]
  v_mfma_f32_16x16x32_bf16 v[120:123], a[164:167], a[120:123], v[120:123]
  ds_read_b64_tr_b16 a[180:181], v3 offset:12288
  v_mfma_f32_16x16x32_bf16 v[120:123], a[160:163], a[104:107], v[120:123]
  buffer_load_dwordx4 a[16:19], v1, s[4:7], s54 offen offset:1024 sc1
  v_mfma_f32_16x16x32_bf16 v[116:119], a[160:163], a[100:103], v[116:119]
  ds_read_b64_tr_b16 a[182:183], v3 offset:14336
  v_mfma_f32_16x16x32_bf16 v[116:119], a[164:167], a[116:119], v[116:119]
  v_mfma_f32_16x16x32_bf16 v[112:115], a[164:167], a[112:115], v[112:115]
HOP15:
  s_cbranch_execz WRET1
  ds_read_b64_tr_b16 a[184:185], v4 offset:8192
  s_add_u32 s54, s54, 262144
  v_mfma_f32_16x16x32_bf16 v[112:115], a[160:163], a[96:99], v[112:115]
  buffer_load_dwordx4 a[4:7], v1, s[4:7], s54 offen offset:0 sc1
  s_waitcnt lgkmcnt(5)
  v_mfma_f32_16x16x32_bf16 v[128:131], a[168:171], a[96:99], v[128:131]
  ds_read_b64_tr_b16 a[186:187], v4 offset:10240
  v_mfma_f32_16x16x32_bf16 v[128:131], a[172:175], a[112:115], v[128:131]
  v_mfma_f32_16x16x32_bf16 v[132:135], a[172:175], a[116:119], v[132:135]
  ds_read_b64_tr_b16 a[160:161], v4 offset:12288
  v_mfma_f32_16x16x32_bf16 v[132:135], a[168:171], a[100:103], v[132:135]
  v_mfma_f32_16x16x32_bf16 v[136:139], a[168:171], a[104:107], v[136:139]
  ds_read_b64_tr_b16 a[162:163], v4 offset:14336
  buffer_load_dwordx4 a[20:23], v1, s[4:7], s54 offen offset:1024 sc1
  v_mfma_f32_16x16x32_bf16 v[136:139], a[172:175], a[120:123], v[136:139]
  v_mfma_f32_16x16x32_bf16 v[140:143], a[172:175], a[124:127], v[140:143]
  ds_read_b64_tr_b16 a[164:165], v5 offset:8192
  v_mfma_f32_16x16x32_bf16 v[140:143], a[168:171], a[108:111], v[140:143]
  s_add_u32 s54, s54, 262144
  s_waitcnt lgkmcnt(5)
  v_mfma_f32_16x16x32_bf16 v[156:159], a[176:179], a[108:111], v[156:159]
  ds_read_b64_tr_b16 a[166:167], v5 offset:10240
  buffer_load_dwordx4 a[8:11], v1, s[4:7], s54 offen offset:0 sc1
  v_mfma_f32_16x16x32_bf16 v[156:159], a[180:183], a[124:127], v[156:159]
  v_mfma_f32_16x16x32_bf16 v[152:155], a[180:183], a[120:123], v[152:155]
  ds_read_b64_tr_b16 a[168:169], v5 offset:12288
  v_mfma_f32_16x16x32_bf16 v[152:155], a[176:179], a[104:107], v[152:155]
  v_mfma_f32_16x16x32_bf16 v[148:151], a[176:179], a[100:103], v[148:151]
  ds_read_b64_tr_b16 a[170:171], v5 offset:14336
  v_mfma_f32_16x16x32_bf16 v[148:151], a[180:183], a[116:119], v[148:151]
  buffer_load_dwordx4 a[24:27], v1, s[4:7], s54 offen offset:1024 sc1
  v_mfma_f32_16x16x32_bf16 v[144:147], a[180:183], a[112:115], v[144:147]
  ds_read_b64_tr_b16 a[172:173], v2 offset:16384
  v_mfma_f32_16x16x32_bf16 v[144:147], a[176:179], a[96:99], v[144:147]
  s_waitcnt lgkmcnt(5)
  v_mfma_f32_16x16x32_bf16 v[160:163], a[184:187], a[96:99], v[160:163]
  ds_read_b64_tr_b16 a[174:175], v2 offset:18432
  s_add_u32 s54, s54, 262144
  v_mfma_f32_16x16x32_bf16 v[160:163], a[160:163], a[112:115], v[160:163]
  buffer_load_dwordx4 a[12:15], v1, s[4:7], s54 offen offset:0 sc1
  v_mfma_f32_16x16x32_bf16 v[164:167], a[160:163], a[116:119], v[164:167]
  ds_read_b64_tr_b16 a[176:177], v2 offset:20480
  v_mfma_f32_16x16x32_bf16 v[164:167], a[184:187], a[100:103], v[164:167]
  v_mfma_f32_16x16x32_bf16 v[168:171], a[184:187], a[104:107], v[168:171]
  ds_read_b64_tr_b16 a[178:179], v2 offset:22528
  v_mfma_f32_16x16x32_bf16 v[168:171], a[160:163], a[120:123], v[168:171]
  v_mfma_f32_16x16x32_bf16 v[172:175], a[160:163], a[124:127], v[172:175]
  ds_read_b64_tr_b16 a[180:181], v3 offset:16384
  buffer_load_dwordx4 a[28:31], v1, s[4:7], s54 offen offset:1024 sc1
  v_mfma_f32_16x16x32_bf16 v[172:175], a[184:187], a[108:111], v[172:175]
  s_waitcnt lgkmcnt(5)
  v_mfma_f32_16x16x32_bf16 v[188:191], a[164:167], a[108:111], v[188:191]
  ds_read_b64_tr_b16 a[182:183], v3 offset:18432
  v_mfma_f32_16x16x32_bf16 v[188:191], a[168:171], a[124:127], v[188:191]
  v_mfma_f32_16x16x32_bf16 v[184:187], a[168:171], a[120:123], v[184:187]
  ds_read_b64_tr_b16 a[184:185], v3 offset:20480
  buffer_load_dwordx4 a[188:191], v1, s[4:7], s55 offen offset:0 sc1
  v_mfma_f32_16x16x32_bf16 v[184:187], a[164:167], a[104:107], v[184:187]
  v_mfma_f32_16x16x32_bf16 v[180:183], a[164:167], a[100:103], v[180:183]
  ds_read_b64_tr_b16 a[186:187], v3 offset:22528
  v_mfma_f32_16x16x32_bf16 v[180:183], a[168:171], a[116:119], v[180:183]
  v_mfma_f32_16x16x32_bf16 v[176:179], a[168:171], a[112:115], v[176:179]
  ds_read_b64_tr_b16 a[160:161], v4 offset:16384
  v_mfma_f32_16x16x32_bf16 v[176:179], a[164:167], a[96:99], v[176:179]
  buffer_load_dwordx4 a[204:207], v1, s[4:7], s55 offen offset:1024 sc1
  s_waitcnt vmcnt(38) lgkmcnt(5)
  v_mfma_f32_16x16x32_bf16 v[64:67], a[172:175], a[128:131], v[64:67]
  ds_read_b64_tr_b16 a[162:163], v4 offset:18432
  v_mfma_f32_16x16x32_bf16 v[64:67], a[176:179], a[144:147], v[64:67]
  v_mfma_f32_16x16x32_bf16 v[68:71], a[176:179], a[148:151], v[68:71]
  ds_read_b64_tr_b16 a[164:165], v4 offset:20480
  s_add_u32 s55, s55, 262144
  v_mfma_f32_16x16x32_bf16 v[68:71], a[172:175], a[132:135], v[68:71]
  buffer_load_dwordx4 a[192:195], v1, s[4:7], s55 offen offset:0 sc1
  v_mfma_f32_16x16x32_bf16 v[72:75], a[172:175], a[136:139], v[72:75]
  ds_read_b64_tr_b16 a[166:167], v4 offset:22528
  v_mfma_f32_16x16x32_bf16 v[72:75], a[176:179], a[152:155], v[72:75]
  v_mfma_f32_16x16x32_bf16 v[76:79], a[176:179], a[156:159], v[76:79]
  ds_read_b64_tr_b16 a[168:169], v5 offset:16384
  v_mfma_f32_16x16x32_bf16 v[76:79], a[172:175], a[140:143], v[76:79]
  s_waitcnt lgkmcnt(5)
  v_mfma_f32_16x16x32_bf16 v[92:95], a[180:183], a[140:143], v[92:95]
  ds_read_b64_tr_b16 a[170:171], v5 offset:18432
  buffer_load_dwordx4 a[208:211], v1, s[4:7], s55 offen offset:1024 sc1
  v_mfma_f32_16x16x32_bf16 v[92:95], a[184:187], a[156:159], v[92:95]
  v_mfma_f32_16x16x32_bf16 v[88:91], a[184:187], a[152:155], v[88:91]
  ds_read_b64_tr_b16 a[172:173], v5 offset:20480
  v_mfma_f32_16x16x32_bf16 v[88:91], a[180:183], a[136:139], v[88:91]
  s_add_u32 s55, s55, 262144
  v_mfma_f32_16x16x32_bf16 v[84:87], a[180:183], a[132:135], v[84:87]
  ds_read_b64_tr_b16 a[174:175], v5 offset:22528
  buffer_load_dwordx4 a[196:199], v1, s[4:7], s55 offen offset:0 sc1
  v_mfma_f32_16x16x32_bf16 v[84:87], a[184:187], a[148:151], v[84:87]
  v_mfma_f32_16x16x32_bf16 v[80:83], a[184:187], a[144:147], v[80:83]
  ds_read_b64_tr_b16 a[176:177], v2 offset:24576
  v_mfma_f32_16x16x32_bf16 v[80:83], a[180:183], a[128:131], v[80:83]
  s_waitcnt lgkmcnt(5)
  v_mfma_f32_16x16x32_bf16 v[96:99], a[160:163], a[128:131], v[96:99]
  ds_read_b64_tr_b16 a[178:179], v2 offset:26624
  v_mfma_f32_16x16x32_bf16 v[96:99], a[164:167], a[144:147], v[96:99]
  buffer_load_dwordx4 a[212:215], v1, s[4:7], s55 offen offset:1024 sc1
  v_mfma_f32_16x16x32_bf16 v[100:103], a[164:167], a[148:151], v[100:103]
  ds_read_b64_tr_b16 a[180:181], v2 offset:28672
  v_mfma_f32_16x16x32_bf16 v[100:103], a[160:163], a[132:135], v[100:103]
  v_mfma_f32_16x16x32_bf16 v[104:107], a[160:163], a[136:139], v[104:107]
  ds_read_b64_tr_b16 a[182:183], v2 offset:30720
  s_add_u32 s55, s55, 262144
  v_mfma_f32_16x16x32_bf16 v[104:107], a[164:167], a[152:155], v[104:107]
  buffer_load_dwordx4 a[200:203], v1, s[4:7], s55 offen offset:0 sc1
  v_mfma_f32_16x16x32_bf16 v[108:111], a[164:167], a[156:159], v[108:111]
  ds_read_b64_tr_b16 a[184:185], v3 offset:24576
  v_mfma_f32_16x16x32_bf16 v[108:111], a[160:163], a[140:143], v[108:111]
  s_waitcnt lgkmcnt(5)
  v_mfma_f32_16x16x32_bf16 v[124:127], a[168:171], a[140:143], v[124:127]
  ds_read_b64_tr_b16 a[186:187], v3 offset:26624
  v_mfma_f32_16x16x32_bf16 v[124:127], a[172:175], a[156:159], v[124:127]
  v_mfma_f32_16x16x32_bf16 v[120:123], a[172:175], a[152:155], v[120:123]
  ds_read_b64_tr_b16 a[160:161], v3 offset:28672
  buffer_load_dwordx4 a[216:219], v1, s[4:7], s55 offen offset:1024 sc1
  v_mfma_f32_16x16x32_bf16 v[120:123], a[168:171], a[136:139], v[120:123]
  v_mfma_f32_16x16x32_bf16 v[116:119], a[168:171], a[132:135], v[116:119]
  ds_read_b64_tr_b16 a[162:163], v3 offset:30720
  v_mfma_f32_16x16x32_bf16 v[116:119], a[172:175], a[148:151], v[116:119]
  v_mfma_f32_16x16x32_bf16 v[112:115], a[172:175], a[144:147], v[112:115]
  ds_read_b64_tr_b16 a[164:165], v4 offset:24576
  buffer_load_dwordx4 a[220:223], v1, s[4:7], s48 offen offset:0 sc1
  v_mfma_f32_16x16x32_bf16 v[112:115], a[168:171], a[128:131], v[112:115]
  s_waitcnt lgkmcnt(5)
  v_mfma_f32_16x16x32_bf16 v[128:131], a[176:179], a[128:131], v[128:131]
  ds_read_b64_tr_b16 a[166:167], v4 offset:26624
  v_mfma_f32_16x16x32_bf16 v[128:131], a[180:183], a[144:147], v[128:131]
  s_waitcnt vmcnt(21)
  v_add_f32 v48, v48, v49
  v_mfma_f32_16x16x32_bf16 v[132:135], a[180:183], a[148:151], v[132:135]
  ds_read_b64_tr_b16 a[168:169], v4 offset:28672
  v_add_f32 v50, v50, v51
  v_mfma_f32_16x16x32_bf16 v[132:135], a[176:179], a[132:135], v[132:135]
  buffer_load_dwordx4 a[236:239], v1, s[4:7], s48 offen offset:1024 sc1
  v_add_f32 v48, v48, v50
  v_mfma_f32_16x16x32_bf16 v[136:139], a[176:179], a[136:139], v[136:139]
  ds_read_b64_tr_b16 a[170:171], v4 offset:30720
  v_cvt_pk_bf16_f32 v48, v48, v48
  v_mfma_f32_16x16x32_bf16 v[136:139], a[180:183], a[152:155], v[136:139]
  v_lshlrev_b32 v48, 16, v48
  ds_write_b32 v45, v48
  v_mfma_f32_16x16x32_bf16 v[140:143], a[180:183], a[156:159], v[140:143]
  ds_read_b64_tr_b16 a[172:173], v5 offset:24576
  s_add_u32 s48, s48, 262144
  v_mfma_f32_16x16x32_bf16 v[140:143], a[176:179], a[140:143], v[140:143]
  buffer_load_dwordx4 a[224:227], v1, s[4:7], s48 offen offset:0 sc1
  s_waitcnt lgkmcnt(6)
  v_mfma_f32_16x16x32_bf16 v[156:159], a[184:187], a[140:143], v[156:159]
  ds_read_b64_tr_b16 a[174:175], v5 offset:26624
  ds_read_b128 v[48:51], v46 offset:0
  v_mfma_f32_16x16x32_bf16 v[156:159], a[160:163], a[156:159], v[156:159]
  ds_read_b128 v[52:55], v46 offset:64
  v_lshlrev_b32 v208, 16, v192
  v_mfma_f32_16x16x32_bf16 v[152:155], a[160:163], a[152:155], v[152:155]
  ds_read_b64_tr_b16 a[176:177], v5 offset:28672
  v_and_b32 v209, 0xffff0000, v192
  v_mfma_f32_16x16x32_bf16 v[152:155], a[184:187], a[136:139], v[152:155]
  v_lshlrev_b32 v210, 16, v193
  v_and_b32 v211, 0xffff0000, v193
  v_mfma_f32_16x16x32_bf16 v[148:151], a[184:187], a[132:135], v[148:151]
  ds_read_b64_tr_b16 a[178:179], v5 offset:30720
  buffer_load_dwordx4 a[240:243], v1, s[4:7], s48 offen offset:1024 sc1
  v_mfma_f32_16x16x32_bf16 v[148:151], a[160:163], a[148:151], v[148:151]
  s_waitcnt vmcnt(39)
  s_barrier
  v_mfma_f32_16x16x32_bf16 v[144:147], a[160:163], a[144:147], v[144:147]
  ds_read_b64_tr_b16 a[180:181], v2 offset:32768
  v_lshlrev_b32 v212, 16, v194
  v_mfma_f32_16x16x32_bf16 v[144:147], a[184:187], a[128:131], v[144:147]
  s_add_u32 s48, s48, 262144
  s_waitcnt lgkmcnt(8)
  v_mfma_f32_16x16x32_bf16 v[160:163], a[164:167], a[128:131], v[160:163]
  ds_read_b64_tr_b16 a[182:183], v2 offset:34816
  buffer_load_dwordx4 a[228:231], v1, s[4:7], s48 offen offset:0 sc1
  v_mfma_f32_16x16x32_bf16 v[160:163], a[168:171], a[144:147], v[160:163]
  v_and_b32 v213, 0xffff0000, v194
  v_lshlrev_b32 v214, 16, v195
  v_mfma_f32_16x16x32_bf16 v[164:167], a[168:171], a[148:151], v[164:167]
  ds_read_b64_tr_b16 a[184:185], v2 offset:36864
  v_and_b32 v215, 0xffff0000, v195
  v_mfma_f32_16x16x32_bf16 v[164:167], a[164:167], a[132:135], v[164:167]
  v_lshlrev_b32 v216, 16, v196
  v_and_b32 v217, 0xffff0000, v196
  v_mfma_f32_16x16x32_bf16 v[168:171], a[164:167], a[136:139], v[168:171]
  ds_read_b64_tr_b16 a[186:187], v2 offset:38912
  v_lshlrev_b32 v218, 16, v197
  v_mfma_f32_16x16x32_bf16 v[168:171], a[168:171], a[152:155], v[168:171]
  buffer_load_dwordx4 a[244:247], v1, s[4:7], s48 offen offset:1024 sc1
  v_and_b32 v219, 0xffff0000, v197
  v_mfma_f32_16x16x32_bf16 v[172:175], a[168:171], a[156:159], v[172:175]
  ds_read_b64_tr_b16 a[160:161], v3 offset:32768
  v_lshlrev_b32 v220, 16, v198
  v_mfma_f32_16x16x32_bf16 v[172:175], a[164:167], a[140:143], v[172:175]
  v_and_b32 v221, 0xffff0000, v198
  s_waitcnt lgkmcnt(5)
  v_mfma_f32_16x16x32_bf16 v[188:191], a[172:175], a[140:143], v[188:191]
  ds_read_b64_tr_b16 a[162:163], v3 offset:34816
  s_add_u32 s48, s48, 262144
  v_mfma_f32_16x16x32_bf16 v[188:191], a[176:179], a[156:159], v[188:191]
  buffer_load_dwordx4 a[232:235], v1, s[4:7], s48 offen offset:0 sc1
  v_lshlrev_b32 v222, 16, v199
  v_mfma_f32_16x16x32_bf16 v[184:187], a[176:179], a[152:155], v[184:187]
  ds_read_b64_tr_b16 a[164:165], v3 offset:36864
  v_and_b32 v223, 0xffff0000, v199
  v_mfma_f32_16x16x32_bf16 v[184:187], a[172:175], a[136:139], v[184:187]
  v_lshlrev_b32 v224, 16, v200
  v_and_b32 v225, 0xffff0000, v200
  v_mfma_f32_16x16x32_bf16 v[180:183], a[172:175], a[132:135], v[180:183]
  ds_read_b64_tr_b16 a[166:167], v3 offset:38912
  v_lshlrev_b32 v226, 16, v201
  v_mfma_f32_16x16x32_bf16 v[180:183], a[176:179], a[148:151], v[180:183]
  v_and_b32 v227, 0xffff0000, v201
  v_lshlrev_b32 v228, 16, v202
  v_mfma_f32_16x16x32_bf16 v[176:179], a[176:179], a[144:147], v[176:179]
  ds_read_b64_tr_b16 a[168:169], v4 offset:32768
  buffer_load_dwordx4 a[248:251], v1, s[4:7], s48 offen offset:1024 sc1
  v_mfma_f32_16x16x32_bf16 v[176:179], a[172:175], a[128:131], v[176:179]
  v_and_b32 v229, 0xffff0000, v202
  s_waitcnt vmcnt(16) lgkmcnt(5)
  v_mfma_f32_16x16x32_bf16 v[64:67], a[180:183], a[0:3], v[64:67]
  ds_read_b64_tr_b16 a[170:171], v4 offset:34816
  v_lshlrev_b32 v230, 16, v203
  v_mfma_f32_16x16x32_bf16 v[64:67], a[184:187], a[16:19], v[64:67]
  s_cmp_eq_u32 s67, 2
  s_cselect_b32 s52, 4, 11
  s_lshl_b32 s44, s52, 17
  s_lshl_b32 s52, s52, 11
  s_add_u32 s52, s52, s60
  s_add_u32 m0, s31, 0
  v_and_b32 v231, 0xffff0000, v203
  v_mfma_f32_16x16x32_bf16 v[68:71], a[184:187], a[20:23], v[68:71]
  ds_read_b64_tr_b16 a[172:173], v4 offset:36864
  buffer_load_dwordx4 v32, s[16:19], s44 offen lds
  v_mfma_f32_16x16x32_bf16 v[68:71], a[180:183], a[4:7], v[68:71]
  v_lshlrev_b32 v232, 16, v204
  v_and_b32 v233, 0xffff0000, v204
  v_mfma_f32_16x16x32_bf16 v[72:75], a[180:183], a[8:11], v[72:75]
  ds_read_b64_tr_b16 a[174:175], v4 offset:38912
  v_lshlrev_b32 v234, 16, v205
  v_mfma_f32_16x16x32_bf16 v[72:75], a[184:187], a[24:27], v[72:75]
  v_and_b32 v235, 0xffff0000, v205
  v_lshlrev_b32 v236, 16, v206
  v_mfma_f32_16x16x32_bf16 v[76:79], a[184:187], a[28:31], v[76:79]
  ds_read_b64_tr_b16 a[176:177], v5 offset:32768
  s_add_u32 m0, s31, 4096
  s_add_u32 s37, s44, 65536
  v_mfma_f32_16x16x32_bf16 v[76:79], a[180:183], a[12:15], v[76:79]
  buffer_load_dwordx4 v32, s[16:19], s37 offen lds
  s_waitcnt lgkmcnt(5)
  v_mfma_f32_16x16x32_bf16 v[92:95], a[160:163], a[12:15], v[92:95]
  ds_read_b64_tr_b16 a[178:179], v5 offset:34816
  v_and_b32 v237, 0xffff0000, v206
  v_mfma_f32_16x16x32_bf16 v[92:95], a[164:167], a[28:31], v[92:95]
  v_lshlrev_b32 v238, 16, v207
  v_and_b32 v239, 0xffff0000, v207
  v_mfma_f32_16x16x32_bf16 v[88:91], a[164:167], a[24:27], v[88:91]
  ds_read_b64_tr_b16 a[180:181], v5 offset:36864
  s_cmp_eq_u32 s67, 3
  s_cselect_b32 s53, 6, 13
  s_lshl_b32 s45, s53, 17
  s_lshl_b32 s53, s53, 11
  s_add_u32 s53, s53, s60
  s_add_u32 m0, s31, 16384
  v_mfma_f32_16x16x32_bf16 v[88:91], a[160:163], a[8:11], v[88:91]
  buffer_load_dwordx4 v32, s[16:19], s45 offen lds
  v_mov_b32 v37, 0
  v_mfma_f32_16x16x32_bf16 v[84:87], a[160:163], a[4:7], v[84:87]
  ds_read_b64_tr_b16 a[182:183], v5 offset:38912
  v_mfma_f32_16x16x32_bf16 v[84:87], a[164:167], a[20:23], v[84:87]
  v_mfma_f32_16x16x32_bf16 v[80:83], a[164:167], a[16:19], v[80:83]
  ds_read_b64_tr_b16 a[184:185], v2 offset:40960
  v_mfma_f32_16x16x32_bf16 v[80:83], a[160:163], a[0:3], v[80:83]
  s_add_u32 m0, s31, 20480
  s_add_u32 s37, s45, 65536
  s_waitcnt lgkmcnt(5)
  v_mfma_f32_16x16x32_bf16 v[96:99], a[168:171], a[0:3], v[96:99]
  ds_read_b64_tr_b16 a[186:187], v2 offset:43008
  buffer_load_dwordx4 v32, s[16:19], s37 offen lds
  v_mfma_f32_16x16x32_bf16 v[96:99], a[172:175], a[16:19], v[96:99]
  v_mfma_f32_16x16x32_bf16 v[100:103], a[172:175], a[20:23], v[100:103]
  ds_read_b64_tr_b16 a[160:161], v2 offset:45056
  v_mfma_f32_16x16x32_bf16 v[100:103], a[168:171], a[4:7], v[100:103]
  v_mfma_f32_16x16x32_bf16 v[104:107], a[168:171], a[8:11], v[104:107]
  ds_read_b64_tr_b16 a[162:163], v2 offset:47104
  buffer_load_dwordx4 a[32:35], v1, s[4:7], s49 offen offset:0 sc1
  v_mfma_f32_16x16x32_bf16 v[104:107], a[172:175], a[24:27], v[104:107]
  v_mfma_f32_16x16x32_bf16 v[108:111], a[172:175], a[28:31], v[108:111]
  ds_read_b64_tr_b16 a[164:165], v3 offset:40960
  v_mfma_f32_16x16x32_bf16 v[108:111], a[168:171], a[12:15], v[108:111]
  s_waitcnt lgkmcnt(5)
  v_mfma_f32_16x16x32_bf16 v[124:127], a[176:179], a[12:15], v[124:127]
  ds_read_b64_tr_b16 a[166:167], v3 offset:43008
  v_mfma_f32_16x16x32_bf16 v[124:127], a[180:183], a[28:31], v[124:127]
  buffer_load_dwordx4 a[48:51], v1, s[4:7], s49 offen offset:1024 sc1
  v_mfma_f32_16x16x32_bf16 v[120:123], a[180:183], a[24:27], v[120:123]
  ds_read_b64_tr_b16 a[168:169], v3 offset:45056
  v_mfma_f32_16x16x32_bf16 v[120:123], a[176:179], a[8:11], v[120:123]
  v_mfma_f32_16x16x32_bf16 v[116:119], a[176:179], a[4:7], v[116:119]
  ds_read_b64_tr_b16 a[170:171], v3 offset:47104
  s_add_u32 s49, s49, 262144
  v_mfma_f32_16x16x32_bf16 v[116:119], a[180:183], a[20:23], v[116:119]
  buffer_load_dwordx4 a[36:39], v1, s[4:7], s49 offen offset:0 sc1
  v_mfma_f32_16x16x32_bf16 v[112:115], a[180:183], a[16:19], v[112:115]
  ds_read_b64_tr_b16 a[172:173], v4 offset:40960
  v_mfma_f32_16x16x32_bf16 v[112:115], a[176:179], a[0:3], v[112:115]
  s_waitcnt lgkmcnt(5)
  v_mfma_f32_16x16x32_bf16 v[128:131], a[184:187], a[0:3], v[128:131]
  ds_read_b64_tr_b16 a[174:175], v4 offset:43008
  v_mfma_f32_16x16x32_bf16 v[128:131], a[160:163], a[16:19], v[128:131]
  v_mfma_f32_16x16x32_bf16 v[132:135], a[160:163], a[20:23], v[132:135]
  ds_read_b64_tr_b16 a[176:177], v4 offset:45056
  buffer_load_dwordx4 a[52:55], v1, s[4:7], s49 offen offset:1024 sc1
  v_mfma_f32_16x16x32_bf16 v[132:135], a[184:187], a[4:7], v[132:135]
  v_mfma_f32_16x16x32_bf16 v[136:139], a[184:187], a[8:11], v[136:139]
  ds_read_b64_tr_b16 a[178:179], v4 offset:47104
  v_mfma_f32_16x16x32_bf16 v[136:139], a[160:163], a[24:27], v[136:139]
  s_add_u32 s49, s49, 262144
  v_mfma_f32_16x16x32_bf16 v[140:143], a[160:163], a[28:31], v[140:143]
  ds_read_b64_tr_b16 a[180:181], v5 offset:40960
  buffer_load_dwordx4 a[40:43], v1, s[4:7], s49 offen offset:0 sc1
  v_mfma_f32_16x16x32_bf16 v[140:143], a[184:187], a[12:15], v[140:143]
  s_waitcnt lgkmcnt(5)
  v_mfma_f32_16x16x32_bf16 v[156:159], a[164:167], a[12:15], v[156:159]
  ds_read_b64_tr_b16 a[182:183], v5 offset:43008
  v_mfma_f32_16x16x32_bf16 v[156:159], a[168:171], a[28:31], v[156:159]
  v_mfma_f32_16x16x32_bf16 v[152:155], a[168:171], a[24:27], v[152:155]
  ds_read_b64_tr_b16 a[184:185], v5 offset:45056
  v_mfma_f32_16x16x32_bf16 v[152:155], a[164:167], a[8:11], v[152:155]
  buffer_load_dwordx4 a[56:59], v1, s[4:7], s49 offen offset:1024 sc1
  v_mfma_f32_16x16x32_bf16 v[148:151], a[164:167], a[4:7], v[148:151]
  ds_read_b64_tr_b16 a[186:187], v5 offset:47104
  v_mfma_f32_16x16x32_bf16 v[148:151], a[168:171], a[20:23], v[148:151]
  v_mfma_f32_16x16x32_bf16 v[144:147], a[168:171], a[16:19], v[144:147]
  ds_read_b64_tr_b16 a[160:161], v2 offset:49152
  s_add_u32 s49, s49, 262144
  v_mfma_f32_16x16x32_bf16 v[144:147], a[164:167], a[0:3], v[144:147]
  buffer_load_dwordx4 a[44:47], v1, s[4:7], s49 offen offset:0 sc1
  s_waitcnt lgkmcnt(5)
  v_mfma_f32_16x16x32_bf16 v[160:163], a[172:175], a[0:3], v[160:163]
  ds_read_b64_tr_b16 a[162:163], v2 offset:51200
  v_mfma_f32_16x16x32_bf16 v[160:163], a[176:179], a[16:19], v[160:163]
  v_mfma_f32_16x16x32_bf16 v[164:167], a[176:179], a[20:23], v[164:167]
  ds_read_b64_tr_b16 a[164:165], v2 offset:53248
  v_mfma_f32_16x16x32_bf16 v[164:167], a[172:175], a[4:7], v[164:167]
  v_mfma_f32_16x16x32_bf16 v[168:171], a[172:175], a[8:11], v[168:171]
  ds_read_b64_tr_b16 a[166:167], v2 offset:55296
  buffer_load_dwordx4 a[60:63], v1, s[4:7], s49 offen offset:1024 sc1
  v_mfma_f32_16x16x32_bf16 v[168:171], a[176:179], a[24:27], v[168:171]
  v_mfma_f32_16x16x32_bf16 v[172:175], a[176:179], a[28:31], v[172:175]
  ds_read_b64_tr_b16 a[168:169], v3 offset:49152
  v_mfma_f32_16x16x32_bf16 v[172:175], a[172:175], a[12:15], v[172:175]
  s_waitcnt lgkmcnt(5)
  v_mfma_f32_16x16x32_bf16 v[188:191], a[180:183], a[12:15], v[188:191]
  ds_read_b64_tr_b16 a[170:171], v3 offset:51200
  buffer_load_dwordx4 a[64:67], v1, s[4:7], s50 offen offset:0 sc1
  v_mfma_f32_16x16x32_bf16 v[188:191], a[184:187], a[28:31], v[188:191]
  v_mfma_f32_16x16x32_bf16 v[184:187], a[184:187], a[24:27], v[184:187]
  ds_read_b64_tr_b16 a[172:173], v3 offset:53248
  v_mfma_f32_16x16x32_bf16 v[184:187], a[180:183], a[8:11], v[184:187]
  v_mfma_f32_16x16x32_bf16 v[180:183], a[180:183], a[4:7], v[180:183]
  ds_read_b64_tr_b16 a[174:175], v3 offset:55296
  v_mfma_f32_16x16x32_bf16 v[180:183], a[184:187], a[20:23], v[180:183]
  buffer_load_dwordx4 a[80:83], v1, s[4:7], s50 offen offset:1024 sc1
  v_mfma_f32_16x16x32_bf16 v[176:179], a[184:187], a[16:19], v[176:179]
  ds_read_b64_tr_b16 a[176:177], v4 offset:49152
  v_mfma_f32_16x16x32_bf16 v[176:179], a[180:183], a[0:3], v[176:179]
  s_waitcnt vmcnt(22) lgkmcnt(5)
  v_mfma_f32_16x16x32_bf16 v[64:67], a[160:163], a[188:191], v[64:67]
  ds_read_b64_tr_b16 a[178:179], v4 offset:51200
  s_add_u32 s50, s50, 262144
  v_mfma_f32_16x16x32_bf16 v[64:67], a[164:167], a[204:207], v[64:67]
  buffer_load_dwordx4 a[68:71], v1, s[4:7], s50 offen offset:0 sc1
  v_mfma_f32_16x16x32_bf16 v[68:71], a[164:167], a[208:211], v[68:71]
  ds_read_b64_tr_b16 a[180:181], v4 offset:53248
  v_mfma_f32_16x16x32_bf16 v[68:71], a[160:163], a[192:195], v[68:71]
  v_mfma_f32_16x16x32_bf16 v[72:75], a[160:163], a[196:199], v[72:75]
  ds_read_b64_tr_b16 a[182:183], v4 offset:55296
  v_mfma_f32_16x16x32_bf16 v[72:75], a[164:167], a[212:215], v[72:75]
  v_mfma_f32_16x16x32_bf16 v[76:79], a[164:167], a[216:219], v[76:79]
  ds_read_b64_tr_b16 a[184:185], v5 offset:49152
  buffer_load_dwordx4 a[84:87], v1, s[4:7], s50 offen offset:1024 sc1
  v_mfma_f32_16x16x32_bf16 v[76:79], a[160:163], a[200:203], v[76:79]
  s_waitcnt lgkmcnt(5)
  v_mfma_f32_16x16x32_bf16 v[92:95], a[168:171], a[200:203], v[92:95]
  ds_read_b64_tr_b16 a[186:187], v5 offset:51200
  v_mfma_f32_16x16x32_bf16 v[92:95], a[172:175], a[216:219], v[92:95]
  s_add_u32 s50, s50, 262144
  v_mfma_f32_16x16x32_bf16 v[88:91], a[172:175], a[212:215], v[88:91]
  ds_read_b64_tr_b16 a[160:161], v5 offset:53248
  buffer_load_dwordx4 a[72:75], v1, s[4:7], s50 offen offset:0 sc1
  v_mfma_f32_16x16x32_bf16 v[88:91], a[168:171], a[196:199], v[88:91]
  v_mfma_f32_16x16x32_bf16 v[84:87], a[168:171], a[192:195], v[84:87]
  ds_read_b64_tr_b16 a[162:163], v5 offset:55296
  v_mfma_f32_16x16x32_bf16 v[84:87], a[172:175], a[208:211], v[84:87]
  v_mfma_f32_16x16x32_bf16 v[80:83], a[172:175], a[204:207], v[80:83]
  ds_read_b64_tr_b16 a[164:165], v2 offset:57344
  v_mfma_f32_16x16x32_bf16 v[80:83], a[168:171], a[188:191], v[80:83]
  buffer_load_dwordx4 a[88:91], v1, s[4:7], s50 offen offset:1024 sc1
  s_waitcnt lgkmcnt(5)
  v_mfma_f32_16x16x32_bf16 v[96:99], a[176:179], a[188:191], v[96:99]
  ds_read_b64_tr_b16 a[166:167], v2 offset:59392
  v_mfma_f32_16x16x32_bf16 v[96:99], a[180:183], a[204:207], v[96:99]
  v_mfma_f32_16x16x32_bf16 v[100:103], a[180:183], a[208:211], v[100:103]
  ds_read_b64_tr_b16 a[168:169], v2 offset:61440
  s_add_u32 s50, s50, 262144
  v_mfma_f32_16x16x32_bf16 v[100:103], a[176:179], a[192:195], v[100:103]
  buffer_load_dwordx4 a[76:79], v1, s[4:7], s50 offen offset:0 sc1
  v_mfma_f32_16x16x32_bf16 v[104:107], a[176:179], a[196:199], v[104:107]
  ds_read_b64_tr_b16 a[170:171], v2 offset:63488
  v_mfma_f32_16x16x32_bf16 v[104:107], a[180:183], a[212:215], v[104:107]
  v_mfma_f32_16x16x32_bf16 v[108:111], a[180:183], a[216:219], v[108:111]
  ds_read_b64_tr_b16 a[172:173], v3 offset:57344
  v_mfma_f32_16x16x32_bf16 v[108:111], a[176:179], a[200:203], v[108:111]
  s_waitcnt lgkmcnt(5)
  v_mfma_f32_16x16x32_bf16 v[124:127], a[184:187], a[200:203], v[124:127]
  ds_read_b64_tr_b16 a[174:175], v3 offset:59392
  buffer_load_dwordx4 a[92:95], v1, s[4:7], s50 offen offset:1024 sc1
  v_mfma_f32_16x16x32_bf16 v[124:127], a[160:163], a[216:219], v[124:127]
  v_mfma_f32_16x16x32_bf16 v[120:123], a[160:163], a[212:215], v[120:123]
  ds_read_b64_tr_b16 a[176:177], v3 offset:61440
  v_mfma_f32_16x16x32_bf16 v[120:123], a[184:187], a[196:199], v[120:123]
  v_mfma_f32_16x16x32_bf16 v[116:119], a[184:187], a[192:195], v[116:119]
  ds_read_b64_tr_b16 a[178:179], v3 offset:63488
  buffer_load_dwordx4 a[96:99], v1, s[4:7], s51 offen offset:0 sc1
  v_mfma_f32_16x16x32_bf16 v[116:119], a[160:163], a[208:211], v[116:119]
  v_mfma_f32_16x16x32_bf16 v[112:115], a[160:163], a[204:207], v[112:115]
  ds_read_b64_tr_b16 a[180:181], v4 offset:57344
  v_mfma_f32_16x16x32_bf16 v[112:115], a[184:187], a[188:191], v[112:115]
  s_waitcnt lgkmcnt(5)
  v_mfma_f32_16x16x32_bf16 v[128:131], a[164:167], a[188:191], v[128:131]
  ds_read_b64_tr_b16 a[182:183], v4 offset:59392
  v_mfma_f32_16x16x32_bf16 v[128:131], a[168:171], a[204:207], v[128:131]
  buffer_load_dwordx4 a[112:115], v1, s[4:7], s51 offen offset:1024 sc1
  v_mfma_f32_16x16x32_bf16 v[132:135], a[168:171], a[208:211], v[132:135]
  ds_read_b64_tr_b16 a[184:185], v4 offset:61440
  v_mfma_f32_16x16x32_bf16 v[132:135], a[164:167], a[192:195], v[132:135]
  v_mfma_f32_16x16x32_bf16 v[136:139], a[164:167], a[196:199], v[136:139]
  ds_read_b64_tr_b16 a[186:187], v4 offset:63488
  s_add_u32 s51, s51, 262144
  v_mfma_f32_16x16x32_bf16 v[136:139], a[168:171], a[212:215], v[136:139]
  buffer_load_dwordx4 a[100:103], v1, s[4:7], s51 offen offset:0 sc1
  v_mfma_f32_16x16x32_bf16 v[140:143], a[168:171], a[216:219], v[140:143]
  ds_read_b64_tr_b16 a[160:161], v5 offset:57344
  v_mfma_f32_16x16x32_bf16 v[140:143], a[164:167], a[200:203], v[140:143]
  s_waitcnt lgkmcnt(5)
  v_mfma_f32_16x16x32_bf16 v[156:159], a[172:175], a[200:203], v[156:159]
  ds_read_b64_tr_b16 a[162:163], v5 offset:59392
  v_mfma_f32_16x16x32_bf16 v[156:159], a[176:179], a[216:219], v[156:159]
  v_mfma_f32_16x16x32_bf16 v[152:155], a[176:179], a[212:215], v[152:155]
  ds_read_b64_tr_b16 a[164:165], v5 offset:61440
  buffer_load_dwordx4 a[116:119], v1, s[4:7], s51 offen offset:1024 sc1
  v_mfma_f32_16x16x32_bf16 v[152:155], a[172:175], a[196:199], v[152:155]
  v_mfma_f32_16x16x32_bf16 v[148:151], a[172:175], a[192:195], v[148:151]
  ds_read_b64_tr_b16 a[166:167], v5 offset:63488
  v_mfma_f32_16x16x32_bf16 v[148:151], a[176:179], a[208:211], v[148:151]
  s_add_u32 s51, s51, 262144
  s_waitcnt vmcnt(63)
  s_barrier
  v_mfma_f32_16x16x32_bf16 v[144:147], a[176:179], a[204:207], v[144:147]
  ds_read_b64_tr_b16 a[168:169], v6 offset:0
  buffer_load_dwordx4 a[104:107], v1, s[4:7], s51 offen offset:0 sc1
  v_mfma_f32_16x16x32_bf16 v[144:147], a[172:175], a[188:191], v[144:147]
  s_waitcnt lgkmcnt(5)
  v_mfma_f32_16x16x32_bf16 v[160:163], a[180:183], a[188:191], v[160:163]
  ds_read_b64_tr_b16 a[170:171], v6 offset:2048
  v_mfma_f32_16x16x32_bf16 v[160:163], a[184:187], a[204:207], v[160:163]
  v_mfma_f32_16x16x32_bf16 v[164:167], a[184:187], a[208:211], v[164:167]
  ds_read_b64_tr_b16 a[172:173], v6 offset:4096
  v_mfma_f32_16x16x32_bf16 v[164:167], a[180:183], a[192:195], v[164:167]
  buffer_load_dwordx4 a[120:123], v1, s[4:7], s51 offen offset:1024 sc1
  v_mfma_f32_16x16x32_bf16 v[168:171], a[180:183], a[196:199], v[168:171]
  ds_read_b64_tr_b16 a[174:175], v6 offset:6144
  v_mfma_f32_16x16x32_bf16 v[168:171], a[184:187], a[212:215], v[168:171]
  v_mfma_f32_16x16x32_bf16 v[172:175], a[184:187], a[216:219], v[172:175]
  ds_read_b64_tr_b16 a[176:177], v7 offset:0
  s_add_u32 s51, s51, 262144
  v_mfma_f32_16x16x32_bf16 v[172:175], a[180:183], a[200:203], v[172:175]
  buffer_load_dwordx4 a[108:111], v1, s[4:7], s51 offen offset:0 sc1
  s_waitcnt lgkmcnt(5)
  v_mfma_f32_16x16x32_bf16 v[188:191], a[160:163], a[200:203], v[188:191]
  ds_read_b64_tr_b16 a[178:179], v7 offset:2048
  v_mfma_f32_16x16x32_bf16 v[188:191], a[164:167], a[216:219], v[188:191]
  v_mfma_f32_16x16x32_bf16 v[184:187], a[164:167], a[212:215], v[184:187]
  ds_read_b64_tr_b16 a[180:181], v7 offset:4096
  v_mfma_f32_16x16x32_bf16 v[184:187], a[160:163], a[196:199], v[184:187]
  v_mfma_f32_16x16x32_bf16 v[180:183], a[160:163], a[192:195], v[180:183]
  ds_read_b64_tr_b16 a[182:183], v7 offset:6144
  buffer_load_dwordx4 a[124:127], v1, s[4:7], s51 offen offset:1024 sc1
  v_mfma_f32_16x16x32_bf16 v[180:183], a[164:167], a[208:211], v[180:183]
  v_mfma_f32_16x16x32_bf16 v[176:179], a[164:167], a[204:207], v[176:179]
  ds_read_b64_tr_b16 a[184:185], v6 offset:16384
  v_mfma_f32_16x16x32_bf16 v[176:179], a[160:163], a[188:191], v[176:179]
  s_waitcnt vmcnt(28) lgkmcnt(5)
  v_mfma_f32_16x16x32_bf16 v[64:67], a[168:171], a[220:223], v[64:67]
  ds_read_b64_tr_b16 a[186:187], v6 offset:18432
  buffer_load_dwordx4 a[128:131], v1, s[4:7], s52 offen offset:0 sc1
  v_mfma_f32_16x16x32_bf16 v[64:67], a[172:175], a[236:239], v[64:67]
  v_mfma_f32_16x16x32_bf16 v[68:71], a[172:175], a[240:243], v[68:71]
  ds_read_b64_tr_b16 a[160:161], v6 offset:20480
  v_mfma_f32_16x16x32_bf16 v[68:71], a[168:171], a[224:227], v[68:71]
  v_mfma_f32_16x16x32_bf16 v[72:75], a[168:171], a[228:231], v[72:75]
  ds_read_b64_tr_b16 a[162:163], v6 offset:22528
  v_mfma_f32_16x16x32_bf16 v[72:75], a[172:175], a[244:247], v[72:75]
  buffer_load_dwordx4 a[144:147], v1, s[4:7], s52 offen offset:1024 sc1
  v_mfma_f32_16x16x32_bf16 v[76:79], a[172:175], a[248:251], v[76:79]
  ds_read_b64_tr_b16 a[164:165], v7 offset:16384
  v_mfma_f32_16x16x32_bf16 v[76:79], a[168:171], a[232:235], v[76:79]
  s_waitcnt lgkmcnt(5)
  v_mfma_f32_16x16x32_bf16 v[92:95], a[176:179], a[232:235], v[92:95]
  ds_read_b64_tr_b16 a[166:167], v7 offset:18432
  s_add_u32 s52, s52, 262144
  v_mfma_f32_16x16x32_bf16 v[92:95], a[180:183], a[248:251], v[92:95]
  buffer_load_dwordx4 a[132:135], v1, s[4:7], s52 offen offset:0 sc1
  v_mfma_f32_16x16x32_bf16 v[88:91], a[180:183], a[244:247], v[88:91]
  ds_read_b64_tr_b16 a[168:169], v7 offset:20480
  v_mfma_f32_16x16x32_bf16 v[88:91], a[176:179], a[228:231], v[88:91]
  v_mfma_f32_16x16x32_bf16 v[84:87], a[176:179], a[224:227], v[84:87]
  ds_read_b64_tr_b16 a[170:171], v7 offset:22528
  v_mfma_f32_16x16x32_bf16 v[84:87], a[180:183], a[240:243], v[84:87]
  s_waitcnt vmcnt(27)
  s_barrier
  v_mfma_f32_16x16x32_bf16 v[80:83], a[180:183], a[236:239], v[80:83]
  ds_read_b64_tr_b16 a[172:173], v6 offset:32768
  buffer_load_dwordx4 a[148:151], v1, s[4:7], s52 offen offset:1024 sc1
  v_mfma_f32_16x16x32_bf16 v[80:83], a[176:179], a[220:223], v[80:83]
  s_waitcnt vmcnt(20) lgkmcnt(5)
  v_mfma_f32_16x16x32_bf16 v[64:67], a[184:187], a[32:35], v[64:67]
  ds_read_b64_tr_b16 a[174:175], v6 offset:34816
  v_mfma_f32_16x16x32_bf16 v[64:67], a[160:163], a[48:51], v[64:67]
  s_add_u32 s52, s52, 262144
  v_mfma_f32_16x16x32_bf16 v[68:71], a[160:163], a[52:55], v[68:71]
  ds_read_b64_tr_b16 a[176:177], v6 offset:36864
  buffer_load_dwordx4 a[136:139], v1, s[4:7], s52 offen offset:0 sc1
  v_mfma_f32_16x16x32_bf16 v[68:71], a[184:187], a[36:39], v[68:71]
  v_mfma_f32_16x16x32_bf16 v[72:75], a[184:187], a[40:43], v[72:75]
  ds_read_b64_tr_b16 a[178:179], v6 offset:38912
  v_mfma_f32_16x16x32_bf16 v[72:75], a[160:163], a[56:59], v[72:75]
  v_mfma_f32_16x16x32_bf16 v[76:79], a[160:163], a[60:63], v[76:79]
  ds_read_b64_tr_b16 a[180:181], v7 offset:32768
  v_mfma_f32_16x16x32_bf16 v[76:79], a[184:187], a[44:47], v[76:79]
  buffer_load_dwordx4 a[152:155], v1, s[4:7], s52 offen offset:1024 sc1
  s_waitcnt lgkmcnt(5)
  v_mfma_f32_16x16x32_bf16 v[92:95], a[164:167], a[44:47], v[92:95]
HOP16:
  s_cbranch_execz WRET1
  ds_read_b64_tr_b16 a[182:183], v7 offset:34816
  v_mfma_f32_16x16x32_bf16 v[92:95], a[168:171], a[60:63], v[92:95]
  v_mfma_f32_16x16x32_bf16 v[88:91], a[168:171], a[56:59], v[88:91]
  ds_read_b64_tr_b16 a[184:185], v7 offset:36864
  s_add_u32 s52, s52, 262144
  v_mfma_f32_16x16x32_bf16 v[88:91], a[164:167], a[40:43], v[88:91]
  buffer_load_dwordx4 a[140:143], v1, s[4:7], s52 offen offset:0 sc1
  v_mfma_f32_16x16x32_bf16 v[84:87], a[164:167], a[36:39], v[84:87]
  ds_read_b64_tr_b16 a[186:187], v7 offset:38912
  v_mfma_f32_16x16x32_bf16 v[84:87], a[168:171], a[52:55], v[84:87]
  v_mfma_f32_16x16x32_bf16 v[80:83], a[168:171], a[48:51], v[80:83]
  ds_read_b64_tr_b16 a[160:161], v6 offset:49152
  v_mfma_f32_16x16x32_bf16 v[80:83], a[164:167], a[32:35], v[80:83]
  s_waitcnt vmcnt(15) lgkmcnt(5)
  v_mfma_f32_16x16x32_bf16 v[64:67], a[172:175], a[64:67], v[64:67]
  ds_read_b64_tr_b16 a[162:163], v6 offset:51200
  buffer_load_dwordx4 a[156:159], v1, s[4:7], s52 offen offset:1024 sc1
  v_mfma_f32_16x16x32_bf16 v[64:67], a[176:179], a[80:83], v[64:67]
  v_mfma_f32_16x16x32_bf16 v[68:71], a[176:179], a[84:87], v[68:71]
  ds_read_b64_tr_b16 a[164:165], v6 offset:53248
  v_mfma_f32_16x16x32_bf16 v[68:71], a[172:175], a[68:71], v[68:71]
  v_mfma_f32_16x16x32_bf16 v[72:75], a[172:175], a[72:75], v[72:75]
  ds_read_b64_tr_b16 a[166:167], v6 offset:55296
  buffer_load_dwordx4 a[0:3], v1, s[4:7], s53 offen offset:0 sc1
  v_mfma_f32_16x16x32_bf16 v[72:75], a[176:179], a[88:91], v[72:75]
  v_mfma_f32_16x16x32_bf16 v[76:79], a[176:179], a[92:95], v[76:79]
  ds_read_b64_tr_b16 a[168:169], v7 offset:49152
  v_mfma_f32_16x16x32_bf16 v[76:79], a[172:175], a[76:79], v[76:79]
  s_waitcnt lgkmcnt(5)
  v_mfma_f32_16x16x32_bf16 v[92:95], a[180:183], a[76:79], v[92:95]
  ds_read_b64_tr_b16 a[170:171], v7 offset:51200
  v_mfma_f32_16x16x32_bf16 v[92:95], a[184:187], a[92:95], v[92:95]
  buffer_load_dwordx4 a[16:19], v1, s[4:7], s53 offen offset:1024 sc1
  v_mfma_f32_16x16x32_bf16 v[88:91], a[184:187], a[88:91], v[88:91]
  ds_read_b64_tr_b16 a[172:173], v7 offset:53248
  v_mfma_f32_16x16x32_bf16 v[88:91], a[180:183], a[72:75], v[88:91]
  v_mfma_f32_16x16x32_bf16 v[84:87], a[180:183], a[68:71], v[84:87]
  ds_read_b64_tr_b16 a[174:175], v7 offset:55296
  s_add_u32 s53, s53, 262144
  v_mfma_f32_16x16x32_bf16 v[84:87], a[184:187], a[84:87], v[84:87]
  buffer_load_dwordx4 a[4:7], v1, s[4:7], s53 offen offset:0 sc1
  v_mfma_f32_16x16x32_bf16 v[80:83], a[184:187], a[80:83], v[80:83]
  ds_read_b64_tr_b16 a[176:177], v2 offset:0
  v_mfma_f32_16x16x32_bf16 v[80:83], a[180:183], a[64:67], v[80:83]
  s_waitcnt vmcnt(11) lgkmcnt(5)
  v_mfma_f32_16x16x32_bf16 v[64:67], a[160:163], a[96:99], v[64:67]
  ds_read_b64_tr_b16 a[178:179], v2 offset:2048
  v_mfma_f32_16x16x32_bf16 v[64:67], a[164:167], a[112:115], v[64:67]
  v_mfma_f32_16x16x32_bf16 v[68:71], a[164:167], a[116:119], v[68:71]
  ds_read_b64_tr_b16 a[180:181], v2 offset:4096
  buffer_load_dwordx4 a[20:23], v1, s[4:7], s53 offen offset:1024 sc1
  v_mfma_f32_16x16x32_bf16 v[68:71], a[160:163], a[100:103], v[68:71]
  v_mfma_f32_16x16x32_bf16 v[72:75], a[160:163], a[104:107], v[72:75]
  ds_read_b64_tr_b16 a[182:183], v2 offset:6144
  v_mfma_f32_16x16x32_bf16 v[72:75], a[164:167], a[120:123], v[72:75]
  s_add_u32 s53, s53, 262144
  v_mfma_f32_16x16x32_bf16 v[76:79], a[164:167], a[124:127], v[76:79]
  ds_read_b64_tr_b16 a[184:185], v3 offset:0
  buffer_load_dwordx4 a[8:11], v1, s[4:7], s53 offen offset:0 sc1
  v_mfma_f32_16x16x32_bf16 v[76:79], a[160:163], a[108:111], v[76:79]
  s_waitcnt lgkmcnt(5)
  v_mfma_f32_16x16x32_bf16 v[92:95], a[168:171], a[108:111], v[92:95]
  ds_read_b64_tr_b16 a[186:187], v3 offset:2048
  v_mfma_f32_16x16x32_bf16 v[92:95], a[172:175], a[124:127], v[92:95]
  v_mfma_f32_16x16x32_bf16 v[88:91], a[172:175], a[120:123], v[88:91]
  ds_read_b64_tr_b16 a[160:161], v3 offset:4096
  v_mfma_f32_16x16x32_bf16 v[88:91], a[168:171], a[104:107], v[88:91]
  buffer_load_dwordx4 a[24:27], v1, s[4:7], s53 offen offset:1024 sc1
  v_mfma_f32_16x16x32_bf16 v[84:87], a[168:171], a[100:103], v[84:87]
  ds_read_b64_tr_b16 a[162:163], v3 offset:6144
  v_mfma_f32_16x16x32_bf16 v[84:87], a[172:175], a[116:119], v[84:87]
  v_mfma_f32_16x16x32_bf16 v[80:83], a[172:175], a[112:115], v[80:83]
  ds_read_b64_tr_b16 a[164:165], v2 offset:16384
  s_add_u32 s53, s53, 262144
  v_mfma_f32_16x16x32_bf16 v[80:83], a[168:171], a[96:99], v[80:83]
  buffer_load_dwordx4 a[12:15], v1, s[4:7], s53 offen offset:0 sc1
  s_waitcnt vmcnt(7) lgkmcnt(5)
  v_mfma_f32_16x16x32_bf16 v[64:67], a[176:179], a[128:131], v[64:67]
  ds_read_b64_tr_b16 a[166:167], v2 offset:18432
  v_mfma_f32_16x16x32_bf16 v[64:67], a[180:183], a[144:147], v[64:67]
  v_mfma_f32_16x16x32_bf16 v[68:71], a[180:183], a[148:151], v[68:71]
  ds_read_b64_tr_b16 a[168:169], v2 offset:20480
  v_mfma_f32_16x16x32_bf16 v[68:71], a[176:179], a[132:135], v[68:71]
  v_mfma_f32_16x16x32_bf16 v[72:75], a[176:179], a[136:139], v[72:75]
  ds_read_b64_tr_b16 a[170:171], v2 offset:22528
  buffer_load_dwordx4 a[28:31], v1, s[4:7], s53 offen offset:1024 sc1
  v_mfma_f32_16x16x32_bf16 v[72:75], a[180:183], a[152:155], v[72:75]
  v_mfma_f32_16x16x32_bf16 v[76:79], a[180:183], a[156:159], v[76:79]
  ds_read_b64_tr_b16 a[172:173], v3 offset:16384
  v_mfma_f32_16x16x32_bf16 v[76:79], a[176:179], a[140:143], v[76:79]
  s_add_u32 m0, s31, 90112
  s_waitcnt lgkmcnt(5)
  v_mfma_f32_16x16x32_bf16 v[92:95], a[184:187], a[140:143], v[92:95]
  ds_read_b64_tr_b16 a[174:175], v3 offset:18432
  buffer_load_dwordx4 v33, s[16:19], s41 offen lds
  v_mfma_f32_16x16x32_bf16 v[92:95], a[160:163], a[156:159], v[92:95]
  v_mfma_f32_16x16x32_bf16 v[88:91], a[160:163], a[152:155], v[88:91]
  ds_read_b64_tr_b16 a[176:177], v3 offset:20480
  v_mfma_f32_16x16x32_bf16 v[88:91], a[184:187], a[136:139], v[88:91]
  v_mfma_f32_16x16x32_bf16 v[84:87], a[184:187], a[132:135], v[84:87]
  ds_read_b64_tr_b16 a[178:179], v3 offset:22528
  s_add_u32 m0, s31, 94208
  s_add_u32 s37, s41, 65536
  v_mfma_f32_16x16x32_bf16 v[84:87], a[160:163], a[148:151], v[84:87]
  buffer_load_dwordx4 v33, s[16:19], s37 offen lds
  v_mfma_f32_16x16x32_bf16 v[80:83], a[160:163], a[144:147], v[80:83]
  ds_read_b64_tr_b16 a[180:181], v8 offset:0
  v_mfma_f32_16x16x32_bf16 v[80:83], a[184:187], a[128:131], v[80:83]
  s_waitcnt vmcnt(2) lgkmcnt(5)
  v_mfma_f32_16x16x32_bf16 v[64:67], a[164:167], a[0:3], v[64:67]
  ds_read_b64_tr_b16 a[182:183], v8 offset:2048
  s_add_u32 m0, s31, 106496
  v_mfma_f32_16x16x32_bf16 v[64:67], a[168:171], a[16:19], v[64:67]
  buffer_load_dwordx4 v33, s[16:19], s42 offen lds
  v_mfma_f32_16x16x32_bf16 v[68:71], a[168:171], a[20:23], v[68:71]
  ds_read_b64_tr_b16 a[184:185], v8 offset:4096
  v_mfma_f32_16x16x32_bf16 v[68:71], a[164:167], a[4:7], v[68:71]
  v_mfma_f32_16x16x32_bf16 v[72:75], a[164:167], a[8:11], v[72:75]
  ds_read_b64_tr_b16 a[186:187], v8 offset:6144
  v_mfma_f32_16x16x32_bf16 v[72:75], a[168:171], a[24:27], v[72:75]
  s_add_u32 m0, s31, 110592
  s_add_u32 s37, s42, 65536
  v_mfma_f32_16x16x32_bf16 v[76:79], a[168:171], a[28:31], v[76:79]
  ds_read_b64_tr_b16 a[160:161], v9 offset:0
  buffer_load_dwordx4 v33, s[16:19], s37 offen lds
  v_mfma_f32_16x16x32_bf16 v[76:79], a[164:167], a[12:15], v[76:79]
  s_waitcnt lgkmcnt(5)
  v_mfma_f32_16x16x32_bf16 v[92:95], a[172:175], a[12:15], v[92:95]
  ds_read_b64_tr_b16 a[162:163], v9 offset:2048
  v_mfma_f32_16x16x32_bf16 v[92:95], a[176:179], a[28:31], v[92:95]
  s_add_u32 m0, s31, 122880
  v_mfma_f32_16x16x32_bf16 v[88:91], a[176:179], a[24:27], v[88:91]
  ds_read_b64_tr_b16 a[164:165], v9 offset:4096
  buffer_load_dwordx4 v33, s[16:19], s43 offen lds
  v_mfma_f32_16x16x32_bf16 v[88:91], a[172:175], a[8:11], v[88:91]
  v_cvt_pk_bf16_f32 v64, v64, v65
  v_cvt_pk_bf16_f32 v65, v66, v67
  v_mfma_f32_16x16x32_bf16 v[84:87], a[172:175], a[4:7], v[84:87]
  ds_read_b64_tr_b16 a[166:167], v9 offset:6144
  v_cvt_pk_bf16_f32 v68, v68, v69
  v_mfma_f32_16x16x32_bf16 v[84:87], a[176:179], a[20:23], v[84:87]
  v_cvt_pk_bf16_f32 v69, v70, v71
  v_cvt_pk_bf16_f32 v72, v72, v73
  v_mfma_f32_16x16x32_bf16 v[80:83], a[176:179], a[16:19], v[80:83]
  ds_read_b64_tr_b16 a[168:169], v8 offset:16384
  s_add_u32 m0, s31, 126976
  s_add_u32 s37, s43, 65536
  v_mfma_f32_16x16x32_bf16 v[80:83], a[172:175], a[0:3], v[80:83]
  buffer_load_dwordx4 v33, s[16:19], s37 offen lds
  s_waitcnt lgkmcnt(5)
  v_mfma_f32_16x16x32_bf16 v[96:99], a[180:183], a[220:223], v[96:99]
  ds_read_b64_tr_b16 a[170:171], v8 offset:18432
  v_cvt_pk_bf16_f32 v73, v74, v75
  v_mfma_f32_16x16x32_bf16 v[96:99], a[184:187], a[236:239], v[96:99]
  v_cvt_pk_bf16_f32 v76, v76, v77
  v_cvt_pk_bf16_f32 v77, v78, v79
  v_mfma_f32_16x16x32_bf16 v[100:103], a[184:187], a[240:243], v[100:103]
  ds_read_b64_tr_b16 a[172:173], v8 offset:20480
  s_add_u32 m0, s31, 8192
  v_mfma_f32_16x16x32_bf16 v[100:103], a[180:183], a[224:227], v[100:103]
  buffer_load_dwordx4 v33, s[16:19], s44 offen lds
  v_cvt_pk_bf16_f32 v66, v80, v81
  v_mfma_f32_16x16x32_bf16 v[104:107], a[180:183], a[228:231], v[104:107]
  ds_read_b64_tr_b16 a[174:175], v8 offset:22528
  v_cvt_pk_bf16_f32 v67, v82, v83
  v_mfma_f32_16x16x32_bf16 v[104:107], a[184:187], a[244:247], v[104:107]
  s_add_u32 s63, s62, 0
  buffer_store_dwordx4 v[64:67], v1, s[4:7], s63 offen offset:0 sc1
  v_cvt_pk_bf16_f32 v70, v84, v85
  v_mfma_f32_16x16x32_bf16 v[108:111], a[184:187], a[248:251], v[108:111]
  ds_read_b64_tr_b16 a[176:177], v9 offset:16384
  v_cvt_pk_bf16_f32 v71, v86, v87
  v_mfma_f32_16x16x32_bf16 v[108:111], a[180:183], a[232:235], v[108:111]
  s_add_u32 m0, s31, 12288
  s_add_u32 s37, s44, 65536
  s_waitcnt lgkmcnt(5)
  v_mfma_f32_16x16x32_bf16 v[124:127], a[160:163], a[232:235], v[124:127]
  ds_read_b64_tr_b16 a[178:179], v9 offset:18432
  buffer_load_dwordx4 v33, s[16:19], s37 offen lds
  v_mfma_f32_16x16x32_bf16 v[124:127], a[164:167], a[248:251], v[124:127]
  buffer_store_dwordx4 v[68:71], v1, s[4:7], s63 offen offset:1024 sc1
  v_cvt_pk_bf16_f32 v74, v88, v89
  v_mfma_f32_16x16x32_bf16 v[120:123], a[164:167], a[244:247], v[120:123]
  ds_read_b64_tr_b16 a[180:181], v9 offset:20480
  v_cvt_pk_bf16_f32 v75, v90, v91
  v_mfma_f32_16x16x32_bf16 v[120:123], a[160:163], a[228:231], v[120:123]
  s_add_u32 m0, s31, 24576
  buffer_store_dwordx4 v[72:75], v1, s[4:7], s63 offen offset:2048 sc1
  v_mfma_f32_16x16x32_bf16 v[116:119], a[160:163], a[224:227], v[116:119]
  ds_read_b64_tr_b16 a[182:183], v9 offset:22528
  buffer_load_dwordx4 v33, s[16:19], s45 offen lds
  v_mfma_f32_16x16x32_bf16 v[116:119], a[164:167], a[240:243], v[116:119]
  v_cvt_pk_bf16_f32 v78, v92, v93
  v_cvt_pk_bf16_f32 v79, v94, v95
  v_mfma_f32_16x16x32_bf16 v[112:115], a[164:167], a[236:239], v[112:115]
  ds_read_b64_tr_b16 a[184:185], v8 offset:32768
  buffer_store_dwordx4 v[76:79], v1, s[4:7], s63 offen offset:3072 sc1
  v_mfma_f32_16x16x32_bf16 v[112:115], a[160:163], a[220:223], v[112:115]
  s_waitcnt lgkmcnt(5)
  v_mfma_f32_16x16x32_bf16 v[96:99], a[168:171], a[32:35], v[96:99]
  ds_read_b64_tr_b16 a[186:187], v8 offset:34816
  s_add_u32 m0, s31, 28672
  s_add_u32 s37, s45, 65536
  v_mfma_f32_16x16x32_bf16 v[96:99], a[172:175], a[48:51], v[96:99]
  buffer_load_dwordx4 v33, s[16:19], s37 offen lds
  v_mfma_f32_16x16x32_bf16 v[100:103], a[172:175], a[52:55], v[100:103]
  ds_read_b64_tr_b16 a[160:161], v8 offset:36864
  v_mfma_f32_16x16x32_bf16 v[100:103], a[168:171], a[36:39], v[100:103]
  v_mfma_f32_16x16x32_bf16 v[104:107], a[168:171], a[40:43], v[104:107]
  ds_read_b64_tr_b16 a[162:163], v8 offset:38912
  v_mfma_f32_16x16x32_bf16 v[104:107], a[172:175], a[56:59], v[104:107]
  v_mfma_f32_16x16x32_bf16 v[108:111], a[172:175], a[60:63], v[108:111]
  ds_read_b64_tr_b16 a[164:165], v9 offset:32768
  v_mfma_f32_16x16x32_bf16 v[108:111], a[168:171], a[44:47], v[108:111]
  s_waitcnt lgkmcnt(5)
  v_mfma_f32_16x16x32_bf16 v[124:127], a[176:179], a[44:47], v[124:127]
  ds_read_b64_tr_b16 a[166:167], v9 offset:34816
  v_mfma_f32_16x16x32_bf16 v[124:127], a[180:183], a[60:63], v[124:127]
  v_mfma_f32_16x16x32_bf16 v[120:123], a[180:183], a[56:59], v[120:123]
  ds_read_b64_tr_b16 a[168:169], v9 offset:36864
  v_mfma_f32_16x16x32_bf16 v[120:123], a[176:179], a[40:43], v[120:123]
  v_mfma_f32_16x16x32_bf16 v[116:119], a[176:179], a[36:39], v[116:119]
  ds_read_b64_tr_b16 a[170:171], v9 offset:38912
  v_mfma_f32_16x16x32_bf16 v[116:119], a[180:183], a[52:55], v[116:119]
  v_mfma_f32_16x16x32_bf16 v[112:115], a[180:183], a[48:51], v[112:115]
  ds_read_b64_tr_b16 a[172:173], v8 offset:49152
  v_mfma_f32_16x16x32_bf16 v[112:115], a[176:179], a[32:35], v[112:115]
  s_waitcnt lgkmcnt(5)
  v_mfma_f32_16x16x32_bf16 v[96:99], a[184:187], a[64:67], v[96:99]
  ds_read_b64_tr_b16 a[174:175], v8 offset:51200
  v_mfma_f32_16x16x32_bf16 v[96:99], a[160:163], a[80:83], v[96:99]
  v_mfma_f32_16x16x32_bf16 v[100:103], a[160:163], a[84:87], v[100:103]
  ds_read_b64_tr_b16 a[176:177], v8 offset:53248
  v_mfma_f32_16x16x32_bf16 v[100:103], a[184:187], a[68:71], v[100:103]
  v_mfma_f32_16x16x32_bf16 v[104:107], a[184:187], a[72:75], v[104:107]
  ds_read_b64_tr_b16 a[178:179], v8 offset:55296
  v_mfma_f32_16x16x32_bf16 v[104:107], a[160:163], a[88:91], v[104:107]
  v_mfma_f32_16x16x32_bf16 v[108:111], a[160:163], a[92:95], v[108:111]
  ds_read_b64_tr_b16 a[180:181], v9 offset:49152
  v_mfma_f32_16x16x32_bf16 v[108:111], a[184:187], a[76:79], v[108:111]
  s_waitcnt lgkmcnt(5)
  v_mfma_f32_16x16x32_bf16 v[124:127], a[164:167], a[76:79], v[124:127]
  ds_read_b64_tr_b16 a[182:183], v9 offset:51200
  v_mfma_f32_16x16x32_bf16 v[124:127], a[168:171], a[92:95], v[124:127]
  v_mfma_f32_16x16x32_bf16 v[120:123], a[168:171], a[88:91], v[120:123]
  ds_read_b64_tr_b16 a[184:185], v9 offset:53248
  v_mfma_f32_16x16x32_bf16 v[120:123], a[164:167], a[72:75], v[120:123]
  v_mfma_f32_16x16x32_bf16 v[116:119], a[164:167], a[68:71], v[116:119]
  ds_read_b64_tr_b16 a[186:187], v9 offset:55296
  v_mfma_f32_16x16x32_bf16 v[116:119], a[168:171], a[84:87], v[116:119]
  v_mfma_f32_16x16x32_bf16 v[112:115], a[168:171], a[80:83], v[112:115]
  ds_read_b64_tr_b16 a[160:161], v4 offset:0
  v_mfma_f32_16x16x32_bf16 v[112:115], a[164:167], a[64:67], v[112:115]
  s_waitcnt lgkmcnt(5)
  v_mfma_f32_16x16x32_bf16 v[96:99], a[172:175], a[96:99], v[96:99]
  ds_read_b64_tr_b16 a[162:163], v4 offset:2048
  v_mfma_f32_16x16x32_bf16 v[96:99], a[176:179], a[112:115], v[96:99]
  v_mfma_f32_16x16x32_bf16 v[100:103], a[176:179], a[116:119], v[100:103]
  ds_read_b64_tr_b16 a[164:165], v4 offset:4096
  v_mfma_f32_16x16x32_bf16 v[100:103], a[172:175], a[100:103], v[100:103]
  v_mfma_f32_16x16x32_bf16 v[104:107], a[172:175], a[104:107], v[104:107]
  ds_read_b64_tr_b16 a[166:167], v4 offset:6144
  v_mfma_f32_16x16x32_bf16 v[104:107], a[176:179], a[120:123], v[104:107]
  v_mfma_f32_16x16x32_bf16 v[108:111], a[176:179], a[124:127], v[108:111]
  ds_read_b64_tr_b16 a[168:169], v5 offset:0
  v_mfma_f32_16x16x32_bf16 v[108:111], a[172:175], a[108:111], v[108:111]
  s_waitcnt lgkmcnt(5)
  v_mfma_f32_16x16x32_bf16 v[124:127], a[180:183], a[108:111], v[124:127]
  ds_read_b64_tr_b16 a[170:171], v5 offset:2048
  v_mfma_f32_16x16x32_bf16 v[124:127], a[184:187], a[124:127], v[124:127]
  v_mfma_f32_16x16x32_bf16 v[120:123], a[184:187], a[120:123], v[120:123]
  ds_read_b64_tr_b16 a[172:173], v5 offset:4096
  v_mfma_f32_16x16x32_bf16 v[120:123], a[180:183], a[104:107], v[120:123]
  v_mfma_f32_16x16x32_bf16 v[116:119], a[180:183], a[100:103], v[116:119]
  ds_read_b64_tr_b16 a[174:175], v5 offset:6144
  v_mfma_f32_16x16x32_bf16 v[116:119], a[184:187], a[116:119], v[116:119]
  v_mfma_f32_16x16x32_bf16 v[112:115], a[184:187], a[112:115], v[112:115]
  ds_read_b64_tr_b16 a[176:177], v4 offset:16384
  v_mfma_f32_16x16x32_bf16 v[112:115], a[180:183], a[96:99], v[112:115]
  s_waitcnt lgkmcnt(5)
  v_mfma_f32_16x16x32_bf16 v[96:99], a[160:163], a[128:131], v[96:99]
  ds_read_b64_tr_b16 a[178:179], v4 offset:18432
  v_mfma_f32_16x16x32_bf16 v[96:99], a[164:167], a[144:147], v[96:99]
  v_mfma_f32_16x16x32_bf16 v[100:103], a[164:167], a[148:151], v[100:103]
  ds_read_b64_tr_b16 a[180:181], v4 offset:20480
  v_mfma_f32_16x16x32_bf16 v[100:103], a[160:163], a[132:135], v[100:103]
  v_mfma_f32_16x16x32_bf16 v[104:107], a[160:163], a[136:139], v[104:107]
  ds_read_b64_tr_b16 a[182:183], v4 offset:22528
  v_mfma_f32_16x16x32_bf16 v[104:107], a[164:167], a[152:155], v[104:107]
  v_mfma_f32_16x16x32_bf16 v[108:111], a[164:167], a[156:159], v[108:111]
  ds_read_b64_tr_b16 a[184:185], v5 offset:16384
  v_mfma_f32_16x16x32_bf16 v[108:111], a[160:163], a[140:143], v[108:111]
  s_waitcnt lgkmcnt(5)
  v_mfma_f32_16x16x32_bf16 v[124:127], a[168:171], a[140:143], v[124:127]
  ds_read_b64_tr_b16 a[186:187], v5 offset:18432
  v_mfma_f32_16x16x32_bf16 v[124:127], a[172:175], a[156:159], v[124:127]
  v_mfma_f32_16x16x32_bf16 v[120:123], a[172:175], a[152:155], v[120:123]
  ds_read_b64_tr_b16 a[160:161], v5 offset:20480
  v_mov_b32 v38, 1
  v_mov_b32 v39, 0
  s_waitcnt vmcnt(1)
  s_mov_b64 exec, 1
  buffer_store_dword v38, v39, s[4:7], s57 offen offset:0 sc1
  s_mov_b64 exec, -1
  v_mfma_f32_16x16x32_bf16 v[120:123], a[168:171], a[136:139], v[120:123]
  v_mfma_f32_16x16x32_bf16 v[116:119], a[168:171], a[132:135], v[116:119]
  ds_read_b64_tr_b16 a[162:163], v5 offset:22528
  v_mfma_f32_16x16x32_bf16 v[116:119], a[172:175], a[148:151], v[116:119]
  s_waitcnt vmcnt(1)
  s_barrier
  v_mfma_f32_16x16x32_bf16 v[112:115], a[172:175], a[144:147], v[112:115]
  ds_read_b64_tr_b16 a[164:165], v8 offset:8192
  v_mfma_f32_16x16x32_bf16 v[112:115], a[168:171], a[128:131], v[112:115]
  s_waitcnt lgkmcnt(5)
  v_mfma_f32_16x16x32_bf16 v[96:99], a[176:179], a[0:3], v[96:99]
  ds_read_b64_tr_b16 a[166:167], v8 offset:10240
  v_mfma_f32_16x16x32_bf16 v[96:99], a[180:183], a[16:19], v[96:99]
  v_mfma_f32_16x16x32_bf16 v[100:103], a[180:183], a[20:23], v[100:103]
  ds_read_b64_tr_b16 a[168:169], v8 offset:12288
  v_mfma_f32_16x16x32_bf16 v[100:103], a[176:179], a[4:7], v[100:103]
  v_mfma_f32_16x16x32_bf16 v[104:107], a[176:179], a[8:11], v[104:107]
  ds_read_b64_tr_b16 a[170:171], v8 offset:14336
  v_mfma_f32_16x16x32_bf16 v[104:107], a[180:183], a[24:27], v[104:107]
  v_mfma_f32_16x16x32_bf16 v[108:111], a[180:183], a[28:31], v[108:111]
  ds_read_b64_tr_b16 a[172:173], v9 offset:8192
  v_mfma_f32_16x16x32_bf16 v[108:111], a[176:179], a[12:15], v[108:111]
  s_waitcnt lgkmcnt(5)
  v_mfma_f32_16x16x32_bf16 v[124:127], a[184:187], a[12:15], v[124:127]
  ds_read_b64_tr_b16 a[174:175], v9 offset:10240
  v_mfma_f32_16x16x32_bf16 v[124:127], a[160:163], a[28:31], v[124:127]
  v_mfma_f32_16x16x32_bf16 v[120:123], a[160:163], a[24:27], v[120:123]
  ds_read_b64_tr_b16 a[176:177], v9 offset:12288
  v_cvt_pk_bf16_f32 v96, v96, v97
  v_mfma_f32_16x16x32_bf16 v[120:123], a[184:187], a[8:11], v[120:123]
  v_cvt_pk_bf16_f32 v97, v98, v99
  v_cvt_pk_bf16_f32 v100, v100, v101
  v_mfma_f32_16x16x32_bf16 v[116:119], a[184:187], a[4:7], v[116:119]
  ds_read_b64_tr_b16 a[178:179], v9 offset:14336
  v_cvt_pk_bf16_f32 v101, v102, v103
  v_mfma_f32_16x16x32_bf16 v[116:119], a[160:163], a[20:23], v[116:119]
  v_cvt_pk_bf16_f32 v104, v104, v105
  v_cvt_pk_bf16_f32 v105, v106, v107
  v_mfma_f32_16x16x32_bf16 v[112:115], a[160:163], a[16:19], v[112:115]
  ds_read_b64_tr_b16 a[180:181], v8 offset:24576
  v_cvt_pk_bf16_f32 v108, v108, v109
  v_mfma_f32_16x16x32_bf16 v[112:115], a[184:187], a[0:3], v[112:115]
  v_cvt_pk_bf16_f32 v109, v110, v111
  s_waitcnt lgkmcnt(5)
  v_mfma_f32_16x16x32_bf16 v[160:163], a[164:167], a[220:223], v[160:163]
  ds_read_b64_tr_b16 a[182:183], v8 offset:26624
  v_mfma_f32_16x16x32_bf16 v[160:163], a[168:171], a[236:239], v[160:163]
  v_mfma_f32_16x16x32_bf16 v[164:167], a[168:171], a[240:243], v[164:167]
  ds_read_b64_tr_b16 a[184:185], v8 offset:28672
  s_nop 0
  v_cvt_pk_bf16_f32 v98, v112, v113
  v_mfma_f32_16x16x32_bf16 v[164:167], a[164:167], a[224:227], v[164:167]
  v_cvt_pk_bf16_f32 v99, v114, v115
  s_add_u32 s63, s62, 4096
  buffer_store_dwordx4 v[96:99], v1, s[4:7], s63 offen offset:0 sc1
  v_mfma_f32_16x16x32_bf16 v[168:171], a[164:167], a[228:231], v[168:171]
  ds_read_b64_tr_b16 a[186:187], v8 offset:30720
  v_cvt_pk_bf16_f32 v102, v116, v117
  v_mfma_f32_16x16x32_bf16 v[168:171], a[168:171], a[244:247], v[168:171]
  v_cvt_pk_bf16_f32 v103, v118, v119
  buffer_store_dwordx4 v[100:103], v1, s[4:7], s63 offen offset:1024 sc1
  v_mfma_f32_16x16x32_bf16 v[172:175], a[168:171], a[248:251], v[172:175]
  ds_read_b64_tr_b16 a[160:161], v9 offset:24576
  v_cvt_pk_bf16_f32 v106, v120, v121
  v_mfma_f32_16x16x32_bf16 v[172:175], a[164:167], a[232:235], v[172:175]
  v_cvt_pk_bf16_f32 v107, v122, v123
  s_waitcnt lgkmcnt(5)
  v_mfma_f32_16x16x32_bf16 v[188:191], a[172:175], a[232:235], v[188:191]
  ds_read_b64_tr_b16 a[162:163], v9 offset:26624
  buffer_store_dwordx4 v[104:107], v1, s[4:7], s63 offen offset:2048 sc1
  v_mfma_f32_16x16x32_bf16 v[188:191], a[176:179], a[248:251], v[188:191]
  v_cvt_pk_bf16_f32 v110, v124, v125
  v_cvt_pk_bf16_f32 v111, v126, v127
  v_mfma_f32_16x16x32_bf16 v[184:187], a[176:179], a[244:247], v[184:187]
  ds_read_b64_tr_b16 a[164:165], v9 offset:28672
  buffer_store_dwordx4 v[108:111], v1, s[4:7], s63 offen offset:3072 sc1
  v_mfma_f32_16x16x32_bf16 v[184:187], a[172:175], a[228:231], v[184:187]
  v_mfma_f32_16x16x32_bf16 v[180:183], a[172:175], a[224:227], v[180:183]
  ds_read_b64_tr_b16 a[166:167], v9 offset:30720
  v_mfma_f32_16x16x32_bf16 v[180:183], a[176:179], a[240:243], v[180:183]
  v_mfma_f32_16x16x32_bf16 v[176:179], a[176:179], a[236:239], v[176:179]
  ds_read_b64_tr_b16 a[168:169], v8 offset:40960
  v_mfma_f32_16x16x32_bf16 v[176:179], a[172:175], a[220:223], v[176:179]
  s_waitcnt lgkmcnt(5)
  v_mfma_f32_16x16x32_bf16 v[160:163], a[180:183], a[32:35], v[160:163]
  ds_read_b64_tr_b16 a[170:171], v8 offset:43008
  v_mfma_f32_16x16x32_bf16 v[160:163], a[184:187], a[48:51], v[160:163]
  v_mfma_f32_16x16x32_bf16 v[164:167], a[184:187], a[52:55], v[164:167]
  ds_read_b64_tr_b16 a[172:173], v8 offset:45056
  v_mfma_f32_16x16x32_bf16 v[164:167], a[180:183], a[36:39], v[164:167]
  v_mfma_f32_16x16x32_bf16 v[168:171], a[180:183], a[40:43], v[168:171]
  ds_read_b64_tr_b16 a[174:175], v8 offset:47104
  v_mfma_f32_16x16x32_bf16 v[168:171], a[184:187], a[56:59], v[168:171]
  v_mfma_f32_16x16x32_bf16 v[172:175], a[184:187], a[60:63], v[172:175]
  ds_read_b64_tr_b16 a[176:177], v9 offset:40960
  v_mfma_f32_16x16x32_bf16 v[172:175], a[180:183], a[44:47], v[172:175]
  s_waitcnt lgkmcnt(5)
  v_mfma_f32_16x16x32_bf16 v[188:191], a[160:163], a[44:47], v[188:191]
  ds_read_b64_tr_b16 a[178:179], v9 offset:43008
  v_mfma_f32_16x16x32_bf16 v[188:191], a[164:167], a[60:63], v[188:191]
  v_mfma_f32_16x16x32_bf16 v[184:187], a[164:167], a[56:59], v[184:187]
  ds_read_b64_tr_b16 a[180:181], v9 offset:45056
  v_mfma_f32_16x16x32_bf16 v[184:187], a[160:163], a[40:43], v[184:187]
  v_mfma_f32_16x16x32_bf16 v[180:183], a[160:163], a[36:39], v[180:183]
  ds_read_b64_tr_b16 a[182:183], v9 offset:47104
  v_mfma_f32_16x16x32_bf16 v[180:183], a[164:167], a[52:55], v[180:183]
  v_mfma_f32_16x16x32_bf16 v[176:179], a[164:167], a[48:51], v[176:179]
  ds_read_b64_tr_b16 a[184:185], v8 offset:57344
  v_mfma_f32_16x16x32_bf16 v[176:179], a[160:163], a[32:35], v[176:179]
  s_waitcnt lgkmcnt(5)
  v_mfma_f32_16x16x32_bf16 v[160:163], a[168:171], a[64:67], v[160:163]
  ds_read_b64_tr_b16 a[186:187], v8 offset:59392
  v_mfma_f32_16x16x32_bf16 v[160:163], a[172:175], a[80:83], v[160:163]
  v_mfma_f32_16x16x32_bf16 v[164:167], a[172:175], a[84:87], v[164:167]
  ds_read_b64_tr_b16 a[160:161], v8 offset:61440
  v_mfma_f32_16x16x32_bf16 v[164:167], a[168:171], a[68:71], v[164:167]
  v_mfma_f32_16x16x32_bf16 v[168:171], a[168:171], a[72:75], v[168:171]
  ds_read_b64_tr_b16 a[162:163], v8 offset:63488
  v_mfma_f32_16x16x32_bf16 v[168:171], a[172:175], a[88:91], v[168:171]
  v_mfma_f32_16x16x32_bf16 v[172:175], a[172:175], a[92:95], v[172:175]
  ds_read_b64_tr_b16 a[164:165], v9 offset:57344
  v_mfma_f32_16x16x32_bf16 v[172:175], a[168:171], a[76:79], v[172:175]
  s_waitcnt lgkmcnt(5)
  v_mfma_f32_16x16x32_bf16 v[188:191], a[176:179], a[76:79], v[188:191]
  ds_read_b64_tr_b16 a[166:167], v9 offset:59392
  v_mfma_f32_16x16x32_bf16 v[188:191], a[180:183], a[92:95], v[188:191]
  v_mfma_f32_16x16x32_bf16 v[184:187], a[180:183], a[88:91], v[184:187]
  ds_read_b64_tr_b16 a[168:169], v9 offset:61440
  v_mfma_f32_16x16x32_bf16 v[184:187], a[176:179], a[72:75], v[184:187]
  s_xor_b32 s58, s57, 256
  s_add_u32 s58, s58, 0
  buffer_load_dword v36, v37, s[4:7], s58 offen sc1
  v_mfma_f32_16x16x32_bf16 v[180:183], a[176:179], a[68:71], v[180:183]
  ds_read_b64_tr_b16 a[170:171], v9 offset:63488
  v_mfma_f32_16x16x32_bf16 v[180:183], a[180:183], a[84:87], v[180:183]
  v_mfma_f32_16x16x32_bf16 v[176:179], a[180:183], a[80:83], v[176:179]
  ds_read_b64_tr_b16 a[172:173], v4 offset:8192
  v_mfma_f32_16x16x32_bf16 v[176:179], a[176:179], a[64:67], v[176:179]
  s_waitcnt lgkmcnt(5)
  v_mfma_f32_16x16x32_bf16 v[160:163], a[184:187], a[96:99], v[160:163]
  ds_read_b64_tr_b16 a[174:175], v4 offset:10240
  v_mfma_f32_16x16x32_bf16 v[160:163], a[160:163], a[112:115], v[160:163]
  v_mfma_f32_16x16x32_bf16 v[164:167], a[160:163], a[116:119], v[164:167]
  ds_read_b64_tr_b16 a[176:177], v4 offset:12288
  v_mfma_f32_16x16x32_bf16 v[164:167], a[184:187], a[100:103], v[164:167]
  v_mfma_f32_16x16x32_bf16 v[168:171], a[184:187], a[104:107], v[168:171]
  ds_read_b64_tr_b16 a[178:179], v4 offset:14336
  v_mfma_f32_16x16x32_bf16 v[168:171], a[160:163], a[120:123], v[168:171]
  v_mfma_f32_16x16x32_bf16 v[172:175], a[160:163], a[124:127], v[172:175]
  ds_read_b64_tr_b16 a[180:181], v5 offset:8192
  v_mfma_f32_16x16x32_bf16 v[172:175], a[184:187], a[108:111], v[172:175]
  s_waitcnt lgkmcnt(5)
  v_mfma_f32_16x16x32_bf16 v[188:191], a[164:167], a[108:111], v[188:191]
  ds_read_b64_tr_b16 a[182:183], v5 offset:10240
  v_mfma_f32_16x16x32_bf16 v[188:191], a[168:171], a[124:127], v[188:191]
  v_mfma_f32_16x16x32_bf16 v[184:187], a[168:171], a[120:123], v[184:187]
  ds_read_b64_tr_b16 a[184:185], v5 offset:12288
  v_mfma_f32_16x16x32_bf16 v[184:187], a[164:167], a[104:107], v[184:187]
  v_mov_b32 v38, 1
  v_mov_b32 v39, 0
  s_waitcnt vmcnt(1)
  s_mov_b64 exec, 1
  buffer_store_dword v38, v39, s[4:7], s57 offen offset:16 sc1
  s_mov_b64 exec, -1
  v_mfma_f32_16x16x32_bf16 v[180:183], a[164:167], a[100:103], v[180:183]
  ds_read_b64_tr_b16 a[186:187], v5 offset:14336
  v_mfma_f32_16x16x32_bf16 v[180:183], a[168:171], a[116:119], v[180:183]
  v_mfma_f32_16x16x32_bf16 v[176:179], a[168:171], a[112:115], v[176:179]
  ds_read_b64_tr_b16 a[160:161], v4 offset:24576
  v_mfma_f32_16x16x32_bf16 v[176:179], a[164:167], a[96:99], v[176:179]
  s_waitcnt lgkmcnt(5)
  v_mfma_f32_16x16x32_bf16 v[160:163], a[172:175], a[128:131], v[160:163]
  ds_read_b64_tr_b16 a[162:163], v4 offset:26624
  v_mfma_f32_16x16x32_bf16 v[160:163], a[176:179], a[144:147], v[160:163]
  v_mfma_f32_16x16x32_bf16 v[164:167], a[176:179], a[148:151], v[164:167]
  ds_read_b64_tr_b16 a[164:165], v4 offset:28672
  v_mfma_f32_16x16x32_bf16 v[164:167], a[172:175], a[132:135], v[164:167]
  v_mfma_f32_16x16x32_bf16 v[168:171], a[172:175], a[136:139], v[168:171]
  ds_read_b64_tr_b16 a[166:167], v4 offset:30720
  v_mfma_f32_16x16x32_bf16 v[168:171], a[176:179], a[152:155], v[168:171]
  v_mfma_f32_16x16x32_bf16 v[172:175], a[176:179], a[156:159], v[172:175]
  ds_read_b64_tr_b16 a[168:169], v5 offset:24576
  v_mfma_f32_16x16x32_bf16 v[172:175], a[172:175], a[140:143], v[172:175]
  s_waitcnt lgkmcnt(5)
  v_mfma_f32_16x16x32_bf16 v[188:191], a[180:183], a[140:143], v[188:191]
  ds_read_b64_tr_b16 a[170:171], v5 offset:26624
  v_mfma_f32_16x16x32_bf16 v[188:191], a[184:187], a[156:159], v[188:191]
  v_mfma_f32_16x16x32_bf16 v[184:187], a[184:187], a[152:155], v[184:187]
  ds_read_b64_tr_b16 a[172:173], v5 offset:28672
  v_mfma_f32_16x16x32_bf16 v[184:187], a[180:183], a[136:139], v[184:187]
  v_mfma_f32_16x16x32_bf16 v[180:183], a[180:183], a[132:135], v[180:183]
  ds_read_b64_tr_b16 a[174:175], v5 offset:30720
  v_mfma_f32_16x16x32_bf16 v[180:183], a[184:187], a[148:151], v[180:183]
  v_mfma_f32_16x16x32_bf16 v[176:179], a[184:187], a[144:147], v[176:179]
  ds_read_b64_tr_b16 a[176:177], v6 offset:8192
  v_mfma_f32_16x16x32_bf16 v[176:179], a[180:183], a[128:131], v[176:179]
  s_waitcnt lgkmcnt(5)
  v_mfma_f32_16x16x32_bf16 v[160:163], a[160:163], a[0:3], v[160:163]
  ds_read_b64_tr_b16 a[178:179], v6 offset:10240
  v_mfma_f32_16x16x32_bf16 v[160:163], a[164:167], a[16:19], v[160:163]
  v_mfma_f32_16x16x32_bf16 v[164:167], a[164:167], a[20:23], v[164:167]
  ds_read_b64_tr_b16 a[180:181], v6 offset:12288
  v_mfma_f32_16x16x32_bf16 v[164:167], a[160:163], a[4:7], v[164:167]
  s_waitcnt vmcnt(1)
  v_cmp_ne_u32 vcc, 1, v36
  s_nop 4
  s_cbranch_vccz PL3_k5_ffn_kernelx
  s_mov_b32 s59, 60000
PL3_k5_ffn_kernel:
  buffer_load_dword v36, v37, s[4:7], s58 offen sc1
  s_sub_u32 s59, s59, 1
  s_cmp_eq_u32 s59, 0
  s_waitcnt vmcnt(0)
  s_cbranch_scc1 PL3_k5_ffn_kernelx
  v_cmp_ne_u32 vcc, 1, v36
  s_nop 4
  s_cbranch_vccnz PL3_k5_ffn_kernel
PL3_k5_ffn_kernelx:
  v_mfma_f32_16x16x32_bf16 v[168:171], a[160:163], a[8:11], v[168:171]
  ds_read_b64_tr_b16 a[182:183], v6 offset:14336
  s_xor_b32 s30, s62, 131072
  s_add_u32 s30, s30, 0
  buffer_load_dwordx4 v[80:83], v1, s[4:7], s30 offen offset:0 sc1
  v_mfma_f32_16x16x32_bf16 v[168:171], a[164:167], a[24:27], v[168:171]
  v_mfma_f32_16x16x32_bf16 v[172:175], a[164:167], a[28:31], v[172:175]
  ds_read_b64_tr_b16 a[184:185], v7 offset:8192
  buffer_load_dwordx4 v[84:87], v1, s[4:7], s30 offen offset:1024 sc1
  v_mfma_f32_16x16x32_bf16 v[172:175], a[160:163], a[12:15], v[172:175]
  s_waitcnt lgkmcnt(5)
  v_mfma_f32_16x16x32_bf16 v[188:191], a[168:171], a[12:15], v[188:191]
  ds_read_b64_tr_b16 a[186:187], v7 offset:10240
  buffer_load_dwordx4 v[88:91], v1, s[4:7], s30 offen offset:2048 sc1
  v_mfma_f32_16x16x32_bf16 v[188:191], a[172:175], a[28:31], v[188:191]
  v_mfma_f32_16x16x32_bf16 v[184:187], a[172:175], a[24:27], v[184:187]
  ds_read_b64_tr_b16 a[160:161], v7 offset:12288
  buffer_load_dwordx4 v[92:95], v1, s[4:7], s30 offen offset:3072 sc1
  v_mfma_f32_16x16x32_bf16 v[184:187], a[168:171], a[8:11], v[184:187]
  v_cvt_pk_bf16_f32 v160, v160, v161
  v_cvt_pk_bf16_f32 v161, v162, v163
HOP17:
  s_cbranch_execz WRET1
  v_mfma_f32_16x16x32_bf16 v[180:183], a[168:171], a[4:7], v[180:183]
  ds_read_b64_tr_b16 a[162:163], v7 offset:14336
  v_cvt_pk_bf16_f32 v164, v164, v165
  v_mfma_f32_16x16x32_bf16 v[180:183], a[172:175], a[20:23], v[180:183]
  v_cvt_pk_bf16_f32 v165, v166, v167
  v_cvt_pk_bf16_f32 v168, v168, v169
  v_mfma_f32_16x16x32_bf16 v[176:179], a[172:175], a[16:19], v[176:179]
  ds_read_b64_tr_b16 a[164:165], v6 offset:24576
  v_cvt_pk_bf16_f32 v169, v170, v171
  v_mfma_f32_16x16x32_bf16 v[176:179], a[168:171], a[0:3], v[176:179]
  v_cvt_pk_bf16_f32 v172, v172, v173
  s_waitcnt lgkmcnt(5)
  v_mfma_f32_16x16x32_bf16 v[128:131], a[176:179], a[220:223], v[128:131]
  ds_read_b64_tr_b16 a[166:167], v6 offset:26624
  v_cvt_pk_bf16_f32 v173, v174, v175
  v_mfma_f32_16x16x32_bf16 v[128:131], a[180:183], a[236:239], v[128:131]
  v_mfma_f32_16x16x32_bf16 v[132:135], a[180:183], a[240:243], v[132:135]
  ds_read_b64_tr_b16 a[168:169], v6 offset:28672
  v_cvt_pk_bf16_f32 v162, v176, v177
  v_mfma_f32_16x16x32_bf16 v[132:135], a[176:179], a[224:227], v[132:135]
  v_cvt_pk_bf16_f32 v163, v178, v179
  s_add_u32 s63, s62, 8192
  buffer_store_dwordx4 v[160:163], v1, s[4:7], s63 offen offset:0 sc1
  v_mfma_f32_16x16x32_bf16 v[136:139], a[176:179], a[228:231], v[136:139]
  ds_read_b64_tr_b16 a[170:171], v6 offset:30720
  v_cvt_pk_bf16_f32 v166, v180, v181
  v_mfma_f32_16x16x32_bf16 v[136:139], a[180:183], a[244:247], v[136:139]
  v_cvt_pk_bf16_f32 v167, v182, v183
  buffer_store_dwordx4 v[164:167], v1, s[4:7], s63 offen offset:1024 sc1
  v_mfma_f32_16x16x32_bf16 v[140:143], a[180:183], a[248:251], v[140:143]
  ds_read_b64_tr_b16 a[172:173], v7 offset:24576
  v_cvt_pk_bf16_f32 v170, v184, v185
  v_mfma_f32_16x16x32_bf16 v[140:143], a[176:179], a[232:235], v[140:143]
  v_cvt_pk_bf16_f32 v171, v186, v187
  s_waitcnt lgkmcnt(5)
  v_mfma_f32_16x16x32_bf16 v[156:159], a[184:187], a[232:235], v[156:159]
  ds_read_b64_tr_b16 a[174:175], v7 offset:26624
  buffer_store_dwordx4 v[168:171], v1, s[4:7], s63 offen offset:2048 sc1
  v_mfma_f32_16x16x32_bf16 v[156:159], a[160:163], a[248:251], v[156:159]
  v_cvt_pk_bf16_f32 v174, v188, v189
  v_cvt_pk_bf16_f32 v175, v190, v191
  v_mfma_f32_16x16x32_bf16 v[152:155], a[160:163], a[244:247], v[152:155]
  ds_read_b64_tr_b16 a[176:177], v7 offset:28672
  buffer_store_dwordx4 v[172:175], v1, s[4:7], s63 offen offset:3072 sc1
  v_mfma_f32_16x16x32_bf16 v[152:155], a[184:187], a[228:231], v[152:155]
  v_mfma_f32_16x16x32_bf16 v[148:151], a[184:187], a[224:227], v[148:151]
  ds_read_b64_tr_b16 a[178:179], v7 offset:30720
  v_mfma_f32_16x16x32_bf16 v[148:151], a[160:163], a[240:243], v[148:151]
  v_mfma_f32_16x16x32_bf16 v[144:147], a[160:163], a[236:239], v[144:147]
  ds_read_b64_tr_b16 a[180:181], v6 offset:40960
  v_mfma_f32_16x16x32_bf16 v[144:147], a[184:187], a[220:223], v[144:147]
  s_waitcnt lgkmcnt(5)
  v_mfma_f32_16x16x32_bf16 v[128:131], a[164:167], a[32:35], v[128:131]
  ds_read_b64_tr_b16 a[182:183], v6 offset:43008
  v_mfma_f32_16x16x32_bf16 v[128:131], a[168:171], a[48:51], v[128:131]
  v_mfma_f32_16x16x32_bf16 v[132:135], a[168:171], a[52:55], v[132:135]
  ds_read_b64_tr_b16 a[184:185], v6 offset:45056
  v_mfma_f32_16x16x32_bf16 v[132:135], a[164:167], a[36:39], v[132:135]
  v_mfma_f32_16x16x32_bf16 v[136:139], a[164:167], a[40:43], v[136:139]
  ds_read_b64_tr_b16 a[186:187], v6 offset:47104
  v_mfma_f32_16x16x32_bf16 v[136:139], a[168:171], a[56:59], v[136:139]
  v_mfma_f32_16x16x32_bf16 v[140:143], a[168:171], a[60:63], v[140:143]
  ds_read_b64_tr_b16 a[160:161], v7 offset:40960
  v_mfma_f32_16x16x32_bf16 v[140:143], a[164:167], a[44:47], v[140:143]
  s_waitcnt lgkmcnt(5)
  v_mfma_f32_16x16x32_bf16 v[156:159], a[172:175], a[44:47], v[156:159]
  ds_read_b64_tr_b16 a[162:163], v7 offset:43008
  v_mfma_f32_16x16x32_bf16 v[156:159], a[176:179], a[60:63], v[156:159]
  v_mfma_f32_16x16x32_bf16 v[152:155], a[176:179], a[56:59], v[152:155]
  ds_read_b64_tr_b16 a[164:165], v7 offset:45056
  v_mfma_f32_16x16x32_bf16 v[152:155], a[172:175], a[40:43], v[152:155]
  v_mfma_f32_16x16x32_bf16 v[148:151], a[172:175], a[36:39], v[148:151]
  ds_read_b64_tr_b16 a[166:167], v7 offset:47104
  v_mfma_f32_16x16x32_bf16 v[148:151], a[176:179], a[52:55], v[148:151]
  v_mfma_f32_16x16x32_bf16 v[144:147], a[176:179], a[48:51], v[144:147]
  ds_read_b64_tr_b16 a[168:169], v6 offset:57344
  v_mfma_f32_16x16x32_bf16 v[144:147], a[172:175], a[32:35], v[144:147]
  s_waitcnt lgkmcnt(5)
  v_mfma_f32_16x16x32_bf16 v[128:131], a[180:183], a[64:67], v[128:131]
  ds_read_b64_tr_b16 a[170:171], v6 offset:59392
  v_mfma_f32_16x16x32_bf16 v[128:131], a[184:187], a[80:83], v[128:131]
  s_xor_b32 s58, s57, 384
  s_add_u32 s58, s58, 16
  buffer_load_dword v36, v37, s[4:7], s58 offen sc1
  v_mfma_f32_16x16x32_bf16 v[132:135], a[184:187], a[84:87], v[132:135]
  ds_read_b64_tr_b16 a[172:173], v6 offset:61440
  v_mfma_f32_16x16x32_bf16 v[132:135], a[180:183], a[68:71], v[132:135]
  v_mfma_f32_16x16x32_bf16 v[136:139], a[180:183], a[72:75], v[136:139]
  ds_read_b64_tr_b16 a[174:175], v6 offset:63488
  v_mfma_f32_16x16x32_bf16 v[136:139], a[184:187], a[88:91], v[136:139]
  v_mfma_f32_16x16x32_bf16 v[140:143], a[184:187], a[92:95], v[140:143]
  ds_read_b64_tr_b16 a[176:177], v7 offset:57344
  v_mfma_f32_16x16x32_bf16 v[140:143], a[180:183], a[76:79], v[140:143]
  s_waitcnt lgkmcnt(5)
  v_mfma_f32_16x16x32_bf16 v[156:159], a[160:163], a[76:79], v[156:159]
  ds_read_b64_tr_b16 a[178:179], v7 offset:59392
  v_mfma_f32_16x16x32_bf16 v[156:159], a[164:167], a[92:95], v[156:159]
  v_mfma_f32_16x16x32_bf16 v[152:155], a[164:167], a[88:91], v[152:155]
  ds_read_b64_tr_b16 a[180:181], v7 offset:61440
  v_mfma_f32_16x16x32_bf16 v[152:155], a[160:163], a[72:75], v[152:155]
  v_mfma_f32_16x16x32_bf16 v[148:151], a[160:163], a[68:71], v[148:151]
  ds_read_b64_tr_b16 a[182:183], v7 offset:63488
  v_mov_b32 v38, 1
  v_mov_b32 v39, 0
  s_waitcnt vmcnt(1)
  s_mov_b64 exec, 1
  buffer_store_dword v38, v39, s[4:7], s57 offen offset:32 sc1
  s_mov_b64 exec, -1
  v_mfma_f32_16x16x32_bf16 v[148:151], a[164:167], a[84:87], v[148:151]
  v_mfma_f32_16x16x32_bf16 v[144:147], a[164:167], a[80:83], v[144:147]
  ds_read_b64_tr_b16 a[184:185], v2 offset:8192
  v_mfma_f32_16x16x32_bf16 v[144:147], a[160:163], a[64:67], v[144:147]
  s_waitcnt lgkmcnt(5)
  v_mfma_f32_16x16x32_bf16 v[128:131], a[168:171], a[96:99], v[128:131]
  ds_read_b64_tr_b16 a[186:187], v2 offset:10240
  v_mfma_f32_16x16x32_bf16 v[128:131], a[172:175], a[112:115], v[128:131]
  v_mfma_f32_16x16x32_bf16 v[132:135], a[172:175], a[116:119], v[132:135]
  ds_read_b64_tr_b16 a[160:161], v2 offset:12288
  v_mfma_f32_16x16x32_bf16 v[132:135], a[168:171], a[100:103], v[132:135]
  v_mfma_f32_16x16x32_bf16 v[136:139], a[168:171], a[104:107], v[136:139]
  ds_read_b64_tr_b16 a[162:163], v2 offset:14336
  v_mfma_f32_16x16x32_bf16 v[136:139], a[172:175], a[120:123], v[136:139]
  v_mfma_f32_16x16x32_bf16 v[140:143], a[172:175], a[124:127], v[140:143]
  ds_read_b64_tr_b16 a[164:165], v3 offset:8192
  v_mfma_f32_16x16x32_bf16 v[140:143], a[168:171], a[108:111], v[140:143]
  s_waitcnt lgkmcnt(5)
  v_mfma_f32_16x16x32_bf16 v[156:159], a[176:179], a[108:111], v[156:159]
  ds_read_b64_tr_b16 a[166:167], v3 offset:10240
  v_mfma_f32_16x16x32_bf16 v[156:159], a[180:183], a[124:127], v[156:159]
  v_mfma_f32_16x16x32_bf16 v[152:155], a[180:183], a[120:123], v[152:155]
  ds_read_b64_tr_b16 a[168:169], v3 offset:12288
  v_mfma_f32_16x16x32_bf16 v[152:155], a[176:179], a[104:107], v[152:155]
  v_mfma_f32_16x16x32_bf16 v[148:151], a[176:179], a[100:103], v[148:151]
  ds_read_b64_tr_b16 a[170:171], v3 offset:14336
  v_mfma_f32_16x16x32_bf16 v[148:151], a[180:183], a[116:119], v[148:151]
  v_mfma_f32_16x16x32_bf16 v[144:147], a[180:183], a[112:115], v[144:147]
  ds_read_b64_tr_b16 a[172:173], v2 offset:24576
  v_mfma_f32_16x16x32_bf16 v[144:147], a[176:179], a[96:99], v[144:147]
  s_waitcnt lgkmcnt(5)
  v_mfma_f32_16x16x32_bf16 v[128:131], a[184:187], a[128:131], v[128:131]
  ds_read_b64_tr_b16 a[174:175], v2 offset:26624
  v_mfma_f32_16x16x32_bf16 v[128:131], a[160:163], a[144:147], v[128:131]
  v_mfma_f32_16x16x32_bf16 v[132:135], a[160:163], a[148:151], v[132:135]
  ds_read_b64_tr_b16 a[176:177], v2 offset:28672
  v_mfma_f32_16x16x32_bf16 v[132:135], a[184:187], a[132:135], v[132:135]
  v_mfma_f32_16x16x32_bf16 v[136:139], a[184:187], a[136:139], v[136:139]
  ds_read_b64_tr_b16 a[178:179], v2 offset:30720
  s_waitcnt vmcnt(1)
  v_cmp_ne_u32 vcc, 1, v36
  s_nop 4
  s_cbranch_vccz PL4_k5_ffn_kernelx
  s_mov_b32 s59, 60000
PL4_k5_ffn_kernel:
  buffer_load_dword v36, v37, s[4:7], s58 offen sc1
  s_sub_u32 s59, s59, 1
  s_cmp_eq_u32 s59, 0
  s_waitcnt vmcnt(0)
  s_cbranch_scc1 PL4_k5_ffn_kernelx
  v_cmp_ne_u32 vcc, 1, v36
  s_nop 4
  s_cbranch_vccnz PL4_k5_ffn_kernel
PL4_k5_ffn_kernelx:
  v_mfma_f32_16x16x32_bf16 v[136:139], a[160:163], a[152:155], v[136:139]
  s_xor_b32 s30, s62, 196608
  s_add_u32 s30, s30, 4096
  buffer_load_dwordx4 v[112:115], v1, s[4:7], s30 offen offset:0 sc1
  v_mfma_f32_16x16x32_bf16 v[140:143], a[160:163], a[156:159], v[140:143]
  ds_read_b64_tr_b16 a[180:181], v3 offset:24576
  v_mfma_f32_16x16x32_bf16 v[140:143], a[184:187], a[140:143], v[140:143]
  buffer_load_dwordx4 v[116:119], v1, s[4:7], s30 offen offset:1024 sc1
  s_waitcnt lgkmcnt(5)
  v_mfma_f32_16x16x32_bf16 v[156:159], a[164:167], a[140:143], v[156:159]
  ds_read_b64_tr_b16 a[182:183], v3 offset:26624
  v_mfma_f32_16x16x32_bf16 v[156:159], a[168:171], a[156:159], v[156:159]
  buffer_load_dwordx4 v[120:123], v1, s[4:7], s30 offen offset:2048 sc1
  v_mfma_f32_16x16x32_bf16 v[152:155], a[168:171], a[152:155], v[152:155]
  ds_read_b64_tr_b16 a[184:185], v3 offset:28672
  v_mfma_f32_16x16x32_bf16 v[152:155], a[164:167], a[136:139], v[152:155]
  buffer_load_dwordx4 v[124:127], v1, s[4:7], s30 offen offset:3072 sc1
  v_mfma_f32_16x16x32_bf16 v[148:151], a[164:167], a[132:135], v[148:151]
  ds_read_b64_tr_b16 a[186:187], v3 offset:30720
  v_mfma_f32_16x16x32_bf16 v[148:151], a[168:171], a[148:151], v[148:151]
  v_mfma_f32_16x16x32_bf16 v[144:147], a[168:171], a[144:147], v[144:147]
  v_mfma_f32_16x16x32_bf16 v[144:147], a[164:167], a[128:131], v[144:147]
  s_waitcnt lgkmcnt(4)
  v_mfma_f32_16x16x32_bf16 v[128:131], a[172:175], a[0:3], v[128:131]
  v_mfma_f32_16x16x32_bf16 v[128:131], a[176:179], a[16:19], v[128:131]
  v_mfma_f32_16x16x32_bf16 v[132:135], a[176:179], a[20:23], v[132:135]
  v_mfma_f32_16x16x32_bf16 v[132:135], a[172:175], a[4:7], v[132:135]
  v_mfma_f32_16x16x32_bf16 v[136:139], a[172:175], a[8:11], v[136:139]
  v_mfma_f32_16x16x32_bf16 v[136:139], a[176:179], a[24:27], v[136:139]
  v_mfma_f32_16x16x32_bf16 v[140:143], a[176:179], a[28:31], v[140:143]
  v_mfma_f32_16x16x32_bf16 v[140:143], a[172:175], a[12:15], v[140:143]
  s_waitcnt lgkmcnt(0)
  v_mfma_f32_16x16x32_bf16 v[156:159], a[180:183], a[12:15], v[156:159]
  v_mfma_f32_16x16x32_bf16 v[156:159], a[184:187], a[28:31], v[156:159]
  s_xor_b32 s58, s57, 128
  s_add_u32 s58, s58, 32
  buffer_load_dword v36, v37, s[4:7], s58 offen sc1
  v_mfma_f32_16x16x32_bf16 v[152:155], a[184:187], a[24:27], v[152:155]
  v_mfma_f32_16x16x32_bf16 v[152:155], a[180:183], a[8:11], v[152:155]
  v_mfma_f32_16x16x32_bf16 v[148:151], a[180:183], a[4:7], v[148:151]
  v_mfma_f32_16x16x32_bf16 v[148:151], a[184:187], a[20:23], v[148:151]
  v_mfma_f32_16x16x32_bf16 v[144:147], a[184:187], a[16:19], v[144:147]
  v_mfma_f32_16x16x32_bf16 v[144:147], a[180:183], a[0:3], v[144:147]
  s_waitcnt vmcnt(0)
  v_cmp_ne_u32 vcc, 1, v36
  s_nop 4
  s_cbranch_vccz PL5_k5_ffn_kernelx
  s_mov_b32 s59, 60000
PL5_k5_ffn_kernel:
  buffer_load_dword v36, v37, s[4:7], s58 offen sc1
  s_sub_u32 s59, s59, 1
  s_cmp_eq_u32 s59, 0
  s_waitcnt vmcnt(0)
  s_cbranch_scc1 PL5_k5_ffn_kernelx
  v_cmp_ne_u32 vcc, 1, v36
  s_nop 4
  s_cbranch_vccnz PL5_k5_ffn_kernel
PL5_k5_ffn_kernelx:
  s_xor_b32 s30, s62, 65536
  s_add_u32 s30, s30, 8192
  buffer_load_dwordx4 v[176:179], v1, s[4:7], s30 offen offset:0 sc1
  buffer_load_dwordx4 v[180:183], v1, s[4:7], s30 offen offset:1024 sc1
  buffer_load_dwordx4 v[184:187], v1, s[4:7], s30 offen offset:2048 sc1
  buffer_load_dwordx4 v[188:191], v1, s[4:7], s30 offen offset:3072 sc1
  s_waitcnt vmcnt(15)
  v_mfma_f32_16x16x32_bf16 v[128:131], v[58:61], v[80:83], v[128:131]
  v_mfma_f32_16x16x32_bf16 v[144:147], v[56:59], v[80:83], v[144:147]
  v_mfma_f32_16x16x32_bf16 v[132:135], v[58:61], v[84:87], v[132:135]
  v_mfma_f32_16x16x32_bf16 v[148:151], v[56:59], v[84:87], v[148:151]
  v_mfma_f32_16x16x32_bf16 v[136:139], v[58:61], v[88:91], v[136:139]
  v_mfma_f32_16x16x32_bf16 v[152:155], v[56:59], v[88:91], v[152:155]
  v_mfma_f32_16x16x32_bf16 v[140:143], v[58:61], v[92:95], v[140:143]
  v_mfma_f32_16x16x32_bf16 v[156:159], v[56:59], v[92:95], v[156:159]
  s_waitcnt vmcnt(5)
  v_mfma_f32_16x16x32_bf16 v[128:131], v[58:61], v[112:115], v[128:131]
  v_mfma_f32_16x16x32_bf16 v[144:147], v[56:59], v[112:115], v[144:147]
  v_mfma_f32_16x16x32_bf16 v[132:135], v[58:61], v[116:119], v[132:135]
  v_mfma_f32_16x16x32_bf16 v[148:151], v[56:59], v[116:119], v[148:151]
  v_mfma_f32_16x16x32_bf16 v[136:139], v[58:61], v[120:123], v[136:139]
  v_mfma_f32_16x16x32_bf16 v[152:155], v[56:59], v[120:123], v[152:155]
  v_mfma_f32_16x16x32_bf16 v[140:143], v[58:61], v[124:127], v[140:143]
  v_mfma_f32_16x16x32_bf16 v[156:159], v[56:59], v[124:127], v[156:159]
  s_waitcnt vmcnt(3)
  v_mfma_f32_16x16x32_bf16 v[128:131], v[58:61], v[176:179], v[128:131]
  v_mfma_f32_16x16x32_bf16 v[144:147], v[56:59], v[176:179], v[144:147]
  s_waitcnt vmcnt(2)
  v_mfma_f32_16x16x32_bf16 v[132:135], v[58:61], v[180:183], v[132:135]
  v_mfma_f32_16x16x32_bf16 v[148:151], v[56:59], v[180:183], v[148:151]
  s_waitcnt vmcnt(1)
  v_mfma_f32_16x16x32_bf16 v[136:139], v[58:61], v[184:187], v[136:139]
  v_mfma_f32_16x16x32_bf16 v[152:155], v[56:59], v[184:187], v[152:155]
  s_waitcnt vmcnt(0)
  v_mfma_f32_16x16x32_bf16 v[140:143], v[58:61], v[188:191], v[140:143]
  v_mfma_f32_16x16x32_bf16 v[156:159], v[56:59], v[188:191], v[156:159]
  v_fmac_f32 v208, v48, v128
  v_fmac_f32 v209, v49, v129
  v_fmac_f32 v210, v50, v130
  v_fmac_f32 v211, v51, v131
  v_fmac_f32 v212, v52, v144
  v_fmac_f32 v213, v53, v145
  v_fmac_f32 v214, v54, v146
  v_fmac_f32 v215, v55, v147
  v_cvt_pk_bf16_f32 v192, v208, v209
  v_cvt_pk_bf16_f32 v193, v210, v211
  v_cvt_pk_bf16_f32 v194, v212, v213
  v_cvt_pk_bf16_f32 v195, v214, v215
  s_nop 0
  v_permlane16_swap_b32 v192, v194
  v_permlane16_swap_b32 v193, v195
  ds_write_b128 v42, v[192:195] offset:0
  ds_read_b128 v[208:211], v43 offset:0
  v_fmac_f32 v216, v48, v132
  v_fmac_f32 v217, v49, v133
  v_fmac_f32 v218, v50, v134
  v_fmac_f32 v219, v51, v135
  v_fmac_f32 v220, v52, v148
  v_fmac_f32 v221, v53, v149
  v_fmac_f32 v222, v54, v150
  v_fmac_f32 v223, v55, v151
  v_cvt_pk_bf16_f32 v196, v216, v217
  v_cvt_pk_bf16_f32 v197, v218, v219
  v_cvt_pk_bf16_f32 v198, v220, v221
  v_cvt_pk_bf16_f32 v199, v222, v223
  s_nop 0
  v_permlane16_swap_b32 v196, v198
  v_permlane16_swap_b32 v197, v199
  ds_write_b128 v42, v[196:199] offset:1024
  ds_read_b128 v[216:219], v43 offset:1024
  v_fmac_f32 v224, v48, v136
  v_fmac_f32 v225, v49, v137
  v_fmac_f32 v226, v50, v138
  v_fmac_f32 v227, v51, v139
  v_fmac_f32 v228, v52, v152
  v_fmac_f32 v229, v53, v153
  v_fmac_f32 v230, v54, v154
  v_fmac_f32 v231, v55, v155
  v_cvt_pk_bf16_f32 v200, v224, v225
  v_cvt_pk_bf16_f32 v201, v226, v227
  v_cvt_pk_bf16_f32 v202, v228, v229
  v_cvt_pk_bf16_f32 v203, v230, v231
  s_nop 0
  v_permlane16_swap_b32 v200, v202
  v_permlane16_swap_b32 v201, v203
  ds_write_b128 v42, v[200:203] offset:2048
  ds_read_b128 v[224:227], v43 offset:2048
  v_fmac_f32 v232, v48, v140
  v_fmac_f32 v233, v49, v141
  v_fmac_f32 v234, v50, v142
  v_fmac_f32 v235, v51, v143
  v_fmac_f32 v236, v52, v156
  v_fmac_f32 v237, v53, v157
  v_fmac_f32 v238, v54, v158
  v_fmac_f32 v239, v55, v159
  v_cvt_pk_bf16_f32 v204, v232, v233
  v_cvt_pk_bf16_f32 v205, v234, v235
  v_cvt_pk_bf16_f32 v206, v236, v237
  v_cvt_pk_bf16_f32 v207, v238, v239
  s_nop 0
  v_permlane16_swap_b32 v204, v206
  v_permlane16_swap_b32 v205, v207
  ds_write_b128 v42, v[204:207] offset:3072
  ds_read_b128 v[232:235], v43 offset:3072
  s_waitcnt lgkmcnt(6)
  buffer_store_dwordx4 v[208:211], v40, s[20:23], s61 offen
  s_add_u32 s61, s61, 65536
  s_waitcnt lgkmcnt(4)
  buffer_store_dwordx4 v[216:219], v40, s[20:23], s61 offen
  s_add_u32 s61, s61, 65536
  s_waitcnt lgkmcnt(2)
  buffer_store_dwordx4 v[224:227], v40, s[20:23], s61 offen
  s_add_u32 s61, s61, 65536
  s_waitcnt lgkmcnt(0)
  buffer_store_dwordx4 v[232:235], v40, s[20:23], s61 offen
E_k5_ffn_kernel:
X_k5_ffn_kernel:
  s_endpgm
code_end:
.fill 2048, 4, 0xBF800000
.section .rodata,"a"
.p2align 6
.amdhsa_kernel k1_mod_kernel
  .amdhsa_next_free_vgpr 77
  .amdhsa_next_free_sgpr 42
  .amdhsa_accum_offset 80
  .amdhsa_group_segment_fixed_size 0
  .amdhsa_kernarg_size 96
  .amdhsa_user_sgpr_count 2
  .amdhsa_user_sgpr_kernarg_segment_ptr 1
  .amdhsa_system_sgpr_workgroup_id_x 1
  .amdhsa_float_denorm_mode_32 3
.end_amdhsa_kernel
.p2align 6
.amdhsa_kernel k3_qkv_kernel
  .amdhsa_next_free_vgpr 248
  .amdhsa_next_free_sgpr 81
  .amdhsa_accum_offset 248
  .amdhsa_group_segment_fixed_size 0
  .amdhsa_kernarg_size 96
  .amdhsa_user_sgpr_count 2
  .amdhsa_user_sgpr_kernarg_segment_ptr 1
  .amdhsa_system_sgpr_workgroup_id_x 1
  .amdhsa_float_denorm_mode_32 3
.end_amdhsa_kernel
.p2align 6
.amdhsa_kernel k5_ffn_kernel
  .amdhsa_next_free_vgpr 512
  .amdhsa_next_free_sgpr 102
  .amdhsa_accum_offset 256
  .amdhsa_group_segment_fixed_size 0
  .amdhsa_kernarg_size 96
  .amdhsa_user_sgpr_count 2
  .amdhsa_user_sgpr_kernarg_segment_ptr 1
  .amdhsa_system_sgpr_workgroup_id_x 1
  .amdhsa_float_denorm_mode_32 3
.end_amdhsa_kernel
```

```asm
; @launch grid=(256,1,1) block=(256,1,1) lds=163840
.amdgcn_target "amdgcn-amd-amdhsa--gfx950"
.text
.globl adaLN_cond__sliding_local_dilated__swiglu_ffn__prompt_kernel
.type adaLN_cond__sliding_local_dilated__swiglu_ffn__prompt_kernel,@function
.p2align 8
adaLN_cond__sliding_local_dilated__swiglu_ffn__prompt_kernel:
  s_cmp_ge_u32 s2, 256
  s_cbranch_scc1 X_adaLN_cond__sliding_local_dilated__swiglu_ffn__prompt_kernel
  s_load_dwordx2 s[4:5], s[0:1], 0
  s_load_dwordx2 s[8:9], s[0:1], 88
  s_load_dwordx2 s[12:13], s[0:1], 8
  s_load_dwordx2 s[16:17], s[0:1], 16
  s_load_dwordx2 s[20:21], s[0:1], 64
  s_load_dwordx2 s[24:25], s[0:1], 56
  s_load_dwordx2 s[28:29], s[0:1], 32
  s_load_dwordx2 s[32:33], s[0:1], 40
  s_load_dwordx2 s[36:37], s[0:1], 48
  s_load_dwordx2 s[40:41], s[0:1], 72
  v_lshrrev_b32 v21, 6, v0
  v_and_b32 v0, 63, v0
  v_readfirstlane_b32 s44, v21
  v_lshrrev_b32 v22, 3, v0
  v_bfe_u32 v11, v22, 1, 2
  v_bfe_u32 v23, v0, 1, 2
  v_xor_b32 v11, v11, v23
  v_lshlrev_b32 v11, 5, v11
  v_and_b32 v23, 1, v0
  v_lshl_add_u32 v11, v23, 4, v11
  s_lshl_b32 s45, s44, 10
  s_lshl_b32 s52, s44, 3
  v_add_u32 v10, s52, v22
  s_and_b32 s52, s2, 7
  s_lshl_b32 s52, s52, 7
  v_add_u32 v35, s52, v10
  v_mul_u32_u24 v35, 12288, v35
  s_lshr_b32 s53, s2, 3
  s_lshl_b32 s53, s53, 7
  v_add3_u32 v35, v35, v11, s53
  s_and_b32 s53, s44, 1
  s_lshl_b32 s53, s53, 6
  s_add_u32 s52, s52, s53
  v_add_lshl_u32 v16, s52, v0, 1
  s_and_b32 s52, s2, 7
  s_lshr_b32 s53, s2, 3
  s_and_b32 s51, s52, 3
  s_lshl_b32 s51, s51, 2
  s_and_b32 s50, s53, 3
  s_add_u32 s51, s51, s50
  s_lshr_b32 s50, s52, 2
  s_lshl_b32 s50, s50, 3
  s_lshr_b32 s53, s53, 2
  s_add_u32 s50, s50, s53
  s_lshl_b32 s54, s50, 4
  s_add_u32 s54, s54, s51
  v_and_b32 v21, 7, v0
  v_lshlrev_b32 v28, 11, v21
  v_lshl_add_u32 v28, v22, 4, v28
  v_mov_b32 v29, 851968
  s_lshr_b32 s38, s54, 1
  s_lshl_b32 s38, s38, 15
  s_and_b32 s53, s54, 1
  s_lshl_b32 s53, s53, 2
  s_add_u32 s53, s53, s44
  s_lshl_b32 s52, s53, 8
  s_add_u32 s30, s38, s52
  s_mov_b32 s6, 4194304
  s_mov_b32 s7, 0x20000
  s_mov_b32 s10, 134217728
  s_mov_b32 s11, 0x20000
  s_mov_b32 s14, 6291456
  s_mov_b32 s15, 0x20000
  s_mov_b32 s18, 2097152
  s_mov_b32 s19, 0x20000
  s_mov_b32 s22, 12582912
  s_mov_b32 s23, 0x20000
  s_mov_b32 s26, 2048
  s_mov_b32 s27, 0x20000
  s_waitcnt lgkmcnt(0)
  buffer_load_ushort v15, v16, s[24:27], 0 offen
  s_add_u32 m0, s45, 131072
  s_mov_b32 s68, 0
  buffer_load_dwordx4 v35, s[20:23], s68 offen nt lds
  s_add_u32 m0, s45, 135168
  s_add_u32 s68, s68, 393216
  buffer_load_dwordx4 v35, s[20:23], s68 offen nt lds
  s_add_u32 m0, s45, 139264
  s_add_u32 s68, s68, 393216
  buffer_load_dwordx4 v35, s[20:23], s68 offen nt lds
  s_add_u32 m0, s45, 143360
  s_add_u32 s68, s68, 393216
  buffer_load_dwordx4 v35, s[20:23], s68 offen nt lds
  buffer_load_dword v36, v29, s[8:11], 0 offen sc1
  s_and_b32 s52, s2, 3
  s_lshl_b32 s52, s52, 2
  s_add_u32 s52, s52, s44
  s_lshl_b32 s52, s52, 7
  v_lshlrev_b32 v23, 1, v0
  buffer_load_ushort v23, v23, s[24:27], s52 offen
  s_add_u32 s52, s30, 0
  buffer_load_dwordx4 v[44:47], v28, s[4:7], s52 offen offset:0
  buffer_load_dwordx4 v[48:51], v28, s[4:7], s52 offen offset:128
  s_add_u32 s52, s30, 16384
  buffer_load_dwordx4 v[52:55], v28, s[4:7], s52 offen offset:0
  buffer_load_dwordx4 v[56:59], v28, s[4:7], s52 offen offset:128
  s_branch BODY0
.p2align 12
BODY0:
  v_lshlrev_b32 v1, 4, v0
  v_add_u32 v2, 65536, v1
  v_add_u32 v13, 131072, v1
  s_lshl_b32 s66, s51, 1
  s_add_u32 s66, s66, s50
  v_mul_u32_u24 v9, 6144, v10
  s_lshl_b32 s52, s51, 7
  v_add3_u32 v9, v9, v11, s52
  s_lshl_b32 s52, s53, 12
  s_add_u32 s38, s38, s52
  s_add_u32 s39, s38, 41943040
  s_add_u32 s38, s38, 1048576
  s_lshl_b32 s34, s53, 9
  s_add_u32 s34, s34, 131072
  s_lshl_b32 s35, s53, 11
  s_add_u32 s35, s35, 819200
  s_lshr_b32 s83, s2, 3
  s_lshl_b32 s83, s83, 2
  s_add_u32 s83, s83, s44
  s_lshl_b32 s83, s83, 10
  s_getpc_b64 s[80:81]
CT1_adaLN_cond__sliding_local_dilated__swiglu_ffn__prompt_kernel:
  s_min_u32 s82, s83, code_end-CT1_adaLN_cond__sliding_local_dilated__swiglu_ffn__prompt_kernel
  s_add_u32 s80, s80, s82
  s_addc_u32 s81, s81, 0
  v_and_b32 v24, 0x70, v1
  v_lshlrev_b32 v24, 3, v24
  global_load_dword a253, v24, s[80:81]
  v_lshrrev_b32 v41, 2, v0
  v_bfe_u32 v40, v41, 1, 2
  v_lshlrev_b32 v40, 5, v40
  v_lshl_add_u32 v40, v41, 7, v40
  v_and_b32 v41, 3, v0
  v_lshl_add_u32 v40, v41, 3, v40
  s_lshl_b32 s52, s44, 5
  v_xor_b32 v3, s52, v40
  s_and_b32 s52, s52, 64
  s_and_b32 s53, s44, 1
  s_lshl_b32 s53, s53, 14
  s_add_u32 s52, s52, s53
  v_xor_b32 v4, s52, v40
  v_xor_b32 v5, 32, v4
  v_add_u32 v6, 65536, v3
  v_add_u32 v7, 65536, v4
  v_add_u32 v8, 65536, v5
  v_add_u32 v35, 131072, v3
  v_lshrrev_b32 v30, 5, v0
  v_lshlrev_b32 v30, 6, v30
  v_bfe_u32 v40, v0, 2, 2
  v_lshl_add_u32 v30, v40, 4, v30
  v_bfe_u32 v40, v0, 4, 1
  v_lshl_add_u32 v30, v40, 3, v30
  v_lshl_add_u32 v30, v41, 1, v30
  s_lshl_b32 s52, s44, 7
  s_add_u32 s52, s52, 149504
  v_add_u32 v30, s52, v30
  v_lshrrev_b32 v32, 4, v0
  v_lshlrev_b32 v32, 4, v32
  v_add_u32 v31, 149504, v32
  v_and_b32 v40, 15, v0
  v_lshl_add_u32 v32, v40, 27, v32
  s_and_b32 s52, s2, 7
  s_lshl_b32 s52, s52, 13
  s_lshr_b32 s53, s2, 3
  s_lshl_b32 s53, s53, 8
  s_add_u32 s52, s52, s53
  s_lshl_b32 s53, s44, 6
  s_add_u32 s52, s52, s53
  s_add_u32 s42, s52, 131072
  s_lshl_b32 s53, s44, 28
  s_lshl_b32 s31, s2, 7
  s_add_u32 s31, s31, s53
  s_add_u32 s31, s31, 819200
  s_lshl_b32 s74, s54, 7
  s_add_u32 s74, s74, s53
  s_add_u32 s75, s74, 786432
  s_add_u32 s74, s74, 655360
  s_lshl_b32 s52, s50, 18
  s_add_u32 s52, s52, 1015808
  s_max_u32 s72, s52, 1048576
  s_lshr_b32 s53, s44, 1
  s_lshl_b32 s70, s53, 15
  s_add_u32 s52, s52, s70
  v_add_u32 v12, s52, v1
  s_lshl_b32 s53, s53, 11
  s_add_u32 s72, s72, s53
  s_lshl_b32 s70, s44, 12
  s_and_b32 s52, s70, 4096
  s_add_u32 s71, s52, s53
  s_and_b32 s52, s44, 1
  s_add_u32 s52, s52, s66
  s_add_u32 s58, s52, 0
  s_and_b32 s58, s58, 7
  s_lshl_b32 s58, s58, 12
  s_add_u32 s59, s52, 2
  s_and_b32 s59, s59, 7
  s_lshl_b32 s59, s59, 12
  s_add_u32 s60, s52, 4
  s_and_b32 s60, s60, 7
  s_lshl_b32 s60, s60, 12
  s_add_u32 s61, s52, 6
  s_and_b32 s61, s61, 7
  s_lshl_b32 s61, s61, 12
  s_lshl_b32 s52, s50, 4
  s_sub_u32 s52, s52, 2
  v_min_u32 v14, 17, v0
  v_add_u32 v14, s52, v14
  v_max_i32 v14, 0, v14
  v_lshlrev_b32 v14, 7, v14
  v_add_u32 v14, 786432, v14
  s_and_b32 s52, s2, 3
  s_lshl_b32 s52, s52, 8
  v_add_u32 v40, s52, v10
  v_mul_u32_u24 v40, 12288, v40
  s_lshr_b32 s53, s2, 2
  s_add_u32 s53, s53, 32
  s_lshl_b32 s53, s53, 7
  v_lshl_add_u32 v10, v10, 11, v11
  v_add3_u32 v11, v40, v11, s53
  s_and_b32 s52, s44, 1
  s_lshl_b32 s53, s50, 3
  s_add_u32 s53, s53, s52
  s_lshl_b32 s73, s53, 15
  s_lshl_b32 s53, s51, 1
  s_lshr_b32 s57, s44, 1
  s_add_u32 s53, s53, s57
  s_lshl_b32 s53, s53, 10
  s_add_u32 s73, s73, s53
  s_add_u32 s73, s73, 7340032
  s_mul_i32 s57, s57, 3072
  s_add_u32 s57, s57, 131072
  v_add_u32 v19, s57, v1
  s_lshl_b32 s53, s52, 3
  v_add_u32 v18, s53, v19
  s_lshl_b32 s53, s52, 10
  v_add_u32 v17, s53, v19
  v_lshrrev_b32 v40, 2, v0
  v_and_b32 v20, 3, v0
  v_lshl_add_u32 v40, v20, 4, v40
  v_lshl_add_u32 v20, v40, 4, s57
  s_mov_b32 s80, 0xfff0ffff
  s_mov_b32 s81, 0xf000ff00
  s_mov_b32 s82, 0xffe0fffe
  s_mov_b32 s83, 0xe000fe00
  s_mov_b32 s84, 0xffc0fffc
  s_mov_b32 s85, 0xc000fc00
  s_mov_b32 s86, 0xff80fff8
  s_mov_b32 s87, 0x8000f800
  s_mov_b32 s88, 0xaaaaaaaa
  s_mov_b32 s89, 0xaaaaaaaa
  s_mov_b32 s90, 0x000f0000
  s_mov_b32 s91, 0x0fff00ff
  s_mov_b32 s92, 0x003f0003
  s_mov_b32 s93, 0x3fff03ff
  v_mov_b32 v41, 0xffff
  v_mov_b32 v24, 0xffff0000
  v_cndmask_b32 v41, v41, v24, s[88:89]
  v_cndmask_b32 v24, 0, v41, s[90:91]
  v_cndmask_b32 v25, 0, v41, s[92:93]
  v_xor_b32 v26, v24, v41
  v_xor_b32 v27, v25, v41
  s_or_b32 s52, s52, s50
  s_cmp_eq_u32 s52, 0
  s_cselect_b64 s[90:91], s[90:91], 0
  s_cselect_b64 s[92:93], s[92:93], 0
  s_bfe_u32 s53, s2, 0x30003
  s_lshl_b32 s43, s53, 1
  s_and_b32 s52, s2, 1
  s_add_u32 s43, s43, s52
  s_and_b32 s79, s2, 4
  s_lshr_b32 s52, s2, 6
  s_add_u32 s79, s79, s52
  s_lshl_b32 s79, s79, 1
  s_add_u32 s67, s79, s53
  s_bfe_u32 s52, s2, 0x10001
  s_add_u32 s79, s79, s52
  s_and_b32 s52, s44, 1
  s_add_u32 s52, s52, s67
  s_add_u32 s62, s52, 0
  s_and_b32 s62, s62, 7
  s_lshl_b32 s62, s62, 12
  s_add_u32 s63, s52, 2
  s_and_b32 s63, s63, 7
  s_lshl_b32 s63, s63, 12
  s_add_u32 s64, s52, 4
  s_and_b32 s64, s64, 7
  s_lshl_b32 s64, s64, 12
  s_add_u32 s65, s52, 6
  s_and_b32 s65, s65, 7
  s_lshl_b32 s65, s65, 12
  s_lshl_b32 s52, s43, 7
  v_add_u32 v10, s52, v10
  s_lshl_b32 s52, s79, 18
  s_lshr_b32 s53, s44, 1
  s_lshl_b32 s53, s53, 15
  s_add_u32 s53, s52, s53
  s_add_u32 s78, s53, 7340032
  s_and_b32 s53, s44, 1
  s_lshl_b32 s53, s53, 15
  s_add_u32 s52, s52, s53
  s_lshl_b32 s53, s43, 1
  s_lshr_b32 s57, s44, 1
  s_add_u32 s53, s53, s57
  s_lshl_b32 s76, s53, 7
  s_lshl_b32 s53, s53, 10
  s_add_u32 s47, s52, s53
  s_lshr_b32 s53, s53, 1
  s_lshl_b32 s52, s79, 1
  s_and_b32 s57, s44, 1
  s_add_u32 s52, s52, s57
  s_lshl_b32 s52, s52, 14
  s_add_u32 s52, s52, s53
  s_add_u32 s48, s52, 6291456
  s_lshl_b32 s52, s79, 11
  s_lshl_b32 s53, s43, 7
  s_add_u32 s53, s53, s52
  s_lshl_b32 s57, s44, 28
  s_add_u32 s53, s53, s57
  s_add_u32 s49, s53, 753664
  s_add_u32 s77, s52, 655360
  s_waitcnt vmcnt(11)
  v_lshlrev_b32 v15, 16, v15
  v_mul_f32 v16, 0xbfb8aa3b, v15
  v_exp_f32 v16, v16
  s_nop 0
  v_add_f32 v16, 1.0, v16
  v_rcp_f32 v16, v16
  s_nop 0
  v_mul_f32 v15, v15, v16
  v_cvt_pk_bf16_f32 v15, v15, v15
  ds_write_b16 v30, v15
  s_waitcnt vmcnt(7) lgkmcnt(0)
  s_barrier
  ds_read_b64_tr_b16 v[60:61], v35 offset:0
  ds_read_b64_tr_b16 v[62:63], v35 offset:2048
  ds_read_b128 v[76:79], v31 offset:0
  ds_read_b64_tr_b16 v[64:65], v35 offset:4096
  ds_read_b64_tr_b16 v[66:67], v35 offset:6144
  ds_read_b128 v[80:83], v31 offset:64
  ds_read_b64_tr_b16 v[68:69], v35 offset:8192
  ds_read_b64_tr_b16 v[70:71], v35 offset:10240
  ds_read_b128 v[84:87], v31 offset:128
  ds_read_b64_tr_b16 v[72:73], v35 offset:12288
  ds_read_b64_tr_b16 v[74:75], v35 offset:14336
  ds_read_b128 v[88:91], v31 offset:192
  s_waitcnt vmcnt(6)
  v_readfirstlane_b32 s46, v36
  s_nop 0
  s_add_u32 s46, s46, 8
  s_waitcnt lgkmcnt(9)
  v_mfma_f32_16x16x32_bf16 v[40:43], v[60:63], v[76:79], 0
  s_waitcnt lgkmcnt(6)
  v_mfma_f32_16x16x32_bf16 v[40:43], v[64:67], v[80:83], v[40:43]
  s_waitcnt lgkmcnt(3)
  v_mfma_f32_16x16x32_bf16 v[40:43], v[68:71], v[84:87], v[40:43]
  s_waitcnt lgkmcnt(0)
  v_mfma_f32_16x16x32_bf16 v[40:43], v[72:75], v[88:91], v[40:43]
  s_nop 7
  buffer_store_dwordx4 v[40:43], v32, s[8:11], s42 offen sc1
  s_xor_b32 s30, s30, 1024
  s_add_u32 s52, s30, 0
  buffer_load_dwordx4 v[92:95], v28, s[4:7], s52 offen offset:0
  buffer_load_dwordx4 v[96:99], v28, s[4:7], s52 offen offset:128
  s_add_u32 s52, s30, 16384
  buffer_load_dwordx4 v[100:103], v28, s[4:7], s52 offen offset:0
  buffer_load_dwordx4 v[104:107], v28, s[4:7], s52 offen offset:128
  s_add_u32 s52, s44, 0
  s_lshr_b32 s53, s52, 1
  s_lshl_b32 s53, s53, 11
  s_and_b32 s52, s52, 1
  s_and_b32 s57, s66, 7
  s_lshl_b32 s57, s57, 1
  s_add_u32 s52, s52, s57
  s_mul_i32 s52, s52, 393216
  s_add_u32 s52, s52, s53
  s_lshl_b32 s53, s51, 7
  s_add_u32 s52, s52, s53
  s_cmp_lt_u32 s44, 2
  s_cselect_b32 s52, s52, 1073741824
  v_mul_u32_u24 v16, 6144, v0
  buffer_load_dword a252, v16, s[12:15], s52 offen
  v_add_u32 v15, s46, v0
  s_waitcnt vmcnt(5)
  s_barrier
  s_mov_b64 exec, 1
  buffer_store_dword v15, v0, s[8:11], s31 offen offset:0 sc1
  s_mov_b64 exec, -1
  s_add_u32 s52, s44, 2
  s_lshr_b32 s53, s52, 1
  s_lshl_b32 s53, s53, 11
  s_and_b32 s52, s52, 1
  s_and_b32 s57, s66, 7
  s_lshl_b32 s57, s57, 1
  s_add_u32 s52, s52, s57
  s_mul_i32 s52, s52, 393216
  s_add_u32 s52, s52, s53
  s_lshl_b32 s53, s51, 7
  s_add_u32 s52, s52, s53
  s_cmp_lt_u32 s44, 4
  s_cselect_b32 s52, s52, 1073741824
  v_mul_u32_u24 v16, 6144, v0
  buffer_load_dword a252, v16, s[12:15], s52 offen
  s_lshl_b32 s53, s44, 4
  v_lshlrev_b32 v31, 6, v21
  v_add_u32 v31, 159744, v31
  v_add_u32 v30, s53, v31
  v_mov_b32 v34, 0x3f803f80
  v_mov_b32 v36, 0
  v_mov_b32 v37, 0
  v_mov_b32 v38, 0
  v_mov_b32 v39, 0
  s_waitcnt vmcnt(9)
  v_dot2c_f32_bf16 v36, v44, v34
  v_dot2c_f32_bf16 v37, v44, v44
  v_dot2c_f32_bf16 v38, v52, v34
  v_dot2c_f32_bf16 v39, v52, v52
  v_dot2c_f32_bf16 v36, v45, v34
  v_dot2c_f32_bf16 v37, v45, v45
  v_dot2c_f32_bf16 v38, v53, v34
  v_dot2c_f32_bf16 v39, v53, v53
  v_dot2c_f32_bf16 v36, v46, v34
  v_dot2c_f32_bf16 v37, v46, v46
  v_dot2c_f32_bf16 v38, v54, v34
  v_dot2c_f32_bf16 v39, v54, v54
  v_dot2c_f32_bf16 v36, v47, v34
  v_dot2c_f32_bf16 v37, v47, v47
  v_dot2c_f32_bf16 v38, v55, v34
  v_dot2c_f32_bf16 v39, v55, v55
  v_dot2c_f32_bf16 v36, v48, v34
  v_dot2c_f32_bf16 v37, v48, v48
  v_dot2c_f32_bf16 v38, v56, v34
  v_dot2c_f32_bf16 v39, v56, v56
  v_dot2c_f32_bf16 v36, v49, v34
  v_dot2c_f32_bf16 v37, v49, v49
  v_dot2c_f32_bf16 v38, v57, v34
  v_dot2c_f32_bf16 v39, v57, v57
  v_dot2c_f32_bf16 v36, v50, v34
  v_dot2c_f32_bf16 v37, v50, v50
  v_dot2c_f32_bf16 v38, v58, v34
  v_dot2c_f32_bf16 v39, v58, v58
  v_dot2c_f32_bf16 v36, v51, v34
  v_dot2c_f32_bf16 v37, v51, v51
  v_dot2c_f32_bf16 v38, v59, v34
  v_dot2c_f32_bf16 v39, v59, v59
  s_waitcnt vmcnt(3)
  v_dot2c_f32_bf16 v36, v92, v34
  v_dot2c_f32_bf16 v37, v92, v92
  v_dot2c_f32_bf16 v38, v100, v34
  v_dot2c_f32_bf16 v39, v100, v100
  v_dot2c_f32_bf16 v36, v93, v34
  v_dot2c_f32_bf16 v37, v93, v93
  v_dot2c_f32_bf16 v38, v101, v34
  v_dot2c_f32_bf16 v39, v101, v101
  v_dot2c_f32_bf16 v36, v94, v34
  v_dot2c_f32_bf16 v37, v94, v94
  v_dot2c_f32_bf16 v38, v102, v34
  v_dot2c_f32_bf16 v39, v102, v102
  v_dot2c_f32_bf16 v36, v95, v34
  v_dot2c_f32_bf16 v37, v95, v95
  v_dot2c_f32_bf16 v38, v103, v34
  v_dot2c_f32_bf16 v39, v103, v103
  v_dot2c_f32_bf16 v36, v96, v34
  v_dot2c_f32_bf16 v37, v96, v96
  v_dot2c_f32_bf16 v38, v104, v34
  v_dot2c_f32_bf16 v39, v104, v104
  v_dot2c_f32_bf16 v36, v97, v34
  v_dot2c_f32_bf16 v37, v97, v97
  v_dot2c_f32_bf16 v38, v105, v34
  v_dot2c_f32_bf16 v39, v105, v105
  v_dot2c_f32_bf16 v36, v98, v34
  v_dot2c_f32_bf16 v37, v98, v98
  v_dot2c_f32_bf16 v38, v106, v34
  v_dot2c_f32_bf16 v39, v106, v106
  v_dot2c_f32_bf16 v36, v99, v34
  v_dot2c_f32_bf16 v37, v99, v99
  v_dot2c_f32_bf16 v38, v107, v34
  v_dot2c_f32_bf16 v39, v107, v107
  s_nop 2
  v_add_f32_dpp v36, v36, v36 row_ror:8 row_mask:0xf bank_mask:0xf
  v_add_f32_dpp v37, v37, v37 row_ror:8 row_mask:0xf bank_mask:0xf
  v_add_f32_dpp v38, v38, v38 row_ror:8 row_mask:0xf bank_mask:0xf
  v_add_f32_dpp v39, v39, v39 row_ror:8 row_mask:0xf bank_mask:0xf
  v_mov_b32 v40, v36
  v_mov_b32 v41, v37
  v_mov_b32 v42, v38
  v_mov_b32 v43, v39
  v_permlane16_swap_b32 v36, v40
  v_permlane16_swap_b32 v37, v41
  v_permlane16_swap_b32 v38, v42
  v_permlane16_swap_b32 v39, v43
  v_add_f32 v36, v36, v40
  v_add_f32 v37, v37, v41
  v_add_f32 v38, v38, v42
  v_add_f32 v39, v39, v43
  v_mov_b32 v40, v36
  v_mov_b32 v41, v37
  v_mov_b32 v42, v38
  v_mov_b32 v43, v39
  v_permlane32_swap_b32 v36, v40
  v_permlane32_swap_b32 v37, v41
  v_permlane32_swap_b32 v38, v42
  v_permlane32_swap_b32 v39, v43
  v_add_f32 v36, v36, v40
  v_add_f32 v37, v37, v41
  v_add_f32 v38, v38, v42
  v_add_f32 v39, v39, v43
  ds_write_b128 v30, v[36:39]
  v_lshlrev_b32 v60, 16, v44
  v_and_b32 v61, 0xffff0000, v44
  v_lshlrev_b32 v62, 16, v45
  v_and_b32 v63, 0xffff0000, v45
  v_lshlrev_b32 v64, 16, v46
  v_and_b32 v65, 0xffff0000, v46
  v_lshlrev_b32 v66, 16, v47
  v_and_b32 v67, 0xffff0000, v47
  v_lshlrev_b32 v68, 16, v48
  v_and_b32 v69, 0xffff0000, v48
  v_lshlrev_b32 v70, 16, v49
  v_and_b32 v71, 0xffff0000, v49
  v_lshlrev_b32 v72, 16, v50
  v_and_b32 v73, 0xffff0000, v50
  v_lshlrev_b32 v74, 16, v51
  v_and_b32 v75, 0xffff0000, v51
  v_lshlrev_b32 v76, 16, v52
  v_and_b32 v77, 0xffff0000, v52
  v_lshlrev_b32 v78, 16, v53
  v_and_b32 v79, 0xffff0000, v53
  v_lshlrev_b32 v80, 16, v54
  v_and_b32 v81, 0xffff0000, v54
  v_lshlrev_b32 v82, 16, v55
  v_and_b32 v83, 0xffff0000, v55
  v_lshlrev_b32 v84, 16, v56
  v_and_b32 v85, 0xffff0000, v56
  v_lshlrev_b32 v86, 16, v57
  v_and_b32 v87, 0xffff0000, v57
  v_lshlrev_b32 v88, 16, v58
  v_and_b32 v89, 0xffff0000, v58
  v_lshlrev_b32 v90, 16, v59
  v_and_b32 v91, 0xffff0000, v59
  s_waitcnt lgkmcnt(0)
  s_barrier
  ds_read_b128 v[92:95], v31 offset:0
  ds_read_b128 v[96:99], v31 offset:16
  ds_read_b128 v[100:103], v31 offset:32
  ds_read_b128 v[104:107], v31 offset:48
  v_permlane16_swap_b32 v44, v46
  v_permlane16_swap_b32 v45, v47
  v_permlane16_swap_b32 v48, v50
  v_permlane16_swap_b32 v49, v51
  v_permlane16_swap_b32 v52, v54
  v_permlane16_swap_b32 v53, v55
  v_permlane16_swap_b32 v56, v58
  v_permlane16_swap_b32 v57, v59
  v_bfe_u32 v36, v0, 3, 1
  v_lshlrev_b32 v28, 9, v36
  v_bfe_u32 v36, v0, 4, 1
  v_lshl_add_u32 v28, v36, 8, v28
  v_lshrrev_b32 v34, 5, v0
  v_lshl_add_u32 v28, v34, 10, v28
  v_lshl_add_u32 v28, v21, 4, v28
  v_and_b32 v29, 31, v0
  v_lshlrev_b32 v29, 4, v29
  v_lshl_add_u32 v29, v34, 12, v29
  v_cvt_f32_u32 v34, v34
  s_add_u32 s53, s45, 151552
  v_add_u32 v32, s53, v1
  v_lshl_add_u32 v33, v22, 5, s53
  v_lshlrev_b32 v36, 14, v36
  v_and_b32 v35, 15, v0
  v_lshl_add_u32 v35, v35, 7, v36
  s_waitcnt lgkmcnt(0)
  v_add_f32 v92, v92, v100
  v_add_f32 v93, v93, v101
  v_add_f32 v94, v94, v102
  v_add_f32 v95, v95, v103
  v_add_f32 v96, v96, v104
  v_add_f32 v97, v97, v105
  v_add_f32 v98, v98, v106
  v_add_f32 v99, v99, v107
  v_add_f32 v92, v92, v96
  v_add_f32 v93, v93, v97
  v_add_f32 v94, v94, v98
  v_add_f32 v95, v95, v99
  v_mul_f32 v92, 0x3a800000, v92
  v_mul_f32 v94, 0x3a800000, v94
  v_mul_f32 v93, 0x3a800000, v93
  v_mul_f32 v95, 0x3a800000, v95
  v_fma_f32 v93, -v92, v92, v93
  v_fma_f32 v95, -v94, v94, v95
  v_max_f32 v93, 0, v93
  v_max_f32 v95, 0, v95
  v_cvt_pk_bf16_f32 v93, v93, v93
  v_cvt_pk_bf16_f32 v95, v95, v95
  v_lshlrev_b32 v93, 16, v93
  v_lshlrev_b32 v95, 16, v95
  v_add_f32 v93, 0x3727c5ac, v93
  v_add_f32 v95, 0x3727c5ac, v95
  v_cvt_pk_bf16_f32 v93, v93, v93
  v_cvt_pk_bf16_f32 v95, v95, v95
  v_lshlrev_b32 v93, 16, v93
  v_lshlrev_b32 v95, 16, v95
  v_sqrt_f32 v93, v93
  v_sqrt_f32 v95, v95
  v_cvt_pk_bf16_f32 v92, v92, v92
  v_cvt_pk_bf16_f32 v94, v94, v94
  v_lshlrev_b32 v92, 16, v92
  v_lshlrev_b32 v94, 16, v94
  v_cvt_pk_bf16_f32 v93, v93, v93
  v_cvt_pk_bf16_f32 v95, v95, v95
  v_lshlrev_b32 v93, 16, v93
  v_lshlrev_b32 v95, 16, v95
  v_rcp_f32 v93, v93
  v_rcp_f32 v95, v95
  v_mul_f32 v92, v92, v93
  v_mul_f32 v94, v94, v95
  v_fma_f32 v60, v60, v93, -v92
  v_fma_f32 v61, v61, v93, -v92
  v_fma_f32 v62, v62, v93, -v92
  v_fma_f32 v63, v63, v93, -v92
  v_fma_f32 v64, v64, v93, -v92
  v_fma_f32 v65, v65, v93, -v92
  v_fma_f32 v66, v66, v93, -v92
  v_fma_f32 v67, v67, v93, -v92
  v_fma_f32 v68, v68, v93, -v92
  v_fma_f32 v69, v69, v93, -v92
  v_fma_f32 v70, v70, v93, -v92
  v_fma_f32 v71, v71, v93, -v92
  v_fma_f32 v72, v72, v93, -v92
  v_fma_f32 v73, v73, v93, -v92
  v_fma_f32 v74, v74, v93, -v92
  v_fma_f32 v75, v75, v93, -v92
  v_fma_f32 v76, v76, v95, -v94
  v_fma_f32 v77, v77, v95, -v94
  v_fma_f32 v78, v78, v95, -v94
  v_fma_f32 v79, v79, v95, -v94
  v_fma_f32 v80, v80, v95, -v94
  v_fma_f32 v81, v81, v95, -v94
  v_fma_f32 v82, v82, v95, -v94
  v_fma_f32 v83, v83, v95, -v94
  v_fma_f32 v84, v84, v95, -v94
  v_fma_f32 v85, v85, v95, -v94
  v_fma_f32 v86, v86, v95, -v94
  v_fma_f32 v87, v87, v95, -v94
  v_fma_f32 v88, v88, v95, -v94
  v_fma_f32 v89, v89, v95, -v94
  v_fma_f32 v90, v90, v95, -v94
  v_fma_f32 v91, v91, v95, -v94
  s_waitcnt vmcnt(13)
  v_lshlrev_b32 v15, 16, v23
  v_mul_f32 v16, 0xbfb8aa3b, v15
  v_exp_f32 v16, v16
  v_lshrrev_b32 v21, 5, v0
  v_add_f32 v16, 1.0, v16
  v_rcp_f32 v16, v16
  v_lshlrev_b32 v21, 6, v21
  v_mul_f32 v15, v15, v16
  v_cvt_pk_bf16_f32 v16, v15, v15
  v_bfe_u32 v15, v0, 2, 2
  v_lshl_add_u32 v21, v15, 4, v21
  v_bfe_u32 v15, v0, 4, 1
  v_lshl_add_u32 v21, v15, 3, v21
  v_and_b32 v15, 3, v0
  v_lshl_add_u32 v21, v15, 1, v21
  s_lshl_b32 s53, s44, 7
  s_add_u32 s53, s53, 149504
  v_add_u32 v21, s53, v21
  s_mov_b64 exec, 0
  s_cmp_eq_u32 s44, 0
  s_cbranch_scc1 HOP0
  s_cmp_eq_u32 s44, 1
  s_cbranch_scc1 HOP1
  s_cmp_eq_u32 s44, 2
  s_cbranch_scc1 HOP2
  s_cmp_eq_u32 s44, 3
  s_cbranch_scc1 HOP3
WRET0:
  s_mov_b64 exec, -1
  buffer_load_dword v36, v35, s[8:11], s35 offen sc1
  s_waitcnt vmcnt(0)
  v_cmp_ne_u32 vcc, s46, v36
  s_nop 4
  s_cbranch_vccz PL2_adaLN_cond__sliding_local_dilated__swiglu_ffn__prompt_kernelx
  s_mov_b32 s57, 60000
PL2_adaLN_cond__sliding_local_dilated__swiglu_ffn__prompt_kernel:
  buffer_load_dword v36, v35, s[8:11], s35 offen sc1
  s_sub_u32 s57, s57, 1
  s_cmp_eq_u32 s57, 0
  s_waitcnt vmcnt(0)
  s_cbranch_scc1 PL2_adaLN_cond__sliding_local_dilated__swiglu_ffn__prompt_kernelx
  v_cmp_ne_u32 vcc, s46, v36
  s_nop 4
  s_cbranch_vccnz PL2_adaLN_cond__sliding_local_dilated__swiglu_ffn__prompt_kernel
PL2_adaLN_cond__sliding_local_dilated__swiglu_ffn__prompt_kernelx:
  buffer_load_dwordx4 v[92:95], v29, s[8:11], s34 offen sc1
  s_add_u32 s34, s34, 8192
  buffer_load_dwordx4 v[96:99], v29, s[8:11], s34 offen sc1
  s_add_u32 s34, s34, 8192
  buffer_load_dwordx4 v[100:103], v29, s[8:11], s34 offen sc1
  s_add_u32 s34, s34, 8192
  buffer_load_dwordx4 v[104:107], v29, s[8:11], s34 offen sc1
  s_add_u32 s34, s34, 8192
  buffer_load_dwordx4 v[108:111], v29, s[8:11], s34 offen sc1
  s_add_u32 s34, s34, 8192
  buffer_load_dwordx4 v[112:115], v29, s[8:11], s34 offen sc1
  s_add_u32 s34, s34, 8192
  buffer_load_dwordx4 v[116:119], v29, s[8:11], s34 offen sc1
  s_add_u32 s34, s34, 8192
  buffer_load_dwordx4 v[120:123], v29, s[8:11], s34 offen sc1
  s_add_u32 m0, s45, 0
  s_add_u32 s68, s66, 0
  s_and_b32 s68, s68, 7
  s_mul_i32 s68, s68, 786432
  buffer_load_dwordx4 v9, s[12:15], s68 offen lds
  s_add_u32 m0, s45, 4096
  s_add_u32 s68, s68, 196608
  buffer_load_dwordx4 v9, s[12:15], s68 offen lds
  s_add_u32 m0, s45, 8192
  s_add_u32 s68, s68, 196608
  buffer_load_dwordx4 v9, s[12:15], s68 offen lds
  s_add_u32 m0, s45, 12288
  s_add_u32 s68, s68, 196608
  buffer_load_dwordx4 v9, s[12:15], s68 offen lds
  s_add_u32 m0, s45, 16384
  s_add_u32 s68, s66, 1
  s_and_b32 s68, s68, 7
  s_mul_i32 s68, s68, 786432
  buffer_load_dwordx4 v9, s[12:15], s68 offen lds
  s_add_u32 m0, s45, 20480
  s_add_u32 s68, s68, 196608
  buffer_load_dwordx4 v9, s[12:15], s68 offen lds
  s_add_u32 m0, s45, 24576
  s_add_u32 s68, s68, 196608
  buffer_load_dwordx4 v9, s[12:15], s68 offen lds
  s_add_u32 m0, s45, 28672
  s_add_u32 s68, s68, 196608
  buffer_load_dwordx4 v9, s[12:15], s68 offen lds
  s_waitcnt vmcnt(14)
  v_pk_add_f32 v[92:93], v[92:93], v[96:97]
  v_pk_add_f32 v[94:95], v[94:95], v[98:99]
  s_waitcnt vmcnt(13)
  v_pk_add_f32 v[92:93], v[92:93], v[100:101]
  v_pk_add_f32 v[94:95], v[94:95], v[102:103]
  s_waitcnt vmcnt(12)
  v_pk_add_f32 v[92:93], v[92:93], v[104:105]
  v_pk_add_f32 v[94:95], v[94:95], v[106:107]
  s_waitcnt vmcnt(11)
  v_pk_add_f32 v[92:93], v[92:93], v[108:109]
  v_pk_add_f32 v[94:95], v[94:95], v[110:111]
  s_waitcnt vmcnt(10)
  v_pk_add_f32 v[92:93], v[92:93], v[112:113]
  v_pk_add_f32 v[94:95], v[94:95], v[114:115]
  s_waitcnt vmcnt(9)
  v_pk_add_f32 v[92:93], v[92:93], v[116:117]
  v_pk_add_f32 v[94:95], v[94:95], v[118:119]
  s_waitcnt vmcnt(8)
  v_pk_add_f32 v[92:93], v[92:93], v[120:121]
  v_pk_add_f32 v[94:95], v[94:95], v[122:123]
  v_cvt_pk_bf16_f32 v96, v92, v93
  v_cvt_pk_bf16_f32 v97, v94, v95
  v_lshlrev_b32 v92, 16, v96
  v_and_b32 v93, 0xffff0000, v96
  v_lshlrev_b32 v94, 16, v97
  v_and_b32 v95, 0xffff0000, v97
  v_add_f32 v92, v34, v92
  v_add_f32 v93, v34, v93
  v_add_f32 v94, v34, v94
  v_add_f32 v95, v34, v95
  v_cvt_pk_bf16_f32 v96, v92, v93
  v_cvt_pk_bf16_f32 v97, v94, v95
  v_lshlrev_b32 v92, 16, v96
  v_and_b32 v93, 0xffff0000, v96
  v_lshlrev_b32 v94, 16, v97
  v_and_b32 v95, 0xffff0000, v97
  ds_write_b128 v32, v[92:95]
  ds_read_b128 v[92:95], v33 offset:512
  ds_read_b128 v[108:111], v33 offset:0
  ds_read_b128 v[96:99], v33 offset:528
  ds_read_b128 v[112:115], v33 offset:16
  ds_read_b128 v[100:103], v33 offset:768
  ds_read_b128 v[116:119], v33 offset:256
  ds_read_b128 v[104:107], v33 offset:784
  ds_read_b128 v[120:123], v33 offset:272
  s_waitcnt lgkmcnt(4)
  v_pk_fma_f32 v[60:61], v[60:61], v[92:93], v[108:109]
  v_pk_fma_f32 v[62:63], v[62:63], v[94:95], v[110:111]
  v_pk_fma_f32 v[64:65], v[64:65], v[96:97], v[112:113]
  v_pk_fma_f32 v[66:67], v[66:67], v[98:99], v[114:115]
  v_pk_fma_f32 v[76:77], v[76:77], v[92:93], v[108:109]
  v_pk_fma_f32 v[78:79], v[78:79], v[94:95], v[110:111]
  v_pk_fma_f32 v[80:81], v[80:81], v[96:97], v[112:113]
  v_pk_fma_f32 v[82:83], v[82:83], v[98:99], v[114:115]
  v_cvt_pk_bf16_f32 v60, v60, v61
  v_cvt_pk_bf16_f32 v61, v62, v63
  v_cvt_pk_bf16_f32 v62, v64, v65
  v_cvt_pk_bf16_f32 v63, v66, v67
  v_cvt_pk_bf16_f32 v76, v76, v77
  v_cvt_pk_bf16_f32 v77, v78, v79
  v_cvt_pk_bf16_f32 v78, v80, v81
  v_cvt_pk_bf16_f32 v79, v82, v83
  v_permlane16_swap_b32 v60, v62
  v_permlane16_swap_b32 v61, v63
  buffer_store_dwordx4 v[60:63], v28, s[8:11], s38 offen offset:0 sc1
  v_permlane16_swap_b32 v76, v78
  v_permlane16_swap_b32 v77, v79
  buffer_store_dwordx4 v[76:79], v28, s[8:11], s38 offen offset:128 sc1
  s_waitcnt lgkmcnt(0)
  v_pk_fma_f32 v[68:69], v[68:69], v[100:101], v[116:117]
  v_pk_fma_f32 v[70:71], v[70:71], v[102:103], v[118:119]
  v_pk_fma_f32 v[72:73], v[72:73], v[104:105], v[120:121]
  v_pk_fma_f32 v[74:75], v[74:75], v[106:107], v[122:123]
  v_pk_fma_f32 v[84:85], v[84:85], v[100:101], v[116:117]
  v_pk_fma_f32 v[86:87], v[86:87], v[102:103], v[118:119]
  v_pk_fma_f32 v[88:89], v[88:89], v[104:105], v[120:121]
  v_pk_fma_f32 v[90:91], v[90:91], v[106:107], v[122:123]
  v_cvt_pk_bf16_f32 v68, v68, v69
  v_cvt_pk_bf16_f32 v69, v70, v71
  v_cvt_pk_bf16_f32 v70, v72, v73
  v_cvt_pk_bf16_f32 v71, v74, v75
  v_cvt_pk_bf16_f32 v84, v84, v85
  v_cvt_pk_bf16_f32 v85, v86, v87
  v_cvt_pk_bf16_f32 v86, v88, v89
  v_cvt_pk_bf16_f32 v87, v90, v91
  v_permlane16_swap_b32 v68, v70
  v_permlane16_swap_b32 v69, v71
  buffer_store_dwordx4 v[68:71], v28, s[8:11], s38 offen offset:2048 sc1
  v_permlane16_swap_b32 v84, v86
  v_permlane16_swap_b32 v85, v87
  buffer_store_dwordx4 v[84:87], v28, s[8:11], s38 offen offset:2176 sc1
HOP0:
  s_cbranch_execz HOP4
  buffer_store_dwordx4 v[44:47], v28, s[8:11], s39 offen offset:0 sc1
  buffer_store_dwordx4 v[48:51], v28, s[8:11], s39 offen offset:2048 sc1
  buffer_store_dwordx4 v[52:55], v28, s[8:11], s39 offen offset:128 sc1
  buffer_store_dwordx4 v[56:59], v28, s[8:11], s39 offen offset:2176 sc1
  s_add_u32 m0, s45, 32768
  s_add_u32 s68, s66, 0
  s_and_b32 s68, s68, 7
  s_mul_i32 s68, s68, 786432
  s_add_u32 s68, s68, 2048
  buffer_load_dwordx4 v9, s[12:15], s68 offen lds
  s_add_u32 m0, s45, 36864
  s_add_u32 s68, s68, 196608
  buffer_load_dwordx4 v9, s[12:15], s68 offen lds
  s_add_u32 m0, s45, 40960
  s_add_u32 s68, s68, 196608
  buffer_load_dwordx4 v9, s[12:15], s68 offen lds
  s_add_u32 m0, s45, 45056
  s_add_u32 s68, s68, 196608
  buffer_load_dwordx4 v9, s[12:15], s68 offen lds
  s_add_u32 m0, s45, 49152
  s_add_u32 s68, s66, 0
  s_and_b32 s68, s68, 7
  s_mul_i32 s68, s68, 786432
  s_add_u32 s68, s68, 4096
  buffer_load_dwordx4 v9, s[12:15], s68 offen lds
  s_add_u32 m0, s45, 53248
  s_add_u32 s68, s68, 196608
  buffer_load_dwordx4 v9, s[12:15], s68 offen lds
  s_add_u32 m0, s45, 57344
  s_add_u32 s68, s68, 196608
  buffer_load_dwordx4 v9, s[12:15], s68 offen lds
  s_add_u32 m0, s45, 61440
  s_add_u32 s68, s68, 196608
  buffer_load_dwordx4 v9, s[12:15], s68 offen lds
  v_add_u32 v15, s46, v0
  s_waitcnt vmcnt(12)
  s_barrier
  s_mov_b64 exec, 1
  buffer_store_dword v15, v0, s[8:11], s75 offen offset:0 sc1
  s_mov_b64 exec, -1
  s_waitcnt vmcnt(17) lgkmcnt(0)
  s_barrier
  s_add_u32 m0, s45, 65536
  s_add_u32 s68, s66, 1
  s_and_b32 s68, s68, 7
  s_mul_i32 s68, s68, 786432
  s_add_u32 s68, s68, 2048
  buffer_load_dwordx4 v9, s[12:15], s68 offen lds
  ds_read_b64_tr_b16 a[0:1], v3 offset:0
  ds_read_b64_tr_b16 a[2:3], v3 offset:2048
  s_add_u32 m0, s45, 69632
  s_add_u32 s68, s68, 196608
  buffer_load_dwordx4 v9, s[12:15], s68 offen lds
  ds_read_b64_tr_b16 a[12:13], v3 offset:4096
  ds_read_b64_tr_b16 a[14:15], v3 offset:6144
  s_add_u32 m0, s45, 73728
  s_add_u32 s68, s68, 196608
  buffer_load_dwordx4 v9, s[12:15], s68 offen lds
  ds_read_b64_tr_b16 a[24:25], v3 offset:8192
  ds_read_b64_tr_b16 a[26:27], v3 offset:10240
  s_add_u32 m0, s45, 77824
  s_add_u32 s68, s68, 196608
  buffer_load_dwordx4 v9, s[12:15], s68 offen lds
  ds_read_b64_tr_b16 a[36:37], v3 offset:12288
  ds_read_b64_tr_b16 a[38:39], v3 offset:14336
  s_add_u32 m0, s45, 81920
  s_add_u32 s68, s66, 1
  s_and_b32 s68, s68, 7
  s_mul_i32 s68, s68, 786432
  s_add_u32 s68, s68, 4096
  buffer_load_dwordx4 v9, s[12:15], s68 offen lds
  ds_read_b64_tr_b16 a[48:49], v3 offset:16384
  ds_read_b64_tr_b16 a[50:51], v3 offset:18432
  s_add_u32 m0, s45, 86016
  s_add_u32 s68, s68, 196608
  buffer_load_dwordx4 v9, s[12:15], s68 offen lds
  ds_read_b64_tr_b16 a[60:61], v3 offset:20480
  ds_read_b64_tr_b16 a[62:63], v3 offset:22528
  s_add_u32 m0, s45, 90112
  s_add_u32 s68, s68, 196608
  buffer_load_dwordx4 v9, s[12:15], s68 offen lds
  ds_read_b64_tr_b16 a[72:73], v3 offset:24576
  ds_read_b64_tr_b16 a[74:75], v3 offset:26624
  s_add_u32 m0, s45, 94208
  s_add_u32 s68, s68, 196608
  buffer_load_dwordx4 v9, s[12:15], s68 offen lds
  ds_read_b64_tr_b16 a[84:85], v3 offset:28672
  ds_read_b64_tr_b16 a[86:87], v3 offset:30720
  s_add_u32 m0, s45, 98304
  s_add_u32 s68, s66, 2
  s_and_b32 s68, s68, 7
  s_mul_i32 s68, s68, 786432
  buffer_load_dwordx4 v9, s[12:15], s68 offen lds
  s_add_u32 m0, s45, 102400
  s_add_u32 s68, s68, 196608
  buffer_load_dwordx4 v9, s[12:15], s68 offen lds
  s_add_u32 m0, s45, 106496
  s_add_u32 s68, s68, 196608
  buffer_load_dwordx4 v9, s[12:15], s68 offen lds
  s_add_u32 m0, s45, 110592
  s_add_u32 s68, s68, 196608
  buffer_load_dwordx4 v9, s[12:15], s68 offen lds
  s_add_u32 m0, s45, 114688
  s_add_u32 s68, s66, 3
  s_and_b32 s68, s68, 7
  s_mul_i32 s68, s68, 786432
  buffer_load_dwordx4 v9, s[12:15], s68 offen lds
  s_add_u32 m0, s45, 118784
  s_add_u32 s68, s68, 196608
  buffer_load_dwordx4 v9, s[12:15], s68 offen lds
  s_add_u32 m0, s45, 122880
  s_add_u32 s68, s68, 196608
  buffer_load_dwordx4 v9, s[12:15], s68 offen lds
  s_add_u32 m0, s45, 126976
  s_add_u32 s68, s68, 196608
  buffer_load_dwordx4 v9, s[12:15], s68 offen lds
  s_waitcnt vmcnt(17) lgkmcnt(0)
  s_barrier
  s_add_u32 m0, s45, 0
  s_add_u32 s68, s66, 2
  s_and_b32 s68, s68, 7
  s_mul_i32 s68, s68, 786432
  s_add_u32 s68, s68, 2048
  buffer_load_dwordx4 v9, s[12:15], s68 offen lds
  ds_read_b64_tr_b16 a[4:5], v4 offset:32768
  ds_read_b64_tr_b16 a[6:7], v4 offset:34816
  s_add_u32 m0, s45, 4096
  s_add_u32 s68, s68, 196608
  buffer_load_dwordx4 v9, s[12:15], s68 offen lds
  ds_read_b64_tr_b16 a[8:9], v5 offset:32768
  ds_read_b64_tr_b16 a[10:11], v5 offset:34816
  s_add_u32 m0, s45, 8192
  s_add_u32 s68, s68, 196608
  buffer_load_dwordx4 v9, s[12:15], s68 offen lds
  ds_read_b64_tr_b16 a[16:17], v4 offset:36864
  ds_read_b64_tr_b16 a[18:19], v4 offset:38912
  s_add_u32 m0, s45, 12288
  s_add_u32 s68, s68, 196608
  buffer_load_dwordx4 v9, s[12:15], s68 offen lds
  ds_read_b64_tr_b16 a[20:21], v5 offset:36864
  ds_read_b64_tr_b16 a[22:23], v5 offset:38912
  s_add_u32 m0, s45, 16384
  s_add_u32 s68, s66, 2
  s_and_b32 s68, s68, 7
  s_mul_i32 s68, s68, 786432
  s_add_u32 s68, s68, 4096
  buffer_load_dwordx4 v9, s[12:15], s68 offen lds
  ds_read_b64_tr_b16 a[28:29], v4 offset:40960
  ds_read_b64_tr_b16 a[30:31], v4 offset:43008
  s_add_u32 m0, s45, 20480
  s_add_u32 s68, s68, 196608
  buffer_load_dwordx4 v9, s[12:15], s68 offen lds
  ds_read_b64_tr_b16 a[32:33], v5 offset:40960
  ds_read_b64_tr_b16 a[34:35], v5 offset:43008
  s_add_u32 m0, s45, 24576
  s_add_u32 s68, s68, 196608
  buffer_load_dwordx4 v9, s[12:15], s68 offen lds
  ds_read_b64_tr_b16 a[40:41], v4 offset:45056
  ds_read_b64_tr_b16 a[42:43], v4 offset:47104
  s_add_u32 m0, s45, 28672
  s_add_u32 s68, s68, 196608
  buffer_load_dwordx4 v9, s[12:15], s68 offen lds
  ds_read_b64_tr_b16 a[44:45], v5 offset:45056
  ds_read_b64_tr_b16 a[46:47], v5 offset:47104
  s_waitcnt vmcnt(16) lgkmcnt(0)
  s_barrier
  s_add_u32 m0, s45, 32768
  s_add_u32 s68, s66, 3
  s_and_b32 s68, s68, 7
  s_mul_i32 s68, s68, 786432
  s_add_u32 s68, s68, 2048
  buffer_load_dwordx4 v9, s[12:15], s68 offen lds
  ds_read_b64_tr_b16 a[52:53], v7 offset:0
  ds_read_b64_tr_b16 a[54:55], v7 offset:2048
  s_add_u32 m0, s45, 36864
  s_add_u32 s68, s68, 196608
  buffer_load_dwordx4 v9, s[12:15], s68 offen lds
  ds_read_b64_tr_b16 a[56:57], v8 offset:0
  ds_read_b64_tr_b16 a[58:59], v8 offset:2048
  s_add_u32 m0, s45, 40960
  s_add_u32 s68, s68, 196608
  buffer_load_dwordx4 v9, s[12:15], s68 offen lds
  ds_read_b64_tr_b16 a[64:65], v7 offset:4096
  ds_read_b64_tr_b16 a[66:67], v7 offset:6144
  s_add_u32 m0, s45, 45056
  s_add_u32 s68, s68, 196608
  buffer_load_dwordx4 v9, s[12:15], s68 offen lds
  ds_read_b64_tr_b16 a[68:69], v8 offset:4096
  ds_read_b64_tr_b16 a[70:71], v8 offset:6144
  s_add_u32 m0, s45, 49152
  s_add_u32 s68, s66, 3
  s_and_b32 s68, s68, 7
  s_mul_i32 s68, s68, 786432
  s_add_u32 s68, s68, 4096
  buffer_load_dwordx4 v9, s[12:15], s68 offen lds
  ds_read_b64_tr_b16 a[76:77], v7 offset:8192
  ds_read_b64_tr_b16 a[78:79], v7 offset:10240
  s_add_u32 m0, s45, 53248
  s_add_u32 s68, s68, 196608
  buffer_load_dwordx4 v9, s[12:15], s68 offen lds
  ds_read_b64_tr_b16 a[80:81], v8 offset:8192
  ds_read_b64_tr_b16 a[82:83], v8 offset:10240
  s_add_u32 m0, s45, 57344
  s_add_u32 s68, s68, 196608
  buffer_load_dwordx4 v9, s[12:15], s68 offen lds
  ds_read_b64_tr_b16 a[88:89], v7 offset:12288
  ds_read_b64_tr_b16 a[90:91], v7 offset:14336
  s_add_u32 m0, s45, 61440
  s_add_u32 s68, s68, 196608
  buffer_load_dwordx4 v9, s[12:15], s68 offen lds
  ds_read_b64_tr_b16 a[92:93], v8 offset:12288
  ds_read_b64_tr_b16 a[94:95], v8 offset:14336
  s_cmp_lg_u32 s44, 0
  s_cbranch_scc1 PI3_adaLN_cond__sliding_local_dilated__swiglu_ffn__prompt_kernel
  buffer_load_dword v36, v14, s[8:11], 0 offen sc1
PI3_adaLN_cond__sliding_local_dilated__swiglu_ffn__prompt_kernel:
  s_waitcnt vmcnt(16) lgkmcnt(0)
  s_barrier
  s_add_u32 m0, s45, 65536
  s_add_u32 s68, s66, 4
  s_and_b32 s68, s68, 7
  s_mul_i32 s68, s68, 786432
  buffer_load_dwordx4 v9, s[12:15], s68 offen lds
  ds_read_b64_tr_b16 a[96:97], v6 offset:32768
  ds_read_b64_tr_b16 a[98:99], v6 offset:34816
  s_add_u32 m0, s45, 69632
  s_add_u32 s68, s68, 196608
  buffer_load_dwordx4 v9, s[12:15], s68 offen lds
  ds_read_b64_tr_b16 a[108:109], v6 offset:36864
  ds_read_b64_tr_b16 a[110:111], v6 offset:38912
  s_add_u32 m0, s45, 73728
  s_add_u32 s68, s68, 196608
  buffer_load_dwordx4 v9, s[12:15], s68 offen lds
  ds_read_b64_tr_b16 a[120:121], v6 offset:40960
  ds_read_b64_tr_b16 a[122:123], v6 offset:43008
  s_add_u32 m0, s45, 77824
  s_add_u32 s68, s68, 196608
  buffer_load_dwordx4 v9, s[12:15], s68 offen lds
  ds_read_b64_tr_b16 a[132:133], v6 offset:45056
  ds_read_b64_tr_b16 a[134:135], v6 offset:47104
  s_add_u32 m0, s45, 81920
  s_add_u32 s68, s66, 5
  s_and_b32 s68, s68, 7
  s_mul_i32 s68, s68, 786432
  buffer_load_dwordx4 v9, s[12:15], s68 offen lds
  ds_read_b64_tr_b16 a[144:145], v6 offset:49152
  ds_read_b64_tr_b16 a[146:147], v6 offset:51200
  s_add_u32 m0, s45, 86016
  s_add_u32 s68, s68, 196608
  buffer_load_dwordx4 v9, s[12:15], s68 offen lds
  ds_read_b64_tr_b16 a[156:157], v6 offset:53248
  ds_read_b64_tr_b16 a[158:159], v6 offset:55296
  s_add_u32 m0, s45, 90112
  s_add_u32 s68, s68, 196608
  buffer_load_dwordx4 v9, s[12:15], s68 offen lds
  ds_read_b64_tr_b16 a[168:169], v6 offset:57344
  ds_read_b64_tr_b16 a[170:171], v6 offset:59392
  s_add_u32 m0, s45, 94208
  s_add_u32 s68, s68, 196608
  buffer_load_dwordx4 v9, s[12:15], s68 offen lds
  ds_read_b64_tr_b16 a[180:181], v6 offset:61440
  ds_read_b64_tr_b16 a[182:183], v6 offset:63488
  s_waitcnt vmcnt(16) lgkmcnt(0)
  s_barrier
  ds_read_b64_tr_b16 a[100:101], v4 offset:0
  ds_read_b64_tr_b16 a[102:103], v4 offset:2048
  ds_read_b64_tr_b16 a[104:105], v5 offset:0
  ds_read_b64_tr_b16 a[106:107], v5 offset:2048
  ds_read_b64_tr_b16 a[112:113], v4 offset:4096
  ds_read_b64_tr_b16 a[114:115], v4 offset:6144
  ds_read_b64_tr_b16 a[116:117], v5 offset:4096
  ds_read_b64_tr_b16 a[118:119], v5 offset:6144
  ds_read_b64_tr_b16 a[124:125], v4 offset:8192
  ds_read_b64_tr_b16 a[126:127], v4 offset:10240
  ds_read_b64_tr_b16 a[128:129], v5 offset:8192
  ds_read_b64_tr_b16 a[130:131], v5 offset:10240
  ds_read_b64_tr_b16 a[136:137], v4 offset:12288
  ds_read_b64_tr_b16 a[138:139], v4 offset:14336
  ds_read_b64_tr_b16 a[140:141], v5 offset:12288
  ds_read_b64_tr_b16 a[142:143], v5 offset:14336
  s_cmp_lg_u32 s44, 0
  s_cbranch_scc1 PL4_adaLN_cond__sliding_local_dilated__swiglu_ffn__prompt_kernelx
  s_waitcnt vmcnt(8)
  v_cmp_ne_u32 vcc, s46, v36
  s_nop 4
  s_cbranch_vccz PL4_adaLN_cond__sliding_local_dilated__swiglu_ffn__prompt_kernelx
  s_mov_b32 s57, 60000
PL4_adaLN_cond__sliding_local_dilated__swiglu_ffn__prompt_kernel:
  buffer_load_dword v36, v14, s[8:11], 0 offen sc1
  s_sub_u32 s57, s57, 1
  s_cmp_eq_u32 s57, 0
  s_waitcnt vmcnt(0)
  s_cbranch_scc1 PL4_adaLN_cond__sliding_local_dilated__swiglu_ffn__prompt_kernelx
  v_cmp_ne_u32 vcc, s46, v36
  s_nop 4
  s_cbranch_vccnz PL4_adaLN_cond__sliding_local_dilated__swiglu_ffn__prompt_kernel
PL4_adaLN_cond__sliding_local_dilated__swiglu_ffn__prompt_kernelx:
  s_barrier
  s_add_u32 m0, s70, 98304
  s_add_u32 s69, s58, 32768
  buffer_load_dwordx4 v12, s[8:11], s69 offen offset:0 sc1 lds
  buffer_load_dwordx4 v12, s[8:11], s69 offen offset:1024 sc1 lds
  buffer_load_dwordx4 v12, s[8:11], s69 offen offset:2048 sc1 lds
  buffer_load_dwordx4 v12, s[8:11], s69 offen offset:3072 sc1 lds
  s_add_u32 m0, s71, 131072
  s_add_u32 s69, s58, s72
  buffer_load_dwordx4 v1, s[8:11], s69 offen offset:0 sc1 lds
  buffer_load_dwordx4 v1, s[8:11], s69 offen offset:1024 sc1 lds
  s_add_u32 m0, s70, 114688
  s_add_u32 s69, s59, 32768
  buffer_load_dwordx4 v12, s[8:11], s69 offen offset:0 sc1 lds
  buffer_load_dwordx4 v12, s[8:11], s69 offen offset:1024 sc1 lds
  buffer_load_dwordx4 v12, s[8:11], s69 offen offset:2048 sc1 lds
  buffer_load_dwordx4 v12, s[8:11], s69 offen offset:3072 sc1 lds
  s_add_u32 m0, s71, 139264
  s_add_u32 s69, s59, s72
  buffer_load_dwordx4 v1, s[8:11], s69 offen offset:0 sc1 lds
  buffer_load_dwordx4 v1, s[8:11], s69 offen offset:1024 sc1 lds
  s_waitcnt vmcnt(20) lgkmcnt(0)
  s_barrier
  s_add_u32 m0, s45, 0
  s_add_u32 s68, s66, 4
  s_and_b32 s68, s68, 7
  s_mul_i32 s68, s68, 786432
  s_add_u32 s68, s68, 2048
  buffer_load_dwordx4 v9, s[12:15], s68 offen lds
  ds_read_b64_tr_b16 a[148:149], v4 offset:32768
  ds_read_b64_tr_b16 a[150:151], v4 offset:34816
  s_add_u32 m0, s45, 4096
  s_add_u32 s68, s68, 196608
  buffer_load_dwordx4 v9, s[12:15], s68 offen lds
  ds_read_b64_tr_b16 a[152:153], v5 offset:32768
  ds_read_b64_tr_b16 a[154:155], v5 offset:34816
  s_add_u32 m0, s45, 8192
  s_add_u32 s68, s68, 196608
  buffer_load_dwordx4 v9, s[12:15], s68 offen lds
  ds_read_b64_tr_b16 a[160:161], v4 offset:36864
  ds_read_b64_tr_b16 a[162:163], v4 offset:38912
  s_add_u32 m0, s45, 12288
  s_add_u32 s68, s68, 196608
  buffer_load_dwordx4 v9, s[12:15], s68 offen lds
  ds_read_b64_tr_b16 a[164:165], v5 offset:36864
  ds_read_b64_tr_b16 a[166:167], v5 offset:38912
  s_add_u32 m0, s45, 16384
  s_add_u32 s68, s66, 4
  s_and_b32 s68, s68, 7
  s_mul_i32 s68, s68, 786432
  s_add_u32 s68, s68, 4096
  buffer_load_dwordx4 v9, s[12:15], s68 offen lds
  ds_read_b64_tr_b16 a[172:173], v4 offset:40960
  ds_read_b64_tr_b16 a[174:175], v4 offset:43008
  s_add_u32 m0, s45, 20480
  s_add_u32 s68, s68, 196608
  buffer_load_dwordx4 v9, s[12:15], s68 offen lds
  ds_read_b64_tr_b16 a[176:177], v5 offset:40960
  ds_read_b64_tr_b16 a[178:179], v5 offset:43008
  s_add_u32 m0, s45, 24576
  s_add_u32 s68, s68, 196608
  buffer_load_dwordx4 v9, s[12:15], s68 offen lds
  ds_read_b64_tr_b16 a[184:185], v4 offset:45056
  ds_read_b64_tr_b16 a[186:187], v4 offset:47104
  s_add_u32 m0, s45, 28672
  s_add_u32 s68, s68, 196608
  buffer_load_dwordx4 v9, s[12:15], s68 offen lds
  ds_read_b64_tr_b16 a[188:189], v5 offset:45056
  ds_read_b64_tr_b16 a[190:191], v5 offset:47104
  s_waitcnt vmcnt(14) lgkmcnt(0)
  s_barrier
  ds_read_b128 v[76:79], v2 offset:32768
  ds_read_b128 v[80:83], v2 offset:33792
  ds_read_b128 v[84:87], v2 offset:40960
  ds_read_b128 v[88:91], v2 offset:41984
  ds_read_b128 v[92:95], v13 offset:0
  ds_read_b128 v[96:99], v13 offset:1024
  ds_read_b128 v[100:103], v2 offset:34816
  ds_read_b128 v[104:107], v2 offset:35840
  s_waitcnt lgkmcnt(2)
  v_mfma_f32_16x16x32_bf16 v[28:31], a[0:3], v[76:79], 0
  ds_read_b64_tr_b16 a[192:193], v6 offset:0
  s_add_u32 m0, s45, 32768
  s_add_u32 s68, s66, 5
  s_and_b32 s68, s68, 7
  s_mul_i32 s68, s68, 786432
  s_add_u32 s68, s68, 2048
  v_mfma_f32_16x16x32_bf16 v[28:31], a[12:15], v[80:83], v[28:31]
  ds_read_b64_tr_b16 a[194:195], v6 offset:2048
  ds_read_b128 v[108:111], v2 offset:43008
  buffer_load_dwordx4 v9, s[12:15], s68 offen lds
  v_mfma_f32_16x16x32_bf16 v[32:35], a[12:15], v[88:91], 0
  ds_read_b64_tr_b16 a[204:205], v6 offset:4096
  v_mfma_f32_16x16x32_bf16 v[32:35], a[0:3], v[84:87], v[32:35]
  ds_read_b64_tr_b16 a[206:207], v6 offset:6144
  v_mfma_f32_16x16x32_bf16 v[40:43], a[4:7], v[84:87], 0
  ds_read_b64_tr_b16 a[216:217], v6 offset:8192
  ds_read_b128 v[112:115], v2 offset:44032
  s_add_u32 m0, s45, 36864
  s_add_u32 s68, s68, 196608
  v_mfma_f32_16x16x32_bf16 v[40:43], a[16:19], v[88:91], v[40:43]
  ds_read_b64_tr_b16 a[218:219], v6 offset:10240
  buffer_load_dwordx4 v9, s[12:15], s68 offen lds
  v_mfma_f32_16x16x32_bf16 v[36:39], a[16:19], v[80:83], 0
  ds_read_b64_tr_b16 a[228:229], v6 offset:12288
  ds_read_b128 v[116:119], v13 offset:2048
  v_mfma_f32_16x16x32_bf16 v[36:39], a[4:7], v[76:79], v[36:39]
  ds_read_b64_tr_b16 a[230:231], v6 offset:14336
  v_mfma_f32_16x16x32_bf16 v[44:47], a[8:11], v[76:79], 0
  ds_read_b64_tr_b16 a[240:241], v6 offset:16384
  s_add_u32 m0, s45, 40960
  s_add_u32 s68, s68, 196608
  v_mfma_f32_16x16x32_bf16 v[44:47], a[20:23], v[80:83], v[44:47]
  ds_read_b64_tr_b16 a[242:243], v6 offset:18432
  ds_read_b128 v[120:123], v13 offset:3072
  buffer_load_dwordx4 v9, s[12:15], s68 offen lds
  v_mfma_f32_16x16x32_bf16 v[48:51], a[20:23], v[88:91], 0
  ds_read_b64_tr_b16 v[124:125], v6 offset:20480
  v_mfma_f32_16x16x32_bf16 v[48:51], a[8:11], v[84:87], v[48:51]
  ds_read_b64_tr_b16 v[126:127], v6 offset:22528
  v_mfma_f32_16x16x32_bf16 v[68:71], a[8:11], v[92:95], 0
  ds_read_b64_tr_b16 v[136:137], v6 offset:24576
  ds_read_b128 v[76:79], v2 offset:36864
  s_add_u32 m0, s45, 45056
  s_add_u32 s68, s68, 196608
  v_mfma_f32_16x16x32_bf16 v[68:71], a[20:23], v[96:99], v[68:71]
  ds_read_b64_tr_b16 v[138:139], v6 offset:26624
  buffer_load_dwordx4 v9, s[12:15], s68 offen lds
  v_mfma_f32_16x16x32_bf16 v[60:63], a[16:19], v[96:99], 0
  ds_read_b64_tr_b16 v[148:149], v6 offset:28672
  ds_read_b128 v[80:83], v2 offset:37888
  v_mfma_f32_16x16x32_bf16 v[60:63], a[4:7], v[92:95], v[60:63]
  ds_read_b64_tr_b16 v[150:151], v6 offset:30720
  s_waitcnt lgkmcnt(8)
  v_mfma_f32_16x16x32_bf16 v[28:31], a[24:27], v[100:103], v[28:31]
  s_add_u32 m0, s45, 49152
  s_add_u32 s68, s66, 5
  s_and_b32 s68, s68, 7
  s_mul_i32 s68, s68, 786432
  s_add_u32 s68, s68, 4096
  v_mfma_f32_16x16x32_bf16 v[28:31], a[36:39], v[104:107], v[28:31]
  ds_read_b128 v[88:91], v2 offset:45056
  buffer_load_dwordx4 v9, s[12:15], s68 offen lds
  v_mfma_f32_16x16x32_bf16 v[32:35], a[36:39], v[112:115], v[32:35]
  v_mfma_f32_16x16x32_bf16 v[32:35], a[24:27], v[108:111], v[32:35]
  v_mfma_f32_16x16x32_bf16 v[40:43], a[28:31], v[108:111], v[40:43]
  ds_read_b128 v[84:87], v2 offset:46080
  s_add_u32 m0, s45, 53248
  s_add_u32 s68, s68, 196608
  v_mfma_f32_16x16x32_bf16 v[40:43], a[40:43], v[112:115], v[40:43]
  buffer_load_dwordx4 v9, s[12:15], s68 offen lds
  v_mfma_f32_16x16x32_bf16 v[36:39], a[40:43], v[104:107], v[36:39]
  ds_read_b128 v[96:99], v13 offset:4096
  v_mfma_f32_16x16x32_bf16 v[36:39], a[28:31], v[100:103], v[36:39]
  v_mfma_f32_16x16x32_bf16 v[44:47], a[32:35], v[100:103], v[44:47]
  s_add_u32 m0, s45, 57344
  s_add_u32 s68, s68, 196608
  v_mfma_f32_16x16x32_bf16 v[44:47], a[44:47], v[104:107], v[44:47]
  ds_read_b128 v[92:95], v13 offset:5120
  buffer_load_dwordx4 v9, s[12:15], s68 offen lds
  v_mfma_f32_16x16x32_bf16 v[48:51], a[44:47], v[112:115], v[48:51]
  v_mfma_f32_16x16x32_bf16 v[48:51], a[32:35], v[108:111], v[48:51]
  v_mfma_f32_16x16x32_bf16 v[68:71], a[32:35], v[116:119], v[68:71]
  ds_read_b128 v[100:103], v2 offset:38912
  s_add_u32 m0, s45, 61440
  s_add_u32 s68, s68, 196608
  v_mfma_f32_16x16x32_bf16 v[68:71], a[44:47], v[120:123], v[68:71]
  buffer_load_dwordx4 v9, s[12:15], s68 offen lds
  v_mfma_f32_16x16x32_bf16 v[60:63], a[40:43], v[120:123], v[60:63]
  ds_read_b128 v[104:107], v2 offset:39936
  v_mfma_f32_16x16x32_bf16 v[60:63], a[28:31], v[116:119], v[60:63]
  s_waitcnt lgkmcnt(2)
  v_mfma_f32_16x16x32_bf16 v[28:31], a[48:51], v[76:79], v[28:31]
  s_add_u32 m0, s71, 147456
  s_add_u32 s69, s60, s72
  v_mfma_f32_16x16x32_bf16 v[28:31], a[60:63], v[80:83], v[28:31]
  ds_read_b128 v[112:115], v2 offset:47104
  buffer_load_dwordx4 v1, s[8:11], s69 offen offset:0 sc1 lds
  v_mfma_f32_16x16x32_bf16 v[32:35], a[60:63], v[84:87], v[32:35]
  v_mfma_f32_16x16x32_bf16 v[32:35], a[48:51], v[88:91], v[32:35]
  v_mfma_f32_16x16x32_bf16 v[40:43], a[52:55], v[88:91], v[40:43]
  ds_read_b128 v[108:111], v2 offset:48128
  v_mfma_f32_16x16x32_bf16 v[40:43], a[64:67], v[84:87], v[40:43]
  buffer_load_dwordx4 v1, s[8:11], s69 offen offset:1024 sc1 lds
  v_mfma_f32_16x16x32_bf16 v[36:39], a[64:67], v[80:83], v[36:39]
  ds_read_b128 v[120:123], v13 offset:6144
  v_mfma_f32_16x16x32_bf16 v[36:39], a[52:55], v[76:79], v[36:39]
  v_mfma_f32_16x16x32_bf16 v[44:47], a[56:59], v[76:79], v[44:47]
  s_add_u32 m0, s71, 155648
  s_add_u32 s69, s61, s72
  v_mfma_f32_16x16x32_bf16 v[44:47], a[68:71], v[80:83], v[44:47]
  ds_read_b128 v[116:119], v13 offset:7168
  buffer_load_dwordx4 v1, s[8:11], s69 offen offset:0 sc1 lds
  v_mfma_f32_16x16x32_bf16 v[48:51], a[68:71], v[84:87], v[48:51]
  v_mfma_f32_16x16x32_bf16 v[48:51], a[56:59], v[88:91], v[48:51]
  s_waitcnt vmcnt(11) lgkmcnt(10)
  s_barrier
  v_mfma_f32_16x16x32_bf16 v[68:71], a[56:59], v[96:99], v[68:71]
  ds_read_b64_tr_b16 a[196:197], v4 offset:0
  ds_read_b128 v[76:79], v2 offset:49152
  v_mfma_f32_16x16x32_bf16 v[68:71], a[68:71], v[92:95], v[68:71]
  ds_read_b64_tr_b16 a[198:199], v4 offset:2048
  buffer_load_dwordx4 v1, s[8:11], s69 offen offset:1024 sc1 lds
  v_mfma_f32_16x16x32_bf16 v[60:63], a[64:67], v[92:95], v[60:63]
  ds_read_b64_tr_b16 a[200:201], v5 offset:0
  ds_read_b128 v[80:83], v2 offset:50176
  v_mfma_f32_16x16x32_bf16 v[60:63], a[52:55], v[96:99], v[60:63]
  ds_read_b64_tr_b16 a[202:203], v5 offset:2048
  s_waitcnt lgkmcnt(6)
  v_mfma_f32_16x16x32_bf16 v[28:31], a[72:75], v[100:103], v[28:31]
  ds_read_b64_tr_b16 a[208:209], v4 offset:4096
  s_add_u32 m0, s45, 65536
  s_add_u32 s68, s66, 6
  s_and_b32 s68, s68, 7
  s_mul_i32 s68, s68, 786432
  v_mfma_f32_16x16x32_bf16 v[28:31], a[84:87], v[104:107], v[28:31]
  ds_read_b64_tr_b16 a[210:211], v4 offset:6144
  ds_read_b128 v[84:87], v2 offset:57344
  buffer_load_dwordx4 v9, s[12:15], s68 offen lds
  v_mfma_f32_16x16x32_bf16 v[32:35], a[84:87], v[108:111], v[32:35]
  ds_read_b64_tr_b16 a[212:213], v5 offset:4096
  v_mfma_f32_16x16x32_bf16 v[32:35], a[72:75], v[112:115], v[32:35]
  ds_read_b64_tr_b16 a[214:215], v5 offset:6144
  v_mfma_f32_16x16x32_bf16 v[40:43], a[76:79], v[112:115], v[40:43]
  ds_read_b64_tr_b16 a[220:221], v4 offset:8192
  ds_read_b128 v[88:91], v2 offset:58368
  s_add_u32 m0, s45, 69632
  s_add_u32 s68, s68, 196608
  v_mfma_f32_16x16x32_bf16 v[40:43], a[88:91], v[108:111], v[40:43]
  ds_read_b64_tr_b16 a[222:223], v4 offset:10240
  buffer_load_dwordx4 v9, s[12:15], s68 offen lds
  v_mfma_f32_16x16x32_bf16 v[36:39], a[88:91], v[104:107], v[36:39]
  ds_read_b64_tr_b16 a[224:225], v5 offset:8192
  ds_read_b128 v[92:95], v13 offset:8192
  v_mfma_f32_16x16x32_bf16 v[36:39], a[76:79], v[100:103], v[36:39]
  ds_read_b64_tr_b16 a[226:227], v5 offset:10240
  v_mfma_f32_16x16x32_bf16 v[44:47], a[80:83], v[100:103], v[44:47]
  ds_read_b64_tr_b16 a[232:233], v4 offset:12288
  s_add_u32 m0, s45, 73728
  s_add_u32 s68, s68, 196608
  v_mfma_f32_16x16x32_bf16 v[44:47], a[92:95], v[104:107], v[44:47]
  ds_read_b64_tr_b16 a[234:235], v4 offset:14336
  ds_read_b128 v[96:99], v13 offset:9216
  buffer_load_dwordx4 v9, s[12:15], s68 offen lds
  v_mfma_f32_16x16x32_bf16 v[48:51], a[92:95], v[108:111], v[48:51]
  ds_read_b64_tr_b16 a[236:237], v5 offset:12288
  v_mfma_f32_16x16x32_bf16 v[48:51], a[80:83], v[112:115], v[48:51]
  ds_read_b64_tr_b16 a[238:239], v5 offset:14336
  v_mfma_f32_16x16x32_bf16 v[68:71], a[80:83], v[120:123], v[68:71]
  ds_read_b128 v[100:103], v2 offset:51200
  s_add_u32 m0, s45, 77824
  s_add_u32 s68, s68, 196608
  v_mfma_f32_16x16x32_bf16 v[68:71], a[92:95], v[116:119], v[68:71]
  buffer_load_dwordx4 v9, s[12:15], s68 offen lds
  v_mfma_f32_16x16x32_bf16 v[60:63], a[88:91], v[116:119], v[60:63]
  ds_read_b128 v[104:107], v2 offset:52224
  v_mfma_f32_16x16x32_bf16 v[60:63], a[76:79], v[120:123], v[60:63]
  s_waitcnt lgkmcnt(4)
  v_mfma_f32_16x16x32_bf16 v[28:31], a[96:99], v[76:79], v[28:31]
HOP1:
  s_cbranch_execz HOP5
  s_add_u32 m0, s70, 81920
  s_add_u32 s69, s60, 32768
  v_mfma_f32_16x16x32_bf16 v[28:31], a[108:111], v[80:83], v[28:31]
  ds_read_b128 v[108:111], v2 offset:59392
  buffer_load_dwordx4 v12, s[8:11], s69 offen offset:0 sc1 lds
  v_mfma_f32_16x16x32_bf16 v[32:35], a[108:111], v[88:91], v[32:35]
  v_mfma_f32_16x16x32_bf16 v[32:35], a[96:99], v[84:87], v[32:35]
  v_mfma_f32_16x16x32_bf16 v[40:43], a[100:103], v[84:87], v[40:43]
  ds_read_b128 v[112:115], v2 offset:60416
  v_mfma_f32_16x16x32_bf16 v[40:43], a[112:115], v[88:91], v[40:43]
  buffer_load_dwordx4 v12, s[8:11], s69 offen offset:1024 sc1 lds
  v_mfma_f32_16x16x32_bf16 v[36:39], a[112:115], v[80:83], v[36:39]
  ds_read_b128 v[116:119], v13 offset:10240
  v_mfma_f32_16x16x32_bf16 v[36:39], a[100:103], v[76:79], v[36:39]
  v_mfma_f32_16x16x32_bf16 v[44:47], a[104:107], v[76:79], v[44:47]
  v_mfma_f32_16x16x32_bf16 v[44:47], a[116:119], v[80:83], v[44:47]
  ds_read_b128 v[120:123], v13 offset:11264
  buffer_load_dwordx4 v12, s[8:11], s69 offen offset:2048 sc1 lds
  v_mfma_f32_16x16x32_bf16 v[48:51], a[116:119], v[88:91], v[48:51]
  v_mfma_f32_16x16x32_bf16 v[48:51], a[104:107], v[84:87], v[48:51]
  s_waitcnt vmcnt(11) lgkmcnt(6)
  s_barrier
  v_mfma_f32_16x16x32_bf16 v[68:71], a[104:107], v[92:95], v[68:71]
  ds_read_b64_tr_b16 a[244:245], v4 offset:32768
  ds_read_b128 v[76:79], v2 offset:53248
  v_mfma_f32_16x16x32_bf16 v[68:71], a[116:119], v[96:99], v[68:71]
  ds_read_b64_tr_b16 a[246:247], v4 offset:34816
  buffer_load_dwordx4 v12, s[8:11], s69 offen offset:3072 sc1 lds
  v_mfma_f32_16x16x32_bf16 v[60:63], a[112:115], v[96:99], v[60:63]
  ds_read_b64_tr_b16 a[248:249], v5 offset:32768
  ds_read_b128 v[80:83], v2 offset:54272
  v_mfma_f32_16x16x32_bf16 v[60:63], a[100:103], v[92:95], v[60:63]
  ds_read_b64_tr_b16 a[250:251], v5 offset:34816
  s_waitcnt lgkmcnt(6)
  v_mfma_f32_16x16x32_bf16 v[28:31], a[120:123], v[100:103], v[28:31]
  ds_read_b64_tr_b16 v[128:129], v4 offset:36864
  s_add_u32 m0, s45, 98304
  s_add_u32 s68, s66, 7
  s_and_b32 s68, s68, 7
  s_mul_i32 s68, s68, 786432
  v_mfma_f32_16x16x32_bf16 v[28:31], a[132:135], v[104:107], v[28:31]
  ds_read_b64_tr_b16 v[130:131], v4 offset:38912
  ds_read_b128 v[88:91], v2 offset:61440
  buffer_load_dwordx4 v9, s[12:15], s68 offen lds
  v_mfma_f32_16x16x32_bf16 v[32:35], a[132:135], v[112:115], v[32:35]
  ds_read_b64_tr_b16 v[132:133], v5 offset:36864
  v_mfma_f32_16x16x32_bf16 v[32:35], a[120:123], v[108:111], v[32:35]
  ds_read_b64_tr_b16 v[134:135], v5 offset:38912
  v_mfma_f32_16x16x32_bf16 v[40:43], a[124:127], v[108:111], v[40:43]
  ds_read_b64_tr_b16 v[140:141], v4 offset:40960
  ds_read_b128 v[84:87], v2 offset:62464
  s_add_u32 m0, s45, 102400
  s_add_u32 s68, s68, 196608
  v_mfma_f32_16x16x32_bf16 v[40:43], a[136:139], v[112:115], v[40:43]
  ds_read_b64_tr_b16 v[142:143], v4 offset:43008
  buffer_load_dwordx4 v9, s[12:15], s68 offen lds
  v_mfma_f32_16x16x32_bf16 v[36:39], a[136:139], v[104:107], v[36:39]
  ds_read_b64_tr_b16 v[144:145], v5 offset:40960
  ds_read_b128 v[96:99], v13 offset:12288
  v_mfma_f32_16x16x32_bf16 v[36:39], a[124:127], v[100:103], v[36:39]
  ds_read_b64_tr_b16 v[146:147], v5 offset:43008
  v_mfma_f32_16x16x32_bf16 v[44:47], a[128:131], v[100:103], v[44:47]
  ds_read_b64_tr_b16 v[152:153], v4 offset:45056
  s_add_u32 m0, s45, 106496
  s_add_u32 s68, s68, 196608
  v_mfma_f32_16x16x32_bf16 v[44:47], a[140:143], v[104:107], v[44:47]
  ds_read_b64_tr_b16 v[154:155], v4 offset:47104
  ds_read_b128 v[92:95], v13 offset:13312
  buffer_load_dwordx4 v9, s[12:15], s68 offen lds
  v_mfma_f32_16x16x32_bf16 v[48:51], a[140:143], v[112:115], v[48:51]
  ds_read_b64_tr_b16 v[156:157], v5 offset:45056
  v_mfma_f32_16x16x32_bf16 v[48:51], a[128:131], v[108:111], v[48:51]
  ds_read_b64_tr_b16 v[158:159], v5 offset:47104
  v_mfma_f32_16x16x32_bf16 v[68:71], a[128:131], v[116:119], v[68:71]
  ds_read_b128 v[100:103], v2 offset:55296
  s_add_u32 m0, s45, 110592
  s_add_u32 s68, s68, 196608
  v_mfma_f32_16x16x32_bf16 v[68:71], a[140:143], v[120:123], v[68:71]
  buffer_load_dwordx4 v9, s[12:15], s68 offen lds
  v_mfma_f32_16x16x32_bf16 v[60:63], a[136:139], v[120:123], v[60:63]
  ds_read_b128 v[104:107], v2 offset:56320
  v_mfma_f32_16x16x32_bf16 v[60:63], a[124:127], v[116:119], v[60:63]
  s_waitcnt lgkmcnt(4)
  v_mfma_f32_16x16x32_bf16 v[28:31], a[144:147], v[76:79], v[28:31]
  s_add_u32 m0, s45, 0
  s_add_u32 s68, s66, 6
  s_and_b32 s68, s68, 7
  s_mul_i32 s68, s68, 786432
  s_add_u32 s68, s68, 2048
  v_mfma_f32_16x16x32_bf16 v[28:31], a[156:159], v[80:83], v[28:31]
  ds_read_b128 v[112:115], v2 offset:63488
  buffer_load_dwordx4 v9, s[12:15], s68 offen lds
  v_mfma_f32_16x16x32_bf16 v[32:35], a[156:159], v[84:87], v[32:35]
  v_mfma_f32_16x16x32_bf16 v[32:35], a[144:147], v[88:91], v[32:35]
  v_mfma_f32_16x16x32_bf16 v[40:43], a[148:151], v[88:91], v[40:43]
  ds_read_b128 v[108:111], v2 offset:64512
  s_add_u32 m0, s45, 4096
  s_add_u32 s68, s68, 196608
  v_mfma_f32_16x16x32_bf16 v[40:43], a[160:163], v[84:87], v[40:43]
  buffer_load_dwordx4 v9, s[12:15], s68 offen lds
  v_mfma_f32_16x16x32_bf16 v[36:39], a[160:163], v[80:83], v[36:39]
  ds_read_b128 v[120:123], v13 offset:14336
  v_mfma_f32_16x16x32_bf16 v[36:39], a[148:151], v[76:79], v[36:39]
  v_mfma_f32_16x16x32_bf16 v[44:47], a[152:155], v[76:79], v[44:47]
  s_add_u32 m0, s45, 8192
  s_add_u32 s68, s68, 196608
  v_mfma_f32_16x16x32_bf16 v[44:47], a[164:167], v[80:83], v[44:47]
  ds_read_b128 v[116:119], v13 offset:15360
  buffer_load_dwordx4 v9, s[12:15], s68 offen lds
  v_mfma_f32_16x16x32_bf16 v[48:51], a[164:167], v[84:87], v[48:51]
  v_mfma_f32_16x16x32_bf16 v[48:51], a[152:155], v[88:91], v[48:51]
  s_waitcnt vmcnt(3) lgkmcnt(6)
  s_barrier
  v_mfma_f32_16x16x32_bf16 v[68:71], a[152:155], v[96:99], v[68:71]
  ds_read_b64_tr_b16 v[160:161], v6 offset:0
  ds_read_b128 v[76:79], v2 offset:16384
  s_add_u32 m0, s45, 12288
  s_add_u32 s68, s68, 196608
  v_mfma_f32_16x16x32_bf16 v[68:71], a[164:167], v[92:95], v[68:71]
  ds_read_b64_tr_b16 v[162:163], v6 offset:2048
  buffer_load_dwordx4 v9, s[12:15], s68 offen lds
  v_mfma_f32_16x16x32_bf16 v[60:63], a[160:163], v[92:95], v[60:63]
  ds_read_b64_tr_b16 v[172:173], v6 offset:4096
  ds_read_b128 v[80:83], v2 offset:17408
  v_mfma_f32_16x16x32_bf16 v[60:63], a[148:151], v[96:99], v[60:63]
  ds_read_b64_tr_b16 v[174:175], v6 offset:6144
  s_waitcnt lgkmcnt(6)
  v_mfma_f32_16x16x32_bf16 v[28:31], a[168:171], v[100:103], v[28:31]
  ds_read_b64_tr_b16 v[184:185], v6 offset:8192
  s_add_u32 m0, s45, 16384
  s_add_u32 s68, s66, 6
  s_and_b32 s68, s68, 7
  s_mul_i32 s68, s68, 786432
  s_add_u32 s68, s68, 4096
  v_mfma_f32_16x16x32_bf16 v[28:31], a[180:183], v[104:107], v[28:31]
  ds_read_b64_tr_b16 v[186:187], v6 offset:10240
  ds_read_b128 v[84:87], v2 offset:24576
  buffer_load_dwordx4 v9, s[12:15], s68 offen lds
  v_mfma_f32_16x16x32_bf16 v[32:35], a[180:183], v[108:111], v[32:35]
  ds_read_b64_tr_b16 v[196:197], v6 offset:12288
  v_mfma_f32_16x16x32_bf16 v[32:35], a[168:171], v[112:115], v[32:35]
  ds_read_b64_tr_b16 v[198:199], v6 offset:14336
  v_mfma_f32_16x16x32_bf16 v[40:43], a[172:175], v[112:115], v[40:43]
  ds_read_b64_tr_b16 v[208:209], v6 offset:32768
  ds_read_b128 v[88:91], v2 offset:25600
  s_add_u32 m0, s45, 20480
  s_add_u32 s68, s68, 196608
  v_mfma_f32_16x16x32_bf16 v[40:43], a[184:187], v[108:111], v[40:43]
  ds_read_b64_tr_b16 v[210:211], v6 offset:34816
  buffer_load_dwordx4 v9, s[12:15], s68 offen lds
  v_mfma_f32_16x16x32_bf16 v[36:39], a[184:187], v[104:107], v[36:39]
  ds_read_b64_tr_b16 v[220:221], v6 offset:36864
  ds_read_b128 v[92:95], v13 offset:16384
  v_mfma_f32_16x16x32_bf16 v[36:39], a[172:175], v[100:103], v[36:39]
  ds_read_b64_tr_b16 v[222:223], v6 offset:38912
  v_mfma_f32_16x16x32_bf16 v[44:47], a[176:179], v[100:103], v[44:47]
  ds_read_b64_tr_b16 v[232:233], v6 offset:40960
  s_add_u32 m0, s45, 24576
  s_add_u32 s68, s68, 196608
  v_mfma_f32_16x16x32_bf16 v[44:47], a[188:191], v[104:107], v[44:47]
  ds_read_b64_tr_b16 v[234:235], v6 offset:43008
  ds_read_b128 v[96:99], v13 offset:17408
  buffer_load_dwordx4 v9, s[12:15], s68 offen lds
  v_mfma_f32_16x16x32_bf16 v[48:51], a[188:191], v[108:111], v[48:51]
  ds_read_b64_tr_b16 v[244:245], v6 offset:45056
  v_mfma_f32_16x16x32_bf16 v[48:51], a[176:179], v[112:115], v[48:51]
  ds_read_b64_tr_b16 v[246:247], v6 offset:47104
  v_mfma_f32_16x16x32_bf16 v[68:71], a[176:179], v[120:123], v[68:71]
  ds_read_b128 v[100:103], v2 offset:18432
  s_add_u32 m0, s45, 28672
  s_add_u32 s68, s68, 196608
  v_mfma_f32_16x16x32_bf16 v[68:71], a[188:191], v[116:119], v[68:71]
  buffer_load_dwordx4 v9, s[12:15], s68 offen lds
  v_mfma_f32_16x16x32_bf16 v[60:63], a[184:187], v[116:119], v[60:63]
  ds_read_b128 v[104:107], v2 offset:19456
  v_mfma_f32_16x16x32_bf16 v[60:63], a[172:175], v[120:123], v[60:63]
  s_waitcnt lgkmcnt(4)
  v_mfma_f32_16x16x32_bf16 v[28:31], a[192:195], v[76:79], v[28:31]
  s_add_u32 m0, s70, 32768
  s_add_u32 s69, s61, 32768
  v_mfma_f32_16x16x32_bf16 v[28:31], a[204:207], v[80:83], v[28:31]
  ds_read_b128 v[108:111], v2 offset:26624
  buffer_load_dwordx4 v12, s[8:11], s69 offen offset:0 sc1 lds
  v_mfma_f32_16x16x32_bf16 v[32:35], a[204:207], v[88:91], v[32:35]
  v_mfma_f32_16x16x32_bf16 v[32:35], a[192:195], v[84:87], v[32:35]
  v_mfma_f32_16x16x32_bf16 v[40:43], a[196:199], v[84:87], v[40:43]
  ds_read_b128 v[112:115], v2 offset:27648
  v_mfma_f32_16x16x32_bf16 v[40:43], a[208:211], v[88:91], v[40:43]
  buffer_load_dwordx4 v12, s[8:11], s69 offen offset:1024 sc1 lds
  v_mfma_f32_16x16x32_bf16 v[36:39], a[208:211], v[80:83], v[36:39]
  ds_read_b128 v[116:119], v13 offset:18432
  v_mfma_f32_16x16x32_bf16 v[36:39], a[196:199], v[76:79], v[36:39]
  v_mfma_f32_16x16x32_bf16 v[44:47], a[200:203], v[76:79], v[44:47]
  v_mfma_f32_16x16x32_bf16 v[44:47], a[212:215], v[80:83], v[44:47]
  ds_read_b128 v[120:123], v13 offset:19456
  buffer_load_dwordx4 v12, s[8:11], s69 offen offset:2048 sc1 lds
  v_mfma_f32_16x16x32_bf16 v[48:51], a[212:215], v[88:91], v[48:51]
  v_mfma_f32_16x16x32_bf16 v[48:51], a[200:203], v[84:87], v[48:51]
  s_waitcnt vmcnt(3) lgkmcnt(6)
  s_barrier
  v_mfma_f32_16x16x32_bf16 v[68:71], a[200:203], v[92:95], v[68:71]
  ds_read_b64_tr_b16 v[164:165], v4 offset:0
  ds_read_b128 v[76:79], v2 offset:20480
  v_mfma_f32_16x16x32_bf16 v[68:71], a[212:215], v[96:99], v[68:71]
  ds_read_b64_tr_b16 v[166:167], v4 offset:2048
  buffer_load_dwordx4 v12, s[8:11], s69 offen offset:3072 sc1 lds
  v_mfma_f32_16x16x32_bf16 v[60:63], a[208:211], v[96:99], v[60:63]
  ds_read_b64_tr_b16 v[168:169], v5 offset:0
  ds_read_b128 v[80:83], v2 offset:21504
  v_mfma_f32_16x16x32_bf16 v[60:63], a[196:199], v[92:95], v[60:63]
  ds_read_b64_tr_b16 v[170:171], v5 offset:2048
  s_waitcnt lgkmcnt(6)
  v_mfma_f32_16x16x32_bf16 v[28:31], a[216:219], v[100:103], v[28:31]
  ds_read_b64_tr_b16 v[176:177], v4 offset:4096
  s_add_u32 m0, s45, 98304
  s_add_u32 s68, s66, 7
  s_and_b32 s68, s68, 7
  s_mul_i32 s68, s68, 786432
  s_add_u32 s68, s68, 2048
  v_mfma_f32_16x16x32_bf16 v[28:31], a[228:231], v[104:107], v[28:31]
  ds_read_b64_tr_b16 v[178:179], v4 offset:6144
  ds_read_b128 v[88:91], v2 offset:28672
  buffer_load_dwordx4 v9, s[12:15], s68 offen lds
  v_mfma_f32_16x16x32_bf16 v[32:35], a[228:231], v[112:115], v[32:35]
  ds_read_b64_tr_b16 v[180:181], v5 offset:4096
  v_mfma_f32_16x16x32_bf16 v[32:35], a[216:219], v[108:111], v[32:35]
  ds_read_b64_tr_b16 v[182:183], v5 offset:6144
  v_mfma_f32_16x16x32_bf16 v[40:43], a[220:223], v[108:111], v[40:43]
  ds_read_b64_tr_b16 v[188:189], v4 offset:8192
  ds_read_b128 v[84:87], v2 offset:29696
  s_add_u32 m0, s45, 102400
  s_add_u32 s68, s68, 196608
  v_mfma_f32_16x16x32_bf16 v[40:43], a[232:235], v[112:115], v[40:43]
  ds_read_b64_tr_b16 v[190:191], v4 offset:10240
  buffer_load_dwordx4 v9, s[12:15], s68 offen lds
  v_mfma_f32_16x16x32_bf16 v[36:39], a[232:235], v[104:107], v[36:39]
  ds_read_b64_tr_b16 v[192:193], v5 offset:8192
  ds_read_b128 v[96:99], v13 offset:20480
  v_mfma_f32_16x16x32_bf16 v[36:39], a[220:223], v[100:103], v[36:39]
  ds_read_b64_tr_b16 v[194:195], v5 offset:10240
  v_mfma_f32_16x16x32_bf16 v[44:47], a[224:227], v[100:103], v[44:47]
  ds_read_b64_tr_b16 v[200:201], v4 offset:12288
  s_add_u32 m0, s45, 106496
  s_add_u32 s68, s68, 196608
  v_mfma_f32_16x16x32_bf16 v[44:47], a[236:239], v[104:107], v[44:47]
  ds_read_b64_tr_b16 v[202:203], v4 offset:14336
  ds_read_b128 v[92:95], v13 offset:21504
  buffer_load_dwordx4 v9, s[12:15], s68 offen lds
  v_mfma_f32_16x16x32_bf16 v[48:51], a[236:239], v[112:115], v[48:51]
  ds_read_b64_tr_b16 v[204:205], v5 offset:12288
  v_mfma_f32_16x16x32_bf16 v[48:51], a[224:227], v[108:111], v[48:51]
  ds_read_b64_tr_b16 v[206:207], v5 offset:14336
  v_mfma_f32_16x16x32_bf16 v[68:71], a[224:227], v[116:119], v[68:71]
  ds_read_b128 v[100:103], v2 offset:22528
  s_add_u32 m0, s45, 110592
  s_add_u32 s68, s68, 196608
  v_mfma_f32_16x16x32_bf16 v[68:71], a[236:239], v[120:123], v[68:71]
  buffer_load_dwordx4 v9, s[12:15], s68 offen lds
  v_mfma_f32_16x16x32_bf16 v[60:63], a[232:235], v[120:123], v[60:63]
  ds_read_b128 v[104:107], v2 offset:23552
  v_mfma_f32_16x16x32_bf16 v[60:63], a[220:223], v[116:119], v[60:63]
  s_waitcnt lgkmcnt(4)
  v_mfma_f32_16x16x32_bf16 v[28:31], a[240:243], v[76:79], v[28:31]
  s_add_u32 m0, s45, 114688
  s_add_u32 s68, s66, 7
  s_and_b32 s68, s68, 7
  s_mul_i32 s68, s68, 786432
  s_add_u32 s68, s68, 4096
  v_mfma_f32_16x16x32_bf16 v[28:31], v[124:127], v[80:83], v[28:31]
  ds_read_b128 v[112:115], v2 offset:30720
  buffer_load_dwordx4 v9, s[12:15], s68 offen lds
  v_mfma_f32_16x16x32_bf16 v[32:35], v[124:127], v[84:87], v[32:35]
  v_mfma_f32_16x16x32_bf16 v[32:35], a[240:243], v[88:91], v[32:35]
  v_mfma_f32_16x16x32_bf16 v[40:43], a[244:247], v[88:91], v[40:43]
  ds_read_b128 v[108:111], v2 offset:31744
  s_add_u32 m0, s45, 118784
  s_add_u32 s68, s68, 196608
  v_mfma_f32_16x16x32_bf16 v[40:43], v[128:131], v[84:87], v[40:43]
  buffer_load_dwordx4 v9, s[12:15], s68 offen lds
  v_mfma_f32_16x16x32_bf16 v[36:39], v[128:131], v[80:83], v[36:39]
  ds_read_b128 v[120:123], v13 offset:22528
  v_mfma_f32_16x16x32_bf16 v[36:39], a[244:247], v[76:79], v[36:39]
  v_mfma_f32_16x16x32_bf16 v[44:47], a[248:251], v[76:79], v[44:47]
  s_add_u32 m0, s45, 122880
  s_add_u32 s68, s68, 196608
  v_mfma_f32_16x16x32_bf16 v[44:47], v[132:135], v[80:83], v[44:47]
  ds_read_b128 v[116:119], v13 offset:23552
  buffer_load_dwordx4 v9, s[12:15], s68 offen lds
  v_mfma_f32_16x16x32_bf16 v[48:51], v[132:135], v[84:87], v[48:51]
  v_mfma_f32_16x16x32_bf16 v[48:51], a[248:251], v[88:91], v[48:51]
  s_waitcnt vmcnt(7) lgkmcnt(6)
  s_barrier
  v_mfma_f32_16x16x32_bf16 v[68:71], a[248:251], v[96:99], v[68:71]
  ds_read_b128 v[76:79], v1 offset:32768
  s_add_u32 m0, s45, 126976
  s_add_u32 s68, s68, 196608
  v_mfma_f32_16x16x32_bf16 v[68:71], v[132:135], v[92:95], v[68:71]
  buffer_load_dwordx4 v9, s[12:15], s68 offen lds
  v_mfma_f32_16x16x32_bf16 v[60:63], v[128:131], v[92:95], v[60:63]
  ds_read_b128 v[80:83], v1 offset:33792
  v_mfma_f32_16x16x32_bf16 v[60:63], a[244:247], v[96:99], v[60:63]
  s_waitcnt lgkmcnt(2)
  v_mfma_f32_16x16x32_bf16 v[28:31], v[136:139], v[100:103], v[28:31]
  s_add_u32 m0, s70, 49152
  s_add_u32 s69, s58, 98304
  v_mfma_f32_16x16x32_bf16 v[28:31], v[148:151], v[104:107], v[28:31]
  ds_read_b128 v[84:87], v1 offset:40960
  buffer_load_dwordx4 v12, s[8:11], s69 offen offset:0 sc1 lds
  v_mfma_f32_16x16x32_bf16 v[32:35], v[148:151], v[108:111], v[32:35]
  v_mfma_f32_16x16x32_bf16 v[32:35], v[136:139], v[112:115], v[32:35]
  v_mfma_f32_16x16x32_bf16 v[40:43], v[140:143], v[112:115], v[40:43]
  ds_read_b128 v[88:91], v1 offset:41984
  v_mfma_f32_16x16x32_bf16 v[40:43], v[152:155], v[108:111], v[40:43]
  buffer_load_dwordx4 v12, s[8:11], s69 offen offset:1024 sc1 lds
  v_mfma_f32_16x16x32_bf16 v[36:39], v[152:155], v[104:107], v[36:39]
  ds_read_b128 v[92:95], v13 offset:24576
  v_mfma_f32_16x16x32_bf16 v[36:39], v[140:143], v[100:103], v[36:39]
  v_mfma_f32_16x16x32_bf16 v[44:47], v[144:147], v[100:103], v[44:47]
  v_mfma_f32_16x16x32_bf16 v[44:47], v[156:159], v[104:107], v[44:47]
  ds_read_b128 v[96:99], v13 offset:25600
  buffer_load_dwordx4 v12, s[8:11], s69 offen offset:2048 sc1 lds
  v_mfma_f32_16x16x32_bf16 v[48:51], v[156:159], v[108:111], v[48:51]
  v_mfma_f32_16x16x32_bf16 v[48:51], v[144:147], v[112:115], v[48:51]
  s_waitcnt vmcnt(3)
  s_barrier
  v_mfma_f32_16x16x32_bf16 v[68:71], v[144:147], v[120:123], v[68:71]
  ds_read_b64_tr_b16 v[212:213], v7 offset:32768
  ds_read_b128 v[100:103], v1 offset:34816
  ds_write_b16 v21, v16
  v_mfma_f32_16x16x32_bf16 v[68:71], v[156:159], v[116:119], v[68:71]
  ds_read_b64_tr_b16 v[214:215], v7 offset:34816
  buffer_load_dwordx4 v12, s[8:11], s69 offen offset:3072 sc1 lds
  v_mfma_f32_16x16x32_bf16 v[60:63], v[152:155], v[116:119], v[60:63]
  ds_read_b64_tr_b16 v[216:217], v8 offset:32768
  ds_read_b128 v[104:107], v1 offset:35840
  v_mfma_f32_16x16x32_bf16 v[60:63], v[140:143], v[120:123], v[60:63]
  ds_read_b64_tr_b16 v[218:219], v8 offset:34816
  s_waitcnt lgkmcnt(7)
  v_mfma_f32_16x16x32_bf16 v[28:31], v[160:163], v[76:79], v[28:31]
  ds_read_b64_tr_b16 v[224:225], v7 offset:36864
  s_add_u32 m0, s70, 65536
  s_add_u32 s69, s59, 98304
  v_mfma_f32_16x16x32_bf16 v[28:31], v[172:175], v[80:83], v[28:31]
  ds_read_b64_tr_b16 v[226:227], v7 offset:38912
  ds_read_b128 v[108:111], v1 offset:43008
  buffer_load_dwordx4 v12, s[8:11], s69 offen offset:0 sc1 lds
  v_mfma_f32_16x16x32_bf16 v[32:35], v[172:175], v[88:91], v[32:35]
  ds_read_b64_tr_b16 v[228:229], v8 offset:36864
  v_mfma_f32_16x16x32_bf16 v[32:35], v[160:163], v[84:87], v[32:35]
  ds_read_b64_tr_b16 v[230:231], v8 offset:38912
  v_mfma_f32_16x16x32_bf16 v[40:43], v[164:167], v[84:87], v[40:43]
  ds_read_b64_tr_b16 v[236:237], v7 offset:40960
  ds_read_b128 v[112:115], v1 offset:44032
  v_mfma_f32_16x16x32_bf16 v[40:43], v[176:179], v[88:91], v[40:43]
  ds_read_b64_tr_b16 v[238:239], v7 offset:43008
  buffer_load_dwordx4 v12, s[8:11], s69 offen offset:1024 sc1 lds
  v_mfma_f32_16x16x32_bf16 v[36:39], v[176:179], v[80:83], v[36:39]
  ds_read_b64_tr_b16 v[240:241], v8 offset:40960
  ds_read_b128 v[116:119], v13 offset:26624
  v_mfma_f32_16x16x32_bf16 v[36:39], v[164:167], v[76:79], v[36:39]
  ds_read_b64_tr_b16 v[242:243], v8 offset:43008
  v_mfma_f32_16x16x32_bf16 v[44:47], v[168:171], v[76:79], v[44:47]
  ds_read_b64_tr_b16 v[248:249], v7 offset:45056
  v_mfma_f32_16x16x32_bf16 v[44:47], v[180:183], v[80:83], v[44:47]
  ds_read_b64_tr_b16 v[250:251], v7 offset:47104
  ds_read_b128 v[120:123], v13 offset:27648
  buffer_load_dwordx4 v12, s[8:11], s69 offen offset:2048 sc1 lds
  v_mfma_f32_16x16x32_bf16 v[48:51], v[180:183], v[88:91], v[48:51]
  ds_read_b64_tr_b16 v[252:253], v8 offset:45056
  v_mfma_f32_16x16x32_bf16 v[48:51], v[168:171], v[84:87], v[48:51]
  ds_read_b64_tr_b16 v[254:255], v8 offset:47104
  v_mfma_f32_16x16x32_bf16 v[68:71], v[168:171], v[92:95], v[68:71]
  ds_read_b128 v[76:79], v1 offset:36864
  v_mfma_f32_16x16x32_bf16 v[68:71], v[180:183], v[96:99], v[68:71]
  buffer_load_dwordx4 v12, s[8:11], s69 offen offset:3072 sc1 lds
  v_mfma_f32_16x16x32_bf16 v[60:63], v[176:179], v[96:99], v[60:63]
  ds_read_b128 v[80:83], v1 offset:37888
  v_mfma_f32_16x16x32_bf16 v[60:63], v[164:167], v[92:95], v[60:63]
  s_waitcnt lgkmcnt(4)
  v_mfma_f32_16x16x32_bf16 v[28:31], v[184:187], v[100:103], v[28:31]
  s_add_u32 m0, s70, 0
  s_add_u32 s69, s60, 98304
  v_mfma_f32_16x16x32_bf16 v[28:31], v[196:199], v[104:107], v[28:31]
  ds_read_b128 v[88:91], v1 offset:45056
  buffer_load_dwordx4 v12, s[8:11], s69 offen offset:0 sc1 lds
  v_mfma_f32_16x16x32_bf16 v[32:35], v[196:199], v[112:115], v[32:35]
  v_mfma_f32_16x16x32_bf16 v[32:35], v[184:187], v[108:111], v[32:35]
  v_mfma_f32_16x16x32_bf16 v[40:43], v[188:191], v[108:111], v[40:43]
  ds_read_b128 v[84:87], v1 offset:46080
  v_mfma_f32_16x16x32_bf16 v[40:43], v[200:203], v[112:115], v[40:43]
  buffer_load_dwordx4 v12, s[8:11], s69 offen offset:1024 sc1 lds
  v_mfma_f32_16x16x32_bf16 v[36:39], v[200:203], v[104:107], v[36:39]
  ds_read_b128 v[96:99], v13 offset:28672
  v_mfma_f32_16x16x32_bf16 v[36:39], v[188:191], v[100:103], v[36:39]
  s_mov_b32 s30, 7340032
  s_mov_b32 s31, 131072
  v_mfma_f32_16x16x32_bf16 v[44:47], v[192:195], v[100:103], v[44:47]
  s_mov_b32 s34, 7340032
  s_mov_b32 s35, 131072
  v_mfma_f32_16x16x32_bf16 v[44:47], v[204:207], v[104:107], v[44:47]
  ds_read_b128 v[92:95], v13 offset:29696
  buffer_load_dwordx4 v12, s[8:11], s69 offen offset:2048 sc1 lds
  v_mfma_f32_16x16x32_bf16 v[48:51], v[204:207], v[112:115], v[48:51]
  s_mov_b32 s38, 7340032
  s_mov_b32 s39, 131072
  v_mfma_f32_16x16x32_bf16 v[48:51], v[192:195], v[108:111], v[48:51]
  s_mov_b32 s42, 4194304
  s_mov_b32 s43, 131072
  v_mfma_f32_16x16x32_bf16 v[68:71], v[192:195], v[116:119], v[68:71]
  ds_read_b128 v[100:103], v1 offset:38912
  v_add_u32 v9, s78, v1
  v_mfma_f32_16x16x32_bf16 v[68:71], v[204:207], v[120:123], v[68:71]
  buffer_load_dwordx4 v12, s[8:11], s69 offen offset:3072 sc1 lds
  v_and_b32 v4, 0xffffbfff, v4
  v_mfma_f32_16x16x32_bf16 v[60:63], v[200:203], v[120:123], v[60:63]
  ds_read_b128 v[104:107], v1 offset:39936
  v_and_b32 v5, 0xffffbfff, v5
  v_mfma_f32_16x16x32_bf16 v[60:63], v[188:191], v[116:119], v[60:63]
  v_and_b32 v7, 0xffffbfff, v7
  s_waitcnt lgkmcnt(2)
  v_mfma_f32_16x16x32_bf16 v[28:31], v[208:211], v[76:79], v[28:31]
  s_add_u32 m0, s45, 16384
  s_mov_b32 s68, 0
  v_mfma_f32_16x16x32_bf16 v[28:31], v[220:223], v[80:83], v[28:31]
  ds_read_b128 v[112:115], v1 offset:47104
  buffer_load_dwordx4 v11, s[20:23], s68 offen nt lds
  v_mfma_f32_16x16x32_bf16 v[32:35], v[220:223], v[84:87], v[32:35]
  v_and_b32 v8, 0xffffbfff, v8
  s_lshl_b32 s52, s44, 13
  v_mfma_f32_16x16x32_bf16 v[32:35], v[208:211], v[88:91], v[32:35]
  s_and_b32 s52, s52, 8192
  v_add_u32 v22, s52, v1
  v_mfma_f32_16x16x32_bf16 v[40:43], v[212:215], v[88:91], v[40:43]
  ds_read_b128 v[108:111], v1 offset:48128
  s_add_u32 m0, s45, 20480
  s_add_u32 s68, s68, 393216
  v_mfma_f32_16x16x32_bf16 v[40:43], v[224:227], v[84:87], v[40:43]
  buffer_load_dwordx4 v11, s[20:23], s68 offen nt lds
  v_add_u32 v23, s52, v2
  v_mfma_f32_16x16x32_bf16 v[36:39], v[224:227], v[80:83], v[36:39]
  ds_read_b128 v[120:123], v13 offset:30720
  v_and_b32 v14, 15, v0
  v_mfma_f32_16x16x32_bf16 v[36:39], v[212:215], v[76:79], v[36:39]
  v_lshlrev_b32 v14, 7, v14
  v_mfma_f32_16x16x32_bf16 v[44:47], v[216:219], v[76:79], v[44:47]
  s_add_u32 m0, s45, 24576
  s_add_u32 s68, s68, 393216
  v_mfma_f32_16x16x32_bf16 v[44:47], v[228:231], v[80:83], v[44:47]
  ds_read_b128 v[116:119], v13 offset:31744
  buffer_load_dwordx4 v11, s[20:23], s68 offen nt lds
  v_mfma_f32_16x16x32_bf16 v[48:51], v[228:231], v[84:87], v[48:51]
  v_mfma_f32_16x16x32_bf16 v[48:51], v[216:219], v[88:91], v[48:51]
  s_waitcnt vmcnt(11) lgkmcnt(12)
  s_barrier
  v_mfma_f32_16x16x32_bf16 v[68:71], v[216:219], v[96:99], v[68:71]
  ds_read_b128 v[76:79], v1 offset:49152
  s_add_u32 m0, s45, 28672
  s_add_u32 s68, s68, 393216
  v_mfma_f32_16x16x32_bf16 v[68:71], v[228:231], v[92:95], v[68:71]
  buffer_load_dwordx4 v11, s[20:23], s68 offen nt lds
  v_mfma_f32_16x16x32_bf16 v[60:63], v[224:227], v[92:95], v[60:63]
  v_mfma_f32_16x16x32_bf16 v[60:63], v[212:215], v[96:99], v[60:63]
  ds_read_b128 v[80:83], v1 offset:50176
  s_waitcnt lgkmcnt(2)
  v_mfma_f32_16x16x32_bf16 v[28:31], v[232:235], v[100:103], v[28:31]
  s_add_u32 m0, s70, 81920
  s_add_u32 s69, s61, 98304
  v_mfma_f32_16x16x32_bf16 v[28:31], v[244:247], v[104:107], v[28:31]
  buffer_load_dwordx4 v12, s[8:11], s69 offen offset:0 sc1 lds
  v_mfma_f32_16x16x32_bf16 v[32:35], v[244:247], v[108:111], v[32:35]
  ds_read_b128 v[84:87], v1 offset:57344
  v_mfma_f32_16x16x32_bf16 v[32:35], v[232:235], v[112:115], v[32:35]
  v_mfma_f32_16x16x32_bf16 v[40:43], v[236:239], v[112:115], v[40:43]
  v_mfma_f32_16x16x32_bf16 v[40:43], v[248:251], v[108:111], v[40:43]
  ds_read_b128 v[88:91], v1 offset:58368
  buffer_load_dwordx4 v12, s[8:11], s69 offen offset:1024 sc1 lds
  v_mfma_f32_16x16x32_bf16 v[36:39], v[248:251], v[104:107], v[36:39]
  v_mfma_f32_16x16x32_bf16 v[36:39], v[236:239], v[100:103], v[36:39]
  v_mfma_f32_16x16x32_bf16 v[44:47], v[240:243], v[100:103], v[44:47]
  ds_read_b128 v[92:95], v1 offset:51200
  v_mfma_f32_16x16x32_bf16 v[44:47], v[252:255], v[104:107], v[44:47]
  buffer_load_dwordx4 v12, s[8:11], s69 offen offset:2048 sc1 lds
  v_mfma_f32_16x16x32_bf16 v[48:51], v[252:255], v[108:111], v[48:51]
  v_mfma_f32_16x16x32_bf16 v[48:51], v[240:243], v[112:115], v[48:51]
  ds_read_b128 v[96:99], v1 offset:52224
  v_mfma_f32_16x16x32_bf16 v[68:71], v[240:243], v[120:123], v[68:71]
  v_mfma_f32_16x16x32_bf16 v[68:71], v[252:255], v[116:119], v[68:71]
  buffer_load_dwordx4 v12, s[8:11], s69 offen offset:3072 sc1 lds
  v_mfma_f32_16x16x32_bf16 v[60:63], v[248:251], v[116:119], v[60:63]
  ds_read_b128 v[100:103], v1 offset:59392
  v_mfma_f32_16x16x32_bf16 v[60:63], v[236:239], v[120:123], v[60:63]
  s_waitcnt lgkmcnt(3)
  v_mfma_f32_16x16x32_bf16 v[52:55], a[0:3], v[76:79], 0
  s_add_u32 m0, s70, 114688
  s_add_u32 s69, s58, 163840
  v_mfma_f32_16x16x32_bf16 v[52:55], a[12:15], v[80:83], v[52:55]
  ds_read_b128 v[104:107], v1 offset:60416
  buffer_load_dwordx4 v12, s[8:11], s69 offen offset:0 sc1 lds
  v_mfma_f32_16x16x32_bf16 v[56:59], a[12:15], v[88:91], 0
  v_cvt_pk_bf16_f32 v60, v60, v61
  v_cvt_pk_bf16_f32 v61, v62, v63
  v_cvt_pk_bf16_f32 v62, v68, v69
  v_cvt_pk_bf16_f32 v63, v70, v71
  ds_write_b128 v17, v[60:63] offset:1024
  v_mfma_f32_16x16x32_bf16 v[56:59], a[0:3], v[84:87], v[56:59]
  v_cvt_pk_bf16_f32 v28, v28, v29
  v_cvt_pk_bf16_f32 v29, v30, v31
  v_mfma_f32_16x16x32_bf16 v[64:67], a[4:7], v[84:87], 0
  ds_read_b128 v[108:111], v1 offset:53248
  ds_write_b64 v18, v[28:29] offset:6144
  v_mfma_f32_16x16x32_bf16 v[64:67], a[16:19], v[88:91], v[64:67]
  v_cvt_pk_bf16_f32 v36, v36, v37
  v_cvt_pk_bf16_f32 v37, v38, v39
  v_mfma_f32_16x16x32_bf16 v[60:63], a[16:19], v[80:83], 0
  buffer_load_dwordx4 v12, s[8:11], s69 offen offset:1024 sc1 lds
  v_cvt_pk_bf16_f32 v38, v44, v45
  v_mfma_f32_16x16x32_bf16 v[60:63], a[4:7], v[76:79], v[60:63]
  ds_read_b128 v[112:115], v1 offset:54272
  v_cvt_pk_bf16_f32 v39, v46, v47
  v_mfma_f32_16x16x32_bf16 v[68:71], a[8:11], v[76:79], 0
  ds_write_b128 v17, v[36:39] offset:7168
  v_cvt_pk_bf16_f32 v32, v32, v33
  v_mfma_f32_16x16x32_bf16 v[68:71], a[20:23], v[80:83], v[68:71]
  v_cvt_pk_bf16_f32 v33, v34, v35
  ds_write_b64 v18, v[32:33] offset:12288
  v_mfma_f32_16x16x32_bf16 v[72:75], a[20:23], v[88:91], 0
  ds_read_b128 v[76:79], v1 offset:61440
  v_cvt_pk_bf16_f32 v40, v40, v41
  v_mfma_f32_16x16x32_bf16 v[72:75], a[8:11], v[84:87], v[72:75]
  buffer_load_dwordx4 v12, s[8:11], s69 offen offset:2048 sc1 lds
  s_waitcnt lgkmcnt(7)
  v_mfma_f32_16x16x32_bf16 v[52:55], a[24:27], v[92:95], v[52:55]
  v_cvt_pk_bf16_f32 v41, v42, v43
HOP2:
  s_cbranch_execz HOP6
  v_cvt_pk_bf16_f32 v42, v48, v49
  v_mfma_f32_16x16x32_bf16 v[52:55], a[36:39], v[96:99], v[52:55]
  ds_read_b128 v[80:83], v1 offset:62464
  v_cvt_pk_bf16_f32 v43, v50, v51
  v_mfma_f32_16x16x32_bf16 v[56:59], a[36:39], v[104:107], v[56:59]
  ds_write_b128 v17, v[40:43] offset:13312
  v_mfma_f32_16x16x32_bf16 v[56:59], a[24:27], v[100:103], v[56:59]
  s_bitcmp1_b32 s44, 0
  s_mov_b32 s52, 6144
  s_cselect_b32 s52, 12288, s52
  s_mov_b32 s53, 0
  s_cselect_b32 s53, 6144, s53
  v_mfma_f32_16x16x32_bf16 v[64:67], a[28:31], v[100:103], v[64:67]
  ds_read_b128 v[88:91], v1 offset:55296
  buffer_load_dwordx4 v12, s[8:11], s69 offen offset:3072 sc1 lds
  v_mfma_f32_16x16x32_bf16 v[64:67], a[40:43], v[104:107], v[64:67]
  v_mfma_f32_16x16x32_bf16 v[60:63], a[40:43], v[96:99], v[60:63]
  v_add_u32 v116, s52, v19
  v_add_u32 v117, s53, v19
  v_mfma_f32_16x16x32_bf16 v[60:63], a[28:31], v[92:95], v[60:63]
  ds_read_b128 v[84:87], v1 offset:56320
  v_add_u32 v118, s52, v20
  v_mfma_f32_16x16x32_bf16 v[68:71], a[32:35], v[92:95], v[68:71]
  s_add_u32 m0, s45, 98304
  s_mov_b32 s68, 1572864
  v_mfma_f32_16x16x32_bf16 v[68:71], a[44:47], v[96:99], v[68:71]
  buffer_load_dwordx4 v11, s[20:23], s68 offen nt lds
  v_mfma_f32_16x16x32_bf16 v[72:75], a[44:47], v[104:107], v[72:75]
  ds_read_b128 v[92:95], v1 offset:63488
  v_mfma_f32_16x16x32_bf16 v[72:75], a[32:35], v[100:103], v[72:75]
  v_add_u32 v119, s53, v20
  s_waitcnt lgkmcnt(4)
  v_mfma_f32_16x16x32_bf16 v[52:55], a[48:51], v[108:111], v[52:55]
  s_waitcnt vmcnt(17) lgkmcnt(3)
  s_barrier
  v_mfma_f32_16x16x32_bf16 v[52:55], a[60:63], v[112:115], v[52:55]
  ds_read_b128 v[96:99], v1 offset:64512
  s_add_u32 m0, s45, 102400
  s_add_u32 s68, s68, 393216
  v_mfma_f32_16x16x32_bf16 v[56:59], a[60:63], v[80:83], v[56:59]
  buffer_load_dwordx4 v11, s[20:23], s68 offen nt lds
  ds_read_b128 v[28:31], v116
  v_mfma_f32_16x16x32_bf16 v[56:59], a[48:51], v[76:79], v[56:59]
  ds_read_b128 v[32:35], v117 offset:1024
  ds_read_b128 v[36:39], v116 offset:1024
  v_mfma_f32_16x16x32_bf16 v[64:67], a[52:55], v[76:79], v[64:67]
  ds_read_b128 v[104:107], v2 offset:0
  ds_read_b64_tr_b16 v[40:41], v119 offset:2048
  v_mfma_f32_16x16x32_bf16 v[64:67], a[64:67], v[80:83], v[64:67]
  ds_read_b64_tr_b16 v[42:43], v118 offset:2048
  ds_read_b64_tr_b16 v[44:45], v119 offset:2056
  v_mfma_f32_16x16x32_bf16 v[60:63], a[64:67], v[112:115], v[60:63]
  s_add_u32 m0, s45, 106496
  s_add_u32 s68, s68, 393216
  v_mfma_f32_16x16x32_bf16 v[60:63], a[52:55], v[108:111], v[60:63]
  ds_read_b128 v[100:103], v2 offset:1024
  buffer_load_dwordx4 v11, s[20:23], s68 offen nt lds
  v_mfma_f32_16x16x32_bf16 v[68:71], a[56:59], v[108:111], v[68:71]
  ds_read_b64_tr_b16 v[46:47], v118 offset:2056
  v_mfma_f32_16x16x32_bf16 v[68:71], a[68:71], v[112:115], v[68:71]
  v_mfma_f32_16x16x32_bf16 v[72:75], a[68:71], v[80:83], v[72:75]
  ds_read_b128 v[108:111], v2 offset:8192
  v_mfma_f32_16x16x32_bf16 v[72:75], a[56:59], v[76:79], v[72:75]
  s_add_u32 m0, s45, 110592
  s_add_u32 s68, s68, 393216
  s_waitcnt lgkmcnt(10)
  v_mfma_f32_16x16x32_bf16 v[52:55], a[72:75], v[88:91], v[52:55]
  buffer_load_dwordx4 v11, s[20:23], s68 offen nt lds
  v_mfma_f32_16x16x32_bf16 v[52:55], a[84:87], v[84:87], v[52:55]
  ds_read_b128 v[112:115], v2 offset:9216
  s_waitcnt lgkmcnt(2)
  v_mfma_f32_16x16x32_bf16 v[56:59], a[84:87], v[96:99], v[56:59]
  v_mfma_f32_16x16x32_bf16 v[116:119], v[32:35], v[28:31], 0
  v_mfma_f32_16x16x32_bf16 v[56:59], a[72:75], v[92:95], v[56:59]
  v_mfma_f32_16x16x32_bf16 v[120:123], v[36:39], v[28:31], 0
  v_mfma_f32_16x16x32_bf16 v[64:67], a[76:79], v[92:95], v[64:67]
  ds_read_b128 v[80:83], v2 offset:2048
  s_add_u32 m0, s70, 32768
  s_add_u32 s69, s59, 163840
  v_mfma_f32_16x16x32_bf16 v[64:67], a[88:91], v[96:99], v[64:67]
  buffer_load_dwordx4 v12, s[8:11], s69 offen offset:0 sc1 lds
  v_mfma_f32_16x16x32_bf16 v[60:63], a[88:91], v[84:87], v[60:63]
  v_mfma_f32_16x16x32_bf16 v[60:63], a[76:79], v[88:91], v[60:63]
  ds_read_b128 v[76:79], v2 offset:3072
  v_cndmask_b32 v48, v116, v120, s[80:81]
  v_mfma_f32_16x16x32_bf16 v[68:71], a[80:83], v[88:91], v[68:71]
  v_cndmask_b32 v49, v117, v121, s[82:83]
  v_cndmask_b32 v50, v118, v122, s[84:85]
  v_mfma_f32_16x16x32_bf16 v[68:71], a[92:95], v[84:87], v[68:71]
  v_cndmask_b32 v51, v119, v123, s[86:87]
  v_cndmask_b32 v48, v48, v49, s[88:89]
  v_mfma_f32_16x16x32_bf16 v[72:75], a[92:95], v[96:99], v[72:75]
  ds_read_b128 v[88:91], v2 offset:10240
  buffer_load_dwordx4 v12, s[8:11], s69 offen offset:1024 sc1 lds
  v_mfma_f32_16x16x32_bf16 v[72:75], a[80:83], v[92:95], v[72:75]
  v_cndmask_b32 v49, v50, v51, s[88:89]
  s_waitcnt lgkmcnt(3)
  v_mfma_f32_16x16x32_bf16 v[52:55], a[96:99], v[104:107], v[52:55]
  v_mul_f32 v48, 0x3e8293ee, v48
  v_mul_f32 v49, 0x3e8293ee, v49
  v_mfma_f32_16x16x32_bf16 v[52:55], a[108:111], v[100:103], v[52:55]
  ds_read_b128 v[84:87], v2 offset:11264
  v_mov_b32 v50, 0xce6e6b28
  v_mfma_f32_16x16x32_bf16 v[56:59], a[108:111], v[112:115], v[56:59]
  v_cndmask_b32 v48, v48, v50, s[90:91]
  v_cndmask_b32 v49, v49, v50, s[92:93]
  v_mfma_f32_16x16x32_bf16 v[56:59], a[96:99], v[108:111], v[56:59]
  buffer_load_dwordx4 v12, s[8:11], s69 offen offset:2048 sc1 lds
  v_max_f32 v50, v48, v49
  v_mfma_f32_16x16x32_bf16 v[64:67], a[100:103], v[108:111], v[64:67]
  ds_read_b128 v[96:99], v2 offset:4096
  v_mov_b32 v51, v50
  v_mfma_f32_16x16x32_bf16 v[64:67], a[112:115], v[112:115], v[64:67]
  s_nop 0
  v_permlane16_swap_b32 v50, v51
  v_max_f32 v50, v50, v51
  v_mfma_f32_16x16x32_bf16 v[60:63], a[112:115], v[100:103], v[60:63]
  v_mov_b32 v51, v50
  v_mfma_f32_16x16x32_bf16 v[60:63], a[100:103], v[104:107], v[60:63]
  ds_read_b128 v[92:95], v2 offset:5120
  v_permlane32_swap_b32 v50, v51
  v_mfma_f32_16x16x32_bf16 v[68:71], a[104:107], v[104:107], v[68:71]
  buffer_load_dwordx4 v12, s[8:11], s69 offen offset:3072 sc1 lds
  v_max_f32 v50, v50, v51
  v_mfma_f32_16x16x32_bf16 v[68:71], a[116:119], v[100:103], v[68:71]
  v_sub_f32 v48, v48, v50
  v_sub_f32 v49, v49, v50
  v_mfma_f32_16x16x32_bf16 v[72:75], a[116:119], v[112:115], v[72:75]
  ds_read_b128 v[104:107], v2 offset:12288
  v_mfma_f32_16x16x32_bf16 v[72:75], a[104:107], v[108:111], v[72:75]
  v_exp_f32 v48, v48
  s_waitcnt lgkmcnt(3)
  v_mfma_f32_16x16x32_bf16 v[52:55], a[120:123], v[80:83], v[52:55]
  v_exp_f32 v49, v49
  v_mfma_f32_16x16x32_bf16 v[52:55], a[132:135], v[76:79], v[52:55]
  ds_read_b128 v[100:103], v2 offset:13312
  v_add_f32 v50, v48, v49
  v_mfma_f32_16x16x32_bf16 v[56:59], a[132:135], v[84:87], v[56:59]
  v_mov_b32 v51, v50
  v_mfma_f32_16x16x32_bf16 v[56:59], a[120:123], v[88:91], v[56:59]
  s_nop 0
  v_permlane16_swap_b32 v50, v51
  v_add_f32 v50, v50, v51
  v_mfma_f32_16x16x32_bf16 v[64:67], a[124:127], v[88:91], v[64:67]
  ds_read_b128 v[112:115], v2 offset:6144
  v_mov_b32 v51, v50
  v_mfma_f32_16x16x32_bf16 v[64:67], a[136:139], v[84:87], v[64:67]
  s_nop 0
  v_permlane32_swap_b32 v50, v51
  v_add_f32 v50, v50, v51
  v_mfma_f32_16x16x32_bf16 v[60:63], a[136:139], v[76:79], v[60:63]
  v_rcp_f32 v50, v50
  v_mfma_f32_16x16x32_bf16 v[60:63], a[124:127], v[80:83], v[60:63]
  ds_read_b128 v[108:111], v2 offset:7168
  v_mul_f32 v48, v48, v50
  v_mfma_f32_16x16x32_bf16 v[68:71], a[128:131], v[80:83], v[68:71]
  v_mul_f32 v49, v49, v50
  v_cvt_pk_bf16_f32 v48, v48, v48
  v_mfma_f32_16x16x32_bf16 v[68:71], a[140:143], v[76:79], v[68:71]
  v_cvt_pk_bf16_f32 v49, v49, v49
  v_and_b32 v28, v24, v48
  v_mfma_f32_16x16x32_bf16 v[72:75], a[140:143], v[84:87], v[72:75]
  ds_read_b128 v[80:83], v2 offset:14336
  v_and_b32 v29, v25, v49
  v_mfma_f32_16x16x32_bf16 v[72:75], a[128:131], v[88:91], v[72:75]
  v_and_b32 v30, v26, v48
  s_waitcnt lgkmcnt(3)
  v_mfma_f32_16x16x32_bf16 v[52:55], a[144:147], v[96:99], v[52:55]
  v_and_b32 v31, v27, v49
  v_mfma_f32_16x16x32_bf16 v[52:55], a[156:159], v[92:95], v[52:55]
  ds_read_b128 v[76:79], v2 offset:15360
  v_mfma_f32_16x16x32_bf16 v[32:35], v[40:43], v[28:31], 0
  v_mfma_f32_16x16x32_bf16 v[56:59], a[156:159], v[100:103], v[56:59]
  v_mfma_f32_16x16x32_bf16 v[36:39], v[44:47], v[28:31], 0
  v_mfma_f32_16x16x32_bf16 v[56:59], a[144:147], v[104:107], v[56:59]
  s_waitcnt vmcnt(12)
  s_barrier
  v_mfma_f32_16x16x32_bf16 v[64:67], a[148:151], v[104:107], v[64:67]
  ds_read_b128 v[84:87], v1 offset:0
  s_add_u32 m0, s70, 49152
  s_add_u32 s69, s60, 163840
  v_mfma_f32_16x16x32_bf16 v[64:67], a[160:163], v[100:103], v[64:67]
  buffer_load_dwordx4 v12, s[8:11], s69 offen offset:0 sc1 lds
  v_mfma_f32_16x16x32_bf16 v[60:63], a[160:163], v[92:95], v[60:63]
  v_cvt_pk_bf16_f32 v116, v32, v33
  v_cvt_pk_bf16_f32 v117, v34, v35
  v_mfma_f32_16x16x32_bf16 v[60:63], a[148:151], v[96:99], v[60:63]
  ds_read_b128 v[88:91], v1 offset:1024
  v_cvt_pk_bf16_f32 v118, v36, v37
  v_mfma_f32_16x16x32_bf16 v[68:71], a[152:155], v[96:99], v[68:71]
  v_cvt_pk_bf16_f32 v119, v38, v39
  buffer_store_dwordx4 v[116:119], v1, s[8:11], s73 offen sc1
  v_mfma_f32_16x16x32_bf16 v[68:71], a[164:167], v[92:95], v[68:71]
  s_add_u32 s73, s73, 65536
  v_mfma_f32_16x16x32_bf16 v[72:75], a[164:167], v[100:103], v[72:75]
  ds_read_b128 v[96:99], v1 offset:8192
  buffer_load_dwordx4 v12, s[8:11], s69 offen offset:1024 sc1 lds
  v_mfma_f32_16x16x32_bf16 v[72:75], a[152:155], v[104:107], v[72:75]
  s_waitcnt lgkmcnt(3)
  v_mfma_f32_16x16x32_bf16 v[52:55], a[168:171], v[112:115], v[52:55]
  v_mfma_f32_16x16x32_bf16 v[52:55], a[180:183], v[108:111], v[52:55]
  ds_read_b128 v[92:95], v1 offset:9216
  v_mfma_f32_16x16x32_bf16 v[56:59], a[180:183], v[76:79], v[56:59]
  v_mfma_f32_16x16x32_bf16 v[56:59], a[168:171], v[80:83], v[56:59]
  buffer_load_dwordx4 v12, s[8:11], s69 offen offset:2048 sc1 lds
  v_mfma_f32_16x16x32_bf16 v[64:67], a[172:175], v[80:83], v[64:67]
  ds_read_b128 v[100:103], v1 offset:2048
  v_mfma_f32_16x16x32_bf16 v[64:67], a[184:187], v[76:79], v[64:67]
  v_mfma_f32_16x16x32_bf16 v[60:63], a[184:187], v[108:111], v[60:63]
  v_mfma_f32_16x16x32_bf16 v[60:63], a[172:175], v[112:115], v[60:63]
  ds_read_b128 v[104:107], v1 offset:3072
  v_mfma_f32_16x16x32_bf16 v[68:71], a[176:179], v[112:115], v[68:71]
  buffer_load_dwordx4 v12, s[8:11], s69 offen offset:3072 sc1 lds
  v_mfma_f32_16x16x32_bf16 v[68:71], a[188:191], v[108:111], v[68:71]
  v_mfma_f32_16x16x32_bf16 v[72:75], a[188:191], v[76:79], v[72:75]
  ds_read_b128 v[112:115], v1 offset:10240
  v_mfma_f32_16x16x32_bf16 v[72:75], a[176:179], v[80:83], v[72:75]
  s_waitcnt lgkmcnt(3)
  v_mfma_f32_16x16x32_bf16 v[52:55], a[192:195], v[84:87], v[52:55]
  v_mfma_f32_16x16x32_bf16 v[52:55], a[204:207], v[88:91], v[52:55]
  ds_read_b128 v[108:111], v1 offset:11264
  v_mfma_f32_16x16x32_bf16 v[56:59], a[204:207], v[92:95], v[56:59]
  v_mfma_f32_16x16x32_bf16 v[56:59], a[192:195], v[96:99], v[56:59]
  v_mfma_f32_16x16x32_bf16 v[64:67], a[196:199], v[96:99], v[64:67]
  ds_read_b128 v[76:79], v1 offset:4096
  v_lshrrev_b32 v40, 4, v0
  v_lshlrev_b32 v40, 4, v40
  v_mfma_f32_16x16x32_bf16 v[64:67], a[208:211], v[92:95], v[64:67]
  v_add_u32 v41, 149504, v40
  v_mfma_f32_16x16x32_bf16 v[60:63], a[208:211], v[88:91], v[60:63]
  ds_read_b64_tr_b16 v[116:117], v3 offset:16384
  v_mfma_f32_16x16x32_bf16 v[60:63], a[196:199], v[84:87], v[60:63]
  ds_read_b128 v[80:83], v1 offset:5120
  ds_read_b64_tr_b16 v[118:119], v3 offset:18432
  v_mfma_f32_16x16x32_bf16 v[68:71], a[200:203], v[84:87], v[68:71]
  ds_read_b128 v[28:31], v41 offset:0
  v_mfma_f32_16x16x32_bf16 v[68:71], a[212:215], v[88:91], v[68:71]
  v_mfma_f32_16x16x32_bf16 v[72:75], a[212:215], v[92:95], v[72:75]
  ds_read_b128 v[84:87], v1 offset:12288
  v_mfma_f32_16x16x32_bf16 v[72:75], a[200:203], v[96:99], v[72:75]
  s_waitcnt lgkmcnt(6)
  v_mfma_f32_16x16x32_bf16 v[52:55], a[216:219], v[100:103], v[52:55]
  v_mfma_f32_16x16x32_bf16 v[52:55], a[228:231], v[104:107], v[52:55]
  ds_read_b128 v[88:91], v1 offset:13312
  v_mfma_f32_16x16x32_bf16 v[56:59], a[228:231], v[108:111], v[56:59]
  v_mfma_f32_16x16x32_bf16 v[56:59], a[216:219], v[112:115], v[56:59]
  v_mfma_f32_16x16x32_bf16 v[64:67], a[220:223], v[112:115], v[64:67]
  ds_read_b128 v[92:95], v1 offset:6144
  ds_read_b64_tr_b16 v[120:121], v3 offset:20480
  v_mfma_f32_16x16x32_bf16 v[64:67], a[232:235], v[108:111], v[64:67]
  ds_read_b64_tr_b16 v[122:123], v3 offset:22528
  s_waitcnt lgkmcnt(5)
  v_mfma_f32_16x16x32_bf16 v[36:39], v[116:119], v[28:31], 0
  v_mfma_f32_16x16x32_bf16 v[60:63], a[232:235], v[104:107], v[60:63]
  ds_read_b128 v[32:35], v41 offset:64
  v_mfma_f32_16x16x32_bf16 v[60:63], a[220:223], v[100:103], v[60:63]
  ds_read_b128 v[96:99], v1 offset:7168
  v_mfma_f32_16x16x32_bf16 v[68:71], a[224:227], v[100:103], v[68:71]
  v_mfma_f32_16x16x32_bf16 v[68:71], a[236:239], v[104:107], v[68:71]
  v_mfma_f32_16x16x32_bf16 v[72:75], a[236:239], v[108:111], v[72:75]
  ds_read_b128 v[100:103], v1 offset:14336
  v_mfma_f32_16x16x32_bf16 v[72:75], a[224:227], v[112:115], v[72:75]
  s_waitcnt lgkmcnt(6)
  v_mfma_f32_16x16x32_bf16 v[52:55], a[240:243], v[76:79], v[52:55]
  v_mfma_f32_16x16x32_bf16 v[52:55], v[124:127], v[80:83], v[52:55]
  ds_read_b128 v[104:107], v1 offset:15360
  v_mfma_f32_16x16x32_bf16 v[56:59], v[124:127], v[88:91], v[56:59]
  ds_read_b64_tr_b16 v[116:117], v3 offset:24576
  v_and_b32 v42, 15, v0
  v_mfma_f32_16x16x32_bf16 v[56:59], a[240:243], v[84:87], v[56:59]
  ds_read_b64_tr_b16 v[118:119], v3 offset:26624
  s_waitcnt lgkmcnt(5)
  v_mfma_f32_16x16x32_bf16 v[36:39], v[120:123], v[32:35], v[36:39]
  v_mfma_f32_16x16x32_bf16 v[64:67], a[244:247], v[84:87], v[64:67]
  ds_read_b128 v[108:111], v2 offset:16384
  ds_read_b128 v[28:31], v41 offset:128
  v_mfma_f32_16x16x32_bf16 v[64:67], v[128:131], v[88:91], v[64:67]
  v_lshl_add_u32 v40, v42, 27, v40
  s_lshr_b32 s52, s2, 2
  v_mfma_f32_16x16x32_bf16 v[60:63], v[128:131], v[80:83], v[60:63]
  s_lshl_b32 s54, s52, 7
  s_lshl_b32 s52, s52, 8
  v_mfma_f32_16x16x32_bf16 v[60:63], a[244:247], v[76:79], v[60:63]
  ds_read_b128 v[112:115], v2 offset:17408
  s_and_b32 s53, s2, 3
  v_mfma_f32_16x16x32_bf16 v[68:71], a[248:251], v[76:79], v[68:71]
  s_mul_i32 s79, s53, 24576
  s_add_u32 s52, s52, s79
  v_mfma_f32_16x16x32_bf16 v[68:71], v[132:135], v[80:83], v[68:71]
  s_lshl_b32 s79, s44, 6
  s_add_u32 s52, s52, s79
  v_mfma_f32_16x16x32_bf16 v[72:75], v[132:135], v[88:91], v[72:75]
  ds_read_b128 v[76:79], v2 offset:24576
  s_add_u32 s52, s52, 8192
  v_mfma_f32_16x16x32_bf16 v[72:75], a[248:251], v[84:87], v[72:75]
  s_lshl_b32 s53, s53, 2
  s_waitcnt lgkmcnt(6)
  v_mfma_f32_16x16x32_bf16 v[52:55], v[136:139], v[92:95], v[52:55]
  ds_read_b64_tr_b16 v[120:121], v3 offset:28672
  s_add_u32 s54, s54, s53
  v_mfma_f32_16x16x32_bf16 v[52:55], v[148:151], v[96:99], v[52:55]
  ds_read_b128 v[80:83], v2 offset:25600
  ds_read_b64_tr_b16 v[122:123], v3 offset:30720
  s_waitcnt lgkmcnt(5)
  v_mfma_f32_16x16x32_bf16 v[36:39], v[116:119], v[28:31], v[36:39]
  v_mfma_f32_16x16x32_bf16 v[56:59], v[148:151], v[104:107], v[56:59]
  ds_read_b128 v[32:35], v41 offset:192
  s_add_u32 s54, s54, 720896
  v_mfma_f32_16x16x32_bf16 v[56:59], v[136:139], v[100:103], v[56:59]
  s_cmp_eq_u32 s44, 0
  s_cselect_b32 s79, s54, 1073741824
  v_mfma_f32_16x16x32_bf16 v[64:67], v[140:143], v[100:103], v[64:67]
  ds_read_b128 v[88:91], v2 offset:18432
  v_mfma_f32_16x16x32_bf16 v[64:67], v[152:155], v[104:107], v[64:67]
  v_mfma_f32_16x16x32_bf16 v[60:63], v[152:155], v[96:99], v[60:63]
  v_mfma_f32_16x16x32_bf16 v[60:63], v[140:143], v[92:95], v[60:63]
  ds_read_b128 v[84:87], v2 offset:19456
  v_mfma_f32_16x16x32_bf16 v[68:71], v[144:147], v[92:95], v[68:71]
  v_mfma_f32_16x16x32_bf16 v[68:71], v[156:159], v[96:99], v[68:71]
  s_waitcnt vmcnt(9)
  s_barrier
  v_mfma_f32_16x16x32_bf16 v[72:75], v[156:159], v[104:107], v[72:75]
  ds_read_b128 v[92:95], v2 offset:26624
  ds_read_b64_tr_b16 v[116:117], v6 offset:32768
  s_add_u32 m0, s70, 65536
  s_add_u32 s69, s61, 163840
  v_mfma_f32_16x16x32_bf16 v[72:75], v[144:147], v[100:103], v[72:75]
  ds_read_b64_tr_b16 v[118:119], v6 offset:34816
  buffer_load_dwordx4 v12, s[8:11], s69 offen offset:0 sc1 lds
  s_waitcnt lgkmcnt(5)
  v_mfma_f32_16x16x32_bf16 v[36:39], v[120:123], v[32:35], v[36:39]
  s_waitcnt lgkmcnt(7)
  v_mfma_f32_16x16x32_bf16 v[52:55], v[160:163], v[108:111], v[52:55]
  ds_read_b128 v[28:31], v41 offset:256
  v_mfma_f32_16x16x32_bf16 v[52:55], v[172:175], v[112:115], v[52:55]
  ds_read_b128 v[96:99], v2 offset:27648
  v_mfma_f32_16x16x32_bf16 v[56:59], v[172:175], v[80:83], v[56:59]
  v_mfma_f32_16x16x32_bf16 v[56:59], v[160:163], v[76:79], v[56:59]
  v_mfma_f32_16x16x32_bf16 v[64:67], v[164:167], v[76:79], v[64:67]
  ds_read_b128 v[104:107], v2 offset:20480
  buffer_load_dwordx4 v12, s[8:11], s69 offen offset:1024 sc1 lds
  v_mfma_f32_16x16x32_bf16 v[64:67], v[176:179], v[80:83], v[64:67]
  v_mfma_f32_16x16x32_bf16 v[60:63], v[176:179], v[112:115], v[60:63]
  v_mfma_f32_16x16x32_bf16 v[60:63], v[164:167], v[108:111], v[60:63]
  ds_read_b128 v[100:103], v2 offset:21504
  v_mfma_f32_16x16x32_bf16 v[68:71], v[168:171], v[108:111], v[68:71]
  ds_read_b64_tr_b16 v[120:121], v6 offset:36864
  v_mfma_f32_16x16x32_bf16 v[68:71], v[180:183], v[112:115], v[68:71]
  ds_read_b64_tr_b16 v[122:123], v6 offset:38912
  buffer_load_dwordx4 v12, s[8:11], s69 offen offset:2048 sc1 lds
  s_waitcnt lgkmcnt(5)
  v_mfma_f32_16x16x32_bf16 v[36:39], v[116:119], v[28:31], v[36:39]
  v_mfma_f32_16x16x32_bf16 v[72:75], v[180:183], v[80:83], v[72:75]
  ds_read_b128 v[108:111], v2 offset:28672
  ds_read_b128 v[32:35], v41 offset:320
  v_mfma_f32_16x16x32_bf16 v[72:75], v[168:171], v[76:79], v[72:75]
  s_waitcnt lgkmcnt(6)
  v_mfma_f32_16x16x32_bf16 v[52:55], v[184:187], v[88:91], v[52:55]
  v_mfma_f32_16x16x32_bf16 v[52:55], v[196:199], v[84:87], v[52:55]
  ds_read_b128 v[112:115], v2 offset:29696
  v_mfma_f32_16x16x32_bf16 v[56:59], v[196:199], v[96:99], v[56:59]
  buffer_load_dwordx4 v12, s[8:11], s69 offen offset:3072 sc1 lds
  v_mfma_f32_16x16x32_bf16 v[56:59], v[184:187], v[92:95], v[56:59]
  v_mfma_f32_16x16x32_bf16 v[64:67], v[188:191], v[92:95], v[64:67]
  ds_read_b128 v[80:83], v2 offset:22528
  v_mfma_f32_16x16x32_bf16 v[64:67], v[200:203], v[96:99], v[64:67]
  v_mfma_f32_16x16x32_bf16 v[60:63], v[200:203], v[84:87], v[60:63]
  ds_read_b64_tr_b16 v[116:117], v6 offset:40960
  s_add_u32 m0, s70, 0
  s_add_u32 s69, s58, 229376
  v_mfma_f32_16x16x32_bf16 v[60:63], v[188:191], v[88:91], v[60:63]
  ds_read_b128 v[76:79], v2 offset:23552
  ds_read_b64_tr_b16 v[118:119], v6 offset:43008
  buffer_load_dwordx4 v12, s[8:11], s69 offen offset:0 sc1 lds
  s_waitcnt lgkmcnt(5)
  v_mfma_f32_16x16x32_bf16 v[36:39], v[120:123], v[32:35], v[36:39]
  v_mfma_f32_16x16x32_bf16 v[68:71], v[192:195], v[88:91], v[68:71]
  ds_read_b128 v[28:31], v41 offset:384
  v_mfma_f32_16x16x32_bf16 v[68:71], v[204:207], v[84:87], v[68:71]
  v_mfma_f32_16x16x32_bf16 v[72:75], v[204:207], v[96:99], v[72:75]
  ds_read_b128 v[88:91], v2 offset:30720
  v_mfma_f32_16x16x32_bf16 v[72:75], v[192:195], v[92:95], v[72:75]
  s_waitcnt lgkmcnt(6)
  v_mfma_f32_16x16x32_bf16 v[52:55], v[208:211], v[104:107], v[52:55]
  buffer_load_dwordx4 v12, s[8:11], s69 offen offset:1024 sc1 lds
  v_mfma_f32_16x16x32_bf16 v[52:55], v[220:223], v[100:103], v[52:55]
  ds_read_b128 v[84:87], v2 offset:31744
  v_mfma_f32_16x16x32_bf16 v[56:59], v[220:223], v[112:115], v[56:59]
  v_mfma_f32_16x16x32_bf16 v[56:59], v[208:211], v[108:111], v[56:59]
  v_mfma_f32_16x16x32_bf16 v[64:67], v[212:215], v[108:111], v[64:67]
  ds_read_b128 v[96:99], v2 offset:49152
  ds_read_b64_tr_b16 v[120:121], v6 offset:45056
  v_mfma_f32_16x16x32_bf16 v[64:67], v[224:227], v[112:115], v[64:67]
  ds_read_b64_tr_b16 v[122:123], v6 offset:47104
  buffer_load_dwordx4 v12, s[8:11], s69 offen offset:2048 sc1 lds
  s_waitcnt lgkmcnt(5)
  v_mfma_f32_16x16x32_bf16 v[36:39], v[116:119], v[28:31], v[36:39]
  v_mfma_f32_16x16x32_bf16 v[60:63], v[224:227], v[100:103], v[60:63]
  ds_read_b128 v[32:35], v41 offset:448
  v_mfma_f32_16x16x32_bf16 v[60:63], v[212:215], v[104:107], v[60:63]
  ds_read_b128 v[92:95], v2 offset:50176
  v_mfma_f32_16x16x32_bf16 v[68:71], v[216:219], v[104:107], v[68:71]
  v_mfma_f32_16x16x32_bf16 v[68:71], v[228:231], v[100:103], v[68:71]
  v_mfma_f32_16x16x32_bf16 v[72:75], v[228:231], v[112:115], v[72:75]
  ds_read_b128 v[104:107], v2 offset:57344
  buffer_load_dwordx4 v12, s[8:11], s69 offen offset:3072 sc1 lds
  v_mfma_f32_16x16x32_bf16 v[72:75], v[216:219], v[108:111], v[72:75]
  s_waitcnt lgkmcnt(6)
  v_mfma_f32_16x16x32_bf16 v[52:55], v[232:235], v[80:83], v[52:55]
  v_mfma_f32_16x16x32_bf16 v[52:55], v[244:247], v[76:79], v[52:55]
  ds_read_b128 v[100:103], v2 offset:58368
  v_mfma_f32_16x16x32_bf16 v[56:59], v[244:247], v[84:87], v[56:59]
  v_mfma_f32_16x16x32_bf16 v[56:59], v[232:235], v[88:91], v[56:59]
  s_waitcnt lgkmcnt(3)
  v_mfma_f32_16x16x32_bf16 v[36:39], v[120:123], v[32:35], v[36:39]
  v_mfma_f32_16x16x32_bf16 v[64:67], v[236:239], v[88:91], v[64:67]
  ds_read_b128 v[112:115], v2 offset:51200
  v_mfma_f32_16x16x32_bf16 v[64:67], v[248:251], v[84:87], v[64:67]
  v_mfma_f32_16x16x32_bf16 v[60:63], v[248:251], v[76:79], v[60:63]
  v_mfma_f32_16x16x32_bf16 v[60:63], v[236:239], v[80:83], v[60:63]
  ds_read_b128 v[108:111], v2 offset:52224
  s_nop 1
  buffer_store_dwordx4 v[36:39], v40, s[8:11], s52 offen sc1
  v_mfma_f32_16x16x32_bf16 v[68:71], v[240:243], v[80:83], v[68:71]
  v_mfma_f32_16x16x32_bf16 v[68:71], v[252:255], v[76:79], v[68:71]
  v_mfma_f32_16x16x32_bf16 v[72:75], v[252:255], v[84:87], v[72:75]
  ds_read_b128 v[80:83], v2 offset:59392
  v_mfma_f32_16x16x32_bf16 v[72:75], v[240:243], v[88:91], v[72:75]
  s_waitcnt lgkmcnt(3)
  v_mfma_f32_16x16x32_bf16 v[28:31], a[0:3], v[96:99], 0
  v_mfma_f32_16x16x32_bf16 v[28:31], a[12:15], v[92:95], v[28:31]
  ds_read_b128 v[76:79], v2 offset:60416
  v_mfma_f32_16x16x32_bf16 v[32:35], a[12:15], v[100:103], 0
  v_mfma_f32_16x16x32_bf16 v[32:35], a[0:3], v[104:107], v[32:35]
  v_cvt_pk_bf16_f32 v52, v52, v53
  v_cvt_pk_bf16_f32 v53, v54, v55
  v_mfma_f32_16x16x32_bf16 v[40:43], a[4:7], v[104:107], 0
  ds_read_b128 v[84:87], v2 offset:53248
  ds_write_b64 v18, v[52:53] offset:0
  v_mfma_f32_16x16x32_bf16 v[40:43], a[16:19], v[100:103], v[40:43]
  v_cvt_pk_bf16_f32 v60, v60, v61
  v_cvt_pk_bf16_f32 v61, v62, v63
  v_mfma_f32_16x16x32_bf16 v[36:39], a[16:19], v[92:95], 0
  v_cvt_pk_bf16_f32 v62, v68, v69
  v_cvt_pk_bf16_f32 v63, v70, v71
  v_mfma_f32_16x16x32_bf16 v[36:39], a[4:7], v[96:99], v[36:39]
  ds_read_b128 v[88:91], v2 offset:54272
  ds_write_b128 v17, v[60:63] offset:1024
  v_mfma_f32_16x16x32_bf16 v[44:47], a[8:11], v[96:99], 0
  v_cvt_pk_bf16_f32 v56, v56, v57
  v_cvt_pk_bf16_f32 v57, v58, v59
  v_mfma_f32_16x16x32_bf16 v[44:47], a[20:23], v[92:95], v[44:47]
  ds_write_b64 v18, v[56:57] offset:6144
  v_cvt_pk_bf16_f32 v64, v64, v65
  v_mfma_f32_16x16x32_bf16 v[48:51], a[20:23], v[100:103], 0
  ds_read_b128 v[96:99], v2 offset:61440
  v_cvt_pk_bf16_f32 v65, v66, v67
  v_mfma_f32_16x16x32_bf16 v[48:51], a[8:11], v[104:107], v[48:51]
  v_cvt_pk_bf16_f32 v66, v72, v73
  s_waitcnt lgkmcnt(6)
  v_mfma_f32_16x16x32_bf16 v[28:31], a[24:27], v[112:115], v[28:31]
  v_cvt_pk_bf16_f32 v67, v74, v75
  ds_write_b128 v17, v[64:67] offset:7168
  v_mfma_f32_16x16x32_bf16 v[28:31], a[36:39], v[108:111], v[28:31]
  ds_read_b128 v[92:95], v2 offset:62464
  v_mfma_f32_16x16x32_bf16 v[32:35], a[36:39], v[76:79], v[32:35]
  s_bitcmp1_b32 s44, 0
  s_mov_b32 s52, 0
  s_cselect_b32 s52, 6144, s52
  s_mov_b32 s53, 12288
  s_cselect_b32 s53, 0, s53
  v_mfma_f32_16x16x32_bf16 v[32:35], a[24:27], v[80:83], v[32:35]
  v_mfma_f32_16x16x32_bf16 v[40:43], a[28:31], v[80:83], v[40:43]
  ds_read_b128 v[100:103], v2 offset:55296
  v_add_u32 v116, s52, v19
  v_mfma_f32_16x16x32_bf16 v[40:43], a[40:43], v[76:79], v[40:43]
  v_add_u32 v117, s53, v19
  v_add_u32 v118, s52, v20
  v_mfma_f32_16x16x32_bf16 v[36:39], a[40:43], v[108:111], v[36:39]
  v_add_u32 v119, s53, v20
  v_mfma_f32_16x16x32_bf16 v[36:39], a[28:31], v[112:115], v[36:39]
  ds_read_b128 v[104:107], v2 offset:56320
  v_mfma_f32_16x16x32_bf16 v[44:47], a[32:35], v[112:115], v[44:47]
  v_mfma_f32_16x16x32_bf16 v[44:47], a[44:47], v[108:111], v[44:47]
  s_waitcnt vmcnt(14) lgkmcnt(3)
  s_barrier
  v_mfma_f32_16x16x32_bf16 v[48:51], a[44:47], v[76:79], v[48:51]
  ds_read_b128 v[112:115], v2 offset:63488
  s_add_u32 m0, s45, 16384
  s_add_u32 s68, s67, 0
  s_and_b32 s68, s68, 7
  s_mul_i32 s68, s68, 262144
  v_mfma_f32_16x16x32_bf16 v[48:51], a[32:35], v[80:83], v[48:51]
  buffer_load_dwordx4 v10, s[16:19], s68 offen lds
  s_waitcnt lgkmcnt(3)
  v_mfma_f32_16x16x32_bf16 v[28:31], a[48:51], v[84:87], v[28:31]
  ds_read_b128 v[52:55], v116
  ds_read_b128 v[56:59], v117 offset:1024
  v_mfma_f32_16x16x32_bf16 v[28:31], a[60:63], v[88:91], v[28:31]
  ds_read_b128 v[108:111], v2 offset:64512
  ds_read_b128 v[60:63], v116 offset:1024
  v_mfma_f32_16x16x32_bf16 v[32:35], a[60:63], v[92:95], v[32:35]
  ds_read_b64_tr_b16 v[64:65], v119 offset:2048
  ds_read_b64_tr_b16 v[66:67], v118 offset:2048
  v_mfma_f32_16x16x32_bf16 v[32:35], a[48:51], v[96:99], v[32:35]
  s_add_u32 m0, s45, 20480
  s_add_u32 s68, s68, 65536
  v_mfma_f32_16x16x32_bf16 v[40:43], a[52:55], v[96:99], v[40:43]
  ds_read_b128 v[76:79], v1 offset:32768
  buffer_load_dwordx4 v10, s[16:19], s68 offen lds
  v_mfma_f32_16x16x32_bf16 v[40:43], a[64:67], v[92:95], v[40:43]
  ds_read_b64_tr_b16 v[68:69], v119 offset:2056
  ds_read_b64_tr_b16 v[70:71], v118 offset:2056
  v_mfma_f32_16x16x32_bf16 v[36:39], a[64:67], v[88:91], v[36:39]
  v_mfma_f32_16x16x32_bf16 v[36:39], a[52:55], v[84:87], v[36:39]
  ds_read_b128 v[80:83], v1 offset:33792
  v_mfma_f32_16x16x32_bf16 v[44:47], a[56:59], v[84:87], v[44:47]
  s_add_u32 m0, s45, 24576
  s_add_u32 s68, s68, 65536
  v_mfma_f32_16x16x32_bf16 v[44:47], a[68:71], v[88:91], v[44:47]
  buffer_load_dwordx4 v10, s[16:19], s68 offen lds
  v_mfma_f32_16x16x32_bf16 v[48:51], a[68:71], v[92:95], v[48:51]
  ds_read_b128 v[84:87], v1 offset:40960
  s_waitcnt lgkmcnt(2)
  v_mfma_f32_16x16x32_bf16 v[48:51], a[56:59], v[96:99], v[48:51]
  s_waitcnt lgkmcnt(8)
  v_mfma_f32_16x16x32_bf16 v[28:31], a[72:75], v[100:103], v[28:31]
  v_mfma_f32_16x16x32_bf16 v[116:119], v[56:59], v[52:55], 0
  v_mfma_f32_16x16x32_bf16 v[28:31], a[84:87], v[104:107], v[28:31]
  ds_read_b128 v[88:91], v1 offset:41984
  s_add_u32 m0, s45, 28672
  s_add_u32 s68, s68, 65536
  v_mfma_f32_16x16x32_bf16 v[32:35], a[84:87], v[108:111], v[32:35]
  buffer_load_dwordx4 v10, s[16:19], s68 offen lds
  v_mfma_f32_16x16x32_bf16 v[32:35], a[72:75], v[112:115], v[32:35]
  v_mfma_f32_16x16x32_bf16 v[120:123], v[60:63], v[52:55], 0
  v_mfma_f32_16x16x32_bf16 v[40:43], a[76:79], v[112:115], v[40:43]
  ds_read_b128 v[92:95], v1 offset:34816
  v_mfma_f32_16x16x32_bf16 v[40:43], a[88:91], v[108:111], v[40:43]
  v_mfma_f32_16x16x32_bf16 v[36:39], a[88:91], v[104:107], v[36:39]
  s_add_u32 m0, s70, 81920
  s_add_u32 s69, s59, 229376
  v_mfma_f32_16x16x32_bf16 v[36:39], a[76:79], v[100:103], v[36:39]
  ds_read_b128 v[96:99], v1 offset:35840
  buffer_load_dwordx4 v12, s[8:11], s69 offen offset:0 sc1 lds
  v_mfma_f32_16x16x32_bf16 v[44:47], a[80:83], v[100:103], v[44:47]
  v_cndmask_b32 v72, v116, v120, s[80:81]
  v_cndmask_b32 v73, v117, v121, s[82:83]
  v_mfma_f32_16x16x32_bf16 v[44:47], a[92:95], v[104:107], v[44:47]
  v_cndmask_b32 v74, v118, v122, s[84:85]
  v_cndmask_b32 v75, v119, v123, s[86:87]
  v_mfma_f32_16x16x32_bf16 v[48:51], a[92:95], v[108:111], v[48:51]
  ds_read_b128 v[100:103], v1 offset:43008
  v_cndmask_b32 v72, v72, v73, s[88:89]
  v_mfma_f32_16x16x32_bf16 v[48:51], a[80:83], v[112:115], v[48:51]
  v_cndmask_b32 v73, v74, v75, s[88:89]
  s_waitcnt lgkmcnt(3)
  v_mfma_f32_16x16x32_bf16 v[28:31], a[96:99], v[76:79], v[28:31]
  buffer_load_dwordx4 v12, s[8:11], s69 offen offset:1024 sc1 lds
  v_mul_f32 v72, 0x3e8293ee, v72
HOP3:
  s_cbranch_execz WRET0
  v_mfma_f32_16x16x32_bf16 v[28:31], a[108:111], v[80:83], v[28:31]
  ds_read_b128 v[104:107], v1 offset:44032
  v_mul_f32 v73, 0x3e8293ee, v73
  v_mfma_f32_16x16x32_bf16 v[32:35], a[108:111], v[88:91], v[32:35]
  v_max_f32 v74, v72, v73
  v_mov_b32 v75, v74
  v_mfma_f32_16x16x32_bf16 v[32:35], a[96:99], v[84:87], v[32:35]
  s_nop 0
  v_permlane16_swap_b32 v74, v75
  v_max_f32 v74, v74, v75
  v_mfma_f32_16x16x32_bf16 v[40:43], a[100:103], v[84:87], v[40:43]
  ds_read_b128 v[108:111], v1 offset:36864
  v_mov_b32 v75, v74
  v_mfma_f32_16x16x32_bf16 v[40:43], a[112:115], v[88:91], v[40:43]
  buffer_load_dwordx4 v12, s[8:11], s69 offen offset:2048 sc1 lds
  v_permlane32_swap_b32 v74, v75
  v_mfma_f32_16x16x32_bf16 v[36:39], a[112:115], v[80:83], v[36:39]
  v_max_f32 v74, v74, v75
  v_sub_f32 v72, v72, v74
  v_mfma_f32_16x16x32_bf16 v[36:39], a[100:103], v[76:79], v[36:39]
  ds_read_b128 v[112:115], v1 offset:37888
  v_sub_f32 v73, v73, v74
  v_mfma_f32_16x16x32_bf16 v[44:47], a[104:107], v[76:79], v[44:47]
  v_exp_f32 v72, v72
  v_mfma_f32_16x16x32_bf16 v[44:47], a[116:119], v[80:83], v[44:47]
  v_exp_f32 v73, v73
  v_mfma_f32_16x16x32_bf16 v[48:51], a[116:119], v[88:91], v[48:51]
  ds_read_b128 v[76:79], v1 offset:45056
  buffer_load_dwordx4 v12, s[8:11], s69 offen offset:3072 sc1 lds
  v_mfma_f32_16x16x32_bf16 v[48:51], a[104:107], v[84:87], v[48:51]
  v_add_f32 v74, v72, v73
  s_waitcnt lgkmcnt(3)
  v_mfma_f32_16x16x32_bf16 v[28:31], a[120:123], v[92:95], v[28:31]
  v_mov_b32 v75, v74
  v_mfma_f32_16x16x32_bf16 v[28:31], a[132:135], v[96:99], v[28:31]
  ds_read_b128 v[80:83], v1 offset:46080
  v_permlane16_swap_b32 v74, v75
  v_mfma_f32_16x16x32_bf16 v[32:35], a[132:135], v[104:107], v[32:35]
  s_add_u32 m0, s45, 98304
  s_add_u32 s68, s67, 1
  s_and_b32 s68, s68, 7
  s_mul_i32 s68, s68, 262144
  v_mfma_f32_16x16x32_bf16 v[32:35], a[120:123], v[100:103], v[32:35]
  buffer_load_dwordx4 v10, s[16:19], s68 offen lds
  v_add_f32 v74, v74, v75
  v_mfma_f32_16x16x32_bf16 v[40:43], a[124:127], v[100:103], v[40:43]
  ds_read_b128 v[88:91], v1 offset:38912
  v_mov_b32 v75, v74
  v_mfma_f32_16x16x32_bf16 v[40:43], a[136:139], v[104:107], v[40:43]
  s_nop 0
  v_permlane32_swap_b32 v74, v75
  v_add_f32 v74, v74, v75
  v_mfma_f32_16x16x32_bf16 v[36:39], a[136:139], v[96:99], v[36:39]
  v_rcp_f32 v74, v74
  v_mfma_f32_16x16x32_bf16 v[36:39], a[124:127], v[92:95], v[36:39]
  ds_read_b128 v[84:87], v1 offset:39936
  s_add_u32 m0, s45, 102400
  s_add_u32 s68, s68, 65536
  v_mfma_f32_16x16x32_bf16 v[44:47], a[128:131], v[92:95], v[44:47]
  buffer_load_dwordx4 v10, s[16:19], s68 offen lds
  v_mul_f32 v72, v72, v74
  v_mfma_f32_16x16x32_bf16 v[44:47], a[140:143], v[96:99], v[44:47]
  v_mul_f32 v73, v73, v74
  v_cvt_pk_bf16_f32 v72, v72, v72
  v_mfma_f32_16x16x32_bf16 v[48:51], a[140:143], v[104:107], v[48:51]
  ds_read_b128 v[92:95], v1 offset:47104
  v_cvt_pk_bf16_f32 v73, v73, v73
  v_mfma_f32_16x16x32_bf16 v[48:51], a[128:131], v[100:103], v[48:51]
  v_and_b32 v52, v24, v72
  s_waitcnt lgkmcnt(3)
  v_mfma_f32_16x16x32_bf16 v[28:31], a[144:147], v[108:111], v[28:31]
  s_add_u32 m0, s45, 106496
  s_add_u32 s68, s68, 65536
  v_mfma_f32_16x16x32_bf16 v[28:31], a[156:159], v[112:115], v[28:31]
  ds_read_b128 v[96:99], v1 offset:48128
  buffer_load_dwordx4 v10, s[16:19], s68 offen lds
  v_mfma_f32_16x16x32_bf16 v[32:35], a[156:159], v[80:83], v[32:35]
  v_and_b32 v53, v25, v73
  v_and_b32 v54, v26, v72
  v_mfma_f32_16x16x32_bf16 v[32:35], a[144:147], v[76:79], v[32:35]
  s_waitcnt vmcnt(11)
  s_barrier
  v_mfma_f32_16x16x32_bf16 v[40:43], a[148:151], v[76:79], v[40:43]
  ds_read_b128 v[104:107], v1 offset:49152
  v_and_b32 v55, v27, v73
  v_add_u32 v15, s46, v0
  s_mov_b64 exec, 1
  buffer_store_dword v15, v0, s[8:11], s79 offen offset:0 sc1
  s_mov_b64 exec, -1
  v_mfma_f32_16x16x32_bf16 v[40:43], a[160:163], v[80:83], v[40:43]
  s_add_u32 m0, s45, 110592
  s_add_u32 s68, s68, 65536
  v_mfma_f32_16x16x32_bf16 v[36:39], a[160:163], v[112:115], v[36:39]
  buffer_load_dwordx4 v10, s[16:19], s68 offen lds
  v_mfma_f32_16x16x32_bf16 v[36:39], a[148:151], v[108:111], v[36:39]
  ds_read_b128 v[100:103], v1 offset:50176
  v_mfma_f32_16x16x32_bf16 v[56:59], v[64:67], v[52:55], 0
  v_mfma_f32_16x16x32_bf16 v[44:47], a[152:155], v[108:111], v[44:47]
  v_mfma_f32_16x16x32_bf16 v[60:63], v[68:71], v[52:55], 0
  v_mfma_f32_16x16x32_bf16 v[44:47], a[164:167], v[112:115], v[44:47]
  v_mfma_f32_16x16x32_bf16 v[48:51], a[164:167], v[80:83], v[48:51]
  ds_read_b128 v[108:111], v1 offset:57344
  s_cmp_gt_u32 s44, 1
  s_cbranch_scc1 TH5_adaLN_cond__sliding_local_dilated__swiglu_ffn__prompt_kernel
  s_cmp_eq_u32 s44, 0
  s_cselect_b64 s[4:5], s[28:29], s[32:33]
  s_lshr_b32 s57, s2, 3
  s_mul_i32 s57, s57, 57344
  s_and_b32 vcc_lo, s2, 7
  s_mul_i32 vcc_lo, vcc_lo, 896
  s_add_u32 s57, s57, vcc_lo
  v_lshrrev_b32 v15, 3, v0
  v_mul_u32_u24 v15, 6144, v15
  v_lshl_add_u32 v15, v0, 7, v15
  s_mov_b32 exec_lo, 0x7f7f7f7f
  s_mov_b32 exec_hi, 0x7f7f7f7f
  buffer_load_dword a253, v15, s[4:7], s57 offen
  s_mov_b64 exec, -1
TH5_adaLN_cond__sliding_local_dilated__swiglu_ffn__prompt_kernel:
  s_add_u32 m0, s70, 114688
  s_add_u32 s69, s60, 229376
  v_mfma_f32_16x16x32_bf16 v[48:51], a[152:155], v[76:79], v[48:51]
  buffer_load_dwordx4 v12, s[8:11], s69 offen offset:0 sc1 lds
  s_waitcnt lgkmcnt(3)
  v_mfma_f32_16x16x32_bf16 v[28:31], a[168:171], v[88:91], v[28:31]
  v_cvt_pk_bf16_f32 v116, v56, v57
  v_cvt_pk_bf16_f32 v117, v58, v59
  v_mfma_f32_16x16x32_bf16 v[28:31], a[180:183], v[84:87], v[28:31]
  ds_read_b128 v[112:115], v1 offset:58368
  v_cvt_pk_bf16_f32 v118, v60, v61
  v_mfma_f32_16x16x32_bf16 v[32:35], a[180:183], v[96:99], v[32:35]
  v_cvt_pk_bf16_f32 v119, v62, v63
  buffer_store_dwordx4 v[116:119], v1, s[8:11], s73 offen sc1
  v_mfma_f32_16x16x32_bf16 v[32:35], a[168:171], v[92:95], v[32:35]
  s_add_u32 s73, s73, 65536
  v_mfma_f32_16x16x32_bf16 v[40:43], a[172:175], v[92:95], v[40:43]
  ds_read_b128 v[80:83], v1 offset:51200
  buffer_load_dwordx4 v12, s[8:11], s69 offen offset:1024 sc1 lds
  v_mfma_f32_16x16x32_bf16 v[40:43], a[184:187], v[96:99], v[40:43]
  v_mfma_f32_16x16x32_bf16 v[36:39], a[184:187], v[84:87], v[36:39]
  v_mfma_f32_16x16x32_bf16 v[36:39], a[172:175], v[88:91], v[36:39]
  ds_read_b128 v[76:79], v1 offset:52224
  v_mfma_f32_16x16x32_bf16 v[44:47], a[176:179], v[88:91], v[44:47]
  v_mfma_f32_16x16x32_bf16 v[44:47], a[188:191], v[84:87], v[44:47]
  buffer_load_dwordx4 v12, s[8:11], s69 offen offset:2048 sc1 lds
  v_mfma_f32_16x16x32_bf16 v[48:51], a[188:191], v[96:99], v[48:51]
  ds_read_b128 v[88:91], v1 offset:59392
  v_mfma_f32_16x16x32_bf16 v[48:51], a[176:179], v[92:95], v[48:51]
  s_waitcnt lgkmcnt(3)
  v_mfma_f32_16x16x32_bf16 v[28:31], a[192:195], v[104:107], v[28:31]
  v_mfma_f32_16x16x32_bf16 v[28:31], a[204:207], v[100:103], v[28:31]
  ds_read_b128 v[84:87], v1 offset:60416
  v_mfma_f32_16x16x32_bf16 v[32:35], a[204:207], v[112:115], v[32:35]
  buffer_load_dwordx4 v12, s[8:11], s69 offen offset:3072 sc1 lds
  v_mfma_f32_16x16x32_bf16 v[32:35], a[192:195], v[108:111], v[32:35]
  v_mfma_f32_16x16x32_bf16 v[40:43], a[196:199], v[108:111], v[40:43]
  ds_read_b128 v[96:99], v1 offset:53248
  v_mfma_f32_16x16x32_bf16 v[40:43], a[208:211], v[112:115], v[40:43]
  v_mfma_f32_16x16x32_bf16 v[36:39], a[208:211], v[100:103], v[36:39]
  v_mfma_f32_16x16x32_bf16 v[36:39], a[196:199], v[104:107], v[36:39]
  ds_read_b128 v[92:95], v1 offset:54272
  v_mfma_f32_16x16x32_bf16 v[44:47], a[200:203], v[104:107], v[44:47]
  v_mfma_f32_16x16x32_bf16 v[44:47], a[212:215], v[100:103], v[44:47]
  v_mfma_f32_16x16x32_bf16 v[48:51], a[212:215], v[112:115], v[48:51]
  ds_read_b128 v[104:107], v1 offset:61440
  v_mfma_f32_16x16x32_bf16 v[48:51], a[200:203], v[108:111], v[48:51]
  s_waitcnt lgkmcnt(3)
  v_mfma_f32_16x16x32_bf16 v[28:31], a[216:219], v[80:83], v[28:31]
  v_mfma_f32_16x16x32_bf16 v[28:31], a[228:231], v[76:79], v[28:31]
  ds_read_b128 v[100:103], v1 offset:62464
  v_mfma_f32_16x16x32_bf16 v[32:35], a[228:231], v[84:87], v[32:35]
  v_lshrrev_b32 v116, 3, v0
  v_bfe_u32 v117, v116, 1, 2
  v_mfma_f32_16x16x32_bf16 v[32:35], a[216:219], v[88:91], v[32:35]
  v_bfe_u32 v118, v0, 1, 2
  v_xor_b32 v117, v117, v118
  v_mfma_f32_16x16x32_bf16 v[40:43], a[220:223], v[88:91], v[40:43]
  ds_read_b128 v[112:115], v1 offset:55296
  s_lshl_b32 s52, s44, 3
  v_mfma_f32_16x16x32_bf16 v[40:43], a[232:235], v[84:87], v[40:43]
  v_add_u32 v116, s52, v116
  v_mul_u32_u24 v116, 7168, v116
  v_mfma_f32_16x16x32_bf16 v[36:39], a[232:235], v[76:79], v[36:39]
  v_and_b32 v118, 1, v0
  v_lshl_add_u32 v116, v118, 4, v116
  v_mfma_f32_16x16x32_bf16 v[36:39], a[220:223], v[80:83], v[36:39]
  ds_read_b128 v[108:111], v1 offset:56320
  s_and_b32 s52, s2, 7
  v_mfma_f32_16x16x32_bf16 v[44:47], a[224:227], v[80:83], v[44:47]
  s_mul_i32 s52, s52, 896
  v_add_u32 v116, s52, v116
  v_mfma_f32_16x16x32_bf16 v[44:47], a[236:239], v[76:79], v[44:47]
  v_lshlrev_b32 v118, 5, v117
  s_and_b32 s53, s2, 24
  v_mfma_f32_16x16x32_bf16 v[48:51], a[236:239], v[84:87], v[48:51]
  ds_read_b128 v[80:83], v1 offset:63488
  s_lshl_b32 s52, s53, 5
  v_mfma_f32_16x16x32_bf16 v[48:51], a[224:227], v[88:91], v[48:51]
  v_add3_u32 v16, v116, v118, s52
  s_waitcnt lgkmcnt(3)
  v_mfma_f32_16x16x32_bf16 v[28:31], a[240:243], v[96:99], v[28:31]
  s_lshr_b32 s52, 0x0b070602, s53
  s_and_b32 s52, s52, 15
  v_mfma_f32_16x16x32_bf16 v[28:31], v[124:127], v[92:95], v[28:31]
  ds_read_b128 v[76:79], v1 offset:64512
  s_lshl_b32 s52, s52, 6
  v_mfma_f32_16x16x32_bf16 v[32:35], v[124:127], v[100:103], v[32:35]
  v_add_u32 v118, s52, v118
  s_lshr_b32 s52, 0x15140706, s53
  v_mfma_f32_16x16x32_bf16 v[32:35], a[240:243], v[104:107], v[32:35]
  s_waitcnt vmcnt(23)
  s_barrier
  v_mfma_f32_16x16x32_bf16 v[40:43], a[244:247], v[104:107], v[40:43]
  ds_read_b128 v[84:87], v2 offset:0
  s_add_u32 m0, s45, 32768
  s_add_u32 s68, s67, 2
  s_and_b32 s68, s68, 7
  s_mul_i32 s68, s68, 262144
  v_mfma_f32_16x16x32_bf16 v[40:43], v[128:131], v[100:103], v[40:43]
  buffer_load_dwordx4 v10, s[16:19], s68 offen lds
  s_and_b32 s52, s52, 31
  v_mfma_f32_16x16x32_bf16 v[36:39], v[128:131], v[92:95], v[36:39]
  s_lshl_b32 s52, s52, 5
  v_mov_b32 v119, s52
  v_mfma_f32_16x16x32_bf16 v[36:39], a[244:247], v[96:99], v[36:39]
  ds_read_b128 v[88:91], v2 offset:1024
  v_mfma_f32_16x16x32_bf16 v[44:47], a[248:251], v[96:99], v[44:47]
  v_cmp_gt_u32 vcc, 2, v117
  s_nop 1
  v_cndmask_b32 v118, v119, v118, vcc
  v_mfma_f32_16x16x32_bf16 v[44:47], v[132:135], v[92:95], v[44:47]
  s_add_u32 m0, s45, 36864
  s_add_u32 s68, s68, 65536
  v_mfma_f32_16x16x32_bf16 v[48:51], v[132:135], v[100:103], v[48:51]
  ds_read_b128 v[96:99], v2 offset:8192
  buffer_load_dwordx4 v10, s[16:19], s68 offen lds
  v_mfma_f32_16x16x32_bf16 v[48:51], a[248:251], v[104:107], v[48:51]
  v_add_u32 v11, v116, v118
  s_waitcnt lgkmcnt(3)
  v_mfma_f32_16x16x32_bf16 v[28:31], v[136:139], v[112:115], v[28:31]
  v_mfma_f32_16x16x32_bf16 v[28:31], v[148:151], v[108:111], v[28:31]
  ds_read_b128 v[92:95], v2 offset:9216
  v_mfma_f32_16x16x32_bf16 v[32:35], v[148:151], v[76:79], v[32:35]
  s_add_u32 m0, s45, 40960
  s_add_u32 s68, s68, 65536
  v_mfma_f32_16x16x32_bf16 v[32:35], v[136:139], v[80:83], v[32:35]
  buffer_load_dwordx4 v10, s[16:19], s68 offen lds
  v_mfma_f32_16x16x32_bf16 v[40:43], v[140:143], v[80:83], v[40:43]
  ds_read_b128 v[100:103], v2 offset:2048
  v_mfma_f32_16x16x32_bf16 v[40:43], v[152:155], v[76:79], v[40:43]
  v_mfma_f32_16x16x32_bf16 v[36:39], v[152:155], v[108:111], v[36:39]
  s_add_u32 m0, s45, 45056
  s_add_u32 s68, s68, 65536
  v_mfma_f32_16x16x32_bf16 v[36:39], v[140:143], v[112:115], v[36:39]
  ds_read_b128 v[104:107], v2 offset:3072
  buffer_load_dwordx4 v10, s[16:19], s68 offen lds
  v_mfma_f32_16x16x32_bf16 v[44:47], v[144:147], v[112:115], v[44:47]
  v_mfma_f32_16x16x32_bf16 v[44:47], v[156:159], v[108:111], v[44:47]
  v_mfma_f32_16x16x32_bf16 v[48:51], v[156:159], v[76:79], v[48:51]
  ds_read_b128 v[112:115], v2 offset:10240
  v_mfma_f32_16x16x32_bf16 v[48:51], v[144:147], v[80:83], v[48:51]
  s_waitcnt lgkmcnt(3)
  v_mfma_f32_16x16x32_bf16 v[28:31], v[160:163], v[84:87], v[28:31]
  v_mfma_f32_16x16x32_bf16 v[28:31], v[172:175], v[88:91], v[28:31]
  ds_read_b128 v[108:111], v2 offset:11264
  v_mfma_f32_16x16x32_bf16 v[32:35], v[172:175], v[92:95], v[32:35]
  v_mfma_f32_16x16x32_bf16 v[32:35], v[160:163], v[96:99], v[32:35]
  v_mfma_f32_16x16x32_bf16 v[40:43], v[164:167], v[96:99], v[40:43]
  ds_read_b128 v[76:79], v2 offset:4096
  v_mfma_f32_16x16x32_bf16 v[40:43], v[176:179], v[92:95], v[40:43]
  v_mfma_f32_16x16x32_bf16 v[36:39], v[176:179], v[88:91], v[36:39]
  v_mfma_f32_16x16x32_bf16 v[36:39], v[164:167], v[84:87], v[36:39]
  ds_read_b128 v[80:83], v2 offset:5120
  v_mfma_f32_16x16x32_bf16 v[44:47], v[168:171], v[84:87], v[44:47]
  v_mfma_f32_16x16x32_bf16 v[44:47], v[180:183], v[88:91], v[44:47]
  v_mfma_f32_16x16x32_bf16 v[48:51], v[180:183], v[92:95], v[48:51]
  ds_read_b128 v[84:87], v2 offset:12288
  v_mfma_f32_16x16x32_bf16 v[48:51], v[168:171], v[96:99], v[48:51]
  s_waitcnt lgkmcnt(3)
  v_mfma_f32_16x16x32_bf16 v[28:31], v[184:187], v[100:103], v[28:31]
  v_mfma_f32_16x16x32_bf16 v[28:31], v[196:199], v[104:107], v[28:31]
  ds_read_b128 v[88:91], v2 offset:13312
  v_add_u32 v15, s46, v0
  v_add_u32 v15, 1, v15
  s_waitcnt vmcnt(7)
  s_barrier
  s_mov_b64 exec, 1
  buffer_store_dword v15, v0, s[8:11], s74 offen offset:0 sc1
  s_mov_b64 exec, -1
  v_mfma_f32_16x16x32_bf16 v[32:35], v[196:199], v[108:111], v[32:35]
  v_mfma_f32_16x16x32_bf16 v[32:35], v[184:187], v[112:115], v[32:35]
  v_mfma_f32_16x16x32_bf16 v[40:43], v[188:191], v[112:115], v[40:43]
  ds_read_b128 v[92:95], v2 offset:6144
  v_mfma_f32_16x16x32_bf16 v[40:43], v[200:203], v[108:111], v[40:43]
  v_mfma_f32_16x16x32_bf16 v[36:39], v[200:203], v[104:107], v[36:39]
  v_mfma_f32_16x16x32_bf16 v[36:39], v[188:191], v[100:103], v[36:39]
  ds_read_b128 v[96:99], v2 offset:7168
  v_mfma_f32_16x16x32_bf16 v[44:47], v[192:195], v[100:103], v[44:47]
  v_mfma_f32_16x16x32_bf16 v[44:47], v[204:207], v[104:107], v[44:47]
  v_mfma_f32_16x16x32_bf16 v[48:51], v[204:207], v[108:111], v[48:51]
  ds_read_b128 v[100:103], v2 offset:14336
  v_mfma_f32_16x16x32_bf16 v[48:51], v[192:195], v[112:115], v[48:51]
  s_waitcnt lgkmcnt(3)
  v_mfma_f32_16x16x32_bf16 v[28:31], v[208:211], v[76:79], v[28:31]
  v_mfma_f32_16x16x32_bf16 v[28:31], v[220:223], v[80:83], v[28:31]
  ds_read_b128 v[104:107], v2 offset:15360
  v_mfma_f32_16x16x32_bf16 v[32:35], v[220:223], v[88:91], v[32:35]
  v_mfma_f32_16x16x32_bf16 v[32:35], v[208:211], v[84:87], v[32:35]
  s_waitcnt vmcnt(24)
  s_barrier
  v_mfma_f32_16x16x32_bf16 v[40:43], v[212:215], v[84:87], v[40:43]
  ds_read_b128 v[108:111], v1 offset:0
  s_add_u32 m0, s45, 49152
  s_add_u32 s68, s67, 3
  s_and_b32 s68, s68, 7
  s_mul_i32 s68, s68, 262144
  v_mfma_f32_16x16x32_bf16 v[40:43], v[224:227], v[88:91], v[40:43]
  buffer_load_dwordx4 v10, s[16:19], s68 offen lds
  v_mfma_f32_16x16x32_bf16 v[36:39], v[224:227], v[80:83], v[36:39]
  v_mfma_f32_16x16x32_bf16 v[36:39], v[212:215], v[76:79], v[36:39]
  ds_read_b128 v[112:115], v1 offset:1024
  v_mfma_f32_16x16x32_bf16 v[44:47], v[216:219], v[76:79], v[44:47]
  s_add_u32 m0, s45, 53248
  s_add_u32 s68, s68, 65536
  v_mfma_f32_16x16x32_bf16 v[44:47], v[228:231], v[80:83], v[44:47]
  buffer_load_dwordx4 v10, s[16:19], s68 offen lds
  v_mfma_f32_16x16x32_bf16 v[48:51], v[228:231], v[88:91], v[48:51]
  ds_read_b128 v[76:79], v1 offset:8192
  v_mfma_f32_16x16x32_bf16 v[48:51], v[216:219], v[84:87], v[48:51]
  s_add_u32 m0, s45, 57344
  s_add_u32 s68, s68, 65536
  s_waitcnt lgkmcnt(3)
  v_mfma_f32_16x16x32_bf16 v[28:31], v[232:235], v[92:95], v[28:31]
  buffer_load_dwordx4 v10, s[16:19], s68 offen lds
  v_mfma_f32_16x16x32_bf16 v[28:31], v[244:247], v[96:99], v[28:31]
  ds_read_b128 v[80:83], v1 offset:9216
  v_mfma_f32_16x16x32_bf16 v[32:35], v[244:247], v[104:107], v[32:35]
  v_mfma_f32_16x16x32_bf16 v[32:35], v[232:235], v[100:103], v[32:35]
  s_add_u32 m0, s45, 61440
  s_add_u32 s68, s68, 65536
  v_mfma_f32_16x16x32_bf16 v[40:43], v[236:239], v[100:103], v[40:43]
  ds_read_b128 v[88:91], v1 offset:2048
  buffer_load_dwordx4 v10, s[16:19], s68 offen lds
  v_mfma_f32_16x16x32_bf16 v[40:43], v[248:251], v[104:107], v[40:43]
  v_mfma_f32_16x16x32_bf16 v[36:39], v[248:251], v[96:99], v[36:39]
  v_mfma_f32_16x16x32_bf16 v[36:39], v[236:239], v[92:95], v[36:39]
  ds_read_b128 v[84:87], v1 offset:3072
  v_mfma_f32_16x16x32_bf16 v[44:47], v[240:243], v[92:95], v[44:47]
  v_mfma_f32_16x16x32_bf16 v[44:47], v[252:255], v[96:99], v[44:47]
  v_mfma_f32_16x16x32_bf16 v[48:51], v[252:255], v[104:107], v[48:51]
  ds_read_b128 v[92:95], v1 offset:10240
  v_mfma_f32_16x16x32_bf16 v[48:51], v[240:243], v[100:103], v[48:51]
  s_waitcnt lgkmcnt(3)
  v_mfma_f32_16x16x32_bf16 v[52:55], a[0:3], v[108:111], 0
  v_mfma_f32_16x16x32_bf16 v[52:55], a[12:15], v[112:115], v[52:55]
  ds_read_b128 v[96:99], v1 offset:11264
  v_mfma_f32_16x16x32_bf16 v[56:59], a[12:15], v[80:83], 0
  v_mfma_f32_16x16x32_bf16 v[56:59], a[0:3], v[76:79], v[56:59]
  v_cvt_pk_bf16_f32 v28, v28, v29
  v_cvt_pk_bf16_f32 v29, v30, v31
  v_mfma_f32_16x16x32_bf16 v[64:67], a[4:7], v[76:79], 0
  ds_read_b128 v[104:107], v1 offset:4096
  ds_write_b64 v18, v[28:29] offset:12288
  v_mfma_f32_16x16x32_bf16 v[64:67], a[16:19], v[80:83], v[64:67]
  v_cvt_pk_bf16_f32 v36, v36, v37
  v_cvt_pk_bf16_f32 v37, v38, v39
  v_mfma_f32_16x16x32_bf16 v[60:63], a[16:19], v[112:115], 0
  v_cvt_pk_bf16_f32 v38, v44, v45
  v_cvt_pk_bf16_f32 v39, v46, v47
  v_mfma_f32_16x16x32_bf16 v[60:63], a[4:7], v[108:111], v[60:63]
  ds_read_b128 v[100:103], v1 offset:5120
  ds_write_b128 v17, v[36:39] offset:13312
  v_mfma_f32_16x16x32_bf16 v[68:71], a[8:11], v[108:111], 0
  v_cvt_pk_bf16_f32 v32, v32, v33
  v_cvt_pk_bf16_f32 v33, v34, v35
  v_mfma_f32_16x16x32_bf16 v[68:71], a[20:23], v[112:115], v[68:71]
  ds_write_b64 v18, v[32:33] offset:0
  v_cvt_pk_bf16_f32 v40, v40, v41
  v_mfma_f32_16x16x32_bf16 v[72:75], a[20:23], v[80:83], 0
  ds_read_b128 v[108:111], v1 offset:12288
  v_cvt_pk_bf16_f32 v41, v42, v43
  v_mfma_f32_16x16x32_bf16 v[72:75], a[8:11], v[76:79], v[72:75]
  v_cvt_pk_bf16_f32 v42, v48, v49
  s_waitcnt lgkmcnt(6)
  v_mfma_f32_16x16x32_bf16 v[52:55], a[24:27], v[88:91], v[52:55]
  v_cvt_pk_bf16_f32 v43, v50, v51
  ds_write_b128 v17, v[40:43] offset:1024
  v_mfma_f32_16x16x32_bf16 v[52:55], a[36:39], v[84:87], v[52:55]
  ds_read_b128 v[112:115], v1 offset:13312
  v_mfma_f32_16x16x32_bf16 v[56:59], a[36:39], v[96:99], v[56:59]
  s_bitcmp1_b32 s44, 0
  s_mov_b32 s52, 12288
  s_cselect_b32 s52, 0, s52
  s_mov_b32 s53, 6144
  s_cselect_b32 s53, 12288, s53
  v_mfma_f32_16x16x32_bf16 v[56:59], a[24:27], v[92:95], v[56:59]
  v_mfma_f32_16x16x32_bf16 v[64:67], a[28:31], v[92:95], v[64:67]
  ds_read_b128 v[80:83], v1 offset:6144
  v_add_u32 v116, s52, v19
  v_mfma_f32_16x16x32_bf16 v[64:67], a[40:43], v[96:99], v[64:67]
  v_add_u32 v117, s53, v19
  v_add_u32 v118, s52, v20
  v_mfma_f32_16x16x32_bf16 v[60:63], a[40:43], v[84:87], v[60:63]
  v_add_u32 v119, s53, v20
  v_mfma_f32_16x16x32_bf16 v[60:63], a[28:31], v[88:91], v[60:63]
  ds_read_b128 v[76:79], v1 offset:7168
  v_mfma_f32_16x16x32_bf16 v[68:71], a[32:35], v[88:91], v[68:71]
  v_mfma_f32_16x16x32_bf16 v[68:71], a[44:47], v[84:87], v[68:71]
  s_waitcnt vmcnt(19) lgkmcnt(3)
  s_barrier
  v_mfma_f32_16x16x32_bf16 v[72:75], a[44:47], v[96:99], v[72:75]
  ds_read_b128 v[88:91], v1 offset:14336
  s_add_u32 m0, s45, 65536
  s_add_u32 s68, s67, 4
  s_and_b32 s68, s68, 7
  s_mul_i32 s68, s68, 262144
  v_mfma_f32_16x16x32_bf16 v[72:75], a[32:35], v[92:95], v[72:75]
  buffer_load_dwordx4 v10, s[16:19], s68 offen lds
  ds_read_b128 v[28:31], v116
  s_waitcnt lgkmcnt(4)
  v_mfma_f32_16x16x32_bf16 v[52:55], a[48:51], v[104:107], v[52:55]
  ds_read_b64_tr_b16 a[0:1], v4 offset:16384
  ds_read_b128 v[32:35], v117 offset:1024
  ds_read_b128 v[36:39], v116 offset:1024
  v_mfma_f32_16x16x32_bf16 v[52:55], a[60:63], v[100:103], v[52:55]
  ds_read_b128 v[84:87], v1 offset:15360
  ds_read_b64_tr_b16 a[2:3], v4 offset:18432
  ds_read_b64_tr_b16 v[40:41], v119 offset:2048
  v_mfma_f32_16x16x32_bf16 v[56:59], a[60:63], v[112:115], v[56:59]
  ds_read_b64_tr_b16 a[4:5], v5 offset:16384
  s_add_u32 m0, s45, 69632
  s_add_u32 s68, s68, 65536
  v_mfma_f32_16x16x32_bf16 v[56:59], a[48:51], v[108:111], v[56:59]
  ds_read_b64_tr_b16 a[6:7], v5 offset:18432
  buffer_load_dwordx4 v10, s[16:19], s68 offen lds
  ds_read_b64_tr_b16 v[42:43], v118 offset:2048
  v_mfma_f32_16x16x32_bf16 v[64:67], a[52:55], v[108:111], v[64:67]
  ds_read_b128 v[96:99], v2 offset:16384
  ds_read_b64_tr_b16 v[44:45], v119 offset:2056
  ds_read_b64_tr_b16 v[46:47], v118 offset:2056
  v_mfma_f32_16x16x32_bf16 v[64:67], a[64:67], v[112:115], v[64:67]
  ds_read_b64_tr_b16 a[8:9], v4 offset:20480
  s_add_u32 m0, s45, 73728
  s_add_u32 s68, s68, 65536
  v_mfma_f32_16x16x32_bf16 v[60:63], a[64:67], v[100:103], v[60:63]
  ds_read_b64_tr_b16 a[10:11], v4 offset:22528
  buffer_load_dwordx4 v10, s[16:19], s68 offen lds
  v_mfma_f32_16x16x32_bf16 v[60:63], a[52:55], v[104:107], v[60:63]
  ds_read_b128 v[92:95], v2 offset:17408
  ds_read_b64_tr_b16 a[12:13], v5 offset:20480
  v_mfma_f32_16x16x32_bf16 v[68:71], a[56:59], v[104:107], v[68:71]
  ds_read_b64_tr_b16 a[14:15], v5 offset:22528
  v_mfma_f32_16x16x32_bf16 v[68:71], a[68:71], v[100:103], v[68:71]
  s_add_u32 m0, s45, 77824
  s_add_u32 s68, s68, 65536
  s_waitcnt lgkmcnt(5)
  v_mfma_f32_16x16x32_bf16 v[72:75], a[68:71], v[112:115], v[72:75]
  ds_read_b128 v[104:107], v2 offset:24576
  ds_read_b64_tr_b16 a[16:17], v4 offset:24576
  buffer_load_dwordx4 v10, s[16:19], s68 offen lds
  v_mfma_f32_16x16x32_bf16 v[72:75], a[56:59], v[108:111], v[72:75]
  ds_read_b64_tr_b16 a[18:19], v4 offset:26624
  s_waitcnt lgkmcnt(15)
  v_mfma_f32_16x16x32_bf16 v[52:55], a[72:75], v[80:83], v[52:55]
  ds_read_b64_tr_b16 a[20:21], v5 offset:24576
  v_mfma_f32_16x16x32_bf16 v[116:119], v[32:35], v[28:31], 0
  v_mfma_f32_16x16x32_bf16 v[52:55], a[84:87], v[76:79], v[52:55]
  ds_read_b128 v[100:103], v2 offset:25600
  ds_read_b64_tr_b16 a[22:23], v5 offset:26624
  v_mfma_f32_16x16x32_bf16 v[56:59], a[84:87], v[84:87], v[56:59]
  v_mfma_f32_16x16x32_bf16 v[120:123], v[36:39], v[28:31], 0
  v_mfma_f32_16x16x32_bf16 v[56:59], a[72:75], v[88:91], v[56:59]
  ds_read_b64_tr_b16 a[24:25], v4 offset:28672
  v_mfma_f32_16x16x32_bf16 v[64:67], a[76:79], v[88:91], v[64:67]
  ds_read_b128 v[112:115], v2 offset:18432
  ds_read_b64_tr_b16 a[26:27], v4 offset:30720
  v_mfma_f32_16x16x32_bf16 v[64:67], a[88:91], v[84:87], v[64:67]
  ds_read_b64_tr_b16 a[28:29], v5 offset:28672
  v_mfma_f32_16x16x32_bf16 v[60:63], a[88:91], v[76:79], v[60:63]
  ds_read_b64_tr_b16 a[30:31], v5 offset:30720
  s_cmp_lg_u32 s44, 0
  s_cbranch_scc1 PI6_adaLN_cond__sliding_local_dilated__swiglu_ffn__prompt_kernel
  buffer_load_dword v13, v14, s[8:11], s77 offen sc1
PI6_adaLN_cond__sliding_local_dilated__swiglu_ffn__prompt_kernel:
  v_mfma_f32_16x16x32_bf16 v[60:63], a[76:79], v[80:83], v[60:63]
  ds_read_b128 v[108:111], v2 offset:19456
  v_cndmask_b32 v48, v116, v120, s[80:81]
  v_cndmask_b32 v49, v117, v121, s[82:83]
  v_mfma_f32_16x16x32_bf16 v[68:71], a[80:83], v[80:83], v[68:71]
  v_cndmask_b32 v50, v118, v122, s[84:85]
  v_cndmask_b32 v51, v119, v123, s[86:87]
  v_cndmask_b32 v48, v48, v49, s[88:89]
  v_mfma_f32_16x16x32_bf16 v[68:71], a[92:95], v[76:79], v[68:71]
  v_cndmask_b32 v49, v50, v51, s[88:89]
  v_mul_f32 v48, 0x3e8293ee, v48
  v_mul_f32 v49, 0x3e8293ee, v49
  v_mfma_f32_16x16x32_bf16 v[72:75], a[92:95], v[84:87], v[72:75]
  ds_read_b128 v[80:83], v2 offset:26624
  v_max_f32 v50, v48, v49
  v_mov_b32 v51, v50
  v_mfma_f32_16x16x32_bf16 v[72:75], a[80:83], v[88:91], v[72:75]
  s_nop 0
  v_permlane16_swap_b32 v50, v51
  v_max_f32 v50, v50, v51
  s_waitcnt lgkmcnt(8)
  v_mfma_f32_16x16x32_bf16 v[52:55], a[96:99], v[96:99], v[52:55]
  v_mov_b32 v51, v50
  v_mfma_f32_16x16x32_bf16 v[52:55], a[108:111], v[92:95], v[52:55]
  ds_read_b128 v[76:79], v2 offset:27648
  v_permlane32_swap_b32 v50, v51
  v_max_f32 v50, v50, v51
  v_mfma_f32_16x16x32_bf16 v[56:59], a[108:111], v[100:103], v[56:59]
  v_sub_f32 v48, v48, v50
  v_sub_f32 v49, v49, v50
  v_mfma_f32_16x16x32_bf16 v[56:59], a[96:99], v[104:107], v[56:59]
  v_exp_f32 v48, v48
  v_exp_f32 v49, v49
  v_mfma_f32_16x16x32_bf16 v[64:67], a[100:103], v[104:107], v[64:67]
  ds_read_b128 v[84:87], v2 offset:20480
  s_waitcnt vmcnt(13) lgkmcnt(4)
  s_barrier
  v_mfma_f32_16x16x32_bf16 v[64:67], a[112:115], v[100:103], v[64:67]
  ds_read_b64_tr_b16 a[32:33], v7 offset:32768
  s_add_u32 m0, s70, 0
  s_add_u32 s69, s61, 229376
  v_mfma_f32_16x16x32_bf16 v[60:63], a[112:115], v[92:95], v[60:63]
  ds_read_b64_tr_b16 a[34:35], v7 offset:34816
  buffer_load_dwordx4 v12, s[8:11], s69 offen offset:0 sc1 lds
  v_add_f32 v50, v48, v49
  v_mfma_f32_16x16x32_bf16 v[60:63], a[100:103], v[96:99], v[60:63]
  ds_read_b128 v[88:91], v2 offset:21504
  ds_read_b64_tr_b16 a[36:37], v8 offset:32768
  v_mov_b32 v51, v50
  v_mfma_f32_16x16x32_bf16 v[68:71], a[104:107], v[96:99], v[68:71]
  ds_read_b64_tr_b16 a[38:39], v8 offset:34816
  v_permlane16_swap_b32 v50, v51
  v_add_f32 v50, v50, v51
  v_mfma_f32_16x16x32_bf16 v[68:71], a[116:119], v[92:95], v[68:71]
  v_mov_b32 v51, v50
  v_mfma_f32_16x16x32_bf16 v[72:75], a[116:119], v[100:103], v[72:75]
  ds_read_b128 v[96:99], v2 offset:28672
  ds_read_b64_tr_b16 a[40:41], v7 offset:36864
  buffer_load_dwordx4 v12, s[8:11], s69 offen offset:1024 sc1 lds
  v_mfma_f32_16x16x32_bf16 v[72:75], a[104:107], v[104:107], v[72:75]
  ds_read_b64_tr_b16 a[42:43], v7 offset:38912
  v_permlane32_swap_b32 v50, v51
  s_waitcnt lgkmcnt(9)
  v_mfma_f32_16x16x32_bf16 v[52:55], a[120:123], v[112:115], v[52:55]
  ds_read_b64_tr_b16 a[44:45], v8 offset:36864
  v_add_f32 v50, v50, v51
  v_mfma_f32_16x16x32_bf16 v[52:55], a[132:135], v[108:111], v[52:55]
  ds_read_b128 v[92:95], v2 offset:29696
  ds_read_b64_tr_b16 a[46:47], v8 offset:38912
  buffer_load_dwordx4 v12, s[8:11], s69 offen offset:2048 sc1 lds
  v_mfma_f32_16x16x32_bf16 v[56:59], a[132:135], v[76:79], v[56:59]
  v_rcp_f32 v50, v50
  v_mfma_f32_16x16x32_bf16 v[56:59], a[120:123], v[80:83], v[56:59]
  ds_read_b64_tr_b16 a[48:49], v7 offset:40960
  v_mul_f32 v48, v48, v50
  v_mul_f32 v49, v49, v50
  v_mfma_f32_16x16x32_bf16 v[64:67], a[124:127], v[80:83], v[64:67]
  ds_read_b128 v[100:103], v2 offset:22528
  ds_read_b64_tr_b16 a[50:51], v7 offset:43008
  v_cvt_pk_bf16_f32 v48, v48, v48
  v_mfma_f32_16x16x32_bf16 v[64:67], a[136:139], v[76:79], v[64:67]
  ds_read_b64_tr_b16 a[52:53], v8 offset:40960
  buffer_load_dwordx4 v12, s[8:11], s69 offen offset:3072 sc1 lds
  v_cvt_pk_bf16_f32 v49, v49, v49
  v_mfma_f32_16x16x32_bf16 v[60:63], a[136:139], v[108:111], v[60:63]
  ds_read_b64_tr_b16 a[54:55], v8 offset:43008
  v_and_b32 v28, v24, v48
  v_and_b32 v29, v25, v49
  v_mfma_f32_16x16x32_bf16 v[60:63], a[124:127], v[112:115], v[60:63]
  ds_read_b128 v[104:107], v2 offset:23552
  s_add_u32 m0, s45, 16384
  s_add_u32 s68, s67, 5
  s_and_b32 s68, s68, 7
  s_mul_i32 s68, s68, 262144
  v_mfma_f32_16x16x32_bf16 v[68:71], a[128:131], v[112:115], v[68:71]
  ds_read_b64_tr_b16 a[56:57], v7 offset:45056
  buffer_load_dwordx4 v10, s[16:19], s68 offen lds
HOP4:
  s_cbranch_execz WRET0
  v_and_b32 v30, v26, v48
  v_mfma_f32_16x16x32_bf16 v[68:71], a[140:143], v[108:111], v[68:71]
  ds_read_b64_tr_b16 a[58:59], v7 offset:47104
  v_and_b32 v31, v27, v49
  v_mfma_f32_16x16x32_bf16 v[72:75], a[140:143], v[76:79], v[72:75]
  ds_read_b128 v[112:115], v2 offset:30720
  ds_read_b64_tr_b16 a[60:61], v8 offset:45056
  v_mfma_f32_16x16x32_bf16 v[32:35], v[40:43], v[28:31], 0
  v_mfma_f32_16x16x32_bf16 v[72:75], a[128:131], v[80:83], v[72:75]
  ds_read_b64_tr_b16 a[62:63], v8 offset:47104
  s_add_u32 m0, s45, 20480
  s_add_u32 s68, s68, 65536
  s_waitcnt lgkmcnt(12)
  v_mfma_f32_16x16x32_bf16 v[52:55], a[144:147], v[84:87], v[52:55]
  buffer_load_dwordx4 v10, s[16:19], s68 offen lds
  v_mfma_f32_16x16x32_bf16 v[36:39], v[44:47], v[28:31], 0
  v_mfma_f32_16x16x32_bf16 v[52:55], a[156:159], v[88:91], v[52:55]
  ds_read_b128 v[108:111], v2 offset:31744
  v_mfma_f32_16x16x32_bf16 v[56:59], a[156:159], v[92:95], v[56:59]
  s_add_u32 m0, s45, 24576
  s_add_u32 s68, s68, 65536
  v_mfma_f32_16x16x32_bf16 v[56:59], a[144:147], v[96:99], v[56:59]
  buffer_load_dwordx4 v10, s[16:19], s68 offen lds
  v_mfma_f32_16x16x32_bf16 v[64:67], a[148:151], v[96:99], v[64:67]
  ds_read_b128 v[76:79], v2 offset:49152
  v_cvt_pk_bf16_f32 v116, v32, v33
  v_cvt_pk_bf16_f32 v117, v34, v35
  v_mfma_f32_16x16x32_bf16 v[64:67], a[160:163], v[92:95], v[64:67]
  s_cmp_lg_u32 s44, 0
  s_cbranch_scc1 PL7_adaLN_cond__sliding_local_dilated__swiglu_ffn__prompt_kernelx
  s_waitcnt vmcnt(7)
  v_subrev_u32 v13, s46, v13
  v_subrev_u32 v13, 1, v13
  v_cmp_lt_u32 vcc, 3, v13
  s_nop 4
  s_cbranch_vccz PL7_adaLN_cond__sliding_local_dilated__swiglu_ffn__prompt_kernelx
  s_mov_b32 s57, 60000
PL7_adaLN_cond__sliding_local_dilated__swiglu_ffn__prompt_kernel:
  buffer_load_dword v13, v14, s[8:11], s77 offen sc1
  s_sub_u32 s57, s57, 1
  s_cmp_eq_u32 s57, 0
  s_waitcnt vmcnt(0)
  s_cbranch_scc1 PL7_adaLN_cond__sliding_local_dilated__swiglu_ffn__prompt_kernelx
  v_subrev_u32 v13, s46, v13
  v_subrev_u32 v13, 1, v13
  v_cmp_lt_u32 vcc, 3, v13
  s_nop 4
  s_cbranch_vccnz PL7_adaLN_cond__sliding_local_dilated__swiglu_ffn__prompt_kernel
PL7_adaLN_cond__sliding_local_dilated__swiglu_ffn__prompt_kernelx:
  s_barrier
  v_mfma_f32_16x16x32_bf16 v[60:63], a[160:163], v[88:91], v[60:63]
  s_add_u32 m0, s45, 28672
  s_add_u32 s68, s68, 65536
  v_cvt_pk_bf16_f32 v118, v36, v37
  v_mfma_f32_16x16x32_bf16 v[60:63], a[148:151], v[84:87], v[60:63]
  ds_read_b128 v[80:83], v2 offset:50176
  buffer_load_dwordx4 v10, s[16:19], s68 offen lds
  v_cvt_pk_bf16_f32 v119, v38, v39
  v_mfma_f32_16x16x32_bf16 v[68:71], a[152:155], v[84:87], v[68:71]
  buffer_store_dwordx4 v[116:119], v1, s[8:11], s73 offen sc1
  s_add_u32 s73, s73, 65536
  v_mfma_f32_16x16x32_bf16 v[68:71], a[164:167], v[88:91], v[68:71]
  v_mfma_f32_16x16x32_bf16 v[72:75], a[164:167], v[92:95], v[72:75]
  ds_read_b128 v[84:87], v2 offset:57344
  v_mfma_f32_16x16x32_bf16 v[72:75], a[152:155], v[96:99], v[72:75]
  s_waitcnt vmcnt(13) lgkmcnt(4)
  s_barrier
  s_waitcnt lgkmcnt(3)
  v_mfma_f32_16x16x32_bf16 v[52:55], a[168:171], v[100:103], v[52:55]
  ds_read_b64_tr_b16 a[64:65], v4 offset:32768
  s_add_u32 m0, s45, 98304
  s_add_u32 s68, s67, 6
  s_and_b32 s68, s68, 7
  s_mul_i32 s68, s68, 262144
  v_mfma_f32_16x16x32_bf16 v[52:55], a[180:183], v[104:107], v[52:55]
  ds_read_b128 v[88:91], v2 offset:58368
  ds_read_b64_tr_b16 a[66:67], v4 offset:34816
  ds_read_b64_tr_b16 a[68:69], v5 offset:32768
  buffer_load_dwordx4 v10, s[16:19], s68 offen lds
  v_mfma_f32_16x16x32_bf16 v[56:59], a[180:183], v[108:111], v[56:59]
  ds_read_b64_tr_b16 a[70:71], v5 offset:34816
  v_mfma_f32_16x16x32_bf16 v[56:59], a[168:171], v[112:115], v[56:59]
  ds_read_b64_tr_b16 a[72:73], v4 offset:36864
  v_mfma_f32_16x16x32_bf16 v[64:67], a[172:175], v[112:115], v[64:67]
  ds_read_b128 v[92:95], v2 offset:51200
  ds_read_b64_tr_b16 a[74:75], v4 offset:38912
  ds_read_b64_tr_b16 a[76:77], v5 offset:36864
  s_add_u32 m0, s45, 102400
  s_add_u32 s68, s68, 65536
  v_mfma_f32_16x16x32_bf16 v[64:67], a[184:187], v[108:111], v[64:67]
  ds_read_b64_tr_b16 a[78:79], v5 offset:38912
  buffer_load_dwordx4 v10, s[16:19], s68 offen lds
  v_mfma_f32_16x16x32_bf16 v[60:63], a[184:187], v[104:107], v[60:63]
  ds_read_b64_tr_b16 a[80:81], v4 offset:40960
  v_mfma_f32_16x16x32_bf16 v[60:63], a[172:175], v[100:103], v[60:63]
  ds_read_b128 v[96:99], v2 offset:52224
  ds_read_b64_tr_b16 a[82:83], v4 offset:43008
  ds_read_b64_tr_b16 a[84:85], v5 offset:40960
  s_add_u32 m0, s45, 106496
  s_add_u32 s68, s68, 65536
  v_mfma_f32_16x16x32_bf16 v[68:71], a[176:179], v[100:103], v[68:71]
  ds_read_b64_tr_b16 a[86:87], v5 offset:43008
  buffer_load_dwordx4 v10, s[16:19], s68 offen lds
  v_mfma_f32_16x16x32_bf16 v[68:71], a[188:191], v[104:107], v[68:71]
  ds_read_b64_tr_b16 a[88:89], v4 offset:45056
  v_mfma_f32_16x16x32_bf16 v[72:75], a[188:191], v[108:111], v[72:75]
  ds_read_b128 v[100:103], v2 offset:59392
  ds_read_b64_tr_b16 a[90:91], v4 offset:47104
  ds_read_b64_tr_b16 a[92:93], v5 offset:45056
  v_mfma_f32_16x16x32_bf16 v[72:75], a[176:179], v[112:115], v[72:75]
  ds_read_b64_tr_b16 a[94:95], v5 offset:47104
  s_add_u32 m0, s45, 110592
  s_add_u32 s68, s68, 65536
  s_waitcnt lgkmcnt(15)
  v_mfma_f32_16x16x32_bf16 v[52:55], a[192:195], v[76:79], v[52:55]
  ds_read_b64_tr_b16 a[96:97], v4 offset:49152
  v_lshlrev_b32 v21, 7, v0
  v_add_u32 v21, 720896, v21
  buffer_load_dwordx4 v10, s[16:19], s68 offen lds
  v_mfma_f32_16x16x32_bf16 v[52:55], a[204:207], v[80:83], v[52:55]
  ds_read_b128 v[104:107], v2 offset:60416
  ds_read_b64_tr_b16 a[98:99], v4 offset:51200
  ds_read_b64_tr_b16 a[100:101], v5 offset:49152
  v_mfma_f32_16x16x32_bf16 v[56:59], a[204:207], v[88:91], v[56:59]
  ds_read_b64_tr_b16 a[102:103], v5 offset:51200
  s_cmp_lg_u32 s44, 0
  s_cbranch_scc1 PI8_adaLN_cond__sliding_local_dilated__swiglu_ffn__prompt_kernel
  buffer_load_dwordx4 v[116:119], v21, s[8:11], 0 offen sc1
PI8_adaLN_cond__sliding_local_dilated__swiglu_ffn__prompt_kernel:
  v_mfma_f32_16x16x32_bf16 v[56:59], a[192:195], v[84:87], v[56:59]
  ds_read_b64_tr_b16 a[104:105], v4 offset:53248
  v_mfma_f32_16x16x32_bf16 v[64:67], a[196:199], v[84:87], v[64:67]
  ds_read_b128 v[108:111], v2 offset:53248
  ds_read_b64_tr_b16 a[106:107], v4 offset:55296
  ds_read_b64_tr_b16 a[108:109], v5 offset:53248
  v_mfma_f32_16x16x32_bf16 v[64:67], a[208:211], v[88:91], v[64:67]
  ds_read_b64_tr_b16 a[110:111], v5 offset:55296
  v_mfma_f32_16x16x32_bf16 v[60:63], a[208:211], v[80:83], v[60:63]
  ds_read_b64_tr_b16 a[112:113], v4 offset:57344
  v_mfma_f32_16x16x32_bf16 v[60:63], a[196:199], v[76:79], v[60:63]
  ds_read_b128 v[112:115], v2 offset:54272
  ds_read_b64_tr_b16 a[114:115], v4 offset:59392
  ds_read_b64_tr_b16 a[116:117], v5 offset:57344
  v_mfma_f32_16x16x32_bf16 v[68:71], a[200:203], v[76:79], v[68:71]
  ds_read_b64_tr_b16 a[118:119], v5 offset:59392
  v_mfma_f32_16x16x32_bf16 v[68:71], a[212:215], v[80:83], v[68:71]
  ds_read_b64_tr_b16 a[120:121], v4 offset:61440
  v_mfma_f32_16x16x32_bf16 v[72:75], a[212:215], v[88:91], v[72:75]
  ds_read_b128 v[76:79], v2 offset:61440
  ds_read_b64_tr_b16 a[122:123], v4 offset:63488
  ds_read_b64_tr_b16 a[124:125], v5 offset:61440
  v_mfma_f32_16x16x32_bf16 v[72:75], a[200:203], v[84:87], v[72:75]
  ds_read_b64_tr_b16 a[126:127], v5 offset:63488
  s_waitcnt lgkmcnt(15)
  v_mfma_f32_16x16x32_bf16 v[52:55], a[216:219], v[92:95], v[52:55]
  v_mfma_f32_16x16x32_bf16 v[52:55], a[228:231], v[96:99], v[52:55]
  ds_read_b128 v[80:83], v2 offset:62464
  v_mfma_f32_16x16x32_bf16 v[56:59], a[228:231], v[104:107], v[56:59]
  v_mfma_f32_16x16x32_bf16 v[56:59], a[216:219], v[100:103], v[56:59]
  v_mfma_f32_16x16x32_bf16 v[64:67], a[220:223], v[100:103], v[64:67]
  ds_read_b128 v[88:91], v2 offset:55296
  v_mfma_f32_16x16x32_bf16 v[64:67], a[232:235], v[104:107], v[64:67]
  v_mfma_f32_16x16x32_bf16 v[60:63], a[232:235], v[96:99], v[60:63]
  s_waitcnt vmcnt(5) lgkmcnt(2)
  s_barrier
  v_mfma_f32_16x16x32_bf16 v[60:63], a[220:223], v[92:95], v[60:63]
  ds_read_b128 v[84:87], v2 offset:56320
  ds_read_b64_tr_b16 a[128:129], v7 offset:0
  s_add_u32 m0, s45, 81920
  s_add_u32 s68, s67, 7
  s_and_b32 s68, s68, 7
  s_mul_i32 s68, s68, 262144
  v_mfma_f32_16x16x32_bf16 v[68:71], a[224:227], v[92:95], v[68:71]
  ds_read_b64_tr_b16 a[130:131], v7 offset:2048
  ds_read_b64_tr_b16 a[132:133], v8 offset:0
  buffer_load_dwordx4 v10, s[16:19], s68 offen lds
  v_mfma_f32_16x16x32_bf16 v[68:71], a[236:239], v[96:99], v[68:71]
  ds_read_b64_tr_b16 a[134:135], v8 offset:2048
  v_mfma_f32_16x16x32_bf16 v[72:75], a[236:239], v[104:107], v[72:75]
  ds_read_b128 v[92:95], v2 offset:63488
  ds_read_b64_tr_b16 a[136:137], v7 offset:4096
  v_mfma_f32_16x16x32_bf16 v[72:75], a[224:227], v[100:103], v[72:75]
  ds_read_b64_tr_b16 a[138:139], v7 offset:6144
  ds_read_b64_tr_b16 a[140:141], v8 offset:4096
  s_add_u32 m0, s45, 86016
  s_add_u32 s68, s68, 65536
  s_waitcnt lgkmcnt(10)
  v_mfma_f32_16x16x32_bf16 v[52:55], a[240:243], v[108:111], v[52:55]
  ds_read_b64_tr_b16 a[142:143], v8 offset:6144
  buffer_load_dwordx4 v10, s[16:19], s68 offen lds
  v_mfma_f32_16x16x32_bf16 v[52:55], v[124:127], v[112:115], v[52:55]
  ds_read_b128 v[96:99], v2 offset:64512
  ds_read_b64_tr_b16 a[144:145], v7 offset:8192
  v_mfma_f32_16x16x32_bf16 v[56:59], v[124:127], v[80:83], v[56:59]
  ds_read_b64_tr_b16 a[146:147], v7 offset:10240
  ds_read_b64_tr_b16 a[148:149], v8 offset:8192
  s_add_u32 m0, s45, 90112
  s_add_u32 s68, s68, 65536
  v_mfma_f32_16x16x32_bf16 v[56:59], a[240:243], v[76:79], v[56:59]
  ds_read_b64_tr_b16 a[150:151], v8 offset:10240
  buffer_load_dwordx4 v10, s[16:19], s68 offen lds
  v_mfma_f32_16x16x32_bf16 v[64:67], a[244:247], v[76:79], v[64:67]
  ds_read_b128 v[104:107], v1 offset:0
  ds_read_b64_tr_b16 a[152:153], v7 offset:12288
  v_mfma_f32_16x16x32_bf16 v[64:67], v[128:131], v[80:83], v[64:67]
  ds_read_b64_tr_b16 a[154:155], v7 offset:14336
  ds_read_b64_tr_b16 a[156:157], v8 offset:12288
  v_add_u32 v15, s46, v0
  v_add_u32 v15, 2, v15
  s_waitcnt vmcnt(7)
  s_barrier
  s_mov_b64 exec, 1
  buffer_store_dword v15, v0, s[8:11], s74 offen offset:0 sc1
  s_mov_b64 exec, -1
  v_mfma_f32_16x16x32_bf16 v[60:63], v[128:131], v[112:115], v[60:63]
  ds_read_b64_tr_b16 a[158:159], v8 offset:14336
  s_add_u32 m0, s45, 94208
  s_add_u32 s68, s68, 65536
  v_mfma_f32_16x16x32_bf16 v[60:63], a[244:247], v[108:111], v[60:63]
  ds_read_b128 v[100:103], v1 offset:1024
  ds_read_b64_tr_b16 a[160:161], v4 offset:16384
  buffer_load_dwordx4 v10, s[16:19], s68 offen lds
  v_mfma_f32_16x16x32_bf16 v[68:71], a[248:251], v[108:111], v[68:71]
  ds_read_b64_tr_b16 a[162:163], v4 offset:18432
  ds_read_b64_tr_b16 a[164:165], v5 offset:16384
  v_mfma_f32_16x16x32_bf16 v[68:71], v[132:135], v[112:115], v[68:71]
  ds_read_b64_tr_b16 a[166:167], v5 offset:18432
  s_add_u32 m0, s70, 32768
  s_add_u32 s69, s62, 0
  v_mfma_f32_16x16x32_bf16 v[72:75], v[132:135], v[80:83], v[72:75]
  ds_read_b128 v[108:111], v1 offset:8192
  ds_read_b64_tr_b16 a[168:169], v4 offset:20480
  buffer_load_dwordx4 v9, s[8:11], s69 offen offset:0 sc1 lds
  v_mfma_f32_16x16x32_bf16 v[72:75], a[248:251], v[76:79], v[72:75]
  ds_read_b64_tr_b16 a[170:171], v4 offset:22528
  ds_read_b64_tr_b16 a[172:173], v5 offset:20480
  s_waitcnt lgkmcnt(15)
  v_mfma_f32_16x16x32_bf16 v[52:55], v[136:139], v[88:91], v[52:55]
  ds_read_b64_tr_b16 a[174:175], v5 offset:22528
  v_mfma_f32_16x16x32_bf16 v[52:55], v[148:151], v[84:87], v[52:55]
  ds_read_b128 v[112:115], v1 offset:9216
  ds_read_b64_tr_b16 a[176:177], v4 offset:24576
  s_cmp_lg_u32 s44, 0
  s_cbranch_scc1 PL9_adaLN_cond__sliding_local_dilated__swiglu_ffn__prompt_kernelx
  s_waitcnt vmcnt(6)
  v_bitop3_b32 v116, v116, v117, s46 bitop3:0x7e
  v_bitop3_b32 v118, v118, v119, s46 bitop3:0x7e
  v_or_b32 v116, v116, v118
  v_cmp_ne_u32 vcc, 0, v116
  s_nop 4
  s_cbranch_vccz PL9_adaLN_cond__sliding_local_dilated__swiglu_ffn__prompt_kernelx
  s_mov_b32 s57, 60000
PL9_adaLN_cond__sliding_local_dilated__swiglu_ffn__prompt_kernel:
  buffer_load_dwordx4 v[116:119], v21, s[8:11], 0 offen sc1
  s_sub_u32 s57, s57, 1
  s_cmp_eq_u32 s57, 0
  s_waitcnt vmcnt(0)
  s_cbranch_scc1 PL9_adaLN_cond__sliding_local_dilated__swiglu_ffn__prompt_kernelx
  v_bitop3_b32 v116, v116, v117, s46 bitop3:0x7e
  v_bitop3_b32 v118, v118, v119, s46 bitop3:0x7e
  v_or_b32 v116, v116, v118
  v_cmp_ne_u32 vcc, 0, v116
  s_nop 4
  s_cbranch_vccnz PL9_adaLN_cond__sliding_local_dilated__swiglu_ffn__prompt_kernel
PL9_adaLN_cond__sliding_local_dilated__swiglu_ffn__prompt_kernelx:
  s_barrier
  v_mfma_f32_16x16x32_bf16 v[56:59], v[148:151], v[96:99], v[56:59]
  ds_read_b64_tr_b16 a[178:179], v4 offset:26624
  ds_read_b64_tr_b16 a[180:181], v5 offset:24576
  buffer_load_dwordx4 v9, s[8:11], s69 offen offset:1024 sc1 lds
  v_mfma_f32_16x16x32_bf16 v[56:59], v[136:139], v[92:95], v[56:59]
  ds_read_b64_tr_b16 a[182:183], v5 offset:26624
  s_or_b32 s57, s2, s44
  s_mov_b32 s57, 851968
  s_cselect_b32 s57, 1073741824, s57
  v_add_u32 v15, s46, v0
  s_mov_b64 exec, 1
  buffer_store_dword v15, v0, s[8:11], s57 offen offset:0 sc1
  s_mov_b64 exec, -1
  v_mfma_f32_16x16x32_bf16 v[64:67], v[140:143], v[92:95], v[64:67]
  ds_read_b128 v[80:83], v1 offset:2048
  ds_read_b64_tr_b16 a[184:185], v4 offset:28672
  v_mfma_f32_16x16x32_bf16 v[64:67], v[152:155], v[96:99], v[64:67]
  ds_read_b64_tr_b16 a[186:187], v4 offset:30720
  ds_read_b64_tr_b16 a[188:189], v5 offset:28672
  buffer_load_dwordx4 v9, s[8:11], s69 offen offset:2048 sc1 lds
  v_mfma_f32_16x16x32_bf16 v[60:63], v[152:155], v[84:87], v[60:63]
  ds_read_b64_tr_b16 a[190:191], v5 offset:30720
  v_mfma_f32_16x16x32_bf16 v[60:63], v[140:143], v[88:91], v[60:63]
  ds_read_b128 v[76:79], v1 offset:3072
  v_mfma_f32_16x16x32_bf16 v[68:71], v[144:147], v[88:91], v[68:71]
  v_mfma_f32_16x16x32_bf16 v[68:71], v[156:159], v[84:87], v[68:71]
  buffer_load_dwordx4 v9, s[8:11], s69 offen offset:3072 sc1 lds
  v_mfma_f32_16x16x32_bf16 v[72:75], v[156:159], v[96:99], v[72:75]
  ds_read_b128 v[88:91], v1 offset:10240
  v_mfma_f32_16x16x32_bf16 v[72:75], v[144:147], v[92:95], v[72:75]
  s_add_u32 m0, s70, 49152
  s_add_u32 s69, s63, 0
  s_waitcnt lgkmcnt(11)
  v_mfma_f32_16x16x32_bf16 v[52:55], v[160:163], v[104:107], v[52:55]
  buffer_load_dwordx4 v9, s[8:11], s69 offen offset:0 sc1 lds
  s_waitcnt vmcnt(6) lgkmcnt(2)
  s_barrier
  v_mfma_f32_16x16x32_bf16 v[52:55], v[172:175], v[100:103], v[52:55]
  ds_read_b128 v[84:87], v1 offset:11264
  ds_read_b64_tr_b16 a[192:193], v7 offset:32768
  v_mfma_f32_16x16x32_bf16 v[56:59], v[172:175], v[112:115], v[56:59]
  ds_read_b64_tr_b16 a[194:195], v7 offset:34816
  ds_read_b64_tr_b16 a[196:197], v8 offset:32768
  v_mfma_f32_16x16x32_bf16 v[56:59], v[160:163], v[108:111], v[56:59]
  ds_read_b64_tr_b16 a[198:199], v8 offset:34816
  v_mfma_f32_16x16x32_bf16 v[64:67], v[164:167], v[108:111], v[64:67]
  ds_read_b128 v[96:99], v1 offset:4096
  ds_read_b64_tr_b16 a[200:201], v7 offset:36864
  buffer_load_dwordx4 v9, s[8:11], s69 offen offset:1024 sc1 lds
  v_mfma_f32_16x16x32_bf16 v[64:67], v[176:179], v[112:115], v[64:67]
  ds_read_b64_tr_b16 a[202:203], v7 offset:38912
  ds_read_b64_tr_b16 a[204:205], v8 offset:36864
  v_mfma_f32_16x16x32_bf16 v[60:63], v[176:179], v[100:103], v[60:63]
  ds_read_b64_tr_b16 a[206:207], v8 offset:38912
  v_mfma_f32_16x16x32_bf16 v[60:63], v[164:167], v[104:107], v[60:63]
  ds_read_b128 v[92:95], v1 offset:5120
  ds_read_b64_tr_b16 a[208:209], v7 offset:40960
  buffer_load_dwordx4 v9, s[8:11], s69 offen offset:2048 sc1 lds
  v_mfma_f32_16x16x32_bf16 v[68:71], v[168:171], v[104:107], v[68:71]
  ds_read_b64_tr_b16 a[210:211], v7 offset:43008
  ds_read_b64_tr_b16 a[212:213], v8 offset:40960
  v_mfma_f32_16x16x32_bf16 v[68:71], v[180:183], v[100:103], v[68:71]
  ds_read_b64_tr_b16 a[214:215], v8 offset:43008
  v_mfma_f32_16x16x32_bf16 v[72:75], v[180:183], v[112:115], v[72:75]
  ds_read_b128 v[104:107], v1 offset:12288
  ds_read_b64_tr_b16 a[216:217], v7 offset:45056
  v_mfma_f32_16x16x32_bf16 v[72:75], v[168:171], v[108:111], v[72:75]
  ds_read_b64_tr_b16 a[218:219], v7 offset:47104
  ds_read_b64_tr_b16 a[220:221], v8 offset:45056
  buffer_load_dwordx4 v9, s[8:11], s69 offen offset:3072 sc1 lds
  s_waitcnt lgkmcnt(15)
  v_mfma_f32_16x16x32_bf16 v[52:55], v[184:187], v[80:83], v[52:55]
  ds_read_b64_tr_b16 a[222:223], v8 offset:47104
  v_mfma_f32_16x16x32_bf16 v[52:55], v[196:199], v[76:79], v[52:55]
  ds_read_b128 v[100:103], v1 offset:13312
  ds_read_b64_tr_b16 a[224:225], v7 offset:16384
  v_and_b32 v21, 31, v0
  v_lshlrev_b32 v21, 2, v21
  v_lshrrev_b32 v181, 5, v0
  v_lshl_add_u32 v21, v181, 13, v21
  s_add_u32 m0, s70, 65536
  s_add_u32 s69, s64, 0
  v_mfma_f32_16x16x32_bf16 v[56:59], v[196:199], v[84:87], v[56:59]
  ds_read_b64_tr_b16 a[226:227], v7 offset:18432
  ds_read_b64_tr_b16 a[228:229], v8 offset:16384
  buffer_load_dwordx4 v9, s[8:11], s69 offen offset:0 sc1 lds
  v_mfma_f32_16x16x32_bf16 v[56:59], v[184:187], v[88:91], v[56:59]
  ds_read_b64_tr_b16 a[230:231], v8 offset:18432
  v_mfma_f32_16x16x32_bf16 v[64:67], v[188:191], v[88:91], v[64:67]
  ds_read_b128 v[112:115], v1 offset:6144
  ds_read_b64_tr_b16 a[232:233], v7 offset:20480
  v_mfma_f32_16x16x32_bf16 v[64:67], v[200:203], v[84:87], v[64:67]
  ds_read_b64_tr_b16 a[234:235], v7 offset:22528
  ds_read_b64_tr_b16 a[236:237], v8 offset:20480
  v_mfma_f32_16x16x32_bf16 v[60:63], v[200:203], v[76:79], v[60:63]
  ds_read_b64_tr_b16 a[238:239], v8 offset:22528
  buffer_load_dwordx4 v9, s[8:11], s69 offen offset:1024 sc1 lds
  v_mfma_f32_16x16x32_bf16 v[60:63], v[188:191], v[80:83], v[60:63]
  ds_read_b128 v[108:111], v1 offset:7168
  ds_read_b64_tr_b16 a[240:241], v7 offset:24576
  v_mfma_f32_16x16x32_bf16 v[68:71], v[192:195], v[80:83], v[68:71]
  ds_read_b64_tr_b16 a[242:243], v7 offset:26624
  ds_read_b64_tr_b16 a[244:245], v8 offset:24576
  v_mfma_f32_16x16x32_bf16 v[68:71], v[204:207], v[76:79], v[68:71]
  ds_read_b64_tr_b16 a[246:247], v8 offset:26624
  buffer_load_dwordx4 v9, s[8:11], s69 offen offset:2048 sc1 lds
  v_mfma_f32_16x16x32_bf16 v[72:75], v[204:207], v[84:87], v[72:75]
  ds_read_b128 v[80:83], v1 offset:14336
  ds_read_b64_tr_b16 a[248:249], v7 offset:28672
  v_mfma_f32_16x16x32_bf16 v[72:75], v[192:195], v[88:91], v[72:75]
  ds_read_b64_tr_b16 a[250:251], v7 offset:30720
  ds_read_b64_tr_b16 v[124:125], v8 offset:28672
  s_waitcnt lgkmcnt(15)
  v_mfma_f32_16x16x32_bf16 v[52:55], v[208:211], v[96:99], v[52:55]
  ds_read_b64_tr_b16 v[126:127], v8 offset:30720
  v_mfma_f32_16x16x32_bf16 v[52:55], v[220:223], v[92:95], v[52:55]
  ds_read_b128 v[76:79], v1 offset:15360
  buffer_load_dwordx4 v9, s[8:11], s69 offen offset:3072 sc1 lds
  v_mfma_f32_16x16x32_bf16 v[56:59], v[220:223], v[100:103], v[56:59]
  v_mfma_f32_16x16x32_bf16 v[56:59], v[208:211], v[104:107], v[56:59]
  s_add_u32 m0, s70, 114688
  s_add_u32 s69, s65, 0
  v_mfma_f32_16x16x32_bf16 v[64:67], v[212:215], v[104:107], v[64:67]
  buffer_load_dwordx4 v9, s[8:11], s69 offen offset:0 sc1 lds
  v_mfma_f32_16x16x32_bf16 v[64:67], v[224:227], v[100:103], v[64:67]
  v_mfma_f32_16x16x32_bf16 v[60:63], v[224:227], v[92:95], v[60:63]
  v_mfma_f32_16x16x32_bf16 v[60:63], v[212:215], v[96:99], v[60:63]
  s_waitcnt vmcnt(5) lgkmcnt(1)
  s_barrier
  v_mfma_f32_16x16x32_bf16 v[68:71], v[216:219], v[96:99], v[68:71]
  ds_read_b128 v[84:87], v22 offset:32768
  buffer_load_dwordx4 v9, s[8:11], s69 offen offset:1024 sc1 lds
  v_mfma_f32_16x16x32_bf16 v[68:71], v[228:231], v[92:95], v[68:71]
  v_mfma_f32_16x16x32_bf16 v[72:75], v[228:231], v[100:103], v[72:75]
  ds_read_b128 v[88:91], v22 offset:33792
  v_mfma_f32_16x16x32_bf16 v[72:75], v[216:219], v[104:107], v[72:75]
  buffer_load_dwordx4 v9, s[8:11], s69 offen offset:2048 sc1 lds
  s_waitcnt lgkmcnt(2)
  v_mfma_f32_16x16x32_bf16 v[52:55], v[232:235], v[112:115], v[52:55]
  ds_read_b128 v[96:99], v22 offset:34816
  v_mfma_f32_16x16x32_bf16 v[52:55], v[244:247], v[108:111], v[52:55]
  v_mfma_f32_16x16x32_bf16 v[56:59], v[244:247], v[76:79], v[56:59]
  ds_read_b128 v[92:95], v22 offset:35840
  v_mfma_f32_16x16x32_bf16 v[56:59], v[232:235], v[80:83], v[56:59]
  buffer_load_dwordx4 v9, s[8:11], s69 offen offset:3072 sc1 lds
  v_mfma_f32_16x16x32_bf16 v[64:67], v[236:239], v[80:83], v[64:67]
  ds_read_b128 v[100:103], v22 offset:36864
  v_mfma_f32_16x16x32_bf16 v[64:67], v[248:251], v[76:79], v[64:67]
  s_add_u32 s56, s76, 8192
  v_mfma_f32_16x16x32_bf16 v[60:63], v[248:251], v[108:111], v[60:63]
  ds_read_b128 v[104:107], v22 offset:37888
  buffer_load_dword v160, v21, s[8:11], s56 offen sc1
  v_mfma_f32_16x16x32_bf16 v[60:63], v[236:239], v[112:115], v[60:63]
  s_add_u32 s56, s76, 32768
  v_mfma_f32_16x16x32_bf16 v[68:71], v[240:243], v[112:115], v[68:71]
  ds_read_b128 v[112:115], v22 offset:38912
  buffer_load_dword v161, v21, s[8:11], s56 offen sc1
  v_mfma_f32_16x16x32_bf16 v[68:71], v[252:255], v[108:111], v[68:71]
  s_add_u32 s56, s76, 57344
  v_mfma_f32_16x16x32_bf16 v[72:75], v[252:255], v[76:79], v[72:75]
  ds_read_b128 v[108:111], v22 offset:39936
  buffer_load_dword v162, v21, s[8:11], s56 offen sc1
  v_mfma_f32_16x16x32_bf16 v[72:75], v[240:243], v[80:83], v[72:75]
  s_add_u32 s56, s76, 81920
  s_waitcnt lgkmcnt(4)
  v_mfma_f32_16x16x32_bf16 v[128:131], a[0:3], v[84:87], 0
  ds_read_b128 v[76:79], v22 offset:49152
  buffer_load_dword v163, v21, s[8:11], s56 offen sc1
  s_add_u32 s56, s47, 41943040
  v_mfma_f32_16x16x32_bf16 v[128:131], a[8:11], v[88:91], v[128:131]
  buffer_load_dwordx4 v[144:147], v1, s[8:11], s56 offen sc1
  v_mfma_f32_16x16x32_bf16 v[132:135], a[12:15], v[88:91], 0
  ds_read_b128 v[80:83], v22 offset:50176
  s_lshr_b32 s79, s2, 6
  s_lshl_b32 s79, s79, 2
  s_add_u32 s79, s79, s44
  s_lshl_b32 s79, s79, 8
  s_add_u32 s56, s47, 42008576
  v_mfma_f32_16x16x32_bf16 v[132:135], a[4:7], v[84:87], v[132:135]
  buffer_load_dwordx4 v[148:151], v1, s[8:11], s56 offen sc1
  v_cvt_pk_bf16_f32 v52, v52, v53
  v_cvt_pk_bf16_f32 v53, v54, v55
  ds_write_b64 v18, v[52:53] offset:6144
  v_cvt_pk_bf16_f32 v60, v60, v61
  v_cvt_pk_bf16_f32 v61, v62, v63
  v_cvt_pk_bf16_f32 v62, v68, v69
  v_mfma_f32_16x16x32_bf16 v[128:131], a[16:19], v[96:99], v[128:131]
  ds_read_b128 v[88:91], v22 offset:51200
  s_add_u32 s56, s47, 42074112
  v_cvt_pk_bf16_f32 v63, v70, v71
  ds_write_b128 v17, v[60:63] offset:7168
  v_cvt_pk_bf16_f32 v56, v56, v57
  v_cvt_pk_bf16_f32 v57, v58, v59
  ds_write_b64 v18, v[56:57] offset:12288
  v_mfma_f32_16x16x32_bf16 v[128:131], a[24:27], v[92:95], v[128:131]
  s_cmp_lg_u32 s44, 0
  s_cbranch_scc1 PI10_adaLN_cond__sliding_local_dilated__swiglu_ffn__prompt_kernel
  buffer_load_dword v13, v14, s[8:11], s77 offen sc1
PI10_adaLN_cond__sliding_local_dilated__swiglu_ffn__prompt_kernel:
  buffer_load_dwordx4 v[152:155], v1, s[8:11], s56 offen sc1
  v_cvt_pk_bf16_f32 v64, v64, v65
  v_cvt_pk_bf16_f32 v65, v66, v67
  v_mfma_f32_16x16x32_bf16 v[132:135], a[28:31], v[92:95], v[132:135]
  ds_read_b128 v[84:87], v22 offset:52224
  s_add_u32 s56, s47, 42139648
  v_cvt_pk_bf16_f32 v66, v72, v73
  v_cvt_pk_bf16_f32 v67, v74, v75
  ds_write_b128 v17, v[64:67] offset:13312
  s_bitcmp1_b32 s44, 0
  s_mov_b32 s52, 6144
  s_cselect_b32 s52, 12288, s52
  s_mov_b32 s53, 0
  s_cselect_b32 s53, 6144, s53
  v_mfma_f32_16x16x32_bf16 v[132:135], a[20:23], v[96:99], v[132:135]
  buffer_load_dwordx4 v[156:159], v1, s[8:11], s56 offen sc1
  v_add_u32 v116, s52, v19
  v_add_u32 v117, s53, v19
  s_waitcnt lgkmcnt(8)
  v_mfma_f32_16x16x32_bf16 v[128:131], a[32:35], v[100:103], v[128:131]
  ds_read_b128 v[92:95], v22 offset:53248
  s_add_u32 m0, s70, 16384
  s_add_u32 s69, s62, 65536
  v_add_u32 v118, s52, v20
  v_add_u32 v119, s53, v20
  s_waitcnt vmcnt(8) lgkmcnt(1)
  s_barrier
  v_mfma_f32_16x16x32_bf16 v[128:131], a[40:43], v[104:107], v[128:131]
  buffer_load_dwordx4 v9, s[8:11], s69 offen offset:0 sc1 lds
  ds_read_b128 v[52:55], v116
  ds_read_b128 v[56:59], v117 offset:1024
  ds_read_b128 v[60:63], v116 offset:1024
  ds_read_b64_tr_b16 v[64:65], v119 offset:2048
  ds_read_b64_tr_b16 v[66:67], v118 offset:2048
  ds_read_b64_tr_b16 v[68:69], v119 offset:2056
  v_mfma_f32_16x16x32_bf16 v[132:135], a[44:47], v[104:107], v[132:135]
  ds_read_b128 v[96:99], v22 offset:54272
  ds_read_b64_tr_b16 v[70:71], v118 offset:2056
  v_mfma_f32_16x16x32_bf16 v[132:135], a[36:39], v[100:103], v[132:135]
  v_mfma_f32_16x16x32_bf16 v[128:131], a[48:51], v[112:115], v[128:131]
  ds_read_b128 v[104:107], v22 offset:55296
  buffer_load_dwordx4 v9, s[8:11], s69 offen offset:1024 sc1 lds
  v_mfma_f32_16x16x32_bf16 v[128:131], a[56:59], v[108:111], v[128:131]
  v_mfma_f32_16x16x32_bf16 v[132:135], a[60:63], v[108:111], v[132:135]
  ds_read_b128 v[100:103], v22 offset:56320
  v_mfma_f32_16x16x32_bf16 v[132:135], a[52:55], v[112:115], v[132:135]
  buffer_load_dwordx4 v9, s[8:11], s69 offen offset:2048 sc1 lds
  s_waitcnt lgkmcnt(2)
  v_mfma_f32_16x16x32_bf16 v[116:119], v[56:59], v[52:55], 0
  v_mfma_f32_16x16x32_bf16 v[120:123], v[60:63], v[52:55], 0
  s_waitcnt lgkmcnt(12)
  v_mfma_f32_16x16x32_bf16 v[128:131], a[64:67], v[76:79], v[128:131]
  ds_read_b128 v[108:111], v23 offset:0
  v_mfma_f32_16x16x32_bf16 v[128:131], a[72:75], v[80:83], v[128:131]
  v_mfma_f32_16x16x32_bf16 v[132:135], a[76:79], v[80:83], v[132:135]
  ds_read_b128 v[112:115], v23 offset:1024
  buffer_load_dwordx4 v9, s[8:11], s69 offen offset:3072 sc1 lds
  v_mfma_f32_16x16x32_bf16 v[132:135], a[68:71], v[76:79], v[132:135]
  v_cndmask_b32 v72, v116, v120, s[80:81]
  v_cndmask_b32 v73, v117, v121, s[82:83]
  v_cndmask_b32 v74, v118, v122, s[84:85]
  v_cndmask_b32 v75, v119, v123, s[86:87]
  v_cndmask_b32 v72, v72, v73, s[88:89]
  v_cndmask_b32 v73, v74, v75, s[88:89]
  v_mul_f32 v72, 0x3e8293ee, v72
  v_mfma_f32_16x16x32_bf16 v[128:131], a[80:83], v[88:91], v[128:131]
  ds_read_b128 v[80:83], v23 offset:2048
  s_add_u32 m0, s70, 98304
  s_add_u32 s69, s63, 65536
  v_mul_f32 v73, 0x3e8293ee, v73
  v_max_f32 v74, v72, v73
  v_mov_b32 v75, v74
  v_mfma_f32_16x16x32_bf16 v[128:131], a[88:91], v[84:87], v[128:131]
  buffer_load_dwordx4 v9, s[8:11], s69 offen offset:0 sc1 lds
  v_permlane16_swap_b32 v74, v75
  v_max_f32 v74, v74, v75
  v_mov_b32 v75, v74
  v_mfma_f32_16x16x32_bf16 v[132:135], a[92:95], v[84:87], v[132:135]
  ds_read_b128 v[76:79], v23 offset:3072
  v_permlane32_swap_b32 v74, v75
  v_max_f32 v74, v74, v75
  v_sub_f32 v72, v72, v74
  v_sub_f32 v73, v73, v74
  v_exp_f32 v72, v72
  v_mfma_f32_16x16x32_bf16 v[132:135], a[84:87], v[88:91], v[132:135]
  v_exp_f32 v73, v73
  s_waitcnt lgkmcnt(4)
  v_mfma_f32_16x16x32_bf16 v[128:131], a[96:99], v[92:95], v[128:131]
  ds_read_b128 v[84:87], v23 offset:4096
  buffer_load_dwordx4 v9, s[8:11], s69 offen offset:1024 sc1 lds
  v_add_f32 v74, v72, v73
  v_mov_b32 v75, v74
  v_mfma_f32_16x16x32_bf16 v[128:131], a[104:107], v[96:99], v[128:131]
  s_nop 0
  v_permlane16_swap_b32 v74, v75
  v_add_f32 v74, v74, v75
  v_mov_b32 v75, v74
  v_mfma_f32_16x16x32_bf16 v[132:135], a[108:111], v[96:99], v[132:135]
  ds_read_b128 v[88:91], v23 offset:5120
  v_permlane32_swap_b32 v74, v75
  v_add_f32 v74, v74, v75
  v_rcp_f32 v74, v74
  v_mfma_f32_16x16x32_bf16 v[132:135], a[100:103], v[92:95], v[132:135]
  buffer_load_dwordx4 v9, s[8:11], s69 offen offset:2048 sc1 lds
  v_mul_f32 v72, v72, v74
  v_mul_f32 v73, v73, v74
  v_cvt_pk_bf16_f32 v72, v72, v72
  v_cvt_pk_bf16_f32 v73, v73, v73
  v_and_b32 v52, v24, v72
  v_and_b32 v53, v25, v73
  v_mfma_f32_16x16x32_bf16 v[128:131], a[112:115], v[104:107], v[128:131]
  ds_read_b128 v[96:99], v23 offset:6144
  v_and_b32 v54, v26, v72
  v_and_b32 v55, v27, v73
  v_mfma_f32_16x16x32_bf16 v[128:131], a[120:123], v[100:103], v[128:131]
HOP5:
  s_cbranch_execz WRET0
  s_nop 0
  v_mfma_f32_16x16x32_bf16 v[56:59], v[64:67], v[52:55], 0
  v_mfma_f32_16x16x32_bf16 v[60:63], v[68:71], v[52:55], 0
  v_mfma_f32_16x16x32_bf16 v[132:135], a[124:127], v[100:103], v[132:135]
  ds_read_b128 v[92:95], v23 offset:7168
  buffer_load_dwordx4 v9, s[8:11], s69 offen offset:3072 sc1 lds
  v_mfma_f32_16x16x32_bf16 v[132:135], a[116:119], v[104:107], v[132:135]
  s_waitcnt lgkmcnt(4)
  v_mfma_f32_16x16x32_bf16 v[128:131], a[128:131], v[108:111], v[128:131]
  ds_read_b128 v[100:103], v23 offset:49152
  s_add_u32 m0, s70, 81920
  s_add_u32 s69, s64, 65536
  v_mfma_f32_16x16x32_bf16 v[128:131], a[136:139], v[112:115], v[128:131]
  buffer_load_dwordx4 v9, s[8:11], s69 offen offset:0 sc1 lds
  v_cvt_pk_bf16_f32 v116, v56, v57
  v_cvt_pk_bf16_f32 v117, v58, v59
  v_cvt_pk_bf16_f32 v118, v60, v61
  v_cvt_pk_bf16_f32 v119, v62, v63
  buffer_store_dwordx4 v[116:119], v1, s[8:11], s73 offen sc1
  s_add_u32 s73, s73, 65536
  v_mfma_f32_16x16x32_bf16 v[132:135], a[140:143], v[112:115], v[132:135]
  ds_read_b128 v[104:107], v23 offset:50176
  v_mfma_f32_16x16x32_bf16 v[132:135], a[132:135], v[108:111], v[132:135]
  v_mfma_f32_16x16x32_bf16 v[128:131], a[144:147], v[80:83], v[128:131]
  ds_read_b128 v[112:115], v23 offset:51200
  buffer_load_dwordx4 v9, s[8:11], s69 offen offset:1024 sc1 lds
  v_mfma_f32_16x16x32_bf16 v[128:131], a[152:155], v[76:79], v[128:131]
  v_mfma_f32_16x16x32_bf16 v[132:135], a[156:159], v[76:79], v[132:135]
  ds_read_b128 v[108:111], v23 offset:52224
  v_mfma_f32_16x16x32_bf16 v[132:135], a[148:151], v[80:83], v[132:135]
  buffer_load_dwordx4 v9, s[8:11], s69 offen offset:2048 sc1 lds
  s_waitcnt lgkmcnt(4)
  v_mfma_f32_16x16x32_bf16 v[128:131], a[160:163], v[84:87], v[128:131]
  ds_read_b128 v[76:79], v23 offset:53248
  s_cmp_lg_u32 s44, 0
  s_cbranch_scc1 PL11_adaLN_cond__sliding_local_dilated__swiglu_ffn__prompt_kernelx
  s_waitcnt vmcnt(14)
  v_subrev_u32 v13, s46, v13
  v_subrev_u32 v13, 2, v13
  v_cmp_lt_u32 vcc, 3, v13
  s_nop 4
  s_cbranch_vccz PL11_adaLN_cond__sliding_local_dilated__swiglu_ffn__prompt_kernelx
  s_mov_b32 s57, 60000
PL11_adaLN_cond__sliding_local_dilated__swiglu_ffn__prompt_kernel:
  buffer_load_dword v13, v14, s[8:11], s77 offen sc1
  s_sub_u32 s57, s57, 1
  s_cmp_eq_u32 s57, 0
  s_waitcnt vmcnt(0)
  s_cbranch_scc1 PL11_adaLN_cond__sliding_local_dilated__swiglu_ffn__prompt_kernelx
  v_subrev_u32 v13, s46, v13
  v_subrev_u32 v13, 2, v13
  v_cmp_lt_u32 vcc, 3, v13
  s_nop 4
  s_cbranch_vccnz PL11_adaLN_cond__sliding_local_dilated__swiglu_ffn__prompt_kernel
PL11_adaLN_cond__sliding_local_dilated__swiglu_ffn__prompt_kernelx:
  s_barrier
  v_mfma_f32_16x16x32_bf16 v[128:131], a[168:171], v[88:91], v[128:131]
  s_waitcnt vmcnt(16)
  v_add_f32 v160, v160, v161
  v_add_f32 v162, v162, v163
  v_mfma_f32_16x16x32_bf16 v[132:135], a[172:175], v[88:91], v[132:135]
  ds_read_b128 v[80:83], v23 offset:54272
  buffer_load_dwordx4 v9, s[8:11], s69 offen offset:3072 sc1 lds
  v_add_f32 v160, v160, v162
  v_mfma_f32_16x16x32_bf16 v[132:135], a[164:167], v[84:87], v[132:135]
  v_cvt_pk_bf16_f32 v160, v160, v160
  v_lshlrev_b32 v160, 16, v160
  v_cvt_f32_u32 v181, v181
  v_mfma_f32_16x16x32_bf16 v[128:131], a[176:179], v[96:99], v[128:131]
  ds_read_b128 v[88:91], v23 offset:55296
  s_add_u32 m0, s70, 0
  s_add_u32 s69, s65, 65536
  v_mfma_f32_16x16x32_bf16 v[128:131], a[184:187], v[92:95], v[128:131]
  buffer_load_dwordx4 v9, s[8:11], s69 offen offset:0 sc1 lds
  v_add_f32 v160, v160, v181
  v_cvt_pk_bf16_f32 v160, v160, v160
  v_mfma_f32_16x16x32_bf16 v[132:135], a[188:191], v[92:95], v[132:135]
  ds_read_b128 v[84:87], v23 offset:56320
  v_lshlrev_b32 v160, 16, v160
  s_lshl_b32 s54, s44, 8
  v_mfma_f32_16x16x32_bf16 v[132:135], a[180:183], v[96:99], v[132:135]
  s_waitcnt vmcnt(6)
  s_barrier
  s_waitcnt lgkmcnt(4)
  v_mfma_f32_16x16x32_bf16 v[128:131], a[192:195], v[100:103], v[128:131]
  ds_read_b128 v[92:95], v22 offset:16384
  buffer_load_dwordx4 v9, s[8:11], s69 offen offset:1024 sc1 lds
  s_add_u32 s54, s54, 150528
  v_mfma_f32_16x16x32_bf16 v[128:131], a[200:203], v[104:107], v[128:131]
  v_lshl_add_u32 v180, v0, 2, s54
  v_lshrrev_b32 v161, 4, v0
  v_lshl_add_u32 v181, v161, 4, s54
  v_mfma_f32_16x16x32_bf16 v[132:135], a[204:207], v[104:107], v[132:135]
  ds_read_b128 v[96:99], v22 offset:17408
  ds_write_b32 v180, v160
  v_bfe_u32 v180, v0, 2, 2
  v_mfma_f32_16x16x32_bf16 v[132:135], a[196:199], v[100:103], v[132:135]
  buffer_load_dwordx4 v9, s[8:11], s69 offen offset:2048 sc1 lds
  v_xor_b32 v180, v180, v161
  v_lshlrev_b32 v180, 27, v180
  v_mfma_f32_16x16x32_bf16 v[128:131], a[208:211], v[112:115], v[128:131]
  ds_read_b128 v[104:107], v22 offset:18432
  v_and_b32 v162, 15, v0
  v_lshl_add_u32 v180, v162, 4, v180
  v_mfma_f32_16x16x32_bf16 v[128:131], a[216:219], v[108:111], v[128:131]
  s_and_b32 s54, s44, 1
  s_lshl_b32 s54, s54, 11
  v_add_u32 v182, s54, v1
  v_mfma_f32_16x16x32_bf16 v[132:135], a[220:223], v[108:111], v[132:135]
  ds_read_b128 v[100:103], v22 offset:19456
  buffer_load_dwordx4 v9, s[8:11], s69 offen offset:3072 sc1 lds
  s_and_b32 s54, s44, 2
  v_mfma_f32_16x16x32_bf16 v[132:135], a[212:215], v[112:115], v[132:135]
  s_lshl_b32 s54, s54, 9
  s_add_u32 s54, s54, 135168
  s_waitcnt lgkmcnt(5)
  v_mfma_f32_16x16x32_bf16 v[128:131], a[224:227], v[76:79], v[128:131]
  ds_read_b128 v[108:111], v22 offset:20480
  s_add_u32 m0, s70, 32768
  s_add_u32 s69, s62, 131072
  v_mfma_f32_16x16x32_bf16 v[128:131], a[232:235], v[80:83], v[128:131]
  buffer_load_dwordx4 v9, s[8:11], s69 offen offset:0 sc1 lds
  v_add_u32 v182, s54, v182
  ds_read_b128 v[160:163], v181 offset:0
  v_mfma_f32_16x16x32_bf16 v[132:135], a[236:239], v[80:83], v[132:135]
  ds_read_b128 v[112:115], v22 offset:21504
  ds_read_b128 v[164:167], v181 offset:64
  ds_read_b128 v[168:171], v181 offset:128
  v_mfma_f32_16x16x32_bf16 v[132:135], a[228:231], v[76:79], v[132:135]
  ds_read_b128 v[172:175], v181 offset:192
  v_mov_b32 v176, 0x3f803f80
  v_mov_b32 v177, 0x3f803f80
  v_mfma_f32_16x16x32_bf16 v[128:131], a[240:243], v[88:91], v[128:131]
  ds_read_b128 v[80:83], v22 offset:22528
  v_lshrrev_b32 v220, 5, v0
  v_xor_b32 v220, 1, v220
  v_lshlrev_b32 v220, 12, v220
  buffer_load_dwordx4 v9, s[8:11], s69 offen offset:1024 sc1 lds
  v_mfma_f32_16x16x32_bf16 v[128:131], a[248:251], v[84:87], v[128:131]
  v_add_u32 v15, s46, v0
  v_add_u32 v15, 3, v15
  s_waitcnt vmcnt(9)
  s_barrier
  s_mov_b64 exec, 1
  buffer_store_dword v15, v0, s[8:11], s74 offen offset:0 sc1
  s_mov_b64 exec, -1
  v_mfma_f32_16x16x32_bf16 v[132:135], v[124:127], v[84:87], v[132:135]
  ds_read_b128 v[76:79], v22 offset:23552
  v_and_b32 v221, 31, v0
  v_lshl_add_u32 v220, v221, 3, v220
  v_mfma_f32_16x16x32_bf16 v[132:135], a[244:247], v[88:91], v[132:135]
  buffer_load_dwordx4 v9, s[8:11], s69 offen offset:2048 sc1 lds
  v_mov_b32 v178, 0x3f803f80
  s_waitcnt lgkmcnt(8)
  v_mfma_f32_16x16x32_bf16 v[136:139], a[0:3], v[92:95], 0
  ds_read_b128 v[84:87], v23 offset:32768
  v_mov_b32 v179, 0x3f803f80
  s_mov_b32 s90, 0xcccccccc
  v_mfma_f32_16x16x32_bf16 v[136:139], a[8:11], v[96:99], v[136:139]
  s_mov_b32 s91, 0xcccccccc
  v_mfma_f32_16x16x32_bf16 v[140:143], a[12:15], v[96:99], 0
  ds_read_b128 v[88:91], v23 offset:33792
  buffer_load_dwordx4 v9, s[8:11], s69 offen offset:3072 sc1 lds
  s_waitcnt vmcnt(25) lgkmcnt(4)
  v_mfma_f32_16x16x32_bf16 v[140:143], a[4:7], v[92:95], v[140:143]
  v_lshlrev_b32 v184, 16, v144
  v_and_b32 v185, 0xffff0000, v144
  v_lshlrev_b32 v186, 16, v145
  v_mfma_f32_16x16x32_bf16 v[136:139], a[16:19], v[104:107], v[136:139]
  ds_read_b128 v[96:99], v23 offset:34816
  s_add_u32 m0, s70, 49152
  s_add_u32 s69, s63, 131072
  v_mfma_f32_16x16x32_bf16 v[136:139], a[24:27], v[100:103], v[136:139]
  buffer_load_dwordx4 v9, s[8:11], s69 offen offset:0 sc1 lds
  v_and_b32 v187, 0xffff0000, v145
  v_lshlrev_b32 v188, 16, v146
  v_mfma_f32_16x16x32_bf16 v[140:143], a[28:31], v[100:103], v[140:143]
  ds_read_b128 v[92:95], v23 offset:35840
  v_and_b32 v189, 0xffff0000, v146
  v_lshlrev_b32 v190, 16, v147
  v_mfma_f32_16x16x32_bf16 v[140:143], a[20:23], v[104:107], v[140:143]
  v_and_b32 v191, 0xffff0000, v147
  v_fmac_f32 v184, v160, v128
  s_waitcnt lgkmcnt(4)
  v_mfma_f32_16x16x32_bf16 v[136:139], a[32:35], v[108:111], v[136:139]
  ds_read_b128 v[100:103], v23 offset:36864
  buffer_load_dwordx4 v9, s[8:11], s69 offen offset:1024 sc1 lds
  v_fmac_f32 v185, v161, v129
  v_mfma_f32_16x16x32_bf16 v[136:139], a[40:43], v[112:115], v[136:139]
  v_fmac_f32 v186, v162, v130
  v_fmac_f32 v187, v163, v131
  v_fmac_f32 v188, v164, v132
  v_mfma_f32_16x16x32_bf16 v[140:143], a[44:47], v[112:115], v[140:143]
  ds_read_b128 v[104:107], v23 offset:37888
  v_fmac_f32 v189, v165, v133
  v_fmac_f32 v190, v166, v134
  v_mfma_f32_16x16x32_bf16 v[140:143], a[36:39], v[108:111], v[140:143]
  buffer_load_dwordx4 v9, s[8:11], s69 offen offset:2048 sc1 lds
  v_fmac_f32 v191, v167, v135
  v_mul_f32 v128, v184, v168
  v_mfma_f32_16x16x32_bf16 v[136:139], a[48:51], v[80:83], v[136:139]
  ds_read_b128 v[112:115], v23 offset:38912
  v_mul_f32 v129, v185, v169
  v_mul_f32 v130, v186, v170
  v_mfma_f32_16x16x32_bf16 v[136:139], a[56:59], v[76:79], v[136:139]
  v_mul_f32 v131, v187, v171
  v_mul_f32 v132, v188, v172
  v_mul_f32 v133, v189, v173
  v_mfma_f32_16x16x32_bf16 v[140:143], a[60:63], v[76:79], v[140:143]
  ds_read_b128 v[108:111], v23 offset:39936
  buffer_load_dwordx4 v9, s[8:11], s69 offen offset:3072 sc1 lds
  v_mul_f32 v134, v190, v174
  v_mfma_f32_16x16x32_bf16 v[140:143], a[52:55], v[80:83], v[140:143]
  s_waitcnt vmcnt(9)
  s_barrier
  s_waitcnt lgkmcnt(4)
  v_mfma_f32_16x16x32_bf16 v[136:139], a[64:67], v[84:87], v[136:139]
  ds_read_b128 v[76:79], v23 offset:16384
  s_add_u32 m0, s70, 65536
  s_add_u32 s69, s64, 131072
  v_mfma_f32_16x16x32_bf16 v[136:139], a[72:75], v[88:91], v[136:139]
  buffer_load_dwordx4 v9, s[8:11], s69 offen offset:0 sc1 lds
  v_mul_f32 v135, v191, v175
  v_cvt_pk_bf16_f32 v196, v128, v129
  v_mfma_f32_16x16x32_bf16 v[140:143], a[76:79], v[88:91], v[140:143]
  ds_read_b128 v[80:83], v23 offset:17408
  v_cvt_pk_bf16_f32 v197, v130, v131
  v_cvt_pk_bf16_f32 v198, v132, v133
  v_mfma_f32_16x16x32_bf16 v[140:143], a[68:71], v[84:87], v[140:143]
  v_cvt_pk_bf16_f32 v199, v134, v135
  s_add_u32 s54, s47, 36700160
  buffer_store_dwordx4 v[196:199], v1, s[8:11], s54 offen sc1
  v_mfma_f32_16x16x32_bf16 v[136:139], a[80:83], v[96:99], v[136:139]
  ds_read_b128 v[88:91], v23 offset:18432
  buffer_load_dwordx4 v9, s[8:11], s69 offen offset:1024 sc1 lds
  v_cvt_pk_bf16_f32 v144, v184, v185
  v_mfma_f32_16x16x32_bf16 v[136:139], a[88:91], v[92:95], v[136:139]
  v_cvt_pk_bf16_f32 v145, v186, v187
  v_cvt_pk_bf16_f32 v146, v188, v189
  v_cvt_pk_bf16_f32 v147, v190, v191
  v_mfma_f32_16x16x32_bf16 v[140:143], a[92:95], v[92:95], v[140:143]
  ds_read_b128 v[84:87], v23 offset:19456
  v_mfma_f32_16x16x32_bf16 v[224:227], v[176:179], v[144:147], 0
  v_mfma_f32_16x16x32_bf16 v[140:143], a[84:87], v[96:99], v[140:143]
  buffer_load_dwordx4 v9, s[8:11], s69 offen offset:2048 sc1 lds
  s_waitcnt lgkmcnt(4)
  v_mfma_f32_16x16x32_bf16 v[136:139], a[96:99], v[100:103], v[136:139]
  ds_read_b128 v[92:95], v23 offset:20480
  v_mfma_f32_16x16x32_bf16 v[192:195], v[144:147], v[144:147], 0
  v_mfma_f32_16x16x32_bf16 v[136:139], a[104:107], v[104:107], v[136:139]
  v_mfma_f32_16x16x32_bf16 v[140:143], a[108:111], v[104:107], v[140:143]
  ds_read_b128 v[96:99], v23 offset:21504
  buffer_load_dwordx4 v9, s[8:11], s69 offen offset:3072 sc1 lds
  v_mfma_f32_16x16x32_bf16 v[140:143], a[100:103], v[100:103], v[140:143]
  s_nop 2
  v_cndmask_b32 v192, v192, v193, s[88:89]
  v_cndmask_b32 v194, v194, v195, s[88:89]
  v_cndmask_b32 v225, v192, v194, s[90:91]
  v_mfma_f32_16x16x32_bf16 v[136:139], a[112:115], v[112:115], v[136:139]
  ds_read_b128 v[104:107], v23 offset:22528
  s_add_u32 m0, s70, 114688
  s_add_u32 s69, s65, 131072
  v_mfma_f32_16x16x32_bf16 v[136:139], a[120:123], v[108:111], v[136:139]
  buffer_load_dwordx4 v9, s[8:11], s69 offen offset:0 sc1 lds
  v_mfma_f32_16x16x32_bf16 v[140:143], a[124:127], v[108:111], v[140:143]
  ds_read_b128 v[100:103], v23 offset:23552
  v_mfma_f32_16x16x32_bf16 v[140:143], a[116:119], v[112:115], v[140:143]
  s_waitcnt lgkmcnt(4)
  v_mfma_f32_16x16x32_bf16 v[136:139], a[128:131], v[76:79], v[136:139]
  ds_read_b128 v[108:111], v22 offset:0
  buffer_load_dwordx4 v9, s[8:11], s69 offen offset:1024 sc1 lds
  v_mfma_f32_16x16x32_bf16 v[136:139], a[136:139], v[80:83], v[136:139]
  v_mfma_f32_16x16x32_bf16 v[140:143], a[140:143], v[80:83], v[140:143]
  ds_read_b128 v[112:115], v22 offset:1024
  v_mfma_f32_16x16x32_bf16 v[140:143], a[132:135], v[76:79], v[140:143]
  buffer_load_dwordx4 v9, s[8:11], s69 offen offset:2048 sc1 lds
  v_mfma_f32_16x16x32_bf16 v[136:139], a[144:147], v[88:91], v[136:139]
  ds_read_b128 v[80:83], v22 offset:2048
  v_mfma_f32_16x16x32_bf16 v[136:139], a[152:155], v[84:87], v[136:139]
  v_mfma_f32_16x16x32_bf16 v[140:143], a[156:159], v[84:87], v[140:143]
  ds_read_b128 v[76:79], v22 offset:3072
  buffer_load_dwordx4 v9, s[8:11], s69 offen offset:3072 sc1 lds
  v_mfma_f32_16x16x32_bf16 v[140:143], a[148:151], v[88:91], v[140:143]
  s_waitcnt lgkmcnt(4)
  v_mfma_f32_16x16x32_bf16 v[136:139], a[160:163], v[92:95], v[136:139]
  ds_read_b128 v[84:87], v22 offset:4096
  v_mfma_f32_16x16x32_bf16 v[136:139], a[168:171], v[96:99], v[136:139]
  s_cmp_lg_u32 s44, 0
  s_cbranch_scc1 PI12_adaLN_cond__sliding_local_dilated__swiglu_ffn__prompt_kernel
  buffer_load_dword v13, v14, s[8:11], s77 offen sc1
PI12_adaLN_cond__sliding_local_dilated__swiglu_ffn__prompt_kernel:
  v_mfma_f32_16x16x32_bf16 v[140:143], a[172:175], v[96:99], v[140:143]
  ds_read_b128 v[88:91], v22 offset:5120
  v_mfma_f32_16x16x32_bf16 v[140:143], a[164:167], v[92:95], v[140:143]
  v_mfma_f32_16x16x32_bf16 v[136:139], a[176:179], v[104:107], v[136:139]
  ds_read_b128 v[96:99], v22 offset:6144
  v_mfma_f32_16x16x32_bf16 v[136:139], a[184:187], v[100:103], v[136:139]
  v_mfma_f32_16x16x32_bf16 v[140:143], a[188:191], v[100:103], v[140:143]
  ds_read_b128 v[92:95], v22 offset:7168
  v_mfma_f32_16x16x32_bf16 v[140:143], a[180:183], v[104:107], v[140:143]
  s_waitcnt vmcnt(9)
  s_barrier
  s_waitcnt lgkmcnt(4)
  v_mfma_f32_16x16x32_bf16 v[136:139], a[192:195], v[108:111], v[136:139]
  ds_read_b128 v[100:103], v22 offset:32768
  v_mfma_f32_16x16x32_bf16 v[136:139], a[200:203], v[112:115], v[136:139]
  v_mfma_f32_16x16x32_bf16 v[140:143], a[204:207], v[112:115], v[140:143]
  ds_read_b128 v[104:107], v22 offset:33792
  v_mfma_f32_16x16x32_bf16 v[140:143], a[196:199], v[108:111], v[140:143]
  v_mfma_f32_16x16x32_bf16 v[136:139], a[208:211], v[80:83], v[136:139]
  ds_read_b128 v[112:115], v22 offset:34816
  s_waitcnt vmcnt(37) lgkmcnt(15)
  v_lshlrev_b32 v184, 16, v148
  v_mfma_f32_16x16x32_bf16 v[136:139], a[216:219], v[76:79], v[136:139]
  v_and_b32 v185, 0xffff0000, v148
  v_lshlrev_b32 v186, 16, v149
  v_and_b32 v187, 0xffff0000, v149
  v_mfma_f32_16x16x32_bf16 v[140:143], a[220:223], v[76:79], v[140:143]
  ds_read_b128 v[108:111], v22 offset:35840
  v_lshlrev_b32 v188, 16, v150
  v_and_b32 v189, 0xffff0000, v150
  v_mfma_f32_16x16x32_bf16 v[140:143], a[212:215], v[80:83], v[140:143]
  v_lshlrev_b32 v190, 16, v151
  v_and_b32 v191, 0xffff0000, v151
  s_waitcnt lgkmcnt(4)
  v_mfma_f32_16x16x32_bf16 v[136:139], a[224:227], v[84:87], v[136:139]
  ds_read_b128 v[76:79], v22 offset:36864
  v_mfma_f32_16x16x32_bf16 v[136:139], a[232:235], v[88:91], v[136:139]
  v_mfma_f32_16x16x32_bf16 v[140:143], a[236:239], v[88:91], v[140:143]
  ds_read_b128 v[80:83], v22 offset:37888
  v_mfma_f32_16x16x32_bf16 v[140:143], a[228:231], v[84:87], v[140:143]
  v_mfma_f32_16x16x32_bf16 v[136:139], a[240:243], v[96:99], v[136:139]
  ds_read_b128 v[88:91], v22 offset:38912
  v_mfma_f32_16x16x32_bf16 v[136:139], a[248:251], v[92:95], v[136:139]
  v_mfma_f32_16x16x32_bf16 v[140:143], v[124:127], v[92:95], v[140:143]
  ds_read_b128 v[84:87], v22 offset:39936
  v_mfma_f32_16x16x32_bf16 v[140:143], a[244:247], v[96:99], v[140:143]
  s_waitcnt lgkmcnt(4)
  v_mfma_f32_16x16x32_bf16 v[128:131], a[0:3], v[100:103], 0
  ds_read_b128 v[92:95], v22 offset:49152
  v_mfma_f32_16x16x32_bf16 v[128:131], a[8:11], v[104:107], v[128:131]
  v_mfma_f32_16x16x32_bf16 v[132:135], a[12:15], v[104:107], 0
  ds_read_b128 v[96:99], v22 offset:50176
  v_fmac_f32 v184, v160, v136
  v_fmac_f32 v185, v161, v137
  v_mfma_f32_16x16x32_bf16 v[132:135], a[4:7], v[100:103], v[132:135]
  v_fmac_f32 v186, v162, v138
  v_fmac_f32 v187, v163, v139
  v_fmac_f32 v188, v164, v140
  v_mfma_f32_16x16x32_bf16 v[128:131], a[16:19], v[112:115], v[128:131]
  ds_read_b128 v[104:107], v22 offset:51200
  v_fmac_f32 v189, v165, v141
  v_fmac_f32 v190, v166, v142
  v_mfma_f32_16x16x32_bf16 v[128:131], a[24:27], v[108:111], v[128:131]
  v_fmac_f32 v191, v167, v143
  v_mul_f32 v136, v184, v168
  v_mul_f32 v137, v185, v169
  v_mfma_f32_16x16x32_bf16 v[132:135], a[28:31], v[108:111], v[132:135]
  ds_read_b128 v[100:103], v22 offset:52224
  v_mul_f32 v138, v186, v170
  v_mul_f32 v139, v187, v171
  v_mfma_f32_16x16x32_bf16 v[132:135], a[20:23], v[112:115], v[132:135]
  v_mul_f32 v140, v188, v172
  v_mul_f32 v141, v189, v173
  s_waitcnt lgkmcnt(4)
  v_mfma_f32_16x16x32_bf16 v[128:131], a[32:35], v[76:79], v[128:131]
  ds_read_b128 v[108:111], v22 offset:53248
  v_mul_f32 v142, v190, v174
  v_mul_f32 v143, v191, v175
  v_mfma_f32_16x16x32_bf16 v[128:131], a[40:43], v[80:83], v[128:131]
  v_cvt_pk_bf16_f32 v200, v136, v137
  v_cvt_pk_bf16_f32 v201, v138, v139
  v_cvt_pk_bf16_f32 v202, v140, v141
  v_mfma_f32_16x16x32_bf16 v[132:135], a[44:47], v[80:83], v[132:135]
  ds_read_b128 v[112:115], v22 offset:54272
  v_cvt_pk_bf16_f32 v203, v142, v143
  v_mfma_f32_16x16x32_bf16 v[132:135], a[36:39], v[76:79], v[132:135]
  s_add_u32 s54, s47, 36765696
  buffer_store_dwordx4 v[200:203], v1, s[8:11], s54 offen sc1
  v_cvt_pk_bf16_f32 v148, v184, v185
  v_mfma_f32_16x16x32_bf16 v[128:131], a[48:51], v[88:91], v[128:131]
  ds_read_b128 v[80:83], v22 offset:55296
  s_cmp_lg_u32 s44, 0
  s_cbranch_scc1 PL13_adaLN_cond__sliding_local_dilated__swiglu_ffn__prompt_kernelx
  s_waitcnt vmcnt(1)
  v_subrev_u32 v13, s46, v13
  v_subrev_u32 v13, 3, v13
  v_cmp_lt_u32 vcc, 3, v13
  s_nop 4
  s_cbranch_vccz PL13_adaLN_cond__sliding_local_dilated__swiglu_ffn__prompt_kernelx
  s_mov_b32 s57, 60000
PL13_adaLN_cond__sliding_local_dilated__swiglu_ffn__prompt_kernel:
  buffer_load_dword v13, v14, s[8:11], s77 offen sc1
  s_sub_u32 s57, s57, 1
  s_cmp_eq_u32 s57, 0
  s_waitcnt vmcnt(0)
  s_cbranch_scc1 PL13_adaLN_cond__sliding_local_dilated__swiglu_ffn__prompt_kernelx
  v_subrev_u32 v13, s46, v13
  v_subrev_u32 v13, 3, v13
  v_cmp_lt_u32 vcc, 3, v13
  s_nop 4
  s_cbranch_vccnz PL13_adaLN_cond__sliding_local_dilated__swiglu_ffn__prompt_kernel
PL13_adaLN_cond__sliding_local_dilated__swiglu_ffn__prompt_kernelx:
  s_barrier
  v_mfma_f32_16x16x32_bf16 v[128:131], a[56:59], v[84:87], v[128:131]
  s_add_u32 m0, s70, 16384
  s_add_u32 s69, s62, 196608
  v_cvt_pk_bf16_f32 v149, v186, v187
  v_mfma_f32_16x16x32_bf16 v[132:135], a[60:63], v[84:87], v[132:135]
  ds_read_b128 v[76:79], v22 offset:56320
  buffer_load_dwordx4 v9, s[8:11], s69 offen offset:0 sc1 lds
  v_cvt_pk_bf16_f32 v150, v188, v189
  v_mfma_f32_16x16x32_bf16 v[132:135], a[52:55], v[88:91], v[132:135]
  s_waitcnt vmcnt(2)
  s_barrier
  s_waitcnt lgkmcnt(4)
  v_mfma_f32_16x16x32_bf16 v[128:131], a[64:67], v[92:95], v[128:131]
  ds_read_b128 v[84:87], v23 offset:0
  buffer_load_dwordx4 v9, s[8:11], s69 offen offset:1024 sc1 lds
  v_cvt_pk_bf16_f32 v151, v190, v191
  v_mfma_f32_16x16x32_bf16 v[128:131], a[72:75], v[96:99], v[128:131]
  buffer_load_dwordx4 v9, s[8:11], s69 offen offset:2048 sc1 lds
  v_mfma_f32_16x16x32_bf16 v[226:229], v[176:179], v[148:151], 0
  v_mfma_f32_16x16x32_bf16 v[132:135], a[76:79], v[96:99], v[132:135]
  ds_read_b128 v[88:91], v23 offset:1024
  v_mfma_f32_16x16x32_bf16 v[192:195], v[148:151], v[148:151], 0
  v_mfma_f32_16x16x32_bf16 v[132:135], a[68:71], v[92:95], v[132:135]
  buffer_load_dwordx4 v9, s[8:11], s69 offen offset:3072 sc1 lds
  s_add_u32 m0, s70, 98304
  s_add_u32 s69, s63, 196608
  v_mfma_f32_16x16x32_bf16 v[128:131], a[80:83], v[104:107], v[128:131]
  ds_read_b128 v[96:99], v23 offset:2048
  buffer_load_dwordx4 v9, s[8:11], s69 offen offset:0 sc1 lds
  v_mfma_f32_16x16x32_bf16 v[128:131], a[88:91], v[100:103], v[128:131]
  v_cndmask_b32 v192, v192, v193, s[88:89]
  v_cndmask_b32 v194, v194, v195, s[88:89]
  v_cndmask_b32 v227, v192, v194, s[90:91]
  v_mfma_f32_16x16x32_bf16 v[132:135], a[92:95], v[100:103], v[132:135]
  ds_read_b128 v[92:95], v23 offset:3072
  buffer_load_dwordx4 v9, s[8:11], s69 offen offset:1024 sc1 lds
  buffer_store_dwordx4 v[224:227], v180, s[8:11], s48 offen offset:0 sc1
  v_mfma_f32_16x16x32_bf16 v[132:135], a[84:87], v[104:107], v[132:135]
  buffer_load_dwordx4 v9, s[8:11], s69 offen offset:2048 sc1 lds
  s_waitcnt lgkmcnt(4)
  v_mfma_f32_16x16x32_bf16 v[128:131], a[96:99], v[108:111], v[128:131]
  ds_read_b128 v[100:103], v23 offset:4096
  v_mfma_f32_16x16x32_bf16 v[128:131], a[104:107], v[112:115], v[128:131]
  buffer_load_dwordx4 v9, s[8:11], s69 offen offset:3072 sc1 lds
  s_add_u32 m0, s70, 81920
  s_add_u32 s69, s64, 196608
  v_mfma_f32_16x16x32_bf16 v[132:135], a[108:111], v[112:115], v[132:135]
  ds_read_b128 v[104:107], v23 offset:5120
  buffer_load_dwordx4 v9, s[8:11], s69 offen offset:0 sc1 lds
  v_mfma_f32_16x16x32_bf16 v[132:135], a[100:103], v[108:111], v[132:135]
  v_mfma_f32_16x16x32_bf16 v[128:131], a[112:115], v[80:83], v[128:131]
  ds_read_b128 v[112:115], v23 offset:6144
  buffer_load_dwordx4 v9, s[8:11], s69 offen offset:1024 sc1 lds
  v_mfma_f32_16x16x32_bf16 v[128:131], a[120:123], v[76:79], v[128:131]
  buffer_load_dwordx4 v9, s[8:11], s69 offen offset:2048 sc1 lds
  v_mfma_f32_16x16x32_bf16 v[132:135], a[124:127], v[76:79], v[132:135]
  ds_read_b128 v[108:111], v23 offset:7168
  v_mfma_f32_16x16x32_bf16 v[132:135], a[116:119], v[80:83], v[132:135]
  buffer_load_dwordx4 v9, s[8:11], s69 offen offset:3072 sc1 lds
  s_add_u32 m0, s70, 0
  s_add_u32 s69, s65, 196608
  s_waitcnt lgkmcnt(4)
  v_mfma_f32_16x16x32_bf16 v[128:131], a[128:131], v[84:87], v[128:131]
  ds_read_b128 v[76:79], v23 offset:49152
  buffer_load_dwordx4 v9, s[8:11], s69 offen offset:0 sc1 lds
  v_mfma_f32_16x16x32_bf16 v[128:131], a[136:139], v[88:91], v[128:131]
  v_mfma_f32_16x16x32_bf16 v[132:135], a[140:143], v[88:91], v[132:135]
  ds_read_b128 v[80:83], v23 offset:50176
  buffer_load_dwordx4 v9, s[8:11], s69 offen offset:1024 sc1 lds
  v_mfma_f32_16x16x32_bf16 v[132:135], a[132:135], v[84:87], v[132:135]
  buffer_load_dwordx4 v9, s[8:11], s69 offen offset:2048 sc1 lds
  v_mfma_f32_16x16x32_bf16 v[128:131], a[144:147], v[96:99], v[128:131]
  ds_read_b128 v[88:91], v23 offset:51200
  v_mfma_f32_16x16x32_bf16 v[128:131], a[152:155], v[92:95], v[128:131]
  buffer_load_dwordx4 v9, s[8:11], s69 offen offset:3072 sc1 lds
  v_mfma_f32_16x16x32_bf16 v[132:135], a[156:159], v[92:95], v[132:135]
  ds_read_b128 v[84:87], v23 offset:52224
  v_mfma_f32_16x16x32_bf16 v[132:135], a[148:151], v[96:99], v[132:135]
  s_waitcnt lgkmcnt(4)
  v_mfma_f32_16x16x32_bf16 v[128:131], a[160:163], v[100:103], v[128:131]
  ds_read_b128 v[92:95], v23 offset:53248
  v_mfma_f32_16x16x32_bf16 v[128:131], a[168:171], v[104:107], v[128:131]
  v_mfma_f32_16x16x32_bf16 v[132:135], a[172:175], v[104:107], v[132:135]
  ds_read_b128 v[96:99], v23 offset:54272
  s_mov_b32 s55, 0
  s_add_u32 m0, s45, 32768
  v_mfma_f32_16x16x32_bf16 v[132:135], a[164:167], v[100:103], v[132:135]
  buffer_load_dwordx4 v16, s[28:31], s55 offen lds
  v_mfma_f32_16x16x32_bf16 v[128:131], a[176:179], v[112:115], v[128:131]
  ds_read_b128 v[104:107], v23 offset:55296
  v_mfma_f32_16x16x32_bf16 v[128:131], a[184:187], v[108:111], v[128:131]
  v_mfma_f32_16x16x32_bf16 v[132:135], a[188:191], v[108:111], v[132:135]
  ds_read_b128 v[100:103], v23 offset:56320
  v_mfma_f32_16x16x32_bf16 v[132:135], a[180:183], v[112:115], v[132:135]
  s_waitcnt vmcnt(9)
  s_barrier
  s_waitcnt lgkmcnt(4)
  v_mfma_f32_16x16x32_bf16 v[128:131], a[192:195], v[76:79], v[128:131]
  ds_read_b128 v[108:111], v22 offset:16384
  s_mov_b32 s55, 0
  s_add_u32 m0, s45, 40960
  v_mfma_f32_16x16x32_bf16 v[128:131], a[200:203], v[80:83], v[128:131]
  buffer_load_dwordx4 v16, s[32:35], s55 offen lds
  v_mfma_f32_16x16x32_bf16 v[132:135], a[204:207], v[80:83], v[132:135]
  ds_read_b128 v[112:115], v22 offset:17408
  v_mfma_f32_16x16x32_bf16 v[132:135], a[196:199], v[76:79], v[132:135]
  v_mfma_f32_16x16x32_bf16 v[128:131], a[208:211], v[88:91], v[128:131]
  ds_read_b128 v[80:83], v22 offset:18432
  s_waitcnt vmcnt(56) lgkmcnt(15)
  v_lshlrev_b32 v184, 16, v152
  v_mfma_f32_16x16x32_bf16 v[128:131], a[216:219], v[84:87], v[128:131]
  v_and_b32 v185, 0xffff0000, v152
  v_lshlrev_b32 v186, 16, v153
  v_and_b32 v187, 0xffff0000, v153
  v_mfma_f32_16x16x32_bf16 v[132:135], a[220:223], v[84:87], v[132:135]
  ds_read_b128 v[76:79], v22 offset:19456
  s_mov_b32 s55, 229376
  s_add_u32 m0, s45, 36864
  v_mfma_f32_16x16x32_bf16 v[132:135], a[212:215], v[88:91], v[132:135]
  buffer_load_dwordx4 v16, s[28:31], s55 offen lds
  v_lshlrev_b32 v188, 16, v154
  s_waitcnt lgkmcnt(4)
  v_mfma_f32_16x16x32_bf16 v[128:131], a[224:227], v[92:95], v[128:131]
  ds_read_b128 v[84:87], v22 offset:20480
  v_and_b32 v189, 0xffff0000, v154
  v_lshlrev_b32 v190, 16, v155
  v_mfma_f32_16x16x32_bf16 v[128:131], a[232:235], v[96:99], v[128:131]
  v_and_b32 v191, 0xffff0000, v155
  v_mfma_f32_16x16x32_bf16 v[132:135], a[236:239], v[96:99], v[132:135]
  ds_read_b128 v[88:91], v22 offset:21504
  v_mfma_f32_16x16x32_bf16 v[132:135], a[228:231], v[92:95], v[132:135]
  v_mfma_f32_16x16x32_bf16 v[128:131], a[240:243], v[104:107], v[128:131]
  ds_read_b128 v[96:99], v22 offset:22528
  s_mov_b32 s55, 229376
  s_add_u32 m0, s45, 45056
  v_mfma_f32_16x16x32_bf16 v[128:131], a[248:251], v[100:103], v[128:131]
  buffer_load_dwordx4 v16, s[32:35], s55 offen lds
  v_mfma_f32_16x16x32_bf16 v[132:135], v[124:127], v[100:103], v[132:135]
  ds_read_b128 v[92:95], v22 offset:23552
  v_mfma_f32_16x16x32_bf16 v[132:135], a[244:247], v[104:107], v[132:135]
  s_waitcnt lgkmcnt(4)
  v_mfma_f32_16x16x32_bf16 v[136:139], a[0:3], v[108:111], 0
  ds_read_b128 v[100:103], v23 offset:32768
  v_mfma_f32_16x16x32_bf16 v[136:139], a[8:11], v[112:115], v[136:139]
  v_mfma_f32_16x16x32_bf16 v[140:143], a[12:15], v[112:115], 0
  ds_read_b128 v[104:107], v23 offset:33792
  s_add_u32 s56, s79, 12288
  v_fmac_f32 v184, v160, v128
  v_mfma_f32_16x16x32_bf16 v[140:143], a[4:7], v[108:111], v[140:143]
  buffer_load_dwordx2 v[212:213], v220, s[8:11], s56 offen sc1
  v_fmac_f32 v185, v161, v129
  v_fmac_f32 v186, v162, v130
  v_mfma_f32_16x16x32_bf16 v[136:139], a[16:19], v[80:83], v[136:139]
  ds_read_b128 v[112:115], v23 offset:34816
  v_fmac_f32 v187, v163, v131
  v_fmac_f32 v188, v164, v132
  v_mfma_f32_16x16x32_bf16 v[136:139], a[24:27], v[76:79], v[136:139]
  s_add_u32 s56, s79, 36864
  v_fmac_f32 v189, v165, v133
  v_fmac_f32 v190, v166, v134
  v_mfma_f32_16x16x32_bf16 v[140:143], a[28:31], v[76:79], v[140:143]
  ds_read_b128 v[108:111], v23 offset:35840
  buffer_load_dwordx2 v[214:215], v220, s[8:11], s56 offen sc1
  v_fmac_f32 v191, v167, v135
  v_mfma_f32_16x16x32_bf16 v[140:143], a[20:23], v[80:83], v[140:143]
  v_mul_f32 v128, v184, v168
  v_mul_f32 v129, v185, v169
  s_waitcnt lgkmcnt(4)
  v_mfma_f32_16x16x32_bf16 v[136:139], a[32:35], v[84:87], v[136:139]
  ds_read_b128 v[76:79], v23 offset:36864
  s_add_u32 s56, s79, 61440
  v_mul_f32 v130, v186, v170
  v_mfma_f32_16x16x32_bf16 v[136:139], a[40:43], v[88:91], v[136:139]
  buffer_load_dwordx2 v[216:217], v220, s[8:11], s56 offen sc1
  v_mul_f32 v131, v187, v171
  v_mul_f32 v132, v188, v172
  v_mfma_f32_16x16x32_bf16 v[140:143], a[44:47], v[88:91], v[140:143]
  ds_read_b128 v[80:83], v23 offset:37888
  v_mul_f32 v133, v189, v173
  v_mul_f32 v134, v190, v174
  v_mfma_f32_16x16x32_bf16 v[140:143], a[36:39], v[84:87], v[140:143]
  s_add_u32 s56, s79, 86016
  v_mul_f32 v135, v191, v175
  v_cvt_pk_bf16_f32 v204, v128, v129
  v_mfma_f32_16x16x32_bf16 v[136:139], a[48:51], v[96:99], v[136:139]
  ds_read_b128 v[88:91], v23 offset:38912
  buffer_load_dwordx2 v[218:219], v220, s[8:11], s56 offen sc1
  v_cvt_pk_bf16_f32 v205, v130, v131
  v_mfma_f32_16x16x32_bf16 v[136:139], a[56:59], v[92:95], v[136:139]
  v_cvt_pk_bf16_f32 v206, v132, v133
  v_cvt_pk_bf16_f32 v207, v134, v135
  v_mfma_f32_16x16x32_bf16 v[140:143], a[60:63], v[92:95], v[140:143]
  ds_read_b128 v[84:87], v23 offset:39936
  s_mov_b32 s55, 0
  s_add_u32 m0, s45, 65536
  v_mfma_f32_16x16x32_bf16 v[140:143], a[52:55], v[96:99], v[140:143]
  buffer_load_dwordx4 v11, s[28:31], s55 offen lds
HOP6:
  s_cbranch_execz WRET0
  s_waitcnt vmcnt(9)
  s_barrier
  s_waitcnt lgkmcnt(4)
  v_mfma_f32_16x16x32_bf16 v[136:139], a[64:67], v[100:103], v[136:139]
  ds_read_b128 v[92:95], v23 offset:16384
  s_add_u32 s54, s47, 36831232
  buffer_store_dwordx4 v[204:207], v1, s[8:11], s54 offen sc1
  v_mfma_f32_16x16x32_bf16 v[136:139], a[72:75], v[104:107], v[136:139]
  v_cvt_pk_bf16_f32 v152, v184, v185
  v_cvt_pk_bf16_f32 v153, v186, v187
  v_cvt_pk_bf16_f32 v154, v188, v189
  v_mfma_f32_16x16x32_bf16 v[140:143], a[76:79], v[104:107], v[140:143]
  ds_read_b128 v[96:99], v23 offset:17408
  v_cvt_pk_bf16_f32 v155, v190, v191
  v_mfma_f32_16x16x32_bf16 v[140:143], a[68:71], v[100:103], v[140:143]
  s_nop 0
  v_mfma_f32_16x16x32_bf16 v[228:231], v[176:179], v[152:155], 0
  v_mfma_f32_16x16x32_bf16 v[192:195], v[152:155], v[152:155], 0
  v_mfma_f32_16x16x32_bf16 v[136:139], a[80:83], v[112:115], v[136:139]
  ds_read_b128 v[104:107], v23 offset:18432
  s_mov_b32 s55, 0
  s_add_u32 m0, s45, 73728
  v_mfma_f32_16x16x32_bf16 v[136:139], a[88:91], v[108:111], v[136:139]
  buffer_load_dwordx4 v11, s[32:35], s55 offen lds
  v_mfma_f32_16x16x32_bf16 v[140:143], a[92:95], v[108:111], v[140:143]
  ds_read_b128 v[100:103], v23 offset:19456
  v_cndmask_b32 v192, v192, v193, s[88:89]
  v_cndmask_b32 v194, v194, v195, s[88:89]
  v_mfma_f32_16x16x32_bf16 v[140:143], a[84:87], v[112:115], v[140:143]
  v_cndmask_b32 v229, v192, v194, s[90:91]
  s_waitcnt lgkmcnt(4)
  v_mfma_f32_16x16x32_bf16 v[136:139], a[96:99], v[76:79], v[136:139]
  ds_read_b128 v[108:111], v23 offset:20480
  v_mfma_f32_16x16x32_bf16 v[136:139], a[104:107], v[80:83], v[136:139]
  v_mfma_f32_16x16x32_bf16 v[140:143], a[108:111], v[80:83], v[140:143]
  ds_read_b128 v[112:115], v23 offset:21504
  s_mov_b32 s55, 229376
  s_add_u32 m0, s45, 69632
  v_mfma_f32_16x16x32_bf16 v[140:143], a[100:103], v[76:79], v[140:143]
  buffer_load_dwordx4 v11, s[28:31], s55 offen lds
  v_mfma_f32_16x16x32_bf16 v[136:139], a[112:115], v[88:91], v[136:139]
  ds_read_b128 v[80:83], v23 offset:22528
  v_mfma_f32_16x16x32_bf16 v[136:139], a[120:123], v[84:87], v[136:139]
  v_mfma_f32_16x16x32_bf16 v[140:143], a[124:127], v[84:87], v[140:143]
  ds_read_b128 v[76:79], v23 offset:23552
  v_mfma_f32_16x16x32_bf16 v[140:143], a[116:119], v[88:91], v[140:143]
  s_waitcnt lgkmcnt(4)
  v_mfma_f32_16x16x32_bf16 v[136:139], a[128:131], v[92:95], v[136:139]
  ds_read_b128 v[84:87], v22 offset:0
  s_mov_b32 s55, 229376
  s_add_u32 m0, s45, 77824
  v_mfma_f32_16x16x32_bf16 v[136:139], a[136:139], v[96:99], v[136:139]
  buffer_load_dwordx4 v11, s[32:35], s55 offen lds
  v_mfma_f32_16x16x32_bf16 v[140:143], a[140:143], v[96:99], v[140:143]
  ds_read_b128 v[88:91], v22 offset:1024
  v_mfma_f32_16x16x32_bf16 v[140:143], a[132:135], v[92:95], v[140:143]
  v_mfma_f32_16x16x32_bf16 v[136:139], a[144:147], v[104:107], v[136:139]
  ds_read_b128 v[96:99], v22 offset:2048
  v_mfma_f32_16x16x32_bf16 v[136:139], a[152:155], v[100:103], v[136:139]
  v_mfma_f32_16x16x32_bf16 v[140:143], a[156:159], v[100:103], v[140:143]
  ds_read_b128 v[92:95], v22 offset:3072
  s_mov_b32 s55, 458752
  s_add_u32 m0, s45, 114688
  v_mfma_f32_16x16x32_bf16 v[140:143], a[148:151], v[104:107], v[140:143]
  buffer_load_dwordx4 v11, s[28:31], s55 offen lds
  s_waitcnt lgkmcnt(4)
  v_mfma_f32_16x16x32_bf16 v[136:139], a[160:163], v[108:111], v[136:139]
  ds_read_b128 v[100:103], v22 offset:4096
  v_mfma_f32_16x16x32_bf16 v[136:139], a[168:171], v[112:115], v[136:139]
  v_mfma_f32_16x16x32_bf16 v[140:143], a[172:175], v[112:115], v[140:143]
  ds_read_b128 v[104:107], v22 offset:5120
  v_mfma_f32_16x16x32_bf16 v[140:143], a[164:167], v[108:111], v[140:143]
  v_mfma_f32_16x16x32_bf16 v[136:139], a[176:179], v[80:83], v[136:139]
  ds_read_b128 v[112:115], v22 offset:6144
  s_mov_b32 s55, 458752
  s_add_u32 m0, s45, 122880
  v_mfma_f32_16x16x32_bf16 v[136:139], a[184:187], v[76:79], v[136:139]
  buffer_load_dwordx4 v11, s[32:35], s55 offen lds
  s_waitcnt vmcnt(63) lgkmcnt(15)
  v_mfma_f32_16x16x32_bf16 v[140:143], a[188:191], v[76:79], v[140:143]
  ds_read_b128 v[108:111], v22 offset:7168
  v_lshlrev_b32 v184, 16, v156
  v_mfma_f32_16x16x32_bf16 v[140:143], a[180:183], v[80:83], v[140:143]
  v_and_b32 v185, 0xffff0000, v156
  s_waitcnt lgkmcnt(4)
  v_mfma_f32_16x16x32_bf16 v[136:139], a[192:195], v[84:87], v[136:139]
  v_lshlrev_b32 v186, 16, v157
  v_and_b32 v187, 0xffff0000, v157
  v_mfma_f32_16x16x32_bf16 v[136:139], a[200:203], v[88:91], v[136:139]
  v_lshlrev_b32 v188, 16, v158
  v_and_b32 v189, 0xffff0000, v158
  v_mfma_f32_16x16x32_bf16 v[140:143], a[204:207], v[88:91], v[140:143]
  s_mov_b32 s55, 688128
  s_add_u32 m0, s45, 118784
  v_mfma_f32_16x16x32_bf16 v[140:143], a[196:199], v[84:87], v[140:143]
  buffer_load_dwordx4 v11, s[28:31], s55 offen lds
  v_lshlrev_b32 v190, 16, v159
  v_mfma_f32_16x16x32_bf16 v[136:139], a[208:211], v[96:99], v[136:139]
  v_and_b32 v191, 0xffff0000, v159
  v_mfma_f32_16x16x32_bf16 v[136:139], a[216:219], v[92:95], v[136:139]
  v_mfma_f32_16x16x32_bf16 v[140:143], a[220:223], v[92:95], v[140:143]
  v_mfma_f32_16x16x32_bf16 v[140:143], a[212:215], v[96:99], v[140:143]
  s_waitcnt lgkmcnt(0)
  v_mfma_f32_16x16x32_bf16 v[136:139], a[224:227], v[100:103], v[136:139]
  s_mov_b32 s55, 688128
  s_add_u32 m0, s45, 126976
  v_mfma_f32_16x16x32_bf16 v[136:139], a[232:235], v[104:107], v[136:139]
  buffer_load_dwordx4 v11, s[32:35], s55 offen lds
  v_mfma_f32_16x16x32_bf16 v[140:143], a[236:239], v[104:107], v[140:143]
  v_mfma_f32_16x16x32_bf16 v[140:143], a[228:231], v[100:103], v[140:143]
  v_mfma_f32_16x16x32_bf16 v[136:139], a[240:243], v[112:115], v[136:139]
  v_mfma_f32_16x16x32_bf16 v[136:139], a[248:251], v[108:111], v[136:139]
  v_mfma_f32_16x16x32_bf16 v[140:143], v[124:127], v[108:111], v[140:143]
  s_mov_b32 s55, 458752
  s_add_u32 m0, s45, 49152
  v_mfma_f32_16x16x32_bf16 v[140:143], a[244:247], v[112:115], v[140:143]
  buffer_load_dwordx4 v16, s[28:31], s55 offen lds
  s_nop 2
  v_fmac_f32 v184, v160, v136
  v_fmac_f32 v185, v161, v137
  v_fmac_f32 v186, v162, v138
  v_fmac_f32 v187, v163, v139
  v_fmac_f32 v188, v164, v140
  v_fmac_f32 v189, v165, v141
  v_fmac_f32 v190, v166, v142
  v_fmac_f32 v191, v167, v143
  v_mul_f32 v136, v184, v168
  v_mul_f32 v137, v185, v169
  v_mul_f32 v138, v186, v170
  v_mul_f32 v139, v187, v171
  v_mul_f32 v140, v188, v172
  v_mul_f32 v141, v189, v173
  v_mul_f32 v142, v190, v174
  v_mul_f32 v143, v191, v175
  v_cvt_pk_bf16_f32 v208, v136, v137
  v_cvt_pk_bf16_f32 v209, v138, v139
  v_cvt_pk_bf16_f32 v210, v140, v141
  v_cvt_pk_bf16_f32 v211, v142, v143
  s_add_u32 s54, s47, 36896768
  buffer_store_dwordx4 v[208:211], v1, s[8:11], s54 offen sc1
  v_cvt_pk_bf16_f32 v156, v184, v185
  v_cvt_pk_bf16_f32 v157, v186, v187
  v_cvt_pk_bf16_f32 v158, v188, v189
  v_cvt_pk_bf16_f32 v159, v190, v191
  s_nop 1
  v_mfma_f32_16x16x32_bf16 v[230:233], v[176:179], v[156:159], 0
  v_mfma_f32_16x16x32_bf16 v[192:195], v[156:159], v[156:159], 0
  s_nop 7
  v_cndmask_b32 v192, v192, v193, s[88:89]
  v_cndmask_b32 v194, v194, v195, s[88:89]
  v_cndmask_b32 v231, v192, v194, s[90:91]
  buffer_store_dwordx4 v[228:231], v180, s[8:11], s48 offen offset:256 sc1
  s_waitcnt lgkmcnt(0)
  s_barrier
  s_mov_b32 s55, 458752
  s_add_u32 m0, s45, 57344
  s_nop 0
  buffer_load_dwordx4 v16, s[32:35], s55 offen lds
  s_mov_b32 s55, 688128
  s_add_u32 m0, s45, 53248
  s_nop 0
  buffer_load_dwordx4 v16, s[28:31], s55 offen lds
  s_mov_b32 s55, 688128
  s_add_u32 m0, s45, 61440
  s_nop 0
  buffer_load_dwordx4 v16, s[32:35], s55 offen lds
  ds_write_b128 v182, v[144:147] offset:0
  ds_write_b128 v182, v[148:151] offset:4096
  ds_write_b128 v182, v[152:155] offset:8192
  ds_write_b128 v182, v[156:159] offset:12288
  v_mov_b32 v10, v16
  v_add_u32 v15, s46, v0
  s_waitcnt vmcnt(3)
  s_barrier
  s_mov_b64 exec, 1
  buffer_store_dword v15, v0, s[8:11], s49 offen offset:0 sc1
  s_mov_b64 exec, -1
  s_mov_b64 exec, 0
  s_cmp_eq_u32 s44, 1
  s_cbranch_scc1 HOP7
  s_cmp_eq_u32 s44, 2
  s_cbranch_scc1 HOP8
  s_cmp_eq_u32 s44, 3
  s_cbranch_scc1 HOP9
WRET1:
  s_mov_b64 exec, -1
  s_and_b32 s52, s2, 7
  s_bfe_u32 s51, s2, 0x20003
  s_lshr_b32 s50, s2, 5
  s_add_u32 s56, s51, s50
  s_and_b32 s56, s56, 3
  s_lshl_b32 s53, s50, 1
  s_lshr_b32 s54, s44, 1
  s_add_u32 s53, s53, s54
  s_lshl_b32 s63, s53, 3
  s_and_b32 s55, s44, 1
  s_add_u32 s63, s63, s55
  s_lshl_b32 s57, s63, 15
  s_add_u32 s57, s57, 36700160
  s_lshl_b32 s53, s50, 12
  s_add_u32 s82, s53, 753664
  v_and_b32 v15, 31, v0
  v_lshlrev_b32 v15, 7, v15
  v_lshrrev_b32 v33, 2, v0
  v_bfe_u32 v32, v33, 1, 2
  v_lshlrev_b32 v32, 5, v32
  v_lshl_add_u32 v32, v33, 7, v32
  v_and_b32 v33, 3, v0
  v_lshl_add_u32 v2, v33, 3, v32
  v_xor_b32 v3, 32, v2
  v_xor_b32 v4, 64, v2
  v_xor_b32 v5, 96, v2
  v_add_u32 v6, 65536, v2
  v_add_u32 v7, 65536, v3
  v_add_u32 v8, 65536, v4
  s_lshl_b32 s80, s2, 7
  s_lshl_b32 s53, s44, 28
  s_add_u32 s80, s80, s53
  s_add_u32 s80, s80, 884736
  s_lshl_b32 s53, s2, 2
  s_add_u32 s53, s53, s44
  s_lshl_b32 s53, s53, 7
  s_add_u32 s81, s53, 917504
  s_waitcnt vmcnt(16)
  v_add_f32 v212, v212, v214
  v_add_f32 v216, v216, v218
  v_add_f32 v212, v212, v216
  v_add_f32 v213, v213, v215
  v_add_f32 v217, v217, v219
  v_add_f32 v213, v213, v217
  v_lshrrev_b32 v32, 5, v0
  v_xor_b32 v33, 1, v32
  v_cvt_f32_u32 v33, v33
  v_cvt_pk_bf16_f32 v214, v212, v213
  v_lshlrev_b32 v212, 16, v214
  v_and_b32 v213, 0xffff0000, v214
  v_add_f32 v212, v212, v33
  v_add_f32 v213, v213, v33
  v_cvt_pk_bf16_f32 v214, v212, v213
  v_lshlrev_b32 v212, 16, v214
  v_and_b32 v213, 0xffff0000, v214
  v_lshrrev_b32 v215, 16, v214
  v_and_b32 v214, 0xffff, v214
  s_add_u32 s53, s45, 151552
  v_lshlrev_b32 v32, 8, v32
  v_lshl_add_u32 v32, v0, 3, v32
  v_add_u32 v32, s53, v32
  ds_write_b64 v32, v[214:215]
  ds_write_b64 v32, v[212:213] offset:256
  s_bitcmp1_b32 s2, 3
  s_cselect_b64 s[12:13], s[32:33], s[28:29]
  s_mov_b32 s14, 7340032
  s_mov_b32 s16, 0x03030303
  s_mov_b32 s17, 0x03030303
  s_mov_b32 s18, 0x0c0c0c0c
  s_mov_b32 s19, 0x0c0c0c0c
  s_mov_b32 s20, 0x30303030
  s_mov_b32 s21, 0x30303030
  s_mov_b32 s22, 0xc0c0c0c0
  s_mov_b32 s23, 0xc0c0c0c0
  s_cmp_lg_u32 s44, 0
  s_cbranch_scc1 PI14_adaLN_cond__sliding_local_dilated__swiglu_ffn__prompt_kernel
  buffer_load_dword v13, v15, s[8:11], s82 offen sc1
PI14_adaLN_cond__sliding_local_dilated__swiglu_ffn__prompt_kernel:
  s_waitcnt vmcnt(11)
  s_cmp_lg_u32 s44, 0
  s_cbranch_scc1 PL15_adaLN_cond__sliding_local_dilated__swiglu_ffn__prompt_kernelx
  s_waitcnt vmcnt(0)
  v_cmp_ne_u32 vcc, s46, v13
  s_nop 4
  s_cbranch_vccz PL15_adaLN_cond__sliding_local_dilated__swiglu_ffn__prompt_kernelx
  s_mov_b32 s83, 60000
PL15_adaLN_cond__sliding_local_dilated__swiglu_ffn__prompt_kernel:
  buffer_load_dword v13, v15, s[8:11], s82 offen sc1
  s_sub_u32 s83, s83, 1
  s_cmp_eq_u32 s83, 0
  s_waitcnt vmcnt(0)
  s_cbranch_scc1 PL15_adaLN_cond__sliding_local_dilated__swiglu_ffn__prompt_kernelx
  v_cmp_ne_u32 vcc, s46, v13
  s_nop 4
  s_cbranch_vccnz PL15_adaLN_cond__sliding_local_dilated__swiglu_ffn__prompt_kernel
PL15_adaLN_cond__sliding_local_dilated__swiglu_ffn__prompt_kernelx:
  s_barrier
  s_mov_b32 s64, 0
  s_add_u32 s72, s57, 0
  buffer_load_dwordx4 a[0:3], v1, s[8:11], s72 offen offset:0 sc1
  buffer_load_dwordx4 a[16:19], v1, s[8:11], s72 offen offset:1024 sc1
  s_add_u32 s72, s72, 65536
  buffer_load_dwordx4 a[4:7], v1, s[8:11], s72 offen offset:0 sc1
  buffer_load_dwordx4 a[20:23], v1, s[8:11], s72 offen offset:1024 sc1
  s_add_u32 s72, s72, 65536
  buffer_load_dwordx4 a[8:11], v1, s[8:11], s72 offen offset:0 sc1
  buffer_load_dwordx4 a[24:27], v1, s[8:11], s72 offen offset:1024 sc1
  s_add_u32 s72, s72, 65536
  buffer_load_dwordx4 a[12:15], v1, s[8:11], s72 offen offset:0 sc1
  buffer_load_dwordx4 a[28:31], v1, s[8:11], s72 offen offset:1024 sc1
  s_mov_b32 s65, 458752
  s_add_u32 s73, s57, 2048
  buffer_load_dwordx4 a[32:35], v1, s[8:11], s73 offen offset:0 sc1
  buffer_load_dwordx4 a[48:51], v1, s[8:11], s73 offen offset:1024 sc1
  s_add_u32 s73, s73, 65536
  buffer_load_dwordx4 a[36:39], v1, s[8:11], s73 offen offset:0 sc1
  buffer_load_dwordx4 a[52:55], v1, s[8:11], s73 offen offset:1024 sc1
  s_add_u32 s73, s73, 65536
  buffer_load_dwordx4 a[40:43], v1, s[8:11], s73 offen offset:0 sc1
  buffer_load_dwordx4 a[56:59], v1, s[8:11], s73 offen offset:1024 sc1
  s_add_u32 s73, s73, 65536
  buffer_load_dwordx4 a[44:47], v1, s[8:11], s73 offen offset:0 sc1
  buffer_load_dwordx4 a[60:63], v1, s[8:11], s73 offen offset:1024 sc1
  v_bfe_u32 v32, v0, 3, 1
  v_lshlrev_b32 v32, 9, v32
  v_and_b32 v33, 1, v0
  v_lshl_add_u32 v32, v33, 8, v32
  v_lshrrev_b32 v33, 4, v0
  v_lshl_add_u32 v32, v33, 6, v32
  v_add_u32 v14, s53, v32
  s_bfe_u32 s53, s2, 0x20004
  s_lshl_b32 s53, s53, 8
  v_and_b32 v32, 15, v0
  v_lshl_add_u32 v32, v32, 4, s53
  v_cmp_gt_u32 vcc, 896, v32
  v_mov_b32 v34, 1073741824
  v_mul_u32_u24 v33, 114688, v33
  v_cndmask_b32 v32, v34, v32, vcc
  s_lshr_b32 s53, s2, 6
  s_lshl_b32 s53, s53, 2
  s_add_u32 s53, s53, s44
  s_mul_i32 s53, s53, 458752
  s_mul_i32 s54, s52, 896
  s_add_u32 s53, s53, s54
  v_add3_u32 v13, v32, v33, s53
  ds_read_b64_tr_b16 a[160:161], v6 offset:0
  ds_read_b64_tr_b16 a[162:163], v6 offset:2048
  ds_read_b64_tr_b16 a[164:165], v6 offset:4096
  ds_read_b64_tr_b16 a[166:167], v6 offset:6144
  ds_read_b64_tr_b16 a[168:169], v6 offset:8192
  ds_read_b64_tr_b16 a[170:171], v6 offset:10240
  ds_read_b64_tr_b16 a[172:173], v6 offset:12288
  ds_read_b64_tr_b16 a[174:175], v6 offset:14336
  ds_read_b64_tr_b16 a[176:177], v7 offset:0
  s_waitcnt vmcnt(8) lgkmcnt(5)
  v_mfma_f32_16x16x32_bf16 v[64:67], a[160:163], a[0:3], 0
  ds_read_b64_tr_b16 a[178:179], v7 offset:2048
  s_mov_b32 s66, 917504
  s_add_u32 s74, s57, 4096
  s_add_u32 m0, s45, 98304
  v_mfma_f32_16x16x32_bf16 v[64:67], a[164:167], a[16:19], v[64:67]
  buffer_load_dwordx4 v11, s[28:31], s66 offen lds
  v_mfma_f32_16x16x32_bf16 v[68:71], a[164:167], a[20:23], 0
  ds_read_b64_tr_b16 a[180:181], v7 offset:4096
  v_mfma_f32_16x16x32_bf16 v[68:71], a[160:163], a[4:7], v[68:71]
  v_mfma_f32_16x16x32_bf16 v[72:75], a[160:163], a[8:11], 0
  ds_read_b64_tr_b16 a[182:183], v7 offset:6144
  s_add_u32 m0, s45, 106496
  v_mfma_f32_16x16x32_bf16 v[72:75], a[164:167], a[24:27], v[72:75]
  buffer_load_dwordx4 v11, s[32:35], s66 offen lds
  v_mfma_f32_16x16x32_bf16 v[76:79], a[164:167], a[28:31], 0
  ds_read_b64_tr_b16 a[164:165], v7 offset:8192
  v_mfma_f32_16x16x32_bf16 v[76:79], a[160:163], a[12:15], v[76:79]
  s_waitcnt lgkmcnt(5)
  v_mfma_f32_16x16x32_bf16 v[92:95], a[168:171], a[12:15], 0
  ds_read_b64_tr_b16 a[166:167], v7 offset:10240
  s_add_u32 m0, s45, 102400
  s_add_u32 s61, s66, 229376
  v_mfma_f32_16x16x32_bf16 v[92:95], a[172:175], a[28:31], v[92:95]
  buffer_load_dwordx4 v11, s[28:31], s61 offen lds
  v_mfma_f32_16x16x32_bf16 v[88:91], a[172:175], a[24:27], 0
  ds_read_b64_tr_b16 a[160:161], v7 offset:12288
  v_mfma_f32_16x16x32_bf16 v[88:91], a[168:171], a[8:11], v[88:91]
  v_mfma_f32_16x16x32_bf16 v[84:87], a[168:171], a[4:7], 0
  ds_read_b64_tr_b16 a[162:163], v7 offset:14336
  s_add_u32 m0, s45, 110592
  s_add_u32 s61, s66, 229376
  v_mfma_f32_16x16x32_bf16 v[84:87], a[172:175], a[20:23], v[84:87]
  buffer_load_dwordx4 v11, s[32:35], s61 offen lds
  v_mfma_f32_16x16x32_bf16 v[80:83], a[172:175], a[16:19], 0
  ds_read_b64_tr_b16 a[172:173], v8 offset:0
  v_mfma_f32_16x16x32_bf16 v[80:83], a[168:171], a[0:3], v[80:83]
  s_waitcnt lgkmcnt(5)
  v_mfma_f32_16x16x32_bf16 v[96:99], a[176:179], a[0:3], 0
  ds_read_b64_tr_b16 a[174:175], v8 offset:2048
  s_add_u32 m0, s45, 16384
  v_mfma_f32_16x16x32_bf16 v[96:99], a[180:183], a[16:19], v[96:99]
  buffer_load_dwordx4 v10, s[28:31], s66 offen lds
  v_mfma_f32_16x16x32_bf16 v[100:103], a[180:183], a[20:23], 0
  ds_read_b64_tr_b16 a[168:169], v8 offset:4096
  v_mfma_f32_16x16x32_bf16 v[100:103], a[176:179], a[4:7], v[100:103]
  v_mfma_f32_16x16x32_bf16 v[104:107], a[176:179], a[8:11], 0
  ds_read_b64_tr_b16 a[170:171], v8 offset:6144
  s_add_u32 m0, s45, 24576
  v_mfma_f32_16x16x32_bf16 v[104:107], a[180:183], a[24:27], v[104:107]
  buffer_load_dwordx4 v10, s[32:35], s66 offen lds
  s_lshl_b32 s58, s51, 12
  v_mfma_f32_16x16x32_bf16 v[108:111], a[180:183], a[28:31], 0
  ds_read_b64_tr_b16 a[180:181], v8 offset:8192
  s_lshl_b32 s54, s51, 3
  v_mfma_f32_16x16x32_bf16 v[108:111], a[176:179], a[12:15], v[108:111]
  s_lshr_b32 s53, 0x0b070602, s54
  s_waitcnt lgkmcnt(5)
  v_mfma_f32_16x16x32_bf16 v[124:127], a[164:167], a[12:15], 0
  ds_read_b64_tr_b16 a[182:183], v8 offset:10240
  s_add_u32 m0, s45, 20480
  s_add_u32 s61, s66, 229376
  v_mfma_f32_16x16x32_bf16 v[124:127], a[160:163], a[28:31], v[124:127]
  buffer_load_dwordx4 v10, s[28:31], s61 offen lds
  s_and_b32 s53, s53, 15
  v_mfma_f32_16x16x32_bf16 v[120:123], a[160:163], a[24:27], 0
  ds_read_b64_tr_b16 a[176:177], v8 offset:12288
  s_lshl_b32 s59, s53, 10
  v_mfma_f32_16x16x32_bf16 v[120:123], a[164:167], a[8:11], v[120:123]
  s_lshr_b32 s53, s51, 1
  s_mul_i32 s53, s53, 7168
  v_mfma_f32_16x16x32_bf16 v[116:119], a[164:167], a[4:7], 0
  ds_read_b64_tr_b16 a[178:179], v8 offset:14336
  s_add_u32 m0, s45, 28672
  s_add_u32 s61, s66, 229376
  v_mfma_f32_16x16x32_bf16 v[116:119], a[160:163], a[20:23], v[116:119]
  buffer_load_dwordx4 v10, s[32:35], s61 offen lds
  s_and_b32 s54, s54, 8
  v_mfma_f32_16x16x32_bf16 v[112:115], a[160:163], a[16:19], 0
  ds_read_b64_tr_b16 a[160:161], v2 offset:32768
  s_add_u32 s53, s53, s54
  v_mfma_f32_16x16x32_bf16 v[112:115], a[164:167], a[0:3], v[112:115]
  s_add_u32 s60, s53, 3072
  s_waitcnt lgkmcnt(5)
  v_mfma_f32_16x16x32_bf16 v[32:35], a[172:175], a[0:3], 0
  ds_read_b64_tr_b16 a[162:163], v2 offset:34816
  v_mfma_f32_16x16x32_bf16 v[32:35], a[168:171], a[16:19], v[32:35]
  buffer_load_dwordx4 a[64:67], v1, s[8:11], s74 offen offset:0 sc1
  s_mul_i32 s53, s52, 14336
  v_mfma_f32_16x16x32_bf16 v[36:39], a[168:171], a[20:23], 0
  ds_read_b64_tr_b16 a[164:165], v2 offset:36864
  s_mul_i32 s54, s63, 131072
  v_mfma_f32_16x16x32_bf16 v[36:39], a[172:175], a[4:7], v[36:39]
  s_add_u32 s53, s53, s54
  s_add_u32 s53, s53, 19922944
  v_mfma_f32_16x16x32_bf16 v[40:43], a[172:175], a[8:11], 0
  ds_read_b64_tr_b16 a[166:167], v2 offset:38912
  s_add_u32 s58, s58, s53
  v_mfma_f32_16x16x32_bf16 v[40:43], a[168:171], a[24:27], v[40:43]
  buffer_load_dwordx4 a[80:83], v1, s[8:11], s74 offen offset:1024 sc1
  s_add_u32 s59, s59, s53
  v_mfma_f32_16x16x32_bf16 v[44:47], a[168:171], a[28:31], 0
  ds_read_b64_tr_b16 a[168:169], v2 offset:40960
  s_add_u32 s60, s60, s53
  v_mfma_f32_16x16x32_bf16 v[44:47], a[172:175], a[12:15], v[44:47]
  s_lshl_b32 s63, s50, 2
  s_waitcnt lgkmcnt(5)
  v_mfma_f32_16x16x32_bf16 v[60:63], a[180:183], a[12:15], 0
  ds_read_b64_tr_b16 a[170:171], v2 offset:43008
  s_add_u32 s74, s74, 65536
  v_mfma_f32_16x16x32_bf16 v[60:63], a[176:179], a[28:31], v[60:63]
  buffer_load_dwordx4 a[68:71], v1, s[8:11], s74 offen offset:0 sc1
  s_add_u32 s63, s63, s44
  v_mfma_f32_16x16x32_bf16 v[56:59], a[176:179], a[24:27], 0
  ds_read_b64_tr_b16 a[172:173], v2 offset:45056
  s_lshl_b32 s63, s63, 14
  v_mfma_f32_16x16x32_bf16 v[56:59], a[180:183], a[8:11], v[56:59]
  s_add_u32 s63, s63, 6291456
  v_and_b32 v12, 0x300, v1
  v_mfma_f32_16x16x32_bf16 v[52:55], a[180:183], a[4:7], 0
  ds_read_b64_tr_b16 a[174:175], v2 offset:47104
  v_add_u32 v12, v12, v1
  v_mfma_f32_16x16x32_bf16 v[52:55], a[176:179], a[20:23], v[52:55]
  buffer_load_dwordx4 a[84:87], v1, s[8:11], s74 offen offset:1024 sc1
  v_mfma_f32_16x16x32_bf16 v[48:51], a[176:179], a[16:19], 0
  ds_read_b64_tr_b16 a[176:177], v3 offset:32768
  v_mfma_f32_16x16x32_bf16 v[48:51], a[180:183], a[0:3], v[48:51]
  s_waitcnt lgkmcnt(5)
  v_mfma_f32_16x16x32_bf16 v[128:131], a[160:163], a[0:3], 0
  ds_read_b64_tr_b16 a[178:179], v3 offset:34816
  s_add_u32 s74, s74, 65536
  v_mfma_f32_16x16x32_bf16 v[128:131], a[164:167], a[16:19], v[128:131]
  buffer_load_dwordx4 a[72:75], v1, s[8:11], s74 offen offset:0 sc1
  v_mfma_f32_16x16x32_bf16 v[132:135], a[164:167], a[20:23], 0
  ds_read_b64_tr_b16 a[180:181], v3 offset:36864
  v_mfma_f32_16x16x32_bf16 v[132:135], a[160:163], a[4:7], v[132:135]
  v_mfma_f32_16x16x32_bf16 v[136:139], a[160:163], a[8:11], 0
  ds_read_b64_tr_b16 a[182:183], v3 offset:38912
  s_add_u32 s62, s63, 0
  v_mfma_f32_16x16x32_bf16 v[136:139], a[164:167], a[24:27], v[136:139]
  buffer_load_dwordx4 a[188:191], v12, s[8:11], s62 offen offset:0 sc1
  v_mfma_f32_16x16x32_bf16 v[140:143], a[164:167], a[28:31], 0
  ds_read_b64_tr_b16 a[164:165], v3 offset:40960
  v_mfma_f32_16x16x32_bf16 v[140:143], a[160:163], a[12:15], v[140:143]
  s_waitcnt lgkmcnt(5)
  v_mfma_f32_16x16x32_bf16 v[156:159], a[168:171], a[12:15], 0
  ds_read_b64_tr_b16 a[166:167], v3 offset:43008
  s_add_u32 s62, s63, 0
  v_mfma_f32_16x16x32_bf16 v[156:159], a[172:175], a[28:31], v[156:159]
  buffer_load_dwordx4 a[192:195], v12, s[8:11], s62 offen offset:256 sc1
  v_mfma_f32_16x16x32_bf16 v[152:155], a[172:175], a[24:27], 0
  ds_read_b64_tr_b16 a[160:161], v3 offset:45056
  v_mfma_f32_16x16x32_bf16 v[152:155], a[168:171], a[8:11], v[152:155]
  v_mfma_f32_16x16x32_bf16 v[148:151], a[168:171], a[4:7], 0
  ds_read_b64_tr_b16 a[162:163], v3 offset:47104
  s_add_u32 s62, s63, 2048
  v_mfma_f32_16x16x32_bf16 v[148:151], a[172:175], a[20:23], v[148:151]
  buffer_load_dwordx4 a[196:199], v12, s[8:11], s62 offen offset:0 sc1
  v_mfma_f32_16x16x32_bf16 v[144:147], a[172:175], a[16:19], 0
  ds_read_b64_tr_b16 a[172:173], v4 offset:32768
  v_mfma_f32_16x16x32_bf16 v[144:147], a[168:171], a[0:3], v[144:147]
  s_waitcnt lgkmcnt(5)
  v_mfma_f32_16x16x32_bf16 v[160:163], a[176:179], a[0:3], 0
  ds_read_b64_tr_b16 a[174:175], v4 offset:34816
  s_add_u32 s62, s63, 2048
  v_mfma_f32_16x16x32_bf16 v[160:163], a[180:183], a[16:19], v[160:163]
  buffer_load_dwordx4 a[200:203], v12, s[8:11], s62 offen offset:256 sc1
  v_mfma_f32_16x16x32_bf16 v[164:167], a[180:183], a[20:23], 0
  ds_read_b64_tr_b16 a[168:169], v4 offset:36864
  v_mfma_f32_16x16x32_bf16 v[164:167], a[176:179], a[4:7], v[164:167]
  v_mfma_f32_16x16x32_bf16 v[168:171], a[176:179], a[8:11], 0
  ds_read_b64_tr_b16 a[170:171], v4 offset:38912
  s_add_u32 s62, s63, 4096
  v_mfma_f32_16x16x32_bf16 v[168:171], a[180:183], a[24:27], v[168:171]
  buffer_load_dwordx4 a[204:207], v12, s[8:11], s62 offen offset:0 sc1
  v_mfma_f32_16x16x32_bf16 v[172:175], a[180:183], a[28:31], 0
  ds_read_b64_tr_b16 a[180:181], v4 offset:40960
  v_mfma_f32_16x16x32_bf16 v[172:175], a[176:179], a[12:15], v[172:175]
  s_waitcnt lgkmcnt(5)
  v_mfma_f32_16x16x32_bf16 v[188:191], a[164:167], a[12:15], 0
  ds_read_b64_tr_b16 a[182:183], v4 offset:43008
  s_add_u32 s62, s63, 4096
  v_mfma_f32_16x16x32_bf16 v[188:191], a[160:163], a[28:31], v[188:191]
  buffer_load_dwordx4 a[208:211], v12, s[8:11], s62 offen offset:256 sc1
  v_mfma_f32_16x16x32_bf16 v[184:187], a[160:163], a[24:27], 0
  ds_read_b64_tr_b16 a[176:177], v4 offset:45056
  v_mfma_f32_16x16x32_bf16 v[184:187], a[164:167], a[8:11], v[184:187]
  v_mfma_f32_16x16x32_bf16 v[180:183], a[164:167], a[4:7], 0
  ds_read_b64_tr_b16 a[178:179], v4 offset:47104
  s_add_u32 s62, s63, 6144
  v_mfma_f32_16x16x32_bf16 v[180:183], a[160:163], a[20:23], v[180:183]
  buffer_load_dwordx4 a[212:215], v12, s[8:11], s62 offen offset:0 sc1
  v_mfma_f32_16x16x32_bf16 v[176:179], a[160:163], a[16:19], 0
  ds_read_b64_tr_b16 a[160:161], v5 offset:32768
  v_mfma_f32_16x16x32_bf16 v[176:179], a[164:167], a[0:3], v[176:179]
  s_waitcnt lgkmcnt(5)
  v_mfma_f32_16x16x32_bf16 v[192:195], a[172:175], a[0:3], 0
  ds_read_b64_tr_b16 a[162:163], v5 offset:34816
  s_add_u32 s62, s63, 6144
  v_mfma_f32_16x16x32_bf16 v[192:195], a[168:171], a[16:19], v[192:195]
  buffer_load_dwordx4 a[216:219], v12, s[8:11], s62 offen offset:256 sc1
  v_mfma_f32_16x16x32_bf16 v[196:199], a[168:171], a[20:23], 0
  ds_read_b64_tr_b16 a[164:165], v5 offset:36864
  v_mfma_f32_16x16x32_bf16 v[196:199], a[172:175], a[4:7], v[196:199]
  v_mfma_f32_16x16x32_bf16 v[200:203], a[172:175], a[8:11], 0
  ds_read_b64_tr_b16 a[166:167], v5 offset:38912
  v_mfma_f32_16x16x32_bf16 v[200:203], a[168:171], a[24:27], v[200:203]
  buffer_load_dwordx4 a[88:91], v1, s[8:11], s74 offen offset:1024 sc1
  v_mfma_f32_16x16x32_bf16 v[204:207], a[168:171], a[28:31], 0
  ds_read_b64_tr_b16 a[168:169], v5 offset:40960
  v_mfma_f32_16x16x32_bf16 v[204:207], a[172:175], a[12:15], v[204:207]
  s_waitcnt lgkmcnt(5)
  v_mfma_f32_16x16x32_bf16 v[220:223], a[180:183], a[12:15], 0
  ds_read_b64_tr_b16 a[170:171], v5 offset:43008
  s_add_u32 s74, s74, 65536
  v_mfma_f32_16x16x32_bf16 v[220:223], a[176:179], a[28:31], v[220:223]
  buffer_load_dwordx4 a[76:79], v1, s[8:11], s74 offen offset:0 sc1
  v_mfma_f32_16x16x32_bf16 v[216:219], a[176:179], a[24:27], 0
  ds_read_b64_tr_b16 a[172:173], v5 offset:45056
  v_mfma_f32_16x16x32_bf16 v[216:219], a[180:183], a[8:11], v[216:219]
  v_mfma_f32_16x16x32_bf16 v[212:215], a[180:183], a[4:7], 0
  ds_read_b64_tr_b16 a[174:175], v5 offset:47104
  v_mfma_f32_16x16x32_bf16 v[212:215], a[176:179], a[20:23], v[212:215]
  buffer_load_dwordx4 a[92:95], v1, s[8:11], s74 offen offset:1024 sc1
  s_waitcnt vmcnt(41)
  s_barrier
  v_mfma_f32_16x16x32_bf16 v[208:211], a[176:179], a[16:19], 0
  ds_read_b64_tr_b16 a[176:177], v6 offset:49152
  v_mfma_f32_16x16x32_bf16 v[208:211], a[180:183], a[0:3], v[208:211]
  s_waitcnt lgkmcnt(5)
  v_mfma_f32_16x16x32_bf16 v[224:227], a[160:163], a[0:3], 0
  ds_read_b64_tr_b16 a[178:179], v6 offset:51200
  s_mov_b32 s67, 1376256
  s_add_u32 s75, s57, 6144
  s_add_u32 m0, s45, 81920
  v_mfma_f32_16x16x32_bf16 v[224:227], a[164:167], a[16:19], v[224:227]
  buffer_load_dwordx4 v11, s[28:31], s67 offen lds
  v_mfma_f32_16x16x32_bf16 v[228:231], a[164:167], a[20:23], 0
  ds_read_b64_tr_b16 a[180:181], v6 offset:53248
  v_mfma_f32_16x16x32_bf16 v[228:231], a[160:163], a[4:7], v[228:231]
  v_mfma_f32_16x16x32_bf16 v[232:235], a[160:163], a[8:11], 0
  ds_read_b64_tr_b16 a[182:183], v6 offset:55296
  s_add_u32 m0, s45, 90112
  v_mfma_f32_16x16x32_bf16 v[232:235], a[164:167], a[24:27], v[232:235]
  buffer_load_dwordx4 v11, s[32:35], s67 offen lds
  v_mfma_f32_16x16x32_bf16 v[236:239], a[164:167], a[28:31], 0
  ds_read_b64_tr_b16 a[164:165], v6 offset:57344
  v_mfma_f32_16x16x32_bf16 v[236:239], a[160:163], a[12:15], v[236:239]
  s_waitcnt lgkmcnt(5)
  v_mfma_f32_16x16x32_bf16 v[252:255], a[168:171], a[12:15], 0
  ds_read_b64_tr_b16 a[166:167], v6 offset:59392
  s_add_u32 m0, s45, 86016
  s_add_u32 s61, s67, 229376
  v_mfma_f32_16x16x32_bf16 v[252:255], a[172:175], a[28:31], v[252:255]
  buffer_load_dwordx4 v11, s[28:31], s61 offen lds
HOP7:
  s_cbranch_execz HOP10
  v_mfma_f32_16x16x32_bf16 v[248:251], a[172:175], a[24:27], 0
  ds_read_b64_tr_b16 a[160:161], v6 offset:61440
  v_mfma_f32_16x16x32_bf16 v[248:251], a[168:171], a[8:11], v[248:251]
  v_mfma_f32_16x16x32_bf16 v[244:247], a[168:171], a[4:7], 0
  ds_read_b64_tr_b16 a[162:163], v6 offset:63488
  s_add_u32 m0, s45, 94208
  s_add_u32 s61, s67, 229376
  v_mfma_f32_16x16x32_bf16 v[244:247], a[172:175], a[20:23], v[244:247]
  buffer_load_dwordx4 v11, s[32:35], s61 offen lds
  v_mfma_f32_16x16x32_bf16 v[240:243], a[172:175], a[16:19], 0
  ds_read_b64_tr_b16 a[172:173], v7 offset:49152
  v_mfma_f32_16x16x32_bf16 v[240:243], a[168:171], a[0:3], v[240:243]
  s_waitcnt vmcnt(28) lgkmcnt(5)
  v_mfma_f32_16x16x32_bf16 v[64:67], a[176:179], a[32:35], v[64:67]
  ds_read_b64_tr_b16 a[174:175], v7 offset:51200
  s_mov_b32 s62, 0
  v_mfma_f32_16x16x32_bf16 v[64:67], a[180:183], a[48:51], v[64:67]
  buffer_load_dwordx4 a[220:223], v13, s[12:15], s62 offen
  v_mfma_f32_16x16x32_bf16 v[68:71], a[180:183], a[52:55], v[68:71]
  ds_read_b64_tr_b16 a[168:169], v7 offset:53248
  s_mov_b32 s62, 7168
  v_mfma_f32_16x16x32_bf16 v[68:71], a[176:179], a[36:39], v[68:71]
  buffer_load_dwordx4 a[224:227], v13, s[12:15], s62 offen
  v_mfma_f32_16x16x32_bf16 v[72:75], a[176:179], a[40:43], v[72:75]
  ds_read_b64_tr_b16 a[170:171], v7 offset:55296
  s_mov_b32 s62, 14336
  v_mfma_f32_16x16x32_bf16 v[72:75], a[180:183], a[56:59], v[72:75]
  buffer_load_dwordx4 a[228:231], v13, s[12:15], s62 offen
  v_mfma_f32_16x16x32_bf16 v[76:79], a[180:183], a[60:63], v[76:79]
  ds_read_b64_tr_b16 a[180:181], v7 offset:57344
  s_mov_b32 s62, 21504
  v_mfma_f32_16x16x32_bf16 v[76:79], a[176:179], a[44:47], v[76:79]
  buffer_load_dwordx4 a[232:235], v13, s[12:15], s62 offen
  s_waitcnt lgkmcnt(5)
  v_mfma_f32_16x16x32_bf16 v[92:95], a[164:167], a[44:47], v[92:95]
  ds_read_b64_tr_b16 a[182:183], v7 offset:59392
  v_mfma_f32_16x16x32_bf16 v[92:95], a[160:163], a[60:63], v[92:95]
  v_mfma_f32_16x16x32_bf16 v[88:91], a[160:163], a[56:59], v[88:91]
  ds_read_b64_tr_b16 a[176:177], v7 offset:61440
  v_mfma_f32_16x16x32_bf16 v[88:91], a[164:167], a[40:43], v[88:91]
  v_mfma_f32_16x16x32_bf16 v[84:87], a[164:167], a[36:39], v[84:87]
  ds_read_b64_tr_b16 a[178:179], v7 offset:63488
  v_mfma_f32_16x16x32_bf16 v[84:87], a[160:163], a[52:55], v[84:87]
  v_mfma_f32_16x16x32_bf16 v[80:83], a[160:163], a[48:51], v[80:83]
  ds_read_b64_tr_b16 a[160:161], v8 offset:49152
  s_waitcnt vmcnt(11)
  v_mfma_f32_16x16x32_bf16 v[80:83], a[164:167], a[32:35], v[80:83]
  v_accvgpr_read_b32 v16, a188
  s_waitcnt lgkmcnt(5)
  v_mfma_f32_16x16x32_bf16 v[96:99], a[172:175], a[32:35], v[96:99]
  ds_read_b64_tr_b16 a[162:163], v8 offset:51200
  v_accvgpr_read_b32 v17, a189
  v_mfma_f32_16x16x32_bf16 v[96:99], a[168:171], a[48:51], v[96:99]
  v_accvgpr_read_b32 v18, a190
  v_accvgpr_read_b32 v19, a191
  v_mfma_f32_16x16x32_bf16 v[100:103], a[168:171], a[52:55], v[100:103]
  ds_read_b64_tr_b16 a[164:165], v8 offset:53248
  v_accvgpr_read_b32 v20, a192
  v_mfma_f32_16x16x32_bf16 v[100:103], a[172:175], a[36:39], v[100:103]
  v_accvgpr_read_b32 v21, a193
  v_accvgpr_read_b32 v22, a194
  v_mfma_f32_16x16x32_bf16 v[104:107], a[172:175], a[40:43], v[104:107]
  ds_read_b64_tr_b16 a[166:167], v8 offset:55296
  v_accvgpr_read_b32 v23, a195
  v_mfma_f32_16x16x32_bf16 v[104:107], a[168:171], a[56:59], v[104:107]
  v_accvgpr_read_b32 v24, a196
  v_accvgpr_read_b32 v25, a197
  v_mfma_f32_16x16x32_bf16 v[108:111], a[168:171], a[60:63], v[108:111]
  ds_read_b64_tr_b16 a[168:169], v8 offset:57344
  v_accvgpr_read_b32 v26, a198
  v_mfma_f32_16x16x32_bf16 v[108:111], a[172:175], a[44:47], v[108:111]
  v_accvgpr_read_b32 v27, a199
  s_waitcnt lgkmcnt(5)
  v_mfma_f32_16x16x32_bf16 v[124:127], a[180:183], a[44:47], v[124:127]
  ds_read_b64_tr_b16 a[170:171], v8 offset:59392
  v_accvgpr_read_b32 v28, a200
  v_mfma_f32_16x16x32_bf16 v[124:127], a[176:179], a[60:63], v[124:127]
  v_accvgpr_read_b32 v29, a201
  v_accvgpr_read_b32 v30, a202
  v_mfma_f32_16x16x32_bf16 v[120:123], a[176:179], a[56:59], v[120:123]
  ds_read_b64_tr_b16 a[172:173], v8 offset:61440
  v_accvgpr_read_b32 v31, a203
  v_mfma_f32_16x16x32_bf16 v[120:123], a[180:183], a[40:43], v[120:123]
  v_add_f32 v16, v16, v24
  v_add_f32 v17, v17, v25
  v_mfma_f32_16x16x32_bf16 v[116:119], a[180:183], a[36:39], v[116:119]
  ds_read_b64_tr_b16 a[174:175], v8 offset:63488
  v_add_f32 v18, v18, v26
  v_mfma_f32_16x16x32_bf16 v[116:119], a[176:179], a[52:55], v[116:119]
  v_add_f32 v19, v19, v27
  v_add_f32 v20, v20, v28
  v_mfma_f32_16x16x32_bf16 v[112:115], a[176:179], a[48:51], v[112:115]
  ds_read_b64_tr_b16 a[176:177], v2 offset:49152
  v_add_f32 v21, v21, v29
  v_mfma_f32_16x16x32_bf16 v[112:115], a[180:183], a[32:35], v[112:115]
  v_add_f32 v22, v22, v30
  s_waitcnt lgkmcnt(5)
  v_mfma_f32_16x16x32_bf16 v[32:35], a[160:163], a[32:35], v[32:35]
  ds_read_b64_tr_b16 a[178:179], v2 offset:51200
  v_add_f32 v23, v23, v31
  v_mfma_f32_16x16x32_bf16 v[32:35], a[164:167], a[48:51], v[32:35]
  v_accvgpr_read_b32 v24, a204
  v_accvgpr_read_b32 v25, a205
  v_mfma_f32_16x16x32_bf16 v[36:39], a[164:167], a[52:55], v[36:39]
  ds_read_b64_tr_b16 a[180:181], v2 offset:53248
  v_accvgpr_read_b32 v26, a206
  v_mfma_f32_16x16x32_bf16 v[36:39], a[160:163], a[36:39], v[36:39]
  v_accvgpr_read_b32 v27, a207
  v_accvgpr_read_b32 v28, a208
  v_mfma_f32_16x16x32_bf16 v[40:43], a[160:163], a[40:43], v[40:43]
  ds_read_b64_tr_b16 a[182:183], v2 offset:55296
  s_add_u32 m0, s45, 0
  v_mfma_f32_16x16x32_bf16 v[40:43], a[164:167], a[56:59], v[40:43]
  buffer_load_dwordx4 v10, s[28:31], s67 offen lds
  v_accvgpr_read_b32 v29, a209
  v_mfma_f32_16x16x32_bf16 v[44:47], a[164:167], a[60:63], v[44:47]
  ds_read_b64_tr_b16 a[164:165], v2 offset:57344
  v_accvgpr_read_b32 v30, a210
  v_mfma_f32_16x16x32_bf16 v[44:47], a[160:163], a[44:47], v[44:47]
  v_accvgpr_read_b32 v31, a211
  s_waitcnt lgkmcnt(5)
  v_mfma_f32_16x16x32_bf16 v[60:63], a[168:171], a[44:47], v[60:63]
  ds_read_b64_tr_b16 a[166:167], v2 offset:59392
  v_add_f32 v16, v16, v24
  v_mfma_f32_16x16x32_bf16 v[60:63], a[172:175], a[60:63], v[60:63]
  s_add_u32 m0, s45, 8192
  v_add_f32 v17, v17, v25
  v_mfma_f32_16x16x32_bf16 v[56:59], a[172:175], a[56:59], v[56:59]
  ds_read_b64_tr_b16 a[160:161], v2 offset:61440
  buffer_load_dwordx4 v10, s[32:35], s67 offen lds
  v_mfma_f32_16x16x32_bf16 v[56:59], a[168:171], a[40:43], v[56:59]
  v_add_f32 v18, v18, v26
  v_add_f32 v19, v19, v27
  v_mfma_f32_16x16x32_bf16 v[52:55], a[168:171], a[36:39], v[52:55]
  ds_read_b64_tr_b16 a[162:163], v2 offset:63488
  v_add_f32 v20, v20, v28
  v_mfma_f32_16x16x32_bf16 v[52:55], a[172:175], a[52:55], v[52:55]
  v_add_f32 v21, v21, v29
  v_add_f32 v22, v22, v30
  v_mfma_f32_16x16x32_bf16 v[48:51], a[172:175], a[48:51], v[48:51]
  ds_read_b64_tr_b16 a[172:173], v3 offset:49152
  s_add_u32 m0, s45, 4096
  s_add_u32 s61, s67, 229376
  v_mfma_f32_16x16x32_bf16 v[48:51], a[168:171], a[32:35], v[48:51]
  buffer_load_dwordx4 v10, s[28:31], s61 offen lds
  s_waitcnt lgkmcnt(5)
  v_mfma_f32_16x16x32_bf16 v[128:131], a[176:179], a[32:35], v[128:131]
  ds_read_b64_tr_b16 a[174:175], v3 offset:51200
  v_add_f32 v23, v23, v31
  v_mfma_f32_16x16x32_bf16 v[128:131], a[180:183], a[48:51], v[128:131]
  v_accvgpr_read_b32 v24, a212
  v_accvgpr_read_b32 v25, a213
  v_mfma_f32_16x16x32_bf16 v[132:135], a[180:183], a[52:55], v[132:135]
  ds_read_b64_tr_b16 a[168:169], v3 offset:53248
  v_accvgpr_read_b32 v26, a214
  v_mfma_f32_16x16x32_bf16 v[132:135], a[176:179], a[36:39], v[132:135]
  s_add_u32 m0, s45, 12288
  s_add_u32 s61, s67, 229376
  v_mfma_f32_16x16x32_bf16 v[136:139], a[176:179], a[40:43], v[136:139]
  ds_read_b64_tr_b16 a[170:171], v3 offset:55296
  buffer_load_dwordx4 v10, s[32:35], s61 offen lds
  v_mfma_f32_16x16x32_bf16 v[136:139], a[180:183], a[56:59], v[136:139]
  v_accvgpr_read_b32 v27, a215
  v_accvgpr_read_b32 v28, a216
  v_mfma_f32_16x16x32_bf16 v[140:143], a[180:183], a[60:63], v[140:143]
  ds_read_b64_tr_b16 a[180:181], v3 offset:57344
  v_accvgpr_read_b32 v29, a217
  v_mfma_f32_16x16x32_bf16 v[140:143], a[176:179], a[44:47], v[140:143]
  v_accvgpr_read_b32 v30, a218
  s_waitcnt lgkmcnt(5)
  v_mfma_f32_16x16x32_bf16 v[156:159], a[164:167], a[44:47], v[156:159]
  ds_read_b64_tr_b16 a[182:183], v3 offset:59392
  v_mfma_f32_16x16x32_bf16 v[156:159], a[160:163], a[60:63], v[156:159]
  buffer_load_dwordx4 a[96:99], v1, s[8:11], s75 offen offset:0 sc1
  v_accvgpr_read_b32 v31, a219
  v_mfma_f32_16x16x32_bf16 v[152:155], a[160:163], a[56:59], v[152:155]
  ds_read_b64_tr_b16 a[176:177], v3 offset:61440
  v_add_f32 v16, v16, v24
  v_mfma_f32_16x16x32_bf16 v[152:155], a[164:167], a[40:43], v[152:155]
  v_add_f32 v17, v17, v25
  v_add_f32 v18, v18, v26
  v_mfma_f32_16x16x32_bf16 v[148:151], a[164:167], a[36:39], v[148:151]
  ds_read_b64_tr_b16 a[178:179], v3 offset:63488
  v_add_f32 v19, v19, v27
  v_mfma_f32_16x16x32_bf16 v[148:151], a[160:163], a[52:55], v[148:151]
  v_add_f32 v20, v20, v28
  v_add_f32 v21, v21, v29
  v_mfma_f32_16x16x32_bf16 v[144:147], a[160:163], a[48:51], v[144:147]
  ds_read_b64_tr_b16 a[160:161], v4 offset:49152
  buffer_load_dwordx4 a[112:115], v1, s[8:11], s75 offen offset:1024 sc1
  v_mfma_f32_16x16x32_bf16 v[144:147], a[164:167], a[32:35], v[144:147]
  v_add_f32 v22, v22, v30
  s_waitcnt lgkmcnt(5)
  v_mfma_f32_16x16x32_bf16 v[160:163], a[172:175], a[32:35], v[160:163]
  ds_read_b64_tr_b16 a[162:163], v4 offset:51200
  v_add_f32 v23, v23, v31
  v_mfma_f32_16x16x32_bf16 v[160:163], a[168:171], a[48:51], v[160:163]
  v_mfma_f32_16x16x32_bf16 v[164:167], a[168:171], a[52:55], v[164:167]
  ds_read_b64_tr_b16 a[164:165], v4 offset:53248
  s_add_u32 s75, s75, 65536
  v_mfma_f32_16x16x32_bf16 v[164:167], a[172:175], a[36:39], v[164:167]
  buffer_load_dwordx4 a[100:103], v1, s[8:11], s75 offen offset:0 sc1
  v_mfma_f32_16x16x32_bf16 v[168:171], a[172:175], a[40:43], v[168:171]
  ds_read_b64_tr_b16 a[166:167], v4 offset:55296
  v_mfma_f32_16x16x32_bf16 v[168:171], a[168:171], a[56:59], v[168:171]
  v_mfma_f32_16x16x32_bf16 v[172:175], a[168:171], a[60:63], v[172:175]
  ds_read_b64_tr_b16 a[168:169], v4 offset:57344
  v_mfma_f32_16x16x32_bf16 v[172:175], a[172:175], a[44:47], v[172:175]
  s_waitcnt lgkmcnt(5)
  v_mfma_f32_16x16x32_bf16 v[188:191], a[180:183], a[44:47], v[188:191]
  ds_read_b64_tr_b16 a[170:171], v4 offset:59392
  buffer_load_dwordx4 a[116:119], v1, s[8:11], s75 offen offset:1024 sc1
  v_mfma_f32_16x16x32_bf16 v[188:191], a[176:179], a[60:63], v[188:191]
  v_mfma_f32_16x16x32_bf16 v[184:187], a[176:179], a[56:59], v[184:187]
  ds_read_b64_tr_b16 a[172:173], v4 offset:61440
  v_mfma_f32_16x16x32_bf16 v[184:187], a[180:183], a[40:43], v[184:187]
  v_mfma_f32_16x16x32_bf16 v[180:183], a[180:183], a[36:39], v[180:183]
  ds_read_b64_tr_b16 a[174:175], v4 offset:63488
  s_add_u32 s75, s75, 65536
  v_mfma_f32_16x16x32_bf16 v[180:183], a[176:179], a[52:55], v[180:183]
  buffer_load_dwordx4 a[104:107], v1, s[8:11], s75 offen offset:0 sc1
  v_mfma_f32_16x16x32_bf16 v[176:179], a[176:179], a[48:51], v[176:179]
  ds_read_b64_tr_b16 a[176:177], v5 offset:49152
  v_mfma_f32_16x16x32_bf16 v[176:179], a[180:183], a[32:35], v[176:179]
  s_waitcnt lgkmcnt(5)
  v_mfma_f32_16x16x32_bf16 v[192:195], a[160:163], a[32:35], v[192:195]
  ds_read_b64_tr_b16 a[178:179], v5 offset:51200
  v_mfma_f32_16x16x32_bf16 v[192:195], a[164:167], a[48:51], v[192:195]
  v_mfma_f32_16x16x32_bf16 v[196:199], a[164:167], a[52:55], v[196:199]
  ds_read_b64_tr_b16 a[180:181], v5 offset:53248
  buffer_load_dwordx4 a[120:123], v1, s[8:11], s75 offen offset:1024 sc1
  v_mfma_f32_16x16x32_bf16 v[196:199], a[160:163], a[36:39], v[196:199]
  v_mfma_f32_16x16x32_bf16 v[200:203], a[160:163], a[40:43], v[200:203]
  ds_read_b64_tr_b16 a[182:183], v5 offset:55296
  v_mfma_f32_16x16x32_bf16 v[200:203], a[164:167], a[56:59], v[200:203]
  v_mfma_f32_16x16x32_bf16 v[204:207], a[164:167], a[60:63], v[204:207]
  ds_read_b64_tr_b16 a[164:165], v5 offset:57344
  s_add_u32 s75, s75, 65536
  v_mfma_f32_16x16x32_bf16 v[204:207], a[160:163], a[44:47], v[204:207]
  buffer_load_dwordx4 a[108:111], v1, s[8:11], s75 offen offset:0 sc1
  s_waitcnt lgkmcnt(5)
  v_mfma_f32_16x16x32_bf16 v[220:223], a[168:171], a[44:47], v[220:223]
  ds_read_b64_tr_b16 a[166:167], v5 offset:59392
  ds_read_b128 v[24:27], v14 offset:0
  v_mfma_f32_16x16x32_bf16 v[220:223], a[172:175], a[60:63], v[220:223]
  v_mfma_f32_16x16x32_bf16 v[216:219], a[172:175], a[56:59], v[216:219]
  ds_read_b64_tr_b16 a[160:161], v5 offset:61440
  v_mfma_f32_16x16x32_bf16 v[216:219], a[168:171], a[40:43], v[216:219]
  v_mfma_f32_16x16x32_bf16 v[212:215], a[168:171], a[36:39], v[212:215]
  ds_read_b64_tr_b16 a[162:163], v5 offset:63488
  buffer_load_dwordx4 a[124:127], v1, s[8:11], s75 offen offset:1024 sc1
  v_mfma_f32_16x16x32_bf16 v[212:215], a[172:175], a[52:55], v[212:215]
  s_waitcnt vmcnt(36)
  s_barrier
  v_mfma_f32_16x16x32_bf16 v[208:211], a[172:175], a[48:51], v[208:211]
  ds_read_b64_tr_b16 a[172:173], v6 offset:32768
  s_waitcnt vmcnt(12) lgkmcnt(3)
  v_mfma_f32_16x16x32_bf16 v[208:211], a[168:171], a[32:35], v[208:211]
  v_cndmask_b32 v28, 0, v24, s[16:17]
  s_waitcnt lgkmcnt(6)
  v_mfma_f32_16x16x32_bf16 v[224:227], a[176:179], a[32:35], v[224:227]
  ds_read_b64_tr_b16 a[174:175], v6 offset:34816
  s_mov_b32 s62, 28672
  v_mfma_f32_16x16x32_bf16 v[224:227], a[180:183], a[48:51], v[224:227]
  buffer_load_dwordx4 a[236:239], v13, s[12:15], s62 offen
  v_cndmask_b32 v29, 0, v24, s[18:19]
  v_mfma_f32_16x16x32_bf16 v[228:231], a[180:183], a[52:55], v[228:231]
  ds_read_b64_tr_b16 a[168:169], v6 offset:36864
  s_mov_b32 s62, 35840
  v_mfma_f32_16x16x32_bf16 v[228:231], a[176:179], a[36:39], v[228:231]
  buffer_load_dwordx4 a[240:243], v13, s[12:15], s62 offen
  v_cndmask_b32 v30, 0, v24, s[20:21]
  v_mfma_f32_16x16x32_bf16 v[232:235], a[176:179], a[40:43], v[232:235]
  ds_read_b64_tr_b16 a[170:171], v6 offset:38912
  s_mov_b32 s62, 43008
  v_mfma_f32_16x16x32_bf16 v[232:235], a[180:183], a[56:59], v[232:235]
  buffer_load_dwordx4 a[244:247], v13, s[12:15], s62 offen
  v_cndmask_b32 v31, 0, v24, s[22:23]
  v_mfma_f32_16x16x32_bf16 v[236:239], a[180:183], a[60:63], v[236:239]
  ds_read_b64_tr_b16 a[180:181], v6 offset:40960
  s_mov_b32 s62, 50176
  v_mfma_f32_16x16x32_bf16 v[236:239], a[176:179], a[44:47], v[236:239]
  buffer_load_dwordx4 a[248:251], v13, s[12:15], s62 offen
  s_waitcnt lgkmcnt(5)
  v_mfma_f32_16x16x32_bf16 v[252:255], a[164:167], a[44:47], v[252:255]
  ds_read_b64_tr_b16 a[182:183], v6 offset:43008
  v_mfma_f32_16x16x32_bf16 v[252:255], a[160:163], a[60:63], v[252:255]
  v_mfma_f32_16x16x32_bf16 a[184:187], v[28:31], a[220:223], 0
  v_mfma_f32_16x16x32_bf16 v[248:251], a[160:163], a[56:59], v[248:251]
  ds_read_b64_tr_b16 a[176:177], v6 offset:45056
  v_cndmask_b32 v28, 0, v25, s[16:17]
  v_mfma_f32_16x16x32_bf16 v[248:251], a[164:167], a[40:43], v[248:251]
  v_cndmask_b32 v29, 0, v25, s[18:19]
  v_cndmask_b32 v30, 0, v25, s[20:21]
  v_mfma_f32_16x16x32_bf16 v[244:247], a[164:167], a[36:39], v[244:247]
  ds_read_b64_tr_b16 a[178:179], v6 offset:47104
  v_cndmask_b32 v31, 0, v25, s[22:23]
  v_mfma_f32_16x16x32_bf16 v[244:247], a[160:163], a[52:55], v[244:247]
  s_nop 0
  v_mfma_f32_16x16x32_bf16 a[184:187], v[28:31], a[224:227], a[184:187]
  v_mfma_f32_16x16x32_bf16 v[240:243], a[160:163], a[48:51], v[240:243]
  ds_read_b64_tr_b16 a[160:161], v7 offset:32768
  v_cndmask_b32 v28, 0, v26, s[16:17]
  v_mfma_f32_16x16x32_bf16 v[240:243], a[164:167], a[32:35], v[240:243]
  v_cndmask_b32 v29, 0, v26, s[18:19]
  s_waitcnt vmcnt(24) lgkmcnt(5)
  v_mfma_f32_16x16x32_bf16 v[64:67], a[172:175], a[64:67], v[64:67]
  ds_read_b64_tr_b16 a[162:163], v7 offset:34816
  v_cndmask_b32 v30, 0, v26, s[20:21]
  v_mfma_f32_16x16x32_bf16 v[64:67], a[168:171], a[80:83], v[64:67]
  v_cndmask_b32 v31, 0, v26, s[22:23]
  v_mfma_f32_16x16x32_bf16 v[68:71], a[168:171], a[84:87], v[68:71]
  ds_read_b64_tr_b16 a[164:165], v7 offset:36864
  v_mfma_f32_16x16x32_bf16 a[184:187], v[28:31], a[228:231], a[184:187]
  v_mfma_f32_16x16x32_bf16 v[68:71], a[172:175], a[68:71], v[68:71]
  v_cndmask_b32 v28, 0, v27, s[16:17]
  v_cndmask_b32 v29, 0, v27, s[18:19]
  v_mfma_f32_16x16x32_bf16 v[72:75], a[172:175], a[72:75], v[72:75]
  ds_read_b64_tr_b16 a[166:167], v7 offset:38912
  v_cndmask_b32 v30, 0, v27, s[20:21]
  v_mfma_f32_16x16x32_bf16 v[72:75], a[168:171], a[88:91], v[72:75]
  v_cndmask_b32 v31, 0, v27, s[22:23]
  v_mfma_f32_16x16x32_bf16 v[76:79], a[168:171], a[92:95], v[76:79]
  ds_read_b64_tr_b16 a[168:169], v7 offset:40960
  v_mfma_f32_16x16x32_bf16 a[184:187], v[28:31], a[232:235], a[184:187]
  v_mfma_f32_16x16x32_bf16 v[76:79], a[172:175], a[76:79], v[76:79]
  s_waitcnt lgkmcnt(5)
  v_mfma_f32_16x16x32_bf16 v[92:95], a[180:183], a[76:79], v[92:95]
  ds_read_b64_tr_b16 a[170:171], v7 offset:43008
  v_mfma_f32_16x16x32_bf16 v[92:95], a[176:179], a[92:95], v[92:95]
  v_mfma_f32_16x16x32_bf16 v[88:91], a[176:179], a[88:91], v[88:91]
  ds_read_b64_tr_b16 a[172:173], v7 offset:45056
  v_mfma_f32_16x16x32_bf16 v[88:91], a[180:183], a[72:75], v[88:91]
  v_mfma_f32_16x16x32_bf16 v[84:87], a[180:183], a[68:71], v[84:87]
  ds_read_b64_tr_b16 a[174:175], v7 offset:47104
  v_mfma_f32_16x16x32_bf16 v[84:87], a[176:179], a[84:87], v[84:87]
  v_mfma_f32_16x16x32_bf16 v[80:83], a[176:179], a[80:83], v[80:83]
  ds_read_b64_tr_b16 a[176:177], v8 offset:32768
  v_mfma_f32_16x16x32_bf16 v[80:83], a[180:183], a[64:67], v[80:83]
  s_waitcnt lgkmcnt(5)
  v_mfma_f32_16x16x32_bf16 v[96:99], a[160:163], a[64:67], v[96:99]
  ds_read_b64_tr_b16 a[178:179], v8 offset:34816
  v_mfma_f32_16x16x32_bf16 v[96:99], a[164:167], a[80:83], v[96:99]
  v_mfma_f32_16x16x32_bf16 v[100:103], a[164:167], a[84:87], v[100:103]
  ds_read_b64_tr_b16 a[180:181], v8 offset:36864
  v_mfma_f32_16x16x32_bf16 v[100:103], a[160:163], a[68:71], v[100:103]
  v_mfma_f32_16x16x32_bf16 v[104:107], a[160:163], a[72:75], v[104:107]
  ds_read_b64_tr_b16 a[182:183], v8 offset:38912
  s_cmp_eq_u32 s56, 0
  s_cselect_b32 s76, 8, 4
  s_mul_i32 s68, s76, 458752
  s_lshl_b32 s76, s76, 11
  s_add_u32 s76, s76, s57
  s_add_u32 m0, s45, 65536
  v_mfma_f32_16x16x32_bf16 v[104:107], a[164:167], a[88:91], v[104:107]
  buffer_load_dwordx4 v11, s[28:31], s68 offen lds
  v_mfma_f32_16x16x32_bf16 v[108:111], a[164:167], a[92:95], v[108:111]
  ds_read_b64_tr_b16 a[164:165], v8 offset:40960
  v_mfma_f32_16x16x32_bf16 v[108:111], a[160:163], a[76:79], v[108:111]
  s_waitcnt lgkmcnt(5)
  v_mfma_f32_16x16x32_bf16 v[124:127], a[168:171], a[76:79], v[124:127]
  ds_read_b64_tr_b16 a[166:167], v8 offset:43008
  v_mfma_f32_16x16x32_bf16 v[124:127], a[172:175], a[92:95], v[124:127]
  s_add_u32 m0, s45, 73728
  v_mfma_f32_16x16x32_bf16 v[120:123], a[172:175], a[88:91], v[120:123]
  ds_read_b64_tr_b16 a[160:161], v8 offset:45056
  buffer_load_dwordx4 v11, s[32:35], s68 offen lds
  v_mfma_f32_16x16x32_bf16 v[120:123], a[168:171], a[72:75], v[120:123]
  v_mfma_f32_16x16x32_bf16 v[116:119], a[168:171], a[68:71], v[116:119]
  ds_read_b64_tr_b16 a[162:163], v8 offset:47104
  v_mfma_f32_16x16x32_bf16 v[116:119], a[172:175], a[84:87], v[116:119]
  v_mfma_f32_16x16x32_bf16 v[112:115], a[172:175], a[80:83], v[112:115]
  ds_read_b64_tr_b16 a[172:173], v2 offset:16384
  s_add_u32 m0, s45, 69632
  s_add_u32 s61, s68, 229376
  v_mfma_f32_16x16x32_bf16 v[112:115], a[168:171], a[64:67], v[112:115]
  buffer_load_dwordx4 v11, s[28:31], s61 offen lds
  s_waitcnt lgkmcnt(5)
  v_mfma_f32_16x16x32_bf16 v[32:35], a[176:179], a[64:67], v[32:35]
  ds_read_b64_tr_b16 a[174:175], v2 offset:18432
  v_mfma_f32_16x16x32_bf16 v[32:35], a[180:183], a[80:83], v[32:35]
  v_mfma_f32_16x16x32_bf16 v[36:39], a[180:183], a[84:87], v[36:39]
  ds_read_b64_tr_b16 a[168:169], v2 offset:20480
  v_mfma_f32_16x16x32_bf16 v[36:39], a[176:179], a[68:71], v[36:39]
  s_add_u32 m0, s45, 77824
  s_add_u32 s61, s68, 229376
  v_mfma_f32_16x16x32_bf16 v[40:43], a[176:179], a[72:75], v[40:43]
  ds_read_b64_tr_b16 a[170:171], v2 offset:22528
  buffer_load_dwordx4 v11, s[32:35], s61 offen lds
  v_mfma_f32_16x16x32_bf16 v[40:43], a[180:183], a[88:91], v[40:43]
  v_mfma_f32_16x16x32_bf16 v[44:47], a[180:183], a[92:95], v[44:47]
  ds_read_b64_tr_b16 a[180:181], v2 offset:24576
  v_mfma_f32_16x16x32_bf16 v[44:47], a[176:179], a[76:79], v[44:47]
  s_waitcnt lgkmcnt(5)
  v_mfma_f32_16x16x32_bf16 v[60:63], a[164:167], a[76:79], v[60:63]
  ds_read_b64_tr_b16 a[182:183], v2 offset:26624
  s_add_u32 s62, s63, 8192
  v_mfma_f32_16x16x32_bf16 v[60:63], a[160:163], a[92:95], v[60:63]
  buffer_load_dwordx4 a[188:191], v12, s[8:11], s62 offen offset:0 sc1
  v_mfma_f32_16x16x32_bf16 v[56:59], a[160:163], a[88:91], v[56:59]
  ds_read_b64_tr_b16 a[176:177], v2 offset:28672
  v_mfma_f32_16x16x32_bf16 v[56:59], a[164:167], a[72:75], v[56:59]
  v_mfma_f32_16x16x32_bf16 v[52:55], a[164:167], a[68:71], v[52:55]
  ds_read_b64_tr_b16 a[178:179], v2 offset:30720
  v_mfma_f32_16x16x32_bf16 v[52:55], a[160:163], a[84:87], v[52:55]
  s_add_u32 s62, s63, 8192
  v_mfma_f32_16x16x32_bf16 v[48:51], a[160:163], a[80:83], v[48:51]
  ds_read_b64_tr_b16 a[160:161], v3 offset:16384
  buffer_load_dwordx4 a[192:195], v12, s[8:11], s62 offen offset:256 sc1
  v_mfma_f32_16x16x32_bf16 v[48:51], a[164:167], a[64:67], v[48:51]
  s_waitcnt lgkmcnt(5)
  v_mfma_f32_16x16x32_bf16 v[128:131], a[172:175], a[64:67], v[128:131]
  ds_read_b64_tr_b16 a[162:163], v3 offset:18432
  v_mfma_f32_16x16x32_bf16 v[128:131], a[168:171], a[80:83], v[128:131]
  v_mfma_f32_16x16x32_bf16 v[132:135], a[168:171], a[84:87], v[132:135]
  ds_read_b64_tr_b16 a[164:165], v3 offset:20480
  s_add_u32 s62, s63, 10240
  v_mfma_f32_16x16x32_bf16 v[132:135], a[172:175], a[68:71], v[132:135]
  buffer_load_dwordx4 a[196:199], v12, s[8:11], s62 offen offset:0 sc1
  v_mfma_f32_16x16x32_bf16 v[136:139], a[172:175], a[72:75], v[136:139]
  ds_read_b64_tr_b16 a[166:167], v3 offset:22528
  v_mfma_f32_16x16x32_bf16 v[136:139], a[168:171], a[88:91], v[136:139]
  v_mfma_f32_16x16x32_bf16 v[140:143], a[168:171], a[92:95], v[140:143]
  ds_read_b64_tr_b16 a[168:169], v3 offset:24576
  v_mfma_f32_16x16x32_bf16 v[140:143], a[172:175], a[76:79], v[140:143]
  s_add_u32 s62, s63, 10240
  s_waitcnt lgkmcnt(5)
  v_mfma_f32_16x16x32_bf16 v[156:159], a[180:183], a[76:79], v[156:159]
  ds_read_b64_tr_b16 a[170:171], v3 offset:26624
  buffer_load_dwordx4 a[200:203], v12, s[8:11], s62 offen offset:256 sc1
  v_mfma_f32_16x16x32_bf16 v[156:159], a[176:179], a[92:95], v[156:159]
  v_mfma_f32_16x16x32_bf16 v[152:155], a[176:179], a[88:91], v[152:155]
  ds_read_b64_tr_b16 a[172:173], v3 offset:28672
  v_mfma_f32_16x16x32_bf16 v[152:155], a[180:183], a[72:75], v[152:155]
  v_mfma_f32_16x16x32_bf16 v[148:151], a[180:183], a[68:71], v[148:151]
  ds_read_b64_tr_b16 a[174:175], v3 offset:30720
  s_add_u32 s62, s63, 12288
  v_mfma_f32_16x16x32_bf16 v[148:151], a[176:179], a[84:87], v[148:151]
  buffer_load_dwordx4 a[204:207], v12, s[8:11], s62 offen offset:0 sc1
  v_mfma_f32_16x16x32_bf16 v[144:147], a[176:179], a[80:83], v[144:147]
  ds_read_b64_tr_b16 a[176:177], v4 offset:16384
  v_mfma_f32_16x16x32_bf16 v[144:147], a[180:183], a[64:67], v[144:147]
  s_waitcnt lgkmcnt(5)
  v_mfma_f32_16x16x32_bf16 v[160:163], a[160:163], a[64:67], v[160:163]
  ds_read_b64_tr_b16 a[178:179], v4 offset:18432
  v_mfma_f32_16x16x32_bf16 v[160:163], a[164:167], a[80:83], v[160:163]
  s_add_u32 s62, s63, 12288
  v_mfma_f32_16x16x32_bf16 v[164:167], a[164:167], a[84:87], v[164:167]
  ds_read_b64_tr_b16 a[180:181], v4 offset:20480
  buffer_load_dwordx4 a[208:211], v12, s[8:11], s62 offen offset:256 sc1
  v_mfma_f32_16x16x32_bf16 v[164:167], a[160:163], a[68:71], v[164:167]
  v_mfma_f32_16x16x32_bf16 v[168:171], a[160:163], a[72:75], v[168:171]
  ds_read_b64_tr_b16 a[182:183], v4 offset:22528
  v_mfma_f32_16x16x32_bf16 v[168:171], a[164:167], a[88:91], v[168:171]
  v_mfma_f32_16x16x32_bf16 v[172:175], a[164:167], a[92:95], v[172:175]
  ds_read_b64_tr_b16 a[164:165], v4 offset:24576
  s_add_u32 s62, s63, 14336
  v_mfma_f32_16x16x32_bf16 v[172:175], a[160:163], a[76:79], v[172:175]
  buffer_load_dwordx4 a[212:215], v12, s[8:11], s62 offen offset:0 sc1
  s_waitcnt lgkmcnt(5)
  v_mfma_f32_16x16x32_bf16 v[188:191], a[168:171], a[76:79], v[188:191]
  ds_read_b64_tr_b16 a[166:167], v4 offset:26624
  v_mfma_f32_16x16x32_bf16 v[188:191], a[172:175], a[92:95], v[188:191]
  v_mfma_f32_16x16x32_bf16 v[184:187], a[172:175], a[88:91], v[184:187]
  ds_read_b64_tr_b16 a[160:161], v4 offset:28672
  v_mfma_f32_16x16x32_bf16 v[184:187], a[168:171], a[72:75], v[184:187]
  s_add_u32 s62, s63, 14336
  v_mfma_f32_16x16x32_bf16 v[180:183], a[168:171], a[68:71], v[180:183]
  ds_read_b64_tr_b16 a[162:163], v4 offset:30720
  buffer_load_dwordx4 a[216:219], v12, s[8:11], s62 offen offset:256 sc1
  v_mfma_f32_16x16x32_bf16 v[180:183], a[172:175], a[84:87], v[180:183]
  ds_read_b128 v[24:27], v14 offset:16
  v_mfma_f32_16x16x32_bf16 v[176:179], a[172:175], a[80:83], v[176:179]
  ds_read_b64_tr_b16 a[172:173], v5 offset:16384
  v_mfma_f32_16x16x32_bf16 v[176:179], a[168:171], a[64:67], v[176:179]
  s_waitcnt lgkmcnt(6)
  v_mfma_f32_16x16x32_bf16 v[192:195], a[176:179], a[64:67], v[192:195]
  ds_read_b64_tr_b16 a[174:175], v5 offset:18432
  s_add_u32 m0, s45, 32768
  v_mfma_f32_16x16x32_bf16 v[192:195], a[180:183], a[80:83], v[192:195]
  buffer_load_dwordx4 v10, s[28:31], s68 offen lds
  v_mfma_f32_16x16x32_bf16 v[196:199], a[180:183], a[84:87], v[196:199]
  ds_read_b64_tr_b16 a[168:169], v5 offset:20480
  v_mfma_f32_16x16x32_bf16 v[196:199], a[176:179], a[68:71], v[196:199]
  s_waitcnt vmcnt(13) lgkmcnt(3)
  v_cndmask_b32 v28, 0, v24, s[16:17]
  v_mfma_f32_16x16x32_bf16 v[200:203], a[176:179], a[72:75], v[200:203]
  ds_read_b64_tr_b16 a[170:171], v5 offset:22528
  v_cndmask_b32 v29, 0, v24, s[18:19]
  v_mfma_f32_16x16x32_bf16 v[200:203], a[180:183], a[88:91], v[200:203]
  s_add_u32 m0, s45, 40960
  v_cndmask_b32 v30, 0, v24, s[20:21]
  v_mfma_f32_16x16x32_bf16 v[204:207], a[180:183], a[92:95], v[204:207]
  ds_read_b64_tr_b16 a[180:181], v5 offset:24576
  buffer_load_dwordx4 v10, s[32:35], s68 offen lds
  v_mfma_f32_16x16x32_bf16 v[204:207], a[176:179], a[76:79], v[204:207]
  v_cndmask_b32 v31, 0, v24, s[22:23]
  s_waitcnt lgkmcnt(6)
  v_mfma_f32_16x16x32_bf16 v[220:223], a[164:167], a[76:79], v[220:223]
  ds_read_b64_tr_b16 a[182:183], v5 offset:26624
  v_mfma_f32_16x16x32_bf16 v[220:223], a[160:163], a[92:95], v[220:223]
  v_mfma_f32_16x16x32_bf16 a[184:187], v[28:31], a[236:239], a[184:187]
  v_mfma_f32_16x16x32_bf16 v[216:219], a[160:163], a[88:91], v[216:219]
  ds_read_b64_tr_b16 a[176:177], v5 offset:28672
  s_add_u32 m0, s45, 36864
  s_add_u32 s61, s68, 229376
  v_mfma_f32_16x16x32_bf16 v[216:219], a[164:167], a[72:75], v[216:219]
  buffer_load_dwordx4 v10, s[28:31], s61 offen lds
  v_cndmask_b32 v28, 0, v25, s[16:17]
  v_mfma_f32_16x16x32_bf16 v[212:215], a[164:167], a[68:71], v[212:215]
  ds_read_b64_tr_b16 a[178:179], v5 offset:30720
  v_cndmask_b32 v29, 0, v25, s[18:19]
  v_mfma_f32_16x16x32_bf16 v[212:215], a[160:163], a[84:87], v[212:215]
  s_waitcnt vmcnt(27)
  s_barrier
  v_mfma_f32_16x16x32_bf16 v[208:211], a[160:163], a[80:83], v[208:211]
  ds_read_b64_tr_b16 a[160:161], v6 offset:16384
  v_cndmask_b32 v30, 0, v25, s[20:21]
  v_mfma_f32_16x16x32_bf16 v[208:211], a[164:167], a[64:67], v[208:211]
  s_add_u32 m0, s45, 45056
  s_add_u32 s61, s68, 229376
  s_waitcnt lgkmcnt(5)
  v_mfma_f32_16x16x32_bf16 v[224:227], a[172:175], a[64:67], v[224:227]
  ds_read_b64_tr_b16 a[162:163], v6 offset:18432
  buffer_load_dwordx4 v10, s[32:35], s61 offen lds
  v_mfma_f32_16x16x32_bf16 v[224:227], a[168:171], a[80:83], v[224:227]
  v_cndmask_b32 v31, 0, v25, s[22:23]
  v_mfma_f32_16x16x32_bf16 v[228:231], a[168:171], a[84:87], v[228:231]
  ds_read_b64_tr_b16 a[164:165], v6 offset:20480
  v_mfma_f32_16x16x32_bf16 a[184:187], v[28:31], a[240:243], a[184:187]
  v_mfma_f32_16x16x32_bf16 v[228:231], a[172:175], a[68:71], v[228:231]
  v_cndmask_b32 v28, 0, v26, s[16:17]
  v_cndmask_b32 v29, 0, v26, s[18:19]
  v_mfma_f32_16x16x32_bf16 v[232:235], a[172:175], a[72:75], v[232:235]
  ds_read_b64_tr_b16 a[166:167], v6 offset:22528
  s_mov_b32 s62, 57344
  v_mfma_f32_16x16x32_bf16 v[232:235], a[168:171], a[88:91], v[232:235]
  buffer_load_dwordx4 a[220:223], v13, s[12:15], s62 offen
  v_cndmask_b32 v30, 0, v26, s[20:21]
  v_mfma_f32_16x16x32_bf16 v[236:239], a[168:171], a[92:95], v[236:239]
  ds_read_b64_tr_b16 a[168:169], v6 offset:24576
  s_mov_b32 s62, 64512
  v_mfma_f32_16x16x32_bf16 v[236:239], a[172:175], a[76:79], v[236:239]
  buffer_load_dwordx4 a[224:227], v13, s[12:15], s62 offen
HOP8:
  s_cbranch_execz HOP11
  s_waitcnt lgkmcnt(5)
  v_mfma_f32_16x16x32_bf16 v[252:255], a[180:183], a[76:79], v[252:255]
  ds_read_b64_tr_b16 a[170:171], v6 offset:26624
  s_mov_b32 s62, 71680
  v_mfma_f32_16x16x32_bf16 v[252:255], a[176:179], a[92:95], v[252:255]
  buffer_load_dwordx4 a[228:231], v13, s[12:15], s62 offen
  v_cndmask_b32 v31, 0, v26, s[22:23]
  v_mfma_f32_16x16x32_bf16 v[248:251], a[176:179], a[88:91], v[248:251]
  ds_read_b64_tr_b16 a[172:173], v6 offset:28672
  s_mov_b32 s62, 78848
  v_mfma_f32_16x16x32_bf16 v[248:251], a[180:183], a[72:75], v[248:251]
  buffer_load_dwordx4 a[232:235], v13, s[12:15], s62 offen
  v_mfma_f32_16x16x32_bf16 v[244:247], a[180:183], a[68:71], v[244:247]
  ds_read_b64_tr_b16 a[174:175], v6 offset:30720
  v_mfma_f32_16x16x32_bf16 a[184:187], v[28:31], a[244:247], a[184:187]
  v_mfma_f32_16x16x32_bf16 v[244:247], a[176:179], a[84:87], v[244:247]
  v_cndmask_b32 v28, 0, v27, s[16:17]
  v_cndmask_b32 v29, 0, v27, s[18:19]
  v_mfma_f32_16x16x32_bf16 v[240:243], a[176:179], a[80:83], v[240:243]
  ds_read_b64_tr_b16 a[176:177], v7 offset:16384
  v_cndmask_b32 v30, 0, v27, s[20:21]
  v_mfma_f32_16x16x32_bf16 v[240:243], a[180:183], a[64:67], v[240:243]
  v_cndmask_b32 v31, 0, v27, s[22:23]
  s_waitcnt vmcnt(24) lgkmcnt(5)
  v_mfma_f32_16x16x32_bf16 v[64:67], a[160:163], a[96:99], v[64:67]
  ds_read_b64_tr_b16 a[178:179], v7 offset:18432
  v_mfma_f32_16x16x32_bf16 v[64:67], a[164:167], a[112:115], v[64:67]
  v_mfma_f32_16x16x32_bf16 a[184:187], v[28:31], a[248:251], a[184:187]
  v_mfma_f32_16x16x32_bf16 v[68:71], a[164:167], a[116:119], v[68:71]
  ds_read_b64_tr_b16 a[180:181], v7 offset:20480
  s_waitcnt vmcnt(8)
  v_mfma_f32_16x16x32_bf16 v[68:71], a[160:163], a[100:103], v[68:71]
  v_accvgpr_read_b32 v24, a188
  v_accvgpr_read_b32 v25, a189
  v_mfma_f32_16x16x32_bf16 v[72:75], a[160:163], a[104:107], v[72:75]
  ds_read_b64_tr_b16 a[182:183], v7 offset:22528
  v_accvgpr_read_b32 v26, a190
  v_mfma_f32_16x16x32_bf16 v[72:75], a[164:167], a[120:123], v[72:75]
  v_accvgpr_read_b32 v27, a191
  v_accvgpr_read_b32 v28, a192
  v_mfma_f32_16x16x32_bf16 v[76:79], a[164:167], a[124:127], v[76:79]
  ds_read_b64_tr_b16 a[164:165], v7 offset:24576
  v_accvgpr_read_b32 v29, a193
  v_mfma_f32_16x16x32_bf16 v[76:79], a[160:163], a[108:111], v[76:79]
  v_accvgpr_read_b32 v30, a194
  s_waitcnt lgkmcnt(5)
  v_mfma_f32_16x16x32_bf16 v[92:95], a[168:171], a[108:111], v[92:95]
  ds_read_b64_tr_b16 a[166:167], v7 offset:26624
  v_accvgpr_read_b32 v31, a195
  v_mfma_f32_16x16x32_bf16 v[92:95], a[172:175], a[124:127], v[92:95]
  v_add_f32 v16, v16, v24
  v_add_f32 v17, v17, v25
  v_mfma_f32_16x16x32_bf16 v[88:91], a[172:175], a[120:123], v[88:91]
  ds_read_b64_tr_b16 a[160:161], v7 offset:28672
  v_add_f32 v18, v18, v26
  v_mfma_f32_16x16x32_bf16 v[88:91], a[168:171], a[104:107], v[88:91]
  v_add_f32 v19, v19, v27
  v_add_f32 v20, v20, v28
  v_mfma_f32_16x16x32_bf16 v[84:87], a[168:171], a[100:103], v[84:87]
  ds_read_b64_tr_b16 a[162:163], v7 offset:30720
  v_add_f32 v21, v21, v29
  v_mfma_f32_16x16x32_bf16 v[84:87], a[172:175], a[116:119], v[84:87]
  v_add_f32 v22, v22, v30
  v_add_f32 v23, v23, v31
  v_mfma_f32_16x16x32_bf16 v[80:83], a[172:175], a[112:115], v[80:83]
  ds_read_b64_tr_b16 a[172:173], v8 offset:16384
  v_accvgpr_read_b32 v24, a196
  v_mfma_f32_16x16x32_bf16 v[80:83], a[168:171], a[96:99], v[80:83]
  v_accvgpr_read_b32 v25, a197
  s_waitcnt lgkmcnt(5)
  v_mfma_f32_16x16x32_bf16 v[96:99], a[176:179], a[96:99], v[96:99]
  ds_read_b64_tr_b16 a[174:175], v8 offset:18432
  v_accvgpr_read_b32 v26, a198
  v_mfma_f32_16x16x32_bf16 v[96:99], a[180:183], a[112:115], v[96:99]
  v_accvgpr_read_b32 v27, a199
  v_accvgpr_read_b32 v28, a200
  v_mfma_f32_16x16x32_bf16 v[100:103], a[180:183], a[116:119], v[100:103]
  ds_read_b64_tr_b16 a[168:169], v8 offset:20480
  v_accvgpr_read_b32 v29, a201
  v_mfma_f32_16x16x32_bf16 v[100:103], a[176:179], a[100:103], v[100:103]
  v_accvgpr_read_b32 v30, a202
  v_accvgpr_read_b32 v31, a203
  v_mfma_f32_16x16x32_bf16 v[104:107], a[176:179], a[104:107], v[104:107]
  ds_read_b64_tr_b16 a[170:171], v8 offset:22528
  v_add_f32 v16, v16, v24
  v_mfma_f32_16x16x32_bf16 v[104:107], a[180:183], a[120:123], v[104:107]
  v_add_f32 v17, v17, v25
  v_add_f32 v18, v18, v26
  v_mfma_f32_16x16x32_bf16 v[108:111], a[180:183], a[124:127], v[108:111]
  ds_read_b64_tr_b16 a[180:181], v8 offset:24576
  v_add_f32 v19, v19, v27
  v_mfma_f32_16x16x32_bf16 v[108:111], a[176:179], a[108:111], v[108:111]
  v_add_f32 v20, v20, v28
  s_waitcnt lgkmcnt(5)
  v_mfma_f32_16x16x32_bf16 v[124:127], a[164:167], a[108:111], v[124:127]
  ds_read_b64_tr_b16 a[182:183], v8 offset:26624
  v_mfma_f32_16x16x32_bf16 v[124:127], a[160:163], a[124:127], v[124:127]
  buffer_load_dwordx4 a[128:131], v1, s[8:11], s76 offen offset:0 sc1
  v_add_f32 v21, v21, v29
  v_mfma_f32_16x16x32_bf16 v[120:123], a[160:163], a[120:123], v[120:123]
  ds_read_b64_tr_b16 a[176:177], v8 offset:28672
  v_add_f32 v22, v22, v30
  v_mfma_f32_16x16x32_bf16 v[120:123], a[164:167], a[104:107], v[120:123]
  v_add_f32 v23, v23, v31
  v_accvgpr_read_b32 v24, a204
  v_mfma_f32_16x16x32_bf16 v[116:119], a[164:167], a[100:103], v[116:119]
  ds_read_b64_tr_b16 a[178:179], v8 offset:30720
  v_accvgpr_read_b32 v25, a205
  v_mfma_f32_16x16x32_bf16 v[116:119], a[160:163], a[116:119], v[116:119]
  v_accvgpr_read_b32 v26, a206
  v_accvgpr_read_b32 v27, a207
  v_mfma_f32_16x16x32_bf16 v[112:115], a[160:163], a[112:115], v[112:115]
  ds_read_b64_tr_b16 a[160:161], v2 offset:0
  buffer_load_dwordx4 a[144:147], v1, s[8:11], s76 offen offset:1024 sc1
  v_mfma_f32_16x16x32_bf16 v[112:115], a[164:167], a[96:99], v[112:115]
  v_accvgpr_read_b32 v28, a208
  s_waitcnt lgkmcnt(5)
  v_mfma_f32_16x16x32_bf16 v[32:35], a[172:175], a[96:99], v[32:35]
  ds_read_b64_tr_b16 a[162:163], v2 offset:2048
  v_accvgpr_read_b32 v29, a209
  v_mfma_f32_16x16x32_bf16 v[32:35], a[168:171], a[112:115], v[32:35]
  v_accvgpr_read_b32 v30, a210
  v_accvgpr_read_b32 v31, a211
  v_mfma_f32_16x16x32_bf16 v[36:39], a[168:171], a[116:119], v[36:39]
  ds_read_b64_tr_b16 a[164:165], v2 offset:4096
  s_add_u32 s76, s76, 65536
  v_mfma_f32_16x16x32_bf16 v[36:39], a[172:175], a[100:103], v[36:39]
  buffer_load_dwordx4 a[132:135], v1, s[8:11], s76 offen offset:0 sc1
  v_add_f32 v16, v16, v24
  v_mfma_f32_16x16x32_bf16 v[40:43], a[172:175], a[104:107], v[40:43]
  ds_read_b64_tr_b16 a[166:167], v2 offset:6144
  v_add_f32 v17, v17, v25
  v_mfma_f32_16x16x32_bf16 v[40:43], a[168:171], a[120:123], v[40:43]
  v_add_f32 v18, v18, v26
  v_add_f32 v19, v19, v27
  v_mfma_f32_16x16x32_bf16 v[44:47], a[168:171], a[124:127], v[44:47]
  ds_read_b64_tr_b16 a[168:169], v2 offset:8192
  v_add_f32 v20, v20, v28
  v_mfma_f32_16x16x32_bf16 v[44:47], a[172:175], a[108:111], v[44:47]
  v_add_f32 v21, v21, v29
  s_waitcnt lgkmcnt(5)
  v_mfma_f32_16x16x32_bf16 v[60:63], a[180:183], a[108:111], v[60:63]
  ds_read_b64_tr_b16 a[170:171], v2 offset:10240
  buffer_load_dwordx4 a[148:151], v1, s[8:11], s76 offen offset:1024 sc1
  v_mfma_f32_16x16x32_bf16 v[60:63], a[176:179], a[124:127], v[60:63]
  v_add_f32 v22, v22, v30
  v_add_f32 v23, v23, v31
  v_mfma_f32_16x16x32_bf16 v[56:59], a[176:179], a[120:123], v[56:59]
  ds_read_b64_tr_b16 a[172:173], v2 offset:12288
  v_accvgpr_read_b32 v24, a212
  v_mfma_f32_16x16x32_bf16 v[56:59], a[180:183], a[104:107], v[56:59]
  v_accvgpr_read_b32 v25, a213
  v_accvgpr_read_b32 v26, a214
  v_mfma_f32_16x16x32_bf16 v[52:55], a[180:183], a[100:103], v[52:55]
  ds_read_b64_tr_b16 a[174:175], v2 offset:14336
  s_add_u32 s76, s76, 65536
  v_mfma_f32_16x16x32_bf16 v[52:55], a[176:179], a[116:119], v[52:55]
  buffer_load_dwordx4 a[136:139], v1, s[8:11], s76 offen offset:0 sc1
  v_accvgpr_read_b32 v27, a215
  v_mfma_f32_16x16x32_bf16 v[48:51], a[176:179], a[112:115], v[48:51]
  ds_read_b64_tr_b16 a[176:177], v3 offset:0
  v_accvgpr_read_b32 v28, a216
  v_mfma_f32_16x16x32_bf16 v[48:51], a[180:183], a[96:99], v[48:51]
  v_accvgpr_read_b32 v29, a217
  s_waitcnt lgkmcnt(5)
  v_mfma_f32_16x16x32_bf16 v[128:131], a[160:163], a[96:99], v[128:131]
  ds_read_b64_tr_b16 a[178:179], v3 offset:2048
  v_accvgpr_read_b32 v30, a218
  v_mfma_f32_16x16x32_bf16 v[128:131], a[164:167], a[112:115], v[128:131]
  v_accvgpr_read_b32 v31, a219
  v_add_f32 v16, v16, v24
  v_mfma_f32_16x16x32_bf16 v[132:135], a[164:167], a[116:119], v[132:135]
  ds_read_b64_tr_b16 a[180:181], v3 offset:4096
  buffer_load_dwordx4 a[152:155], v1, s[8:11], s76 offen offset:1024 sc1
  v_mfma_f32_16x16x32_bf16 v[132:135], a[160:163], a[100:103], v[132:135]
  v_add_f32 v17, v17, v25
  v_add_f32 v18, v18, v26
  v_mfma_f32_16x16x32_bf16 v[136:139], a[160:163], a[104:107], v[136:139]
  ds_read_b64_tr_b16 a[182:183], v3 offset:6144
  v_add_f32 v19, v19, v27
  v_mfma_f32_16x16x32_bf16 v[136:139], a[164:167], a[120:123], v[136:139]
  v_add_f32 v20, v20, v28
  v_add_f32 v21, v21, v29
  v_mfma_f32_16x16x32_bf16 v[140:143], a[164:167], a[124:127], v[140:143]
  ds_read_b64_tr_b16 a[164:165], v3 offset:8192
  s_add_u32 s76, s76, 65536
  v_mfma_f32_16x16x32_bf16 v[140:143], a[160:163], a[108:111], v[140:143]
  buffer_load_dwordx4 a[140:143], v1, s[8:11], s76 offen offset:0 sc1
  s_waitcnt lgkmcnt(5)
  v_mfma_f32_16x16x32_bf16 v[156:159], a[168:171], a[108:111], v[156:159]
  ds_read_b64_tr_b16 a[166:167], v3 offset:10240
  v_add_f32 v22, v22, v30
  v_mfma_f32_16x16x32_bf16 v[156:159], a[172:175], a[124:127], v[156:159]
  v_add_f32 v23, v23, v31
  v_mov_b32 v24, v16
  v_mfma_f32_16x16x32_bf16 v[152:155], a[172:175], a[120:123], v[152:155]
  ds_read_b64_tr_b16 a[160:161], v3 offset:12288
  v_mov_b32 v25, v17
  v_mfma_f32_16x16x32_bf16 v[152:155], a[168:171], a[104:107], v[152:155]
  v_mov_b32 v26, v18
  v_mov_b32 v27, v19
  v_mfma_f32_16x16x32_bf16 v[148:151], a[168:171], a[100:103], v[148:151]
  ds_read_b64_tr_b16 a[162:163], v3 offset:14336
  buffer_load_dwordx4 a[156:159], v1, s[8:11], s76 offen offset:1024 sc1
  v_mfma_f32_16x16x32_bf16 v[148:151], a[172:175], a[116:119], v[148:151]
  v_mov_b32 v28, v20
  v_mov_b32 v29, v21
  v_mfma_f32_16x16x32_bf16 v[144:147], a[172:175], a[112:115], v[144:147]
  ds_read_b64_tr_b16 a[172:173], v4 offset:0
  v_mov_b32 v30, v22
  v_mfma_f32_16x16x32_bf16 v[144:147], a[168:171], a[96:99], v[144:147]
  v_mov_b32 v31, v23
  s_waitcnt lgkmcnt(5)
  v_mfma_f32_16x16x32_bf16 v[160:163], a[176:179], a[96:99], v[160:163]
  ds_read_b64_tr_b16 a[174:175], v4 offset:2048
  s_cmp_eq_u32 s56, 1
  s_cselect_b32 s77, 9, 5
  s_mul_i32 s69, s77, 458752
  s_lshl_b32 s77, s77, 11
  s_add_u32 s77, s77, s57
  s_add_u32 m0, s45, 114688
  v_mfma_f32_16x16x32_bf16 v[160:163], a[180:183], a[112:115], v[160:163]
  buffer_load_dwordx4 v11, s[28:31], s69 offen lds
  v_permlane16_swap_b32 v16, v24
  v_mfma_f32_16x16x32_bf16 v[164:167], a[180:183], a[116:119], v[164:167]
  ds_read_b64_tr_b16 a[168:169], v4 offset:4096
  v_permlane16_swap_b32 v17, v25
  v_mfma_f32_16x16x32_bf16 v[164:167], a[176:179], a[100:103], v[164:167]
  v_permlane16_swap_b32 v18, v26
  v_permlane16_swap_b32 v19, v27
  v_mfma_f32_16x16x32_bf16 v[168:171], a[176:179], a[104:107], v[168:171]
  ds_read_b64_tr_b16 a[170:171], v4 offset:6144
  v_permlane16_swap_b32 v20, v28
  v_mfma_f32_16x16x32_bf16 v[168:171], a[180:183], a[120:123], v[168:171]
  s_add_u32 m0, s45, 122880
  v_permlane16_swap_b32 v21, v29
  v_mfma_f32_16x16x32_bf16 v[172:175], a[180:183], a[124:127], v[172:175]
  ds_read_b64_tr_b16 a[180:181], v4 offset:8192
  buffer_load_dwordx4 v11, s[32:35], s69 offen lds
  v_mfma_f32_16x16x32_bf16 v[172:175], a[176:179], a[108:111], v[172:175]
  v_permlane16_swap_b32 v22, v30
  s_waitcnt lgkmcnt(5)
  v_mfma_f32_16x16x32_bf16 v[188:191], a[164:167], a[108:111], v[188:191]
  ds_read_b64_tr_b16 a[182:183], v4 offset:10240
  v_permlane16_swap_b32 v23, v31
  v_mfma_f32_16x16x32_bf16 v[188:191], a[160:163], a[124:127], v[188:191]
  v_add_f32 v16, v16, v24
  v_add_f32 v17, v17, v25
  v_mfma_f32_16x16x32_bf16 v[184:187], a[160:163], a[120:123], v[184:187]
  ds_read_b64_tr_b16 a[176:177], v4 offset:12288
  s_add_u32 m0, s45, 118784
  s_add_u32 s61, s69, 229376
  v_mfma_f32_16x16x32_bf16 v[184:187], a[164:167], a[104:107], v[184:187]
  buffer_load_dwordx4 v11, s[28:31], s61 offen lds
  v_add_f32 v18, v18, v26
  v_mfma_f32_16x16x32_bf16 v[180:183], a[164:167], a[100:103], v[180:183]
  ds_read_b64_tr_b16 a[178:179], v4 offset:14336
  v_add_f32 v19, v19, v27
  v_mfma_f32_16x16x32_bf16 v[180:183], a[160:163], a[116:119], v[180:183]
  v_add_f32 v20, v20, v28
  v_add_f32 v21, v21, v29
  v_mfma_f32_16x16x32_bf16 v[176:179], a[160:163], a[112:115], v[176:179]
  ds_read_b64_tr_b16 a[160:161], v5 offset:0
  v_add_f32 v22, v22, v30
  v_mfma_f32_16x16x32_bf16 v[176:179], a[164:167], a[96:99], v[176:179]
  s_add_u32 m0, s45, 126976
  s_add_u32 s61, s69, 229376
  s_waitcnt lgkmcnt(5)
  v_mfma_f32_16x16x32_bf16 v[192:195], a[172:175], a[96:99], v[192:195]
  ds_read_b64_tr_b16 a[162:163], v5 offset:2048
  buffer_load_dwordx4 v11, s[32:35], s61 offen lds
  v_mfma_f32_16x16x32_bf16 v[192:195], a[168:171], a[112:115], v[192:195]
  v_add_f32 v23, v23, v31
  v_mov_b32 v24, v16
  v_mfma_f32_16x16x32_bf16 v[196:199], a[168:171], a[116:119], v[196:199]
  ds_read_b64_tr_b16 a[164:165], v5 offset:4096
  v_mov_b32 v25, v17
  v_mfma_f32_16x16x32_bf16 v[196:199], a[172:175], a[100:103], v[196:199]
  v_mov_b32 v26, v18
  v_mov_b32 v27, v19
  v_mfma_f32_16x16x32_bf16 v[200:203], a[172:175], a[104:107], v[200:203]
  ds_read_b64_tr_b16 a[166:167], v5 offset:6144
  s_add_u32 m0, s45, 49152
  v_mfma_f32_16x16x32_bf16 v[200:203], a[168:171], a[120:123], v[200:203]
  buffer_load_dwordx4 v10, s[28:31], s69 offen lds
  v_mov_b32 v28, v20
  v_mfma_f32_16x16x32_bf16 v[204:207], a[168:171], a[124:127], v[204:207]
  ds_read_b64_tr_b16 a[168:169], v5 offset:8192
  v_mov_b32 v29, v21
  v_mfma_f32_16x16x32_bf16 v[204:207], a[172:175], a[108:111], v[204:207]
  v_mov_b32 v30, v22
  s_waitcnt lgkmcnt(5)
  v_mfma_f32_16x16x32_bf16 v[220:223], a[180:183], a[108:111], v[220:223]
  ds_read_b64_tr_b16 a[170:171], v5 offset:10240
  v_mov_b32 v31, v23
  v_mfma_f32_16x16x32_bf16 v[220:223], a[176:179], a[124:127], v[220:223]
  s_add_u32 m0, s45, 57344
  v_permlane32_swap_b32 v16, v24
  v_mfma_f32_16x16x32_bf16 v[216:219], a[176:179], a[120:123], v[216:219]
  ds_read_b64_tr_b16 a[172:173], v5 offset:12288
  buffer_load_dwordx4 v10, s[32:35], s69 offen lds
  v_mfma_f32_16x16x32_bf16 v[216:219], a[180:183], a[104:107], v[216:219]
  v_permlane32_swap_b32 v17, v25
  v_permlane32_swap_b32 v18, v26
  v_mfma_f32_16x16x32_bf16 v[212:215], a[180:183], a[100:103], v[212:215]
  ds_read_b64_tr_b16 a[174:175], v5 offset:14336
  v_permlane32_swap_b32 v19, v27
  v_mfma_f32_16x16x32_bf16 v[212:215], a[176:179], a[116:119], v[212:215]
  s_waitcnt vmcnt(18)
  s_barrier
  v_mfma_f32_16x16x32_bf16 v[208:211], a[176:179], a[112:115], v[208:211]
  ds_read_b64_tr_b16 a[176:177], v6 offset:0
  s_add_u32 m0, s45, 53248
  s_add_u32 s61, s69, 229376
  v_mfma_f32_16x16x32_bf16 v[208:211], a[180:183], a[96:99], v[208:211]
  buffer_load_dwordx4 v10, s[28:31], s61 offen lds
  s_waitcnt lgkmcnt(5)
  v_mfma_f32_16x16x32_bf16 v[224:227], a[160:163], a[96:99], v[224:227]
  ds_read_b64_tr_b16 a[178:179], v6 offset:2048
  v_permlane32_swap_b32 v20, v28
  v_mfma_f32_16x16x32_bf16 v[224:227], a[164:167], a[112:115], v[224:227]
  v_permlane32_swap_b32 v21, v29
  v_permlane32_swap_b32 v22, v30
  v_mfma_f32_16x16x32_bf16 v[228:231], a[164:167], a[116:119], v[228:231]
  ds_read_b64_tr_b16 a[180:181], v6 offset:4096
  v_permlane32_swap_b32 v23, v31
  v_mfma_f32_16x16x32_bf16 v[228:231], a[160:163], a[100:103], v[228:231]
  s_add_u32 m0, s45, 61440
  s_add_u32 s61, s69, 229376
  v_mfma_f32_16x16x32_bf16 v[232:235], a[160:163], a[104:107], v[232:235]
  ds_read_b64_tr_b16 a[182:183], v6 offset:6144
  buffer_load_dwordx4 v10, s[32:35], s61 offen lds
  v_mfma_f32_16x16x32_bf16 v[232:235], a[164:167], a[120:123], v[232:235]
  v_add_f32 v16, v16, v24
  v_add_f32 v17, v17, v25
  v_mfma_f32_16x16x32_bf16 v[236:239], a[164:167], a[124:127], v[236:239]
  ds_read_b64_tr_b16 a[164:165], v6 offset:8192
  v_add_f32 v18, v18, v26
  v_mfma_f32_16x16x32_bf16 v[236:239], a[160:163], a[108:111], v[236:239]
  v_add_f32 v19, v19, v27
  s_waitcnt lgkmcnt(5)
  v_mfma_f32_16x16x32_bf16 v[252:255], a[168:171], a[108:111], v[252:255]
  ds_read_b64_tr_b16 a[166:167], v6 offset:10240
  s_mov_b32 s62, 86016
  v_mfma_f32_16x16x32_bf16 v[252:255], a[172:175], a[124:127], v[252:255]
  buffer_load_dwordx4 a[236:239], v13, s[12:15], s62 offen
  v_add_f32 v20, v20, v28
  v_mfma_f32_16x16x32_bf16 v[248:251], a[172:175], a[120:123], v[248:251]
  ds_read_b64_tr_b16 a[160:161], v6 offset:12288
  s_mov_b32 s62, 93184
  v_mfma_f32_16x16x32_bf16 v[248:251], a[168:171], a[104:107], v[248:251]
  buffer_load_dwordx4 a[240:243], v13, s[12:15], s62 offen
  v_add_f32 v21, v21, v29
  v_mfma_f32_16x16x32_bf16 v[244:247], a[168:171], a[100:103], v[244:247]
  ds_read_b64_tr_b16 a[162:163], v6 offset:14336
  s_mov_b32 s62, 100352
  v_mfma_f32_16x16x32_bf16 v[244:247], a[172:175], a[116:119], v[244:247]
  buffer_load_dwordx4 a[244:247], v13, s[12:15], s62 offen
  v_add_f32 v22, v22, v30
  v_mfma_f32_16x16x32_bf16 v[240:243], a[172:175], a[112:115], v[240:243]
  ds_read_b64_tr_b16 a[172:173], v7 offset:0
  s_mov_b32 s62, 107520
  v_mfma_f32_16x16x32_bf16 v[240:243], a[168:171], a[96:99], v[240:243]
  buffer_load_dwordx4 a[248:251], v13, s[12:15], s62 offen
  s_waitcnt vmcnt(12) lgkmcnt(5)
  v_mfma_f32_16x16x32_bf16 v[64:67], a[176:179], a[128:131], v[64:67]
  ds_read_b64_tr_b16 a[174:175], v7 offset:2048
  v_add_f32 v23, v23, v31
  v_mfma_f32_16x16x32_bf16 v[64:67], a[180:183], a[144:147], v[64:67]
  v_mul_f32 v16, 0x3a800000, v16
  v_mul_f32 v18, 0x3a800000, v18
  v_mfma_f32_16x16x32_bf16 v[68:71], a[180:183], a[148:151], v[68:71]
  ds_read_b64_tr_b16 a[168:169], v7 offset:4096
  v_mul_f32 v20, 0x3a800000, v20
  v_mfma_f32_16x16x32_bf16 v[68:71], a[176:179], a[132:135], v[68:71]
  v_mul_f32 v22, 0x3a800000, v22
  v_mul_f32 v17, 0x3a800000, v17
  v_mfma_f32_16x16x32_bf16 v[72:75], a[176:179], a[136:139], v[72:75]
  ds_read_b64_tr_b16 a[170:171], v7 offset:6144
  v_mul_f32 v19, 0x3a800000, v19
  v_mfma_f32_16x16x32_bf16 v[72:75], a[180:183], a[152:155], v[72:75]
  v_mul_f32 v21, 0x3a800000, v21
  v_mul_f32 v23, 0x3a800000, v23
  v_mfma_f32_16x16x32_bf16 v[76:79], a[180:183], a[156:159], v[76:79]
  ds_read_b64_tr_b16 a[180:181], v7 offset:8192
  v_fma_f32 v17, -v16, v16, v17
  v_mfma_f32_16x16x32_bf16 v[76:79], a[176:179], a[140:143], v[76:79]
  v_fma_f32 v19, -v18, v18, v19
  s_waitcnt lgkmcnt(5)
  v_mfma_f32_16x16x32_bf16 v[92:95], a[164:167], a[140:143], v[92:95]
  ds_read_b64_tr_b16 a[182:183], v7 offset:10240
  v_fma_f32 v21, -v20, v20, v21
  v_mfma_f32_16x16x32_bf16 v[92:95], a[160:163], a[156:159], v[92:95]
  v_fma_f32 v23, -v22, v22, v23
  v_max_f32 v17, 0, v17
  v_mfma_f32_16x16x32_bf16 v[88:91], a[160:163], a[152:155], v[88:91]
  ds_read_b64_tr_b16 a[176:177], v7 offset:12288
  v_max_f32 v19, 0, v19
  v_mfma_f32_16x16x32_bf16 v[88:91], a[164:167], a[136:139], v[88:91]
  v_max_f32 v21, 0, v21
  v_max_f32 v23, 0, v23
  v_mfma_f32_16x16x32_bf16 v[84:87], a[164:167], a[132:135], v[84:87]
  ds_read_b64_tr_b16 a[178:179], v7 offset:14336
  v_cvt_pk_bf16_f32 v17, v17, v17
  v_mfma_f32_16x16x32_bf16 v[84:87], a[160:163], a[148:151], v[84:87]
  v_cvt_pk_bf16_f32 v19, v19, v19
  v_cvt_pk_bf16_f32 v21, v21, v21
  v_mfma_f32_16x16x32_bf16 v[80:83], a[160:163], a[144:147], v[80:83]
  ds_read_b64_tr_b16 a[160:161], v8 offset:0
  v_cvt_pk_bf16_f32 v23, v23, v23
  v_mfma_f32_16x16x32_bf16 v[80:83], a[164:167], a[128:131], v[80:83]
  v_lshlrev_b32 v17, 16, v17
  s_waitcnt lgkmcnt(5)
  v_mfma_f32_16x16x32_bf16 v[96:99], a[172:175], a[128:131], v[96:99]
  ds_read_b64_tr_b16 a[162:163], v8 offset:2048
  v_lshlrev_b32 v19, 16, v19
  v_mfma_f32_16x16x32_bf16 v[96:99], a[168:171], a[144:147], v[96:99]
  v_lshlrev_b32 v21, 16, v21
  v_lshlrev_b32 v23, 16, v23
  v_mfma_f32_16x16x32_bf16 v[100:103], a[168:171], a[148:151], v[100:103]
  ds_read_b64_tr_b16 a[164:165], v8 offset:4096
  v_add_f32 v17, 0x3727c5ac, v17
  v_mfma_f32_16x16x32_bf16 v[100:103], a[172:175], a[132:135], v[100:103]
  v_add_f32 v19, 0x3727c5ac, v19
  v_add_f32 v21, 0x3727c5ac, v21
  v_mfma_f32_16x16x32_bf16 v[104:107], a[172:175], a[136:139], v[104:107]
  ds_read_b64_tr_b16 a[166:167], v8 offset:6144
  v_add_f32 v23, 0x3727c5ac, v23
  v_mfma_f32_16x16x32_bf16 v[104:107], a[168:171], a[152:155], v[104:107]
  v_cvt_pk_bf16_f32 v17, v17, v17
  v_cvt_pk_bf16_f32 v19, v19, v19
  v_mfma_f32_16x16x32_bf16 v[108:111], a[168:171], a[156:159], v[108:111]
  ds_read_b64_tr_b16 a[168:169], v8 offset:8192
  v_cvt_pk_bf16_f32 v21, v21, v21
  v_mfma_f32_16x16x32_bf16 v[108:111], a[172:175], a[140:143], v[108:111]
  v_cvt_pk_bf16_f32 v23, v23, v23
  s_waitcnt lgkmcnt(5)
  v_mfma_f32_16x16x32_bf16 v[124:127], a[180:183], a[140:143], v[124:127]
  ds_read_b64_tr_b16 a[170:171], v8 offset:10240
  v_lshlrev_b32 v17, 16, v17
  v_mfma_f32_16x16x32_bf16 v[124:127], a[176:179], a[156:159], v[124:127]
  v_lshlrev_b32 v19, 16, v19
  v_lshlrev_b32 v21, 16, v21
  v_mfma_f32_16x16x32_bf16 v[120:123], a[176:179], a[152:155], v[120:123]
  ds_read_b64_tr_b16 a[172:173], v8 offset:12288
  v_lshlrev_b32 v23, 16, v23
  v_mfma_f32_16x16x32_bf16 v[120:123], a[180:183], a[136:139], v[120:123]
  v_sqrt_f32 v17, v17
  v_mfma_f32_16x16x32_bf16 v[116:119], a[180:183], a[132:135], v[116:119]
  ds_read_b64_tr_b16 a[174:175], v8 offset:14336
  v_mfma_f32_16x16x32_bf16 v[116:119], a[176:179], a[148:151], v[116:119]
  buffer_load_dwordx4 a[0:3], v1, s[8:11], s77 offen offset:0 sc1
  v_mfma_f32_16x16x32_bf16 v[112:115], a[176:179], a[144:147], v[112:115]
  ds_read_b64_tr_b16 a[176:177], v2 offset:32768
  v_sqrt_f32 v19, v19
  v_mfma_f32_16x16x32_bf16 v[112:115], a[180:183], a[128:131], v[112:115]
  s_waitcnt lgkmcnt(5)
  v_mfma_f32_16x16x32_bf16 v[32:35], a[160:163], a[128:131], v[32:35]
  ds_read_b64_tr_b16 a[178:179], v2 offset:34816
  v_sqrt_f32 v21, v21
  v_mfma_f32_16x16x32_bf16 v[32:35], a[164:167], a[144:147], v[32:35]
  v_sqrt_f32 v23, v23
  v_mfma_f32_16x16x32_bf16 v[36:39], a[164:167], a[148:151], v[36:39]
  ds_read_b64_tr_b16 a[180:181], v2 offset:36864
  buffer_load_dwordx4 a[16:19], v1, s[8:11], s77 offen offset:1024 sc1
  v_mfma_f32_16x16x32_bf16 v[36:39], a[160:163], a[132:135], v[36:39]
  v_cvt_pk_bf16_f32 v16, v16, v16
  v_cvt_pk_bf16_f32 v18, v18, v18
  v_mfma_f32_16x16x32_bf16 v[40:43], a[160:163], a[136:139], v[40:43]
  ds_read_b64_tr_b16 a[182:183], v2 offset:38912
  v_cvt_pk_bf16_f32 v20, v20, v20
  v_mfma_f32_16x16x32_bf16 v[40:43], a[164:167], a[152:155], v[40:43]
  v_cvt_pk_bf16_f32 v22, v22, v22
  v_lshlrev_b32 v16, 16, v16
  v_mfma_f32_16x16x32_bf16 v[44:47], a[164:167], a[156:159], v[44:47]
  ds_read_b64_tr_b16 a[164:165], v2 offset:40960
  s_add_u32 s77, s77, 65536
  v_mfma_f32_16x16x32_bf16 v[44:47], a[160:163], a[140:143], v[44:47]
  buffer_load_dwordx4 a[4:7], v1, s[8:11], s77 offen offset:0 sc1
  s_waitcnt lgkmcnt(5)
  v_mfma_f32_16x16x32_bf16 v[60:63], a[168:171], a[140:143], v[60:63]
  ds_read_b64_tr_b16 a[166:167], v2 offset:43008
  v_lshlrev_b32 v18, 16, v18
  v_mfma_f32_16x16x32_bf16 v[60:63], a[172:175], a[156:159], v[60:63]
  v_lshlrev_b32 v20, 16, v20
  v_lshlrev_b32 v22, 16, v22
  v_mfma_f32_16x16x32_bf16 v[56:59], a[172:175], a[152:155], v[56:59]
  ds_read_b64_tr_b16 a[160:161], v2 offset:45056
  v_cvt_pk_bf16_f32 v17, v17, v17
  v_mfma_f32_16x16x32_bf16 v[56:59], a[168:171], a[136:139], v[56:59]
  v_cvt_pk_bf16_f32 v19, v19, v19
  v_cvt_pk_bf16_f32 v21, v21, v21
  v_mfma_f32_16x16x32_bf16 v[52:55], a[168:171], a[132:135], v[52:55]
  ds_read_b64_tr_b16 a[162:163], v2 offset:47104
  buffer_load_dwordx4 a[20:23], v1, s[8:11], s77 offen offset:1024 sc1
  v_mfma_f32_16x16x32_bf16 v[52:55], a[172:175], a[148:151], v[52:55]
  v_cvt_pk_bf16_f32 v23, v23, v23
  v_lshlrev_b32 v17, 16, v17
  v_mfma_f32_16x16x32_bf16 v[48:51], a[172:175], a[144:147], v[48:51]
  ds_read_b64_tr_b16 a[172:173], v3 offset:32768
  v_lshlrev_b32 v19, 16, v19
  v_mfma_f32_16x16x32_bf16 v[48:51], a[168:171], a[128:131], v[48:51]
  v_lshlrev_b32 v21, 16, v21
  s_waitcnt lgkmcnt(5)
  v_mfma_f32_16x16x32_bf16 v[128:131], a[176:179], a[128:131], v[128:131]
  ds_read_b64_tr_b16 a[174:175], v3 offset:34816
  s_add_u32 s77, s77, 65536
  v_mfma_f32_16x16x32_bf16 v[128:131], a[180:183], a[144:147], v[128:131]
  buffer_load_dwordx4 a[8:11], v1, s[8:11], s77 offen offset:0 sc1
  v_lshlrev_b32 v23, 16, v23
  v_mfma_f32_16x16x32_bf16 v[132:135], a[180:183], a[148:151], v[132:135]
  ds_read_b64_tr_b16 a[168:169], v3 offset:36864
  v_sub_f32 v16, 0, v16
  v_mfma_f32_16x16x32_bf16 v[132:135], a[176:179], a[132:135], v[132:135]
  v_sub_f32 v18, 0, v18
  v_sub_f32 v20, 0, v20
  v_mfma_f32_16x16x32_bf16 v[136:139], a[176:179], a[136:139], v[136:139]
  ds_read_b64_tr_b16 a[170:171], v3 offset:38912
  v_sub_f32 v22, 0, v22
  v_mfma_f32_16x16x32_bf16 v[136:139], a[180:183], a[152:155], v[136:139]
  v_lshrrev_b32 v12, 8, v1
  v_lshlrev_b32 v12, 4, v12
  v_mfma_f32_16x16x32_bf16 v[140:143], a[180:183], a[156:159], v[140:143]
  ds_read_b64_tr_b16 a[180:181], v3 offset:40960
  buffer_load_dwordx4 a[24:27], v1, s[8:11], s77 offen offset:1024 sc1
  v_mfma_f32_16x16x32_bf16 v[140:143], a[176:179], a[140:143], v[140:143]
  v_add_u32 v12, 131072, v12
  s_waitcnt lgkmcnt(5)
  v_mfma_f32_16x16x32_bf16 v[156:159], a[164:167], a[140:143], v[156:159]
  ds_read_b64_tr_b16 a[182:183], v3 offset:43008
  ds_read_b128 v[24:27], v14 offset:32
  v_mfma_f32_16x16x32_bf16 v[156:159], a[160:163], a[156:159], v[156:159]
  v_mfma_f32_16x16x32_bf16 v[152:155], a[160:163], a[152:155], v[152:155]
  ds_read_b64_tr_b16 a[176:177], v3 offset:45056
  s_add_u32 s77, s77, 65536
  v_mfma_f32_16x16x32_bf16 v[152:155], a[164:167], a[136:139], v[152:155]
  buffer_load_dwordx4 a[12:15], v1, s[8:11], s77 offen offset:0 sc1
  v_mfma_f32_16x16x32_bf16 v[148:151], a[164:167], a[132:135], v[148:151]
  ds_read_b64_tr_b16 a[178:179], v3 offset:47104
  v_mfma_f32_16x16x32_bf16 v[148:151], a[160:163], a[148:151], v[148:151]
  v_mfma_f32_16x16x32_bf16 v[144:147], a[160:163], a[144:147], v[144:147]
  ds_read_b64_tr_b16 a[160:161], v4 offset:32768
  s_waitcnt vmcnt(27) lgkmcnt(3)
  v_mfma_f32_16x16x32_bf16 v[144:147], a[164:167], a[128:131], v[144:147]
  v_cndmask_b32 v28, 0, v24, s[16:17]
  s_waitcnt lgkmcnt(6)
  v_mfma_f32_16x16x32_bf16 v[160:163], a[172:175], a[128:131], v[160:163]
  ds_read_b64_tr_b16 a[162:163], v4 offset:34816
  buffer_load_dwordx4 a[28:31], v1, s[8:11], s77 offen offset:1024 sc1
  v_mfma_f32_16x16x32_bf16 v[160:163], a[168:171], a[144:147], v[160:163]
  v_cndmask_b32 v29, 0, v24, s[18:19]
  v_cndmask_b32 v30, 0, v24, s[20:21]
  v_mfma_f32_16x16x32_bf16 v[164:167], a[168:171], a[148:151], v[164:167]
  ds_read_b64_tr_b16 a[164:165], v4 offset:36864
  v_cndmask_b32 v31, 0, v24, s[22:23]
  v_mfma_f32_16x16x32_bf16 v[164:167], a[172:175], a[132:135], v[164:167]
  s_nop 0
  v_mfma_f32_16x16x32_bf16 a[184:187], v[28:31], a[220:223], a[184:187]
  v_mfma_f32_16x16x32_bf16 v[168:171], a[172:175], a[136:139], v[168:171]
  ds_read_b64_tr_b16 a[166:167], v4 offset:38912
  s_cmp_eq_u32 s56, 2
  s_cselect_b32 s78, 10, 6
  s_mul_i32 s70, s78, 458752
  s_lshl_b32 s78, s78, 11
  s_add_u32 s78, s78, s57
  s_add_u32 m0, s45, 98304
  v_mfma_f32_16x16x32_bf16 v[168:171], a[168:171], a[152:155], v[168:171]
  buffer_load_dwordx4 v11, s[28:31], s70 offen lds
  v_cndmask_b32 v28, 0, v25, s[16:17]
  v_mfma_f32_16x16x32_bf16 v[172:175], a[168:171], a[156:159], v[172:175]
  ds_read_b64_tr_b16 a[168:169], v4 offset:40960
  v_cndmask_b32 v29, 0, v25, s[18:19]
  v_mfma_f32_16x16x32_bf16 v[172:175], a[172:175], a[140:143], v[172:175]
  v_cndmask_b32 v30, 0, v25, s[20:21]
  s_waitcnt lgkmcnt(5)
  v_mfma_f32_16x16x32_bf16 v[188:191], a[180:183], a[140:143], v[188:191]
  ds_read_b64_tr_b16 a[170:171], v4 offset:43008
  v_cndmask_b32 v31, 0, v25, s[22:23]
  v_mfma_f32_16x16x32_bf16 v[188:191], a[176:179], a[156:159], v[188:191]
  s_add_u32 m0, s45, 106496
  v_mfma_f32_16x16x32_bf16 v[184:187], a[176:179], a[152:155], v[184:187]
  ds_read_b64_tr_b16 a[172:173], v4 offset:45056
  buffer_load_dwordx4 v11, s[32:35], s70 offen lds
  v_mfma_f32_16x16x32_bf16 v[184:187], a[180:183], a[136:139], v[184:187]
  v_mfma_f32_16x16x32_bf16 a[184:187], v[28:31], a[224:227], a[184:187]
HOP9:
  s_cbranch_execz HOP12
  v_mfma_f32_16x16x32_bf16 v[180:183], a[180:183], a[132:135], v[180:183]
  ds_read_b64_tr_b16 a[174:175], v4 offset:47104
  v_cndmask_b32 v28, 0, v26, s[16:17]
  v_mfma_f32_16x16x32_bf16 v[180:183], a[176:179], a[148:151], v[180:183]
  v_cndmask_b32 v29, 0, v26, s[18:19]
  v_cndmask_b32 v30, 0, v26, s[20:21]
  v_mfma_f32_16x16x32_bf16 v[176:179], a[176:179], a[144:147], v[176:179]
  ds_read_b64_tr_b16 a[176:177], v5 offset:32768
  s_add_u32 m0, s45, 102400
  s_add_u32 s61, s70, 229376
  v_mfma_f32_16x16x32_bf16 v[176:179], a[180:183], a[128:131], v[176:179]
  buffer_load_dwordx4 v11, s[28:31], s61 offen lds
  s_waitcnt lgkmcnt(5)
  v_mfma_f32_16x16x32_bf16 v[192:195], a[160:163], a[128:131], v[192:195]
  ds_read_b64_tr_b16 a[178:179], v5 offset:34816
  v_cndmask_b32 v31, 0, v26, s[22:23]
  v_mfma_f32_16x16x32_bf16 v[192:195], a[164:167], a[144:147], v[192:195]
  s_nop 0
  v_mfma_f32_16x16x32_bf16 a[184:187], v[28:31], a[228:231], a[184:187]
  v_mfma_f32_16x16x32_bf16 v[196:199], a[164:167], a[148:151], v[196:199]
  ds_read_b64_tr_b16 a[180:181], v5 offset:36864
  v_cndmask_b32 v28, 0, v27, s[16:17]
  v_mfma_f32_16x16x32_bf16 v[196:199], a[160:163], a[132:135], v[196:199]
  s_add_u32 m0, s45, 110592
  s_add_u32 s61, s70, 229376
  v_mfma_f32_16x16x32_bf16 v[200:203], a[160:163], a[136:139], v[200:203]
  ds_read_b64_tr_b16 a[182:183], v5 offset:38912
  buffer_load_dwordx4 v11, s[32:35], s61 offen lds
  v_mfma_f32_16x16x32_bf16 v[200:203], a[164:167], a[152:155], v[200:203]
  v_cndmask_b32 v29, 0, v27, s[18:19]
  v_cndmask_b32 v30, 0, v27, s[20:21]
  v_mfma_f32_16x16x32_bf16 v[204:207], a[164:167], a[156:159], v[204:207]
  ds_read_b64_tr_b16 a[164:165], v5 offset:40960
  v_cndmask_b32 v31, 0, v27, s[22:23]
  v_mfma_f32_16x16x32_bf16 v[204:207], a[160:163], a[140:143], v[204:207]
  s_waitcnt lgkmcnt(5)
  v_mfma_f32_16x16x32_bf16 v[220:223], a[168:171], a[140:143], v[220:223]
  ds_read_b64_tr_b16 a[166:167], v5 offset:43008
  s_add_u32 m0, s45, 16384
  v_mfma_f32_16x16x32_bf16 v[220:223], a[172:175], a[156:159], v[220:223]
  buffer_load_dwordx4 v10, s[28:31], s70 offen lds
  v_mfma_f32_16x16x32_bf16 v[216:219], a[172:175], a[152:155], v[216:219]
  ds_read_b64_tr_b16 a[160:161], v5 offset:45056
  v_mfma_f32_16x16x32_bf16 a[184:187], v[28:31], a[232:235], a[184:187]
  v_mfma_f32_16x16x32_bf16 v[216:219], a[168:171], a[136:139], v[216:219]
  ds_read_b128 v[24:27], v14 offset:48
  v_mfma_f32_16x16x32_bf16 v[212:215], a[168:171], a[132:135], v[212:215]
  ds_read_b64_tr_b16 a[162:163], v5 offset:47104
  v_mfma_f32_16x16x32_bf16 v[212:215], a[172:175], a[148:151], v[212:215]
  s_add_u32 m0, s45, 24576
  s_waitcnt vmcnt(17)
  s_barrier
  v_mfma_f32_16x16x32_bf16 v[208:211], a[172:175], a[144:147], v[208:211]
  ds_read_b64_tr_b16 a[172:173], v6 offset:49152
  buffer_load_dwordx4 v10, s[32:35], s70 offen lds
  v_mfma_f32_16x16x32_bf16 v[208:211], a[168:171], a[128:131], v[208:211]
  s_waitcnt lgkmcnt(6)
  v_mfma_f32_16x16x32_bf16 v[224:227], a[176:179], a[128:131], v[224:227]
  ds_read_b64_tr_b16 a[174:175], v6 offset:51200
  v_mfma_f32_16x16x32_bf16 v[224:227], a[180:183], a[144:147], v[224:227]
  s_waitcnt vmcnt(14) lgkmcnt(3)
  v_cndmask_b32 v28, 0, v24, s[16:17]
  v_mfma_f32_16x16x32_bf16 v[228:231], a[180:183], a[148:151], v[228:231]
  ds_read_b64_tr_b16 a[168:169], v6 offset:53248
  s_add_u32 m0, s45, 20480
  s_add_u32 s61, s70, 229376
  v_mfma_f32_16x16x32_bf16 v[228:231], a[176:179], a[132:135], v[228:231]
  buffer_load_dwordx4 v10, s[28:31], s61 offen lds
  v_cndmask_b32 v29, 0, v24, s[18:19]
  v_mfma_f32_16x16x32_bf16 v[232:235], a[176:179], a[136:139], v[232:235]
  ds_read_b64_tr_b16 a[170:171], v6 offset:55296
  v_cndmask_b32 v30, 0, v24, s[20:21]
  v_mfma_f32_16x16x32_bf16 v[232:235], a[180:183], a[152:155], v[232:235]
  v_cndmask_b32 v31, 0, v24, s[22:23]
  v_mfma_f32_16x16x32_bf16 v[236:239], a[180:183], a[156:159], v[236:239]
  ds_read_b64_tr_b16 a[180:181], v6 offset:57344
  v_mfma_f32_16x16x32_bf16 a[184:187], v[28:31], a[236:239], a[184:187]
  v_mfma_f32_16x16x32_bf16 v[236:239], a[176:179], a[140:143], v[236:239]
  s_add_u32 m0, s45, 28672
  s_add_u32 s61, s70, 229376
  s_waitcnt lgkmcnt(5)
  v_mfma_f32_16x16x32_bf16 v[252:255], a[164:167], a[140:143], v[252:255]
  ds_read_b64_tr_b16 a[182:183], v6 offset:59392
  buffer_load_dwordx4 v10, s[32:35], s61 offen lds
  v_mfma_f32_16x16x32_bf16 v[252:255], a[160:163], a[156:159], v[252:255]
  v_cndmask_b32 v28, 0, v25, s[16:17]
  v_cndmask_b32 v29, 0, v25, s[18:19]
  v_mfma_f32_16x16x32_bf16 v[248:251], a[160:163], a[152:155], v[248:251]
  ds_read_b64_tr_b16 a[176:177], v6 offset:61440
  v_cndmask_b32 v30, 0, v25, s[20:21]
  v_mfma_f32_16x16x32_bf16 v[248:251], a[164:167], a[136:139], v[248:251]
  v_cndmask_b32 v31, 0, v25, s[22:23]
  v_mfma_f32_16x16x32_bf16 v[244:247], a[164:167], a[132:135], v[244:247]
  ds_read_b64_tr_b16 a[178:179], v6 offset:63488
  v_mfma_f32_16x16x32_bf16 v[244:247], a[160:163], a[148:151], v[244:247]
  buffer_load_dwordx4 a[32:35], v1, s[8:11], s78 offen offset:0 sc1
  v_mfma_f32_16x16x32_bf16 v[240:243], a[160:163], a[144:147], v[240:243]
  ds_read_b64_tr_b16 a[160:161], v7 offset:49152
  v_mfma_f32_16x16x32_bf16 a[184:187], v[28:31], a[240:243], a[184:187]
  v_mfma_f32_16x16x32_bf16 v[240:243], a[164:167], a[128:131], v[240:243]
  v_cndmask_b32 v28, 0, v26, s[16:17]
  s_waitcnt vmcnt(9) lgkmcnt(5)
  v_mfma_f32_16x16x32_bf16 v[64:67], a[172:175], a[0:3], v[64:67]
  ds_read_b64_tr_b16 a[162:163], v7 offset:51200
  v_cndmask_b32 v29, 0, v26, s[18:19]
  v_mfma_f32_16x16x32_bf16 v[64:67], a[168:171], a[16:19], v[64:67]
  v_cndmask_b32 v30, 0, v26, s[20:21]
  v_cndmask_b32 v31, 0, v26, s[22:23]
  v_mfma_f32_16x16x32_bf16 v[68:71], a[168:171], a[20:23], v[68:71]
  ds_read_b64_tr_b16 a[164:165], v7 offset:53248
  buffer_load_dwordx4 a[48:51], v1, s[8:11], s78 offen offset:1024 sc1
  v_mfma_f32_16x16x32_bf16 v[68:71], a[172:175], a[4:7], v[68:71]
  v_mfma_f32_16x16x32_bf16 a[184:187], v[28:31], a[244:247], a[184:187]
  v_mfma_f32_16x16x32_bf16 v[72:75], a[172:175], a[8:11], v[72:75]
  ds_read_b64_tr_b16 a[166:167], v7 offset:55296
  v_cndmask_b32 v28, 0, v27, s[16:17]
  v_mfma_f32_16x16x32_bf16 v[72:75], a[168:171], a[24:27], v[72:75]
  v_cndmask_b32 v29, 0, v27, s[18:19]
  v_cndmask_b32 v30, 0, v27, s[20:21]
  v_mfma_f32_16x16x32_bf16 v[76:79], a[168:171], a[28:31], v[76:79]
  ds_read_b64_tr_b16 a[168:169], v7 offset:57344
  s_add_u32 s78, s78, 65536
  v_mfma_f32_16x16x32_bf16 v[76:79], a[172:175], a[12:15], v[76:79]
  buffer_load_dwordx4 a[36:39], v1, s[8:11], s78 offen offset:0 sc1
  s_waitcnt lgkmcnt(5)
  v_mfma_f32_16x16x32_bf16 v[92:95], a[180:183], a[12:15], v[92:95]
  ds_read_b64_tr_b16 a[170:171], v7 offset:59392
  v_cndmask_b32 v31, 0, v27, s[22:23]
  v_mfma_f32_16x16x32_bf16 v[92:95], a[176:179], a[28:31], v[92:95]
  s_nop 0
  v_mfma_f32_16x16x32_bf16 a[184:187], v[28:31], a[248:251], a[184:187]
  v_mfma_f32_16x16x32_bf16 v[88:91], a[176:179], a[24:27], v[88:91]
  ds_read_b64_tr_b16 a[172:173], v7 offset:61440
  v_mfma_f32_16x16x32_bf16 v[88:91], a[180:183], a[8:11], v[88:91]
  v_mfma_f32_16x16x32_bf16 v[84:87], a[180:183], a[4:7], v[84:87]
  ds_read_b64_tr_b16 a[174:175], v7 offset:63488
  buffer_load_dwordx4 a[52:55], v1, s[8:11], s78 offen offset:1024 sc1
  v_mfma_f32_16x16x32_bf16 v[84:87], a[176:179], a[20:23], v[84:87]
  s_bfe_u32 s53, s2, 0x20004
  s_lshl_b32 s53, s53, 9
  v_mfma_f32_16x16x32_bf16 v[80:83], a[176:179], a[16:19], v[80:83]
  ds_read_b64_tr_b16 a[176:177], v8 offset:49152
  v_and_b32 v14, 15, v0
  v_mfma_f32_16x16x32_bf16 v[80:83], a[180:183], a[0:3], v[80:83]
  v_lshl_add_u32 v14, v14, 5, s53
  s_waitcnt lgkmcnt(5)
  v_mfma_f32_16x16x32_bf16 v[96:99], a[160:163], a[0:3], v[96:99]
  ds_read_b64_tr_b16 a[178:179], v8 offset:51200
  s_add_u32 s78, s78, 65536
  v_mfma_f32_16x16x32_bf16 v[96:99], a[164:167], a[16:19], v[96:99]
  buffer_load_dwordx4 a[40:43], v1, s[8:11], s78 offen offset:0 sc1
  v_mfma_f32_16x16x32_bf16 v[100:103], a[164:167], a[20:23], v[100:103]
  ds_read_b64_tr_b16 a[180:181], v8 offset:53248
  v_cmp_gt_u32 vcc, 1792, v14
  v_mov_b32 v15, 134217728
  v_bfe_u32 v13, v0, 4, 1
  v_cndmask_b32 v14, v15, v14, vcc
  v_mfma_f32_16x16x32_bf16 v[100:103], a[160:163], a[4:7], v[100:103]
  v_lshl_add_u32 v14, v13, 4, v14
  v_lshrrev_b32 v13, 5, v0
  v_mfma_f32_16x16x32_bf16 v[104:107], a[160:163], a[8:11], v[104:107]
  ds_read_b64_tr_b16 a[182:183], v8 offset:55296
  v_mul_u32_u24 v13, 14336, v13
  v_mfma_f32_16x16x32_bf16 v[104:107], a[164:167], a[24:27], v[104:107]
  v_add_u32 v14, v14, v13
  s_lshr_b32 s53, s2, 6
  v_mfma_f32_16x16x32_bf16 v[108:111], a[164:167], a[28:31], v[108:111]
  ds_read_b64_tr_b16 a[164:165], v8 offset:57344
  buffer_load_dwordx4 a[56:59], v1, s[8:11], s78 offen offset:1024 sc1
  v_mfma_f32_16x16x32_bf16 v[108:111], a[160:163], a[12:15], v[108:111]
  s_lshl_b32 s53, s53, 2
  s_waitcnt lgkmcnt(5)
  v_mfma_f32_16x16x32_bf16 v[124:127], a[168:171], a[12:15], v[124:127]
  ds_read_b64_tr_b16 a[166:167], v8 offset:59392
  s_add_u32 s53, s53, s44
  v_mfma_f32_16x16x32_bf16 v[124:127], a[172:175], a[28:31], v[124:127]
  s_lshl_b32 s53, s53, 1
  s_bfe_u32 s54, s2, 0x10003
  v_mfma_f32_16x16x32_bf16 v[120:123], a[172:175], a[24:27], v[120:123]
  ds_read_b64_tr_b16 a[160:161], v8 offset:61440
  s_add_u32 s78, s78, 65536
  v_mfma_f32_16x16x32_bf16 v[120:123], a[168:171], a[8:11], v[120:123]
  buffer_load_dwordx4 a[44:47], v1, s[8:11], s78 offen offset:0 sc1
  s_add_u32 s53, s53, s54
  v_mfma_f32_16x16x32_bf16 v[116:119], a[168:171], a[4:7], v[116:119]
  ds_read_b64_tr_b16 a[162:163], v8 offset:63488
  s_mul_i32 s53, s53, 28672
  v_mfma_f32_16x16x32_bf16 v[116:119], a[172:175], a[20:23], v[116:119]
  s_mul_i32 s54, s52, 1792
  s_add_u32 s53, s53, s54
  v_mfma_f32_16x16x32_bf16 v[112:115], a[172:175], a[16:19], v[112:115]
  ds_read_b64_tr_b16 a[172:173], v2 offset:49152
  s_add_u32 s53, s53, 46137344
  v_mfma_f32_16x16x32_bf16 v[112:115], a[168:171], a[0:3], v[112:115]
  buffer_store_dwordx4 a[184:187], v14, s[8:11], s53 offen sc1
  s_waitcnt lgkmcnt(5)
  v_mfma_f32_16x16x32_bf16 v[32:35], a[176:179], a[0:3], v[32:35]
  ds_read_b64_tr_b16 a[174:175], v2 offset:51200
  buffer_load_dwordx4 a[60:63], v1, s[8:11], s78 offen offset:1024 sc1
  v_mfma_f32_16x16x32_bf16 v[32:35], a[180:183], a[16:19], v[32:35]
  s_lshl_b32 s53, s52, 7
  s_add_u32 s53, s53, 884736
  v_mfma_f32_16x16x32_bf16 v[36:39], a[180:183], a[20:23], v[36:39]
  ds_read_b64_tr_b16 a[168:169], v2 offset:53248
  v_and_b32 v13, 31, v0
  v_mfma_f32_16x16x32_bf16 v[36:39], a[176:179], a[4:7], v[36:39]
  v_min_u32 v15, 27, v13
  v_lshl_add_u32 v13, v13, 10, s53
  v_mfma_f32_16x16x32_bf16 v[40:43], a[176:179], a[8:11], v[40:43]
  ds_read_b64_tr_b16 a[170:171], v2 offset:55296
  s_cmp_eq_u32 s56, 3
  s_cselect_b32 s79, 11, 7
  s_mul_i32 s71, s79, 458752
  s_lshl_b32 s79, s79, 11
  s_add_u32 s79, s79, s57
  s_add_u32 m0, s45, 81920
  v_mfma_f32_16x16x32_bf16 v[40:43], a[180:183], a[24:27], v[40:43]
  buffer_load_dwordx4 v11, s[28:31], s71 offen lds
  v_lshlrev_b32 v15, 4, v15
  v_mfma_f32_16x16x32_bf16 v[44:47], a[180:183], a[28:31], v[44:47]
  ds_read_b64_tr_b16 a[180:181], v2 offset:57344
  s_lshl_b32 s53, s51, 9
  v_mfma_f32_16x16x32_bf16 v[44:47], a[176:179], a[12:15], v[44:47]
  v_mov_b32 v14, s53
  s_waitcnt lgkmcnt(5)
  v_mfma_f32_16x16x32_bf16 v[60:63], a[164:167], a[12:15], v[60:63]
  ds_read_b64_tr_b16 a[182:183], v2 offset:59392
  s_lshl_b32 s55, s51, 3
  v_mfma_f32_16x16x32_bf16 v[60:63], a[160:163], a[28:31], v[60:63]
  s_add_u32 m0, s45, 90112
  s_lshr_b32 s53, 0x0b070602, s55
  v_mfma_f32_16x16x32_bf16 v[56:59], a[160:163], a[24:27], v[56:59]
  ds_read_b64_tr_b16 a[176:177], v2 offset:61440
  buffer_load_dwordx4 v11, s[32:35], s71 offen lds
  v_mfma_f32_16x16x32_bf16 v[56:59], a[164:167], a[8:11], v[56:59]
  s_and_b32 s53, s53, 15
  s_lshl_b32 s53, s53, 7
  v_mfma_f32_16x16x32_bf16 v[52:55], a[164:167], a[4:7], v[52:55]
  ds_read_b64_tr_b16 a[178:179], v2 offset:63488
  s_sub_u32 s53, s53, 256
  v_mfma_f32_16x16x32_bf16 v[52:55], a[160:163], a[20:23], v[52:55]
  v_mov_b32 v24, s53
  v_mfma_f32_16x16x32_bf16 v[48:51], a[160:163], a[16:19], v[48:51]
  ds_read_b64_tr_b16 a[160:161], v3 offset:49152
  s_add_u32 m0, s45, 86016
  s_add_u32 s61, s71, 229376
  v_mfma_f32_16x16x32_bf16 v[48:51], a[164:167], a[0:3], v[48:51]
  buffer_load_dwordx4 v11, s[28:31], s61 offen lds
  s_waitcnt lgkmcnt(5)
  v_mfma_f32_16x16x32_bf16 v[128:131], a[172:175], a[0:3], v[128:131]
  ds_read_b64_tr_b16 a[162:163], v3 offset:51200
  v_mfma_f32_16x16x32_bf16 v[128:131], a[168:171], a[16:19], v[128:131]
  v_cmp_gt_u32 vcc, 256, v15
  s_nop 1
  v_cndmask_b32 v14, v24, v14, vcc
  v_mfma_f32_16x16x32_bf16 v[132:135], a[168:171], a[20:23], v[132:135]
  ds_read_b64_tr_b16 a[164:165], v3 offset:53248
  s_lshr_b32 s53, 0x15140706, s55
  v_mfma_f32_16x16x32_bf16 v[132:135], a[172:175], a[4:7], v[132:135]
  s_add_u32 m0, s45, 94208
  s_add_u32 s61, s71, 229376
  v_mfma_f32_16x16x32_bf16 v[136:139], a[172:175], a[8:11], v[136:139]
  ds_read_b64_tr_b16 a[166:167], v3 offset:55296
  buffer_load_dwordx4 v11, s[32:35], s61 offen lds
  v_mfma_f32_16x16x32_bf16 v[136:139], a[168:171], a[24:27], v[136:139]
  s_and_b32 s53, s53, 31
  s_lshl_b32 s53, s53, 6
  v_mfma_f32_16x16x32_bf16 v[140:143], a[168:171], a[28:31], v[140:143]
  ds_read_b64_tr_b16 a[168:169], v3 offset:57344
  s_sub_u32 s53, s53, 384
  v_mfma_f32_16x16x32_bf16 v[140:143], a[172:175], a[12:15], v[140:143]
  v_mov_b32 v24, s53
  s_waitcnt lgkmcnt(5)
  v_mfma_f32_16x16x32_bf16 v[156:159], a[180:183], a[12:15], v[156:159]
  ds_read_b64_tr_b16 a[170:171], v3 offset:59392
  s_add_u32 m0, s45, 0
  v_mfma_f32_16x16x32_bf16 v[156:159], a[176:179], a[28:31], v[156:159]
  buffer_load_dwordx4 v10, s[28:31], s71 offen lds
  v_mfma_f32_16x16x32_bf16 v[152:155], a[176:179], a[24:27], v[152:155]
  ds_read_b64_tr_b16 a[172:173], v3 offset:61440
  v_cmp_gt_u32 vcc, 384, v15
  s_nop 1
  v_cndmask_b32 v14, v24, v14, vcc
  v_mfma_f32_16x16x32_bf16 v[152:155], a[180:183], a[8:11], v[152:155]
  v_lshrrev_b32 v24, 5, v0
  v_mul_u32_u24 v24, 57344, v24
  v_mfma_f32_16x16x32_bf16 v[148:151], a[180:183], a[4:7], v[148:151]
  ds_read_b64_tr_b16 a[174:175], v3 offset:63488
  v_add3_u32 v14, v14, v15, v24
  v_mfma_f32_16x16x32_bf16 v[148:151], a[176:179], a[20:23], v[148:151]
  s_add_u32 m0, s45, 8192
  s_mul_i32 s53, s44, 14336
  v_mfma_f32_16x16x32_bf16 v[144:147], a[176:179], a[16:19], v[144:147]
  ds_read_b64_tr_b16 a[176:177], v4 offset:49152
  buffer_load_dwordx4 v10, s[32:35], s71 offen lds
  v_mfma_f32_16x16x32_bf16 v[144:147], a[180:183], a[0:3], v[144:147]
  s_add_u32 s53, s53, s54
  s_waitcnt lgkmcnt(5)
  v_mfma_f32_16x16x32_bf16 v[160:163], a[160:163], a[0:3], v[160:163]
  ds_read_b64_tr_b16 a[178:179], v4 offset:51200
  s_add_u32 s53, s53, 46137344
  v_mfma_f32_16x16x32_bf16 v[160:163], a[164:167], a[16:19], v[160:163]
  v_add_u32 v14, s53, v14
  s_lshl_b32 s53, s44, 9
  v_mfma_f32_16x16x32_bf16 v[164:167], a[164:167], a[20:23], v[164:167]
  ds_read_b64_tr_b16 a[180:181], v4 offset:53248
  s_add_u32 m0, s45, 4096
  s_add_u32 s61, s71, 229376
  v_mfma_f32_16x16x32_bf16 v[164:167], a[160:163], a[4:7], v[164:167]
  buffer_load_dwordx4 v10, s[28:31], s61 offen lds
  s_add_u32 s53, s53, 131072
  v_mfma_f32_16x16x32_bf16 v[168:171], a[160:163], a[8:11], v[168:171]
  ds_read_b64_tr_b16 a[182:183], v4 offset:55296
  v_add_u32 v15, s53, v15
  v_mfma_f32_16x16x32_bf16 v[168:171], a[164:167], a[24:27], v[168:171]
  s_and_b32 s50, s2, 4
  s_lshr_b32 s53, s2, 6
  v_mfma_f32_16x16x32_bf16 v[172:175], a[164:167], a[28:31], v[172:175]
  ds_read_b64_tr_b16 a[164:165], v4 offset:57344
  s_add_u32 s50, s50, s53
  v_mfma_f32_16x16x32_bf16 v[172:175], a[160:163], a[12:15], v[172:175]
  s_add_u32 m0, s45, 12288
  s_add_u32 s61, s71, 229376
  s_waitcnt lgkmcnt(5)
  v_mfma_f32_16x16x32_bf16 v[188:191], a[168:171], a[12:15], v[188:191]
  ds_read_b64_tr_b16 a[166:167], v4 offset:59392
  buffer_load_dwordx4 v10, s[32:35], s61 offen lds
  v_mfma_f32_16x16x32_bf16 v[188:191], a[172:175], a[28:31], v[188:191]
  s_bfe_u32 s51, s2, 0x30003
  s_and_b32 s52, s2, 3
  v_mfma_f32_16x16x32_bf16 v[184:187], a[172:175], a[24:27], v[184:187]
  ds_read_b64_tr_b16 a[160:161], v4 offset:61440
  s_add_u32 s91, s50, s51
  v_mfma_f32_16x16x32_bf16 v[184:187], a[168:171], a[8:11], v[184:187]
  s_and_b32 s91, s91, 3
  s_lshl_b32 s53, s50, 4
  v_mfma_f32_16x16x32_bf16 v[180:183], a[168:171], a[4:7], v[180:183]
  ds_read_b64_tr_b16 a[162:163], v4 offset:63488
  v_mfma_f32_16x16x32_bf16 v[180:183], a[172:175], a[20:23], v[180:183]
  buffer_load_dwordx4 a[64:67], v1, s[8:11], s79 offen offset:0 sc1
  s_and_b32 s54, s52, 2
  v_mfma_f32_16x16x32_bf16 v[176:179], a[172:175], a[16:19], v[176:179]
  ds_read_b64_tr_b16 a[172:173], v5 offset:49152
  s_mul_i32 s89, s54, 4293918720
  v_mfma_f32_16x16x32_bf16 v[176:179], a[168:171], a[0:3], v[176:179]
  s_add_u32 s89, s89, 917504
  s_waitcnt lgkmcnt(5)
  v_mfma_f32_16x16x32_bf16 v[192:195], a[176:179], a[0:3], v[192:195]
  ds_read_b64_tr_b16 a[174:175], v5 offset:51200
  s_lshl_b32 s54, s54, 2
  v_mfma_f32_16x16x32_bf16 v[192:195], a[180:183], a[16:19], v[192:195]
  s_add_u32 s53, s53, s54
  s_lshl_b32 s54, s44, 1
  v_mfma_f32_16x16x32_bf16 v[196:199], a[180:183], a[20:23], v[196:199]
  ds_read_b64_tr_b16 a[168:169], v5 offset:53248
  buffer_load_dwordx4 a[80:83], v1, s[8:11], s79 offen offset:1024 sc1
  v_mfma_f32_16x16x32_bf16 v[196:199], a[176:179], a[4:7], v[196:199]
  s_add_u32 s53, s53, s54
  s_mul_i32 s84, s53, 131072
  v_mfma_f32_16x16x32_bf16 v[200:203], a[176:179], a[8:11], v[200:203]
  ds_read_b64_tr_b16 a[170:171], v5 offset:55296
  s_mul_i32 s54, s52, 28672
  v_mfma_f32_16x16x32_bf16 v[200:203], a[180:183], a[24:27], v[200:203]
  s_add_u32 s84, s84, s54
  s_add_u32 s84, s84, 19922944
  v_mfma_f32_16x16x32_bf16 v[204:207], a[180:183], a[28:31], v[204:207]
  ds_read_b64_tr_b16 a[180:181], v5 offset:57344
  s_add_u32 s79, s79, 65536
  v_mfma_f32_16x16x32_bf16 v[204:207], a[176:179], a[12:15], v[204:207]
  buffer_load_dwordx4 a[68:71], v1, s[8:11], s79 offen offset:0 sc1
  s_waitcnt lgkmcnt(5)
  v_mfma_f32_16x16x32_bf16 v[220:223], a[164:167], a[12:15], v[220:223]
  ds_read_b64_tr_b16 a[182:183], v5 offset:59392
  s_lshl_b32 s85, s53, 15
  v_mfma_f32_16x16x32_bf16 v[220:223], a[160:163], a[28:31], v[220:223]
  s_lshl_b32 s51, s51, 1
  s_and_b32 s54, s52, 1
  v_mfma_f32_16x16x32_bf16 v[216:219], a[160:163], a[24:27], v[216:219]
  ds_read_b64_tr_b16 a[176:177], v5 offset:61440
  s_add_u32 s51, s51, s54
  v_mfma_f32_16x16x32_bf16 v[216:219], a[164:167], a[8:11], v[216:219]
  s_lshl_b32 s53, s51, 7
  s_add_u32 s85, s85, s53
  v_mfma_f32_16x16x32_bf16 v[212:215], a[164:167], a[4:7], v[212:215]
  ds_read_b64_tr_b16 a[178:179], v5 offset:63488
  buffer_load_dwordx4 a[84:87], v1, s[8:11], s79 offen offset:1024 sc1
  v_mfma_f32_16x16x32_bf16 v[212:215], a[160:163], a[20:23], v[212:215]
  s_waitcnt vmcnt(21)
  s_barrier
  v_mfma_f32_16x16x32_bf16 v[208:211], a[160:163], a[16:19], v[208:211]
  ds_read_b64_tr_b16 a[160:161], v6 offset:32768
  s_lshl_b32 s88, s51, 8
  v_mfma_f32_16x16x32_bf16 v[208:211], a[164:167], a[0:3], v[208:211]
  s_add_u32 s88, s88, 20480
  s_waitcnt lgkmcnt(5)
  v_mfma_f32_16x16x32_bf16 v[224:227], a[172:175], a[0:3], v[224:227]
  ds_read_b64_tr_b16 a[162:163], v6 offset:34816
  s_add_u32 s79, s79, 65536
  v_mfma_f32_16x16x32_bf16 v[224:227], a[168:171], a[16:19], v[224:227]
  buffer_load_dwordx4 a[72:75], v1, s[8:11], s79 offen offset:0 sc1
  s_lshl_b32 s53, s50, 12
  v_mfma_f32_16x16x32_bf16 v[228:231], a[168:171], a[20:23], v[228:231]
  ds_read_b64_tr_b16 a[164:165], v6 offset:36864
  s_lshl_b32 s54, s52, 8
  v_mfma_f32_16x16x32_bf16 v[228:231], a[172:175], a[4:7], v[228:231]
  s_add_u32 s53, s53, s54
  s_add_u32 s82, s53, 688128
  v_mfma_f32_16x16x32_bf16 v[232:235], a[172:175], a[8:11], v[232:235]
  ds_read_b64_tr_b16 a[166:167], v6 offset:38912
  s_lshl_b32 s90, s44, 12
  v_mfma_f32_16x16x32_bf16 v[232:235], a[168:171], a[24:27], v[232:235]
  s_add_u32 s90, s90, 135168
  s_lshl_b32 s86, s2, 16
  v_mfma_f32_16x16x32_bf16 v[236:239], a[168:171], a[28:31], v[236:239]
  ds_read_b64_tr_b16 a[168:169], v6 offset:40960
  buffer_load_dwordx4 a[88:91], v1, s[8:11], s79 offen offset:1024 sc1
  v_mfma_f32_16x16x32_bf16 v[236:239], a[172:175], a[12:15], v[236:239]
  s_lshl_b32 s53, s44, 14
  s_waitcnt lgkmcnt(5)
  v_mfma_f32_16x16x32_bf16 v[252:255], a[180:183], a[12:15], v[252:255]
  ds_read_b64_tr_b16 a[170:171], v6 offset:43008
  v_add_u32 v9, s46, v0
  s_waitcnt vmcnt(15)
  s_barrier
  s_mov_b64 exec, 1
  buffer_store_dword v9, v0, s[8:11], s80 offen offset:0 sc1
  s_mov_b64 exec, -1
  s_sub_u32 s80, s80, 196608
  v_mfma_f32_16x16x32_bf16 v[252:255], a[176:179], a[28:31], v[252:255]
  s_add_u32 s86, s86, s53
  s_add_u32 s86, s86, 67108864
  v_mfma_f32_16x16x32_bf16 v[248:251], a[176:179], a[24:27], v[248:251]
  ds_read_b64_tr_b16 a[172:173], v6 offset:45056
  s_add_u32 s79, s79, 65536
  v_mfma_f32_16x16x32_bf16 v[248:251], a[180:183], a[8:11], v[248:251]
  buffer_load_dwordx4 a[76:79], v1, s[8:11], s79 offen offset:0 sc1
  s_lshr_b32 s53, s2, 3
  v_mfma_f32_16x16x32_bf16 v[244:247], a[180:183], a[4:7], v[244:247]
  ds_read_b64_tr_b16 a[174:175], v6 offset:47104
  s_lshl_b32 s53, s53, 2
  v_mfma_f32_16x16x32_bf16 v[244:247], a[176:179], a[20:23], v[244:247]
  s_add_u32 s53, s53, s44
  s_mul_i32 s92, s53, 14336
  v_mfma_f32_16x16x32_bf16 v[240:243], a[176:179], a[16:19], v[240:243]
  ds_read_b64_tr_b16 a[176:177], v7 offset:32768
  s_mul_i32 s53, s52, 1835008
  v_mfma_f32_16x16x32_bf16 v[240:243], a[180:183], a[0:3], v[240:243]
  s_add_u32 s92, s92, s53
  s_waitcnt vmcnt(16) lgkmcnt(5)
  v_mfma_f32_16x16x32_bf16 v[64:67], a[160:163], a[32:35], v[64:67]
  ds_read_b64_tr_b16 a[178:179], v7 offset:34816
  buffer_load_dwordx4 a[92:95], v1, s[8:11], s79 offen offset:1024 sc1
  v_mfma_f32_16x16x32_bf16 v[64:67], a[164:167], a[48:51], v[64:67]
  s_nop 0
  v_mfma_f32_16x16x32_bf16 v[68:71], a[164:167], a[52:55], v[68:71]
  ds_read_b64_tr_b16 a[180:181], v7 offset:36864
  v_mfma_f32_16x16x32_bf16 v[68:71], a[160:163], a[36:39], v[68:71]
  v_mfma_f32_16x16x32_bf16 v[72:75], a[160:163], a[40:43], v[72:75]
  ds_read_b64_tr_b16 a[182:183], v7 offset:38912
  s_cmp_eq_u32 s56, 0
  s_cselect_b32 s72, 12, 8
  s_mul_i32 s64, s72, 458752
  s_lshl_b32 s72, s72, 11
  s_add_u32 s72, s72, s57
  s_add_u32 m0, s45, 65536
  v_mfma_f32_16x16x32_bf16 v[72:75], a[164:167], a[56:59], v[72:75]
  buffer_load_dwordx4 v11, s[28:31], s64 offen lds
  v_mfma_f32_16x16x32_bf16 v[76:79], a[164:167], a[60:63], v[76:79]
  ds_read_b64_tr_b16 a[164:165], v7 offset:40960
  v_mfma_f32_16x16x32_bf16 v[76:79], a[160:163], a[44:47], v[76:79]
  s_waitcnt lgkmcnt(5)
  v_mfma_f32_16x16x32_bf16 v[92:95], a[168:171], a[44:47], v[92:95]
  ds_read_b64_tr_b16 a[166:167], v7 offset:43008
  v_mfma_f32_16x16x32_bf16 v[92:95], a[172:175], a[60:63], v[92:95]
  s_add_u32 m0, s45, 73728
  v_mfma_f32_16x16x32_bf16 v[88:91], a[172:175], a[56:59], v[88:91]
  ds_read_b64_tr_b16 a[160:161], v7 offset:45056
  buffer_load_dwordx4 v11, s[32:35], s64 offen lds
  v_mfma_f32_16x16x32_bf16 v[88:91], a[168:171], a[40:43], v[88:91]
  v_mfma_f32_16x16x32_bf16 v[84:87], a[168:171], a[36:39], v[84:87]
  ds_read_b64_tr_b16 a[162:163], v7 offset:47104
  v_mfma_f32_16x16x32_bf16 v[84:87], a[172:175], a[52:55], v[84:87]
  v_mfma_f32_16x16x32_bf16 v[80:83], a[172:175], a[48:51], v[80:83]
  ds_read_b64_tr_b16 a[172:173], v8 offset:32768
  s_add_u32 m0, s45, 69632
  s_add_u32 s61, s64, 229376
  v_mfma_f32_16x16x32_bf16 v[80:83], a[168:171], a[32:35], v[80:83]
  buffer_load_dwordx4 v11, s[28:31], s61 offen lds
  s_waitcnt lgkmcnt(5)
  v_mfma_f32_16x16x32_bf16 v[96:99], a[176:179], a[32:35], v[96:99]
  ds_read_b64_tr_b16 a[174:175], v8 offset:34816
  v_mfma_f32_16x16x32_bf16 v[96:99], a[180:183], a[48:51], v[96:99]
  v_mfma_f32_16x16x32_bf16 v[100:103], a[180:183], a[52:55], v[100:103]
  ds_read_b64_tr_b16 a[168:169], v8 offset:36864
  v_mfma_f32_16x16x32_bf16 v[100:103], a[176:179], a[36:39], v[100:103]
  s_add_u32 m0, s45, 77824
  s_add_u32 s61, s64, 229376
  v_mfma_f32_16x16x32_bf16 v[104:107], a[176:179], a[40:43], v[104:107]
  ds_read_b64_tr_b16 a[170:171], v8 offset:38912
  buffer_load_dwordx4 v11, s[32:35], s61 offen lds
  v_mfma_f32_16x16x32_bf16 v[104:107], a[180:183], a[56:59], v[104:107]
  v_mfma_f32_16x16x32_bf16 v[108:111], a[180:183], a[60:63], v[108:111]
  ds_read_b64_tr_b16 a[180:181], v8 offset:40960
  v_mfma_f32_16x16x32_bf16 v[108:111], a[176:179], a[44:47], v[108:111]
  s_waitcnt lgkmcnt(5)
  v_mfma_f32_16x16x32_bf16 v[124:127], a[164:167], a[44:47], v[124:127]
  ds_read_b64_tr_b16 a[182:183], v8 offset:43008
  s_add_u32 m0, s45, 32768
  v_mfma_f32_16x16x32_bf16 v[124:127], a[160:163], a[60:63], v[124:127]
  buffer_load_dwordx4 v10, s[28:31], s64 offen lds
  v_mfma_f32_16x16x32_bf16 v[120:123], a[160:163], a[56:59], v[120:123]
  ds_read_b64_tr_b16 a[176:177], v8 offset:45056
  v_mfma_f32_16x16x32_bf16 v[120:123], a[164:167], a[40:43], v[120:123]
  v_mfma_f32_16x16x32_bf16 v[116:119], a[164:167], a[36:39], v[116:119]
  ds_read_b64_tr_b16 a[178:179], v8 offset:47104
  v_mfma_f32_16x16x32_bf16 v[116:119], a[160:163], a[52:55], v[116:119]
  s_add_u32 m0, s45, 40960
  v_mfma_f32_16x16x32_bf16 v[112:115], a[160:163], a[48:51], v[112:115]
  ds_read_b64_tr_b16 a[160:161], v2 offset:16384
  buffer_load_dwordx4 v10, s[32:35], s64 offen lds
  v_mfma_f32_16x16x32_bf16 v[112:115], a[164:167], a[32:35], v[112:115]
  s_waitcnt lgkmcnt(5)
  v_mfma_f32_16x16x32_bf16 v[32:35], a[172:175], a[32:35], v[32:35]
  ds_read_b64_tr_b16 a[162:163], v2 offset:18432
  v_mfma_f32_16x16x32_bf16 v[32:35], a[168:171], a[48:51], v[32:35]
  s_cmp_lg_u32 s44, 0
  s_cbranch_scc1 PI16_adaLN_cond__sliding_local_dilated__swiglu_ffn__prompt_kernel
  buffer_load_dword v9, v13, s[8:11], 0 offen sc1
PI16_adaLN_cond__sliding_local_dilated__swiglu_ffn__prompt_kernel:
  v_mfma_f32_16x16x32_bf16 v[36:39], a[168:171], a[52:55], v[36:39]
  ds_read_b64_tr_b16 a[164:165], v2 offset:20480
  s_add_u32 m0, s45, 36864
  s_add_u32 s61, s64, 229376
  v_mfma_f32_16x16x32_bf16 v[36:39], a[172:175], a[36:39], v[36:39]
  buffer_load_dwordx4 v10, s[28:31], s61 offen lds
  v_mfma_f32_16x16x32_bf16 v[40:43], a[172:175], a[40:43], v[40:43]
  ds_read_b64_tr_b16 a[166:167], v2 offset:22528
  v_mfma_f32_16x16x32_bf16 v[40:43], a[168:171], a[56:59], v[40:43]
  v_mfma_f32_16x16x32_bf16 v[44:47], a[168:171], a[60:63], v[44:47]
  ds_read_b64_tr_b16 a[168:169], v2 offset:24576
  v_mfma_f32_16x16x32_bf16 v[44:47], a[172:175], a[44:47], v[44:47]
  s_add_u32 m0, s45, 45056
  s_add_u32 s61, s64, 229376
  s_waitcnt lgkmcnt(5)
  v_mfma_f32_16x16x32_bf16 v[60:63], a[180:183], a[44:47], v[60:63]
  ds_read_b64_tr_b16 a[170:171], v2 offset:26624
  buffer_load_dwordx4 v10, s[32:35], s61 offen lds
  v_mfma_f32_16x16x32_bf16 v[60:63], a[176:179], a[60:63], v[60:63]
  v_mfma_f32_16x16x32_bf16 v[56:59], a[176:179], a[56:59], v[56:59]
  ds_read_b64_tr_b16 a[172:173], v2 offset:28672
  v_mfma_f32_16x16x32_bf16 v[56:59], a[180:183], a[40:43], v[56:59]
  v_mfma_f32_16x16x32_bf16 v[52:55], a[180:183], a[36:39], v[52:55]
  ds_read_b64_tr_b16 a[174:175], v2 offset:30720
  v_mfma_f32_16x16x32_bf16 v[52:55], a[176:179], a[52:55], v[52:55]
  buffer_load_dwordx4 a[96:99], v1, s[8:11], s72 offen offset:0 sc1
  v_mfma_f32_16x16x32_bf16 v[48:51], a[176:179], a[48:51], v[48:51]
  ds_read_b64_tr_b16 a[176:177], v3 offset:16384
  v_mfma_f32_16x16x32_bf16 v[48:51], a[180:183], a[32:35], v[48:51]
  s_waitcnt lgkmcnt(5)
  v_mfma_f32_16x16x32_bf16 v[128:131], a[160:163], a[32:35], v[128:131]
  ds_read_b64_tr_b16 a[178:179], v3 offset:18432
  v_mfma_f32_16x16x32_bf16 v[128:131], a[164:167], a[48:51], v[128:131]
  v_mfma_f32_16x16x32_bf16 v[132:135], a[164:167], a[52:55], v[132:135]
  ds_read_b64_tr_b16 a[180:181], v3 offset:20480
  buffer_load_dwordx4 a[112:115], v1, s[8:11], s72 offen offset:1024 sc1
  v_mfma_f32_16x16x32_bf16 v[132:135], a[160:163], a[36:39], v[132:135]
  v_mfma_f32_16x16x32_bf16 v[136:139], a[160:163], a[40:43], v[136:139]
  ds_read_b64_tr_b16 a[182:183], v3 offset:22528
  v_mfma_f32_16x16x32_bf16 v[136:139], a[164:167], a[56:59], v[136:139]
HOP10:
  s_cbranch_execz HOP13
  v_mfma_f32_16x16x32_bf16 v[140:143], a[164:167], a[60:63], v[140:143]
  ds_read_b64_tr_b16 a[164:165], v3 offset:24576
  s_add_u32 s72, s72, 65536
  v_mfma_f32_16x16x32_bf16 v[140:143], a[160:163], a[44:47], v[140:143]
  buffer_load_dwordx4 a[100:103], v1, s[8:11], s72 offen offset:0 sc1
  s_waitcnt lgkmcnt(5)
  v_mfma_f32_16x16x32_bf16 v[156:159], a[168:171], a[44:47], v[156:159]
  ds_read_b64_tr_b16 a[166:167], v3 offset:26624
  v_mfma_f32_16x16x32_bf16 v[156:159], a[172:175], a[60:63], v[156:159]
  v_mfma_f32_16x16x32_bf16 v[152:155], a[172:175], a[56:59], v[152:155]
  ds_read_b64_tr_b16 a[160:161], v3 offset:28672
  v_mfma_f32_16x16x32_bf16 v[152:155], a[168:171], a[40:43], v[152:155]
  v_mfma_f32_16x16x32_bf16 v[148:151], a[168:171], a[36:39], v[148:151]
  ds_read_b64_tr_b16 a[162:163], v3 offset:30720
  buffer_load_dwordx4 a[116:119], v1, s[8:11], s72 offen offset:1024 sc1
  v_mfma_f32_16x16x32_bf16 v[148:151], a[172:175], a[52:55], v[148:151]
  v_mfma_f32_16x16x32_bf16 v[144:147], a[172:175], a[48:51], v[144:147]
  ds_read_b64_tr_b16 a[172:173], v4 offset:16384
  v_mfma_f32_16x16x32_bf16 v[144:147], a[168:171], a[32:35], v[144:147]
  s_waitcnt lgkmcnt(5)
  v_mfma_f32_16x16x32_bf16 v[160:163], a[176:179], a[32:35], v[160:163]
  ds_read_b64_tr_b16 a[174:175], v4 offset:18432
  s_add_u32 s72, s72, 65536
  v_mfma_f32_16x16x32_bf16 v[160:163], a[180:183], a[48:51], v[160:163]
  buffer_load_dwordx4 a[104:107], v1, s[8:11], s72 offen offset:0 sc1
  v_mfma_f32_16x16x32_bf16 v[164:167], a[180:183], a[52:55], v[164:167]
  ds_read_b64_tr_b16 a[168:169], v4 offset:20480
  v_mfma_f32_16x16x32_bf16 v[164:167], a[176:179], a[36:39], v[164:167]
  v_mfma_f32_16x16x32_bf16 v[168:171], a[176:179], a[40:43], v[168:171]
  ds_read_b64_tr_b16 a[170:171], v4 offset:22528
  v_mfma_f32_16x16x32_bf16 v[168:171], a[180:183], a[56:59], v[168:171]
  v_mfma_f32_16x16x32_bf16 v[172:175], a[180:183], a[60:63], v[172:175]
  ds_read_b64_tr_b16 a[180:181], v4 offset:24576
  buffer_load_dwordx4 a[120:123], v1, s[8:11], s72 offen offset:1024 sc1
  v_mfma_f32_16x16x32_bf16 v[172:175], a[176:179], a[44:47], v[172:175]
  s_waitcnt lgkmcnt(5)
  v_mfma_f32_16x16x32_bf16 v[188:191], a[164:167], a[44:47], v[188:191]
  ds_read_b64_tr_b16 a[182:183], v4 offset:26624
  v_mfma_f32_16x16x32_bf16 v[188:191], a[160:163], a[60:63], v[188:191]
  s_cmp_lg_u32 s44, 0
  s_cbranch_scc1 PL17_adaLN_cond__sliding_local_dilated__swiglu_ffn__prompt_kernelx
  s_waitcnt vmcnt(8)
  v_cmp_ne_u32 vcc, s46, v9
  s_nop 4
  s_cbranch_vccz PL17_adaLN_cond__sliding_local_dilated__swiglu_ffn__prompt_kernelx
  s_mov_b32 s83, 60000
PL17_adaLN_cond__sliding_local_dilated__swiglu_ffn__prompt_kernel:
  buffer_load_dword v9, v13, s[8:11], 0 offen sc1
  s_sub_u32 s83, s83, 1
  s_cmp_eq_u32 s83, 0
  s_waitcnt vmcnt(0)
  s_cbranch_scc1 PL17_adaLN_cond__sliding_local_dilated__swiglu_ffn__prompt_kernelx
  v_cmp_ne_u32 vcc, s46, v9
  s_nop 4
  s_cbranch_vccnz PL17_adaLN_cond__sliding_local_dilated__swiglu_ffn__prompt_kernel
PL17_adaLN_cond__sliding_local_dilated__swiglu_ffn__prompt_kernelx:
  s_barrier
  v_mfma_f32_16x16x32_bf16 v[184:187], a[160:163], a[56:59], v[184:187]
  ds_read_b64_tr_b16 a[176:177], v4 offset:28672
  s_mov_b32 s62, 0
  v_mfma_f32_16x16x32_bf16 v[184:187], a[164:167], a[40:43], v[184:187]
  buffer_load_dwordx4 a[220:223], v14, s[8:11], s62 offen sc1
  v_mfma_f32_16x16x32_bf16 v[180:183], a[164:167], a[36:39], v[180:183]
  ds_read_b64_tr_b16 a[178:179], v4 offset:30720
  v_mfma_f32_16x16x32_bf16 v[180:183], a[160:163], a[52:55], v[180:183]
  s_mov_b32 s62, 114688
  v_mfma_f32_16x16x32_bf16 v[176:179], a[160:163], a[48:51], v[176:179]
  ds_read_b64_tr_b16 a[160:161], v5 offset:16384
  buffer_load_dwordx4 a[224:227], v14, s[8:11], s62 offen sc1
  v_mfma_f32_16x16x32_bf16 v[176:179], a[164:167], a[32:35], v[176:179]
  s_mov_b32 s62, 229376
  s_waitcnt lgkmcnt(5)
  v_mfma_f32_16x16x32_bf16 v[192:195], a[172:175], a[32:35], v[192:195]
  ds_read_b64_tr_b16 a[162:163], v5 offset:18432
  buffer_load_dwordx4 a[228:231], v14, s[8:11], s62 offen sc1
  v_mfma_f32_16x16x32_bf16 v[192:195], a[168:171], a[48:51], v[192:195]
  v_mfma_f32_16x16x32_bf16 v[196:199], a[168:171], a[52:55], v[196:199]
  ds_read_b64_tr_b16 a[164:165], v5 offset:20480
  s_mov_b32 s62, 344064
  v_mfma_f32_16x16x32_bf16 v[196:199], a[172:175], a[36:39], v[196:199]
  buffer_load_dwordx4 a[232:235], v14, s[8:11], s62 offen sc1
  v_mfma_f32_16x16x32_bf16 v[200:203], a[172:175], a[40:43], v[200:203]
  ds_read_b64_tr_b16 a[166:167], v5 offset:22528
  s_mov_b32 s62, 458752
  v_mfma_f32_16x16x32_bf16 v[200:203], a[168:171], a[56:59], v[200:203]
  buffer_load_dwordx4 a[236:239], v14, s[8:11], s62 offen sc1
  v_mfma_f32_16x16x32_bf16 v[204:207], a[168:171], a[60:63], v[204:207]
  ds_read_b64_tr_b16 a[168:169], v5 offset:24576
  v_mfma_f32_16x16x32_bf16 v[204:207], a[172:175], a[44:47], v[204:207]
  s_mov_b32 s62, 573440
  s_waitcnt lgkmcnt(5)
  v_mfma_f32_16x16x32_bf16 v[220:223], a[180:183], a[44:47], v[220:223]
  ds_read_b64_tr_b16 a[170:171], v5 offset:26624
  buffer_load_dwordx4 a[240:243], v14, s[8:11], s62 offen sc1
  v_mfma_f32_16x16x32_bf16 v[220:223], a[176:179], a[60:63], v[220:223]
  s_mov_b32 s62, 688128
  v_mfma_f32_16x16x32_bf16 v[216:219], a[176:179], a[56:59], v[216:219]
  ds_read_b64_tr_b16 a[172:173], v5 offset:28672
  buffer_load_dwordx4 a[244:247], v14, s[8:11], s62 offen sc1
  v_mfma_f32_16x16x32_bf16 v[216:219], a[180:183], a[40:43], v[216:219]
  v_mfma_f32_16x16x32_bf16 v[212:215], a[180:183], a[36:39], v[212:215]
  ds_read_b64_tr_b16 a[174:175], v5 offset:30720
  s_mov_b32 s62, 802816
  v_mfma_f32_16x16x32_bf16 v[212:215], a[176:179], a[52:55], v[212:215]
  buffer_load_dwordx4 a[248:251], v14, s[8:11], s62 offen sc1
  s_waitcnt vmcnt(31)
  s_barrier
  v_mfma_f32_16x16x32_bf16 v[208:211], a[176:179], a[48:51], v[208:211]
  ds_read_b64_tr_b16 a[176:177], v6 offset:16384
  s_add_u32 s72, s72, 65536
  v_mfma_f32_16x16x32_bf16 v[208:211], a[180:183], a[32:35], v[208:211]
  buffer_load_dwordx4 a[108:111], v1, s[8:11], s72 offen offset:0 sc1
  s_waitcnt lgkmcnt(5)
  v_mfma_f32_16x16x32_bf16 v[224:227], a[160:163], a[32:35], v[224:227]
  ds_read_b64_tr_b16 a[178:179], v6 offset:18432
  v_mfma_f32_16x16x32_bf16 v[224:227], a[164:167], a[48:51], v[224:227]
  v_mfma_f32_16x16x32_bf16 v[228:231], a[164:167], a[52:55], v[228:231]
  ds_read_b64_tr_b16 a[180:181], v6 offset:20480
  v_mfma_f32_16x16x32_bf16 v[228:231], a[160:163], a[36:39], v[228:231]
  v_mfma_f32_16x16x32_bf16 v[232:235], a[160:163], a[40:43], v[232:235]
  ds_read_b64_tr_b16 a[182:183], v6 offset:22528
  buffer_load_dwordx4 a[124:127], v1, s[8:11], s72 offen offset:1024 sc1
  v_mfma_f32_16x16x32_bf16 v[232:235], a[164:167], a[56:59], v[232:235]
  v_mfma_f32_16x16x32_bf16 v[236:239], a[164:167], a[60:63], v[236:239]
  ds_read_b64_tr_b16 a[164:165], v6 offset:24576
  v_mfma_f32_16x16x32_bf16 v[236:239], a[160:163], a[44:47], v[236:239]
  s_waitcnt lgkmcnt(5)
  v_mfma_f32_16x16x32_bf16 v[252:255], a[168:171], a[44:47], v[252:255]
  ds_read_b64_tr_b16 a[166:167], v6 offset:26624
  s_cmp_eq_u32 s56, 1
  s_cselect_b32 s73, 13, 9
  s_mul_i32 s65, s73, 458752
  s_lshl_b32 s73, s73, 11
  s_add_u32 s73, s73, s57
  s_add_u32 m0, s45, 114688
  v_mfma_f32_16x16x32_bf16 v[252:255], a[172:175], a[60:63], v[252:255]
  buffer_load_dwordx4 v11, s[28:31], s65 offen lds
  v_mfma_f32_16x16x32_bf16 v[248:251], a[172:175], a[56:59], v[248:251]
  ds_read_b64_tr_b16 a[160:161], v6 offset:28672
  v_mfma_f32_16x16x32_bf16 v[248:251], a[168:171], a[40:43], v[248:251]
  v_mfma_f32_16x16x32_bf16 v[244:247], a[168:171], a[36:39], v[244:247]
  ds_read_b64_tr_b16 a[162:163], v6 offset:30720
  v_mfma_f32_16x16x32_bf16 v[244:247], a[172:175], a[52:55], v[244:247]
  s_add_u32 m0, s45, 122880
  v_mfma_f32_16x16x32_bf16 v[240:243], a[172:175], a[48:51], v[240:243]
  ds_read_b64_tr_b16 a[172:173], v7 offset:16384
  buffer_load_dwordx4 v11, s[32:35], s65 offen lds
  v_mfma_f32_16x16x32_bf16 v[240:243], a[168:171], a[32:35], v[240:243]
  s_waitcnt vmcnt(26) lgkmcnt(5)
  v_mfma_f32_16x16x32_bf16 v[64:67], a[176:179], a[64:67], v[64:67]
  ds_read_b64_tr_b16 a[174:175], v7 offset:18432
  v_mfma_f32_16x16x32_bf16 v[64:67], a[180:183], a[80:83], v[64:67]
  v_mfma_f32_16x16x32_bf16 v[68:71], a[180:183], a[84:87], v[68:71]
  ds_read_b64_tr_b16 a[168:169], v7 offset:20480
  s_add_u32 m0, s45, 118784
  s_add_u32 s61, s65, 229376
  v_mfma_f32_16x16x32_bf16 v[68:71], a[176:179], a[68:71], v[68:71]
  buffer_load_dwordx4 v11, s[28:31], s61 offen lds
  v_mfma_f32_16x16x32_bf16 v[72:75], a[176:179], a[72:75], v[72:75]
  ds_read_b64_tr_b16 a[170:171], v7 offset:22528
  v_mfma_f32_16x16x32_bf16 v[72:75], a[180:183], a[88:91], v[72:75]
  v_mfma_f32_16x16x32_bf16 v[76:79], a[180:183], a[92:95], v[76:79]
  ds_read_b64_tr_b16 a[180:181], v7 offset:24576
  v_mfma_f32_16x16x32_bf16 v[76:79], a[176:179], a[76:79], v[76:79]
  s_add_u32 m0, s45, 126976
  s_add_u32 s61, s65, 229376
  s_waitcnt lgkmcnt(5)
  v_mfma_f32_16x16x32_bf16 v[92:95], a[164:167], a[76:79], v[92:95]
  ds_read_b64_tr_b16 a[182:183], v7 offset:26624
  buffer_load_dwordx4 v11, s[32:35], s61 offen lds
  v_mfma_f32_16x16x32_bf16 v[92:95], a[160:163], a[92:95], v[92:95]
  v_mfma_f32_16x16x32_bf16 v[88:91], a[160:163], a[88:91], v[88:91]
  ds_read_b64_tr_b16 a[176:177], v7 offset:28672
  v_mfma_f32_16x16x32_bf16 v[88:91], a[164:167], a[72:75], v[88:91]
  v_mfma_f32_16x16x32_bf16 v[84:87], a[164:167], a[68:71], v[84:87]
  ds_read_b64_tr_b16 a[178:179], v7 offset:30720
  s_add_u32 m0, s45, 49152
  v_mfma_f32_16x16x32_bf16 v[84:87], a[160:163], a[84:87], v[84:87]
  buffer_load_dwordx4 v10, s[28:31], s65 offen lds
  v_mfma_f32_16x16x32_bf16 v[80:83], a[160:163], a[80:83], v[80:83]
  ds_read_b64_tr_b16 a[160:161], v8 offset:16384
  v_mfma_f32_16x16x32_bf16 v[80:83], a[164:167], a[64:67], v[80:83]
  s_waitcnt lgkmcnt(5)
  v_mfma_f32_16x16x32_bf16 v[96:99], a[172:175], a[64:67], v[96:99]
  ds_read_b64_tr_b16 a[162:163], v8 offset:18432
  v_mfma_f32_16x16x32_bf16 v[96:99], a[168:171], a[80:83], v[96:99]
  s_add_u32 m0, s45, 57344
  v_mfma_f32_16x16x32_bf16 v[100:103], a[168:171], a[84:87], v[100:103]
  ds_read_b64_tr_b16 a[164:165], v8 offset:20480
  buffer_load_dwordx4 v10, s[32:35], s65 offen lds
  v_mfma_f32_16x16x32_bf16 v[100:103], a[172:175], a[68:71], v[100:103]
  v_mfma_f32_16x16x32_bf16 v[104:107], a[172:175], a[72:75], v[104:107]
  ds_read_b64_tr_b16 a[166:167], v8 offset:22528
  v_mfma_f32_16x16x32_bf16 v[104:107], a[168:171], a[88:91], v[104:107]
  v_mfma_f32_16x16x32_bf16 v[108:111], a[168:171], a[92:95], v[108:111]
  ds_read_b64_tr_b16 a[168:169], v8 offset:24576
  s_add_u32 m0, s45, 53248
  s_add_u32 s61, s65, 229376
  v_mfma_f32_16x16x32_bf16 v[108:111], a[172:175], a[76:79], v[108:111]
  buffer_load_dwordx4 v10, s[28:31], s61 offen lds
  s_waitcnt lgkmcnt(5)
  v_mfma_f32_16x16x32_bf16 v[124:127], a[180:183], a[76:79], v[124:127]
  ds_read_b64_tr_b16 a[170:171], v8 offset:26624
  v_mfma_f32_16x16x32_bf16 v[124:127], a[176:179], a[92:95], v[124:127]
  v_mfma_f32_16x16x32_bf16 v[120:123], a[176:179], a[88:91], v[120:123]
  ds_read_b64_tr_b16 a[172:173], v8 offset:28672
  s_waitcnt vmcnt(9)
  v_mfma_f32_16x16x32_bf16 v[120:123], a[180:183], a[72:75], v[120:123]
  s_add_u32 m0, s45, 61440
  s_add_u32 s61, s65, 229376
  v_accvgpr_read_b32 v24, a220
  v_mfma_f32_16x16x32_bf16 v[116:119], a[180:183], a[68:71], v[116:119]
  ds_read_b64_tr_b16 a[174:175], v8 offset:30720
  buffer_load_dwordx4 v10, s[32:35], s61 offen lds
  v_mfma_f32_16x16x32_bf16 v[116:119], a[176:179], a[84:87], v[116:119]
  v_accvgpr_read_b32 v25, a221
  v_accvgpr_read_b32 v26, a222
  v_mfma_f32_16x16x32_bf16 v[112:115], a[176:179], a[80:83], v[112:115]
  ds_read_b64_tr_b16 a[176:177], v2 offset:0
  v_accvgpr_read_b32 v27, a223
  v_mfma_f32_16x16x32_bf16 v[112:115], a[180:183], a[64:67], v[112:115]
  v_accvgpr_read_b32 v28, a224
  v_accvgpr_read_b32 v29, a225
  s_waitcnt lgkmcnt(5)
  v_mfma_f32_16x16x32_bf16 v[32:35], a[160:163], a[64:67], v[32:35]
  ds_read_b64_tr_b16 a[178:179], v2 offset:2048
  v_mfma_f32_16x16x32_bf16 v[32:35], a[164:167], a[80:83], v[32:35]
  buffer_load_dwordx4 a[128:131], v1, s[8:11], s73 offen offset:0 sc1
  v_accvgpr_read_b32 v30, a226
  v_mfma_f32_16x16x32_bf16 v[36:39], a[164:167], a[84:87], v[36:39]
  ds_read_b64_tr_b16 a[180:181], v2 offset:4096
  v_accvgpr_read_b32 v31, a227
  v_mfma_f32_16x16x32_bf16 v[36:39], a[160:163], a[68:71], v[36:39]
  v_add_f32 v24, v24, v28
  v_add_f32 v25, v25, v29
  v_add_f32 v26, v26, v30
  v_mfma_f32_16x16x32_bf16 v[40:43], a[160:163], a[72:75], v[40:43]
  ds_read_b64_tr_b16 a[182:183], v2 offset:6144
  v_add_f32 v27, v27, v31
  v_mfma_f32_16x16x32_bf16 v[40:43], a[164:167], a[88:91], v[40:43]
  v_accvgpr_read_b32 v28, a228
  v_accvgpr_read_b32 v29, a229
  v_mfma_f32_16x16x32_bf16 v[44:47], a[164:167], a[92:95], v[44:47]
  ds_read_b64_tr_b16 a[164:165], v2 offset:8192
  buffer_load_dwordx4 a[144:147], v1, s[8:11], s73 offen offset:1024 sc1
  v_mfma_f32_16x16x32_bf16 v[44:47], a[160:163], a[76:79], v[44:47]
  v_accvgpr_read_b32 v30, a230
  v_accvgpr_read_b32 v31, a231
  s_waitcnt lgkmcnt(5)
  v_mfma_f32_16x16x32_bf16 v[60:63], a[168:171], a[76:79], v[60:63]
  ds_read_b64_tr_b16 a[166:167], v2 offset:10240
  v_add_f32 v24, v24, v28
  v_mfma_f32_16x16x32_bf16 v[60:63], a[172:175], a[92:95], v[60:63]
  v_add_f32 v25, v25, v29
  v_add_f32 v26, v26, v30
  v_mfma_f32_16x16x32_bf16 v[56:59], a[172:175], a[88:91], v[56:59]
  ds_read_b64_tr_b16 a[160:161], v2 offset:12288
  s_add_u32 s73, s73, 65536
  v_mfma_f32_16x16x32_bf16 v[56:59], a[168:171], a[72:75], v[56:59]
  buffer_load_dwordx4 a[132:135], v1, s[8:11], s73 offen offset:0 sc1
  v_add_f32 v27, v27, v31
  v_accvgpr_read_b32 v28, a232
  v_mfma_f32_16x16x32_bf16 v[52:55], a[168:171], a[68:71], v[52:55]
  ds_read_b64_tr_b16 a[162:163], v2 offset:14336
  v_accvgpr_read_b32 v29, a233
  v_mfma_f32_16x16x32_bf16 v[52:55], a[172:175], a[84:87], v[52:55]
  v_accvgpr_read_b32 v30, a234
  v_accvgpr_read_b32 v31, a235
  v_mfma_f32_16x16x32_bf16 v[48:51], a[172:175], a[80:83], v[48:51]
  ds_read_b64_tr_b16 a[172:173], v3 offset:0
  v_add_f32 v24, v24, v28
  v_add_f32 v25, v25, v29
  v_mfma_f32_16x16x32_bf16 v[48:51], a[168:171], a[64:67], v[48:51]
  v_add_f32 v26, v26, v30
  s_waitcnt lgkmcnt(5)
  v_mfma_f32_16x16x32_bf16 v[128:131], a[176:179], a[64:67], v[128:131]
  ds_read_b64_tr_b16 a[174:175], v3 offset:2048
  buffer_load_dwordx4 a[148:151], v1, s[8:11], s73 offen offset:1024 sc1
  v_mfma_f32_16x16x32_bf16 v[128:131], a[180:183], a[80:83], v[128:131]
  v_add_f32 v27, v27, v31
  v_accvgpr_read_b32 v28, a236
  v_mfma_f32_16x16x32_bf16 v[132:135], a[180:183], a[84:87], v[132:135]
  ds_read_b64_tr_b16 a[168:169], v3 offset:4096
  v_accvgpr_read_b32 v29, a237
  v_accvgpr_read_b32 v30, a238
  v_mfma_f32_16x16x32_bf16 v[132:135], a[176:179], a[68:71], v[132:135]
  v_accvgpr_read_b32 v31, a239
  v_add_f32 v24, v24, v28
  v_mfma_f32_16x16x32_bf16 v[136:139], a[176:179], a[72:75], v[136:139]
  ds_read_b64_tr_b16 a[170:171], v3 offset:6144
  s_add_u32 s73, s73, 65536
  v_mfma_f32_16x16x32_bf16 v[136:139], a[180:183], a[88:91], v[136:139]
  buffer_load_dwordx4 a[136:139], v1, s[8:11], s73 offen offset:0 sc1
  v_add_f32 v25, v25, v29
  v_mfma_f32_16x16x32_bf16 v[140:143], a[180:183], a[92:95], v[140:143]
  ds_read_b64_tr_b16 a[180:181], v3 offset:8192
  v_add_f32 v26, v26, v30
  v_add_f32 v27, v27, v31
  v_mfma_f32_16x16x32_bf16 v[140:143], a[176:179], a[76:79], v[140:143]
  v_accvgpr_read_b32 v28, a240
  s_waitcnt lgkmcnt(5)
  v_mfma_f32_16x16x32_bf16 v[156:159], a[164:167], a[76:79], v[156:159]
  ds_read_b64_tr_b16 a[182:183], v3 offset:10240
  v_accvgpr_read_b32 v29, a241
  v_mfma_f32_16x16x32_bf16 v[156:159], a[160:163], a[92:95], v[156:159]
  v_accvgpr_read_b32 v30, a242
  v_accvgpr_read_b32 v31, a243
  v_mfma_f32_16x16x32_bf16 v[152:155], a[160:163], a[88:91], v[152:155]
  ds_read_b64_tr_b16 a[176:177], v3 offset:12288
  buffer_load_dwordx4 a[152:155], v1, s[8:11], s73 offen offset:1024 sc1
  v_add_f32 v24, v24, v28
  v_mfma_f32_16x16x32_bf16 v[152:155], a[164:167], a[72:75], v[152:155]
  v_add_f32 v25, v25, v29
  v_add_f32 v26, v26, v30
  v_mfma_f32_16x16x32_bf16 v[148:151], a[164:167], a[68:71], v[148:151]
  ds_read_b64_tr_b16 a[178:179], v3 offset:14336
  v_add_f32 v27, v27, v31
  v_mfma_f32_16x16x32_bf16 v[148:151], a[160:163], a[84:87], v[148:151]
  v_accvgpr_read_b32 v28, a244
  v_accvgpr_read_b32 v29, a245
  v_mfma_f32_16x16x32_bf16 v[144:147], a[160:163], a[80:83], v[144:147]
  ds_read_b64_tr_b16 a[160:161], v4 offset:0
  s_add_u32 s73, s73, 65536
  v_accvgpr_read_b32 v30, a246
  v_mfma_f32_16x16x32_bf16 v[144:147], a[164:167], a[64:67], v[144:147]
  buffer_load_dwordx4 a[140:143], v1, s[8:11], s73 offen offset:0 sc1
  s_waitcnt lgkmcnt(5)
  v_mfma_f32_16x16x32_bf16 v[160:163], a[172:175], a[64:67], v[160:163]
  ds_read_b64_tr_b16 a[162:163], v4 offset:2048
  v_accvgpr_read_b32 v31, a247
  v_mfma_f32_16x16x32_bf16 v[160:163], a[168:171], a[80:83], v[160:163]
  v_add_f32 v24, v24, v28
  v_add_f32 v25, v25, v29
  v_mfma_f32_16x16x32_bf16 v[164:167], a[168:171], a[84:87], v[164:167]
  ds_read_b64_tr_b16 a[164:165], v4 offset:4096
  v_add_f32 v26, v26, v30
  v_add_f32 v27, v27, v31
  v_mfma_f32_16x16x32_bf16 v[164:167], a[172:175], a[68:71], v[164:167]
  v_accvgpr_read_b32 v28, a248
  v_accvgpr_read_b32 v29, a249
  v_mfma_f32_16x16x32_bf16 v[168:171], a[172:175], a[72:75], v[168:171]
  ds_read_b64_tr_b16 a[166:167], v4 offset:6144
  buffer_load_dwordx4 a[156:159], v1, s[8:11], s73 offen offset:1024 sc1
  v_mfma_f32_16x16x32_bf16 v[168:171], a[168:171], a[88:91], v[168:171]
  v_accvgpr_read_b32 v30, a250
  v_accvgpr_read_b32 v31, a251
  v_add_f32 v24, v24, v28
  v_mfma_f32_16x16x32_bf16 v[172:175], a[168:171], a[92:95], v[172:175]
  ds_read_b64_tr_b16 a[168:169], v4 offset:8192
  v_add_f32 v25, v25, v29
  v_mfma_f32_16x16x32_bf16 v[172:175], a[172:175], a[76:79], v[172:175]
  v_add_f32 v26, v26, v30
  s_waitcnt lgkmcnt(5)
  v_mfma_f32_16x16x32_bf16 v[188:191], a[180:183], a[76:79], v[188:191]
  ds_read_b64_tr_b16 a[170:171], v4 offset:10240
  s_cmp_eq_u32 s56, 2
  s_cselect_b32 s74, 14, 10
  s_mul_i32 s66, s74, 458752
  s_lshl_b32 s74, s74, 11
  s_add_u32 s74, s74, s57
  s_add_u32 m0, s45, 98304
  v_mfma_f32_16x16x32_bf16 v[188:191], a[176:179], a[92:95], v[188:191]
  buffer_load_dwordx4 v11, s[28:31], s66 offen lds
  v_add_f32 v27, v27, v31
  v_mov_b32 v28, v24
  v_mfma_f32_16x16x32_bf16 v[184:187], a[176:179], a[88:91], v[184:187]
  ds_read_b64_tr_b16 a[172:173], v4 offset:12288
  v_mov_b32 v29, v25
  v_mfma_f32_16x16x32_bf16 v[184:187], a[180:183], a[72:75], v[184:187]
  v_mov_b32 v30, v26
  v_mov_b32 v31, v27
  v_mfma_f32_16x16x32_bf16 v[180:183], a[180:183], a[68:71], v[180:183]
  ds_read_b64_tr_b16 a[174:175], v4 offset:14336
  v_permlane32_swap_b32 v24, v28
  v_mfma_f32_16x16x32_bf16 v[180:183], a[176:179], a[84:87], v[180:183]
  s_add_u32 m0, s45, 106496
  v_permlane32_swap_b32 v25, v29
  v_permlane32_swap_b32 v26, v30
  v_mfma_f32_16x16x32_bf16 v[176:179], a[176:179], a[80:83], v[176:179]
  ds_read_b64_tr_b16 a[176:177], v5 offset:0
  buffer_load_dwordx4 v11, s[32:35], s66 offen lds
  v_mfma_f32_16x16x32_bf16 v[176:179], a[180:183], a[64:67], v[176:179]
  v_permlane32_swap_b32 v27, v31
  s_waitcnt lgkmcnt(5)
  v_mfma_f32_16x16x32_bf16 v[192:195], a[160:163], a[64:67], v[192:195]
  ds_read_b64_tr_b16 a[178:179], v5 offset:2048
  v_lshrrev_b32 v13, 8, v1
  v_lshlrev_b32 v13, 28, v13
  v_mfma_f32_16x16x32_bf16 v[192:195], a[164:167], a[80:83], v[192:195]
  v_lshl_add_u32 v13, v1, 3, v13
  v_xor_b32 v9, 96, v6
  v_mfma_f32_16x16x32_bf16 v[196:199], a[164:167], a[84:87], v[196:199]
  ds_read_b64_tr_b16 a[180:181], v5 offset:4096
  s_add_u32 m0, s45, 102400
  s_add_u32 s61, s66, 229376
  v_mfma_f32_16x16x32_bf16 v[196:199], a[160:163], a[68:71], v[196:199]
  buffer_load_dwordx4 v11, s[28:31], s61 offen lds
  v_mfma_f32_16x16x32_bf16 v[200:203], a[160:163], a[72:75], v[200:203]
  ds_read_b64_tr_b16 a[182:183], v5 offset:6144
  v_add_f32 v24, v24, v28
  v_mfma_f32_16x16x32_bf16 v[200:203], a[164:167], a[88:91], v[200:203]
  v_add_f32 v25, v25, v29
  v_add_f32 v26, v26, v30
  v_add_f32 v27, v27, v31
  v_mfma_f32_16x16x32_bf16 v[204:207], a[164:167], a[92:95], v[204:207]
  ds_read_b64_tr_b16 a[164:165], v5 offset:8192
  ds_write_b128 v15, v[24:27]
  v_mfma_f32_16x16x32_bf16 v[204:207], a[160:163], a[76:79], v[204:207]
  s_add_u32 m0, s45, 110592
  s_add_u32 s61, s66, 229376
  s_waitcnt lgkmcnt(6)
  v_mfma_f32_16x16x32_bf16 v[220:223], a[168:171], a[76:79], v[220:223]
  ds_read_b64_tr_b16 a[166:167], v5 offset:10240
  buffer_load_dwordx4 v11, s[32:35], s61 offen lds
  s_waitcnt lgkmcnt(1)
  s_barrier
  v_mfma_f32_16x16x32_bf16 v[220:223], a[172:175], a[92:95], v[220:223]
  ds_read_b128 v[24:27], v12 offset:384
  ds_read_b128 v[28:31], v12 offset:896
  v_mfma_f32_16x16x32_bf16 v[216:219], a[172:175], a[88:91], v[216:219]
  ds_read_b64_tr_b16 a[160:161], v5 offset:12288
  v_mfma_f32_16x16x32_bf16 v[216:219], a[168:171], a[72:75], v[216:219]
  v_mfma_f32_16x16x32_bf16 v[212:215], a[168:171], a[68:71], v[212:215]
  ds_read_b64_tr_b16 a[162:163], v5 offset:14336
  s_add_u32 m0, s45, 16384
  v_mfma_f32_16x16x32_bf16 v[212:215], a[172:175], a[84:87], v[212:215]
  buffer_load_dwordx4 v10, s[28:31], s66 offen lds
  s_waitcnt vmcnt(37)
  s_barrier
  v_mfma_f32_16x16x32_bf16 v[208:211], a[172:175], a[80:83], v[208:211]
  ds_read_b64_tr_b16 a[172:173], v6 offset:0
  v_mfma_f32_16x16x32_bf16 v[208:211], a[168:171], a[64:67], v[208:211]
  s_waitcnt lgkmcnt(8)
  v_mfma_f32_16x16x32_bf16 v[224:227], a[176:179], a[64:67], v[224:227]
  ds_read_b64_tr_b16 a[174:175], v6 offset:2048
  v_mfma_f32_16x16x32_bf16 v[224:227], a[180:183], a[80:83], v[224:227]
  s_add_u32 m0, s45, 24576
  s_waitcnt lgkmcnt(5)
  v_mfma_f32_16x16x32_bf16 v[228:231], a[180:183], a[84:87], v[228:231]
  ds_read_b64_tr_b16 a[168:169], v6 offset:4096
  buffer_load_dwordx4 v10, s[32:35], s66 offen lds
  v_mfma_f32_16x16x32_bf16 v[228:231], a[176:179], a[68:71], v[228:231]
  v_fmac_f32 v32, v16, v24
  v_fmac_f32 v33, v16, v25
  v_mfma_f32_16x16x32_bf16 v[232:235], a[176:179], a[72:75], v[232:235]
  ds_read_b64_tr_b16 a[170:171], v6 offset:6144
  v_fmac_f32 v34, v16, v26
  v_mfma_f32_16x16x32_bf16 v[232:235], a[180:183], a[88:91], v[232:235]
  v_fmac_f32 v35, v16, v27
  v_fmac_f32 v36, v18, v24
  v_mfma_f32_16x16x32_bf16 v[236:239], a[180:183], a[92:95], v[236:239]
  ds_read_b64_tr_b16 a[180:181], v6 offset:8192
  s_add_u32 m0, s45, 20480
  s_add_u32 s61, s66, 229376
  v_mfma_f32_16x16x32_bf16 v[236:239], a[176:179], a[76:79], v[236:239]
  buffer_load_dwordx4 v10, s[28:31], s61 offen lds
  s_waitcnt lgkmcnt(5)
  v_mfma_f32_16x16x32_bf16 v[252:255], a[164:167], a[76:79], v[252:255]
  ds_read_b64_tr_b16 a[182:183], v6 offset:10240
  v_fmac_f32 v37, v18, v25
  v_mfma_f32_16x16x32_bf16 v[252:255], a[160:163], a[92:95], v[252:255]
  v_fmac_f32 v38, v18, v26
  v_fmac_f32 v39, v18, v27
  v_mfma_f32_16x16x32_bf16 v[248:251], a[160:163], a[88:91], v[248:251]
  ds_read_b64_tr_b16 a[176:177], v6 offset:12288
  v_fmac_f32 v40, v20, v24
  v_mfma_f32_16x16x32_bf16 v[248:251], a[164:167], a[72:75], v[248:251]
  s_add_u32 m0, s45, 28672
  s_add_u32 s61, s66, 229376
  v_mfma_f32_16x16x32_bf16 v[244:247], a[164:167], a[68:71], v[244:247]
  ds_read_b64_tr_b16 a[178:179], v6 offset:14336
  buffer_load_dwordx4 v10, s[32:35], s61 offen lds
  v_mfma_f32_16x16x32_bf16 v[244:247], a[160:163], a[84:87], v[244:247]
  v_fmac_f32 v41, v20, v25
  v_fmac_f32 v42, v20, v26
  v_mfma_f32_16x16x32_bf16 v[240:243], a[160:163], a[80:83], v[240:243]
  ds_read_b64_tr_b16 a[160:161], v7 offset:0
  v_fmac_f32 v43, v20, v27
  v_mfma_f32_16x16x32_bf16 v[240:243], a[164:167], a[64:67], v[240:243]
  v_fmac_f32 v44, v22, v24
  s_waitcnt vmcnt(24) lgkmcnt(5)
  v_mfma_f32_16x16x32_bf16 v[64:67], a[172:175], a[96:99], v[64:67]
  ds_read_b64_tr_b16 a[162:163], v7 offset:2048
  v_mfma_f32_16x16x32_bf16 v[64:67], a[168:171], a[112:115], v[64:67]
  buffer_load_dwordx4 a[0:3], v1, s[8:11], s74 offen offset:0 sc1
  v_fmac_f32 v45, v22, v25
  v_mfma_f32_16x16x32_bf16 v[68:71], a[168:171], a[116:119], v[68:71]
  ds_read_b64_tr_b16 a[164:165], v7 offset:4096
  v_fmac_f32 v46, v22, v26
  v_mfma_f32_16x16x32_bf16 v[68:71], a[172:175], a[100:103], v[68:71]
  v_fmac_f32 v47, v22, v27
  ds_read_b128 v[24:27], v12 offset:256
  v_mfma_f32_16x16x32_bf16 v[72:75], a[172:175], a[104:107], v[72:75]
  ds_read_b64_tr_b16 a[166:167], v7 offset:6144
  s_waitcnt lgkmcnt(15)
  v_mfma_f32_16x16x32_bf16 v[72:75], a[168:171], a[120:123], v[72:75]
  v_fmac_f32 v32, v17, v28
  v_fmac_f32 v33, v17, v29
  v_mfma_f32_16x16x32_bf16 v[76:79], a[168:171], a[124:127], v[76:79]
  ds_read_b64_tr_b16 a[168:169], v7 offset:8192
  buffer_load_dwordx4 a[16:19], v1, s[8:11], s74 offen offset:1024 sc1
  v_mfma_f32_16x16x32_bf16 v[76:79], a[172:175], a[108:111], v[76:79]
  v_fmac_f32 v34, v17, v30
  s_waitcnt lgkmcnt(6)
  v_mfma_f32_16x16x32_bf16 v[92:95], a[180:183], a[108:111], v[92:95]
  ds_read_b64_tr_b16 a[170:171], v7 offset:10240
  v_fmac_f32 v35, v17, v31
  v_mfma_f32_16x16x32_bf16 v[92:95], a[176:179], a[124:127], v[92:95]
  v_fmac_f32 v36, v19, v28
  v_fmac_f32 v37, v19, v29
  v_mfma_f32_16x16x32_bf16 v[88:91], a[176:179], a[120:123], v[88:91]
  ds_read_b64_tr_b16 a[172:173], v7 offset:12288
  s_add_u32 s74, s74, 65536
  v_mfma_f32_16x16x32_bf16 v[88:91], a[180:183], a[104:107], v[88:91]
  buffer_load_dwordx4 a[4:7], v1, s[8:11], s74 offen offset:0 sc1
  v_fmac_f32 v38, v19, v30
  v_mfma_f32_16x16x32_bf16 v[84:87], a[180:183], a[100:103], v[84:87]
  ds_read_b64_tr_b16 a[174:175], v7 offset:14336
  v_fmac_f32 v39, v19, v31
  v_mfma_f32_16x16x32_bf16 v[84:87], a[176:179], a[116:119], v[84:87]
  v_fmac_f32 v40, v21, v28
  v_fmac_f32 v41, v21, v29
  v_mfma_f32_16x16x32_bf16 v[80:83], a[176:179], a[112:115], v[80:83]
  ds_read_b64_tr_b16 a[176:177], v8 offset:0
  v_fmac_f32 v42, v21, v30
  v_mfma_f32_16x16x32_bf16 v[80:83], a[180:183], a[96:99], v[80:83]
  v_fmac_f32 v43, v21, v31
  s_waitcnt lgkmcnt(5)
  v_mfma_f32_16x16x32_bf16 v[96:99], a[160:163], a[96:99], v[96:99]
  ds_read_b64_tr_b16 a[178:179], v8 offset:2048
  buffer_load_dwordx4 a[20:23], v1, s[8:11], s74 offen offset:1024 sc1
  v_mfma_f32_16x16x32_bf16 v[96:99], a[164:167], a[112:115], v[96:99]
  v_fmac_f32 v44, v23, v28
  v_fmac_f32 v45, v23, v29
  v_mfma_f32_16x16x32_bf16 v[100:103], a[164:167], a[116:119], v[100:103]
  ds_read_b64_tr_b16 a[180:181], v8 offset:4096
  v_fmac_f32 v46, v23, v30
  v_mfma_f32_16x16x32_bf16 v[100:103], a[160:163], a[100:103], v[100:103]
  v_fmac_f32 v47, v23, v31
  ds_read_b128 v[28:31], v12 offset:768
  v_mfma_f32_16x16x32_bf16 v[104:107], a[160:163], a[104:107], v[104:107]
  ds_read_b64_tr_b16 a[182:183], v8 offset:6144
  s_add_u32 s74, s74, 65536
  v_mfma_f32_16x16x32_bf16 v[104:107], a[164:167], a[120:123], v[104:107]
  buffer_load_dwordx4 a[8:11], v1, s[8:11], s74 offen offset:0 sc1
  s_waitcnt lgkmcnt(10)
  v_mfma_f32_16x16x32_bf16 v[108:111], a[164:167], a[124:127], v[108:111]
  ds_read_b64_tr_b16 a[164:165], v8 offset:8192
  v_fmac_f32 v64, v16, v24
  v_mfma_f32_16x16x32_bf16 v[108:111], a[160:163], a[108:111], v[108:111]
  v_fmac_f32 v65, v16, v25
  s_waitcnt lgkmcnt(6)
  v_mfma_f32_16x16x32_bf16 v[124:127], a[168:171], a[108:111], v[124:127]
  ds_read_b64_tr_b16 a[166:167], v8 offset:10240
  v_fmac_f32 v66, v16, v26
  v_mfma_f32_16x16x32_bf16 v[124:127], a[172:175], a[124:127], v[124:127]
  v_fmac_f32 v67, v16, v27
  v_fmac_f32 v68, v18, v24
  v_mfma_f32_16x16x32_bf16 v[120:123], a[172:175], a[120:123], v[120:123]
  ds_read_b64_tr_b16 a[160:161], v8 offset:12288
  buffer_load_dwordx4 a[24:27], v1, s[8:11], s74 offen offset:1024 sc1
  v_mfma_f32_16x16x32_bf16 v[120:123], a[168:171], a[104:107], v[120:123]
  v_fmac_f32 v69, v18, v25
  v_fmac_f32 v70, v18, v26
  v_mfma_f32_16x16x32_bf16 v[116:119], a[168:171], a[100:103], v[116:119]
  ds_read_b64_tr_b16 a[162:163], v8 offset:14336
  v_fmac_f32 v71, v18, v27
  v_mfma_f32_16x16x32_bf16 v[116:119], a[172:175], a[116:119], v[116:119]
  v_fmac_f32 v72, v20, v24
  v_fmac_f32 v73, v20, v25
  v_mfma_f32_16x16x32_bf16 v[112:115], a[172:175], a[112:115], v[112:115]
  ds_read_b64_tr_b16 a[172:173], v2 offset:32768
  s_add_u32 s74, s74, 65536
  v_mfma_f32_16x16x32_bf16 v[112:115], a[168:171], a[96:99], v[112:115]
  buffer_load_dwordx4 a[12:15], v1, s[8:11], s74 offen offset:0 sc1
  s_waitcnt lgkmcnt(5)
  v_mfma_f32_16x16x32_bf16 v[32:35], a[176:179], a[96:99], v[32:35]
  ds_read_b64_tr_b16 a[174:175], v2 offset:34816
  v_fmac_f32 v74, v20, v26
  v_mfma_f32_16x16x32_bf16 v[32:35], a[180:183], a[112:115], v[32:35]
  v_fmac_f32 v75, v20, v27
  v_fmac_f32 v76, v22, v24
  v_mfma_f32_16x16x32_bf16 v[36:39], a[180:183], a[116:119], v[36:39]
  ds_read_b64_tr_b16 a[168:169], v2 offset:36864
  v_fmac_f32 v77, v22, v25
  v_mfma_f32_16x16x32_bf16 v[36:39], a[176:179], a[100:103], v[36:39]
  v_fmac_f32 v78, v22, v26
  v_fmac_f32 v79, v22, v27
HOP11:
  s_cbranch_execz HOP14
  v_mfma_f32_16x16x32_bf16 v[40:43], a[176:179], a[104:107], v[40:43]
  ds_read_b64_tr_b16 a[170:171], v2 offset:38912
  buffer_load_dwordx4 a[28:31], v1, s[8:11], s74 offen offset:1024 sc1
  v_mfma_f32_16x16x32_bf16 v[40:43], a[180:183], a[120:123], v[40:43]
  ds_read_b128 v[24:27], v12 offset:1408
  s_waitcnt lgkmcnt(10)
  v_mfma_f32_16x16x32_bf16 v[44:47], a[180:183], a[124:127], v[44:47]
  ds_read_b64_tr_b16 a[180:181], v2 offset:40960
  v_fmac_f32 v64, v17, v28
  v_mfma_f32_16x16x32_bf16 v[44:47], a[176:179], a[108:111], v[44:47]
  v_fmac_f32 v65, v17, v29
  s_waitcnt lgkmcnt(6)
  v_mfma_f32_16x16x32_bf16 v[60:63], a[164:167], a[108:111], v[60:63]
  ds_read_b64_tr_b16 a[182:183], v2 offset:43008
  s_cmp_eq_u32 s56, 3
  s_cselect_b32 s75, 15, 11
  s_mul_i32 s67, s75, 458752
  s_lshl_b32 s75, s75, 11
  s_add_u32 s75, s75, s57
  s_add_u32 m0, s45, 81920
  v_mfma_f32_16x16x32_bf16 v[60:63], a[160:163], a[124:127], v[60:63]
  buffer_load_dwordx4 v11, s[28:31], s67 offen lds
  v_fmac_f32 v66, v17, v30
  v_mfma_f32_16x16x32_bf16 v[56:59], a[160:163], a[120:123], v[56:59]
  ds_read_b64_tr_b16 a[176:177], v2 offset:45056
  v_fmac_f32 v67, v17, v31
  v_mfma_f32_16x16x32_bf16 v[56:59], a[164:167], a[104:107], v[56:59]
  v_fmac_f32 v68, v19, v28
  v_fmac_f32 v69, v19, v29
  v_mfma_f32_16x16x32_bf16 v[52:55], a[164:167], a[100:103], v[52:55]
  ds_read_b64_tr_b16 a[178:179], v2 offset:47104
  v_fmac_f32 v70, v19, v30
  v_mfma_f32_16x16x32_bf16 v[52:55], a[160:163], a[116:119], v[52:55]
  s_add_u32 m0, s45, 90112
  v_fmac_f32 v71, v19, v31
  v_mfma_f32_16x16x32_bf16 v[48:51], a[160:163], a[112:115], v[48:51]
  ds_read_b64_tr_b16 a[160:161], v3 offset:32768
  buffer_load_dwordx4 v11, s[32:35], s67 offen lds
  v_mfma_f32_16x16x32_bf16 v[48:51], a[164:167], a[96:99], v[48:51]
  v_fmac_f32 v72, v21, v28
  s_waitcnt lgkmcnt(6)
  v_mfma_f32_16x16x32_bf16 v[128:131], a[172:175], a[96:99], v[128:131]
  ds_read_b64_tr_b16 a[162:163], v3 offset:34816
  v_fmac_f32 v73, v21, v29
  v_mfma_f32_16x16x32_bf16 v[128:131], a[168:171], a[112:115], v[128:131]
  v_fmac_f32 v74, v21, v30
  v_fmac_f32 v75, v21, v31
  v_mfma_f32_16x16x32_bf16 v[132:135], a[168:171], a[116:119], v[132:135]
  ds_read_b64_tr_b16 a[164:165], v3 offset:36864
  s_add_u32 m0, s45, 86016
  s_add_u32 s61, s67, 229376
  v_mfma_f32_16x16x32_bf16 v[132:135], a[172:175], a[100:103], v[132:135]
  buffer_load_dwordx4 v11, s[28:31], s61 offen lds
  v_fmac_f32 v76, v23, v28
  v_mfma_f32_16x16x32_bf16 v[136:139], a[172:175], a[104:107], v[136:139]
  ds_read_b64_tr_b16 a[166:167], v3 offset:38912
  v_fmac_f32 v77, v23, v29
  v_mfma_f32_16x16x32_bf16 v[136:139], a[168:171], a[120:123], v[136:139]
  v_fmac_f32 v78, v23, v30
  v_fmac_f32 v79, v23, v31
  v_mfma_f32_16x16x32_bf16 v[140:143], a[168:171], a[124:127], v[140:143]
  ds_read_b64_tr_b16 a[168:169], v3 offset:40960
  ds_read_b128 v[28:31], v12 offset:1920
  v_mfma_f32_16x16x32_bf16 v[140:143], a[172:175], a[108:111], v[140:143]
  s_add_u32 m0, s45, 94208
  s_add_u32 s61, s67, 229376
  s_waitcnt lgkmcnt(6)
  v_mfma_f32_16x16x32_bf16 v[156:159], a[180:183], a[108:111], v[156:159]
  ds_read_b64_tr_b16 a[170:171], v3 offset:43008
  buffer_load_dwordx4 v11, s[32:35], s61 offen lds
  v_mfma_f32_16x16x32_bf16 v[156:159], a[176:179], a[124:127], v[156:159]
  s_waitcnt lgkmcnt(11)
  v_fmac_f32 v48, v16, v24
  v_mfma_f32_16x16x32_bf16 v[152:155], a[176:179], a[120:123], v[152:155]
  ds_read_b64_tr_b16 a[172:173], v3 offset:45056
  v_fmac_f32 v49, v16, v25
  v_mfma_f32_16x16x32_bf16 v[152:155], a[180:183], a[104:107], v[152:155]
  v_fmac_f32 v50, v16, v26
  v_fmac_f32 v51, v16, v27
  v_mfma_f32_16x16x32_bf16 v[148:151], a[180:183], a[100:103], v[148:151]
  ds_read_b64_tr_b16 a[174:175], v3 offset:47104
  v_mfma_f32_16x16x32_bf16 v[148:151], a[176:179], a[116:119], v[148:151]
  buffer_load_dwordx4 a[32:35], v1, s[8:11], s75 offen offset:0 sc1
  v_fmac_f32 v52, v18, v24
  v_mfma_f32_16x16x32_bf16 v[144:147], a[176:179], a[112:115], v[144:147]
  ds_read_b64_tr_b16 a[176:177], v4 offset:32768
  v_fmac_f32 v53, v18, v25
  v_mfma_f32_16x16x32_bf16 v[144:147], a[180:183], a[96:99], v[144:147]
  v_fmac_f32 v54, v18, v26
  s_waitcnt lgkmcnt(6)
  v_mfma_f32_16x16x32_bf16 v[160:163], a[160:163], a[96:99], v[160:163]
  ds_read_b64_tr_b16 a[178:179], v4 offset:34816
  v_fmac_f32 v55, v18, v27
  v_mfma_f32_16x16x32_bf16 v[160:163], a[164:167], a[112:115], v[160:163]
  v_fmac_f32 v56, v20, v24
  v_fmac_f32 v57, v20, v25
  v_mfma_f32_16x16x32_bf16 v[164:167], a[164:167], a[116:119], v[164:167]
  ds_read_b64_tr_b16 a[180:181], v4 offset:36864
  buffer_load_dwordx4 a[48:51], v1, s[8:11], s75 offen offset:1024 sc1
  v_mfma_f32_16x16x32_bf16 v[164:167], a[160:163], a[100:103], v[164:167]
  v_fmac_f32 v58, v20, v26
  v_fmac_f32 v59, v20, v27
  v_mfma_f32_16x16x32_bf16 v[168:171], a[160:163], a[104:107], v[168:171]
  ds_read_b64_tr_b16 a[182:183], v4 offset:38912
  v_fmac_f32 v60, v22, v24
  v_mfma_f32_16x16x32_bf16 v[168:171], a[164:167], a[120:123], v[168:171]
  v_fmac_f32 v61, v22, v25
  v_fmac_f32 v62, v22, v26
  v_mfma_f32_16x16x32_bf16 v[172:175], a[164:167], a[124:127], v[172:175]
  ds_read_b64_tr_b16 a[164:165], v4 offset:40960
  s_add_u32 s75, s75, 65536
  v_mfma_f32_16x16x32_bf16 v[172:175], a[160:163], a[108:111], v[172:175]
  buffer_load_dwordx4 a[36:39], v1, s[8:11], s75 offen offset:0 sc1
  s_waitcnt lgkmcnt(5)
  v_mfma_f32_16x16x32_bf16 v[188:191], a[168:171], a[108:111], v[188:191]
  ds_read_b64_tr_b16 a[166:167], v4 offset:43008
  v_fmac_f32 v63, v22, v27
  v_mfma_f32_16x16x32_bf16 v[188:191], a[172:175], a[124:127], v[188:191]
  ds_read_b128 v[24:27], v12 offset:1280
  s_waitcnt lgkmcnt(10)
  v_mfma_f32_16x16x32_bf16 v[184:187], a[172:175], a[120:123], v[184:187]
  ds_read_b64_tr_b16 a[160:161], v4 offset:45056
  v_fmac_f32 v48, v17, v28
  v_mfma_f32_16x16x32_bf16 v[184:187], a[168:171], a[104:107], v[184:187]
  v_fmac_f32 v49, v17, v29
  v_fmac_f32 v50, v17, v30
  v_mfma_f32_16x16x32_bf16 v[180:183], a[168:171], a[100:103], v[180:183]
  ds_read_b64_tr_b16 a[162:163], v4 offset:47104
  buffer_load_dwordx4 a[52:55], v1, s[8:11], s75 offen offset:1024 sc1
  v_mfma_f32_16x16x32_bf16 v[180:183], a[172:175], a[116:119], v[180:183]
  v_fmac_f32 v51, v17, v31
  v_fmac_f32 v52, v19, v28
  v_mfma_f32_16x16x32_bf16 v[176:179], a[172:175], a[112:115], v[176:179]
  ds_read_b64_tr_b16 a[172:173], v5 offset:32768
  v_fmac_f32 v53, v19, v29
  v_mfma_f32_16x16x32_bf16 v[176:179], a[168:171], a[96:99], v[176:179]
  v_fmac_f32 v54, v19, v30
  s_waitcnt lgkmcnt(6)
  v_mfma_f32_16x16x32_bf16 v[192:195], a[176:179], a[96:99], v[192:195]
  ds_read_b64_tr_b16 a[174:175], v5 offset:34816
  s_add_u32 s75, s75, 65536
  v_mfma_f32_16x16x32_bf16 v[192:195], a[180:183], a[112:115], v[192:195]
  buffer_load_dwordx4 a[40:43], v1, s[8:11], s75 offen offset:0 sc1
  v_fmac_f32 v55, v19, v31
  v_mfma_f32_16x16x32_bf16 v[196:199], a[180:183], a[116:119], v[196:199]
  ds_read_b64_tr_b16 a[168:169], v5 offset:36864
  v_fmac_f32 v56, v21, v28
  v_mfma_f32_16x16x32_bf16 v[196:199], a[176:179], a[100:103], v[196:199]
  v_fmac_f32 v57, v21, v29
  v_fmac_f32 v58, v21, v30
  v_mfma_f32_16x16x32_bf16 v[200:203], a[176:179], a[104:107], v[200:203]
  ds_read_b64_tr_b16 a[170:171], v5 offset:38912
  v_fmac_f32 v59, v21, v31
  v_mfma_f32_16x16x32_bf16 v[200:203], a[180:183], a[120:123], v[200:203]
  v_fmac_f32 v60, v23, v28
  v_fmac_f32 v61, v23, v29
  v_mfma_f32_16x16x32_bf16 v[204:207], a[180:183], a[124:127], v[204:207]
  ds_read_b64_tr_b16 a[180:181], v5 offset:40960
  buffer_load_dwordx4 a[56:59], v1, s[8:11], s75 offen offset:1024 sc1
  v_mfma_f32_16x16x32_bf16 v[204:207], a[176:179], a[108:111], v[204:207]
  v_fmac_f32 v62, v23, v30
  s_waitcnt lgkmcnt(5)
  v_mfma_f32_16x16x32_bf16 v[220:223], a[164:167], a[108:111], v[220:223]
  ds_read_b64_tr_b16 a[182:183], v5 offset:43008
  v_fmac_f32 v63, v23, v31
  v_mfma_f32_16x16x32_bf16 v[220:223], a[160:163], a[124:127], v[220:223]
  ds_read_b128 v[28:31], v12 offset:1792
  v_mfma_f32_16x16x32_bf16 v[216:219], a[160:163], a[120:123], v[216:219]
  ds_read_b64_tr_b16 a[176:177], v5 offset:45056
  s_add_u32 s75, s75, 65536
  v_mfma_f32_16x16x32_bf16 v[216:219], a[164:167], a[104:107], v[216:219]
  buffer_load_dwordx4 a[44:47], v1, s[8:11], s75 offen offset:0 sc1
  s_waitcnt lgkmcnt(10)
  v_mfma_f32_16x16x32_bf16 v[212:215], a[164:167], a[100:103], v[212:215]
  ds_read_b64_tr_b16 a[178:179], v5 offset:47104
  v_fmac_f32 v80, v16, v24
  v_mfma_f32_16x16x32_bf16 v[212:215], a[160:163], a[116:119], v[212:215]
  s_waitcnt vmcnt(35)
  s_barrier
  v_mfma_f32_16x16x32_bf16 v[208:211], a[160:163], a[112:115], v[208:211]
  ds_read_b64_tr_b16 a[160:161], v6 offset:49152
  v_fmac_f32 v81, v16, v25
  v_mfma_f32_16x16x32_bf16 v[208:211], a[164:167], a[96:99], v[208:211]
  s_cmp_eq_u32 s56, 0
  s_cselect_b32 s76, 4, 12
  s_mul_i32 s68, s76, 458752
  s_lshl_b32 s76, s76, 11
  s_add_u32 s76, s76, s57
  s_add_u32 m0, s45, 65536
  s_waitcnt lgkmcnt(6)
  v_mfma_f32_16x16x32_bf16 v[224:227], a[172:175], a[96:99], v[224:227]
  ds_read_b64_tr_b16 a[162:163], v6 offset:51200
  buffer_load_dwordx4 v11, s[28:31], s68 offen lds
  v_mfma_f32_16x16x32_bf16 v[224:227], a[168:171], a[112:115], v[224:227]
  v_fmac_f32 v82, v16, v26
  v_fmac_f32 v83, v16, v27
  v_mfma_f32_16x16x32_bf16 v[228:231], a[168:171], a[116:119], v[228:231]
  ds_read_b64_tr_b16 a[164:165], v6 offset:53248
  v_fmac_f32 v84, v18, v24
  v_mfma_f32_16x16x32_bf16 v[228:231], a[172:175], a[100:103], v[228:231]
  v_fmac_f32 v85, v18, v25
  v_fmac_f32 v86, v18, v26
  v_mfma_f32_16x16x32_bf16 v[232:235], a[172:175], a[104:107], v[232:235]
  ds_read_b64_tr_b16 a[166:167], v6 offset:55296
  s_add_u32 m0, s45, 73728
  v_mfma_f32_16x16x32_bf16 v[232:235], a[168:171], a[120:123], v[232:235]
  buffer_load_dwordx4 v11, s[32:35], s68 offen lds
  v_fmac_f32 v87, v18, v27
  v_mfma_f32_16x16x32_bf16 v[236:239], a[168:171], a[124:127], v[236:239]
  ds_read_b64_tr_b16 a[168:169], v6 offset:57344
  v_fmac_f32 v88, v20, v24
  v_mfma_f32_16x16x32_bf16 v[236:239], a[172:175], a[108:111], v[236:239]
  v_fmac_f32 v89, v20, v25
  s_waitcnt lgkmcnt(5)
  v_mfma_f32_16x16x32_bf16 v[252:255], a[180:183], a[108:111], v[252:255]
  ds_read_b64_tr_b16 a[170:171], v6 offset:59392
  v_fmac_f32 v90, v20, v26
  v_mfma_f32_16x16x32_bf16 v[252:255], a[176:179], a[124:127], v[252:255]
  s_add_u32 m0, s45, 69632
  s_add_u32 s61, s68, 229376
  v_mfma_f32_16x16x32_bf16 v[248:251], a[176:179], a[120:123], v[248:251]
  ds_read_b64_tr_b16 a[172:173], v6 offset:61440
  buffer_load_dwordx4 v11, s[28:31], s61 offen lds
  v_mfma_f32_16x16x32_bf16 v[248:251], a[180:183], a[104:107], v[248:251]
  v_fmac_f32 v91, v20, v27
  v_fmac_f32 v92, v22, v24
  v_mfma_f32_16x16x32_bf16 v[244:247], a[180:183], a[100:103], v[244:247]
  ds_read_b64_tr_b16 a[174:175], v6 offset:63488
  v_fmac_f32 v93, v22, v25
  v_mfma_f32_16x16x32_bf16 v[244:247], a[176:179], a[116:119], v[244:247]
  v_fmac_f32 v94, v22, v26
  v_fmac_f32 v95, v22, v27
  v_mfma_f32_16x16x32_bf16 v[240:243], a[176:179], a[112:115], v[240:243]
  ds_read_b64_tr_b16 a[176:177], v7 offset:49152
  s_add_u32 m0, s45, 77824
  s_add_u32 s61, s68, 229376
  v_mfma_f32_16x16x32_bf16 v[240:243], a[180:183], a[96:99], v[240:243]
  buffer_load_dwordx4 v11, s[32:35], s61 offen lds
  s_waitcnt vmcnt(31) lgkmcnt(5)
  v_mfma_f32_16x16x32_bf16 v[64:67], a[160:163], a[128:131], v[64:67]
  ds_read_b64_tr_b16 a[178:179], v7 offset:51200
  ds_read_b128 v[24:27], v12 offset:0
  v_mfma_f32_16x16x32_bf16 v[64:67], a[164:167], a[144:147], v[64:67]
  s_waitcnt lgkmcnt(13)
  v_fmac_f32 v80, v17, v28
  v_mfma_f32_16x16x32_bf16 v[68:71], a[164:167], a[148:151], v[68:71]
  ds_read_b64_tr_b16 a[180:181], v7 offset:53248
  v_fmac_f32 v81, v17, v29
  v_mfma_f32_16x16x32_bf16 v[68:71], a[160:163], a[132:135], v[68:71]
  v_fmac_f32 v82, v17, v30
  v_fmac_f32 v83, v17, v31
  v_mfma_f32_16x16x32_bf16 v[72:75], a[160:163], a[136:139], v[72:75]
  ds_read_b64_tr_b16 a[182:183], v7 offset:55296
  buffer_load_dwordx4 a[60:63], v1, s[8:11], s75 offen offset:1024 sc1
  v_mfma_f32_16x16x32_bf16 v[72:75], a[164:167], a[152:155], v[72:75]
  v_fmac_f32 v84, v19, v28
  v_fmac_f32 v85, v19, v29
  v_mfma_f32_16x16x32_bf16 v[76:79], a[164:167], a[156:159], v[76:79]
  ds_read_b64_tr_b16 a[164:165], v7 offset:57344
  v_fmac_f32 v86, v19, v30
  v_mfma_f32_16x16x32_bf16 v[76:79], a[160:163], a[140:143], v[76:79]
  v_fmac_f32 v87, v19, v31
  s_waitcnt lgkmcnt(6)
  v_mfma_f32_16x16x32_bf16 v[92:95], a[168:171], a[140:143], v[92:95]
  ds_read_b64_tr_b16 a[166:167], v7 offset:59392
  v_mfma_f32_16x16x32_bf16 v[92:95], a[172:175], a[156:159], v[92:95]
  buffer_load_dwordx4 a[64:67], v1, s[8:11], s76 offen offset:0 sc1
  v_fmac_f32 v88, v21, v28
  s_nop 1
  v_mfma_f32_16x16x32_bf16 v[88:91], a[172:175], a[152:155], v[88:91]
  ds_read_b64_tr_b16 a[160:161], v7 offset:61440
  s_nop 6
  v_fmac_f32 v89, v21, v29
  s_nop 1
  v_mfma_f32_16x16x32_bf16 v[88:91], a[168:171], a[136:139], v[88:91]
  s_nop 7
  v_fmac_f32 v90, v21, v30
  v_fmac_f32 v91, v21, v31
  v_mfma_f32_16x16x32_bf16 v[84:87], a[168:171], a[132:135], v[84:87]
  ds_read_b64_tr_b16 a[162:163], v7 offset:63488
  v_fmac_f32 v92, v23, v28
  v_mfma_f32_16x16x32_bf16 v[84:87], a[172:175], a[148:151], v[84:87]
  v_fmac_f32 v93, v23, v29
  v_fmac_f32 v94, v23, v30
  v_mfma_f32_16x16x32_bf16 v[80:83], a[172:175], a[144:147], v[80:83]
  ds_read_b64_tr_b16 a[172:173], v8 offset:49152
  buffer_load_dwordx4 a[80:83], v1, s[8:11], s76 offen offset:1024 sc1
  v_mfma_f32_16x16x32_bf16 v[80:83], a[168:171], a[128:131], v[80:83]
  v_fmac_f32 v95, v23, v31
  s_waitcnt lgkmcnt(5)
  v_mfma_f32_16x16x32_bf16 v[96:99], a[176:179], a[128:131], v[96:99]
  ds_read_b64_tr_b16 a[174:175], v8 offset:51200
  ds_read_b128 v[28:31], v12 offset:512
  v_mfma_f32_16x16x32_bf16 v[96:99], a[180:183], a[144:147], v[96:99]
  s_waitcnt lgkmcnt(9)
  v_fmac_f32 v128, v16, v24
  v_mfma_f32_16x16x32_bf16 v[100:103], a[180:183], a[148:151], v[100:103]
  ds_read_b64_tr_b16 a[168:169], v8 offset:53248
  s_add_u32 s76, s76, 65536
  v_mfma_f32_16x16x32_bf16 v[100:103], a[176:179], a[132:135], v[100:103]
  buffer_load_dwordx4 a[68:71], v1, s[8:11], s76 offen offset:0 sc1
  v_fmac_f32 v129, v16, v25
  v_mfma_f32_16x16x32_bf16 v[104:107], a[176:179], a[136:139], v[104:107]
  ds_read_b64_tr_b16 a[170:171], v8 offset:55296
  v_fmac_f32 v130, v16, v26
  v_mfma_f32_16x16x32_bf16 v[104:107], a[180:183], a[152:155], v[104:107]
  v_fmac_f32 v131, v16, v27
  v_fmac_f32 v132, v18, v24
  v_mfma_f32_16x16x32_bf16 v[108:111], a[180:183], a[156:159], v[108:111]
  ds_read_b64_tr_b16 a[180:181], v8 offset:57344
  v_fmac_f32 v133, v18, v25
  v_mfma_f32_16x16x32_bf16 v[108:111], a[176:179], a[140:143], v[108:111]
  s_add_u32 s62, s92, 0
  s_waitcnt lgkmcnt(6)
  v_mfma_f32_16x16x32_bf16 v[124:127], a[164:167], a[140:143], v[124:127]
  ds_read_b64_tr_b16 a[182:183], v8 offset:59392
  buffer_load_dword a253, v13, s[36:39], s62 offen
  v_mfma_f32_16x16x32_bf16 v[124:127], a[160:163], a[156:159], v[124:127]
  v_fmac_f32 v134, v18, v26
  v_fmac_f32 v135, v18, v27
  v_mfma_f32_16x16x32_bf16 v[120:123], a[160:163], a[152:155], v[120:123]
  ds_read_b64_tr_b16 a[176:177], v8 offset:61440
  v_fmac_f32 v136, v20, v24
  v_mfma_f32_16x16x32_bf16 v[120:123], a[164:167], a[136:139], v[120:123]
  v_fmac_f32 v137, v20, v25
  v_fmac_f32 v138, v20, v26
  v_mfma_f32_16x16x32_bf16 v[116:119], a[164:167], a[132:135], v[116:119]
  ds_read_b64_tr_b16 a[178:179], v8 offset:63488
  v_fmac_f32 v139, v20, v27
  v_mfma_f32_16x16x32_bf16 v[116:119], a[160:163], a[148:151], v[116:119]
  v_fmac_f32 v140, v22, v24
  v_fmac_f32 v141, v22, v25
  v_mfma_f32_16x16x32_bf16 v[112:115], a[160:163], a[144:147], v[112:115]
  ds_read_b64_tr_b16 a[160:161], v2 offset:49152
  v_fmac_f32 v142, v22, v26
  v_mfma_f32_16x16x32_bf16 v[112:115], a[164:167], a[128:131], v[112:115]
  v_fmac_f32 v143, v22, v27
  s_waitcnt lgkmcnt(5)
  v_mfma_f32_16x16x32_bf16 v[32:35], a[172:175], a[128:131], v[32:35]
  ds_read_b64_tr_b16 a[162:163], v2 offset:51200
  ds_read_b128 v[24:27], v12 offset:320
  v_mfma_f32_16x16x32_bf16 v[32:35], a[168:171], a[144:147], v[32:35]
  s_waitcnt lgkmcnt(9)
  v_fmac_f32 v128, v17, v28
  v_mfma_f32_16x16x32_bf16 v[36:39], a[168:171], a[148:151], v[36:39]
  ds_read_b64_tr_b16 a[164:165], v2 offset:53248
  buffer_load_dwordx4 a[84:87], v1, s[8:11], s76 offen offset:1024 sc1
  v_mfma_f32_16x16x32_bf16 v[36:39], a[172:175], a[132:135], v[36:39]
  v_fmac_f32 v129, v17, v29
  v_fmac_f32 v130, v17, v30
  v_mfma_f32_16x16x32_bf16 v[40:43], a[172:175], a[136:139], v[40:43]
  ds_read_b64_tr_b16 a[166:167], v2 offset:55296
  v_fmac_f32 v131, v17, v31
  v_mfma_f32_16x16x32_bf16 v[40:43], a[168:171], a[152:155], v[40:43]
  v_fmac_f32 v132, v19, v28
  v_fmac_f32 v133, v19, v29
  v_mfma_f32_16x16x32_bf16 v[44:47], a[168:171], a[156:159], v[44:47]
  ds_read_b64_tr_b16 a[168:169], v2 offset:57344
  s_add_u32 s76, s76, 65536
  v_mfma_f32_16x16x32_bf16 v[44:47], a[172:175], a[140:143], v[44:47]
  buffer_load_dwordx4 a[72:75], v1, s[8:11], s76 offen offset:0 sc1
  s_waitcnt lgkmcnt(6)
  v_mfma_f32_16x16x32_bf16 v[60:63], a[180:183], a[140:143], v[60:63]
  ds_read_b64_tr_b16 a[170:171], v2 offset:59392
  v_fmac_f32 v134, v19, v30
  v_mfma_f32_16x16x32_bf16 v[60:63], a[176:179], a[156:159], v[60:63]
  v_fmac_f32 v135, v19, v31
  v_fmac_f32 v136, v21, v28
  v_mfma_f32_16x16x32_bf16 v[56:59], a[176:179], a[152:155], v[56:59]
  ds_read_b64_tr_b16 a[172:173], v2 offset:61440
  v_fmac_f32 v137, v21, v29
  v_mfma_f32_16x16x32_bf16 v[56:59], a[180:183], a[136:139], v[56:59]
  v_fmac_f32 v138, v21, v30
  v_fmac_f32 v139, v21, v31
  v_mfma_f32_16x16x32_bf16 v[52:55], a[180:183], a[132:135], v[52:55]
  ds_read_b64_tr_b16 a[174:175], v2 offset:63488
  buffer_load_dwordx4 a[88:91], v1, s[8:11], s76 offen offset:1024 sc1
  v_mfma_f32_16x16x32_bf16 v[52:55], a[176:179], a[148:151], v[52:55]
  v_fmac_f32 v140, v23, v28
  v_fmac_f32 v141, v23, v29
  v_mfma_f32_16x16x32_bf16 v[48:51], a[176:179], a[144:147], v[48:51]
  ds_read_b64_tr_b16 a[176:177], v3 offset:49152
  v_fmac_f32 v142, v23, v30
  v_mfma_f32_16x16x32_bf16 v[48:51], a[180:183], a[128:131], v[48:51]
  v_fmac_f32 v143, v23, v31
  s_waitcnt lgkmcnt(5)
  v_mfma_f32_16x16x32_bf16 v[128:131], a[160:163], a[128:131], v[128:131]
  ds_read_b64_tr_b16 a[178:179], v3 offset:51200
  s_add_u32 s76, s76, 65536
  v_mfma_f32_16x16x32_bf16 v[128:131], a[164:167], a[144:147], v[128:131]
  buffer_load_dwordx4 a[76:79], v1, s[8:11], s76 offen offset:0 sc1
  ds_read_b128 v[28:31], v12 offset:832
  v_mfma_f32_16x16x32_bf16 v[132:135], a[164:167], a[148:151], v[132:135]
  ds_read_b64_tr_b16 a[180:181], v3 offset:53248
  s_waitcnt lgkmcnt(10)
  v_mfma_f32_16x16x32_bf16 v[132:135], a[160:163], a[132:135], v[132:135]
  v_fmac_f32 v96, v16, v24
  v_fmac_f32 v97, v16, v25
  v_mfma_f32_16x16x32_bf16 v[136:139], a[160:163], a[136:139], v[136:139]
  ds_read_b64_tr_b16 a[182:183], v3 offset:55296
  v_fmac_f32 v98, v16, v26
  v_mfma_f32_16x16x32_bf16 v[136:139], a[164:167], a[152:155], v[136:139]
  v_fmac_f32 v99, v16, v27
  v_fmac_f32 v100, v18, v24
  v_mfma_f32_16x16x32_bf16 v[140:143], a[164:167], a[156:159], v[140:143]
  ds_read_b64_tr_b16 a[164:165], v3 offset:57344
  buffer_load_dwordx4 a[92:95], v1, s[8:11], s76 offen offset:1024 sc1
  v_mfma_f32_16x16x32_bf16 v[140:143], a[160:163], a[140:143], v[140:143]
  v_fmac_f32 v101, v18, v25
  s_waitcnt lgkmcnt(6)
  v_mfma_f32_16x16x32_bf16 v[156:159], a[168:171], a[140:143], v[156:159]
  ds_read_b64_tr_b16 a[166:167], v3 offset:59392
  v_fmac_f32 v102, v18, v26
  v_mfma_f32_16x16x32_bf16 v[156:159], a[172:175], a[156:159], v[156:159]
  v_fmac_f32 v103, v18, v27
  v_fmac_f32 v104, v20, v24
  v_mfma_f32_16x16x32_bf16 v[152:155], a[172:175], a[152:155], v[152:155]
  ds_read_b64_tr_b16 a[160:161], v3 offset:61440
  s_cmp_eq_u32 s56, 1
  s_cselect_b32 s77, 5, 13
  s_mul_i32 s69, s77, 458752
  s_lshl_b32 s77, s77, 11
  s_add_u32 s77, s77, s57
  v_mfma_f32_16x16x32_bf16 v[152:155], a[168:171], a[136:139], v[152:155]
  buffer_load_dwordx4 a[96:99], v1, s[8:11], s77 offen offset:0 sc1
  v_fmac_f32 v105, v20, v25
  v_mfma_f32_16x16x32_bf16 v[148:151], a[168:171], a[132:135], v[148:151]
  ds_read_b64_tr_b16 a[162:163], v3 offset:63488
  v_fmac_f32 v106, v20, v26
  v_mfma_f32_16x16x32_bf16 v[148:151], a[172:175], a[148:151], v[148:151]
  v_fmac_f32 v107, v20, v27
  v_fmac_f32 v108, v22, v24
  v_mfma_f32_16x16x32_bf16 v[144:147], a[172:175], a[144:147], v[144:147]
  ds_read_b64_tr_b16 a[172:173], v4 offset:49152
  v_fmac_f32 v109, v22, v25
  v_mfma_f32_16x16x32_bf16 v[144:147], a[168:171], a[128:131], v[144:147]
  v_fmac_f32 v110, v22, v26
  s_waitcnt lgkmcnt(5)
  v_mfma_f32_16x16x32_bf16 v[160:163], a[176:179], a[128:131], v[160:163]
  ds_read_b64_tr_b16 a[174:175], v4 offset:51200
  buffer_load_dwordx4 a[112:115], v1, s[8:11], s77 offen offset:1024 sc1
  v_mfma_f32_16x16x32_bf16 v[160:163], a[180:183], a[144:147], v[160:163]
  v_fmac_f32 v111, v22, v27
  ds_read_b128 v[24:27], v12 offset:1344
  v_mfma_f32_16x16x32_bf16 v[164:167], a[180:183], a[148:151], v[164:167]
  ds_read_b64_tr_b16 a[168:169], v4 offset:53248
  s_waitcnt lgkmcnt(10)
  v_mfma_f32_16x16x32_bf16 v[164:167], a[176:179], a[132:135], v[164:167]
  v_fmac_f32 v96, v17, v28
  v_fmac_f32 v97, v17, v29
  v_mfma_f32_16x16x32_bf16 v[168:171], a[176:179], a[136:139], v[168:171]
  ds_read_b64_tr_b16 a[170:171], v4 offset:55296
  s_add_u32 s77, s77, 65536
  v_mfma_f32_16x16x32_bf16 v[168:171], a[180:183], a[152:155], v[168:171]
  buffer_load_dwordx4 a[100:103], v1, s[8:11], s77 offen offset:0 sc1
  v_fmac_f32 v98, v17, v30
  v_mfma_f32_16x16x32_bf16 v[172:175], a[180:183], a[156:159], v[172:175]
  ds_read_b64_tr_b16 a[180:181], v4 offset:57344
  v_fmac_f32 v99, v17, v31
  v_mfma_f32_16x16x32_bf16 v[172:175], a[176:179], a[140:143], v[172:175]
  v_fmac_f32 v100, v19, v28
  s_waitcnt lgkmcnt(6)
  v_mfma_f32_16x16x32_bf16 v[188:191], a[164:167], a[140:143], v[188:191]
  ds_read_b64_tr_b16 a[182:183], v4 offset:59392
  v_fmac_f32 v101, v19, v29
  v_mfma_f32_16x16x32_bf16 v[188:191], a[160:163], a[156:159], v[188:191]
  v_fmac_f32 v102, v19, v30
  v_fmac_f32 v103, v19, v31
  v_mfma_f32_16x16x32_bf16 v[184:187], a[160:163], a[152:155], v[184:187]
  ds_read_b64_tr_b16 a[176:177], v4 offset:61440
  buffer_load_dwordx4 a[116:119], v1, s[8:11], s77 offen offset:1024 sc1
  v_mfma_f32_16x16x32_bf16 v[184:187], a[164:167], a[136:139], v[184:187]
  v_fmac_f32 v104, v21, v28
  v_fmac_f32 v105, v21, v29
  v_mfma_f32_16x16x32_bf16 v[180:183], a[164:167], a[132:135], v[180:183]
  ds_read_b64_tr_b16 a[178:179], v4 offset:63488
  v_fmac_f32 v106, v21, v30
  v_mfma_f32_16x16x32_bf16 v[180:183], a[160:163], a[148:151], v[180:183]
  v_fmac_f32 v107, v21, v31
  v_fmac_f32 v108, v23, v28
  v_mfma_f32_16x16x32_bf16 v[176:179], a[160:163], a[144:147], v[176:179]
  ds_read_b64_tr_b16 a[160:161], v5 offset:49152
  s_add_u32 s77, s77, 65536
  v_mfma_f32_16x16x32_bf16 v[176:179], a[164:167], a[128:131], v[176:179]
  buffer_load_dwordx4 a[104:107], v1, s[8:11], s77 offen offset:0 sc1
  s_waitcnt lgkmcnt(5)
  v_mfma_f32_16x16x32_bf16 v[192:195], a[172:175], a[128:131], v[192:195]
  ds_read_b64_tr_b16 a[162:163], v5 offset:51200
  v_fmac_f32 v109, v23, v29
  v_mfma_f32_16x16x32_bf16 v[192:195], a[168:171], a[144:147], v[192:195]
  v_fmac_f32 v110, v23, v30
  v_fmac_f32 v111, v23, v31
  v_mfma_f32_16x16x32_bf16 v[196:199], a[168:171], a[148:151], v[196:199]
  ds_read_b64_tr_b16 a[164:165], v5 offset:53248
  ds_read_b128 v[28:31], v12 offset:1856
  v_mfma_f32_16x16x32_bf16 v[196:199], a[172:175], a[132:135], v[196:199]
  s_waitcnt lgkmcnt(10)
  v_fmac_f32 v112, v16, v24
  v_mfma_f32_16x16x32_bf16 v[200:203], a[172:175], a[136:139], v[200:203]
  ds_read_b64_tr_b16 a[166:167], v5 offset:55296
  buffer_load_dwordx4 a[120:123], v1, s[8:11], s77 offen offset:1024 sc1
  v_mfma_f32_16x16x32_bf16 v[200:203], a[168:171], a[152:155], v[200:203]
  v_fmac_f32 v113, v16, v25
  v_fmac_f32 v114, v16, v26
  v_mfma_f32_16x16x32_bf16 v[204:207], a[168:171], a[156:159], v[204:207]
  ds_read_b64_tr_b16 a[168:169], v5 offset:57344
  v_fmac_f32 v115, v16, v27
  v_mfma_f32_16x16x32_bf16 v[204:207], a[172:175], a[140:143], v[204:207]
  v_fmac_f32 v116, v18, v24
  s_waitcnt lgkmcnt(6)
  v_mfma_f32_16x16x32_bf16 v[220:223], a[180:183], a[140:143], v[220:223]
  ds_read_b64_tr_b16 a[170:171], v5 offset:59392
  s_add_u32 s77, s77, 65536
  v_mfma_f32_16x16x32_bf16 v[220:223], a[176:179], a[156:159], v[220:223]
  buffer_load_dwordx4 a[108:111], v1, s[8:11], s77 offen offset:0 sc1
  v_fmac_f32 v117, v18, v25
  v_mfma_f32_16x16x32_bf16 v[216:219], a[176:179], a[152:155], v[216:219]
  ds_read_b64_tr_b16 a[172:173], v5 offset:61440
  v_fmac_f32 v118, v18, v26
  v_mfma_f32_16x16x32_bf16 v[216:219], a[180:183], a[136:139], v[216:219]
  v_fmac_f32 v119, v18, v27
  v_fmac_f32 v120, v20, v24
  v_mfma_f32_16x16x32_bf16 v[212:215], a[180:183], a[132:135], v[212:215]
  ds_read_b64_tr_b16 a[174:175], v5 offset:63488
  v_fmac_f32 v121, v20, v25
  v_mfma_f32_16x16x32_bf16 v[212:215], a[176:179], a[148:151], v[212:215]
  s_add_u32 s62, s92, 2048
  s_waitcnt vmcnt(40)
  s_barrier
  v_mfma_f32_16x16x32_bf16 v[208:211], a[176:179], a[144:147], v[208:211]
  ds_read_b64_tr_b16 a[176:177], v6 offset:32768
  buffer_load_dword a253, v13, s[36:39], s62 offen
  v_mfma_f32_16x16x32_bf16 v[208:211], a[180:183], a[128:131], v[208:211]
  v_fmac_f32 v122, v20, v26
  s_waitcnt lgkmcnt(5)
  v_mfma_f32_16x16x32_bf16 v[224:227], a[160:163], a[128:131], v[224:227]
  ds_read_b64_tr_b16 a[178:179], v6 offset:34816
  v_fmac_f32 v123, v20, v27
  v_mfma_f32_16x16x32_bf16 v[224:227], a[164:167], a[144:147], v[224:227]
  v_fmac_f32 v124, v22, v24
  v_fmac_f32 v125, v22, v25
  v_mfma_f32_16x16x32_bf16 v[228:231], a[164:167], a[148:151], v[228:231]
  ds_read_b64_tr_b16 a[180:181], v6 offset:36864
  v_fmac_f32 v126, v22, v26
  v_mfma_f32_16x16x32_bf16 v[228:231], a[160:163], a[132:135], v[228:231]
  v_fmac_f32 v127, v22, v27
  ds_read_b128 v[24:27], v12 offset:1024
  v_mfma_f32_16x16x32_bf16 v[232:235], a[160:163], a[136:139], v[232:235]
  ds_read_b64_tr_b16 a[182:183], v6 offset:38912
  s_waitcnt lgkmcnt(10)
  v_mfma_f32_16x16x32_bf16 v[232:235], a[164:167], a[152:155], v[232:235]
  v_fmac_f32 v112, v17, v28
  v_fmac_f32 v113, v17, v29
  v_mfma_f32_16x16x32_bf16 v[236:239], a[164:167], a[156:159], v[236:239]
  ds_read_b64_tr_b16 a[164:165], v6 offset:40960
  v_fmac_f32 v114, v17, v30
  v_mfma_f32_16x16x32_bf16 v[236:239], a[160:163], a[140:143], v[236:239]
  s_add_u32 m0, s45, 114688
  s_waitcnt lgkmcnt(6)
  v_mfma_f32_16x16x32_bf16 v[252:255], a[168:171], a[140:143], v[252:255]
  ds_read_b64_tr_b16 a[166:167], v6 offset:43008
  buffer_load_dwordx4 v11, s[28:31], s69 offen lds
  v_mfma_f32_16x16x32_bf16 v[252:255], a[172:175], a[156:159], v[252:255]
  v_fmac_f32 v115, v17, v31
  v_fmac_f32 v116, v19, v28
  v_mfma_f32_16x16x32_bf16 v[248:251], a[172:175], a[152:155], v[248:251]
  ds_read_b64_tr_b16 a[160:161], v6 offset:45056
  v_fmac_f32 v117, v19, v29
  v_mfma_f32_16x16x32_bf16 v[248:251], a[168:171], a[136:139], v[248:251]
  v_fmac_f32 v118, v19, v30
  v_fmac_f32 v119, v19, v31
  v_mfma_f32_16x16x32_bf16 v[244:247], a[168:171], a[132:135], v[244:247]
  ds_read_b64_tr_b16 a[162:163], v6 offset:47104
  s_add_u32 m0, s45, 122880
  v_mfma_f32_16x16x32_bf16 v[244:247], a[172:175], a[148:151], v[244:247]
  buffer_load_dwordx4 v11, s[32:35], s69 offen lds
  v_fmac_f32 v120, v21, v28
  v_mfma_f32_16x16x32_bf16 v[240:243], a[172:175], a[144:147], v[240:243]
  ds_read_b64_tr_b16 a[172:173], v7 offset:32768
  v_fmac_f32 v121, v21, v29
  v_mfma_f32_16x16x32_bf16 v[240:243], a[168:171], a[128:131], v[240:243]
  v_fmac_f32 v122, v21, v30
  s_waitcnt vmcnt(35) lgkmcnt(5)
  v_mfma_f32_16x16x32_bf16 v[64:67], a[176:179], a[0:3], v[64:67]
  ds_read_b64_tr_b16 a[174:175], v7 offset:34816
  v_fmac_f32 v123, v21, v31
  v_mfma_f32_16x16x32_bf16 v[64:67], a[180:183], a[16:19], v[64:67]
  s_add_u32 m0, s45, 118784
  s_add_u32 s61, s69, 229376
  v_mfma_f32_16x16x32_bf16 v[68:71], a[180:183], a[20:23], v[68:71]
  ds_read_b64_tr_b16 a[168:169], v7 offset:36864
  buffer_load_dwordx4 v11, s[28:31], s61 offen lds
  v_mfma_f32_16x16x32_bf16 v[68:71], a[176:179], a[4:7], v[68:71]
  v_fmac_f32 v124, v23, v28
  v_fmac_f32 v125, v23, v29
  v_mfma_f32_16x16x32_bf16 v[72:75], a[176:179], a[8:11], v[72:75]
  ds_read_b64_tr_b16 a[170:171], v7 offset:38912
  v_fmac_f32 v126, v23, v30
  v_mfma_f32_16x16x32_bf16 v[72:75], a[180:183], a[24:27], v[72:75]
  v_fmac_f32 v127, v23, v31
  ds_read_b128 v[28:31], v12 offset:1536
  v_mfma_f32_16x16x32_bf16 v[76:79], a[180:183], a[28:31], v[76:79]
  ds_read_b64_tr_b16 a[180:181], v7 offset:40960
  s_add_u32 m0, s45, 126976
  s_add_u32 s61, s69, 229376
  v_mfma_f32_16x16x32_bf16 v[76:79], a[176:179], a[12:15], v[76:79]
  buffer_load_dwordx4 v11, s[32:35], s61 offen lds
  s_waitcnt lgkmcnt(6)
  v_mfma_f32_16x16x32_bf16 v[92:95], a[164:167], a[12:15], v[92:95]
  ds_read_b64_tr_b16 a[182:183], v7 offset:43008
  s_waitcnt lgkmcnt(12)
  v_mfma_f32_16x16x32_bf16 v[92:95], a[160:163], a[28:31], v[92:95]
  v_fmac_f32 v144, v16, v24
  v_fmac_f32 v145, v16, v25
  v_mfma_f32_16x16x32_bf16 v[88:91], a[160:163], a[24:27], v[88:91]
  ds_read_b64_tr_b16 a[176:177], v7 offset:45056
  v_fmac_f32 v146, v16, v26
  v_mfma_f32_16x16x32_bf16 v[88:91], a[164:167], a[8:11], v[88:91]
  v_fmac_f32 v147, v16, v27
  v_fmac_f32 v148, v18, v24
  v_mfma_f32_16x16x32_bf16 v[84:87], a[164:167], a[4:7], v[84:87]
  ds_read_b64_tr_b16 a[178:179], v7 offset:47104
  buffer_load_dwordx4 a[124:127], v1, s[8:11], s77 offen offset:1024 sc1
  v_mfma_f32_16x16x32_bf16 v[84:87], a[160:163], a[20:23], v[84:87]
  v_fmac_f32 v149, v18, v25
  v_fmac_f32 v150, v18, v26
  v_mfma_f32_16x16x32_bf16 v[80:83], a[160:163], a[16:19], v[80:83]
  ds_read_b64_tr_b16 a[160:161], v8 offset:32768
  v_fmac_f32 v151, v18, v27
  v_mfma_f32_16x16x32_bf16 v[80:83], a[164:167], a[0:3], v[80:83]
  v_fmac_f32 v152, v20, v24
  s_waitcnt lgkmcnt(6)
  v_mfma_f32_16x16x32_bf16 v[96:99], a[172:175], a[0:3], v[96:99]
  ds_read_b64_tr_b16 a[162:163], v8 offset:34816
HOP12:
  s_cbranch_execz HOP15
  s_cmp_eq_u32 s56, 2
  s_cselect_b32 s78, 6, 14
  s_mul_i32 s70, s78, 458752
  s_lshl_b32 s78, s78, 11
  s_add_u32 s78, s78, s57
  v_mfma_f32_16x16x32_bf16 v[96:99], a[168:171], a[16:19], v[96:99]
  buffer_load_dwordx4 a[128:131], v1, s[8:11], s78 offen offset:0 sc1
  v_fmac_f32 v153, v20, v25
  v_mfma_f32_16x16x32_bf16 v[100:103], a[168:171], a[20:23], v[100:103]
  ds_read_b64_tr_b16 a[164:165], v8 offset:36864
  v_fmac_f32 v154, v20, v26
  v_mfma_f32_16x16x32_bf16 v[100:103], a[172:175], a[4:7], v[100:103]
  v_fmac_f32 v155, v20, v27
  v_fmac_f32 v156, v22, v24
  v_mfma_f32_16x16x32_bf16 v[104:107], a[172:175], a[8:11], v[104:107]
  ds_read_b64_tr_b16 a[166:167], v8 offset:38912
  v_fmac_f32 v157, v22, v25
  v_mfma_f32_16x16x32_bf16 v[104:107], a[168:171], a[24:27], v[104:107]
  v_fmac_f32 v158, v22, v26
  v_fmac_f32 v159, v22, v27
  v_mfma_f32_16x16x32_bf16 v[108:111], a[168:171], a[28:31], v[108:111]
  ds_read_b64_tr_b16 a[168:169], v8 offset:40960
  buffer_load_dwordx4 a[144:147], v1, s[8:11], s78 offen offset:1024 sc1
  v_mfma_f32_16x16x32_bf16 v[108:111], a[172:175], a[12:15], v[108:111]
  ds_read_b128 v[24:27], v12 offset:1088
  s_waitcnt lgkmcnt(6)
  v_mfma_f32_16x16x32_bf16 v[124:127], a[180:183], a[12:15], v[124:127]
  ds_read_b64_tr_b16 a[170:171], v8 offset:43008
  s_waitcnt lgkmcnt(11)
  v_mfma_f32_16x16x32_bf16 v[124:127], a[176:179], a[28:31], v[124:127]
  v_fmac_f32 v144, v17, v28
  v_fmac_f32 v145, v17, v29
  v_mfma_f32_16x16x32_bf16 v[120:123], a[176:179], a[24:27], v[120:123]
  ds_read_b64_tr_b16 a[172:173], v8 offset:45056
  s_add_u32 s78, s78, 65536
  v_mfma_f32_16x16x32_bf16 v[120:123], a[180:183], a[8:11], v[120:123]
  buffer_load_dwordx4 a[132:135], v1, s[8:11], s78 offen offset:0 sc1
  v_fmac_f32 v146, v17, v30
  v_mfma_f32_16x16x32_bf16 v[116:119], a[180:183], a[4:7], v[116:119]
  ds_read_b64_tr_b16 a[174:175], v8 offset:47104
  v_fmac_f32 v147, v17, v31
  v_mfma_f32_16x16x32_bf16 v[116:119], a[176:179], a[20:23], v[116:119]
  v_fmac_f32 v148, v19, v28
  v_fmac_f32 v149, v19, v29
  v_mfma_f32_16x16x32_bf16 v[112:115], a[176:179], a[16:19], v[112:115]
  ds_read_b64_tr_b16 a[176:177], v2 offset:16384
  v_fmac_f32 v150, v19, v30
  v_mfma_f32_16x16x32_bf16 v[112:115], a[180:183], a[0:3], v[112:115]
  v_fmac_f32 v151, v19, v31
  s_waitcnt lgkmcnt(6)
  v_mfma_f32_16x16x32_bf16 v[32:35], a[160:163], a[0:3], v[32:35]
  ds_read_b64_tr_b16 a[178:179], v2 offset:18432
  buffer_load_dwordx4 a[148:151], v1, s[8:11], s78 offen offset:1024 sc1
  v_mfma_f32_16x16x32_bf16 v[32:35], a[164:167], a[16:19], v[32:35]
  v_fmac_f32 v152, v21, v28
  v_fmac_f32 v153, v21, v29
  v_mfma_f32_16x16x32_bf16 v[36:39], a[164:167], a[20:23], v[36:39]
  ds_read_b64_tr_b16 a[180:181], v2 offset:20480
  v_fmac_f32 v154, v21, v30
  v_mfma_f32_16x16x32_bf16 v[36:39], a[160:163], a[4:7], v[36:39]
  v_fmac_f32 v155, v21, v31
  v_fmac_f32 v156, v23, v28
  v_mfma_f32_16x16x32_bf16 v[40:43], a[160:163], a[8:11], v[40:43]
  ds_read_b64_tr_b16 a[182:183], v2 offset:22528
  s_add_u32 s78, s78, 65536
  v_mfma_f32_16x16x32_bf16 v[40:43], a[164:167], a[24:27], v[40:43]
  buffer_load_dwordx4 a[136:139], v1, s[8:11], s78 offen offset:0 sc1
  v_fmac_f32 v157, v23, v29
  v_mfma_f32_16x16x32_bf16 v[44:47], a[164:167], a[28:31], v[44:47]
  ds_read_b64_tr_b16 a[164:165], v2 offset:24576
  v_fmac_f32 v158, v23, v30
  v_mfma_f32_16x16x32_bf16 v[44:47], a[160:163], a[12:15], v[44:47]
  v_fmac_f32 v159, v23, v31
  s_waitcnt lgkmcnt(5)
  v_mfma_f32_16x16x32_bf16 v[60:63], a[168:171], a[12:15], v[60:63]
  ds_read_b64_tr_b16 a[166:167], v2 offset:26624
  ds_read_b128 v[28:31], v12 offset:1600
  v_mfma_f32_16x16x32_bf16 v[60:63], a[172:175], a[28:31], v[60:63]
  s_waitcnt lgkmcnt(10)
  v_fmac_f32 v176, v16, v24
  v_mfma_f32_16x16x32_bf16 v[56:59], a[172:175], a[24:27], v[56:59]
  ds_read_b64_tr_b16 a[160:161], v2 offset:28672
  buffer_load_dwordx4 a[152:155], v1, s[8:11], s78 offen offset:1024 sc1
  v_mfma_f32_16x16x32_bf16 v[56:59], a[168:171], a[8:11], v[56:59]
  v_fmac_f32 v177, v16, v25
  v_fmac_f32 v178, v16, v26
  v_mfma_f32_16x16x32_bf16 v[52:55], a[168:171], a[4:7], v[52:55]
  ds_read_b64_tr_b16 a[162:163], v2 offset:30720
  v_fmac_f32 v179, v16, v27
  v_mfma_f32_16x16x32_bf16 v[52:55], a[172:175], a[20:23], v[52:55]
  v_fmac_f32 v180, v18, v24
  v_fmac_f32 v181, v18, v25
  v_mfma_f32_16x16x32_bf16 v[48:51], a[172:175], a[16:19], v[48:51]
  ds_read_b64_tr_b16 a[172:173], v3 offset:16384
  s_add_u32 s78, s78, 65536
  v_mfma_f32_16x16x32_bf16 v[48:51], a[168:171], a[0:3], v[48:51]
  buffer_load_dwordx4 a[140:143], v1, s[8:11], s78 offen offset:0 sc1
  s_waitcnt lgkmcnt(6)
  v_mfma_f32_16x16x32_bf16 v[128:131], a[176:179], a[0:3], v[128:131]
  ds_read_b64_tr_b16 a[174:175], v3 offset:18432
  v_fmac_f32 v182, v18, v26
  v_mfma_f32_16x16x32_bf16 v[128:131], a[180:183], a[16:19], v[128:131]
  v_fmac_f32 v183, v18, v27
  v_fmac_f32 v184, v20, v24
  v_mfma_f32_16x16x32_bf16 v[132:135], a[180:183], a[20:23], v[132:135]
  ds_read_b64_tr_b16 a[168:169], v3 offset:20480
  v_fmac_f32 v185, v20, v25
  v_mfma_f32_16x16x32_bf16 v[132:135], a[176:179], a[4:7], v[132:135]
  s_add_u32 s62, s92, 4096
  v_fmac_f32 v186, v20, v26
  v_mfma_f32_16x16x32_bf16 v[136:139], a[176:179], a[8:11], v[136:139]
  ds_read_b64_tr_b16 a[170:171], v3 offset:22528
  buffer_load_dword a253, v13, s[36:39], s62 offen
  v_mfma_f32_16x16x32_bf16 v[136:139], a[180:183], a[24:27], v[136:139]
  v_fmac_f32 v187, v20, v27
  v_fmac_f32 v188, v22, v24
  v_mfma_f32_16x16x32_bf16 v[140:143], a[180:183], a[28:31], v[140:143]
  ds_read_b64_tr_b16 a[180:181], v3 offset:24576
  v_fmac_f32 v189, v22, v25
  v_mfma_f32_16x16x32_bf16 v[140:143], a[176:179], a[12:15], v[140:143]
  v_fmac_f32 v190, v22, v26
  s_waitcnt lgkmcnt(5)
  v_mfma_f32_16x16x32_bf16 v[156:159], a[164:167], a[12:15], v[156:159]
  ds_read_b64_tr_b16 a[182:183], v3 offset:26624
  v_fmac_f32 v191, v22, v27
  v_mfma_f32_16x16x32_bf16 v[156:159], a[160:163], a[28:31], v[156:159]
  ds_read_b128 v[24:27], v12 offset:64
  s_waitcnt lgkmcnt(9)
  v_mfma_f32_16x16x32_bf16 v[152:155], a[160:163], a[24:27], v[152:155]
  ds_read_b64_tr_b16 a[176:177], v3 offset:28672
  v_fmac_f32 v176, v17, v28
  v_mfma_f32_16x16x32_bf16 v[152:155], a[164:167], a[8:11], v[152:155]
  v_fmac_f32 v177, v17, v29
  v_fmac_f32 v178, v17, v30
  v_mfma_f32_16x16x32_bf16 v[148:151], a[164:167], a[4:7], v[148:151]
  ds_read_b64_tr_b16 a[178:179], v3 offset:30720
  v_fmac_f32 v179, v17, v31
  v_mfma_f32_16x16x32_bf16 v[148:151], a[160:163], a[20:23], v[148:151]
  v_fmac_f32 v180, v19, v28
  v_fmac_f32 v181, v19, v29
  v_mfma_f32_16x16x32_bf16 v[144:147], a[160:163], a[16:19], v[144:147]
  ds_read_b64_tr_b16 a[160:161], v4 offset:16384
  buffer_load_dwordx4 a[156:159], v1, s[8:11], s78 offen offset:1024 sc1
  v_mfma_f32_16x16x32_bf16 v[144:147], a[164:167], a[0:3], v[144:147]
  v_fmac_f32 v182, v19, v30
  s_waitcnt lgkmcnt(6)
  v_mfma_f32_16x16x32_bf16 v[160:163], a[172:175], a[0:3], v[160:163]
  ds_read_b64_tr_b16 a[162:163], v4 offset:18432
  v_fmac_f32 v183, v19, v31
  v_mfma_f32_16x16x32_bf16 v[160:163], a[168:171], a[16:19], v[160:163]
  v_fmac_f32 v184, v21, v28
  v_fmac_f32 v185, v21, v29
  v_mfma_f32_16x16x32_bf16 v[164:167], a[168:171], a[20:23], v[164:167]
  ds_read_b64_tr_b16 a[164:165], v4 offset:20480
  s_add_u32 m0, s45, 0
  v_mfma_f32_16x16x32_bf16 v[164:167], a[172:175], a[4:7], v[164:167]
  buffer_load_dwordx4 v10, s[28:31], s67 offen lds
  v_fmac_f32 v186, v21, v30
  v_mfma_f32_16x16x32_bf16 v[168:171], a[172:175], a[8:11], v[168:171]
  ds_read_b64_tr_b16 a[166:167], v4 offset:22528
  v_fmac_f32 v187, v21, v31
  v_mfma_f32_16x16x32_bf16 v[168:171], a[168:171], a[24:27], v[168:171]
  v_fmac_f32 v188, v23, v28
  v_fmac_f32 v189, v23, v29
  v_mfma_f32_16x16x32_bf16 v[172:175], a[168:171], a[28:31], v[172:175]
  ds_read_b64_tr_b16 a[168:169], v4 offset:24576
  v_fmac_f32 v190, v23, v30
  v_mfma_f32_16x16x32_bf16 v[172:175], a[172:175], a[12:15], v[172:175]
  s_add_u32 m0, s45, 8192
  s_waitcnt lgkmcnt(5)
  v_mfma_f32_16x16x32_bf16 v[188:191], a[180:183], a[12:15], v[188:191]
  ds_read_b64_tr_b16 a[170:171], v4 offset:26624
  buffer_load_dwordx4 v10, s[32:35], s67 offen lds
  v_mfma_f32_16x16x32_bf16 v[188:191], a[176:179], a[28:31], v[188:191]
  s_nop 7
  v_fmac_f32 v191, v23, v31
  ds_read_b128 v[28:31], v12 offset:576
  v_mfma_f32_16x16x32_bf16 v[184:187], a[176:179], a[24:27], v[184:187]
  ds_read_b64_tr_b16 a[172:173], v4 offset:28672
  s_waitcnt lgkmcnt(10)
  v_mfma_f32_16x16x32_bf16 v[184:187], a[180:183], a[8:11], v[184:187]
  v_fmac_f32 v160, v16, v24
  v_fmac_f32 v161, v16, v25
  v_mfma_f32_16x16x32_bf16 v[180:183], a[180:183], a[4:7], v[180:183]
  ds_read_b64_tr_b16 a[174:175], v4 offset:30720
  s_add_u32 m0, s45, 4096
  s_add_u32 s61, s67, 229376
  v_mfma_f32_16x16x32_bf16 v[180:183], a[176:179], a[20:23], v[180:183]
  buffer_load_dwordx4 v10, s[28:31], s61 offen lds
  v_fmac_f32 v162, v16, v26
  v_mfma_f32_16x16x32_bf16 v[176:179], a[176:179], a[16:19], v[176:179]
  ds_read_b64_tr_b16 a[176:177], v5 offset:16384
  v_fmac_f32 v163, v16, v27
  v_mfma_f32_16x16x32_bf16 v[176:179], a[180:183], a[0:3], v[176:179]
  v_fmac_f32 v164, v18, v24
  s_waitcnt lgkmcnt(6)
  v_mfma_f32_16x16x32_bf16 v[192:195], a[160:163], a[0:3], v[192:195]
  ds_read_b64_tr_b16 a[178:179], v5 offset:18432
  v_fmac_f32 v165, v18, v25
  v_mfma_f32_16x16x32_bf16 v[192:195], a[164:167], a[16:19], v[192:195]
  s_add_u32 m0, s45, 12288
  s_add_u32 s61, s67, 229376
  v_mfma_f32_16x16x32_bf16 v[196:199], a[164:167], a[20:23], v[196:199]
  ds_read_b64_tr_b16 a[180:181], v5 offset:20480
  buffer_load_dwordx4 v10, s[32:35], s61 offen lds
  v_mfma_f32_16x16x32_bf16 v[196:199], a[160:163], a[4:7], v[196:199]
  v_fmac_f32 v166, v18, v26
  v_fmac_f32 v167, v18, v27
  v_mfma_f32_16x16x32_bf16 v[200:203], a[160:163], a[8:11], v[200:203]
  ds_read_b64_tr_b16 a[182:183], v5 offset:22528
  v_fmac_f32 v168, v20, v24
  v_mfma_f32_16x16x32_bf16 v[200:203], a[164:167], a[24:27], v[200:203]
  v_fmac_f32 v169, v20, v25
  v_fmac_f32 v170, v20, v26
  v_mfma_f32_16x16x32_bf16 v[204:207], a[164:167], a[28:31], v[204:207]
  ds_read_b64_tr_b16 a[164:165], v5 offset:24576
  s_add_u32 m0, s45, 32768
  v_mfma_f32_16x16x32_bf16 v[204:207], a[160:163], a[12:15], v[204:207]
  buffer_load_dwordx4 v10, s[28:31], s68 offen lds
  s_waitcnt lgkmcnt(5)
  v_mfma_f32_16x16x32_bf16 v[220:223], a[168:171], a[12:15], v[220:223]
  ds_read_b64_tr_b16 a[166:167], v5 offset:26624
  v_fmac_f32 v171, v20, v27
  v_mfma_f32_16x16x32_bf16 v[220:223], a[172:175], a[28:31], v[220:223]
  v_fmac_f32 v172, v22, v24
  v_fmac_f32 v173, v22, v25
  v_mfma_f32_16x16x32_bf16 v[216:219], a[172:175], a[24:27], v[216:219]
  ds_read_b64_tr_b16 a[160:161], v5 offset:28672
  v_fmac_f32 v174, v22, v26
  v_mfma_f32_16x16x32_bf16 v[216:219], a[168:171], a[8:11], v[216:219]
  s_add_u32 m0, s45, 40960
  v_fmac_f32 v175, v22, v27
  v_mfma_f32_16x16x32_bf16 v[212:215], a[168:171], a[4:7], v[212:215]
  ds_read_b64_tr_b16 a[162:163], v5 offset:30720
  buffer_load_dwordx4 v10, s[32:35], s68 offen lds
  v_mfma_f32_16x16x32_bf16 v[212:215], a[172:175], a[20:23], v[212:215]
  s_waitcnt vmcnt(16)
  s_barrier
  v_mfma_f32_16x16x32_bf16 v[208:211], a[172:175], a[16:19], v[208:211]
  ds_read_b64_tr_b16 a[172:173], v6 offset:16384
  ds_read_b128 v[24:27], v12 offset:128
  v_mfma_f32_16x16x32_bf16 v[208:211], a[168:171], a[0:3], v[208:211]
  s_waitcnt lgkmcnt(12)
  s_waitcnt lgkmcnt(6)
  v_mfma_f32_16x16x32_bf16 v[224:227], a[176:179], a[0:3], v[224:227]
  ds_read_b64_tr_b16 a[174:175], v6 offset:18432
  s_add_u32 m0, s45, 36864
  s_add_u32 s61, s68, 229376
  v_mfma_f32_16x16x32_bf16 v[224:227], a[180:183], a[16:19], v[224:227]
  buffer_load_dwordx4 v10, s[28:31], s61 offen lds
  v_fmac_f32 v160, v17, v28
  v_mfma_f32_16x16x32_bf16 v[228:231], a[180:183], a[20:23], v[228:231]
  ds_read_b64_tr_b16 a[168:169], v6 offset:20480
  v_fmac_f32 v161, v17, v29
  v_mfma_f32_16x16x32_bf16 v[228:231], a[176:179], a[4:7], v[228:231]
  v_fmac_f32 v162, v17, v30
  v_fmac_f32 v163, v17, v31
  v_mfma_f32_16x16x32_bf16 v[232:235], a[176:179], a[8:11], v[232:235]
  ds_read_b64_tr_b16 a[170:171], v6 offset:22528
  v_fmac_f32 v164, v19, v28
  v_mfma_f32_16x16x32_bf16 v[232:235], a[180:183], a[24:27], v[232:235]
  s_add_u32 m0, s45, 45056
  s_add_u32 s61, s68, 229376
  v_mfma_f32_16x16x32_bf16 v[236:239], a[180:183], a[28:31], v[236:239]
  ds_read_b64_tr_b16 a[180:181], v6 offset:24576
  buffer_load_dwordx4 v10, s[32:35], s61 offen lds
  v_mfma_f32_16x16x32_bf16 v[236:239], a[176:179], a[12:15], v[236:239]
  v_fmac_f32 v165, v19, v29
  s_waitcnt lgkmcnt(6)
  v_mfma_f32_16x16x32_bf16 v[252:255], a[164:167], a[12:15], v[252:255]
  ds_read_b64_tr_b16 a[182:183], v6 offset:26624
  v_fmac_f32 v166, v19, v30
  v_mfma_f32_16x16x32_bf16 v[252:255], a[160:163], a[28:31], v[252:255]
  v_fmac_f32 v167, v19, v31
  v_fmac_f32 v168, v21, v28
  v_mfma_f32_16x16x32_bf16 v[248:251], a[160:163], a[24:27], v[248:251]
  ds_read_b64_tr_b16 a[176:177], v6 offset:28672
  s_add_u32 m0, s45, 98304
  v_mfma_f32_16x16x32_bf16 v[248:251], a[164:167], a[8:11], v[248:251]
  buffer_load_dwordx4 v11, s[28:31], s70 offen lds
  v_fmac_f32 v169, v21, v29
  v_mfma_f32_16x16x32_bf16 v[244:247], a[164:167], a[4:7], v[244:247]
  ds_read_b64_tr_b16 a[178:179], v6 offset:30720
  v_fmac_f32 v170, v21, v30
  v_mfma_f32_16x16x32_bf16 v[244:247], a[160:163], a[20:23], v[244:247]
  v_fmac_f32 v171, v21, v31
  v_fmac_f32 v172, v23, v28
  v_mfma_f32_16x16x32_bf16 v[240:243], a[160:163], a[16:19], v[240:243]
  ds_read_b64_tr_b16 a[160:161], v7 offset:16384
  v_fmac_f32 v173, v23, v29
  v_mfma_f32_16x16x32_bf16 v[240:243], a[164:167], a[0:3], v[240:243]
  s_add_u32 m0, s45, 106496
  s_waitcnt vmcnt(40) lgkmcnt(5)
  v_mfma_f32_16x16x32_bf16 v[64:67], a[172:175], a[32:35], v[64:67]
  ds_read_b64_tr_b16 a[162:163], v7 offset:18432
  buffer_load_dwordx4 v11, s[32:35], s70 offen lds
  v_mfma_f32_16x16x32_bf16 v[64:67], a[168:171], a[48:51], v[64:67]
  v_fmac_f32 v174, v23, v30
  v_fmac_f32 v175, v23, v31
  v_mfma_f32_16x16x32_bf16 v[68:71], a[168:171], a[52:55], v[68:71]
  ds_read_b64_tr_b16 a[164:165], v7 offset:20480
  ds_read_b128 v[28:31], v12 offset:640
  v_mfma_f32_16x16x32_bf16 v[68:71], a[172:175], a[36:39], v[68:71]
  s_waitcnt lgkmcnt(11)
  v_fmac_f32 v192, v16, v24
  v_mfma_f32_16x16x32_bf16 v[72:75], a[172:175], a[40:43], v[72:75]
  ds_read_b64_tr_b16 a[166:167], v7 offset:22528
  s_add_u32 m0, s45, 102400
  s_add_u32 s61, s70, 229376
  v_mfma_f32_16x16x32_bf16 v[72:75], a[168:171], a[56:59], v[72:75]
  buffer_load_dwordx4 v11, s[28:31], s61 offen lds
  v_fmac_f32 v193, v16, v25
  v_mfma_f32_16x16x32_bf16 v[76:79], a[168:171], a[60:63], v[76:79]
  ds_read_b64_tr_b16 a[168:169], v7 offset:24576
  v_fmac_f32 v194, v16, v26
  v_mfma_f32_16x16x32_bf16 v[76:79], a[172:175], a[44:47], v[76:79]
  v_fmac_f32 v195, v16, v27
  s_waitcnt lgkmcnt(6)
  v_mfma_f32_16x16x32_bf16 v[92:95], a[180:183], a[44:47], v[92:95]
  ds_read_b64_tr_b16 a[170:171], v7 offset:26624
  v_fmac_f32 v196, v18, v24
  v_mfma_f32_16x16x32_bf16 v[92:95], a[176:179], a[60:63], v[92:95]
  s_add_u32 m0, s45, 110592
  s_add_u32 s61, s70, 229376
  v_mfma_f32_16x16x32_bf16 v[88:91], a[176:179], a[56:59], v[88:91]
  ds_read_b64_tr_b16 a[172:173], v7 offset:28672
  buffer_load_dwordx4 v11, s[32:35], s61 offen lds
  v_mfma_f32_16x16x32_bf16 v[88:91], a[180:183], a[40:43], v[88:91]
  v_fmac_f32 v197, v18, v25
  v_fmac_f32 v198, v18, v26
  v_mfma_f32_16x16x32_bf16 v[84:87], a[180:183], a[36:39], v[84:87]
  ds_read_b64_tr_b16 a[174:175], v7 offset:30720
  v_fmac_f32 v199, v18, v27
  v_mfma_f32_16x16x32_bf16 v[84:87], a[176:179], a[52:55], v[84:87]
  v_fmac_f32 v200, v20, v24
  v_fmac_f32 v201, v20, v25
  v_mfma_f32_16x16x32_bf16 v[80:83], a[176:179], a[48:51], v[80:83]
  ds_read_b64_tr_b16 a[176:177], v8 offset:16384
  s_add_u32 s62, s92, 6144
  v_mfma_f32_16x16x32_bf16 v[80:83], a[180:183], a[32:35], v[80:83]
  buffer_load_dword a253, v13, s[36:39], s62 offen
  s_waitcnt lgkmcnt(5)
  v_mfma_f32_16x16x32_bf16 v[96:99], a[160:163], a[32:35], v[96:99]
  ds_read_b64_tr_b16 a[178:179], v8 offset:18432
  v_fmac_f32 v202, v20, v26
  v_mfma_f32_16x16x32_bf16 v[96:99], a[164:167], a[48:51], v[96:99]
  v_fmac_f32 v203, v20, v27
  v_fmac_f32 v204, v22, v24
  v_mfma_f32_16x16x32_bf16 v[100:103], a[164:167], a[52:55], v[100:103]
  ds_read_b64_tr_b16 a[180:181], v8 offset:20480
  v_fmac_f32 v205, v22, v25
  v_mfma_f32_16x16x32_bf16 v[100:103], a[160:163], a[36:39], v[100:103]
  v_fmac_f32 v206, v22, v26
  v_fmac_f32 v207, v22, v27
  v_mfma_f32_16x16x32_bf16 v[104:107], a[160:163], a[40:43], v[104:107]
  ds_read_b64_tr_b16 a[182:183], v8 offset:22528
  ds_read_b128 v[24:27], v12 offset:1152
  v_mfma_f32_16x16x32_bf16 v[104:107], a[164:167], a[56:59], v[104:107]
  s_waitcnt lgkmcnt(10)
  v_fmac_f32 v192, v17, v28
  v_mfma_f32_16x16x32_bf16 v[108:111], a[164:167], a[60:63], v[108:111]
  ds_read_b64_tr_b16 a[164:165], v8 offset:24576
  v_fmac_f32 v193, v17, v29
  v_mfma_f32_16x16x32_bf16 v[108:111], a[160:163], a[44:47], v[108:111]
  v_fmac_f32 v194, v17, v30
  s_waitcnt lgkmcnt(6)
  v_mfma_f32_16x16x32_bf16 v[124:127], a[168:171], a[44:47], v[124:127]
  ds_read_b64_tr_b16 a[166:167], v8 offset:26624
  s_cmp_eq_u32 s56, 3
  s_cselect_b32 s79, 7, 15
  s_mul_i32 s71, s79, 458752
  s_lshl_b32 s79, s79, 11
  s_add_u32 s79, s79, s57
  v_mfma_f32_16x16x32_bf16 v[124:127], a[172:175], a[60:63], v[124:127]
  buffer_load_dwordx4 a[0:3], v1, s[8:11], s79 offen offset:0 sc1
  v_fmac_f32 v195, v17, v31
  v_mfma_f32_16x16x32_bf16 v[120:123], a[172:175], a[56:59], v[120:123]
  ds_read_b64_tr_b16 a[160:161], v8 offset:28672
  v_fmac_f32 v196, v19, v28
  v_mfma_f32_16x16x32_bf16 v[120:123], a[168:171], a[40:43], v[120:123]
  v_fmac_f32 v197, v19, v29
  v_fmac_f32 v198, v19, v30
  v_mfma_f32_16x16x32_bf16 v[116:119], a[168:171], a[36:39], v[116:119]
  ds_read_b64_tr_b16 a[162:163], v8 offset:30720
  v_fmac_f32 v199, v19, v31
  v_mfma_f32_16x16x32_bf16 v[116:119], a[172:175], a[52:55], v[116:119]
  v_fmac_f32 v200, v21, v28
  v_fmac_f32 v201, v21, v29
  v_mfma_f32_16x16x32_bf16 v[112:115], a[172:175], a[48:51], v[112:115]
  ds_read_b64_tr_b16 a[172:173], v8 offset:0
  buffer_load_dwordx4 a[16:19], v1, s[8:11], s79 offen offset:1024 sc1
  v_mfma_f32_16x16x32_bf16 v[112:115], a[168:171], a[32:35], v[112:115]
  v_fmac_f32 v202, v21, v30
  s_waitcnt lgkmcnt(6)
  v_mfma_f32_16x16x32_bf16 v[32:35], a[176:179], a[32:35], v[32:35]
  ds_read_b64_tr_b16 a[174:175], v8 offset:2048
  v_fmac_f32 v203, v21, v31
  v_mfma_f32_16x16x32_bf16 v[32:35], a[180:183], a[48:51], v[32:35]
  v_fmac_f32 v204, v23, v28
  v_fmac_f32 v205, v23, v29
  v_mfma_f32_16x16x32_bf16 v[36:39], a[180:183], a[52:55], v[36:39]
  ds_read_b64_tr_b16 a[168:169], v8 offset:4096
  s_add_u32 s79, s79, 65536
  v_mfma_f32_16x16x32_bf16 v[36:39], a[176:179], a[36:39], v[36:39]
  buffer_load_dwordx4 a[4:7], v1, s[8:11], s79 offen offset:0 sc1
  v_fmac_f32 v206, v23, v30
  v_mfma_f32_16x16x32_bf16 v[40:43], a[176:179], a[40:43], v[40:43]
  ds_read_b64_tr_b16 a[170:171], v8 offset:6144
  v_fmac_f32 v207, v23, v31
  v_mfma_f32_16x16x32_bf16 v[40:43], a[180:183], a[56:59], v[40:43]
  ds_read_b128 v[28:31], v12 offset:1664
  v_mfma_f32_16x16x32_bf16 v[44:47], a[180:183], a[60:63], v[44:47]
  ds_read_b64_tr_b16 a[180:181], v8 offset:8192
  s_waitcnt lgkmcnt(10)
  v_mfma_f32_16x16x32_bf16 v[44:47], a[176:179], a[44:47], v[44:47]
  v_fmac_f32 v208, v16, v24
  s_waitcnt lgkmcnt(6)
  v_mfma_f32_16x16x32_bf16 v[60:63], a[164:167], a[44:47], v[60:63]
  ds_read_b64_tr_b16 a[182:183], v8 offset:10240
  buffer_load_dwordx4 a[20:23], v1, s[8:11], s79 offen offset:1024 sc1
  v_mfma_f32_16x16x32_bf16 v[60:63], a[160:163], a[60:63], v[60:63]
  v_fmac_f32 v209, v16, v25
  v_fmac_f32 v210, v16, v26
  v_mfma_f32_16x16x32_bf16 v[56:59], a[160:163], a[56:59], v[56:59]
  ds_read_b64_tr_b16 a[176:177], v8 offset:12288
  v_fmac_f32 v211, v16, v27
  v_mfma_f32_16x16x32_bf16 v[56:59], a[164:167], a[40:43], v[56:59]
  v_fmac_f32 v212, v18, v24
  v_fmac_f32 v213, v18, v25
  v_mfma_f32_16x16x32_bf16 v[52:55], a[164:167], a[36:39], v[52:55]
  ds_read_b64_tr_b16 a[178:179], v8 offset:14336
  s_add_u32 s79, s79, 65536
  v_mfma_f32_16x16x32_bf16 v[52:55], a[160:163], a[52:55], v[52:55]
  buffer_load_dwordx4 a[8:11], v1, s[8:11], s79 offen offset:0 sc1
  v_fmac_f32 v214, v18, v26
  v_mfma_f32_16x16x32_bf16 v[48:51], a[160:163], a[48:51], v[48:51]
  ds_read_b64_tr_b16 a[160:161], v8 offset:49152
  v_fmac_f32 v215, v18, v27
  v_mfma_f32_16x16x32_bf16 v[48:51], a[164:167], a[32:35], v[48:51]
  v_fmac_f32 v216, v20, v24
  s_waitcnt vmcnt(40) lgkmcnt(6)
  v_mfma_f32_16x16x32_bf16 v[32:35], a[172:175], a[64:67], v[32:35]
  ds_read_b64_tr_b16 a[162:163], v8 offset:51200
  s_waitcnt vmcnt(6)
  s_barrier
  v_mfma_f32_16x16x32_bf16 v[32:35], a[168:171], a[80:83], v[32:35]
  s_add_u32 m0, s45, 81920
  v_fmac_f32 v217, v20, v25
  v_mfma_f32_16x16x32_bf16 v[36:39], a[168:171], a[84:87], v[36:39]
  ds_read_b64_tr_b16 a[164:165], v8 offset:53248
  buffer_load_dwordx4 v11, s[28:31], s71 offen lds
  v_mfma_f32_16x16x32_bf16 v[36:39], a[172:175], a[68:71], v[36:39]
  v_fmac_f32 v218, v20, v26
  v_fmac_f32 v219, v20, v27
  v_mfma_f32_16x16x32_bf16 v[40:43], a[172:175], a[72:75], v[40:43]
  ds_read_b64_tr_b16 a[166:167], v8 offset:55296
  v_fmac_f32 v220, v22, v24
  v_mfma_f32_16x16x32_bf16 v[40:43], a[168:171], a[88:91], v[40:43]
  s_add_u32 m0, s45, 90112
  v_fmac_f32 v221, v22, v25
  v_mfma_f32_16x16x32_bf16 v[44:47], a[168:171], a[92:95], v[44:47]
  ds_read_b64_tr_b16 a[168:169], v8 offset:57344
  buffer_load_dwordx4 v11, s[32:35], s71 offen lds
  v_mfma_f32_16x16x32_bf16 v[44:47], a[172:175], a[76:79], v[44:47]
  v_fmac_f32 v222, v22, v26
  s_waitcnt lgkmcnt(5)
  v_mfma_f32_16x16x32_bf16 v[60:63], a[180:183], a[76:79], v[60:63]
  ds_read_b64_tr_b16 a[170:171], v8 offset:59392
  v_fmac_f32 v223, v22, v27
  v_mfma_f32_16x16x32_bf16 v[60:63], a[176:179], a[92:95], v[60:63]
  s_add_u32 m0, s45, 86016
  s_add_u32 s61, s71, 229376
  v_mfma_f32_16x16x32_bf16 v[56:59], a[176:179], a[88:91], v[56:59]
  ds_read_b64_tr_b16 a[172:173], v8 offset:61440
  buffer_load_dwordx4 v11, s[28:31], s61 offen lds
  v_mfma_f32_16x16x32_bf16 v[56:59], a[180:183], a[72:75], v[56:59]
  ds_read_b128 v[24:27], v12 offset:192
  s_waitcnt lgkmcnt(12)
  v_mfma_f32_16x16x32_bf16 v[52:55], a[180:183], a[68:71], v[52:55]
  ds_read_b64_tr_b16 a[174:175], v8 offset:63488
  v_fmac_f32 v208, v17, v28
  v_mfma_f32_16x16x32_bf16 v[52:55], a[176:179], a[84:87], v[52:55]
  s_add_u32 m0, s45, 94208
  s_add_u32 s61, s71, 229376
  v_mfma_f32_16x16x32_bf16 v[48:51], a[176:179], a[80:83], v[48:51]
  ds_read_b64_tr_b16 a[176:177], v8 offset:32768
  buffer_load_dwordx4 v11, s[32:35], s61 offen lds
  v_mfma_f32_16x16x32_bf16 v[48:51], a[180:183], a[64:67], v[48:51]
  v_fmac_f32 v209, v17, v29
  s_waitcnt vmcnt(31) lgkmcnt(6)
  v_mfma_f32_16x16x32_bf16 v[32:35], a[160:163], a[96:99], v[32:35]
  ds_read_b64_tr_b16 a[178:179], v8 offset:34816
  v_fmac_f32 v210, v17, v30
  v_mfma_f32_16x16x32_bf16 v[32:35], a[164:167], a[112:115], v[32:35]
  v_fmac_f32 v211, v17, v31
  v_fmac_f32 v212, v19, v28
  v_mfma_f32_16x16x32_bf16 v[36:39], a[164:167], a[116:119], v[36:39]
  ds_read_b64_tr_b16 a[180:181], v8 offset:36864
  buffer_load_dwordx4 a[24:27], v1, s[8:11], s79 offen offset:1024 sc1
  v_mfma_f32_16x16x32_bf16 v[36:39], a[160:163], a[100:103], v[36:39]
  v_fmac_f32 v213, v19, v29
  v_fmac_f32 v214, v19, v30
  v_mfma_f32_16x16x32_bf16 v[40:43], a[160:163], a[104:107], v[40:43]
  ds_read_b64_tr_b16 a[182:183], v8 offset:38912
  v_fmac_f32 v215, v19, v31
  v_mfma_f32_16x16x32_bf16 v[40:43], a[164:167], a[120:123], v[40:43]
  s_add_u32 s79, s79, 65536
  v_fmac_f32 v216, v21, v28
  v_mfma_f32_16x16x32_bf16 v[44:47], a[164:167], a[124:127], v[44:47]
  ds_read_b64_tr_b16 a[164:165], v8 offset:40960
  buffer_load_dwordx4 a[12:15], v1, s[8:11], s79 offen offset:0 sc1
  v_mfma_f32_16x16x32_bf16 v[44:47], a[160:163], a[108:111], v[44:47]
  v_fmac_f32 v217, v21, v29
  s_waitcnt lgkmcnt(5)
  v_mfma_f32_16x16x32_bf16 v[60:63], a[168:171], a[108:111], v[60:63]
  ds_read_b64_tr_b16 a[166:167], v8 offset:43008
  v_fmac_f32 v218, v21, v30
  v_mfma_f32_16x16x32_bf16 v[60:63], a[172:175], a[124:127], v[60:63]
  v_fmac_f32 v219, v21, v31
  v_fmac_f32 v220, v23, v28
  v_mfma_f32_16x16x32_bf16 v[56:59], a[172:175], a[120:123], v[56:59]
  ds_read_b64_tr_b16 a[160:161], v8 offset:45056
  buffer_load_dwordx4 a[28:31], v1, s[8:11], s79 offen offset:1024 sc1
  v_mfma_f32_16x16x32_bf16 v[56:59], a[168:171], a[104:107], v[56:59]
  v_fmac_f32 v221, v23, v29
  v_fmac_f32 v222, v23, v30
  v_mfma_f32_16x16x32_bf16 v[52:55], a[168:171], a[100:103], v[52:55]
  ds_read_b64_tr_b16 a[162:163], v8 offset:47104
  v_fmac_f32 v223, v23, v31
  v_mfma_f32_16x16x32_bf16 v[52:55], a[172:175], a[116:119], v[52:55]
  s_add_u32 m0, s45, 49152
  ds_read_b128 v[28:31], v12 offset:704
  v_mfma_f32_16x16x32_bf16 v[48:51], a[172:175], a[112:115], v[48:51]
  ds_read_b64_tr_b16 a[172:173], v6 offset:0
  buffer_load_dwordx4 v10, s[28:31], s69 offen lds
  v_mfma_f32_16x16x32_bf16 v[48:51], a[168:171], a[96:99], v[48:51]
  s_waitcnt lgkmcnt(11)
  s_waitcnt vmcnt(26) lgkmcnt(6)
  v_mfma_f32_16x16x32_bf16 v[32:35], a[176:179], a[128:131], v[32:35]
  ds_read_b64_tr_b16 a[174:175], v6 offset:2048
  v_fmac_f32 v224, v16, v24
  v_mfma_f32_16x16x32_bf16 v[32:35], a[180:183], a[144:147], v[32:35]
  s_add_u32 m0, s45, 57344
  v_fmac_f32 v225, v16, v25
  v_mfma_f32_16x16x32_bf16 v[36:39], a[180:183], a[148:151], v[36:39]
  ds_read_b64_tr_b16 a[168:169], v6 offset:4096
  buffer_load_dwordx4 v10, s[32:35], s69 offen lds
  v_mfma_f32_16x16x32_bf16 v[36:39], a[176:179], a[132:135], v[36:39]
  v_fmac_f32 v226, v16, v26
  v_fmac_f32 v227, v16, v27
  v_mfma_f32_16x16x32_bf16 v[40:43], a[176:179], a[136:139], v[40:43]
  ds_read_b64_tr_b16 a[170:171], v6 offset:6144
  v_fmac_f32 v228, v18, v24
  v_mfma_f32_16x16x32_bf16 v[40:43], a[180:183], a[152:155], v[40:43]
  s_add_u32 m0, s45, 53248
  s_add_u32 s61, s69, 229376
  v_mfma_f32_16x16x32_bf16 v[44:47], a[180:183], a[156:159], v[44:47]
  ds_read_b64_tr_b16 a[180:181], v6 offset:8192
  buffer_load_dwordx4 v10, s[28:31], s61 offen lds
  v_mfma_f32_16x16x32_bf16 v[44:47], a[176:179], a[140:143], v[44:47]
  v_fmac_f32 v229, v18, v25
  s_waitcnt lgkmcnt(6)
  v_mfma_f32_16x16x32_bf16 v[60:63], a[164:167], a[140:143], v[60:63]
  ds_read_b64_tr_b16 a[182:183], v6 offset:10240
  v_fmac_f32 v230, v18, v26
  v_mfma_f32_16x16x32_bf16 v[60:63], a[160:163], a[156:159], v[60:63]
  s_add_u32 m0, s45, 61440
  s_add_u32 s61, s69, 229376
  v_mfma_f32_16x16x32_bf16 v[56:59], a[160:163], a[152:155], v[56:59]
  ds_read_b64_tr_b16 a[176:177], v6 offset:12288
  buffer_load_dwordx4 v10, s[32:35], s61 offen lds
  v_mfma_f32_16x16x32_bf16 v[56:59], a[164:167], a[136:139], v[56:59]
  v_fmac_f32 v231, v18, v27
  v_fmac_f32 v232, v20, v24
  v_mfma_f32_16x16x32_bf16 v[52:55], a[164:167], a[132:135], v[52:55]
  ds_read_b64_tr_b16 a[178:179], v6 offset:14336
  v_fmac_f32 v233, v20, v25
  v_mfma_f32_16x16x32_bf16 v[52:55], a[160:163], a[148:151], v[52:55]
  s_add_u32 s62, s92, 8192
  v_fmac_f32 v234, v20, v26
  v_mfma_f32_16x16x32_bf16 v[48:51], a[160:163], a[144:147], v[48:51]
  ds_read_b64_tr_b16 a[160:161], v6 offset:49152
  buffer_load_dword a253, v13, s[36:39], s62 offen
  v_mfma_f32_16x16x32_bf16 v[48:51], a[164:167], a[128:131], v[48:51]
  v_fmac_f32 v235, v20, v27
  s_waitcnt lgkmcnt(5)
  v_mfma_f32_16x16x32_bf16 v[64:67], a[172:175], a[64:67], v[64:67]
  ds_read_b64_tr_b16 a[162:163], v6 offset:51200
  v_fmac_f32 v236, v22, v24
  v_mfma_f32_16x16x32_bf16 v[64:67], a[168:171], a[80:83], v[64:67]
  v_fmac_f32 v237, v22, v25
  v_fmac_f32 v238, v22, v26
  v_mfma_f32_16x16x32_bf16 v[68:71], a[168:171], a[84:87], v[68:71]
  ds_read_b64_tr_b16 a[164:165], v6 offset:53248
  v_fmac_f32 v239, v22, v27
  v_mfma_f32_16x16x32_bf16 v[68:71], a[172:175], a[68:71], v[68:71]
  ds_read_b128 v[24:27], v12 offset:1216
  s_waitcnt lgkmcnt(12)
  v_mfma_f32_16x16x32_bf16 v[72:75], a[172:175], a[72:75], v[72:75]
  ds_read_b64_tr_b16 a[166:167], v6 offset:55296
  v_fmac_f32 v224, v17, v28
  v_mfma_f32_16x16x32_bf16 v[72:75], a[168:171], a[88:91], v[72:75]
  s_add_u32 m0, s45, 16384
  v_fmac_f32 v225, v17, v29
  v_mfma_f32_16x16x32_bf16 v[76:79], a[168:171], a[92:95], v[76:79]
  ds_read_b64_tr_b16 a[168:169], v6 offset:57344
  buffer_load_dwordx4 v10, s[28:31], s70 offen lds
  v_mfma_f32_16x16x32_bf16 v[76:79], a[172:175], a[76:79], v[76:79]
  v_fmac_f32 v226, v17, v30
  s_waitcnt lgkmcnt(6)
  v_mfma_f32_16x16x32_bf16 v[92:95], a[180:183], a[76:79], v[92:95]
  ds_read_b64_tr_b16 a[170:171], v6 offset:59392
  v_fmac_f32 v227, v17, v31
  v_mfma_f32_16x16x32_bf16 v[92:95], a[176:179], a[92:95], v[92:95]
  s_add_u32 m0, s45, 24576
  v_fmac_f32 v228, v19, v28
  v_mfma_f32_16x16x32_bf16 v[88:91], a[176:179], a[88:91], v[88:91]
  ds_read_b64_tr_b16 a[172:173], v6 offset:61440
  buffer_load_dwordx4 v10, s[32:35], s70 offen lds
  v_mfma_f32_16x16x32_bf16 v[88:91], a[180:183], a[72:75], v[88:91]
  v_fmac_f32 v229, v19, v29
  v_fmac_f32 v230, v19, v30
  v_mfma_f32_16x16x32_bf16 v[84:87], a[180:183], a[68:71], v[84:87]
HOP13:
  s_cbranch_execz HOP16
  ds_read_b64_tr_b16 a[174:175], v6 offset:63488
  v_fmac_f32 v231, v19, v31
  v_mfma_f32_16x16x32_bf16 v[84:87], a[176:179], a[84:87], v[84:87]
  s_add_u32 m0, s45, 20480
  s_add_u32 s61, s70, 229376
  v_mfma_f32_16x16x32_bf16 v[80:83], a[176:179], a[80:83], v[80:83]
  ds_read_b64_tr_b16 a[176:177], v6 offset:32768
  buffer_load_dwordx4 v10, s[28:31], s61 offen lds
  v_mfma_f32_16x16x32_bf16 v[80:83], a[180:183], a[64:67], v[80:83]
  v_fmac_f32 v232, v21, v28
  s_waitcnt lgkmcnt(5)
  v_mfma_f32_16x16x32_bf16 v[64:67], a[160:163], a[96:99], v[64:67]
  ds_read_b64_tr_b16 a[178:179], v6 offset:34816
  v_fmac_f32 v233, v21, v29
  v_mfma_f32_16x16x32_bf16 v[64:67], a[164:167], a[112:115], v[64:67]
  s_add_u32 m0, s45, 28672
  s_add_u32 s61, s70, 229376
  v_mfma_f32_16x16x32_bf16 v[68:71], a[164:167], a[116:119], v[68:71]
  ds_read_b64_tr_b16 a[180:181], v6 offset:36864
  buffer_load_dwordx4 v10, s[32:35], s61 offen lds
  v_mfma_f32_16x16x32_bf16 v[68:71], a[160:163], a[100:103], v[68:71]
  v_fmac_f32 v234, v21, v30
  v_fmac_f32 v235, v21, v31
  v_mfma_f32_16x16x32_bf16 v[72:75], a[160:163], a[104:107], v[72:75]
  ds_read_b64_tr_b16 a[182:183], v6 offset:38912
  v_fmac_f32 v236, v23, v28
  v_mfma_f32_16x16x32_bf16 v[72:75], a[164:167], a[120:123], v[72:75]
  v_fmac_f32 v237, v23, v29
  v_fmac_f32 v238, v23, v30
  v_mfma_f32_16x16x32_bf16 v[76:79], a[164:167], a[124:127], v[76:79]
  ds_read_b64_tr_b16 a[164:165], v6 offset:40960
  v_fmac_f32 v239, v23, v31
  v_mfma_f32_16x16x32_bf16 v[76:79], a[160:163], a[108:111], v[76:79]
  ds_read_b128 v[28:31], v12 offset:1728
  s_waitcnt lgkmcnt(6)
  v_mfma_f32_16x16x32_bf16 v[92:95], a[168:171], a[108:111], v[92:95]
  ds_read_b64_tr_b16 a[166:167], v6 offset:43008
  s_waitcnt lgkmcnt(12)
  v_mfma_f32_16x16x32_bf16 v[92:95], a[172:175], a[124:127], v[92:95]
  v_fmac_f32 v240, v16, v24
  v_fmac_f32 v241, v16, v25
  v_mfma_f32_16x16x32_bf16 v[88:91], a[172:175], a[120:123], v[88:91]
  ds_read_b64_tr_b16 a[160:161], v6 offset:45056
  v_fmac_f32 v242, v16, v26
  v_mfma_f32_16x16x32_bf16 v[88:91], a[168:171], a[104:107], v[88:91]
  v_fmac_f32 v243, v16, v27
  v_fmac_f32 v244, v18, v24
  v_mfma_f32_16x16x32_bf16 v[84:87], a[168:171], a[100:103], v[84:87]
  ds_read_b64_tr_b16 a[162:163], v6 offset:47104
  v_fmac_f32 v245, v18, v25
  v_mfma_f32_16x16x32_bf16 v[84:87], a[172:175], a[116:119], v[84:87]
  s_waitcnt vmcnt(12)
  s_barrier
  v_mfma_f32_16x16x32_bf16 v[80:83], a[172:175], a[112:115], v[80:83]
  ds_read_b64_tr_b16 a[172:173], v8 offset:16384
  v_fmac_f32 v246, v18, v26
  v_mfma_f32_16x16x32_bf16 v[80:83], a[168:171], a[96:99], v[80:83]
  v_fmac_f32 v247, v18, v27
  s_waitcnt lgkmcnt(6)
  v_mfma_f32_16x16x32_bf16 v[64:67], a[176:179], a[128:131], v[64:67]
  ds_read_b64_tr_b16 a[174:175], v8 offset:18432
  v_fmac_f32 v248, v20, v24
  v_mfma_f32_16x16x32_bf16 v[64:67], a[180:183], a[144:147], v[64:67]
  v_fmac_f32 v249, v20, v25
  v_fmac_f32 v250, v20, v26
  v_mfma_f32_16x16x32_bf16 v[68:71], a[180:183], a[148:151], v[68:71]
  ds_read_b64_tr_b16 a[168:169], v8 offset:20480
  v_fmac_f32 v251, v20, v27
  v_mfma_f32_16x16x32_bf16 v[68:71], a[176:179], a[132:135], v[68:71]
  v_fmac_f32 v252, v22, v24
  v_fmac_f32 v253, v22, v25
  v_mfma_f32_16x16x32_bf16 v[72:75], a[176:179], a[136:139], v[72:75]
  ds_read_b64_tr_b16 a[170:171], v8 offset:22528
  v_fmac_f32 v254, v22, v26
  v_mfma_f32_16x16x32_bf16 v[72:75], a[180:183], a[152:155], v[72:75]
  v_fmac_f32 v255, v22, v27
  s_waitcnt lgkmcnt(7)
  v_mfma_f32_16x16x32_bf16 v[76:79], a[180:183], a[156:159], v[76:79]
  ds_read_b64_tr_b16 a[180:181], v8 offset:24576
  v_fmac_f32 v240, v17, v28
  v_mfma_f32_16x16x32_bf16 v[76:79], a[176:179], a[140:143], v[76:79]
  v_fmac_f32 v241, v17, v29
  s_waitcnt lgkmcnt(5)
  v_mfma_f32_16x16x32_bf16 v[92:95], a[164:167], a[140:143], v[92:95]
  ds_read_b64_tr_b16 a[182:183], v8 offset:26624
  v_fmac_f32 v242, v17, v30
  v_mfma_f32_16x16x32_bf16 v[92:95], a[160:163], a[156:159], v[92:95]
  v_fmac_f32 v243, v17, v31
  v_fmac_f32 v244, v19, v28
  v_mfma_f32_16x16x32_bf16 v[88:91], a[160:163], a[152:155], v[88:91]
  ds_read_b64_tr_b16 a[176:177], v8 offset:28672
  v_fmac_f32 v245, v19, v29
  v_mfma_f32_16x16x32_bf16 v[88:91], a[164:167], a[136:139], v[88:91]
  v_fmac_f32 v246, v19, v30
  v_fmac_f32 v247, v19, v31
  v_mfma_f32_16x16x32_bf16 v[84:87], a[164:167], a[132:135], v[84:87]
  ds_read_b64_tr_b16 a[178:179], v8 offset:30720
  v_fmac_f32 v248, v21, v28
  v_mfma_f32_16x16x32_bf16 v[84:87], a[160:163], a[148:151], v[84:87]
  v_fmac_f32 v249, v21, v29
  v_fmac_f32 v250, v21, v30
  v_mfma_f32_16x16x32_bf16 v[80:83], a[160:163], a[144:147], v[80:83]
  ds_read_b64_tr_b16 a[160:161], v6 offset:16384
  v_fmac_f32 v251, v21, v31
  v_mfma_f32_16x16x32_bf16 v[80:83], a[164:167], a[128:131], v[80:83]
  v_fmac_f32 v252, v23, v28
  s_waitcnt vmcnt(9) lgkmcnt(5)
  v_mfma_f32_16x16x32_bf16 v[32:35], a[172:175], a[0:3], v[32:35]
  ds_read_b64_tr_b16 a[162:163], v6 offset:18432
  v_fmac_f32 v253, v23, v29
  v_mfma_f32_16x16x32_bf16 v[32:35], a[168:171], a[16:19], v[32:35]
  v_fmac_f32 v254, v23, v30
  v_fmac_f32 v255, v23, v31
  v_mfma_f32_16x16x32_bf16 v[36:39], a[168:171], a[20:23], v[36:39]
  ds_read_b64_tr_b16 a[164:165], v6 offset:20480
  v_mfma_f32_16x16x32_bf16 v[36:39], a[172:175], a[4:7], v[36:39]
  v_rcp_f32 v16, v17
  v_mfma_f32_16x16x32_bf16 v[40:43], a[172:175], a[8:11], v[40:43]
  ds_read_b64_tr_b16 a[166:167], v6 offset:22528
  s_add_u32 s62, s92, 10240
  v_mfma_f32_16x16x32_bf16 v[40:43], a[168:171], a[24:27], v[40:43]
  buffer_load_dword a253, v13, s[36:39], s62 offen
  v_mfma_f32_16x16x32_bf16 v[44:47], a[168:171], a[28:31], v[44:47]
  ds_read_b64_tr_b16 a[168:169], v6 offset:24576
  v_rcp_f32 v18, v19
  v_mfma_f32_16x16x32_bf16 v[44:47], a[172:175], a[12:15], v[44:47]
  s_waitcnt lgkmcnt(5)
  v_mfma_f32_16x16x32_bf16 v[60:63], a[180:183], a[12:15], v[60:63]
  ds_read_b64_tr_b16 a[170:171], v6 offset:26624
  v_rcp_f32 v20, v21
  v_mfma_f32_16x16x32_bf16 v[60:63], a[176:179], a[28:31], v[60:63]
  v_rcp_f32 v22, v23
  v_mfma_f32_16x16x32_bf16 v[56:59], a[176:179], a[24:27], v[56:59]
  ds_read_b64_tr_b16 a[172:173], v6 offset:28672
  v_mul_f32 v17, v17, v17
  v_mfma_f32_16x16x32_bf16 v[56:59], a[180:183], a[8:11], v[56:59]
  v_mul_f32 v19, v19, v19
  v_mul_f32 v21, v21, v21
  v_mfma_f32_16x16x32_bf16 v[52:55], a[180:183], a[4:7], v[52:55]
  ds_read_b64_tr_b16 a[174:175], v6 offset:30720
  v_mul_f32 v23, v23, v23
  v_mfma_f32_16x16x32_bf16 v[52:55], a[176:179], a[20:23], v[52:55]
  v_mul_f32 v16, 0xbfb8aa3b, v16
  v_mul_f32 v18, 0xbfb8aa3b, v18
  v_mfma_f32_16x16x32_bf16 v[48:51], a[176:179], a[16:19], v[48:51]
  ds_read_b64_tr_b16 a[176:177], v7 offset:0
  v_mul_f32 v20, 0xbfb8aa3b, v20
  v_mfma_f32_16x16x32_bf16 v[48:51], a[180:183], a[0:3], v[48:51]
  v_mul_f32 v22, 0xbfb8aa3b, v22
  s_waitcnt lgkmcnt(5)
  v_mfma_f32_16x16x32_bf16 v[64:67], a[160:163], a[0:3], v[64:67]
  ds_read_b64_tr_b16 a[178:179], v7 offset:2048
  v_mfma_f32_16x16x32_bf16 v[64:67], a[164:167], a[16:19], v[64:67]
  v_mfma_f32_16x16x32_bf16 v[68:71], a[164:167], a[20:23], v[68:71]
  ds_read_b64_tr_b16 a[180:181], v7 offset:4096
  v_mul_f32 v24, v16, v32
  v_mul_f32 v25, v16, v33
  v_mul_f32 v26, v16, v34
  v_mfma_f32_16x16x32_bf16 v[68:71], a[160:163], a[4:7], v[68:71]
  v_mul_f32 v27, v16, v35
  v_mul_f32 v28, v18, v36
  v_mul_f32 v29, v18, v37
  v_mfma_f32_16x16x32_bf16 v[72:75], a[160:163], a[8:11], v[72:75]
  ds_read_b64_tr_b16 a[182:183], v7 offset:6144
  v_mul_f32 v30, v18, v38
  v_mul_f32 v31, v18, v39
  v_mfma_f32_16x16x32_bf16 v[72:75], a[164:167], a[24:27], v[72:75]
  v_exp_f32 v24, v24
  v_mul_f32 v48, v32, v48
  v_mfma_f32_16x16x32_bf16 v[76:79], a[164:167], a[28:31], v[76:79]
  ds_read_b64_tr_b16 a[164:165], v7 offset:8192
  v_exp_f32 v25, v25
  v_mul_f32 v49, v33, v49
  v_mfma_f32_16x16x32_bf16 v[76:79], a[160:163], a[12:15], v[76:79]
  v_exp_f32 v26, v26
  v_mul_f32 v50, v34, v50
  s_waitcnt lgkmcnt(5)
  v_mfma_f32_16x16x32_bf16 v[92:95], a[168:171], a[12:15], v[92:95]
  ds_read_b64_tr_b16 a[166:167], v7 offset:10240
  v_exp_f32 v27, v27
  v_mul_f32 v51, v35, v51
  v_mfma_f32_16x16x32_bf16 v[92:95], a[172:175], a[28:31], v[92:95]
  v_exp_f32 v28, v28
  v_mul_f32 v52, v36, v52
  v_mfma_f32_16x16x32_bf16 v[88:91], a[172:175], a[24:27], v[88:91]
  ds_read_b64_tr_b16 a[160:161], v7 offset:12288
  v_exp_f32 v29, v29
  v_mul_f32 v53, v37, v53
  v_mfma_f32_16x16x32_bf16 v[88:91], a[168:171], a[8:11], v[88:91]
  v_exp_f32 v30, v30
  v_mul_f32 v54, v38, v54
  v_mfma_f32_16x16x32_bf16 v[84:87], a[168:171], a[4:7], v[84:87]
  ds_read_b64_tr_b16 a[162:163], v7 offset:14336
  v_exp_f32 v31, v31
  v_mul_f32 v55, v39, v55
  v_mfma_f32_16x16x32_bf16 v[84:87], a[172:175], a[20:23], v[84:87]
  v_fma_f32 v24, v24, v17, v17
  v_fma_f32 v25, v25, v17, v17
  v_fma_f32 v26, v26, v17, v17
  v_mfma_f32_16x16x32_bf16 v[80:83], a[172:175], a[16:19], v[80:83]
  ds_read_b64_tr_b16 a[172:173], v7 offset:49152
  v_fma_f32 v27, v27, v17, v17
  v_fma_f32 v28, v28, v19, v19
  v_fma_f32 v29, v29, v19, v19
  v_mfma_f32_16x16x32_bf16 v[80:83], a[168:171], a[0:3], v[80:83]
  v_fma_f32 v30, v30, v19, v19
  v_fma_f32 v31, v31, v19, v19
  s_waitcnt lgkmcnt(5)
  v_mfma_f32_16x16x32_bf16 v[96:99], a[176:179], a[64:67], v[96:99]
  ds_read_b64_tr_b16 a[174:175], v7 offset:51200
  v_rcp_f32 v24, v24
  v_mfma_f32_16x16x32_bf16 v[96:99], a[180:183], a[80:83], v[96:99]
  v_rcp_f32 v25, v25
  v_rcp_f32 v26, v26
  v_mfma_f32_16x16x32_bf16 v[100:103], a[180:183], a[84:87], v[100:103]
  ds_read_b64_tr_b16 a[168:169], v7 offset:53248
  v_rcp_f32 v27, v27
  v_mfma_f32_16x16x32_bf16 v[100:103], a[176:179], a[68:71], v[100:103]
  v_rcp_f32 v28, v28
  v_rcp_f32 v29, v29
  v_mfma_f32_16x16x32_bf16 v[104:107], a[176:179], a[72:75], v[104:107]
  ds_read_b64_tr_b16 a[170:171], v7 offset:55296
  v_rcp_f32 v30, v30
  v_mfma_f32_16x16x32_bf16 v[104:107], a[180:183], a[88:91], v[104:107]
  v_rcp_f32 v31, v31
  v_mul_f32 v48, v48, v24
  v_mul_f32 v49, v49, v25
  v_mfma_f32_16x16x32_bf16 v[108:111], a[180:183], a[92:95], v[108:111]
  ds_read_b64_tr_b16 a[180:181], v7 offset:57344
  v_mul_f32 v50, v50, v26
  v_mul_f32 v51, v51, v27
  v_mul_f32 v52, v52, v28
  v_mfma_f32_16x16x32_bf16 v[108:111], a[176:179], a[76:79], v[108:111]
  v_mul_f32 v53, v53, v29
  v_mul_f32 v54, v54, v30
  s_waitcnt lgkmcnt(5)
  v_mfma_f32_16x16x32_bf16 v[124:127], a[164:167], a[76:79], v[124:127]
  ds_read_b64_tr_b16 a[182:183], v7 offset:59392
  v_mul_f32 v55, v55, v31
  v_cvt_pk_bf16_f32 v32, v48, v49
  v_cvt_pk_bf16_f32 v33, v50, v51
  v_mfma_f32_16x16x32_bf16 v[124:127], a[160:163], a[92:95], v[124:127]
  buffer_store_dwordx2 v[32:33], v1, s[8:11], s60 offen sc1
  v_cvt_pk_bf16_f32 v36, v52, v53
  v_mfma_f32_16x16x32_bf16 v[120:123], a[160:163], a[88:91], v[120:123]
  ds_read_b64_tr_b16 a[176:177], v7 offset:61440
  v_cvt_pk_bf16_f32 v37, v54, v55
  s_add_u32 s55, s60, 262144
  buffer_store_dwordx2 v[36:37], v1, s[8:11], s55 offen sc1
  v_mfma_f32_16x16x32_bf16 v[120:123], a[164:167], a[72:75], v[120:123]
  v_mul_f32 v24, v20, v40
  v_mul_f32 v25, v20, v41
  v_mul_f32 v26, v20, v42
  v_mfma_f32_16x16x32_bf16 v[116:119], a[164:167], a[68:71], v[116:119]
  ds_read_b64_tr_b16 a[178:179], v7 offset:63488
  v_mul_f32 v27, v20, v43
  v_mul_f32 v28, v22, v44
  v_mul_f32 v29, v22, v45
  v_mfma_f32_16x16x32_bf16 v[116:119], a[160:163], a[84:87], v[116:119]
  v_mul_f32 v30, v22, v46
  v_mul_f32 v31, v22, v47
  v_mfma_f32_16x16x32_bf16 v[112:115], a[160:163], a[80:83], v[112:115]
  ds_read_b64_tr_b16 a[160:161], v7 offset:32768
  v_exp_f32 v24, v24
  v_mul_f32 v56, v40, v56
  v_mfma_f32_16x16x32_bf16 v[112:115], a[164:167], a[64:67], v[112:115]
  v_exp_f32 v25, v25
  v_mul_f32 v57, v41, v57
  s_waitcnt lgkmcnt(5)
  v_mfma_f32_16x16x32_bf16 v[96:99], a[172:175], a[96:99], v[96:99]
  ds_read_b64_tr_b16 a[162:163], v7 offset:34816
  v_exp_f32 v26, v26
  v_mul_f32 v58, v42, v58
  v_mfma_f32_16x16x32_bf16 v[96:99], a[168:171], a[112:115], v[96:99]
  v_exp_f32 v27, v27
  v_mul_f32 v59, v43, v59
  v_mfma_f32_16x16x32_bf16 v[100:103], a[168:171], a[116:119], v[100:103]
  ds_read_b64_tr_b16 a[164:165], v7 offset:36864
  v_exp_f32 v28, v28
  v_mul_f32 v60, v44, v60
  v_mfma_f32_16x16x32_bf16 v[100:103], a[172:175], a[100:103], v[100:103]
  v_exp_f32 v29, v29
  v_mul_f32 v61, v45, v61
  v_mfma_f32_16x16x32_bf16 v[104:107], a[172:175], a[104:107], v[104:107]
  ds_read_b64_tr_b16 a[166:167], v7 offset:38912
  v_exp_f32 v30, v30
  v_mul_f32 v62, v46, v62
  v_mfma_f32_16x16x32_bf16 v[104:107], a[168:171], a[120:123], v[104:107]
  v_exp_f32 v31, v31
  v_mul_f32 v63, v47, v63
  v_mfma_f32_16x16x32_bf16 v[108:111], a[168:171], a[124:127], v[108:111]
  ds_read_b64_tr_b16 a[168:169], v7 offset:40960
  v_fma_f32 v24, v24, v21, v21
  v_fma_f32 v25, v25, v21, v21
  v_fma_f32 v26, v26, v21, v21
  v_mfma_f32_16x16x32_bf16 v[108:111], a[172:175], a[108:111], v[108:111]
  v_fma_f32 v27, v27, v21, v21
  v_fma_f32 v28, v28, v23, v23
  s_waitcnt lgkmcnt(5)
  v_mfma_f32_16x16x32_bf16 v[124:127], a[180:183], a[108:111], v[124:127]
  ds_read_b64_tr_b16 a[170:171], v7 offset:43008
  v_fma_f32 v29, v29, v23, v23
  v_fma_f32 v30, v30, v23, v23
  v_fma_f32 v31, v31, v23, v23
  v_mfma_f32_16x16x32_bf16 v[124:127], a[176:179], a[124:127], v[124:127]
  v_rcp_f32 v24, v24
  v_mfma_f32_16x16x32_bf16 v[120:123], a[176:179], a[120:123], v[120:123]
  ds_read_b64_tr_b16 a[172:173], v7 offset:45056
  v_rcp_f32 v25, v25
  v_rcp_f32 v26, v26
  v_mfma_f32_16x16x32_bf16 v[120:123], a[180:183], a[104:107], v[120:123]
  v_rcp_f32 v27, v27
  v_mfma_f32_16x16x32_bf16 v[116:119], a[180:183], a[100:103], v[116:119]
  ds_read_b64_tr_b16 a[174:175], v7 offset:47104
  v_rcp_f32 v28, v28
  v_rcp_f32 v29, v29
  v_mfma_f32_16x16x32_bf16 v[116:119], a[176:179], a[116:119], v[116:119]
  v_rcp_f32 v30, v30
  v_mfma_f32_16x16x32_bf16 v[112:115], a[176:179], a[112:115], v[112:115]
  ds_read_b64_tr_b16 a[176:177], v7 offset:16384
  v_rcp_f32 v31, v31
  v_mul_f32 v56, v56, v24
  v_mul_f32 v57, v57, v25
  v_mfma_f32_16x16x32_bf16 v[112:115], a[180:183], a[96:99], v[112:115]
  v_mul_f32 v58, v58, v26
  v_mul_f32 v59, v59, v27
  s_waitcnt lgkmcnt(5)
  v_mfma_f32_16x16x32_bf16 v[96:99], a[160:163], a[128:131], v[96:99]
  ds_read_b64_tr_b16 a[178:179], v7 offset:18432
  v_mul_f32 v60, v60, v28
  v_mul_f32 v61, v61, v29
  v_mul_f32 v62, v62, v30
  v_mfma_f32_16x16x32_bf16 v[96:99], a[164:167], a[144:147], v[96:99]
  v_mul_f32 v63, v63, v31
  v_cvt_pk_bf16_f32 v40, v56, v57
  v_cvt_pk_bf16_f32 v41, v58, v59
  v_mfma_f32_16x16x32_bf16 v[100:103], a[164:167], a[148:151], v[100:103]
  ds_read_b64_tr_b16 a[180:181], v7 offset:20480
  s_add_u32 s55, s60, 524288
  buffer_store_dwordx2 v[40:41], v1, s[8:11], s55 offen sc1
  v_cvt_pk_bf16_f32 v44, v60, v61
  v_mfma_f32_16x16x32_bf16 v[100:103], a[160:163], a[132:135], v[100:103]
  v_cvt_pk_bf16_f32 v45, v62, v63
  s_add_u32 s55, s60, 786432
  buffer_store_dwordx2 v[44:45], v1, s[8:11], s55 offen sc1
  v_mfma_f32_16x16x32_bf16 v[104:107], a[160:163], a[136:139], v[104:107]
  ds_read_b64_tr_b16 a[182:183], v7 offset:22528
  v_mul_f32 v24, v16, v64
  v_mul_f32 v25, v16, v65
  v_mfma_f32_16x16x32_bf16 v[104:107], a[164:167], a[152:155], v[104:107]
  v_mul_f32 v26, v16, v66
  v_mul_f32 v27, v16, v67
  v_mul_f32 v28, v18, v68
  v_mul_f32 v29, v18, v69
  v_mfma_f32_16x16x32_bf16 v[108:111], a[164:167], a[156:159], v[108:111]
  ds_read_b64_tr_b16 a[164:165], v7 offset:24576
  v_mul_f32 v30, v18, v70
  v_mul_f32 v31, v18, v71
  v_mfma_f32_16x16x32_bf16 v[108:111], a[160:163], a[140:143], v[108:111]
  v_exp_f32 v24, v24
  v_mul_f32 v80, v64, v80
  s_waitcnt lgkmcnt(5)
  v_mfma_f32_16x16x32_bf16 v[124:127], a[168:171], a[140:143], v[124:127]
  ds_read_b64_tr_b16 a[166:167], v7 offset:26624
  v_exp_f32 v25, v25
  v_mfma_f32_16x16x32_bf16 v[124:127], a[172:175], a[156:159], v[124:127]
  v_mul_f32 v81, v65, v81
  v_exp_f32 v26, v26
  v_mul_f32 v82, v66, v82
  v_mfma_f32_16x16x32_bf16 v[120:123], a[172:175], a[152:155], v[120:123]
  ds_read_b64_tr_b16 a[160:161], v7 offset:28672
  s_add_u32 s62, s92, 12288
  v_mfma_f32_16x16x32_bf16 v[120:123], a[168:171], a[136:139], v[120:123]
  buffer_load_dword a253, v13, s[36:39], s62 offen
  v_exp_f32 v27, v27
  v_mul_f32 v83, v67, v83
  v_mfma_f32_16x16x32_bf16 v[116:119], a[168:171], a[132:135], v[116:119]
  ds_read_b64_tr_b16 a[162:163], v7 offset:30720
  v_exp_f32 v28, v28
  v_mul_f32 v84, v68, v84
  v_mfma_f32_16x16x32_bf16 v[116:119], a[172:175], a[148:151], v[116:119]
  v_exp_f32 v29, v29
  v_mul_f32 v85, v69, v85
  v_mfma_f32_16x16x32_bf16 v[112:115], a[172:175], a[144:147], v[112:115]
  ds_read_b64_tr_b16 a[172:173], v2 offset:0
  v_lshrrev_b32 v48, 3, v0
  v_bfe_u32 v49, v48, 1, 2
  v_bfe_u32 v50, v0, 1, 2
  v_mfma_f32_16x16x32_bf16 v[112:115], a[168:171], a[128:131], v[112:115]
  v_xor_b32 v49, v49, v50
  v_lshlrev_b32 v49, 5, v49
  s_waitcnt lgkmcnt(5)
  v_mfma_f32_16x16x32_bf16 v[96:99], a[176:179], a[0:3], v[96:99]
  ds_read_b64_tr_b16 a[174:175], v2 offset:2048
  v_and_b32 v50, 1, v0
  v_lshl_add_u32 v49, v50, 4, v49
  s_lshl_b32 s53, s44, 3
  v_mfma_f32_16x16x32_bf16 v[96:99], a[180:183], a[16:19], v[96:99]
  v_add_u32 v48, s53, v48
  v_lshl_add_u32 v48, v48, 11, v49
  s_mul_i32 s53, s52, 1835008
  v_mfma_f32_16x16x32_bf16 v[100:103], a[180:183], a[20:23], v[100:103]
  ds_read_b64_tr_b16 a[168:169], v2 offset:4096
  s_lshl_b32 s54, s51, 7
  s_add_u32 s53, s53, s54
  v_add_u32 v33, s53, v48
  v_mfma_f32_16x16x32_bf16 v[100:103], a[176:179], a[4:7], v[100:103]
  v_xor_b32 v32, 128, v33
  v_and_b32 v48, 3, v0
  v_bfe_u32 v49, v0, 2, 1
  v_mfma_f32_16x16x32_bf16 v[104:107], a[176:179], a[8:11], v[104:107]
  ds_read_b64_tr_b16 a[170:171], v2 offset:6144
  v_lshl_add_u32 v48, v48, 3, v49
  v_lshlrev_b32 v37, 7, v48
  v_mfma_f32_16x16x32_bf16 v[104:107], a[180:183], a[24:27], v[104:107]
  v_exp_f32 v30, v30
  v_mul_f32 v86, v70, v86
  v_mfma_f32_16x16x32_bf16 v[108:111], a[180:183], a[28:31], v[108:111]
  ds_read_b64_tr_b16 a[180:181], v2 offset:8192
  v_exp_f32 v31, v31
  v_mul_f32 v87, v71, v87
  v_mfma_f32_16x16x32_bf16 v[108:111], a[176:179], a[12:15], v[108:111]
  v_fma_f32 v24, v24, v17, v17
  v_fma_f32 v25, v25, v17, v17
  v_fma_f32 v26, v26, v17, v17
  s_waitcnt lgkmcnt(5)
  v_mfma_f32_16x16x32_bf16 v[124:127], a[164:167], a[12:15], v[124:127]
  ds_read_b64_tr_b16 a[182:183], v2 offset:10240
  v_fma_f32 v27, v27, v17, v17
  v_fma_f32 v28, v28, v19, v19
  v_mfma_f32_16x16x32_bf16 v[124:127], a[160:163], a[28:31], v[124:127]
  v_fma_f32 v29, v29, v19, v19
  v_fma_f32 v30, v30, v19, v19
  v_fma_f32 v31, v31, v19, v19
  v_mfma_f32_16x16x32_bf16 v[120:123], a[160:163], a[24:27], v[120:123]
  ds_read_b64_tr_b16 a[176:177], v2 offset:12288
  v_rcp_f32 v24, v24
  v_mfma_f32_16x16x32_bf16 v[120:123], a[164:167], a[8:11], v[120:123]
  v_rcp_f32 v25, v25
  v_rcp_f32 v26, v26
  v_mfma_f32_16x16x32_bf16 v[116:119], a[164:167], a[4:7], v[116:119]
  ds_read_b64_tr_b16 a[178:179], v2 offset:14336
  v_rcp_f32 v27, v27
  v_mfma_f32_16x16x32_bf16 v[116:119], a[160:163], a[20:23], v[116:119]
  v_rcp_f32 v28, v28
  v_rcp_f32 v29, v29
  v_mfma_f32_16x16x32_bf16 v[112:115], a[160:163], a[16:19], v[112:115]
  ds_read_b64_tr_b16 a[160:161], v3 offset:0
  v_rcp_f32 v30, v30
  v_mfma_f32_16x16x32_bf16 v[112:115], a[164:167], a[0:3], v[112:115]
  v_rcp_f32 v31, v31
  v_mul_f32 v80, v80, v24
  s_waitcnt lgkmcnt(5)
  v_mfma_f32_16x16x32_bf16 v[128:131], a[172:175], a[32:35], v[128:131]
  ds_read_b64_tr_b16 a[162:163], v3 offset:2048
  v_mul_f32 v81, v81, v25
  s_waitcnt vmcnt(11)
  s_barrier
  v_mfma_f32_16x16x32_bf16 v[128:131], a[168:171], a[48:51], v[128:131]
  v_mul_f32 v82, v82, v26
  v_mul_f32 v83, v83, v27
  v_mul_f32 v84, v84, v28
  v_mfma_f32_16x16x32_bf16 v[132:135], a[168:171], a[52:55], v[132:135]
  ds_read_b64_tr_b16 a[164:165], v3 offset:4096
  v_mul_f32 v85, v85, v29
  v_mul_f32 v86, v86, v30
  v_mul_f32 v87, v87, v31
  v_mfma_f32_16x16x32_bf16 v[132:135], a[172:175], a[36:39], v[132:135]
  v_cvt_pk_bf16_f32 v64, v80, v81
  v_cvt_pk_bf16_f32 v65, v82, v83
  v_cvt_pk_bf16_f32 v68, v84, v85
  v_mfma_f32_16x16x32_bf16 v[136:139], a[172:175], a[40:43], v[136:139]
  ds_read_b64_tr_b16 a[166:167], v3 offset:6144
  v_cvt_pk_bf16_f32 v69, v86, v87
  v_mul_f32 v24, v20, v72
  v_mul_f32 v25, v20, v73
  v_mfma_f32_16x16x32_bf16 v[136:139], a[168:171], a[56:59], v[136:139]
  v_mul_f32 v26, v20, v74
  v_mul_f32 v27, v20, v75
  v_mul_f32 v28, v22, v76
  v_mfma_f32_16x16x32_bf16 v[140:143], a[168:171], a[60:63], v[140:143]
  ds_read_b64_tr_b16 a[168:169], v3 offset:8192
  v_mul_f32 v29, v22, v77
  v_mul_f32 v30, v22, v78
  v_mul_f32 v31, v22, v79
  v_mfma_f32_16x16x32_bf16 v[140:143], a[172:175], a[44:47], v[140:143]
  v_exp_f32 v24, v24
  s_waitcnt lgkmcnt(5)
  v_mfma_f32_16x16x32_bf16 v[156:159], a[180:183], a[44:47], v[156:159]
  ds_read_b64_tr_b16 a[170:171], v3 offset:10240
  v_mul_f32 v88, v72, v88
  v_exp_f32 v25, v25
  v_mfma_f32_16x16x32_bf16 v[156:159], a[176:179], a[60:63], v[156:159]
  v_mul_f32 v89, v73, v89
  v_exp_f32 v26, v26
  v_mfma_f32_16x16x32_bf16 v[152:155], a[176:179], a[56:59], v[152:155]
  ds_read_b64_tr_b16 a[172:173], v3 offset:12288
  v_mul_f32 v90, v74, v90
  v_mfma_f32_16x16x32_bf16 v[152:155], a[180:183], a[40:43], v[152:155]
  v_exp_f32 v27, v27
  v_mul_f32 v91, v75, v91
  v_mfma_f32_16x16x32_bf16 v[148:151], a[180:183], a[36:39], v[148:151]
  ds_read_b64_tr_b16 a[174:175], v3 offset:14336
  v_exp_f32 v28, v28
  v_mul_f32 v92, v76, v92
  v_mfma_f32_16x16x32_bf16 v[148:151], a[176:179], a[52:55], v[148:151]
  v_exp_f32 v29, v29
  v_mul_f32 v93, v77, v93
  v_mfma_f32_16x16x32_bf16 v[144:147], a[176:179], a[48:51], v[144:147]
  ds_read_b64_tr_b16 a[176:177], v4 offset:0
  v_exp_f32 v30, v30
  v_mul_f32 v94, v78, v94
  v_mfma_f32_16x16x32_bf16 v[144:147], a[180:183], a[32:35], v[144:147]
  v_exp_f32 v31, v31
  v_mul_f32 v95, v79, v95
  s_waitcnt lgkmcnt(5)
  v_mfma_f32_16x16x32_bf16 v[160:163], a[160:163], a[32:35], v[160:163]
  ds_read_b64_tr_b16 a[178:179], v4 offset:2048
  v_fma_f32 v24, v24, v21, v21
  v_fma_f32 v25, v25, v21, v21
  v_mfma_f32_16x16x32_bf16 v[160:163], a[164:167], a[48:51], v[160:163]
  v_fma_f32 v26, v26, v21, v21
  v_fma_f32 v27, v27, v21, v21
  v_fma_f32 v28, v28, v23, v23
  v_fma_f32 v29, v29, v23, v23
  v_mfma_f32_16x16x32_bf16 v[164:167], a[164:167], a[52:55], v[164:167]
  ds_read_b64_tr_b16 a[180:181], v4 offset:4096
  v_fma_f32 v30, v30, v23, v23
  v_fma_f32 v31, v31, v23, v23
  v_mfma_f32_16x16x32_bf16 v[164:167], a[160:163], a[36:39], v[164:167]
  v_rcp_f32 v24, v24
  v_rcp_f32 v25, v25
  v_mfma_f32_16x16x32_bf16 v[168:171], a[160:163], a[40:43], v[168:171]
  ds_read_b64_tr_b16 a[182:183], v4 offset:6144
  v_rcp_f32 v26, v26
  v_mfma_f32_16x16x32_bf16 v[168:171], a[164:167], a[56:59], v[168:171]
  v_rcp_f32 v27, v27
  v_rcp_f32 v28, v28
  v_mfma_f32_16x16x32_bf16 v[172:175], a[164:167], a[60:63], v[172:175]
  ds_read_b64_tr_b16 a[164:165], v4 offset:8192
  v_rcp_f32 v29, v29
  v_mfma_f32_16x16x32_bf16 v[172:175], a[160:163], a[44:47], v[172:175]
  v_rcp_f32 v30, v30
  s_waitcnt lgkmcnt(5)
  v_mfma_f32_16x16x32_bf16 v[188:191], a[168:171], a[44:47], v[188:191]
  ds_read_b64_tr_b16 a[166:167], v4 offset:10240
  v_rcp_f32 v31, v31
  v_mul_f32 v88, v88, v24
  v_mfma_f32_16x16x32_bf16 v[188:191], a[172:175], a[60:63], v[188:191]
  v_mul_f32 v89, v89, v25
  v_mul_f32 v90, v90, v26
  v_mul_f32 v91, v91, v27
  v_mul_f32 v92, v92, v28
  v_mfma_f32_16x16x32_bf16 v[184:187], a[172:175], a[56:59], v[184:187]
  ds_read_b64_tr_b16 a[160:161], v4 offset:12288
  v_mul_f32 v93, v93, v29
  v_mul_f32 v94, v94, v30
  v_mfma_f32_16x16x32_bf16 v[184:187], a[168:171], a[40:43], v[184:187]
  v_mul_f32 v95, v95, v31
  v_cvt_pk_bf16_f32 v72, v88, v89
  v_cvt_pk_bf16_f32 v73, v90, v91
  v_cvt_pk_bf16_f32 v76, v92, v93
  v_cvt_pk_bf16_f32 v77, v94, v95
  v_mfma_f32_16x16x32_bf16 v[180:183], a[168:171], a[36:39], v[180:183]
  ds_read_b64_tr_b16 a[162:163], v4 offset:14336
  s_cmp_eq_u32 s91, 0
  s_cselect_b32 s72, 8, 1
  s_lshl_b32 s64, s72, 17
  s_lshl_b32 s72, s72, 11
  s_add_u32 s72, s72, s84
  s_add_u32 m0, s45, 65536
  v_mul_f32 v24, v16, v96
  v_mul_f32 v25, v16, v97
  v_mfma_f32_16x16x32_bf16 v[180:183], a[172:175], a[52:55], v[180:183]
  buffer_load_dwordx4 v32, s[36:39], s64 offen lds
  v_mul_f32 v26, v16, v98
  v_mul_f32 v27, v16, v99
  v_mul_f32 v28, v18, v100
  v_mfma_f32_16x16x32_bf16 v[176:179], a[172:175], a[48:51], v[176:179]
  ds_read_b64_tr_b16 a[172:173], v5 offset:0
  v_mul_f32 v29, v18, v101
  v_mul_f32 v30, v18, v102
  v_mul_f32 v31, v18, v103
  v_mfma_f32_16x16x32_bf16 v[176:179], a[168:171], a[32:35], v[176:179]
  v_exp_f32 v24, v24
  v_mul_f32 v112, v96, v112
  s_waitcnt lgkmcnt(5)
  v_mfma_f32_16x16x32_bf16 v[192:195], a[176:179], a[32:35], v[192:195]
  ds_read_b64_tr_b16 a[174:175], v5 offset:2048
  s_add_u32 m0, s45, 69632
  s_add_u32 s61, s64, 65536
  v_exp_f32 v25, v25
  v_mfma_f32_16x16x32_bf16 v[192:195], a[180:183], a[48:51], v[192:195]
  buffer_load_dwordx4 v32, s[36:39], s61 offen lds
  v_mul_f32 v113, v97, v113
  v_exp_f32 v26, v26
  v_mfma_f32_16x16x32_bf16 v[196:199], a[180:183], a[52:55], v[196:199]
  ds_read_b64_tr_b16 a[168:169], v5 offset:4096
  v_mul_f32 v114, v98, v114
  v_exp_f32 v27, v27
  v_mfma_f32_16x16x32_bf16 v[196:199], a[176:179], a[36:39], v[196:199]
  v_mul_f32 v115, v99, v115
  v_exp_f32 v28, v28
  v_mul_f32 v116, v100, v116
  v_mfma_f32_16x16x32_bf16 v[200:203], a[176:179], a[40:43], v[200:203]
  ds_read_b64_tr_b16 a[170:171], v5 offset:6144
  s_add_u32 m0, s45, 73728
  v_exp_f32 v29, v29
  v_mul_f32 v117, v101, v117
  v_mfma_f32_16x16x32_bf16 v[200:203], a[180:183], a[56:59], v[200:203]
  buffer_load_dwordx4 v33, s[36:39], s64 offen lds
  v_exp_f32 v30, v30
  v_mul_f32 v118, v102, v118
  v_mfma_f32_16x16x32_bf16 v[204:207], a[180:183], a[60:63], v[204:207]
  ds_read_b64_tr_b16 a[180:181], v5 offset:8192
  v_exp_f32 v31, v31
  v_mul_f32 v119, v103, v119
  v_mfma_f32_16x16x32_bf16 v[204:207], a[176:179], a[44:47], v[204:207]
  v_fma_f32 v24, v24, v17, v17
  v_fma_f32 v25, v25, v17, v17
  v_fma_f32 v26, v26, v17, v17
  s_waitcnt lgkmcnt(5)
  v_mfma_f32_16x16x32_bf16 v[220:223], a[164:167], a[44:47], v[220:223]
  ds_read_b64_tr_b16 a[182:183], v5 offset:10240
  s_add_u32 m0, s45, 77824
  s_add_u32 s61, s64, 65536
  v_fma_f32 v27, v27, v17, v17
  v_mfma_f32_16x16x32_bf16 v[220:223], a[160:163], a[60:63], v[220:223]
  buffer_load_dwordx4 v33, s[36:39], s61 offen lds
  v_fma_f32 v28, v28, v19, v19
  v_fma_f32 v29, v29, v19, v19
  v_fma_f32 v30, v30, v19, v19
  v_fma_f32 v31, v31, v19, v19
  v_mfma_f32_16x16x32_bf16 v[216:219], a[160:163], a[56:59], v[216:219]
  ds_read_b64_tr_b16 a[176:177], v5 offset:12288
  v_rcp_f32 v24, v24
  v_mfma_f32_16x16x32_bf16 v[216:219], a[164:167], a[40:43], v[216:219]
  v_rcp_f32 v25, v25
  v_rcp_f32 v26, v26
  v_mfma_f32_16x16x32_bf16 v[212:215], a[164:167], a[36:39], v[212:215]
  ds_read_b64_tr_b16 a[178:179], v5 offset:14336
  s_cmp_eq_u32 s91, 1
  s_cselect_b32 s73, 10, 3
  s_lshl_b32 s65, s73, 17
  s_lshl_b32 s73, s73, 11
  s_add_u32 s73, s73, s84
  s_add_u32 m0, s45, 114688
  v_rcp_f32 v27, v27
  v_mfma_f32_16x16x32_bf16 v[212:215], a[160:163], a[52:55], v[212:215]
  buffer_load_dwordx4 v32, s[36:39], s65 offen lds
  v_rcp_f32 v28, v28
  v_rcp_f32 v29, v29
  v_mfma_f32_16x16x32_bf16 v[208:211], a[160:163], a[48:51], v[208:211]
  ds_read_b64_tr_b16 a[160:161], v2 offset:32768
  v_rcp_f32 v30, v30
  v_mfma_f32_16x16x32_bf16 v[208:211], a[164:167], a[32:35], v[208:211]
HOP14:
  s_cbranch_execz HOP17
  v_rcp_f32 v31, v31
  v_mul_f32 v112, v112, v24
  v_mul_f32 v113, v113, v25
  s_waitcnt lgkmcnt(5)
  v_mfma_f32_16x16x32_bf16 v[224:227], a[172:175], a[32:35], v[224:227]
  ds_read_b64_tr_b16 a[162:163], v2 offset:34816
  s_add_u32 m0, s45, 118784
  s_add_u32 s61, s65, 65536
  v_mul_f32 v114, v114, v26
  v_mfma_f32_16x16x32_bf16 v[224:227], a[168:171], a[48:51], v[224:227]
  buffer_load_dwordx4 v32, s[36:39], s61 offen lds
  v_mul_f32 v115, v115, v27
  v_mul_f32 v116, v116, v28
  v_mul_f32 v117, v117, v29
  v_mul_f32 v118, v118, v30
  v_mfma_f32_16x16x32_bf16 v[228:231], a[168:171], a[52:55], v[228:231]
  ds_read_b64_tr_b16 a[164:165], v2 offset:36864
  v_mul_f32 v119, v119, v31
  v_cvt_pk_bf16_f32 v66, v112, v113
  v_cvt_pk_bf16_f32 v67, v114, v115
  v_mfma_f32_16x16x32_bf16 v[228:231], a[172:175], a[36:39], v[228:231]
  buffer_store_dwordx4 v[64:67], v1, s[8:11], s59 offen offset:0 sc1
  v_cvt_pk_bf16_f32 v70, v116, v117
  v_cvt_pk_bf16_f32 v71, v118, v119
  v_mfma_f32_16x16x32_bf16 v[232:235], a[172:175], a[40:43], v[232:235]
  ds_read_b64_tr_b16 a[166:167], v2 offset:38912
  s_add_u32 m0, s45, 122880
  s_add_u32 s55, s59, 262144
  buffer_store_dwordx4 v[68:71], v1, s[8:11], s55 offen offset:0 sc1
  v_mfma_f32_16x16x32_bf16 v[232:235], a[168:171], a[56:59], v[232:235]
  buffer_load_dwordx4 v33, s[36:39], s65 offen lds
  v_mul_f32 v24, v20, v104
  v_mul_f32 v25, v20, v105
  v_mul_f32 v26, v20, v106
  v_mfma_f32_16x16x32_bf16 v[236:239], a[168:171], a[60:63], v[236:239]
  ds_read_b64_tr_b16 a[168:169], v2 offset:40960
  v_mul_f32 v27, v20, v107
  v_mul_f32 v28, v22, v108
  v_mul_f32 v29, v22, v109
  v_mfma_f32_16x16x32_bf16 v[236:239], a[172:175], a[44:47], v[236:239]
  v_mul_f32 v30, v22, v110
  v_mul_f32 v31, v22, v111
  v_exp_f32 v24, v24
  s_waitcnt lgkmcnt(5)
  v_mfma_f32_16x16x32_bf16 v[252:255], a[180:183], a[44:47], v[252:255]
  ds_read_b64_tr_b16 a[170:171], v2 offset:43008
  s_add_u32 m0, s45, 126976
  s_add_u32 s61, s65, 65536
  v_mul_f32 v120, v104, v120
  v_mfma_f32_16x16x32_bf16 v[252:255], a[176:179], a[60:63], v[252:255]
  buffer_load_dwordx4 v33, s[36:39], s61 offen lds
  v_exp_f32 v25, v25
  v_mul_f32 v121, v105, v121
  v_mfma_f32_16x16x32_bf16 v[248:251], a[176:179], a[56:59], v[248:251]
  ds_read_b64_tr_b16 a[172:173], v2 offset:45056
  v_exp_f32 v26, v26
  v_mul_f32 v122, v106, v122
  v_mfma_f32_16x16x32_bf16 v[248:251], a[180:183], a[40:43], v[248:251]
  v_exp_f32 v27, v27
  v_mul_f32 v123, v107, v123
  v_mfma_f32_16x16x32_bf16 v[244:247], a[180:183], a[36:39], v[244:247]
  ds_read_b64_tr_b16 a[174:175], v2 offset:47104
  s_cmp_eq_u32 s91, 2
  s_cselect_b32 s74, 12, 5
  s_lshl_b32 s66, s74, 17
  s_lshl_b32 s74, s74, 11
  s_add_u32 s74, s74, s84
  s_add_u32 m0, s45, 98304
  v_exp_f32 v28, v28
  v_mul_f32 v124, v108, v124
  v_mfma_f32_16x16x32_bf16 v[244:247], a[176:179], a[52:55], v[244:247]
  buffer_load_dwordx4 v32, s[36:39], s66 offen lds
  v_exp_f32 v29, v29
  v_mul_f32 v125, v109, v125
  v_mfma_f32_16x16x32_bf16 v[240:243], a[176:179], a[48:51], v[240:243]
  ds_read_b64_tr_b16 a[176:177], v2 offset:49152
  v_exp_f32 v30, v30
  v_mul_f32 v126, v110, v126
  v_mfma_f32_16x16x32_bf16 v[240:243], a[180:183], a[32:35], v[240:243]
  v_exp_f32 v31, v31
  v_mul_f32 v127, v111, v127
  v_fma_f32 v24, v24, v21, v21
  s_waitcnt lgkmcnt(5)
  v_mfma_f32_16x16x32_bf16 v[128:131], a[160:163], a[64:67], v[128:131]
  ds_read_b64_tr_b16 a[178:179], v2 offset:51200
  s_add_u32 m0, s45, 102400
  s_add_u32 s61, s66, 65536
  s_waitcnt vmcnt(17)
  s_barrier
  v_mfma_f32_16x16x32_bf16 v[128:131], a[164:167], a[80:83], v[128:131]
  buffer_load_dwordx4 v32, s[36:39], s61 offen lds
  v_fma_f32 v25, v25, v21, v21
  v_fma_f32 v26, v26, v21, v21
  v_mfma_f32_16x16x32_bf16 v[132:135], a[164:167], a[84:87], v[132:135]
  ds_read_b64_tr_b16 a[180:181], v2 offset:53248
  v_fma_f32 v27, v27, v21, v21
  v_fma_f32 v28, v28, v23, v23
  v_fma_f32 v29, v29, v23, v23
  v_mfma_f32_16x16x32_bf16 v[132:135], a[160:163], a[68:71], v[132:135]
  v_fma_f32 v30, v30, v23, v23
  v_fma_f32 v31, v31, v23, v23
  v_rcp_f32 v24, v24
  v_mfma_f32_16x16x32_bf16 v[136:139], a[160:163], a[72:75], v[136:139]
  ds_read_b64_tr_b16 a[182:183], v2 offset:55296
  s_add_u32 m0, s45, 0
  v_rcp_f32 v25, v25
  v_mfma_f32_16x16x32_bf16 v[136:139], a[164:167], a[88:91], v[136:139]
  buffer_load_dwordx4 v10, s[28:31], s71 offen lds
  v_rcp_f32 v26, v26
  v_rcp_f32 v27, v27
  v_mfma_f32_16x16x32_bf16 v[140:143], a[164:167], a[92:95], v[140:143]
  ds_read_b64_tr_b16 a[164:165], v2 offset:57344
  v_rcp_f32 v28, v28
  v_mfma_f32_16x16x32_bf16 v[140:143], a[160:163], a[76:79], v[140:143]
  v_rcp_f32 v29, v29
  v_rcp_f32 v30, v30
  s_waitcnt lgkmcnt(5)
  v_mfma_f32_16x16x32_bf16 v[156:159], a[168:171], a[76:79], v[156:159]
  ds_read_b64_tr_b16 a[166:167], v2 offset:59392
  s_add_u32 m0, s45, 8192
  v_rcp_f32 v31, v31
  v_mfma_f32_16x16x32_bf16 v[156:159], a[172:175], a[92:95], v[156:159]
  buffer_load_dwordx4 v10, s[32:35], s71 offen lds
  v_mul_f32 v120, v120, v24
  v_mul_f32 v121, v121, v25
  v_mul_f32 v122, v122, v26
  v_mul_f32 v123, v123, v27
  v_mfma_f32_16x16x32_bf16 v[152:155], a[172:175], a[88:91], v[152:155]
  ds_read_b64_tr_b16 a[160:161], v2 offset:61440
  v_mul_f32 v124, v124, v28
  v_mul_f32 v125, v125, v29
  v_mul_f32 v126, v126, v30
  v_mfma_f32_16x16x32_bf16 v[152:155], a[168:171], a[72:75], v[152:155]
  v_mul_f32 v127, v127, v31
  v_cvt_pk_bf16_f32 v74, v120, v121
  v_cvt_pk_bf16_f32 v75, v122, v123
  v_mfma_f32_16x16x32_bf16 v[148:151], a[168:171], a[68:71], v[148:151]
  ds_read_b64_tr_b16 a[162:163], v2 offset:63488
  s_add_u32 m0, s45, 4096
  s_add_u32 s61, s71, 229376
  s_add_u32 s55, s59, 524288
  buffer_store_dwordx4 v[72:75], v1, s[8:11], s55 offen offset:0 sc1
  v_mfma_f32_16x16x32_bf16 v[148:151], a[172:175], a[84:87], v[148:151]
  buffer_load_dwordx4 v10, s[28:31], s61 offen lds
  v_cvt_pk_bf16_f32 v78, v124, v125
  v_cvt_pk_bf16_f32 v79, v126, v127
  s_add_u32 s55, s59, 786432
  buffer_store_dwordx4 v[76:79], v1, s[8:11], s55 offen offset:0 sc1
  v_mfma_f32_16x16x32_bf16 v[144:147], a[172:175], a[80:83], v[144:147]
  ds_read_b64_tr_b16 a[172:173], v2 offset:16384
  v_mfma_f32_16x16x32_bf16 v[144:147], a[168:171], a[64:67], v[144:147]
  s_waitcnt lgkmcnt(5)
  v_mfma_f32_16x16x32_bf16 v[128:131], a[176:179], a[96:99], v[128:131]
  ds_read_b64_tr_b16 a[174:175], v2 offset:18432
  s_add_u32 m0, s45, 12288
  s_add_u32 s61, s71, 229376
  v_mfma_f32_16x16x32_bf16 v[128:131], a[180:183], a[112:115], v[128:131]
  buffer_load_dwordx4 v10, s[32:35], s61 offen lds
  v_mfma_f32_16x16x32_bf16 v[132:135], a[180:183], a[116:119], v[132:135]
  ds_read_b64_tr_b16 a[168:169], v2 offset:20480
  v_mfma_f32_16x16x32_bf16 v[132:135], a[176:179], a[100:103], v[132:135]
  v_mfma_f32_16x16x32_bf16 v[136:139], a[176:179], a[104:107], v[136:139]
  ds_read_b64_tr_b16 a[170:171], v2 offset:22528
  s_add_u32 m0, s45, 106496
  v_mfma_f32_16x16x32_bf16 v[136:139], a[180:183], a[120:123], v[136:139]
  buffer_load_dwordx4 v33, s[36:39], s66 offen lds
  v_mfma_f32_16x16x32_bf16 v[140:143], a[180:183], a[124:127], v[140:143]
  ds_read_b64_tr_b16 a[180:181], v2 offset:24576
  v_mfma_f32_16x16x32_bf16 v[140:143], a[176:179], a[108:111], v[140:143]
  s_waitcnt lgkmcnt(5)
  v_mfma_f32_16x16x32_bf16 v[156:159], a[164:167], a[108:111], v[156:159]
  ds_read_b64_tr_b16 a[182:183], v2 offset:26624
  s_add_u32 m0, s45, 110592
  s_add_u32 s61, s66, 65536
  v_mfma_f32_16x16x32_bf16 v[156:159], a[160:163], a[124:127], v[156:159]
  buffer_load_dwordx4 v33, s[36:39], s61 offen lds
  v_mfma_f32_16x16x32_bf16 v[152:155], a[160:163], a[120:123], v[152:155]
  ds_read_b64_tr_b16 a[176:177], v2 offset:28672
  v_mfma_f32_16x16x32_bf16 v[152:155], a[164:167], a[104:107], v[152:155]
  v_mfma_f32_16x16x32_bf16 v[148:151], a[164:167], a[100:103], v[148:151]
  ds_read_b64_tr_b16 a[178:179], v2 offset:30720
  s_cmp_eq_u32 s91, 0
  s_cselect_b32 s75, 1, 8
  s_lshl_b32 s67, s75, 17
  s_lshl_b32 s75, s75, 11
  s_add_u32 s75, s75, s84
  s_add_u32 m0, s45, 81920
  v_mfma_f32_16x16x32_bf16 v[148:151], a[160:163], a[116:119], v[148:151]
  buffer_load_dwordx4 v32, s[36:39], s67 offen lds
  v_mfma_f32_16x16x32_bf16 v[144:147], a[160:163], a[112:115], v[144:147]
  ds_read_b64_tr_b16 a[160:161], v3 offset:32768
  v_mfma_f32_16x16x32_bf16 v[144:147], a[164:167], a[96:99], v[144:147]
  s_waitcnt lgkmcnt(5)
  v_mfma_f32_16x16x32_bf16 v[128:131], a[172:175], a[128:131], v[128:131]
  ds_read_b64_tr_b16 a[162:163], v3 offset:34816
  s_add_u32 m0, s45, 86016
  s_add_u32 s61, s67, 65536
  v_mfma_f32_16x16x32_bf16 v[128:131], a[168:171], a[144:147], v[128:131]
  buffer_load_dwordx4 v32, s[36:39], s61 offen lds
  v_mfma_f32_16x16x32_bf16 v[132:135], a[168:171], a[148:151], v[132:135]
  ds_read_b64_tr_b16 a[164:165], v3 offset:36864
  v_mfma_f32_16x16x32_bf16 v[132:135], a[172:175], a[132:135], v[132:135]
  v_mfma_f32_16x16x32_bf16 v[136:139], a[172:175], a[136:139], v[136:139]
  ds_read_b64_tr_b16 a[166:167], v3 offset:38912
  s_add_u32 m0, s45, 90112
  v_mfma_f32_16x16x32_bf16 v[136:139], a[168:171], a[152:155], v[136:139]
  buffer_load_dwordx4 v33, s[36:39], s67 offen lds
  v_mfma_f32_16x16x32_bf16 v[140:143], a[168:171], a[156:159], v[140:143]
  ds_read_b64_tr_b16 a[168:169], v3 offset:40960
  v_mfma_f32_16x16x32_bf16 v[140:143], a[172:175], a[140:143], v[140:143]
  s_waitcnt lgkmcnt(5)
  v_mfma_f32_16x16x32_bf16 v[156:159], a[180:183], a[140:143], v[156:159]
  ds_read_b64_tr_b16 a[170:171], v3 offset:43008
  s_add_u32 m0, s45, 94208
  s_add_u32 s61, s67, 65536
  v_mfma_f32_16x16x32_bf16 v[156:159], a[176:179], a[156:159], v[156:159]
  buffer_load_dwordx4 v33, s[36:39], s61 offen lds
  v_mfma_f32_16x16x32_bf16 v[152:155], a[176:179], a[152:155], v[152:155]
  ds_read_b64_tr_b16 a[172:173], v3 offset:45056
  v_mfma_f32_16x16x32_bf16 v[152:155], a[180:183], a[136:139], v[152:155]
  v_mfma_f32_16x16x32_bf16 v[148:151], a[180:183], a[132:135], v[148:151]
  ds_read_b64_tr_b16 a[174:175], v3 offset:47104
  v_mfma_f32_16x16x32_bf16 v[148:151], a[176:179], a[148:151], v[148:151]
  v_mfma_f32_16x16x32_bf16 v[144:147], a[176:179], a[144:147], v[144:147]
  ds_read_b64_tr_b16 a[176:177], v3 offset:49152
  v_mfma_f32_16x16x32_bf16 v[144:147], a[180:183], a[128:131], v[144:147]
  s_waitcnt lgkmcnt(5)
  v_mfma_f32_16x16x32_bf16 v[160:163], a[160:163], a[64:67], v[160:163]
  ds_read_b64_tr_b16 a[178:179], v3 offset:51200
  v_mfma_f32_16x16x32_bf16 v[160:163], a[164:167], a[80:83], v[160:163]
  v_mfma_f32_16x16x32_bf16 v[164:167], a[164:167], a[84:87], v[164:167]
  ds_read_b64_tr_b16 a[180:181], v3 offset:53248
  v_mfma_f32_16x16x32_bf16 v[164:167], a[160:163], a[68:71], v[164:167]
  v_mfma_f32_16x16x32_bf16 v[168:171], a[160:163], a[72:75], v[168:171]
  ds_read_b64_tr_b16 a[182:183], v3 offset:55296
  v_mfma_f32_16x16x32_bf16 v[168:171], a[164:167], a[88:91], v[168:171]
  v_mfma_f32_16x16x32_bf16 v[172:175], a[164:167], a[92:95], v[172:175]
  ds_read_b64_tr_b16 a[164:165], v3 offset:57344
  v_mfma_f32_16x16x32_bf16 v[172:175], a[160:163], a[76:79], v[172:175]
  s_waitcnt lgkmcnt(5)
  v_mfma_f32_16x16x32_bf16 v[188:191], a[168:171], a[76:79], v[188:191]
  ds_read_b64_tr_b16 a[166:167], v3 offset:59392
  v_mfma_f32_16x16x32_bf16 v[188:191], a[172:175], a[92:95], v[188:191]
  v_mfma_f32_16x16x32_bf16 v[184:187], a[172:175], a[88:91], v[184:187]
  ds_read_b64_tr_b16 a[160:161], v3 offset:61440
  v_mfma_f32_16x16x32_bf16 v[184:187], a[168:171], a[72:75], v[184:187]
  v_mfma_f32_16x16x32_bf16 v[180:183], a[168:171], a[68:71], v[180:183]
  ds_read_b64_tr_b16 a[162:163], v3 offset:63488
  v_mfma_f32_16x16x32_bf16 v[180:183], a[172:175], a[84:87], v[180:183]
  v_mfma_f32_16x16x32_bf16 v[176:179], a[172:175], a[80:83], v[176:179]
  ds_read_b64_tr_b16 a[172:173], v3 offset:16384
  v_mfma_f32_16x16x32_bf16 v[176:179], a[168:171], a[64:67], v[176:179]
  s_waitcnt lgkmcnt(5)
  v_mfma_f32_16x16x32_bf16 v[160:163], a[176:179], a[96:99], v[160:163]
  ds_read_b64_tr_b16 a[174:175], v3 offset:18432
  v_mfma_f32_16x16x32_bf16 v[160:163], a[180:183], a[112:115], v[160:163]
  v_mfma_f32_16x16x32_bf16 v[164:167], a[180:183], a[116:119], v[164:167]
  ds_read_b64_tr_b16 a[168:169], v3 offset:20480
  v_mfma_f32_16x16x32_bf16 v[164:167], a[176:179], a[100:103], v[164:167]
  v_mfma_f32_16x16x32_bf16 v[168:171], a[176:179], a[104:107], v[168:171]
  ds_read_b64_tr_b16 a[170:171], v3 offset:22528
  v_add_u32 v38, s46, v0
  s_waitcnt vmcnt(7)
  s_barrier
  s_mov_b64 exec, 1
  buffer_store_dword v38, v0, s[8:11], s80 offen offset:0 sc1
  s_mov_b64 exec, -1
  v_mfma_f32_16x16x32_bf16 v[168:171], a[180:183], a[120:123], v[168:171]
  v_mfma_f32_16x16x32_bf16 v[172:175], a[180:183], a[124:127], v[172:175]
  ds_read_b64_tr_b16 a[180:181], v3 offset:24576
  v_mfma_f32_16x16x32_bf16 v[172:175], a[176:179], a[108:111], v[172:175]
  s_waitcnt lgkmcnt(5)
  v_mfma_f32_16x16x32_bf16 v[188:191], a[164:167], a[108:111], v[188:191]
  ds_read_b64_tr_b16 a[182:183], v3 offset:26624
  v_mfma_f32_16x16x32_bf16 v[188:191], a[160:163], a[124:127], v[188:191]
  v_mfma_f32_16x16x32_bf16 v[184:187], a[160:163], a[120:123], v[184:187]
  ds_read_b64_tr_b16 a[176:177], v3 offset:28672
  v_mfma_f32_16x16x32_bf16 v[184:187], a[164:167], a[104:107], v[184:187]
  v_mfma_f32_16x16x32_bf16 v[180:183], a[164:167], a[100:103], v[180:183]
  ds_read_b64_tr_b16 a[178:179], v3 offset:30720
  v_mfma_f32_16x16x32_bf16 v[180:183], a[160:163], a[116:119], v[180:183]
  s_waitcnt vmcnt(7)
  s_barrier
  v_mfma_f32_16x16x32_bf16 v[176:179], a[160:163], a[112:115], v[176:179]
  ds_read_b64_tr_b16 a[160:161], v2 offset:0
  v_mfma_f32_16x16x32_bf16 v[176:179], a[164:167], a[96:99], v[176:179]
  s_waitcnt lgkmcnt(5)
  v_mfma_f32_16x16x32_bf16 v[160:163], a[172:175], a[128:131], v[160:163]
  ds_read_b64_tr_b16 a[162:163], v2 offset:2048
  v_mfma_f32_16x16x32_bf16 v[160:163], a[168:171], a[144:147], v[160:163]
  v_mfma_f32_16x16x32_bf16 v[164:167], a[168:171], a[148:151], v[164:167]
  ds_read_b64_tr_b16 a[164:165], v2 offset:4096
  v_mfma_f32_16x16x32_bf16 v[164:167], a[172:175], a[132:135], v[164:167]
  v_mfma_f32_16x16x32_bf16 v[168:171], a[172:175], a[136:139], v[168:171]
  ds_read_b64_tr_b16 a[166:167], v2 offset:6144
  v_mfma_f32_16x16x32_bf16 v[168:171], a[168:171], a[152:155], v[168:171]
  v_mfma_f32_16x16x32_bf16 v[172:175], a[168:171], a[156:159], v[172:175]
  ds_read_b64_tr_b16 a[168:169], v2 offset:8192
  v_mfma_f32_16x16x32_bf16 v[172:175], a[172:175], a[140:143], v[172:175]
  s_waitcnt lgkmcnt(5)
  v_mfma_f32_16x16x32_bf16 v[188:191], a[180:183], a[140:143], v[188:191]
  ds_read_b64_tr_b16 a[170:171], v2 offset:10240
  v_mfma_f32_16x16x32_bf16 v[188:191], a[176:179], a[156:159], v[188:191]
  v_mfma_f32_16x16x32_bf16 v[184:187], a[176:179], a[152:155], v[184:187]
  ds_read_b64_tr_b16 a[172:173], v2 offset:12288
  v_mfma_f32_16x16x32_bf16 v[184:187], a[180:183], a[136:139], v[184:187]
  v_mfma_f32_16x16x32_bf16 v[180:183], a[180:183], a[132:135], v[180:183]
  ds_read_b64_tr_b16 a[174:175], v2 offset:14336
  v_mfma_f32_16x16x32_bf16 v[180:183], a[176:179], a[148:151], v[180:183]
  v_mfma_f32_16x16x32_bf16 v[176:179], a[176:179], a[144:147], v[176:179]
  ds_read_b64_tr_b16 a[176:177], v3 offset:0
  v_mfma_f32_16x16x32_bf16 v[176:179], a[180:183], a[128:131], v[176:179]
  s_waitcnt lgkmcnt(5)
  v_mfma_f32_16x16x32_bf16 v[128:131], a[160:163], a[0:3], v[128:131]
  ds_read_b64_tr_b16 a[178:179], v3 offset:2048
  v_mfma_f32_16x16x32_bf16 v[128:131], a[164:167], a[16:19], v[128:131]
  v_mfma_f32_16x16x32_bf16 v[132:135], a[164:167], a[20:23], v[132:135]
  ds_read_b64_tr_b16 a[180:181], v3 offset:4096
  v_mfma_f32_16x16x32_bf16 v[132:135], a[160:163], a[4:7], v[132:135]
  v_mfma_f32_16x16x32_bf16 v[136:139], a[160:163], a[8:11], v[136:139]
  ds_read_b64_tr_b16 a[182:183], v3 offset:6144
  v_mfma_f32_16x16x32_bf16 v[136:139], a[164:167], a[24:27], v[136:139]
  v_mfma_f32_16x16x32_bf16 v[140:143], a[164:167], a[28:31], v[140:143]
  ds_read_b64_tr_b16 a[164:165], v3 offset:8192
  v_mfma_f32_16x16x32_bf16 v[140:143], a[160:163], a[12:15], v[140:143]
  s_waitcnt lgkmcnt(5)
  v_mfma_f32_16x16x32_bf16 v[156:159], a[168:171], a[12:15], v[156:159]
  ds_read_b64_tr_b16 a[166:167], v3 offset:10240
  v_mfma_f32_16x16x32_bf16 v[156:159], a[172:175], a[28:31], v[156:159]
  v_mfma_f32_16x16x32_bf16 v[152:155], a[172:175], a[24:27], v[152:155]
  ds_read_b64_tr_b16 a[160:161], v3 offset:12288
  v_mfma_f32_16x16x32_bf16 v[152:155], a[168:171], a[8:11], v[152:155]
  v_mfma_f32_16x16x32_bf16 v[148:151], a[168:171], a[4:7], v[148:151]
  ds_read_b64_tr_b16 a[162:163], v3 offset:14336
  v_mfma_f32_16x16x32_bf16 v[148:151], a[172:175], a[20:23], v[148:151]
  v_mfma_f32_16x16x32_bf16 v[144:147], a[172:175], a[16:19], v[144:147]
  ds_read_b64_tr_b16 a[172:173], v4 offset:32768
  v_mfma_f32_16x16x32_bf16 v[144:147], a[168:171], a[0:3], v[144:147]
  s_waitcnt lgkmcnt(5)
  v_mfma_f32_16x16x32_bf16 v[160:163], a[176:179], a[0:3], v[160:163]
  ds_read_b64_tr_b16 a[174:175], v4 offset:34816
  v_mfma_f32_16x16x32_bf16 v[160:163], a[180:183], a[16:19], v[160:163]
  v_mfma_f32_16x16x32_bf16 v[164:167], a[180:183], a[20:23], v[164:167]
  ds_read_b64_tr_b16 a[168:169], v4 offset:36864
  v_mul_f32 v24, v16, v128
  v_mul_f32 v25, v16, v129
  v_mfma_f32_16x16x32_bf16 v[164:167], a[176:179], a[4:7], v[164:167]
  v_mul_f32 v26, v16, v130
  v_mul_f32 v27, v16, v131
  v_mul_f32 v28, v18, v132
  v_mfma_f32_16x16x32_bf16 v[168:171], a[176:179], a[8:11], v[168:171]
  ds_read_b64_tr_b16 a[170:171], v4 offset:38912
  v_mul_f32 v29, v18, v133
  v_mul_f32 v30, v18, v134
  v_mfma_f32_16x16x32_bf16 v[168:171], a[180:183], a[24:27], v[168:171]
  v_mul_f32 v31, v18, v135
  v_exp_f32 v24, v24
  v_mfma_f32_16x16x32_bf16 v[172:175], a[180:183], a[28:31], v[172:175]
  ds_read_b64_tr_b16 a[180:181], v4 offset:40960
  v_mul_f32 v144, v128, v144
  v_mfma_f32_16x16x32_bf16 v[172:175], a[176:179], a[12:15], v[172:175]
  v_exp_f32 v25, v25
  v_mul_f32 v145, v129, v145
  s_waitcnt lgkmcnt(5)
  v_mfma_f32_16x16x32_bf16 v[188:191], a[164:167], a[12:15], v[188:191]
  ds_read_b64_tr_b16 a[182:183], v4 offset:43008
  v_exp_f32 v26, v26
  v_mfma_f32_16x16x32_bf16 v[188:191], a[160:163], a[28:31], v[188:191]
  v_mul_f32 v146, v130, v146
  v_exp_f32 v27, v27
  v_mfma_f32_16x16x32_bf16 v[184:187], a[160:163], a[24:27], v[184:187]
  ds_read_b64_tr_b16 a[176:177], v4 offset:45056
  v_mul_f32 v147, v131, v147
  v_mfma_f32_16x16x32_bf16 v[184:187], a[164:167], a[8:11], v[184:187]
  v_exp_f32 v28, v28
  v_mul_f32 v148, v132, v148
  v_mfma_f32_16x16x32_bf16 v[180:183], a[164:167], a[4:7], v[180:183]
  ds_read_b64_tr_b16 a[178:179], v4 offset:47104
  v_exp_f32 v29, v29
  v_mul_f32 v149, v133, v149
  v_mfma_f32_16x16x32_bf16 v[180:183], a[160:163], a[20:23], v[180:183]
  v_exp_f32 v30, v30
  v_mul_f32 v150, v134, v150
  v_mfma_f32_16x16x32_bf16 v[176:179], a[160:163], a[16:19], v[176:179]
  ds_read_b64_tr_b16 a[160:161], v4 offset:49152
  s_cmp_lg_u32 s44, 0
  s_cbranch_scc1 PI18_adaLN_cond__sliding_local_dilated__swiglu_ffn__prompt_kernel
  buffer_load_dword v36, v37, s[8:11], s82 offen sc1
PI18_adaLN_cond__sliding_local_dilated__swiglu_ffn__prompt_kernel:
  v_mfma_f32_16x16x32_bf16 v[176:179], a[164:167], a[0:3], v[176:179]
  s_waitcnt lgkmcnt(5)
  v_mfma_f32_16x16x32_bf16 v[192:195], a[172:175], a[64:67], v[192:195]
  ds_read_b64_tr_b16 a[162:163], v4 offset:51200
  v_exp_f32 v31, v31
  v_mul_f32 v151, v135, v151
  v_mfma_f32_16x16x32_bf16 v[192:195], a[168:171], a[80:83], v[192:195]
  v_fma_f32 v24, v24, v17, v17
  v_fma_f32 v25, v25, v17, v17
  v_fma_f32 v26, v26, v17, v17
  v_mfma_f32_16x16x32_bf16 v[196:199], a[168:171], a[84:87], v[196:199]
  ds_read_b64_tr_b16 a[164:165], v4 offset:53248
  v_fma_f32 v27, v27, v17, v17
  v_fma_f32 v28, v28, v19, v19
  v_mfma_f32_16x16x32_bf16 v[196:199], a[172:175], a[68:71], v[196:199]
  v_fma_f32 v29, v29, v19, v19
  v_fma_f32 v30, v30, v19, v19
  v_fma_f32 v31, v31, v19, v19
  v_mfma_f32_16x16x32_bf16 v[200:203], a[172:175], a[72:75], v[200:203]
  ds_read_b64_tr_b16 a[166:167], v4 offset:55296
  v_rcp_f32 v24, v24
  v_mfma_f32_16x16x32_bf16 v[200:203], a[168:171], a[88:91], v[200:203]
  v_rcp_f32 v25, v25
  v_mfma_f32_16x16x32_bf16 v[204:207], a[168:171], a[92:95], v[204:207]
  ds_read_b64_tr_b16 a[168:169], v4 offset:57344
  v_rcp_f32 v26, v26
  v_mfma_f32_16x16x32_bf16 v[204:207], a[172:175], a[76:79], v[204:207]
  v_rcp_f32 v27, v27
  s_waitcnt lgkmcnt(5)
  v_mfma_f32_16x16x32_bf16 v[220:223], a[180:183], a[76:79], v[220:223]
  ds_read_b64_tr_b16 a[170:171], v4 offset:59392
  v_rcp_f32 v28, v28
  v_mfma_f32_16x16x32_bf16 v[220:223], a[176:179], a[92:95], v[220:223]
  v_rcp_f32 v29, v29
  v_rcp_f32 v30, v30
  v_mfma_f32_16x16x32_bf16 v[216:219], a[176:179], a[88:91], v[216:219]
  ds_read_b64_tr_b16 a[172:173], v4 offset:61440
  v_rcp_f32 v31, v31
  v_mfma_f32_16x16x32_bf16 v[216:219], a[180:183], a[72:75], v[216:219]
  v_mul_f32 v144, v144, v24
  v_mul_f32 v145, v145, v25
  v_mul_f32 v146, v146, v26
  v_mfma_f32_16x16x32_bf16 v[212:215], a[180:183], a[68:71], v[212:215]
  ds_read_b64_tr_b16 a[174:175], v4 offset:63488
  v_mul_f32 v147, v147, v27
  v_mul_f32 v148, v148, v28
  v_mfma_f32_16x16x32_bf16 v[212:215], a[176:179], a[84:87], v[212:215]
  v_mul_f32 v149, v149, v29
  v_mul_f32 v150, v150, v30
  v_mul_f32 v151, v151, v31
  v_mfma_f32_16x16x32_bf16 v[208:211], a[176:179], a[80:83], v[208:211]
  ds_read_b64_tr_b16 a[176:177], v4 offset:16384
  v_cvt_pk_bf16_f32 v128, v144, v145
  v_cvt_pk_bf16_f32 v129, v146, v147
  v_mfma_f32_16x16x32_bf16 v[208:211], a[180:183], a[64:67], v[208:211]
  v_cvt_pk_bf16_f32 v132, v148, v149
  v_cvt_pk_bf16_f32 v133, v150, v151
  s_waitcnt lgkmcnt(5)
  v_mfma_f32_16x16x32_bf16 v[192:195], a[160:163], a[96:99], v[192:195]
  ds_read_b64_tr_b16 a[178:179], v4 offset:18432
  v_mul_f32 v24, v20, v136
  v_mul_f32 v25, v20, v137
  v_mfma_f32_16x16x32_bf16 v[192:195], a[164:167], a[112:115], v[192:195]
  v_mul_f32 v26, v20, v138
  v_mul_f32 v27, v20, v139
  v_mul_f32 v28, v22, v140
  v_mfma_f32_16x16x32_bf16 v[196:199], a[164:167], a[116:119], v[196:199]
  ds_read_b64_tr_b16 a[180:181], v4 offset:20480
  v_mul_f32 v29, v22, v141
  v_mfma_f32_16x16x32_bf16 v[196:199], a[160:163], a[100:103], v[196:199]
  v_mul_f32 v30, v22, v142
  v_mul_f32 v31, v22, v143
  v_mfma_f32_16x16x32_bf16 v[200:203], a[160:163], a[104:107], v[200:203]
  ds_read_b64_tr_b16 a[182:183], v4 offset:22528
  v_exp_f32 v24, v24
  v_mul_f32 v152, v136, v152
  v_mfma_f32_16x16x32_bf16 v[200:203], a[164:167], a[120:123], v[200:203]
  v_exp_f32 v25, v25
  v_mul_f32 v153, v137, v153
  v_mfma_f32_16x16x32_bf16 v[204:207], a[164:167], a[124:127], v[204:207]
  ds_read_b64_tr_b16 a[164:165], v4 offset:24576
  v_exp_f32 v26, v26
  v_mfma_f32_16x16x32_bf16 v[204:207], a[160:163], a[108:111], v[204:207]
  v_mul_f32 v154, v138, v154
  s_waitcnt lgkmcnt(5)
  v_mfma_f32_16x16x32_bf16 v[220:223], a[168:171], a[108:111], v[220:223]
  ds_read_b64_tr_b16 a[166:167], v4 offset:26624
  v_exp_f32 v27, v27
  v_mul_f32 v155, v139, v155
  v_mfma_f32_16x16x32_bf16 v[220:223], a[172:175], a[124:127], v[220:223]
  v_exp_f32 v28, v28
  v_mul_f32 v156, v140, v156
  v_mfma_f32_16x16x32_bf16 v[216:219], a[172:175], a[120:123], v[216:219]
  ds_read_b64_tr_b16 a[160:161], v4 offset:28672
  v_exp_f32 v29, v29
  v_mfma_f32_16x16x32_bf16 v[216:219], a[168:171], a[104:107], v[216:219]
  v_mul_f32 v157, v141, v157
  v_exp_f32 v30, v30
  v_mfma_f32_16x16x32_bf16 v[212:215], a[168:171], a[100:103], v[212:215]
  ds_read_b64_tr_b16 a[162:163], v4 offset:30720
  v_mul_f32 v158, v142, v158
  v_mfma_f32_16x16x32_bf16 v[212:215], a[172:175], a[116:119], v[212:215]
  v_exp_f32 v31, v31
  v_mul_f32 v159, v143, v159
  v_fma_f32 v24, v24, v21, v21
  v_mfma_f32_16x16x32_bf16 v[208:211], a[172:175], a[112:115], v[208:211]
  ds_read_b64_tr_b16 a[172:173], v4 offset:0
  v_fma_f32 v25, v25, v21, v21
  v_fma_f32 v26, v26, v21, v21
  v_mfma_f32_16x16x32_bf16 v[208:211], a[168:171], a[96:99], v[208:211]
  v_fma_f32 v27, v27, v21, v21
  v_fma_f32 v28, v28, v23, v23
  s_waitcnt lgkmcnt(5)
  v_mfma_f32_16x16x32_bf16 v[192:195], a[176:179], a[128:131], v[192:195]
  ds_read_b64_tr_b16 a[174:175], v4 offset:2048
  v_fma_f32 v29, v29, v23, v23
  v_fma_f32 v30, v30, v23, v23
  v_mfma_f32_16x16x32_bf16 v[192:195], a[180:183], a[144:147], v[192:195]
  v_fma_f32 v31, v31, v23, v23
  v_rcp_f32 v24, v24
  v_mfma_f32_16x16x32_bf16 v[196:199], a[180:183], a[148:151], v[196:199]
  ds_read_b64_tr_b16 a[168:169], v4 offset:4096
  v_rcp_f32 v25, v25
  v_mfma_f32_16x16x32_bf16 v[196:199], a[176:179], a[132:135], v[196:199]
  v_rcp_f32 v26, v26
  v_mfma_f32_16x16x32_bf16 v[200:203], a[176:179], a[136:139], v[200:203]
  ds_read_b64_tr_b16 a[170:171], v4 offset:6144
  v_rcp_f32 v27, v27
  v_mfma_f32_16x16x32_bf16 v[200:203], a[180:183], a[152:155], v[200:203]
  v_rcp_f32 v28, v28
  v_rcp_f32 v29, v29
  v_mfma_f32_16x16x32_bf16 v[204:207], a[180:183], a[156:159], v[204:207]
  ds_read_b64_tr_b16 a[180:181], v4 offset:8192
  s_cmp_lg_u32 s44, 0
  s_cbranch_scc1 PL19_adaLN_cond__sliding_local_dilated__swiglu_ffn__prompt_kernelx
  s_waitcnt vmcnt(0)
  v_cmp_ne_u32 vcc, s46, v36
  s_nop 4
  s_cbranch_vccz PL19_adaLN_cond__sliding_local_dilated__swiglu_ffn__prompt_kernelx
  s_mov_b32 s83, 60000
PL19_adaLN_cond__sliding_local_dilated__swiglu_ffn__prompt_kernel:
  buffer_load_dword v36, v37, s[8:11], s82 offen sc1
  s_sub_u32 s83, s83, 1
  s_cmp_eq_u32 s83, 0
  s_waitcnt vmcnt(0)
  s_cbranch_scc1 PL19_adaLN_cond__sliding_local_dilated__swiglu_ffn__prompt_kernelx
  v_cmp_ne_u32 vcc, s46, v36
  s_nop 4
  s_cbranch_vccnz PL19_adaLN_cond__sliding_local_dilated__swiglu_ffn__prompt_kernel
PL19_adaLN_cond__sliding_local_dilated__swiglu_ffn__prompt_kernelx:
  s_barrier
  v_mfma_f32_16x16x32_bf16 v[204:207], a[176:179], a[140:143], v[204:207]
  s_waitcnt lgkmcnt(5)
  v_mfma_f32_16x16x32_bf16 v[220:223], a[164:167], a[140:143], v[220:223]
  ds_read_b64_tr_b16 a[182:183], v4 offset:10240
  buffer_load_dwordx4 a[188:191], v1, s[8:11], s72 offen offset:0 sc1
  v_mfma_f32_16x16x32_bf16 v[220:223], a[160:163], a[156:159], v[220:223]
  v_mfma_f32_16x16x32_bf16 v[216:219], a[160:163], a[152:155], v[216:219]
  ds_read_b64_tr_b16 a[176:177], v4 offset:12288
  v_rcp_f32 v30, v30
  v_mfma_f32_16x16x32_bf16 v[216:219], a[164:167], a[136:139], v[216:219]
  v_rcp_f32 v31, v31
  v_mul_f32 v152, v152, v24
  v_mfma_f32_16x16x32_bf16 v[212:215], a[164:167], a[132:135], v[212:215]
  ds_read_b64_tr_b16 a[178:179], v4 offset:14336
  buffer_load_dwordx4 a[204:207], v1, s[8:11], s72 offen offset:1024 sc1
  v_mul_f32 v153, v153, v25
  v_mfma_f32_16x16x32_bf16 v[212:215], a[160:163], a[148:151], v[212:215]
  v_mul_f32 v154, v154, v26
  v_mul_f32 v155, v155, v27
  v_mul_f32 v156, v156, v28
  v_mfma_f32_16x16x32_bf16 v[208:211], a[160:163], a[144:147], v[208:211]
  ds_read_b64_tr_b16 a[160:161], v5 offset:32768
  v_mul_f32 v157, v157, v29
  v_mul_f32 v158, v158, v30
  v_mfma_f32_16x16x32_bf16 v[208:211], a[164:167], a[128:131], v[208:211]
  s_add_u32 s72, s72, 131072
  v_mul_f32 v159, v159, v31
  s_waitcnt lgkmcnt(5)
  v_mfma_f32_16x16x32_bf16 v[192:195], a[172:175], a[0:3], v[192:195]
  ds_read_b64_tr_b16 a[162:163], v5 offset:34816
  buffer_load_dwordx4 a[192:195], v1, s[8:11], s72 offen offset:0 sc1
  v_cvt_pk_bf16_f32 v136, v152, v153
  v_mfma_f32_16x16x32_bf16 v[192:195], a[168:171], a[16:19], v[192:195]
  v_cvt_pk_bf16_f32 v137, v154, v155
  v_cvt_pk_bf16_f32 v140, v156, v157
  v_cvt_pk_bf16_f32 v141, v158, v159
  v_mfma_f32_16x16x32_bf16 v[196:199], a[168:171], a[20:23], v[196:199]
  ds_read_b64_tr_b16 a[164:165], v5 offset:36864
  v_mul_f32 v24, v16, v160
  v_mul_f32 v25, v16, v161
  v_mfma_f32_16x16x32_bf16 v[196:199], a[172:175], a[4:7], v[196:199]
  v_mul_f32 v26, v16, v162
  v_mul_f32 v27, v16, v163
  v_mul_f32 v28, v18, v164
  v_mul_f32 v29, v18, v165
  v_mfma_f32_16x16x32_bf16 v[200:203], a[172:175], a[8:11], v[200:203]
  ds_read_b64_tr_b16 a[166:167], v5 offset:38912
  buffer_load_dwordx4 a[208:211], v1, s[8:11], s72 offen offset:1024 sc1
  v_mul_f32 v30, v18, v166
  v_mfma_f32_16x16x32_bf16 v[200:203], a[168:171], a[24:27], v[200:203]
  v_mul_f32 v31, v18, v167
  v_exp_f32 v24, v24
  v_mfma_f32_16x16x32_bf16 v[204:207], a[168:171], a[28:31], v[204:207]
  ds_read_b64_tr_b16 a[168:169], v5 offset:40960
  v_mul_f32 v176, v160, v176
  v_mfma_f32_16x16x32_bf16 v[204:207], a[172:175], a[12:15], v[204:207]
  s_add_u32 s72, s72, s89
  v_exp_f32 v25, v25
  s_waitcnt lgkmcnt(5)
  v_mfma_f32_16x16x32_bf16 v[220:223], a[180:183], a[12:15], v[220:223]
  ds_read_b64_tr_b16 a[170:171], v5 offset:43008
  buffer_load_dwordx4 a[196:199], v1, s[8:11], s72 offen offset:0 sc1
  v_mul_f32 v177, v161, v177
  v_mfma_f32_16x16x32_bf16 v[220:223], a[176:179], a[28:31], v[220:223]
  v_exp_f32 v26, v26
  v_mul_f32 v178, v162, v178
  v_mfma_f32_16x16x32_bf16 v[216:219], a[176:179], a[24:27], v[216:219]
  ds_read_b64_tr_b16 a[172:173], v5 offset:45056
  v_exp_f32 v27, v27
  v_mul_f32 v179, v163, v179
  v_mfma_f32_16x16x32_bf16 v[216:219], a[180:183], a[8:11], v[216:219]
  v_exp_f32 v28, v28
  v_mul_f32 v180, v164, v180
  v_mfma_f32_16x16x32_bf16 v[212:215], a[180:183], a[4:7], v[212:215]
  ds_read_b64_tr_b16 a[174:175], v5 offset:47104
  buffer_load_dwordx4 a[212:215], v1, s[8:11], s72 offen offset:1024 sc1
  v_exp_f32 v29, v29
  v_mfma_f32_16x16x32_bf16 v[212:215], a[176:179], a[20:23], v[212:215]
  v_mul_f32 v181, v165, v181
  v_exp_f32 v30, v30
  v_mfma_f32_16x16x32_bf16 v[208:211], a[176:179], a[16:19], v[208:211]
HOP15:
  s_cbranch_execz HOP18
  ds_read_b64_tr_b16 a[176:177], v5 offset:49152
  v_mul_f32 v182, v166, v182
  v_mfma_f32_16x16x32_bf16 v[208:211], a[180:183], a[0:3], v[208:211]
  s_add_u32 s72, s72, 131072
  v_exp_f32 v31, v31
  s_waitcnt lgkmcnt(5)
  v_mfma_f32_16x16x32_bf16 v[224:227], a[160:163], a[64:67], v[224:227]
  ds_read_b64_tr_b16 a[178:179], v5 offset:51200
  buffer_load_dwordx4 a[200:203], v1, s[8:11], s72 offen offset:0 sc1
  v_mul_f32 v183, v167, v183
  v_fma_f32 v24, v24, v17, v17
  v_mfma_f32_16x16x32_bf16 v[224:227], a[164:167], a[80:83], v[224:227]
  v_fma_f32 v25, v25, v17, v17
  v_fma_f32 v26, v26, v17, v17
  v_fma_f32 v27, v27, v17, v17
  v_mfma_f32_16x16x32_bf16 v[228:231], a[164:167], a[84:87], v[228:231]
  ds_read_b64_tr_b16 a[180:181], v5 offset:53248
  v_fma_f32 v28, v28, v19, v19
  v_fma_f32 v29, v29, v19, v19
  v_mfma_f32_16x16x32_bf16 v[228:231], a[160:163], a[68:71], v[228:231]
  v_fma_f32 v30, v30, v19, v19
  v_fma_f32 v31, v31, v19, v19
  v_mfma_f32_16x16x32_bf16 v[232:235], a[160:163], a[72:75], v[232:235]
  ds_read_b64_tr_b16 a[182:183], v5 offset:55296
  buffer_load_dwordx4 a[216:219], v1, s[8:11], s72 offen offset:1024 sc1
  v_rcp_f32 v24, v24
  v_mfma_f32_16x16x32_bf16 v[232:235], a[164:167], a[88:91], v[232:235]
  v_rcp_f32 v25, v25
  v_rcp_f32 v26, v26
  v_mfma_f32_16x16x32_bf16 v[236:239], a[164:167], a[92:95], v[236:239]
  ds_read_b64_tr_b16 a[164:165], v5 offset:57344
  v_rcp_f32 v27, v27
  v_mfma_f32_16x16x32_bf16 v[236:239], a[160:163], a[76:79], v[236:239]
  s_waitcnt lgkmcnt(5)
  v_mfma_f32_16x16x32_bf16 v[252:255], a[168:171], a[76:79], v[252:255]
  ds_read_b64_tr_b16 a[166:167], v5 offset:59392
  buffer_load_dwordx4 a[220:223], v1, s[8:11], s73 offen offset:0 sc1
  v_rcp_f32 v28, v28
  v_mfma_f32_16x16x32_bf16 v[252:255], a[172:175], a[92:95], v[252:255]
  v_rcp_f32 v29, v29
  v_rcp_f32 v30, v30
  v_mfma_f32_16x16x32_bf16 v[248:251], a[172:175], a[88:91], v[248:251]
  ds_read_b64_tr_b16 a[160:161], v5 offset:61440
  v_rcp_f32 v31, v31
  v_mfma_f32_16x16x32_bf16 v[248:251], a[168:171], a[72:75], v[248:251]
  v_mul_f32 v176, v176, v24
  v_mul_f32 v177, v177, v25
  v_mul_f32 v178, v178, v26
  v_mfma_f32_16x16x32_bf16 v[244:247], a[168:171], a[68:71], v[244:247]
  ds_read_b64_tr_b16 a[162:163], v5 offset:63488
  buffer_load_dwordx4 a[236:239], v1, s[8:11], s73 offen offset:1024 sc1
  v_mul_f32 v179, v179, v27
  v_mfma_f32_16x16x32_bf16 v[244:247], a[172:175], a[84:87], v[244:247]
  v_mul_f32 v180, v180, v28
  v_mul_f32 v181, v181, v29
  v_mul_f32 v182, v182, v30
  v_mul_f32 v183, v183, v31
  v_mfma_f32_16x16x32_bf16 v[240:243], a[172:175], a[80:83], v[240:243]
  ds_read_b64_tr_b16 a[172:173], v5 offset:16384
  v_cvt_pk_bf16_f32 v130, v176, v177
  v_cvt_pk_bf16_f32 v131, v178, v179
  v_mfma_f32_16x16x32_bf16 v[240:243], a[168:171], a[64:67], v[240:243]
  s_add_u32 s73, s73, 131072
  s_waitcnt lgkmcnt(5)
  v_mfma_f32_16x16x32_bf16 v[224:227], a[176:179], a[96:99], v[224:227]
  ds_read_b64_tr_b16 a[174:175], v5 offset:18432
  buffer_load_dwordx4 a[224:227], v1, s[8:11], s73 offen offset:0 sc1
  buffer_store_dwordx4 v[128:131], v1, s[8:11], s58 offen offset:0 sc1
  v_mfma_f32_16x16x32_bf16 v[224:227], a[180:183], a[112:115], v[224:227]
  v_cvt_pk_bf16_f32 v134, v180, v181
  v_cvt_pk_bf16_f32 v135, v182, v183
  s_add_u32 s55, s58, 262144
  buffer_store_dwordx4 v[132:135], v1, s[8:11], s55 offen offset:0 sc1
  v_mfma_f32_16x16x32_bf16 v[228:231], a[180:183], a[116:119], v[228:231]
  ds_read_b64_tr_b16 a[168:169], v5 offset:20480
  v_mul_f32 v24, v20, v168
  v_mul_f32 v25, v20, v169
  v_mfma_f32_16x16x32_bf16 v[228:231], a[176:179], a[100:103], v[228:231]
  v_mul_f32 v26, v20, v170
  v_mul_f32 v27, v20, v171
  v_mul_f32 v28, v22, v172
  v_mfma_f32_16x16x32_bf16 v[232:235], a[176:179], a[104:107], v[232:235]
  ds_read_b64_tr_b16 a[170:171], v5 offset:22528
  buffer_load_dwordx4 a[240:243], v1, s[8:11], s73 offen offset:1024 sc1
  v_mul_f32 v29, v22, v173
  v_mfma_f32_16x16x32_bf16 v[232:235], a[180:183], a[120:123], v[232:235]
  v_mul_f32 v30, v22, v174
  v_mul_f32 v31, v22, v175
  v_exp_f32 v24, v24
  v_mfma_f32_16x16x32_bf16 v[236:239], a[180:183], a[124:127], v[236:239]
  ds_read_b64_tr_b16 a[180:181], v5 offset:24576
  v_mul_f32 v184, v168, v184
  v_mfma_f32_16x16x32_bf16 v[236:239], a[176:179], a[108:111], v[236:239]
  s_add_u32 s73, s73, s89
  v_exp_f32 v25, v25
  s_waitcnt lgkmcnt(5)
  v_mfma_f32_16x16x32_bf16 v[252:255], a[164:167], a[108:111], v[252:255]
  ds_read_b64_tr_b16 a[182:183], v5 offset:26624
  buffer_load_dwordx4 a[228:231], v1, s[8:11], s73 offen offset:0 sc1
  v_mul_f32 v185, v169, v185
  v_mfma_f32_16x16x32_bf16 v[252:255], a[160:163], a[124:127], v[252:255]
  v_exp_f32 v26, v26
  v_mul_f32 v186, v170, v186
  v_mfma_f32_16x16x32_bf16 v[248:251], a[160:163], a[120:123], v[248:251]
  ds_read_b64_tr_b16 a[176:177], v5 offset:28672
  v_exp_f32 v27, v27
  v_mul_f32 v187, v171, v187
  v_mfma_f32_16x16x32_bf16 v[248:251], a[164:167], a[104:107], v[248:251]
  v_exp_f32 v28, v28
  v_mul_f32 v188, v172, v188
  v_mfma_f32_16x16x32_bf16 v[244:247], a[164:167], a[100:103], v[244:247]
  ds_read_b64_tr_b16 a[178:179], v5 offset:30720
  buffer_load_dwordx4 a[244:247], v1, s[8:11], s73 offen offset:1024 sc1
  v_exp_f32 v29, v29
  v_mfma_f32_16x16x32_bf16 v[244:247], a[160:163], a[116:119], v[244:247]
  v_mul_f32 v189, v173, v189
  v_exp_f32 v30, v30
  v_mfma_f32_16x16x32_bf16 v[240:243], a[160:163], a[112:115], v[240:243]
  ds_read_b64_tr_b16 a[160:161], v5 offset:0
  v_mul_f32 v190, v174, v190
  v_mfma_f32_16x16x32_bf16 v[240:243], a[164:167], a[96:99], v[240:243]
  s_add_u32 s73, s73, 131072
  v_exp_f32 v31, v31
  s_waitcnt lgkmcnt(5)
  v_mfma_f32_16x16x32_bf16 v[224:227], a[172:175], a[128:131], v[224:227]
  ds_read_b64_tr_b16 a[162:163], v5 offset:2048
  buffer_load_dwordx4 a[232:235], v1, s[8:11], s73 offen offset:0 sc1
  v_mul_f32 v191, v175, v191
  v_fma_f32 v24, v24, v21, v21
  v_mfma_f32_16x16x32_bf16 v[224:227], a[168:171], a[144:147], v[224:227]
  v_fma_f32 v25, v25, v21, v21
  v_fma_f32 v26, v26, v21, v21
  v_fma_f32 v27, v27, v21, v21
  v_mfma_f32_16x16x32_bf16 v[228:231], a[168:171], a[148:151], v[228:231]
  ds_read_b64_tr_b16 a[164:165], v5 offset:4096
  v_fma_f32 v28, v28, v23, v23
  v_fma_f32 v29, v29, v23, v23
  v_mfma_f32_16x16x32_bf16 v[228:231], a[172:175], a[132:135], v[228:231]
  v_fma_f32 v30, v30, v23, v23
  v_fma_f32 v31, v31, v23, v23
  v_mfma_f32_16x16x32_bf16 v[232:235], a[172:175], a[136:139], v[232:235]
  ds_read_b64_tr_b16 a[166:167], v5 offset:6144
  buffer_load_dwordx4 a[248:251], v1, s[8:11], s73 offen offset:1024 sc1
  v_rcp_f32 v24, v24
  v_mfma_f32_16x16x32_bf16 v[232:235], a[168:171], a[152:155], v[232:235]
  v_rcp_f32 v25, v25
  v_rcp_f32 v26, v26
  v_mfma_f32_16x16x32_bf16 v[236:239], a[168:171], a[156:159], v[236:239]
  ds_read_b64_tr_b16 a[168:169], v5 offset:8192
  v_rcp_f32 v27, v27
  v_mfma_f32_16x16x32_bf16 v[236:239], a[172:175], a[140:143], v[236:239]
  s_waitcnt lgkmcnt(5)
  v_mfma_f32_16x16x32_bf16 v[252:255], a[180:183], a[140:143], v[252:255]
  ds_read_b64_tr_b16 a[170:171], v5 offset:10240
  buffer_load_dwordx4 a[32:35], v1, s[8:11], s74 offen offset:0 sc1
  v_rcp_f32 v28, v28
  v_mfma_f32_16x16x32_bf16 v[252:255], a[176:179], a[156:159], v[252:255]
  v_rcp_f32 v29, v29
  v_rcp_f32 v30, v30
  v_mfma_f32_16x16x32_bf16 v[248:251], a[176:179], a[152:155], v[248:251]
  ds_read_b64_tr_b16 a[172:173], v5 offset:12288
  v_rcp_f32 v31, v31
  v_mfma_f32_16x16x32_bf16 v[248:251], a[180:183], a[136:139], v[248:251]
  v_mul_f32 v184, v184, v24
  v_mul_f32 v185, v185, v25
  v_mul_f32 v186, v186, v26
  v_mfma_f32_16x16x32_bf16 v[244:247], a[180:183], a[132:135], v[244:247]
  ds_read_b64_tr_b16 a[174:175], v5 offset:14336
  buffer_load_dwordx4 a[48:51], v1, s[8:11], s74 offen offset:1024 sc1
  v_mul_f32 v187, v187, v27
  v_mfma_f32_16x16x32_bf16 v[244:247], a[176:179], a[148:151], v[244:247]
  v_mul_f32 v188, v188, v28
  v_mul_f32 v189, v189, v29
  s_waitcnt vmcnt(43)
  s_barrier
  v_mfma_f32_16x16x32_bf16 v[240:243], a[176:179], a[144:147], v[240:243]
  ds_read_b64_tr_b16 a[176:177], v6 offset:0
  v_mul_f32 v190, v190, v30
  v_mul_f32 v191, v191, v31
  v_mfma_f32_16x16x32_bf16 v[240:243], a[180:183], a[128:131], v[240:243]
  s_add_u32 s74, s74, 131072
  v_cvt_pk_bf16_f32 v138, v184, v185
  s_waitcnt lgkmcnt(5)
  v_mfma_f32_16x16x32_bf16 v[224:227], a[160:163], a[0:3], v[224:227]
  ds_read_b64_tr_b16 a[178:179], v6 offset:2048
  buffer_load_dwordx4 a[36:39], v1, s[8:11], s74 offen offset:0 sc1
  v_cvt_pk_bf16_f32 v139, v186, v187
  v_mfma_f32_16x16x32_bf16 v[224:227], a[164:167], a[16:19], v[224:227]
  s_add_u32 s55, s58, 524288
  buffer_store_dwordx4 v[136:139], v1, s[8:11], s55 offen offset:0 sc1
  v_cvt_pk_bf16_f32 v142, v188, v189
  v_cvt_pk_bf16_f32 v143, v190, v191
  s_add_u32 s55, s58, 786432
  buffer_store_dwordx4 v[140:143], v1, s[8:11], s55 offen offset:0 sc1
  v_mfma_f32_16x16x32_bf16 v[228:231], a[164:167], a[20:23], v[228:231]
  ds_read_b64_tr_b16 a[180:181], v6 offset:4096
  v_mul_f32 v24, v16, v192
  v_mul_f32 v25, v16, v193
  v_mfma_f32_16x16x32_bf16 v[228:231], a[160:163], a[4:7], v[228:231]
  v_mul_f32 v26, v16, v194
  v_mul_f32 v27, v16, v195
  v_mul_f32 v28, v18, v196
  v_mfma_f32_16x16x32_bf16 v[232:235], a[160:163], a[8:11], v[232:235]
  ds_read_b64_tr_b16 a[182:183], v6 offset:6144
  buffer_load_dwordx4 a[52:55], v1, s[8:11], s74 offen offset:1024 sc1
  v_mul_f32 v29, v18, v197
  v_mfma_f32_16x16x32_bf16 v[232:235], a[164:167], a[24:27], v[232:235]
  v_mul_f32 v30, v18, v198
  v_mul_f32 v31, v18, v199
  v_exp_f32 v24, v24
  v_mfma_f32_16x16x32_bf16 v[236:239], a[164:167], a[28:31], v[236:239]
  ds_read_b64_tr_b16 a[164:165], v7 offset:0
  v_mul_f32 v208, v192, v208
  v_mfma_f32_16x16x32_bf16 v[236:239], a[160:163], a[12:15], v[236:239]
  s_add_u32 s74, s74, s89
  v_exp_f32 v25, v25
  s_waitcnt lgkmcnt(5)
  v_mfma_f32_16x16x32_bf16 v[252:255], a[168:171], a[12:15], v[252:255]
  ds_read_b64_tr_b16 a[166:167], v7 offset:2048
  buffer_load_dwordx4 a[40:43], v1, s[8:11], s74 offen offset:0 sc1
  v_mul_f32 v209, v193, v209
  v_mfma_f32_16x16x32_bf16 v[252:255], a[172:175], a[28:31], v[252:255]
  v_exp_f32 v26, v26
  v_mul_f32 v210, v194, v210
  v_mfma_f32_16x16x32_bf16 v[248:251], a[172:175], a[24:27], v[248:251]
  ds_read_b64_tr_b16 a[160:161], v7 offset:4096
  v_exp_f32 v27, v27
  v_mfma_f32_16x16x32_bf16 v[248:251], a[168:171], a[8:11], v[248:251]
  v_mul_f32 v211, v195, v211
  v_exp_f32 v28, v28
  v_mul_f32 v212, v196, v212
  v_mfma_f32_16x16x32_bf16 v[244:247], a[168:171], a[4:7], v[244:247]
  ds_read_b64_tr_b16 a[162:163], v7 offset:6144
  buffer_load_dwordx4 a[56:59], v1, s[8:11], s74 offen offset:1024 sc1
  v_mfma_f32_16x16x32_bf16 v[244:247], a[172:175], a[20:23], v[244:247]
  v_exp_f32 v29, v29
  v_mul_f32 v213, v197, v213
  v_mfma_f32_16x16x32_bf16 v[240:243], a[172:175], a[16:19], v[240:243]
  ds_read_b64_tr_b16 a[172:173], v8 offset:0
  v_exp_f32 v30, v30
  v_mul_f32 v214, v198, v214
  v_mfma_f32_16x16x32_bf16 v[240:243], a[168:171], a[0:3], v[240:243]
  s_add_u32 s74, s74, 131072
  s_waitcnt vmcnt(18) lgkmcnt(5)
  v_mfma_f32_16x16x32_bf16 v[64:67], a[176:179], a[188:191], 0
  ds_read_b64_tr_b16 a[174:175], v8 offset:2048
  buffer_load_dwordx4 a[44:47], v1, s[8:11], s74 offen offset:0 sc1
  v_exp_f32 v31, v31
  v_mfma_f32_16x16x32_bf16 v[64:67], a[180:183], a[204:207], v[64:67]
  v_mul_f32 v215, v199, v215
  s_waitcnt vmcnt(42)
  s_barrier
  v_mfma_f32_16x16x32_bf16 v[68:71], a[180:183], a[208:211], 0
  ds_read_b64_tr_b16 a[168:169], v8 offset:4096
  v_fma_f32 v24, v24, v17, v17
  v_fma_f32 v25, v25, v17, v17
  v_mfma_f32_16x16x32_bf16 v[68:71], a[176:179], a[192:195], v[68:71]
  v_fma_f32 v26, v26, v17, v17
  v_fma_f32 v27, v27, v17, v17
  v_fma_f32 v28, v28, v19, v19
  v_fma_f32 v29, v29, v19, v19
  v_mfma_f32_16x16x32_bf16 v[72:75], a[176:179], a[196:199], 0
  ds_read_b64_tr_b16 a[170:171], v8 offset:6144
  buffer_load_dwordx4 a[60:63], v1, s[8:11], s74 offen offset:1024 sc1
  v_fma_f32 v30, v30, v19, v19
  v_mfma_f32_16x16x32_bf16 v[72:75], a[180:183], a[212:215], v[72:75]
  v_fma_f32 v31, v31, v19, v19
  v_rcp_f32 v24, v24
  v_mfma_f32_16x16x32_bf16 v[76:79], a[180:183], a[216:219], 0
  ds_read_b64_tr_b16 a[180:181], v9 offset:0
  v_rcp_f32 v25, v25
  v_mfma_f32_16x16x32_bf16 v[76:79], a[176:179], a[200:203], v[76:79]
  v_rcp_f32 v26, v26
  s_waitcnt lgkmcnt(5)
  v_mfma_f32_16x16x32_bf16 v[92:95], a[164:167], a[200:203], 0
  ds_read_b64_tr_b16 a[182:183], v9 offset:2048
  v_mfma_f32_16x16x32_bf16 v[92:95], a[160:163], a[216:219], v[92:95]
  buffer_load_dwordx4 a[64:67], v1, s[8:11], s75 offen offset:0 sc1
  v_rcp_f32 v27, v27
  v_mfma_f32_16x16x32_bf16 v[88:91], a[160:163], a[212:215], 0
  ds_read_b64_tr_b16 a[176:177], v9 offset:4096
  v_rcp_f32 v28, v28
  v_mfma_f32_16x16x32_bf16 v[88:91], a[164:167], a[196:199], v[88:91]
  v_rcp_f32 v29, v29
  v_rcp_f32 v30, v30
  v_mfma_f32_16x16x32_bf16 v[84:87], a[164:167], a[192:195], 0
  ds_read_b64_tr_b16 a[178:179], v9 offset:6144
  v_rcp_f32 v31, v31
  v_mfma_f32_16x16x32_bf16 v[84:87], a[160:163], a[208:211], v[84:87]
  buffer_load_dwordx4 a[80:83], v1, s[8:11], s75 offen offset:1024 sc1
  v_mul_f32 v208, v208, v24
  v_mul_f32 v209, v209, v25
  v_mfma_f32_16x16x32_bf16 v[80:83], a[160:163], a[204:207], 0
  ds_read_b64_tr_b16 a[160:161], v6 offset:8192
  v_mul_f32 v210, v210, v26
  v_mul_f32 v211, v211, v27
  v_mul_f32 v212, v212, v28
  v_mfma_f32_16x16x32_bf16 v[80:83], a[164:167], a[188:191], v[80:83]
  v_mul_f32 v213, v213, v29
  v_mul_f32 v214, v214, v30
  s_waitcnt lgkmcnt(5)
  v_mfma_f32_16x16x32_bf16 v[96:99], a[172:175], a[188:191], 0
  ds_read_b64_tr_b16 a[162:163], v6 offset:10240
  v_mul_f32 v215, v215, v31
  v_cvt_pk_bf16_f32 v192, v208, v209
  v_mfma_f32_16x16x32_bf16 v[96:99], a[168:171], a[204:207], v[96:99]
  s_add_u32 s75, s75, 131072
  v_cvt_pk_bf16_f32 v193, v210, v211
  v_cvt_pk_bf16_f32 v196, v212, v213
  v_mfma_f32_16x16x32_bf16 v[100:103], a[168:171], a[208:211], 0
  ds_read_b64_tr_b16 a[164:165], v6 offset:12288
  buffer_load_dwordx4 a[68:71], v1, s[8:11], s75 offen offset:0 sc1
  v_cvt_pk_bf16_f32 v197, v214, v215
  v_mfma_f32_16x16x32_bf16 v[100:103], a[172:175], a[192:195], v[100:103]
  v_mul_f32 v24, v20, v200
  v_mul_f32 v25, v20, v201
  v_mul_f32 v26, v20, v202
  v_mfma_f32_16x16x32_bf16 v[104:107], a[172:175], a[196:199], 0
  ds_read_b64_tr_b16 a[166:167], v6 offset:14336
  v_mul_f32 v27, v20, v203
  v_mul_f32 v28, v22, v204
  v_mul_f32 v29, v22, v205
  v_mfma_f32_16x16x32_bf16 v[104:107], a[168:171], a[212:215], v[104:107]
  v_mul_f32 v30, v22, v206
  v_mul_f32 v31, v22, v207
  v_mfma_f32_16x16x32_bf16 v[108:111], a[168:171], a[216:219], 0
  ds_read_b64_tr_b16 a[168:169], v7 offset:8192
  buffer_load_dwordx4 a[84:87], v1, s[8:11], s75 offen offset:1024 sc1
  v_exp_f32 v24, v24
  v_mfma_f32_16x16x32_bf16 v[108:111], a[172:175], a[200:203], v[108:111]
  v_mul_f32 v216, v200, v216
  s_waitcnt lgkmcnt(5)
  v_mfma_f32_16x16x32_bf16 v[124:127], a[180:183], a[200:203], 0
  ds_read_b64_tr_b16 a[170:171], v7 offset:10240
  v_exp_f32 v25, v25
  v_mul_f32 v217, v201, v217
  v_mfma_f32_16x16x32_bf16 v[124:127], a[176:179], a[216:219], v[124:127]
  v_exp_f32 v26, v26
  v_mul_f32 v218, v202, v218
  v_mfma_f32_16x16x32_bf16 v[120:123], a[176:179], a[212:215], 0
  ds_read_b64_tr_b16 a[172:173], v7 offset:12288
  s_add_u32 s75, s75, s89
  v_mfma_f32_16x16x32_bf16 v[120:123], a[180:183], a[196:199], v[120:123]
  buffer_load_dwordx4 a[72:75], v1, s[8:11], s75 offen offset:0 sc1
  v_exp_f32 v27, v27
  v_mul_f32 v219, v203, v219
  v_mfma_f32_16x16x32_bf16 v[116:119], a[180:183], a[192:195], 0
  ds_read_b64_tr_b16 a[174:175], v7 offset:14336
  v_exp_f32 v28, v28
  v_mfma_f32_16x16x32_bf16 v[116:119], a[176:179], a[208:211], v[116:119]
  v_mul_f32 v220, v204, v220
  v_exp_f32 v29, v29
  v_mfma_f32_16x16x32_bf16 v[112:115], a[176:179], a[204:207], 0
  ds_read_b64_tr_b16 a[176:177], v8 offset:8192
  v_mul_f32 v221, v205, v221
  v_exp_f32 v30, v30
  v_mfma_f32_16x16x32_bf16 v[112:115], a[180:183], a[188:191], v[112:115]
  buffer_load_dwordx4 a[88:91], v1, s[8:11], s75 offen offset:1024 sc1
  v_mul_f32 v222, v206, v222
  s_waitcnt lgkmcnt(5)
  v_mfma_f32_16x16x32_bf16 v[128:131], a[160:163], a[188:191], 0
  ds_read_b64_tr_b16 a[178:179], v8 offset:10240
  v_exp_f32 v31, v31
  v_mfma_f32_16x16x32_bf16 v[128:131], a[164:167], a[204:207], v[128:131]
  v_mul_f32 v223, v207, v223
  v_fma_f32 v24, v24, v21, v21
  v_fma_f32 v25, v25, v21, v21
  v_mfma_f32_16x16x32_bf16 v[132:135], a[164:167], a[208:211], 0
  ds_read_b64_tr_b16 a[180:181], v8 offset:12288
  v_fma_f32 v26, v26, v21, v21
  v_fma_f32 v27, v27, v21, v21
  v_mfma_f32_16x16x32_bf16 v[132:135], a[160:163], a[192:195], v[132:135]
  s_add_u32 s75, s75, 131072
  v_fma_f32 v28, v28, v23, v23
  v_fma_f32 v29, v29, v23, v23
  v_mfma_f32_16x16x32_bf16 v[136:139], a[160:163], a[196:199], 0
  ds_read_b64_tr_b16 a[182:183], v8 offset:14336
  buffer_load_dwordx4 a[76:79], v1, s[8:11], s75 offen offset:0 sc1
  v_fma_f32 v30, v30, v23, v23
  v_fma_f32 v31, v31, v23, v23
  v_mfma_f32_16x16x32_bf16 v[136:139], a[164:167], a[212:215], v[136:139]
  v_rcp_f32 v24, v24
  v_mfma_f32_16x16x32_bf16 v[140:143], a[164:167], a[216:219], 0
  ds_read_b64_tr_b16 a[164:165], v9 offset:8192
  v_rcp_f32 v25, v25
  v_mfma_f32_16x16x32_bf16 v[140:143], a[160:163], a[200:203], v[140:143]
  v_rcp_f32 v26, v26
  s_waitcnt lgkmcnt(5)
  v_mfma_f32_16x16x32_bf16 v[156:159], a[168:171], a[200:203], 0
  ds_read_b64_tr_b16 a[166:167], v9 offset:10240
  buffer_load_dwordx4 a[92:95], v1, s[8:11], s75 offen offset:1024 sc1
  v_rcp_f32 v27, v27
  v_mfma_f32_16x16x32_bf16 v[156:159], a[172:175], a[216:219], v[156:159]
  v_rcp_f32 v28, v28
  v_mfma_f32_16x16x32_bf16 v[152:155], a[172:175], a[212:215], 0
  ds_read_b64_tr_b16 a[160:161], v9 offset:12288
  v_rcp_f32 v29, v29
  v_mfma_f32_16x16x32_bf16 v[152:155], a[168:171], a[196:199], v[152:155]
  v_rcp_f32 v30, v30
  v_rcp_f32 v31, v31
  v_mfma_f32_16x16x32_bf16 v[148:151], a[168:171], a[192:195], 0
  ds_read_b64_tr_b16 a[162:163], v9 offset:14336
  s_cmp_eq_u32 s91, 1
  s_cselect_b32 s76, 3, 10
  s_lshl_b32 s68, s76, 17
  s_lshl_b32 s76, s76, 11
  s_add_u32 s76, s76, s84
  s_add_u32 m0, s45, 32768
  v_mul_f32 v216, v216, v24
  v_mfma_f32_16x16x32_bf16 v[148:151], a[172:175], a[208:211], v[148:151]
  buffer_load_dwordx4 v32, s[36:39], s68 offen lds
  v_mul_f32 v217, v217, v25
  v_mul_f32 v218, v218, v26
  v_mfma_f32_16x16x32_bf16 v[144:147], a[172:175], a[204:207], 0
  ds_read_b64_tr_b16 a[172:173], v6 offset:49152
  v_mul_f32 v219, v219, v27
  v_mul_f32 v220, v220, v28
  v_mul_f32 v221, v221, v29
  v_mfma_f32_16x16x32_bf16 v[144:147], a[168:171], a[188:191], v[144:147]
  v_mul_f32 v222, v222, v30
  v_mul_f32 v223, v223, v31
  s_waitcnt lgkmcnt(5)
  v_mfma_f32_16x16x32_bf16 v[160:163], a[176:179], a[188:191], 0
  ds_read_b64_tr_b16 a[174:175], v6 offset:51200
  s_add_u32 m0, s45, 36864
  s_add_u32 s61, s68, 65536
  v_mfma_f32_16x16x32_bf16 v[160:163], a[180:183], a[204:207], v[160:163]
  buffer_load_dwordx4 v32, s[36:39], s61 offen lds
  v_cvt_pk_bf16_f32 v200, v216, v217
  v_cvt_pk_bf16_f32 v201, v218, v219
  v_cvt_pk_bf16_f32 v204, v220, v221
  v_cvt_pk_bf16_f32 v205, v222, v223
  v_mfma_f32_16x16x32_bf16 v[164:167], a[180:183], a[208:211], 0
  ds_read_b64_tr_b16 a[168:169], v6 offset:53248
  v_mul_f32 v24, v16, v224
  v_mul_f32 v25, v16, v225
  v_mfma_f32_16x16x32_bf16 v[164:167], a[176:179], a[192:195], v[164:167]
  v_mul_f32 v26, v16, v226
  v_mul_f32 v27, v16, v227
  v_mul_f32 v28, v18, v228
  v_mul_f32 v29, v18, v229
  v_mfma_f32_16x16x32_bf16 v[168:171], a[176:179], a[196:199], 0
  ds_read_b64_tr_b16 a[170:171], v6 offset:55296
  v_mul_f32 v30, v18, v230
  v_mul_f32 v31, v18, v231
  v_mfma_f32_16x16x32_bf16 v[168:171], a[180:183], a[212:215], v[168:171]
  s_add_u32 m0, s45, 40960
  v_exp_f32 v24, v24
  v_mfma_f32_16x16x32_bf16 v[172:175], a[180:183], a[216:219], 0
  ds_read_b64_tr_b16 a[180:181], v7 offset:49152
  buffer_load_dwordx4 v33, s[36:39], s68 offen lds
  v_mul_f32 v240, v224, v240
  v_mfma_f32_16x16x32_bf16 v[172:175], a[176:179], a[200:203], v[172:175]
  v_exp_f32 v25, v25
  v_mul_f32 v241, v225, v241
  s_waitcnt lgkmcnt(5)
  v_mfma_f32_16x16x32_bf16 v[188:191], a[164:167], a[200:203], 0
  ds_read_b64_tr_b16 a[182:183], v7 offset:51200
  v_exp_f32 v26, v26
  v_mfma_f32_16x16x32_bf16 v[188:191], a[160:163], a[216:219], v[188:191]
  s_add_u32 m0, s45, 45056
  s_add_u32 s61, s68, 65536
  v_mul_f32 v242, v226, v242
  v_mfma_f32_16x16x32_bf16 v[184:187], a[160:163], a[212:215], 0
  ds_read_b64_tr_b16 a[176:177], v7 offset:53248
  buffer_load_dwordx4 v33, s[36:39], s61 offen lds
  v_exp_f32 v27, v27
  v_mfma_f32_16x16x32_bf16 v[184:187], a[164:167], a[196:199], v[184:187]
  v_mul_f32 v243, v227, v243
  v_exp_f32 v28, v28
  v_mfma_f32_16x16x32_bf16 v[180:183], a[164:167], a[192:195], 0
  ds_read_b64_tr_b16 a[178:179], v7 offset:55296
  v_mul_f32 v244, v228, v244
  v_exp_f32 v29, v29
  v_mfma_f32_16x16x32_bf16 v[180:183], a[160:163], a[208:211], v[180:183]
  v_mul_f32 v245, v229, v245
  v_exp_f32 v30, v30
  v_mfma_f32_16x16x32_bf16 v[176:179], a[160:163], a[204:207], 0
  ds_read_b64_tr_b16 a[160:161], v8 offset:49152
  s_cmp_eq_u32 s91, 2
  s_cselect_b32 s77, 5, 12
  s_lshl_b32 s69, s77, 17
  s_lshl_b32 s77, s77, 11
  s_add_u32 s77, s77, s84
  s_add_u32 m0, s45, 49152
  v_mul_f32 v246, v230, v246
  v_mfma_f32_16x16x32_bf16 v[176:179], a[164:167], a[188:191], v[176:179]
  buffer_load_dwordx4 v32, s[36:39], s69 offen lds
  v_exp_f32 v31, v31
  s_waitcnt vmcnt(23) lgkmcnt(5)
  v_mfma_f32_16x16x32_bf16 v[64:67], a[172:175], a[220:223], v[64:67]
  ds_read_b64_tr_b16 a[162:163], v8 offset:51200
  v_mul_f32 v247, v231, v247
  v_fma_f32 v24, v24, v17, v17
  v_mfma_f32_16x16x32_bf16 v[64:67], a[168:171], a[236:239], v[64:67]
  v_fma_f32 v25, v25, v17, v17
  v_fma_f32 v26, v26, v17, v17
  v_fma_f32 v27, v27, v17, v17
  v_mfma_f32_16x16x32_bf16 v[68:71], a[168:171], a[240:243], v[68:71]
  ds_read_b64_tr_b16 a[164:165], v8 offset:53248
  s_add_u32 m0, s45, 53248
  s_add_u32 s61, s69, 65536
  v_fma_f32 v28, v28, v19, v19
  v_mfma_f32_16x16x32_bf16 v[68:71], a[172:175], a[224:227], v[68:71]
  buffer_load_dwordx4 v32, s[36:39], s61 offen lds
  v_fma_f32 v29, v29, v19, v19
  v_fma_f32 v30, v30, v19, v19
  v_mfma_f32_16x16x32_bf16 v[72:75], a[172:175], a[228:231], v[72:75]
  ds_read_b64_tr_b16 a[166:167], v8 offset:55296
  v_fma_f32 v31, v31, v19, v19
  v_mfma_f32_16x16x32_bf16 v[72:75], a[168:171], a[244:247], v[72:75]
  v_rcp_f32 v24, v24
  v_rcp_f32 v25, v25
  v_mfma_f32_16x16x32_bf16 v[76:79], a[168:171], a[248:251], v[76:79]
  ds_read_b64_tr_b16 a[168:169], v9 offset:49152
  v_rcp_f32 v26, v26
  v_mfma_f32_16x16x32_bf16 v[76:79], a[172:175], a[232:235], v[76:79]
  s_add_u32 m0, s45, 57344
  v_rcp_f32 v27, v27
  s_waitcnt lgkmcnt(5)
  v_mfma_f32_16x16x32_bf16 v[92:95], a[180:183], a[232:235], v[92:95]
  ds_read_b64_tr_b16 a[170:171], v9 offset:51200
  buffer_load_dwordx4 v33, s[36:39], s69 offen lds
  v_mfma_f32_16x16x32_bf16 v[92:95], a[176:179], a[248:251], v[92:95]
  v_rcp_f32 v28, v28
  v_rcp_f32 v29, v29
  v_mfma_f32_16x16x32_bf16 v[88:91], a[176:179], a[244:247], v[88:91]
  ds_read_b64_tr_b16 a[172:173], v9 offset:53248
  v_rcp_f32 v30, v30
  v_mfma_f32_16x16x32_bf16 v[88:91], a[180:183], a[228:231], v[88:91]
  s_add_u32 m0, s45, 61440
  s_add_u32 s61, s69, 65536
  v_rcp_f32 v31, v31
  v_mfma_f32_16x16x32_bf16 v[84:87], a[180:183], a[224:227], v[84:87]
  ds_read_b64_tr_b16 a[174:175], v9 offset:55296
  buffer_load_dwordx4 v33, s[36:39], s61 offen lds
  v_mul_f32 v240, v240, v24
  v_mfma_f32_16x16x32_bf16 v[84:87], a[176:179], a[240:243], v[84:87]
  v_mul_f32 v241, v241, v25
  v_mul_f32 v242, v242, v26
  v_mul_f32 v243, v243, v27
  v_mul_f32 v244, v244, v28
  v_mfma_f32_16x16x32_bf16 v[80:83], a[176:179], a[236:239], v[80:83]
  ds_read_b64_tr_b16 a[176:177], v6 offset:57344
  v_mul_f32 v245, v245, v29
  v_mul_f32 v246, v246, v30
  v_mfma_f32_16x16x32_bf16 v[80:83], a[180:183], a[220:223], v[80:83]
  v_mul_f32 v247, v247, v31
  v_cvt_pk_bf16_f32 v194, v240, v241
  s_waitcnt lgkmcnt(5)
  v_mfma_f32_16x16x32_bf16 v[96:99], a[160:163], a[220:223], v[96:99]
  ds_read_b64_tr_b16 a[178:179], v6 offset:59392
  v_cvt_pk_bf16_f32 v195, v242, v243
  v_mfma_f32_16x16x32_bf16 v[96:99], a[164:167], a[236:239], v[96:99]
  buffer_load_dwordx4 a[96:99], v1, s[8:11], s76 offen offset:0 sc1
  buffer_store_dwordx4 v[192:195], v1, s[8:11], s58 offen offset:1024 sc1
  v_cvt_pk_bf16_f32 v198, v244, v245
  v_mfma_f32_16x16x32_bf16 v[100:103], a[164:167], a[240:243], v[100:103]
  ds_read_b64_tr_b16 a[180:181], v6 offset:61440
  v_cvt_pk_bf16_f32 v199, v246, v247
  v_mfma_f32_16x16x32_bf16 v[100:103], a[160:163], a[224:227], v[100:103]
  s_add_u32 s55, s58, 262144
  buffer_store_dwordx4 v[196:199], v1, s[8:11], s55 offen offset:1024 sc1
  v_mul_f32 v24, v20, v232
  v_mul_f32 v25, v20, v233
  v_mfma_f32_16x16x32_bf16 v[104:107], a[160:163], a[228:231], v[104:107]
  ds_read_b64_tr_b16 a[182:183], v6 offset:63488
  v_mul_f32 v26, v20, v234
  v_mul_f32 v27, v20, v235
  v_mul_f32 v28, v22, v236
  v_mfma_f32_16x16x32_bf16 v[104:107], a[164:167], a[244:247], v[104:107]
  buffer_load_dwordx4 a[112:115], v1, s[8:11], s76 offen offset:1024 sc1
  v_mul_f32 v29, v22, v237
  v_mul_f32 v30, v22, v238
  v_mfma_f32_16x16x32_bf16 v[108:111], a[164:167], a[248:251], v[108:111]
  ds_read_b64_tr_b16 a[164:165], v7 offset:57344
  v_mul_f32 v31, v22, v239
  v_mfma_f32_16x16x32_bf16 v[108:111], a[160:163], a[232:235], v[108:111]
  v_exp_f32 v24, v24
  v_mul_f32 v248, v232, v248
  s_waitcnt lgkmcnt(5)
  v_mfma_f32_16x16x32_bf16 v[124:127], a[168:171], a[232:235], v[124:127]
  ds_read_b64_tr_b16 a[166:167], v7 offset:59392
  v_exp_f32 v25, v25
  v_mul_f32 v249, v233, v249
  v_mfma_f32_16x16x32_bf16 v[124:127], a[172:175], a[248:251], v[124:127]
  s_add_u32 s76, s76, 131072
  v_exp_f32 v26, v26
  v_mfma_f32_16x16x32_bf16 v[120:123], a[172:175], a[244:247], v[120:123]
  ds_read_b64_tr_b16 a[160:161], v7 offset:61440
  buffer_load_dwordx4 a[100:103], v1, s[8:11], s76 offen offset:0 sc1
  v_mul_f32 v250, v234, v250
  v_mfma_f32_16x16x32_bf16 v[120:123], a[168:171], a[228:231], v[120:123]
  v_exp_f32 v27, v27
  v_mul_f32 v251, v235, v251
  v_mfma_f32_16x16x32_bf16 v[116:119], a[168:171], a[224:227], v[116:119]
  ds_read_b64_tr_b16 a[162:163], v7 offset:63488
  v_exp_f32 v28, v28
  v_mul_f32 v252, v236, v252
  v_mfma_f32_16x16x32_bf16 v[116:119], a[172:175], a[240:243], v[116:119]
  v_exp_f32 v29, v29
  v_mul_f32 v253, v237, v253
  v_mfma_f32_16x16x32_bf16 v[112:115], a[172:175], a[236:239], v[112:115]
  ds_read_b64_tr_b16 a[172:173], v8 offset:57344
  buffer_load_dwordx4 a[116:119], v1, s[8:11], s76 offen offset:1024 sc1
  v_exp_f32 v30, v30
  v_mfma_f32_16x16x32_bf16 v[112:115], a[168:171], a[220:223], v[112:115]
  v_mul_f32 v254, v238, v254
  s_waitcnt lgkmcnt(5)
  v_mfma_f32_16x16x32_bf16 v[128:131], a[176:179], a[220:223], v[128:131]
  ds_read_b64_tr_b16 a[174:175], v8 offset:59392
  v_exp_f32 v31, v31
  v_mul_f32 v255, v239, v255
  v_mfma_f32_16x16x32_bf16 v[128:131], a[180:183], a[236:239], v[128:131]
  v_fma_f32 v24, v24, v21, v21
  v_fma_f32 v25, v25, v21, v21
  v_fma_f32 v26, v26, v21, v21
  v_fma_f32 v27, v27, v21, v21
  v_mfma_f32_16x16x32_bf16 v[132:135], a[180:183], a[240:243], v[132:135]
  ds_read_b64_tr_b16 a[168:169], v8 offset:61440
  s_add_u32 s76, s76, s89
  v_fma_f32 v28, v28, v23, v23
  v_mfma_f32_16x16x32_bf16 v[132:135], a[176:179], a[224:227], v[132:135]
  buffer_load_dwordx4 a[104:107], v1, s[8:11], s76 offen offset:0 sc1
  v_fma_f32 v29, v29, v23, v23
  v_fma_f32 v30, v30, v23, v23
  v_mfma_f32_16x16x32_bf16 v[136:139], a[176:179], a[228:231], v[136:139]
  ds_read_b64_tr_b16 a[170:171], v8 offset:63488
  v_fma_f32 v31, v31, v23, v23
  v_rcp_f32 v24, v24
  v_mfma_f32_16x16x32_bf16 v[136:139], a[180:183], a[244:247], v[136:139]
  v_rcp_f32 v25, v25
  v_mfma_f32_16x16x32_bf16 v[140:143], a[180:183], a[248:251], v[140:143]
  ds_read_b64_tr_b16 a[180:181], v9 offset:57344
HOP16:
  s_cbranch_execz HOP19
  v_rcp_f32 v26, v26
  v_mfma_f32_16x16x32_bf16 v[140:143], a[176:179], a[232:235], v[140:143]
  buffer_load_dwordx4 a[120:123], v1, s[8:11], s76 offen offset:1024 sc1
  v_rcp_f32 v27, v27
  s_waitcnt lgkmcnt(5)
  v_mfma_f32_16x16x32_bf16 v[156:159], a[164:167], a[232:235], v[156:159]
  ds_read_b64_tr_b16 a[182:183], v9 offset:59392
  v_rcp_f32 v28, v28
  v_mfma_f32_16x16x32_bf16 v[156:159], a[160:163], a[248:251], v[156:159]
  v_rcp_f32 v29, v29
  v_rcp_f32 v30, v30
  v_mfma_f32_16x16x32_bf16 v[152:155], a[160:163], a[244:247], v[152:155]
  ds_read_b64_tr_b16 a[176:177], v9 offset:61440
  v_rcp_f32 v31, v31
  v_mfma_f32_16x16x32_bf16 v[152:155], a[164:167], a[228:231], v[152:155]
  s_add_u32 s76, s76, 131072
  v_mul_f32 v248, v248, v24
  v_mul_f32 v249, v249, v25
  v_mul_f32 v250, v250, v26
  v_mfma_f32_16x16x32_bf16 v[148:151], a[164:167], a[224:227], v[148:151]
  ds_read_b64_tr_b16 a[178:179], v9 offset:63488
  buffer_load_dwordx4 a[108:111], v1, s[8:11], s76 offen offset:0 sc1
  v_mul_f32 v251, v251, v27
  v_mfma_f32_16x16x32_bf16 v[148:151], a[160:163], a[240:243], v[148:151]
  v_mul_f32 v252, v252, v28
  s_waitcnt vmcnt(54)
  s_barrier
  v_mfma_f32_16x16x32_bf16 v[144:147], a[160:163], a[236:239], v[144:147]
  ds_read_b64_tr_b16 a[160:161], v6 offset:32768
  v_mul_f32 v253, v253, v29
  v_mul_f32 v254, v254, v30
  v_mul_f32 v255, v255, v31
  v_mfma_f32_16x16x32_bf16 v[144:147], a[164:167], a[220:223], v[144:147]
  v_cvt_pk_bf16_f32 v202, v248, v249
  v_cvt_pk_bf16_f32 v203, v250, v251
  s_waitcnt lgkmcnt(5)
  v_mfma_f32_16x16x32_bf16 v[160:163], a[172:175], a[220:223], v[160:163]
  ds_read_b64_tr_b16 a[162:163], v6 offset:34816
  buffer_load_dwordx4 a[124:127], v1, s[8:11], s76 offen offset:1024 sc1
  v_mfma_f32_16x16x32_bf16 v[160:163], a[168:171], a[236:239], v[160:163]
  s_add_u32 s55, s58, 524288
  buffer_store_dwordx4 v[200:203], v1, s[8:11], s55 offen offset:1024 sc1
  v_cvt_pk_bf16_f32 v206, v252, v253
  v_cvt_pk_bf16_f32 v207, v254, v255
  s_add_u32 s55, s58, 786432
  buffer_store_dwordx4 v[204:207], v1, s[8:11], s55 offen offset:1024 sc1
  v_mfma_f32_16x16x32_bf16 v[164:167], a[168:171], a[240:243], v[164:167]
  ds_read_b64_tr_b16 a[164:165], v6 offset:36864
  s_sub_u32 s80, s80, 491520
  v_mfma_f32_16x16x32_bf16 v[164:167], a[172:175], a[224:227], v[164:167]
  v_mfma_f32_16x16x32_bf16 v[168:171], a[172:175], a[228:231], v[168:171]
  ds_read_b64_tr_b16 a[166:167], v6 offset:38912
  v_mfma_f32_16x16x32_bf16 v[168:171], a[168:171], a[244:247], v[168:171]
  buffer_load_dwordx4 a[128:131], v1, s[8:11], s77 offen offset:0 sc1
  v_mfma_f32_16x16x32_bf16 v[172:175], a[168:171], a[248:251], v[172:175]
  ds_read_b64_tr_b16 a[168:169], v7 offset:32768
  v_mfma_f32_16x16x32_bf16 v[172:175], a[172:175], a[232:235], v[172:175]
  s_waitcnt lgkmcnt(5)
  v_mfma_f32_16x16x32_bf16 v[188:191], a[180:183], a[232:235], v[188:191]
  ds_read_b64_tr_b16 a[170:171], v7 offset:34816
  v_mfma_f32_16x16x32_bf16 v[188:191], a[176:179], a[248:251], v[188:191]
  buffer_load_dwordx4 a[144:147], v1, s[8:11], s77 offen offset:1024 sc1
  v_mfma_f32_16x16x32_bf16 v[184:187], a[176:179], a[244:247], v[184:187]
  ds_read_b64_tr_b16 a[172:173], v7 offset:36864
  v_mfma_f32_16x16x32_bf16 v[184:187], a[180:183], a[228:231], v[184:187]
  v_mfma_f32_16x16x32_bf16 v[180:183], a[180:183], a[224:227], v[180:183]
  ds_read_b64_tr_b16 a[174:175], v7 offset:38912
  v_mfma_f32_16x16x32_bf16 v[180:183], a[176:179], a[240:243], v[180:183]
  s_add_u32 s77, s77, 131072
  v_mfma_f32_16x16x32_bf16 v[176:179], a[176:179], a[236:239], v[176:179]
  ds_read_b64_tr_b16 a[176:177], v8 offset:32768
  buffer_load_dwordx4 a[132:135], v1, s[8:11], s77 offen offset:0 sc1
  v_mfma_f32_16x16x32_bf16 v[176:179], a[180:183], a[220:223], v[176:179]
  s_waitcnt vmcnt(31) lgkmcnt(5)
  v_mfma_f32_16x16x32_bf16 v[64:67], a[160:163], a[32:35], v[64:67]
  ds_read_b64_tr_b16 a[178:179], v8 offset:34816
  v_mfma_f32_16x16x32_bf16 v[64:67], a[164:167], a[48:51], v[64:67]
  v_mfma_f32_16x16x32_bf16 v[68:71], a[164:167], a[52:55], v[68:71]
  ds_read_b64_tr_b16 a[180:181], v8 offset:36864
  buffer_load_dwordx4 a[148:151], v1, s[8:11], s77 offen offset:1024 sc1
  v_mfma_f32_16x16x32_bf16 v[68:71], a[160:163], a[36:39], v[68:71]
  v_mfma_f32_16x16x32_bf16 v[72:75], a[160:163], a[40:43], v[72:75]
  ds_read_b64_tr_b16 a[182:183], v8 offset:38912
  v_mfma_f32_16x16x32_bf16 v[72:75], a[164:167], a[56:59], v[72:75]
  v_mfma_f32_16x16x32_bf16 v[76:79], a[164:167], a[60:63], v[76:79]
  ds_read_b64_tr_b16 a[164:165], v9 offset:32768
  s_add_u32 s77, s77, s89
  v_mfma_f32_16x16x32_bf16 v[76:79], a[160:163], a[44:47], v[76:79]
  buffer_load_dwordx4 a[136:139], v1, s[8:11], s77 offen offset:0 sc1
  s_waitcnt lgkmcnt(5)
  v_mfma_f32_16x16x32_bf16 v[92:95], a[168:171], a[44:47], v[92:95]
  ds_read_b64_tr_b16 a[166:167], v9 offset:34816
  v_mfma_f32_16x16x32_bf16 v[92:95], a[172:175], a[60:63], v[92:95]
  v_mfma_f32_16x16x32_bf16 v[88:91], a[172:175], a[56:59], v[88:91]
  ds_read_b64_tr_b16 a[160:161], v9 offset:36864
  v_mfma_f32_16x16x32_bf16 v[88:91], a[168:171], a[40:43], v[88:91]
  buffer_load_dwordx4 a[152:155], v1, s[8:11], s77 offen offset:1024 sc1
  v_mfma_f32_16x16x32_bf16 v[84:87], a[168:171], a[36:39], v[84:87]
  ds_read_b64_tr_b16 a[162:163], v9 offset:38912
  v_mfma_f32_16x16x32_bf16 v[84:87], a[172:175], a[52:55], v[84:87]
  v_mfma_f32_16x16x32_bf16 v[80:83], a[172:175], a[48:51], v[80:83]
  ds_read_b64_tr_b16 a[172:173], v6 offset:40960
  v_mfma_f32_16x16x32_bf16 v[80:83], a[168:171], a[32:35], v[80:83]
  s_add_u32 s77, s77, 131072
  s_waitcnt lgkmcnt(5)
  v_mfma_f32_16x16x32_bf16 v[96:99], a[176:179], a[32:35], v[96:99]
  ds_read_b64_tr_b16 a[174:175], v6 offset:43008
  buffer_load_dwordx4 a[140:143], v1, s[8:11], s77 offen offset:0 sc1
  v_mfma_f32_16x16x32_bf16 v[96:99], a[180:183], a[48:51], v[96:99]
  v_mfma_f32_16x16x32_bf16 v[100:103], a[180:183], a[52:55], v[100:103]
  ds_read_b64_tr_b16 a[168:169], v6 offset:45056
  v_mfma_f32_16x16x32_bf16 v[100:103], a[176:179], a[36:39], v[100:103]
  v_mfma_f32_16x16x32_bf16 v[104:107], a[176:179], a[40:43], v[104:107]
  ds_read_b64_tr_b16 a[170:171], v6 offset:47104
  buffer_load_dwordx4 a[156:159], v1, s[8:11], s77 offen offset:1024 sc1
  v_mfma_f32_16x16x32_bf16 v[104:107], a[180:183], a[56:59], v[104:107]
  v_mfma_f32_16x16x32_bf16 v[108:111], a[180:183], a[60:63], v[108:111]
  ds_read_b64_tr_b16 a[180:181], v7 offset:40960
  v_mfma_f32_16x16x32_bf16 v[108:111], a[176:179], a[44:47], v[108:111]
  s_waitcnt lgkmcnt(5)
  v_mfma_f32_16x16x32_bf16 v[124:127], a[164:167], a[44:47], v[124:127]
  ds_read_b64_tr_b16 a[182:183], v7 offset:43008
  s_cmp_eq_u32 s91, 0
  s_cselect_b32 s78, 7, 0
  s_lshl_b32 s70, s78, 17
  s_lshl_b32 s78, s78, 11
  s_add_u32 s78, s78, s84
  s_add_u32 m0, s45, 16384
  v_mfma_f32_16x16x32_bf16 v[124:127], a[160:163], a[60:63], v[124:127]
  buffer_load_dwordx4 v32, s[36:39], s70 offen lds
  v_mfma_f32_16x16x32_bf16 v[120:123], a[160:163], a[56:59], v[120:123]
  ds_read_b64_tr_b16 a[176:177], v7 offset:45056
  v_mfma_f32_16x16x32_bf16 v[120:123], a[164:167], a[40:43], v[120:123]
  v_mfma_f32_16x16x32_bf16 v[116:119], a[164:167], a[36:39], v[116:119]
  ds_read_b64_tr_b16 a[178:179], v7 offset:47104
  s_add_u32 m0, s45, 20480
  s_add_u32 s61, s70, 65536
  v_mfma_f32_16x16x32_bf16 v[116:119], a[160:163], a[52:55], v[116:119]
  buffer_load_dwordx4 v32, s[36:39], s61 offen lds
  v_mfma_f32_16x16x32_bf16 v[112:115], a[160:163], a[48:51], v[112:115]
  ds_read_b64_tr_b16 a[160:161], v8 offset:40960
  v_mfma_f32_16x16x32_bf16 v[112:115], a[164:167], a[32:35], v[112:115]
  s_waitcnt lgkmcnt(5)
  v_mfma_f32_16x16x32_bf16 v[128:131], a[172:175], a[32:35], v[128:131]
  ds_read_b64_tr_b16 a[162:163], v8 offset:43008
  v_mfma_f32_16x16x32_bf16 v[128:131], a[168:171], a[48:51], v[128:131]
  s_add_u32 m0, s45, 24576
  v_mfma_f32_16x16x32_bf16 v[132:135], a[168:171], a[52:55], v[132:135]
  ds_read_b64_tr_b16 a[164:165], v8 offset:45056
  buffer_load_dwordx4 v33, s[36:39], s70 offen lds
  v_mfma_f32_16x16x32_bf16 v[132:135], a[172:175], a[36:39], v[132:135]
  v_mfma_f32_16x16x32_bf16 v[136:139], a[172:175], a[40:43], v[136:139]
  ds_read_b64_tr_b16 a[166:167], v8 offset:47104
  v_mfma_f32_16x16x32_bf16 v[136:139], a[168:171], a[56:59], v[136:139]
  s_add_u32 m0, s45, 28672
  s_add_u32 s61, s70, 65536
  v_mfma_f32_16x16x32_bf16 v[140:143], a[168:171], a[60:63], v[140:143]
  ds_read_b64_tr_b16 a[168:169], v9 offset:40960
  buffer_load_dwordx4 v33, s[36:39], s61 offen lds
  v_mfma_f32_16x16x32_bf16 v[140:143], a[172:175], a[44:47], v[140:143]
  s_waitcnt lgkmcnt(5)
  v_mfma_f32_16x16x32_bf16 v[156:159], a[180:183], a[44:47], v[156:159]
  ds_read_b64_tr_b16 a[170:171], v9 offset:43008
  v_mfma_f32_16x16x32_bf16 v[156:159], a[176:179], a[60:63], v[156:159]
  v_mfma_f32_16x16x32_bf16 v[152:155], a[176:179], a[56:59], v[152:155]
  ds_read_b64_tr_b16 a[172:173], v9 offset:45056
  s_cmp_eq_u32 s91, 1
  s_cselect_b32 s79, 9, 2
  s_lshl_b32 s71, s79, 17
  s_lshl_b32 s79, s79, 11
  s_add_u32 s79, s79, s84
  s_add_u32 m0, s45, 0
  v_mfma_f32_16x16x32_bf16 v[152:155], a[180:183], a[40:43], v[152:155]
  buffer_load_dwordx4 v32, s[36:39], s71 offen lds
  v_mfma_f32_16x16x32_bf16 v[148:151], a[180:183], a[36:39], v[148:151]
  ds_read_b64_tr_b16 a[174:175], v9 offset:47104
  v_mfma_f32_16x16x32_bf16 v[148:151], a[176:179], a[52:55], v[148:151]
  v_mfma_f32_16x16x32_bf16 v[144:147], a[176:179], a[48:51], v[144:147]
  ds_read_b64_tr_b16 a[176:177], v6 offset:16384
  s_add_u32 m0, s45, 4096
  s_add_u32 s61, s71, 65536
  v_mfma_f32_16x16x32_bf16 v[144:147], a[180:183], a[32:35], v[144:147]
  buffer_load_dwordx4 v32, s[36:39], s61 offen lds
  s_waitcnt lgkmcnt(5)
  v_mfma_f32_16x16x32_bf16 v[160:163], a[160:163], a[32:35], v[160:163]
  ds_read_b64_tr_b16 a[178:179], v6 offset:18432
  v_mfma_f32_16x16x32_bf16 v[160:163], a[164:167], a[48:51], v[160:163]
  v_add_u32 v38, s46, v0
  s_waitcnt vmcnt(14)
  s_barrier
  s_mov_b64 exec, 1
  buffer_store_dword v38, v0, s[8:11], s80 offen offset:0 sc1
  s_mov_b64 exec, -1
  v_mfma_f32_16x16x32_bf16 v[164:167], a[164:167], a[52:55], v[164:167]
  ds_read_b64_tr_b16 a[180:181], v6 offset:20480
  s_lshl_b32 s53, s44, 8
  v_mfma_f32_16x16x32_bf16 v[164:167], a[160:163], a[36:39], v[164:167]
  s_add_u32 m0, s45, 8192
  s_add_u32 s53, s53, 133120
  v_mfma_f32_16x16x32_bf16 v[168:171], a[160:163], a[40:43], v[168:171]
  ds_read_b64_tr_b16 a[182:183], v6 offset:22528
  buffer_load_dwordx4 v33, s[36:39], s71 offen lds
  v_mfma_f32_16x16x32_bf16 v[168:171], a[164:167], a[56:59], v[168:171]
  v_lshrrev_b32 v49, 4, v0
  v_lshl_add_u32 v46, v49, 4, s53
  v_mfma_f32_16x16x32_bf16 v[172:175], a[164:167], a[60:63], v[172:175]
  ds_read_b64_tr_b16 a[164:165], v7 offset:16384
  v_lshlrev_b32 v47, 2, v0
  v_mfma_f32_16x16x32_bf16 v[172:175], a[160:163], a[44:47], v[172:175]
  s_add_u32 m0, s45, 12288
  s_add_u32 s61, s71, 65536
  s_waitcnt lgkmcnt(5)
  v_mfma_f32_16x16x32_bf16 v[188:191], a[168:171], a[44:47], v[188:191]
  ds_read_b64_tr_b16 a[166:167], v7 offset:18432
  buffer_load_dwordx4 v33, s[36:39], s61 offen lds
  v_mfma_f32_16x16x32_bf16 v[188:191], a[172:175], a[60:63], v[188:191]
  v_add_u32 v45, s53, v47
  v_lshrrev_b32 v48, 3, v0
  v_mfma_f32_16x16x32_bf16 v[184:187], a[172:175], a[56:59], v[184:187]
  ds_read_b64_tr_b16 a[160:161], v7 offset:20480
  v_and_b32 v50, 7, v0
  v_mfma_f32_16x16x32_bf16 v[184:187], a[168:171], a[40:43], v[184:187]
  v_xor_b32 v51, v50, v48
  v_lshlrev_b32 v51, 4, v51
  v_mfma_f32_16x16x32_bf16 v[180:183], a[168:171], a[36:39], v[180:183]
  ds_read_b64_tr_b16 a[162:163], v7 offset:22528
  s_cmp_eq_u32 s91, 2
  s_cselect_b32 s72, 11, 4
  s_lshl_b32 s64, s72, 17
  s_lshl_b32 s72, s72, 11
  s_add_u32 s72, s72, s84
  s_add_u32 m0, s45, 65536
  v_mfma_f32_16x16x32_bf16 v[180:183], a[172:175], a[52:55], v[180:183]
  buffer_load_dwordx4 v32, s[36:39], s64 offen lds
  v_lshl_add_u32 v40, v48, 11, v51
  v_mfma_f32_16x16x32_bf16 v[176:179], a[172:175], a[48:51], v[176:179]
  ds_read_b64_tr_b16 a[172:173], v8 offset:16384
  v_bfe_u32 v48, v0, 4, 1
  v_mfma_f32_16x16x32_bf16 v[176:179], a[168:171], a[32:35], v[176:179]
  v_lshrrev_b32 v51, 5, v0
  s_waitcnt vmcnt(38) lgkmcnt(5)
  v_mfma_f32_16x16x32_bf16 v[64:67], a[176:179], a[64:67], v[64:67]
  ds_read_b64_tr_b16 a[174:175], v8 offset:18432
  s_add_u32 m0, s45, 69632
  s_add_u32 s61, s64, 65536
  v_mfma_f32_16x16x32_bf16 v[64:67], a[180:183], a[80:83], v[64:67]
  buffer_load_dwordx4 v32, s[36:39], s61 offen lds
  v_lshl_add_u32 v48, v48, 1, v51
  v_mfma_f32_16x16x32_bf16 v[68:71], a[180:183], a[84:87], v[68:71]
  ds_read_b64_tr_b16 a[168:169], v8 offset:20480
  v_xor_b32 v48, v48, v50
  v_mfma_f32_16x16x32_bf16 v[68:71], a[176:179], a[68:71], v[68:71]
  v_lshlrev_b32 v48, 4, v48
  v_and_b32 v50, 15, v0
  v_mfma_f32_16x16x32_bf16 v[72:75], a[176:179], a[72:75], v[72:75]
  ds_read_b64_tr_b16 a[170:171], v8 offset:22528
  v_lshl_add_u32 v48, v50, 7, v48
  v_mfma_f32_16x16x32_bf16 v[72:75], a[180:183], a[88:91], v[72:75]
  s_cmp_eq_u32 s91, 3
  s_cselect_b32 s73, 13, 6
  s_lshl_b32 s65, s73, 17
  s_lshl_b32 s73, s73, 11
  s_add_u32 s73, s73, s84
  s_add_u32 m0, s45, 114688
  v_add_u32 v42, s90, v48
  v_mfma_f32_16x16x32_bf16 v[76:79], a[180:183], a[92:95], v[76:79]
  ds_read_b64_tr_b16 a[180:181], v9 offset:16384
  buffer_load_dwordx4 v32, s[36:39], s65 offen lds
  v_mfma_f32_16x16x32_bf16 v[76:79], a[176:179], a[76:79], v[76:79]
  v_xor_b32 v43, 64, v42
  s_waitcnt lgkmcnt(5)
  v_mfma_f32_16x16x32_bf16 v[92:95], a[164:167], a[76:79], v[92:95]
  ds_read_b64_tr_b16 a[182:183], v9 offset:18432
  v_add_u32 v44, s90, v1
  v_mfma_f32_16x16x32_bf16 v[92:95], a[160:163], a[92:95], v[92:95]
  s_add_u32 m0, s45, 118784
  s_add_u32 s61, s65, 65536
  v_mfma_f32_16x16x32_bf16 v[88:91], a[160:163], a[88:91], v[88:91]
  ds_read_b64_tr_b16 a[176:177], v9 offset:20480
  buffer_load_dwordx4 v32, s[36:39], s61 offen lds
  v_mfma_f32_16x16x32_bf16 v[88:91], a[164:167], a[72:75], v[88:91]
  v_bfe_u32 v48, v0, 2, 2
  v_lshrrev_b32 v49, 4, v0
  v_mfma_f32_16x16x32_bf16 v[84:87], a[164:167], a[68:71], v[84:87]
  ds_read_b64_tr_b16 a[178:179], v9 offset:22528
  v_and_b32 v50, 1, v0
  v_mfma_f32_16x16x32_bf16 v[84:87], a[160:163], a[84:87], v[84:87]
  v_lshlrev_b32 v50, 4, v50
  v_mov_b32 v51, 0x3f80
  v_mfma_f32_16x16x32_bf16 v[80:83], a[160:163], a[80:83], v[80:83]
  ds_read_b64_tr_b16 a[160:161], v6 offset:24576
  s_add_u32 m0, s45, 73728
  v_mfma_f32_16x16x32_bf16 v[80:83], a[164:167], a[64:67], v[80:83]
  buffer_load_dwordx4 v33, s[36:39], s64 offen lds
  s_waitcnt lgkmcnt(5)
  v_mfma_f32_16x16x32_bf16 v[96:99], a[172:175], a[64:67], v[96:99]
  ds_read_b64_tr_b16 a[162:163], v6 offset:26624
  v_lshlrev_b32 v50, v50, v51
  v_mfma_f32_16x16x32_bf16 v[96:99], a[168:171], a[80:83], v[96:99]
  v_cmp_eq_u32 vcc, v48, v49
  v_mov_b32 v60, 0
  v_mov_b32 v61, 0
  v_cndmask_b32 v48, 0, v50, vcc
  v_mfma_f32_16x16x32_bf16 v[100:103], a[168:171], a[84:87], v[100:103]
  ds_read_b64_tr_b16 a[164:165], v6 offset:28672
  s_add_u32 m0, s45, 77824
  s_add_u32 s61, s64, 65536
  v_mfma_f32_16x16x32_bf16 v[100:103], a[172:175], a[68:71], v[100:103]
  buffer_load_dwordx4 v33, s[36:39], s61 offen lds
  v_and_b32 v49, 2, v0
  v_mfma_f32_16x16x32_bf16 v[104:107], a[172:175], a[72:75], v[104:107]
  ds_read_b64_tr_b16 a[166:167], v6 offset:30720
  v_mfma_f32_16x16x32_bf16 v[104:107], a[168:171], a[88:91], v[104:107]
  v_cmp_eq_u32 vcc, 0, v49
  v_mov_b32 v56, 0
  v_mov_b32 v57, 0
  v_cndmask_b32 v58, 0, v48, vcc
  v_mfma_f32_16x16x32_bf16 v[108:111], a[168:171], a[92:95], v[108:111]
  ds_read_b64_tr_b16 a[168:169], v7 offset:24576
  v_sub_u32 v59, v48, v58
  v_mfma_f32_16x16x32_bf16 v[108:111], a[172:175], a[76:79], v[108:111]
  s_waitcnt lgkmcnt(5)
  v_mfma_f32_16x16x32_bf16 v[124:127], a[180:183], a[76:79], v[124:127]
  ds_read_b64_tr_b16 a[170:171], v7 offset:26624
  v_mfma_f32_16x16x32_bf16 v[124:127], a[176:179], a[92:95], v[124:127]
  v_mfma_f32_16x16x32_bf16 v[120:123], a[176:179], a[88:91], v[120:123]
  ds_read_b64_tr_b16 a[172:173], v7 offset:28672
  v_mfma_f32_16x16x32_bf16 v[120:123], a[180:183], a[72:75], v[120:123]
  v_mfma_f32_16x16x32_bf16 v[116:119], a[180:183], a[68:71], v[116:119]
  ds_read_b64_tr_b16 a[174:175], v7 offset:30720
  v_mfma_f32_16x16x32_bf16 v[116:119], a[176:179], a[84:87], v[116:119]
  v_mfma_f32_16x16x32_bf16 v[112:115], a[176:179], a[80:83], v[112:115]
  ds_read_b64_tr_b16 a[176:177], v8 offset:24576
  v_mfma_f32_16x16x32_bf16 v[112:115], a[180:183], a[64:67], v[112:115]
  s_add_u32 s62, s88, 0
  s_waitcnt lgkmcnt(5)
  v_mfma_f32_16x16x32_bf16 v[128:131], a[160:163], a[64:67], v[128:131]
  ds_read_b64_tr_b16 a[178:179], v8 offset:26624
  buffer_load_dword v240, v47, s[8:11], s62 offen sc1
  v_mfma_f32_16x16x32_bf16 v[128:131], a[164:167], a[80:83], v[128:131]
  v_mfma_f32_16x16x32_bf16 v[132:135], a[164:167], a[84:87], v[132:135]
  ds_read_b64_tr_b16 a[180:181], v8 offset:28672
  v_mfma_f32_16x16x32_bf16 v[132:135], a[160:163], a[68:71], v[132:135]
  v_mfma_f32_16x16x32_bf16 v[136:139], a[160:163], a[72:75], v[136:139]
  ds_read_b64_tr_b16 a[182:183], v8 offset:30720
  s_add_u32 s62, s88, 24576
  v_mfma_f32_16x16x32_bf16 v[136:139], a[164:167], a[88:91], v[136:139]
  buffer_load_dword v241, v47, s[8:11], s62 offen sc1
  v_mfma_f32_16x16x32_bf16 v[140:143], a[164:167], a[92:95], v[140:143]
  ds_read_b64_tr_b16 a[164:165], v9 offset:24576
  v_mfma_f32_16x16x32_bf16 v[140:143], a[160:163], a[76:79], v[140:143]
  s_waitcnt lgkmcnt(5)
  v_mfma_f32_16x16x32_bf16 v[156:159], a[168:171], a[76:79], v[156:159]
  ds_read_b64_tr_b16 a[166:167], v9 offset:26624
  s_add_u32 s62, s88, 49152
  v_mfma_f32_16x16x32_bf16 v[156:159], a[172:175], a[92:95], v[156:159]
  s_sub_u32 s82, s82, 491520
  buffer_load_dword v242, v47, s[8:11], s62 offen sc1
  v_mfma_f32_16x16x32_bf16 v[152:155], a[172:175], a[88:91], v[152:155]
  ds_read_b64_tr_b16 a[160:161], v9 offset:28672
  s_cmp_lg_u32 s44, 0
  s_cbranch_scc1 PI20_adaLN_cond__sliding_local_dilated__swiglu_ffn__prompt_kernel
  buffer_load_dword v36, v37, s[8:11], s82 offen sc1
PI20_adaLN_cond__sliding_local_dilated__swiglu_ffn__prompt_kernel:
  v_mfma_f32_16x16x32_bf16 v[152:155], a[168:171], a[72:75], v[152:155]
  v_mfma_f32_16x16x32_bf16 v[148:151], a[168:171], a[68:71], v[148:151]
  ds_read_b64_tr_b16 a[162:163], v9 offset:30720
  v_mfma_f32_16x16x32_bf16 v[148:151], a[172:175], a[84:87], v[148:151]
  s_add_u32 s62, s88, 73728
  s_waitcnt vmcnt(38)
  s_barrier
  v_mfma_f32_16x16x32_bf16 v[144:147], a[172:175], a[80:83], v[144:147]
  ds_read_b64_tr_b16 a[172:173], v2 offset:32768
  buffer_load_dword v243, v47, s[8:11], s62 offen sc1
  v_mfma_f32_16x16x32_bf16 v[144:147], a[168:171], a[64:67], v[144:147]
  s_waitcnt lgkmcnt(5)
  v_mfma_f32_16x16x32_bf16 v[160:163], a[176:179], a[64:67], v[160:163]
  ds_read_b64_tr_b16 a[174:175], v2 offset:34816
  v_mfma_f32_16x16x32_bf16 v[160:163], a[180:183], a[80:83], v[160:163]
  s_cmp_eq_u32 s91, 0
  s_cselect_b32 s74, 0, 7
  s_lshl_b32 s66, s74, 17
  s_lshl_b32 s74, s74, 11
  s_add_u32 s74, s74, s84
  s_add_u32 m0, s45, 98304
  v_mfma_f32_16x16x32_bf16 v[164:167], a[180:183], a[84:87], v[164:167]
  ds_read_b64_tr_b16 a[168:169], v2 offset:36864
  buffer_load_dwordx4 v32, s[36:39], s66 offen lds
  v_mfma_f32_16x16x32_bf16 v[164:167], a[176:179], a[68:71], v[164:167]
  v_mfma_f32_16x16x32_bf16 v[168:171], a[176:179], a[72:75], v[168:171]
  ds_read_b64_tr_b16 a[170:171], v2 offset:38912
  v_mfma_f32_16x16x32_bf16 v[168:171], a[180:183], a[88:91], v[168:171]
  v_mfma_f32_16x16x32_bf16 v[172:175], a[180:183], a[92:95], v[172:175]
  ds_read_b64_tr_b16 a[180:181], v3 offset:32768
  s_add_u32 m0, s45, 102400
  s_add_u32 s61, s66, 65536
  v_mfma_f32_16x16x32_bf16 v[172:175], a[176:179], a[76:79], v[172:175]
  buffer_load_dwordx4 v32, s[36:39], s61 offen lds
  s_waitcnt lgkmcnt(5)
  v_mfma_f32_16x16x32_bf16 v[188:191], a[164:167], a[76:79], v[188:191]
  ds_read_b64_tr_b16 a[182:183], v3 offset:34816
  v_mfma_f32_16x16x32_bf16 v[188:191], a[160:163], a[92:95], v[188:191]
  v_mfma_f32_16x16x32_bf16 v[184:187], a[160:163], a[88:91], v[184:187]
  ds_read_b64_tr_b16 a[176:177], v3 offset:36864
  s_cmp_eq_u32 s91, 1
  s_cselect_b32 s75, 2, 9
  s_lshl_b32 s67, s75, 17
  s_lshl_b32 s75, s75, 11
  s_add_u32 s75, s75, s84
  s_add_u32 m0, s45, 81920
  v_mfma_f32_16x16x32_bf16 v[184:187], a[164:167], a[72:75], v[184:187]
  buffer_load_dwordx4 v32, s[36:39], s67 offen lds
  v_mfma_f32_16x16x32_bf16 v[180:183], a[164:167], a[68:71], v[180:183]
  ds_read_b64_tr_b16 a[178:179], v3 offset:38912
  v_mfma_f32_16x16x32_bf16 v[180:183], a[160:163], a[84:87], v[180:183]
  v_mfma_f32_16x16x32_bf16 v[176:179], a[160:163], a[80:83], v[176:179]
  ds_read_b64_tr_b16 a[160:161], v4 offset:32768
  v_mfma_f32_16x16x32_bf16 v[176:179], a[164:167], a[64:67], v[176:179]
  s_add_u32 m0, s45, 86016
  s_add_u32 s61, s67, 65536
  s_waitcnt vmcnt(32) lgkmcnt(5)
  v_mfma_f32_16x16x32_bf16 v[64:67], a[172:175], a[96:99], v[64:67]
  ds_read_b64_tr_b16 a[162:163], v4 offset:34816
  buffer_load_dwordx4 v32, s[36:39], s61 offen lds
  v_mfma_f32_16x16x32_bf16 v[64:67], a[168:171], a[112:115], v[64:67]
  v_mfma_f32_16x16x32_bf16 v[68:71], a[168:171], a[116:119], v[68:71]
  ds_read_b64_tr_b16 a[164:165], v4 offset:36864
  v_mfma_f32_16x16x32_bf16 v[68:71], a[172:175], a[100:103], v[68:71]
  s_add_u32 m0, s45, 122880
  v_mfma_f32_16x16x32_bf16 v[72:75], a[172:175], a[104:107], v[72:75]
  ds_read_b64_tr_b16 a[166:167], v4 offset:38912
  buffer_load_dwordx4 v33, s[36:39], s65 offen lds
  v_mfma_f32_16x16x32_bf16 v[72:75], a[168:171], a[120:123], v[72:75]
  v_mfma_f32_16x16x32_bf16 v[76:79], a[168:171], a[124:127], v[76:79]
  ds_read_b64_tr_b16 a[168:169], v5 offset:32768
  v_mfma_f32_16x16x32_bf16 v[76:79], a[172:175], a[108:111], v[76:79]
  s_waitcnt lgkmcnt(5)
  v_mfma_f32_16x16x32_bf16 v[92:95], a[180:183], a[108:111], v[92:95]
  ds_read_b64_tr_b16 a[170:171], v5 offset:34816
  s_add_u32 m0, s45, 126976
  s_add_u32 s61, s65, 65536
  v_mfma_f32_16x16x32_bf16 v[92:95], a[176:179], a[124:127], v[92:95]
  buffer_load_dwordx4 v33, s[36:39], s61 offen lds
  v_mfma_f32_16x16x32_bf16 v[88:91], a[176:179], a[120:123], v[88:91]
  ds_read_b64_tr_b16 a[172:173], v5 offset:36864
  v_mfma_f32_16x16x32_bf16 v[88:91], a[180:183], a[104:107], v[88:91]
  v_mfma_f32_16x16x32_bf16 v[84:87], a[180:183], a[100:103], v[84:87]
  ds_read_b64_tr_b16 a[174:175], v5 offset:38912
  s_add_u32 m0, s45, 106496
  v_mfma_f32_16x16x32_bf16 v[84:87], a[176:179], a[116:119], v[84:87]
  buffer_load_dwordx4 v33, s[36:39], s66 offen lds
  v_mfma_f32_16x16x32_bf16 v[80:83], a[176:179], a[112:115], v[80:83]
  ds_read_b64_tr_b16 a[176:177], v2 offset:40960
  v_mfma_f32_16x16x32_bf16 v[80:83], a[180:183], a[96:99], v[80:83]
  s_waitcnt lgkmcnt(5)
  v_mfma_f32_16x16x32_bf16 v[96:99], a[160:163], a[96:99], v[96:99]
  ds_read_b64_tr_b16 a[178:179], v2 offset:43008
  v_mfma_f32_16x16x32_bf16 v[96:99], a[164:167], a[112:115], v[96:99]
  s_add_u32 m0, s45, 110592
  s_add_u32 s61, s66, 65536
  v_mfma_f32_16x16x32_bf16 v[100:103], a[164:167], a[116:119], v[100:103]
  ds_read_b64_tr_b16 a[180:181], v2 offset:45056
  s_cmp_lg_u32 s44, 0
  s_cbranch_scc1 PL21_adaLN_cond__sliding_local_dilated__swiglu_ffn__prompt_kernelx
  s_waitcnt vmcnt(8)
  v_cmp_ne_u32 vcc, s46, v36
  s_nop 4
  s_cbranch_vccz PL21_adaLN_cond__sliding_local_dilated__swiglu_ffn__prompt_kernelx
  s_mov_b32 s83, 60000
PL21_adaLN_cond__sliding_local_dilated__swiglu_ffn__prompt_kernel:
  buffer_load_dword v36, v37, s[8:11], s82 offen sc1
  s_sub_u32 s83, s83, 1
  s_cmp_eq_u32 s83, 0
  s_waitcnt vmcnt(0)
  s_cbranch_scc1 PL21_adaLN_cond__sliding_local_dilated__swiglu_ffn__prompt_kernelx
  v_cmp_ne_u32 vcc, s46, v36
  s_nop 4
  s_cbranch_vccnz PL21_adaLN_cond__sliding_local_dilated__swiglu_ffn__prompt_kernel
PL21_adaLN_cond__sliding_local_dilated__swiglu_ffn__prompt_kernelx:
  s_barrier
  buffer_load_dwordx4 v33, s[36:39], s61 offen lds
  v_mfma_f32_16x16x32_bf16 v[100:103], a[160:163], a[100:103], v[100:103]
  v_mfma_f32_16x16x32_bf16 v[104:107], a[160:163], a[104:107], v[104:107]
  ds_read_b64_tr_b16 a[182:183], v2 offset:47104
  v_mfma_f32_16x16x32_bf16 v[104:107], a[164:167], a[120:123], v[104:107]
  v_mfma_f32_16x16x32_bf16 v[108:111], a[164:167], a[124:127], v[108:111]
  ds_read_b64_tr_b16 a[164:165], v3 offset:40960
  buffer_load_dwordx4 a[0:3], v1, s[8:11], s78 offen offset:0 sc1
  v_mfma_f32_16x16x32_bf16 v[108:111], a[160:163], a[108:111], v[108:111]
  s_waitcnt lgkmcnt(5)
  v_mfma_f32_16x16x32_bf16 v[124:127], a[168:171], a[108:111], v[124:127]
  ds_read_b64_tr_b16 a[166:167], v3 offset:43008
  v_mfma_f32_16x16x32_bf16 v[124:127], a[172:175], a[124:127], v[124:127]
  v_mfma_f32_16x16x32_bf16 v[120:123], a[172:175], a[120:123], v[120:123]
  ds_read_b64_tr_b16 a[160:161], v3 offset:45056
  v_mfma_f32_16x16x32_bf16 v[120:123], a[168:171], a[104:107], v[120:123]
  buffer_load_dwordx4 a[16:19], v1, s[8:11], s78 offen offset:1024 sc1
  v_mfma_f32_16x16x32_bf16 v[116:119], a[168:171], a[100:103], v[116:119]
  ds_read_b64_tr_b16 a[162:163], v3 offset:47104
  v_mfma_f32_16x16x32_bf16 v[116:119], a[172:175], a[116:119], v[116:119]
  v_mfma_f32_16x16x32_bf16 v[112:115], a[172:175], a[112:115], v[112:115]
  ds_read_b64_tr_b16 a[172:173], v4 offset:40960
  s_add_u32 s78, s78, 131072
  v_mfma_f32_16x16x32_bf16 v[112:115], a[168:171], a[96:99], v[112:115]
  buffer_load_dwordx4 a[4:7], v1, s[8:11], s78 offen offset:0 sc1
  s_waitcnt lgkmcnt(5)
  v_mfma_f32_16x16x32_bf16 v[128:131], a[176:179], a[96:99], v[128:131]
  ds_read_b64_tr_b16 a[174:175], v4 offset:43008
  v_mfma_f32_16x16x32_bf16 v[128:131], a[180:183], a[112:115], v[128:131]
  v_mfma_f32_16x16x32_bf16 v[132:135], a[180:183], a[116:119], v[132:135]
  ds_read_b64_tr_b16 a[168:169], v4 offset:45056
  v_mfma_f32_16x16x32_bf16 v[132:135], a[176:179], a[100:103], v[132:135]
  v_mfma_f32_16x16x32_bf16 v[136:139], a[176:179], a[104:107], v[136:139]
  ds_read_b64_tr_b16 a[170:171], v4 offset:47104
  buffer_load_dwordx4 a[20:23], v1, s[8:11], s78 offen offset:1024 sc1
  v_mfma_f32_16x16x32_bf16 v[136:139], a[180:183], a[120:123], v[136:139]
  v_mfma_f32_16x16x32_bf16 v[140:143], a[180:183], a[124:127], v[140:143]
  ds_read_b64_tr_b16 a[180:181], v5 offset:40960
  v_mfma_f32_16x16x32_bf16 v[140:143], a[176:179], a[108:111], v[140:143]
  s_add_u32 s78, s78, s89
  s_waitcnt lgkmcnt(5)
  v_mfma_f32_16x16x32_bf16 v[156:159], a[164:167], a[108:111], v[156:159]
  ds_read_b64_tr_b16 a[182:183], v5 offset:43008
  buffer_load_dwordx4 a[8:11], v1, s[8:11], s78 offen offset:0 sc1
  v_mfma_f32_16x16x32_bf16 v[156:159], a[160:163], a[124:127], v[156:159]
  v_mfma_f32_16x16x32_bf16 v[152:155], a[160:163], a[120:123], v[152:155]
  ds_read_b64_tr_b16 a[176:177], v5 offset:45056
  v_mfma_f32_16x16x32_bf16 v[152:155], a[164:167], a[104:107], v[152:155]
  v_mfma_f32_16x16x32_bf16 v[148:151], a[164:167], a[100:103], v[148:151]
  ds_read_b64_tr_b16 a[178:179], v5 offset:47104
  v_mfma_f32_16x16x32_bf16 v[148:151], a[160:163], a[116:119], v[148:151]
  buffer_load_dwordx4 a[24:27], v1, s[8:11], s78 offen offset:1024 sc1
  v_mfma_f32_16x16x32_bf16 v[144:147], a[160:163], a[112:115], v[144:147]
  ds_read_b64_tr_b16 a[160:161], v2 offset:49152
  v_mfma_f32_16x16x32_bf16 v[144:147], a[164:167], a[96:99], v[144:147]
  s_waitcnt lgkmcnt(5)
  v_mfma_f32_16x16x32_bf16 v[160:163], a[172:175], a[96:99], v[160:163]
  ds_read_b64_tr_b16 a[162:163], v2 offset:51200
  s_add_u32 s78, s78, 131072
  v_mfma_f32_16x16x32_bf16 v[160:163], a[168:171], a[112:115], v[160:163]
  buffer_load_dwordx4 a[12:15], v1, s[8:11], s78 offen offset:0 sc1
  v_mfma_f32_16x16x32_bf16 v[164:167], a[168:171], a[116:119], v[164:167]
  ds_read_b64_tr_b16 a[164:165], v2 offset:53248
  v_mfma_f32_16x16x32_bf16 v[164:167], a[172:175], a[100:103], v[164:167]
  v_mfma_f32_16x16x32_bf16 v[168:171], a[172:175], a[104:107], v[168:171]
  ds_read_b64_tr_b16 a[166:167], v2 offset:55296
  v_mfma_f32_16x16x32_bf16 v[168:171], a[168:171], a[120:123], v[168:171]
  v_mfma_f32_16x16x32_bf16 v[172:175], a[168:171], a[124:127], v[172:175]
  ds_read_b64_tr_b16 a[168:169], v3 offset:49152
  buffer_load_dwordx4 a[28:31], v1, s[8:11], s78 offen offset:1024 sc1
  v_mfma_f32_16x16x32_bf16 v[172:175], a[172:175], a[108:111], v[172:175]
  s_waitcnt lgkmcnt(5)
  v_mfma_f32_16x16x32_bf16 v[188:191], a[180:183], a[108:111], v[188:191]
  ds_read_b64_tr_b16 a[170:171], v3 offset:51200
  v_mfma_f32_16x16x32_bf16 v[188:191], a[176:179], a[124:127], v[188:191]
  v_mfma_f32_16x16x32_bf16 v[184:187], a[176:179], a[120:123], v[184:187]
  ds_read_b64_tr_b16 a[172:173], v3 offset:53248
  buffer_load_dwordx4 a[188:191], v1, s[8:11], s79 offen offset:0 sc1
  v_mfma_f32_16x16x32_bf16 v[184:187], a[180:183], a[104:107], v[184:187]
  v_mfma_f32_16x16x32_bf16 v[180:183], a[180:183], a[100:103], v[180:183]
  ds_read_b64_tr_b16 a[174:175], v3 offset:55296
  v_mfma_f32_16x16x32_bf16 v[180:183], a[176:179], a[116:119], v[180:183]
  v_mfma_f32_16x16x32_bf16 v[176:179], a[176:179], a[112:115], v[176:179]
  ds_read_b64_tr_b16 a[176:177], v4 offset:49152
  v_mfma_f32_16x16x32_bf16 v[176:179], a[180:183], a[96:99], v[176:179]
  buffer_load_dwordx4 a[204:207], v1, s[8:11], s79 offen offset:1024 sc1
  s_waitcnt vmcnt(37) lgkmcnt(5)
  v_mfma_f32_16x16x32_bf16 v[64:67], a[160:163], a[128:131], v[64:67]
  ds_read_b64_tr_b16 a[178:179], v4 offset:51200
  v_mfma_f32_16x16x32_bf16 v[64:67], a[164:167], a[144:147], v[64:67]
  v_mfma_f32_16x16x32_bf16 v[68:71], a[164:167], a[148:151], v[68:71]
  ds_read_b64_tr_b16 a[180:181], v4 offset:53248
  s_add_u32 s79, s79, 131072
  v_mfma_f32_16x16x32_bf16 v[68:71], a[160:163], a[132:135], v[68:71]
  buffer_load_dwordx4 a[192:195], v1, s[8:11], s79 offen offset:0 sc1
  v_mfma_f32_16x16x32_bf16 v[72:75], a[160:163], a[136:139], v[72:75]
  ds_read_b64_tr_b16 a[182:183], v4 offset:55296
  v_mfma_f32_16x16x32_bf16 v[72:75], a[164:167], a[152:155], v[72:75]
  v_mfma_f32_16x16x32_bf16 v[76:79], a[164:167], a[156:159], v[76:79]
HOP17:
  s_cbranch_execz WRET1
  ds_read_b64_tr_b16 a[164:165], v5 offset:49152
  v_mfma_f32_16x16x32_bf16 v[76:79], a[160:163], a[140:143], v[76:79]
  s_waitcnt lgkmcnt(5)
  v_mfma_f32_16x16x32_bf16 v[92:95], a[168:171], a[140:143], v[92:95]
  ds_read_b64_tr_b16 a[166:167], v5 offset:51200
  buffer_load_dwordx4 a[208:211], v1, s[8:11], s79 offen offset:1024 sc1
  v_mfma_f32_16x16x32_bf16 v[92:95], a[172:175], a[156:159], v[92:95]
  v_mfma_f32_16x16x32_bf16 v[88:91], a[172:175], a[152:155], v[88:91]
  ds_read_b64_tr_b16 a[160:161], v5 offset:53248
  v_mfma_f32_16x16x32_bf16 v[88:91], a[168:171], a[136:139], v[88:91]
  s_add_u32 s79, s79, s89
  v_mfma_f32_16x16x32_bf16 v[84:87], a[168:171], a[132:135], v[84:87]
  ds_read_b64_tr_b16 a[162:163], v5 offset:55296
  buffer_load_dwordx4 a[196:199], v1, s[8:11], s79 offen offset:0 sc1
  v_mfma_f32_16x16x32_bf16 v[84:87], a[172:175], a[148:151], v[84:87]
  v_mfma_f32_16x16x32_bf16 v[80:83], a[172:175], a[144:147], v[80:83]
  ds_read_b64_tr_b16 a[172:173], v2 offset:57344
  v_mfma_f32_16x16x32_bf16 v[80:83], a[168:171], a[128:131], v[80:83]
  s_waitcnt lgkmcnt(5)
  v_mfma_f32_16x16x32_bf16 v[96:99], a[176:179], a[128:131], v[96:99]
  ds_read_b64_tr_b16 a[174:175], v2 offset:59392
  v_mfma_f32_16x16x32_bf16 v[96:99], a[180:183], a[144:147], v[96:99]
  buffer_load_dwordx4 a[212:215], v1, s[8:11], s79 offen offset:1024 sc1
  v_mfma_f32_16x16x32_bf16 v[100:103], a[180:183], a[148:151], v[100:103]
  ds_read_b64_tr_b16 a[168:169], v2 offset:61440
  v_mfma_f32_16x16x32_bf16 v[100:103], a[176:179], a[132:135], v[100:103]
  v_mfma_f32_16x16x32_bf16 v[104:107], a[176:179], a[136:139], v[104:107]
  ds_read_b64_tr_b16 a[170:171], v2 offset:63488
  s_add_u32 s79, s79, 131072
  v_mfma_f32_16x16x32_bf16 v[104:107], a[180:183], a[152:155], v[104:107]
  buffer_load_dwordx4 a[200:203], v1, s[8:11], s79 offen offset:0 sc1
  v_mfma_f32_16x16x32_bf16 v[108:111], a[180:183], a[156:159], v[108:111]
  ds_read_b64_tr_b16 a[180:181], v3 offset:57344
  v_mfma_f32_16x16x32_bf16 v[108:111], a[176:179], a[140:143], v[108:111]
  s_waitcnt lgkmcnt(5)
  v_mfma_f32_16x16x32_bf16 v[124:127], a[164:167], a[140:143], v[124:127]
  ds_read_b64_tr_b16 a[182:183], v3 offset:59392
  v_mfma_f32_16x16x32_bf16 v[124:127], a[160:163], a[156:159], v[124:127]
  v_mfma_f32_16x16x32_bf16 v[120:123], a[160:163], a[152:155], v[120:123]
  ds_read_b64_tr_b16 a[176:177], v3 offset:61440
  buffer_load_dwordx4 a[216:219], v1, s[8:11], s79 offen offset:1024 sc1
  v_mfma_f32_16x16x32_bf16 v[120:123], a[164:167], a[136:139], v[120:123]
  v_mfma_f32_16x16x32_bf16 v[116:119], a[164:167], a[132:135], v[116:119]
  ds_read_b64_tr_b16 a[178:179], v3 offset:63488
  v_mfma_f32_16x16x32_bf16 v[116:119], a[160:163], a[148:151], v[116:119]
  v_mfma_f32_16x16x32_bf16 v[112:115], a[160:163], a[144:147], v[112:115]
  ds_read_b64_tr_b16 a[160:161], v4 offset:57344
  buffer_load_dwordx4 a[220:223], v1, s[8:11], s72 offen offset:0 sc1
  v_mfma_f32_16x16x32_bf16 v[112:115], a[164:167], a[128:131], v[112:115]
  s_waitcnt lgkmcnt(5)
  v_mfma_f32_16x16x32_bf16 v[128:131], a[172:175], a[128:131], v[128:131]
  ds_read_b64_tr_b16 a[162:163], v4 offset:59392
  v_mfma_f32_16x16x32_bf16 v[128:131], a[168:171], a[144:147], v[128:131]
  ds_read_b128 v[192:195], v44 offset:0
  ds_read_b128 v[196:199], v44 offset:1024
  v_mfma_f32_16x16x32_bf16 v[132:135], a[168:171], a[148:151], v[132:135]
  ds_read_b64_tr_b16 a[164:165], v4 offset:61440
  ds_read_b128 v[200:203], v44 offset:2048
  v_mfma_f32_16x16x32_bf16 v[132:135], a[172:175], a[132:135], v[132:135]
  buffer_load_dwordx4 a[236:239], v1, s[8:11], s72 offen offset:1024 sc1
  ds_read_b128 v[204:207], v44 offset:3072
  v_mfma_f32_16x16x32_bf16 v[136:139], a[172:175], a[136:139], v[136:139]
  ds_read_b64_tr_b16 a[166:167], v4 offset:63488
  s_waitcnt vmcnt(26)
  v_mfma_f32_16x16x32_bf16 v[136:139], a[168:171], a[152:155], v[136:139]
  v_add_f32 v240, v240, v241
  v_add_f32 v242, v242, v243
  v_mfma_f32_16x16x32_bf16 v[140:143], a[168:171], a[156:159], v[140:143]
  ds_read_b64_tr_b16 a[168:169], v5 offset:57344
  s_add_u32 s72, s72, 131072
  v_mfma_f32_16x16x32_bf16 v[140:143], a[172:175], a[140:143], v[140:143]
  buffer_load_dwordx4 a[224:227], v1, s[8:11], s72 offen offset:0 sc1
  s_waitcnt lgkmcnt(9)
  v_mfma_f32_16x16x32_bf16 v[156:159], a[180:183], a[140:143], v[156:159]
  ds_read_b64_tr_b16 a[170:171], v5 offset:59392
  v_add_f32 v240, v240, v242
  v_mfma_f32_16x16x32_bf16 v[156:159], a[176:179], a[156:159], v[156:159]
  v_cvt_pk_bf16_f32 v240, v240, v240
  v_lshlrev_b32 v240, 16, v240
  v_mfma_f32_16x16x32_bf16 v[152:155], a[176:179], a[152:155], v[152:155]
  ds_read_b64_tr_b16 a[172:173], v5 offset:61440
  ds_write_b32 v45, v240
  v_mfma_f32_16x16x32_bf16 v[152:155], a[180:183], a[136:139], v[152:155]
  ds_read_b128 v[240:243], v46 offset:0
  ds_read_b128 v[244:247], v46 offset:64
  v_mfma_f32_16x16x32_bf16 v[148:151], a[180:183], a[132:135], v[148:151]
  ds_read_b64_tr_b16 a[174:175], v5 offset:63488
  buffer_load_dwordx4 a[240:243], v1, s[8:11], s72 offen offset:1024 sc1
  v_mfma_f32_16x16x32_bf16 v[148:151], a[176:179], a[148:151], v[148:151]
  s_waitcnt vmcnt(38)
  s_barrier
  v_mfma_f32_16x16x32_bf16 v[144:147], a[176:179], a[144:147], v[144:147]
  ds_read_b64_tr_b16 a[176:177], v2 offset:16384
  ds_read_b128 v[248:251], v46 offset:128
  v_mfma_f32_16x16x32_bf16 v[144:147], a[180:183], a[128:131], v[144:147]
  s_add_u32 s72, s72, s89
  s_waitcnt lgkmcnt(9)
  v_mfma_f32_16x16x32_bf16 v[160:163], a[160:163], a[128:131], v[160:163]
  ds_read_b64_tr_b16 a[178:179], v2 offset:18432
  buffer_load_dwordx4 a[228:231], v1, s[8:11], s72 offen offset:0 sc1
  v_mfma_f32_16x16x32_bf16 v[160:163], a[164:167], a[144:147], v[160:163]
  ds_read_b128 v[252:255], v46 offset:192
  s_waitcnt lgkmcnt(12)
  v_mfma_f32_16x16x32_bf16 v[164:167], a[164:167], a[148:151], v[164:167]
  ds_read_b64_tr_b16 a[180:181], v2 offset:20480
  v_lshlrev_b32 v208, 16, v192
  v_mfma_f32_16x16x32_bf16 v[164:167], a[160:163], a[132:135], v[164:167]
  v_and_b32 v209, 0xffff0000, v192
  v_lshlrev_b32 v210, 16, v193
  v_mfma_f32_16x16x32_bf16 v[168:171], a[160:163], a[136:139], v[168:171]
  ds_read_b64_tr_b16 a[182:183], v2 offset:22528
  v_and_b32 v211, 0xffff0000, v193
  v_mfma_f32_16x16x32_bf16 v[168:171], a[164:167], a[152:155], v[168:171]
  buffer_load_dwordx4 a[244:247], v1, s[8:11], s72 offen offset:1024 sc1
  v_lshlrev_b32 v212, 16, v194
  v_mfma_f32_16x16x32_bf16 v[172:175], a[164:167], a[156:159], v[172:175]
  ds_read_b64_tr_b16 a[164:165], v3 offset:16384
  v_and_b32 v213, 0xffff0000, v194
  v_mfma_f32_16x16x32_bf16 v[172:175], a[160:163], a[140:143], v[172:175]
  v_lshlrev_b32 v214, 16, v195
  s_waitcnt lgkmcnt(7)
  v_mfma_f32_16x16x32_bf16 v[188:191], a[168:171], a[140:143], v[188:191]
  ds_read_b64_tr_b16 a[166:167], v3 offset:18432
  s_add_u32 s72, s72, 131072
  v_mfma_f32_16x16x32_bf16 v[188:191], a[172:175], a[156:159], v[188:191]
  buffer_load_dwordx4 a[232:235], v1, s[8:11], s72 offen offset:0 sc1
  v_and_b32 v215, 0xffff0000, v195
  v_mfma_f32_16x16x32_bf16 v[184:187], a[172:175], a[152:155], v[184:187]
  ds_read_b64_tr_b16 a[160:161], v3 offset:20480
  v_lshlrev_b32 v216, 16, v196
  v_mfma_f32_16x16x32_bf16 v[184:187], a[168:171], a[136:139], v[184:187]
  v_and_b32 v217, 0xffff0000, v196
  v_lshlrev_b32 v218, 16, v197
  v_mfma_f32_16x16x32_bf16 v[180:183], a[168:171], a[132:135], v[180:183]
  ds_read_b64_tr_b16 a[162:163], v3 offset:22528
  v_and_b32 v219, 0xffff0000, v197
  v_mfma_f32_16x16x32_bf16 v[180:183], a[172:175], a[148:151], v[180:183]
  v_lshlrev_b32 v220, 16, v198
  v_and_b32 v221, 0xffff0000, v198
  v_mfma_f32_16x16x32_bf16 v[176:179], a[172:175], a[144:147], v[176:179]
  ds_read_b64_tr_b16 a[172:173], v4 offset:16384
  buffer_load_dwordx4 a[248:251], v1, s[8:11], s72 offen offset:1024 sc1
  v_mfma_f32_16x16x32_bf16 v[176:179], a[168:171], a[128:131], v[176:179]
  v_lshlrev_b32 v222, 16, v199
  s_waitcnt vmcnt(16) lgkmcnt(5)
  v_mfma_f32_16x16x32_bf16 v[64:67], a[176:179], a[0:3], v[64:67]
  ds_read_b64_tr_b16 a[174:175], v4 offset:18432
  v_and_b32 v223, 0xffff0000, v199
  v_mfma_f32_16x16x32_bf16 v[64:67], a[180:183], a[16:19], v[64:67]
  v_lshlrev_b32 v224, 16, v200
  v_mfma_f32_16x16x32_bf16 v[68:71], a[180:183], a[20:23], v[68:71]
  ds_read_b64_tr_b16 a[168:169], v4 offset:20480
  buffer_load_dwordx4 a[32:35], v1, s[8:11], s73 offen offset:0 sc1
  v_mfma_f32_16x16x32_bf16 v[68:71], a[176:179], a[4:7], v[68:71]
  v_and_b32 v225, 0xffff0000, v200
  v_lshlrev_b32 v226, 16, v201
  v_mfma_f32_16x16x32_bf16 v[72:75], a[176:179], a[8:11], v[72:75]
  ds_read_b64_tr_b16 a[170:171], v4 offset:22528
  v_and_b32 v227, 0xffff0000, v201
  v_mfma_f32_16x16x32_bf16 v[72:75], a[180:183], a[24:27], v[72:75]
  v_lshlrev_b32 v228, 16, v202
  v_and_b32 v229, 0xffff0000, v202
  v_mfma_f32_16x16x32_bf16 v[76:79], a[180:183], a[28:31], v[76:79]
  ds_read_b64_tr_b16 a[180:181], v5 offset:16384
  v_lshlrev_b32 v230, 16, v203
  v_mfma_f32_16x16x32_bf16 v[76:79], a[176:179], a[12:15], v[76:79]
  buffer_load_dwordx4 a[48:51], v1, s[8:11], s73 offen offset:1024 sc1
  s_waitcnt lgkmcnt(5)
  v_mfma_f32_16x16x32_bf16 v[92:95], a[164:167], a[12:15], v[92:95]
  ds_read_b64_tr_b16 a[182:183], v5 offset:18432
  v_and_b32 v231, 0xffff0000, v203
  v_mfma_f32_16x16x32_bf16 v[92:95], a[160:163], a[28:31], v[92:95]
  v_lshlrev_b32 v232, 16, v204
  v_and_b32 v233, 0xffff0000, v204
  v_mfma_f32_16x16x32_bf16 v[88:91], a[160:163], a[24:27], v[88:91]
  ds_read_b64_tr_b16 a[176:177], v5 offset:20480
  s_add_u32 s73, s73, 131072
  v_mfma_f32_16x16x32_bf16 v[88:91], a[164:167], a[8:11], v[88:91]
  buffer_load_dwordx4 a[36:39], v1, s[8:11], s73 offen offset:0 sc1
  v_lshlrev_b32 v234, 16, v205
  v_mfma_f32_16x16x32_bf16 v[84:87], a[164:167], a[4:7], v[84:87]
  ds_read_b64_tr_b16 a[178:179], v5 offset:22528
  v_and_b32 v235, 0xffff0000, v205
  v_mfma_f32_16x16x32_bf16 v[84:87], a[160:163], a[20:23], v[84:87]
  v_lshlrev_b32 v236, 16, v206
  v_and_b32 v237, 0xffff0000, v206
  v_mfma_f32_16x16x32_bf16 v[80:83], a[160:163], a[16:19], v[80:83]
  ds_read_b64_tr_b16 a[160:161], v2 offset:24576
  v_lshlrev_b32 v238, 16, v207
  v_mfma_f32_16x16x32_bf16 v[80:83], a[164:167], a[0:3], v[80:83]
  v_and_b32 v239, 0xffff0000, v207
  s_waitcnt lgkmcnt(5)
  v_mfma_f32_16x16x32_bf16 v[96:99], a[172:175], a[0:3], v[96:99]
  ds_read_b64_tr_b16 a[162:163], v2 offset:26624
  buffer_load_dwordx4 a[52:55], v1, s[8:11], s73 offen offset:1024 sc1
  v_mfma_f32_16x16x32_bf16 v[96:99], a[168:171], a[16:19], v[96:99]
  v_mov_b32 v37, 0
  v_mfma_f32_16x16x32_bf16 v[100:103], a[168:171], a[20:23], v[100:103]
  ds_read_b64_tr_b16 a[164:165], v2 offset:28672
  v_mfma_f32_16x16x32_bf16 v[100:103], a[172:175], a[4:7], v[100:103]
  s_add_u32 s73, s73, s89
  v_mfma_f32_16x16x32_bf16 v[104:107], a[172:175], a[8:11], v[104:107]
  ds_read_b64_tr_b16 a[166:167], v2 offset:30720
  buffer_load_dwordx4 a[40:43], v1, s[8:11], s73 offen offset:0 sc1
  v_mfma_f32_16x16x32_bf16 v[104:107], a[168:171], a[24:27], v[104:107]
  v_mfma_f32_16x16x32_bf16 v[108:111], a[168:171], a[28:31], v[108:111]
  ds_read_b64_tr_b16 a[168:169], v3 offset:24576
  v_mfma_f32_16x16x32_bf16 v[108:111], a[172:175], a[12:15], v[108:111]
  s_waitcnt lgkmcnt(5)
  v_mfma_f32_16x16x32_bf16 v[124:127], a[180:183], a[12:15], v[124:127]
  ds_read_b64_tr_b16 a[170:171], v3 offset:26624
  v_mfma_f32_16x16x32_bf16 v[124:127], a[176:179], a[28:31], v[124:127]
  buffer_load_dwordx4 a[56:59], v1, s[8:11], s73 offen offset:1024 sc1
  v_mfma_f32_16x16x32_bf16 v[120:123], a[176:179], a[24:27], v[120:123]
  ds_read_b64_tr_b16 a[172:173], v3 offset:28672
  v_mfma_f32_16x16x32_bf16 v[120:123], a[180:183], a[8:11], v[120:123]
  v_mfma_f32_16x16x32_bf16 v[116:119], a[180:183], a[4:7], v[116:119]
  ds_read_b64_tr_b16 a[174:175], v3 offset:30720
  s_add_u32 s73, s73, 131072
  v_mfma_f32_16x16x32_bf16 v[116:119], a[176:179], a[20:23], v[116:119]
  buffer_load_dwordx4 a[44:47], v1, s[8:11], s73 offen offset:0 sc1
  v_mfma_f32_16x16x32_bf16 v[112:115], a[176:179], a[16:19], v[112:115]
  ds_read_b64_tr_b16 a[176:177], v4 offset:24576
  v_mfma_f32_16x16x32_bf16 v[112:115], a[180:183], a[0:3], v[112:115]
  s_waitcnt lgkmcnt(5)
  v_mfma_f32_16x16x32_bf16 v[128:131], a[160:163], a[0:3], v[128:131]
  ds_read_b64_tr_b16 a[178:179], v4 offset:26624
  v_mfma_f32_16x16x32_bf16 v[128:131], a[164:167], a[16:19], v[128:131]
  v_mfma_f32_16x16x32_bf16 v[132:135], a[164:167], a[20:23], v[132:135]
  ds_read_b64_tr_b16 a[180:181], v4 offset:28672
  buffer_load_dwordx4 a[60:63], v1, s[8:11], s73 offen offset:1024 sc1
  v_mfma_f32_16x16x32_bf16 v[132:135], a[160:163], a[4:7], v[132:135]
  v_mfma_f32_16x16x32_bf16 v[136:139], a[160:163], a[8:11], v[136:139]
  ds_read_b64_tr_b16 a[182:183], v4 offset:30720
  v_mfma_f32_16x16x32_bf16 v[136:139], a[164:167], a[24:27], v[136:139]
  s_cmp_eq_u32 s91, 2
  s_cselect_b32 s76, 4, 11
  s_lshl_b32 s68, s76, 17
  s_lshl_b32 s76, s76, 11
  s_add_u32 s76, s76, s84
  s_add_u32 m0, s45, 32768
  v_mfma_f32_16x16x32_bf16 v[140:143], a[164:167], a[28:31], v[140:143]
  ds_read_b64_tr_b16 a[164:165], v5 offset:24576
  buffer_load_dwordx4 v32, s[36:39], s68 offen lds
  v_mfma_f32_16x16x32_bf16 v[140:143], a[160:163], a[12:15], v[140:143]
  s_waitcnt lgkmcnt(5)
  v_mfma_f32_16x16x32_bf16 v[156:159], a[168:171], a[12:15], v[156:159]
  ds_read_b64_tr_b16 a[166:167], v5 offset:26624
  v_mfma_f32_16x16x32_bf16 v[156:159], a[172:175], a[28:31], v[156:159]
  v_mfma_f32_16x16x32_bf16 v[152:155], a[172:175], a[24:27], v[152:155]
  ds_read_b64_tr_b16 a[160:161], v5 offset:28672
  s_add_u32 m0, s45, 36864
  s_add_u32 s61, s68, 65536
  v_mfma_f32_16x16x32_bf16 v[152:155], a[168:171], a[8:11], v[152:155]
  buffer_load_dwordx4 v32, s[36:39], s61 offen lds
  v_mfma_f32_16x16x32_bf16 v[148:151], a[168:171], a[4:7], v[148:151]
  ds_read_b64_tr_b16 a[162:163], v5 offset:30720
  v_mfma_f32_16x16x32_bf16 v[148:151], a[172:175], a[20:23], v[148:151]
  v_mfma_f32_16x16x32_bf16 v[144:147], a[172:175], a[16:19], v[144:147]
  ds_read_b64_tr_b16 a[172:173], v2 offset:0
  s_cmp_eq_u32 s91, 3
  s_cselect_b32 s77, 6, 13
  s_lshl_b32 s69, s77, 17
  s_lshl_b32 s77, s77, 11
  s_add_u32 s77, s77, s84
  s_add_u32 m0, s45, 49152
  v_mfma_f32_16x16x32_bf16 v[144:147], a[168:171], a[0:3], v[144:147]
  buffer_load_dwordx4 v32, s[36:39], s69 offen lds
  s_waitcnt lgkmcnt(5)
  v_mfma_f32_16x16x32_bf16 v[160:163], a[176:179], a[0:3], v[160:163]
  ds_read_b64_tr_b16 a[174:175], v2 offset:2048
  v_mfma_f32_16x16x32_bf16 v[160:163], a[180:183], a[16:19], v[160:163]
  v_mfma_f32_16x16x32_bf16 v[164:167], a[180:183], a[20:23], v[164:167]
  ds_read_b64_tr_b16 a[168:169], v2 offset:4096
  v_mfma_f32_16x16x32_bf16 v[164:167], a[176:179], a[4:7], v[164:167]
  s_add_u32 m0, s45, 53248
  s_add_u32 s61, s69, 65536
  v_mfma_f32_16x16x32_bf16 v[168:171], a[176:179], a[8:11], v[168:171]
  ds_read_b64_tr_b16 a[170:171], v2 offset:6144
  buffer_load_dwordx4 v32, s[36:39], s61 offen lds
  v_mfma_f32_16x16x32_bf16 v[168:171], a[180:183], a[24:27], v[168:171]
  v_mfma_f32_16x16x32_bf16 v[172:175], a[180:183], a[28:31], v[172:175]
  ds_read_b64_tr_b16 a[180:181], v3 offset:0
  v_mfma_f32_16x16x32_bf16 v[172:175], a[176:179], a[12:15], v[172:175]
  s_waitcnt lgkmcnt(5)
  v_mfma_f32_16x16x32_bf16 v[188:191], a[164:167], a[12:15], v[188:191]
  ds_read_b64_tr_b16 a[182:183], v3 offset:2048
  buffer_load_dwordx4 a[64:67], v1, s[8:11], s74 offen offset:0 sc1
  v_mfma_f32_16x16x32_bf16 v[188:191], a[160:163], a[28:31], v[188:191]
  v_mfma_f32_16x16x32_bf16 v[184:187], a[160:163], a[24:27], v[184:187]
  ds_read_b64_tr_b16 a[176:177], v3 offset:4096
  v_mfma_f32_16x16x32_bf16 v[184:187], a[164:167], a[8:11], v[184:187]
  v_mfma_f32_16x16x32_bf16 v[180:183], a[164:167], a[4:7], v[180:183]
  ds_read_b64_tr_b16 a[178:179], v3 offset:6144
  v_mfma_f32_16x16x32_bf16 v[180:183], a[160:163], a[20:23], v[180:183]
  buffer_load_dwordx4 a[80:83], v1, s[8:11], s74 offen offset:1024 sc1
  v_mfma_f32_16x16x32_bf16 v[176:179], a[160:163], a[16:19], v[176:179]
  ds_read_b64_tr_b16 a[160:161], v4 offset:0
  v_mfma_f32_16x16x32_bf16 v[176:179], a[164:167], a[0:3], v[176:179]
  s_waitcnt vmcnt(22) lgkmcnt(5)
  v_mfma_f32_16x16x32_bf16 v[64:67], a[172:175], a[188:191], v[64:67]
  ds_read_b64_tr_b16 a[162:163], v4 offset:2048
  s_add_u32 s74, s74, 131072
  v_mfma_f32_16x16x32_bf16 v[64:67], a[168:171], a[204:207], v[64:67]
  buffer_load_dwordx4 a[68:71], v1, s[8:11], s74 offen offset:0 sc1
  v_mfma_f32_16x16x32_bf16 v[68:71], a[168:171], a[208:211], v[68:71]
  ds_read_b64_tr_b16 a[164:165], v4 offset:4096
  v_mfma_f32_16x16x32_bf16 v[68:71], a[172:175], a[192:195], v[68:71]
  v_mfma_f32_16x16x32_bf16 v[72:75], a[172:175], a[196:199], v[72:75]
  ds_read_b64_tr_b16 a[166:167], v4 offset:6144
  v_mfma_f32_16x16x32_bf16 v[72:75], a[168:171], a[212:215], v[72:75]
  v_mfma_f32_16x16x32_bf16 v[76:79], a[168:171], a[216:219], v[76:79]
  ds_read_b64_tr_b16 a[168:169], v5 offset:0
  buffer_load_dwordx4 a[84:87], v1, s[8:11], s74 offen offset:1024 sc1
  v_mfma_f32_16x16x32_bf16 v[76:79], a[172:175], a[200:203], v[76:79]
  s_waitcnt lgkmcnt(5)
  v_mfma_f32_16x16x32_bf16 v[92:95], a[180:183], a[200:203], v[92:95]
  ds_read_b64_tr_b16 a[170:171], v5 offset:2048
  v_mfma_f32_16x16x32_bf16 v[92:95], a[176:179], a[216:219], v[92:95]
  s_add_u32 s74, s74, s89
  v_mfma_f32_16x16x32_bf16 v[88:91], a[176:179], a[212:215], v[88:91]
  ds_read_b64_tr_b16 a[172:173], v5 offset:4096
  buffer_load_dwordx4 a[72:75], v1, s[8:11], s74 offen offset:0 sc1
  v_mfma_f32_16x16x32_bf16 v[88:91], a[180:183], a[196:199], v[88:91]
  v_mfma_f32_16x16x32_bf16 v[84:87], a[180:183], a[192:195], v[84:87]
  ds_read_b64_tr_b16 a[174:175], v5 offset:6144
  v_mfma_f32_16x16x32_bf16 v[84:87], a[176:179], a[208:211], v[84:87]
  v_mfma_f32_16x16x32_bf16 v[80:83], a[176:179], a[204:207], v[80:83]
  ds_read_b64_tr_b16 a[176:177], v2 offset:8192
  v_mfma_f32_16x16x32_bf16 v[80:83], a[180:183], a[188:191], v[80:83]
  buffer_load_dwordx4 a[88:91], v1, s[8:11], s74 offen offset:1024 sc1
  s_waitcnt lgkmcnt(5)
  v_mfma_f32_16x16x32_bf16 v[96:99], a[160:163], a[188:191], v[96:99]
  ds_read_b64_tr_b16 a[178:179], v2 offset:10240
  v_mfma_f32_16x16x32_bf16 v[96:99], a[164:167], a[204:207], v[96:99]
  v_mfma_f32_16x16x32_bf16 v[100:103], a[164:167], a[208:211], v[100:103]
  ds_read_b64_tr_b16 a[180:181], v2 offset:12288
  s_add_u32 s74, s74, 131072
  v_mfma_f32_16x16x32_bf16 v[100:103], a[160:163], a[192:195], v[100:103]
  buffer_load_dwordx4 a[76:79], v1, s[8:11], s74 offen offset:0 sc1
  v_mfma_f32_16x16x32_bf16 v[104:107], a[160:163], a[196:199], v[104:107]
  ds_read_b64_tr_b16 a[182:183], v2 offset:14336
  v_mfma_f32_16x16x32_bf16 v[104:107], a[164:167], a[212:215], v[104:107]
  v_mfma_f32_16x16x32_bf16 v[108:111], a[164:167], a[216:219], v[108:111]
  ds_read_b64_tr_b16 a[164:165], v3 offset:8192
  v_mfma_f32_16x16x32_bf16 v[108:111], a[160:163], a[200:203], v[108:111]
  s_waitcnt lgkmcnt(5)
  v_mfma_f32_16x16x32_bf16 v[124:127], a[168:171], a[200:203], v[124:127]
  ds_read_b64_tr_b16 a[166:167], v3 offset:10240
  buffer_load_dwordx4 a[92:95], v1, s[8:11], s74 offen offset:1024 sc1
  v_mfma_f32_16x16x32_bf16 v[124:127], a[172:175], a[216:219], v[124:127]
  v_mfma_f32_16x16x32_bf16 v[120:123], a[172:175], a[212:215], v[120:123]
  ds_read_b64_tr_b16 a[160:161], v3 offset:12288
  v_mfma_f32_16x16x32_bf16 v[120:123], a[168:171], a[196:199], v[120:123]
  v_mfma_f32_16x16x32_bf16 v[116:119], a[168:171], a[192:195], v[116:119]
  ds_read_b64_tr_b16 a[162:163], v3 offset:14336
  buffer_load_dwordx4 a[96:99], v1, s[8:11], s75 offen offset:0 sc1
  v_mfma_f32_16x16x32_bf16 v[116:119], a[172:175], a[208:211], v[116:119]
  v_mfma_f32_16x16x32_bf16 v[112:115], a[172:175], a[204:207], v[112:115]
  ds_read_b64_tr_b16 a[172:173], v4 offset:8192
  v_mfma_f32_16x16x32_bf16 v[112:115], a[168:171], a[188:191], v[112:115]
  s_waitcnt lgkmcnt(5)
  v_mfma_f32_16x16x32_bf16 v[128:131], a[176:179], a[188:191], v[128:131]
  ds_read_b64_tr_b16 a[174:175], v4 offset:10240
  v_mfma_f32_16x16x32_bf16 v[128:131], a[180:183], a[204:207], v[128:131]
  buffer_load_dwordx4 a[112:115], v1, s[8:11], s75 offen offset:1024 sc1
  v_mfma_f32_16x16x32_bf16 v[132:135], a[180:183], a[208:211], v[132:135]
  ds_read_b64_tr_b16 a[168:169], v4 offset:12288
  v_mfma_f32_16x16x32_bf16 v[132:135], a[176:179], a[192:195], v[132:135]
  v_mfma_f32_16x16x32_bf16 v[136:139], a[176:179], a[196:199], v[136:139]
  ds_read_b64_tr_b16 a[170:171], v4 offset:14336
  s_add_u32 s75, s75, 131072
  v_mfma_f32_16x16x32_bf16 v[136:139], a[180:183], a[212:215], v[136:139]
  buffer_load_dwordx4 a[100:103], v1, s[8:11], s75 offen offset:0 sc1
  v_mfma_f32_16x16x32_bf16 v[140:143], a[180:183], a[216:219], v[140:143]
  ds_read_b64_tr_b16 a[180:181], v5 offset:8192
  v_mfma_f32_16x16x32_bf16 v[140:143], a[176:179], a[200:203], v[140:143]
  s_waitcnt lgkmcnt(5)
  v_mfma_f32_16x16x32_bf16 v[156:159], a[164:167], a[200:203], v[156:159]
  ds_read_b64_tr_b16 a[182:183], v5 offset:10240
  v_mfma_f32_16x16x32_bf16 v[156:159], a[160:163], a[216:219], v[156:159]
  v_mfma_f32_16x16x32_bf16 v[152:155], a[160:163], a[212:215], v[152:155]
  ds_read_b64_tr_b16 a[176:177], v5 offset:12288
  buffer_load_dwordx4 a[116:119], v1, s[8:11], s75 offen offset:1024 sc1
  v_mfma_f32_16x16x32_bf16 v[152:155], a[164:167], a[196:199], v[152:155]
  v_mfma_f32_16x16x32_bf16 v[148:151], a[164:167], a[192:195], v[148:151]
  ds_read_b64_tr_b16 a[178:179], v5 offset:14336
  v_mfma_f32_16x16x32_bf16 v[148:151], a[160:163], a[208:211], v[148:151]
  s_add_u32 s75, s75, s89
  s_waitcnt vmcnt(62)
  s_barrier
  v_mfma_f32_16x16x32_bf16 v[144:147], a[160:163], a[204:207], v[144:147]
  ds_read_b64_tr_b16 a[160:161], v6 offset:0
  buffer_load_dwordx4 a[104:107], v1, s[8:11], s75 offen offset:0 sc1
  v_mfma_f32_16x16x32_bf16 v[144:147], a[164:167], a[188:191], v[144:147]
  s_waitcnt lgkmcnt(5)
  v_mfma_f32_16x16x32_bf16 v[160:163], a[172:175], a[188:191], v[160:163]
  ds_read_b64_tr_b16 a[162:163], v6 offset:2048
  v_mfma_f32_16x16x32_bf16 v[160:163], a[168:171], a[204:207], v[160:163]
  v_mfma_f32_16x16x32_bf16 v[164:167], a[168:171], a[208:211], v[164:167]
  ds_read_b64_tr_b16 a[164:165], v6 offset:4096
  v_mfma_f32_16x16x32_bf16 v[164:167], a[172:175], a[192:195], v[164:167]
  buffer_load_dwordx4 a[120:123], v1, s[8:11], s75 offen offset:1024 sc1
  v_mfma_f32_16x16x32_bf16 v[168:171], a[172:175], a[196:199], v[168:171]
  ds_read_b64_tr_b16 a[166:167], v6 offset:6144
  v_mfma_f32_16x16x32_bf16 v[168:171], a[168:171], a[212:215], v[168:171]
  v_mfma_f32_16x16x32_bf16 v[172:175], a[168:171], a[216:219], v[172:175]
  ds_read_b64_tr_b16 a[168:169], v7 offset:0
  s_add_u32 s75, s75, 131072
  v_mfma_f32_16x16x32_bf16 v[172:175], a[172:175], a[200:203], v[172:175]
  buffer_load_dwordx4 a[108:111], v1, s[8:11], s75 offen offset:0 sc1
  s_waitcnt lgkmcnt(5)
  v_mfma_f32_16x16x32_bf16 v[188:191], a[180:183], a[200:203], v[188:191]
  ds_read_b64_tr_b16 a[170:171], v7 offset:2048
  v_mfma_f32_16x16x32_bf16 v[188:191], a[176:179], a[216:219], v[188:191]
  v_mfma_f32_16x16x32_bf16 v[184:187], a[176:179], a[212:215], v[184:187]
  ds_read_b64_tr_b16 a[172:173], v7 offset:4096
  v_mfma_f32_16x16x32_bf16 v[184:187], a[180:183], a[196:199], v[184:187]
  v_mfma_f32_16x16x32_bf16 v[180:183], a[180:183], a[192:195], v[180:183]
  ds_read_b64_tr_b16 a[174:175], v7 offset:6144
  buffer_load_dwordx4 a[124:127], v1, s[8:11], s75 offen offset:1024 sc1
  v_mfma_f32_16x16x32_bf16 v[180:183], a[176:179], a[208:211], v[180:183]
  v_mfma_f32_16x16x32_bf16 v[176:179], a[176:179], a[204:207], v[176:179]
  ds_read_b64_tr_b16 a[176:177], v8 offset:0
  v_mfma_f32_16x16x32_bf16 v[176:179], a[180:183], a[188:191], v[176:179]
  s_waitcnt vmcnt(28) lgkmcnt(5)
  v_mfma_f32_16x16x32_bf16 v[64:67], a[160:163], a[220:223], v[64:67]
  ds_read_b64_tr_b16 a[178:179], v8 offset:2048
  buffer_load_dwordx4 a[128:131], v1, s[8:11], s76 offen offset:0 sc1
  v_mfma_f32_16x16x32_bf16 v[64:67], a[164:167], a[236:239], v[64:67]
  v_mfma_f32_16x16x32_bf16 v[68:71], a[164:167], a[240:243], v[68:71]
  ds_read_b64_tr_b16 a[180:181], v8 offset:4096
  v_mfma_f32_16x16x32_bf16 v[68:71], a[160:163], a[224:227], v[68:71]
  v_mfma_f32_16x16x32_bf16 v[72:75], a[160:163], a[228:231], v[72:75]
  ds_read_b64_tr_b16 a[182:183], v8 offset:6144
  v_mfma_f32_16x16x32_bf16 v[72:75], a[164:167], a[244:247], v[72:75]
  buffer_load_dwordx4 a[144:147], v1, s[8:11], s76 offen offset:1024 sc1
  v_mfma_f32_16x16x32_bf16 v[76:79], a[164:167], a[248:251], v[76:79]
  ds_read_b64_tr_b16 a[164:165], v9 offset:0
  v_mfma_f32_16x16x32_bf16 v[76:79], a[160:163], a[232:235], v[76:79]
  s_waitcnt lgkmcnt(5)
  v_mfma_f32_16x16x32_bf16 v[92:95], a[168:171], a[232:235], v[92:95]
  ds_read_b64_tr_b16 a[166:167], v9 offset:2048
  s_add_u32 s76, s76, 131072
  v_mfma_f32_16x16x32_bf16 v[92:95], a[172:175], a[248:251], v[92:95]
  buffer_load_dwordx4 a[132:135], v1, s[8:11], s76 offen offset:0 sc1
  v_mfma_f32_16x16x32_bf16 v[88:91], a[172:175], a[244:247], v[88:91]
  ds_read_b64_tr_b16 a[160:161], v9 offset:4096
  v_mfma_f32_16x16x32_bf16 v[88:91], a[168:171], a[228:231], v[88:91]
  v_mfma_f32_16x16x32_bf16 v[84:87], a[168:171], a[224:227], v[84:87]
  ds_read_b64_tr_b16 a[162:163], v9 offset:6144
  v_mfma_f32_16x16x32_bf16 v[84:87], a[172:175], a[240:243], v[84:87]
  v_mfma_f32_16x16x32_bf16 v[80:83], a[172:175], a[236:239], v[80:83]
  ds_read_b64_tr_b16 a[172:173], v6 offset:49152
  buffer_load_dwordx4 a[148:151], v1, s[8:11], s76 offen offset:1024 sc1
  v_mfma_f32_16x16x32_bf16 v[80:83], a[168:171], a[220:223], v[80:83]
  s_waitcnt lgkmcnt(5)
  v_mfma_f32_16x16x32_bf16 v[96:99], a[176:179], a[220:223], v[96:99]
  ds_read_b64_tr_b16 a[174:175], v6 offset:51200
  v_mfma_f32_16x16x32_bf16 v[96:99], a[180:183], a[236:239], v[96:99]
  s_add_u32 s76, s76, s89
  v_mfma_f32_16x16x32_bf16 v[100:103], a[180:183], a[240:243], v[100:103]
  ds_read_b64_tr_b16 a[168:169], v6 offset:53248
  buffer_load_dwordx4 a[136:139], v1, s[8:11], s76 offen offset:0 sc1
  v_mfma_f32_16x16x32_bf16 v[100:103], a[176:179], a[224:227], v[100:103]
  v_mfma_f32_16x16x32_bf16 v[104:107], a[176:179], a[228:231], v[104:107]
  ds_read_b64_tr_b16 a[170:171], v6 offset:55296
  v_mfma_f32_16x16x32_bf16 v[104:107], a[180:183], a[244:247], v[104:107]
  v_mfma_f32_16x16x32_bf16 v[108:111], a[180:183], a[248:251], v[108:111]
  ds_read_b64_tr_b16 a[180:181], v7 offset:49152
  v_mfma_f32_16x16x32_bf16 v[108:111], a[176:179], a[232:235], v[108:111]
  buffer_load_dwordx4 a[152:155], v1, s[8:11], s76 offen offset:1024 sc1
  s_waitcnt lgkmcnt(5)
  v_mfma_f32_16x16x32_bf16 v[124:127], a[164:167], a[232:235], v[124:127]
  ds_read_b64_tr_b16 a[182:183], v7 offset:51200
  v_mfma_f32_16x16x32_bf16 v[124:127], a[160:163], a[248:251], v[124:127]
  v_mfma_f32_16x16x32_bf16 v[120:123], a[160:163], a[244:247], v[120:123]
  ds_read_b64_tr_b16 a[176:177], v7 offset:53248
  s_add_u32 s76, s76, 131072
  v_mfma_f32_16x16x32_bf16 v[120:123], a[164:167], a[228:231], v[120:123]
  buffer_load_dwordx4 a[140:143], v1, s[8:11], s76 offen offset:0 sc1
  v_mfma_f32_16x16x32_bf16 v[116:119], a[164:167], a[224:227], v[116:119]
  ds_read_b64_tr_b16 a[178:179], v7 offset:55296
  v_mfma_f32_16x16x32_bf16 v[116:119], a[160:163], a[240:243], v[116:119]
  v_mfma_f32_16x16x32_bf16 v[112:115], a[160:163], a[236:239], v[112:115]
  ds_read_b64_tr_b16 a[160:161], v8 offset:49152
  v_mfma_f32_16x16x32_bf16 v[112:115], a[164:167], a[220:223], v[112:115]
  s_waitcnt vmcnt(27) lgkmcnt(5)
  v_mfma_f32_16x16x32_bf16 v[64:67], a[172:175], a[32:35], v[64:67]
  ds_read_b64_tr_b16 a[162:163], v8 offset:51200
  buffer_load_dwordx4 a[156:159], v1, s[8:11], s76 offen offset:1024 sc1
  v_mfma_f32_16x16x32_bf16 v[64:67], a[168:171], a[48:51], v[64:67]
  v_mfma_f32_16x16x32_bf16 v[68:71], a[168:171], a[52:55], v[68:71]
  ds_read_b64_tr_b16 a[164:165], v8 offset:53248
  v_mfma_f32_16x16x32_bf16 v[68:71], a[172:175], a[36:39], v[68:71]
  v_mfma_f32_16x16x32_bf16 v[72:75], a[172:175], a[40:43], v[72:75]
  ds_read_b64_tr_b16 a[166:167], v8 offset:55296
  buffer_load_dwordx4 a[0:3], v1, s[8:11], s77 offen offset:0 sc1
  v_mfma_f32_16x16x32_bf16 v[72:75], a[168:171], a[56:59], v[72:75]
  v_mfma_f32_16x16x32_bf16 v[76:79], a[168:171], a[60:63], v[76:79]
  ds_read_b64_tr_b16 a[168:169], v9 offset:49152
  v_mfma_f32_16x16x32_bf16 v[76:79], a[172:175], a[44:47], v[76:79]
  s_waitcnt lgkmcnt(5)
  v_mfma_f32_16x16x32_bf16 v[92:95], a[180:183], a[44:47], v[92:95]
  ds_read_b64_tr_b16 a[170:171], v9 offset:51200
  v_mfma_f32_16x16x32_bf16 v[92:95], a[176:179], a[60:63], v[92:95]
  buffer_load_dwordx4 a[16:19], v1, s[8:11], s77 offen offset:1024 sc1
  v_mfma_f32_16x16x32_bf16 v[88:91], a[176:179], a[56:59], v[88:91]
  ds_read_b64_tr_b16 a[172:173], v9 offset:53248
  v_mfma_f32_16x16x32_bf16 v[88:91], a[180:183], a[40:43], v[88:91]
  v_mfma_f32_16x16x32_bf16 v[84:87], a[180:183], a[36:39], v[84:87]
  ds_read_b64_tr_b16 a[174:175], v9 offset:55296
  s_add_u32 s77, s77, 131072
  v_mfma_f32_16x16x32_bf16 v[84:87], a[176:179], a[52:55], v[84:87]
  buffer_load_dwordx4 a[4:7], v1, s[8:11], s77 offen offset:0 sc1
  s_waitcnt vmcnt(27)
  s_barrier
  v_mfma_f32_16x16x32_bf16 v[80:83], a[176:179], a[48:51], v[80:83]
  ds_read_b64_tr_b16 a[176:177], v6 offset:32768
  v_mfma_f32_16x16x32_bf16 v[80:83], a[180:183], a[32:35], v[80:83]
  s_waitcnt lgkmcnt(5)
  v_mfma_f32_16x16x32_bf16 v[96:99], a[160:163], a[32:35], v[96:99]
  ds_read_b64_tr_b16 a[178:179], v6 offset:34816
  v_mfma_f32_16x16x32_bf16 v[96:99], a[164:167], a[48:51], v[96:99]
  v_mfma_f32_16x16x32_bf16 v[100:103], a[164:167], a[52:55], v[100:103]
  ds_read_b64_tr_b16 a[180:181], v6 offset:36864
  buffer_load_dwordx4 a[20:23], v1, s[8:11], s77 offen offset:1024 sc1
  v_mfma_f32_16x16x32_bf16 v[100:103], a[160:163], a[36:39], v[100:103]
  v_mfma_f32_16x16x32_bf16 v[104:107], a[160:163], a[40:43], v[104:107]
  ds_read_b64_tr_b16 a[182:183], v6 offset:38912
  v_mfma_f32_16x16x32_bf16 v[104:107], a[164:167], a[56:59], v[104:107]
  s_add_u32 s77, s77, s89
  v_mfma_f32_16x16x32_bf16 v[108:111], a[164:167], a[60:63], v[108:111]
  ds_read_b64_tr_b16 a[164:165], v7 offset:32768
  buffer_load_dwordx4 a[8:11], v1, s[8:11], s77 offen offset:0 sc1
  v_mfma_f32_16x16x32_bf16 v[108:111], a[160:163], a[44:47], v[108:111]
  s_waitcnt lgkmcnt(5)
  v_mfma_f32_16x16x32_bf16 v[124:127], a[168:171], a[44:47], v[124:127]
  ds_read_b64_tr_b16 a[166:167], v7 offset:34816
  v_mfma_f32_16x16x32_bf16 v[124:127], a[172:175], a[60:63], v[124:127]
  v_mfma_f32_16x16x32_bf16 v[120:123], a[172:175], a[56:59], v[120:123]
  ds_read_b64_tr_b16 a[160:161], v7 offset:36864
  v_mfma_f32_16x16x32_bf16 v[120:123], a[168:171], a[40:43], v[120:123]
  buffer_load_dwordx4 a[24:27], v1, s[8:11], s77 offen offset:1024 sc1
  v_mfma_f32_16x16x32_bf16 v[116:119], a[168:171], a[36:39], v[116:119]
  ds_read_b64_tr_b16 a[162:163], v7 offset:38912
  v_mfma_f32_16x16x32_bf16 v[116:119], a[172:175], a[52:55], v[116:119]
  v_mfma_f32_16x16x32_bf16 v[112:115], a[172:175], a[48:51], v[112:115]
  ds_read_b64_tr_b16 a[172:173], v8 offset:32768
  s_add_u32 s77, s77, 131072
HOP18:
  s_cbranch_execz WRET1
  v_mfma_f32_16x16x32_bf16 v[112:115], a[168:171], a[32:35], v[112:115]
  buffer_load_dwordx4 a[12:15], v1, s[8:11], s77 offen offset:0 sc1
  s_waitcnt vmcnt(23) lgkmcnt(5)
  v_mfma_f32_16x16x32_bf16 v[64:67], a[176:179], a[64:67], v[64:67]
  ds_read_b64_tr_b16 a[174:175], v8 offset:34816
  v_mfma_f32_16x16x32_bf16 v[64:67], a[180:183], a[80:83], v[64:67]
  v_mfma_f32_16x16x32_bf16 v[68:71], a[180:183], a[84:87], v[68:71]
  ds_read_b64_tr_b16 a[168:169], v8 offset:36864
  v_mfma_f32_16x16x32_bf16 v[68:71], a[176:179], a[68:71], v[68:71]
  v_mfma_f32_16x16x32_bf16 v[72:75], a[176:179], a[72:75], v[72:75]
  ds_read_b64_tr_b16 a[170:171], v8 offset:38912
  buffer_load_dwordx4 a[28:31], v1, s[8:11], s77 offen offset:1024 sc1
  v_mfma_f32_16x16x32_bf16 v[72:75], a[180:183], a[88:91], v[72:75]
  v_mfma_f32_16x16x32_bf16 v[76:79], a[180:183], a[92:95], v[76:79]
  ds_read_b64_tr_b16 a[180:181], v9 offset:32768
  v_mfma_f32_16x16x32_bf16 v[76:79], a[176:179], a[76:79], v[76:79]
  s_add_u32 m0, s45, 90112
  s_waitcnt lgkmcnt(5)
  v_mfma_f32_16x16x32_bf16 v[92:95], a[164:167], a[76:79], v[92:95]
  ds_read_b64_tr_b16 a[182:183], v9 offset:34816
  buffer_load_dwordx4 v33, s[36:39], s67 offen lds
  v_mfma_f32_16x16x32_bf16 v[92:95], a[160:163], a[92:95], v[92:95]
  v_mfma_f32_16x16x32_bf16 v[88:91], a[160:163], a[88:91], v[88:91]
  ds_read_b64_tr_b16 a[176:177], v9 offset:36864
  v_mfma_f32_16x16x32_bf16 v[88:91], a[164:167], a[72:75], v[88:91]
  v_mfma_f32_16x16x32_bf16 v[84:87], a[164:167], a[68:71], v[84:87]
  ds_read_b64_tr_b16 a[178:179], v9 offset:38912
  s_add_u32 m0, s45, 94208
  s_add_u32 s61, s67, 65536
  v_mfma_f32_16x16x32_bf16 v[84:87], a[160:163], a[84:87], v[84:87]
  buffer_load_dwordx4 v33, s[36:39], s61 offen lds
  v_mfma_f32_16x16x32_bf16 v[80:83], a[160:163], a[80:83], v[80:83]
  ds_read_b64_tr_b16 a[160:161], v6 offset:16384
  v_mfma_f32_16x16x32_bf16 v[80:83], a[164:167], a[64:67], v[80:83]
  s_waitcnt lgkmcnt(5)
  v_mfma_f32_16x16x32_bf16 v[96:99], a[172:175], a[64:67], v[96:99]
  ds_read_b64_tr_b16 a[162:163], v6 offset:18432
  s_add_u32 m0, s45, 40960
  v_mfma_f32_16x16x32_bf16 v[96:99], a[168:171], a[80:83], v[96:99]
  buffer_load_dwordx4 v33, s[36:39], s68 offen lds
  v_mfma_f32_16x16x32_bf16 v[100:103], a[168:171], a[84:87], v[100:103]
  ds_read_b64_tr_b16 a[164:165], v6 offset:20480
  v_mfma_f32_16x16x32_bf16 v[100:103], a[172:175], a[68:71], v[100:103]
  v_mfma_f32_16x16x32_bf16 v[104:107], a[172:175], a[72:75], v[104:107]
  ds_read_b64_tr_b16 a[166:167], v6 offset:22528
  v_mfma_f32_16x16x32_bf16 v[104:107], a[168:171], a[88:91], v[104:107]
  s_add_u32 m0, s45, 45056
  s_add_u32 s61, s68, 65536
  v_mfma_f32_16x16x32_bf16 v[108:111], a[168:171], a[92:95], v[108:111]
  ds_read_b64_tr_b16 a[168:169], v7 offset:16384
  buffer_load_dwordx4 v33, s[36:39], s61 offen lds
  v_mfma_f32_16x16x32_bf16 v[108:111], a[172:175], a[76:79], v[108:111]
  s_waitcnt lgkmcnt(5)
  v_mfma_f32_16x16x32_bf16 v[124:127], a[180:183], a[76:79], v[124:127]
  ds_read_b64_tr_b16 a[170:171], v7 offset:18432
  v_mfma_f32_16x16x32_bf16 v[124:127], a[176:179], a[92:95], v[124:127]
  s_add_u32 m0, s45, 57344
  v_mfma_f32_16x16x32_bf16 v[120:123], a[176:179], a[88:91], v[120:123]
  ds_read_b64_tr_b16 a[172:173], v7 offset:20480
  buffer_load_dwordx4 v33, s[36:39], s69 offen lds
  v_mfma_f32_16x16x32_bf16 v[120:123], a[180:183], a[72:75], v[120:123]
  v_mfma_f32_16x16x32_bf16 v[116:119], a[180:183], a[68:71], v[116:119]
  ds_read_b64_tr_b16 a[174:175], v7 offset:22528
  v_mfma_f32_16x16x32_bf16 v[116:119], a[176:179], a[84:87], v[116:119]
  v_mfma_f32_16x16x32_bf16 v[112:115], a[176:179], a[80:83], v[112:115]
  ds_read_b64_tr_b16 a[176:177], v8 offset:16384
  s_add_u32 m0, s45, 61440
  s_add_u32 s61, s69, 65536
  v_mfma_f32_16x16x32_bf16 v[112:115], a[180:183], a[64:67], v[112:115]
  buffer_load_dwordx4 v33, s[36:39], s61 offen lds
  s_waitcnt vmcnt(22) lgkmcnt(5)
  v_mfma_f32_16x16x32_bf16 v[64:67], a[160:163], a[96:99], v[64:67]
  ds_read_b64_tr_b16 a[178:179], v8 offset:18432
  v_mfma_f32_16x16x32_bf16 v[64:67], a[164:167], a[112:115], v[64:67]
  v_mfma_f32_16x16x32_bf16 v[68:71], a[164:167], a[116:119], v[68:71]
  ds_read_b64_tr_b16 a[180:181], v8 offset:20480
  v_mfma_f32_16x16x32_bf16 v[68:71], a[160:163], a[100:103], v[68:71]
  v_mfma_f32_16x16x32_bf16 v[72:75], a[160:163], a[104:107], v[72:75]
  ds_read_b64_tr_b16 a[182:183], v8 offset:22528
  v_mfma_f32_16x16x32_bf16 v[72:75], a[164:167], a[120:123], v[72:75]
  v_mfma_f32_16x16x32_bf16 v[76:79], a[164:167], a[124:127], v[76:79]
  ds_read_b64_tr_b16 a[164:165], v9 offset:16384
  v_mfma_f32_16x16x32_bf16 v[76:79], a[160:163], a[108:111], v[76:79]
  s_waitcnt lgkmcnt(5)
  v_mfma_f32_16x16x32_bf16 v[92:95], a[168:171], a[108:111], v[92:95]
  ds_read_b64_tr_b16 a[166:167], v9 offset:18432
  v_mfma_f32_16x16x32_bf16 v[92:95], a[172:175], a[124:127], v[92:95]
  v_mfma_f32_16x16x32_bf16 v[88:91], a[172:175], a[120:123], v[88:91]
  ds_read_b64_tr_b16 a[160:161], v9 offset:20480
  v_mfma_f32_16x16x32_bf16 v[88:91], a[168:171], a[104:107], v[88:91]
  v_mfma_f32_16x16x32_bf16 v[84:87], a[168:171], a[100:103], v[84:87]
  ds_read_b64_tr_b16 a[162:163], v9 offset:22528
  v_mfma_f32_16x16x32_bf16 v[84:87], a[172:175], a[116:119], v[84:87]
  v_mfma_f32_16x16x32_bf16 v[80:83], a[172:175], a[112:115], v[80:83]
  ds_read_b64_tr_b16 a[172:173], v2 offset:32768
  v_mfma_f32_16x16x32_bf16 v[80:83], a[168:171], a[96:99], v[80:83]
  s_waitcnt lgkmcnt(5)
  v_mfma_f32_16x16x32_bf16 v[96:99], a[176:179], a[96:99], v[96:99]
  ds_read_b64_tr_b16 a[174:175], v2 offset:34816
  v_mfma_f32_16x16x32_bf16 v[96:99], a[180:183], a[112:115], v[96:99]
  v_mfma_f32_16x16x32_bf16 v[100:103], a[180:183], a[116:119], v[100:103]
  ds_read_b64_tr_b16 a[168:169], v2 offset:36864
  v_mfma_f32_16x16x32_bf16 v[100:103], a[176:179], a[100:103], v[100:103]
  v_mfma_f32_16x16x32_bf16 v[104:107], a[176:179], a[104:107], v[104:107]
  ds_read_b64_tr_b16 a[170:171], v2 offset:38912
  v_mfma_f32_16x16x32_bf16 v[104:107], a[180:183], a[120:123], v[104:107]
  v_mfma_f32_16x16x32_bf16 v[108:111], a[180:183], a[124:127], v[108:111]
  ds_read_b64_tr_b16 a[180:181], v3 offset:32768
  v_mfma_f32_16x16x32_bf16 v[108:111], a[176:179], a[108:111], v[108:111]
  s_waitcnt lgkmcnt(5)
  v_mfma_f32_16x16x32_bf16 v[124:127], a[164:167], a[108:111], v[124:127]
  ds_read_b64_tr_b16 a[182:183], v3 offset:34816
  v_mfma_f32_16x16x32_bf16 v[124:127], a[160:163], a[124:127], v[124:127]
  v_mfma_f32_16x16x32_bf16 v[120:123], a[160:163], a[120:123], v[120:123]
  ds_read_b64_tr_b16 a[176:177], v3 offset:36864
  v_mfma_f32_16x16x32_bf16 v[120:123], a[164:167], a[104:107], v[120:123]
  v_mfma_f32_16x16x32_bf16 v[116:119], a[164:167], a[100:103], v[116:119]
  ds_read_b64_tr_b16 a[178:179], v3 offset:38912
  v_mfma_f32_16x16x32_bf16 v[116:119], a[160:163], a[116:119], v[116:119]
  v_mfma_f32_16x16x32_bf16 v[112:115], a[160:163], a[112:115], v[112:115]
  ds_read_b64_tr_b16 a[160:161], v4 offset:32768
  v_mfma_f32_16x16x32_bf16 v[112:115], a[164:167], a[96:99], v[112:115]
  s_waitcnt vmcnt(14) lgkmcnt(5)
  v_mfma_f32_16x16x32_bf16 v[64:67], a[172:175], a[128:131], v[64:67]
  ds_read_b64_tr_b16 a[162:163], v4 offset:34816
  v_mfma_f32_16x16x32_bf16 v[64:67], a[168:171], a[144:147], v[64:67]
  v_mfma_f32_16x16x32_bf16 v[68:71], a[168:171], a[148:151], v[68:71]
  ds_read_b64_tr_b16 a[164:165], v4 offset:36864
  v_mfma_f32_16x16x32_bf16 v[68:71], a[172:175], a[132:135], v[68:71]
  v_mfma_f32_16x16x32_bf16 v[72:75], a[172:175], a[136:139], v[72:75]
  ds_read_b64_tr_b16 a[166:167], v4 offset:38912
  v_mfma_f32_16x16x32_bf16 v[72:75], a[168:171], a[152:155], v[72:75]
  v_mfma_f32_16x16x32_bf16 v[76:79], a[168:171], a[156:159], v[76:79]
  ds_read_b64_tr_b16 a[168:169], v5 offset:32768
  v_mfma_f32_16x16x32_bf16 v[76:79], a[172:175], a[140:143], v[76:79]
  s_waitcnt lgkmcnt(5)
  v_mfma_f32_16x16x32_bf16 v[92:95], a[180:183], a[140:143], v[92:95]
  ds_read_b64_tr_b16 a[170:171], v5 offset:34816
  v_mfma_f32_16x16x32_bf16 v[92:95], a[176:179], a[156:159], v[92:95]
  v_mfma_f32_16x16x32_bf16 v[88:91], a[176:179], a[152:155], v[88:91]
  ds_read_b64_tr_b16 a[172:173], v5 offset:36864
  v_mfma_f32_16x16x32_bf16 v[88:91], a[180:183], a[136:139], v[88:91]
  v_mfma_f32_16x16x32_bf16 v[84:87], a[180:183], a[132:135], v[84:87]
  ds_read_b64_tr_b16 a[174:175], v5 offset:38912
  v_mfma_f32_16x16x32_bf16 v[84:87], a[176:179], a[148:151], v[84:87]
  v_mfma_f32_16x16x32_bf16 v[80:83], a[176:179], a[144:147], v[80:83]
  ds_read_b64_tr_b16 a[176:177], v2 offset:49152
  v_mfma_f32_16x16x32_bf16 v[80:83], a[180:183], a[128:131], v[80:83]
  s_waitcnt lgkmcnt(5)
  v_mfma_f32_16x16x32_bf16 v[96:99], a[160:163], a[128:131], v[96:99]
  ds_read_b64_tr_b16 a[178:179], v2 offset:51200
  v_mfma_f32_16x16x32_bf16 v[96:99], a[164:167], a[144:147], v[96:99]
  v_mfma_f32_16x16x32_bf16 v[100:103], a[164:167], a[148:151], v[100:103]
  ds_read_b64_tr_b16 a[180:181], v2 offset:53248
  v_mfma_f32_16x16x32_bf16 v[100:103], a[160:163], a[132:135], v[100:103]
  v_mfma_f32_16x16x32_bf16 v[104:107], a[160:163], a[136:139], v[104:107]
  ds_read_b64_tr_b16 a[182:183], v2 offset:55296
  v_mfma_f32_16x16x32_bf16 v[104:107], a[164:167], a[152:155], v[104:107]
  v_mfma_f32_16x16x32_bf16 v[108:111], a[164:167], a[156:159], v[108:111]
  ds_read_b64_tr_b16 a[164:165], v3 offset:49152
  v_mfma_f32_16x16x32_bf16 v[108:111], a[160:163], a[140:143], v[108:111]
  s_waitcnt lgkmcnt(5)
  v_mfma_f32_16x16x32_bf16 v[124:127], a[168:171], a[140:143], v[124:127]
  ds_read_b64_tr_b16 a[166:167], v3 offset:51200
  v_mfma_f32_16x16x32_bf16 v[124:127], a[172:175], a[156:159], v[124:127]
  v_mfma_f32_16x16x32_bf16 v[120:123], a[172:175], a[152:155], v[120:123]
  ds_read_b64_tr_b16 a[160:161], v3 offset:53248
  v_mfma_f32_16x16x32_bf16 v[120:123], a[168:171], a[136:139], v[120:123]
  v_mfma_f32_16x16x32_bf16 v[116:119], a[168:171], a[132:135], v[116:119]
  ds_read_b64_tr_b16 a[162:163], v3 offset:55296
  v_mfma_f32_16x16x32_bf16 v[116:119], a[172:175], a[148:151], v[116:119]
  v_mfma_f32_16x16x32_bf16 v[112:115], a[172:175], a[144:147], v[112:115]
  ds_read_b64_tr_b16 a[172:173], v4 offset:49152
  v_mfma_f32_16x16x32_bf16 v[112:115], a[168:171], a[128:131], v[112:115]
  s_waitcnt vmcnt(6) lgkmcnt(5)
  v_mfma_f32_16x16x32_bf16 v[64:67], a[176:179], a[0:3], v[64:67]
  ds_read_b64_tr_b16 a[174:175], v4 offset:51200
  v_mfma_f32_16x16x32_bf16 v[64:67], a[180:183], a[16:19], v[64:67]
  v_mfma_f32_16x16x32_bf16 v[68:71], a[180:183], a[20:23], v[68:71]
  ds_read_b64_tr_b16 a[168:169], v4 offset:53248
  v_mfma_f32_16x16x32_bf16 v[68:71], a[176:179], a[4:7], v[68:71]
  v_mfma_f32_16x16x32_bf16 v[72:75], a[176:179], a[8:11], v[72:75]
  ds_read_b64_tr_b16 a[170:171], v4 offset:55296
  v_mfma_f32_16x16x32_bf16 v[72:75], a[180:183], a[24:27], v[72:75]
  v_mfma_f32_16x16x32_bf16 v[76:79], a[180:183], a[28:31], v[76:79]
  ds_read_b64_tr_b16 a[180:181], v5 offset:49152
  v_mfma_f32_16x16x32_bf16 v[76:79], a[176:179], a[12:15], v[76:79]
  s_waitcnt lgkmcnt(5)
  v_mfma_f32_16x16x32_bf16 v[92:95], a[164:167], a[12:15], v[92:95]
  ds_read_b64_tr_b16 a[182:183], v5 offset:51200
  v_mfma_f32_16x16x32_bf16 v[92:95], a[160:163], a[28:31], v[92:95]
  v_mfma_f32_16x16x32_bf16 v[88:91], a[160:163], a[24:27], v[88:91]
  ds_read_b64_tr_b16 a[176:177], v5 offset:53248
  v_cvt_pk_bf16_f32 v72, v72, v73
  v_mfma_f32_16x16x32_bf16 v[88:91], a[164:167], a[8:11], v[88:91]
  v_cvt_pk_bf16_f32 v73, v74, v75
  v_cvt_pk_bf16_f32 v76, v76, v77
  v_mfma_f32_16x16x32_bf16 v[84:87], a[164:167], a[4:7], v[84:87]
  ds_read_b64_tr_b16 a[178:179], v5 offset:55296
  v_cvt_pk_bf16_f32 v77, v78, v79
  v_mfma_f32_16x16x32_bf16 v[84:87], a[160:163], a[20:23], v[84:87]
  v_cvt_pk_bf16_f32 v64, v64, v65
  v_cvt_pk_bf16_f32 v65, v66, v67
  v_mfma_f32_16x16x32_bf16 v[80:83], a[160:163], a[16:19], v[80:83]
  v_cvt_pk_bf16_f32 v68, v68, v69
  v_cvt_pk_bf16_f32 v69, v70, v71
  v_mfma_f32_16x16x32_bf16 v[80:83], a[164:167], a[0:3], v[80:83]
  s_waitcnt lgkmcnt(4)
  v_mfma_f32_16x16x32_bf16 v[96:99], a[172:175], a[0:3], v[96:99]
  v_mfma_f32_16x16x32_bf16 v[96:99], a[168:171], a[16:19], v[96:99]
  s_waitcnt vmcnt(0)
  s_barrier
  v_mfma_f32_16x16x32_bf16 v[100:103], a[168:171], a[20:23], v[100:103]
  ds_read_b64_tr_b16 v[16:17], v6 offset:8192
  v_cvt_pk_bf16_f32 v74, v88, v89
  v_mfma_f32_16x16x32_bf16 v[100:103], a[172:175], a[4:7], v[100:103]
  ds_read_b64_tr_b16 v[18:19], v6 offset:10240
  v_cvt_pk_bf16_f32 v75, v90, v91
  v_mfma_f32_16x16x32_bf16 v[104:107], a[172:175], a[8:11], v[104:107]
  ds_read_b64_tr_b16 v[20:21], v6 offset:12288
  v_mfma_f32_16x16x32_bf16 v[104:107], a[168:171], a[24:27], v[104:107]
  ds_read_b64_tr_b16 v[22:23], v6 offset:14336
  s_add_u32 s87, s86, 0
  buffer_store_dwordx4 v[72:75], v1, s[8:11], s87 offen offset:0 sc1
  v_mfma_f32_16x16x32_bf16 v[108:111], a[168:171], a[28:31], v[108:111]
  ds_read_b64_tr_b16 v[24:25], v7 offset:8192
  v_mfma_f32_16x16x32_bf16 v[108:111], a[172:175], a[12:15], v[108:111]
  ds_read_b64_tr_b16 v[26:27], v7 offset:10240
  s_waitcnt lgkmcnt(6)
  v_mfma_f32_16x16x32_bf16 v[124:127], a[180:183], a[12:15], v[124:127]
  ds_read_b64_tr_b16 v[28:29], v7 offset:12288
  v_cvt_pk_bf16_f32 v78, v92, v93
  v_mfma_f32_16x16x32_bf16 v[124:127], a[176:179], a[28:31], v[124:127]
  ds_read_b64_tr_b16 v[30:31], v7 offset:14336
  v_cvt_pk_bf16_f32 v79, v94, v95
  v_mfma_f32_16x16x32_bf16 v[120:123], a[176:179], a[24:27], v[120:123]
  ds_read_b64_tr_b16 a[160:161], v8 offset:8192
  v_mfma_f32_16x16x32_bf16 v[120:123], a[180:183], a[8:11], v[120:123]
  ds_read_b64_tr_b16 a[162:163], v8 offset:10240
  s_add_u32 s87, s86, 0
  buffer_store_dwordx4 v[76:79], v1, s[8:11], s87 offen offset:2048 sc1
  v_mfma_f32_16x16x32_bf16 v[116:119], a[180:183], a[4:7], v[116:119]
  ds_read_b64_tr_b16 a[164:165], v8 offset:12288
  v_mfma_f32_16x16x32_bf16 v[116:119], a[176:179], a[20:23], v[116:119]
  ds_read_b64_tr_b16 a[166:167], v8 offset:14336
  v_cvt_pk_bf16_f32 v66, v80, v81
  v_mfma_f32_16x16x32_bf16 v[112:115], a[176:179], a[16:19], v[112:115]
  ds_read_b64_tr_b16 a[168:169], v9 offset:8192
  v_cvt_pk_bf16_f32 v67, v82, v83
  v_mfma_f32_16x16x32_bf16 v[112:115], a[180:183], a[0:3], v[112:115]
  ds_read_b64_tr_b16 a[170:171], v9 offset:10240
  s_waitcnt lgkmcnt(10)
  v_mfma_f32_16x16x32_bf16 v[136:139], v[16:19], a[228:231], v[136:139]
  ds_read_b64_tr_b16 a[172:173], v9 offset:12288
  v_mfma_f32_16x16x32_bf16 v[136:139], v[20:23], a[244:247], v[136:139]
  ds_read_b64_tr_b16 a[174:175], v9 offset:14336
  s_add_u32 s87, s86, 4096
  buffer_store_dwordx4 v[64:67], v1, s[8:11], s87 offen offset:0 sc1
  v_mfma_f32_16x16x32_bf16 v[140:143], v[20:23], a[248:251], v[140:143]
  ds_read_b64_tr_b16 a[176:177], v6 offset:57344
  v_mfma_f32_16x16x32_bf16 v[140:143], v[16:19], a[232:235], v[140:143]
  ds_read_b64_tr_b16 a[178:179], v6 offset:59392
  s_waitcnt lgkmcnt(10)
  v_mfma_f32_16x16x32_bf16 v[156:159], v[24:27], a[232:235], v[156:159]
  ds_read_b64_tr_b16 a[180:181], v6 offset:61440
  v_cvt_pk_bf16_f32 v70, v84, v85
  v_mfma_f32_16x16x32_bf16 v[156:159], v[28:31], a[248:251], v[156:159]
  ds_read_b64_tr_b16 a[182:183], v6 offset:63488
  v_cvt_pk_bf16_f32 v71, v86, v87
  v_mfma_f32_16x16x32_bf16 v[152:155], v[28:31], a[244:247], v[152:155]
  ds_read_b64_tr_b16 v[20:21], v7 offset:57344
  v_mfma_f32_16x16x32_bf16 v[152:155], v[24:27], a[228:231], v[152:155]
  ds_read_b64_tr_b16 v[22:23], v7 offset:59392
  s_waitcnt lgkmcnt(10)
  v_mfma_f32_16x16x32_bf16 v[168:171], a[160:163], a[228:231], v[168:171]
  ds_read_b64_tr_b16 v[16:17], v7 offset:61440
  v_mfma_f32_16x16x32_bf16 v[168:171], a[164:167], a[244:247], v[168:171]
  ds_read_b64_tr_b16 v[18:19], v7 offset:63488
  s_add_u32 s87, s86, 4096
  buffer_store_dwordx4 v[68:71], v1, s[8:11], s87 offen offset:2048 sc1
  v_mfma_f32_16x16x32_bf16 v[172:175], a[164:167], a[248:251], v[172:175]
  ds_read_b64_tr_b16 v[28:29], v8 offset:57344
  v_mfma_f32_16x16x32_bf16 v[172:175], a[160:163], a[232:235], v[172:175]
  ds_read_b64_tr_b16 v[30:31], v8 offset:59392
  s_waitcnt lgkmcnt(10)
  v_mfma_f32_16x16x32_bf16 v[188:191], a[168:171], a[232:235], v[188:191]
  ds_read_b64_tr_b16 v[24:25], v8 offset:61440
  v_cvt_pk_bf16_f32 v104, v104, v105
  v_mfma_f32_16x16x32_bf16 v[188:191], a[172:175], a[248:251], v[188:191]
  ds_read_b64_tr_b16 v[26:27], v8 offset:63488
  v_cvt_pk_bf16_f32 v105, v106, v107
  v_mfma_f32_16x16x32_bf16 v[184:187], a[172:175], a[244:247], v[184:187]
  ds_read_b64_tr_b16 a[164:165], v9 offset:57344
  v_cvt_pk_bf16_f32 v108, v108, v109
  v_mfma_f32_16x16x32_bf16 v[184:187], a[168:171], a[228:231], v[184:187]
  ds_read_b64_tr_b16 a[166:167], v9 offset:59392
  s_waitcnt lgkmcnt(10)
  v_mfma_f32_16x16x32_bf16 v[136:139], a[176:179], a[40:43], v[136:139]
  ds_read_b64_tr_b16 a[160:161], v9 offset:61440
  v_cvt_pk_bf16_f32 v109, v110, v111
  v_mfma_f32_16x16x32_bf16 v[136:139], a[180:183], a[56:59], v[136:139]
  ds_read_b64_tr_b16 a[162:163], v9 offset:63488
  v_cvt_pk_bf16_f32 v96, v96, v97
  v_mfma_f32_16x16x32_bf16 v[140:143], a[180:183], a[60:63], v[140:143]
  ds_read_b64_tr_b16 a[172:173], v6 offset:40960
  v_cvt_pk_bf16_f32 v97, v98, v99
  v_mfma_f32_16x16x32_bf16 v[140:143], a[176:179], a[44:47], v[140:143]
  ds_read_b64_tr_b16 a[174:175], v6 offset:43008
  s_waitcnt lgkmcnt(10)
  v_mfma_f32_16x16x32_bf16 v[156:159], v[20:23], a[44:47], v[156:159]
  ds_read_b64_tr_b16 a[168:169], v6 offset:45056
  v_cvt_pk_bf16_f32 v100, v100, v101
  v_mfma_f32_16x16x32_bf16 v[156:159], v[16:19], a[60:63], v[156:159]
  ds_read_b64_tr_b16 a[170:171], v6 offset:47104
  v_cvt_pk_bf16_f32 v101, v102, v103
  v_mfma_f32_16x16x32_bf16 v[152:155], v[16:19], a[56:59], v[152:155]
  ds_read_b64_tr_b16 a[180:181], v7 offset:40960
  v_cvt_pk_bf16_f32 v106, v120, v121
  v_mfma_f32_16x16x32_bf16 v[152:155], v[20:23], a[40:43], v[152:155]
  ds_read_b64_tr_b16 a[182:183], v7 offset:43008
  s_waitcnt lgkmcnt(10)
  v_mfma_f32_16x16x32_bf16 v[168:171], v[28:31], a[40:43], v[168:171]
  ds_read_b64_tr_b16 a[176:177], v7 offset:45056
  v_cvt_pk_bf16_f32 v107, v122, v123
  v_mfma_f32_16x16x32_bf16 v[168:171], v[24:27], a[56:59], v[168:171]
  ds_read_b64_tr_b16 a[178:179], v7 offset:47104
  v_mfma_f32_16x16x32_bf16 v[172:175], v[24:27], a[60:63], v[172:175]
  ds_read_b64_tr_b16 v[16:17], v8 offset:40960
  s_add_u32 s87, s86, 0
  buffer_store_dwordx4 v[104:107], v1, s[8:11], s87 offen offset:1024 sc1
  v_mfma_f32_16x16x32_bf16 v[172:175], v[28:31], a[44:47], v[172:175]
  ds_read_b64_tr_b16 v[18:19], v8 offset:43008
  s_waitcnt lgkmcnt(10)
  v_mfma_f32_16x16x32_bf16 v[188:191], a[164:167], a[44:47], v[188:191]
  ds_read_b64_tr_b16 v[20:21], v8 offset:45056
  v_cvt_pk_bf16_f32 v110, v124, v125
  v_mfma_f32_16x16x32_bf16 v[188:191], a[160:163], a[60:63], v[188:191]
  ds_read_b64_tr_b16 v[22:23], v8 offset:47104
  v_cvt_pk_bf16_f32 v111, v126, v127
  v_mfma_f32_16x16x32_bf16 v[184:187], a[160:163], a[56:59], v[184:187]
  ds_read_b64_tr_b16 v[24:25], v9 offset:40960
  v_mfma_f32_16x16x32_bf16 v[184:187], a[164:167], a[40:43], v[184:187]
  ds_read_b64_tr_b16 v[26:27], v9 offset:43008
  s_waitcnt lgkmcnt(10)
  v_mfma_f32_16x16x32_bf16 v[136:139], a[172:175], a[72:75], v[136:139]
  ds_read_b64_tr_b16 v[28:29], v9 offset:45056
  v_mfma_f32_16x16x32_bf16 v[136:139], a[168:171], a[88:91], v[136:139]
  ds_read_b64_tr_b16 v[30:31], v9 offset:47104
  s_add_u32 s87, s86, 0
  buffer_store_dwordx4 v[108:111], v1, s[8:11], s87 offen offset:3072 sc1
  v_mfma_f32_16x16x32_bf16 v[140:143], a[168:171], a[92:95], v[140:143]
  ds_read_b64_tr_b16 a[160:161], v6 offset:24576
  v_mfma_f32_16x16x32_bf16 v[140:143], a[172:175], a[76:79], v[140:143]
  ds_read_b64_tr_b16 a[162:163], v6 offset:26624
  s_waitcnt lgkmcnt(10)
  v_mfma_f32_16x16x32_bf16 v[156:159], a[180:183], a[76:79], v[156:159]
  ds_read_b64_tr_b16 a[164:165], v6 offset:28672
  v_cvt_pk_bf16_f32 v98, v112, v113
  v_mfma_f32_16x16x32_bf16 v[156:159], a[176:179], a[92:95], v[156:159]
  ds_read_b64_tr_b16 a[166:167], v6 offset:30720
  v_cvt_pk_bf16_f32 v99, v114, v115
  v_mfma_f32_16x16x32_bf16 v[152:155], a[176:179], a[88:91], v[152:155]
  ds_read_b64_tr_b16 a[168:169], v7 offset:24576
  v_mfma_f32_16x16x32_bf16 v[152:155], a[180:183], a[72:75], v[152:155]
  ds_read_b64_tr_b16 a[170:171], v7 offset:26624
  s_waitcnt lgkmcnt(10)
  v_mfma_f32_16x16x32_bf16 v[168:171], v[16:19], a[72:75], v[168:171]
  ds_read_b64_tr_b16 a[172:173], v7 offset:28672
  v_mfma_f32_16x16x32_bf16 v[168:171], v[20:23], a[88:91], v[168:171]
  ds_read_b64_tr_b16 a[174:175], v7 offset:30720
  s_add_u32 s87, s86, 4096
  buffer_store_dwordx4 v[96:99], v1, s[8:11], s87 offen offset:1024 sc1
  v_mfma_f32_16x16x32_bf16 v[172:175], v[20:23], a[92:95], v[172:175]
  ds_read_b64_tr_b16 a[176:177], v8 offset:24576
  v_mfma_f32_16x16x32_bf16 v[172:175], v[16:19], a[76:79], v[172:175]
  ds_read_b64_tr_b16 a[178:179], v8 offset:26624
  s_waitcnt lgkmcnt(10)
  v_mfma_f32_16x16x32_bf16 v[188:191], v[24:27], a[76:79], v[188:191]
  ds_read_b64_tr_b16 a[180:181], v8 offset:28672
  v_cvt_pk_bf16_f32 v102, v116, v117
  v_mfma_f32_16x16x32_bf16 v[188:191], v[28:31], a[92:95], v[188:191]
  ds_read_b64_tr_b16 a[182:183], v8 offset:30720
  v_cvt_pk_bf16_f32 v103, v118, v119
  v_mfma_f32_16x16x32_bf16 v[184:187], v[28:31], a[88:91], v[184:187]
  ds_read_b64_tr_b16 v[20:21], v9 offset:24576
  v_mfma_f32_16x16x32_bf16 v[184:187], v[24:27], a[72:75], v[184:187]
  ds_read_b64_tr_b16 v[22:23], v9 offset:26624
  s_waitcnt lgkmcnt(10)
  v_mfma_f32_16x16x32_bf16 v[136:139], a[160:163], a[104:107], v[136:139]
  ds_read_b64_tr_b16 v[16:17], v9 offset:28672
  v_mfma_f32_16x16x32_bf16 v[136:139], a[164:167], a[120:123], v[136:139]
  ds_read_b64_tr_b16 v[18:19], v9 offset:30720
  s_add_u32 s87, s86, 4096
  buffer_store_dwordx4 v[100:103], v1, s[8:11], s87 offen offset:3072 sc1
  v_mfma_f32_16x16x32_bf16 v[140:143], a[164:167], a[124:127], v[140:143]
  ds_read_b64_tr_b16 v[28:29], v2 offset:40960
  v_mfma_f32_16x16x32_bf16 v[140:143], a[160:163], a[108:111], v[140:143]
  ds_read_b64_tr_b16 v[30:31], v2 offset:43008
  s_waitcnt lgkmcnt(10)
  v_mfma_f32_16x16x32_bf16 v[156:159], a[168:171], a[108:111], v[156:159]
  ds_read_b64_tr_b16 v[24:25], v2 offset:45056
  v_mfma_f32_16x16x32_bf16 v[156:159], a[172:175], a[124:127], v[156:159]
  ds_read_b64_tr_b16 v[26:27], v2 offset:47104
  v_mfma_f32_16x16x32_bf16 v[152:155], a[172:175], a[120:123], v[152:155]
  ds_read_b64_tr_b16 a[164:165], v3 offset:40960
  v_mfma_f32_16x16x32_bf16 v[152:155], a[168:171], a[104:107], v[152:155]
  ds_read_b64_tr_b16 a[166:167], v3 offset:43008
  s_waitcnt lgkmcnt(10)
  v_mfma_f32_16x16x32_bf16 v[168:171], a[176:179], a[104:107], v[168:171]
  ds_read_b64_tr_b16 a[160:161], v3 offset:45056
  v_mfma_f32_16x16x32_bf16 v[168:171], a[180:183], a[120:123], v[168:171]
  ds_read_b64_tr_b16 a[162:163], v3 offset:47104
  v_mfma_f32_16x16x32_bf16 v[172:175], a[180:183], a[124:127], v[172:175]
  ds_read_b64_tr_b16 a[172:173], v4 offset:40960
  v_mfma_f32_16x16x32_bf16 v[172:175], a[176:179], a[108:111], v[172:175]
  ds_read_b64_tr_b16 a[174:175], v4 offset:43008
  s_waitcnt lgkmcnt(10)
  v_mfma_f32_16x16x32_bf16 v[188:191], v[20:23], a[108:111], v[188:191]
  ds_read_b64_tr_b16 a[168:169], v4 offset:45056
  v_mfma_f32_16x16x32_bf16 v[188:191], v[16:19], a[124:127], v[188:191]
  ds_read_b64_tr_b16 a[170:171], v4 offset:47104
  v_mfma_f32_16x16x32_bf16 v[184:187], v[16:19], a[120:123], v[184:187]
  ds_read_b64_tr_b16 a[180:181], v5 offset:40960
  v_mfma_f32_16x16x32_bf16 v[184:187], v[20:23], a[104:107], v[184:187]
  ds_read_b64_tr_b16 a[182:183], v5 offset:43008
  s_waitcnt lgkmcnt(10)
  v_mfma_f32_16x16x32_bf16 v[136:139], v[28:31], a[136:139], v[136:139]
  ds_read_b64_tr_b16 a[176:177], v5 offset:45056
  v_mfma_f32_16x16x32_bf16 v[136:139], v[24:27], a[152:155], v[136:139]
  ds_read_b64_tr_b16 a[178:179], v5 offset:47104
  v_mfma_f32_16x16x32_bf16 v[140:143], v[24:27], a[156:159], v[140:143]
  ds_read_b64_tr_b16 v[16:17], v2 offset:57344
  v_mfma_f32_16x16x32_bf16 v[140:143], v[28:31], a[140:143], v[140:143]
  ds_read_b64_tr_b16 v[18:19], v2 offset:59392
  s_waitcnt lgkmcnt(10)
  v_mfma_f32_16x16x32_bf16 v[156:159], a[164:167], a[140:143], v[156:159]
  ds_read_b64_tr_b16 v[20:21], v2 offset:61440
  v_mfma_f32_16x16x32_bf16 v[156:159], a[160:163], a[156:159], v[156:159]
  ds_read_b64_tr_b16 v[22:23], v2 offset:63488
  v_mfma_f32_16x16x32_bf16 v[152:155], a[160:163], a[152:155], v[152:155]
  ds_read_b64_tr_b16 v[24:25], v3 offset:57344
  v_mfma_f32_16x16x32_bf16 v[152:155], a[164:167], a[136:139], v[152:155]
  ds_read_b64_tr_b16 v[26:27], v3 offset:59392
  s_waitcnt lgkmcnt(10)
  v_mfma_f32_16x16x32_bf16 v[168:171], a[172:175], a[136:139], v[168:171]
  ds_read_b64_tr_b16 v[28:29], v3 offset:61440
  v_mfma_f32_16x16x32_bf16 v[168:171], a[168:171], a[152:155], v[168:171]
  ds_read_b64_tr_b16 v[30:31], v3 offset:63488
  v_mfma_f32_16x16x32_bf16 v[172:175], a[168:171], a[156:159], v[172:175]
  ds_read_b64_tr_b16 a[160:161], v4 offset:57344
  v_add_u32 v38, s46, v0
  s_waitcnt vmcnt(0)
  s_mov_b64 exec, 1
  buffer_store_dword v38, v0, s[8:11], s81 offen offset:0 sc1
  s_mov_b64 exec, -1
  v_mfma_f32_16x16x32_bf16 v[172:175], a[172:175], a[140:143], v[172:175]
  ds_read_b64_tr_b16 a[162:163], v4 offset:59392
  s_waitcnt lgkmcnt(10)
  v_mfma_f32_16x16x32_bf16 v[188:191], a[180:183], a[140:143], v[188:191]
  ds_read_b64_tr_b16 a[164:165], v4 offset:61440
  v_mfma_f32_16x16x32_bf16 v[188:191], a[176:179], a[156:159], v[188:191]
  ds_read_b64_tr_b16 a[166:167], v4 offset:63488
  v_mfma_f32_16x16x32_bf16 v[184:187], a[176:179], a[152:155], v[184:187]
  ds_read_b64_tr_b16 a[168:169], v5 offset:57344
  v_mfma_f32_16x16x32_bf16 v[184:187], a[180:183], a[136:139], v[184:187]
  ds_read_b64_tr_b16 a[170:171], v5 offset:59392
  s_waitcnt lgkmcnt(10)
  v_mfma_f32_16x16x32_bf16 v[136:139], v[16:19], a[8:11], v[136:139]
  ds_read_b64_tr_b16 a[172:173], v5 offset:61440
  v_mfma_f32_16x16x32_bf16 v[136:139], v[20:23], a[24:27], v[136:139]
  ds_read_b64_tr_b16 a[174:175], v5 offset:63488
  v_mfma_f32_16x16x32_bf16 v[140:143], v[20:23], a[28:31], v[140:143]
  ds_read_b64_tr_b16 a[176:177], v6 offset:8192
  v_mfma_f32_16x16x32_bf16 v[140:143], v[16:19], a[12:15], v[140:143]
  ds_read_b64_tr_b16 a[178:179], v6 offset:10240
  s_waitcnt lgkmcnt(10)
  v_mfma_f32_16x16x32_bf16 v[156:159], v[24:27], a[12:15], v[156:159]
  ds_read_b64_tr_b16 a[180:181], v6 offset:12288
  v_mfma_f32_16x16x32_bf16 v[156:159], v[28:31], a[28:31], v[156:159]
  ds_read_b64_tr_b16 a[182:183], v6 offset:14336
  v_mfma_f32_16x16x32_bf16 v[152:155], v[28:31], a[24:27], v[152:155]
  ds_read_b64_tr_b16 v[20:21], v7 offset:8192
  v_cvt_pk_bf16_f32 v136, v136, v137
  v_mfma_f32_16x16x32_bf16 v[152:155], v[24:27], a[8:11], v[152:155]
  ds_read_b64_tr_b16 v[22:23], v7 offset:10240
  s_waitcnt lgkmcnt(10)
  v_mfma_f32_16x16x32_bf16 v[168:171], a[160:163], a[8:11], v[168:171]
  ds_read_b64_tr_b16 v[16:17], v7 offset:12288
  v_cvt_pk_bf16_f32 v137, v138, v139
  v_mfma_f32_16x16x32_bf16 v[168:171], a[164:167], a[24:27], v[168:171]
  ds_read_b64_tr_b16 v[18:19], v7 offset:14336
  v_cvt_pk_bf16_f32 v140, v140, v141
  v_mfma_f32_16x16x32_bf16 v[172:175], a[164:167], a[28:31], v[172:175]
  ds_read_b64_tr_b16 v[28:29], v8 offset:8192
  v_cvt_pk_bf16_f32 v141, v142, v143
  v_mfma_f32_16x16x32_bf16 v[172:175], a[160:163], a[12:15], v[172:175]
  ds_read_b64_tr_b16 v[30:31], v8 offset:10240
  s_waitcnt lgkmcnt(10)
  v_mfma_f32_16x16x32_bf16 v[188:191], a[168:171], a[12:15], v[188:191]
  ds_read_b64_tr_b16 v[24:25], v8 offset:12288
  v_cvt_pk_bf16_f32 v138, v152, v153
  v_mfma_f32_16x16x32_bf16 v[188:191], a[172:175], a[28:31], v[188:191]
  ds_read_b64_tr_b16 v[26:27], v8 offset:14336
  v_cvt_pk_bf16_f32 v139, v154, v155
  v_mfma_f32_16x16x32_bf16 v[184:187], a[172:175], a[24:27], v[184:187]
  ds_read_b64_tr_b16 a[164:165], v9 offset:8192
  v_mfma_f32_16x16x32_bf16 v[184:187], a[168:171], a[8:11], v[184:187]
  ds_read_b64_tr_b16 a[166:167], v9 offset:10240
  s_waitcnt lgkmcnt(10)
  v_mfma_f32_16x16x32_bf16 v[128:131], a[176:179], a[220:223], v[128:131]
  ds_read_b64_tr_b16 a[160:161], v9 offset:12288
  v_mfma_f32_16x16x32_bf16 v[128:131], a[180:183], a[236:239], v[128:131]
  ds_read_b64_tr_b16 a[162:163], v9 offset:14336
  s_add_u32 s87, s86, 8192
  buffer_store_dwordx4 v[136:139], v1, s[8:11], s87 offen offset:0 sc1
  v_mfma_f32_16x16x32_bf16 v[132:135], a[180:183], a[240:243], v[132:135]
  ds_read_b64_tr_b16 a[172:173], v6 offset:57344
  v_mfma_f32_16x16x32_bf16 v[132:135], a[176:179], a[224:227], v[132:135]
  ds_read_b64_tr_b16 a[174:175], v6 offset:59392
  s_waitcnt lgkmcnt(10)
  v_mfma_f32_16x16x32_bf16 v[148:151], v[20:23], a[224:227], v[148:151]
  ds_read_b64_tr_b16 a[168:169], v6 offset:61440
  v_cvt_pk_bf16_f32 v142, v156, v157
  v_mfma_f32_16x16x32_bf16 v[148:151], v[16:19], a[240:243], v[148:151]
  ds_read_b64_tr_b16 a[170:171], v6 offset:63488
  v_cvt_pk_bf16_f32 v143, v158, v159
  v_mfma_f32_16x16x32_bf16 v[144:147], v[16:19], a[236:239], v[144:147]
  ds_read_b64_tr_b16 a[180:181], v7 offset:57344
  v_mfma_f32_16x16x32_bf16 v[144:147], v[20:23], a[220:223], v[144:147]
  ds_read_b64_tr_b16 a[182:183], v7 offset:59392
  s_waitcnt lgkmcnt(10)
  v_mfma_f32_16x16x32_bf16 v[160:163], v[28:31], a[220:223], v[160:163]
  ds_read_b64_tr_b16 a[176:177], v7 offset:61440
  v_mfma_f32_16x16x32_bf16 v[160:163], v[24:27], a[236:239], v[160:163]
  ds_read_b64_tr_b16 a[178:179], v7 offset:63488
  s_add_u32 s87, s86, 8192
  buffer_store_dwordx4 v[140:143], v1, s[8:11], s87 offen offset:2048 sc1
  v_mfma_f32_16x16x32_bf16 v[164:167], v[24:27], a[240:243], v[164:167]
HOP19:
  s_cbranch_execz WRET1
  ds_read_b64_tr_b16 v[16:17], v8 offset:57344
  v_mfma_f32_16x16x32_bf16 v[164:167], v[28:31], a[224:227], v[164:167]
  ds_read_b64_tr_b16 v[18:19], v8 offset:59392
  s_waitcnt lgkmcnt(10)
  v_mfma_f32_16x16x32_bf16 v[180:183], a[164:167], a[224:227], v[180:183]
  ds_read_b64_tr_b16 v[20:21], v8 offset:61440
  v_cvt_pk_bf16_f32 v168, v168, v169
  v_mfma_f32_16x16x32_bf16 v[180:183], a[160:163], a[240:243], v[180:183]
  ds_read_b64_tr_b16 v[22:23], v8 offset:63488
  v_cvt_pk_bf16_f32 v169, v170, v171
  v_mfma_f32_16x16x32_bf16 v[176:179], a[160:163], a[236:239], v[176:179]
  ds_read_b64_tr_b16 v[24:25], v9 offset:57344
  v_cvt_pk_bf16_f32 v172, v172, v173
  v_mfma_f32_16x16x32_bf16 v[176:179], a[164:167], a[220:223], v[176:179]
  ds_read_b64_tr_b16 v[26:27], v9 offset:59392
  s_waitcnt lgkmcnt(10)
  v_mfma_f32_16x16x32_bf16 v[128:131], a[172:175], a[32:35], v[128:131]
  ds_read_b64_tr_b16 v[28:29], v9 offset:61440
  v_cvt_pk_bf16_f32 v173, v174, v175
  v_mfma_f32_16x16x32_bf16 v[128:131], a[168:171], a[48:51], v[128:131]
  ds_read_b64_tr_b16 v[30:31], v9 offset:63488
  v_cvt_pk_bf16_f32 v170, v184, v185
  v_mfma_f32_16x16x32_bf16 v[132:135], a[168:171], a[52:55], v[132:135]
  ds_read_b64_tr_b16 a[160:161], v6 offset:40960
  v_cvt_pk_bf16_f32 v171, v186, v187
  v_mfma_f32_16x16x32_bf16 v[132:135], a[172:175], a[36:39], v[132:135]
  ds_read_b64_tr_b16 a[162:163], v6 offset:43008
  s_waitcnt lgkmcnt(10)
  v_mfma_f32_16x16x32_bf16 v[148:151], a[180:183], a[36:39], v[148:151]
  ds_read_b64_tr_b16 a[164:165], v6 offset:45056
  v_mfma_f32_16x16x32_bf16 v[148:151], a[176:179], a[52:55], v[148:151]
  ds_read_b64_tr_b16 a[166:167], v6 offset:47104
  s_add_u32 s87, s86, 8192
  buffer_store_dwordx4 v[168:171], v1, s[8:11], s87 offen offset:1024 sc1
  v_mfma_f32_16x16x32_bf16 v[144:147], a[176:179], a[48:51], v[144:147]
  ds_read_b64_tr_b16 a[168:169], v7 offset:40960
  v_mfma_f32_16x16x32_bf16 v[144:147], a[180:183], a[32:35], v[144:147]
  ds_read_b64_tr_b16 a[170:171], v7 offset:43008
  s_waitcnt lgkmcnt(10)
  v_mfma_f32_16x16x32_bf16 v[160:163], v[16:19], a[32:35], v[160:163]
  ds_read_b64_tr_b16 a[172:173], v7 offset:45056
  v_cvt_pk_bf16_f32 v174, v188, v189
  v_mfma_f32_16x16x32_bf16 v[160:163], v[20:23], a[48:51], v[160:163]
  ds_read_b64_tr_b16 a[174:175], v7 offset:47104
  v_cvt_pk_bf16_f32 v175, v190, v191
  v_mfma_f32_16x16x32_bf16 v[164:167], v[20:23], a[52:55], v[164:167]
  ds_read_b64_tr_b16 a[176:177], v8 offset:40960
  v_mfma_f32_16x16x32_bf16 v[164:167], v[16:19], a[36:39], v[164:167]
  ds_read_b64_tr_b16 a[178:179], v8 offset:43008
  s_waitcnt lgkmcnt(10)
  v_mfma_f32_16x16x32_bf16 v[180:183], v[24:27], a[36:39], v[180:183]
  ds_read_b64_tr_b16 a[180:181], v8 offset:45056
  v_mfma_f32_16x16x32_bf16 v[180:183], v[28:31], a[52:55], v[180:183]
  ds_read_b64_tr_b16 a[182:183], v8 offset:47104
  s_add_u32 s87, s86, 8192
  buffer_store_dwordx4 v[172:175], v1, s[8:11], s87 offen offset:3072 sc1
  v_mfma_f32_16x16x32_bf16 v[176:179], v[28:31], a[48:51], v[176:179]
  ds_read_b64_tr_b16 v[20:21], v9 offset:40960
  v_mfma_f32_16x16x32_bf16 v[176:179], v[24:27], a[32:35], v[176:179]
  ds_read_b64_tr_b16 v[22:23], v9 offset:43008
  s_waitcnt lgkmcnt(10)
  v_mfma_f32_16x16x32_bf16 v[128:131], a[160:163], a[64:67], v[128:131]
  ds_read_b64_tr_b16 v[16:17], v9 offset:45056
  v_mfma_f32_16x16x32_bf16 v[128:131], a[164:167], a[80:83], v[128:131]
  ds_read_b64_tr_b16 v[18:19], v9 offset:47104
  s_xor_b32 s82, s81, 1536
  s_add_u32 s82, s82, 0
  buffer_load_dword v36, v37, s[8:11], s82 offen sc1
  v_mfma_f32_16x16x32_bf16 v[132:135], a[164:167], a[84:87], v[132:135]
  ds_read_b64_tr_b16 v[28:29], v6 offset:24576
  v_mfma_f32_16x16x32_bf16 v[132:135], a[160:163], a[68:71], v[132:135]
  ds_read_b64_tr_b16 v[30:31], v6 offset:26624
  s_xor_b32 s91, s81, 512
  s_add_u32 s91, s91, 0
  buffer_load_dword v39, v37, s[8:11], s91 offen sc1
  s_waitcnt lgkmcnt(10)
  v_mfma_f32_16x16x32_bf16 v[148:151], a[168:171], a[68:71], v[148:151]
  ds_read_b64_tr_b16 v[24:25], v6 offset:28672
  v_mfma_f32_16x16x32_bf16 v[148:151], a[172:175], a[84:87], v[148:151]
  ds_read_b64_tr_b16 v[26:27], v6 offset:30720
  v_mfma_f32_16x16x32_bf16 v[144:147], a[172:175], a[80:83], v[144:147]
  ds_read_b64_tr_b16 a[164:165], v7 offset:24576
  v_mfma_f32_16x16x32_bf16 v[144:147], a[168:171], a[64:67], v[144:147]
  ds_read_b64_tr_b16 a[166:167], v7 offset:26624
  s_waitcnt lgkmcnt(10)
  v_mfma_f32_16x16x32_bf16 v[160:163], a[176:179], a[64:67], v[160:163]
  ds_read_b64_tr_b16 a[160:161], v7 offset:28672
  v_mfma_f32_16x16x32_bf16 v[160:163], a[180:183], a[80:83], v[160:163]
  ds_read_b64_tr_b16 a[162:163], v7 offset:30720
  v_mfma_f32_16x16x32_bf16 v[164:167], a[180:183], a[84:87], v[164:167]
  ds_read_b64_tr_b16 a[172:173], v8 offset:24576
  v_mfma_f32_16x16x32_bf16 v[164:167], a[176:179], a[68:71], v[164:167]
  ds_read_b64_tr_b16 a[174:175], v8 offset:26624
  s_waitcnt lgkmcnt(10)
  v_mfma_f32_16x16x32_bf16 v[180:183], v[20:23], a[68:71], v[180:183]
  ds_read_b64_tr_b16 a[168:169], v8 offset:28672
  v_mfma_f32_16x16x32_bf16 v[180:183], v[16:19], a[84:87], v[180:183]
  ds_read_b64_tr_b16 a[170:171], v8 offset:30720
  v_mfma_f32_16x16x32_bf16 v[176:179], v[16:19], a[80:83], v[176:179]
  ds_read_b64_tr_b16 a[180:181], v9 offset:24576
  v_mfma_f32_16x16x32_bf16 v[176:179], v[20:23], a[64:67], v[176:179]
  ds_read_b64_tr_b16 a[182:183], v9 offset:26624
  s_waitcnt lgkmcnt(10)
  v_mfma_f32_16x16x32_bf16 v[128:131], v[28:31], a[96:99], v[128:131]
  ds_read_b64_tr_b16 a[176:177], v9 offset:28672
  v_mfma_f32_16x16x32_bf16 v[128:131], v[24:27], a[112:115], v[128:131]
  ds_read_b64_tr_b16 a[178:179], v9 offset:30720
  v_add_u32 v38, s46, v0
  s_waitcnt vmcnt(2)
  s_mov_b64 exec, 1
  buffer_store_dword v38, v0, s[8:11], s81 offen offset:16 sc1
  s_mov_b64 exec, -1
  v_mfma_f32_16x16x32_bf16 v[132:135], v[24:27], a[116:119], v[132:135]
  ds_read_b64_tr_b16 v[16:17], v2 offset:40960
  v_mfma_f32_16x16x32_bf16 v[132:135], v[28:31], a[100:103], v[132:135]
  ds_read_b64_tr_b16 v[18:19], v2 offset:43008
  s_waitcnt lgkmcnt(10)
  v_mfma_f32_16x16x32_bf16 v[148:151], a[164:167], a[100:103], v[148:151]
  ds_read_b64_tr_b16 v[20:21], v2 offset:45056
  v_mfma_f32_16x16x32_bf16 v[148:151], a[160:163], a[116:119], v[148:151]
  ds_read_b64_tr_b16 v[22:23], v2 offset:47104
  v_mfma_f32_16x16x32_bf16 v[144:147], a[160:163], a[112:115], v[144:147]
  ds_read_b64_tr_b16 v[24:25], v3 offset:40960
  v_mfma_f32_16x16x32_bf16 v[144:147], a[164:167], a[96:99], v[144:147]
  ds_read_b64_tr_b16 v[26:27], v3 offset:43008
  s_waitcnt lgkmcnt(10)
  v_mfma_f32_16x16x32_bf16 v[160:163], a[172:175], a[96:99], v[160:163]
  ds_read_b64_tr_b16 v[28:29], v3 offset:45056
  v_mfma_f32_16x16x32_bf16 v[160:163], a[168:171], a[112:115], v[160:163]
  ds_read_b64_tr_b16 v[30:31], v3 offset:47104
  v_mfma_f32_16x16x32_bf16 v[164:167], a[168:171], a[116:119], v[164:167]
  ds_read_b64_tr_b16 a[160:161], v4 offset:40960
  v_mfma_f32_16x16x32_bf16 v[164:167], a[172:175], a[100:103], v[164:167]
  ds_read_b64_tr_b16 a[162:163], v4 offset:43008
  s_waitcnt lgkmcnt(10)
  v_mfma_f32_16x16x32_bf16 v[180:183], a[180:183], a[100:103], v[180:183]
  ds_read_b64_tr_b16 a[164:165], v4 offset:45056
  v_mfma_f32_16x16x32_bf16 v[180:183], a[176:179], a[116:119], v[180:183]
  ds_read_b64_tr_b16 a[166:167], v4 offset:47104
  v_mfma_f32_16x16x32_bf16 v[176:179], a[176:179], a[112:115], v[176:179]
  ds_read_b64_tr_b16 a[168:169], v5 offset:40960
  v_mfma_f32_16x16x32_bf16 v[176:179], a[180:183], a[96:99], v[176:179]
  ds_read_b64_tr_b16 a[170:171], v5 offset:43008
  s_waitcnt lgkmcnt(10)
  v_mfma_f32_16x16x32_bf16 v[128:131], v[16:19], a[128:131], v[128:131]
  ds_read_b64_tr_b16 a[172:173], v5 offset:45056
  v_mfma_f32_16x16x32_bf16 v[128:131], v[20:23], a[144:147], v[128:131]
  ds_read_b64_tr_b16 a[174:175], v5 offset:47104
  v_mfma_f32_16x16x32_bf16 v[132:135], v[20:23], a[148:151], v[132:135]
  ds_read_b64_tr_b16 a[176:177], v2 offset:57344
  v_mfma_f32_16x16x32_bf16 v[132:135], v[16:19], a[132:135], v[132:135]
  ds_read_b64_tr_b16 a[178:179], v2 offset:59392
  s_waitcnt lgkmcnt(10)
  v_mfma_f32_16x16x32_bf16 v[148:151], v[24:27], a[132:135], v[148:151]
  ds_read_b64_tr_b16 a[180:181], v2 offset:61440
  s_waitcnt vmcnt(2)
  v_cmp_ne_u32 vcc, s46, v36
  s_nop 4
  s_cbranch_vccz PL22_adaLN_cond__sliding_local_dilated__swiglu_ffn__prompt_kernelx
  s_mov_b32 s83, 60000
PL22_adaLN_cond__sliding_local_dilated__swiglu_ffn__prompt_kernel:
  buffer_load_dword v36, v37, s[8:11], s82 offen sc1
  s_sub_u32 s83, s83, 1
  s_cmp_eq_u32 s83, 0
  s_waitcnt vmcnt(0)
  s_cbranch_scc1 PL22_adaLN_cond__sliding_local_dilated__swiglu_ffn__prompt_kernelx
  v_cmp_ne_u32 vcc, s46, v36
  s_nop 4
  s_cbranch_vccnz PL22_adaLN_cond__sliding_local_dilated__swiglu_ffn__prompt_kernel
PL22_adaLN_cond__sliding_local_dilated__swiglu_ffn__prompt_kernelx:
  v_mfma_f32_16x16x32_bf16 v[148:151], v[28:31], a[148:151], v[148:151]
  ds_read_b64_tr_b16 a[182:183], v2 offset:63488
  s_xor_b32 s55, s86, 196608
  s_add_u32 s55, s55, 0
  buffer_load_dwordx4 v[88:91], v1, s[8:11], s55 offen offset:0 sc1
  v_mfma_f32_16x16x32_bf16 v[144:147], v[28:31], a[144:147], v[144:147]
  ds_read_b64_tr_b16 v[20:21], v3 offset:57344
  s_waitcnt vmcnt(2)
  v_cmp_ne_u32 vcc, s46, v39
  s_nop 4
  s_cbranch_vccz PL23_adaLN_cond__sliding_local_dilated__swiglu_ffn__prompt_kernelx
  s_mov_b32 s83, 60000
PL23_adaLN_cond__sliding_local_dilated__swiglu_ffn__prompt_kernel:
  buffer_load_dword v39, v37, s[8:11], s91 offen sc1
  s_sub_u32 s83, s83, 1
  s_cmp_eq_u32 s83, 0
  s_waitcnt vmcnt(0)
  s_cbranch_scc1 PL23_adaLN_cond__sliding_local_dilated__swiglu_ffn__prompt_kernelx
  v_cmp_ne_u32 vcc, s46, v39
  s_nop 4
  s_cbranch_vccnz PL23_adaLN_cond__sliding_local_dilated__swiglu_ffn__prompt_kernel
PL23_adaLN_cond__sliding_local_dilated__swiglu_ffn__prompt_kernelx:
  v_mfma_f32_16x16x32_bf16 v[144:147], v[24:27], a[128:131], v[144:147]
  ds_read_b64_tr_b16 v[22:23], v3 offset:59392
  s_xor_b32 s55, s86, 65536
  s_add_u32 s55, s55, 4096
  buffer_load_dwordx4 v[80:83], v1, s[8:11], s55 offen offset:0 sc1
  s_waitcnt lgkmcnt(10)
  v_mfma_f32_16x16x32_bf16 v[160:163], a[160:163], a[128:131], v[160:163]
  ds_read_b64_tr_b16 v[16:17], v3 offset:61440
  v_mfma_f32_16x16x32_bf16 v[160:163], a[164:167], a[144:147], v[160:163]
  ds_read_b64_tr_b16 v[18:19], v3 offset:63488
  s_xor_b32 s55, s86, 196608
  s_add_u32 s55, s55, 0
  buffer_load_dwordx4 v[120:123], v1, s[8:11], s55 offen offset:1024 sc1
  v_mfma_f32_16x16x32_bf16 v[164:167], a[164:167], a[148:151], v[164:167]
  ds_read_b64_tr_b16 v[28:29], v4 offset:57344
  v_mfma_f32_16x16x32_bf16 v[164:167], a[160:163], a[132:135], v[164:167]
  ds_read_b64_tr_b16 v[30:31], v4 offset:59392
  s_xor_b32 s55, s86, 65536
  s_add_u32 s55, s55, 4096
  buffer_load_dwordx4 v[112:115], v1, s[8:11], s55 offen offset:1024 sc1
  s_waitcnt lgkmcnt(10)
  v_mfma_f32_16x16x32_bf16 v[180:183], a[168:171], a[132:135], v[180:183]
  ds_read_b64_tr_b16 v[24:25], v4 offset:61440
  v_mfma_f32_16x16x32_bf16 v[180:183], a[172:175], a[148:151], v[180:183]
  ds_read_b64_tr_b16 v[26:27], v4 offset:63488
  s_xor_b32 s55, s86, 196608
  s_add_u32 s55, s55, 0
  buffer_load_dwordx4 v[92:95], v1, s[8:11], s55 offen offset:2048 sc1
  v_mfma_f32_16x16x32_bf16 v[176:179], a[172:175], a[144:147], v[176:179]
  ds_read_b64_tr_b16 a[164:165], v5 offset:57344
  v_mfma_f32_16x16x32_bf16 v[176:179], a[168:171], a[128:131], v[176:179]
  ds_read_b64_tr_b16 a[166:167], v5 offset:59392
  s_xor_b32 s55, s86, 65536
  s_add_u32 s55, s55, 4096
  buffer_load_dwordx4 v[84:87], v1, s[8:11], s55 offen offset:2048 sc1
  s_waitcnt lgkmcnt(10)
  v_mfma_f32_16x16x32_bf16 v[128:131], a[176:179], a[0:3], v[128:131]
  ds_read_b64_tr_b16 a[160:161], v5 offset:61440
  v_mfma_f32_16x16x32_bf16 v[128:131], a[180:183], a[16:19], v[128:131]
  ds_read_b64_tr_b16 a[162:163], v5 offset:63488
  s_xor_b32 s55, s86, 196608
  s_add_u32 s55, s55, 0
  buffer_load_dwordx4 v[124:127], v1, s[8:11], s55 offen offset:3072 sc1
  v_mfma_f32_16x16x32_bf16 v[132:135], a[180:183], a[20:23], v[132:135]
  v_mfma_f32_16x16x32_bf16 v[132:135], a[176:179], a[4:7], v[132:135]
  s_xor_b32 s55, s86, 65536
  s_add_u32 s55, s55, 4096
  buffer_load_dwordx4 v[116:119], v1, s[8:11], s55 offen offset:3072 sc1
  s_waitcnt lgkmcnt(8)
  v_mfma_f32_16x16x32_bf16 v[148:151], v[20:23], a[4:7], v[148:151]
  v_mfma_f32_16x16x32_bf16 v[148:151], v[16:19], a[20:23], v[148:151]
  v_mfma_f32_16x16x32_bf16 v[144:147], v[16:19], a[16:19], v[144:147]
  v_mfma_f32_16x16x32_bf16 v[144:147], v[20:23], a[0:3], v[144:147]
  s_waitcnt lgkmcnt(4)
  v_mfma_f32_16x16x32_bf16 v[160:163], v[28:31], a[0:3], v[160:163]
  v_mfma_f32_16x16x32_bf16 v[160:163], v[24:27], a[16:19], v[160:163]
  s_xor_b32 s82, s81, 1024
  s_add_u32 s82, s82, 16
  buffer_load_dword v36, v37, s[8:11], s82 offen sc1
  v_mfma_f32_16x16x32_bf16 v[164:167], v[24:27], a[20:23], v[164:167]
  v_mfma_f32_16x16x32_bf16 v[164:167], v[28:31], a[4:7], v[164:167]
  s_waitcnt lgkmcnt(0)
  v_mfma_f32_16x16x32_bf16 v[180:183], a[164:167], a[4:7], v[180:183]
  v_mfma_f32_16x16x32_bf16 v[180:183], a[160:163], a[20:23], v[180:183]
  v_mfma_f32_16x16x32_bf16 v[176:179], a[160:163], a[16:19], v[176:179]
  v_mfma_f32_16x16x32_bf16 v[176:179], a[164:167], a[0:3], v[176:179]
  s_waitcnt vmcnt(0)
  v_cmp_ne_u32 vcc, s46, v36
  s_nop 4
  s_cbranch_vccz PL24_adaLN_cond__sliding_local_dilated__swiglu_ffn__prompt_kernelx
  s_mov_b32 s83, 60000
PL24_adaLN_cond__sliding_local_dilated__swiglu_ffn__prompt_kernel:
  buffer_load_dword v36, v37, s[8:11], s82 offen sc1
  s_sub_u32 s83, s83, 1
  s_cmp_eq_u32 s83, 0
  s_waitcnt vmcnt(0)
  s_cbranch_scc1 PL24_adaLN_cond__sliding_local_dilated__swiglu_ffn__prompt_kernelx
  v_cmp_ne_u32 vcc, s46, v36
  s_nop 4
  s_cbranch_vccnz PL24_adaLN_cond__sliding_local_dilated__swiglu_ffn__prompt_kernel
PL24_adaLN_cond__sliding_local_dilated__swiglu_ffn__prompt_kernelx:
  s_xor_b32 s55, s86, 131072
  s_add_u32 s55, s55, 8192
  buffer_load_dwordx4 v[152:155], v1, s[8:11], s55 offen offset:0 sc1
  s_xor_b32 s55, s86, 131072
  s_add_u32 s55, s55, 8192
  buffer_load_dwordx4 v[184:187], v1, s[8:11], s55 offen offset:1024 sc1
  s_xor_b32 s55, s86, 131072
  s_add_u32 s55, s55, 8192
  buffer_load_dwordx4 v[156:159], v1, s[8:11], s55 offen offset:2048 sc1
  s_xor_b32 s55, s86, 131072
  s_add_u32 s55, s55, 8192
  buffer_load_dwordx4 v[188:191], v1, s[8:11], s55 offen offset:3072 sc1
  s_waitcnt vmcnt(5)
  v_mfma_f32_16x16x32_bf16 v[128:131], v[58:61], v[88:91], v[128:131]
  v_mfma_f32_16x16x32_bf16 v[144:147], v[56:59], v[88:91], v[144:147]
  v_mfma_f32_16x16x32_bf16 v[160:163], v[58:61], v[120:123], v[160:163]
  v_mfma_f32_16x16x32_bf16 v[176:179], v[56:59], v[120:123], v[176:179]
  v_mfma_f32_16x16x32_bf16 v[132:135], v[58:61], v[92:95], v[132:135]
  v_mfma_f32_16x16x32_bf16 v[148:151], v[56:59], v[92:95], v[148:151]
  v_mfma_f32_16x16x32_bf16 v[164:167], v[58:61], v[124:127], v[164:167]
  v_mfma_f32_16x16x32_bf16 v[180:183], v[56:59], v[124:127], v[180:183]
  v_mfma_f32_16x16x32_bf16 v[128:131], v[58:61], v[80:83], v[128:131]
  v_mfma_f32_16x16x32_bf16 v[144:147], v[56:59], v[80:83], v[144:147]
  v_mfma_f32_16x16x32_bf16 v[160:163], v[58:61], v[112:115], v[160:163]
  v_mfma_f32_16x16x32_bf16 v[176:179], v[56:59], v[112:115], v[176:179]
  v_mfma_f32_16x16x32_bf16 v[132:135], v[58:61], v[84:87], v[132:135]
  v_mfma_f32_16x16x32_bf16 v[148:151], v[56:59], v[84:87], v[148:151]
  v_mfma_f32_16x16x32_bf16 v[164:167], v[58:61], v[116:119], v[164:167]
  v_mfma_f32_16x16x32_bf16 v[180:183], v[56:59], v[116:119], v[180:183]
  s_waitcnt vmcnt(3)
  v_mfma_f32_16x16x32_bf16 v[128:131], v[58:61], v[152:155], v[128:131]
  v_mfma_f32_16x16x32_bf16 v[144:147], v[56:59], v[152:155], v[144:147]
  s_waitcnt vmcnt(2)
  v_mfma_f32_16x16x32_bf16 v[160:163], v[58:61], v[184:187], v[160:163]
  v_mfma_f32_16x16x32_bf16 v[176:179], v[56:59], v[184:187], v[176:179]
  s_waitcnt vmcnt(1)
  v_mfma_f32_16x16x32_bf16 v[132:135], v[58:61], v[156:159], v[132:135]
  v_mfma_f32_16x16x32_bf16 v[148:151], v[56:59], v[156:159], v[148:151]
  s_waitcnt vmcnt(0)
  v_mfma_f32_16x16x32_bf16 v[164:167], v[58:61], v[188:191], v[164:167]
  v_mfma_f32_16x16x32_bf16 v[180:183], v[56:59], v[188:191], v[180:183]
  v_fmac_f32 v208, v240, v128
  v_fmac_f32 v209, v241, v129
  v_fmac_f32 v210, v242, v130
  v_fmac_f32 v211, v243, v131
  v_fmac_f32 v212, v244, v144
  v_fmac_f32 v213, v245, v145
  v_fmac_f32 v214, v246, v146
  v_fmac_f32 v215, v247, v147
  v_cvt_pk_bf16_f32 v192, v208, v209
  v_cvt_pk_bf16_f32 v193, v210, v211
  v_cvt_pk_bf16_f32 v194, v212, v213
  v_cvt_pk_bf16_f32 v195, v214, v215
  s_nop 0
  v_permlane16_swap_b32 v192, v194
  v_permlane16_swap_b32 v193, v195
  ds_write_b128 v42, v[192:195] offset:0
  v_fmac_f32 v216, v248, v160
  v_fmac_f32 v217, v249, v161
  v_fmac_f32 v218, v250, v162
  v_fmac_f32 v219, v251, v163
  v_fmac_f32 v220, v252, v176
  v_fmac_f32 v221, v253, v177
  v_fmac_f32 v222, v254, v178
  v_fmac_f32 v223, v255, v179
  v_cvt_pk_bf16_f32 v196, v216, v217
  v_cvt_pk_bf16_f32 v197, v218, v219
  v_cvt_pk_bf16_f32 v198, v220, v221
  v_cvt_pk_bf16_f32 v199, v222, v223
  s_nop 0
  v_permlane16_swap_b32 v196, v198
  v_permlane16_swap_b32 v197, v199
  ds_write_b128 v43, v[196:199] offset:0
  ds_read_b128 v[208:211], v44 offset:0
  ds_read_b128 v[212:215], v44 offset:1024
  v_fmac_f32 v224, v240, v132
  v_fmac_f32 v225, v241, v133
  v_fmac_f32 v226, v242, v134
  v_fmac_f32 v227, v243, v135
  v_fmac_f32 v228, v244, v148
  v_fmac_f32 v229, v245, v149
  v_fmac_f32 v230, v246, v150
  v_fmac_f32 v231, v247, v151
  v_cvt_pk_bf16_f32 v200, v224, v225
  v_cvt_pk_bf16_f32 v201, v226, v227
  v_cvt_pk_bf16_f32 v202, v228, v229
  v_cvt_pk_bf16_f32 v203, v230, v231
  s_nop 0
  v_permlane16_swap_b32 v200, v202
  v_permlane16_swap_b32 v201, v203
  ds_write_b128 v42, v[200:203] offset:2048
  v_fmac_f32 v232, v248, v164
  v_fmac_f32 v233, v249, v165
  v_fmac_f32 v234, v250, v166
  v_fmac_f32 v235, v251, v167
  v_fmac_f32 v236, v252, v180
  v_fmac_f32 v237, v253, v181
  v_fmac_f32 v238, v254, v182
  v_fmac_f32 v239, v255, v183
  v_cvt_pk_bf16_f32 v204, v232, v233
  v_cvt_pk_bf16_f32 v205, v234, v235
  v_cvt_pk_bf16_f32 v206, v236, v237
  v_cvt_pk_bf16_f32 v207, v238, v239
  s_nop 0
  v_permlane16_swap_b32 v204, v206
  v_permlane16_swap_b32 v205, v207
  ds_write_b128 v43, v[204:207] offset:2048
  ds_read_b128 v[224:227], v44 offset:2048
  ds_read_b128 v[228:231], v44 offset:3072
  s_waitcnt lgkmcnt(5)
  buffer_store_dwordx4 v[208:211], v40, s[40:43], s85 offen
  s_add_u32 s85, s85, 16384
  s_waitcnt lgkmcnt(4)
  buffer_store_dwordx4 v[212:215], v40, s[40:43], s85 offen
  s_add_u32 s85, s85, 16384
  s_waitcnt lgkmcnt(1)
  buffer_store_dwordx4 v[224:227], v40, s[40:43], s85 offen
  s_add_u32 s85, s85, 16384
  s_waitcnt lgkmcnt(0)
  buffer_store_dwordx4 v[228:231], v40, s[40:43], s85 offen
E_adaLN_cond__sliding_local_dilated__swiglu_ffn__prompt_kernel:
X_adaLN_cond__sliding_local_dilated__swiglu_ffn__prompt_kernel:
  s_endpgm
code_end:
.fill 2048, 4, 0xBF800000
.section .rodata,"a"
.p2align 6
.amdhsa_kernel adaLN_cond__sliding_local_dilated__swiglu_ffn__prompt_kernel
  .amdhsa_next_free_vgpr 512
  .amdhsa_next_free_sgpr 102
  .amdhsa_accum_offset 256
  .amdhsa_group_segment_fixed_size 0
  .amdhsa_kernarg_size 96
  .amdhsa_user_sgpr_count 2
  .amdhsa_user_sgpr_kernarg_segment_ptr 1
  .amdhsa_system_sgpr_workgroup_id_x 1
  .amdhsa_float_denorm_mode_32 3
.end_amdhsa_kernel
```

```asm
; @launch grid=(256,1,1) block=(256,1,1) lds=163840
.amdgcn_target "amdgcn-amd-amdhsa--gfx950"
.text
.globl adaLN_cond__sliding_local_dilated__swiglu_ffn__prompt_kernel
.type adaLN_cond__sliding_local_dilated__swiglu_ffn__prompt_kernel,@function
.p2align 8
adaLN_cond__sliding_local_dilated__swiglu_ffn__prompt_kernel:
  s_cmp_ge_u32 s2, 256
  s_cbranch_scc1 X_adaLN_cond__sliding_local_dilated__swiglu_ffn__prompt_kernel
  s_load_dwordx2 s[4:5], s[0:1], 0
  s_load_dwordx2 s[8:9], s[0:1], 88
  s_load_dwordx2 s[12:13], s[0:1], 8
  s_load_dwordx2 s[16:17], s[0:1], 16
  s_load_dwordx2 s[20:21], s[0:1], 64
  s_load_dwordx2 s[24:25], s[0:1], 56
  s_load_dwordx2 s[28:29], s[0:1], 32
  s_load_dwordx2 s[32:33], s[0:1], 40
  s_load_dwordx2 s[36:37], s[0:1], 48
  s_load_dwordx2 s[40:41], s[0:1], 72
  v_lshrrev_b32 v21, 6, v0
  v_and_b32 v0, 63, v0
  v_readfirstlane_b32 s44, v21
  v_lshrrev_b32 v22, 3, v0
  v_bfe_u32 v11, v22, 1, 2
  v_bfe_u32 v23, v0, 1, 2
  v_xor_b32 v11, v11, v23
  v_lshlrev_b32 v11, 5, v11
  v_and_b32 v23, 1, v0
  v_lshl_add_u32 v11, v23, 4, v11
  s_lshl_b32 s45, s44, 10
  s_lshl_b32 s52, s44, 3
  v_add_u32 v10, s52, v22
  s_and_b32 s52, s2, 7
  s_lshl_b32 s52, s52, 7
  v_add_u32 v35, s52, v10
  v_mul_u32_u24 v35, 12288, v35
  s_lshr_b32 s53, s2, 3
  s_lshl_b32 s53, s53, 7
  v_add3_u32 v35, v35, v11, s53
  s_and_b32 s53, s44, 1
  s_lshl_b32 s53, s53, 6
  s_add_u32 s52, s52, s53
  v_add_lshl_u32 v16, s52, v0, 1
  s_and_b32 s52, s2, 7
  s_lshr_b32 s53, s2, 3
  s_and_b32 s51, s52, 3
  s_lshl_b32 s51, s51, 2
  s_and_b32 s50, s53, 3
  s_add_u32 s51, s51, s50
  s_lshr_b32 s50, s52, 2
  s_lshl_b32 s50, s50, 3
  s_lshr_b32 s53, s53, 2
  s_add_u32 s50, s50, s53
  s_lshl_b32 s54, s50, 4
  s_add_u32 s54, s54, s51
  v_and_b32 v21, 7, v0
  v_lshlrev_b32 v28, 11, v21
  v_lshl_add_u32 v28, v22, 4, v28
  v_mov_b32 v29, 851968
  s_lshr_b32 s38, s54, 1
  s_lshl_b32 s38, s38, 15
  s_and_b32 s53, s54, 1
  s_lshl_b32 s53, s53, 2
  s_add_u32 s53, s53, s44
  s_lshl_b32 s52, s53, 8
  s_add_u32 s30, s38, s52
  s_mov_b32 s6, 4194304
  s_mov_b32 s7, 0x20000
  s_mov_b32 s10, 134217728
  s_mov_b32 s11, 0x20000
  s_mov_b32 s14, 6291456
  s_mov_b32 s15, 0x20000
  s_mov_b32 s18, 2097152
  s_mov_b32 s19, 0x20000
  s_mov_b32 s22, 12582912
  s_mov_b32 s23, 0x20000
  s_mov_b32 s26, 2048
  s_mov_b32 s27, 0x20000
  s_waitcnt lgkmcnt(0)
  buffer_load_ushort v15, v16, s[24:27], 0 offen
  s_add_u32 m0, s45, 131072
  s_mov_b32 s68, 0
  buffer_load_dwordx4 v35, s[20:23], s68 offen nt lds
  s_add_u32 m0, s45, 135168
  s_add_u32 s68, s68, 393216
  buffer_load_dwordx4 v35, s[20:23], s68 offen nt lds
  s_add_u32 m0, s45, 139264
  s_add_u32 s68, s68, 393216
  buffer_load_dwordx4 v35, s[20:23], s68 offen nt lds
  s_add_u32 m0, s45, 143360
  s_add_u32 s68, s68, 393216
  buffer_load_dwordx4 v35, s[20:23], s68 offen nt lds
  buffer_load_dword v36, v29, s[8:11], 0 offen sc1
  s_and_b32 s52, s2, 3
  s_lshl_b32 s52, s52, 2
  s_add_u32 s52, s52, s44
  s_lshl_b32 s52, s52, 7
  v_lshlrev_b32 v23, 1, v0
  buffer_load_ushort v23, v23, s[24:27], s52 offen
  s_add_u32 s52, s30, 0
  buffer_load_dwordx4 v[44:47], v28, s[4:7], s52 offen offset:0 nt
  buffer_load_dwordx4 v[48:51], v28, s[4:7], s52 offen offset:128 nt
  s_add_u32 s52, s30, 16384
  buffer_load_dwordx4 v[52:55], v28, s[4:7], s52 offen offset:0 nt
  buffer_load_dwordx4 v[56:59], v28, s[4:7], s52 offen offset:128 nt
  s_branch BODY0
.p2align 12
BODY0:
  v_lshlrev_b32 v1, 4, v0
  v_add_u32 v2, 65536, v1
  v_add_u32 v13, 131072, v1
  s_lshl_b32 s66, s51, 1
  s_add_u32 s66, s66, s50
  v_mul_u32_u24 v9, 6144, v10
  s_lshl_b32 s52, s51, 7
  v_add3_u32 v9, v9, v11, s52
  s_lshl_b32 s52, s53, 12
  s_add_u32 s38, s38, s52
  s_add_u32 s39, s38, 41943040
  s_add_u32 s38, s38, 1048576
  s_lshl_b32 s34, s53, 9
  s_add_u32 s34, s34, 131072
  s_lshl_b32 s35, s53, 11
  s_add_u32 s35, s35, 819200
  s_lshr_b32 s83, s2, 3
  s_lshl_b32 s83, s83, 2
  s_add_u32 s83, s83, s44
  s_lshl_b32 s83, s83, 10
  s_getpc_b64 s[80:81]
CT1_adaLN_cond__sliding_local_dilated__swiglu_ffn__prompt_kernel:
  s_min_u32 s82, s83, code_end-CT1_adaLN_cond__sliding_local_dilated__swiglu_ffn__prompt_kernel
  s_add_u32 s80, s80, s82
  s_addc_u32 s81, s81, 0
  v_and_b32 v24, 0x70, v1
  v_lshlrev_b32 v24, 3, v24
  global_load_dword a253, v24, s[80:81]
  v_lshrrev_b32 v41, 2, v0
  v_bfe_u32 v40, v41, 1, 2
  v_lshlrev_b32 v40, 5, v40
  v_lshl_add_u32 v40, v41, 7, v40
  v_and_b32 v41, 3, v0
  v_lshl_add_u32 v40, v41, 3, v40
  s_lshl_b32 s52, s44, 5
  v_xor_b32 v3, s52, v40
  s_and_b32 s52, s52, 64
  s_and_b32 s53, s44, 1
  s_lshl_b32 s53, s53, 14
  s_add_u32 s52, s52, s53
  v_xor_b32 v4, s52, v40
  v_xor_b32 v5, 32, v4
  v_add_u32 v6, 65536, v3
  v_add_u32 v7, 65536, v4
  v_add_u32 v8, 65536, v5
  v_add_u32 v35, 131072, v3
  v_lshrrev_b32 v30, 5, v0
  v_lshlrev_b32 v30, 6, v30
  v_bfe_u32 v40, v0, 2, 2
  v_lshl_add_u32 v30, v40, 4, v30
  v_bfe_u32 v40, v0, 4, 1
  v_lshl_add_u32 v30, v40, 3, v30
  v_lshl_add_u32 v30, v41, 1, v30
  s_lshl_b32 s52, s44, 7
  s_add_u32 s52, s52, 149504
  v_add_u32 v30, s52, v30
  v_lshrrev_b32 v32, 4, v0
  v_lshlrev_b32 v32, 4, v32
  v_add_u32 v31, 149504, v32
  v_and_b32 v40, 15, v0
  v_lshl_add_u32 v32, v40, 27, v32
  s_and_b32 s52, s2, 7
  s_lshl_b32 s52, s52, 13
  s_lshr_b32 s53, s2, 3
  s_lshl_b32 s53, s53, 8
  s_add_u32 s52, s52, s53
  s_lshl_b32 s53, s44, 6
  s_add_u32 s52, s52, s53
  s_add_u32 s42, s52, 131072
  s_lshl_b32 s53, s44, 28
  s_lshl_b32 s31, s2, 7
  s_add_u32 s31, s31, s53
  s_add_u32 s31, s31, 819200
  s_lshl_b32 s74, s54, 7
  s_add_u32 s74, s74, s53
  s_add_u32 s75, s74, 786432
  s_add_u32 s74, s74, 655360
  s_lshl_b32 s52, s50, 18
  s_add_u32 s52, s52, 1015808
  s_max_u32 s72, s52, 1048576
  s_lshr_b32 s53, s44, 1
  s_lshl_b32 s70, s53, 15
  s_add_u32 s52, s52, s70
  v_add_u32 v12, s52, v1
  s_lshl_b32 s53, s53, 11
  s_add_u32 s72, s72, s53
  s_lshl_b32 s70, s44, 12
  s_and_b32 s52, s70, 4096
  s_add_u32 s71, s52, s53
  s_and_b32 s52, s44, 1
  s_add_u32 s52, s52, s66
  s_add_u32 s58, s52, 0
  s_and_b32 s58, s58, 7
  s_lshl_b32 s58, s58, 12
  s_add_u32 s59, s52, 2
  s_and_b32 s59, s59, 7
  s_lshl_b32 s59, s59, 12
  s_add_u32 s60, s52, 4
  s_and_b32 s60, s60, 7
  s_lshl_b32 s60, s60, 12
  s_add_u32 s61, s52, 6
  s_and_b32 s61, s61, 7
  s_lshl_b32 s61, s61, 12
  s_lshl_b32 s52, s50, 4
  s_sub_u32 s52, s52, 2
  v_min_u32 v14, 17, v0
  v_add_u32 v14, s52, v14
  v_max_i32 v14, 0, v14
  v_lshlrev_b32 v14, 7, v14
  v_add_u32 v14, 786432, v14
  s_and_b32 s52, s2, 3
  s_lshl_b32 s52, s52, 8
  v_add_u32 v40, s52, v10
  v_mul_u32_u24 v40, 12288, v40
  s_lshr_b32 s53, s2, 2
  s_add_u32 s53, s53, 32
  s_lshl_b32 s53, s53, 7
  v_lshl_add_u32 v10, v10, 11, v11
  v_add3_u32 v11, v40, v11, s53
  s_and_b32 s52, s44, 1
  s_lshl_b32 s53, s50, 3
  s_add_u32 s53, s53, s52
  s_lshl_b32 s73, s53, 15
  s_lshl_b32 s53, s51, 1
  s_lshr_b32 s57, s44, 1
  s_add_u32 s53, s53, s57
  s_lshl_b32 s53, s53, 10
  s_add_u32 s73, s73, s53
  s_add_u32 s73, s73, 7340032
  s_mul_i32 s57, s57, 3072
  s_add_u32 s57, s57, 131072
  v_add_u32 v19, s57, v1
  s_lshl_b32 s53, s52, 3
  v_add_u32 v18, s53, v19
  s_lshl_b32 s53, s52, 10
  v_add_u32 v17, s53, v19
  v_lshrrev_b32 v40, 2, v0
  v_and_b32 v20, 3, v0
  v_lshl_add_u32 v40, v20, 4, v40
  v_lshl_add_u32 v20, v40, 4, s57
  s_mov_b32 s80, 0xfff0ffff
  s_mov_b32 s81, 0xf000ff00
  s_mov_b32 s82, 0xffe0fffe
  s_mov_b32 s83, 0xe000fe00
  s_mov_b32 s84, 0xffc0fffc
  s_mov_b32 s85, 0xc000fc00
  s_mov_b32 s86, 0xff80fff8
  s_mov_b32 s87, 0x8000f800
  s_mov_b32 s88, 0xaaaaaaaa
  s_mov_b32 s89, 0xaaaaaaaa
  s_mov_b32 s90, 0x000f0000
  s_mov_b32 s91, 0x0fff00ff
  s_mov_b32 s92, 0x003f0003
  s_mov_b32 s93, 0x3fff03ff
  v_mov_b32 v41, 0xffff
  v_mov_b32 v24, 0xffff0000
  v_cndmask_b32 v41, v41, v24, s[88:89]
  v_cndmask_b32 v24, 0, v41, s[90:91]
  v_cndmask_b32 v25, 0, v41, s[92:93]
  v_xor_b32 v26, v24, v41
  v_xor_b32 v27, v25, v41
  s_or_b32 s52, s52, s50
  s_cmp_eq_u32 s52, 0
  s_cselect_b64 s[90:91], s[90:91], 0
  s_cselect_b64 s[92:93], s[92:93], 0
  s_bfe_u32 s53, s2, 0x30003
  s_lshl_b32 s43, s53, 1
  s_and_b32 s52, s2, 1
  s_add_u32 s43, s43, s52
  s_and_b32 s79, s2, 4
  s_lshr_b32 s52, s2, 6
  s_add_u32 s79, s79, s52
  s_lshl_b32 s79, s79, 1
  s_add_u32 s67, s79, s53
  s_bfe_u32 s52, s2, 0x10001
  s_add_u32 s79, s79, s52
  s_and_b32 s52, s44, 1
  s_add_u32 s52, s52, s67
  s_add_u32 s62, s52, 0
  s_and_b32 s62, s62, 7
  s_lshl_b32 s62, s62, 12
  s_add_u32 s63, s52, 2
  s_and_b32 s63, s63, 7
  s_lshl_b32 s63, s63, 12
  s_add_u32 s64, s52, 4
  s_and_b32 s64, s64, 7
  s_lshl_b32 s64, s64, 12
  s_add_u32 s65, s52, 6
  s_and_b32 s65, s65, 7
  s_lshl_b32 s65, s65, 12
  s_lshl_b32 s52, s43, 7
  v_add_u32 v10, s52, v10
  s_lshl_b32 s52, s79, 18
  s_lshr_b32 s53, s44, 1
  s_lshl_b32 s53, s53, 15
  s_add_u32 s53, s52, s53
  s_add_u32 s78, s53, 7340032
  s_and_b32 s53, s44, 1
  s_lshl_b32 s53, s53, 15
  s_add_u32 s52, s52, s53
  s_lshl_b32 s53, s43, 1
  s_lshr_b32 s57, s44, 1
  s_add_u32 s53, s53, s57
  s_lshl_b32 s76, s53, 7
  s_lshl_b32 s53, s53, 10
  s_add_u32 s47, s52, s53
  s_lshr_b32 s53, s53, 1
  s_lshl_b32 s52, s79, 1
  s_and_b32 s57, s44, 1
  s_add_u32 s52, s52, s57
  s_lshl_b32 s52, s52, 14
  s_add_u32 s52, s52, s53
  s_add_u32 s48, s52, 6291456
  s_lshl_b32 s52, s79, 11
  s_lshl_b32 s53, s43, 7
  s_add_u32 s53, s53, s52
  s_lshl_b32 s57, s44, 28
  s_add_u32 s53, s53, s57
  s_add_u32 s49, s53, 753664
  s_add_u32 s77, s52, 655360
  s_waitcnt vmcnt(11)
  v_lshlrev_b32 v15, 16, v15
  v_mul_f32 v16, 0xbfb8aa3b, v15
  v_exp_f32 v16, v16
  s_nop 0
  v_add_f32 v16, 1.0, v16
  v_rcp_f32 v16, v16
  s_nop 0
  v_mul_f32 v15, v15, v16
  v_cvt_pk_bf16_f32 v15, v15, v15
  ds_write_b16 v30, v15
  s_waitcnt vmcnt(7) lgkmcnt(0)
  s_barrier
  ds_read_b64_tr_b16 v[60:61], v35 offset:0
  ds_read_b64_tr_b16 v[62:63], v35 offset:2048
  ds_read_b128 v[76:79], v31 offset:0
  ds_read_b64_tr_b16 v[64:65], v35 offset:4096
  ds_read_b64_tr_b16 v[66:67], v35 offset:6144
  ds_read_b128 v[80:83], v31 offset:64
  ds_read_b64_tr_b16 v[68:69], v35 offset:8192
  ds_read_b64_tr_b16 v[70:71], v35 offset:10240
  ds_read_b128 v[84:87], v31 offset:128
  ds_read_b64_tr_b16 v[72:73], v35 offset:12288
  ds_read_b64_tr_b16 v[74:75], v35 offset:14336
  ds_read_b128 v[88:91], v31 offset:192
  s_waitcnt vmcnt(6)
  v_readfirstlane_b32 s46, v36
  s_nop 0
  s_add_u32 s46, s46, 8
  s_waitcnt lgkmcnt(9)
  v_mfma_f32_16x16x32_bf16 v[40:43], v[60:63], v[76:79], 0
  s_waitcnt lgkmcnt(6)
  v_mfma_f32_16x16x32_bf16 v[40:43], v[64:67], v[80:83], v[40:43]
  s_waitcnt lgkmcnt(3)
  v_mfma_f32_16x16x32_bf16 v[40:43], v[68:71], v[84:87], v[40:43]
  s_waitcnt lgkmcnt(0)
  v_mfma_f32_16x16x32_bf16 v[40:43], v[72:75], v[88:91], v[40:43]
  s_nop 7
  buffer_store_dwordx4 v[40:43], v32, s[8:11], s42 offen sc1
  s_xor_b32 s30, s30, 1024
  s_add_u32 s52, s30, 0
  buffer_load_dwordx4 v[92:95], v28, s[4:7], s52 offen offset:0 nt
  buffer_load_dwordx4 v[96:99], v28, s[4:7], s52 offen offset:128 nt
  s_add_u32 s52, s30, 16384
  buffer_load_dwordx4 v[100:103], v28, s[4:7], s52 offen offset:0 nt
  buffer_load_dwordx4 v[104:107], v28, s[4:7], s52 offen offset:128 nt
  s_add_u32 s52, s44, 0
  s_sub_u32 s53, 5, s52
  s_bitcmp1_b32 s2, 2
  s_cselect_b32 s52, s53, s52
  s_lshr_b32 s53, s52, 1
  s_lshl_b32 s53, s53, 11
  s_and_b32 s52, s52, 1
  s_lshr_b32 s57, s2, 3
  s_lshl_b32 s57, s57, 1
  s_add_u32 s52, s52, s57
  s_mul_i32 s52, s52, 98304
  s_add_u32 s52, s52, s53
  s_and_b32 s53, s2, 3
  s_lshl_b32 s53, s53, 9
  s_add_u32 s52, s52, s53
  s_cmp_lt_u32 s44, 3
  s_cselect_b32 s52, s52, 1073741824
  v_lshrrev_b32 v16, 2, v0
  v_mul_u32_u24 v16, 5632, v16
  v_lshl_add_u32 v16, v0, 7, v16
  buffer_load_dword a252, v16, s[12:15], s52 offen
  v_add_u32 v15, s46, v0
  s_waitcnt vmcnt(5)
  s_barrier
  s_mov_b64 exec, 1
  buffer_store_dword v15, v0, s[8:11], s31 offen offset:0 sc1
  s_mov_b64 exec, -1
  s_add_u32 s52, s44, 3
  s_sub_u32 s53, 5, s52
  s_bitcmp1_b32 s2, 2
  s_cselect_b32 s52, s53, s52
  s_lshr_b32 s53, s52, 1
  s_lshl_b32 s53, s53, 11
  s_and_b32 s52, s52, 1
  s_lshr_b32 s57, s2, 3
  s_lshl_b32 s57, s57, 1
  s_add_u32 s52, s52, s57
  s_mul_i32 s52, s52, 98304
  s_add_u32 s52, s52, s53
  s_and_b32 s53, s2, 3
  s_lshl_b32 s53, s53, 9
  s_add_u32 s52, s52, s53
  s_cmp_lt_u32 s44, 3
  s_cselect_b32 s52, s52, 1073741824
  v_lshrrev_b32 v16, 2, v0
  v_mul_u32_u24 v16, 5632, v16
  v_lshl_add_u32 v16, v0, 7, v16
  buffer_load_dword a252, v16, s[12:15], s52 offen
  s_lshl_b32 s53, s44, 4
  v_lshlrev_b32 v31, 6, v21
  v_add_u32 v31, 159744, v31
  v_add_u32 v30, s53, v31
  v_mov_b32 v34, 0x3f803f80
  v_mov_b32 v36, 0
  v_mov_b32 v37, 0
  v_mov_b32 v38, 0
  v_mov_b32 v39, 0
  s_waitcnt vmcnt(9)
  v_dot2c_f32_bf16 v36, v44, v34
  v_dot2c_f32_bf16 v37, v44, v44
  v_dot2c_f32_bf16 v38, v52, v34
  v_dot2c_f32_bf16 v39, v52, v52
  v_dot2c_f32_bf16 v36, v45, v34
  v_dot2c_f32_bf16 v37, v45, v45
  v_dot2c_f32_bf16 v38, v53, v34
  v_dot2c_f32_bf16 v39, v53, v53
  v_dot2c_f32_bf16 v36, v46, v34
  v_dot2c_f32_bf16 v37, v46, v46
  v_dot2c_f32_bf16 v38, v54, v34
  v_dot2c_f32_bf16 v39, v54, v54
  v_dot2c_f32_bf16 v36, v47, v34
  v_dot2c_f32_bf16 v37, v47, v47
  v_dot2c_f32_bf16 v38, v55, v34
  v_dot2c_f32_bf16 v39, v55, v55
  v_dot2c_f32_bf16 v36, v48, v34
  v_dot2c_f32_bf16 v37, v48, v48
  v_dot2c_f32_bf16 v38, v56, v34
  v_dot2c_f32_bf16 v39, v56, v56
  v_dot2c_f32_bf16 v36, v49, v34
  v_dot2c_f32_bf16 v37, v49, v49
  v_dot2c_f32_bf16 v38, v57, v34
  v_dot2c_f32_bf16 v39, v57, v57
  v_dot2c_f32_bf16 v36, v50, v34
  v_dot2c_f32_bf16 v37, v50, v50
  v_dot2c_f32_bf16 v38, v58, v34
  v_dot2c_f32_bf16 v39, v58, v58
  v_dot2c_f32_bf16 v36, v51, v34
  v_dot2c_f32_bf16 v37, v51, v51
  v_dot2c_f32_bf16 v38, v59, v34
  v_dot2c_f32_bf16 v39, v59, v59
  s_waitcnt vmcnt(3)
  v_dot2c_f32_bf16 v36, v92, v34
  v_dot2c_f32_bf16 v37, v92, v92
  v_dot2c_f32_bf16 v38, v100, v34
  v_dot2c_f32_bf16 v39, v100, v100
  v_dot2c_f32_bf16 v36, v93, v34
  v_dot2c_f32_bf16 v37, v93, v93
  v_dot2c_f32_bf16 v38, v101, v34
  v_dot2c_f32_bf16 v39, v101, v101
  v_dot2c_f32_bf16 v36, v94, v34
  v_dot2c_f32_bf16 v37, v94, v94
  v_dot2c_f32_bf16 v38, v102, v34
  v_dot2c_f32_bf16 v39, v102, v102
  v_dot2c_f32_bf16 v36, v95, v34
  v_dot2c_f32_bf16 v37, v95, v95
  v_dot2c_f32_bf16 v38, v103, v34
  v_dot2c_f32_bf16 v39, v103, v103
  v_dot2c_f32_bf16 v36, v96, v34
  v_dot2c_f32_bf16 v37, v96, v96
  v_dot2c_f32_bf16 v38, v104, v34
  v_dot2c_f32_bf16 v39, v104, v104
  v_dot2c_f32_bf16 v36, v97, v34
  v_dot2c_f32_bf16 v37, v97, v97
  v_dot2c_f32_bf16 v38, v105, v34
  v_dot2c_f32_bf16 v39, v105, v105
  v_dot2c_f32_bf16 v36, v98, v34
  v_dot2c_f32_bf16 v37, v98, v98
  v_dot2c_f32_bf16 v38, v106, v34
  v_dot2c_f32_bf16 v39, v106, v106
  v_dot2c_f32_bf16 v36, v99, v34
  v_dot2c_f32_bf16 v37, v99, v99
  v_dot2c_f32_bf16 v38, v107, v34
  v_dot2c_f32_bf16 v39, v107, v107
  s_nop 2
  v_add_f32_dpp v36, v36, v36 row_ror:8 row_mask:0xf bank_mask:0xf
  v_add_f32_dpp v37, v37, v37 row_ror:8 row_mask:0xf bank_mask:0xf
  v_add_f32_dpp v38, v38, v38 row_ror:8 row_mask:0xf bank_mask:0xf
  v_add_f32_dpp v39, v39, v39 row_ror:8 row_mask:0xf bank_mask:0xf
  v_mov_b32 v40, v36
  v_mov_b32 v41, v37
  v_mov_b32 v42, v38
  v_mov_b32 v43, v39
  v_permlane16_swap_b32 v36, v40
  v_permlane16_swap_b32 v37, v41
  v_permlane16_swap_b32 v38, v42
  v_permlane16_swap_b32 v39, v43
  v_add_f32 v36, v36, v40
  v_add_f32 v37, v37, v41
  v_add_f32 v38, v38, v42
  v_add_f32 v39, v39, v43
  v_mov_b32 v40, v36
  v_mov_b32 v41, v37
  v_mov_b32 v42, v38
  v_mov_b32 v43, v39
  v_permlane32_swap_b32 v36, v40
  v_permlane32_swap_b32 v37, v41
  v_permlane32_swap_b32 v38, v42
  v_permlane32_swap_b32 v39, v43
  v_add_f32 v36, v36, v40
  v_add_f32 v37, v37, v41
  v_add_f32 v38, v38, v42
  v_add_f32 v39, v39, v43
  ds_write_b128 v30, v[36:39]
  v_lshlrev_b32 v60, 16, v44
  v_and_b32 v61, 0xffff0000, v44
  v_lshlrev_b32 v62, 16, v45
  v_and_b32 v63, 0xffff0000, v45
  v_lshlrev_b32 v64, 16, v46
  v_and_b32 v65, 0xffff0000, v46
  v_lshlrev_b32 v66, 16, v47
  v_and_b32 v67, 0xffff0000, v47
  v_lshlrev_b32 v68, 16, v48
  v_and_b32 v69, 0xffff0000, v48
  v_lshlrev_b32 v70, 16, v49
  v_and_b32 v71, 0xffff0000, v49
  v_lshlrev_b32 v72, 16, v50
  v_and_b32 v73, 0xffff0000, v50
  v_lshlrev_b32 v74, 16, v51
  v_and_b32 v75, 0xffff0000, v51
  v_lshlrev_b32 v76, 16, v52
  v_and_b32 v77, 0xffff0000, v52
  v_lshlrev_b32 v78, 16, v53
  v_and_b32 v79, 0xffff0000, v53
  v_lshlrev_b32 v80, 16, v54
  v_and_b32 v81, 0xffff0000, v54
  v_lshlrev_b32 v82, 16, v55
  v_and_b32 v83, 0xffff0000, v55
  v_lshlrev_b32 v84, 16, v56
  v_and_b32 v85, 0xffff0000, v56
  v_lshlrev_b32 v86, 16, v57
  v_and_b32 v87, 0xffff0000, v57
  v_lshlrev_b32 v88, 16, v58
  v_and_b32 v89, 0xffff0000, v58
  v_lshlrev_b32 v90, 16, v59
  v_and_b32 v91, 0xffff0000, v59
  s_waitcnt lgkmcnt(0)
  s_barrier
  ds_read_b128 v[92:95], v31 offset:0
  ds_read_b128 v[96:99], v31 offset:16
  ds_read_b128 v[100:103], v31 offset:32
  ds_read_b128 v[104:107], v31 offset:48
  v_permlane16_swap_b32 v44, v46
  v_permlane16_swap_b32 v45, v47
  v_permlane16_swap_b32 v48, v50
  v_permlane16_swap_b32 v49, v51
  v_permlane16_swap_b32 v52, v54
  v_permlane16_swap_b32 v53, v55
  v_permlane16_swap_b32 v56, v58
  v_permlane16_swap_b32 v57, v59
  v_bfe_u32 v36, v0, 3, 1
  v_lshlrev_b32 v28, 9, v36
  v_bfe_u32 v36, v0, 4, 1
  v_lshl_add_u32 v28, v36, 8, v28
  v_lshrrev_b32 v34, 5, v0
  v_lshl_add_u32 v28, v34, 10, v28
  v_lshl_add_u32 v28, v21, 4, v28
  v_and_b32 v29, 31, v0
  v_lshlrev_b32 v29, 4, v29
  v_lshl_add_u32 v29, v34, 12, v29
  v_cvt_f32_u32 v34, v34
  s_add_u32 s53, s45, 151552
  v_add_u32 v32, s53, v1
  v_lshl_add_u32 v33, v22, 5, s53
  v_lshlrev_b32 v36, 14, v36
  v_and_b32 v35, 15, v0
  v_lshl_add_u32 v35, v35, 7, v36
  s_waitcnt lgkmcnt(0)
  v_add_f32 v92, v92, v100
  v_add_f32 v93, v93, v101
  v_add_f32 v94, v94, v102
  v_add_f32 v95, v95, v103
  v_add_f32 v96, v96, v104
  v_add_f32 v97, v97, v105
  v_add_f32 v98, v98, v106
  v_add_f32 v99, v99, v107
  v_add_f32 v92, v92, v96
  v_add_f32 v93, v93, v97
  v_add_f32 v94, v94, v98
  v_add_f32 v95, v95, v99
  v_mul_f32 v92, 0x3a800000, v92
  v_mul_f32 v94, 0x3a800000, v94
  v_mul_f32 v93, 0x3a800000, v93
  v_mul_f32 v95, 0x3a800000, v95
  v_fma_f32 v93, -v92, v92, v93
  v_fma_f32 v95, -v94, v94, v95
  v_max_f32 v93, 0, v93
  v_max_f32 v95, 0, v95
  v_cvt_pk_bf16_f32 v93, v93, v93
  v_cvt_pk_bf16_f32 v95, v95, v95
  v_lshlrev_b32 v93, 16, v93
  v_lshlrev_b32 v95, 16, v95
  v_add_f32 v93, 0x3727c5ac, v93
  v_add_f32 v95, 0x3727c5ac, v95
  v_cvt_pk_bf16_f32 v93, v93, v93
  v_cvt_pk_bf16_f32 v95, v95, v95
  v_lshlrev_b32 v93, 16, v93
  v_lshlrev_b32 v95, 16, v95
  v_sqrt_f32 v93, v93
  v_sqrt_f32 v95, v95
  v_cvt_pk_bf16_f32 v92, v92, v92
  v_cvt_pk_bf16_f32 v94, v94, v94
  v_lshlrev_b32 v92, 16, v92
  v_lshlrev_b32 v94, 16, v94
  v_cvt_pk_bf16_f32 v93, v93, v93
  v_cvt_pk_bf16_f32 v95, v95, v95
  v_lshlrev_b32 v93, 16, v93
  v_lshlrev_b32 v95, 16, v95
  v_rcp_f32 v93, v93
  v_rcp_f32 v95, v95
  v_mul_f32 v92, v92, v93
  v_mul_f32 v94, v94, v95
  v_fma_f32 v60, v60, v93, -v92
  v_fma_f32 v61, v61, v93, -v92
  v_fma_f32 v62, v62, v93, -v92
  v_fma_f32 v63, v63, v93, -v92
  v_fma_f32 v64, v64, v93, -v92
  v_fma_f32 v65, v65, v93, -v92
  v_fma_f32 v66, v66, v93, -v92
  v_fma_f32 v67, v67, v93, -v92
  v_fma_f32 v68, v68, v93, -v92
  v_fma_f32 v69, v69, v93, -v92
  v_fma_f32 v70, v70, v93, -v92
  v_fma_f32 v71, v71, v93, -v92
  v_fma_f32 v72, v72, v93, -v92
  v_fma_f32 v73, v73, v93, -v92
  v_fma_f32 v74, v74, v93, -v92
  v_fma_f32 v75, v75, v93, -v92
  v_fma_f32 v76, v76, v95, -v94
  v_fma_f32 v77, v77, v95, -v94
  v_fma_f32 v78, v78, v95, -v94
  v_fma_f32 v79, v79, v95, -v94
  v_fma_f32 v80, v80, v95, -v94
  v_fma_f32 v81, v81, v95, -v94
  v_fma_f32 v82, v82, v95, -v94
  v_fma_f32 v83, v83, v95, -v94
  v_fma_f32 v84, v84, v95, -v94
  v_fma_f32 v85, v85, v95, -v94
  v_fma_f32 v86, v86, v95, -v94
  v_fma_f32 v87, v87, v95, -v94
  v_fma_f32 v88, v88, v95, -v94
  v_fma_f32 v89, v89, v95, -v94
  v_fma_f32 v90, v90, v95, -v94
  v_fma_f32 v91, v91, v95, -v94
  s_waitcnt vmcnt(13)
  v_lshlrev_b32 v15, 16, v23
  v_mul_f32 v16, 0xbfb8aa3b, v15
  v_exp_f32 v16, v16
  v_lshrrev_b32 v21, 5, v0
  v_add_f32 v16, 1.0, v16
  v_rcp_f32 v16, v16
  v_lshlrev_b32 v21, 6, v21
  v_mul_f32 v15, v15, v16
  v_cvt_pk_bf16_f32 v16, v15, v15
  v_bfe_u32 v15, v0, 2, 2
  v_lshl_add_u32 v21, v15, 4, v21
  v_bfe_u32 v15, v0, 4, 1
  v_lshl_add_u32 v21, v15, 3, v21
  v_and_b32 v15, 3, v0
  v_lshl_add_u32 v21, v15, 1, v21
  s_lshl_b32 s53, s44, 7
  s_add_u32 s53, s53, 149504
  v_add_u32 v21, s53, v21
  s_mov_b64 exec, 0
  s_cmp_eq_u32 s44, 0
  s_cbranch_scc1 HOP0
  s_cmp_eq_u32 s44, 1
  s_cbranch_scc1 HOP1
  s_cmp_eq_u32 s44, 2
  s_cbranch_scc1 HOP2
  s_cmp_eq_u32 s44, 3
  s_cbranch_scc1 HOP3
WRET0:
  s_mov_b64 exec, -1
  buffer_load_dword v36, v35, s[8:11], s35 offen sc1
  s_waitcnt vmcnt(0)
  v_cmp_ne_u32 vcc, s46, v36
  s_nop 4
  s_cbranch_vccz PL2_adaLN_cond__sliding_local_dilated__swiglu_ffn__prompt_kernelx
  s_mov_b32 s57, 60000
PL2_adaLN_cond__sliding_local_dilated__swiglu_ffn__prompt_kernel:
  buffer_load_dword v36, v35, s[8:11], s35 offen sc1
  s_sub_u32 s57, s57, 1
  s_cmp_eq_u32 s57, 0
  s_waitcnt vmcnt(0)
  s_cbranch_scc1 PL2_adaLN_cond__sliding_local_dilated__swiglu_ffn__prompt_kernelx
  v_cmp_ne_u32 vcc, s46, v36
  s_nop 4
  s_cbranch_vccnz PL2_adaLN_cond__sliding_local_dilated__swiglu_ffn__prompt_kernel
PL2_adaLN_cond__sliding_local_dilated__swiglu_ffn__prompt_kernelx:
  buffer_load_dwordx4 v[92:95], v29, s[8:11], s34 offen sc1
  s_add_u32 s34, s34, 8192
  buffer_load_dwordx4 v[96:99], v29, s[8:11], s34 offen sc1
  s_add_u32 s34, s34, 8192
  buffer_load_dwordx4 v[100:103], v29, s[8:11], s34 offen sc1
  s_add_u32 s34, s34, 8192
  buffer_load_dwordx4 v[104:107], v29, s[8:11], s34 offen sc1
  s_add_u32 s34, s34, 8192
  buffer_load_dwordx4 v[108:111], v29, s[8:11], s34 offen sc1
  s_add_u32 s34, s34, 8192
  buffer_load_dwordx4 v[112:115], v29, s[8:11], s34 offen sc1
  s_add_u32 s34, s34, 8192
  buffer_load_dwordx4 v[116:119], v29, s[8:11], s34 offen sc1
  s_add_u32 s34, s34, 8192
  buffer_load_dwordx4 v[120:123], v29, s[8:11], s34 offen sc1
  s_add_u32 m0, s45, 0
  s_add_u32 s68, s66, 0
  s_and_b32 s68, s68, 7
  s_mul_i32 s68, s68, 786432
  buffer_load_dwordx4 v9, s[12:15], s68 offen lds
  s_add_u32 m0, s45, 4096
  s_add_u32 s68, s68, 196608
  buffer_load_dwordx4 v9, s[12:15], s68 offen lds
  s_add_u32 m0, s45, 8192
  s_add_u32 s68, s68, 196608
  buffer_load_dwordx4 v9, s[12:15], s68 offen lds
  s_add_u32 m0, s45, 12288
  s_add_u32 s68, s68, 196608
  buffer_load_dwordx4 v9, s[12:15], s68 offen lds
  s_add_u32 m0, s45, 16384
  s_add_u32 s68, s66, 1
  s_and_b32 s68, s68, 7
  s_mul_i32 s68, s68, 786432
  buffer_load_dwordx4 v9, s[12:15], s68 offen lds
  s_add_u32 m0, s45, 20480
  s_add_u32 s68, s68, 196608
  buffer_load_dwordx4 v9, s[12:15], s68 offen lds
  s_add_u32 m0, s45, 24576
  s_add_u32 s68, s68, 196608
  buffer_load_dwordx4 v9, s[12:15], s68 offen lds
  s_add_u32 m0, s45, 28672
  s_add_u32 s68, s68, 196608
  buffer_load_dwordx4 v9, s[12:15], s68 offen lds
  s_waitcnt vmcnt(14)
  v_pk_add_f32 v[92:93], v[92:93], v[96:97]
  v_pk_add_f32 v[94:95], v[94:95], v[98:99]
  s_waitcnt vmcnt(13)
  v_pk_add_f32 v[92:93], v[92:93], v[100:101]
  v_pk_add_f32 v[94:95], v[94:95], v[102:103]
  s_waitcnt vmcnt(12)
  v_pk_add_f32 v[92:93], v[92:93], v[104:105]
  v_pk_add_f32 v[94:95], v[94:95], v[106:107]
  s_waitcnt vmcnt(11)
  v_pk_add_f32 v[92:93], v[92:93], v[108:109]
  v_pk_add_f32 v[94:95], v[94:95], v[110:111]
  s_waitcnt vmcnt(10)
  v_pk_add_f32 v[92:93], v[92:93], v[112:113]
  v_pk_add_f32 v[94:95], v[94:95], v[114:115]
  s_waitcnt vmcnt(9)
  v_pk_add_f32 v[92:93], v[92:93], v[116:117]
  v_pk_add_f32 v[94:95], v[94:95], v[118:119]
  s_waitcnt vmcnt(8)
  v_pk_add_f32 v[92:93], v[92:93], v[120:121]
  v_pk_add_f32 v[94:95], v[94:95], v[122:123]
  v_cvt_pk_bf16_f32 v96, v92, v93
  v_cvt_pk_bf16_f32 v97, v94, v95
  v_lshlrev_b32 v92, 16, v96
  v_and_b32 v93, 0xffff0000, v96
  v_lshlrev_b32 v94, 16, v97
  v_and_b32 v95, 0xffff0000, v97
  v_add_f32 v92, v34, v92
  v_add_f32 v93, v34, v93
  v_add_f32 v94, v34, v94
  v_add_f32 v95, v34, v95
  v_cvt_pk_bf16_f32 v96, v92, v93
  v_cvt_pk_bf16_f32 v97, v94, v95
  v_lshlrev_b32 v92, 16, v96
  v_and_b32 v93, 0xffff0000, v96
  v_lshlrev_b32 v94, 16, v97
  v_and_b32 v95, 0xffff0000, v97
  ds_write_b128 v32, v[92:95]
  ds_read_b128 v[92:95], v33 offset:512
  ds_read_b128 v[108:111], v33 offset:0
  ds_read_b128 v[96:99], v33 offset:528
  ds_read_b128 v[112:115], v33 offset:16
  ds_read_b128 v[100:103], v33 offset:768
  ds_read_b128 v[116:119], v33 offset:256
  ds_read_b128 v[104:107], v33 offset:784
  ds_read_b128 v[120:123], v33 offset:272
  s_waitcnt lgkmcnt(4)
  v_pk_fma_f32 v[60:61], v[60:61], v[92:93], v[108:109]
  v_pk_fma_f32 v[62:63], v[62:63], v[94:95], v[110:111]
  v_pk_fma_f32 v[64:65], v[64:65], v[96:97], v[112:113]
  v_pk_fma_f32 v[66:67], v[66:67], v[98:99], v[114:115]
  v_pk_fma_f32 v[76:77], v[76:77], v[92:93], v[108:109]
  v_pk_fma_f32 v[78:79], v[78:79], v[94:95], v[110:111]
  v_pk_fma_f32 v[80:81], v[80:81], v[96:97], v[112:113]
  v_pk_fma_f32 v[82:83], v[82:83], v[98:99], v[114:115]
  v_cvt_pk_bf16_f32 v60, v60, v61
  v_cvt_pk_bf16_f32 v61, v62, v63
  v_cvt_pk_bf16_f32 v62, v64, v65
  v_cvt_pk_bf16_f32 v63, v66, v67
  v_cvt_pk_bf16_f32 v76, v76, v77
  v_cvt_pk_bf16_f32 v77, v78, v79
  v_cvt_pk_bf16_f32 v78, v80, v81
  v_cvt_pk_bf16_f32 v79, v82, v83
  v_permlane16_swap_b32 v60, v62
  v_permlane16_swap_b32 v61, v63
  buffer_store_dwordx4 v[60:63], v28, s[8:11], s38 offen offset:0 sc1
  v_permlane16_swap_b32 v76, v78
  v_permlane16_swap_b32 v77, v79
  buffer_store_dwordx4 v[76:79], v28, s[8:11], s38 offen offset:128 sc1
  s_waitcnt lgkmcnt(0)
  v_pk_fma_f32 v[68:69], v[68:69], v[100:101], v[116:117]
  v_pk_fma_f32 v[70:71], v[70:71], v[102:103], v[118:119]
  v_pk_fma_f32 v[72:73], v[72:73], v[104:105], v[120:121]
  v_pk_fma_f32 v[74:75], v[74:75], v[106:107], v[122:123]
  v_pk_fma_f32 v[84:85], v[84:85], v[100:101], v[116:117]
  v_pk_fma_f32 v[86:87], v[86:87], v[102:103], v[118:119]
  v_pk_fma_f32 v[88:89], v[88:89], v[104:105], v[120:121]
  v_pk_fma_f32 v[90:91], v[90:91], v[106:107], v[122:123]
  v_cvt_pk_bf16_f32 v68, v68, v69
  v_cvt_pk_bf16_f32 v69, v70, v71
  v_cvt_pk_bf16_f32 v70, v72, v73
  v_cvt_pk_bf16_f32 v71, v74, v75
  v_cvt_pk_bf16_f32 v84, v84, v85
HOP0:
  s_cbranch_execz HOP4
  v_cvt_pk_bf16_f32 v85, v86, v87
  v_cvt_pk_bf16_f32 v86, v88, v89
  v_cvt_pk_bf16_f32 v87, v90, v91
  v_permlane16_swap_b32 v68, v70
  v_permlane16_swap_b32 v69, v71
  buffer_store_dwordx4 v[68:71], v28, s[8:11], s38 offen offset:2048 sc1
  v_permlane16_swap_b32 v84, v86
  v_permlane16_swap_b32 v85, v87
  buffer_store_dwordx4 v[84:87], v28, s[8:11], s38 offen offset:2176 sc1
  buffer_store_dwordx4 v[44:47], v28, s[8:11], s39 offen offset:0 sc1
  buffer_store_dwordx4 v[48:51], v28, s[8:11], s39 offen offset:2048 sc1
  buffer_store_dwordx4 v[52:55], v28, s[8:11], s39 offen offset:128 sc1
  buffer_store_dwordx4 v[56:59], v28, s[8:11], s39 offen offset:2176 sc1
  s_add_u32 m0, s45, 32768
  s_add_u32 s68, s66, 0
  s_and_b32 s68, s68, 7
  s_mul_i32 s68, s68, 786432
  s_add_u32 s68, s68, 2048
  buffer_load_dwordx4 v9, s[12:15], s68 offen lds
  s_add_u32 m0, s45, 36864
  s_add_u32 s68, s68, 196608
  buffer_load_dwordx4 v9, s[12:15], s68 offen lds
  s_add_u32 m0, s45, 40960
  s_add_u32 s68, s68, 196608
  buffer_load_dwordx4 v9, s[12:15], s68 offen lds
  s_add_u32 m0, s45, 45056
  s_add_u32 s68, s68, 196608
  buffer_load_dwordx4 v9, s[12:15], s68 offen lds
  s_add_u32 m0, s45, 49152
  s_add_u32 s68, s66, 0
  s_and_b32 s68, s68, 7
  s_mul_i32 s68, s68, 786432
  s_add_u32 s68, s68, 4096
  buffer_load_dwordx4 v9, s[12:15], s68 offen lds
  s_add_u32 m0, s45, 53248
  s_add_u32 s68, s68, 196608
  buffer_load_dwordx4 v9, s[12:15], s68 offen lds
  s_add_u32 m0, s45, 57344
  s_add_u32 s68, s68, 196608
  buffer_load_dwordx4 v9, s[12:15], s68 offen lds
  s_add_u32 m0, s45, 61440
  s_add_u32 s68, s68, 196608
  buffer_load_dwordx4 v9, s[12:15], s68 offen lds
  v_add_u32 v15, s46, v0
  s_waitcnt vmcnt(12)
  s_barrier
  s_mov_b64 exec, 1
  buffer_store_dword v15, v0, s[8:11], s75 offen offset:0 sc1
  s_mov_b64 exec, -1
  s_waitcnt vmcnt(17) lgkmcnt(0)
  s_barrier
  s_add_u32 m0, s45, 65536
  s_add_u32 s68, s66, 1
  s_and_b32 s68, s68, 7
  s_mul_i32 s68, s68, 786432
  s_add_u32 s68, s68, 2048
  buffer_load_dwordx4 v9, s[12:15], s68 offen lds
  ds_read_b64_tr_b16 a[0:1], v3 offset:0
  ds_read_b64_tr_b16 a[2:3], v3 offset:2048
  s_add_u32 m0, s45, 69632
  s_add_u32 s68, s68, 196608
  buffer_load_dwordx4 v9, s[12:15], s68 offen lds
  ds_read_b64_tr_b16 a[12:13], v3 offset:4096
  ds_read_b64_tr_b16 a[14:15], v3 offset:6144
  s_add_u32 m0, s45, 73728
  s_add_u32 s68, s68, 196608
  buffer_load_dwordx4 v9, s[12:15], s68 offen lds
  ds_read_b64_tr_b16 a[24:25], v3 offset:8192
  ds_read_b64_tr_b16 a[26:27], v3 offset:10240
  s_add_u32 m0, s45, 77824
  s_add_u32 s68, s68, 196608
  buffer_load_dwordx4 v9, s[12:15], s68 offen lds
  ds_read_b64_tr_b16 a[36:37], v3 offset:12288
  ds_read_b64_tr_b16 a[38:39], v3 offset:14336
  s_add_u32 m0, s45, 81920
  s_add_u32 s68, s66, 1
  s_and_b32 s68, s68, 7
  s_mul_i32 s68, s68, 786432
  s_add_u32 s68, s68, 4096
  buffer_load_dwordx4 v9, s[12:15], s68 offen lds
  ds_read_b64_tr_b16 a[48:49], v3 offset:16384
  ds_read_b64_tr_b16 a[50:51], v3 offset:18432
  s_add_u32 m0, s45, 86016
  s_add_u32 s68, s68, 196608
  buffer_load_dwordx4 v9, s[12:15], s68 offen lds
  ds_read_b64_tr_b16 a[60:61], v3 offset:20480
  ds_read_b64_tr_b16 a[62:63], v3 offset:22528
  s_add_u32 m0, s45, 90112
  s_add_u32 s68, s68, 196608
  buffer_load_dwordx4 v9, s[12:15], s68 offen lds
  ds_read_b64_tr_b16 a[72:73], v3 offset:24576
  ds_read_b64_tr_b16 a[74:75], v3 offset:26624
  s_add_u32 m0, s45, 94208
  s_add_u32 s68, s68, 196608
  buffer_load_dwordx4 v9, s[12:15], s68 offen lds
  ds_read_b64_tr_b16 a[84:85], v3 offset:28672
  ds_read_b64_tr_b16 a[86:87], v3 offset:30720
  s_add_u32 m0, s45, 98304
  s_add_u32 s68, s66, 2
  s_and_b32 s68, s68, 7
  s_mul_i32 s68, s68, 786432
  buffer_load_dwordx4 v9, s[12:15], s68 offen lds
  s_add_u32 m0, s45, 102400
  s_add_u32 s68, s68, 196608
  buffer_load_dwordx4 v9, s[12:15], s68 offen lds
  s_add_u32 m0, s45, 106496
  s_add_u32 s68, s68, 196608
  buffer_load_dwordx4 v9, s[12:15], s68 offen lds
  s_add_u32 m0, s45, 110592
  s_add_u32 s68, s68, 196608
  buffer_load_dwordx4 v9, s[12:15], s68 offen lds
  s_add_u32 m0, s45, 114688
  s_add_u32 s68, s66, 3
  s_and_b32 s68, s68, 7
  s_mul_i32 s68, s68, 786432
  buffer_load_dwordx4 v9, s[12:15], s68 offen lds
  s_add_u32 m0, s45, 118784
  s_add_u32 s68, s68, 196608
  buffer_load_dwordx4 v9, s[12:15], s68 offen lds
  s_add_u32 m0, s45, 122880
  s_add_u32 s68, s68, 196608
  buffer_load_dwordx4 v9, s[12:15], s68 offen lds
  s_add_u32 m0, s45, 126976
  s_add_u32 s68, s68, 196608
  buffer_load_dwordx4 v9, s[12:15], s68 offen lds
  s_waitcnt vmcnt(17) lgkmcnt(0)
  s_barrier
  s_add_u32 m0, s45, 0
  s_add_u32 s68, s66, 2
  s_and_b32 s68, s68, 7
  s_mul_i32 s68, s68, 786432
  s_add_u32 s68, s68, 2048
  buffer_load_dwordx4 v9, s[12:15], s68 offen lds
  ds_read_b64_tr_b16 a[4:5], v4 offset:32768
  ds_read_b64_tr_b16 a[6:7], v4 offset:34816
  s_add_u32 m0, s45, 4096
  s_add_u32 s68, s68, 196608
  buffer_load_dwordx4 v9, s[12:15], s68 offen lds
  ds_read_b64_tr_b16 a[8:9], v5 offset:32768
  ds_read_b64_tr_b16 a[10:11], v5 offset:34816
  s_add_u32 m0, s45, 8192
  s_add_u32 s68, s68, 196608
  buffer_load_dwordx4 v9, s[12:15], s68 offen lds
  ds_read_b64_tr_b16 a[16:17], v4 offset:36864
  ds_read_b64_tr_b16 a[18:19], v4 offset:38912
  s_add_u32 m0, s45, 12288
  s_add_u32 s68, s68, 196608
  buffer_load_dwordx4 v9, s[12:15], s68 offen lds
  ds_read_b64_tr_b16 a[20:21], v5 offset:36864
  ds_read_b64_tr_b16 a[22:23], v5 offset:38912
  s_add_u32 m0, s45, 16384
  s_add_u32 s68, s66, 2
  s_and_b32 s68, s68, 7
  s_mul_i32 s68, s68, 786432
  s_add_u32 s68, s68, 4096
  buffer_load_dwordx4 v9, s[12:15], s68 offen lds
  ds_read_b64_tr_b16 a[28:29], v4 offset:40960
  ds_read_b64_tr_b16 a[30:31], v4 offset:43008
  s_add_u32 m0, s45, 20480
  s_add_u32 s68, s68, 196608
  buffer_load_dwordx4 v9, s[12:15], s68 offen lds
  ds_read_b64_tr_b16 a[32:33], v5 offset:40960
  ds_read_b64_tr_b16 a[34:35], v5 offset:43008
  s_add_u32 m0, s45, 24576
  s_add_u32 s68, s68, 196608
  buffer_load_dwordx4 v9, s[12:15], s68 offen lds
  ds_read_b64_tr_b16 a[40:41], v4 offset:45056
  ds_read_b64_tr_b16 a[42:43], v4 offset:47104
  s_add_u32 m0, s45, 28672
  s_add_u32 s68, s68, 196608
  buffer_load_dwordx4 v9, s[12:15], s68 offen lds
  ds_read_b64_tr_b16 a[44:45], v5 offset:45056
  ds_read_b64_tr_b16 a[46:47], v5 offset:47104
  s_waitcnt vmcnt(16) lgkmcnt(0)
  s_barrier
  s_add_u32 m0, s45, 32768
  s_add_u32 s68, s66, 3
  s_and_b32 s68, s68, 7
  s_mul_i32 s68, s68, 786432
  s_add_u32 s68, s68, 2048
  buffer_load_dwordx4 v9, s[12:15], s68 offen lds
  ds_read_b64_tr_b16 a[52:53], v7 offset:0
  ds_read_b64_tr_b16 a[54:55], v7 offset:2048
  s_add_u32 m0, s45, 36864
  s_add_u32 s68, s68, 196608
  buffer_load_dwordx4 v9, s[12:15], s68 offen lds
  ds_read_b64_tr_b16 a[56:57], v8 offset:0
  ds_read_b64_tr_b16 a[58:59], v8 offset:2048
  s_add_u32 m0, s45, 40960
  s_add_u32 s68, s68, 196608
  buffer_load_dwordx4 v9, s[12:15], s68 offen lds
  ds_read_b64_tr_b16 a[64:65], v7 offset:4096
  ds_read_b64_tr_b16 a[66:67], v7 offset:6144
  s_add_u32 m0, s45, 45056
  s_add_u32 s68, s68, 196608
  buffer_load_dwordx4 v9, s[12:15], s68 offen lds
  ds_read_b64_tr_b16 a[68:69], v8 offset:4096
  ds_read_b64_tr_b16 a[70:71], v8 offset:6144
  s_add_u32 m0, s45, 49152
  s_add_u32 s68, s66, 3
  s_and_b32 s68, s68, 7
  s_mul_i32 s68, s68, 786432
  s_add_u32 s68, s68, 4096
  buffer_load_dwordx4 v9, s[12:15], s68 offen lds
  ds_read_b64_tr_b16 a[76:77], v7 offset:8192
  ds_read_b64_tr_b16 a[78:79], v7 offset:10240
  s_add_u32 m0, s45, 53248
  s_add_u32 s68, s68, 196608
  buffer_load_dwordx4 v9, s[12:15], s68 offen lds
  ds_read_b64_tr_b16 a[80:81], v8 offset:8192
  ds_read_b64_tr_b16 a[82:83], v8 offset:10240
  s_add_u32 m0, s45, 57344
  s_add_u32 s68, s68, 196608
  buffer_load_dwordx4 v9, s[12:15], s68 offen lds
  ds_read_b64_tr_b16 a[88:89], v7 offset:12288
  ds_read_b64_tr_b16 a[90:91], v7 offset:14336
  s_add_u32 m0, s45, 61440
  s_add_u32 s68, s68, 196608
  buffer_load_dwordx4 v9, s[12:15], s68 offen lds
  ds_read_b64_tr_b16 a[92:93], v8 offset:12288
  ds_read_b64_tr_b16 a[94:95], v8 offset:14336
  s_cmp_lg_u32 s44, 0
  s_cbranch_scc1 PI3_adaLN_cond__sliding_local_dilated__swiglu_ffn__prompt_kernel
  buffer_load_dword v36, v14, s[8:11], 0 offen sc1
PI3_adaLN_cond__sliding_local_dilated__swiglu_ffn__prompt_kernel:
  s_waitcnt vmcnt(16) lgkmcnt(0)
  s_barrier
  s_add_u32 m0, s45, 65536
  s_add_u32 s68, s66, 4
  s_and_b32 s68, s68, 7
  s_mul_i32 s68, s68, 786432
  buffer_load_dwordx4 v9, s[12:15], s68 offen lds
  ds_read_b64_tr_b16 a[96:97], v6 offset:32768
  ds_read_b64_tr_b16 a[98:99], v6 offset:34816
  s_add_u32 m0, s45, 69632
  s_add_u32 s68, s68, 196608
  buffer_load_dwordx4 v9, s[12:15], s68 offen lds
  ds_read_b64_tr_b16 a[108:109], v6 offset:36864
  ds_read_b64_tr_b16 a[110:111], v6 offset:38912
  s_add_u32 m0, s45, 73728
  s_add_u32 s68, s68, 196608
  buffer_load_dwordx4 v9, s[12:15], s68 offen lds
  ds_read_b64_tr_b16 a[120:121], v6 offset:40960
  ds_read_b64_tr_b16 a[122:123], v6 offset:43008
  s_add_u32 m0, s45, 77824
  s_add_u32 s68, s68, 196608
  buffer_load_dwordx4 v9, s[12:15], s68 offen lds
  ds_read_b64_tr_b16 a[132:133], v6 offset:45056
  ds_read_b64_tr_b16 a[134:135], v6 offset:47104
  s_add_u32 m0, s45, 81920
  s_add_u32 s68, s66, 5
  s_and_b32 s68, s68, 7
  s_mul_i32 s68, s68, 786432
  buffer_load_dwordx4 v9, s[12:15], s68 offen lds
  ds_read_b64_tr_b16 a[144:145], v6 offset:49152
  ds_read_b64_tr_b16 a[146:147], v6 offset:51200
  s_add_u32 m0, s45, 86016
  s_add_u32 s68, s68, 196608
  buffer_load_dwordx4 v9, s[12:15], s68 offen lds
  ds_read_b64_tr_b16 a[156:157], v6 offset:53248
  ds_read_b64_tr_b16 a[158:159], v6 offset:55296
  s_add_u32 m0, s45, 90112
  s_add_u32 s68, s68, 196608
  buffer_load_dwordx4 v9, s[12:15], s68 offen lds
  ds_read_b64_tr_b16 a[168:169], v6 offset:57344
  ds_read_b64_tr_b16 a[170:171], v6 offset:59392
  s_add_u32 m0, s45, 94208
  s_add_u32 s68, s68, 196608
  buffer_load_dwordx4 v9, s[12:15], s68 offen lds
  ds_read_b64_tr_b16 a[180:181], v6 offset:61440
  ds_read_b64_tr_b16 a[182:183], v6 offset:63488
  s_waitcnt vmcnt(16) lgkmcnt(0)
  s_barrier
  ds_read_b64_tr_b16 a[100:101], v4 offset:0
  ds_read_b64_tr_b16 a[102:103], v4 offset:2048
  ds_read_b64_tr_b16 a[104:105], v5 offset:0
  ds_read_b64_tr_b16 a[106:107], v5 offset:2048
  ds_read_b64_tr_b16 a[112:113], v4 offset:4096
  ds_read_b64_tr_b16 a[114:115], v4 offset:6144
  ds_read_b64_tr_b16 a[116:117], v5 offset:4096
  ds_read_b64_tr_b16 a[118:119], v5 offset:6144
  ds_read_b64_tr_b16 a[124:125], v4 offset:8192
  ds_read_b64_tr_b16 a[126:127], v4 offset:10240
  ds_read_b64_tr_b16 a[128:129], v5 offset:8192
  ds_read_b64_tr_b16 a[130:131], v5 offset:10240
  ds_read_b64_tr_b16 a[136:137], v4 offset:12288
  ds_read_b64_tr_b16 a[138:139], v4 offset:14336
  ds_read_b64_tr_b16 a[140:141], v5 offset:12288
  ds_read_b64_tr_b16 a[142:143], v5 offset:14336
  s_cmp_lg_u32 s44, 0
  s_cbranch_scc1 PL4_adaLN_cond__sliding_local_dilated__swiglu_ffn__prompt_kernelx
  s_waitcnt vmcnt(8)
  v_cmp_ne_u32 vcc, s46, v36
  s_nop 4
  s_cbranch_vccz PL4_adaLN_cond__sliding_local_dilated__swiglu_ffn__prompt_kernelx
  s_mov_b32 s57, 60000
PL4_adaLN_cond__sliding_local_dilated__swiglu_ffn__prompt_kernel:
  buffer_load_dword v36, v14, s[8:11], 0 offen sc1
  s_sub_u32 s57, s57, 1
  s_cmp_eq_u32 s57, 0
  s_waitcnt vmcnt(0)
  s_cbranch_scc1 PL4_adaLN_cond__sliding_local_dilated__swiglu_ffn__prompt_kernelx
  v_cmp_ne_u32 vcc, s46, v36
  s_nop 4
  s_cbranch_vccnz PL4_adaLN_cond__sliding_local_dilated__swiglu_ffn__prompt_kernel
PL4_adaLN_cond__sliding_local_dilated__swiglu_ffn__prompt_kernelx:
  s_barrier
  s_add_u32 m0, s70, 98304
  s_add_u32 s69, s58, 32768
  buffer_load_dwordx4 v12, s[8:11], s69 offen offset:0 sc1 lds
  buffer_load_dwordx4 v12, s[8:11], s69 offen offset:1024 sc1 lds
  buffer_load_dwordx4 v12, s[8:11], s69 offen offset:2048 sc1 lds
  buffer_load_dwordx4 v12, s[8:11], s69 offen offset:3072 sc1 lds
  s_add_u32 m0, s71, 131072
  s_add_u32 s69, s58, s72
  buffer_load_dwordx4 v1, s[8:11], s69 offen offset:0 sc1 lds
  buffer_load_dwordx4 v1, s[8:11], s69 offen offset:1024 sc1 lds
  s_add_u32 m0, s70, 114688
  s_add_u32 s69, s59, 32768
  buffer_load_dwordx4 v12, s[8:11], s69 offen offset:0 sc1 lds
  buffer_load_dwordx4 v12, s[8:11], s69 offen offset:1024 sc1 lds
  buffer_load_dwordx4 v12, s[8:11], s69 offen offset:2048 sc1 lds
  buffer_load_dwordx4 v12, s[8:11], s69 offen offset:3072 sc1 lds
  s_add_u32 m0, s71, 139264
  s_add_u32 s69, s59, s72
  buffer_load_dwordx4 v1, s[8:11], s69 offen offset:0 sc1 lds
  buffer_load_dwordx4 v1, s[8:11], s69 offen offset:1024 sc1 lds
  s_waitcnt vmcnt(20) lgkmcnt(0)
  s_barrier
  s_add_u32 m0, s45, 0
  s_add_u32 s68, s66, 4
  s_and_b32 s68, s68, 7
  s_mul_i32 s68, s68, 786432
  s_add_u32 s68, s68, 2048
  buffer_load_dwordx4 v9, s[12:15], s68 offen lds
  ds_read_b64_tr_b16 a[148:149], v4 offset:32768
  ds_read_b64_tr_b16 a[150:151], v4 offset:34816
  s_add_u32 m0, s45, 4096
  s_add_u32 s68, s68, 196608
  buffer_load_dwordx4 v9, s[12:15], s68 offen lds
  ds_read_b64_tr_b16 a[152:153], v5 offset:32768
  ds_read_b64_tr_b16 a[154:155], v5 offset:34816
  s_add_u32 m0, s45, 8192
  s_add_u32 s68, s68, 196608
  buffer_load_dwordx4 v9, s[12:15], s68 offen lds
  ds_read_b64_tr_b16 a[160:161], v4 offset:36864
  ds_read_b64_tr_b16 a[162:163], v4 offset:38912
  s_add_u32 m0, s45, 12288
  s_add_u32 s68, s68, 196608
  buffer_load_dwordx4 v9, s[12:15], s68 offen lds
  ds_read_b64_tr_b16 a[164:165], v5 offset:36864
  ds_read_b64_tr_b16 a[166:167], v5 offset:38912
  s_add_u32 m0, s45, 16384
  s_add_u32 s68, s66, 4
  s_and_b32 s68, s68, 7
  s_mul_i32 s68, s68, 786432
  s_add_u32 s68, s68, 4096
  buffer_load_dwordx4 v9, s[12:15], s68 offen lds
  ds_read_b64_tr_b16 a[172:173], v4 offset:40960
  ds_read_b64_tr_b16 a[174:175], v4 offset:43008
  s_add_u32 m0, s45, 20480
  s_add_u32 s68, s68, 196608
  buffer_load_dwordx4 v9, s[12:15], s68 offen lds
  ds_read_b64_tr_b16 a[176:177], v5 offset:40960
  ds_read_b64_tr_b16 a[178:179], v5 offset:43008
  s_add_u32 m0, s45, 24576
  s_add_u32 s68, s68, 196608
  buffer_load_dwordx4 v9, s[12:15], s68 offen lds
  ds_read_b64_tr_b16 a[184:185], v4 offset:45056
  ds_read_b64_tr_b16 a[186:187], v4 offset:47104
  s_add_u32 m0, s45, 28672
  s_add_u32 s68, s68, 196608
  buffer_load_dwordx4 v9, s[12:15], s68 offen lds
  ds_read_b64_tr_b16 a[188:189], v5 offset:45056
  ds_read_b64_tr_b16 a[190:191], v5 offset:47104
  s_waitcnt vmcnt(14) lgkmcnt(0)
  s_barrier
  ds_read_b128 v[76:79], v2 offset:32768
  ds_read_b128 v[80:83], v2 offset:33792
  ds_read_b128 v[84:87], v2 offset:40960
  ds_read_b128 v[88:91], v2 offset:41984
  ds_read_b128 v[92:95], v13 offset:0
  ds_read_b128 v[96:99], v13 offset:1024
  ds_read_b128 v[100:103], v2 offset:34816
  ds_read_b128 v[104:107], v2 offset:35840
  s_waitcnt lgkmcnt(2)
  v_mfma_f32_16x16x32_bf16 v[28:31], a[0:3], v[76:79], 0
  ds_read_b64_tr_b16 a[192:193], v6 offset:0
  s_add_u32 m0, s45, 32768
  s_add_u32 s68, s66, 5
  s_and_b32 s68, s68, 7
  s_mul_i32 s68, s68, 786432
  s_add_u32 s68, s68, 2048
  v_mfma_f32_16x16x32_bf16 v[28:31], a[12:15], v[80:83], v[28:31]
  ds_read_b128 v[108:111], v2 offset:43008
  buffer_load_dwordx4 v9, s[12:15], s68 offen lds
  v_mfma_f32_16x16x32_bf16 v[32:35], a[12:15], v[88:91], 0
  ds_read_b64_tr_b16 a[194:195], v6 offset:2048
  v_mfma_f32_16x16x32_bf16 v[32:35], a[0:3], v[84:87], v[32:35]
  ds_read_b64_tr_b16 a[204:205], v6 offset:4096
  v_mfma_f32_16x16x32_bf16 v[40:43], a[4:7], v[84:87], 0
  ds_read_b128 v[112:115], v2 offset:44032
  s_add_u32 m0, s45, 36864
  s_add_u32 s68, s68, 196608
  v_mfma_f32_16x16x32_bf16 v[40:43], a[16:19], v[88:91], v[40:43]
  ds_read_b64_tr_b16 a[206:207], v6 offset:6144
  buffer_load_dwordx4 v9, s[12:15], s68 offen lds
  v_mfma_f32_16x16x32_bf16 v[36:39], a[16:19], v[80:83], 0
  ds_read_b128 v[116:119], v13 offset:2048
  v_mfma_f32_16x16x32_bf16 v[36:39], a[4:7], v[76:79], v[36:39]
  ds_read_b64_tr_b16 a[216:217], v6 offset:8192
  v_mfma_f32_16x16x32_bf16 v[44:47], a[8:11], v[76:79], 0
  ds_read_b64_tr_b16 a[218:219], v6 offset:10240
  s_add_u32 m0, s45, 40960
  s_add_u32 s68, s68, 196608
  v_mfma_f32_16x16x32_bf16 v[44:47], a[20:23], v[80:83], v[44:47]
  ds_read_b128 v[120:123], v13 offset:3072
  buffer_load_dwordx4 v9, s[12:15], s68 offen lds
  v_mfma_f32_16x16x32_bf16 v[48:51], a[20:23], v[88:91], 0
  ds_read_b64_tr_b16 a[228:229], v6 offset:12288
  v_mfma_f32_16x16x32_bf16 v[48:51], a[8:11], v[84:87], v[48:51]
  ds_read_b64_tr_b16 a[230:231], v6 offset:14336
  v_mfma_f32_16x16x32_bf16 v[68:71], a[8:11], v[92:95], 0
  ds_read_b128 v[76:79], v2 offset:36864
  s_add_u32 m0, s45, 45056
  s_add_u32 s68, s68, 196608
  v_mfma_f32_16x16x32_bf16 v[68:71], a[20:23], v[96:99], v[68:71]
  ds_read_b64_tr_b16 a[240:241], v6 offset:16384
  buffer_load_dwordx4 v9, s[12:15], s68 offen lds
  v_mfma_f32_16x16x32_bf16 v[60:63], a[16:19], v[96:99], 0
  ds_read_b128 v[80:83], v2 offset:37888
  v_mfma_f32_16x16x32_bf16 v[60:63], a[4:7], v[92:95], v[60:63]
  s_waitcnt lgkmcnt(5)
  ds_read_b64_tr_b16 a[242:243], v6 offset:18432
  v_mfma_f32_16x16x32_bf16 v[28:31], a[24:27], v[100:103], v[28:31]
  ds_read_b64_tr_b16 v[124:125], v6 offset:20480
  s_add_u32 m0, s45, 49152
  s_add_u32 s68, s66, 5
  s_and_b32 s68, s68, 7
  s_mul_i32 s68, s68, 786432
  s_add_u32 s68, s68, 4096
  v_mfma_f32_16x16x32_bf16 v[28:31], a[36:39], v[104:107], v[28:31]
  ds_read_b128 v[88:91], v2 offset:45056
  buffer_load_dwordx4 v9, s[12:15], s68 offen lds
  v_mfma_f32_16x16x32_bf16 v[32:35], a[36:39], v[112:115], v[32:35]
  ds_read_b64_tr_b16 v[126:127], v6 offset:22528
  v_mfma_f32_16x16x32_bf16 v[32:35], a[24:27], v[108:111], v[32:35]
  ds_read_b64_tr_b16 v[136:137], v6 offset:24576
  v_mfma_f32_16x16x32_bf16 v[40:43], a[28:31], v[108:111], v[40:43]
  ds_read_b128 v[84:87], v2 offset:46080
  s_add_u32 m0, s45, 53248
  s_add_u32 s68, s68, 196608
  v_mfma_f32_16x16x32_bf16 v[40:43], a[40:43], v[112:115], v[40:43]
  ds_read_b64_tr_b16 v[138:139], v6 offset:26624
  buffer_load_dwordx4 v9, s[12:15], s68 offen lds
  v_mfma_f32_16x16x32_bf16 v[36:39], a[40:43], v[104:107], v[36:39]
  ds_read_b128 v[96:99], v13 offset:4096
  v_mfma_f32_16x16x32_bf16 v[36:39], a[28:31], v[100:103], v[36:39]
  ds_read_b64_tr_b16 v[148:149], v6 offset:28672
  v_mfma_f32_16x16x32_bf16 v[44:47], a[32:35], v[100:103], v[44:47]
  ds_read_b64_tr_b16 v[150:151], v6 offset:30720
  v_mfma_f32_16x16x32_bf16 v[44:47], a[44:47], v[104:107], v[44:47]
  ds_read_b128 v[92:95], v13 offset:5120
  s_add_u32 m0, s45, 57344
  s_add_u32 s68, s68, 196608
  v_mfma_f32_16x16x32_bf16 v[48:51], a[44:47], v[112:115], v[48:51]
  buffer_load_dwordx4 v9, s[12:15], s68 offen lds
  v_mfma_f32_16x16x32_bf16 v[48:51], a[32:35], v[108:111], v[48:51]
  s_add_u32 m0, s45, 61440
  s_add_u32 s68, s68, 196608
  v_mfma_f32_16x16x32_bf16 v[68:71], a[32:35], v[116:119], v[68:71]
  ds_read_b128 v[100:103], v2 offset:38912
  v_mfma_f32_16x16x32_bf16 v[68:71], a[44:47], v[120:123], v[68:71]
  buffer_load_dwordx4 v9, s[12:15], s68 offen lds
  v_mfma_f32_16x16x32_bf16 v[60:63], a[40:43], v[120:123], v[60:63]
  ds_read_b128 v[104:107], v2 offset:39936
  v_mfma_f32_16x16x32_bf16 v[60:63], a[28:31], v[116:119], v[60:63]
  s_waitcnt lgkmcnt(2)
  v_mfma_f32_16x16x32_bf16 v[28:31], a[48:51], v[76:79], v[28:31]
  s_add_u32 m0, s71, 147456
  s_add_u32 s69, s60, s72
  v_mfma_f32_16x16x32_bf16 v[28:31], a[60:63], v[80:83], v[28:31]
  ds_read_b128 v[112:115], v2 offset:47104
  v_mfma_f32_16x16x32_bf16 v[32:35], a[60:63], v[84:87], v[32:35]
  buffer_load_dwordx4 v1, s[8:11], s69 offen offset:0 sc1 lds
  v_mfma_f32_16x16x32_bf16 v[32:35], a[48:51], v[88:91], v[32:35]
  v_mfma_f32_16x16x32_bf16 v[40:43], a[52:55], v[88:91], v[40:43]
  ds_read_b128 v[108:111], v2 offset:48128
  v_mfma_f32_16x16x32_bf16 v[40:43], a[64:67], v[84:87], v[40:43]
  buffer_load_dwordx4 v1, s[8:11], s69 offen offset:1024 sc1 lds
  v_mfma_f32_16x16x32_bf16 v[36:39], a[64:67], v[80:83], v[36:39]
  ds_read_b128 v[120:123], v13 offset:6144
  v_mfma_f32_16x16x32_bf16 v[36:39], a[52:55], v[76:79], v[36:39]
  v_mfma_f32_16x16x32_bf16 v[44:47], a[56:59], v[76:79], v[44:47]
  s_add_u32 m0, s71, 155648
  s_add_u32 s69, s61, s72
  v_mfma_f32_16x16x32_bf16 v[44:47], a[68:71], v[80:83], v[44:47]
  ds_read_b128 v[116:119], v13 offset:7168
  v_mfma_f32_16x16x32_bf16 v[48:51], a[68:71], v[84:87], v[48:51]
  buffer_load_dwordx4 v1, s[8:11], s69 offen offset:0 sc1 lds
  v_mfma_f32_16x16x32_bf16 v[48:51], a[56:59], v[88:91], v[48:51]
  s_waitcnt vmcnt(11) lgkmcnt(7)
  s_barrier
  v_mfma_f32_16x16x32_bf16 v[68:71], a[56:59], v[96:99], v[68:71]
  ds_read_b128 v[76:79], v2 offset:49152
  v_mfma_f32_16x16x32_bf16 v[68:71], a[68:71], v[92:95], v[68:71]
  ds_read_b64_tr_b16 a[196:197], v4 offset:0
  buffer_load_dwordx4 v1, s[8:11], s69 offen offset:1024 sc1 lds
  v_mfma_f32_16x16x32_bf16 v[60:63], a[64:67], v[92:95], v[60:63]
  ds_read_b128 v[80:83], v2 offset:50176
  v_mfma_f32_16x16x32_bf16 v[60:63], a[52:55], v[96:99], v[60:63]
  s_waitcnt lgkmcnt(3)
  ds_read_b64_tr_b16 a[198:199], v4 offset:2048
  v_mfma_f32_16x16x32_bf16 v[28:31], a[72:75], v[100:103], v[28:31]
  ds_read_b64_tr_b16 a[200:201], v5 offset:0
  s_add_u32 m0, s70, 65536
  s_add_u32 s69, s60, 32768
  v_mfma_f32_16x16x32_bf16 v[28:31], a[84:87], v[104:107], v[28:31]
  ds_read_b128 v[84:87], v2 offset:57344
  buffer_load_dwordx4 v12, s[8:11], s69 offen offset:0 sc1 lds
  v_mfma_f32_16x16x32_bf16 v[32:35], a[84:87], v[108:111], v[32:35]
  ds_read_b64_tr_b16 a[202:203], v5 offset:2048
  v_mfma_f32_16x16x32_bf16 v[32:35], a[72:75], v[112:115], v[32:35]
  ds_read_b64_tr_b16 a[208:209], v4 offset:4096
  v_mfma_f32_16x16x32_bf16 v[40:43], a[76:79], v[112:115], v[40:43]
  ds_read_b128 v[88:91], v2 offset:58368
  v_mfma_f32_16x16x32_bf16 v[40:43], a[88:91], v[108:111], v[40:43]
  ds_read_b64_tr_b16 a[210:211], v4 offset:6144
  buffer_load_dwordx4 v12, s[8:11], s69 offen offset:1024 sc1 lds
  v_mfma_f32_16x16x32_bf16 v[36:39], a[88:91], v[104:107], v[36:39]
  ds_read_b128 v[92:95], v13 offset:8192
  v_mfma_f32_16x16x32_bf16 v[36:39], a[76:79], v[100:103], v[36:39]
  ds_read_b64_tr_b16 a[212:213], v5 offset:4096
  v_mfma_f32_16x16x32_bf16 v[44:47], a[80:83], v[100:103], v[44:47]
  ds_read_b64_tr_b16 a[214:215], v5 offset:6144
  v_mfma_f32_16x16x32_bf16 v[44:47], a[92:95], v[104:107], v[44:47]
  ds_read_b128 v[96:99], v13 offset:9216
  buffer_load_dwordx4 v12, s[8:11], s69 offen offset:2048 sc1 lds
  v_mfma_f32_16x16x32_bf16 v[48:51], a[92:95], v[108:111], v[48:51]
  ds_read_b64_tr_b16 a[220:221], v4 offset:8192
  v_mfma_f32_16x16x32_bf16 v[48:51], a[80:83], v[112:115], v[48:51]
  ds_read_b64_tr_b16 a[222:223], v4 offset:10240
  v_mfma_f32_16x16x32_bf16 v[68:71], a[80:83], v[120:123], v[68:71]
  ds_read_b128 v[100:103], v2 offset:51200
  v_mfma_f32_16x16x32_bf16 v[68:71], a[92:95], v[116:119], v[68:71]
  ds_read_b64_tr_b16 a[224:225], v5 offset:8192
  buffer_load_dwordx4 v12, s[8:11], s69 offen offset:3072 sc1 lds
  v_mfma_f32_16x16x32_bf16 v[60:63], a[88:91], v[116:119], v[60:63]
  ds_read_b128 v[104:107], v2 offset:52224
  v_mfma_f32_16x16x32_bf16 v[60:63], a[76:79], v[120:123], v[60:63]
  s_waitcnt lgkmcnt(5)
  ds_read_b64_tr_b16 a[226:227], v5 offset:10240
  v_mfma_f32_16x16x32_bf16 v[28:31], a[96:99], v[76:79], v[28:31]
  ds_read_b64_tr_b16 a[232:233], v4 offset:12288
  s_add_u32 m0, s45, 81920
  s_add_u32 s68, s66, 6
  s_and_b32 s68, s68, 7
  s_mul_i32 s68, s68, 786432
HOP1:
  s_cbranch_execz HOP5
  v_mfma_f32_16x16x32_bf16 v[28:31], a[108:111], v[80:83], v[28:31]
  ds_read_b128 v[108:111], v2 offset:59392
  buffer_load_dwordx4 v9, s[12:15], s68 offen lds
  v_mfma_f32_16x16x32_bf16 v[32:35], a[108:111], v[88:91], v[32:35]
  ds_read_b64_tr_b16 a[234:235], v4 offset:14336
  v_mfma_f32_16x16x32_bf16 v[32:35], a[96:99], v[84:87], v[32:35]
  ds_read_b64_tr_b16 a[236:237], v5 offset:12288
  v_mfma_f32_16x16x32_bf16 v[40:43], a[100:103], v[84:87], v[40:43]
  ds_read_b128 v[112:115], v2 offset:60416
  s_add_u32 m0, s45, 86016
  s_add_u32 s68, s68, 196608
  v_mfma_f32_16x16x32_bf16 v[40:43], a[112:115], v[88:91], v[40:43]
  ds_read_b64_tr_b16 a[238:239], v5 offset:14336
  buffer_load_dwordx4 v9, s[12:15], s68 offen lds
  v_mfma_f32_16x16x32_bf16 v[36:39], a[112:115], v[80:83], v[36:39]
  ds_read_b128 v[116:119], v13 offset:10240
  v_mfma_f32_16x16x32_bf16 v[36:39], a[100:103], v[76:79], v[36:39]
  v_mfma_f32_16x16x32_bf16 v[44:47], a[104:107], v[76:79], v[44:47]
  s_add_u32 m0, s45, 90112
  s_add_u32 s68, s68, 196608
  v_mfma_f32_16x16x32_bf16 v[44:47], a[116:119], v[80:83], v[44:47]
  ds_read_b128 v[120:123], v13 offset:11264
  v_mfma_f32_16x16x32_bf16 v[48:51], a[116:119], v[88:91], v[48:51]
  buffer_load_dwordx4 v9, s[12:15], s68 offen lds
  v_mfma_f32_16x16x32_bf16 v[48:51], a[104:107], v[84:87], v[48:51]
  s_waitcnt vmcnt(11) lgkmcnt(2)
  s_barrier
  v_mfma_f32_16x16x32_bf16 v[68:71], a[104:107], v[92:95], v[68:71]
  ds_read_b128 v[76:79], v2 offset:53248
  s_add_u32 m0, s45, 94208
  s_add_u32 s68, s68, 196608
  v_mfma_f32_16x16x32_bf16 v[68:71], a[116:119], v[96:99], v[68:71]
  ds_read_b64_tr_b16 a[244:245], v4 offset:32768
  buffer_load_dwordx4 v9, s[12:15], s68 offen lds
  v_mfma_f32_16x16x32_bf16 v[60:63], a[112:115], v[96:99], v[60:63]
  ds_read_b128 v[80:83], v2 offset:54272
  v_mfma_f32_16x16x32_bf16 v[60:63], a[100:103], v[92:95], v[60:63]
  s_waitcnt lgkmcnt(3)
  ds_read_b64_tr_b16 a[246:247], v4 offset:34816
  v_mfma_f32_16x16x32_bf16 v[28:31], a[120:123], v[100:103], v[28:31]
  ds_read_b64_tr_b16 a[248:249], v5 offset:32768
  s_add_u32 m0, s45, 98304
  s_add_u32 s68, s66, 7
  s_and_b32 s68, s68, 7
  s_mul_i32 s68, s68, 786432
  v_mfma_f32_16x16x32_bf16 v[28:31], a[132:135], v[104:107], v[28:31]
  ds_read_b128 v[88:91], v2 offset:61440
  buffer_load_dwordx4 v9, s[12:15], s68 offen lds
  v_mfma_f32_16x16x32_bf16 v[32:35], a[132:135], v[112:115], v[32:35]
  ds_read_b64_tr_b16 a[250:251], v5 offset:34816
  v_mfma_f32_16x16x32_bf16 v[32:35], a[120:123], v[108:111], v[32:35]
  ds_read_b64_tr_b16 v[128:129], v4 offset:36864
  v_mfma_f32_16x16x32_bf16 v[40:43], a[124:127], v[108:111], v[40:43]
  ds_read_b128 v[84:87], v2 offset:62464
  s_add_u32 m0, s45, 102400
  s_add_u32 s68, s68, 196608
  v_mfma_f32_16x16x32_bf16 v[40:43], a[136:139], v[112:115], v[40:43]
  ds_read_b64_tr_b16 v[130:131], v4 offset:38912
  buffer_load_dwordx4 v9, s[12:15], s68 offen lds
  v_mfma_f32_16x16x32_bf16 v[36:39], a[136:139], v[104:107], v[36:39]
  ds_read_b128 v[96:99], v13 offset:12288
  v_mfma_f32_16x16x32_bf16 v[36:39], a[124:127], v[100:103], v[36:39]
  ds_read_b64_tr_b16 v[132:133], v5 offset:36864
  v_mfma_f32_16x16x32_bf16 v[44:47], a[128:131], v[100:103], v[44:47]
  ds_read_b64_tr_b16 v[134:135], v5 offset:38912
  s_add_u32 m0, s45, 106496
  s_add_u32 s68, s68, 196608
  v_mfma_f32_16x16x32_bf16 v[44:47], a[140:143], v[104:107], v[44:47]
  ds_read_b128 v[92:95], v13 offset:13312
  buffer_load_dwordx4 v9, s[12:15], s68 offen lds
  v_mfma_f32_16x16x32_bf16 v[48:51], a[140:143], v[112:115], v[48:51]
  ds_read_b64_tr_b16 v[140:141], v4 offset:40960
  v_mfma_f32_16x16x32_bf16 v[48:51], a[128:131], v[108:111], v[48:51]
  ds_read_b64_tr_b16 v[142:143], v4 offset:43008
  v_mfma_f32_16x16x32_bf16 v[68:71], a[128:131], v[116:119], v[68:71]
  ds_read_b128 v[100:103], v2 offset:55296
  s_add_u32 m0, s45, 110592
  s_add_u32 s68, s68, 196608
  v_mfma_f32_16x16x32_bf16 v[68:71], a[140:143], v[120:123], v[68:71]
  ds_read_b64_tr_b16 v[144:145], v5 offset:40960
  buffer_load_dwordx4 v9, s[12:15], s68 offen lds
  v_mfma_f32_16x16x32_bf16 v[60:63], a[136:139], v[120:123], v[60:63]
  ds_read_b128 v[104:107], v2 offset:56320
  v_mfma_f32_16x16x32_bf16 v[60:63], a[124:127], v[116:119], v[60:63]
  s_waitcnt lgkmcnt(5)
  ds_read_b64_tr_b16 v[146:147], v5 offset:43008
  v_mfma_f32_16x16x32_bf16 v[28:31], a[144:147], v[76:79], v[28:31]
  ds_read_b64_tr_b16 v[152:153], v4 offset:45056
  s_add_u32 m0, s45, 0
  s_add_u32 s68, s66, 6
  s_and_b32 s68, s68, 7
  s_mul_i32 s68, s68, 786432
  s_add_u32 s68, s68, 2048
  v_mfma_f32_16x16x32_bf16 v[28:31], a[156:159], v[80:83], v[28:31]
  ds_read_b128 v[112:115], v2 offset:63488
  buffer_load_dwordx4 v9, s[12:15], s68 offen lds
  v_mfma_f32_16x16x32_bf16 v[32:35], a[156:159], v[84:87], v[32:35]
  ds_read_b64_tr_b16 v[154:155], v4 offset:47104
  v_mfma_f32_16x16x32_bf16 v[32:35], a[144:147], v[88:91], v[32:35]
  ds_read_b64_tr_b16 v[156:157], v5 offset:45056
  v_mfma_f32_16x16x32_bf16 v[40:43], a[148:151], v[88:91], v[40:43]
  ds_read_b128 v[108:111], v2 offset:64512
  s_add_u32 m0, s45, 4096
  s_add_u32 s68, s68, 196608
  v_mfma_f32_16x16x32_bf16 v[40:43], a[160:163], v[84:87], v[40:43]
  ds_read_b64_tr_b16 v[158:159], v5 offset:47104
  buffer_load_dwordx4 v9, s[12:15], s68 offen lds
  v_mfma_f32_16x16x32_bf16 v[36:39], a[160:163], v[80:83], v[36:39]
  ds_read_b128 v[120:123], v13 offset:14336
  v_mfma_f32_16x16x32_bf16 v[36:39], a[148:151], v[76:79], v[36:39]
  v_mfma_f32_16x16x32_bf16 v[44:47], a[152:155], v[76:79], v[44:47]
  s_add_u32 m0, s45, 8192
  s_add_u32 s68, s68, 196608
  v_mfma_f32_16x16x32_bf16 v[44:47], a[164:167], v[80:83], v[44:47]
  ds_read_b128 v[116:119], v13 offset:15360
  v_mfma_f32_16x16x32_bf16 v[48:51], a[164:167], v[84:87], v[48:51]
  buffer_load_dwordx4 v9, s[12:15], s68 offen lds
  v_mfma_f32_16x16x32_bf16 v[48:51], a[152:155], v[88:91], v[48:51]
  s_waitcnt vmcnt(3) lgkmcnt(2)
  s_barrier
  v_mfma_f32_16x16x32_bf16 v[68:71], a[152:155], v[96:99], v[68:71]
  ds_read_b128 v[76:79], v2 offset:0
  s_add_u32 m0, s45, 12288
  s_add_u32 s68, s68, 196608
  v_mfma_f32_16x16x32_bf16 v[68:71], a[164:167], v[92:95], v[68:71]
  ds_read_b64_tr_b16 v[160:161], v6 offset:16384
  buffer_load_dwordx4 v9, s[12:15], s68 offen lds
  v_mfma_f32_16x16x32_bf16 v[60:63], a[160:163], v[92:95], v[60:63]
  ds_read_b128 v[80:83], v2 offset:1024
  v_mfma_f32_16x16x32_bf16 v[60:63], a[148:151], v[96:99], v[60:63]
  s_waitcnt lgkmcnt(3)
  ds_read_b64_tr_b16 v[162:163], v6 offset:18432
  v_mfma_f32_16x16x32_bf16 v[28:31], a[168:171], v[100:103], v[28:31]
  ds_read_b64_tr_b16 v[172:173], v6 offset:20480
  s_add_u32 m0, s45, 16384
  s_add_u32 s68, s66, 6
  s_and_b32 s68, s68, 7
  s_mul_i32 s68, s68, 786432
  s_add_u32 s68, s68, 4096
  v_mfma_f32_16x16x32_bf16 v[28:31], a[180:183], v[104:107], v[28:31]
  ds_read_b128 v[84:87], v2 offset:8192
  buffer_load_dwordx4 v9, s[12:15], s68 offen lds
  v_mfma_f32_16x16x32_bf16 v[32:35], a[180:183], v[108:111], v[32:35]
  ds_read_b64_tr_b16 v[174:175], v6 offset:22528
  v_mfma_f32_16x16x32_bf16 v[32:35], a[168:171], v[112:115], v[32:35]
  ds_read_b64_tr_b16 v[184:185], v6 offset:24576
  v_mfma_f32_16x16x32_bf16 v[40:43], a[172:175], v[112:115], v[40:43]
  ds_read_b128 v[88:91], v2 offset:9216
  s_add_u32 m0, s45, 20480
  s_add_u32 s68, s68, 196608
  v_mfma_f32_16x16x32_bf16 v[40:43], a[184:187], v[108:111], v[40:43]
  ds_read_b64_tr_b16 v[186:187], v6 offset:26624
  buffer_load_dwordx4 v9, s[12:15], s68 offen lds
  v_mfma_f32_16x16x32_bf16 v[36:39], a[184:187], v[104:107], v[36:39]
  ds_read_b128 v[92:95], v13 offset:16384
  v_mfma_f32_16x16x32_bf16 v[36:39], a[172:175], v[100:103], v[36:39]
  ds_read_b64_tr_b16 v[196:197], v6 offset:28672
  v_mfma_f32_16x16x32_bf16 v[44:47], a[176:179], v[100:103], v[44:47]
  ds_read_b64_tr_b16 v[198:199], v6 offset:30720
  s_add_u32 m0, s45, 24576
  s_add_u32 s68, s68, 196608
  v_mfma_f32_16x16x32_bf16 v[44:47], a[188:191], v[104:107], v[44:47]
  ds_read_b128 v[96:99], v13 offset:17408
  buffer_load_dwordx4 v9, s[12:15], s68 offen lds
  v_mfma_f32_16x16x32_bf16 v[48:51], a[188:191], v[108:111], v[48:51]
  ds_read_b64_tr_b16 v[208:209], v6 offset:32768
  v_mfma_f32_16x16x32_bf16 v[48:51], a[176:179], v[112:115], v[48:51]
  ds_read_b64_tr_b16 v[210:211], v6 offset:34816
  v_mfma_f32_16x16x32_bf16 v[68:71], a[176:179], v[120:123], v[68:71]
  ds_read_b128 v[100:103], v2 offset:2048
  s_add_u32 m0, s45, 28672
  s_add_u32 s68, s68, 196608
  v_mfma_f32_16x16x32_bf16 v[68:71], a[188:191], v[116:119], v[68:71]
  ds_read_b64_tr_b16 v[220:221], v6 offset:36864
  buffer_load_dwordx4 v9, s[12:15], s68 offen lds
  v_mfma_f32_16x16x32_bf16 v[60:63], a[184:187], v[116:119], v[60:63]
  ds_read_b128 v[104:107], v2 offset:3072
  v_mfma_f32_16x16x32_bf16 v[60:63], a[172:175], v[120:123], v[60:63]
  s_waitcnt lgkmcnt(5)
  ds_read_b64_tr_b16 v[222:223], v6 offset:38912
  v_mfma_f32_16x16x32_bf16 v[28:31], a[192:195], v[76:79], v[28:31]
  ds_read_b64_tr_b16 v[232:233], v6 offset:40960
  s_add_u32 m0, s70, 32768
  s_add_u32 s69, s61, 32768
  v_mfma_f32_16x16x32_bf16 v[28:31], a[204:207], v[80:83], v[28:31]
  ds_read_b128 v[108:111], v2 offset:10240
  buffer_load_dwordx4 v12, s[8:11], s69 offen offset:0 sc1 lds
  v_mfma_f32_16x16x32_bf16 v[32:35], a[204:207], v[88:91], v[32:35]
  ds_read_b64_tr_b16 v[234:235], v6 offset:43008
  v_mfma_f32_16x16x32_bf16 v[32:35], a[192:195], v[84:87], v[32:35]
  ds_read_b64_tr_b16 v[244:245], v6 offset:45056
  v_mfma_f32_16x16x32_bf16 v[40:43], a[196:199], v[84:87], v[40:43]
  ds_read_b128 v[112:115], v2 offset:11264
  v_mfma_f32_16x16x32_bf16 v[40:43], a[208:211], v[88:91], v[40:43]
  ds_read_b64_tr_b16 v[246:247], v6 offset:47104
  buffer_load_dwordx4 v12, s[8:11], s69 offen offset:1024 sc1 lds
  v_mfma_f32_16x16x32_bf16 v[36:39], a[208:211], v[80:83], v[36:39]
  ds_read_b128 v[116:119], v13 offset:18432
  v_mfma_f32_16x16x32_bf16 v[36:39], a[196:199], v[76:79], v[36:39]
  v_mfma_f32_16x16x32_bf16 v[44:47], a[200:203], v[76:79], v[44:47]
  v_mfma_f32_16x16x32_bf16 v[44:47], a[212:215], v[80:83], v[44:47]
  ds_read_b128 v[120:123], v13 offset:19456
  v_mfma_f32_16x16x32_bf16 v[48:51], a[212:215], v[88:91], v[48:51]
  buffer_load_dwordx4 v12, s[8:11], s69 offen offset:2048 sc1 lds
  v_mfma_f32_16x16x32_bf16 v[48:51], a[200:203], v[84:87], v[48:51]
  s_waitcnt vmcnt(3) lgkmcnt(2)
  s_barrier
  v_mfma_f32_16x16x32_bf16 v[68:71], a[200:203], v[92:95], v[68:71]
  ds_read_b128 v[76:79], v2 offset:4096
  v_mfma_f32_16x16x32_bf16 v[68:71], a[212:215], v[96:99], v[68:71]
  ds_read_b64_tr_b16 v[164:165], v4 offset:0
  buffer_load_dwordx4 v12, s[8:11], s69 offen offset:3072 sc1 lds
  v_mfma_f32_16x16x32_bf16 v[60:63], a[208:211], v[96:99], v[60:63]
  ds_read_b128 v[80:83], v2 offset:5120
  v_mfma_f32_16x16x32_bf16 v[60:63], a[196:199], v[92:95], v[60:63]
  s_waitcnt lgkmcnt(3)
  ds_read_b64_tr_b16 v[166:167], v4 offset:2048
  v_mfma_f32_16x16x32_bf16 v[28:31], a[216:219], v[100:103], v[28:31]
  ds_read_b64_tr_b16 v[168:169], v5 offset:0
  s_add_u32 m0, s45, 81920
  s_add_u32 s68, s66, 7
  s_and_b32 s68, s68, 7
  s_mul_i32 s68, s68, 786432
  s_add_u32 s68, s68, 2048
  v_mfma_f32_16x16x32_bf16 v[28:31], a[228:231], v[104:107], v[28:31]
  ds_read_b128 v[88:91], v2 offset:12288
  buffer_load_dwordx4 v9, s[12:15], s68 offen lds
  v_mfma_f32_16x16x32_bf16 v[32:35], a[228:231], v[112:115], v[32:35]
  ds_read_b64_tr_b16 v[170:171], v5 offset:2048
  v_mfma_f32_16x16x32_bf16 v[32:35], a[216:219], v[108:111], v[32:35]
  ds_read_b64_tr_b16 v[176:177], v4 offset:4096
  v_mfma_f32_16x16x32_bf16 v[40:43], a[220:223], v[108:111], v[40:43]
  ds_read_b128 v[84:87], v2 offset:13312
  s_add_u32 m0, s45, 86016
  s_add_u32 s68, s68, 196608
  v_mfma_f32_16x16x32_bf16 v[40:43], a[232:235], v[112:115], v[40:43]
  ds_read_b64_tr_b16 v[178:179], v4 offset:6144
  buffer_load_dwordx4 v9, s[12:15], s68 offen lds
  v_mfma_f32_16x16x32_bf16 v[36:39], a[232:235], v[104:107], v[36:39]
  ds_read_b128 v[96:99], v13 offset:20480
  v_mfma_f32_16x16x32_bf16 v[36:39], a[220:223], v[100:103], v[36:39]
  ds_read_b64_tr_b16 v[180:181], v5 offset:4096
  v_mfma_f32_16x16x32_bf16 v[44:47], a[224:227], v[100:103], v[44:47]
  ds_read_b64_tr_b16 v[182:183], v5 offset:6144
  s_add_u32 m0, s45, 90112
  s_add_u32 s68, s68, 196608
  v_mfma_f32_16x16x32_bf16 v[44:47], a[236:239], v[104:107], v[44:47]
  ds_read_b128 v[92:95], v13 offset:21504
  buffer_load_dwordx4 v9, s[12:15], s68 offen lds
  v_mfma_f32_16x16x32_bf16 v[48:51], a[236:239], v[112:115], v[48:51]
  ds_read_b64_tr_b16 v[188:189], v4 offset:8192
  v_mfma_f32_16x16x32_bf16 v[48:51], a[224:227], v[108:111], v[48:51]
  ds_read_b64_tr_b16 v[190:191], v4 offset:10240
  v_mfma_f32_16x16x32_bf16 v[68:71], a[224:227], v[116:119], v[68:71]
  ds_read_b128 v[100:103], v2 offset:6144
  s_add_u32 m0, s45, 94208
  s_add_u32 s68, s68, 196608
  v_mfma_f32_16x16x32_bf16 v[68:71], a[236:239], v[120:123], v[68:71]
  ds_read_b64_tr_b16 v[192:193], v5 offset:8192
  buffer_load_dwordx4 v9, s[12:15], s68 offen lds
  v_mfma_f32_16x16x32_bf16 v[60:63], a[232:235], v[120:123], v[60:63]
  ds_read_b128 v[104:107], v2 offset:7168
  v_mfma_f32_16x16x32_bf16 v[60:63], a[220:223], v[116:119], v[60:63]
  s_waitcnt lgkmcnt(5)
  ds_read_b64_tr_b16 v[194:195], v5 offset:10240
  v_mfma_f32_16x16x32_bf16 v[28:31], a[240:243], v[76:79], v[28:31]
  ds_read_b64_tr_b16 v[200:201], v4 offset:12288
  s_add_u32 m0, s45, 98304
  s_add_u32 s68, s66, 7
  s_and_b32 s68, s68, 7
  s_mul_i32 s68, s68, 786432
  s_add_u32 s68, s68, 4096
  v_mfma_f32_16x16x32_bf16 v[28:31], v[124:127], v[80:83], v[28:31]
  ds_read_b128 v[112:115], v2 offset:14336
  buffer_load_dwordx4 v9, s[12:15], s68 offen lds
  v_mfma_f32_16x16x32_bf16 v[32:35], v[124:127], v[84:87], v[32:35]
  ds_read_b64_tr_b16 v[202:203], v4 offset:14336
  v_mfma_f32_16x16x32_bf16 v[32:35], a[240:243], v[88:91], v[32:35]
  ds_read_b64_tr_b16 v[204:205], v5 offset:12288
  v_mfma_f32_16x16x32_bf16 v[40:43], a[244:247], v[88:91], v[40:43]
  ds_read_b128 v[108:111], v2 offset:15360
  s_add_u32 m0, s45, 102400
  s_add_u32 s68, s68, 196608
  v_mfma_f32_16x16x32_bf16 v[40:43], v[128:131], v[84:87], v[40:43]
  ds_read_b64_tr_b16 v[206:207], v5 offset:14336
  buffer_load_dwordx4 v9, s[12:15], s68 offen lds
  v_mfma_f32_16x16x32_bf16 v[36:39], v[128:131], v[80:83], v[36:39]
  ds_read_b128 v[120:123], v13 offset:22528
  v_mfma_f32_16x16x32_bf16 v[36:39], a[244:247], v[76:79], v[36:39]
  v_mfma_f32_16x16x32_bf16 v[44:47], a[248:251], v[76:79], v[44:47]
  s_add_u32 m0, s45, 106496
  s_add_u32 s68, s68, 196608
  v_mfma_f32_16x16x32_bf16 v[44:47], v[132:135], v[80:83], v[44:47]
  ds_read_b128 v[116:119], v13 offset:23552
  v_mfma_f32_16x16x32_bf16 v[48:51], v[132:135], v[84:87], v[48:51]
  buffer_load_dwordx4 v9, s[12:15], s68 offen lds
  v_mfma_f32_16x16x32_bf16 v[48:51], a[248:251], v[88:91], v[48:51]
  s_waitcnt vmcnt(7) lgkmcnt(2)
  s_barrier
  v_mfma_f32_16x16x32_bf16 v[68:71], a[248:251], v[96:99], v[68:71]
  ds_read_b128 v[76:79], v1 offset:32768
  s_add_u32 m0, s45, 110592
  s_add_u32 s68, s68, 196608
  v_mfma_f32_16x16x32_bf16 v[68:71], v[132:135], v[92:95], v[68:71]
  buffer_load_dwordx4 v9, s[12:15], s68 offen lds
  v_mfma_f32_16x16x32_bf16 v[60:63], v[128:131], v[92:95], v[60:63]
  ds_read_b128 v[80:83], v1 offset:33792
  v_mfma_f32_16x16x32_bf16 v[60:63], a[244:247], v[96:99], v[60:63]
  s_waitcnt lgkmcnt(2)
  v_mfma_f32_16x16x32_bf16 v[28:31], v[136:139], v[100:103], v[28:31]
  s_add_u32 m0, s70, 49152
  s_add_u32 s69, s58, 98304
  v_mfma_f32_16x16x32_bf16 v[28:31], v[148:151], v[104:107], v[28:31]
  ds_read_b128 v[84:87], v1 offset:40960
  v_mfma_f32_16x16x32_bf16 v[32:35], v[148:151], v[108:111], v[32:35]
  buffer_load_dwordx4 v12, s[8:11], s69 offen offset:0 sc1 lds
  v_mfma_f32_16x16x32_bf16 v[32:35], v[136:139], v[112:115], v[32:35]
  v_mfma_f32_16x16x32_bf16 v[40:43], v[140:143], v[112:115], v[40:43]
  ds_read_b128 v[88:91], v1 offset:41984
  v_mfma_f32_16x16x32_bf16 v[40:43], v[152:155], v[108:111], v[40:43]
  buffer_load_dwordx4 v12, s[8:11], s69 offen offset:1024 sc1 lds
  v_mfma_f32_16x16x32_bf16 v[36:39], v[152:155], v[104:107], v[36:39]
  ds_read_b128 v[92:95], v13 offset:24576
  v_mfma_f32_16x16x32_bf16 v[36:39], v[140:143], v[100:103], v[36:39]
  v_mfma_f32_16x16x32_bf16 v[44:47], v[144:147], v[100:103], v[44:47]
  v_mfma_f32_16x16x32_bf16 v[44:47], v[156:159], v[104:107], v[44:47]
  ds_read_b128 v[96:99], v13 offset:25600
  v_mfma_f32_16x16x32_bf16 v[48:51], v[156:159], v[108:111], v[48:51]
  buffer_load_dwordx4 v12, s[8:11], s69 offen offset:2048 sc1 lds
  v_mfma_f32_16x16x32_bf16 v[48:51], v[144:147], v[112:115], v[48:51]
  s_waitcnt vmcnt(3)
  s_barrier
  v_mfma_f32_16x16x32_bf16 v[68:71], v[144:147], v[120:123], v[68:71]
  ds_read_b128 v[100:103], v1 offset:34816
  ds_write_b16 v21, v16
  v_mfma_f32_16x16x32_bf16 v[68:71], v[156:159], v[116:119], v[68:71]
  ds_read_b64_tr_b16 v[212:213], v7 offset:16384
  buffer_load_dwordx4 v12, s[8:11], s69 offen offset:3072 sc1 lds
  v_mfma_f32_16x16x32_bf16 v[60:63], v[152:155], v[116:119], v[60:63]
  ds_read_b128 v[104:107], v1 offset:35840
  v_mfma_f32_16x16x32_bf16 v[60:63], v[140:143], v[120:123], v[60:63]
  s_waitcnt lgkmcnt(4)
  ds_read_b64_tr_b16 v[214:215], v7 offset:18432
  v_mfma_f32_16x16x32_bf16 v[28:31], v[160:163], v[76:79], v[28:31]
  ds_read_b64_tr_b16 v[216:217], v8 offset:16384
  s_add_u32 m0, s70, 114688
  s_add_u32 s69, s59, 98304
  v_mfma_f32_16x16x32_bf16 v[28:31], v[172:175], v[80:83], v[28:31]
  ds_read_b128 v[108:111], v1 offset:43008
  buffer_load_dwordx4 v12, s[8:11], s69 offen offset:0 sc1 lds
  v_mfma_f32_16x16x32_bf16 v[32:35], v[172:175], v[88:91], v[32:35]
  ds_read_b64_tr_b16 v[218:219], v8 offset:18432
  v_mfma_f32_16x16x32_bf16 v[32:35], v[160:163], v[84:87], v[32:35]
  ds_read_b64_tr_b16 v[224:225], v7 offset:20480
  v_mfma_f32_16x16x32_bf16 v[40:43], v[164:167], v[84:87], v[40:43]
  ds_read_b128 v[112:115], v1 offset:44032
  v_mfma_f32_16x16x32_bf16 v[40:43], v[176:179], v[88:91], v[40:43]
  ds_read_b64_tr_b16 v[226:227], v7 offset:22528
  buffer_load_dwordx4 v12, s[8:11], s69 offen offset:1024 sc1 lds
  v_mfma_f32_16x16x32_bf16 v[36:39], v[176:179], v[80:83], v[36:39]
  ds_read_b128 v[116:119], v13 offset:26624
  v_mfma_f32_16x16x32_bf16 v[36:39], v[164:167], v[76:79], v[36:39]
  ds_read_b64_tr_b16 v[228:229], v8 offset:20480
  v_mfma_f32_16x16x32_bf16 v[44:47], v[168:171], v[76:79], v[44:47]
  ds_read_b64_tr_b16 v[230:231], v8 offset:22528
  v_mfma_f32_16x16x32_bf16 v[44:47], v[180:183], v[80:83], v[44:47]
  ds_read_b128 v[120:123], v13 offset:27648
  buffer_load_dwordx4 v12, s[8:11], s69 offen offset:2048 sc1 lds
  v_mfma_f32_16x16x32_bf16 v[48:51], v[180:183], v[88:91], v[48:51]
  ds_read_b64_tr_b16 v[236:237], v7 offset:24576
  v_mfma_f32_16x16x32_bf16 v[48:51], v[168:171], v[84:87], v[48:51]
  ds_read_b64_tr_b16 v[238:239], v7 offset:26624
  v_mfma_f32_16x16x32_bf16 v[68:71], v[168:171], v[92:95], v[68:71]
  ds_read_b128 v[76:79], v1 offset:36864
  v_mfma_f32_16x16x32_bf16 v[68:71], v[180:183], v[96:99], v[68:71]
  ds_read_b64_tr_b16 v[240:241], v8 offset:24576
  buffer_load_dwordx4 v12, s[8:11], s69 offen offset:3072 sc1 lds
  v_mfma_f32_16x16x32_bf16 v[60:63], v[176:179], v[96:99], v[60:63]
  ds_read_b128 v[80:83], v1 offset:37888
  v_mfma_f32_16x16x32_bf16 v[60:63], v[164:167], v[92:95], v[60:63]
  s_waitcnt lgkmcnt(5)
  ds_read_b64_tr_b16 v[242:243], v8 offset:26624
  v_mfma_f32_16x16x32_bf16 v[28:31], v[184:187], v[100:103], v[28:31]
  ds_read_b64_tr_b16 v[248:249], v7 offset:28672
  s_add_u32 m0, s70, 0
  s_add_u32 s69, s60, 98304
  v_mfma_f32_16x16x32_bf16 v[28:31], v[196:199], v[104:107], v[28:31]
  ds_read_b128 v[88:91], v1 offset:45056
  buffer_load_dwordx4 v12, s[8:11], s69 offen offset:0 sc1 lds
  v_mfma_f32_16x16x32_bf16 v[32:35], v[196:199], v[112:115], v[32:35]
  ds_read_b64_tr_b16 v[250:251], v7 offset:30720
  v_mfma_f32_16x16x32_bf16 v[32:35], v[184:187], v[108:111], v[32:35]
  ds_read_b64_tr_b16 v[252:253], v8 offset:28672
  v_mfma_f32_16x16x32_bf16 v[40:43], v[188:191], v[108:111], v[40:43]
  ds_read_b128 v[84:87], v1 offset:46080
  v_mfma_f32_16x16x32_bf16 v[40:43], v[200:203], v[112:115], v[40:43]
  ds_read_b64_tr_b16 v[254:255], v8 offset:30720
  buffer_load_dwordx4 v12, s[8:11], s69 offen offset:1024 sc1 lds
  v_mfma_f32_16x16x32_bf16 v[36:39], v[200:203], v[104:107], v[36:39]
  ds_read_b128 v[96:99], v13 offset:28672
  v_mfma_f32_16x16x32_bf16 v[36:39], v[188:191], v[100:103], v[36:39]
  v_mfma_f32_16x16x32_bf16 v[44:47], v[192:195], v[100:103], v[44:47]
  v_mfma_f32_16x16x32_bf16 v[44:47], v[204:207], v[104:107], v[44:47]
  ds_read_b128 v[92:95], v13 offset:29696
  v_mfma_f32_16x16x32_bf16 v[48:51], v[204:207], v[112:115], v[48:51]
  buffer_load_dwordx4 v12, s[8:11], s69 offen offset:2048 sc1 lds
  v_mfma_f32_16x16x32_bf16 v[48:51], v[192:195], v[108:111], v[48:51]
  v_mfma_f32_16x16x32_bf16 v[68:71], v[192:195], v[116:119], v[68:71]
  ds_read_b128 v[100:103], v1 offset:38912
  v_mfma_f32_16x16x32_bf16 v[68:71], v[204:207], v[120:123], v[68:71]
  buffer_load_dwordx4 v12, s[8:11], s69 offen offset:3072 sc1 lds
  v_mfma_f32_16x16x32_bf16 v[60:63], v[200:203], v[120:123], v[60:63]
  ds_read_b128 v[104:107], v1 offset:39936
  s_mov_b32 s30, 7340032
  v_mfma_f32_16x16x32_bf16 v[60:63], v[188:191], v[116:119], v[60:63]
  s_waitcnt lgkmcnt(2)
  s_mov_b32 s31, 131072
  s_mov_b32 s34, 7340032
  v_mfma_f32_16x16x32_bf16 v[28:31], v[208:211], v[76:79], v[28:31]
  s_add_u32 m0, s45, 16384
  s_mov_b32 s68, 0
  v_mfma_f32_16x16x32_bf16 v[28:31], v[220:223], v[80:83], v[28:31]
  ds_read_b128 v[112:115], v1 offset:47104
  s_mov_b32 s35, 131072
  v_mfma_f32_16x16x32_bf16 v[32:35], v[220:223], v[84:87], v[32:35]
  buffer_load_dwordx4 v11, s[20:23], s68 offen nt lds
  s_mov_b32 s38, 7340032
  s_mov_b32 s39, 131072
  v_mfma_f32_16x16x32_bf16 v[32:35], v[208:211], v[88:91], v[32:35]
  s_add_u32 m0, s45, 20480
  s_add_u32 s68, s68, 393216
  s_mov_b32 s42, 4194304
  v_mfma_f32_16x16x32_bf16 v[40:43], v[212:215], v[88:91], v[40:43]
  ds_read_b128 v[108:111], v1 offset:48128
  s_mov_b32 s43, 131072
  v_mfma_f32_16x16x32_bf16 v[40:43], v[224:227], v[84:87], v[40:43]
  buffer_load_dwordx4 v11, s[20:23], s68 offen nt lds
  v_add_u32 v9, s78, v1
  v_and_b32 v4, 0xffffbfff, v4
  v_mfma_f32_16x16x32_bf16 v[36:39], v[224:227], v[80:83], v[36:39]
  ds_read_b128 v[120:123], v13 offset:30720
  v_and_b32 v5, 0xffffbfff, v5
  v_mfma_f32_16x16x32_bf16 v[36:39], v[212:215], v[76:79], v[36:39]
  v_and_b32 v7, 0xffffbfff, v7
  v_and_b32 v8, 0xffffbfff, v8
  v_mfma_f32_16x16x32_bf16 v[44:47], v[216:219], v[76:79], v[44:47]
  s_add_u32 m0, s45, 24576
  s_add_u32 s68, s68, 393216
  s_lshl_b32 s52, s44, 13
  v_mfma_f32_16x16x32_bf16 v[44:47], v[228:231], v[80:83], v[44:47]
  ds_read_b128 v[116:119], v13 offset:31744
  s_and_b32 s52, s52, 8192
  v_mfma_f32_16x16x32_bf16 v[48:51], v[228:231], v[84:87], v[48:51]
  buffer_load_dwordx4 v11, s[20:23], s68 offen nt lds
  v_add_u32 v22, s52, v1
  v_add_u32 v23, s52, v2
  v_mfma_f32_16x16x32_bf16 v[48:51], v[216:219], v[88:91], v[48:51]
  s_waitcnt vmcnt(11) lgkmcnt(8)
  s_barrier
  v_mfma_f32_16x16x32_bf16 v[68:71], v[216:219], v[96:99], v[68:71]
  ds_read_b128 v[76:79], v1 offset:49152
  s_add_u32 m0, s45, 28672
  s_add_u32 s68, s68, 393216
  v_mfma_f32_16x16x32_bf16 v[68:71], v[228:231], v[92:95], v[68:71]
  buffer_load_dwordx4 v11, s[20:23], s68 offen nt lds
  v_and_b32 v14, 15, v0
  v_lshlrev_b32 v14, 7, v14
  v_mfma_f32_16x16x32_bf16 v[60:63], v[224:227], v[92:95], v[60:63]
  v_mfma_f32_16x16x32_bf16 v[60:63], v[212:215], v[96:99], v[60:63]
  s_waitcnt lgkmcnt(1)
  ds_read_b128 v[80:83], v1 offset:50176
  v_mfma_f32_16x16x32_bf16 v[28:31], v[232:235], v[100:103], v[28:31]
  s_add_u32 m0, s70, 65536
  s_add_u32 s69, s61, 98304
  v_mfma_f32_16x16x32_bf16 v[28:31], v[244:247], v[104:107], v[28:31]
  buffer_load_dwordx4 v12, s[8:11], s69 offen offset:0 sc1 lds
  v_mfma_f32_16x16x32_bf16 v[32:35], v[244:247], v[108:111], v[32:35]
  ds_read_b128 v[84:87], v1 offset:57344
  v_mfma_f32_16x16x32_bf16 v[32:35], v[232:235], v[112:115], v[32:35]
  v_mfma_f32_16x16x32_bf16 v[40:43], v[236:239], v[112:115], v[40:43]
  v_mfma_f32_16x16x32_bf16 v[40:43], v[248:251], v[108:111], v[40:43]
  ds_read_b128 v[88:91], v1 offset:58368
  v_mfma_f32_16x16x32_bf16 v[36:39], v[248:251], v[104:107], v[36:39]
  buffer_load_dwordx4 v12, s[8:11], s69 offen offset:1024 sc1 lds
  v_mfma_f32_16x16x32_bf16 v[36:39], v[236:239], v[100:103], v[36:39]
  v_mfma_f32_16x16x32_bf16 v[44:47], v[240:243], v[100:103], v[44:47]
  ds_read_b128 v[92:95], v1 offset:51200
  v_mfma_f32_16x16x32_bf16 v[44:47], v[252:255], v[104:107], v[44:47]
  buffer_load_dwordx4 v12, s[8:11], s69 offen offset:2048 sc1 lds
  v_mfma_f32_16x16x32_bf16 v[48:51], v[252:255], v[108:111], v[48:51]
  v_mfma_f32_16x16x32_bf16 v[48:51], v[240:243], v[112:115], v[48:51]
  ds_read_b128 v[96:99], v1 offset:52224
  v_mfma_f32_16x16x32_bf16 v[68:71], v[240:243], v[120:123], v[68:71]
  v_mfma_f32_16x16x32_bf16 v[68:71], v[252:255], v[116:119], v[68:71]
  buffer_load_dwordx4 v12, s[8:11], s69 offen offset:3072 sc1 lds
  v_mfma_f32_16x16x32_bf16 v[60:63], v[248:251], v[116:119], v[60:63]
  ds_read_b128 v[100:103], v1 offset:59392
  v_mfma_f32_16x16x32_bf16 v[60:63], v[236:239], v[120:123], v[60:63]
  s_waitcnt lgkmcnt(3)
  v_mfma_f32_16x16x32_bf16 v[52:55], a[0:3], v[76:79], 0
  s_add_u32 m0, s70, 98304
  s_add_u32 s69, s58, 163840
  v_mfma_f32_16x16x32_bf16 v[52:55], a[12:15], v[80:83], v[52:55]
  ds_read_b128 v[104:107], v1 offset:60416
  v_mfma_f32_16x16x32_bf16 v[56:59], a[12:15], v[88:91], 0
  buffer_load_dwordx4 v12, s[8:11], s69 offen offset:0 sc1 lds
  v_cvt_pk_bf16_f32 v60, v60, v61
  v_cvt_pk_bf16_f32 v61, v62, v63
  v_cvt_pk_bf16_f32 v62, v68, v69
  v_cvt_pk_bf16_f32 v63, v70, v71
  ds_write_b128 v17, v[60:63] offset:1024
  v_mfma_f32_16x16x32_bf16 v[56:59], a[0:3], v[84:87], v[56:59]
  v_cvt_pk_bf16_f32 v28, v28, v29
  v_cvt_pk_bf16_f32 v29, v30, v31
  v_mfma_f32_16x16x32_bf16 v[64:67], a[4:7], v[84:87], 0
  ds_read_b128 v[108:111], v1 offset:53248
  v_mfma_f32_16x16x32_bf16 v[64:67], a[16:19], v[88:91], v[64:67]
  ds_write_b64 v18, v[28:29] offset:6144
  v_mfma_f32_16x16x32_bf16 v[60:63], a[16:19], v[80:83], 0
  buffer_load_dwordx4 v12, s[8:11], s69 offen offset:1024 sc1 lds
  v_cvt_pk_bf16_f32 v36, v36, v37
  v_cvt_pk_bf16_f32 v37, v38, v39
  v_mfma_f32_16x16x32_bf16 v[60:63], a[4:7], v[76:79], v[60:63]
  ds_read_b128 v[112:115], v1 offset:54272
  v_cvt_pk_bf16_f32 v38, v44, v45
  v_mfma_f32_16x16x32_bf16 v[68:71], a[8:11], v[76:79], 0
  v_cvt_pk_bf16_f32 v39, v46, v47
  v_mfma_f32_16x16x32_bf16 v[68:71], a[20:23], v[80:83], v[68:71]
  ds_write_b128 v17, v[36:39] offset:7168
  v_mfma_f32_16x16x32_bf16 v[72:75], a[20:23], v[88:91], 0
  ds_read_b128 v[76:79], v1 offset:61440
  v_cvt_pk_bf16_f32 v32, v32, v33
  v_mfma_f32_16x16x32_bf16 v[72:75], a[8:11], v[84:87], v[72:75]
HOP2:
  s_cbranch_execz HOP6
  s_waitcnt lgkmcnt(6)
  v_cvt_pk_bf16_f32 v33, v34, v35
  v_mfma_f32_16x16x32_bf16 v[52:55], a[24:27], v[92:95], v[52:55]
  buffer_load_dwordx4 v12, s[8:11], s69 offen offset:2048 sc1 lds
  ds_write_b64 v18, v[32:33] offset:12288
  v_mfma_f32_16x16x32_bf16 v[52:55], a[36:39], v[96:99], v[52:55]
  ds_read_b128 v[80:83], v1 offset:62464
  v_cvt_pk_bf16_f32 v40, v40, v41
  v_mfma_f32_16x16x32_bf16 v[56:59], a[36:39], v[104:107], v[56:59]
  v_cvt_pk_bf16_f32 v41, v42, v43
  v_cvt_pk_bf16_f32 v42, v48, v49
  v_mfma_f32_16x16x32_bf16 v[56:59], a[24:27], v[100:103], v[56:59]
  v_cvt_pk_bf16_f32 v43, v50, v51
  v_mfma_f32_16x16x32_bf16 v[64:67], a[28:31], v[100:103], v[64:67]
  ds_read_b128 v[88:91], v1 offset:55296
  v_mfma_f32_16x16x32_bf16 v[64:67], a[40:43], v[104:107], v[64:67]
  buffer_load_dwordx4 v12, s[8:11], s69 offen offset:3072 sc1 lds
  ds_write_b128 v17, v[40:43] offset:13312
  v_mfma_f32_16x16x32_bf16 v[60:63], a[40:43], v[96:99], v[60:63]
  s_bitcmp1_b32 s44, 0
  s_mov_b32 s52, 6144
  s_cselect_b32 s52, 12288, s52
  s_mov_b32 s53, 0
  s_cselect_b32 s53, 6144, s53
  v_mfma_f32_16x16x32_bf16 v[60:63], a[28:31], v[92:95], v[60:63]
  ds_read_b128 v[84:87], v1 offset:56320
  v_add_u32 v116, s52, v19
  v_mfma_f32_16x16x32_bf16 v[68:71], a[32:35], v[92:95], v[68:71]
  s_add_u32 m0, s45, 81920
  s_mov_b32 s68, 1572864
  v_mfma_f32_16x16x32_bf16 v[68:71], a[44:47], v[96:99], v[68:71]
  buffer_load_dwordx4 v11, s[20:23], s68 offen nt lds
  v_add_u32 v117, s53, v19
  v_add_u32 v118, s52, v20
  v_mfma_f32_16x16x32_bf16 v[72:75], a[44:47], v[104:107], v[72:75]
  ds_read_b128 v[92:95], v1 offset:63488
  v_add_u32 v119, s53, v20
  v_mfma_f32_16x16x32_bf16 v[72:75], a[32:35], v[100:103], v[72:75]
  s_waitcnt lgkmcnt(4)
  v_mfma_f32_16x16x32_bf16 v[52:55], a[48:51], v[108:111], v[52:55]
  s_waitcnt vmcnt(17) lgkmcnt(2)
  s_barrier
  v_mfma_f32_16x16x32_bf16 v[52:55], a[60:63], v[112:115], v[52:55]
  ds_read_b128 v[96:99], v1 offset:64512
  s_add_u32 m0, s45, 86016
  s_add_u32 s68, s68, 393216
  v_mfma_f32_16x16x32_bf16 v[56:59], a[60:63], v[80:83], v[56:59]
  buffer_load_dwordx4 v11, s[20:23], s68 offen nt lds
  ds_read_b128 v[28:31], v116
  v_mfma_f32_16x16x32_bf16 v[56:59], a[48:51], v[76:79], v[56:59]
  ds_read_b128 v[32:35], v117 offset:1024
  v_mfma_f32_16x16x32_bf16 v[64:67], a[52:55], v[76:79], v[64:67]
  ds_read_b128 v[104:107], v2 offset:49152
  v_mfma_f32_16x16x32_bf16 v[64:67], a[64:67], v[80:83], v[64:67]
  ds_read_b128 v[36:39], v116 offset:1024
  v_mfma_f32_16x16x32_bf16 v[60:63], a[64:67], v[112:115], v[60:63]
  s_add_u32 m0, s45, 90112
  s_add_u32 s68, s68, 393216
  v_mfma_f32_16x16x32_bf16 v[60:63], a[52:55], v[108:111], v[60:63]
  ds_read_b128 v[100:103], v2 offset:50176
  v_mfma_f32_16x16x32_bf16 v[68:71], a[56:59], v[108:111], v[68:71]
  buffer_load_dwordx4 v11, s[20:23], s68 offen nt lds
  ds_read_b64_tr_b16 v[40:41], v119 offset:2048
  v_mfma_f32_16x16x32_bf16 v[68:71], a[68:71], v[112:115], v[68:71]
  ds_read_b64_tr_b16 v[42:43], v118 offset:2048
  v_mfma_f32_16x16x32_bf16 v[72:75], a[68:71], v[80:83], v[72:75]
  ds_read_b128 v[108:111], v2 offset:57344
  v_mfma_f32_16x16x32_bf16 v[72:75], a[56:59], v[76:79], v[72:75]
  s_waitcnt lgkmcnt(8)
  s_add_u32 m0, s45, 94208
  s_add_u32 s68, s68, 393216
  v_mfma_f32_16x16x32_bf16 v[52:55], a[72:75], v[88:91], v[52:55]
  buffer_load_dwordx4 v11, s[20:23], s68 offen nt lds
  ds_read_b64_tr_b16 v[44:45], v119 offset:2056
  v_mfma_f32_16x16x32_bf16 v[52:55], a[84:87], v[84:87], v[52:55]
  ds_read_b128 v[112:115], v2 offset:58368
  v_mfma_f32_16x16x32_bf16 v[56:59], a[84:87], v[96:99], v[56:59]
  ds_read_b64_tr_b16 v[46:47], v118 offset:2056
  v_mfma_f32_16x16x32_bf16 v[56:59], a[72:75], v[92:95], v[56:59]
  s_add_u32 m0, s70, 32768
  s_add_u32 s69, s59, 163840
  v_mfma_f32_16x16x32_bf16 v[64:67], a[76:79], v[92:95], v[64:67]
  ds_read_b128 v[80:83], v2 offset:51200
  v_mfma_f32_16x16x32_bf16 v[64:67], a[88:91], v[96:99], v[64:67]
  buffer_load_dwordx4 v12, s[8:11], s69 offen offset:0 sc1 lds
  v_mfma_f32_16x16x32_bf16 v[60:63], a[88:91], v[84:87], v[60:63]
  v_mfma_f32_16x16x32_bf16 v[60:63], a[76:79], v[88:91], v[60:63]
  ds_read_b128 v[76:79], v2 offset:52224
  s_waitcnt lgkmcnt(2)
  v_mfma_f32_16x16x32_bf16 v[116:119], v[32:35], v[28:31], 0
  v_mfma_f32_16x16x32_bf16 v[120:123], v[36:39], v[28:31], 0
  v_mfma_f32_16x16x32_bf16 v[68:71], a[80:83], v[88:91], v[68:71]
  v_mfma_f32_16x16x32_bf16 v[68:71], a[92:95], v[84:87], v[68:71]
  v_mfma_f32_16x16x32_bf16 v[72:75], a[92:95], v[96:99], v[72:75]
  ds_read_b128 v[88:91], v2 offset:59392
  v_mfma_f32_16x16x32_bf16 v[72:75], a[80:83], v[92:95], v[72:75]
  s_waitcnt lgkmcnt(4)
  buffer_load_dwordx4 v12, s[8:11], s69 offen offset:1024 sc1 lds
  s_nop 0
  v_cndmask_b32 v48, v116, v120, s[80:81]
  v_mfma_f32_16x16x32_bf16 v[52:55], a[96:99], v[104:107], v[52:55]
  v_cndmask_b32 v49, v117, v121, s[82:83]
  v_cndmask_b32 v50, v118, v122, s[84:85]
  v_mfma_f32_16x16x32_bf16 v[52:55], a[108:111], v[100:103], v[52:55]
  ds_read_b128 v[84:87], v2 offset:60416
  v_cndmask_b32 v51, v119, v123, s[86:87]
  v_mfma_f32_16x16x32_bf16 v[56:59], a[108:111], v[112:115], v[56:59]
  v_cndmask_b32 v48, v48, v49, s[88:89]
  v_cndmask_b32 v49, v50, v51, s[88:89]
  v_mfma_f32_16x16x32_bf16 v[56:59], a[96:99], v[108:111], v[56:59]
  buffer_load_dwordx4 v12, s[8:11], s69 offen offset:2048 sc1 lds
  v_mul_f32 v48, 0x3e8293ee, v48
  v_mul_f32 v49, 0x3e8293ee, v49
  v_mfma_f32_16x16x32_bf16 v[64:67], a[100:103], v[108:111], v[64:67]
  ds_read_b128 v[96:99], v2 offset:53248
  v_mov_b32 v50, 0xce6e6b28
  v_mfma_f32_16x16x32_bf16 v[64:67], a[112:115], v[112:115], v[64:67]
  v_cndmask_b32 v48, v48, v50, s[90:91]
  v_cndmask_b32 v49, v49, v50, s[92:93]
  v_mfma_f32_16x16x32_bf16 v[60:63], a[112:115], v[100:103], v[60:63]
  v_max_f32 v50, v48, v49
  v_mov_b32 v51, v50
  v_mfma_f32_16x16x32_bf16 v[60:63], a[100:103], v[104:107], v[60:63]
  ds_read_b128 v[92:95], v2 offset:54272
  v_mfma_f32_16x16x32_bf16 v[68:71], a[104:107], v[104:107], v[68:71]
  buffer_load_dwordx4 v12, s[8:11], s69 offen offset:3072 sc1 lds
  v_permlane16_swap_b32 v50, v51
  v_mfma_f32_16x16x32_bf16 v[68:71], a[116:119], v[100:103], v[68:71]
  v_max_f32 v50, v50, v51
  v_mov_b32 v51, v50
  v_mfma_f32_16x16x32_bf16 v[72:75], a[116:119], v[112:115], v[72:75]
  ds_read_b128 v[104:107], v2 offset:61440
  v_mfma_f32_16x16x32_bf16 v[72:75], a[104:107], v[108:111], v[72:75]
  s_waitcnt lgkmcnt(3)
  v_permlane32_swap_b32 v50, v51
  v_mfma_f32_16x16x32_bf16 v[52:55], a[120:123], v[80:83], v[52:55]
  v_max_f32 v50, v50, v51
  v_sub_f32 v48, v48, v50
  v_mfma_f32_16x16x32_bf16 v[52:55], a[132:135], v[76:79], v[52:55]
  ds_read_b128 v[100:103], v2 offset:62464
  v_sub_f32 v49, v49, v50
  v_mfma_f32_16x16x32_bf16 v[56:59], a[132:135], v[84:87], v[56:59]
  v_exp_f32 v48, v48
  v_mfma_f32_16x16x32_bf16 v[56:59], a[120:123], v[88:91], v[56:59]
  v_exp_f32 v49, v49
  v_mfma_f32_16x16x32_bf16 v[64:67], a[124:127], v[88:91], v[64:67]
  ds_read_b128 v[112:115], v2 offset:55296
  v_add_f32 v50, v48, v49
  v_mfma_f32_16x16x32_bf16 v[64:67], a[136:139], v[84:87], v[64:67]
  v_mov_b32 v51, v50
  v_mfma_f32_16x16x32_bf16 v[60:63], a[136:139], v[76:79], v[60:63]
  s_nop 0
  v_permlane16_swap_b32 v50, v51
  v_mfma_f32_16x16x32_bf16 v[60:63], a[124:127], v[80:83], v[60:63]
  ds_read_b128 v[108:111], v2 offset:56320
  v_add_f32 v50, v50, v51
  v_mfma_f32_16x16x32_bf16 v[68:71], a[128:131], v[80:83], v[68:71]
  v_mov_b32 v51, v50
  v_mfma_f32_16x16x32_bf16 v[68:71], a[140:143], v[76:79], v[68:71]
  s_nop 0
  v_permlane32_swap_b32 v50, v51
  v_mfma_f32_16x16x32_bf16 v[72:75], a[140:143], v[84:87], v[72:75]
  ds_read_b128 v[80:83], v2 offset:63488
  v_add_f32 v50, v50, v51
  v_mfma_f32_16x16x32_bf16 v[72:75], a[128:131], v[88:91], v[72:75]
  s_waitcnt lgkmcnt(3)
  v_rcp_f32 v50, v50
  v_mfma_f32_16x16x32_bf16 v[52:55], a[144:147], v[96:99], v[52:55]
  v_mul_f32 v48, v48, v50
  v_mul_f32 v49, v49, v50
  v_mfma_f32_16x16x32_bf16 v[52:55], a[156:159], v[92:95], v[52:55]
  ds_read_b128 v[76:79], v2 offset:64512
  v_cvt_pk_bf16_f32 v48, v48, v48
  v_mfma_f32_16x16x32_bf16 v[56:59], a[156:159], v[100:103], v[56:59]
  v_cvt_pk_bf16_f32 v49, v49, v49
  v_and_b32 v28, v24, v48
  v_mfma_f32_16x16x32_bf16 v[56:59], a[144:147], v[104:107], v[56:59]
  s_waitcnt vmcnt(12)
  s_barrier
  v_mfma_f32_16x16x32_bf16 v[64:67], a[148:151], v[104:107], v[64:67]
  ds_read_b128 v[84:87], v1 offset:0
  s_add_u32 m0, s70, 49152
  s_add_u32 s69, s60, 163840
  v_mfma_f32_16x16x32_bf16 v[64:67], a[160:163], v[100:103], v[64:67]
  buffer_load_dwordx4 v12, s[8:11], s69 offen offset:0 sc1 lds
  v_and_b32 v29, v25, v49
  v_and_b32 v30, v26, v48
  v_mfma_f32_16x16x32_bf16 v[60:63], a[160:163], v[92:95], v[60:63]
  v_and_b32 v31, v27, v49
  v_mfma_f32_16x16x32_bf16 v[60:63], a[148:151], v[96:99], v[60:63]
  ds_read_b128 v[88:91], v1 offset:1024
  v_mfma_f32_16x16x32_bf16 v[32:35], v[40:43], v[28:31], 0
  v_mfma_f32_16x16x32_bf16 v[36:39], v[44:47], v[28:31], 0
  v_mfma_f32_16x16x32_bf16 v[68:71], a[152:155], v[96:99], v[68:71]
  v_mfma_f32_16x16x32_bf16 v[68:71], a[164:167], v[92:95], v[68:71]
  v_mfma_f32_16x16x32_bf16 v[72:75], a[164:167], v[100:103], v[72:75]
  ds_read_b128 v[96:99], v1 offset:8192
  v_mfma_f32_16x16x32_bf16 v[72:75], a[152:155], v[104:107], v[72:75]
  s_waitcnt lgkmcnt(3)
  buffer_load_dwordx4 v12, s[8:11], s69 offen offset:1024 sc1 lds
  v_cvt_pk_bf16_f32 v116, v32, v33
  v_mfma_f32_16x16x32_bf16 v[52:55], a[168:171], v[112:115], v[52:55]
  v_cvt_pk_bf16_f32 v117, v34, v35
  v_cvt_pk_bf16_f32 v118, v36, v37
  v_mfma_f32_16x16x32_bf16 v[52:55], a[180:183], v[108:111], v[52:55]
  ds_read_b128 v[92:95], v1 offset:9216
  v_cvt_pk_bf16_f32 v119, v38, v39
  v_mfma_f32_16x16x32_bf16 v[56:59], a[180:183], v[76:79], v[56:59]
  buffer_store_dwordx4 v[116:119], v1, s[8:11], s73 offen sc1
  v_mfma_f32_16x16x32_bf16 v[56:59], a[168:171], v[80:83], v[56:59]
  buffer_load_dwordx4 v12, s[8:11], s69 offen offset:2048 sc1 lds
  s_add_u32 s73, s73, 65536
  v_mfma_f32_16x16x32_bf16 v[64:67], a[172:175], v[80:83], v[64:67]
  ds_read_b128 v[100:103], v1 offset:2048
  v_mfma_f32_16x16x32_bf16 v[64:67], a[184:187], v[76:79], v[64:67]
  v_mfma_f32_16x16x32_bf16 v[60:63], a[184:187], v[108:111], v[60:63]
  v_mfma_f32_16x16x32_bf16 v[60:63], a[172:175], v[112:115], v[60:63]
  ds_read_b128 v[104:107], v1 offset:3072
  v_mfma_f32_16x16x32_bf16 v[68:71], a[176:179], v[112:115], v[68:71]
  buffer_load_dwordx4 v12, s[8:11], s69 offen offset:3072 sc1 lds
  v_mfma_f32_16x16x32_bf16 v[68:71], a[188:191], v[108:111], v[68:71]
  v_mfma_f32_16x16x32_bf16 v[72:75], a[188:191], v[76:79], v[72:75]
  ds_read_b128 v[112:115], v1 offset:10240
  v_mfma_f32_16x16x32_bf16 v[72:75], a[176:179], v[80:83], v[72:75]
  s_waitcnt lgkmcnt(3)
  v_mfma_f32_16x16x32_bf16 v[52:55], a[192:195], v[84:87], v[52:55]
  v_mfma_f32_16x16x32_bf16 v[52:55], a[204:207], v[88:91], v[52:55]
  ds_read_b128 v[108:111], v1 offset:11264
  v_mfma_f32_16x16x32_bf16 v[56:59], a[204:207], v[92:95], v[56:59]
  v_mfma_f32_16x16x32_bf16 v[56:59], a[192:195], v[96:99], v[56:59]
  v_mfma_f32_16x16x32_bf16 v[64:67], a[196:199], v[96:99], v[64:67]
  ds_read_b128 v[76:79], v1 offset:4096
  v_lshrrev_b32 v40, 4, v0
  v_lshlrev_b32 v40, 4, v40
  v_mfma_f32_16x16x32_bf16 v[64:67], a[208:211], v[92:95], v[64:67]
  v_add_u32 v41, 149504, v40
  v_mfma_f32_16x16x32_bf16 v[60:63], a[208:211], v[88:91], v[60:63]
  ds_read_b64_tr_b16 v[116:117], v3 offset:16384
  v_mfma_f32_16x16x32_bf16 v[60:63], a[196:199], v[84:87], v[60:63]
  ds_read_b128 v[80:83], v1 offset:5120
  ds_read_b64_tr_b16 v[118:119], v3 offset:18432
  v_mfma_f32_16x16x32_bf16 v[68:71], a[200:203], v[84:87], v[68:71]
  ds_read_b128 v[28:31], v41 offset:0
  v_mfma_f32_16x16x32_bf16 v[68:71], a[212:215], v[88:91], v[68:71]
  v_mfma_f32_16x16x32_bf16 v[72:75], a[212:215], v[92:95], v[72:75]
  ds_read_b128 v[84:87], v1 offset:12288
  v_mfma_f32_16x16x32_bf16 v[72:75], a[200:203], v[96:99], v[72:75]
  s_waitcnt lgkmcnt(6)
  v_mfma_f32_16x16x32_bf16 v[52:55], a[216:219], v[100:103], v[52:55]
  v_mfma_f32_16x16x32_bf16 v[52:55], a[228:231], v[104:107], v[52:55]
  ds_read_b128 v[88:91], v1 offset:13312
  v_mfma_f32_16x16x32_bf16 v[56:59], a[228:231], v[108:111], v[56:59]
  v_mfma_f32_16x16x32_bf16 v[56:59], a[216:219], v[112:115], v[56:59]
  v_mfma_f32_16x16x32_bf16 v[64:67], a[220:223], v[112:115], v[64:67]
  ds_read_b128 v[92:95], v1 offset:6144
  ds_read_b64_tr_b16 v[120:121], v3 offset:20480
  v_mfma_f32_16x16x32_bf16 v[64:67], a[232:235], v[108:111], v[64:67]
  ds_read_b64_tr_b16 v[122:123], v3 offset:22528
  s_waitcnt lgkmcnt(5)
  v_mfma_f32_16x16x32_bf16 v[36:39], v[116:119], v[28:31], 0
  v_mfma_f32_16x16x32_bf16 v[60:63], a[232:235], v[104:107], v[60:63]
  ds_read_b128 v[32:35], v41 offset:64
  v_mfma_f32_16x16x32_bf16 v[60:63], a[220:223], v[100:103], v[60:63]
  ds_read_b128 v[96:99], v1 offset:7168
  v_mfma_f32_16x16x32_bf16 v[68:71], a[224:227], v[100:103], v[68:71]
  v_mfma_f32_16x16x32_bf16 v[68:71], a[236:239], v[104:107], v[68:71]
  v_mfma_f32_16x16x32_bf16 v[72:75], a[236:239], v[108:111], v[72:75]
  ds_read_b128 v[100:103], v1 offset:14336
  v_mfma_f32_16x16x32_bf16 v[72:75], a[224:227], v[112:115], v[72:75]
  s_waitcnt lgkmcnt(6)
  v_mfma_f32_16x16x32_bf16 v[52:55], a[240:243], v[76:79], v[52:55]
  v_mfma_f32_16x16x32_bf16 v[52:55], v[124:127], v[80:83], v[52:55]
  ds_read_b128 v[104:107], v1 offset:15360
  v_mfma_f32_16x16x32_bf16 v[56:59], v[124:127], v[88:91], v[56:59]
  ds_read_b64_tr_b16 v[116:117], v3 offset:24576
  v_and_b32 v42, 15, v0
  v_mfma_f32_16x16x32_bf16 v[56:59], a[240:243], v[84:87], v[56:59]
  ds_read_b64_tr_b16 v[118:119], v3 offset:26624
  s_waitcnt lgkmcnt(5)
  v_mfma_f32_16x16x32_bf16 v[36:39], v[120:123], v[32:35], v[36:39]
  v_lshl_add_u32 v40, v42, 27, v40
  s_lshr_b32 s52, s2, 2
  v_mfma_f32_16x16x32_bf16 v[64:67], a[244:247], v[84:87], v[64:67]
  ds_read_b128 v[108:111], v2 offset:0
  ds_read_b128 v[28:31], v41 offset:128
  v_mfma_f32_16x16x32_bf16 v[64:67], v[128:131], v[88:91], v[64:67]
  s_lshl_b32 s54, s52, 7
  s_lshl_b32 s52, s52, 8
  s_and_b32 s53, s2, 3
  v_mfma_f32_16x16x32_bf16 v[60:63], v[128:131], v[80:83], v[60:63]
  s_mul_i32 s79, s53, 24576
  s_add_u32 s52, s52, s79
  s_lshl_b32 s79, s44, 6
  v_mfma_f32_16x16x32_bf16 v[60:63], a[244:247], v[76:79], v[60:63]
  ds_read_b128 v[112:115], v2 offset:1024
  s_add_u32 s52, s52, s79
  v_mfma_f32_16x16x32_bf16 v[68:71], a[248:251], v[76:79], v[68:71]
  s_add_u32 s52, s52, 8192
  s_lshl_b32 s53, s53, 2
  s_add_u32 s54, s54, s53
  v_mfma_f32_16x16x32_bf16 v[68:71], v[132:135], v[80:83], v[68:71]
  s_add_u32 s54, s54, 720896
  s_cmp_eq_u32 s44, 0
  s_cselect_b32 s79, s54, 1073741824
  v_mfma_f32_16x16x32_bf16 v[72:75], v[132:135], v[88:91], v[72:75]
  ds_read_b128 v[76:79], v2 offset:8192
  v_mfma_f32_16x16x32_bf16 v[72:75], a[248:251], v[84:87], v[72:75]
  s_waitcnt lgkmcnt(6)
  v_mfma_f32_16x16x32_bf16 v[52:55], v[136:139], v[92:95], v[52:55]
  ds_read_b64_tr_b16 v[120:121], v3 offset:28672
  v_mfma_f32_16x16x32_bf16 v[52:55], v[148:151], v[96:99], v[52:55]
  ds_read_b128 v[80:83], v2 offset:9216
  ds_read_b64_tr_b16 v[122:123], v3 offset:30720
  s_waitcnt lgkmcnt(5)
  v_mfma_f32_16x16x32_bf16 v[36:39], v[116:119], v[28:31], v[36:39]
  v_mfma_f32_16x16x32_bf16 v[56:59], v[148:151], v[104:107], v[56:59]
  ds_read_b128 v[32:35], v41 offset:192
  v_mfma_f32_16x16x32_bf16 v[56:59], v[136:139], v[100:103], v[56:59]
  v_mfma_f32_16x16x32_bf16 v[64:67], v[140:143], v[100:103], v[64:67]
  ds_read_b128 v[88:91], v2 offset:2048
  v_mfma_f32_16x16x32_bf16 v[64:67], v[152:155], v[104:107], v[64:67]
  v_mfma_f32_16x16x32_bf16 v[60:63], v[152:155], v[96:99], v[60:63]
  v_mfma_f32_16x16x32_bf16 v[60:63], v[140:143], v[92:95], v[60:63]
  ds_read_b128 v[84:87], v2 offset:3072
  v_mfma_f32_16x16x32_bf16 v[68:71], v[144:147], v[92:95], v[68:71]
  v_mfma_f32_16x16x32_bf16 v[68:71], v[156:159], v[96:99], v[68:71]
  s_waitcnt vmcnt(9)
  s_barrier
  v_mfma_f32_16x16x32_bf16 v[72:75], v[156:159], v[104:107], v[72:75]
  ds_read_b128 v[92:95], v2 offset:10240
  ds_read_b64_tr_b16 v[116:117], v6 offset:16384
  v_mfma_f32_16x16x32_bf16 v[72:75], v[144:147], v[100:103], v[72:75]
  s_waitcnt lgkmcnt(6)
  ds_read_b64_tr_b16 v[118:119], v6 offset:18432
  s_add_u32 m0, s70, 114688
  s_add_u32 s69, s61, 163840
  s_waitcnt lgkmcnt(5)
  v_mfma_f32_16x16x32_bf16 v[36:39], v[120:123], v[32:35], v[36:39]
  v_mfma_f32_16x16x32_bf16 v[52:55], v[160:163], v[108:111], v[52:55]
  buffer_load_dwordx4 v12, s[8:11], s69 offen offset:0 sc1 lds
  ds_read_b128 v[28:31], v41 offset:256
  v_mfma_f32_16x16x32_bf16 v[52:55], v[172:175], v[112:115], v[52:55]
  ds_read_b128 v[96:99], v2 offset:11264
  v_mfma_f32_16x16x32_bf16 v[56:59], v[172:175], v[80:83], v[56:59]
  v_mfma_f32_16x16x32_bf16 v[56:59], v[160:163], v[76:79], v[56:59]
  v_mfma_f32_16x16x32_bf16 v[64:67], v[164:167], v[76:79], v[64:67]
  ds_read_b128 v[104:107], v2 offset:4096
  v_mfma_f32_16x16x32_bf16 v[64:67], v[176:179], v[80:83], v[64:67]
  buffer_load_dwordx4 v12, s[8:11], s69 offen offset:1024 sc1 lds
  v_mfma_f32_16x16x32_bf16 v[60:63], v[176:179], v[112:115], v[60:63]
  v_mfma_f32_16x16x32_bf16 v[60:63], v[164:167], v[108:111], v[60:63]
  ds_read_b128 v[100:103], v2 offset:5120
  v_mfma_f32_16x16x32_bf16 v[68:71], v[168:171], v[108:111], v[68:71]
  ds_read_b64_tr_b16 v[120:121], v6 offset:20480
  v_mfma_f32_16x16x32_bf16 v[68:71], v[180:183], v[112:115], v[68:71]
  ds_read_b64_tr_b16 v[122:123], v6 offset:22528
  buffer_load_dwordx4 v12, s[8:11], s69 offen offset:2048 sc1 lds
  s_waitcnt lgkmcnt(5)
  v_mfma_f32_16x16x32_bf16 v[36:39], v[116:119], v[28:31], v[36:39]
  v_mfma_f32_16x16x32_bf16 v[72:75], v[180:183], v[80:83], v[72:75]
  ds_read_b128 v[108:111], v2 offset:12288
  ds_read_b128 v[32:35], v41 offset:320
  v_mfma_f32_16x16x32_bf16 v[72:75], v[168:171], v[76:79], v[72:75]
  s_waitcnt lgkmcnt(6)
  v_mfma_f32_16x16x32_bf16 v[52:55], v[184:187], v[88:91], v[52:55]
  v_mfma_f32_16x16x32_bf16 v[52:55], v[196:199], v[84:87], v[52:55]
  ds_read_b128 v[112:115], v2 offset:13312
  v_mfma_f32_16x16x32_bf16 v[56:59], v[196:199], v[96:99], v[56:59]
  buffer_load_dwordx4 v12, s[8:11], s69 offen offset:3072 sc1 lds
  v_mfma_f32_16x16x32_bf16 v[56:59], v[184:187], v[92:95], v[56:59]
  v_mfma_f32_16x16x32_bf16 v[64:67], v[188:191], v[92:95], v[64:67]
  ds_read_b128 v[80:83], v2 offset:6144
  v_mfma_f32_16x16x32_bf16 v[64:67], v[200:203], v[96:99], v[64:67]
  v_mfma_f32_16x16x32_bf16 v[60:63], v[200:203], v[84:87], v[60:63]
  ds_read_b64_tr_b16 v[116:117], v6 offset:24576
  s_add_u32 m0, s70, 0
  s_add_u32 s69, s58, 229376
  v_mfma_f32_16x16x32_bf16 v[60:63], v[188:191], v[88:91], v[60:63]
  ds_read_b128 v[76:79], v2 offset:7168
  ds_read_b64_tr_b16 v[118:119], v6 offset:26624
  s_waitcnt lgkmcnt(5)
  v_mfma_f32_16x16x32_bf16 v[36:39], v[120:123], v[32:35], v[36:39]
  v_mfma_f32_16x16x32_bf16 v[68:71], v[192:195], v[88:91], v[68:71]
  buffer_load_dwordx4 v12, s[8:11], s69 offen offset:0 sc1 lds
  ds_read_b128 v[28:31], v41 offset:384
  v_mfma_f32_16x16x32_bf16 v[68:71], v[204:207], v[84:87], v[68:71]
  v_mfma_f32_16x16x32_bf16 v[72:75], v[204:207], v[96:99], v[72:75]
  ds_read_b128 v[88:91], v2 offset:14336
  v_mfma_f32_16x16x32_bf16 v[72:75], v[192:195], v[92:95], v[72:75]
  s_waitcnt lgkmcnt(6)
  v_mfma_f32_16x16x32_bf16 v[52:55], v[208:211], v[104:107], v[52:55]
  buffer_load_dwordx4 v12, s[8:11], s69 offen offset:1024 sc1 lds
  v_mfma_f32_16x16x32_bf16 v[52:55], v[220:223], v[100:103], v[52:55]
  ds_read_b128 v[84:87], v2 offset:15360
  v_mfma_f32_16x16x32_bf16 v[56:59], v[220:223], v[112:115], v[56:59]
  v_mfma_f32_16x16x32_bf16 v[56:59], v[208:211], v[108:111], v[56:59]
  v_mfma_f32_16x16x32_bf16 v[64:67], v[212:215], v[108:111], v[64:67]
  ds_read_b128 v[96:99], v2 offset:32768
  ds_read_b64_tr_b16 v[120:121], v6 offset:28672
  v_mfma_f32_16x16x32_bf16 v[64:67], v[224:227], v[112:115], v[64:67]
  ds_read_b64_tr_b16 v[122:123], v6 offset:30720
  s_waitcnt lgkmcnt(5)
  v_mfma_f32_16x16x32_bf16 v[36:39], v[116:119], v[28:31], v[36:39]
  v_mfma_f32_16x16x32_bf16 v[60:63], v[224:227], v[100:103], v[60:63]
  buffer_load_dwordx4 v12, s[8:11], s69 offen offset:2048 sc1 lds
  ds_read_b128 v[32:35], v41 offset:448
  v_mfma_f32_16x16x32_bf16 v[60:63], v[212:215], v[104:107], v[60:63]
  ds_read_b128 v[92:95], v2 offset:33792
  v_mfma_f32_16x16x32_bf16 v[68:71], v[216:219], v[104:107], v[68:71]
  v_mfma_f32_16x16x32_bf16 v[68:71], v[228:231], v[100:103], v[68:71]
  v_mfma_f32_16x16x32_bf16 v[72:75], v[228:231], v[112:115], v[72:75]
  ds_read_b128 v[104:107], v2 offset:40960
  v_mfma_f32_16x16x32_bf16 v[72:75], v[216:219], v[108:111], v[72:75]
  s_waitcnt lgkmcnt(6)
  buffer_load_dwordx4 v12, s[8:11], s69 offen offset:3072 sc1 lds
  v_mfma_f32_16x16x32_bf16 v[52:55], v[232:235], v[80:83], v[52:55]
  v_mfma_f32_16x16x32_bf16 v[52:55], v[244:247], v[76:79], v[52:55]
  ds_read_b128 v[100:103], v2 offset:41984
  v_mfma_f32_16x16x32_bf16 v[56:59], v[244:247], v[84:87], v[56:59]
  v_mfma_f32_16x16x32_bf16 v[56:59], v[232:235], v[88:91], v[56:59]
  s_waitcnt lgkmcnt(3)
  v_mfma_f32_16x16x32_bf16 v[36:39], v[120:123], v[32:35], v[36:39]
  v_mfma_f32_16x16x32_bf16 v[64:67], v[236:239], v[88:91], v[64:67]
  ds_read_b128 v[112:115], v2 offset:34816
  v_mfma_f32_16x16x32_bf16 v[64:67], v[248:251], v[84:87], v[64:67]
  v_mfma_f32_16x16x32_bf16 v[60:63], v[248:251], v[76:79], v[60:63]
  v_mfma_f32_16x16x32_bf16 v[60:63], v[236:239], v[80:83], v[60:63]
  ds_read_b128 v[108:111], v2 offset:35840
  v_mfma_f32_16x16x32_bf16 v[68:71], v[240:243], v[80:83], v[68:71]
  s_nop 0
  buffer_store_dwordx4 v[36:39], v40, s[8:11], s52 offen sc1
  v_mfma_f32_16x16x32_bf16 v[68:71], v[252:255], v[76:79], v[68:71]
  v_mfma_f32_16x16x32_bf16 v[72:75], v[252:255], v[84:87], v[72:75]
  ds_read_b128 v[80:83], v2 offset:43008
  v_mfma_f32_16x16x32_bf16 v[72:75], v[240:243], v[88:91], v[72:75]
  s_waitcnt lgkmcnt(3)
  v_mfma_f32_16x16x32_bf16 v[28:31], a[0:3], v[96:99], 0
  v_mfma_f32_16x16x32_bf16 v[28:31], a[12:15], v[92:95], v[28:31]
  ds_read_b128 v[76:79], v2 offset:44032
  v_mfma_f32_16x16x32_bf16 v[32:35], a[12:15], v[100:103], 0
  v_mfma_f32_16x16x32_bf16 v[32:35], a[0:3], v[104:107], v[32:35]
  v_cvt_pk_bf16_f32 v52, v52, v53
  v_cvt_pk_bf16_f32 v53, v54, v55
  v_mfma_f32_16x16x32_bf16 v[40:43], a[4:7], v[104:107], 0
  ds_read_b128 v[84:87], v2 offset:36864
  v_mfma_f32_16x16x32_bf16 v[40:43], a[16:19], v[100:103], v[40:43]
  ds_write_b64 v18, v[52:53] offset:0
  v_mfma_f32_16x16x32_bf16 v[36:39], a[16:19], v[92:95], 0
  v_cvt_pk_bf16_f32 v60, v60, v61
  v_cvt_pk_bf16_f32 v61, v62, v63
  v_mfma_f32_16x16x32_bf16 v[36:39], a[4:7], v[96:99], v[36:39]
  ds_read_b128 v[88:91], v2 offset:37888
  v_cvt_pk_bf16_f32 v62, v68, v69
  v_cvt_pk_bf16_f32 v63, v70, v71
  v_mfma_f32_16x16x32_bf16 v[44:47], a[8:11], v[96:99], 0
  ds_write_b128 v17, v[60:63] offset:1024
  v_mfma_f32_16x16x32_bf16 v[44:47], a[20:23], v[92:95], v[44:47]
  v_cvt_pk_bf16_f32 v56, v56, v57
  v_cvt_pk_bf16_f32 v57, v58, v59
  v_mfma_f32_16x16x32_bf16 v[48:51], a[20:23], v[100:103], 0
  ds_read_b128 v[96:99], v2 offset:45056
  v_mfma_f32_16x16x32_bf16 v[48:51], a[8:11], v[104:107], v[48:51]
  s_waitcnt lgkmcnt(5)
  ds_write_b64 v18, v[56:57] offset:6144
  v_mfma_f32_16x16x32_bf16 v[28:31], a[24:27], v[112:115], v[28:31]
  v_cvt_pk_bf16_f32 v64, v64, v65
  v_cvt_pk_bf16_f32 v65, v66, v67
  v_mfma_f32_16x16x32_bf16 v[28:31], a[36:39], v[108:111], v[28:31]
  ds_read_b128 v[92:95], v2 offset:46080
  v_cvt_pk_bf16_f32 v66, v72, v73
  v_mfma_f32_16x16x32_bf16 v[32:35], a[36:39], v[76:79], v[32:35]
  v_cvt_pk_bf16_f32 v67, v74, v75
  v_mfma_f32_16x16x32_bf16 v[32:35], a[24:27], v[80:83], v[32:35]
  ds_write_b128 v17, v[64:67] offset:7168
  v_mfma_f32_16x16x32_bf16 v[40:43], a[28:31], v[80:83], v[40:43]
  ds_read_b128 v[100:103], v2 offset:38912
  v_mfma_f32_16x16x32_bf16 v[40:43], a[40:43], v[76:79], v[40:43]
  s_bitcmp1_b32 s44, 0
  s_mov_b32 s52, 0
  s_cselect_b32 s52, 6144, s52
  s_mov_b32 s53, 12288
  s_cselect_b32 s53, 0, s53
  v_mfma_f32_16x16x32_bf16 v[36:39], a[40:43], v[108:111], v[36:39]
  v_add_u32 v116, s52, v19
  v_add_u32 v117, s53, v19
  v_mfma_f32_16x16x32_bf16 v[36:39], a[28:31], v[112:115], v[36:39]
  ds_read_b128 v[104:107], v2 offset:39936
  v_add_u32 v118, s52, v20
  v_mfma_f32_16x16x32_bf16 v[44:47], a[32:35], v[112:115], v[44:47]
  v_add_u32 v119, s53, v20
  v_mfma_f32_16x16x32_bf16 v[44:47], a[44:47], v[108:111], v[44:47]
  s_waitcnt vmcnt(14) lgkmcnt(2)
  s_barrier
  v_mfma_f32_16x16x32_bf16 v[48:51], a[44:47], v[76:79], v[48:51]
  ds_read_b128 v[112:115], v2 offset:47104
  v_mfma_f32_16x16x32_bf16 v[48:51], a[32:35], v[80:83], v[48:51]
  s_waitcnt lgkmcnt(4)
  s_add_u32 m0, s45, 16384
  s_add_u32 s68, s67, 0
  s_and_b32 s68, s68, 7
  s_mul_i32 s68, s68, 262144
  v_mfma_f32_16x16x32_bf16 v[28:31], a[48:51], v[84:87], v[28:31]
  buffer_load_dwordx4 v10, s[16:19], s68 offen lds
  ds_read_b128 v[52:55], v116
  v_mfma_f32_16x16x32_bf16 v[28:31], a[60:63], v[88:91], v[28:31]
  ds_read_b128 v[108:111], v2 offset:48128
  v_mfma_f32_16x16x32_bf16 v[32:35], a[60:63], v[92:95], v[32:35]
  ds_read_b128 v[56:59], v117 offset:1024
  v_mfma_f32_16x16x32_bf16 v[32:35], a[48:51], v[96:99], v[32:35]
  s_add_u32 m0, s45, 20480
  s_add_u32 s68, s68, 65536
  v_mfma_f32_16x16x32_bf16 v[40:43], a[52:55], v[96:99], v[40:43]
  ds_read_b128 v[76:79], v1 offset:32768
  v_mfma_f32_16x16x32_bf16 v[40:43], a[64:67], v[92:95], v[40:43]
  buffer_load_dwordx4 v10, s[16:19], s68 offen lds
  ds_read_b128 v[60:63], v116 offset:1024
  v_mfma_f32_16x16x32_bf16 v[36:39], a[64:67], v[88:91], v[36:39]
  ds_read_b64_tr_b16 v[64:65], v119 offset:2048
  v_mfma_f32_16x16x32_bf16 v[36:39], a[52:55], v[84:87], v[36:39]
  ds_read_b128 v[80:83], v1 offset:33792
  v_mfma_f32_16x16x32_bf16 v[44:47], a[56:59], v[84:87], v[44:47]
  s_add_u32 m0, s45, 24576
  s_add_u32 s68, s68, 65536
  v_mfma_f32_16x16x32_bf16 v[44:47], a[68:71], v[88:91], v[44:47]
  buffer_load_dwordx4 v10, s[16:19], s68 offen lds
  ds_read_b64_tr_b16 v[66:67], v118 offset:2048
  v_mfma_f32_16x16x32_bf16 v[48:51], a[68:71], v[92:95], v[48:51]
  ds_read_b128 v[84:87], v1 offset:40960
  v_mfma_f32_16x16x32_bf16 v[48:51], a[56:59], v[96:99], v[48:51]
  s_waitcnt lgkmcnt(7)
  ds_read_b64_tr_b16 v[68:69], v119 offset:2056
  v_mfma_f32_16x16x32_bf16 v[28:31], a[72:75], v[100:103], v[28:31]
  s_add_u32 m0, s45, 28672
  s_add_u32 s68, s68, 65536
  v_mfma_f32_16x16x32_bf16 v[28:31], a[84:87], v[104:107], v[28:31]
  ds_read_b128 v[88:91], v1 offset:41984
  v_mfma_f32_16x16x32_bf16 v[32:35], a[84:87], v[108:111], v[32:35]
  buffer_load_dwordx4 v10, s[16:19], s68 offen lds
  ds_read_b64_tr_b16 v[70:71], v118 offset:2056
  v_mfma_f32_16x16x32_bf16 v[32:35], a[72:75], v[112:115], v[32:35]
  v_mfma_f32_16x16x32_bf16 v[40:43], a[76:79], v[112:115], v[40:43]
  ds_read_b128 v[92:95], v1 offset:34816
  v_mfma_f32_16x16x32_bf16 v[40:43], a[88:91], v[108:111], v[40:43]
  v_mfma_f32_16x16x32_bf16 v[36:39], a[88:91], v[104:107], v[36:39]
  s_add_u32 m0, s70, 65536
  s_add_u32 s69, s59, 229376
  v_mfma_f32_16x16x32_bf16 v[36:39], a[76:79], v[100:103], v[36:39]
  ds_read_b128 v[96:99], v1 offset:35840
  s_waitcnt lgkmcnt(2)
  v_mfma_f32_16x16x32_bf16 v[116:119], v[56:59], v[52:55], 0
  v_mfma_f32_16x16x32_bf16 v[120:123], v[60:63], v[52:55], 0
  v_mfma_f32_16x16x32_bf16 v[44:47], a[80:83], v[100:103], v[44:47]
  buffer_load_dwordx4 v12, s[8:11], s69 offen offset:0 sc1 lds
  v_mfma_f32_16x16x32_bf16 v[44:47], a[92:95], v[104:107], v[44:47]
  v_mfma_f32_16x16x32_bf16 v[48:51], a[92:95], v[108:111], v[48:51]
  ds_read_b128 v[100:103], v1 offset:43008
  v_mfma_f32_16x16x32_bf16 v[48:51], a[80:83], v[112:115], v[48:51]
  s_waitcnt lgkmcnt(4)
  s_nop 0
  v_cndmask_b32 v72, v116, v120, s[80:81]
HOP3:
  s_cbranch_execz WRET0
  v_cndmask_b32 v73, v117, v121, s[82:83]
  v_mfma_f32_16x16x32_bf16 v[28:31], a[96:99], v[76:79], v[28:31]
  buffer_load_dwordx4 v12, s[8:11], s69 offen offset:1024 sc1 lds
  v_cndmask_b32 v74, v118, v122, s[84:85]
  v_cndmask_b32 v75, v119, v123, s[86:87]
  v_mfma_f32_16x16x32_bf16 v[28:31], a[108:111], v[80:83], v[28:31]
  ds_read_b128 v[104:107], v1 offset:44032
  v_cndmask_b32 v72, v72, v73, s[88:89]
  v_mfma_f32_16x16x32_bf16 v[32:35], a[108:111], v[88:91], v[32:35]
  v_cndmask_b32 v73, v74, v75, s[88:89]
  v_mul_f32 v72, 0x3e8293ee, v72
  v_mfma_f32_16x16x32_bf16 v[32:35], a[96:99], v[84:87], v[32:35]
  v_mul_f32 v73, 0x3e8293ee, v73
  v_max_f32 v74, v72, v73
  v_mfma_f32_16x16x32_bf16 v[40:43], a[100:103], v[84:87], v[40:43]
  ds_read_b128 v[108:111], v1 offset:36864
  v_mov_b32 v75, v74
  v_mfma_f32_16x16x32_bf16 v[40:43], a[112:115], v[88:91], v[40:43]
  buffer_load_dwordx4 v12, s[8:11], s69 offen offset:2048 sc1 lds
  v_permlane16_swap_b32 v74, v75
  v_mfma_f32_16x16x32_bf16 v[36:39], a[112:115], v[80:83], v[36:39]
  v_max_f32 v74, v74, v75
  v_mov_b32 v75, v74
  v_mfma_f32_16x16x32_bf16 v[36:39], a[100:103], v[76:79], v[36:39]
  ds_read_b128 v[112:115], v1 offset:37888
  v_mfma_f32_16x16x32_bf16 v[44:47], a[104:107], v[76:79], v[44:47]
  v_permlane32_swap_b32 v74, v75
  v_mfma_f32_16x16x32_bf16 v[44:47], a[116:119], v[80:83], v[44:47]
  v_max_f32 v74, v74, v75
  v_sub_f32 v72, v72, v74
  v_mfma_f32_16x16x32_bf16 v[48:51], a[116:119], v[88:91], v[48:51]
  ds_read_b128 v[76:79], v1 offset:45056
  v_sub_f32 v73, v73, v74
  v_mfma_f32_16x16x32_bf16 v[48:51], a[104:107], v[84:87], v[48:51]
  s_waitcnt lgkmcnt(3)
  buffer_load_dwordx4 v12, s[8:11], s69 offen offset:3072 sc1 lds
  v_mfma_f32_16x16x32_bf16 v[28:31], a[120:123], v[92:95], v[28:31]
  v_exp_f32 v72, v72
  v_mfma_f32_16x16x32_bf16 v[28:31], a[132:135], v[96:99], v[28:31]
  ds_read_b128 v[80:83], v1 offset:46080
  v_mfma_f32_16x16x32_bf16 v[32:35], a[132:135], v[104:107], v[32:35]
  s_add_u32 m0, s45, 81920
  s_add_u32 s68, s67, 1
  s_and_b32 s68, s68, 7
  s_mul_i32 s68, s68, 262144
  v_mfma_f32_16x16x32_bf16 v[32:35], a[120:123], v[100:103], v[32:35]
  buffer_load_dwordx4 v10, s[16:19], s68 offen lds
  v_exp_f32 v73, v73
  v_mfma_f32_16x16x32_bf16 v[40:43], a[124:127], v[100:103], v[40:43]
  ds_read_b128 v[88:91], v1 offset:38912
  v_add_f32 v74, v72, v73
  v_mfma_f32_16x16x32_bf16 v[40:43], a[136:139], v[104:107], v[40:43]
  v_mov_b32 v75, v74
  v_mfma_f32_16x16x32_bf16 v[36:39], a[136:139], v[96:99], v[36:39]
  s_add_u32 m0, s45, 86016
  s_add_u32 s68, s68, 65536
  v_mfma_f32_16x16x32_bf16 v[36:39], a[124:127], v[92:95], v[36:39]
  ds_read_b128 v[84:87], v1 offset:39936
  v_mfma_f32_16x16x32_bf16 v[44:47], a[128:131], v[92:95], v[44:47]
  buffer_load_dwordx4 v10, s[16:19], s68 offen lds
  v_permlane16_swap_b32 v74, v75
  v_mfma_f32_16x16x32_bf16 v[44:47], a[140:143], v[96:99], v[44:47]
  v_add_f32 v74, v74, v75
  v_mov_b32 v75, v74
  v_mfma_f32_16x16x32_bf16 v[48:51], a[140:143], v[104:107], v[48:51]
  ds_read_b128 v[92:95], v1 offset:47104
  v_mfma_f32_16x16x32_bf16 v[48:51], a[128:131], v[100:103], v[48:51]
  s_waitcnt lgkmcnt(3)
  v_permlane32_swap_b32 v74, v75
  v_mfma_f32_16x16x32_bf16 v[28:31], a[144:147], v[108:111], v[28:31]
  s_add_u32 m0, s45, 90112
  s_add_u32 s68, s68, 65536
  v_add_f32 v74, v74, v75
  v_mfma_f32_16x16x32_bf16 v[28:31], a[156:159], v[112:115], v[28:31]
  ds_read_b128 v[96:99], v1 offset:48128
  v_mfma_f32_16x16x32_bf16 v[32:35], a[156:159], v[80:83], v[32:35]
  buffer_load_dwordx4 v10, s[16:19], s68 offen lds
  v_rcp_f32 v74, v74
  v_mfma_f32_16x16x32_bf16 v[32:35], a[144:147], v[76:79], v[32:35]
  s_waitcnt vmcnt(11)
  s_barrier
  v_mfma_f32_16x16x32_bf16 v[40:43], a[148:151], v[76:79], v[40:43]
  ds_read_b128 v[104:107], v1 offset:49152
  v_mul_f32 v72, v72, v74
  v_add_u32 v15, s46, v0
  s_mov_b64 exec, 1
  buffer_store_dword v15, v0, s[8:11], s79 offen offset:0 sc1
  s_mov_b64 exec, -1
  v_mfma_f32_16x16x32_bf16 v[40:43], a[160:163], v[80:83], v[40:43]
  s_add_u32 m0, s45, 94208
  s_add_u32 s68, s68, 65536
  v_mul_f32 v73, v73, v74
  v_mfma_f32_16x16x32_bf16 v[36:39], a[160:163], v[112:115], v[36:39]
  buffer_load_dwordx4 v10, s[16:19], s68 offen lds
  v_cvt_pk_bf16_f32 v72, v72, v72
  v_cvt_pk_bf16_f32 v73, v73, v73
  v_mfma_f32_16x16x32_bf16 v[36:39], a[148:151], v[108:111], v[36:39]
  ds_read_b128 v[100:103], v1 offset:50176
  v_and_b32 v52, v24, v72
  v_mfma_f32_16x16x32_bf16 v[44:47], a[152:155], v[108:111], v[44:47]
  v_and_b32 v53, v25, v73
  v_and_b32 v54, v26, v72
  v_mfma_f32_16x16x32_bf16 v[44:47], a[164:167], v[112:115], v[44:47]
  v_and_b32 v55, v27, v73
  v_mfma_f32_16x16x32_bf16 v[48:51], a[164:167], v[80:83], v[48:51]
  ds_read_b128 v[108:111], v1 offset:57344
  s_cmp_gt_u32 s44, 1
  s_cbranch_scc1 TH5_adaLN_cond__sliding_local_dilated__swiglu_ffn__prompt_kernel
  s_cmp_eq_u32 s44, 0
  s_cselect_b64 s[4:5], s[28:29], s[32:33]
  s_lshr_b32 s57, s2, 3
  s_mul_i32 s57, s57, 57344
  s_and_b32 vcc_lo, s2, 7
  s_mul_i32 vcc_lo, vcc_lo, 896
  s_add_u32 s57, s57, vcc_lo
  v_lshrrev_b32 v15, 3, v0
  v_mul_u32_u24 v15, 6144, v15
  v_lshl_add_u32 v15, v0, 7, v15
  s_mov_b32 exec_lo, 0x7f7f7f7f
  s_mov_b32 exec_hi, 0x7f7f7f7f
  buffer_load_dword a253, v15, s[4:7], s57 offen
  s_mov_b64 exec, -1
TH5_adaLN_cond__sliding_local_dilated__swiglu_ffn__prompt_kernel:
  v_mfma_f32_16x16x32_bf16 v[56:59], v[64:67], v[52:55], 0
  v_mfma_f32_16x16x32_bf16 v[60:63], v[68:71], v[52:55], 0
  v_mfma_f32_16x16x32_bf16 v[48:51], a[152:155], v[76:79], v[48:51]
  s_waitcnt lgkmcnt(3)
  s_add_u32 m0, s70, 98304
  s_add_u32 s69, s60, 229376
  v_mfma_f32_16x16x32_bf16 v[28:31], a[168:171], v[88:91], v[28:31]
  buffer_load_dwordx4 v12, s[8:11], s69 offen offset:0 sc1 lds
  v_mfma_f32_16x16x32_bf16 v[28:31], a[180:183], v[84:87], v[28:31]
  ds_read_b128 v[112:115], v1 offset:58368
  v_mfma_f32_16x16x32_bf16 v[32:35], a[180:183], v[96:99], v[32:35]
  v_cvt_pk_bf16_f32 v116, v56, v57
  v_cvt_pk_bf16_f32 v117, v58, v59
  v_mfma_f32_16x16x32_bf16 v[32:35], a[168:171], v[92:95], v[32:35]
  v_cvt_pk_bf16_f32 v118, v60, v61
  v_cvt_pk_bf16_f32 v119, v62, v63
  v_mfma_f32_16x16x32_bf16 v[40:43], a[172:175], v[92:95], v[40:43]
  ds_read_b128 v[80:83], v1 offset:51200
  v_mfma_f32_16x16x32_bf16 v[40:43], a[184:187], v[96:99], v[40:43]
  buffer_load_dwordx4 v12, s[8:11], s69 offen offset:1024 sc1 lds
  buffer_store_dwordx4 v[116:119], v1, s[8:11], s73 offen sc1
  v_mfma_f32_16x16x32_bf16 v[36:39], a[184:187], v[84:87], v[36:39]
  s_add_u32 s73, s73, 65536
  v_mfma_f32_16x16x32_bf16 v[36:39], a[172:175], v[88:91], v[36:39]
  ds_read_b128 v[76:79], v1 offset:52224
  v_mfma_f32_16x16x32_bf16 v[44:47], a[176:179], v[88:91], v[44:47]
  v_mfma_f32_16x16x32_bf16 v[44:47], a[188:191], v[84:87], v[44:47]
  buffer_load_dwordx4 v12, s[8:11], s69 offen offset:2048 sc1 lds
  v_mfma_f32_16x16x32_bf16 v[48:51], a[188:191], v[96:99], v[48:51]
  ds_read_b128 v[88:91], v1 offset:59392
  v_mfma_f32_16x16x32_bf16 v[48:51], a[176:179], v[92:95], v[48:51]
  s_waitcnt lgkmcnt(3)
  v_mfma_f32_16x16x32_bf16 v[28:31], a[192:195], v[104:107], v[28:31]
  v_mfma_f32_16x16x32_bf16 v[28:31], a[204:207], v[100:103], v[28:31]
  ds_read_b128 v[84:87], v1 offset:60416
  v_mfma_f32_16x16x32_bf16 v[32:35], a[204:207], v[112:115], v[32:35]
  buffer_load_dwordx4 v12, s[8:11], s69 offen offset:3072 sc1 lds
  v_mfma_f32_16x16x32_bf16 v[32:35], a[192:195], v[108:111], v[32:35]
  v_mfma_f32_16x16x32_bf16 v[40:43], a[196:199], v[108:111], v[40:43]
  ds_read_b128 v[96:99], v1 offset:53248
  v_mfma_f32_16x16x32_bf16 v[40:43], a[208:211], v[112:115], v[40:43]
  v_mfma_f32_16x16x32_bf16 v[36:39], a[208:211], v[100:103], v[36:39]
  v_mfma_f32_16x16x32_bf16 v[36:39], a[196:199], v[104:107], v[36:39]
  ds_read_b128 v[92:95], v1 offset:54272
  v_mfma_f32_16x16x32_bf16 v[44:47], a[200:203], v[104:107], v[44:47]
  v_mfma_f32_16x16x32_bf16 v[44:47], a[212:215], v[100:103], v[44:47]
  v_mfma_f32_16x16x32_bf16 v[48:51], a[212:215], v[112:115], v[48:51]
  ds_read_b128 v[104:107], v1 offset:61440
  v_mfma_f32_16x16x32_bf16 v[48:51], a[200:203], v[108:111], v[48:51]
  s_waitcnt lgkmcnt(3)
  v_mfma_f32_16x16x32_bf16 v[28:31], a[216:219], v[80:83], v[28:31]
  v_mfma_f32_16x16x32_bf16 v[28:31], a[228:231], v[76:79], v[28:31]
  ds_read_b128 v[100:103], v1 offset:62464
  v_mfma_f32_16x16x32_bf16 v[32:35], a[228:231], v[84:87], v[32:35]
  v_lshrrev_b32 v116, 3, v0
  v_bfe_u32 v117, v116, 1, 2
  v_mfma_f32_16x16x32_bf16 v[32:35], a[216:219], v[88:91], v[32:35]
  v_bfe_u32 v118, v0, 1, 2
  v_xor_b32 v117, v117, v118
  v_mfma_f32_16x16x32_bf16 v[40:43], a[220:223], v[88:91], v[40:43]
  ds_read_b128 v[112:115], v1 offset:55296
  s_lshl_b32 s52, s44, 3
  v_mfma_f32_16x16x32_bf16 v[40:43], a[232:235], v[84:87], v[40:43]
  v_add_u32 v116, s52, v116
  v_mul_u32_u24 v116, 7168, v116
  v_mfma_f32_16x16x32_bf16 v[36:39], a[232:235], v[76:79], v[36:39]
  v_and_b32 v118, 1, v0
  v_lshl_add_u32 v116, v118, 4, v116
  v_mfma_f32_16x16x32_bf16 v[36:39], a[220:223], v[80:83], v[36:39]
  ds_read_b128 v[108:111], v1 offset:56320
  s_and_b32 s52, s2, 7
  v_mfma_f32_16x16x32_bf16 v[44:47], a[224:227], v[80:83], v[44:47]
  s_mul_i32 s52, s52, 896
  v_add_u32 v116, s52, v116
  v_lshlrev_b32 v118, 5, v117
  v_mfma_f32_16x16x32_bf16 v[44:47], a[236:239], v[76:79], v[44:47]
  s_and_b32 s53, s2, 24
  s_lshl_b32 s52, s53, 5
  v_add3_u32 v16, v116, v118, s52
  v_mfma_f32_16x16x32_bf16 v[48:51], a[236:239], v[84:87], v[48:51]
  ds_read_b128 v[80:83], v1 offset:63488
  s_lshr_b32 s52, 0x0b070602, s53
  v_mfma_f32_16x16x32_bf16 v[48:51], a[224:227], v[88:91], v[48:51]
  s_waitcnt lgkmcnt(3)
  s_and_b32 s52, s52, 15
  s_lshl_b32 s52, s52, 6
  v_mfma_f32_16x16x32_bf16 v[28:31], a[240:243], v[96:99], v[28:31]
  v_add_u32 v118, s52, v118
  s_lshr_b32 s52, 0x15140706, s53
  v_mfma_f32_16x16x32_bf16 v[28:31], v[124:127], v[92:95], v[28:31]
  ds_read_b128 v[76:79], v1 offset:64512
  s_and_b32 s52, s52, 31
  v_mfma_f32_16x16x32_bf16 v[32:35], v[124:127], v[100:103], v[32:35]
  s_lshl_b32 s52, s52, 5
  v_mov_b32 v119, s52
  v_mfma_f32_16x16x32_bf16 v[32:35], a[240:243], v[104:107], v[32:35]
  s_waitcnt vmcnt(23)
  s_barrier
  v_mfma_f32_16x16x32_bf16 v[40:43], a[244:247], v[104:107], v[40:43]
  ds_read_b128 v[84:87], v2 offset:49152
  s_add_u32 m0, s45, 32768
  s_add_u32 s68, s67, 2
  s_and_b32 s68, s68, 7
  s_mul_i32 s68, s68, 262144
  v_mfma_f32_16x16x32_bf16 v[40:43], v[128:131], v[100:103], v[40:43]
  buffer_load_dwordx4 v10, s[16:19], s68 offen lds
  v_cmp_gt_u32 vcc, 2, v117
  s_nop 1
  v_cndmask_b32 v118, v119, v118, vcc
  v_mfma_f32_16x16x32_bf16 v[36:39], v[128:131], v[92:95], v[36:39]
  v_add_u32 v11, v116, v118
  v_mfma_f32_16x16x32_bf16 v[36:39], a[244:247], v[96:99], v[36:39]
  ds_read_b128 v[88:91], v2 offset:50176
  v_mfma_f32_16x16x32_bf16 v[44:47], a[248:251], v[96:99], v[44:47]
  v_mfma_f32_16x16x32_bf16 v[44:47], v[132:135], v[92:95], v[44:47]
  s_add_u32 m0, s45, 36864
  s_add_u32 s68, s68, 65536
  v_mfma_f32_16x16x32_bf16 v[48:51], v[132:135], v[100:103], v[48:51]
  ds_read_b128 v[96:99], v2 offset:57344
  v_mfma_f32_16x16x32_bf16 v[48:51], a[248:251], v[104:107], v[48:51]
  s_waitcnt lgkmcnt(3)
  buffer_load_dwordx4 v10, s[16:19], s68 offen lds
  v_mfma_f32_16x16x32_bf16 v[28:31], v[136:139], v[112:115], v[28:31]
  v_mfma_f32_16x16x32_bf16 v[28:31], v[148:151], v[108:111], v[28:31]
  ds_read_b128 v[92:95], v2 offset:58368
  v_mfma_f32_16x16x32_bf16 v[32:35], v[148:151], v[76:79], v[32:35]
  s_add_u32 m0, s45, 40960
  s_add_u32 s68, s68, 65536
  v_mfma_f32_16x16x32_bf16 v[32:35], v[136:139], v[80:83], v[32:35]
  buffer_load_dwordx4 v10, s[16:19], s68 offen lds
  v_mfma_f32_16x16x32_bf16 v[40:43], v[140:143], v[80:83], v[40:43]
  ds_read_b128 v[100:103], v2 offset:51200
  v_mfma_f32_16x16x32_bf16 v[40:43], v[152:155], v[76:79], v[40:43]
  v_mfma_f32_16x16x32_bf16 v[36:39], v[152:155], v[108:111], v[36:39]
  s_add_u32 m0, s45, 45056
  s_add_u32 s68, s68, 65536
  v_mfma_f32_16x16x32_bf16 v[36:39], v[140:143], v[112:115], v[36:39]
  ds_read_b128 v[104:107], v2 offset:52224
  v_mfma_f32_16x16x32_bf16 v[44:47], v[144:147], v[112:115], v[44:47]
  buffer_load_dwordx4 v10, s[16:19], s68 offen lds
  v_mfma_f32_16x16x32_bf16 v[44:47], v[156:159], v[108:111], v[44:47]
  v_mfma_f32_16x16x32_bf16 v[48:51], v[156:159], v[76:79], v[48:51]
  ds_read_b128 v[112:115], v2 offset:59392
  v_mfma_f32_16x16x32_bf16 v[48:51], v[144:147], v[80:83], v[48:51]
  s_waitcnt lgkmcnt(3)
  v_mfma_f32_16x16x32_bf16 v[28:31], v[160:163], v[84:87], v[28:31]
  v_mfma_f32_16x16x32_bf16 v[28:31], v[172:175], v[88:91], v[28:31]
  ds_read_b128 v[108:111], v2 offset:60416
  v_mfma_f32_16x16x32_bf16 v[32:35], v[172:175], v[92:95], v[32:35]
  v_mfma_f32_16x16x32_bf16 v[32:35], v[160:163], v[96:99], v[32:35]
  v_mfma_f32_16x16x32_bf16 v[40:43], v[164:167], v[96:99], v[40:43]
  ds_read_b128 v[76:79], v2 offset:53248
  v_mfma_f32_16x16x32_bf16 v[40:43], v[176:179], v[92:95], v[40:43]
  v_mfma_f32_16x16x32_bf16 v[36:39], v[176:179], v[88:91], v[36:39]
  v_mfma_f32_16x16x32_bf16 v[36:39], v[164:167], v[84:87], v[36:39]
  ds_read_b128 v[80:83], v2 offset:54272
  v_mfma_f32_16x16x32_bf16 v[44:47], v[168:171], v[84:87], v[44:47]
  v_mfma_f32_16x16x32_bf16 v[44:47], v[180:183], v[88:91], v[44:47]
  v_mfma_f32_16x16x32_bf16 v[48:51], v[180:183], v[92:95], v[48:51]
  ds_read_b128 v[84:87], v2 offset:61440
  v_mfma_f32_16x16x32_bf16 v[48:51], v[168:171], v[96:99], v[48:51]
  s_waitcnt lgkmcnt(3)
  v_mfma_f32_16x16x32_bf16 v[28:31], v[184:187], v[100:103], v[28:31]
  v_mfma_f32_16x16x32_bf16 v[28:31], v[196:199], v[104:107], v[28:31]
  ds_read_b128 v[88:91], v2 offset:62464
  v_mfma_f32_16x16x32_bf16 v[32:35], v[196:199], v[108:111], v[32:35]
  v_mfma_f32_16x16x32_bf16 v[32:35], v[184:187], v[112:115], v[32:35]
  v_mfma_f32_16x16x32_bf16 v[40:43], v[188:191], v[112:115], v[40:43]
  ds_read_b128 v[92:95], v2 offset:55296
  v_add_u32 v15, s46, v0
  v_add_u32 v15, 1, v15
  s_waitcnt vmcnt(6)
  s_barrier
  s_mov_b64 exec, 1
  buffer_store_dword v15, v0, s[8:11], s74 offen offset:0 sc1
  s_mov_b64 exec, -1
  v_mfma_f32_16x16x32_bf16 v[40:43], v[200:203], v[108:111], v[40:43]
  v_mfma_f32_16x16x32_bf16 v[36:39], v[200:203], v[104:107], v[36:39]
  v_mfma_f32_16x16x32_bf16 v[36:39], v[188:191], v[100:103], v[36:39]
  ds_read_b128 v[96:99], v2 offset:56320
  v_mfma_f32_16x16x32_bf16 v[44:47], v[192:195], v[100:103], v[44:47]
  v_mfma_f32_16x16x32_bf16 v[44:47], v[204:207], v[104:107], v[44:47]
  v_mfma_f32_16x16x32_bf16 v[48:51], v[204:207], v[108:111], v[48:51]
  ds_read_b128 v[100:103], v2 offset:63488
  v_mfma_f32_16x16x32_bf16 v[48:51], v[192:195], v[112:115], v[48:51]
  s_waitcnt lgkmcnt(3)
  v_mfma_f32_16x16x32_bf16 v[28:31], v[208:211], v[76:79], v[28:31]
  v_mfma_f32_16x16x32_bf16 v[28:31], v[220:223], v[80:83], v[28:31]
  ds_read_b128 v[104:107], v2 offset:64512
  v_mfma_f32_16x16x32_bf16 v[32:35], v[220:223], v[88:91], v[32:35]
  v_mfma_f32_16x16x32_bf16 v[32:35], v[208:211], v[84:87], v[32:35]
  s_waitcnt vmcnt(24)
  s_barrier
  v_mfma_f32_16x16x32_bf16 v[40:43], v[212:215], v[84:87], v[40:43]
  ds_read_b128 v[108:111], v1 offset:0
  s_add_u32 m0, s45, 49152
  s_add_u32 s68, s67, 3
  s_and_b32 s68, s68, 7
  s_mul_i32 s68, s68, 262144
  v_mfma_f32_16x16x32_bf16 v[40:43], v[224:227], v[88:91], v[40:43]
  buffer_load_dwordx4 v10, s[16:19], s68 offen lds
  v_mfma_f32_16x16x32_bf16 v[36:39], v[224:227], v[80:83], v[36:39]
  v_mfma_f32_16x16x32_bf16 v[36:39], v[212:215], v[76:79], v[36:39]
  ds_read_b128 v[112:115], v1 offset:1024
  v_mfma_f32_16x16x32_bf16 v[44:47], v[216:219], v[76:79], v[44:47]
  s_add_u32 m0, s45, 53248
  s_add_u32 s68, s68, 65536
  v_mfma_f32_16x16x32_bf16 v[44:47], v[228:231], v[80:83], v[44:47]
  buffer_load_dwordx4 v10, s[16:19], s68 offen lds
  v_mfma_f32_16x16x32_bf16 v[48:51], v[228:231], v[88:91], v[48:51]
  ds_read_b128 v[76:79], v1 offset:8192
  v_mfma_f32_16x16x32_bf16 v[48:51], v[216:219], v[84:87], v[48:51]
  s_waitcnt lgkmcnt(3)
  s_add_u32 m0, s45, 57344
  s_add_u32 s68, s68, 65536
  v_mfma_f32_16x16x32_bf16 v[28:31], v[232:235], v[92:95], v[28:31]
  buffer_load_dwordx4 v10, s[16:19], s68 offen lds
  v_mfma_f32_16x16x32_bf16 v[28:31], v[244:247], v[96:99], v[28:31]
  ds_read_b128 v[80:83], v1 offset:9216
  v_mfma_f32_16x16x32_bf16 v[32:35], v[244:247], v[104:107], v[32:35]
  v_mfma_f32_16x16x32_bf16 v[32:35], v[232:235], v[100:103], v[32:35]
  s_add_u32 m0, s45, 61440
  s_add_u32 s68, s68, 65536
  v_mfma_f32_16x16x32_bf16 v[40:43], v[236:239], v[100:103], v[40:43]
  ds_read_b128 v[88:91], v1 offset:2048
  v_mfma_f32_16x16x32_bf16 v[40:43], v[248:251], v[104:107], v[40:43]
  buffer_load_dwordx4 v10, s[16:19], s68 offen lds
  v_mfma_f32_16x16x32_bf16 v[36:39], v[248:251], v[96:99], v[36:39]
  v_mfma_f32_16x16x32_bf16 v[36:39], v[236:239], v[92:95], v[36:39]
  ds_read_b128 v[84:87], v1 offset:3072
  v_mfma_f32_16x16x32_bf16 v[44:47], v[240:243], v[92:95], v[44:47]
  v_mfma_f32_16x16x32_bf16 v[44:47], v[252:255], v[96:99], v[44:47]
  v_mfma_f32_16x16x32_bf16 v[48:51], v[252:255], v[104:107], v[48:51]
  ds_read_b128 v[92:95], v1 offset:10240
  v_mfma_f32_16x16x32_bf16 v[48:51], v[240:243], v[100:103], v[48:51]
  s_waitcnt lgkmcnt(3)
  v_mfma_f32_16x16x32_bf16 v[52:55], a[0:3], v[108:111], 0
  v_mfma_f32_16x16x32_bf16 v[52:55], a[12:15], v[112:115], v[52:55]
  ds_read_b128 v[96:99], v1 offset:11264
  v_mfma_f32_16x16x32_bf16 v[56:59], a[12:15], v[80:83], 0
  v_mfma_f32_16x16x32_bf16 v[56:59], a[0:3], v[76:79], v[56:59]
  v_cvt_pk_bf16_f32 v28, v28, v29
  v_cvt_pk_bf16_f32 v29, v30, v31
  v_mfma_f32_16x16x32_bf16 v[64:67], a[4:7], v[76:79], 0
  ds_read_b128 v[104:107], v1 offset:4096
  v_mfma_f32_16x16x32_bf16 v[64:67], a[16:19], v[80:83], v[64:67]
  ds_write_b64 v18, v[28:29] offset:12288
  v_mfma_f32_16x16x32_bf16 v[60:63], a[16:19], v[112:115], 0
  v_cvt_pk_bf16_f32 v36, v36, v37
  v_cvt_pk_bf16_f32 v37, v38, v39
  v_mfma_f32_16x16x32_bf16 v[60:63], a[4:7], v[108:111], v[60:63]
  ds_read_b128 v[100:103], v1 offset:5120
  v_cvt_pk_bf16_f32 v38, v44, v45
  v_cvt_pk_bf16_f32 v39, v46, v47
  v_mfma_f32_16x16x32_bf16 v[68:71], a[8:11], v[108:111], 0
  ds_write_b128 v17, v[36:39] offset:13312
  v_mfma_f32_16x16x32_bf16 v[68:71], a[20:23], v[112:115], v[68:71]
  v_cvt_pk_bf16_f32 v32, v32, v33
  v_cvt_pk_bf16_f32 v33, v34, v35
  v_mfma_f32_16x16x32_bf16 v[72:75], a[20:23], v[80:83], 0
  ds_read_b128 v[108:111], v1 offset:12288
  v_mfma_f32_16x16x32_bf16 v[72:75], a[8:11], v[76:79], v[72:75]
  s_waitcnt lgkmcnt(5)
  ds_write_b64 v18, v[32:33] offset:0
  v_mfma_f32_16x16x32_bf16 v[52:55], a[24:27], v[88:91], v[52:55]
  v_cvt_pk_bf16_f32 v40, v40, v41
  v_cvt_pk_bf16_f32 v41, v42, v43
  v_mfma_f32_16x16x32_bf16 v[52:55], a[36:39], v[84:87], v[52:55]
  ds_read_b128 v[112:115], v1 offset:13312
  v_cvt_pk_bf16_f32 v42, v48, v49
  v_mfma_f32_16x16x32_bf16 v[56:59], a[36:39], v[96:99], v[56:59]
  v_cvt_pk_bf16_f32 v43, v50, v51
  v_mfma_f32_16x16x32_bf16 v[56:59], a[24:27], v[92:95], v[56:59]
  ds_write_b128 v17, v[40:43] offset:1024
  v_mfma_f32_16x16x32_bf16 v[64:67], a[28:31], v[92:95], v[64:67]
  ds_read_b128 v[80:83], v1 offset:6144
  v_mfma_f32_16x16x32_bf16 v[64:67], a[40:43], v[96:99], v[64:67]
  s_bitcmp1_b32 s44, 0
  s_mov_b32 s52, 12288
  s_cselect_b32 s52, 0, s52
  s_mov_b32 s53, 6144
  s_cselect_b32 s53, 12288, s53
  v_mfma_f32_16x16x32_bf16 v[60:63], a[40:43], v[84:87], v[60:63]
  v_add_u32 v116, s52, v19
  v_add_u32 v117, s53, v19
  v_mfma_f32_16x16x32_bf16 v[60:63], a[28:31], v[88:91], v[60:63]
  ds_read_b128 v[76:79], v1 offset:7168
  v_add_u32 v118, s52, v20
  v_mfma_f32_16x16x32_bf16 v[68:71], a[32:35], v[88:91], v[68:71]
  v_add_u32 v119, s53, v20
  v_mfma_f32_16x16x32_bf16 v[68:71], a[44:47], v[84:87], v[68:71]
  s_waitcnt vmcnt(19) lgkmcnt(2)
  s_barrier
  v_mfma_f32_16x16x32_bf16 v[72:75], a[44:47], v[96:99], v[72:75]
  ds_read_b128 v[88:91], v1 offset:14336
  s_add_u32 m0, s45, 114688
  s_add_u32 s68, s67, 4
  s_and_b32 s68, s68, 7
  s_mul_i32 s68, s68, 262144
  v_mfma_f32_16x16x32_bf16 v[72:75], a[32:35], v[92:95], v[72:75]
  s_waitcnt lgkmcnt(4)
  buffer_load_dwordx4 v10, s[16:19], s68 offen lds
  ds_read_b128 v[28:31], v116
  v_mfma_f32_16x16x32_bf16 v[52:55], a[48:51], v[104:107], v[52:55]
  ds_read_b64_tr_b16 a[0:1], v4 offset:16384
  ds_read_b128 v[32:35], v117 offset:1024
  v_mfma_f32_16x16x32_bf16 v[52:55], a[60:63], v[100:103], v[52:55]
  ds_read_b128 v[84:87], v1 offset:15360
  ds_read_b128 v[36:39], v116 offset:1024
  v_mfma_f32_16x16x32_bf16 v[56:59], a[60:63], v[112:115], v[56:59]
  ds_read_b64_tr_b16 a[2:3], v4 offset:18432
  s_add_u32 m0, s45, 118784
  s_add_u32 s68, s68, 65536
  v_mfma_f32_16x16x32_bf16 v[56:59], a[48:51], v[108:111], v[56:59]
  ds_read_b64_tr_b16 a[4:5], v5 offset:16384
  buffer_load_dwordx4 v10, s[16:19], s68 offen lds
  v_mfma_f32_16x16x32_bf16 v[64:67], a[52:55], v[108:111], v[64:67]
  ds_read_b128 v[96:99], v2 offset:0
  ds_read_b64_tr_b16 v[40:41], v119 offset:2048
  v_mfma_f32_16x16x32_bf16 v[64:67], a[64:67], v[112:115], v[64:67]
  ds_read_b64_tr_b16 a[6:7], v5 offset:18432
  s_add_u32 m0, s45, 122880
  s_add_u32 s68, s68, 65536
  v_mfma_f32_16x16x32_bf16 v[60:63], a[64:67], v[100:103], v[60:63]
  ds_read_b64_tr_b16 a[8:9], v4 offset:20480
  buffer_load_dwordx4 v10, s[16:19], s68 offen lds
  v_mfma_f32_16x16x32_bf16 v[60:63], a[52:55], v[104:107], v[60:63]
  ds_read_b128 v[92:95], v2 offset:1024
  ds_read_b64_tr_b16 v[42:43], v118 offset:2048
  v_mfma_f32_16x16x32_bf16 v[68:71], a[56:59], v[104:107], v[68:71]
  ds_read_b64_tr_b16 a[10:11], v4 offset:22528
  ds_read_b64_tr_b16 v[44:45], v119 offset:2056
  v_mfma_f32_16x16x32_bf16 v[68:71], a[68:71], v[100:103], v[68:71]
  ds_read_b64_tr_b16 a[12:13], v5 offset:20480
  s_add_u32 m0, s45, 126976
  s_add_u32 s68, s68, 65536
  v_mfma_f32_16x16x32_bf16 v[72:75], a[68:71], v[112:115], v[72:75]
  ds_read_b128 v[104:107], v2 offset:8192
  buffer_load_dwordx4 v10, s[16:19], s68 offen lds
  v_mfma_f32_16x16x32_bf16 v[72:75], a[56:59], v[108:111], v[72:75]
  s_waitcnt lgkmcnt(13)
  ds_read_b64_tr_b16 a[14:15], v5 offset:22528
  v_mfma_f32_16x16x32_bf16 v[52:55], a[72:75], v[80:83], v[52:55]
  ds_read_b64_tr_b16 a[16:17], v4 offset:24576
  ds_read_b64_tr_b16 v[46:47], v118 offset:2056
  v_mfma_f32_16x16x32_bf16 v[52:55], a[84:87], v[76:79], v[52:55]
  ds_read_b128 v[100:103], v2 offset:9216
  v_mfma_f32_16x16x32_bf16 v[56:59], a[84:87], v[84:87], v[56:59]
  ds_read_b64_tr_b16 a[18:19], v4 offset:26624
  v_mfma_f32_16x16x32_bf16 v[56:59], a[72:75], v[88:91], v[56:59]
  ds_read_b64_tr_b16 a[20:21], v5 offset:24576
  v_mfma_f32_16x16x32_bf16 v[64:67], a[76:79], v[88:91], v[64:67]
  ds_read_b128 v[112:115], v2 offset:2048
  v_mfma_f32_16x16x32_bf16 v[64:67], a[88:91], v[84:87], v[64:67]
  ds_read_b64_tr_b16 a[22:23], v5 offset:26624
  s_waitcnt lgkmcnt(5)
  v_mfma_f32_16x16x32_bf16 v[116:119], v[32:35], v[28:31], 0
  v_mfma_f32_16x16x32_bf16 v[120:123], v[36:39], v[28:31], 0
  v_mfma_f32_16x16x32_bf16 v[60:63], a[88:91], v[76:79], v[60:63]
  ds_read_b64_tr_b16 a[24:25], v4 offset:28672
  s_cmp_lg_u32 s44, 0
  s_cbranch_scc1 PI6_adaLN_cond__sliding_local_dilated__swiglu_ffn__prompt_kernel
  buffer_load_dword v13, v14, s[8:11], s77 offen sc1
PI6_adaLN_cond__sliding_local_dilated__swiglu_ffn__prompt_kernel:
  v_mfma_f32_16x16x32_bf16 v[60:63], a[76:79], v[80:83], v[60:63]
  ds_read_b128 v[108:111], v2 offset:3072
  v_mfma_f32_16x16x32_bf16 v[68:71], a[80:83], v[80:83], v[68:71]
  ds_read_b64_tr_b16 a[26:27], v4 offset:30720
  v_mfma_f32_16x16x32_bf16 v[68:71], a[92:95], v[76:79], v[68:71]
  ds_read_b64_tr_b16 a[28:29], v5 offset:28672
  v_cndmask_b32 v48, v116, v120, s[80:81]
  v_cndmask_b32 v49, v117, v121, s[82:83]
  v_mfma_f32_16x16x32_bf16 v[72:75], a[92:95], v[84:87], v[72:75]
  ds_read_b128 v[80:83], v2 offset:10240
  v_cndmask_b32 v50, v118, v122, s[84:85]
  v_cndmask_b32 v51, v119, v123, s[86:87]
  v_mfma_f32_16x16x32_bf16 v[72:75], a[80:83], v[88:91], v[72:75]
  s_waitcnt lgkmcnt(9)
  ds_read_b64_tr_b16 a[30:31], v5 offset:30720
  v_cndmask_b32 v48, v48, v49, s[88:89]
  v_mfma_f32_16x16x32_bf16 v[52:55], a[96:99], v[96:99], v[52:55]
  v_cndmask_b32 v49, v50, v51, s[88:89]
  v_mul_f32 v48, 0x3e8293ee, v48
  v_mul_f32 v49, 0x3e8293ee, v49
  v_mfma_f32_16x16x32_bf16 v[52:55], a[108:111], v[92:95], v[52:55]
  ds_read_b128 v[76:79], v2 offset:11264
  v_max_f32 v50, v48, v49
  v_mov_b32 v51, v50
  v_mfma_f32_16x16x32_bf16 v[56:59], a[108:111], v[100:103], v[56:59]
  s_nop 0
  v_permlane16_swap_b32 v50, v51
  v_max_f32 v50, v50, v51
  v_mfma_f32_16x16x32_bf16 v[56:59], a[96:99], v[104:107], v[56:59]
  v_mov_b32 v51, v50
  v_mfma_f32_16x16x32_bf16 v[64:67], a[100:103], v[104:107], v[64:67]
  ds_read_b128 v[84:87], v2 offset:4096
  s_waitcnt vmcnt(13)
  s_barrier
  v_mfma_f32_16x16x32_bf16 v[64:67], a[112:115], v[100:103], v[64:67]
  ds_read_b64_tr_b16 a[32:33], v7 offset:16384
  s_add_u32 m0, s70, 0
  s_add_u32 s69, s61, 229376
  v_mfma_f32_16x16x32_bf16 v[60:63], a[112:115], v[92:95], v[60:63]
  ds_read_b64_tr_b16 a[34:35], v7 offset:18432
  buffer_load_dwordx4 v12, s[8:11], s69 offen offset:0 sc1 lds
  v_mfma_f32_16x16x32_bf16 v[60:63], a[100:103], v[96:99], v[60:63]
  ds_read_b128 v[88:91], v2 offset:5120
  v_permlane32_swap_b32 v50, v51
  v_mfma_f32_16x16x32_bf16 v[68:71], a[104:107], v[96:99], v[68:71]
  ds_read_b64_tr_b16 a[36:37], v8 offset:16384
  v_max_f32 v50, v50, v51
  v_sub_f32 v48, v48, v50
  v_mfma_f32_16x16x32_bf16 v[68:71], a[116:119], v[92:95], v[68:71]
  ds_read_b64_tr_b16 a[38:39], v8 offset:18432
  v_sub_f32 v49, v49, v50
  v_mfma_f32_16x16x32_bf16 v[72:75], a[116:119], v[100:103], v[72:75]
  ds_read_b128 v[96:99], v2 offset:12288
  buffer_load_dwordx4 v12, s[8:11], s69 offen offset:1024 sc1 lds
  v_mfma_f32_16x16x32_bf16 v[72:75], a[104:107], v[104:107], v[72:75]
  s_waitcnt lgkmcnt(7)
  ds_read_b64_tr_b16 a[40:41], v7 offset:20480
  v_mfma_f32_16x16x32_bf16 v[52:55], a[120:123], v[112:115], v[52:55]
  ds_read_b64_tr_b16 a[42:43], v7 offset:22528
  v_exp_f32 v48, v48
  v_mfma_f32_16x16x32_bf16 v[52:55], a[132:135], v[108:111], v[52:55]
  ds_read_b128 v[92:95], v2 offset:13312
  buffer_load_dwordx4 v12, s[8:11], s69 offen offset:2048 sc1 lds
  v_mfma_f32_16x16x32_bf16 v[56:59], a[132:135], v[76:79], v[56:59]
  ds_read_b64_tr_b16 a[44:45], v8 offset:20480
  v_exp_f32 v49, v49
  v_mfma_f32_16x16x32_bf16 v[56:59], a[120:123], v[80:83], v[56:59]
  ds_read_b64_tr_b16 a[46:47], v8 offset:22528
  v_add_f32 v50, v48, v49
  v_mov_b32 v51, v50
  v_mfma_f32_16x16x32_bf16 v[64:67], a[124:127], v[80:83], v[64:67]
  ds_read_b128 v[100:103], v2 offset:6144
  v_permlane16_swap_b32 v50, v51
  v_mfma_f32_16x16x32_bf16 v[64:67], a[136:139], v[76:79], v[64:67]
  ds_read_b64_tr_b16 a[48:49], v7 offset:24576
  buffer_load_dwordx4 v12, s[8:11], s69 offen offset:3072 sc1 lds
  v_add_f32 v50, v50, v51
  v_mfma_f32_16x16x32_bf16 v[60:63], a[136:139], v[108:111], v[60:63]
  ds_read_b64_tr_b16 a[50:51], v7 offset:26624
  v_mov_b32 v51, v50
  v_mfma_f32_16x16x32_bf16 v[60:63], a[124:127], v[112:115], v[60:63]
  ds_read_b128 v[104:107], v2 offset:7168
  v_permlane32_swap_b32 v50, v51
  v_mfma_f32_16x16x32_bf16 v[68:71], a[128:131], v[112:115], v[68:71]
  ds_read_b64_tr_b16 a[52:53], v8 offset:24576
  v_add_f32 v50, v50, v51
  v_mfma_f32_16x16x32_bf16 v[68:71], a[140:143], v[108:111], v[68:71]
  ds_read_b64_tr_b16 a[54:55], v8 offset:26624
  v_rcp_f32 v50, v50
  v_mfma_f32_16x16x32_bf16 v[72:75], a[140:143], v[76:79], v[72:75]
  ds_read_b128 v[112:115], v2 offset:14336
HOP4:
  s_cbranch_execz WRET0
  v_mul_f32 v48, v48, v50
  v_mul_f32 v49, v49, v50
  v_mfma_f32_16x16x32_bf16 v[72:75], a[128:131], v[80:83], v[72:75]
  s_waitcnt lgkmcnt(9)
  ds_read_b64_tr_b16 a[56:57], v7 offset:28672
  v_cvt_pk_bf16_f32 v48, v48, v48
  v_mfma_f32_16x16x32_bf16 v[52:55], a[144:147], v[84:87], v[52:55]
  ds_read_b64_tr_b16 a[58:59], v7 offset:30720
  v_cvt_pk_bf16_f32 v49, v49, v49
  v_and_b32 v28, v24, v48
  v_mfma_f32_16x16x32_bf16 v[52:55], a[156:159], v[88:91], v[52:55]
  ds_read_b128 v[108:111], v2 offset:15360
  v_and_b32 v29, v25, v49
  v_and_b32 v30, v26, v48
  v_mfma_f32_16x16x32_bf16 v[56:59], a[156:159], v[92:95], v[56:59]
  ds_read_b64_tr_b16 a[60:61], v8 offset:28672
  v_and_b32 v31, v27, v49
  v_mfma_f32_16x16x32_bf16 v[56:59], a[144:147], v[96:99], v[56:59]
  ds_read_b64_tr_b16 a[62:63], v8 offset:30720
  v_mfma_f32_16x16x32_bf16 v[32:35], v[40:43], v[28:31], 0
  v_mfma_f32_16x16x32_bf16 v[36:39], v[44:47], v[28:31], 0
  v_mfma_f32_16x16x32_bf16 v[64:67], a[148:151], v[96:99], v[64:67]
  ds_read_b128 v[76:79], v2 offset:32768
  v_mfma_f32_16x16x32_bf16 v[64:67], a[160:163], v[92:95], v[64:67]
  s_cmp_lg_u32 s44, 0
  s_cbranch_scc1 PL7_adaLN_cond__sliding_local_dilated__swiglu_ffn__prompt_kernelx
  s_waitcnt vmcnt(4)
  v_subrev_u32 v13, s46, v13
  v_subrev_u32 v13, 1, v13
  v_cmp_lt_u32 vcc, 3, v13
  s_nop 4
  s_cbranch_vccz PL7_adaLN_cond__sliding_local_dilated__swiglu_ffn__prompt_kernelx
  s_mov_b32 s57, 60000
PL7_adaLN_cond__sliding_local_dilated__swiglu_ffn__prompt_kernel:
  buffer_load_dword v13, v14, s[8:11], s77 offen sc1
  s_sub_u32 s57, s57, 1
  s_cmp_eq_u32 s57, 0
  s_waitcnt vmcnt(0)
  s_cbranch_scc1 PL7_adaLN_cond__sliding_local_dilated__swiglu_ffn__prompt_kernelx
  v_subrev_u32 v13, s46, v13
  v_subrev_u32 v13, 1, v13
  v_cmp_lt_u32 vcc, 3, v13
  s_nop 4
  s_cbranch_vccnz PL7_adaLN_cond__sliding_local_dilated__swiglu_ffn__prompt_kernel
PL7_adaLN_cond__sliding_local_dilated__swiglu_ffn__prompt_kernelx:
  s_barrier
  v_mfma_f32_16x16x32_bf16 v[60:63], a[160:163], v[88:91], v[60:63]
  v_mfma_f32_16x16x32_bf16 v[60:63], a[148:151], v[84:87], v[60:63]
  ds_read_b128 v[80:83], v2 offset:33792
  v_cvt_pk_bf16_f32 v116, v32, v33
  v_cvt_pk_bf16_f32 v117, v34, v35
  v_mfma_f32_16x16x32_bf16 v[68:71], a[152:155], v[84:87], v[68:71]
  v_cvt_pk_bf16_f32 v118, v36, v37
  v_cvt_pk_bf16_f32 v119, v38, v39
  v_mfma_f32_16x16x32_bf16 v[68:71], a[164:167], v[88:91], v[68:71]
  buffer_store_dwordx4 v[116:119], v1, s[8:11], s73 offen sc1
  v_mfma_f32_16x16x32_bf16 v[72:75], a[164:167], v[92:95], v[72:75]
  ds_read_b128 v[84:87], v2 offset:40960
  s_add_u32 s73, s73, 65536
  v_mfma_f32_16x16x32_bf16 v[72:75], a[152:155], v[96:99], v[72:75]
  s_waitcnt lgkmcnt(5)
  s_waitcnt vmcnt(9) lgkmcnt(3)
  s_barrier
  v_mfma_f32_16x16x32_bf16 v[52:55], a[168:171], v[100:103], v[52:55]
  ds_read_b64_tr_b16 a[64:65], v4 offset:32768
  s_add_u32 m0, s45, 16384
  s_add_u32 s68, s67, 5
  s_and_b32 s68, s68, 7
  s_mul_i32 s68, s68, 262144
  v_mfma_f32_16x16x32_bf16 v[52:55], a[180:183], v[104:107], v[52:55]
  ds_read_b128 v[88:91], v2 offset:41984
  ds_read_b64_tr_b16 a[66:67], v4 offset:34816
  v_mfma_f32_16x16x32_bf16 v[56:59], a[180:183], v[108:111], v[56:59]
  ds_read_b64_tr_b16 a[68:69], v5 offset:32768
  buffer_load_dwordx4 v10, s[16:19], s68 offen lds
  v_mfma_f32_16x16x32_bf16 v[56:59], a[168:171], v[112:115], v[56:59]
  ds_read_b64_tr_b16 a[70:71], v5 offset:34816
  ds_read_b64_tr_b16 a[72:73], v4 offset:36864
  v_mfma_f32_16x16x32_bf16 v[64:67], a[172:175], v[112:115], v[64:67]
  ds_read_b128 v[92:95], v2 offset:34816
  ds_read_b64_tr_b16 a[74:75], v4 offset:38912
  s_add_u32 m0, s45, 20480
  s_add_u32 s68, s68, 65536
  v_mfma_f32_16x16x32_bf16 v[64:67], a[184:187], v[108:111], v[64:67]
  ds_read_b64_tr_b16 a[76:77], v5 offset:36864
  buffer_load_dwordx4 v10, s[16:19], s68 offen lds
  v_mfma_f32_16x16x32_bf16 v[60:63], a[184:187], v[104:107], v[60:63]
  ds_read_b64_tr_b16 a[78:79], v5 offset:38912
  ds_read_b64_tr_b16 a[80:81], v4 offset:40960
  v_mfma_f32_16x16x32_bf16 v[60:63], a[172:175], v[100:103], v[60:63]
  ds_read_b128 v[96:99], v2 offset:35840
  ds_read_b64_tr_b16 a[82:83], v4 offset:43008
  s_add_u32 m0, s45, 24576
  s_add_u32 s68, s68, 65536
  v_mfma_f32_16x16x32_bf16 v[68:71], a[176:179], v[100:103], v[68:71]
  ds_read_b64_tr_b16 a[84:85], v5 offset:40960
  buffer_load_dwordx4 v10, s[16:19], s68 offen lds
  v_mfma_f32_16x16x32_bf16 v[68:71], a[188:191], v[104:107], v[68:71]
  ds_read_b64_tr_b16 a[86:87], v5 offset:43008
  ds_read_b64_tr_b16 a[88:89], v4 offset:45056
  v_mfma_f32_16x16x32_bf16 v[72:75], a[188:191], v[108:111], v[72:75]
  ds_read_b128 v[100:103], v2 offset:43008
  ds_read_b64_tr_b16 a[90:91], v4 offset:47104
  v_mfma_f32_16x16x32_bf16 v[72:75], a[176:179], v[112:115], v[72:75]
  s_waitcnt lgkmcnt(15)
  ds_read_b64_tr_b16 a[92:93], v5 offset:45056
  s_add_u32 m0, s45, 28672
  s_add_u32 s68, s68, 65536
  v_mfma_f32_16x16x32_bf16 v[52:55], a[192:195], v[76:79], v[52:55]
  ds_read_b64_tr_b16 a[94:95], v5 offset:47104
  ds_read_b64_tr_b16 a[96:97], v4 offset:49152
  buffer_load_dwordx4 v10, s[16:19], s68 offen lds
  v_mfma_f32_16x16x32_bf16 v[52:55], a[204:207], v[80:83], v[52:55]
  ds_read_b128 v[104:107], v2 offset:44032
  ds_read_b64_tr_b16 a[98:99], v4 offset:51200
  v_mfma_f32_16x16x32_bf16 v[56:59], a[204:207], v[88:91], v[56:59]
  ds_read_b64_tr_b16 a[100:101], v5 offset:49152
  s_add_u32 m0, s45, 81920
  s_add_u32 s68, s67, 6
  s_and_b32 s68, s68, 7
  s_mul_i32 s68, s68, 262144
  v_mfma_f32_16x16x32_bf16 v[56:59], a[192:195], v[84:87], v[56:59]
  ds_read_b64_tr_b16 a[102:103], v5 offset:51200
  ds_read_b64_tr_b16 a[104:105], v4 offset:53248
  buffer_load_dwordx4 v10, s[16:19], s68 offen lds
  v_mfma_f32_16x16x32_bf16 v[64:67], a[196:199], v[84:87], v[64:67]
  ds_read_b128 v[108:111], v2 offset:36864
  ds_read_b64_tr_b16 a[106:107], v4 offset:55296
  v_mfma_f32_16x16x32_bf16 v[64:67], a[208:211], v[88:91], v[64:67]
  ds_read_b64_tr_b16 a[108:109], v5 offset:53248
  v_mfma_f32_16x16x32_bf16 v[60:63], a[208:211], v[80:83], v[60:63]
  ds_read_b64_tr_b16 a[110:111], v5 offset:55296
  ds_read_b64_tr_b16 a[112:113], v4 offset:57344
  v_mfma_f32_16x16x32_bf16 v[60:63], a[196:199], v[76:79], v[60:63]
  ds_read_b128 v[112:115], v2 offset:37888
  ds_read_b64_tr_b16 a[114:115], v4 offset:59392
  s_add_u32 m0, s45, 86016
  s_add_u32 s68, s68, 65536
  v_mfma_f32_16x16x32_bf16 v[68:71], a[200:203], v[76:79], v[68:71]
  ds_read_b64_tr_b16 a[116:117], v5 offset:57344
  buffer_load_dwordx4 v10, s[16:19], s68 offen lds
  v_mfma_f32_16x16x32_bf16 v[68:71], a[212:215], v[80:83], v[68:71]
  ds_read_b64_tr_b16 a[118:119], v5 offset:59392
  ds_read_b64_tr_b16 a[120:121], v4 offset:61440
  v_mfma_f32_16x16x32_bf16 v[72:75], a[212:215], v[88:91], v[72:75]
  ds_read_b128 v[76:79], v2 offset:45056
  ds_read_b64_tr_b16 a[122:123], v4 offset:63488
  s_add_u32 m0, s45, 90112
  s_add_u32 s68, s68, 65536
  v_mfma_f32_16x16x32_bf16 v[72:75], a[200:203], v[84:87], v[72:75]
  s_waitcnt lgkmcnt(15)
  ds_read_b64_tr_b16 a[124:125], v5 offset:61440
  buffer_load_dwordx4 v10, s[16:19], s68 offen lds
  v_mfma_f32_16x16x32_bf16 v[52:55], a[216:219], v[92:95], v[52:55]
  ds_read_b64_tr_b16 a[126:127], v5 offset:63488
  v_mfma_f32_16x16x32_bf16 v[52:55], a[228:231], v[96:99], v[52:55]
  ds_read_b128 v[80:83], v2 offset:46080
  s_add_u32 m0, s45, 94208
  s_add_u32 s68, s68, 65536
  v_mfma_f32_16x16x32_bf16 v[56:59], a[228:231], v[104:107], v[56:59]
  v_lshlrev_b32 v21, 7, v0
  v_add_u32 v21, 720896, v21
  v_mfma_f32_16x16x32_bf16 v[56:59], a[216:219], v[100:103], v[56:59]
  buffer_load_dwordx4 v10, s[16:19], s68 offen lds
  v_mfma_f32_16x16x32_bf16 v[64:67], a[220:223], v[100:103], v[64:67]
  ds_read_b128 v[88:91], v2 offset:38912
  s_cmp_lg_u32 s44, 0
  s_cbranch_scc1 PI8_adaLN_cond__sliding_local_dilated__swiglu_ffn__prompt_kernel
  buffer_load_dwordx4 v[116:119], v21, s[8:11], 0 offen sc1
PI8_adaLN_cond__sliding_local_dilated__swiglu_ffn__prompt_kernel:
  v_mfma_f32_16x16x32_bf16 v[64:67], a[232:235], v[104:107], v[64:67]
  v_mfma_f32_16x16x32_bf16 v[60:63], a[232:235], v[96:99], v[60:63]
  s_waitcnt vmcnt(4) lgkmcnt(2)
  s_barrier
  v_mfma_f32_16x16x32_bf16 v[60:63], a[220:223], v[92:95], v[60:63]
  ds_read_b128 v[84:87], v2 offset:39936
  ds_read_b64_tr_b16 a[128:129], v7 offset:49152
  s_add_u32 m0, s45, 65536
  s_add_u32 s68, s67, 7
  s_and_b32 s68, s68, 7
  s_mul_i32 s68, s68, 262144
  v_mfma_f32_16x16x32_bf16 v[68:71], a[224:227], v[92:95], v[68:71]
  ds_read_b64_tr_b16 a[130:131], v7 offset:51200
  buffer_load_dwordx4 v10, s[16:19], s68 offen lds
  v_mfma_f32_16x16x32_bf16 v[68:71], a[236:239], v[96:99], v[68:71]
  ds_read_b64_tr_b16 a[132:133], v8 offset:49152
  v_mfma_f32_16x16x32_bf16 v[72:75], a[236:239], v[104:107], v[72:75]
  ds_read_b128 v[92:95], v2 offset:47104
  ds_read_b64_tr_b16 a[134:135], v8 offset:51200
  ds_read_b64_tr_b16 a[136:137], v7 offset:53248
  v_mfma_f32_16x16x32_bf16 v[72:75], a[224:227], v[100:103], v[72:75]
  s_waitcnt lgkmcnt(8)
  ds_read_b64_tr_b16 a[138:139], v7 offset:55296
  s_add_u32 m0, s45, 69632
  s_add_u32 s68, s68, 65536
  v_mfma_f32_16x16x32_bf16 v[52:55], a[240:243], v[108:111], v[52:55]
  ds_read_b64_tr_b16 a[140:141], v8 offset:53248
  buffer_load_dwordx4 v10, s[16:19], s68 offen lds
  v_mfma_f32_16x16x32_bf16 v[52:55], v[124:127], v[112:115], v[52:55]
  ds_read_b128 v[96:99], v2 offset:48128
  ds_read_b64_tr_b16 a[142:143], v8 offset:55296
  ds_read_b64_tr_b16 a[144:145], v7 offset:57344
  v_mfma_f32_16x16x32_bf16 v[56:59], v[124:127], v[80:83], v[56:59]
  ds_read_b64_tr_b16 a[146:147], v7 offset:59392
  s_add_u32 m0, s45, 73728
  s_add_u32 s68, s68, 65536
  v_mfma_f32_16x16x32_bf16 v[56:59], a[240:243], v[76:79], v[56:59]
  ds_read_b64_tr_b16 a[148:149], v8 offset:57344
  buffer_load_dwordx4 v10, s[16:19], s68 offen lds
  v_mfma_f32_16x16x32_bf16 v[64:67], a[244:247], v[76:79], v[64:67]
  ds_read_b128 v[104:107], v1 offset:0
  ds_read_b64_tr_b16 a[150:151], v8 offset:59392
  ds_read_b64_tr_b16 a[152:153], v7 offset:61440
  v_mfma_f32_16x16x32_bf16 v[64:67], v[128:131], v[80:83], v[64:67]
  ds_read_b64_tr_b16 a[154:155], v7 offset:63488
  v_mfma_f32_16x16x32_bf16 v[60:63], v[128:131], v[112:115], v[60:63]
  ds_read_b64_tr_b16 a[156:157], v8 offset:61440
  s_add_u32 m0, s45, 77824
  s_add_u32 s68, s68, 65536
  v_mfma_f32_16x16x32_bf16 v[60:63], a[244:247], v[108:111], v[60:63]
  ds_read_b128 v[100:103], v1 offset:1024
  ds_read_b64_tr_b16 a[158:159], v8 offset:63488
  ds_read_b64_tr_b16 a[160:161], v4 offset:16384
  v_add_u32 v15, s46, v0
  v_add_u32 v15, 2, v15
  s_waitcnt vmcnt(11)
  s_barrier
  s_mov_b64 exec, 1
  buffer_store_dword v15, v0, s[8:11], s74 offen offset:0 sc1
  s_mov_b64 exec, -1
  v_mfma_f32_16x16x32_bf16 v[68:71], a[248:251], v[108:111], v[68:71]
  ds_read_b64_tr_b16 a[162:163], v4 offset:18432
  buffer_load_dwordx4 v10, s[16:19], s68 offen lds
  v_mfma_f32_16x16x32_bf16 v[68:71], v[132:135], v[112:115], v[68:71]
  ds_read_b64_tr_b16 a[164:165], v5 offset:16384
  s_add_u32 m0, s70, 32768
  s_add_u32 s69, s62, 0
  v_mfma_f32_16x16x32_bf16 v[72:75], v[132:135], v[80:83], v[72:75]
  ds_read_b128 v[108:111], v1 offset:8192
  ds_read_b64_tr_b16 a[166:167], v5 offset:18432
  ds_read_b64_tr_b16 a[168:169], v4 offset:20480
  v_mfma_f32_16x16x32_bf16 v[72:75], a[248:251], v[76:79], v[72:75]
  s_waitcnt lgkmcnt(15)
  ds_read_b64_tr_b16 a[170:171], v4 offset:22528
  buffer_load_dwordx4 v9, s[8:11], s69 offen offset:0 sc1 lds
  v_mfma_f32_16x16x32_bf16 v[52:55], v[136:139], v[88:91], v[52:55]
  ds_read_b64_tr_b16 a[172:173], v5 offset:20480
  v_mfma_f32_16x16x32_bf16 v[52:55], v[148:151], v[84:87], v[52:55]
  ds_read_b128 v[112:115], v1 offset:9216
  ds_read_b64_tr_b16 a[174:175], v5 offset:22528
  ds_read_b64_tr_b16 a[176:177], v4 offset:24576
  v_mfma_f32_16x16x32_bf16 v[56:59], v[148:151], v[96:99], v[56:59]
  ds_read_b64_tr_b16 a[178:179], v4 offset:26624
  buffer_load_dwordx4 v9, s[8:11], s69 offen offset:1024 sc1 lds
  v_mfma_f32_16x16x32_bf16 v[56:59], v[136:139], v[92:95], v[56:59]
  ds_read_b64_tr_b16 a[180:181], v5 offset:24576
  v_mfma_f32_16x16x32_bf16 v[64:67], v[140:143], v[92:95], v[64:67]
  ds_read_b128 v[80:83], v1 offset:2048
  ds_read_b64_tr_b16 a[182:183], v5 offset:26624
  ds_read_b64_tr_b16 a[184:185], v4 offset:28672
  v_mfma_f32_16x16x32_bf16 v[64:67], v[152:155], v[96:99], v[64:67]
  ds_read_b64_tr_b16 a[186:187], v4 offset:30720
  buffer_load_dwordx4 v9, s[8:11], s69 offen offset:2048 sc1 lds
  v_mfma_f32_16x16x32_bf16 v[60:63], v[152:155], v[84:87], v[60:63]
  ds_read_b64_tr_b16 a[188:189], v5 offset:28672
  v_mfma_f32_16x16x32_bf16 v[60:63], v[140:143], v[88:91], v[60:63]
  ds_read_b128 v[76:79], v1 offset:3072
  ds_read_b64_tr_b16 a[190:191], v5 offset:30720
  v_mfma_f32_16x16x32_bf16 v[68:71], v[144:147], v[88:91], v[68:71]
  v_mfma_f32_16x16x32_bf16 v[68:71], v[156:159], v[84:87], v[68:71]
  buffer_load_dwordx4 v9, s[8:11], s69 offen offset:3072 sc1 lds
  v_mfma_f32_16x16x32_bf16 v[72:75], v[156:159], v[96:99], v[72:75]
  ds_read_b128 v[88:91], v1 offset:10240
  v_mfma_f32_16x16x32_bf16 v[72:75], v[144:147], v[92:95], v[72:75]
  s_waitcnt lgkmcnt(12)
  s_add_u32 m0, s70, 49152
  s_add_u32 s69, s63, 0
  v_mfma_f32_16x16x32_bf16 v[52:55], v[160:163], v[104:107], v[52:55]
  buffer_load_dwordx4 v9, s[8:11], s69 offen offset:0 sc1 lds
  s_waitcnt vmcnt(5) lgkmcnt(15)
  s_barrier
  v_mfma_f32_16x16x32_bf16 v[52:55], v[172:175], v[100:103], v[52:55]
  ds_read_b128 v[84:87], v1 offset:11264
  ds_read_b64_tr_b16 a[192:193], v7 offset:16384
  v_mfma_f32_16x16x32_bf16 v[56:59], v[172:175], v[112:115], v[56:59]
  ds_read_b64_tr_b16 a[194:195], v7 offset:18432
  v_mfma_f32_16x16x32_bf16 v[56:59], v[160:163], v[108:111], v[56:59]
  ds_read_b64_tr_b16 a[196:197], v8 offset:16384
  s_cmp_lg_u32 s44, 0
  s_cbranch_scc1 PL9_adaLN_cond__sliding_local_dilated__swiglu_ffn__prompt_kernelx
  s_waitcnt vmcnt(10)
  v_bitop3_b32 v116, v116, v117, s46 bitop3:0x7e
  v_bitop3_b32 v118, v118, v119, s46 bitop3:0x7e
  v_or_b32 v116, v116, v118
  v_cmp_ne_u32 vcc, 0, v116
  s_nop 4
  s_cbranch_vccz PL9_adaLN_cond__sliding_local_dilated__swiglu_ffn__prompt_kernelx
  s_mov_b32 s57, 60000
PL9_adaLN_cond__sliding_local_dilated__swiglu_ffn__prompt_kernel:
  buffer_load_dwordx4 v[116:119], v21, s[8:11], 0 offen sc1
  s_sub_u32 s57, s57, 1
  s_cmp_eq_u32 s57, 0
  s_waitcnt vmcnt(0)
  s_cbranch_scc1 PL9_adaLN_cond__sliding_local_dilated__swiglu_ffn__prompt_kernelx
  v_bitop3_b32 v116, v116, v117, s46 bitop3:0x7e
  v_bitop3_b32 v118, v118, v119, s46 bitop3:0x7e
  v_or_b32 v116, v116, v118
  v_cmp_ne_u32 vcc, 0, v116
  s_nop 4
  s_cbranch_vccnz PL9_adaLN_cond__sliding_local_dilated__swiglu_ffn__prompt_kernel
PL9_adaLN_cond__sliding_local_dilated__swiglu_ffn__prompt_kernelx:
  s_barrier
  v_mfma_f32_16x16x32_bf16 v[64:67], v[164:167], v[108:111], v[64:67]
  ds_read_b128 v[96:99], v1 offset:4096
  ds_read_b64_tr_b16 a[198:199], v8 offset:18432
  ds_read_b64_tr_b16 a[200:201], v7 offset:20480
  buffer_load_dwordx4 v9, s[8:11], s69 offen offset:1024 sc1 lds
  v_mfma_f32_16x16x32_bf16 v[64:67], v[176:179], v[112:115], v[64:67]
  ds_read_b64_tr_b16 a[202:203], v7 offset:22528
  s_or_b32 s57, s2, s44
  s_mov_b32 s57, 851968
  s_cselect_b32 s57, 1073741824, s57
  v_add_u32 v15, s46, v0
  s_mov_b64 exec, 1
  buffer_store_dword v15, v0, s[8:11], s57 offen offset:0 sc1
  s_mov_b64 exec, -1
  v_mfma_f32_16x16x32_bf16 v[60:63], v[176:179], v[100:103], v[60:63]
  ds_read_b64_tr_b16 a[204:205], v8 offset:20480
  v_mfma_f32_16x16x32_bf16 v[60:63], v[164:167], v[104:107], v[60:63]
  ds_read_b128 v[92:95], v1 offset:5120
  ds_read_b64_tr_b16 a[206:207], v8 offset:22528
  ds_read_b64_tr_b16 a[208:209], v7 offset:24576
  v_mfma_f32_16x16x32_bf16 v[68:71], v[168:171], v[104:107], v[68:71]
  ds_read_b64_tr_b16 a[210:211], v7 offset:26624
  buffer_load_dwordx4 v9, s[8:11], s69 offen offset:2048 sc1 lds
  v_mfma_f32_16x16x32_bf16 v[68:71], v[180:183], v[100:103], v[68:71]
  ds_read_b64_tr_b16 a[212:213], v8 offset:24576
  v_mfma_f32_16x16x32_bf16 v[72:75], v[180:183], v[112:115], v[72:75]
  ds_read_b128 v[104:107], v1 offset:12288
  ds_read_b64_tr_b16 a[214:215], v8 offset:26624
  ds_read_b64_tr_b16 a[216:217], v7 offset:28672
  v_mfma_f32_16x16x32_bf16 v[72:75], v[168:171], v[108:111], v[72:75]
  s_waitcnt lgkmcnt(15)
  ds_read_b64_tr_b16 a[218:219], v7 offset:30720
  v_mfma_f32_16x16x32_bf16 v[52:55], v[184:187], v[80:83], v[52:55]
  ds_read_b64_tr_b16 a[220:221], v8 offset:28672
  buffer_load_dwordx4 v9, s[8:11], s69 offen offset:3072 sc1 lds
  s_add_u32 m0, s70, 98304
  s_add_u32 s69, s64, 0
  v_mfma_f32_16x16x32_bf16 v[52:55], v[196:199], v[76:79], v[52:55]
  ds_read_b128 v[100:103], v1 offset:13312
  ds_read_b64_tr_b16 a[222:223], v8 offset:30720
  ds_read_b64_tr_b16 a[224:225], v7 offset:0
  v_mfma_f32_16x16x32_bf16 v[56:59], v[196:199], v[84:87], v[56:59]
  ds_read_b64_tr_b16 a[226:227], v7 offset:2048
  buffer_load_dwordx4 v9, s[8:11], s69 offen offset:0 sc1 lds
  v_mfma_f32_16x16x32_bf16 v[56:59], v[184:187], v[88:91], v[56:59]
  ds_read_b64_tr_b16 a[228:229], v8 offset:0
  v_mfma_f32_16x16x32_bf16 v[64:67], v[188:191], v[88:91], v[64:67]
  ds_read_b128 v[112:115], v1 offset:6144
  ds_read_b64_tr_b16 a[230:231], v8 offset:2048
  ds_read_b64_tr_b16 a[232:233], v7 offset:4096
  v_mfma_f32_16x16x32_bf16 v[64:67], v[200:203], v[84:87], v[64:67]
  ds_read_b64_tr_b16 a[234:235], v7 offset:6144
  v_mfma_f32_16x16x32_bf16 v[60:63], v[200:203], v[76:79], v[60:63]
  ds_read_b64_tr_b16 a[236:237], v8 offset:4096
  buffer_load_dwordx4 v9, s[8:11], s69 offen offset:1024 sc1 lds
  v_mfma_f32_16x16x32_bf16 v[60:63], v[188:191], v[80:83], v[60:63]
  ds_read_b128 v[108:111], v1 offset:7168
  ds_read_b64_tr_b16 a[238:239], v8 offset:6144
  ds_read_b64_tr_b16 a[240:241], v7 offset:8192
  v_mfma_f32_16x16x32_bf16 v[68:71], v[192:195], v[80:83], v[68:71]
  ds_read_b64_tr_b16 a[242:243], v7 offset:10240
  v_mfma_f32_16x16x32_bf16 v[68:71], v[204:207], v[76:79], v[68:71]
  ds_read_b64_tr_b16 a[244:245], v8 offset:8192
  buffer_load_dwordx4 v9, s[8:11], s69 offen offset:2048 sc1 lds
  v_mfma_f32_16x16x32_bf16 v[72:75], v[204:207], v[84:87], v[72:75]
  ds_read_b128 v[80:83], v1 offset:14336
  ds_read_b64_tr_b16 a[246:247], v8 offset:10240
  ds_read_b64_tr_b16 a[248:249], v7 offset:12288
  v_mfma_f32_16x16x32_bf16 v[72:75], v[192:195], v[88:91], v[72:75]
  s_waitcnt lgkmcnt(15)
  ds_read_b64_tr_b16 a[250:251], v7 offset:14336
  v_mfma_f32_16x16x32_bf16 v[52:55], v[208:211], v[96:99], v[52:55]
  ds_read_b64_tr_b16 v[124:125], v8 offset:12288
  v_mfma_f32_16x16x32_bf16 v[52:55], v[220:223], v[92:95], v[52:55]
  ds_read_b128 v[76:79], v1 offset:15360
  ds_read_b64_tr_b16 v[126:127], v8 offset:14336
  v_mfma_f32_16x16x32_bf16 v[56:59], v[220:223], v[100:103], v[56:59]
  buffer_load_dwordx4 v9, s[8:11], s69 offen offset:3072 sc1 lds
  s_add_u32 m0, s70, 114688
  s_add_u32 s69, s65, 0
  v_mfma_f32_16x16x32_bf16 v[56:59], v[208:211], v[104:107], v[56:59]
  v_and_b32 v21, 31, v0
  v_lshlrev_b32 v21, 2, v21
  v_lshrrev_b32 v181, 5, v0
  v_lshl_add_u32 v21, v181, 13, v21
  v_mfma_f32_16x16x32_bf16 v[64:67], v[212:215], v[104:107], v[64:67]
  buffer_load_dwordx4 v9, s[8:11], s69 offen offset:0 sc1 lds
  v_mfma_f32_16x16x32_bf16 v[64:67], v[224:227], v[100:103], v[64:67]
  v_mfma_f32_16x16x32_bf16 v[60:63], v[224:227], v[92:95], v[60:63]
  v_mfma_f32_16x16x32_bf16 v[60:63], v[212:215], v[96:99], v[60:63]
  s_waitcnt vmcnt(5) lgkmcnt(0)
  s_barrier
  v_mfma_f32_16x16x32_bf16 v[68:71], v[216:219], v[96:99], v[68:71]
  ds_read_b128 v[84:87], v22 offset:32768
  v_mfma_f32_16x16x32_bf16 v[68:71], v[228:231], v[92:95], v[68:71]
  buffer_load_dwordx4 v9, s[8:11], s69 offen offset:1024 sc1 lds
  v_mfma_f32_16x16x32_bf16 v[72:75], v[228:231], v[100:103], v[72:75]
  ds_read_b128 v[88:91], v22 offset:33792
  v_mfma_f32_16x16x32_bf16 v[72:75], v[216:219], v[104:107], v[72:75]
  s_waitcnt lgkmcnt(3)
  buffer_load_dwordx4 v9, s[8:11], s69 offen offset:2048 sc1 lds
  v_mfma_f32_16x16x32_bf16 v[52:55], v[232:235], v[112:115], v[52:55]
  ds_read_b128 v[96:99], v22 offset:34816
  v_mfma_f32_16x16x32_bf16 v[52:55], v[244:247], v[108:111], v[52:55]
  v_mfma_f32_16x16x32_bf16 v[56:59], v[244:247], v[76:79], v[56:59]
  ds_read_b128 v[92:95], v22 offset:35840
  v_mfma_f32_16x16x32_bf16 v[56:59], v[232:235], v[80:83], v[56:59]
  buffer_load_dwordx4 v9, s[8:11], s69 offen offset:3072 sc1 lds
  v_mfma_f32_16x16x32_bf16 v[64:67], v[236:239], v[80:83], v[64:67]
  ds_read_b128 v[100:103], v22 offset:36864
  v_mfma_f32_16x16x32_bf16 v[64:67], v[248:251], v[76:79], v[64:67]
  s_add_u32 s56, s76, 8192
  v_mfma_f32_16x16x32_bf16 v[60:63], v[248:251], v[108:111], v[60:63]
  ds_read_b128 v[104:107], v22 offset:37888
  buffer_load_dword v160, v21, s[8:11], s56 offen sc1
  v_mfma_f32_16x16x32_bf16 v[60:63], v[236:239], v[112:115], v[60:63]
  s_add_u32 s56, s76, 32768
  v_mfma_f32_16x16x32_bf16 v[68:71], v[240:243], v[112:115], v[68:71]
  ds_read_b128 v[112:115], v22 offset:38912
  buffer_load_dword v161, v21, s[8:11], s56 offen sc1
  v_mfma_f32_16x16x32_bf16 v[68:71], v[252:255], v[108:111], v[68:71]
  s_add_u32 s56, s76, 57344
  v_mfma_f32_16x16x32_bf16 v[72:75], v[252:255], v[76:79], v[72:75]
  ds_read_b128 v[108:111], v22 offset:39936
  buffer_load_dword v162, v21, s[8:11], s56 offen sc1
  v_mfma_f32_16x16x32_bf16 v[72:75], v[240:243], v[80:83], v[72:75]
  s_waitcnt lgkmcnt(4)
  s_add_u32 s56, s76, 81920
  v_mfma_f32_16x16x32_bf16 v[128:131], a[0:3], v[84:87], 0
  ds_read_b128 v[76:79], v22 offset:49152
  buffer_load_dword v163, v21, s[8:11], s56 offen sc1
  s_add_u32 s56, s47, 41943040
  v_mfma_f32_16x16x32_bf16 v[128:131], a[8:11], v[88:91], v[128:131]
  buffer_load_dwordx4 v[144:147], v1, s[8:11], s56 offen sc1
  s_add_u32 s56, s47, 42008576
  v_mfma_f32_16x16x32_bf16 v[132:135], a[12:15], v[88:91], 0
  ds_read_b128 v[80:83], v22 offset:50176
  s_lshr_b32 s79, s2, 6
  s_lshl_b32 s79, s79, 2
  s_add_u32 s79, s79, s44
  s_lshl_b32 s79, s79, 8
  v_mfma_f32_16x16x32_bf16 v[132:135], a[4:7], v[84:87], v[132:135]
  buffer_load_dwordx4 v[148:151], v1, s[8:11], s56 offen sc1
  s_add_u32 s56, s47, 42074112
  v_cvt_pk_bf16_f32 v52, v52, v53
  v_cvt_pk_bf16_f32 v53, v54, v55
  ds_write_b64 v18, v[52:53] offset:6144
  v_cvt_pk_bf16_f32 v60, v60, v61
  v_cvt_pk_bf16_f32 v61, v62, v63
  v_cvt_pk_bf16_f32 v62, v68, v69
  v_mfma_f32_16x16x32_bf16 v[128:131], a[16:19], v[96:99], v[128:131]
  ds_read_b128 v[88:91], v22 offset:51200
  v_cvt_pk_bf16_f32 v63, v70, v71
  ds_write_b128 v17, v[60:63] offset:7168
  v_cvt_pk_bf16_f32 v56, v56, v57
  v_cvt_pk_bf16_f32 v57, v58, v59
  v_mfma_f32_16x16x32_bf16 v[128:131], a[24:27], v[92:95], v[128:131]
  s_cmp_lg_u32 s44, 0
  s_cbranch_scc1 PI10_adaLN_cond__sliding_local_dilated__swiglu_ffn__prompt_kernel
  buffer_load_dword v13, v14, s[8:11], s77 offen sc1
PI10_adaLN_cond__sliding_local_dilated__swiglu_ffn__prompt_kernel:
  buffer_load_dwordx4 v[152:155], v1, s[8:11], s56 offen sc1
  ds_write_b64 v18, v[56:57] offset:12288
  v_cvt_pk_bf16_f32 v64, v64, v65
  v_cvt_pk_bf16_f32 v65, v66, v67
  v_mfma_f32_16x16x32_bf16 v[132:135], a[28:31], v[92:95], v[132:135]
  ds_read_b128 v[84:87], v22 offset:52224
  s_add_u32 s56, s47, 42139648
  v_cvt_pk_bf16_f32 v66, v72, v73
  v_cvt_pk_bf16_f32 v67, v74, v75
  ds_write_b128 v17, v[64:67] offset:13312
  v_mfma_f32_16x16x32_bf16 v[132:135], a[20:23], v[96:99], v[132:135]
  s_waitcnt lgkmcnt(8)
  buffer_load_dwordx4 v[156:159], v1, s[8:11], s56 offen sc1
  s_add_u32 m0, s70, 16384
  s_add_u32 s69, s62, 65536
  s_bitcmp1_b32 s44, 0
  s_mov_b32 s52, 6144
  s_cselect_b32 s52, 12288, s52
  s_mov_b32 s53, 0
  s_cselect_b32 s53, 6144, s53
  v_add_u32 v116, s52, v19
  v_add_u32 v117, s53, v19
  v_mfma_f32_16x16x32_bf16 v[128:131], a[32:35], v[100:103], v[128:131]
  ds_read_b128 v[92:95], v22 offset:53248
  v_add_u32 v118, s52, v20
  v_add_u32 v119, s53, v20
  s_waitcnt vmcnt(8) lgkmcnt(1)
  s_barrier
  v_mfma_f32_16x16x32_bf16 v[128:131], a[40:43], v[104:107], v[128:131]
  buffer_load_dwordx4 v9, s[8:11], s69 offen offset:0 sc1 lds
  ds_read_b128 v[52:55], v116
  ds_read_b128 v[56:59], v117 offset:1024
  ds_read_b128 v[60:63], v116 offset:1024
  v_mfma_f32_16x16x32_bf16 v[132:135], a[44:47], v[104:107], v[132:135]
  ds_read_b128 v[96:99], v22 offset:54272
  ds_read_b64_tr_b16 v[64:65], v119 offset:2048
  ds_read_b64_tr_b16 v[66:67], v118 offset:2048
  ds_read_b64_tr_b16 v[68:69], v119 offset:2056
  v_mfma_f32_16x16x32_bf16 v[132:135], a[36:39], v[100:103], v[132:135]
  ds_read_b64_tr_b16 v[70:71], v118 offset:2056
  v_mfma_f32_16x16x32_bf16 v[128:131], a[48:51], v[112:115], v[128:131]
  ds_read_b128 v[104:107], v22 offset:55296
  v_mfma_f32_16x16x32_bf16 v[128:131], a[56:59], v[108:111], v[128:131]
  buffer_load_dwordx4 v9, s[8:11], s69 offen offset:1024 sc1 lds
  v_mfma_f32_16x16x32_bf16 v[132:135], a[60:63], v[108:111], v[132:135]
  ds_read_b128 v[100:103], v22 offset:56320
  v_mfma_f32_16x16x32_bf16 v[132:135], a[52:55], v[112:115], v[132:135]
  s_waitcnt lgkmcnt(12)
  buffer_load_dwordx4 v9, s[8:11], s69 offen offset:2048 sc1 lds
  v_mfma_f32_16x16x32_bf16 v[128:131], a[64:67], v[76:79], v[128:131]
  ds_read_b128 v[108:111], v23 offset:32768
  s_waitcnt lgkmcnt(3)
  v_mfma_f32_16x16x32_bf16 v[116:119], v[56:59], v[52:55], 0
  v_mfma_f32_16x16x32_bf16 v[120:123], v[60:63], v[52:55], 0
  v_mfma_f32_16x16x32_bf16 v[128:131], a[72:75], v[80:83], v[128:131]
  v_mfma_f32_16x16x32_bf16 v[132:135], a[76:79], v[80:83], v[132:135]
  ds_read_b128 v[112:115], v23 offset:33792
  v_mfma_f32_16x16x32_bf16 v[132:135], a[68:71], v[76:79], v[132:135]
  buffer_load_dwordx4 v9, s[8:11], s69 offen offset:3072 sc1 lds
  s_add_u32 m0, s70, 81920
  s_add_u32 s69, s63, 65536
  v_mfma_f32_16x16x32_bf16 v[128:131], a[80:83], v[88:91], v[128:131]
  ds_read_b128 v[80:83], v23 offset:34816
  v_cndmask_b32 v72, v116, v120, s[80:81]
  v_cndmask_b32 v73, v117, v121, s[82:83]
  v_cndmask_b32 v74, v118, v122, s[84:85]
  v_cndmask_b32 v75, v119, v123, s[86:87]
  v_cndmask_b32 v72, v72, v73, s[88:89]
  v_cndmask_b32 v73, v74, v75, s[88:89]
  v_mfma_f32_16x16x32_bf16 v[128:131], a[88:91], v[84:87], v[128:131]
  buffer_load_dwordx4 v9, s[8:11], s69 offen offset:0 sc1 lds
  v_mul_f32 v72, 0x3e8293ee, v72
  v_mul_f32 v73, 0x3e8293ee, v73
  v_max_f32 v74, v72, v73
  v_mov_b32 v75, v74
  v_mfma_f32_16x16x32_bf16 v[132:135], a[92:95], v[84:87], v[132:135]
  ds_read_b128 v[76:79], v23 offset:35840
  v_permlane16_swap_b32 v74, v75
  v_max_f32 v74, v74, v75
  v_mov_b32 v75, v74
  v_mfma_f32_16x16x32_bf16 v[132:135], a[84:87], v[88:91], v[132:135]
  s_waitcnt lgkmcnt(4)
  v_permlane32_swap_b32 v74, v75
  v_max_f32 v74, v74, v75
  v_sub_f32 v72, v72, v74
  v_sub_f32 v73, v73, v74
  v_exp_f32 v72, v72
  v_mfma_f32_16x16x32_bf16 v[128:131], a[96:99], v[92:95], v[128:131]
  ds_read_b128 v[84:87], v23 offset:36864
  v_exp_f32 v73, v73
  v_mfma_f32_16x16x32_bf16 v[128:131], a[104:107], v[96:99], v[128:131]
  buffer_load_dwordx4 v9, s[8:11], s69 offen offset:1024 sc1 lds
  v_add_f32 v74, v72, v73
  v_mov_b32 v75, v74
  v_mfma_f32_16x16x32_bf16 v[132:135], a[108:111], v[96:99], v[132:135]
  ds_read_b128 v[88:91], v23 offset:37888
  v_permlane16_swap_b32 v74, v75
  v_add_f32 v74, v74, v75
  v_mov_b32 v75, v74
  v_mfma_f32_16x16x32_bf16 v[132:135], a[100:103], v[92:95], v[132:135]
  buffer_load_dwordx4 v9, s[8:11], s69 offen offset:2048 sc1 lds
  v_permlane32_swap_b32 v74, v75
  v_add_f32 v74, v74, v75
  v_rcp_f32 v74, v74
  v_mfma_f32_16x16x32_bf16 v[128:131], a[112:115], v[104:107], v[128:131]
  ds_read_b128 v[96:99], v23 offset:38912
HOP5:
  s_cbranch_execz WRET0
  v_mul_f32 v72, v72, v74
  v_mul_f32 v73, v73, v74
  v_cvt_pk_bf16_f32 v72, v72, v72
  v_cvt_pk_bf16_f32 v73, v73, v73
  v_and_b32 v52, v24, v72
  v_and_b32 v53, v25, v73
  v_mfma_f32_16x16x32_bf16 v[128:131], a[120:123], v[100:103], v[128:131]
  v_and_b32 v54, v26, v72
  v_and_b32 v55, v27, v73
  v_mfma_f32_16x16x32_bf16 v[132:135], a[124:127], v[100:103], v[132:135]
  ds_read_b128 v[92:95], v23 offset:39936
  v_mfma_f32_16x16x32_bf16 v[56:59], v[64:67], v[52:55], 0
  v_mfma_f32_16x16x32_bf16 v[60:63], v[68:71], v[52:55], 0
  v_mfma_f32_16x16x32_bf16 v[132:135], a[116:119], v[104:107], v[132:135]
  s_waitcnt lgkmcnt(4)
  buffer_load_dwordx4 v9, s[8:11], s69 offen offset:3072 sc1 lds
  v_mfma_f32_16x16x32_bf16 v[128:131], a[128:131], v[108:111], v[128:131]
  ds_read_b128 v[100:103], v23 offset:49152
  s_add_u32 m0, s70, 65536
  s_add_u32 s69, s64, 65536
  v_mfma_f32_16x16x32_bf16 v[128:131], a[136:139], v[112:115], v[128:131]
  buffer_load_dwordx4 v9, s[8:11], s69 offen offset:0 sc1 lds
  v_mfma_f32_16x16x32_bf16 v[132:135], a[140:143], v[112:115], v[132:135]
  ds_read_b128 v[104:107], v23 offset:50176
  v_cvt_pk_bf16_f32 v116, v56, v57
  v_cvt_pk_bf16_f32 v117, v58, v59
  v_cvt_pk_bf16_f32 v118, v60, v61
  v_cvt_pk_bf16_f32 v119, v62, v63
  v_mfma_f32_16x16x32_bf16 v[132:135], a[132:135], v[108:111], v[132:135]
  buffer_store_dwordx4 v[116:119], v1, s[8:11], s73 offen sc1
  s_add_u32 s73, s73, 65536
  v_mfma_f32_16x16x32_bf16 v[128:131], a[144:147], v[80:83], v[128:131]
  ds_read_b128 v[112:115], v23 offset:51200
  v_mfma_f32_16x16x32_bf16 v[128:131], a[152:155], v[76:79], v[128:131]
  buffer_load_dwordx4 v9, s[8:11], s69 offen offset:1024 sc1 lds
  v_mfma_f32_16x16x32_bf16 v[132:135], a[156:159], v[76:79], v[132:135]
  ds_read_b128 v[108:111], v23 offset:52224
  v_mfma_f32_16x16x32_bf16 v[132:135], a[148:151], v[80:83], v[132:135]
  s_waitcnt lgkmcnt(4)
  buffer_load_dwordx4 v9, s[8:11], s69 offen offset:2048 sc1 lds
  v_mfma_f32_16x16x32_bf16 v[128:131], a[160:163], v[84:87], v[128:131]
  ds_read_b128 v[76:79], v23 offset:53248
  s_cmp_lg_u32 s44, 0
  s_cbranch_scc1 PL11_adaLN_cond__sliding_local_dilated__swiglu_ffn__prompt_kernelx
  s_waitcnt vmcnt(14)
  v_subrev_u32 v13, s46, v13
  v_subrev_u32 v13, 2, v13
  v_cmp_lt_u32 vcc, 3, v13
  s_nop 4
  s_cbranch_vccz PL11_adaLN_cond__sliding_local_dilated__swiglu_ffn__prompt_kernelx
  s_mov_b32 s57, 60000
PL11_adaLN_cond__sliding_local_dilated__swiglu_ffn__prompt_kernel:
  buffer_load_dword v13, v14, s[8:11], s77 offen sc1
  s_sub_u32 s57, s57, 1
  s_cmp_eq_u32 s57, 0
  s_waitcnt vmcnt(0)
  s_cbranch_scc1 PL11_adaLN_cond__sliding_local_dilated__swiglu_ffn__prompt_kernelx
  v_subrev_u32 v13, s46, v13
  v_subrev_u32 v13, 2, v13
  v_cmp_lt_u32 vcc, 3, v13
  s_nop 4
  s_cbranch_vccnz PL11_adaLN_cond__sliding_local_dilated__swiglu_ffn__prompt_kernel
PL11_adaLN_cond__sliding_local_dilated__swiglu_ffn__prompt_kernelx:
  s_barrier
  v_mfma_f32_16x16x32_bf16 v[128:131], a[168:171], v[88:91], v[128:131]
  s_waitcnt vmcnt(16)
  v_add_f32 v160, v160, v161
  v_add_f32 v162, v162, v163
  v_add_f32 v160, v160, v162
  v_mfma_f32_16x16x32_bf16 v[132:135], a[172:175], v[88:91], v[132:135]
  ds_read_b128 v[80:83], v23 offset:54272
  v_cvt_pk_bf16_f32 v160, v160, v160
  v_lshlrev_b32 v160, 16, v160
  v_mfma_f32_16x16x32_bf16 v[132:135], a[164:167], v[84:87], v[132:135]
  buffer_load_dwordx4 v9, s[8:11], s69 offen offset:3072 sc1 lds
  s_add_u32 m0, s70, 0
  s_add_u32 s69, s65, 65536
  v_cvt_f32_u32 v181, v181
  v_mfma_f32_16x16x32_bf16 v[128:131], a[176:179], v[96:99], v[128:131]
  ds_read_b128 v[88:91], v23 offset:55296
  v_add_f32 v160, v160, v181
  v_cvt_pk_bf16_f32 v160, v160, v160
  v_mfma_f32_16x16x32_bf16 v[128:131], a[184:187], v[92:95], v[128:131]
  buffer_load_dwordx4 v9, s[8:11], s69 offen offset:0 sc1 lds
  v_lshlrev_b32 v160, 16, v160
  s_lshl_b32 s54, s44, 8
  s_add_u32 s54, s54, 150528
  v_mfma_f32_16x16x32_bf16 v[132:135], a[188:191], v[92:95], v[132:135]
  ds_read_b128 v[84:87], v23 offset:56320
  v_lshl_add_u32 v180, v0, 2, s54
  v_lshrrev_b32 v161, 4, v0
  v_mfma_f32_16x16x32_bf16 v[132:135], a[180:183], v[96:99], v[132:135]
  s_waitcnt lgkmcnt(4)
  v_lshl_add_u32 v181, v161, 4, s54
  s_waitcnt vmcnt(6)
  s_barrier
  v_mfma_f32_16x16x32_bf16 v[128:131], a[192:195], v[100:103], v[128:131]
  ds_read_b128 v[92:95], v22 offset:16384
  ds_write_b32 v180, v160
  v_mfma_f32_16x16x32_bf16 v[128:131], a[200:203], v[104:107], v[128:131]
  buffer_load_dwordx4 v9, s[8:11], s69 offen offset:1024 sc1 lds
  v_bfe_u32 v180, v0, 2, 2
  v_xor_b32 v180, v180, v161
  v_lshlrev_b32 v180, 27, v180
  v_mfma_f32_16x16x32_bf16 v[132:135], a[204:207], v[104:107], v[132:135]
  ds_read_b128 v[96:99], v22 offset:17408
  v_and_b32 v162, 15, v0
  v_lshl_add_u32 v180, v162, 4, v180
  v_mfma_f32_16x16x32_bf16 v[132:135], a[196:199], v[100:103], v[132:135]
  buffer_load_dwordx4 v9, s[8:11], s69 offen offset:2048 sc1 lds
  s_and_b32 s54, s44, 1
  s_lshl_b32 s54, s54, 11
  v_add_u32 v182, s54, v1
  v_mfma_f32_16x16x32_bf16 v[128:131], a[208:211], v[112:115], v[128:131]
  ds_read_b128 v[104:107], v22 offset:18432
  s_and_b32 s54, s44, 2
  s_lshl_b32 s54, s54, 9
  v_mfma_f32_16x16x32_bf16 v[128:131], a[216:219], v[108:111], v[128:131]
  s_add_u32 s54, s54, 135168
  v_add_u32 v182, s54, v182
  ds_read_b128 v[160:163], v181 offset:0
  v_mfma_f32_16x16x32_bf16 v[132:135], a[220:223], v[108:111], v[132:135]
  ds_read_b128 v[100:103], v22 offset:19456
  ds_read_b128 v[164:167], v181 offset:64
  v_mfma_f32_16x16x32_bf16 v[132:135], a[212:215], v[112:115], v[132:135]
  s_waitcnt lgkmcnt(7)
  buffer_load_dwordx4 v9, s[8:11], s69 offen offset:3072 sc1 lds
  ds_read_b128 v[168:171], v181 offset:128
  v_mfma_f32_16x16x32_bf16 v[128:131], a[224:227], v[76:79], v[128:131]
  ds_read_b128 v[108:111], v22 offset:20480
  s_add_u32 m0, s70, 32768
  s_add_u32 s69, s62, 131072
  v_mfma_f32_16x16x32_bf16 v[128:131], a[232:235], v[80:83], v[128:131]
  buffer_load_dwordx4 v9, s[8:11], s69 offen offset:0 sc1 lds
  ds_read_b128 v[172:175], v181 offset:192
  v_mov_b32 v176, 0x3f803f80
  v_mfma_f32_16x16x32_bf16 v[132:135], a[236:239], v[80:83], v[132:135]
  ds_read_b128 v[112:115], v22 offset:21504
  v_mov_b32 v177, 0x3f803f80
  v_mov_b32 v178, 0x3f803f80
  v_mfma_f32_16x16x32_bf16 v[132:135], a[228:231], v[76:79], v[132:135]
  v_mov_b32 v179, 0x3f803f80
  s_mov_b32 s90, 0xcccccccc
  s_mov_b32 s91, 0xcccccccc
  v_mfma_f32_16x16x32_bf16 v[128:131], a[240:243], v[88:91], v[128:131]
  ds_read_b128 v[80:83], v22 offset:22528
  v_lshrrev_b32 v220, 5, v0
  v_xor_b32 v220, 1, v220
  v_lshlrev_b32 v220, 12, v220
  v_mfma_f32_16x16x32_bf16 v[128:131], a[248:251], v[84:87], v[128:131]
  buffer_load_dwordx4 v9, s[8:11], s69 offen offset:1024 sc1 lds
  s_waitcnt vmcnt(22) lgkmcnt(2)
  v_lshlrev_b32 v184, 16, v144
  v_and_b32 v185, 0xffff0000, v144
  v_mfma_f32_16x16x32_bf16 v[132:135], v[124:127], v[84:87], v[132:135]
  ds_read_b128 v[76:79], v22 offset:23552
  v_and_b32 v221, 31, v0
  v_lshl_add_u32 v220, v221, 3, v220
  v_mfma_f32_16x16x32_bf16 v[132:135], a[244:247], v[88:91], v[132:135]
  s_waitcnt lgkmcnt(7)
  buffer_load_dwordx4 v9, s[8:11], s69 offen offset:2048 sc1 lds
  v_add_u32 v15, s46, v0
  v_add_u32 v15, 3, v15
  s_waitcnt vmcnt(10)
  s_barrier
  s_mov_b64 exec, 1
  buffer_store_dword v15, v0, s[8:11], s74 offen offset:0 sc1
  s_mov_b64 exec, -1
  v_mfma_f32_16x16x32_bf16 v[136:139], a[0:3], v[92:95], 0
  ds_read_b128 v[84:87], v23 offset:16384
  v_lshlrev_b32 v186, 16, v145
  v_and_b32 v187, 0xffff0000, v145
  v_mfma_f32_16x16x32_bf16 v[136:139], a[8:11], v[96:99], v[136:139]
  v_lshlrev_b32 v188, 16, v146
  v_and_b32 v189, 0xffff0000, v146
  v_lshlrev_b32 v190, 16, v147
  v_mfma_f32_16x16x32_bf16 v[140:143], a[12:15], v[96:99], 0
  ds_read_b128 v[88:91], v23 offset:17408
  v_and_b32 v191, 0xffff0000, v147
  v_fmac_f32 v184, v160, v128
  v_mfma_f32_16x16x32_bf16 v[140:143], a[4:7], v[92:95], v[140:143]
  buffer_load_dwordx4 v9, s[8:11], s69 offen offset:3072 sc1 lds
  s_add_u32 m0, s70, 49152
  s_add_u32 s69, s63, 131072
  v_fmac_f32 v185, v161, v129
  v_mfma_f32_16x16x32_bf16 v[136:139], a[16:19], v[104:107], v[136:139]
  ds_read_b128 v[96:99], v23 offset:18432
  v_fmac_f32 v186, v162, v130
  v_fmac_f32 v187, v163, v131
  v_mfma_f32_16x16x32_bf16 v[136:139], a[24:27], v[100:103], v[136:139]
  buffer_load_dwordx4 v9, s[8:11], s69 offen offset:0 sc1 lds
  v_fmac_f32 v188, v164, v132
  v_fmac_f32 v189, v165, v133
  v_fmac_f32 v190, v166, v134
  v_mfma_f32_16x16x32_bf16 v[140:143], a[28:31], v[100:103], v[140:143]
  ds_read_b128 v[92:95], v23 offset:19456
  v_fmac_f32 v191, v167, v135
  v_mul_f32 v128, v184, v168
  v_mfma_f32_16x16x32_bf16 v[140:143], a[20:23], v[104:107], v[140:143]
  s_waitcnt lgkmcnt(4)
  v_mul_f32 v129, v185, v169
  v_mul_f32 v130, v186, v170
  v_mul_f32 v131, v187, v171
  v_mfma_f32_16x16x32_bf16 v[136:139], a[32:35], v[108:111], v[136:139]
  ds_read_b128 v[100:103], v23 offset:20480
  v_mul_f32 v132, v188, v172
  v_mul_f32 v133, v189, v173
  v_mfma_f32_16x16x32_bf16 v[136:139], a[40:43], v[112:115], v[136:139]
  buffer_load_dwordx4 v9, s[8:11], s69 offen offset:1024 sc1 lds
  v_mul_f32 v134, v190, v174
  v_mul_f32 v135, v191, v175
  v_cvt_pk_bf16_f32 v196, v128, v129
  v_mfma_f32_16x16x32_bf16 v[140:143], a[44:47], v[112:115], v[140:143]
  ds_read_b128 v[104:107], v23 offset:21504
  v_cvt_pk_bf16_f32 v197, v130, v131
  v_cvt_pk_bf16_f32 v198, v132, v133
  v_mfma_f32_16x16x32_bf16 v[140:143], a[36:39], v[108:111], v[140:143]
  buffer_load_dwordx4 v9, s[8:11], s69 offen offset:2048 sc1 lds
  v_cvt_pk_bf16_f32 v199, v134, v135
  v_mfma_f32_16x16x32_bf16 v[136:139], a[48:51], v[80:83], v[136:139]
  ds_read_b128 v[112:115], v23 offset:22528
  v_mfma_f32_16x16x32_bf16 v[136:139], a[56:59], v[76:79], v[136:139]
  s_add_u32 s54, s47, 36700160
  buffer_store_dwordx4 v[196:199], v1, s[8:11], s54 offen sc1
  v_mfma_f32_16x16x32_bf16 v[140:143], a[60:63], v[76:79], v[140:143]
  ds_read_b128 v[108:111], v23 offset:23552
  buffer_load_dwordx4 v9, s[8:11], s69 offen offset:3072 sc1 lds
  v_cvt_pk_bf16_f32 v144, v184, v185
  v_mfma_f32_16x16x32_bf16 v[140:143], a[52:55], v[80:83], v[140:143]
  s_waitcnt lgkmcnt(4)
  v_cvt_pk_bf16_f32 v145, v186, v187
  s_waitcnt vmcnt(10)
  s_barrier
  v_mfma_f32_16x16x32_bf16 v[136:139], a[64:67], v[84:87], v[136:139]
  ds_read_b128 v[76:79], v23 offset:0
  s_add_u32 m0, s70, 98304
  s_add_u32 s69, s64, 131072
  v_mfma_f32_16x16x32_bf16 v[136:139], a[72:75], v[88:91], v[136:139]
  buffer_load_dwordx4 v9, s[8:11], s69 offen offset:0 sc1 lds
  v_cvt_pk_bf16_f32 v146, v188, v189
  v_cvt_pk_bf16_f32 v147, v190, v191
  v_mfma_f32_16x16x32_bf16 v[140:143], a[76:79], v[88:91], v[140:143]
  ds_read_b128 v[80:83], v23 offset:1024
  v_mfma_f32_16x16x32_bf16 v[224:227], v[176:179], v[144:147], 0
  v_mfma_f32_16x16x32_bf16 v[192:195], v[144:147], v[144:147], 0
  v_mfma_f32_16x16x32_bf16 v[140:143], a[68:71], v[84:87], v[140:143]
  v_mfma_f32_16x16x32_bf16 v[136:139], a[80:83], v[96:99], v[136:139]
  ds_read_b128 v[88:91], v23 offset:2048
  v_mfma_f32_16x16x32_bf16 v[136:139], a[88:91], v[92:95], v[136:139]
  buffer_load_dwordx4 v9, s[8:11], s69 offen offset:1024 sc1 lds
  s_nop 2
  v_cndmask_b32 v192, v192, v193, s[88:89]
  v_cndmask_b32 v194, v194, v195, s[88:89]
  v_cndmask_b32 v225, v192, v194, s[90:91]
  v_mfma_f32_16x16x32_bf16 v[140:143], a[92:95], v[92:95], v[140:143]
  ds_read_b128 v[84:87], v23 offset:3072
  v_mfma_f32_16x16x32_bf16 v[140:143], a[84:87], v[96:99], v[140:143]
  s_waitcnt lgkmcnt(4)
  buffer_load_dwordx4 v9, s[8:11], s69 offen offset:2048 sc1 lds
  v_mfma_f32_16x16x32_bf16 v[136:139], a[96:99], v[100:103], v[136:139]
  ds_read_b128 v[92:95], v23 offset:4096
  v_mfma_f32_16x16x32_bf16 v[136:139], a[104:107], v[104:107], v[136:139]
  v_mfma_f32_16x16x32_bf16 v[140:143], a[108:111], v[104:107], v[140:143]
  ds_read_b128 v[96:99], v23 offset:5120
  v_mfma_f32_16x16x32_bf16 v[140:143], a[100:103], v[100:103], v[140:143]
  buffer_load_dwordx4 v9, s[8:11], s69 offen offset:3072 sc1 lds
  s_add_u32 m0, s70, 114688
  s_add_u32 s69, s65, 131072
  v_mfma_f32_16x16x32_bf16 v[136:139], a[112:115], v[112:115], v[136:139]
  ds_read_b128 v[104:107], v23 offset:6144
  v_mfma_f32_16x16x32_bf16 v[136:139], a[120:123], v[108:111], v[136:139]
  buffer_load_dwordx4 v9, s[8:11], s69 offen offset:0 sc1 lds
  v_mfma_f32_16x16x32_bf16 v[140:143], a[124:127], v[108:111], v[140:143]
  ds_read_b128 v[100:103], v23 offset:7168
  v_mfma_f32_16x16x32_bf16 v[140:143], a[116:119], v[112:115], v[140:143]
  s_waitcnt lgkmcnt(4)
  v_mfma_f32_16x16x32_bf16 v[136:139], a[128:131], v[76:79], v[136:139]
  ds_read_b128 v[108:111], v22 offset:0
  v_mfma_f32_16x16x32_bf16 v[136:139], a[136:139], v[80:83], v[136:139]
  buffer_load_dwordx4 v9, s[8:11], s69 offen offset:1024 sc1 lds
  v_mfma_f32_16x16x32_bf16 v[140:143], a[140:143], v[80:83], v[140:143]
  ds_read_b128 v[112:115], v22 offset:1024
  v_mfma_f32_16x16x32_bf16 v[140:143], a[132:135], v[76:79], v[140:143]
  buffer_load_dwordx4 v9, s[8:11], s69 offen offset:2048 sc1 lds
  v_mfma_f32_16x16x32_bf16 v[136:139], a[144:147], v[88:91], v[136:139]
  ds_read_b128 v[80:83], v22 offset:2048
  v_mfma_f32_16x16x32_bf16 v[136:139], a[152:155], v[84:87], v[136:139]
  v_mfma_f32_16x16x32_bf16 v[140:143], a[156:159], v[84:87], v[140:143]
  ds_read_b128 v[76:79], v22 offset:3072
  v_mfma_f32_16x16x32_bf16 v[140:143], a[148:151], v[88:91], v[140:143]
  s_waitcnt lgkmcnt(4)
  buffer_load_dwordx4 v9, s[8:11], s69 offen offset:3072 sc1 lds
  v_mfma_f32_16x16x32_bf16 v[136:139], a[160:163], v[92:95], v[136:139]
  ds_read_b128 v[84:87], v22 offset:4096
  v_mfma_f32_16x16x32_bf16 v[136:139], a[168:171], v[96:99], v[136:139]
  s_cmp_lg_u32 s44, 0
  s_cbranch_scc1 PI12_adaLN_cond__sliding_local_dilated__swiglu_ffn__prompt_kernel
  buffer_load_dword v13, v14, s[8:11], s77 offen sc1
PI12_adaLN_cond__sliding_local_dilated__swiglu_ffn__prompt_kernel:
  v_mfma_f32_16x16x32_bf16 v[140:143], a[172:175], v[96:99], v[140:143]
  ds_read_b128 v[88:91], v22 offset:5120
  v_mfma_f32_16x16x32_bf16 v[140:143], a[164:167], v[92:95], v[140:143]
  v_mfma_f32_16x16x32_bf16 v[136:139], a[176:179], v[104:107], v[136:139]
  ds_read_b128 v[96:99], v22 offset:6144
  v_mfma_f32_16x16x32_bf16 v[136:139], a[184:187], v[100:103], v[136:139]
  v_mfma_f32_16x16x32_bf16 v[140:143], a[188:191], v[100:103], v[140:143]
  ds_read_b128 v[92:95], v22 offset:7168
  v_mfma_f32_16x16x32_bf16 v[140:143], a[180:183], v[104:107], v[140:143]
  s_waitcnt lgkmcnt(4)
  s_waitcnt vmcnt(8)
  s_barrier
  v_mfma_f32_16x16x32_bf16 v[136:139], a[192:195], v[108:111], v[136:139]
  ds_read_b128 v[100:103], v22 offset:32768
  v_mfma_f32_16x16x32_bf16 v[136:139], a[200:203], v[112:115], v[136:139]
  v_mfma_f32_16x16x32_bf16 v[140:143], a[204:207], v[112:115], v[140:143]
  ds_read_b128 v[104:107], v22 offset:33792
  v_mfma_f32_16x16x32_bf16 v[140:143], a[196:199], v[108:111], v[140:143]
  v_mfma_f32_16x16x32_bf16 v[136:139], a[208:211], v[80:83], v[136:139]
  ds_read_b128 v[112:115], v22 offset:34816
  s_waitcnt vmcnt(37) lgkmcnt(15)
  v_lshlrev_b32 v184, 16, v148
  v_mfma_f32_16x16x32_bf16 v[136:139], a[216:219], v[76:79], v[136:139]
  v_and_b32 v185, 0xffff0000, v148
  v_lshlrev_b32 v186, 16, v149
  v_and_b32 v187, 0xffff0000, v149
  v_mfma_f32_16x16x32_bf16 v[140:143], a[220:223], v[76:79], v[140:143]
  ds_read_b128 v[108:111], v22 offset:35840
  v_lshlrev_b32 v188, 16, v150
  v_and_b32 v189, 0xffff0000, v150
  v_mfma_f32_16x16x32_bf16 v[140:143], a[212:215], v[80:83], v[140:143]
  s_waitcnt lgkmcnt(4)
  v_lshlrev_b32 v190, 16, v151
  v_and_b32 v191, 0xffff0000, v151
  v_mfma_f32_16x16x32_bf16 v[136:139], a[224:227], v[84:87], v[136:139]
  ds_read_b128 v[76:79], v22 offset:36864
  v_mfma_f32_16x16x32_bf16 v[136:139], a[232:235], v[88:91], v[136:139]
  v_mfma_f32_16x16x32_bf16 v[140:143], a[236:239], v[88:91], v[140:143]
  ds_read_b128 v[80:83], v22 offset:37888
  v_mfma_f32_16x16x32_bf16 v[140:143], a[228:231], v[84:87], v[140:143]
  v_mfma_f32_16x16x32_bf16 v[136:139], a[240:243], v[96:99], v[136:139]
  ds_read_b128 v[88:91], v22 offset:38912
  v_mfma_f32_16x16x32_bf16 v[136:139], a[248:251], v[92:95], v[136:139]
  v_mfma_f32_16x16x32_bf16 v[140:143], v[124:127], v[92:95], v[140:143]
  ds_read_b128 v[84:87], v22 offset:39936
  v_mfma_f32_16x16x32_bf16 v[140:143], a[244:247], v[96:99], v[140:143]
  s_waitcnt lgkmcnt(4)
  v_mfma_f32_16x16x32_bf16 v[128:131], a[0:3], v[100:103], 0
  ds_read_b128 v[92:95], v22 offset:49152
  v_mfma_f32_16x16x32_bf16 v[128:131], a[8:11], v[104:107], v[128:131]
  v_mfma_f32_16x16x32_bf16 v[132:135], a[12:15], v[104:107], 0
  ds_read_b128 v[96:99], v22 offset:50176
  v_fmac_f32 v184, v160, v136
  v_fmac_f32 v185, v161, v137
  v_mfma_f32_16x16x32_bf16 v[132:135], a[4:7], v[100:103], v[132:135]
  v_fmac_f32 v186, v162, v138
  v_fmac_f32 v187, v163, v139
  v_fmac_f32 v188, v164, v140
  v_mfma_f32_16x16x32_bf16 v[128:131], a[16:19], v[112:115], v[128:131]
  ds_read_b128 v[104:107], v22 offset:51200
  v_fmac_f32 v189, v165, v141
  v_fmac_f32 v190, v166, v142
  v_mfma_f32_16x16x32_bf16 v[128:131], a[24:27], v[108:111], v[128:131]
  v_fmac_f32 v191, v167, v143
  v_mul_f32 v136, v184, v168
  v_mul_f32 v137, v185, v169
  v_mfma_f32_16x16x32_bf16 v[132:135], a[28:31], v[108:111], v[132:135]
  ds_read_b128 v[100:103], v22 offset:52224
  v_mul_f32 v138, v186, v170
  v_mul_f32 v139, v187, v171
  v_mfma_f32_16x16x32_bf16 v[132:135], a[20:23], v[112:115], v[132:135]
  s_waitcnt lgkmcnt(4)
  v_mul_f32 v140, v188, v172
  v_mul_f32 v141, v189, v173
  v_mul_f32 v142, v190, v174
  v_mfma_f32_16x16x32_bf16 v[128:131], a[32:35], v[76:79], v[128:131]
  ds_read_b128 v[108:111], v22 offset:53248
  v_mul_f32 v143, v191, v175
  v_cvt_pk_bf16_f32 v200, v136, v137
  v_mfma_f32_16x16x32_bf16 v[128:131], a[40:43], v[80:83], v[128:131]
  v_cvt_pk_bf16_f32 v201, v138, v139
  v_cvt_pk_bf16_f32 v202, v140, v141
  v_cvt_pk_bf16_f32 v203, v142, v143
  v_mfma_f32_16x16x32_bf16 v[132:135], a[44:47], v[80:83], v[132:135]
  ds_read_b128 v[112:115], v22 offset:54272
  v_mfma_f32_16x16x32_bf16 v[132:135], a[36:39], v[76:79], v[132:135]
  s_add_u32 s54, s47, 36765696
  buffer_store_dwordx4 v[200:203], v1, s[8:11], s54 offen sc1
  v_mfma_f32_16x16x32_bf16 v[128:131], a[48:51], v[88:91], v[128:131]
  ds_read_b128 v[80:83], v22 offset:55296
  s_cmp_lg_u32 s44, 0
  s_cbranch_scc1 PL13_adaLN_cond__sliding_local_dilated__swiglu_ffn__prompt_kernelx
  s_waitcnt vmcnt(1)
  v_subrev_u32 v13, s46, v13
  v_subrev_u32 v13, 3, v13
  v_cmp_lt_u32 vcc, 3, v13
  s_nop 4
  s_cbranch_vccz PL13_adaLN_cond__sliding_local_dilated__swiglu_ffn__prompt_kernelx
  s_mov_b32 s57, 60000
PL13_adaLN_cond__sliding_local_dilated__swiglu_ffn__prompt_kernel:
  buffer_load_dword v13, v14, s[8:11], s77 offen sc1
  s_sub_u32 s57, s57, 1
  s_cmp_eq_u32 s57, 0
  s_waitcnt vmcnt(0)
  s_cbranch_scc1 PL13_adaLN_cond__sliding_local_dilated__swiglu_ffn__prompt_kernelx
  v_subrev_u32 v13, s46, v13
  v_subrev_u32 v13, 3, v13
  v_cmp_lt_u32 vcc, 3, v13
  s_nop 4
  s_cbranch_vccnz PL13_adaLN_cond__sliding_local_dilated__swiglu_ffn__prompt_kernel
PL13_adaLN_cond__sliding_local_dilated__swiglu_ffn__prompt_kernelx:
  s_barrier
  v_mfma_f32_16x16x32_bf16 v[128:131], a[56:59], v[84:87], v[128:131]
  s_add_u32 m0, s70, 16384
  s_add_u32 s69, s62, 196608
  v_cvt_pk_bf16_f32 v148, v184, v185
  v_cvt_pk_bf16_f32 v149, v186, v187
  v_mfma_f32_16x16x32_bf16 v[132:135], a[60:63], v[84:87], v[132:135]
  ds_read_b128 v[76:79], v22 offset:56320
  buffer_load_dwordx4 v9, s[8:11], s69 offen offset:0 sc1 lds
  v_cvt_pk_bf16_f32 v150, v188, v189
  v_mfma_f32_16x16x32_bf16 v[132:135], a[52:55], v[88:91], v[132:135]
  s_waitcnt lgkmcnt(4)
  v_cvt_pk_bf16_f32 v151, v190, v191
  s_waitcnt vmcnt(2)
  s_barrier
  v_mfma_f32_16x16x32_bf16 v[128:131], a[64:67], v[92:95], v[128:131]
  ds_read_b128 v[84:87], v23 offset:32768
  buffer_load_dwordx4 v9, s[8:11], s69 offen offset:1024 sc1 lds
  v_mfma_f32_16x16x32_bf16 v[226:229], v[176:179], v[148:151], 0
  v_mfma_f32_16x16x32_bf16 v[192:195], v[148:151], v[148:151], 0
  v_mfma_f32_16x16x32_bf16 v[128:131], a[72:75], v[96:99], v[128:131]
  buffer_load_dwordx4 v9, s[8:11], s69 offen offset:2048 sc1 lds
  v_mfma_f32_16x16x32_bf16 v[132:135], a[76:79], v[96:99], v[132:135]
  ds_read_b128 v[88:91], v23 offset:33792
  v_mfma_f32_16x16x32_bf16 v[132:135], a[68:71], v[92:95], v[132:135]
  buffer_load_dwordx4 v9, s[8:11], s69 offen offset:3072 sc1 lds
  s_add_u32 m0, s70, 81920
  s_add_u32 s69, s63, 196608
  v_cndmask_b32 v192, v192, v193, s[88:89]
  v_mfma_f32_16x16x32_bf16 v[128:131], a[80:83], v[104:107], v[128:131]
  ds_read_b128 v[96:99], v23 offset:34816
  buffer_load_dwordx4 v9, s[8:11], s69 offen offset:0 sc1 lds
  v_cndmask_b32 v194, v194, v195, s[88:89]
  v_mfma_f32_16x16x32_bf16 v[128:131], a[88:91], v[100:103], v[128:131]
  v_cndmask_b32 v227, v192, v194, s[90:91]
  v_mfma_f32_16x16x32_bf16 v[132:135], a[92:95], v[100:103], v[132:135]
  ds_read_b128 v[92:95], v23 offset:35840
  buffer_load_dwordx4 v9, s[8:11], s69 offen offset:1024 sc1 lds
  v_mfma_f32_16x16x32_bf16 v[132:135], a[84:87], v[104:107], v[132:135]
  s_waitcnt lgkmcnt(4)
  buffer_load_dwordx4 v9, s[8:11], s69 offen offset:2048 sc1 lds
  v_mfma_f32_16x16x32_bf16 v[128:131], a[96:99], v[108:111], v[128:131]
  ds_read_b128 v[100:103], v23 offset:36864
  buffer_store_dwordx4 v[224:227], v180, s[8:11], s48 offen offset:0 sc1
  v_mfma_f32_16x16x32_bf16 v[128:131], a[104:107], v[112:115], v[128:131]
  buffer_load_dwordx4 v9, s[8:11], s69 offen offset:3072 sc1 lds
  s_add_u32 m0, s70, 65536
  s_add_u32 s69, s64, 196608
  v_mfma_f32_16x16x32_bf16 v[132:135], a[108:111], v[112:115], v[132:135]
  ds_read_b128 v[104:107], v23 offset:37888
  buffer_load_dwordx4 v9, s[8:11], s69 offen offset:0 sc1 lds
  v_mfma_f32_16x16x32_bf16 v[132:135], a[100:103], v[108:111], v[132:135]
  v_mfma_f32_16x16x32_bf16 v[128:131], a[112:115], v[80:83], v[128:131]
  ds_read_b128 v[112:115], v23 offset:38912
  buffer_load_dwordx4 v9, s[8:11], s69 offen offset:1024 sc1 lds
  v_mfma_f32_16x16x32_bf16 v[128:131], a[120:123], v[76:79], v[128:131]
  buffer_load_dwordx4 v9, s[8:11], s69 offen offset:2048 sc1 lds
  v_mfma_f32_16x16x32_bf16 v[132:135], a[124:127], v[76:79], v[132:135]
  ds_read_b128 v[108:111], v23 offset:39936
  v_mfma_f32_16x16x32_bf16 v[132:135], a[116:119], v[80:83], v[132:135]
  s_waitcnt lgkmcnt(4)
  buffer_load_dwordx4 v9, s[8:11], s69 offen offset:3072 sc1 lds
  s_add_u32 m0, s70, 0
  s_add_u32 s69, s65, 196608
  v_mfma_f32_16x16x32_bf16 v[128:131], a[128:131], v[84:87], v[128:131]
  ds_read_b128 v[76:79], v23 offset:49152
  buffer_load_dwordx4 v9, s[8:11], s69 offen offset:0 sc1 lds
  v_mfma_f32_16x16x32_bf16 v[128:131], a[136:139], v[88:91], v[128:131]
  v_mfma_f32_16x16x32_bf16 v[132:135], a[140:143], v[88:91], v[132:135]
  ds_read_b128 v[80:83], v23 offset:50176
  buffer_load_dwordx4 v9, s[8:11], s69 offen offset:1024 sc1 lds
  v_mfma_f32_16x16x32_bf16 v[132:135], a[132:135], v[84:87], v[132:135]
  buffer_load_dwordx4 v9, s[8:11], s69 offen offset:2048 sc1 lds
  v_mfma_f32_16x16x32_bf16 v[128:131], a[144:147], v[96:99], v[128:131]
  ds_read_b128 v[88:91], v23 offset:51200
  v_mfma_f32_16x16x32_bf16 v[128:131], a[152:155], v[92:95], v[128:131]
  buffer_load_dwordx4 v9, s[8:11], s69 offen offset:3072 sc1 lds
  v_mfma_f32_16x16x32_bf16 v[132:135], a[156:159], v[92:95], v[132:135]
  ds_read_b128 v[84:87], v23 offset:52224
  v_mfma_f32_16x16x32_bf16 v[132:135], a[148:151], v[96:99], v[132:135]
  s_waitcnt lgkmcnt(4)
  v_mfma_f32_16x16x32_bf16 v[128:131], a[160:163], v[100:103], v[128:131]
  ds_read_b128 v[92:95], v23 offset:53248
  v_mfma_f32_16x16x32_bf16 v[128:131], a[168:171], v[104:107], v[128:131]
  s_mov_b32 s55, 0
  s_add_u32 m0, s45, 32768
  v_mfma_f32_16x16x32_bf16 v[132:135], a[172:175], v[104:107], v[132:135]
  ds_read_b128 v[96:99], v23 offset:54272
  v_mfma_f32_16x16x32_bf16 v[132:135], a[164:167], v[100:103], v[132:135]
  buffer_load_dwordx4 v16, s[28:31], s55 offen lds
  v_mfma_f32_16x16x32_bf16 v[128:131], a[176:179], v[112:115], v[128:131]
  ds_read_b128 v[104:107], v23 offset:55296
  v_mfma_f32_16x16x32_bf16 v[128:131], a[184:187], v[108:111], v[128:131]
  v_mfma_f32_16x16x32_bf16 v[132:135], a[188:191], v[108:111], v[132:135]
  ds_read_b128 v[100:103], v23 offset:56320
  v_mfma_f32_16x16x32_bf16 v[132:135], a[180:183], v[112:115], v[132:135]
  s_waitcnt lgkmcnt(4)
  s_waitcnt vmcnt(9)
  s_barrier
  v_mfma_f32_16x16x32_bf16 v[128:131], a[192:195], v[76:79], v[128:131]
  ds_read_b128 v[108:111], v22 offset:16384
  s_mov_b32 s55, 0
  s_add_u32 m0, s45, 40960
  v_mfma_f32_16x16x32_bf16 v[128:131], a[200:203], v[80:83], v[128:131]
  buffer_load_dwordx4 v16, s[32:35], s55 offen lds
  v_mfma_f32_16x16x32_bf16 v[132:135], a[204:207], v[80:83], v[132:135]
  ds_read_b128 v[112:115], v22 offset:17408
  v_mfma_f32_16x16x32_bf16 v[132:135], a[196:199], v[76:79], v[132:135]
  v_mfma_f32_16x16x32_bf16 v[128:131], a[208:211], v[88:91], v[128:131]
  ds_read_b128 v[80:83], v22 offset:18432
  s_waitcnt vmcnt(56) lgkmcnt(15)
  v_lshlrev_b32 v184, 16, v152
  v_mfma_f32_16x16x32_bf16 v[128:131], a[216:219], v[84:87], v[128:131]
  s_mov_b32 s55, 229376
  s_add_u32 m0, s45, 36864
  v_and_b32 v185, 0xffff0000, v152
  v_lshlrev_b32 v186, 16, v153
  v_mfma_f32_16x16x32_bf16 v[132:135], a[220:223], v[84:87], v[132:135]
  ds_read_b128 v[76:79], v22 offset:19456
  v_and_b32 v187, 0xffff0000, v153
  v_lshlrev_b32 v188, 16, v154
  v_mfma_f32_16x16x32_bf16 v[132:135], a[212:215], v[88:91], v[132:135]
  s_waitcnt lgkmcnt(4)
  buffer_load_dwordx4 v16, s[28:31], s55 offen lds
  v_and_b32 v189, 0xffff0000, v154
  v_lshlrev_b32 v190, 16, v155
  v_mfma_f32_16x16x32_bf16 v[128:131], a[224:227], v[92:95], v[128:131]
  ds_read_b128 v[84:87], v22 offset:20480
  v_and_b32 v191, 0xffff0000, v155
  v_mfma_f32_16x16x32_bf16 v[128:131], a[232:235], v[96:99], v[128:131]
  v_mfma_f32_16x16x32_bf16 v[132:135], a[236:239], v[96:99], v[132:135]
  ds_read_b128 v[88:91], v22 offset:21504
  v_mfma_f32_16x16x32_bf16 v[132:135], a[228:231], v[92:95], v[132:135]
  s_mov_b32 s55, 229376
  s_add_u32 m0, s45, 45056
  v_mfma_f32_16x16x32_bf16 v[128:131], a[240:243], v[104:107], v[128:131]
  ds_read_b128 v[96:99], v22 offset:22528
  v_mfma_f32_16x16x32_bf16 v[128:131], a[248:251], v[100:103], v[128:131]
  buffer_load_dwordx4 v16, s[32:35], s55 offen lds
  v_mfma_f32_16x16x32_bf16 v[132:135], v[124:127], v[100:103], v[132:135]
  ds_read_b128 v[92:95], v22 offset:23552
  v_mfma_f32_16x16x32_bf16 v[132:135], a[244:247], v[104:107], v[132:135]
  s_waitcnt lgkmcnt(4)
  v_mfma_f32_16x16x32_bf16 v[136:139], a[0:3], v[108:111], 0
  ds_read_b128 v[100:103], v23 offset:16384
  v_mfma_f32_16x16x32_bf16 v[136:139], a[8:11], v[112:115], v[136:139]
  s_add_u32 s56, s79, 12288
  v_mfma_f32_16x16x32_bf16 v[140:143], a[12:15], v[112:115], 0
  ds_read_b128 v[104:107], v23 offset:17408
  v_fmac_f32 v184, v160, v128
  v_fmac_f32 v185, v161, v129
  v_mfma_f32_16x16x32_bf16 v[140:143], a[4:7], v[108:111], v[140:143]
  buffer_load_dwordx2 v[212:213], v220, s[8:11], s56 offen sc1
  v_fmac_f32 v186, v162, v130
  v_fmac_f32 v187, v163, v131
  v_fmac_f32 v188, v164, v132
  v_mfma_f32_16x16x32_bf16 v[136:139], a[16:19], v[80:83], v[136:139]
  ds_read_b128 v[112:115], v23 offset:18432
  v_fmac_f32 v189, v165, v133
  v_fmac_f32 v190, v166, v134
  v_mfma_f32_16x16x32_bf16 v[136:139], a[24:27], v[76:79], v[136:139]
  s_add_u32 s56, s79, 36864
  v_fmac_f32 v191, v167, v135
  v_mul_f32 v128, v184, v168
  v_mul_f32 v129, v185, v169
  v_mfma_f32_16x16x32_bf16 v[140:143], a[28:31], v[76:79], v[140:143]
  ds_read_b128 v[108:111], v23 offset:19456
  v_mul_f32 v130, v186, v170
  v_mul_f32 v131, v187, v171
  v_mfma_f32_16x16x32_bf16 v[140:143], a[20:23], v[80:83], v[140:143]
  s_waitcnt lgkmcnt(4)
  buffer_load_dwordx2 v[214:215], v220, s[8:11], s56 offen sc1
  v_mul_f32 v132, v188, v172
  v_mul_f32 v133, v189, v173
  v_mfma_f32_16x16x32_bf16 v[136:139], a[32:35], v[84:87], v[136:139]
  ds_read_b128 v[76:79], v23 offset:20480
  s_add_u32 s56, s79, 61440
  v_mul_f32 v134, v190, v174
  v_mfma_f32_16x16x32_bf16 v[136:139], a[40:43], v[88:91], v[136:139]
  buffer_load_dwordx2 v[216:217], v220, s[8:11], s56 offen sc1
  v_mul_f32 v135, v191, v175
  v_cvt_pk_bf16_f32 v204, v128, v129
  v_cvt_pk_bf16_f32 v205, v130, v131
  v_mfma_f32_16x16x32_bf16 v[140:143], a[44:47], v[88:91], v[140:143]
  ds_read_b128 v[80:83], v23 offset:21504
  v_cvt_pk_bf16_f32 v206, v132, v133
  v_cvt_pk_bf16_f32 v207, v134, v135
  v_mfma_f32_16x16x32_bf16 v[140:143], a[36:39], v[84:87], v[140:143]
  s_add_u32 s56, s79, 86016
  s_add_u32 s54, s47, 36831232
  buffer_store_dwordx4 v[204:207], v1, s[8:11], s54 offen sc1
  v_mfma_f32_16x16x32_bf16 v[136:139], a[48:51], v[96:99], v[136:139]
  ds_read_b128 v[88:91], v23 offset:22528
HOP6:
  s_cbranch_execz WRET0
  v_cvt_pk_bf16_f32 v152, v184, v185
  v_cvt_pk_bf16_f32 v153, v186, v187
  v_mfma_f32_16x16x32_bf16 v[136:139], a[56:59], v[92:95], v[136:139]
  buffer_load_dwordx2 v[218:219], v220, s[8:11], s56 offen sc1
  v_cvt_pk_bf16_f32 v154, v188, v189
  v_cvt_pk_bf16_f32 v155, v190, v191
  v_mfma_f32_16x16x32_bf16 v[140:143], a[60:63], v[92:95], v[140:143]
  ds_read_b128 v[84:87], v23 offset:23552
  s_mov_b32 s55, 0
  s_add_u32 m0, s45, 98304
  v_mfma_f32_16x16x32_bf16 v[228:231], v[176:179], v[152:155], 0
  v_mfma_f32_16x16x32_bf16 v[192:195], v[152:155], v[152:155], 0
  v_mfma_f32_16x16x32_bf16 v[140:143], a[52:55], v[96:99], v[140:143]
  s_waitcnt lgkmcnt(4)
  s_waitcnt vmcnt(9)
  s_barrier
  v_mfma_f32_16x16x32_bf16 v[136:139], a[64:67], v[100:103], v[136:139]
  ds_read_b128 v[92:95], v23 offset:0
  buffer_load_dwordx4 v11, s[28:31], s55 offen lds
  v_mfma_f32_16x16x32_bf16 v[136:139], a[72:75], v[104:107], v[136:139]
  v_cndmask_b32 v192, v192, v193, s[88:89]
  v_cndmask_b32 v194, v194, v195, s[88:89]
  v_cndmask_b32 v229, v192, v194, s[90:91]
  v_mfma_f32_16x16x32_bf16 v[140:143], a[76:79], v[104:107], v[140:143]
  ds_read_b128 v[96:99], v23 offset:1024
  v_mfma_f32_16x16x32_bf16 v[140:143], a[68:71], v[100:103], v[140:143]
  s_mov_b32 s55, 0
  s_add_u32 m0, s45, 106496
  v_mfma_f32_16x16x32_bf16 v[136:139], a[80:83], v[112:115], v[136:139]
  ds_read_b128 v[104:107], v23 offset:2048
  v_mfma_f32_16x16x32_bf16 v[136:139], a[88:91], v[108:111], v[136:139]
  buffer_load_dwordx4 v11, s[32:35], s55 offen lds
  v_mfma_f32_16x16x32_bf16 v[140:143], a[92:95], v[108:111], v[140:143]
  ds_read_b128 v[100:103], v23 offset:3072
  v_mfma_f32_16x16x32_bf16 v[140:143], a[84:87], v[112:115], v[140:143]
  s_waitcnt lgkmcnt(4)
  v_mfma_f32_16x16x32_bf16 v[136:139], a[96:99], v[76:79], v[136:139]
  ds_read_b128 v[108:111], v23 offset:4096
  v_mfma_f32_16x16x32_bf16 v[136:139], a[104:107], v[80:83], v[136:139]
  s_mov_b32 s55, 229376
  s_add_u32 m0, s45, 102400
  v_mfma_f32_16x16x32_bf16 v[140:143], a[108:111], v[80:83], v[140:143]
  ds_read_b128 v[112:115], v23 offset:5120
  v_mfma_f32_16x16x32_bf16 v[140:143], a[100:103], v[76:79], v[140:143]
  buffer_load_dwordx4 v11, s[28:31], s55 offen lds
  v_mfma_f32_16x16x32_bf16 v[136:139], a[112:115], v[88:91], v[136:139]
  ds_read_b128 v[80:83], v23 offset:6144
  v_mfma_f32_16x16x32_bf16 v[136:139], a[120:123], v[84:87], v[136:139]
  v_mfma_f32_16x16x32_bf16 v[140:143], a[124:127], v[84:87], v[140:143]
  ds_read_b128 v[76:79], v23 offset:7168
  v_mfma_f32_16x16x32_bf16 v[140:143], a[116:119], v[88:91], v[140:143]
  s_waitcnt lgkmcnt(4)
  s_mov_b32 s55, 229376
  s_add_u32 m0, s45, 110592
  v_mfma_f32_16x16x32_bf16 v[136:139], a[128:131], v[92:95], v[136:139]
  ds_read_b128 v[84:87], v22 offset:0
  v_mfma_f32_16x16x32_bf16 v[136:139], a[136:139], v[96:99], v[136:139]
  buffer_load_dwordx4 v11, s[32:35], s55 offen lds
  v_mfma_f32_16x16x32_bf16 v[140:143], a[140:143], v[96:99], v[140:143]
  ds_read_b128 v[88:91], v22 offset:1024
  v_mfma_f32_16x16x32_bf16 v[140:143], a[132:135], v[92:95], v[140:143]
  v_mfma_f32_16x16x32_bf16 v[136:139], a[144:147], v[104:107], v[136:139]
  ds_read_b128 v[96:99], v22 offset:2048
  v_mfma_f32_16x16x32_bf16 v[136:139], a[152:155], v[100:103], v[136:139]
  s_mov_b32 s55, 458752
  s_add_u32 m0, s45, 114688
  v_mfma_f32_16x16x32_bf16 v[140:143], a[156:159], v[100:103], v[140:143]
  ds_read_b128 v[92:95], v22 offset:3072
  v_mfma_f32_16x16x32_bf16 v[140:143], a[148:151], v[104:107], v[140:143]
  s_waitcnt lgkmcnt(4)
  buffer_load_dwordx4 v11, s[28:31], s55 offen lds
  v_mfma_f32_16x16x32_bf16 v[136:139], a[160:163], v[108:111], v[136:139]
  ds_read_b128 v[100:103], v22 offset:4096
  v_mfma_f32_16x16x32_bf16 v[136:139], a[168:171], v[112:115], v[136:139]
  v_mfma_f32_16x16x32_bf16 v[140:143], a[172:175], v[112:115], v[140:143]
  ds_read_b128 v[104:107], v22 offset:5120
  v_mfma_f32_16x16x32_bf16 v[140:143], a[164:167], v[108:111], v[140:143]
  s_mov_b32 s55, 458752
  s_add_u32 m0, s45, 122880
  v_mfma_f32_16x16x32_bf16 v[136:139], a[176:179], v[80:83], v[136:139]
  ds_read_b128 v[112:115], v22 offset:6144
  s_waitcnt vmcnt(63) lgkmcnt(15)
  v_mfma_f32_16x16x32_bf16 v[136:139], a[184:187], v[76:79], v[136:139]
  buffer_load_dwordx4 v11, s[32:35], s55 offen lds
  v_lshlrev_b32 v184, 16, v156
  v_and_b32 v185, 0xffff0000, v156
  v_mfma_f32_16x16x32_bf16 v[140:143], a[188:191], v[76:79], v[140:143]
  ds_read_b128 v[108:111], v22 offset:7168
  v_lshlrev_b32 v186, 16, v157
  v_mfma_f32_16x16x32_bf16 v[140:143], a[180:183], v[80:83], v[140:143]
  s_waitcnt lgkmcnt(4)
  v_and_b32 v187, 0xffff0000, v157
  v_lshlrev_b32 v188, 16, v158
  v_mfma_f32_16x16x32_bf16 v[136:139], a[192:195], v[84:87], v[136:139]
  v_and_b32 v189, 0xffff0000, v158
  v_lshlrev_b32 v190, 16, v159
  v_mfma_f32_16x16x32_bf16 v[136:139], a[200:203], v[88:91], v[136:139]
  v_and_b32 v191, 0xffff0000, v159
  v_mfma_f32_16x16x32_bf16 v[140:143], a[204:207], v[88:91], v[140:143]
  s_mov_b32 s55, 688128
  s_add_u32 m0, s45, 118784
  v_mfma_f32_16x16x32_bf16 v[140:143], a[196:199], v[84:87], v[140:143]
  buffer_load_dwordx4 v11, s[28:31], s55 offen lds
  v_mfma_f32_16x16x32_bf16 v[136:139], a[208:211], v[96:99], v[136:139]
  v_mfma_f32_16x16x32_bf16 v[136:139], a[216:219], v[92:95], v[136:139]
  v_mfma_f32_16x16x32_bf16 v[140:143], a[220:223], v[92:95], v[140:143]
  v_mfma_f32_16x16x32_bf16 v[140:143], a[212:215], v[96:99], v[140:143]
  s_waitcnt lgkmcnt(0)
  v_mfma_f32_16x16x32_bf16 v[136:139], a[224:227], v[100:103], v[136:139]
  s_mov_b32 s55, 688128
  s_add_u32 m0, s45, 126976
  v_mfma_f32_16x16x32_bf16 v[136:139], a[232:235], v[104:107], v[136:139]
  buffer_load_dwordx4 v11, s[32:35], s55 offen lds
  v_mfma_f32_16x16x32_bf16 v[140:143], a[236:239], v[104:107], v[140:143]
  v_mfma_f32_16x16x32_bf16 v[140:143], a[228:231], v[100:103], v[140:143]
  v_mfma_f32_16x16x32_bf16 v[136:139], a[240:243], v[112:115], v[136:139]
  v_mfma_f32_16x16x32_bf16 v[136:139], a[248:251], v[108:111], v[136:139]
  v_mfma_f32_16x16x32_bf16 v[140:143], v[124:127], v[108:111], v[140:143]
  v_mfma_f32_16x16x32_bf16 v[140:143], a[244:247], v[112:115], v[140:143]
  s_nop 5
  v_fmac_f32 v184, v160, v136
  v_fmac_f32 v185, v161, v137
  v_fmac_f32 v186, v162, v138
  v_fmac_f32 v187, v163, v139
  v_fmac_f32 v188, v164, v140
  v_fmac_f32 v189, v165, v141
  v_fmac_f32 v190, v166, v142
  v_fmac_f32 v191, v167, v143
  v_mul_f32 v136, v184, v168
  v_mul_f32 v137, v185, v169
  v_mul_f32 v138, v186, v170
  v_mul_f32 v139, v187, v171
  v_mul_f32 v140, v188, v172
  v_mul_f32 v141, v189, v173
  v_mul_f32 v142, v190, v174
  v_mul_f32 v143, v191, v175
  v_cvt_pk_bf16_f32 v208, v136, v137
  v_cvt_pk_bf16_f32 v209, v138, v139
  v_cvt_pk_bf16_f32 v210, v140, v141
  v_cvt_pk_bf16_f32 v211, v142, v143
  s_add_u32 s54, s47, 36896768
  buffer_store_dwordx4 v[208:211], v1, s[8:11], s54 offen sc1
  v_cvt_pk_bf16_f32 v156, v184, v185
  v_cvt_pk_bf16_f32 v157, v186, v187
  v_cvt_pk_bf16_f32 v158, v188, v189
  v_cvt_pk_bf16_f32 v159, v190, v191
  s_nop 1
  v_mfma_f32_16x16x32_bf16 v[230:233], v[176:179], v[156:159], 0
  v_mfma_f32_16x16x32_bf16 v[192:195], v[156:159], v[156:159], 0
  s_nop 7
  v_cndmask_b32 v192, v192, v193, s[88:89]
  v_cndmask_b32 v194, v194, v195, s[88:89]
  v_cndmask_b32 v231, v192, v194, s[90:91]
  buffer_store_dwordx4 v[228:231], v180, s[8:11], s48 offen offset:256 sc1
  s_waitcnt lgkmcnt(0)
  s_barrier
  s_mov_b32 s55, 458752
  s_add_u32 m0, s45, 49152
  s_nop 0
  buffer_load_dwordx4 v16, s[28:31], s55 offen lds
  s_mov_b32 s55, 458752
  s_add_u32 m0, s45, 57344
  s_nop 0
  buffer_load_dwordx4 v16, s[32:35], s55 offen lds
  s_mov_b32 s55, 688128
  s_add_u32 m0, s45, 53248
  s_nop 0
  buffer_load_dwordx4 v16, s[28:31], s55 offen lds
  s_mov_b32 s55, 688128
  s_add_u32 m0, s45, 61440
  s_nop 0
  buffer_load_dwordx4 v16, s[32:35], s55 offen lds
  ds_write_b128 v182, v[144:147] offset:0
  ds_write_b128 v182, v[148:151] offset:4096
  ds_write_b128 v182, v[152:155] offset:8192
  ds_write_b128 v182, v[156:159] offset:12288
  v_mov_b32 v10, v16
  v_add_u32 v15, s46, v0
  s_waitcnt vmcnt(4)
  s_barrier
  s_mov_b64 exec, 1
  buffer_store_dword v15, v0, s[8:11], s49 offen offset:0 sc1
  s_mov_b64 exec, -1
  s_mov_b64 exec, 0
  s_cmp_eq_u32 s44, 1
  s_cbranch_scc1 HOP7
  s_cmp_eq_u32 s44, 2
  s_cbranch_scc1 HOP8
  s_cmp_eq_u32 s44, 3
  s_cbranch_scc1 HOP9
WRET1:
  s_mov_b64 exec, -1
  s_and_b32 s52, s2, 7
  s_bfe_u32 s51, s2, 0x20003
  s_lshr_b32 s50, s2, 5
  s_add_u32 s56, s51, s50
  s_and_b32 s56, s56, 3
  s_lshl_b32 s53, s50, 1
  s_lshr_b32 s54, s44, 1
  s_add_u32 s53, s53, s54
  s_lshl_b32 s63, s53, 3
  s_and_b32 s55, s44, 1
  s_add_u32 s63, s63, s55
  s_lshl_b32 s57, s63, 15
  s_add_u32 s57, s57, 36700160
  s_lshl_b32 s53, s50, 12
  s_add_u32 s82, s53, 753664
  v_and_b32 v15, 31, v0
  v_lshlrev_b32 v15, 7, v15
  v_lshrrev_b32 v33, 2, v0
  v_bfe_u32 v32, v33, 1, 2
  v_lshlrev_b32 v32, 5, v32
  v_lshl_add_u32 v32, v33, 7, v32
  v_and_b32 v33, 3, v0
  v_lshl_add_u32 v2, v33, 3, v32
  v_xor_b32 v3, 32, v2
  v_xor_b32 v4, 64, v2
  v_xor_b32 v5, 96, v2
  v_add_u32 v6, 65536, v2
  v_add_u32 v7, 65536, v3
  v_add_u32 v8, 65536, v4
  s_lshl_b32 s80, s2, 7
  s_lshl_b32 s53, s44, 28
  s_add_u32 s80, s80, s53
  s_add_u32 s80, s80, 884736
  s_lshl_b32 s53, s2, 2
  s_add_u32 s53, s53, s44
  s_lshl_b32 s53, s53, 7
  s_add_u32 s81, s53, 917504
  s_waitcnt vmcnt(15)
  v_add_f32 v212, v212, v214
  v_add_f32 v216, v216, v218
  v_add_f32 v212, v212, v216
  v_add_f32 v213, v213, v215
  v_add_f32 v217, v217, v219
  v_add_f32 v213, v213, v217
  v_lshrrev_b32 v32, 5, v0
  v_xor_b32 v33, 1, v32
  v_cvt_f32_u32 v33, v33
  v_cvt_pk_bf16_f32 v214, v212, v213
  v_lshlrev_b32 v212, 16, v214
  v_and_b32 v213, 0xffff0000, v214
  v_add_f32 v212, v212, v33
  v_add_f32 v213, v213, v33
  v_cvt_pk_bf16_f32 v214, v212, v213
  v_lshlrev_b32 v212, 16, v214
  v_and_b32 v213, 0xffff0000, v214
  v_lshrrev_b32 v215, 16, v214
  v_and_b32 v214, 0xffff, v214
  s_add_u32 s53, s45, 151552
  v_lshlrev_b32 v32, 8, v32
  v_lshl_add_u32 v32, v0, 3, v32
  v_add_u32 v32, s53, v32
  ds_write_b64 v32, v[214:215]
  ds_write_b64 v32, v[212:213] offset:256
  s_bitcmp1_b32 s2, 3
  s_cselect_b64 s[12:13], s[32:33], s[28:29]
  s_mov_b32 s14, 7340032
  s_mov_b32 s16, 0x03030303
  s_mov_b32 s17, 0x03030303
  s_mov_b32 s18, 0x0c0c0c0c
  s_mov_b32 s19, 0x0c0c0c0c
  s_mov_b32 s20, 0x30303030
  s_mov_b32 s21, 0x30303030
  s_mov_b32 s22, 0xc0c0c0c0
  s_mov_b32 s23, 0xc0c0c0c0
  s_cmp_lg_u32 s44, 0
  s_cbranch_scc1 PI14_adaLN_cond__sliding_local_dilated__swiglu_ffn__prompt_kernel
  buffer_load_dword v13, v15, s[8:11], s82 offen sc1
PI14_adaLN_cond__sliding_local_dilated__swiglu_ffn__prompt_kernel:
  s_waitcnt vmcnt(11)
  s_cmp_lg_u32 s44, 0
  s_cbranch_scc1 PL15_adaLN_cond__sliding_local_dilated__swiglu_ffn__prompt_kernelx
  s_waitcnt vmcnt(0)
  v_cmp_ne_u32 vcc, s46, v13
  s_nop 4
  s_cbranch_vccz PL15_adaLN_cond__sliding_local_dilated__swiglu_ffn__prompt_kernelx
  s_mov_b32 s83, 60000
PL15_adaLN_cond__sliding_local_dilated__swiglu_ffn__prompt_kernel:
  buffer_load_dword v13, v15, s[8:11], s82 offen sc1
  s_sub_u32 s83, s83, 1
  s_cmp_eq_u32 s83, 0
  s_waitcnt vmcnt(0)
  s_cbranch_scc1 PL15_adaLN_cond__sliding_local_dilated__swiglu_ffn__prompt_kernelx
  v_cmp_ne_u32 vcc, s46, v13
  s_nop 4
  s_cbranch_vccnz PL15_adaLN_cond__sliding_local_dilated__swiglu_ffn__prompt_kernel
PL15_adaLN_cond__sliding_local_dilated__swiglu_ffn__prompt_kernelx:
  s_barrier
  s_mov_b32 s64, 0
  s_add_u32 s72, s57, 0
  buffer_load_dwordx4 a[0:3], v1, s[8:11], s72 offen offset:0 sc1
  buffer_load_dwordx4 a[16:19], v1, s[8:11], s72 offen offset:1024 sc1
  s_add_u32 s72, s72, 65536
  buffer_load_dwordx4 a[4:7], v1, s[8:11], s72 offen offset:0 sc1
  buffer_load_dwordx4 a[20:23], v1, s[8:11], s72 offen offset:1024 sc1
  s_add_u32 s72, s72, 65536
  buffer_load_dwordx4 a[8:11], v1, s[8:11], s72 offen offset:0 sc1
  buffer_load_dwordx4 a[24:27], v1, s[8:11], s72 offen offset:1024 sc1
  s_add_u32 s72, s72, 65536
  buffer_load_dwordx4 a[12:15], v1, s[8:11], s72 offen offset:0 sc1
  buffer_load_dwordx4 a[28:31], v1, s[8:11], s72 offen offset:1024 sc1
  s_mov_b32 s65, 458752
  s_add_u32 s73, s57, 2048
  buffer_load_dwordx4 a[32:35], v1, s[8:11], s73 offen offset:0 sc1
  buffer_load_dwordx4 a[48:51], v1, s[8:11], s73 offen offset:1024 sc1
  s_add_u32 s73, s73, 65536
  buffer_load_dwordx4 a[36:39], v1, s[8:11], s73 offen offset:0 sc1
  buffer_load_dwordx4 a[52:55], v1, s[8:11], s73 offen offset:1024 sc1
  s_add_u32 s73, s73, 65536
  buffer_load_dwordx4 a[40:43], v1, s[8:11], s73 offen offset:0 sc1
  buffer_load_dwordx4 a[56:59], v1, s[8:11], s73 offen offset:1024 sc1
  s_add_u32 s73, s73, 65536
  buffer_load_dwordx4 a[44:47], v1, s[8:11], s73 offen offset:0 sc1
  buffer_load_dwordx4 a[60:63], v1, s[8:11], s73 offen offset:1024 sc1
  v_bfe_u32 v32, v0, 3, 1
  v_lshlrev_b32 v32, 9, v32
  v_and_b32 v33, 1, v0
  v_lshl_add_u32 v32, v33, 8, v32
  v_lshrrev_b32 v33, 4, v0
  v_lshl_add_u32 v32, v33, 6, v32
  v_add_u32 v14, s53, v32
  s_bfe_u32 s53, s2, 0x20004
  s_lshl_b32 s53, s53, 8
  v_and_b32 v32, 15, v0
  v_lshl_add_u32 v32, v32, 4, s53
  v_cmp_gt_u32 vcc, 896, v32
  v_mov_b32 v34, 1073741824
  v_mul_u32_u24 v33, 114688, v33
  v_cndmask_b32 v32, v34, v32, vcc
  s_lshr_b32 s53, s2, 6
  s_lshl_b32 s53, s53, 2
  s_add_u32 s53, s53, s44
  s_mul_i32 s53, s53, 458752
  s_mul_i32 s54, s52, 896
  s_add_u32 s53, s53, s54
  v_add3_u32 v13, v32, v33, s53
  ds_read_b64_tr_b16 a[160:161], v6 offset:32768
  ds_read_b64_tr_b16 a[162:163], v6 offset:34816
  ds_read_b64_tr_b16 a[164:165], v6 offset:36864
  ds_read_b64_tr_b16 a[166:167], v6 offset:38912
  ds_read_b64_tr_b16 a[168:169], v6 offset:40960
  ds_read_b64_tr_b16 a[170:171], v6 offset:43008
  ds_read_b64_tr_b16 a[172:173], v6 offset:45056
  ds_read_b64_tr_b16 a[174:175], v6 offset:47104
  ds_read_b64_tr_b16 a[176:177], v7 offset:32768
  s_waitcnt vmcnt(8) lgkmcnt(5)
  v_mfma_f32_16x16x32_bf16 v[64:67], a[160:163], a[0:3], 0
  ds_read_b64_tr_b16 a[178:179], v7 offset:34816
  s_mov_b32 s66, 917504
  s_add_u32 s74, s57, 4096
  s_add_u32 m0, s45, 81920
  v_mfma_f32_16x16x32_bf16 v[64:67], a[164:167], a[16:19], v[64:67]
  buffer_load_dwordx4 v11, s[28:31], s66 offen lds
  v_mfma_f32_16x16x32_bf16 v[68:71], a[164:167], a[20:23], 0
  ds_read_b64_tr_b16 a[180:181], v7 offset:36864
  v_mfma_f32_16x16x32_bf16 v[68:71], a[160:163], a[4:7], v[68:71]
  s_add_u32 m0, s45, 90112
  v_mfma_f32_16x16x32_bf16 v[72:75], a[160:163], a[8:11], 0
  ds_read_b64_tr_b16 a[182:183], v7 offset:38912
  v_mfma_f32_16x16x32_bf16 v[72:75], a[164:167], a[24:27], v[72:75]
  buffer_load_dwordx4 v11, s[32:35], s66 offen lds
  v_mfma_f32_16x16x32_bf16 v[76:79], a[164:167], a[28:31], 0
  ds_read_b64_tr_b16 a[164:165], v7 offset:40960
  v_mfma_f32_16x16x32_bf16 v[76:79], a[160:163], a[12:15], v[76:79]
  s_waitcnt lgkmcnt(5)
  s_add_u32 m0, s45, 86016
  s_add_u32 s61, s66, 229376
  v_mfma_f32_16x16x32_bf16 v[92:95], a[168:171], a[12:15], 0
  ds_read_b64_tr_b16 a[166:167], v7 offset:43008
  v_mfma_f32_16x16x32_bf16 v[92:95], a[172:175], a[28:31], v[92:95]
  buffer_load_dwordx4 v11, s[28:31], s61 offen lds
  v_mfma_f32_16x16x32_bf16 v[88:91], a[172:175], a[24:27], 0
  ds_read_b64_tr_b16 a[160:161], v7 offset:45056
  v_mfma_f32_16x16x32_bf16 v[88:91], a[168:171], a[8:11], v[88:91]
  s_add_u32 m0, s45, 94208
  s_add_u32 s61, s66, 229376
  v_mfma_f32_16x16x32_bf16 v[84:87], a[168:171], a[4:7], 0
  ds_read_b64_tr_b16 a[162:163], v7 offset:47104
  v_mfma_f32_16x16x32_bf16 v[84:87], a[172:175], a[20:23], v[84:87]
  buffer_load_dwordx4 v11, s[32:35], s61 offen lds
  v_mfma_f32_16x16x32_bf16 v[80:83], a[172:175], a[16:19], 0
  ds_read_b64_tr_b16 a[172:173], v8 offset:32768
  v_mfma_f32_16x16x32_bf16 v[80:83], a[168:171], a[0:3], v[80:83]
  s_waitcnt lgkmcnt(5)
  s_add_u32 m0, s45, 16384
  v_mfma_f32_16x16x32_bf16 v[96:99], a[176:179], a[0:3], 0
  ds_read_b64_tr_b16 a[174:175], v8 offset:34816
  v_mfma_f32_16x16x32_bf16 v[96:99], a[180:183], a[16:19], v[96:99]
  buffer_load_dwordx4 v10, s[28:31], s66 offen lds
  v_mfma_f32_16x16x32_bf16 v[100:103], a[180:183], a[20:23], 0
  ds_read_b64_tr_b16 a[168:169], v8 offset:36864
  v_mfma_f32_16x16x32_bf16 v[100:103], a[176:179], a[4:7], v[100:103]
  s_add_u32 m0, s45, 24576
  v_mfma_f32_16x16x32_bf16 v[104:107], a[176:179], a[8:11], 0
  ds_read_b64_tr_b16 a[170:171], v8 offset:38912
  s_lshl_b32 s58, s51, 12
  v_mfma_f32_16x16x32_bf16 v[104:107], a[180:183], a[24:27], v[104:107]
  buffer_load_dwordx4 v10, s[32:35], s66 offen lds
  s_lshl_b32 s54, s51, 3
  s_lshr_b32 s53, 0x0b070602, s54
  v_mfma_f32_16x16x32_bf16 v[108:111], a[180:183], a[28:31], 0
  ds_read_b64_tr_b16 a[180:181], v8 offset:40960
  s_and_b32 s53, s53, 15
  v_mfma_f32_16x16x32_bf16 v[108:111], a[176:179], a[12:15], v[108:111]
  s_waitcnt lgkmcnt(5)
  s_add_u32 m0, s45, 20480
  s_add_u32 s61, s66, 229376
  v_mfma_f32_16x16x32_bf16 v[124:127], a[164:167], a[12:15], 0
  ds_read_b64_tr_b16 a[182:183], v8 offset:43008
  s_lshl_b32 s59, s53, 10
  v_mfma_f32_16x16x32_bf16 v[124:127], a[160:163], a[28:31], v[124:127]
  buffer_load_dwordx4 v10, s[28:31], s61 offen lds
  s_lshr_b32 s53, s51, 1
  s_mul_i32 s53, s53, 7168
  v_mfma_f32_16x16x32_bf16 v[120:123], a[160:163], a[24:27], 0
  ds_read_b64_tr_b16 a[176:177], v8 offset:45056
  s_and_b32 s54, s54, 8
  v_mfma_f32_16x16x32_bf16 v[120:123], a[164:167], a[8:11], v[120:123]
  s_add_u32 m0, s45, 28672
  s_add_u32 s61, s66, 229376
  s_add_u32 s53, s53, s54
  v_mfma_f32_16x16x32_bf16 v[116:119], a[164:167], a[4:7], 0
  ds_read_b64_tr_b16 a[178:179], v8 offset:47104
  s_add_u32 s60, s53, 3072
  v_mfma_f32_16x16x32_bf16 v[116:119], a[160:163], a[20:23], v[116:119]
  buffer_load_dwordx4 v10, s[32:35], s61 offen lds
  s_mul_i32 s53, s52, 14336
  s_mul_i32 s54, s63, 131072
  v_mfma_f32_16x16x32_bf16 v[112:115], a[160:163], a[16:19], 0
  ds_read_b64_tr_b16 a[160:161], v2 offset:32768
  s_add_u32 s53, s53, s54
  v_mfma_f32_16x16x32_bf16 v[112:115], a[164:167], a[0:3], v[112:115]
  s_waitcnt lgkmcnt(5)
  s_add_u32 s53, s53, 19922944
  v_mfma_f32_16x16x32_bf16 v[32:35], a[172:175], a[0:3], 0
  ds_read_b64_tr_b16 a[162:163], v2 offset:34816
  s_add_u32 s58, s58, s53
  v_mfma_f32_16x16x32_bf16 v[32:35], a[168:171], a[16:19], v[32:35]
  buffer_load_dwordx4 a[64:67], v1, s[8:11], s74 offen offset:0 sc1
  s_add_u32 s59, s59, s53
  s_add_u32 s60, s60, s53
  v_mfma_f32_16x16x32_bf16 v[36:39], a[168:171], a[20:23], 0
  ds_read_b64_tr_b16 a[164:165], v2 offset:36864
  s_lshl_b32 s63, s50, 2
  v_mfma_f32_16x16x32_bf16 v[36:39], a[172:175], a[4:7], v[36:39]
  s_add_u32 s63, s63, s44
  s_lshl_b32 s63, s63, 14
  s_add_u32 s63, s63, 6291456
  v_mfma_f32_16x16x32_bf16 v[40:43], a[172:175], a[8:11], 0
  ds_read_b64_tr_b16 a[166:167], v2 offset:38912
  v_and_b32 v12, 0x300, v1
  v_mfma_f32_16x16x32_bf16 v[40:43], a[168:171], a[24:27], v[40:43]
  buffer_load_dwordx4 a[80:83], v1, s[8:11], s74 offen offset:1024 sc1
  v_add_u32 v12, v12, v1
  v_mfma_f32_16x16x32_bf16 v[44:47], a[168:171], a[28:31], 0
  ds_read_b64_tr_b16 a[168:169], v2 offset:40960
  v_mfma_f32_16x16x32_bf16 v[44:47], a[172:175], a[12:15], v[44:47]
  s_waitcnt lgkmcnt(5)
  s_add_u32 s74, s74, 65536
  v_mfma_f32_16x16x32_bf16 v[60:63], a[180:183], a[12:15], 0
  ds_read_b64_tr_b16 a[170:171], v2 offset:43008
  v_mfma_f32_16x16x32_bf16 v[60:63], a[176:179], a[28:31], v[60:63]
  buffer_load_dwordx4 a[68:71], v1, s[8:11], s74 offen offset:0 sc1
  v_mfma_f32_16x16x32_bf16 v[56:59], a[176:179], a[24:27], 0
  ds_read_b64_tr_b16 a[172:173], v2 offset:45056
  v_mfma_f32_16x16x32_bf16 v[56:59], a[180:183], a[8:11], v[56:59]
  v_mfma_f32_16x16x32_bf16 v[52:55], a[180:183], a[4:7], 0
  ds_read_b64_tr_b16 a[174:175], v2 offset:47104
  v_mfma_f32_16x16x32_bf16 v[52:55], a[176:179], a[20:23], v[52:55]
  buffer_load_dwordx4 a[84:87], v1, s[8:11], s74 offen offset:1024 sc1
  v_mfma_f32_16x16x32_bf16 v[48:51], a[176:179], a[16:19], 0
  ds_read_b64_tr_b16 a[176:177], v3 offset:32768
  v_mfma_f32_16x16x32_bf16 v[48:51], a[180:183], a[0:3], v[48:51]
  s_waitcnt lgkmcnt(5)
  s_add_u32 s74, s74, 65536
  v_mfma_f32_16x16x32_bf16 v[128:131], a[160:163], a[0:3], 0
  ds_read_b64_tr_b16 a[178:179], v3 offset:34816
  v_mfma_f32_16x16x32_bf16 v[128:131], a[164:167], a[16:19], v[128:131]
  buffer_load_dwordx4 a[72:75], v1, s[8:11], s74 offen offset:0 sc1
  v_mfma_f32_16x16x32_bf16 v[132:135], a[164:167], a[20:23], 0
  ds_read_b64_tr_b16 a[180:181], v3 offset:36864
  v_mfma_f32_16x16x32_bf16 v[132:135], a[160:163], a[4:7], v[132:135]
  v_mfma_f32_16x16x32_bf16 v[136:139], a[160:163], a[8:11], 0
  ds_read_b64_tr_b16 a[182:183], v3 offset:38912
  v_mfma_f32_16x16x32_bf16 v[136:139], a[164:167], a[24:27], v[136:139]
  buffer_load_dwordx4 a[88:91], v1, s[8:11], s74 offen offset:1024 sc1
  v_mfma_f32_16x16x32_bf16 v[140:143], a[164:167], a[28:31], 0
  ds_read_b64_tr_b16 a[164:165], v3 offset:40960
  v_mfma_f32_16x16x32_bf16 v[140:143], a[160:163], a[12:15], v[140:143]
  s_waitcnt lgkmcnt(5)
  s_add_u32 s74, s74, 65536
  v_mfma_f32_16x16x32_bf16 v[156:159], a[168:171], a[12:15], 0
  ds_read_b64_tr_b16 a[166:167], v3 offset:43008
  v_mfma_f32_16x16x32_bf16 v[156:159], a[172:175], a[28:31], v[156:159]
  buffer_load_dwordx4 a[76:79], v1, s[8:11], s74 offen offset:0 sc1
  v_mfma_f32_16x16x32_bf16 v[152:155], a[172:175], a[24:27], 0
  ds_read_b64_tr_b16 a[160:161], v3 offset:45056
  v_mfma_f32_16x16x32_bf16 v[152:155], a[168:171], a[8:11], v[152:155]
  v_mfma_f32_16x16x32_bf16 v[148:151], a[168:171], a[4:7], 0
  ds_read_b64_tr_b16 a[162:163], v3 offset:47104
  v_mfma_f32_16x16x32_bf16 v[148:151], a[172:175], a[20:23], v[148:151]
  buffer_load_dwordx4 a[92:95], v1, s[8:11], s74 offen offset:1024 sc1
  v_mfma_f32_16x16x32_bf16 v[144:147], a[172:175], a[16:19], 0
  ds_read_b64_tr_b16 a[172:173], v4 offset:32768
  v_mfma_f32_16x16x32_bf16 v[144:147], a[168:171], a[0:3], v[144:147]
  s_waitcnt lgkmcnt(5)
  s_mov_b32 s67, 1376256
  s_add_u32 s75, s57, 6144
  s_add_u32 m0, s45, 65536
  v_mfma_f32_16x16x32_bf16 v[160:163], a[176:179], a[0:3], 0
  ds_read_b64_tr_b16 a[174:175], v4 offset:34816
  v_mfma_f32_16x16x32_bf16 v[160:163], a[180:183], a[16:19], v[160:163]
  buffer_load_dwordx4 v11, s[28:31], s67 offen lds
  v_mfma_f32_16x16x32_bf16 v[164:167], a[180:183], a[20:23], 0
  ds_read_b64_tr_b16 a[168:169], v4 offset:36864
  v_mfma_f32_16x16x32_bf16 v[164:167], a[176:179], a[4:7], v[164:167]
  s_add_u32 m0, s45, 73728
  v_mfma_f32_16x16x32_bf16 v[168:171], a[176:179], a[8:11], 0
  ds_read_b64_tr_b16 a[170:171], v4 offset:38912
  v_mfma_f32_16x16x32_bf16 v[168:171], a[180:183], a[24:27], v[168:171]
  buffer_load_dwordx4 v11, s[32:35], s67 offen lds
  v_mfma_f32_16x16x32_bf16 v[172:175], a[180:183], a[28:31], 0
  ds_read_b64_tr_b16 a[180:181], v4 offset:40960
  v_mfma_f32_16x16x32_bf16 v[172:175], a[176:179], a[12:15], v[172:175]
  s_waitcnt lgkmcnt(5)
  s_add_u32 m0, s45, 69632
  s_add_u32 s61, s67, 229376
  v_mfma_f32_16x16x32_bf16 v[188:191], a[164:167], a[12:15], 0
  ds_read_b64_tr_b16 a[182:183], v4 offset:43008
  v_mfma_f32_16x16x32_bf16 v[188:191], a[160:163], a[28:31], v[188:191]
  buffer_load_dwordx4 v11, s[28:31], s61 offen lds
  v_mfma_f32_16x16x32_bf16 v[184:187], a[160:163], a[24:27], 0
  ds_read_b64_tr_b16 a[176:177], v4 offset:45056
  v_mfma_f32_16x16x32_bf16 v[184:187], a[164:167], a[8:11], v[184:187]
  s_add_u32 m0, s45, 77824
  s_add_u32 s61, s67, 229376
  v_mfma_f32_16x16x32_bf16 v[180:183], a[164:167], a[4:7], 0
  ds_read_b64_tr_b16 a[178:179], v4 offset:47104
  v_mfma_f32_16x16x32_bf16 v[180:183], a[160:163], a[20:23], v[180:183]
  buffer_load_dwordx4 v11, s[32:35], s61 offen lds
  v_mfma_f32_16x16x32_bf16 v[176:179], a[160:163], a[16:19], 0
  ds_read_b64_tr_b16 a[160:161], v5 offset:32768
  v_mfma_f32_16x16x32_bf16 v[176:179], a[164:167], a[0:3], v[176:179]
  s_waitcnt lgkmcnt(5)
  s_mov_b32 s62, 0
  v_mfma_f32_16x16x32_bf16 v[192:195], a[172:175], a[0:3], 0
  ds_read_b64_tr_b16 a[162:163], v5 offset:34816
  v_mfma_f32_16x16x32_bf16 v[192:195], a[168:171], a[16:19], v[192:195]
  buffer_load_dwordx4 a[220:223], v13, s[12:15], s62 offen
  s_mov_b32 s62, 7168
  v_mfma_f32_16x16x32_bf16 v[196:199], a[168:171], a[20:23], 0
  ds_read_b64_tr_b16 a[164:165], v5 offset:36864
  v_mfma_f32_16x16x32_bf16 v[196:199], a[172:175], a[4:7], v[196:199]
  buffer_load_dwordx4 a[224:227], v13, s[12:15], s62 offen
  s_mov_b32 s62, 14336
  v_mfma_f32_16x16x32_bf16 v[200:203], a[172:175], a[8:11], 0
  ds_read_b64_tr_b16 a[166:167], v5 offset:38912
  v_mfma_f32_16x16x32_bf16 v[200:203], a[168:171], a[24:27], v[200:203]
  buffer_load_dwordx4 a[228:231], v13, s[12:15], s62 offen
  s_mov_b32 s62, 21504
  v_mfma_f32_16x16x32_bf16 v[204:207], a[168:171], a[28:31], 0
  ds_read_b64_tr_b16 a[168:169], v5 offset:40960
  v_mfma_f32_16x16x32_bf16 v[204:207], a[172:175], a[12:15], v[204:207]
  s_waitcnt lgkmcnt(5)
  buffer_load_dwordx4 a[232:235], v13, s[12:15], s62 offen
  v_mfma_f32_16x16x32_bf16 v[220:223], a[180:183], a[12:15], 0
  ds_read_b64_tr_b16 a[170:171], v5 offset:43008
  v_mfma_f32_16x16x32_bf16 v[220:223], a[176:179], a[28:31], v[220:223]
  v_mfma_f32_16x16x32_bf16 v[216:219], a[176:179], a[24:27], 0
  ds_read_b64_tr_b16 a[172:173], v5 offset:45056
  v_mfma_f32_16x16x32_bf16 v[216:219], a[180:183], a[8:11], v[216:219]
  v_mfma_f32_16x16x32_bf16 v[212:215], a[180:183], a[4:7], 0
  ds_read_b64_tr_b16 a[174:175], v5 offset:47104
  v_mfma_f32_16x16x32_bf16 v[212:215], a[176:179], a[20:23], v[212:215]
  s_waitcnt vmcnt(41)
  s_barrier
  v_mfma_f32_16x16x32_bf16 v[208:211], a[176:179], a[16:19], 0
  ds_read_b64_tr_b16 a[176:177], v6 offset:49152
  v_mfma_f32_16x16x32_bf16 v[208:211], a[180:183], a[0:3], v[208:211]
  s_waitcnt lgkmcnt(5)
  v_mfma_f32_16x16x32_bf16 v[224:227], a[160:163], a[0:3], 0
  ds_read_b64_tr_b16 a[178:179], v6 offset:51200
  v_mfma_f32_16x16x32_bf16 v[224:227], a[164:167], a[16:19], v[224:227]
  v_mfma_f32_16x16x32_bf16 v[228:231], a[164:167], a[20:23], 0
  ds_read_b64_tr_b16 a[180:181], v6 offset:53248
  v_mfma_f32_16x16x32_bf16 v[228:231], a[160:163], a[4:7], v[228:231]
  v_mfma_f32_16x16x32_bf16 v[232:235], a[160:163], a[8:11], 0
  ds_read_b64_tr_b16 a[182:183], v6 offset:55296
  v_mfma_f32_16x16x32_bf16 v[232:235], a[164:167], a[24:27], v[232:235]
  v_mfma_f32_16x16x32_bf16 v[236:239], a[164:167], a[28:31], 0
  ds_read_b64_tr_b16 a[164:165], v6 offset:57344
  v_mfma_f32_16x16x32_bf16 v[236:239], a[160:163], a[12:15], v[236:239]
  s_waitcnt lgkmcnt(5)
  v_mfma_f32_16x16x32_bf16 v[252:255], a[168:171], a[12:15], 0
  ds_read_b64_tr_b16 a[166:167], v6 offset:59392
HOP7:
  s_cbranch_execz HOP10
  v_mfma_f32_16x16x32_bf16 v[252:255], a[172:175], a[28:31], v[252:255]
  v_mfma_f32_16x16x32_bf16 v[248:251], a[172:175], a[24:27], 0
  ds_read_b64_tr_b16 a[160:161], v6 offset:61440
  v_mfma_f32_16x16x32_bf16 v[248:251], a[168:171], a[8:11], v[248:251]
  v_mfma_f32_16x16x32_bf16 v[244:247], a[168:171], a[4:7], 0
  ds_read_b64_tr_b16 a[162:163], v6 offset:63488
  v_mfma_f32_16x16x32_bf16 v[244:247], a[172:175], a[20:23], v[244:247]
  s_add_u32 m0, s45, 0
  v_mfma_f32_16x16x32_bf16 v[240:243], a[172:175], a[16:19], 0
  ds_read_b64_tr_b16 a[172:173], v7 offset:49152
  v_mfma_f32_16x16x32_bf16 v[240:243], a[168:171], a[0:3], v[240:243]
  s_waitcnt vmcnt(24) lgkmcnt(5)
  buffer_load_dwordx4 v10, s[28:31], s67 offen lds
  v_mfma_f32_16x16x32_bf16 v[64:67], a[176:179], a[32:35], v[64:67]
  ds_read_b64_tr_b16 a[174:175], v7 offset:51200
  v_mfma_f32_16x16x32_bf16 v[64:67], a[180:183], a[48:51], v[64:67]
  s_add_u32 m0, s45, 8192
  v_mfma_f32_16x16x32_bf16 v[68:71], a[180:183], a[52:55], v[68:71]
  ds_read_b64_tr_b16 a[168:169], v7 offset:53248
  v_mfma_f32_16x16x32_bf16 v[68:71], a[176:179], a[36:39], v[68:71]
  buffer_load_dwordx4 v10, s[32:35], s67 offen lds
  v_mfma_f32_16x16x32_bf16 v[72:75], a[176:179], a[40:43], v[72:75]
  ds_read_b64_tr_b16 a[170:171], v7 offset:55296
  v_mfma_f32_16x16x32_bf16 v[72:75], a[180:183], a[56:59], v[72:75]
  s_add_u32 m0, s45, 4096
  s_add_u32 s61, s67, 229376
  v_mfma_f32_16x16x32_bf16 v[76:79], a[180:183], a[60:63], v[76:79]
  ds_read_b64_tr_b16 a[180:181], v7 offset:57344
  v_mfma_f32_16x16x32_bf16 v[76:79], a[176:179], a[44:47], v[76:79]
  s_waitcnt lgkmcnt(5)
  buffer_load_dwordx4 v10, s[28:31], s61 offen lds
  v_mfma_f32_16x16x32_bf16 v[92:95], a[164:167], a[44:47], v[92:95]
  ds_read_b64_tr_b16 a[182:183], v7 offset:59392
  v_mfma_f32_16x16x32_bf16 v[92:95], a[160:163], a[60:63], v[92:95]
  v_mfma_f32_16x16x32_bf16 v[88:91], a[160:163], a[56:59], v[88:91]
  ds_read_b64_tr_b16 a[176:177], v7 offset:61440
  v_mfma_f32_16x16x32_bf16 v[88:91], a[164:167], a[40:43], v[88:91]
  s_add_u32 m0, s45, 12288
  s_add_u32 s61, s67, 229376
  v_mfma_f32_16x16x32_bf16 v[84:87], a[164:167], a[36:39], v[84:87]
  ds_read_b64_tr_b16 a[178:179], v7 offset:63488
  v_mfma_f32_16x16x32_bf16 v[84:87], a[160:163], a[52:55], v[84:87]
  buffer_load_dwordx4 v10, s[32:35], s61 offen lds
  v_mfma_f32_16x16x32_bf16 v[80:83], a[160:163], a[48:51], v[80:83]
  ds_read_b64_tr_b16 a[160:161], v8 offset:49152
  v_mfma_f32_16x16x32_bf16 v[80:83], a[164:167], a[32:35], v[80:83]
  s_waitcnt lgkmcnt(5)
  s_add_u32 s62, s63, 0
  v_mfma_f32_16x16x32_bf16 v[96:99], a[172:175], a[32:35], v[96:99]
  ds_read_b64_tr_b16 a[162:163], v8 offset:51200
  v_mfma_f32_16x16x32_bf16 v[96:99], a[168:171], a[48:51], v[96:99]
  buffer_load_dwordx4 a[188:191], v12, s[8:11], s62 offen offset:0 sc1
  v_mfma_f32_16x16x32_bf16 v[100:103], a[168:171], a[52:55], v[100:103]
  ds_read_b64_tr_b16 a[164:165], v8 offset:53248
  v_mfma_f32_16x16x32_bf16 v[100:103], a[172:175], a[36:39], v[100:103]
  v_mfma_f32_16x16x32_bf16 v[104:107], a[172:175], a[40:43], v[104:107]
  ds_read_b64_tr_b16 a[166:167], v8 offset:55296
  v_mfma_f32_16x16x32_bf16 v[104:107], a[168:171], a[56:59], v[104:107]
  s_add_u32 s62, s63, 0
  v_mfma_f32_16x16x32_bf16 v[108:111], a[168:171], a[60:63], v[108:111]
  ds_read_b64_tr_b16 a[168:169], v8 offset:57344
  v_mfma_f32_16x16x32_bf16 v[108:111], a[172:175], a[44:47], v[108:111]
  s_waitcnt lgkmcnt(5)
  buffer_load_dwordx4 a[192:195], v12, s[8:11], s62 offen offset:256 sc1
  v_mfma_f32_16x16x32_bf16 v[124:127], a[180:183], a[44:47], v[124:127]
  ds_read_b64_tr_b16 a[170:171], v8 offset:59392
  v_mfma_f32_16x16x32_bf16 v[124:127], a[176:179], a[60:63], v[124:127]
  s_add_u32 s62, s63, 2048
  v_mfma_f32_16x16x32_bf16 v[120:123], a[176:179], a[56:59], v[120:123]
  ds_read_b64_tr_b16 a[172:173], v8 offset:61440
  v_mfma_f32_16x16x32_bf16 v[120:123], a[180:183], a[40:43], v[120:123]
  buffer_load_dwordx4 a[196:199], v12, s[8:11], s62 offen offset:0 sc1
  v_mfma_f32_16x16x32_bf16 v[116:119], a[180:183], a[36:39], v[116:119]
  ds_read_b64_tr_b16 a[174:175], v8 offset:63488
  v_mfma_f32_16x16x32_bf16 v[116:119], a[176:179], a[52:55], v[116:119]
  v_mfma_f32_16x16x32_bf16 v[112:115], a[176:179], a[48:51], v[112:115]
  ds_read_b64_tr_b16 a[176:177], v2 offset:49152
  v_mfma_f32_16x16x32_bf16 v[112:115], a[180:183], a[32:35], v[112:115]
  s_waitcnt lgkmcnt(5)
  s_add_u32 s62, s63, 2048
  v_mfma_f32_16x16x32_bf16 v[32:35], a[160:163], a[32:35], v[32:35]
  ds_read_b64_tr_b16 a[178:179], v2 offset:51200
  v_mfma_f32_16x16x32_bf16 v[32:35], a[164:167], a[48:51], v[32:35]
  buffer_load_dwordx4 a[200:203], v12, s[8:11], s62 offen offset:256 sc1
  v_mfma_f32_16x16x32_bf16 v[36:39], a[164:167], a[52:55], v[36:39]
  ds_read_b64_tr_b16 a[180:181], v2 offset:53248
  v_mfma_f32_16x16x32_bf16 v[36:39], a[160:163], a[36:39], v[36:39]
  s_add_u32 s62, s63, 4096
  v_mfma_f32_16x16x32_bf16 v[40:43], a[160:163], a[40:43], v[40:43]
  ds_read_b64_tr_b16 a[182:183], v2 offset:55296
  v_mfma_f32_16x16x32_bf16 v[40:43], a[164:167], a[56:59], v[40:43]
  buffer_load_dwordx4 a[204:207], v12, s[8:11], s62 offen offset:0 sc1
  v_mfma_f32_16x16x32_bf16 v[44:47], a[164:167], a[60:63], v[44:47]
  ds_read_b64_tr_b16 a[164:165], v2 offset:57344
  v_mfma_f32_16x16x32_bf16 v[44:47], a[160:163], a[44:47], v[44:47]
  s_waitcnt lgkmcnt(5)
  v_mfma_f32_16x16x32_bf16 v[60:63], a[168:171], a[44:47], v[60:63]
  ds_read_b64_tr_b16 a[166:167], v2 offset:59392
  v_mfma_f32_16x16x32_bf16 v[60:63], a[172:175], a[60:63], v[60:63]
  s_add_u32 s62, s63, 4096
  v_mfma_f32_16x16x32_bf16 v[56:59], a[172:175], a[56:59], v[56:59]
  ds_read_b64_tr_b16 a[160:161], v2 offset:61440
  v_mfma_f32_16x16x32_bf16 v[56:59], a[168:171], a[40:43], v[56:59]
  buffer_load_dwordx4 a[208:211], v12, s[8:11], s62 offen offset:256 sc1
  v_mfma_f32_16x16x32_bf16 v[52:55], a[168:171], a[36:39], v[52:55]
  ds_read_b64_tr_b16 a[162:163], v2 offset:63488
  v_mfma_f32_16x16x32_bf16 v[52:55], a[172:175], a[52:55], v[52:55]
  s_add_u32 s62, s63, 6144
  v_mfma_f32_16x16x32_bf16 v[48:51], a[172:175], a[48:51], v[48:51]
  ds_read_b64_tr_b16 a[172:173], v3 offset:49152
  v_mfma_f32_16x16x32_bf16 v[48:51], a[168:171], a[32:35], v[48:51]
  s_waitcnt lgkmcnt(5)
  buffer_load_dwordx4 a[212:215], v12, s[8:11], s62 offen offset:0 sc1
  v_mfma_f32_16x16x32_bf16 v[128:131], a[176:179], a[32:35], v[128:131]
  ds_read_b64_tr_b16 a[174:175], v3 offset:51200
  v_mfma_f32_16x16x32_bf16 v[128:131], a[180:183], a[48:51], v[128:131]
  v_mfma_f32_16x16x32_bf16 v[132:135], a[180:183], a[52:55], v[132:135]
  ds_read_b64_tr_b16 a[168:169], v3 offset:53248
  v_mfma_f32_16x16x32_bf16 v[132:135], a[176:179], a[36:39], v[132:135]
  s_add_u32 s62, s63, 6144
  v_mfma_f32_16x16x32_bf16 v[136:139], a[176:179], a[40:43], v[136:139]
  ds_read_b64_tr_b16 a[170:171], v3 offset:55296
  v_mfma_f32_16x16x32_bf16 v[136:139], a[180:183], a[56:59], v[136:139]
  buffer_load_dwordx4 a[216:219], v12, s[8:11], s62 offen offset:256 sc1
  ds_read_b128 v[24:27], v14 offset:0
  v_mfma_f32_16x16x32_bf16 v[140:143], a[180:183], a[60:63], v[140:143]
  ds_read_b64_tr_b16 a[180:181], v3 offset:57344
  v_mfma_f32_16x16x32_bf16 v[140:143], a[176:179], a[44:47], v[140:143]
  s_waitcnt lgkmcnt(6)
  v_mfma_f32_16x16x32_bf16 v[156:159], a[164:167], a[44:47], v[156:159]
  ds_read_b64_tr_b16 a[182:183], v3 offset:59392
  v_mfma_f32_16x16x32_bf16 v[156:159], a[160:163], a[60:63], v[156:159]
  buffer_load_dwordx4 a[96:99], v1, s[8:11], s75 offen offset:0 sc1
  v_mfma_f32_16x16x32_bf16 v[152:155], a[160:163], a[56:59], v[152:155]
  ds_read_b64_tr_b16 a[176:177], v3 offset:61440
  v_mfma_f32_16x16x32_bf16 v[152:155], a[164:167], a[40:43], v[152:155]
  s_waitcnt vmcnt(13) lgkmcnt(3)
  v_cndmask_b32 v28, 0, v24, s[16:17]
  v_cndmask_b32 v29, 0, v24, s[18:19]
  v_mfma_f32_16x16x32_bf16 v[148:151], a[164:167], a[36:39], v[148:151]
  ds_read_b64_tr_b16 a[178:179], v3 offset:63488
  v_cndmask_b32 v30, 0, v24, s[20:21]
  v_mfma_f32_16x16x32_bf16 v[148:151], a[160:163], a[52:55], v[148:151]
  s_mov_b32 s62, 28672
  v_cndmask_b32 v31, 0, v24, s[22:23]
  v_mfma_f32_16x16x32_bf16 v[144:147], a[160:163], a[48:51], v[144:147]
  ds_read_b64_tr_b16 a[160:161], v4 offset:49152
  buffer_load_dwordx4 a[236:239], v13, s[12:15], s62 offen
  v_mfma_f32_16x16x32_bf16 a[184:187], v[28:31], a[220:223], 0
  v_cndmask_b32 v28, 0, v25, s[16:17]
  v_cndmask_b32 v29, 0, v25, s[18:19]
  v_mfma_f32_16x16x32_bf16 v[144:147], a[164:167], a[32:35], v[144:147]
  s_waitcnt lgkmcnt(6)
  s_mov_b32 s62, 35840
  v_cndmask_b32 v30, 0, v25, s[20:21]
  v_mfma_f32_16x16x32_bf16 v[160:163], a[172:175], a[32:35], v[160:163]
  ds_read_b64_tr_b16 a[162:163], v4 offset:51200
  buffer_load_dwordx4 a[240:243], v13, s[12:15], s62 offen
  v_mfma_f32_16x16x32_bf16 v[160:163], a[168:171], a[48:51], v[160:163]
  s_mov_b32 s62, 43008
  v_cndmask_b32 v31, 0, v25, s[22:23]
  v_mfma_f32_16x16x32_bf16 v[164:167], a[168:171], a[52:55], v[164:167]
  ds_read_b64_tr_b16 a[164:165], v4 offset:53248
  buffer_load_dwordx4 a[244:247], v13, s[12:15], s62 offen
  v_mfma_f32_16x16x32_bf16 a[184:187], v[28:31], a[224:227], a[184:187]
  v_cndmask_b32 v28, 0, v26, s[16:17]
  v_cndmask_b32 v29, 0, v26, s[18:19]
  v_mfma_f32_16x16x32_bf16 v[164:167], a[172:175], a[36:39], v[164:167]
  s_mov_b32 s62, 50176
  v_cndmask_b32 v30, 0, v26, s[20:21]
  v_cndmask_b32 v31, 0, v26, s[22:23]
  v_mfma_f32_16x16x32_bf16 v[168:171], a[172:175], a[40:43], v[168:171]
  ds_read_b64_tr_b16 a[166:167], v4 offset:55296
  v_mfma_f32_16x16x32_bf16 a[184:187], v[28:31], a[228:231], a[184:187]
  v_cndmask_b32 v28, 0, v27, s[16:17]
  v_cndmask_b32 v29, 0, v27, s[18:19]
  v_mfma_f32_16x16x32_bf16 v[168:171], a[168:171], a[56:59], v[168:171]
  buffer_load_dwordx4 a[248:251], v13, s[12:15], s62 offen
  v_cndmask_b32 v30, 0, v27, s[20:21]
  v_cndmask_b32 v31, 0, v27, s[22:23]
  v_mfma_f32_16x16x32_bf16 v[172:175], a[168:171], a[60:63], v[172:175]
  ds_read_b64_tr_b16 a[168:169], v4 offset:57344
  v_mfma_f32_16x16x32_bf16 a[184:187], v[28:31], a[232:235], a[184:187]
  v_mfma_f32_16x16x32_bf16 v[172:175], a[172:175], a[44:47], v[172:175]
  s_waitcnt lgkmcnt(5)
  v_mfma_f32_16x16x32_bf16 v[188:191], a[180:183], a[44:47], v[188:191]
  ds_read_b64_tr_b16 a[170:171], v4 offset:59392
  v_mfma_f32_16x16x32_bf16 v[188:191], a[176:179], a[60:63], v[188:191]
  v_mfma_f32_16x16x32_bf16 v[184:187], a[176:179], a[56:59], v[184:187]
  ds_read_b64_tr_b16 a[172:173], v4 offset:61440
  v_mfma_f32_16x16x32_bf16 v[184:187], a[180:183], a[40:43], v[184:187]
  v_mfma_f32_16x16x32_bf16 v[180:183], a[180:183], a[36:39], v[180:183]
  ds_read_b64_tr_b16 a[174:175], v4 offset:63488
  v_mfma_f32_16x16x32_bf16 v[180:183], a[176:179], a[52:55], v[180:183]
  v_mfma_f32_16x16x32_bf16 v[176:179], a[176:179], a[48:51], v[176:179]
  ds_read_b64_tr_b16 a[176:177], v5 offset:49152
  v_mfma_f32_16x16x32_bf16 v[176:179], a[180:183], a[32:35], v[176:179]
  s_waitcnt lgkmcnt(5)
  v_mfma_f32_16x16x32_bf16 v[192:195], a[160:163], a[32:35], v[192:195]
  ds_read_b64_tr_b16 a[178:179], v5 offset:51200
  v_mfma_f32_16x16x32_bf16 v[192:195], a[164:167], a[48:51], v[192:195]
  v_mfma_f32_16x16x32_bf16 v[196:199], a[164:167], a[52:55], v[196:199]
  ds_read_b64_tr_b16 a[180:181], v5 offset:53248
  v_mfma_f32_16x16x32_bf16 v[196:199], a[160:163], a[36:39], v[196:199]
  v_mfma_f32_16x16x32_bf16 v[200:203], a[160:163], a[40:43], v[200:203]
  ds_read_b64_tr_b16 a[182:183], v5 offset:55296
  v_mfma_f32_16x16x32_bf16 v[200:203], a[164:167], a[56:59], v[200:203]
  v_mfma_f32_16x16x32_bf16 v[204:207], a[164:167], a[60:63], v[204:207]
  ds_read_b64_tr_b16 a[164:165], v5 offset:57344
  v_mfma_f32_16x16x32_bf16 v[204:207], a[160:163], a[44:47], v[204:207]
  s_waitcnt lgkmcnt(5)
  v_mfma_f32_16x16x32_bf16 v[220:223], a[168:171], a[44:47], v[220:223]
  ds_read_b64_tr_b16 a[166:167], v5 offset:59392
  v_mfma_f32_16x16x32_bf16 v[220:223], a[172:175], a[60:63], v[220:223]
  v_mfma_f32_16x16x32_bf16 v[216:219], a[172:175], a[56:59], v[216:219]
  ds_read_b64_tr_b16 a[160:161], v5 offset:61440
  v_mfma_f32_16x16x32_bf16 v[216:219], a[168:171], a[40:43], v[216:219]
  v_mfma_f32_16x16x32_bf16 v[212:215], a[168:171], a[36:39], v[212:215]
  ds_read_b64_tr_b16 a[162:163], v5 offset:63488
  v_mfma_f32_16x16x32_bf16 v[212:215], a[172:175], a[52:55], v[212:215]
  s_waitcnt vmcnt(33)
  s_barrier
  v_mfma_f32_16x16x32_bf16 v[208:211], a[172:175], a[48:51], v[208:211]
  ds_read_b64_tr_b16 a[172:173], v6 offset:16384
  v_mfma_f32_16x16x32_bf16 v[208:211], a[168:171], a[32:35], v[208:211]
  s_waitcnt lgkmcnt(5)
  v_mfma_f32_16x16x32_bf16 v[224:227], a[176:179], a[32:35], v[224:227]
  ds_read_b64_tr_b16 a[174:175], v6 offset:18432
  v_mfma_f32_16x16x32_bf16 v[224:227], a[180:183], a[48:51], v[224:227]
  v_mfma_f32_16x16x32_bf16 v[228:231], a[180:183], a[52:55], v[228:231]
  ds_read_b64_tr_b16 a[168:169], v6 offset:20480
  v_mfma_f32_16x16x32_bf16 v[228:231], a[176:179], a[36:39], v[228:231]
  buffer_load_dwordx4 a[112:115], v1, s[8:11], s75 offen offset:1024 sc1
  v_mfma_f32_16x16x32_bf16 v[232:235], a[176:179], a[40:43], v[232:235]
  ds_read_b64_tr_b16 a[170:171], v6 offset:22528
  v_mfma_f32_16x16x32_bf16 v[232:235], a[180:183], a[56:59], v[232:235]
  s_add_u32 s75, s75, 65536
  v_mfma_f32_16x16x32_bf16 v[236:239], a[180:183], a[60:63], v[236:239]
  ds_read_b64_tr_b16 a[180:181], v6 offset:24576
  v_mfma_f32_16x16x32_bf16 v[236:239], a[176:179], a[44:47], v[236:239]
  s_waitcnt lgkmcnt(5)
  buffer_load_dwordx4 a[100:103], v1, s[8:11], s75 offen offset:0 sc1
  s_waitcnt vmcnt(7)
  v_mfma_f32_16x16x32_bf16 v[252:255], a[164:167], a[44:47], v[252:255]
  ds_read_b64_tr_b16 a[182:183], v6 offset:26624
  v_accvgpr_read_b32 v16, a188
  v_mfma_f32_16x16x32_bf16 v[252:255], a[160:163], a[60:63], v[252:255]
  v_accvgpr_read_b32 v17, a189
  v_accvgpr_read_b32 v18, a190
  v_mfma_f32_16x16x32_bf16 v[248:251], a[160:163], a[56:59], v[248:251]
  ds_read_b64_tr_b16 a[176:177], v6 offset:28672
  v_accvgpr_read_b32 v19, a191
  v_mfma_f32_16x16x32_bf16 v[248:251], a[164:167], a[40:43], v[248:251]
  v_accvgpr_read_b32 v20, a192
  v_accvgpr_read_b32 v21, a193
  v_mfma_f32_16x16x32_bf16 v[244:247], a[164:167], a[36:39], v[244:247]
  ds_read_b64_tr_b16 a[178:179], v6 offset:30720
  v_accvgpr_read_b32 v22, a194
  v_mfma_f32_16x16x32_bf16 v[244:247], a[160:163], a[52:55], v[244:247]
  buffer_load_dwordx4 a[116:119], v1, s[8:11], s75 offen offset:1024 sc1
  v_accvgpr_read_b32 v23, a195
  v_accvgpr_read_b32 v24, a196
  v_mfma_f32_16x16x32_bf16 v[240:243], a[160:163], a[48:51], v[240:243]
  ds_read_b64_tr_b16 a[160:161], v7 offset:16384
  v_accvgpr_read_b32 v25, a197
  v_mfma_f32_16x16x32_bf16 v[240:243], a[164:167], a[32:35], v[240:243]
  s_waitcnt vmcnt(28) lgkmcnt(5)
  s_add_u32 s75, s75, 65536
  v_accvgpr_read_b32 v26, a198
  v_mfma_f32_16x16x32_bf16 v[64:67], a[172:175], a[64:67], v[64:67]
  ds_read_b64_tr_b16 a[162:163], v7 offset:18432
  v_accvgpr_read_b32 v27, a199
  v_mfma_f32_16x16x32_bf16 v[64:67], a[168:171], a[80:83], v[64:67]
  buffer_load_dwordx4 a[104:107], v1, s[8:11], s75 offen offset:0 sc1
  v_accvgpr_read_b32 v28, a200
  v_accvgpr_read_b32 v29, a201
  v_mfma_f32_16x16x32_bf16 v[68:71], a[168:171], a[84:87], v[68:71]
  ds_read_b64_tr_b16 a[164:165], v7 offset:20480
  v_accvgpr_read_b32 v30, a202
  v_mfma_f32_16x16x32_bf16 v[68:71], a[172:175], a[68:71], v[68:71]
  v_accvgpr_read_b32 v31, a203
  v_add_f32 v16, v16, v24
  v_mfma_f32_16x16x32_bf16 v[72:75], a[172:175], a[72:75], v[72:75]
  ds_read_b64_tr_b16 a[166:167], v7 offset:22528
  v_add_f32 v17, v17, v25
  v_mfma_f32_16x16x32_bf16 v[72:75], a[168:171], a[88:91], v[72:75]
  v_add_f32 v18, v18, v26
  v_add_f32 v19, v19, v27
  v_mfma_f32_16x16x32_bf16 v[76:79], a[168:171], a[92:95], v[76:79]
  ds_read_b64_tr_b16 a[168:169], v7 offset:24576
  v_add_f32 v20, v20, v28
  v_mfma_f32_16x16x32_bf16 v[76:79], a[172:175], a[76:79], v[76:79]
  s_waitcnt lgkmcnt(5)
  buffer_load_dwordx4 a[120:123], v1, s[8:11], s75 offen offset:1024 sc1
  v_add_f32 v21, v21, v29
  v_mfma_f32_16x16x32_bf16 v[92:95], a[180:183], a[76:79], v[92:95]
  ds_read_b64_tr_b16 a[170:171], v7 offset:26624
  v_add_f32 v22, v22, v30
  v_mfma_f32_16x16x32_bf16 v[92:95], a[176:179], a[92:95], v[92:95]
  s_add_u32 s75, s75, 65536
  v_add_f32 v23, v23, v31
  v_accvgpr_read_b32 v24, a204
  v_mfma_f32_16x16x32_bf16 v[88:91], a[176:179], a[88:91], v[88:91]
  ds_read_b64_tr_b16 a[172:173], v7 offset:28672
  v_accvgpr_read_b32 v25, a205
  v_mfma_f32_16x16x32_bf16 v[88:91], a[180:183], a[72:75], v[88:91]
  buffer_load_dwordx4 a[108:111], v1, s[8:11], s75 offen offset:0 sc1
  v_accvgpr_read_b32 v26, a206
  v_accvgpr_read_b32 v27, a207
  v_mfma_f32_16x16x32_bf16 v[84:87], a[180:183], a[68:71], v[84:87]
  ds_read_b64_tr_b16 a[174:175], v7 offset:30720
  v_accvgpr_read_b32 v28, a208
  v_mfma_f32_16x16x32_bf16 v[84:87], a[176:179], a[84:87], v[84:87]
  v_accvgpr_read_b32 v29, a209
  v_accvgpr_read_b32 v30, a210
  v_mfma_f32_16x16x32_bf16 v[80:83], a[176:179], a[80:83], v[80:83]
  ds_read_b64_tr_b16 a[176:177], v8 offset:16384
  v_accvgpr_read_b32 v31, a211
  v_mfma_f32_16x16x32_bf16 v[80:83], a[180:183], a[64:67], v[80:83]
  s_waitcnt lgkmcnt(5)
  v_add_f32 v16, v16, v24
  v_add_f32 v17, v17, v25
  v_mfma_f32_16x16x32_bf16 v[96:99], a[160:163], a[64:67], v[96:99]
  ds_read_b64_tr_b16 a[178:179], v8 offset:18432
  v_add_f32 v18, v18, v26
  v_mfma_f32_16x16x32_bf16 v[96:99], a[164:167], a[80:83], v[96:99]
  buffer_load_dwordx4 a[124:127], v1, s[8:11], s75 offen offset:1024 sc1
  v_add_f32 v19, v19, v27
  v_add_f32 v20, v20, v28
  v_mfma_f32_16x16x32_bf16 v[100:103], a[164:167], a[84:87], v[100:103]
  ds_read_b64_tr_b16 a[180:181], v8 offset:20480
  v_add_f32 v21, v21, v29
  v_mfma_f32_16x16x32_bf16 v[100:103], a[160:163], a[68:71], v[100:103]
  s_cmp_eq_u32 s56, 0
  s_cselect_b32 s76, 8, 4
  s_mul_i32 s68, s76, 458752
  s_lshl_b32 s76, s76, 11
  s_add_u32 s76, s76, s57
  s_add_u32 m0, s45, 98304
  v_add_f32 v22, v22, v30
  v_add_f32 v23, v23, v31
  v_mfma_f32_16x16x32_bf16 v[104:107], a[160:163], a[72:75], v[104:107]
  ds_read_b64_tr_b16 a[182:183], v8 offset:22528
  v_accvgpr_read_b32 v24, a212
  v_mfma_f32_16x16x32_bf16 v[104:107], a[164:167], a[88:91], v[104:107]
  buffer_load_dwordx4 v11, s[28:31], s68 offen lds
  v_accvgpr_read_b32 v25, a213
  v_accvgpr_read_b32 v26, a214
  v_mfma_f32_16x16x32_bf16 v[108:111], a[164:167], a[92:95], v[108:111]
  ds_read_b64_tr_b16 a[164:165], v8 offset:24576
  v_accvgpr_read_b32 v27, a215
  v_mfma_f32_16x16x32_bf16 v[108:111], a[160:163], a[76:79], v[108:111]
  s_waitcnt lgkmcnt(5)
  v_accvgpr_read_b32 v28, a216
  v_accvgpr_read_b32 v29, a217
  v_mfma_f32_16x16x32_bf16 v[124:127], a[168:171], a[76:79], v[124:127]
  ds_read_b64_tr_b16 a[166:167], v8 offset:26624
  v_accvgpr_read_b32 v30, a218
  v_mfma_f32_16x16x32_bf16 v[124:127], a[172:175], a[92:95], v[124:127]
  s_add_u32 m0, s45, 106496
  v_accvgpr_read_b32 v31, a219
  v_add_f32 v16, v16, v24
  v_mfma_f32_16x16x32_bf16 v[120:123], a[172:175], a[88:91], v[120:123]
  ds_read_b64_tr_b16 a[160:161], v8 offset:28672
  v_add_f32 v17, v17, v25
  v_mfma_f32_16x16x32_bf16 v[120:123], a[168:171], a[72:75], v[120:123]
  buffer_load_dwordx4 v11, s[32:35], s68 offen lds
  v_add_f32 v18, v18, v26
  v_add_f32 v19, v19, v27
  v_mfma_f32_16x16x32_bf16 v[116:119], a[168:171], a[68:71], v[116:119]
  ds_read_b64_tr_b16 a[162:163], v8 offset:30720
  v_add_f32 v20, v20, v28
  v_mfma_f32_16x16x32_bf16 v[116:119], a[172:175], a[84:87], v[116:119]
  s_add_u32 m0, s45, 102400
  s_add_u32 s61, s68, 229376
  v_add_f32 v21, v21, v29
  v_mfma_f32_16x16x32_bf16 v[112:115], a[172:175], a[80:83], v[112:115]
  ds_read_b64_tr_b16 a[172:173], v2 offset:16384
  v_add_f32 v22, v22, v30
  v_mfma_f32_16x16x32_bf16 v[112:115], a[168:171], a[64:67], v[112:115]
  s_waitcnt lgkmcnt(5)
  buffer_load_dwordx4 v11, s[28:31], s61 offen lds
  v_add_f32 v23, v23, v31
  v_mfma_f32_16x16x32_bf16 v[32:35], a[176:179], a[64:67], v[32:35]
  ds_read_b64_tr_b16 a[174:175], v2 offset:18432
  v_mfma_f32_16x16x32_bf16 v[32:35], a[180:183], a[80:83], v[32:35]
  v_mfma_f32_16x16x32_bf16 v[36:39], a[180:183], a[84:87], v[36:39]
  ds_read_b64_tr_b16 a[168:169], v2 offset:20480
  v_mfma_f32_16x16x32_bf16 v[36:39], a[176:179], a[68:71], v[36:39]
  s_add_u32 m0, s45, 110592
  s_add_u32 s61, s68, 229376
  v_mfma_f32_16x16x32_bf16 v[40:43], a[176:179], a[72:75], v[40:43]
  ds_read_b64_tr_b16 a[170:171], v2 offset:22528
  v_mfma_f32_16x16x32_bf16 v[40:43], a[180:183], a[88:91], v[40:43]
  buffer_load_dwordx4 v11, s[32:35], s61 offen lds
  v_mfma_f32_16x16x32_bf16 v[44:47], a[180:183], a[92:95], v[44:47]
  ds_read_b64_tr_b16 a[180:181], v2 offset:24576
  v_mfma_f32_16x16x32_bf16 v[44:47], a[176:179], a[76:79], v[44:47]
  s_waitcnt lgkmcnt(5)
  s_add_u32 m0, s45, 32768
  v_mfma_f32_16x16x32_bf16 v[60:63], a[164:167], a[76:79], v[60:63]
  ds_read_b64_tr_b16 a[182:183], v2 offset:26624
  v_mfma_f32_16x16x32_bf16 v[60:63], a[160:163], a[92:95], v[60:63]
  buffer_load_dwordx4 v10, s[28:31], s68 offen lds
  ds_read_b128 v[24:27], v14 offset:16
  v_mfma_f32_16x16x32_bf16 v[56:59], a[160:163], a[88:91], v[56:59]
  ds_read_b64_tr_b16 a[176:177], v2 offset:28672
  v_mfma_f32_16x16x32_bf16 v[56:59], a[164:167], a[72:75], v[56:59]
  v_mfma_f32_16x16x32_bf16 v[52:55], a[164:167], a[68:71], v[52:55]
  ds_read_b64_tr_b16 a[178:179], v2 offset:30720
  v_mfma_f32_16x16x32_bf16 v[52:55], a[160:163], a[84:87], v[52:55]
  s_add_u32 m0, s45, 40960
  v_mfma_f32_16x16x32_bf16 v[48:51], a[160:163], a[80:83], v[48:51]
  ds_read_b64_tr_b16 a[160:161], v3 offset:16384
  v_mfma_f32_16x16x32_bf16 v[48:51], a[164:167], a[64:67], v[48:51]
  s_waitcnt lgkmcnt(6)
  buffer_load_dwordx4 v10, s[32:35], s68 offen lds
  s_waitcnt vmcnt(13) lgkmcnt(3)
  v_mfma_f32_16x16x32_bf16 v[128:131], a[172:175], a[64:67], v[128:131]
  ds_read_b64_tr_b16 a[162:163], v3 offset:18432
  v_cndmask_b32 v28, 0, v24, s[16:17]
  v_mfma_f32_16x16x32_bf16 v[128:131], a[168:171], a[80:83], v[128:131]
  s_add_u32 m0, s45, 36864
  s_add_u32 s61, s68, 229376
  v_cndmask_b32 v29, 0, v24, s[18:19]
  v_mfma_f32_16x16x32_bf16 v[132:135], a[168:171], a[84:87], v[132:135]
  ds_read_b64_tr_b16 a[164:165], v3 offset:20480
  v_cndmask_b32 v30, 0, v24, s[20:21]
  v_mfma_f32_16x16x32_bf16 v[132:135], a[172:175], a[68:71], v[132:135]
  buffer_load_dwordx4 v10, s[28:31], s61 offen lds
  v_cndmask_b32 v31, 0, v24, s[22:23]
  v_mfma_f32_16x16x32_bf16 v[136:139], a[172:175], a[72:75], v[136:139]
  ds_read_b64_tr_b16 a[166:167], v3 offset:22528
  v_mfma_f32_16x16x32_bf16 a[184:187], v[28:31], a[236:239], a[184:187]
  v_cndmask_b32 v28, 0, v25, s[16:17]
  v_cndmask_b32 v29, 0, v25, s[18:19]
  v_mfma_f32_16x16x32_bf16 v[136:139], a[168:171], a[88:91], v[136:139]
  v_cndmask_b32 v30, 0, v25, s[20:21]
  v_cndmask_b32 v31, 0, v25, s[22:23]
  v_mfma_f32_16x16x32_bf16 v[140:143], a[168:171], a[92:95], v[140:143]
  ds_read_b64_tr_b16 a[168:169], v3 offset:24576
  v_mfma_f32_16x16x32_bf16 a[184:187], v[28:31], a[240:243], a[184:187]
  v_cndmask_b32 v28, 0, v26, s[16:17]
  v_cndmask_b32 v29, 0, v26, s[18:19]
  v_mfma_f32_16x16x32_bf16 v[140:143], a[172:175], a[76:79], v[140:143]
  s_waitcnt lgkmcnt(5)
  s_add_u32 m0, s45, 45056
  s_add_u32 s61, s68, 229376
  v_mfma_f32_16x16x32_bf16 v[156:159], a[180:183], a[76:79], v[156:159]
  ds_read_b64_tr_b16 a[170:171], v3 offset:26624
  v_cndmask_b32 v30, 0, v26, s[20:21]
  v_mfma_f32_16x16x32_bf16 v[156:159], a[176:179], a[92:95], v[156:159]
  buffer_load_dwordx4 v10, s[32:35], s61 offen lds
  v_cndmask_b32 v31, 0, v26, s[22:23]
  v_mfma_f32_16x16x32_bf16 v[152:155], a[176:179], a[88:91], v[152:155]
  ds_read_b64_tr_b16 a[172:173], v3 offset:28672
  v_mfma_f32_16x16x32_bf16 a[184:187], v[28:31], a[244:247], a[184:187]
  v_cndmask_b32 v28, 0, v27, s[16:17]
  v_cndmask_b32 v29, 0, v27, s[18:19]
  v_mfma_f32_16x16x32_bf16 v[152:155], a[180:183], a[72:75], v[152:155]
  s_mov_b32 s62, 57344
  v_cndmask_b32 v30, 0, v27, s[20:21]
  v_cndmask_b32 v31, 0, v27, s[22:23]
  v_mfma_f32_16x16x32_bf16 v[148:151], a[180:183], a[68:71], v[148:151]
  ds_read_b64_tr_b16 a[174:175], v3 offset:30720
  v_mfma_f32_16x16x32_bf16 a[184:187], v[28:31], a[248:251], a[184:187]
  v_mfma_f32_16x16x32_bf16 v[148:151], a[176:179], a[84:87], v[148:151]
  buffer_load_dwordx4 a[220:223], v13, s[12:15], s62 offen
  s_mov_b32 s62, 64512
  v_mfma_f32_16x16x32_bf16 v[144:147], a[176:179], a[80:83], v[144:147]
  ds_read_b64_tr_b16 a[176:177], v4 offset:16384
  v_mfma_f32_16x16x32_bf16 v[144:147], a[180:183], a[64:67], v[144:147]
  s_waitcnt lgkmcnt(5)
  buffer_load_dwordx4 a[224:227], v13, s[12:15], s62 offen
  v_mfma_f32_16x16x32_bf16 v[160:163], a[160:163], a[64:67], v[160:163]
  ds_read_b64_tr_b16 a[178:179], v4 offset:18432
  s_mov_b32 s62, 71680
  v_mfma_f32_16x16x32_bf16 v[160:163], a[164:167], a[80:83], v[160:163]
  buffer_load_dwordx4 a[228:231], v13, s[12:15], s62 offen
  s_mov_b32 s62, 78848
  v_mfma_f32_16x16x32_bf16 v[164:167], a[164:167], a[84:87], v[164:167]
  ds_read_b64_tr_b16 a[180:181], v4 offset:20480
  v_mfma_f32_16x16x32_bf16 v[164:167], a[160:163], a[68:71], v[164:167]
  buffer_load_dwordx4 a[232:235], v13, s[12:15], s62 offen
  v_mfma_f32_16x16x32_bf16 v[168:171], a[160:163], a[72:75], v[168:171]
  ds_read_b64_tr_b16 a[182:183], v4 offset:22528
  v_mfma_f32_16x16x32_bf16 v[168:171], a[164:167], a[88:91], v[168:171]
  v_mfma_f32_16x16x32_bf16 v[172:175], a[164:167], a[92:95], v[172:175]
  ds_read_b64_tr_b16 a[164:165], v4 offset:24576
  v_mfma_f32_16x16x32_bf16 v[172:175], a[160:163], a[76:79], v[172:175]
  s_waitcnt lgkmcnt(5)
  v_mfma_f32_16x16x32_bf16 v[188:191], a[168:171], a[76:79], v[188:191]
  ds_read_b64_tr_b16 a[166:167], v4 offset:26624
  v_mfma_f32_16x16x32_bf16 v[188:191], a[172:175], a[92:95], v[188:191]
  v_mfma_f32_16x16x32_bf16 v[184:187], a[172:175], a[88:91], v[184:187]
  ds_read_b64_tr_b16 a[160:161], v4 offset:28672
  v_mfma_f32_16x16x32_bf16 v[184:187], a[168:171], a[72:75], v[184:187]
  v_mfma_f32_16x16x32_bf16 v[180:183], a[168:171], a[68:71], v[180:183]
  ds_read_b64_tr_b16 a[162:163], v4 offset:30720
  v_mfma_f32_16x16x32_bf16 v[180:183], a[172:175], a[84:87], v[180:183]
  v_mfma_f32_16x16x32_bf16 v[176:179], a[172:175], a[80:83], v[176:179]
  ds_read_b64_tr_b16 a[172:173], v5 offset:16384
  v_mfma_f32_16x16x32_bf16 v[176:179], a[168:171], a[64:67], v[176:179]
  s_waitcnt lgkmcnt(5)
  v_mfma_f32_16x16x32_bf16 v[192:195], a[176:179], a[64:67], v[192:195]
  ds_read_b64_tr_b16 a[174:175], v5 offset:18432
  v_mfma_f32_16x16x32_bf16 v[192:195], a[180:183], a[80:83], v[192:195]
  v_mfma_f32_16x16x32_bf16 v[196:199], a[180:183], a[84:87], v[196:199]
  ds_read_b64_tr_b16 a[168:169], v5 offset:20480
  v_mfma_f32_16x16x32_bf16 v[196:199], a[176:179], a[68:71], v[196:199]
  v_mfma_f32_16x16x32_bf16 v[200:203], a[176:179], a[72:75], v[200:203]
  ds_read_b64_tr_b16 a[170:171], v5 offset:22528
  v_mfma_f32_16x16x32_bf16 v[200:203], a[180:183], a[88:91], v[200:203]
  v_mfma_f32_16x16x32_bf16 v[204:207], a[180:183], a[92:95], v[204:207]
  ds_read_b64_tr_b16 a[180:181], v5 offset:24576
  v_mfma_f32_16x16x32_bf16 v[204:207], a[176:179], a[76:79], v[204:207]
  s_waitcnt lgkmcnt(5)
  v_mfma_f32_16x16x32_bf16 v[220:223], a[164:167], a[76:79], v[220:223]
  ds_read_b64_tr_b16 a[182:183], v5 offset:26624
  v_mfma_f32_16x16x32_bf16 v[220:223], a[160:163], a[92:95], v[220:223]
  v_mfma_f32_16x16x32_bf16 v[216:219], a[160:163], a[88:91], v[216:219]
  ds_read_b64_tr_b16 a[176:177], v5 offset:28672
  v_mfma_f32_16x16x32_bf16 v[216:219], a[164:167], a[72:75], v[216:219]
  v_mfma_f32_16x16x32_bf16 v[212:215], a[164:167], a[68:71], v[212:215]
  ds_read_b64_tr_b16 a[178:179], v5 offset:30720
  v_mfma_f32_16x16x32_bf16 v[212:215], a[160:163], a[84:87], v[212:215]
  s_waitcnt vmcnt(32)
  s_barrier
  v_mfma_f32_16x16x32_bf16 v[208:211], a[160:163], a[80:83], v[208:211]
  ds_read_b64_tr_b16 a[160:161], v6 offset:0
  v_mfma_f32_16x16x32_bf16 v[208:211], a[164:167], a[64:67], v[208:211]
  s_waitcnt lgkmcnt(5)
  v_mfma_f32_16x16x32_bf16 v[224:227], a[172:175], a[64:67], v[224:227]
  ds_read_b64_tr_b16 a[162:163], v6 offset:2048
  v_mfma_f32_16x16x32_bf16 v[224:227], a[168:171], a[80:83], v[224:227]
  buffer_load_dwordx4 a[128:131], v1, s[8:11], s76 offen offset:0 sc1
  v_mfma_f32_16x16x32_bf16 v[228:231], a[168:171], a[84:87], v[228:231]
  ds_read_b64_tr_b16 a[164:165], v6 offset:4096
  v_mfma_f32_16x16x32_bf16 v[228:231], a[172:175], a[68:71], v[228:231]
  v_mfma_f32_16x16x32_bf16 v[232:235], a[172:175], a[72:75], v[232:235]
  ds_read_b64_tr_b16 a[166:167], v6 offset:6144
  v_mfma_f32_16x16x32_bf16 v[232:235], a[168:171], a[88:91], v[232:235]
  v_mfma_f32_16x16x32_bf16 v[236:239], a[168:171], a[92:95], v[236:239]
  ds_read_b64_tr_b16 a[168:169], v6 offset:8192
HOP8:
  s_cbranch_execz HOP11
  v_mfma_f32_16x16x32_bf16 v[236:239], a[172:175], a[76:79], v[236:239]
  s_waitcnt lgkmcnt(5)
  buffer_load_dwordx4 a[144:147], v1, s[8:11], s76 offen offset:1024 sc1
  v_mfma_f32_16x16x32_bf16 v[252:255], a[180:183], a[76:79], v[252:255]
  ds_read_b64_tr_b16 a[170:171], v6 offset:10240
  v_mfma_f32_16x16x32_bf16 v[252:255], a[176:179], a[92:95], v[252:255]
  s_add_u32 s76, s76, 65536
  v_mfma_f32_16x16x32_bf16 v[248:251], a[176:179], a[88:91], v[248:251]
  ds_read_b64_tr_b16 a[172:173], v6 offset:12288
  v_mfma_f32_16x16x32_bf16 v[248:251], a[180:183], a[72:75], v[248:251]
  buffer_load_dwordx4 a[132:135], v1, s[8:11], s76 offen offset:0 sc1
  v_mfma_f32_16x16x32_bf16 v[244:247], a[180:183], a[68:71], v[244:247]
  ds_read_b64_tr_b16 a[174:175], v6 offset:14336
  v_mfma_f32_16x16x32_bf16 v[244:247], a[176:179], a[84:87], v[244:247]
  v_mfma_f32_16x16x32_bf16 v[240:243], a[176:179], a[80:83], v[240:243]
  ds_read_b64_tr_b16 a[176:177], v7 offset:0
  v_mfma_f32_16x16x32_bf16 v[240:243], a[180:183], a[64:67], v[240:243]
  s_waitcnt vmcnt(15) lgkmcnt(5)
  v_mfma_f32_16x16x32_bf16 v[64:67], a[160:163], a[96:99], v[64:67]
  ds_read_b64_tr_b16 a[178:179], v7 offset:2048
  v_mfma_f32_16x16x32_bf16 v[64:67], a[164:167], a[112:115], v[64:67]
  buffer_load_dwordx4 a[148:151], v1, s[8:11], s76 offen offset:1024 sc1
  v_mfma_f32_16x16x32_bf16 v[68:71], a[164:167], a[116:119], v[68:71]
  ds_read_b64_tr_b16 a[180:181], v7 offset:4096
  v_mfma_f32_16x16x32_bf16 v[68:71], a[160:163], a[100:103], v[68:71]
  s_add_u32 s76, s76, 65536
  v_mfma_f32_16x16x32_bf16 v[72:75], a[160:163], a[104:107], v[72:75]
  ds_read_b64_tr_b16 a[182:183], v7 offset:6144
  v_mfma_f32_16x16x32_bf16 v[72:75], a[164:167], a[120:123], v[72:75]
  buffer_load_dwordx4 a[136:139], v1, s[8:11], s76 offen offset:0 sc1
  v_mfma_f32_16x16x32_bf16 v[76:79], a[164:167], a[124:127], v[76:79]
  ds_read_b64_tr_b16 a[164:165], v7 offset:8192
  v_mfma_f32_16x16x32_bf16 v[76:79], a[160:163], a[108:111], v[76:79]
  s_waitcnt lgkmcnt(5)
  v_mfma_f32_16x16x32_bf16 v[92:95], a[168:171], a[108:111], v[92:95]
  ds_read_b64_tr_b16 a[166:167], v7 offset:10240
  v_mfma_f32_16x16x32_bf16 v[92:95], a[172:175], a[124:127], v[92:95]
  v_mfma_f32_16x16x32_bf16 v[88:91], a[172:175], a[120:123], v[88:91]
  ds_read_b64_tr_b16 a[160:161], v7 offset:12288
  v_mfma_f32_16x16x32_bf16 v[88:91], a[168:171], a[104:107], v[88:91]
  buffer_load_dwordx4 a[152:155], v1, s[8:11], s76 offen offset:1024 sc1
  v_mfma_f32_16x16x32_bf16 v[84:87], a[168:171], a[100:103], v[84:87]
  ds_read_b64_tr_b16 a[162:163], v7 offset:14336
  v_mfma_f32_16x16x32_bf16 v[84:87], a[172:175], a[116:119], v[84:87]
  s_add_u32 s76, s76, 65536
  v_mfma_f32_16x16x32_bf16 v[80:83], a[172:175], a[112:115], v[80:83]
  ds_read_b64_tr_b16 a[172:173], v8 offset:0
  v_mfma_f32_16x16x32_bf16 v[80:83], a[168:171], a[96:99], v[80:83]
  s_waitcnt lgkmcnt(5)
  buffer_load_dwordx4 a[140:143], v1, s[8:11], s76 offen offset:0 sc1
  v_mfma_f32_16x16x32_bf16 v[96:99], a[176:179], a[96:99], v[96:99]
  ds_read_b64_tr_b16 a[174:175], v8 offset:2048
  v_mfma_f32_16x16x32_bf16 v[96:99], a[180:183], a[112:115], v[96:99]
  v_mfma_f32_16x16x32_bf16 v[100:103], a[180:183], a[116:119], v[100:103]
  ds_read_b64_tr_b16 a[168:169], v8 offset:4096
  v_mfma_f32_16x16x32_bf16 v[100:103], a[176:179], a[100:103], v[100:103]
  v_mfma_f32_16x16x32_bf16 v[104:107], a[176:179], a[104:107], v[104:107]
  ds_read_b64_tr_b16 a[170:171], v8 offset:6144
  v_mfma_f32_16x16x32_bf16 v[104:107], a[180:183], a[120:123], v[104:107]
  buffer_load_dwordx4 a[156:159], v1, s[8:11], s76 offen offset:1024 sc1
  v_mfma_f32_16x16x32_bf16 v[108:111], a[180:183], a[124:127], v[108:111]
  ds_read_b64_tr_b16 a[180:181], v8 offset:8192
  v_mfma_f32_16x16x32_bf16 v[108:111], a[176:179], a[108:111], v[108:111]
  s_waitcnt lgkmcnt(5)
  s_cmp_eq_u32 s56, 1
  s_cselect_b32 s77, 9, 5
  s_mul_i32 s69, s77, 458752
  s_lshl_b32 s77, s77, 11
  s_add_u32 s77, s77, s57
  s_add_u32 m0, s45, 114688
  v_mfma_f32_16x16x32_bf16 v[124:127], a[164:167], a[108:111], v[124:127]
  ds_read_b64_tr_b16 a[182:183], v8 offset:10240
  v_mfma_f32_16x16x32_bf16 v[124:127], a[160:163], a[124:127], v[124:127]
  buffer_load_dwordx4 v11, s[28:31], s69 offen lds
  v_mfma_f32_16x16x32_bf16 v[120:123], a[160:163], a[120:123], v[120:123]
  ds_read_b64_tr_b16 a[176:177], v8 offset:12288
  v_mfma_f32_16x16x32_bf16 v[120:123], a[164:167], a[104:107], v[120:123]
  v_mfma_f32_16x16x32_bf16 v[116:119], a[164:167], a[100:103], v[116:119]
  ds_read_b64_tr_b16 a[178:179], v8 offset:14336
  v_mfma_f32_16x16x32_bf16 v[116:119], a[160:163], a[116:119], v[116:119]
  s_add_u32 m0, s45, 122880
  v_mfma_f32_16x16x32_bf16 v[112:115], a[160:163], a[112:115], v[112:115]
  ds_read_b64_tr_b16 a[160:161], v2 offset:0
  v_mfma_f32_16x16x32_bf16 v[112:115], a[164:167], a[96:99], v[112:115]
  s_waitcnt lgkmcnt(5)
  buffer_load_dwordx4 v11, s[32:35], s69 offen lds
  v_mfma_f32_16x16x32_bf16 v[32:35], a[172:175], a[96:99], v[32:35]
  ds_read_b64_tr_b16 a[162:163], v2 offset:2048
  v_mfma_f32_16x16x32_bf16 v[32:35], a[168:171], a[112:115], v[32:35]
  s_add_u32 m0, s45, 118784
  s_add_u32 s61, s69, 229376
  v_mfma_f32_16x16x32_bf16 v[36:39], a[168:171], a[116:119], v[36:39]
  ds_read_b64_tr_b16 a[164:165], v2 offset:4096
  v_mfma_f32_16x16x32_bf16 v[36:39], a[172:175], a[100:103], v[36:39]
  buffer_load_dwordx4 v11, s[28:31], s61 offen lds
  v_mfma_f32_16x16x32_bf16 v[40:43], a[172:175], a[104:107], v[40:43]
  ds_read_b64_tr_b16 a[166:167], v2 offset:6144
  v_mfma_f32_16x16x32_bf16 v[40:43], a[168:171], a[120:123], v[40:43]
  v_mfma_f32_16x16x32_bf16 v[44:47], a[168:171], a[124:127], v[44:47]
  ds_read_b64_tr_b16 a[168:169], v2 offset:8192
  v_mfma_f32_16x16x32_bf16 v[44:47], a[172:175], a[108:111], v[44:47]
  s_waitcnt lgkmcnt(5)
  s_add_u32 m0, s45, 126976
  s_add_u32 s61, s69, 229376
  v_mfma_f32_16x16x32_bf16 v[60:63], a[180:183], a[108:111], v[60:63]
  ds_read_b64_tr_b16 a[170:171], v2 offset:10240
  v_mfma_f32_16x16x32_bf16 v[60:63], a[176:179], a[124:127], v[60:63]
  buffer_load_dwordx4 v11, s[32:35], s61 offen lds
  ds_read_b128 v[24:27], v14 offset:32
  v_mfma_f32_16x16x32_bf16 v[56:59], a[176:179], a[120:123], v[56:59]
  ds_read_b64_tr_b16 a[172:173], v2 offset:12288
  v_mfma_f32_16x16x32_bf16 v[56:59], a[180:183], a[104:107], v[56:59]
  s_add_u32 m0, s45, 49152
  v_mfma_f32_16x16x32_bf16 v[52:55], a[180:183], a[100:103], v[52:55]
  ds_read_b64_tr_b16 a[174:175], v2 offset:14336
  v_mfma_f32_16x16x32_bf16 v[52:55], a[176:179], a[116:119], v[52:55]
  buffer_load_dwordx4 v10, s[28:31], s69 offen lds
  v_mfma_f32_16x16x32_bf16 v[48:51], a[176:179], a[112:115], v[48:51]
  ds_read_b64_tr_b16 a[176:177], v3 offset:0
  v_mfma_f32_16x16x32_bf16 v[48:51], a[180:183], a[96:99], v[48:51]
  s_waitcnt lgkmcnt(6)
  s_waitcnt vmcnt(13) lgkmcnt(3)
  v_cndmask_b32 v28, 0, v24, s[16:17]
  v_mfma_f32_16x16x32_bf16 v[128:131], a[160:163], a[96:99], v[128:131]
  ds_read_b64_tr_b16 a[178:179], v3 offset:2048
  v_cndmask_b32 v29, 0, v24, s[18:19]
  v_mfma_f32_16x16x32_bf16 v[128:131], a[164:167], a[112:115], v[128:131]
  s_add_u32 m0, s45, 57344
  v_cndmask_b32 v30, 0, v24, s[20:21]
  v_cndmask_b32 v31, 0, v24, s[22:23]
  v_mfma_f32_16x16x32_bf16 v[132:135], a[164:167], a[116:119], v[132:135]
  ds_read_b64_tr_b16 a[180:181], v3 offset:4096
  v_mfma_f32_16x16x32_bf16 a[184:187], v[28:31], a[220:223], a[184:187]
  v_cndmask_b32 v28, 0, v25, s[16:17]
  v_cndmask_b32 v29, 0, v25, s[18:19]
  v_mfma_f32_16x16x32_bf16 v[132:135], a[160:163], a[100:103], v[132:135]
  buffer_load_dwordx4 v10, s[32:35], s69 offen lds
  v_cndmask_b32 v30, 0, v25, s[20:21]
  v_cndmask_b32 v31, 0, v25, s[22:23]
  v_mfma_f32_16x16x32_bf16 v[136:139], a[160:163], a[104:107], v[136:139]
  ds_read_b64_tr_b16 a[182:183], v3 offset:6144
  v_mfma_f32_16x16x32_bf16 a[184:187], v[28:31], a[224:227], a[184:187]
  v_cndmask_b32 v28, 0, v26, s[16:17]
  v_cndmask_b32 v29, 0, v26, s[18:19]
  v_mfma_f32_16x16x32_bf16 v[136:139], a[164:167], a[120:123], v[136:139]
  s_add_u32 m0, s45, 53248
  s_add_u32 s61, s69, 229376
  v_cndmask_b32 v30, 0, v26, s[20:21]
  v_mfma_f32_16x16x32_bf16 v[140:143], a[164:167], a[124:127], v[140:143]
  ds_read_b64_tr_b16 a[164:165], v3 offset:8192
  v_cndmask_b32 v31, 0, v26, s[22:23]
  v_mfma_f32_16x16x32_bf16 v[140:143], a[160:163], a[108:111], v[140:143]
  s_waitcnt lgkmcnt(5)
  buffer_load_dwordx4 v10, s[28:31], s61 offen lds
  v_mfma_f32_16x16x32_bf16 a[184:187], v[28:31], a[228:231], a[184:187]
  v_cndmask_b32 v28, 0, v27, s[16:17]
  v_cndmask_b32 v29, 0, v27, s[18:19]
  v_mfma_f32_16x16x32_bf16 v[156:159], a[168:171], a[108:111], v[156:159]
  ds_read_b64_tr_b16 a[166:167], v3 offset:10240
  v_cndmask_b32 v30, 0, v27, s[20:21]
  v_mfma_f32_16x16x32_bf16 v[156:159], a[172:175], a[124:127], v[156:159]
  v_cndmask_b32 v31, 0, v27, s[22:23]
  v_mfma_f32_16x16x32_bf16 v[152:155], a[172:175], a[120:123], v[152:155]
  ds_read_b64_tr_b16 a[160:161], v3 offset:12288
  v_mfma_f32_16x16x32_bf16 a[184:187], v[28:31], a[232:235], a[184:187]
  v_mfma_f32_16x16x32_bf16 v[152:155], a[168:171], a[104:107], v[152:155]
  s_add_u32 m0, s45, 61440
  s_add_u32 s61, s69, 229376
  v_mfma_f32_16x16x32_bf16 v[148:151], a[168:171], a[100:103], v[148:151]
  ds_read_b64_tr_b16 a[162:163], v3 offset:14336
  v_mfma_f32_16x16x32_bf16 v[148:151], a[172:175], a[116:119], v[148:151]
  buffer_load_dwordx4 v10, s[32:35], s61 offen lds
  v_mfma_f32_16x16x32_bf16 v[144:147], a[172:175], a[112:115], v[144:147]
  ds_read_b64_tr_b16 a[172:173], v4 offset:0
  v_mfma_f32_16x16x32_bf16 v[144:147], a[168:171], a[96:99], v[144:147]
  s_waitcnt lgkmcnt(5)
  s_mov_b32 s62, 86016
  v_mfma_f32_16x16x32_bf16 v[160:163], a[176:179], a[96:99], v[160:163]
  ds_read_b64_tr_b16 a[174:175], v4 offset:2048
  v_mfma_f32_16x16x32_bf16 v[160:163], a[180:183], a[112:115], v[160:163]
  buffer_load_dwordx4 a[236:239], v13, s[12:15], s62 offen
  s_mov_b32 s62, 93184
  v_mfma_f32_16x16x32_bf16 v[164:167], a[180:183], a[116:119], v[164:167]
  ds_read_b64_tr_b16 a[168:169], v4 offset:4096
  v_mfma_f32_16x16x32_bf16 v[164:167], a[176:179], a[100:103], v[164:167]
  buffer_load_dwordx4 a[240:243], v13, s[12:15], s62 offen
  s_mov_b32 s62, 100352
  v_mfma_f32_16x16x32_bf16 v[168:171], a[176:179], a[104:107], v[168:171]
  ds_read_b64_tr_b16 a[170:171], v4 offset:6144
  v_mfma_f32_16x16x32_bf16 v[168:171], a[180:183], a[120:123], v[168:171]
  buffer_load_dwordx4 a[244:247], v13, s[12:15], s62 offen
  s_mov_b32 s62, 107520
  v_mfma_f32_16x16x32_bf16 v[172:175], a[180:183], a[124:127], v[172:175]
  ds_read_b64_tr_b16 a[180:181], v4 offset:8192
  v_mfma_f32_16x16x32_bf16 v[172:175], a[176:179], a[108:111], v[172:175]
  s_waitcnt lgkmcnt(5)
  buffer_load_dwordx4 a[248:251], v13, s[12:15], s62 offen
  v_mfma_f32_16x16x32_bf16 v[188:191], a[164:167], a[108:111], v[188:191]
  ds_read_b64_tr_b16 a[182:183], v4 offset:10240
  v_mfma_f32_16x16x32_bf16 v[188:191], a[160:163], a[124:127], v[188:191]
  v_mfma_f32_16x16x32_bf16 v[184:187], a[160:163], a[120:123], v[184:187]
  ds_read_b64_tr_b16 a[176:177], v4 offset:12288
  v_mfma_f32_16x16x32_bf16 v[184:187], a[164:167], a[104:107], v[184:187]
  v_mfma_f32_16x16x32_bf16 v[180:183], a[164:167], a[100:103], v[180:183]
  ds_read_b64_tr_b16 a[178:179], v4 offset:14336
  v_mfma_f32_16x16x32_bf16 v[180:183], a[160:163], a[116:119], v[180:183]
  v_mfma_f32_16x16x32_bf16 v[176:179], a[160:163], a[112:115], v[176:179]
  ds_read_b64_tr_b16 a[160:161], v5 offset:0
  v_mfma_f32_16x16x32_bf16 v[176:179], a[164:167], a[96:99], v[176:179]
  s_waitcnt lgkmcnt(5)
  v_mfma_f32_16x16x32_bf16 v[192:195], a[172:175], a[96:99], v[192:195]
  ds_read_b64_tr_b16 a[162:163], v5 offset:2048
  v_mfma_f32_16x16x32_bf16 v[192:195], a[168:171], a[112:115], v[192:195]
  v_mfma_f32_16x16x32_bf16 v[196:199], a[168:171], a[116:119], v[196:199]
  ds_read_b64_tr_b16 a[164:165], v5 offset:4096
  v_mfma_f32_16x16x32_bf16 v[196:199], a[172:175], a[100:103], v[196:199]
  v_mfma_f32_16x16x32_bf16 v[200:203], a[172:175], a[104:107], v[200:203]
  ds_read_b64_tr_b16 a[166:167], v5 offset:6144
  v_mfma_f32_16x16x32_bf16 v[200:203], a[168:171], a[120:123], v[200:203]
  v_mfma_f32_16x16x32_bf16 v[204:207], a[168:171], a[124:127], v[204:207]
  ds_read_b64_tr_b16 a[168:169], v5 offset:8192
  v_mfma_f32_16x16x32_bf16 v[204:207], a[172:175], a[108:111], v[204:207]
  s_waitcnt lgkmcnt(5)
  v_mfma_f32_16x16x32_bf16 v[220:223], a[180:183], a[108:111], v[220:223]
  ds_read_b64_tr_b16 a[170:171], v5 offset:10240
  v_mfma_f32_16x16x32_bf16 v[220:223], a[176:179], a[124:127], v[220:223]
  v_mfma_f32_16x16x32_bf16 v[216:219], a[176:179], a[120:123], v[216:219]
  ds_read_b64_tr_b16 a[172:173], v5 offset:12288
  v_mfma_f32_16x16x32_bf16 v[216:219], a[180:183], a[104:107], v[216:219]
  v_mfma_f32_16x16x32_bf16 v[212:215], a[180:183], a[100:103], v[212:215]
  ds_read_b64_tr_b16 a[174:175], v5 offset:14336
  v_mfma_f32_16x16x32_bf16 v[212:215], a[176:179], a[116:119], v[212:215]
  s_waitcnt vmcnt(24)
  s_barrier
  v_mfma_f32_16x16x32_bf16 v[208:211], a[176:179], a[112:115], v[208:211]
  ds_read_b64_tr_b16 a[176:177], v6 offset:32768
  v_mfma_f32_16x16x32_bf16 v[208:211], a[180:183], a[96:99], v[208:211]
  s_waitcnt lgkmcnt(5)
  v_mfma_f32_16x16x32_bf16 v[224:227], a[160:163], a[96:99], v[224:227]
  ds_read_b64_tr_b16 a[178:179], v6 offset:34816
  v_mfma_f32_16x16x32_bf16 v[224:227], a[164:167], a[112:115], v[224:227]
  v_mfma_f32_16x16x32_bf16 v[228:231], a[164:167], a[116:119], v[228:231]
  ds_read_b64_tr_b16 a[180:181], v6 offset:36864
  v_mfma_f32_16x16x32_bf16 v[228:231], a[160:163], a[100:103], v[228:231]
  s_add_u32 s62, s63, 8192
  v_mfma_f32_16x16x32_bf16 v[232:235], a[160:163], a[104:107], v[232:235]
  ds_read_b64_tr_b16 a[182:183], v6 offset:38912
  v_mfma_f32_16x16x32_bf16 v[232:235], a[164:167], a[120:123], v[232:235]
  buffer_load_dwordx4 a[188:191], v12, s[8:11], s62 offen offset:0 sc1
  v_mfma_f32_16x16x32_bf16 v[236:239], a[164:167], a[124:127], v[236:239]
  ds_read_b64_tr_b16 a[164:165], v6 offset:40960
  v_mfma_f32_16x16x32_bf16 v[236:239], a[160:163], a[108:111], v[236:239]
  s_waitcnt lgkmcnt(5)
  v_mfma_f32_16x16x32_bf16 v[252:255], a[168:171], a[108:111], v[252:255]
  ds_read_b64_tr_b16 a[166:167], v6 offset:43008
  v_mfma_f32_16x16x32_bf16 v[252:255], a[172:175], a[124:127], v[252:255]
  s_add_u32 s62, s63, 8192
  v_mfma_f32_16x16x32_bf16 v[248:251], a[172:175], a[120:123], v[248:251]
  ds_read_b64_tr_b16 a[160:161], v6 offset:45056
  v_mfma_f32_16x16x32_bf16 v[248:251], a[168:171], a[104:107], v[248:251]
  buffer_load_dwordx4 a[192:195], v12, s[8:11], s62 offen offset:256 sc1
  v_mfma_f32_16x16x32_bf16 v[244:247], a[168:171], a[100:103], v[244:247]
  ds_read_b64_tr_b16 a[162:163], v6 offset:47104
  v_mfma_f32_16x16x32_bf16 v[244:247], a[172:175], a[116:119], v[244:247]
  s_add_u32 s62, s63, 10240
  v_mfma_f32_16x16x32_bf16 v[240:243], a[172:175], a[112:115], v[240:243]
  ds_read_b64_tr_b16 a[172:173], v7 offset:32768
  v_mfma_f32_16x16x32_bf16 v[240:243], a[168:171], a[96:99], v[240:243]
  s_waitcnt vmcnt(14) lgkmcnt(5)
  buffer_load_dwordx4 a[196:199], v12, s[8:11], s62 offen offset:0 sc1
  v_mfma_f32_16x16x32_bf16 v[64:67], a[176:179], a[128:131], v[64:67]
  ds_read_b64_tr_b16 a[174:175], v7 offset:34816
  v_mfma_f32_16x16x32_bf16 v[64:67], a[180:183], a[144:147], v[64:67]
  v_mfma_f32_16x16x32_bf16 v[68:71], a[180:183], a[148:151], v[68:71]
  ds_read_b64_tr_b16 a[168:169], v7 offset:36864
  v_mfma_f32_16x16x32_bf16 v[68:71], a[176:179], a[132:135], v[68:71]
  s_add_u32 s62, s63, 10240
  v_mfma_f32_16x16x32_bf16 v[72:75], a[176:179], a[136:139], v[72:75]
  ds_read_b64_tr_b16 a[170:171], v7 offset:38912
  v_mfma_f32_16x16x32_bf16 v[72:75], a[180:183], a[152:155], v[72:75]
  buffer_load_dwordx4 a[200:203], v12, s[8:11], s62 offen offset:256 sc1
  v_mfma_f32_16x16x32_bf16 v[76:79], a[180:183], a[156:159], v[76:79]
  ds_read_b64_tr_b16 a[180:181], v7 offset:40960
  v_mfma_f32_16x16x32_bf16 v[76:79], a[176:179], a[140:143], v[76:79]
  s_waitcnt lgkmcnt(5)
  s_add_u32 s62, s63, 12288
  v_mfma_f32_16x16x32_bf16 v[92:95], a[164:167], a[140:143], v[92:95]
  ds_read_b64_tr_b16 a[182:183], v7 offset:43008
  v_mfma_f32_16x16x32_bf16 v[92:95], a[160:163], a[156:159], v[92:95]
  buffer_load_dwordx4 a[204:207], v12, s[8:11], s62 offen offset:0 sc1
  v_mfma_f32_16x16x32_bf16 v[88:91], a[160:163], a[152:155], v[88:91]
  ds_read_b64_tr_b16 a[176:177], v7 offset:45056
  v_mfma_f32_16x16x32_bf16 v[88:91], a[164:167], a[136:139], v[88:91]
  v_mfma_f32_16x16x32_bf16 v[84:87], a[164:167], a[132:135], v[84:87]
  ds_read_b64_tr_b16 a[178:179], v7 offset:47104
  v_mfma_f32_16x16x32_bf16 v[84:87], a[160:163], a[148:151], v[84:87]
  s_add_u32 s62, s63, 12288
  v_mfma_f32_16x16x32_bf16 v[80:83], a[160:163], a[144:147], v[80:83]
  ds_read_b64_tr_b16 a[160:161], v8 offset:32768
  v_mfma_f32_16x16x32_bf16 v[80:83], a[164:167], a[128:131], v[80:83]
  s_waitcnt lgkmcnt(5)
  buffer_load_dwordx4 a[208:211], v12, s[8:11], s62 offen offset:256 sc1
  v_mfma_f32_16x16x32_bf16 v[96:99], a[172:175], a[128:131], v[96:99]
  ds_read_b64_tr_b16 a[162:163], v8 offset:34816
  v_mfma_f32_16x16x32_bf16 v[96:99], a[168:171], a[144:147], v[96:99]
  s_add_u32 s62, s63, 14336
  v_mfma_f32_16x16x32_bf16 v[100:103], a[168:171], a[148:151], v[100:103]
  ds_read_b64_tr_b16 a[164:165], v8 offset:36864
  v_mfma_f32_16x16x32_bf16 v[100:103], a[172:175], a[132:135], v[100:103]
  buffer_load_dwordx4 a[212:215], v12, s[8:11], s62 offen offset:0 sc1
  v_mfma_f32_16x16x32_bf16 v[104:107], a[172:175], a[136:139], v[104:107]
  ds_read_b64_tr_b16 a[166:167], v8 offset:38912
  v_mfma_f32_16x16x32_bf16 v[104:107], a[168:171], a[152:155], v[104:107]
  v_mfma_f32_16x16x32_bf16 v[108:111], a[168:171], a[156:159], v[108:111]
  ds_read_b64_tr_b16 a[168:169], v8 offset:40960
  v_mfma_f32_16x16x32_bf16 v[108:111], a[172:175], a[140:143], v[108:111]
  s_waitcnt lgkmcnt(5)
  s_add_u32 s62, s63, 14336
  v_mfma_f32_16x16x32_bf16 v[124:127], a[180:183], a[140:143], v[124:127]
  ds_read_b64_tr_b16 a[170:171], v8 offset:43008
  v_mfma_f32_16x16x32_bf16 v[124:127], a[176:179], a[156:159], v[124:127]
  buffer_load_dwordx4 a[216:219], v12, s[8:11], s62 offen offset:256 sc1
  v_mfma_f32_16x16x32_bf16 v[120:123], a[176:179], a[152:155], v[120:123]
  ds_read_b64_tr_b16 a[172:173], v8 offset:45056
  v_mfma_f32_16x16x32_bf16 v[120:123], a[180:183], a[136:139], v[120:123]
  v_mfma_f32_16x16x32_bf16 v[116:119], a[180:183], a[132:135], v[116:119]
  ds_read_b64_tr_b16 a[174:175], v8 offset:47104
  v_mfma_f32_16x16x32_bf16 v[116:119], a[176:179], a[148:151], v[116:119]
  buffer_load_dwordx4 a[0:3], v1, s[8:11], s77 offen offset:0 sc1
  v_mfma_f32_16x16x32_bf16 v[112:115], a[176:179], a[144:147], v[112:115]
  ds_read_b64_tr_b16 a[176:177], v2 offset:32768
  v_mfma_f32_16x16x32_bf16 v[112:115], a[180:183], a[128:131], v[112:115]
  s_waitcnt lgkmcnt(5)
  v_mfma_f32_16x16x32_bf16 v[32:35], a[160:163], a[128:131], v[32:35]
  ds_read_b64_tr_b16 a[178:179], v2 offset:34816
  v_mfma_f32_16x16x32_bf16 v[32:35], a[164:167], a[144:147], v[32:35]
  ds_read_b128 v[24:27], v14 offset:48
  v_mfma_f32_16x16x32_bf16 v[36:39], a[164:167], a[148:151], v[36:39]
  ds_read_b64_tr_b16 a[180:181], v2 offset:36864
  v_mfma_f32_16x16x32_bf16 v[36:39], a[160:163], a[132:135], v[36:39]
  buffer_load_dwordx4 a[16:19], v1, s[8:11], s77 offen offset:1024 sc1
  v_mfma_f32_16x16x32_bf16 v[40:43], a[160:163], a[136:139], v[40:43]
  ds_read_b64_tr_b16 a[182:183], v2 offset:38912
  v_mfma_f32_16x16x32_bf16 v[40:43], a[164:167], a[152:155], v[40:43]
  s_add_u32 s77, s77, 65536
  v_mfma_f32_16x16x32_bf16 v[44:47], a[164:167], a[156:159], v[44:47]
  ds_read_b64_tr_b16 a[164:165], v2 offset:40960
  v_mfma_f32_16x16x32_bf16 v[44:47], a[160:163], a[140:143], v[44:47]
  s_waitcnt lgkmcnt(6)
  buffer_load_dwordx4 a[4:7], v1, s[8:11], s77 offen offset:0 sc1
  s_waitcnt vmcnt(11) lgkmcnt(3)
  v_mfma_f32_16x16x32_bf16 v[60:63], a[168:171], a[140:143], v[60:63]
  ds_read_b64_tr_b16 a[166:167], v2 offset:43008
  v_cndmask_b32 v28, 0, v24, s[16:17]
  v_mfma_f32_16x16x32_bf16 v[60:63], a[172:175], a[156:159], v[60:63]
  v_cndmask_b32 v29, 0, v24, s[18:19]
  v_cndmask_b32 v30, 0, v24, s[20:21]
  v_mfma_f32_16x16x32_bf16 v[56:59], a[172:175], a[152:155], v[56:59]
  ds_read_b64_tr_b16 a[160:161], v2 offset:45056
  v_cndmask_b32 v31, 0, v24, s[22:23]
  v_mfma_f32_16x16x32_bf16 v[56:59], a[168:171], a[136:139], v[56:59]
  s_nop 0
  v_mfma_f32_16x16x32_bf16 a[184:187], v[28:31], a[236:239], a[184:187]
  v_cndmask_b32 v28, 0, v25, s[16:17]
  v_cndmask_b32 v29, 0, v25, s[18:19]
  v_mfma_f32_16x16x32_bf16 v[52:55], a[168:171], a[132:135], v[52:55]
  ds_read_b64_tr_b16 a[162:163], v2 offset:47104
  v_cndmask_b32 v30, 0, v25, s[20:21]
  v_mfma_f32_16x16x32_bf16 v[52:55], a[172:175], a[148:151], v[52:55]
  buffer_load_dwordx4 a[20:23], v1, s[8:11], s77 offen offset:1024 sc1
  v_cndmask_b32 v31, 0, v25, s[22:23]
  v_mfma_f32_16x16x32_bf16 v[48:51], a[172:175], a[144:147], v[48:51]
  ds_read_b64_tr_b16 a[172:173], v3 offset:32768
  v_mfma_f32_16x16x32_bf16 a[184:187], v[28:31], a[240:243], a[184:187]
  v_cndmask_b32 v28, 0, v26, s[16:17]
  v_cndmask_b32 v29, 0, v26, s[18:19]
  v_mfma_f32_16x16x32_bf16 v[48:51], a[168:171], a[128:131], v[48:51]
  s_waitcnt lgkmcnt(5)
  s_add_u32 s77, s77, 65536
  v_cndmask_b32 v30, 0, v26, s[20:21]
  v_mfma_f32_16x16x32_bf16 v[128:131], a[176:179], a[128:131], v[128:131]
  ds_read_b64_tr_b16 a[174:175], v3 offset:34816
  v_cndmask_b32 v31, 0, v26, s[22:23]
  v_mfma_f32_16x16x32_bf16 v[128:131], a[180:183], a[144:147], v[128:131]
  buffer_load_dwordx4 a[8:11], v1, s[8:11], s77 offen offset:0 sc1
  v_mfma_f32_16x16x32_bf16 a[184:187], v[28:31], a[244:247], a[184:187]
  v_cndmask_b32 v28, 0, v27, s[16:17]
  v_cndmask_b32 v29, 0, v27, s[18:19]
  v_mfma_f32_16x16x32_bf16 v[132:135], a[180:183], a[148:151], v[132:135]
  ds_read_b64_tr_b16 a[168:169], v3 offset:36864
  v_cndmask_b32 v30, 0, v27, s[20:21]
  v_mfma_f32_16x16x32_bf16 v[132:135], a[176:179], a[132:135], v[132:135]
  v_cndmask_b32 v31, 0, v27, s[22:23]
  v_mfma_f32_16x16x32_bf16 v[136:139], a[176:179], a[136:139], v[136:139]
  ds_read_b64_tr_b16 a[170:171], v3 offset:38912
  v_mfma_f32_16x16x32_bf16 a[184:187], v[28:31], a[248:251], a[184:187]
  v_mfma_f32_16x16x32_bf16 v[136:139], a[180:183], a[152:155], v[136:139]
  v_mfma_f32_16x16x32_bf16 v[140:143], a[180:183], a[156:159], v[140:143]
  ds_read_b64_tr_b16 a[180:181], v3 offset:40960
  v_mfma_f32_16x16x32_bf16 v[140:143], a[176:179], a[140:143], v[140:143]
  s_waitcnt lgkmcnt(5)
  buffer_load_dwordx4 a[24:27], v1, s[8:11], s77 offen offset:1024 sc1
  v_mfma_f32_16x16x32_bf16 v[156:159], a[164:167], a[140:143], v[156:159]
  ds_read_b64_tr_b16 a[182:183], v3 offset:43008
  s_bfe_u32 s53, s2, 0x20004
  v_mfma_f32_16x16x32_bf16 v[156:159], a[160:163], a[156:159], v[156:159]
  s_add_u32 s77, s77, 65536
  s_lshl_b32 s53, s53, 9
  v_and_b32 v14, 15, v0
  v_mfma_f32_16x16x32_bf16 v[152:155], a[160:163], a[152:155], v[152:155]
  ds_read_b64_tr_b16 a[176:177], v3 offset:45056
  v_lshl_add_u32 v14, v14, 5, s53
  v_mfma_f32_16x16x32_bf16 v[152:155], a[164:167], a[136:139], v[152:155]
  buffer_load_dwordx4 a[12:15], v1, s[8:11], s77 offen offset:0 sc1
  v_cmp_gt_u32 vcc, 1792, v14
  v_mov_b32 v15, 134217728
  v_bfe_u32 v13, v0, 4, 1
  v_cndmask_b32 v14, v15, v14, vcc
  v_mfma_f32_16x16x32_bf16 v[148:151], a[164:167], a[132:135], v[148:151]
  ds_read_b64_tr_b16 a[178:179], v3 offset:47104
  v_lshl_add_u32 v14, v13, 4, v14
  v_mfma_f32_16x16x32_bf16 v[148:151], a[160:163], a[148:151], v[148:151]
  v_lshrrev_b32 v13, 5, v0
  v_mul_u32_u24 v13, 14336, v13
  v_mfma_f32_16x16x32_bf16 v[144:147], a[160:163], a[144:147], v[144:147]
  ds_read_b64_tr_b16 a[160:161], v4 offset:32768
  v_add_u32 v14, v14, v13
  v_mfma_f32_16x16x32_bf16 v[144:147], a[164:167], a[128:131], v[144:147]
  s_waitcnt lgkmcnt(5)
  s_lshr_b32 s53, s2, 6
  s_lshl_b32 s53, s53, 2
  v_mfma_f32_16x16x32_bf16 v[160:163], a[172:175], a[128:131], v[160:163]
  ds_read_b64_tr_b16 a[162:163], v4 offset:34816
  s_add_u32 s53, s53, s44
  v_mfma_f32_16x16x32_bf16 v[160:163], a[168:171], a[144:147], v[160:163]
  buffer_load_dwordx4 a[28:31], v1, s[8:11], s77 offen offset:1024 sc1
  s_lshl_b32 s53, s53, 1
  s_bfe_u32 s54, s2, 0x10003
  v_mfma_f32_16x16x32_bf16 v[164:167], a[168:171], a[148:151], v[164:167]
  ds_read_b64_tr_b16 a[164:165], v4 offset:36864
  s_add_u32 s53, s53, s54
  v_mfma_f32_16x16x32_bf16 v[164:167], a[172:175], a[132:135], v[164:167]
  s_cmp_eq_u32 s56, 2
  s_cselect_b32 s78, 10, 6
  s_mul_i32 s70, s78, 458752
  s_lshl_b32 s78, s78, 11
  s_add_u32 s78, s78, s57
  s_add_u32 m0, s45, 81920
  s_mul_i32 s53, s53, 28672
  s_mul_i32 s54, s52, 1792
  v_mfma_f32_16x16x32_bf16 v[168:171], a[172:175], a[136:139], v[168:171]
  ds_read_b64_tr_b16 a[166:167], v4 offset:38912
  s_add_u32 s53, s53, s54
  v_mfma_f32_16x16x32_bf16 v[168:171], a[168:171], a[152:155], v[168:171]
  buffer_load_dwordx4 v11, s[28:31], s70 offen lds
  s_add_u32 s53, s53, 46137344
  v_mfma_f32_16x16x32_bf16 v[172:175], a[168:171], a[156:159], v[172:175]
  ds_read_b64_tr_b16 a[168:169], v4 offset:40960
  v_mfma_f32_16x16x32_bf16 v[172:175], a[172:175], a[140:143], v[172:175]
  s_waitcnt lgkmcnt(5)
  buffer_store_dwordx4 a[184:187], v14, s[8:11], s53 offen sc1
  v_mfma_f32_16x16x32_bf16 v[188:191], a[180:183], a[140:143], v[188:191]
  ds_read_b64_tr_b16 a[170:171], v4 offset:43008
  s_lshl_b32 s53, s52, 7
  v_mfma_f32_16x16x32_bf16 v[188:191], a[176:179], a[156:159], v[188:191]
  s_add_u32 m0, s45, 90112
  s_add_u32 s53, s53, 884736
  v_and_b32 v13, 31, v0
  v_mfma_f32_16x16x32_bf16 v[184:187], a[176:179], a[152:155], v[184:187]
  ds_read_b64_tr_b16 a[172:173], v4 offset:45056
  v_min_u32 v15, 27, v13
  v_mfma_f32_16x16x32_bf16 v[184:187], a[180:183], a[136:139], v[184:187]
  buffer_load_dwordx4 v11, s[32:35], s70 offen lds
  v_lshl_add_u32 v13, v13, 10, s53
  v_lshlrev_b32 v15, 4, v15
  v_mfma_f32_16x16x32_bf16 v[180:183], a[180:183], a[132:135], v[180:183]
  ds_read_b64_tr_b16 a[174:175], v4 offset:47104
  s_lshl_b32 s53, s51, 9
  v_mfma_f32_16x16x32_bf16 v[180:183], a[176:179], a[148:151], v[180:183]
  s_add_u32 m0, s45, 86016
  s_add_u32 s61, s70, 229376
  v_mov_b32 v14, s53
  v_mfma_f32_16x16x32_bf16 v[176:179], a[176:179], a[144:147], v[176:179]
  ds_read_b64_tr_b16 a[176:177], v5 offset:32768
  s_lshl_b32 s55, s51, 3
  v_mfma_f32_16x16x32_bf16 v[176:179], a[180:183], a[128:131], v[176:179]
  s_waitcnt lgkmcnt(5)
  buffer_load_dwordx4 v11, s[28:31], s61 offen lds
  s_lshr_b32 s53, 0x0b070602, s55
  v_mfma_f32_16x16x32_bf16 v[192:195], a[160:163], a[128:131], v[192:195]
  ds_read_b64_tr_b16 a[178:179], v5 offset:34816
  s_and_b32 s53, s53, 15
  v_mfma_f32_16x16x32_bf16 v[192:195], a[164:167], a[144:147], v[192:195]
  s_lshl_b32 s53, s53, 7
  s_sub_u32 s53, s53, 256
  v_mov_b32 v24, s53
  v_mfma_f32_16x16x32_bf16 v[196:199], a[164:167], a[148:151], v[196:199]
  ds_read_b64_tr_b16 a[180:181], v5 offset:36864
  v_mfma_f32_16x16x32_bf16 v[196:199], a[160:163], a[132:135], v[196:199]
  s_add_u32 m0, s45, 94208
  s_add_u32 s61, s70, 229376
  v_mfma_f32_16x16x32_bf16 v[200:203], a[160:163], a[136:139], v[200:203]
  ds_read_b64_tr_b16 a[182:183], v5 offset:38912
  v_mfma_f32_16x16x32_bf16 v[200:203], a[164:167], a[152:155], v[200:203]
  buffer_load_dwordx4 v11, s[32:35], s61 offen lds
  v_cmp_gt_u32 vcc, 256, v15
  s_nop 1
  v_cndmask_b32 v14, v24, v14, vcc
  v_mfma_f32_16x16x32_bf16 v[204:207], a[164:167], a[156:159], v[204:207]
  ds_read_b64_tr_b16 a[164:165], v5 offset:40960
  s_lshr_b32 s53, 0x15140706, s55
  v_mfma_f32_16x16x32_bf16 v[204:207], a[160:163], a[140:143], v[204:207]
  s_waitcnt lgkmcnt(5)
  s_add_u32 m0, s45, 16384
  s_and_b32 s53, s53, 31
  v_mfma_f32_16x16x32_bf16 v[220:223], a[168:171], a[140:143], v[220:223]
  ds_read_b64_tr_b16 a[166:167], v5 offset:43008
  s_lshl_b32 s53, s53, 6
  v_mfma_f32_16x16x32_bf16 v[220:223], a[172:175], a[156:159], v[220:223]
  buffer_load_dwordx4 v10, s[28:31], s70 offen lds
  s_sub_u32 s53, s53, 384
  v_mov_b32 v24, s53
  v_mfma_f32_16x16x32_bf16 v[216:219], a[172:175], a[152:155], v[216:219]
  ds_read_b64_tr_b16 a[160:161], v5 offset:45056
  v_mfma_f32_16x16x32_bf16 v[216:219], a[168:171], a[136:139], v[216:219]
  v_cmp_gt_u32 vcc, 384, v15
  s_nop 1
  v_cndmask_b32 v14, v24, v14, vcc
  v_mfma_f32_16x16x32_bf16 v[212:215], a[168:171], a[132:135], v[212:215]
  ds_read_b64_tr_b16 a[162:163], v5 offset:47104
  v_lshrrev_b32 v24, 5, v0
  v_mfma_f32_16x16x32_bf16 v[212:215], a[172:175], a[148:151], v[212:215]
  s_waitcnt vmcnt(26)
  s_barrier
  v_mfma_f32_16x16x32_bf16 v[208:211], a[172:175], a[144:147], v[208:211]
  ds_read_b64_tr_b16 a[172:173], v6 offset:49152
  s_add_u32 m0, s45, 24576
  v_mfma_f32_16x16x32_bf16 v[208:211], a[168:171], a[128:131], v[208:211]
  s_waitcnt lgkmcnt(5)
  buffer_load_dwordx4 v10, s[32:35], s70 offen lds
  v_mul_u32_u24 v24, 57344, v24
  v_mfma_f32_16x16x32_bf16 v[224:227], a[176:179], a[128:131], v[224:227]
  ds_read_b64_tr_b16 a[174:175], v6 offset:51200
  v_add3_u32 v14, v14, v15, v24
  v_mfma_f32_16x16x32_bf16 v[224:227], a[180:183], a[144:147], v[224:227]
  s_add_u32 m0, s45, 20480
  s_add_u32 s61, s70, 229376
HOP9:
  s_cbranch_execz HOP12
  s_mul_i32 s53, s44, 14336
  v_mfma_f32_16x16x32_bf16 v[228:231], a[180:183], a[148:151], v[228:231]
  ds_read_b64_tr_b16 a[168:169], v6 offset:53248
  s_add_u32 s53, s53, s54
  v_mfma_f32_16x16x32_bf16 v[228:231], a[176:179], a[132:135], v[228:231]
  buffer_load_dwordx4 v10, s[28:31], s61 offen lds
  s_add_u32 s53, s53, 46137344
  v_add_u32 v14, s53, v14
  v_mfma_f32_16x16x32_bf16 v[232:235], a[176:179], a[136:139], v[232:235]
  ds_read_b64_tr_b16 a[170:171], v6 offset:55296
  s_lshl_b32 s53, s44, 9
  v_mfma_f32_16x16x32_bf16 v[232:235], a[180:183], a[152:155], v[232:235]
  s_add_u32 s53, s53, 131072
  v_add_u32 v15, s53, v15
  v_mfma_f32_16x16x32_bf16 v[236:239], a[180:183], a[156:159], v[236:239]
  ds_read_b64_tr_b16 a[180:181], v6 offset:57344
  s_waitcnt vmcnt(16)
  v_mfma_f32_16x16x32_bf16 v[236:239], a[176:179], a[140:143], v[236:239]
  s_waitcnt lgkmcnt(5)
  s_add_u32 m0, s45, 28672
  s_add_u32 s61, s70, 229376
  v_mfma_f32_16x16x32_bf16 v[252:255], a[164:167], a[140:143], v[252:255]
  ds_read_b64_tr_b16 a[182:183], v6 offset:59392
  v_accvgpr_read_b32 v24, a188
  v_mfma_f32_16x16x32_bf16 v[252:255], a[160:163], a[156:159], v[252:255]
  buffer_load_dwordx4 v10, s[32:35], s61 offen lds
  v_accvgpr_read_b32 v25, a189
  v_accvgpr_read_b32 v26, a190
  v_mfma_f32_16x16x32_bf16 v[248:251], a[160:163], a[152:155], v[248:251]
  ds_read_b64_tr_b16 a[176:177], v6 offset:61440
  v_accvgpr_read_b32 v27, a191
  v_mfma_f32_16x16x32_bf16 v[248:251], a[164:167], a[136:139], v[248:251]
  v_accvgpr_read_b32 v28, a192
  v_accvgpr_read_b32 v29, a193
  v_mfma_f32_16x16x32_bf16 v[244:247], a[164:167], a[132:135], v[244:247]
  ds_read_b64_tr_b16 a[178:179], v6 offset:63488
  v_accvgpr_read_b32 v30, a194
  v_mfma_f32_16x16x32_bf16 v[244:247], a[160:163], a[148:151], v[244:247]
  buffer_load_dwordx4 a[32:35], v1, s[8:11], s78 offen offset:0 sc1
  v_accvgpr_read_b32 v31, a195
  v_add_f32 v16, v16, v24
  v_mfma_f32_16x16x32_bf16 v[240:243], a[160:163], a[144:147], v[240:243]
  ds_read_b64_tr_b16 a[160:161], v7 offset:49152
  v_add_f32 v17, v17, v25
  v_mfma_f32_16x16x32_bf16 v[240:243], a[164:167], a[128:131], v[240:243]
  s_waitcnt vmcnt(10) lgkmcnt(5)
  v_add_f32 v18, v18, v26
  v_add_f32 v19, v19, v27
  v_mfma_f32_16x16x32_bf16 v[64:67], a[172:175], a[0:3], v[64:67]
  ds_read_b64_tr_b16 a[162:163], v7 offset:51200
  v_add_f32 v20, v20, v28
  v_mfma_f32_16x16x32_bf16 v[64:67], a[168:171], a[16:19], v[64:67]
  v_add_f32 v21, v21, v29
  v_add_f32 v22, v22, v30
  v_mfma_f32_16x16x32_bf16 v[68:71], a[168:171], a[20:23], v[68:71]
  ds_read_b64_tr_b16 a[164:165], v7 offset:53248
  v_add_f32 v23, v23, v31
  v_mfma_f32_16x16x32_bf16 v[68:71], a[172:175], a[4:7], v[68:71]
  buffer_load_dwordx4 a[48:51], v1, s[8:11], s78 offen offset:1024 sc1
  v_accvgpr_read_b32 v24, a196
  v_accvgpr_read_b32 v25, a197
  v_mfma_f32_16x16x32_bf16 v[72:75], a[172:175], a[8:11], v[72:75]
  ds_read_b64_tr_b16 a[166:167], v7 offset:55296
  v_accvgpr_read_b32 v26, a198
  v_mfma_f32_16x16x32_bf16 v[72:75], a[168:171], a[24:27], v[72:75]
  s_add_u32 s78, s78, 65536
  v_accvgpr_read_b32 v27, a199
  v_accvgpr_read_b32 v28, a200
  v_mfma_f32_16x16x32_bf16 v[76:79], a[168:171], a[28:31], v[76:79]
  ds_read_b64_tr_b16 a[168:169], v7 offset:57344
  v_accvgpr_read_b32 v29, a201
  v_mfma_f32_16x16x32_bf16 v[76:79], a[172:175], a[12:15], v[76:79]
  s_waitcnt lgkmcnt(5)
  buffer_load_dwordx4 a[36:39], v1, s[8:11], s78 offen offset:0 sc1
  v_accvgpr_read_b32 v30, a202
  v_mfma_f32_16x16x32_bf16 v[92:95], a[180:183], a[12:15], v[92:95]
  ds_read_b64_tr_b16 a[170:171], v7 offset:59392
  v_accvgpr_read_b32 v31, a203
  v_mfma_f32_16x16x32_bf16 v[92:95], a[176:179], a[28:31], v[92:95]
  v_add_f32 v16, v16, v24
  v_add_f32 v17, v17, v25
  v_mfma_f32_16x16x32_bf16 v[88:91], a[176:179], a[24:27], v[88:91]
  ds_read_b64_tr_b16 a[172:173], v7 offset:61440
  v_add_f32 v18, v18, v26
  v_mfma_f32_16x16x32_bf16 v[88:91], a[180:183], a[8:11], v[88:91]
  v_add_f32 v19, v19, v27
  v_add_f32 v20, v20, v28
  v_mfma_f32_16x16x32_bf16 v[84:87], a[180:183], a[4:7], v[84:87]
  ds_read_b64_tr_b16 a[174:175], v7 offset:63488
  v_add_f32 v21, v21, v29
  v_mfma_f32_16x16x32_bf16 v[84:87], a[176:179], a[20:23], v[84:87]
  buffer_load_dwordx4 a[52:55], v1, s[8:11], s78 offen offset:1024 sc1
  v_add_f32 v22, v22, v30
  v_add_f32 v23, v23, v31
  v_mfma_f32_16x16x32_bf16 v[80:83], a[176:179], a[16:19], v[80:83]
  ds_read_b64_tr_b16 a[176:177], v8 offset:49152
  v_accvgpr_read_b32 v24, a204
  v_mfma_f32_16x16x32_bf16 v[80:83], a[180:183], a[0:3], v[80:83]
  s_waitcnt lgkmcnt(5)
  s_add_u32 s78, s78, 65536
  v_accvgpr_read_b32 v25, a205
  v_mfma_f32_16x16x32_bf16 v[96:99], a[160:163], a[0:3], v[96:99]
  ds_read_b64_tr_b16 a[178:179], v8 offset:51200
  v_accvgpr_read_b32 v26, a206
  v_mfma_f32_16x16x32_bf16 v[96:99], a[164:167], a[16:19], v[96:99]
  buffer_load_dwordx4 a[40:43], v1, s[8:11], s78 offen offset:0 sc1
  v_accvgpr_read_b32 v27, a207
  v_accvgpr_read_b32 v28, a208
  v_mfma_f32_16x16x32_bf16 v[100:103], a[164:167], a[20:23], v[100:103]
  ds_read_b64_tr_b16 a[180:181], v8 offset:53248
  v_accvgpr_read_b32 v29, a209
  v_mfma_f32_16x16x32_bf16 v[100:103], a[160:163], a[4:7], v[100:103]
  v_accvgpr_read_b32 v30, a210
  v_accvgpr_read_b32 v31, a211
  v_mfma_f32_16x16x32_bf16 v[104:107], a[160:163], a[8:11], v[104:107]
  ds_read_b64_tr_b16 a[182:183], v8 offset:55296
  v_add_u32 v9, s46, v0
  s_waitcnt vmcnt(12)
  s_barrier
  s_mov_b64 exec, 1
  buffer_store_dword v9, v0, s[8:11], s80 offen offset:0 sc1
  s_mov_b64 exec, -1
  s_sub_u32 s80, s80, 196608
  v_mfma_f32_16x16x32_bf16 v[104:107], a[164:167], a[24:27], v[104:107]
  v_add_f32 v16, v16, v24
  v_add_f32 v17, v17, v25
  v_mfma_f32_16x16x32_bf16 v[108:111], a[164:167], a[28:31], v[108:111]
  ds_read_b64_tr_b16 a[164:165], v8 offset:57344
  v_add_f32 v18, v18, v26
  v_mfma_f32_16x16x32_bf16 v[108:111], a[160:163], a[12:15], v[108:111]
  s_waitcnt lgkmcnt(5)
  buffer_load_dwordx4 a[56:59], v1, s[8:11], s78 offen offset:1024 sc1
  v_add_f32 v19, v19, v27
  v_mfma_f32_16x16x32_bf16 v[124:127], a[168:171], a[12:15], v[124:127]
  ds_read_b64_tr_b16 a[166:167], v8 offset:59392
  v_add_f32 v20, v20, v28
  v_mfma_f32_16x16x32_bf16 v[124:127], a[172:175], a[28:31], v[124:127]
  s_add_u32 s78, s78, 65536
  v_add_f32 v21, v21, v29
  v_add_f32 v22, v22, v30
  v_mfma_f32_16x16x32_bf16 v[120:123], a[172:175], a[24:27], v[120:123]
  ds_read_b64_tr_b16 a[160:161], v8 offset:61440
  v_add_f32 v23, v23, v31
  v_mfma_f32_16x16x32_bf16 v[120:123], a[168:171], a[8:11], v[120:123]
  buffer_load_dwordx4 a[44:47], v1, s[8:11], s78 offen offset:0 sc1
  v_accvgpr_read_b32 v24, a212
  v_accvgpr_read_b32 v25, a213
  v_mfma_f32_16x16x32_bf16 v[116:119], a[168:171], a[4:7], v[116:119]
  ds_read_b64_tr_b16 a[162:163], v8 offset:63488
  v_accvgpr_read_b32 v26, a214
  v_mfma_f32_16x16x32_bf16 v[116:119], a[172:175], a[20:23], v[116:119]
  v_accvgpr_read_b32 v27, a215
  v_accvgpr_read_b32 v28, a216
  v_mfma_f32_16x16x32_bf16 v[112:115], a[172:175], a[16:19], v[112:115]
  ds_read_b64_tr_b16 a[172:173], v2 offset:49152
  v_accvgpr_read_b32 v29, a217
  v_mfma_f32_16x16x32_bf16 v[112:115], a[168:171], a[0:3], v[112:115]
  s_waitcnt lgkmcnt(5)
  v_accvgpr_read_b32 v30, a218
  v_accvgpr_read_b32 v31, a219
  v_mfma_f32_16x16x32_bf16 v[32:35], a[176:179], a[0:3], v[32:35]
  ds_read_b64_tr_b16 a[174:175], v2 offset:51200
  v_add_f32 v16, v16, v24
  v_mfma_f32_16x16x32_bf16 v[32:35], a[180:183], a[16:19], v[32:35]
  buffer_load_dwordx4 a[60:63], v1, s[8:11], s78 offen offset:1024 sc1
  v_add_f32 v17, v17, v25
  v_add_f32 v18, v18, v26
  v_mfma_f32_16x16x32_bf16 v[36:39], a[180:183], a[20:23], v[36:39]
  ds_read_b64_tr_b16 a[168:169], v2 offset:53248
  v_add_f32 v19, v19, v27
  v_mfma_f32_16x16x32_bf16 v[36:39], a[176:179], a[4:7], v[36:39]
  s_cmp_eq_u32 s56, 3
  s_cselect_b32 s79, 11, 7
  s_mul_i32 s71, s79, 458752
  s_lshl_b32 s79, s79, 11
  s_add_u32 s79, s79, s57
  s_add_u32 m0, s45, 65536
  v_add_f32 v20, v20, v28
  v_add_f32 v21, v21, v29
  v_mfma_f32_16x16x32_bf16 v[40:43], a[176:179], a[8:11], v[40:43]
  ds_read_b64_tr_b16 a[170:171], v2 offset:55296
  v_add_f32 v22, v22, v30
  v_mfma_f32_16x16x32_bf16 v[40:43], a[180:183], a[24:27], v[40:43]
  buffer_load_dwordx4 v11, s[28:31], s71 offen lds
  v_add_f32 v23, v23, v31
  v_mov_b32 v24, v16
  v_mfma_f32_16x16x32_bf16 v[44:47], a[180:183], a[28:31], v[44:47]
  ds_read_b64_tr_b16 a[180:181], v2 offset:57344
  v_mov_b32 v25, v17
  v_mfma_f32_16x16x32_bf16 v[44:47], a[176:179], a[12:15], v[44:47]
  s_waitcnt lgkmcnt(5)
  v_mov_b32 v26, v18
  v_mov_b32 v27, v19
  v_mfma_f32_16x16x32_bf16 v[60:63], a[164:167], a[12:15], v[60:63]
  ds_read_b64_tr_b16 a[182:183], v2 offset:59392
  v_mov_b32 v28, v20
  v_mfma_f32_16x16x32_bf16 v[60:63], a[160:163], a[28:31], v[60:63]
  s_add_u32 m0, s45, 73728
  v_mov_b32 v29, v21
  v_mov_b32 v30, v22
  v_mfma_f32_16x16x32_bf16 v[56:59], a[160:163], a[24:27], v[56:59]
  ds_read_b64_tr_b16 a[176:177], v2 offset:61440
  v_mov_b32 v31, v23
  v_mfma_f32_16x16x32_bf16 v[56:59], a[164:167], a[8:11], v[56:59]
  buffer_load_dwordx4 v11, s[32:35], s71 offen lds
  v_permlane16_swap_b32 v16, v24
  v_mfma_f32_16x16x32_bf16 v[52:55], a[164:167], a[4:7], v[52:55]
  ds_read_b64_tr_b16 a[178:179], v2 offset:63488
  v_mfma_f32_16x16x32_bf16 v[52:55], a[160:163], a[20:23], v[52:55]
  s_add_u32 m0, s45, 69632
  s_add_u32 s61, s71, 229376
  v_mfma_f32_16x16x32_bf16 v[48:51], a[160:163], a[16:19], v[48:51]
  ds_read_b64_tr_b16 a[160:161], v3 offset:49152
  v_mfma_f32_16x16x32_bf16 v[48:51], a[164:167], a[0:3], v[48:51]
  s_waitcnt lgkmcnt(5)
  buffer_load_dwordx4 v11, s[28:31], s61 offen lds
  v_mfma_f32_16x16x32_bf16 v[128:131], a[172:175], a[0:3], v[128:131]
  ds_read_b64_tr_b16 a[162:163], v3 offset:51200
  v_permlane16_swap_b32 v17, v25
  v_mfma_f32_16x16x32_bf16 v[128:131], a[168:171], a[16:19], v[128:131]
  v_permlane16_swap_b32 v18, v26
  v_mfma_f32_16x16x32_bf16 v[132:135], a[168:171], a[20:23], v[132:135]
  ds_read_b64_tr_b16 a[164:165], v3 offset:53248
  v_mfma_f32_16x16x32_bf16 v[132:135], a[172:175], a[4:7], v[132:135]
  s_add_u32 m0, s45, 77824
  s_add_u32 s61, s71, 229376
  v_mfma_f32_16x16x32_bf16 v[136:139], a[172:175], a[8:11], v[136:139]
  ds_read_b64_tr_b16 a[166:167], v3 offset:55296
  v_mfma_f32_16x16x32_bf16 v[136:139], a[168:171], a[24:27], v[136:139]
  buffer_load_dwordx4 v11, s[32:35], s61 offen lds
  v_permlane16_swap_b32 v19, v27
  v_mfma_f32_16x16x32_bf16 v[140:143], a[168:171], a[28:31], v[140:143]
  ds_read_b64_tr_b16 a[168:169], v3 offset:57344
  v_mfma_f32_16x16x32_bf16 v[140:143], a[172:175], a[12:15], v[140:143]
  s_waitcnt lgkmcnt(5)
  s_add_u32 m0, s45, 0
  v_mfma_f32_16x16x32_bf16 v[156:159], a[180:183], a[12:15], v[156:159]
  ds_read_b64_tr_b16 a[170:171], v3 offset:59392
  v_mfma_f32_16x16x32_bf16 v[156:159], a[176:179], a[28:31], v[156:159]
  buffer_load_dwordx4 v10, s[28:31], s71 offen lds
  v_permlane16_swap_b32 v20, v28
  v_mfma_f32_16x16x32_bf16 v[152:155], a[176:179], a[24:27], v[152:155]
  ds_read_b64_tr_b16 a[172:173], v3 offset:61440
  v_mfma_f32_16x16x32_bf16 v[152:155], a[180:183], a[8:11], v[152:155]
  v_permlane16_swap_b32 v21, v29
  v_mfma_f32_16x16x32_bf16 v[148:151], a[180:183], a[4:7], v[148:151]
  ds_read_b64_tr_b16 a[174:175], v3 offset:63488
  v_mfma_f32_16x16x32_bf16 v[148:151], a[176:179], a[20:23], v[148:151]
  s_add_u32 m0, s45, 8192
  v_permlane16_swap_b32 v22, v30
  v_mfma_f32_16x16x32_bf16 v[144:147], a[176:179], a[16:19], v[144:147]
  ds_read_b64_tr_b16 a[176:177], v4 offset:49152
  v_mfma_f32_16x16x32_bf16 v[144:147], a[180:183], a[0:3], v[144:147]
  s_waitcnt lgkmcnt(5)
  buffer_load_dwordx4 v10, s[32:35], s71 offen lds
  v_mfma_f32_16x16x32_bf16 v[160:163], a[160:163], a[0:3], v[160:163]
  ds_read_b64_tr_b16 a[178:179], v4 offset:51200
  v_mfma_f32_16x16x32_bf16 v[160:163], a[164:167], a[16:19], v[160:163]
  s_add_u32 m0, s45, 4096
  s_add_u32 s61, s71, 229376
  v_mfma_f32_16x16x32_bf16 v[164:167], a[164:167], a[20:23], v[164:167]
  ds_read_b64_tr_b16 a[180:181], v4 offset:53248
  v_permlane16_swap_b32 v23, v31
  v_mfma_f32_16x16x32_bf16 v[164:167], a[160:163], a[4:7], v[164:167]
  buffer_load_dwordx4 v10, s[28:31], s61 offen lds
  v_add_f32 v16, v16, v24
  v_add_f32 v17, v17, v25
  v_mfma_f32_16x16x32_bf16 v[168:171], a[160:163], a[8:11], v[168:171]
  ds_read_b64_tr_b16 a[182:183], v4 offset:55296
  v_add_f32 v18, v18, v26
  v_mfma_f32_16x16x32_bf16 v[168:171], a[164:167], a[24:27], v[168:171]
  v_add_f32 v19, v19, v27
  v_add_f32 v20, v20, v28
  v_mfma_f32_16x16x32_bf16 v[172:175], a[164:167], a[28:31], v[172:175]
  ds_read_b64_tr_b16 a[164:165], v4 offset:57344
  v_add_f32 v21, v21, v29
  v_mfma_f32_16x16x32_bf16 v[172:175], a[160:163], a[12:15], v[172:175]
  s_waitcnt lgkmcnt(5)
  s_add_u32 m0, s45, 12288
  s_add_u32 s61, s71, 229376
  v_mfma_f32_16x16x32_bf16 v[188:191], a[168:171], a[12:15], v[188:191]
  ds_read_b64_tr_b16 a[166:167], v4 offset:59392
  v_add_f32 v22, v22, v30
  v_mfma_f32_16x16x32_bf16 v[188:191], a[172:175], a[28:31], v[188:191]
  buffer_load_dwordx4 v10, s[32:35], s61 offen lds
  v_add_f32 v23, v23, v31
  v_mov_b32 v24, v16
  v_mfma_f32_16x16x32_bf16 v[184:187], a[172:175], a[24:27], v[184:187]
  ds_read_b64_tr_b16 a[160:161], v4 offset:61440
  v_mov_b32 v25, v17
  v_mfma_f32_16x16x32_bf16 v[184:187], a[168:171], a[8:11], v[184:187]
  v_mov_b32 v26, v18
  v_mov_b32 v27, v19
  v_mfma_f32_16x16x32_bf16 v[180:183], a[168:171], a[4:7], v[180:183]
  ds_read_b64_tr_b16 a[162:163], v4 offset:63488
  v_mov_b32 v28, v20
  v_mfma_f32_16x16x32_bf16 v[180:183], a[172:175], a[20:23], v[180:183]
  buffer_load_dwordx4 a[64:67], v1, s[8:11], s79 offen offset:0 sc1
  v_mov_b32 v29, v21
  v_mov_b32 v30, v22
  v_mfma_f32_16x16x32_bf16 v[176:179], a[172:175], a[16:19], v[176:179]
  ds_read_b64_tr_b16 a[172:173], v5 offset:49152
  v_mov_b32 v31, v23
  v_mfma_f32_16x16x32_bf16 v[176:179], a[168:171], a[0:3], v[176:179]
  s_waitcnt lgkmcnt(5)
  v_permlane32_swap_b32 v16, v24
  v_mfma_f32_16x16x32_bf16 v[192:195], a[176:179], a[0:3], v[192:195]
  ds_read_b64_tr_b16 a[174:175], v5 offset:51200
  v_mfma_f32_16x16x32_bf16 v[192:195], a[180:183], a[16:19], v[192:195]
  v_permlane32_swap_b32 v17, v25
  v_mfma_f32_16x16x32_bf16 v[196:199], a[180:183], a[20:23], v[196:199]
  ds_read_b64_tr_b16 a[168:169], v5 offset:53248
  v_mfma_f32_16x16x32_bf16 v[196:199], a[176:179], a[4:7], v[196:199]
  buffer_load_dwordx4 a[80:83], v1, s[8:11], s79 offen offset:1024 sc1
  v_permlane32_swap_b32 v18, v26
  v_mfma_f32_16x16x32_bf16 v[200:203], a[176:179], a[8:11], v[200:203]
  ds_read_b64_tr_b16 a[170:171], v5 offset:55296
  v_mfma_f32_16x16x32_bf16 v[200:203], a[180:183], a[24:27], v[200:203]
  s_add_u32 s79, s79, 65536
  v_permlane32_swap_b32 v19, v27
  v_mfma_f32_16x16x32_bf16 v[204:207], a[180:183], a[28:31], v[204:207]
  ds_read_b64_tr_b16 a[180:181], v5 offset:57344
  v_mfma_f32_16x16x32_bf16 v[204:207], a[176:179], a[12:15], v[204:207]
  s_waitcnt lgkmcnt(5)
  buffer_load_dwordx4 a[68:71], v1, s[8:11], s79 offen offset:0 sc1
  v_mfma_f32_16x16x32_bf16 v[220:223], a[164:167], a[12:15], v[220:223]
  ds_read_b64_tr_b16 a[182:183], v5 offset:59392
  v_mfma_f32_16x16x32_bf16 v[220:223], a[160:163], a[28:31], v[220:223]
  v_permlane32_swap_b32 v20, v28
  v_mfma_f32_16x16x32_bf16 v[216:219], a[160:163], a[24:27], v[216:219]
  ds_read_b64_tr_b16 a[176:177], v5 offset:61440
  v_mfma_f32_16x16x32_bf16 v[216:219], a[164:167], a[8:11], v[216:219]
  v_permlane32_swap_b32 v21, v29
  v_mfma_f32_16x16x32_bf16 v[212:215], a[164:167], a[4:7], v[212:215]
  ds_read_b64_tr_b16 a[178:179], v5 offset:63488
  buffer_load_dwordx4 a[84:87], v1, s[8:11], s79 offen offset:1024 sc1
  v_mfma_f32_16x16x32_bf16 v[212:215], a[160:163], a[20:23], v[212:215]
  s_waitcnt vmcnt(21)
  s_barrier
  v_mfma_f32_16x16x32_bf16 v[208:211], a[160:163], a[16:19], v[208:211]
  ds_read_b64_tr_b16 a[160:161], v6 offset:16384
  v_mfma_f32_16x16x32_bf16 v[208:211], a[164:167], a[0:3], v[208:211]
  s_waitcnt lgkmcnt(5)
  s_add_u32 s79, s79, 65536
  v_mfma_f32_16x16x32_bf16 v[224:227], a[172:175], a[0:3], v[224:227]
  ds_read_b64_tr_b16 a[162:163], v6 offset:18432
  v_permlane32_swap_b32 v22, v30
  v_mfma_f32_16x16x32_bf16 v[224:227], a[168:171], a[16:19], v[224:227]
  buffer_load_dwordx4 a[72:75], v1, s[8:11], s79 offen offset:0 sc1
  v_permlane32_swap_b32 v23, v31
  v_mfma_f32_16x16x32_bf16 v[228:231], a[168:171], a[20:23], v[228:231]
  ds_read_b64_tr_b16 a[164:165], v6 offset:20480
  v_add_f32 v16, v16, v24
  v_mfma_f32_16x16x32_bf16 v[228:231], a[172:175], a[4:7], v[228:231]
  v_add_f32 v17, v17, v25
  v_add_f32 v18, v18, v26
  v_mfma_f32_16x16x32_bf16 v[232:235], a[172:175], a[8:11], v[232:235]
  ds_read_b64_tr_b16 a[166:167], v6 offset:22528
  v_add_f32 v19, v19, v27
  v_mfma_f32_16x16x32_bf16 v[232:235], a[168:171], a[24:27], v[232:235]
  v_add_f32 v20, v20, v28
  v_add_f32 v21, v21, v29
  v_mfma_f32_16x16x32_bf16 v[236:239], a[168:171], a[28:31], v[236:239]
  ds_read_b64_tr_b16 a[168:169], v6 offset:24576
  v_add_f32 v22, v22, v30
  v_mfma_f32_16x16x32_bf16 v[236:239], a[172:175], a[12:15], v[236:239]
  s_waitcnt lgkmcnt(5)
  buffer_load_dwordx4 a[88:91], v1, s[8:11], s79 offen offset:1024 sc1
  v_add_f32 v23, v23, v31
  v_mfma_f32_16x16x32_bf16 v[252:255], a[180:183], a[12:15], v[252:255]
  ds_read_b64_tr_b16 a[170:171], v6 offset:26624
  v_mul_f32 v16, 0x3a800000, v16
  v_mfma_f32_16x16x32_bf16 v[252:255], a[176:179], a[28:31], v[252:255]
  s_add_u32 s79, s79, 65536
  v_mul_f32 v18, 0x3a800000, v18
  v_mul_f32 v20, 0x3a800000, v20
  v_mfma_f32_16x16x32_bf16 v[248:251], a[176:179], a[24:27], v[248:251]
  ds_read_b64_tr_b16 a[172:173], v6 offset:28672
  v_mul_f32 v22, 0x3a800000, v22
  v_mfma_f32_16x16x32_bf16 v[248:251], a[180:183], a[8:11], v[248:251]
  buffer_load_dwordx4 a[76:79], v1, s[8:11], s79 offen offset:0 sc1
  v_mul_f32 v17, 0x3a800000, v17
  v_mul_f32 v19, 0x3a800000, v19
  v_mfma_f32_16x16x32_bf16 v[244:247], a[180:183], a[4:7], v[244:247]
  ds_read_b64_tr_b16 a[174:175], v6 offset:30720
  v_mul_f32 v21, 0x3a800000, v21
  v_mfma_f32_16x16x32_bf16 v[244:247], a[176:179], a[20:23], v[244:247]
  v_mul_f32 v23, 0x3a800000, v23
  v_fma_f32 v17, -v16, v16, v17
  v_mfma_f32_16x16x32_bf16 v[240:243], a[176:179], a[16:19], v[240:243]
  ds_read_b64_tr_b16 a[176:177], v7 offset:16384
  v_fma_f32 v19, -v18, v18, v19
  v_mfma_f32_16x16x32_bf16 v[240:243], a[180:183], a[0:3], v[240:243]
  s_waitcnt vmcnt(15) lgkmcnt(5)
  v_fma_f32 v21, -v20, v20, v21
  v_fma_f32 v23, -v22, v22, v23
  v_mfma_f32_16x16x32_bf16 v[64:67], a[160:163], a[32:35], v[64:67]
  ds_read_b64_tr_b16 a[178:179], v7 offset:18432
  v_max_f32 v17, 0, v17
  v_mfma_f32_16x16x32_bf16 v[64:67], a[164:167], a[48:51], v[64:67]
  buffer_load_dwordx4 a[92:95], v1, s[8:11], s79 offen offset:1024 sc1
  v_max_f32 v19, 0, v19
  v_max_f32 v21, 0, v21
  v_mfma_f32_16x16x32_bf16 v[68:71], a[164:167], a[52:55], v[68:71]
  ds_read_b64_tr_b16 a[180:181], v7 offset:20480
  v_max_f32 v23, 0, v23
  v_mfma_f32_16x16x32_bf16 v[68:71], a[160:163], a[36:39], v[68:71]
  s_cmp_eq_u32 s56, 0
  s_cselect_b32 s72, 12, 8
  s_mul_i32 s64, s72, 458752
  s_lshl_b32 s72, s72, 11
  s_add_u32 s72, s72, s57
  s_add_u32 m0, s45, 98304
  v_cvt_pk_bf16_f32 v17, v17, v17
  v_cvt_pk_bf16_f32 v19, v19, v19
  v_mfma_f32_16x16x32_bf16 v[72:75], a[160:163], a[40:43], v[72:75]
  ds_read_b64_tr_b16 a[182:183], v7 offset:22528
  v_cvt_pk_bf16_f32 v21, v21, v21
  v_mfma_f32_16x16x32_bf16 v[72:75], a[164:167], a[56:59], v[72:75]
  buffer_load_dwordx4 v11, s[28:31], s64 offen lds
  v_cvt_pk_bf16_f32 v23, v23, v23
  v_lshlrev_b32 v17, 16, v17
  v_mfma_f32_16x16x32_bf16 v[76:79], a[164:167], a[60:63], v[76:79]
  ds_read_b64_tr_b16 a[164:165], v7 offset:24576
  v_lshlrev_b32 v19, 16, v19
  v_mfma_f32_16x16x32_bf16 v[76:79], a[160:163], a[44:47], v[76:79]
  s_waitcnt lgkmcnt(5)
  v_lshlrev_b32 v21, 16, v21
  v_lshlrev_b32 v23, 16, v23
  v_mfma_f32_16x16x32_bf16 v[92:95], a[168:171], a[44:47], v[92:95]
  ds_read_b64_tr_b16 a[166:167], v7 offset:26624
  v_add_f32 v17, 0x3727c5ac, v17
  v_mfma_f32_16x16x32_bf16 v[92:95], a[172:175], a[60:63], v[92:95]
  s_add_u32 m0, s45, 106496
  v_add_f32 v19, 0x3727c5ac, v19
  v_add_f32 v21, 0x3727c5ac, v21
  v_mfma_f32_16x16x32_bf16 v[88:91], a[172:175], a[56:59], v[88:91]
  ds_read_b64_tr_b16 a[160:161], v7 offset:28672
  v_add_f32 v23, 0x3727c5ac, v23
  v_mfma_f32_16x16x32_bf16 v[88:91], a[168:171], a[40:43], v[88:91]
  buffer_load_dwordx4 v11, s[32:35], s64 offen lds
  v_cvt_pk_bf16_f32 v17, v17, v17
  v_cvt_pk_bf16_f32 v19, v19, v19
  v_mfma_f32_16x16x32_bf16 v[84:87], a[168:171], a[36:39], v[84:87]
  ds_read_b64_tr_b16 a[162:163], v7 offset:30720
  v_cvt_pk_bf16_f32 v21, v21, v21
  v_mfma_f32_16x16x32_bf16 v[84:87], a[172:175], a[52:55], v[84:87]
  s_cmp_lg_u32 s44, 0
  s_cbranch_scc1 PI16_adaLN_cond__sliding_local_dilated__swiglu_ffn__prompt_kernel
  buffer_load_dword v9, v13, s[8:11], 0 offen sc1
PI16_adaLN_cond__sliding_local_dilated__swiglu_ffn__prompt_kernel:
  v_mfma_f32_16x16x32_bf16 v[80:83], a[172:175], a[48:51], v[80:83]
  ds_read_b64_tr_b16 a[172:173], v8 offset:16384
  s_add_u32 m0, s45, 102400
  s_add_u32 s61, s64, 229376
  v_mfma_f32_16x16x32_bf16 v[80:83], a[168:171], a[32:35], v[80:83]
  s_waitcnt lgkmcnt(5)
  buffer_load_dwordx4 v11, s[28:31], s61 offen lds
  v_cvt_pk_bf16_f32 v23, v23, v23
  v_mfma_f32_16x16x32_bf16 v[96:99], a[176:179], a[32:35], v[96:99]
  ds_read_b64_tr_b16 a[174:175], v8 offset:18432
  v_lshlrev_b32 v17, 16, v17
  v_mfma_f32_16x16x32_bf16 v[96:99], a[180:183], a[48:51], v[96:99]
  v_lshlrev_b32 v19, 16, v19
  v_lshlrev_b32 v21, 16, v21
  v_mfma_f32_16x16x32_bf16 v[100:103], a[180:183], a[52:55], v[100:103]
  ds_read_b64_tr_b16 a[168:169], v8 offset:20480
  v_lshlrev_b32 v23, 16, v23
  v_mfma_f32_16x16x32_bf16 v[100:103], a[176:179], a[36:39], v[100:103]
  s_add_u32 m0, s45, 110592
  s_add_u32 s61, s64, 229376
  v_mfma_f32_16x16x32_bf16 v[104:107], a[176:179], a[40:43], v[104:107]
  ds_read_b64_tr_b16 a[170:171], v8 offset:22528
  v_mfma_f32_16x16x32_bf16 v[104:107], a[180:183], a[56:59], v[104:107]
  buffer_load_dwordx4 v11, s[32:35], s61 offen lds
  v_sqrt_f32 v17, v17
  v_mfma_f32_16x16x32_bf16 v[108:111], a[180:183], a[60:63], v[108:111]
  ds_read_b64_tr_b16 a[180:181], v8 offset:24576
  v_mfma_f32_16x16x32_bf16 v[108:111], a[176:179], a[44:47], v[108:111]
  s_waitcnt lgkmcnt(5)
  s_add_u32 m0, s45, 32768
  v_mfma_f32_16x16x32_bf16 v[124:127], a[164:167], a[44:47], v[124:127]
  ds_read_b64_tr_b16 a[182:183], v8 offset:26624
  v_mfma_f32_16x16x32_bf16 v[124:127], a[160:163], a[60:63], v[124:127]
  buffer_load_dwordx4 v10, s[28:31], s64 offen lds
  v_sqrt_f32 v19, v19
  v_mfma_f32_16x16x32_bf16 v[120:123], a[160:163], a[56:59], v[120:123]
  ds_read_b64_tr_b16 a[176:177], v8 offset:28672
  v_mfma_f32_16x16x32_bf16 v[120:123], a[164:167], a[40:43], v[120:123]
  v_sqrt_f32 v21, v21
  v_mfma_f32_16x16x32_bf16 v[116:119], a[164:167], a[36:39], v[116:119]
  ds_read_b64_tr_b16 a[178:179], v8 offset:30720
  v_mfma_f32_16x16x32_bf16 v[116:119], a[160:163], a[52:55], v[116:119]
  s_add_u32 m0, s45, 40960
  v_sqrt_f32 v23, v23
  v_mfma_f32_16x16x32_bf16 v[112:115], a[160:163], a[48:51], v[112:115]
  ds_read_b64_tr_b16 a[160:161], v2 offset:16384
  v_cvt_pk_bf16_f32 v16, v16, v16
  v_mfma_f32_16x16x32_bf16 v[112:115], a[164:167], a[32:35], v[112:115]
  s_waitcnt lgkmcnt(5)
  buffer_load_dwordx4 v10, s[32:35], s64 offen lds
  v_cvt_pk_bf16_f32 v18, v18, v18
  v_mfma_f32_16x16x32_bf16 v[32:35], a[172:175], a[32:35], v[32:35]
  ds_read_b64_tr_b16 a[162:163], v2 offset:18432
  v_cvt_pk_bf16_f32 v20, v20, v20
  v_mfma_f32_16x16x32_bf16 v[32:35], a[168:171], a[48:51], v[32:35]
  s_add_u32 m0, s45, 36864
  s_add_u32 s61, s64, 229376
  v_cvt_pk_bf16_f32 v22, v22, v22
  v_mfma_f32_16x16x32_bf16 v[36:39], a[168:171], a[52:55], v[36:39]
  ds_read_b64_tr_b16 a[164:165], v2 offset:20480
  v_lshlrev_b32 v16, 16, v16
  v_mfma_f32_16x16x32_bf16 v[36:39], a[172:175], a[36:39], v[36:39]
  buffer_load_dwordx4 v10, s[28:31], s61 offen lds
  v_lshlrev_b32 v18, 16, v18
  v_lshlrev_b32 v20, 16, v20
  v_mfma_f32_16x16x32_bf16 v[40:43], a[172:175], a[40:43], v[40:43]
  ds_read_b64_tr_b16 a[166:167], v2 offset:22528
  v_lshlrev_b32 v22, 16, v22
  v_mfma_f32_16x16x32_bf16 v[40:43], a[168:171], a[56:59], v[40:43]
  v_cvt_pk_bf16_f32 v17, v17, v17
  v_cvt_pk_bf16_f32 v19, v19, v19
  v_mfma_f32_16x16x32_bf16 v[44:47], a[168:171], a[60:63], v[44:47]
  ds_read_b64_tr_b16 a[168:169], v2 offset:24576
  v_cvt_pk_bf16_f32 v21, v21, v21
  v_mfma_f32_16x16x32_bf16 v[44:47], a[172:175], a[44:47], v[44:47]
  s_waitcnt lgkmcnt(5)
  s_add_u32 m0, s45, 45056
  s_add_u32 s61, s64, 229376
  v_mfma_f32_16x16x32_bf16 v[60:63], a[180:183], a[44:47], v[60:63]
  ds_read_b64_tr_b16 a[170:171], v2 offset:26624
  v_cvt_pk_bf16_f32 v23, v23, v23
  v_mfma_f32_16x16x32_bf16 v[60:63], a[176:179], a[60:63], v[60:63]
  buffer_load_dwordx4 v10, s[32:35], s61 offen lds
  v_lshlrev_b32 v17, 16, v17
  v_lshlrev_b32 v19, 16, v19
  v_mfma_f32_16x16x32_bf16 v[56:59], a[176:179], a[56:59], v[56:59]
  ds_read_b64_tr_b16 a[172:173], v2 offset:28672
  v_lshlrev_b32 v21, 16, v21
  v_mfma_f32_16x16x32_bf16 v[56:59], a[180:183], a[40:43], v[56:59]
  v_lshlrev_b32 v23, 16, v23
  v_sub_f32 v16, 0, v16
  v_mfma_f32_16x16x32_bf16 v[52:55], a[180:183], a[36:39], v[52:55]
  ds_read_b64_tr_b16 a[174:175], v2 offset:30720
  v_sub_f32 v18, 0, v18
  v_mfma_f32_16x16x32_bf16 v[52:55], a[176:179], a[52:55], v[52:55]
  buffer_load_dwordx4 a[96:99], v1, s[8:11], s72 offen offset:0 sc1
  v_sub_f32 v20, 0, v20
  v_sub_f32 v22, 0, v22
  v_mfma_f32_16x16x32_bf16 v[48:51], a[176:179], a[48:51], v[48:51]
  ds_read_b64_tr_b16 a[176:177], v3 offset:16384
  v_lshrrev_b32 v12, 8, v1
  v_mfma_f32_16x16x32_bf16 v[48:51], a[180:183], a[32:35], v[48:51]
  s_waitcnt lgkmcnt(5)
  v_lshlrev_b32 v12, 4, v12
  v_add_u32 v12, 131072, v12
  v_mfma_f32_16x16x32_bf16 v[128:131], a[160:163], a[32:35], v[128:131]
  ds_read_b64_tr_b16 a[178:179], v3 offset:18432
  s_and_b32 s50, s2, 4
  v_mfma_f32_16x16x32_bf16 v[128:131], a[164:167], a[48:51], v[128:131]
  s_lshr_b32 s53, s2, 6
  s_add_u32 s50, s50, s53
  s_bfe_u32 s51, s2, 0x30003
  v_mfma_f32_16x16x32_bf16 v[132:135], a[164:167], a[52:55], v[132:135]
  ds_read_b64_tr_b16 a[180:181], v3 offset:20480
  s_and_b32 s52, s2, 3
  v_mfma_f32_16x16x32_bf16 v[132:135], a[160:163], a[36:39], v[132:135]
  buffer_load_dwordx4 a[112:115], v1, s[8:11], s72 offen offset:1024 sc1
  s_add_u32 s91, s50, s51
  s_and_b32 s91, s91, 3
  v_mfma_f32_16x16x32_bf16 v[136:139], a[160:163], a[40:43], v[136:139]
  ds_read_b64_tr_b16 a[182:183], v3 offset:22528
  s_lshl_b32 s53, s50, 4
  v_mfma_f32_16x16x32_bf16 v[136:139], a[164:167], a[56:59], v[136:139]
  s_cmp_lg_u32 s44, 0
  s_cbranch_scc1 PL17_adaLN_cond__sliding_local_dilated__swiglu_ffn__prompt_kernelx
  s_waitcnt vmcnt(8)
  v_cmp_ne_u32 vcc, s46, v9
  s_nop 4
  s_cbranch_vccz PL17_adaLN_cond__sliding_local_dilated__swiglu_ffn__prompt_kernelx
  s_mov_b32 s83, 60000
PL17_adaLN_cond__sliding_local_dilated__swiglu_ffn__prompt_kernel:
  buffer_load_dword v9, v13, s[8:11], 0 offen sc1
  s_sub_u32 s83, s83, 1
  s_cmp_eq_u32 s83, 0
  s_waitcnt vmcnt(0)
  s_cbranch_scc1 PL17_adaLN_cond__sliding_local_dilated__swiglu_ffn__prompt_kernelx
  v_cmp_ne_u32 vcc, s46, v9
  s_nop 4
  s_cbranch_vccnz PL17_adaLN_cond__sliding_local_dilated__swiglu_ffn__prompt_kernel
PL17_adaLN_cond__sliding_local_dilated__swiglu_ffn__prompt_kernelx:
  s_barrier
  v_mfma_f32_16x16x32_bf16 v[140:143], a[164:167], a[60:63], v[140:143]
  ds_read_b64_tr_b16 a[164:165], v3 offset:24576
  s_mov_b32 s62, 0
  v_mfma_f32_16x16x32_bf16 v[140:143], a[160:163], a[44:47], v[140:143]
  s_waitcnt lgkmcnt(5)
  buffer_load_dwordx4 a[220:223], v14, s[8:11], s62 offen sc1
  s_and_b32 s54, s52, 2
  v_mfma_f32_16x16x32_bf16 v[156:159], a[168:171], a[44:47], v[156:159]
  ds_read_b64_tr_b16 a[166:167], v3 offset:26624
  s_mul_i32 s89, s54, 4293918720
  v_mfma_f32_16x16x32_bf16 v[156:159], a[172:175], a[60:63], v[156:159]
  s_mov_b32 s62, 114688
HOP10:
  s_cbranch_execz HOP13
  s_add_u32 s89, s89, 917504
  s_lshl_b32 s54, s54, 2
  v_mfma_f32_16x16x32_bf16 v[152:155], a[172:175], a[56:59], v[152:155]
  ds_read_b64_tr_b16 a[160:161], v3 offset:28672
  buffer_load_dwordx4 a[224:227], v14, s[8:11], s62 offen sc1
  v_mfma_f32_16x16x32_bf16 v[152:155], a[168:171], a[40:43], v[152:155]
  s_mov_b32 s62, 229376
  s_add_u32 s53, s53, s54
  s_lshl_b32 s54, s44, 1
  v_mfma_f32_16x16x32_bf16 v[148:151], a[168:171], a[36:39], v[148:151]
  ds_read_b64_tr_b16 a[162:163], v3 offset:30720
  buffer_load_dwordx4 a[228:231], v14, s[8:11], s62 offen sc1
  v_mfma_f32_16x16x32_bf16 v[148:151], a[172:175], a[52:55], v[148:151]
  s_mov_b32 s62, 344064
  s_add_u32 s53, s53, s54
  s_mul_i32 s84, s53, 131072
  v_mfma_f32_16x16x32_bf16 v[144:147], a[172:175], a[48:51], v[144:147]
  ds_read_b64_tr_b16 a[172:173], v4 offset:16384
  s_mul_i32 s54, s52, 28672
  v_mfma_f32_16x16x32_bf16 v[144:147], a[168:171], a[32:35], v[144:147]
  s_waitcnt lgkmcnt(5)
  buffer_load_dwordx4 a[232:235], v14, s[8:11], s62 offen sc1
  s_add_u32 s84, s84, s54
  v_mfma_f32_16x16x32_bf16 v[160:163], a[176:179], a[32:35], v[160:163]
  ds_read_b64_tr_b16 a[174:175], v4 offset:18432
  s_mov_b32 s62, 458752
  v_mfma_f32_16x16x32_bf16 v[160:163], a[180:183], a[48:51], v[160:163]
  buffer_load_dwordx4 a[236:239], v14, s[8:11], s62 offen sc1
  s_add_u32 s84, s84, 19922944
  s_lshl_b32 s85, s53, 15
  v_mfma_f32_16x16x32_bf16 v[164:167], a[180:183], a[52:55], v[164:167]
  ds_read_b64_tr_b16 a[168:169], v4 offset:20480
  s_lshl_b32 s51, s51, 1
  v_mfma_f32_16x16x32_bf16 v[164:167], a[176:179], a[36:39], v[164:167]
  s_mov_b32 s62, 573440
  s_and_b32 s54, s52, 1
  s_add_u32 s51, s51, s54
  v_mfma_f32_16x16x32_bf16 v[168:171], a[176:179], a[40:43], v[168:171]
  ds_read_b64_tr_b16 a[170:171], v4 offset:22528
  buffer_load_dwordx4 a[240:243], v14, s[8:11], s62 offen sc1
  v_mfma_f32_16x16x32_bf16 v[168:171], a[180:183], a[56:59], v[168:171]
  s_mov_b32 s62, 688128
  s_lshl_b32 s53, s51, 7
  s_add_u32 s85, s85, s53
  v_mfma_f32_16x16x32_bf16 v[172:175], a[180:183], a[60:63], v[172:175]
  ds_read_b64_tr_b16 a[180:181], v4 offset:24576
  buffer_load_dwordx4 a[244:247], v14, s[8:11], s62 offen sc1
  v_mfma_f32_16x16x32_bf16 v[172:175], a[176:179], a[44:47], v[172:175]
  s_waitcnt lgkmcnt(5)
  s_mov_b32 s62, 802816
  s_lshl_b32 s88, s51, 8
  v_mfma_f32_16x16x32_bf16 v[188:191], a[164:167], a[44:47], v[188:191]
  ds_read_b64_tr_b16 a[182:183], v4 offset:26624
  s_add_u32 s88, s88, 20480
  v_mfma_f32_16x16x32_bf16 v[188:191], a[160:163], a[60:63], v[188:191]
  buffer_load_dwordx4 a[248:251], v14, s[8:11], s62 offen sc1
  s_add_u32 s72, s72, 65536
  s_lshl_b32 s53, s50, 12
  v_mfma_f32_16x16x32_bf16 v[184:187], a[160:163], a[56:59], v[184:187]
  ds_read_b64_tr_b16 a[176:177], v4 offset:28672
  s_lshl_b32 s54, s52, 8
  v_mfma_f32_16x16x32_bf16 v[184:187], a[164:167], a[40:43], v[184:187]
  buffer_load_dwordx4 a[100:103], v1, s[8:11], s72 offen offset:0 sc1
  s_add_u32 s53, s53, s54
  s_add_u32 s82, s53, 688128
  v_mfma_f32_16x16x32_bf16 v[180:183], a[164:167], a[36:39], v[180:183]
  ds_read_b64_tr_b16 a[178:179], v4 offset:30720
  s_lshl_b32 s90, s44, 12
  v_mfma_f32_16x16x32_bf16 v[180:183], a[160:163], a[52:55], v[180:183]
  s_add_u32 s90, s90, 135168
  s_lshl_b32 s86, s2, 16
  s_lshl_b32 s53, s44, 14
  v_mfma_f32_16x16x32_bf16 v[176:179], a[160:163], a[48:51], v[176:179]
  ds_read_b64_tr_b16 a[160:161], v5 offset:16384
  s_add_u32 s86, s86, s53
  v_mfma_f32_16x16x32_bf16 v[176:179], a[164:167], a[32:35], v[176:179]
  s_waitcnt lgkmcnt(5)
  s_add_u32 s86, s86, 67108864
  s_lshr_b32 s53, s2, 3
  v_mfma_f32_16x16x32_bf16 v[192:195], a[172:175], a[32:35], v[192:195]
  ds_read_b64_tr_b16 a[162:163], v5 offset:18432
  s_lshl_b32 s53, s53, 2
  v_mfma_f32_16x16x32_bf16 v[192:195], a[168:171], a[48:51], v[192:195]
  buffer_load_dwordx4 a[116:119], v1, s[8:11], s72 offen offset:1024 sc1
  s_add_u32 s53, s53, s44
  s_mul_i32 s92, s53, 14336
  v_mfma_f32_16x16x32_bf16 v[196:199], a[168:171], a[52:55], v[196:199]
  ds_read_b64_tr_b16 a[164:165], v5 offset:20480
  s_mul_i32 s53, s52, 1835008
  v_mfma_f32_16x16x32_bf16 v[196:199], a[172:175], a[36:39], v[196:199]
  s_add_u32 s72, s72, 65536
  s_add_u32 s92, s92, s53
  s_nop 0
  v_mfma_f32_16x16x32_bf16 v[200:203], a[172:175], a[40:43], v[200:203]
  ds_read_b64_tr_b16 a[166:167], v5 offset:22528
  v_mfma_f32_16x16x32_bf16 v[200:203], a[168:171], a[56:59], v[200:203]
  buffer_load_dwordx4 a[104:107], v1, s[8:11], s72 offen offset:0 sc1
  v_mfma_f32_16x16x32_bf16 v[204:207], a[168:171], a[60:63], v[204:207]
  ds_read_b64_tr_b16 a[168:169], v5 offset:24576
  v_mfma_f32_16x16x32_bf16 v[204:207], a[172:175], a[44:47], v[204:207]
  s_waitcnt lgkmcnt(5)
  v_mfma_f32_16x16x32_bf16 v[220:223], a[180:183], a[44:47], v[220:223]
  ds_read_b64_tr_b16 a[170:171], v5 offset:26624
  v_mfma_f32_16x16x32_bf16 v[220:223], a[176:179], a[60:63], v[220:223]
  v_mfma_f32_16x16x32_bf16 v[216:219], a[176:179], a[56:59], v[216:219]
  ds_read_b64_tr_b16 a[172:173], v5 offset:28672
  v_mfma_f32_16x16x32_bf16 v[216:219], a[180:183], a[40:43], v[216:219]
  buffer_load_dwordx4 a[120:123], v1, s[8:11], s72 offen offset:1024 sc1
  v_mfma_f32_16x16x32_bf16 v[212:215], a[180:183], a[36:39], v[212:215]
  ds_read_b64_tr_b16 a[174:175], v5 offset:30720
  v_mfma_f32_16x16x32_bf16 v[212:215], a[176:179], a[52:55], v[212:215]
  s_waitcnt vmcnt(30)
  s_barrier
  v_mfma_f32_16x16x32_bf16 v[208:211], a[176:179], a[48:51], v[208:211]
  ds_read_b64_tr_b16 a[176:177], v6 offset:0
  s_add_u32 s72, s72, 65536
  v_mfma_f32_16x16x32_bf16 v[208:211], a[180:183], a[32:35], v[208:211]
  s_waitcnt lgkmcnt(5)
  buffer_load_dwordx4 a[108:111], v1, s[8:11], s72 offen offset:0 sc1
  v_mfma_f32_16x16x32_bf16 v[224:227], a[160:163], a[32:35], v[224:227]
  ds_read_b64_tr_b16 a[178:179], v6 offset:2048
  v_mfma_f32_16x16x32_bf16 v[224:227], a[164:167], a[48:51], v[224:227]
  v_mfma_f32_16x16x32_bf16 v[228:231], a[164:167], a[52:55], v[228:231]
  ds_read_b64_tr_b16 a[180:181], v6 offset:4096
  v_mfma_f32_16x16x32_bf16 v[228:231], a[160:163], a[36:39], v[228:231]
  v_mfma_f32_16x16x32_bf16 v[232:235], a[160:163], a[40:43], v[232:235]
  ds_read_b64_tr_b16 a[182:183], v6 offset:6144
  v_mfma_f32_16x16x32_bf16 v[232:235], a[164:167], a[56:59], v[232:235]
  buffer_load_dwordx4 a[124:127], v1, s[8:11], s72 offen offset:1024 sc1
  v_mfma_f32_16x16x32_bf16 v[236:239], a[164:167], a[60:63], v[236:239]
  ds_read_b64_tr_b16 a[164:165], v6 offset:8192
  v_mfma_f32_16x16x32_bf16 v[236:239], a[160:163], a[44:47], v[236:239]
  s_waitcnt lgkmcnt(5)
  s_cmp_eq_u32 s56, 1
  s_cselect_b32 s73, 13, 9
  s_mul_i32 s65, s73, 458752
  s_lshl_b32 s73, s73, 11
  s_add_u32 s73, s73, s57
  s_add_u32 m0, s45, 114688
  v_mfma_f32_16x16x32_bf16 v[252:255], a[168:171], a[44:47], v[252:255]
  ds_read_b64_tr_b16 a[166:167], v6 offset:10240
  v_mfma_f32_16x16x32_bf16 v[252:255], a[172:175], a[60:63], v[252:255]
  buffer_load_dwordx4 v11, s[28:31], s65 offen lds
  v_mfma_f32_16x16x32_bf16 v[248:251], a[172:175], a[56:59], v[248:251]
  ds_read_b64_tr_b16 a[160:161], v6 offset:12288
  v_mfma_f32_16x16x32_bf16 v[248:251], a[168:171], a[40:43], v[248:251]
  v_mfma_f32_16x16x32_bf16 v[244:247], a[168:171], a[36:39], v[244:247]
  ds_read_b64_tr_b16 a[162:163], v6 offset:14336
  v_mfma_f32_16x16x32_bf16 v[244:247], a[172:175], a[52:55], v[244:247]
  s_add_u32 m0, s45, 122880
  v_mfma_f32_16x16x32_bf16 v[240:243], a[172:175], a[48:51], v[240:243]
  ds_read_b64_tr_b16 a[172:173], v7 offset:0
  v_mfma_f32_16x16x32_bf16 v[240:243], a[168:171], a[32:35], v[240:243]
  s_waitcnt vmcnt(25) lgkmcnt(5)
  buffer_load_dwordx4 v11, s[32:35], s65 offen lds
  v_mfma_f32_16x16x32_bf16 v[64:67], a[176:179], a[64:67], v[64:67]
  ds_read_b64_tr_b16 a[174:175], v7 offset:2048
  v_mfma_f32_16x16x32_bf16 v[64:67], a[180:183], a[80:83], v[64:67]
  s_add_u32 m0, s45, 118784
  s_add_u32 s61, s65, 229376
  v_mfma_f32_16x16x32_bf16 v[68:71], a[180:183], a[84:87], v[68:71]
  ds_read_b64_tr_b16 a[168:169], v7 offset:4096
  v_mfma_f32_16x16x32_bf16 v[68:71], a[176:179], a[68:71], v[68:71]
  buffer_load_dwordx4 v11, s[28:31], s61 offen lds
  v_mfma_f32_16x16x32_bf16 v[72:75], a[176:179], a[72:75], v[72:75]
  ds_read_b64_tr_b16 a[170:171], v7 offset:6144
  v_mfma_f32_16x16x32_bf16 v[72:75], a[180:183], a[88:91], v[72:75]
  v_mfma_f32_16x16x32_bf16 v[76:79], a[180:183], a[92:95], v[76:79]
  ds_read_b64_tr_b16 a[180:181], v7 offset:8192
  s_waitcnt vmcnt(9)
  v_mfma_f32_16x16x32_bf16 v[76:79], a[176:179], a[76:79], v[76:79]
  s_waitcnt lgkmcnt(5)
  s_add_u32 m0, s45, 126976
  s_add_u32 s61, s65, 229376
  v_accvgpr_read_b32 v24, a220
  v_mfma_f32_16x16x32_bf16 v[92:95], a[164:167], a[76:79], v[92:95]
  ds_read_b64_tr_b16 a[182:183], v7 offset:10240
  v_accvgpr_read_b32 v25, a221
  v_mfma_f32_16x16x32_bf16 v[92:95], a[160:163], a[92:95], v[92:95]
  buffer_load_dwordx4 v11, s[32:35], s61 offen lds
  v_accvgpr_read_b32 v26, a222
  v_accvgpr_read_b32 v27, a223
  v_mfma_f32_16x16x32_bf16 v[88:91], a[160:163], a[88:91], v[88:91]
  ds_read_b64_tr_b16 a[176:177], v7 offset:12288
  v_accvgpr_read_b32 v28, a224
  v_mfma_f32_16x16x32_bf16 v[88:91], a[164:167], a[72:75], v[88:91]
  s_add_u32 m0, s45, 49152
  v_accvgpr_read_b32 v29, a225
  v_accvgpr_read_b32 v30, a226
  v_mfma_f32_16x16x32_bf16 v[84:87], a[164:167], a[68:71], v[84:87]
  ds_read_b64_tr_b16 a[178:179], v7 offset:14336
  v_accvgpr_read_b32 v31, a227
  v_mfma_f32_16x16x32_bf16 v[84:87], a[160:163], a[84:87], v[84:87]
  buffer_load_dwordx4 v10, s[28:31], s65 offen lds
  v_add_f32 v24, v24, v28
  v_add_f32 v25, v25, v29
  v_mfma_f32_16x16x32_bf16 v[80:83], a[160:163], a[80:83], v[80:83]
  ds_read_b64_tr_b16 a[160:161], v8 offset:0
  v_add_f32 v26, v26, v30
  v_mfma_f32_16x16x32_bf16 v[80:83], a[164:167], a[64:67], v[80:83]
  s_waitcnt lgkmcnt(5)
  v_add_f32 v27, v27, v31
  v_accvgpr_read_b32 v28, a228
  v_accvgpr_read_b32 v29, a229
  v_mfma_f32_16x16x32_bf16 v[96:99], a[172:175], a[64:67], v[96:99]
  ds_read_b64_tr_b16 a[162:163], v8 offset:2048
  v_accvgpr_read_b32 v30, a230
  v_mfma_f32_16x16x32_bf16 v[96:99], a[168:171], a[80:83], v[96:99]
  s_add_u32 m0, s45, 57344
  v_accvgpr_read_b32 v31, a231
  v_add_f32 v24, v24, v28
  v_mfma_f32_16x16x32_bf16 v[100:103], a[168:171], a[84:87], v[100:103]
  ds_read_b64_tr_b16 a[164:165], v8 offset:4096
  v_add_f32 v25, v25, v29
  v_mfma_f32_16x16x32_bf16 v[100:103], a[172:175], a[68:71], v[100:103]
  buffer_load_dwordx4 v10, s[32:35], s65 offen lds
  v_add_f32 v26, v26, v30
  v_add_f32 v27, v27, v31
  v_mfma_f32_16x16x32_bf16 v[104:107], a[172:175], a[72:75], v[104:107]
  ds_read_b64_tr_b16 a[166:167], v8 offset:6144
  v_accvgpr_read_b32 v28, a232
  v_mfma_f32_16x16x32_bf16 v[104:107], a[168:171], a[88:91], v[104:107]
  s_add_u32 m0, s45, 53248
  s_add_u32 s61, s65, 229376
  v_accvgpr_read_b32 v29, a233
  v_mfma_f32_16x16x32_bf16 v[108:111], a[168:171], a[92:95], v[108:111]
  ds_read_b64_tr_b16 a[168:169], v8 offset:8192
  v_accvgpr_read_b32 v30, a234
  v_mfma_f32_16x16x32_bf16 v[108:111], a[172:175], a[76:79], v[108:111]
  s_waitcnt lgkmcnt(5)
  buffer_load_dwordx4 v10, s[28:31], s61 offen lds
  v_accvgpr_read_b32 v31, a235
  v_add_f32 v24, v24, v28
  v_mfma_f32_16x16x32_bf16 v[124:127], a[180:183], a[76:79], v[124:127]
  ds_read_b64_tr_b16 a[170:171], v8 offset:10240
  v_add_f32 v25, v25, v29
  v_mfma_f32_16x16x32_bf16 v[124:127], a[176:179], a[92:95], v[124:127]
  v_add_f32 v26, v26, v30
  v_add_f32 v27, v27, v31
  v_mfma_f32_16x16x32_bf16 v[120:123], a[176:179], a[88:91], v[120:123]
  ds_read_b64_tr_b16 a[172:173], v8 offset:12288
  v_accvgpr_read_b32 v28, a236
  v_mfma_f32_16x16x32_bf16 v[120:123], a[180:183], a[72:75], v[120:123]
  s_add_u32 m0, s45, 61440
  s_add_u32 s61, s65, 229376
  v_accvgpr_read_b32 v29, a237
  v_mfma_f32_16x16x32_bf16 v[116:119], a[180:183], a[68:71], v[116:119]
  ds_read_b64_tr_b16 a[174:175], v8 offset:14336
  v_accvgpr_read_b32 v30, a238
  v_mfma_f32_16x16x32_bf16 v[116:119], a[176:179], a[84:87], v[116:119]
  buffer_load_dwordx4 v10, s[32:35], s61 offen lds
  v_accvgpr_read_b32 v31, a239
  v_add_f32 v24, v24, v28
  v_mfma_f32_16x16x32_bf16 v[112:115], a[176:179], a[80:83], v[112:115]
  ds_read_b64_tr_b16 a[176:177], v2 offset:0
  v_add_f32 v25, v25, v29
  v_mfma_f32_16x16x32_bf16 v[112:115], a[180:183], a[64:67], v[112:115]
  s_waitcnt lgkmcnt(5)
  v_add_f32 v26, v26, v30
  v_add_f32 v27, v27, v31
  v_mfma_f32_16x16x32_bf16 v[32:35], a[160:163], a[64:67], v[32:35]
  ds_read_b64_tr_b16 a[178:179], v2 offset:2048
  v_accvgpr_read_b32 v28, a240
  v_mfma_f32_16x16x32_bf16 v[32:35], a[164:167], a[80:83], v[32:35]
  buffer_load_dwordx4 a[128:131], v1, s[8:11], s73 offen offset:0 sc1
  v_accvgpr_read_b32 v29, a241
  v_accvgpr_read_b32 v30, a242
  v_mfma_f32_16x16x32_bf16 v[36:39], a[164:167], a[84:87], v[36:39]
  ds_read_b64_tr_b16 a[180:181], v2 offset:4096
  v_accvgpr_read_b32 v31, a243
  v_mfma_f32_16x16x32_bf16 v[36:39], a[160:163], a[68:71], v[36:39]
  v_add_f32 v24, v24, v28
  v_add_f32 v25, v25, v29
  v_mfma_f32_16x16x32_bf16 v[40:43], a[160:163], a[72:75], v[40:43]
  ds_read_b64_tr_b16 a[182:183], v2 offset:6144
  v_add_f32 v26, v26, v30
  v_mfma_f32_16x16x32_bf16 v[40:43], a[164:167], a[88:91], v[40:43]
  v_add_f32 v27, v27, v31
  v_accvgpr_read_b32 v28, a244
  v_mfma_f32_16x16x32_bf16 v[44:47], a[164:167], a[92:95], v[44:47]
  ds_read_b64_tr_b16 a[164:165], v2 offset:8192
  v_accvgpr_read_b32 v29, a245
  v_mfma_f32_16x16x32_bf16 v[44:47], a[160:163], a[76:79], v[44:47]
  s_waitcnt lgkmcnt(5)
  buffer_load_dwordx4 a[144:147], v1, s[8:11], s73 offen offset:1024 sc1
  v_accvgpr_read_b32 v30, a246
  v_accvgpr_read_b32 v31, a247
  v_mfma_f32_16x16x32_bf16 v[60:63], a[168:171], a[76:79], v[60:63]
  ds_read_b64_tr_b16 a[166:167], v2 offset:10240
  v_add_f32 v24, v24, v28
  v_mfma_f32_16x16x32_bf16 v[60:63], a[172:175], a[92:95], v[60:63]
  s_add_u32 s73, s73, 65536
  v_add_f32 v25, v25, v29
  v_add_f32 v26, v26, v30
  v_mfma_f32_16x16x32_bf16 v[56:59], a[172:175], a[88:91], v[56:59]
  ds_read_b64_tr_b16 a[160:161], v2 offset:12288
  v_add_f32 v27, v27, v31
  v_mfma_f32_16x16x32_bf16 v[56:59], a[168:171], a[72:75], v[56:59]
  buffer_load_dwordx4 a[132:135], v1, s[8:11], s73 offen offset:0 sc1
  v_accvgpr_read_b32 v28, a248
  v_accvgpr_read_b32 v29, a249
  v_mfma_f32_16x16x32_bf16 v[52:55], a[168:171], a[68:71], v[52:55]
  ds_read_b64_tr_b16 a[162:163], v2 offset:14336
  v_accvgpr_read_b32 v30, a250
  v_mfma_f32_16x16x32_bf16 v[52:55], a[172:175], a[84:87], v[52:55]
  v_accvgpr_read_b32 v31, a251
  v_add_f32 v24, v24, v28
  v_mfma_f32_16x16x32_bf16 v[48:51], a[172:175], a[80:83], v[48:51]
  ds_read_b64_tr_b16 a[172:173], v3 offset:0
  v_add_f32 v25, v25, v29
  v_mfma_f32_16x16x32_bf16 v[48:51], a[168:171], a[64:67], v[48:51]
  s_waitcnt lgkmcnt(5)
  v_add_f32 v26, v26, v30
  v_add_f32 v27, v27, v31
  v_mov_b32 v28, v24
  v_mfma_f32_16x16x32_bf16 v[128:131], a[176:179], a[64:67], v[128:131]
  ds_read_b64_tr_b16 a[174:175], v3 offset:2048
  v_mov_b32 v29, v25
  v_mfma_f32_16x16x32_bf16 v[128:131], a[180:183], a[80:83], v[128:131]
  buffer_load_dwordx4 a[148:151], v1, s[8:11], s73 offen offset:1024 sc1
  v_mov_b32 v30, v26
  v_mov_b32 v31, v27
  v_mfma_f32_16x16x32_bf16 v[132:135], a[180:183], a[84:87], v[132:135]
  ds_read_b64_tr_b16 a[168:169], v3 offset:4096
  v_mfma_f32_16x16x32_bf16 v[132:135], a[176:179], a[68:71], v[132:135]
  s_add_u32 s73, s73, 65536
  v_permlane32_swap_b32 v24, v28
  v_mfma_f32_16x16x32_bf16 v[136:139], a[176:179], a[72:75], v[136:139]
  ds_read_b64_tr_b16 a[170:171], v3 offset:6144
  v_mfma_f32_16x16x32_bf16 v[136:139], a[180:183], a[88:91], v[136:139]
  buffer_load_dwordx4 a[136:139], v1, s[8:11], s73 offen offset:0 sc1
  v_permlane32_swap_b32 v25, v29
  v_mfma_f32_16x16x32_bf16 v[140:143], a[180:183], a[92:95], v[140:143]
  ds_read_b64_tr_b16 a[180:181], v3 offset:8192
  v_mfma_f32_16x16x32_bf16 v[140:143], a[176:179], a[76:79], v[140:143]
  s_waitcnt lgkmcnt(5)
  v_permlane32_swap_b32 v26, v30
  v_mfma_f32_16x16x32_bf16 v[156:159], a[164:167], a[76:79], v[156:159]
  ds_read_b64_tr_b16 a[182:183], v3 offset:10240
  v_mfma_f32_16x16x32_bf16 v[156:159], a[160:163], a[92:95], v[156:159]
  v_permlane32_swap_b32 v27, v31
  v_mfma_f32_16x16x32_bf16 v[152:155], a[160:163], a[88:91], v[152:155]
  ds_read_b64_tr_b16 a[176:177], v3 offset:12288
  v_add_f32 v24, v24, v28
  v_mfma_f32_16x16x32_bf16 v[152:155], a[164:167], a[72:75], v[152:155]
  buffer_load_dwordx4 a[152:155], v1, s[8:11], s73 offen offset:1024 sc1
  v_add_f32 v25, v25, v29
  v_add_f32 v26, v26, v30
  v_mfma_f32_16x16x32_bf16 v[148:151], a[164:167], a[68:71], v[148:151]
  ds_read_b64_tr_b16 a[178:179], v3 offset:14336
  v_lshrrev_b32 v13, 8, v1
  v_lshlrev_b32 v13, 28, v13
  v_mfma_f32_16x16x32_bf16 v[148:151], a[160:163], a[84:87], v[148:151]
  v_lshl_add_u32 v13, v1, 3, v13
  v_xor_b32 v9, 96, v6
  v_mfma_f32_16x16x32_bf16 v[144:147], a[160:163], a[80:83], v[144:147]
  ds_read_b64_tr_b16 a[160:161], v4 offset:0
  s_add_u32 s73, s73, 65536
  v_mfma_f32_16x16x32_bf16 v[144:147], a[164:167], a[64:67], v[144:147]
  s_waitcnt lgkmcnt(5)
  buffer_load_dwordx4 a[140:143], v1, s[8:11], s73 offen offset:0 sc1
  v_add_f32 v27, v27, v31
  v_mfma_f32_16x16x32_bf16 v[160:163], a[172:175], a[64:67], v[160:163]
  ds_read_b64_tr_b16 a[162:163], v4 offset:2048
  v_mfma_f32_16x16x32_bf16 v[160:163], a[168:171], a[80:83], v[160:163]
  ds_write_b128 v15, v[24:27]
  v_mfma_f32_16x16x32_bf16 v[164:167], a[168:171], a[84:87], v[164:167]
  ds_read_b64_tr_b16 a[164:165], v4 offset:4096
  v_mfma_f32_16x16x32_bf16 v[164:167], a[172:175], a[68:71], v[164:167]
  v_mfma_f32_16x16x32_bf16 v[168:171], a[172:175], a[72:75], v[168:171]
  ds_read_b64_tr_b16 a[166:167], v4 offset:6144
  s_waitcnt lgkmcnt(2)
  s_barrier
  v_mfma_f32_16x16x32_bf16 v[168:171], a[168:171], a[88:91], v[168:171]
  buffer_load_dwordx4 a[156:159], v1, s[8:11], s73 offen offset:1024 sc1
  ds_read_b128 v[24:27], v12 offset:384
  v_mfma_f32_16x16x32_bf16 v[172:175], a[168:171], a[92:95], v[172:175]
  ds_read_b64_tr_b16 a[168:169], v4 offset:8192
  v_mfma_f32_16x16x32_bf16 v[172:175], a[172:175], a[76:79], v[172:175]
  s_waitcnt lgkmcnt(7)
  s_cmp_eq_u32 s56, 2
  s_cselect_b32 s74, 14, 10
  s_mul_i32 s66, s74, 458752
  s_lshl_b32 s74, s74, 11
  s_add_u32 s74, s74, s57
  s_add_u32 m0, s45, 81920
  v_mfma_f32_16x16x32_bf16 v[188:191], a[180:183], a[76:79], v[188:191]
  ds_read_b64_tr_b16 a[170:171], v4 offset:10240
  v_mfma_f32_16x16x32_bf16 v[188:191], a[176:179], a[92:95], v[188:191]
  buffer_load_dwordx4 v11, s[28:31], s66 offen lds
  ds_read_b128 v[28:31], v12 offset:896
  v_mfma_f32_16x16x32_bf16 v[184:187], a[176:179], a[88:91], v[184:187]
  ds_read_b64_tr_b16 a[172:173], v4 offset:12288
  v_mfma_f32_16x16x32_bf16 v[184:187], a[180:183], a[72:75], v[184:187]
  v_mfma_f32_16x16x32_bf16 v[180:183], a[180:183], a[68:71], v[180:183]
  ds_read_b64_tr_b16 a[174:175], v4 offset:14336
  v_mfma_f32_16x16x32_bf16 v[180:183], a[176:179], a[84:87], v[180:183]
  s_add_u32 m0, s45, 90112
  s_waitcnt lgkmcnt(5)
  v_fmac_f32 v32, v16, v24
  v_mfma_f32_16x16x32_bf16 v[176:179], a[176:179], a[80:83], v[176:179]
  ds_read_b64_tr_b16 a[176:177], v5 offset:0
  v_fmac_f32 v33, v16, v25
  v_mfma_f32_16x16x32_bf16 v[176:179], a[180:183], a[64:67], v[176:179]
  s_waitcnt lgkmcnt(7)
  buffer_load_dwordx4 v11, s[32:35], s66 offen lds
  v_fmac_f32 v34, v16, v26
  v_mfma_f32_16x16x32_bf16 v[192:195], a[160:163], a[64:67], v[192:195]
  ds_read_b64_tr_b16 a[178:179], v5 offset:2048
  v_fmac_f32 v35, v16, v27
  v_mfma_f32_16x16x32_bf16 v[192:195], a[164:167], a[80:83], v[192:195]
  s_add_u32 m0, s45, 86016
  s_add_u32 s61, s66, 229376
  v_fmac_f32 v36, v18, v24
  v_mfma_f32_16x16x32_bf16 v[196:199], a[164:167], a[84:87], v[196:199]
  ds_read_b64_tr_b16 a[180:181], v5 offset:4096
  v_fmac_f32 v37, v18, v25
  v_mfma_f32_16x16x32_bf16 v[196:199], a[160:163], a[68:71], v[196:199]
  buffer_load_dwordx4 v11, s[28:31], s61 offen lds
  v_fmac_f32 v38, v18, v26
  v_fmac_f32 v39, v18, v27
  v_mfma_f32_16x16x32_bf16 v[200:203], a[160:163], a[72:75], v[200:203]
  ds_read_b64_tr_b16 a[182:183], v5 offset:6144
  v_fmac_f32 v40, v20, v24
  v_mfma_f32_16x16x32_bf16 v[200:203], a[164:167], a[88:91], v[200:203]
  v_fmac_f32 v41, v20, v25
  v_fmac_f32 v42, v20, v26
  v_mfma_f32_16x16x32_bf16 v[204:207], a[164:167], a[92:95], v[204:207]
  ds_read_b64_tr_b16 a[164:165], v5 offset:8192
  v_fmac_f32 v43, v20, v27
  v_mfma_f32_16x16x32_bf16 v[204:207], a[160:163], a[76:79], v[204:207]
  s_waitcnt lgkmcnt(5)
  s_add_u32 m0, s45, 94208
  s_add_u32 s61, s66, 229376
  v_mfma_f32_16x16x32_bf16 v[220:223], a[168:171], a[76:79], v[220:223]
  ds_read_b64_tr_b16 a[166:167], v5 offset:10240
  v_fmac_f32 v44, v22, v24
  v_mfma_f32_16x16x32_bf16 v[220:223], a[172:175], a[92:95], v[220:223]
  buffer_load_dwordx4 v11, s[32:35], s61 offen lds
  v_fmac_f32 v45, v22, v25
  v_fmac_f32 v46, v22, v26
  v_mfma_f32_16x16x32_bf16 v[216:219], a[172:175], a[88:91], v[216:219]
  ds_read_b64_tr_b16 a[160:161], v5 offset:12288
  v_fmac_f32 v47, v22, v27
  v_mfma_f32_16x16x32_bf16 v[216:219], a[168:171], a[72:75], v[216:219]
  s_cmp_eq_u32 s56, 3
  s_cselect_b32 s75, 15, 11
  s_mul_i32 s67, s75, 458752
  s_lshl_b32 s75, s75, 11
  s_add_u32 s75, s75, s57
  s_add_u32 m0, s45, 65536
  ds_read_b128 v[24:27], v12 offset:1408
  v_mfma_f32_16x16x32_bf16 v[212:215], a[168:171], a[68:71], v[212:215]
  ds_read_b64_tr_b16 a[162:163], v5 offset:14336
  s_waitcnt lgkmcnt(11)
  v_mfma_f32_16x16x32_bf16 v[212:215], a[172:175], a[84:87], v[212:215]
  buffer_load_dwordx4 v11, s[28:31], s67 offen lds
  s_waitcnt vmcnt(37)
  s_barrier
  v_mfma_f32_16x16x32_bf16 v[208:211], a[172:175], a[80:83], v[208:211]
  ds_read_b64_tr_b16 a[172:173], v6 offset:32768
  v_fmac_f32 v32, v17, v28
  v_mfma_f32_16x16x32_bf16 v[208:211], a[168:171], a[64:67], v[208:211]
  s_waitcnt lgkmcnt(6)
  v_fmac_f32 v33, v17, v29
  v_fmac_f32 v34, v17, v30
  v_mfma_f32_16x16x32_bf16 v[224:227], a[176:179], a[64:67], v[224:227]
  ds_read_b64_tr_b16 a[174:175], v6 offset:34816
  v_fmac_f32 v35, v17, v31
  v_mfma_f32_16x16x32_bf16 v[224:227], a[180:183], a[80:83], v[224:227]
  s_add_u32 m0, s45, 73728
  v_fmac_f32 v36, v19, v28
  v_fmac_f32 v37, v19, v29
  v_mfma_f32_16x16x32_bf16 v[228:231], a[180:183], a[84:87], v[228:231]
  ds_read_b64_tr_b16 a[168:169], v6 offset:36864
  v_fmac_f32 v38, v19, v30
  v_mfma_f32_16x16x32_bf16 v[228:231], a[176:179], a[68:71], v[228:231]
  buffer_load_dwordx4 v11, s[32:35], s67 offen lds
  v_fmac_f32 v39, v19, v31
  v_fmac_f32 v40, v21, v28
  v_mfma_f32_16x16x32_bf16 v[232:235], a[176:179], a[72:75], v[232:235]
  ds_read_b64_tr_b16 a[170:171], v6 offset:38912
  v_fmac_f32 v41, v21, v29
  v_mfma_f32_16x16x32_bf16 v[232:235], a[180:183], a[88:91], v[232:235]
  s_add_u32 m0, s45, 69632
  s_add_u32 s61, s67, 229376
  v_fmac_f32 v42, v21, v30
  v_mfma_f32_16x16x32_bf16 v[236:239], a[180:183], a[92:95], v[236:239]
  ds_read_b64_tr_b16 a[180:181], v6 offset:40960
  v_fmac_f32 v43, v21, v31
  v_mfma_f32_16x16x32_bf16 v[236:239], a[176:179], a[76:79], v[236:239]
  s_waitcnt lgkmcnt(5)
  buffer_load_dwordx4 v11, s[28:31], s61 offen lds
  v_fmac_f32 v44, v23, v28
  v_mfma_f32_16x16x32_bf16 v[252:255], a[164:167], a[76:79], v[252:255]
  ds_read_b64_tr_b16 a[182:183], v6 offset:43008
  v_fmac_f32 v45, v23, v29
  v_mfma_f32_16x16x32_bf16 v[252:255], a[160:163], a[92:95], v[252:255]
  v_fmac_f32 v46, v23, v30
  v_fmac_f32 v47, v23, v31
  v_mfma_f32_16x16x32_bf16 v[248:251], a[160:163], a[88:91], v[248:251]
  ds_read_b64_tr_b16 a[176:177], v6 offset:45056
  v_mfma_f32_16x16x32_bf16 v[248:251], a[164:167], a[72:75], v[248:251]
  s_add_u32 m0, s45, 77824
  s_add_u32 s61, s67, 229376
  v_mfma_f32_16x16x32_bf16 v[244:247], a[164:167], a[68:71], v[244:247]
  ds_read_b64_tr_b16 a[178:179], v6 offset:47104
  v_mfma_f32_16x16x32_bf16 v[244:247], a[160:163], a[84:87], v[244:247]
  buffer_load_dwordx4 v11, s[32:35], s61 offen lds
  ds_read_b128 v[28:31], v12 offset:1920
  v_mfma_f32_16x16x32_bf16 v[240:243], a[160:163], a[80:83], v[240:243]
  ds_read_b64_tr_b16 a[160:161], v7 offset:32768
  s_waitcnt lgkmcnt(11)
  v_mfma_f32_16x16x32_bf16 v[240:243], a[164:167], a[64:67], v[240:243]
  s_waitcnt vmcnt(24) lgkmcnt(6)
  s_add_u32 m0, s45, 16384
  v_fmac_f32 v48, v16, v24
  v_mfma_f32_16x16x32_bf16 v[64:67], a[172:175], a[96:99], v[64:67]
  ds_read_b64_tr_b16 a[162:163], v7 offset:34816
  v_fmac_f32 v49, v16, v25
  v_mfma_f32_16x16x32_bf16 v[64:67], a[168:171], a[112:115], v[64:67]
  buffer_load_dwordx4 v10, s[28:31], s66 offen lds
  v_fmac_f32 v50, v16, v26
  v_fmac_f32 v51, v16, v27
  v_mfma_f32_16x16x32_bf16 v[68:71], a[168:171], a[116:119], v[68:71]
  ds_read_b64_tr_b16 a[164:165], v7 offset:36864
  v_fmac_f32 v52, v18, v24
  v_mfma_f32_16x16x32_bf16 v[68:71], a[172:175], a[100:103], v[68:71]
  v_fmac_f32 v53, v18, v25
  v_fmac_f32 v54, v18, v26
  v_mfma_f32_16x16x32_bf16 v[72:75], a[172:175], a[104:107], v[72:75]
  ds_read_b64_tr_b16 a[166:167], v7 offset:38912
  v_fmac_f32 v55, v18, v27
  v_mfma_f32_16x16x32_bf16 v[72:75], a[168:171], a[120:123], v[72:75]
  s_add_u32 m0, s45, 24576
  v_fmac_f32 v56, v20, v24
  v_fmac_f32 v57, v20, v25
  v_mfma_f32_16x16x32_bf16 v[76:79], a[168:171], a[124:127], v[76:79]
  ds_read_b64_tr_b16 a[168:169], v7 offset:40960
  v_fmac_f32 v58, v20, v26
  v_mfma_f32_16x16x32_bf16 v[76:79], a[172:175], a[108:111], v[76:79]
  s_waitcnt lgkmcnt(6)
  buffer_load_dwordx4 v10, s[32:35], s66 offen lds
  v_fmac_f32 v59, v20, v27
  v_mfma_f32_16x16x32_bf16 v[92:95], a[180:183], a[108:111], v[92:95]
  ds_read_b64_tr_b16 a[170:171], v7 offset:43008
  v_fmac_f32 v60, v22, v24
  v_mfma_f32_16x16x32_bf16 v[92:95], a[176:179], a[124:127], v[92:95]
  s_add_u32 m0, s45, 20480
  s_add_u32 s61, s66, 229376
  v_fmac_f32 v61, v22, v25
  v_mfma_f32_16x16x32_bf16 v[88:91], a[176:179], a[120:123], v[88:91]
  ds_read_b64_tr_b16 a[172:173], v7 offset:45056
  v_fmac_f32 v62, v22, v26
  v_mfma_f32_16x16x32_bf16 v[88:91], a[180:183], a[104:107], v[88:91]
  buffer_load_dwordx4 v10, s[28:31], s61 offen lds
  v_fmac_f32 v63, v22, v27
  v_mfma_f32_16x16x32_bf16 v[84:87], a[180:183], a[100:103], v[84:87]
  ds_read_b64_tr_b16 a[174:175], v7 offset:47104
  v_mfma_f32_16x16x32_bf16 v[84:87], a[176:179], a[116:119], v[84:87]
  ds_read_b128 v[24:27], v12 offset:256
  s_waitcnt lgkmcnt(9)
  v_mfma_f32_16x16x32_bf16 v[80:83], a[176:179], a[112:115], v[80:83]
  ds_read_b64_tr_b16 a[176:177], v8 offset:32768
  v_fmac_f32 v48, v17, v28
  v_mfma_f32_16x16x32_bf16 v[80:83], a[180:183], a[96:99], v[80:83]
  s_waitcnt lgkmcnt(6)
  s_add_u32 m0, s45, 28672
  s_add_u32 s61, s66, 229376
  v_mfma_f32_16x16x32_bf16 v[96:99], a[160:163], a[96:99], v[96:99]
  ds_read_b64_tr_b16 a[178:179], v8 offset:34816
  v_fmac_f32 v49, v17, v29
  v_mfma_f32_16x16x32_bf16 v[96:99], a[164:167], a[112:115], v[96:99]
  buffer_load_dwordx4 v10, s[32:35], s61 offen lds
  v_fmac_f32 v50, v17, v30
  v_fmac_f32 v51, v17, v31
  v_mfma_f32_16x16x32_bf16 v[100:103], a[164:167], a[116:119], v[100:103]
  ds_read_b64_tr_b16 a[180:181], v8 offset:36864
  v_fmac_f32 v52, v19, v28
  v_mfma_f32_16x16x32_bf16 v[100:103], a[160:163], a[100:103], v[100:103]
  v_fmac_f32 v53, v19, v29
  v_fmac_f32 v54, v19, v30
  v_mfma_f32_16x16x32_bf16 v[104:107], a[160:163], a[104:107], v[104:107]
  ds_read_b64_tr_b16 a[182:183], v8 offset:38912
  v_fmac_f32 v55, v19, v31
  v_mfma_f32_16x16x32_bf16 v[104:107], a[164:167], a[120:123], v[104:107]
  buffer_load_dwordx4 a[0:3], v1, s[8:11], s74 offen offset:0 sc1
  v_fmac_f32 v56, v21, v28
  v_fmac_f32 v57, v21, v29
  v_mfma_f32_16x16x32_bf16 v[108:111], a[164:167], a[124:127], v[108:111]
  ds_read_b64_tr_b16 a[164:165], v8 offset:40960
  v_fmac_f32 v58, v21, v30
  v_mfma_f32_16x16x32_bf16 v[108:111], a[160:163], a[108:111], v[108:111]
  s_waitcnt lgkmcnt(6)
  v_fmac_f32 v59, v21, v31
  v_fmac_f32 v60, v23, v28
  v_mfma_f32_16x16x32_bf16 v[124:127], a[168:171], a[108:111], v[124:127]
  ds_read_b64_tr_b16 a[166:167], v8 offset:43008
  v_fmac_f32 v61, v23, v29
HOP11:
  s_cbranch_execz HOP14
  v_mfma_f32_16x16x32_bf16 v[124:127], a[172:175], a[124:127], v[124:127]
  v_fmac_f32 v62, v23, v30
  v_fmac_f32 v63, v23, v31
  v_mfma_f32_16x16x32_bf16 v[120:123], a[172:175], a[120:123], v[120:123]
  ds_read_b64_tr_b16 a[160:161], v8 offset:45056
  v_mfma_f32_16x16x32_bf16 v[120:123], a[168:171], a[104:107], v[120:123]
  buffer_load_dwordx4 a[16:19], v1, s[8:11], s74 offen offset:1024 sc1
  ds_read_b128 v[28:31], v12 offset:768
  v_mfma_f32_16x16x32_bf16 v[116:119], a[168:171], a[100:103], v[116:119]
  ds_read_b64_tr_b16 a[162:163], v8 offset:47104
  s_waitcnt lgkmcnt(9)
  v_mfma_f32_16x16x32_bf16 v[116:119], a[172:175], a[116:119], v[116:119]
  s_add_u32 s74, s74, 65536
  v_fmac_f32 v64, v16, v24
  v_fmac_f32 v65, v16, v25
  v_mfma_f32_16x16x32_bf16 v[112:115], a[172:175], a[112:115], v[112:115]
  ds_read_b64_tr_b16 a[172:173], v2 offset:32768
  v_fmac_f32 v66, v16, v26
  v_mfma_f32_16x16x32_bf16 v[112:115], a[168:171], a[96:99], v[112:115]
  s_waitcnt lgkmcnt(6)
  buffer_load_dwordx4 a[4:7], v1, s[8:11], s74 offen offset:0 sc1
  v_fmac_f32 v67, v16, v27
  v_mfma_f32_16x16x32_bf16 v[32:35], a[176:179], a[96:99], v[32:35]
  ds_read_b64_tr_b16 a[174:175], v2 offset:34816
  v_fmac_f32 v68, v18, v24
  v_mfma_f32_16x16x32_bf16 v[32:35], a[180:183], a[112:115], v[32:35]
  v_fmac_f32 v69, v18, v25
  v_fmac_f32 v70, v18, v26
  v_mfma_f32_16x16x32_bf16 v[36:39], a[180:183], a[116:119], v[36:39]
  ds_read_b64_tr_b16 a[168:169], v2 offset:36864
  v_fmac_f32 v71, v18, v27
  v_mfma_f32_16x16x32_bf16 v[36:39], a[176:179], a[100:103], v[36:39]
  v_fmac_f32 v72, v20, v24
  v_fmac_f32 v73, v20, v25
  v_mfma_f32_16x16x32_bf16 v[40:43], a[176:179], a[104:107], v[40:43]
  ds_read_b64_tr_b16 a[170:171], v2 offset:38912
  v_fmac_f32 v74, v20, v26
  v_mfma_f32_16x16x32_bf16 v[40:43], a[180:183], a[120:123], v[40:43]
  buffer_load_dwordx4 a[20:23], v1, s[8:11], s74 offen offset:1024 sc1
  v_fmac_f32 v75, v20, v27
  v_fmac_f32 v76, v22, v24
  v_mfma_f32_16x16x32_bf16 v[44:47], a[180:183], a[124:127], v[44:47]
  ds_read_b64_tr_b16 a[180:181], v2 offset:40960
  v_fmac_f32 v77, v22, v25
  v_mfma_f32_16x16x32_bf16 v[44:47], a[176:179], a[108:111], v[44:47]
  s_waitcnt lgkmcnt(5)
  s_add_u32 s74, s74, 65536
  v_fmac_f32 v78, v22, v26
  v_mfma_f32_16x16x32_bf16 v[60:63], a[164:167], a[108:111], v[60:63]
  ds_read_b64_tr_b16 a[182:183], v2 offset:43008
  v_fmac_f32 v79, v22, v27
  v_mfma_f32_16x16x32_bf16 v[60:63], a[160:163], a[124:127], v[60:63]
  buffer_load_dwordx4 a[8:11], v1, s[8:11], s74 offen offset:0 sc1
  ds_read_b128 v[24:27], v12 offset:1280
  v_mfma_f32_16x16x32_bf16 v[56:59], a[160:163], a[120:123], v[56:59]
  ds_read_b64_tr_b16 a[176:177], v2 offset:45056
  s_waitcnt lgkmcnt(9)
  v_mfma_f32_16x16x32_bf16 v[56:59], a[164:167], a[104:107], v[56:59]
  v_fmac_f32 v64, v17, v28
  v_fmac_f32 v65, v17, v29
  v_mfma_f32_16x16x32_bf16 v[52:55], a[164:167], a[100:103], v[52:55]
  ds_read_b64_tr_b16 a[178:179], v2 offset:47104
  v_fmac_f32 v66, v17, v30
  v_mfma_f32_16x16x32_bf16 v[52:55], a[160:163], a[116:119], v[52:55]
  v_fmac_f32 v67, v17, v31
  v_fmac_f32 v68, v19, v28
  v_mfma_f32_16x16x32_bf16 v[48:51], a[160:163], a[112:115], v[48:51]
  ds_read_b64_tr_b16 a[160:161], v3 offset:32768
  v_fmac_f32 v69, v19, v29
  v_mfma_f32_16x16x32_bf16 v[48:51], a[164:167], a[96:99], v[48:51]
  s_waitcnt lgkmcnt(6)
  buffer_load_dwordx4 a[24:27], v1, s[8:11], s74 offen offset:1024 sc1
  v_fmac_f32 v70, v19, v30
  v_mfma_f32_16x16x32_bf16 v[128:131], a[172:175], a[96:99], v[128:131]
  ds_read_b64_tr_b16 a[162:163], v3 offset:34816
  v_fmac_f32 v71, v19, v31
  v_mfma_f32_16x16x32_bf16 v[128:131], a[168:171], a[112:115], v[128:131]
  s_add_u32 s74, s74, 65536
  v_fmac_f32 v72, v21, v28
  v_fmac_f32 v73, v21, v29
  v_mfma_f32_16x16x32_bf16 v[132:135], a[168:171], a[116:119], v[132:135]
  ds_read_b64_tr_b16 a[164:165], v3 offset:36864
  v_fmac_f32 v74, v21, v30
  v_mfma_f32_16x16x32_bf16 v[132:135], a[172:175], a[100:103], v[132:135]
  buffer_load_dwordx4 a[12:15], v1, s[8:11], s74 offen offset:0 sc1
  v_fmac_f32 v75, v21, v31
  v_fmac_f32 v76, v23, v28
  v_mfma_f32_16x16x32_bf16 v[136:139], a[172:175], a[104:107], v[136:139]
  ds_read_b64_tr_b16 a[166:167], v3 offset:38912
  v_fmac_f32 v77, v23, v29
  v_mfma_f32_16x16x32_bf16 v[136:139], a[168:171], a[120:123], v[136:139]
  v_fmac_f32 v78, v23, v30
  v_fmac_f32 v79, v23, v31
  v_mfma_f32_16x16x32_bf16 v[140:143], a[168:171], a[124:127], v[140:143]
  ds_read_b64_tr_b16 a[168:169], v3 offset:40960
  v_mfma_f32_16x16x32_bf16 v[140:143], a[172:175], a[108:111], v[140:143]
  s_waitcnt lgkmcnt(5)
  ds_read_b128 v[28:31], v12 offset:1792
  v_mfma_f32_16x16x32_bf16 v[156:159], a[180:183], a[108:111], v[156:159]
  ds_read_b64_tr_b16 a[170:171], v3 offset:43008
  v_mfma_f32_16x16x32_bf16 v[156:159], a[176:179], a[124:127], v[156:159]
  buffer_load_dwordx4 a[28:31], v1, s[8:11], s74 offen offset:1024 sc1
  v_mfma_f32_16x16x32_bf16 v[152:155], a[176:179], a[120:123], v[152:155]
  ds_read_b64_tr_b16 a[172:173], v3 offset:45056
  s_waitcnt lgkmcnt(10)
  v_mfma_f32_16x16x32_bf16 v[152:155], a[180:183], a[104:107], v[152:155]
  v_fmac_f32 v80, v16, v24
  v_fmac_f32 v81, v16, v25
  v_mfma_f32_16x16x32_bf16 v[148:151], a[180:183], a[100:103], v[148:151]
  ds_read_b64_tr_b16 a[174:175], v3 offset:47104
  v_fmac_f32 v82, v16, v26
  v_mfma_f32_16x16x32_bf16 v[148:151], a[176:179], a[116:119], v[148:151]
  buffer_load_dwordx4 a[32:35], v1, s[8:11], s75 offen offset:0 sc1
  v_fmac_f32 v83, v16, v27
  v_fmac_f32 v84, v18, v24
  v_mfma_f32_16x16x32_bf16 v[144:147], a[176:179], a[112:115], v[144:147]
  ds_read_b64_tr_b16 a[176:177], v4 offset:32768
  v_fmac_f32 v85, v18, v25
  v_mfma_f32_16x16x32_bf16 v[144:147], a[180:183], a[96:99], v[144:147]
  s_waitcnt lgkmcnt(6)
  v_fmac_f32 v86, v18, v26
  v_fmac_f32 v87, v18, v27
  v_mfma_f32_16x16x32_bf16 v[160:163], a[160:163], a[96:99], v[160:163]
  ds_read_b64_tr_b16 a[178:179], v4 offset:34816
  v_fmac_f32 v88, v20, v24
  v_mfma_f32_16x16x32_bf16 v[160:163], a[164:167], a[112:115], v[160:163]
  v_fmac_f32 v89, v20, v25
  v_fmac_f32 v90, v20, v26
  v_mfma_f32_16x16x32_bf16 v[164:167], a[164:167], a[116:119], v[164:167]
  ds_read_b64_tr_b16 a[180:181], v4 offset:36864
  v_fmac_f32 v91, v20, v27
  v_mfma_f32_16x16x32_bf16 v[164:167], a[160:163], a[100:103], v[164:167]
  buffer_load_dwordx4 a[48:51], v1, s[8:11], s75 offen offset:1024 sc1
  v_fmac_f32 v92, v22, v24
  v_fmac_f32 v93, v22, v25
  v_mfma_f32_16x16x32_bf16 v[168:171], a[160:163], a[104:107], v[168:171]
  ds_read_b64_tr_b16 a[182:183], v4 offset:38912
  v_fmac_f32 v94, v22, v26
  v_mfma_f32_16x16x32_bf16 v[168:171], a[164:167], a[120:123], v[168:171]
  s_add_u32 s75, s75, 65536
  v_fmac_f32 v95, v22, v27
  v_mfma_f32_16x16x32_bf16 v[172:175], a[164:167], a[124:127], v[172:175]
  ds_read_b64_tr_b16 a[164:165], v4 offset:40960
  v_mfma_f32_16x16x32_bf16 v[172:175], a[160:163], a[108:111], v[172:175]
  s_waitcnt lgkmcnt(5)
  buffer_load_dwordx4 a[36:39], v1, s[8:11], s75 offen offset:0 sc1
  v_mfma_f32_16x16x32_bf16 v[188:191], a[168:171], a[108:111], v[188:191]
  ds_read_b64_tr_b16 a[166:167], v4 offset:43008
  v_mfma_f32_16x16x32_bf16 v[188:191], a[172:175], a[124:127], v[188:191]
  ds_read_b128 v[24:27], v12 offset:320
  s_waitcnt lgkmcnt(10)
  v_mfma_f32_16x16x32_bf16 v[184:187], a[172:175], a[120:123], v[184:187]
  ds_read_b64_tr_b16 a[160:161], v4 offset:45056
  v_fmac_f32 v80, v17, v28
  v_mfma_f32_16x16x32_bf16 v[184:187], a[168:171], a[104:107], v[184:187]
  v_fmac_f32 v81, v17, v29
  v_fmac_f32 v82, v17, v30
  v_mfma_f32_16x16x32_bf16 v[180:183], a[168:171], a[100:103], v[180:183]
  ds_read_b64_tr_b16 a[162:163], v4 offset:47104
  v_fmac_f32 v83, v17, v31
  v_mfma_f32_16x16x32_bf16 v[180:183], a[172:175], a[116:119], v[180:183]
  buffer_load_dwordx4 a[52:55], v1, s[8:11], s75 offen offset:1024 sc1
  v_fmac_f32 v84, v19, v28
  v_fmac_f32 v85, v19, v29
  v_mfma_f32_16x16x32_bf16 v[176:179], a[172:175], a[112:115], v[176:179]
  ds_read_b64_tr_b16 a[172:173], v5 offset:32768
  v_fmac_f32 v86, v19, v30
  v_mfma_f32_16x16x32_bf16 v[176:179], a[168:171], a[96:99], v[176:179]
  s_waitcnt lgkmcnt(6)
  s_add_u32 s75, s75, 65536
  v_fmac_f32 v87, v19, v31
  v_mfma_f32_16x16x32_bf16 v[192:195], a[176:179], a[96:99], v[192:195]
  ds_read_b64_tr_b16 a[174:175], v5 offset:34816
  v_fmac_f32 v88, v21, v28
  v_mfma_f32_16x16x32_bf16 v[192:195], a[180:183], a[112:115], v[192:195]
  buffer_load_dwordx4 a[40:43], v1, s[8:11], s75 offen offset:0 sc1
  v_fmac_f32 v89, v21, v29
  v_fmac_f32 v90, v21, v30
  v_mfma_f32_16x16x32_bf16 v[196:199], a[180:183], a[116:119], v[196:199]
  ds_read_b64_tr_b16 a[168:169], v5 offset:36864
  v_fmac_f32 v91, v21, v31
  v_mfma_f32_16x16x32_bf16 v[196:199], a[176:179], a[100:103], v[196:199]
  v_fmac_f32 v92, v23, v28
  v_fmac_f32 v93, v23, v29
  v_mfma_f32_16x16x32_bf16 v[200:203], a[176:179], a[104:107], v[200:203]
  ds_read_b64_tr_b16 a[170:171], v5 offset:38912
  v_fmac_f32 v94, v23, v30
  v_mfma_f32_16x16x32_bf16 v[200:203], a[180:183], a[120:123], v[200:203]
  v_fmac_f32 v95, v23, v31
  v_mfma_f32_16x16x32_bf16 v[204:207], a[180:183], a[124:127], v[204:207]
  ds_read_b64_tr_b16 a[180:181], v5 offset:40960
  v_mfma_f32_16x16x32_bf16 v[204:207], a[176:179], a[108:111], v[204:207]
  s_waitcnt lgkmcnt(5)
  buffer_load_dwordx4 a[56:59], v1, s[8:11], s75 offen offset:1024 sc1
  v_mfma_f32_16x16x32_bf16 v[220:223], a[164:167], a[108:111], v[220:223]
  ds_read_b64_tr_b16 a[182:183], v5 offset:43008
  v_mfma_f32_16x16x32_bf16 v[220:223], a[160:163], a[124:127], v[220:223]
  s_add_u32 s75, s75, 65536
  ds_read_b128 v[28:31], v12 offset:832
  v_mfma_f32_16x16x32_bf16 v[216:219], a[160:163], a[120:123], v[216:219]
  ds_read_b64_tr_b16 a[176:177], v5 offset:45056
  s_waitcnt lgkmcnt(10)
  v_mfma_f32_16x16x32_bf16 v[216:219], a[164:167], a[104:107], v[216:219]
  buffer_load_dwordx4 a[44:47], v1, s[8:11], s75 offen offset:0 sc1
  v_fmac_f32 v96, v16, v24
  v_fmac_f32 v97, v16, v25
  v_mfma_f32_16x16x32_bf16 v[212:215], a[164:167], a[100:103], v[212:215]
  ds_read_b64_tr_b16 a[178:179], v5 offset:47104
  v_fmac_f32 v98, v16, v26
  v_mfma_f32_16x16x32_bf16 v[212:215], a[160:163], a[116:119], v[212:215]
  s_waitcnt vmcnt(35)
  s_barrier
  v_mfma_f32_16x16x32_bf16 v[208:211], a[160:163], a[112:115], v[208:211]
  ds_read_b64_tr_b16 a[160:161], v6 offset:49152
  v_fmac_f32 v99, v16, v27
  v_mfma_f32_16x16x32_bf16 v[208:211], a[164:167], a[96:99], v[208:211]
  s_waitcnt lgkmcnt(6)
  v_fmac_f32 v100, v18, v24
  v_fmac_f32 v101, v18, v25
  v_mfma_f32_16x16x32_bf16 v[224:227], a[172:175], a[96:99], v[224:227]
  ds_read_b64_tr_b16 a[162:163], v6 offset:51200
  v_fmac_f32 v102, v18, v26
  v_mfma_f32_16x16x32_bf16 v[224:227], a[168:171], a[112:115], v[224:227]
  buffer_load_dwordx4 a[60:63], v1, s[8:11], s75 offen offset:1024 sc1
  v_fmac_f32 v103, v18, v27
  v_fmac_f32 v104, v20, v24
  v_mfma_f32_16x16x32_bf16 v[228:231], a[168:171], a[116:119], v[228:231]
  ds_read_b64_tr_b16 a[164:165], v6 offset:53248
  v_fmac_f32 v105, v20, v25
  v_mfma_f32_16x16x32_bf16 v[228:231], a[172:175], a[100:103], v[228:231]
  s_cmp_eq_u32 s56, 0
  s_cselect_b32 s76, 4, 12
  s_mul_i32 s68, s76, 458752
  s_lshl_b32 s76, s76, 11
  s_add_u32 s76, s76, s57
  s_add_u32 m0, s45, 98304
  v_fmac_f32 v106, v20, v26
  v_fmac_f32 v107, v20, v27
  v_mfma_f32_16x16x32_bf16 v[232:235], a[172:175], a[104:107], v[232:235]
  ds_read_b64_tr_b16 a[166:167], v6 offset:55296
  v_fmac_f32 v108, v22, v24
  v_mfma_f32_16x16x32_bf16 v[232:235], a[168:171], a[120:123], v[232:235]
  buffer_load_dwordx4 v11, s[28:31], s68 offen lds
  v_fmac_f32 v109, v22, v25
  v_fmac_f32 v110, v22, v26
  v_mfma_f32_16x16x32_bf16 v[236:239], a[168:171], a[124:127], v[236:239]
  ds_read_b64_tr_b16 a[168:169], v6 offset:57344
  v_fmac_f32 v111, v22, v27
  v_mfma_f32_16x16x32_bf16 v[236:239], a[172:175], a[108:111], v[236:239]
  s_waitcnt lgkmcnt(5)
  ds_read_b128 v[24:27], v12 offset:0
  v_mfma_f32_16x16x32_bf16 v[252:255], a[180:183], a[108:111], v[252:255]
  ds_read_b64_tr_b16 a[170:171], v6 offset:59392
  s_waitcnt lgkmcnt(9)
  v_mfma_f32_16x16x32_bf16 v[252:255], a[176:179], a[124:127], v[252:255]
  s_add_u32 m0, s45, 106496
  v_fmac_f32 v96, v17, v28
  v_fmac_f32 v97, v17, v29
  v_mfma_f32_16x16x32_bf16 v[248:251], a[176:179], a[120:123], v[248:251]
  ds_read_b64_tr_b16 a[172:173], v6 offset:61440
  v_fmac_f32 v98, v17, v30
  v_mfma_f32_16x16x32_bf16 v[248:251], a[180:183], a[104:107], v[248:251]
  buffer_load_dwordx4 v11, s[32:35], s68 offen lds
  v_fmac_f32 v99, v17, v31
  v_fmac_f32 v100, v19, v28
  v_mfma_f32_16x16x32_bf16 v[244:247], a[180:183], a[100:103], v[244:247]
  ds_read_b64_tr_b16 a[174:175], v6 offset:63488
  v_fmac_f32 v101, v19, v29
  v_mfma_f32_16x16x32_bf16 v[244:247], a[176:179], a[116:119], v[244:247]
  s_add_u32 m0, s45, 102400
  s_add_u32 s61, s68, 229376
  v_fmac_f32 v102, v19, v30
  v_mfma_f32_16x16x32_bf16 v[240:243], a[176:179], a[112:115], v[240:243]
  ds_read_b64_tr_b16 a[176:177], v7 offset:49152
  v_fmac_f32 v103, v19, v31
  v_mfma_f32_16x16x32_bf16 v[240:243], a[180:183], a[96:99], v[240:243]
  s_waitcnt vmcnt(30) lgkmcnt(6)
  buffer_load_dwordx4 v11, s[28:31], s61 offen lds
  v_fmac_f32 v104, v21, v28
  v_mfma_f32_16x16x32_bf16 v[64:67], a[160:163], a[128:131], v[64:67]
  ds_read_b64_tr_b16 a[178:179], v7 offset:51200
  v_fmac_f32 v105, v21, v29
  v_mfma_f32_16x16x32_bf16 v[64:67], a[164:167], a[144:147], v[64:67]
  v_fmac_f32 v106, v21, v30
  v_fmac_f32 v107, v21, v31
  v_mfma_f32_16x16x32_bf16 v[68:71], a[164:167], a[148:151], v[68:71]
  ds_read_b64_tr_b16 a[180:181], v7 offset:53248
  v_fmac_f32 v108, v23, v28
  v_mfma_f32_16x16x32_bf16 v[68:71], a[160:163], a[132:135], v[68:71]
  s_add_u32 m0, s45, 110592
  s_add_u32 s61, s68, 229376
  v_fmac_f32 v109, v23, v29
  v_mfma_f32_16x16x32_bf16 v[72:75], a[160:163], a[136:139], v[72:75]
  ds_read_b64_tr_b16 a[182:183], v7 offset:55296
  v_fmac_f32 v110, v23, v30
  v_mfma_f32_16x16x32_bf16 v[72:75], a[164:167], a[152:155], v[72:75]
  buffer_load_dwordx4 v11, s[32:35], s61 offen lds
  v_fmac_f32 v111, v23, v31
  v_mfma_f32_16x16x32_bf16 v[76:79], a[164:167], a[156:159], v[76:79]
  ds_read_b64_tr_b16 a[164:165], v7 offset:57344
  v_mfma_f32_16x16x32_bf16 v[76:79], a[160:163], a[140:143], v[76:79]
  s_waitcnt lgkmcnt(5)
  v_mfma_f32_16x16x32_bf16 v[92:95], a[168:171], a[140:143], v[92:95]
  ds_read_b64_tr_b16 a[166:167], v7 offset:59392
  v_mfma_f32_16x16x32_bf16 v[92:95], a[172:175], a[156:159], v[92:95]
  buffer_load_dwordx4 a[64:67], v1, s[8:11], s76 offen offset:0 sc1
  ds_read_b128 v[28:31], v12 offset:512
  v_mfma_f32_16x16x32_bf16 v[88:91], a[172:175], a[152:155], v[88:91]
  ds_read_b64_tr_b16 a[160:161], v7 offset:61440
  s_waitcnt lgkmcnt(11)
  v_mfma_f32_16x16x32_bf16 v[88:91], a[168:171], a[136:139], v[88:91]
  v_fmac_f32 v128, v16, v24
  v_fmac_f32 v129, v16, v25
  v_mfma_f32_16x16x32_bf16 v[84:87], a[168:171], a[132:135], v[84:87]
  ds_read_b64_tr_b16 a[162:163], v7 offset:63488
  v_fmac_f32 v130, v16, v26
  v_mfma_f32_16x16x32_bf16 v[84:87], a[172:175], a[148:151], v[84:87]
  v_fmac_f32 v131, v16, v27
  v_fmac_f32 v132, v18, v24
  v_mfma_f32_16x16x32_bf16 v[80:83], a[172:175], a[144:147], v[80:83]
  ds_read_b64_tr_b16 a[172:173], v8 offset:49152
  v_fmac_f32 v133, v18, v25
  v_mfma_f32_16x16x32_bf16 v[80:83], a[168:171], a[128:131], v[80:83]
  s_waitcnt lgkmcnt(6)
  buffer_load_dwordx4 a[80:83], v1, s[8:11], s76 offen offset:1024 sc1
  v_fmac_f32 v134, v18, v26
  v_mfma_f32_16x16x32_bf16 v[96:99], a[176:179], a[128:131], v[96:99]
  ds_read_b64_tr_b16 a[174:175], v8 offset:51200
  v_fmac_f32 v135, v18, v27
  v_mfma_f32_16x16x32_bf16 v[96:99], a[180:183], a[144:147], v[96:99]
  s_add_u32 s76, s76, 65536
  v_fmac_f32 v136, v20, v24
  v_fmac_f32 v137, v20, v25
  v_mfma_f32_16x16x32_bf16 v[100:103], a[180:183], a[148:151], v[100:103]
  ds_read_b64_tr_b16 a[168:169], v8 offset:53248
  v_fmac_f32 v138, v20, v26
  v_mfma_f32_16x16x32_bf16 v[100:103], a[176:179], a[132:135], v[100:103]
  buffer_load_dwordx4 a[68:71], v1, s[8:11], s76 offen offset:0 sc1
  v_fmac_f32 v139, v20, v27
  v_fmac_f32 v140, v22, v24
  v_mfma_f32_16x16x32_bf16 v[104:107], a[176:179], a[136:139], v[104:107]
  ds_read_b64_tr_b16 a[170:171], v8 offset:55296
  v_fmac_f32 v141, v22, v25
  v_mfma_f32_16x16x32_bf16 v[104:107], a[180:183], a[152:155], v[104:107]
  v_fmac_f32 v142, v22, v26
  v_fmac_f32 v143, v22, v27
  v_mfma_f32_16x16x32_bf16 v[108:111], a[180:183], a[156:159], v[108:111]
  ds_read_b64_tr_b16 a[180:181], v8 offset:57344
  v_mfma_f32_16x16x32_bf16 v[108:111], a[176:179], a[140:143], v[108:111]
  s_waitcnt lgkmcnt(5)
  s_add_u32 s62, s92, 0
  v_mfma_f32_16x16x32_bf16 v[124:127], a[164:167], a[140:143], v[124:127]
  ds_read_b64_tr_b16 a[182:183], v8 offset:59392
  v_mfma_f32_16x16x32_bf16 v[124:127], a[160:163], a[156:159], v[124:127]
  buffer_load_dword a253, v13, s[36:39], s62 offen
  ds_read_b128 v[24:27], v12 offset:1344
  v_mfma_f32_16x16x32_bf16 v[120:123], a[160:163], a[152:155], v[120:123]
  ds_read_b64_tr_b16 a[176:177], v8 offset:61440
  s_waitcnt lgkmcnt(10)
  v_mfma_f32_16x16x32_bf16 v[120:123], a[164:167], a[136:139], v[120:123]
  v_fmac_f32 v128, v17, v28
  v_fmac_f32 v129, v17, v29
  v_mfma_f32_16x16x32_bf16 v[116:119], a[164:167], a[132:135], v[116:119]
  ds_read_b64_tr_b16 a[178:179], v8 offset:63488
  v_fmac_f32 v130, v17, v30
  v_mfma_f32_16x16x32_bf16 v[116:119], a[160:163], a[148:151], v[116:119]
  v_fmac_f32 v131, v17, v31
  v_fmac_f32 v132, v19, v28
  v_mfma_f32_16x16x32_bf16 v[112:115], a[160:163], a[144:147], v[112:115]
  ds_read_b64_tr_b16 a[160:161], v2 offset:49152
  v_fmac_f32 v133, v19, v29
  v_mfma_f32_16x16x32_bf16 v[112:115], a[164:167], a[128:131], v[112:115]
  s_waitcnt lgkmcnt(6)
  v_fmac_f32 v134, v19, v30
  v_fmac_f32 v135, v19, v31
  v_mfma_f32_16x16x32_bf16 v[32:35], a[172:175], a[128:131], v[32:35]
  ds_read_b64_tr_b16 a[162:163], v2 offset:51200
  v_fmac_f32 v136, v21, v28
  v_mfma_f32_16x16x32_bf16 v[32:35], a[168:171], a[144:147], v[32:35]
  v_fmac_f32 v137, v21, v29
  v_fmac_f32 v138, v21, v30
  v_mfma_f32_16x16x32_bf16 v[36:39], a[168:171], a[148:151], v[36:39]
  ds_read_b64_tr_b16 a[164:165], v2 offset:53248
  v_fmac_f32 v139, v21, v31
  v_mfma_f32_16x16x32_bf16 v[36:39], a[172:175], a[132:135], v[36:39]
  buffer_load_dwordx4 a[84:87], v1, s[8:11], s76 offen offset:1024 sc1
  v_fmac_f32 v140, v23, v28
  v_fmac_f32 v141, v23, v29
  v_mfma_f32_16x16x32_bf16 v[40:43], a[172:175], a[136:139], v[40:43]
  ds_read_b64_tr_b16 a[166:167], v2 offset:55296
  v_fmac_f32 v142, v23, v30
  v_mfma_f32_16x16x32_bf16 v[40:43], a[168:171], a[152:155], v[40:43]
  s_add_u32 s76, s76, 65536
  v_fmac_f32 v143, v23, v31
  v_mfma_f32_16x16x32_bf16 v[44:47], a[168:171], a[156:159], v[44:47]
  ds_read_b64_tr_b16 a[168:169], v2 offset:57344
  v_mfma_f32_16x16x32_bf16 v[44:47], a[172:175], a[140:143], v[44:47]
  s_waitcnt lgkmcnt(5)
  buffer_load_dwordx4 a[72:75], v1, s[8:11], s76 offen offset:0 sc1
  v_mfma_f32_16x16x32_bf16 v[60:63], a[180:183], a[140:143], v[60:63]
  ds_read_b64_tr_b16 a[170:171], v2 offset:59392
  v_mfma_f32_16x16x32_bf16 v[60:63], a[176:179], a[156:159], v[60:63]
  ds_read_b128 v[28:31], v12 offset:1856
  v_mfma_f32_16x16x32_bf16 v[56:59], a[176:179], a[152:155], v[56:59]
  ds_read_b64_tr_b16 a[172:173], v2 offset:61440
  s_waitcnt lgkmcnt(10)
  v_mfma_f32_16x16x32_bf16 v[56:59], a[180:183], a[136:139], v[56:59]
  v_fmac_f32 v112, v16, v24
  v_fmac_f32 v113, v16, v25
  v_mfma_f32_16x16x32_bf16 v[52:55], a[180:183], a[132:135], v[52:55]
  ds_read_b64_tr_b16 a[174:175], v2 offset:63488
  v_fmac_f32 v114, v16, v26
  v_mfma_f32_16x16x32_bf16 v[52:55], a[176:179], a[148:151], v[52:55]
  buffer_load_dwordx4 a[88:91], v1, s[8:11], s76 offen offset:1024 sc1
  v_fmac_f32 v115, v16, v27
  v_fmac_f32 v116, v18, v24
  v_mfma_f32_16x16x32_bf16 v[48:51], a[176:179], a[144:147], v[48:51]
  ds_read_b64_tr_b16 a[176:177], v3 offset:49152
  v_fmac_f32 v117, v18, v25
  v_mfma_f32_16x16x32_bf16 v[48:51], a[180:183], a[128:131], v[48:51]
  s_waitcnt lgkmcnt(6)
  s_add_u32 s76, s76, 65536
  v_fmac_f32 v118, v18, v26
  v_mfma_f32_16x16x32_bf16 v[128:131], a[160:163], a[128:131], v[128:131]
  ds_read_b64_tr_b16 a[178:179], v3 offset:51200
  v_fmac_f32 v119, v18, v27
  v_mfma_f32_16x16x32_bf16 v[128:131], a[164:167], a[144:147], v[128:131]
  buffer_load_dwordx4 a[76:79], v1, s[8:11], s76 offen offset:0 sc1
  v_fmac_f32 v120, v20, v24
  v_fmac_f32 v121, v20, v25
  v_mfma_f32_16x16x32_bf16 v[132:135], a[164:167], a[148:151], v[132:135]
  ds_read_b64_tr_b16 a[180:181], v3 offset:53248
  v_fmac_f32 v122, v20, v26
  v_mfma_f32_16x16x32_bf16 v[132:135], a[160:163], a[132:135], v[132:135]
  v_fmac_f32 v123, v20, v27
  v_fmac_f32 v124, v22, v24
  v_mfma_f32_16x16x32_bf16 v[136:139], a[160:163], a[136:139], v[136:139]
  ds_read_b64_tr_b16 a[182:183], v3 offset:55296
  v_fmac_f32 v125, v22, v25
  v_mfma_f32_16x16x32_bf16 v[136:139], a[164:167], a[152:155], v[136:139]
  v_fmac_f32 v126, v22, v26
  v_fmac_f32 v127, v22, v27
  v_mfma_f32_16x16x32_bf16 v[140:143], a[164:167], a[156:159], v[140:143]
  ds_read_b64_tr_b16 a[164:165], v3 offset:57344
  v_mfma_f32_16x16x32_bf16 v[140:143], a[160:163], a[140:143], v[140:143]
  s_waitcnt lgkmcnt(5)
  buffer_load_dwordx4 a[92:95], v1, s[8:11], s76 offen offset:1024 sc1
  v_mfma_f32_16x16x32_bf16 v[156:159], a[168:171], a[140:143], v[156:159]
  ds_read_b64_tr_b16 a[166:167], v3 offset:59392
  v_mfma_f32_16x16x32_bf16 v[156:159], a[172:175], a[156:159], v[156:159]
  s_cmp_eq_u32 s56, 1
  s_cselect_b32 s77, 5, 13
  s_mul_i32 s69, s77, 458752
  s_lshl_b32 s77, s77, 11
  s_add_u32 s77, s77, s57
  ds_read_b128 v[24:27], v12 offset:1024
  v_mfma_f32_16x16x32_bf16 v[152:155], a[172:175], a[152:155], v[152:155]
  ds_read_b64_tr_b16 a[160:161], v3 offset:61440
  s_waitcnt lgkmcnt(10)
  v_mfma_f32_16x16x32_bf16 v[152:155], a[168:171], a[136:139], v[152:155]
  buffer_load_dwordx4 a[96:99], v1, s[8:11], s77 offen offset:0 sc1
  v_fmac_f32 v112, v17, v28
  v_fmac_f32 v113, v17, v29
  v_mfma_f32_16x16x32_bf16 v[148:151], a[168:171], a[132:135], v[148:151]
  ds_read_b64_tr_b16 a[162:163], v3 offset:63488
  v_fmac_f32 v114, v17, v30
  v_mfma_f32_16x16x32_bf16 v[148:151], a[172:175], a[148:151], v[148:151]
  v_fmac_f32 v115, v17, v31
  v_fmac_f32 v116, v19, v28
  v_mfma_f32_16x16x32_bf16 v[144:147], a[172:175], a[144:147], v[144:147]
  ds_read_b64_tr_b16 a[172:173], v4 offset:49152
  v_fmac_f32 v117, v19, v29
  v_mfma_f32_16x16x32_bf16 v[144:147], a[168:171], a[128:131], v[144:147]
  s_waitcnt lgkmcnt(6)
  v_fmac_f32 v118, v19, v30
  v_fmac_f32 v119, v19, v31
  v_mfma_f32_16x16x32_bf16 v[160:163], a[176:179], a[128:131], v[160:163]
  ds_read_b64_tr_b16 a[174:175], v4 offset:51200
  v_fmac_f32 v120, v21, v28
  v_mfma_f32_16x16x32_bf16 v[160:163], a[180:183], a[144:147], v[160:163]
  buffer_load_dwordx4 a[112:115], v1, s[8:11], s77 offen offset:1024 sc1
  v_fmac_f32 v121, v21, v29
  v_fmac_f32 v122, v21, v30
  v_mfma_f32_16x16x32_bf16 v[164:167], a[180:183], a[148:151], v[164:167]
  ds_read_b64_tr_b16 a[168:169], v4 offset:53248
  v_fmac_f32 v123, v21, v31
  v_mfma_f32_16x16x32_bf16 v[164:167], a[176:179], a[132:135], v[164:167]
  s_add_u32 s77, s77, 65536
  v_fmac_f32 v124, v23, v28
  v_fmac_f32 v125, v23, v29
  v_mfma_f32_16x16x32_bf16 v[168:171], a[176:179], a[136:139], v[168:171]
  ds_read_b64_tr_b16 a[170:171], v4 offset:55296
  v_fmac_f32 v126, v23, v30
  v_mfma_f32_16x16x32_bf16 v[168:171], a[180:183], a[152:155], v[168:171]
  buffer_load_dwordx4 a[100:103], v1, s[8:11], s77 offen offset:0 sc1
  v_fmac_f32 v127, v23, v31
  v_mfma_f32_16x16x32_bf16 v[172:175], a[180:183], a[156:159], v[172:175]
  ds_read_b64_tr_b16 a[180:181], v4 offset:57344
  v_mfma_f32_16x16x32_bf16 v[172:175], a[176:179], a[140:143], v[172:175]
  s_waitcnt lgkmcnt(5)
  ds_read_b128 v[28:31], v12 offset:1536
  v_mfma_f32_16x16x32_bf16 v[188:191], a[164:167], a[140:143], v[188:191]
  ds_read_b64_tr_b16 a[182:183], v4 offset:59392
  s_waitcnt lgkmcnt(9)
  v_mfma_f32_16x16x32_bf16 v[188:191], a[160:163], a[156:159], v[188:191]
  v_fmac_f32 v144, v16, v24
  v_fmac_f32 v145, v16, v25
  v_mfma_f32_16x16x32_bf16 v[184:187], a[160:163], a[152:155], v[184:187]
  ds_read_b64_tr_b16 a[176:177], v4 offset:61440
  v_fmac_f32 v146, v16, v26
  v_mfma_f32_16x16x32_bf16 v[184:187], a[164:167], a[136:139], v[184:187]
  buffer_load_dwordx4 a[116:119], v1, s[8:11], s77 offen offset:1024 sc1
  v_fmac_f32 v147, v16, v27
  v_fmac_f32 v148, v18, v24
  v_mfma_f32_16x16x32_bf16 v[180:183], a[164:167], a[132:135], v[180:183]
  ds_read_b64_tr_b16 a[178:179], v4 offset:63488
  v_fmac_f32 v149, v18, v25
  v_mfma_f32_16x16x32_bf16 v[180:183], a[160:163], a[148:151], v[180:183]
  s_add_u32 s77, s77, 65536
  v_fmac_f32 v150, v18, v26
  v_fmac_f32 v151, v18, v27
  v_mfma_f32_16x16x32_bf16 v[176:179], a[160:163], a[144:147], v[176:179]
  ds_read_b64_tr_b16 a[160:161], v5 offset:49152
  v_fmac_f32 v152, v20, v24
  v_mfma_f32_16x16x32_bf16 v[176:179], a[164:167], a[128:131], v[176:179]
  s_waitcnt lgkmcnt(6)
  buffer_load_dwordx4 a[104:107], v1, s[8:11], s77 offen offset:0 sc1
  v_fmac_f32 v153, v20, v25
  v_mfma_f32_16x16x32_bf16 v[192:195], a[172:175], a[128:131], v[192:195]
  ds_read_b64_tr_b16 a[162:163], v5 offset:51200
  v_fmac_f32 v154, v20, v26
  v_mfma_f32_16x16x32_bf16 v[192:195], a[168:171], a[144:147], v[192:195]
  v_fmac_f32 v155, v20, v27
  v_fmac_f32 v156, v22, v24
  v_mfma_f32_16x16x32_bf16 v[196:199], a[168:171], a[148:151], v[196:199]
  ds_read_b64_tr_b16 a[164:165], v5 offset:53248
  v_fmac_f32 v157, v22, v25
  v_mfma_f32_16x16x32_bf16 v[196:199], a[172:175], a[132:135], v[196:199]
  v_fmac_f32 v158, v22, v26
  v_fmac_f32 v159, v22, v27
  v_mfma_f32_16x16x32_bf16 v[200:203], a[172:175], a[136:139], v[200:203]
  ds_read_b64_tr_b16 a[166:167], v5 offset:55296
  v_mfma_f32_16x16x32_bf16 v[200:203], a[168:171], a[152:155], v[200:203]
  buffer_load_dwordx4 a[120:123], v1, s[8:11], s77 offen offset:1024 sc1
  ds_read_b128 v[24:27], v12 offset:64
  v_mfma_f32_16x16x32_bf16 v[204:207], a[168:171], a[156:159], v[204:207]
  ds_read_b64_tr_b16 a[168:169], v5 offset:57344
  s_waitcnt lgkmcnt(9)
  v_mfma_f32_16x16x32_bf16 v[204:207], a[172:175], a[140:143], v[204:207]
  s_waitcnt lgkmcnt(6)
  s_add_u32 s77, s77, 65536
  v_fmac_f32 v144, v17, v28
  v_mfma_f32_16x16x32_bf16 v[220:223], a[180:183], a[140:143], v[220:223]
  ds_read_b64_tr_b16 a[170:171], v5 offset:59392
  v_fmac_f32 v145, v17, v29
  v_mfma_f32_16x16x32_bf16 v[220:223], a[176:179], a[156:159], v[220:223]
  buffer_load_dwordx4 a[108:111], v1, s[8:11], s77 offen offset:0 sc1
  v_fmac_f32 v146, v17, v30
  v_fmac_f32 v147, v17, v31
  v_mfma_f32_16x16x32_bf16 v[216:219], a[176:179], a[152:155], v[216:219]
  ds_read_b64_tr_b16 a[172:173], v5 offset:61440
  v_fmac_f32 v148, v19, v28
  v_mfma_f32_16x16x32_bf16 v[216:219], a[180:183], a[136:139], v[216:219]
  v_fmac_f32 v149, v19, v29
  v_fmac_f32 v150, v19, v30
  v_mfma_f32_16x16x32_bf16 v[212:215], a[180:183], a[132:135], v[212:215]
  ds_read_b64_tr_b16 a[174:175], v5 offset:63488
  v_fmac_f32 v151, v19, v31
  v_mfma_f32_16x16x32_bf16 v[212:215], a[176:179], a[148:151], v[212:215]
  s_waitcnt vmcnt(36)
  s_barrier
  v_mfma_f32_16x16x32_bf16 v[208:211], a[176:179], a[144:147], v[208:211]
  ds_read_b64_tr_b16 a[176:177], v6 offset:16384
  s_add_u32 s62, s92, 2048
  v_mfma_f32_16x16x32_bf16 v[208:211], a[180:183], a[128:131], v[208:211]
  s_waitcnt lgkmcnt(6)
  buffer_load_dword a253, v13, s[36:39], s62 offen
  v_fmac_f32 v152, v21, v28
  v_mfma_f32_16x16x32_bf16 v[224:227], a[160:163], a[128:131], v[224:227]
  ds_read_b64_tr_b16 a[178:179], v6 offset:18432
  v_fmac_f32 v153, v21, v29
  v_mfma_f32_16x16x32_bf16 v[224:227], a[164:167], a[144:147], v[224:227]
  v_fmac_f32 v154, v21, v30
  v_fmac_f32 v155, v21, v31
  v_mfma_f32_16x16x32_bf16 v[228:231], a[164:167], a[148:151], v[228:231]
  ds_read_b64_tr_b16 a[180:181], v6 offset:20480
  v_fmac_f32 v156, v23, v28
  v_mfma_f32_16x16x32_bf16 v[228:231], a[160:163], a[132:135], v[228:231]
  v_fmac_f32 v157, v23, v29
  v_fmac_f32 v158, v23, v30
  v_mfma_f32_16x16x32_bf16 v[232:235], a[160:163], a[136:139], v[232:235]
  ds_read_b64_tr_b16 a[182:183], v6 offset:22528
  v_fmac_f32 v159, v23, v31
  v_mfma_f32_16x16x32_bf16 v[232:235], a[164:167], a[152:155], v[232:235]
  ds_read_b128 v[28:31], v12 offset:576
  v_mfma_f32_16x16x32_bf16 v[236:239], a[164:167], a[156:159], v[236:239]
  ds_read_b64_tr_b16 a[164:165], v6 offset:24576
  s_waitcnt lgkmcnt(10)
  v_mfma_f32_16x16x32_bf16 v[236:239], a[160:163], a[140:143], v[236:239]
  s_waitcnt lgkmcnt(6)
  s_add_u32 m0, s45, 114688
  v_fmac_f32 v160, v16, v24
  v_mfma_f32_16x16x32_bf16 v[252:255], a[168:171], a[140:143], v[252:255]
  ds_read_b64_tr_b16 a[166:167], v6 offset:26624
  v_fmac_f32 v161, v16, v25
  v_mfma_f32_16x16x32_bf16 v[252:255], a[172:175], a[156:159], v[252:255]
  buffer_load_dwordx4 v11, s[28:31], s69 offen lds
  v_fmac_f32 v162, v16, v26
  v_fmac_f32 v163, v16, v27
  v_mfma_f32_16x16x32_bf16 v[248:251], a[172:175], a[152:155], v[248:251]
  ds_read_b64_tr_b16 a[160:161], v6 offset:28672
  v_fmac_f32 v164, v18, v24
  v_mfma_f32_16x16x32_bf16 v[248:251], a[168:171], a[136:139], v[248:251]
  s_add_u32 m0, s45, 122880
  v_fmac_f32 v165, v18, v25
  v_fmac_f32 v166, v18, v26
  v_mfma_f32_16x16x32_bf16 v[244:247], a[168:171], a[132:135], v[244:247]
  ds_read_b64_tr_b16 a[162:163], v6 offset:30720
  v_fmac_f32 v167, v18, v27
  v_mfma_f32_16x16x32_bf16 v[244:247], a[172:175], a[148:151], v[244:247]
  buffer_load_dwordx4 v11, s[32:35], s69 offen lds
  v_fmac_f32 v168, v20, v24
  v_fmac_f32 v169, v20, v25
  v_mfma_f32_16x16x32_bf16 v[240:243], a[172:175], a[144:147], v[240:243]
  ds_read_b64_tr_b16 a[172:173], v7 offset:16384
  v_fmac_f32 v170, v20, v26
  v_mfma_f32_16x16x32_bf16 v[240:243], a[168:171], a[128:131], v[240:243]
  s_waitcnt vmcnt(31) lgkmcnt(6)
  v_fmac_f32 v171, v20, v27
  v_fmac_f32 v172, v22, v24
  v_mfma_f32_16x16x32_bf16 v[64:67], a[176:179], a[0:3], v[64:67]
  ds_read_b64_tr_b16 a[174:175], v7 offset:18432
  v_fmac_f32 v173, v22, v25
  v_mfma_f32_16x16x32_bf16 v[64:67], a[180:183], a[16:19], v[64:67]
  s_add_u32 m0, s45, 118784
  s_add_u32 s61, s69, 229376
  v_fmac_f32 v174, v22, v26
  v_mfma_f32_16x16x32_bf16 v[68:71], a[180:183], a[20:23], v[68:71]
  ds_read_b64_tr_b16 a[168:169], v7 offset:20480
  v_fmac_f32 v175, v22, v27
  v_mfma_f32_16x16x32_bf16 v[68:71], a[176:179], a[4:7], v[68:71]
  buffer_load_dwordx4 v11, s[28:31], s61 offen lds
HOP12:
  s_cbranch_execz HOP15
  ds_read_b128 v[24:27], v12 offset:1088
  v_mfma_f32_16x16x32_bf16 v[72:75], a[176:179], a[8:11], v[72:75]
  ds_read_b64_tr_b16 a[170:171], v7 offset:22528
  s_waitcnt lgkmcnt(9)
  v_mfma_f32_16x16x32_bf16 v[72:75], a[180:183], a[24:27], v[72:75]
  s_add_u32 m0, s45, 126976
  s_add_u32 s61, s69, 229376
  v_fmac_f32 v160, v17, v28
  v_mfma_f32_16x16x32_bf16 v[76:79], a[180:183], a[28:31], v[76:79]
  ds_read_b64_tr_b16 a[180:181], v7 offset:24576
  v_fmac_f32 v161, v17, v29
  v_mfma_f32_16x16x32_bf16 v[76:79], a[176:179], a[12:15], v[76:79]
  s_waitcnt lgkmcnt(6)
  buffer_load_dwordx4 v11, s[32:35], s61 offen lds
  v_fmac_f32 v162, v17, v30
  v_mfma_f32_16x16x32_bf16 v[92:95], a[164:167], a[12:15], v[92:95]
  ds_read_b64_tr_b16 a[182:183], v7 offset:26624
  v_fmac_f32 v163, v17, v31
  v_mfma_f32_16x16x32_bf16 v[92:95], a[160:163], a[28:31], v[92:95]
  v_fmac_f32 v164, v19, v28
  v_fmac_f32 v165, v19, v29
  v_mfma_f32_16x16x32_bf16 v[88:91], a[160:163], a[24:27], v[88:91]
  ds_read_b64_tr_b16 a[176:177], v7 offset:28672
  v_fmac_f32 v166, v19, v30
  v_mfma_f32_16x16x32_bf16 v[88:91], a[164:167], a[8:11], v[88:91]
  v_fmac_f32 v167, v19, v31
  v_fmac_f32 v168, v21, v28
  v_mfma_f32_16x16x32_bf16 v[84:87], a[164:167], a[4:7], v[84:87]
  ds_read_b64_tr_b16 a[178:179], v7 offset:30720
  v_fmac_f32 v169, v21, v29
  v_mfma_f32_16x16x32_bf16 v[84:87], a[160:163], a[20:23], v[84:87]
  buffer_load_dwordx4 a[124:127], v1, s[8:11], s77 offen offset:1024 sc1
  v_fmac_f32 v170, v21, v30
  v_fmac_f32 v171, v21, v31
  v_mfma_f32_16x16x32_bf16 v[80:83], a[160:163], a[16:19], v[80:83]
  ds_read_b64_tr_b16 a[160:161], v8 offset:16384
  v_fmac_f32 v172, v23, v28
  v_mfma_f32_16x16x32_bf16 v[80:83], a[164:167], a[0:3], v[80:83]
  s_waitcnt lgkmcnt(5)
  s_cmp_eq_u32 s56, 2
  s_cselect_b32 s78, 6, 14
  s_mul_i32 s70, s78, 458752
  s_lshl_b32 s78, s78, 11
  s_add_u32 s78, s78, s57
  v_fmac_f32 v173, v23, v29
  v_mfma_f32_16x16x32_bf16 v[96:99], a[172:175], a[0:3], v[96:99]
  ds_read_b64_tr_b16 a[162:163], v8 offset:18432
  v_fmac_f32 v174, v23, v30
  v_mfma_f32_16x16x32_bf16 v[96:99], a[168:171], a[16:19], v[96:99]
  buffer_load_dwordx4 a[128:131], v1, s[8:11], s78 offen offset:0 sc1
  v_fmac_f32 v175, v23, v31
  v_mfma_f32_16x16x32_bf16 v[100:103], a[168:171], a[20:23], v[100:103]
  ds_read_b64_tr_b16 a[164:165], v8 offset:20480
  v_mfma_f32_16x16x32_bf16 v[100:103], a[172:175], a[4:7], v[100:103]
  ds_read_b128 v[28:31], v12 offset:1600
  v_mfma_f32_16x16x32_bf16 v[104:107], a[172:175], a[8:11], v[104:107]
  ds_read_b64_tr_b16 a[166:167], v8 offset:22528
  s_waitcnt lgkmcnt(10)
  v_mfma_f32_16x16x32_bf16 v[104:107], a[168:171], a[24:27], v[104:107]
  v_fmac_f32 v176, v16, v24
  v_fmac_f32 v177, v16, v25
  v_mfma_f32_16x16x32_bf16 v[108:111], a[168:171], a[28:31], v[108:111]
  ds_read_b64_tr_b16 a[168:169], v8 offset:24576
  v_fmac_f32 v178, v16, v26
  v_mfma_f32_16x16x32_bf16 v[108:111], a[172:175], a[12:15], v[108:111]
  s_waitcnt lgkmcnt(6)
  buffer_load_dwordx4 a[144:147], v1, s[8:11], s78 offen offset:1024 sc1
  v_fmac_f32 v179, v16, v27
  v_mfma_f32_16x16x32_bf16 v[124:127], a[180:183], a[12:15], v[124:127]
  ds_read_b64_tr_b16 a[170:171], v8 offset:26624
  v_fmac_f32 v180, v18, v24
  v_mfma_f32_16x16x32_bf16 v[124:127], a[176:179], a[28:31], v[124:127]
  s_add_u32 s78, s78, 65536
  v_fmac_f32 v181, v18, v25
  v_fmac_f32 v182, v18, v26
  v_mfma_f32_16x16x32_bf16 v[120:123], a[176:179], a[24:27], v[120:123]
  ds_read_b64_tr_b16 a[172:173], v8 offset:28672
  v_fmac_f32 v183, v18, v27
  v_mfma_f32_16x16x32_bf16 v[120:123], a[180:183], a[8:11], v[120:123]
  buffer_load_dwordx4 a[132:135], v1, s[8:11], s78 offen offset:0 sc1
  v_fmac_f32 v184, v20, v24
  v_fmac_f32 v185, v20, v25
  v_mfma_f32_16x16x32_bf16 v[116:119], a[180:183], a[4:7], v[116:119]
  ds_read_b64_tr_b16 a[174:175], v8 offset:30720
  v_fmac_f32 v186, v20, v26
  v_mfma_f32_16x16x32_bf16 v[116:119], a[176:179], a[20:23], v[116:119]
  v_fmac_f32 v187, v20, v27
  v_fmac_f32 v188, v22, v24
  v_mfma_f32_16x16x32_bf16 v[112:115], a[176:179], a[16:19], v[112:115]
  ds_read_b64_tr_b16 a[176:177], v6 offset:0
  v_fmac_f32 v189, v22, v25
  v_mfma_f32_16x16x32_bf16 v[112:115], a[180:183], a[0:3], v[112:115]
  s_waitcnt lgkmcnt(5)
  v_fmac_f32 v190, v22, v26
  v_fmac_f32 v191, v22, v27
  v_mfma_f32_16x16x32_bf16 v[32:35], a[160:163], a[0:3], v[32:35]
  ds_read_b64_tr_b16 a[178:179], v6 offset:2048
  v_mfma_f32_16x16x32_bf16 v[32:35], a[164:167], a[16:19], v[32:35]
  buffer_load_dwordx4 a[148:151], v1, s[8:11], s78 offen offset:1024 sc1
  ds_read_b128 v[24:27], v12 offset:128
  v_mfma_f32_16x16x32_bf16 v[36:39], a[164:167], a[20:23], v[36:39]
  ds_read_b64_tr_b16 a[180:181], v6 offset:4096
  s_waitcnt lgkmcnt(9)
  v_mfma_f32_16x16x32_bf16 v[36:39], a[160:163], a[4:7], v[36:39]
  s_add_u32 s78, s78, 65536
  v_fmac_f32 v176, v17, v28
  v_fmac_f32 v177, v17, v29
  v_mfma_f32_16x16x32_bf16 v[40:43], a[160:163], a[8:11], v[40:43]
  ds_read_b64_tr_b16 a[182:183], v6 offset:6144
  v_fmac_f32 v178, v17, v30
  v_mfma_f32_16x16x32_bf16 v[40:43], a[164:167], a[24:27], v[40:43]
  buffer_load_dwordx4 a[136:139], v1, s[8:11], s78 offen offset:0 sc1
  v_fmac_f32 v179, v17, v31
  v_fmac_f32 v180, v19, v28
  v_mfma_f32_16x16x32_bf16 v[44:47], a[164:167], a[28:31], v[44:47]
  ds_read_b64_tr_b16 a[164:165], v6 offset:8192
  v_fmac_f32 v181, v19, v29
  v_mfma_f32_16x16x32_bf16 v[44:47], a[160:163], a[12:15], v[44:47]
  s_waitcnt lgkmcnt(6)
  v_fmac_f32 v182, v19, v30
  v_fmac_f32 v183, v19, v31
  v_mfma_f32_16x16x32_bf16 v[60:63], a[168:171], a[12:15], v[60:63]
  ds_read_b64_tr_b16 a[166:167], v6 offset:10240
  v_fmac_f32 v184, v21, v28
  v_mfma_f32_16x16x32_bf16 v[60:63], a[172:175], a[28:31], v[60:63]
  v_fmac_f32 v185, v21, v29
  v_fmac_f32 v186, v21, v30
  v_mfma_f32_16x16x32_bf16 v[56:59], a[172:175], a[24:27], v[56:59]
  ds_read_b64_tr_b16 a[160:161], v6 offset:12288
  v_fmac_f32 v187, v21, v31
  v_mfma_f32_16x16x32_bf16 v[56:59], a[168:171], a[8:11], v[56:59]
  buffer_load_dwordx4 a[152:155], v1, s[8:11], s78 offen offset:1024 sc1
  v_fmac_f32 v188, v23, v28
  v_fmac_f32 v189, v23, v29
  v_mfma_f32_16x16x32_bf16 v[52:55], a[168:171], a[4:7], v[52:55]
  ds_read_b64_tr_b16 a[162:163], v6 offset:14336
  v_fmac_f32 v190, v23, v30
  v_mfma_f32_16x16x32_bf16 v[52:55], a[172:175], a[20:23], v[52:55]
  s_add_u32 s78, s78, 65536
  v_fmac_f32 v191, v23, v31
  v_mfma_f32_16x16x32_bf16 v[48:51], a[172:175], a[16:19], v[48:51]
  ds_read_b64_tr_b16 a[172:173], v7 offset:0
  v_mfma_f32_16x16x32_bf16 v[48:51], a[168:171], a[0:3], v[48:51]
  s_waitcnt vmcnt(32) lgkmcnt(5)
  buffer_load_dwordx4 a[140:143], v1, s[8:11], s78 offen offset:0 sc1
  v_mfma_f32_16x16x32_bf16 v[64:67], a[176:179], a[32:35], v[64:67]
  ds_read_b64_tr_b16 a[174:175], v7 offset:2048
  v_mfma_f32_16x16x32_bf16 v[64:67], a[180:183], a[48:51], v[64:67]
  ds_read_b128 v[28:31], v12 offset:640
  v_mfma_f32_16x16x32_bf16 v[68:71], a[180:183], a[52:55], v[68:71]
  ds_read_b64_tr_b16 a[168:169], v7 offset:4096
  s_waitcnt lgkmcnt(10)
  v_mfma_f32_16x16x32_bf16 v[68:71], a[176:179], a[36:39], v[68:71]
  s_add_u32 s62, s92, 4096
  v_fmac_f32 v192, v16, v24
  v_fmac_f32 v193, v16, v25
  v_mfma_f32_16x16x32_bf16 v[72:75], a[176:179], a[40:43], v[72:75]
  ds_read_b64_tr_b16 a[170:171], v7 offset:6144
  v_fmac_f32 v194, v16, v26
  v_mfma_f32_16x16x32_bf16 v[72:75], a[180:183], a[56:59], v[72:75]
  buffer_load_dword a253, v13, s[36:39], s62 offen
  v_fmac_f32 v195, v16, v27
  v_fmac_f32 v196, v18, v24
  v_mfma_f32_16x16x32_bf16 v[76:79], a[180:183], a[60:63], v[76:79]
  ds_read_b64_tr_b16 a[180:181], v7 offset:8192
  v_fmac_f32 v197, v18, v25
  v_mfma_f32_16x16x32_bf16 v[76:79], a[176:179], a[44:47], v[76:79]
  s_waitcnt lgkmcnt(6)
  v_fmac_f32 v198, v18, v26
  v_fmac_f32 v199, v18, v27
  v_mfma_f32_16x16x32_bf16 v[92:95], a[164:167], a[44:47], v[92:95]
  ds_read_b64_tr_b16 a[182:183], v7 offset:10240
  v_fmac_f32 v200, v20, v24
  v_mfma_f32_16x16x32_bf16 v[92:95], a[160:163], a[60:63], v[92:95]
  v_fmac_f32 v201, v20, v25
  v_fmac_f32 v202, v20, v26
  v_mfma_f32_16x16x32_bf16 v[88:91], a[160:163], a[56:59], v[88:91]
  ds_read_b64_tr_b16 a[176:177], v7 offset:12288
  v_fmac_f32 v203, v20, v27
  v_mfma_f32_16x16x32_bf16 v[88:91], a[164:167], a[40:43], v[88:91]
  v_fmac_f32 v204, v22, v24
  v_fmac_f32 v205, v22, v25
  v_mfma_f32_16x16x32_bf16 v[84:87], a[164:167], a[36:39], v[84:87]
  ds_read_b64_tr_b16 a[178:179], v7 offset:14336
  v_fmac_f32 v206, v22, v26
  v_mfma_f32_16x16x32_bf16 v[84:87], a[160:163], a[52:55], v[84:87]
  v_fmac_f32 v207, v22, v27
  v_mfma_f32_16x16x32_bf16 v[80:83], a[160:163], a[48:51], v[80:83]
  ds_read_b64_tr_b16 a[160:161], v8 offset:0
  v_mfma_f32_16x16x32_bf16 v[80:83], a[164:167], a[32:35], v[80:83]
  s_waitcnt lgkmcnt(5)
  buffer_load_dwordx4 a[156:159], v1, s[8:11], s78 offen offset:1024 sc1
  v_mfma_f32_16x16x32_bf16 v[96:99], a[172:175], a[32:35], v[96:99]
  ds_read_b64_tr_b16 a[162:163], v8 offset:2048
  v_mfma_f32_16x16x32_bf16 v[96:99], a[168:171], a[48:51], v[96:99]
  s_cmp_eq_u32 s56, 3
  s_cselect_b32 s79, 7, 15
  s_mul_i32 s71, s79, 458752
  s_lshl_b32 s79, s79, 11
  s_add_u32 s79, s79, s57
  ds_read_b128 v[24:27], v12 offset:1152
  v_mfma_f32_16x16x32_bf16 v[100:103], a[168:171], a[52:55], v[100:103]
  ds_read_b64_tr_b16 a[164:165], v8 offset:4096
  s_waitcnt lgkmcnt(10)
  v_mfma_f32_16x16x32_bf16 v[100:103], a[172:175], a[36:39], v[100:103]
  buffer_load_dwordx4 a[188:191], v1, s[8:11], s79 offen offset:0 sc1
  v_fmac_f32 v192, v17, v28
  v_fmac_f32 v193, v17, v29
  v_mfma_f32_16x16x32_bf16 v[104:107], a[172:175], a[40:43], v[104:107]
  ds_read_b64_tr_b16 a[166:167], v8 offset:6144
  v_fmac_f32 v194, v17, v30
  v_mfma_f32_16x16x32_bf16 v[104:107], a[168:171], a[56:59], v[104:107]
  v_fmac_f32 v195, v17, v31
  v_fmac_f32 v196, v19, v28
  v_mfma_f32_16x16x32_bf16 v[108:111], a[168:171], a[60:63], v[108:111]
  ds_read_b64_tr_b16 a[168:169], v8 offset:8192
  v_fmac_f32 v197, v19, v29
  v_mfma_f32_16x16x32_bf16 v[108:111], a[172:175], a[44:47], v[108:111]
  s_waitcnt lgkmcnt(6)
  v_fmac_f32 v198, v19, v30
  v_fmac_f32 v199, v19, v31
  v_mfma_f32_16x16x32_bf16 v[124:127], a[180:183], a[44:47], v[124:127]
  ds_read_b64_tr_b16 a[170:171], v8 offset:10240
  v_fmac_f32 v200, v21, v28
  v_mfma_f32_16x16x32_bf16 v[124:127], a[176:179], a[60:63], v[124:127]
  buffer_load_dwordx4 a[204:207], v1, s[8:11], s79 offen offset:1024 sc1
  v_fmac_f32 v201, v21, v29
  v_fmac_f32 v202, v21, v30
  v_mfma_f32_16x16x32_bf16 v[120:123], a[176:179], a[56:59], v[120:123]
  ds_read_b64_tr_b16 a[172:173], v8 offset:12288
  v_fmac_f32 v203, v21, v31
  v_mfma_f32_16x16x32_bf16 v[120:123], a[180:183], a[40:43], v[120:123]
  s_add_u32 s79, s79, 65536
  v_fmac_f32 v204, v23, v28
  v_fmac_f32 v205, v23, v29
  v_mfma_f32_16x16x32_bf16 v[116:119], a[180:183], a[36:39], v[116:119]
  ds_read_b64_tr_b16 a[174:175], v8 offset:14336
  v_fmac_f32 v206, v23, v30
  v_mfma_f32_16x16x32_bf16 v[116:119], a[176:179], a[52:55], v[116:119]
  buffer_load_dwordx4 a[192:195], v1, s[8:11], s79 offen offset:0 sc1
  v_fmac_f32 v207, v23, v31
  v_mfma_f32_16x16x32_bf16 v[112:115], a[176:179], a[48:51], v[112:115]
  ds_read_b64_tr_b16 a[176:177], v2 offset:16384
  v_mfma_f32_16x16x32_bf16 v[112:115], a[180:183], a[32:35], v[112:115]
  s_waitcnt lgkmcnt(5)
  ds_read_b128 v[28:31], v12 offset:1664
  v_mfma_f32_16x16x32_bf16 v[32:35], a[160:163], a[32:35], v[32:35]
  ds_read_b64_tr_b16 a[178:179], v2 offset:18432
  s_waitcnt lgkmcnt(9)
  v_mfma_f32_16x16x32_bf16 v[32:35], a[164:167], a[48:51], v[32:35]
  v_fmac_f32 v208, v16, v24
  v_fmac_f32 v209, v16, v25
  v_mfma_f32_16x16x32_bf16 v[36:39], a[164:167], a[52:55], v[36:39]
  ds_read_b64_tr_b16 a[180:181], v2 offset:20480
  v_fmac_f32 v210, v16, v26
  v_mfma_f32_16x16x32_bf16 v[36:39], a[160:163], a[36:39], v[36:39]
  buffer_load_dwordx4 a[208:211], v1, s[8:11], s79 offen offset:1024 sc1
  v_fmac_f32 v211, v16, v27
  v_fmac_f32 v212, v18, v24
  v_mfma_f32_16x16x32_bf16 v[40:43], a[160:163], a[40:43], v[40:43]
  ds_read_b64_tr_b16 a[182:183], v2 offset:22528
  v_fmac_f32 v213, v18, v25
  v_mfma_f32_16x16x32_bf16 v[40:43], a[164:167], a[56:59], v[40:43]
  s_add_u32 s79, s79, 65536
  v_fmac_f32 v214, v18, v26
  v_fmac_f32 v215, v18, v27
  v_mfma_f32_16x16x32_bf16 v[44:47], a[164:167], a[60:63], v[44:47]
  ds_read_b64_tr_b16 a[164:165], v2 offset:24576
  v_fmac_f32 v216, v20, v24
  v_mfma_f32_16x16x32_bf16 v[44:47], a[160:163], a[44:47], v[44:47]
  s_waitcnt lgkmcnt(6)
  buffer_load_dwordx4 a[196:199], v1, s[8:11], s79 offen offset:0 sc1
  v_fmac_f32 v217, v20, v25
  v_mfma_f32_16x16x32_bf16 v[60:63], a[168:171], a[44:47], v[60:63]
  ds_read_b64_tr_b16 a[166:167], v2 offset:26624
  s_barrier
  v_mfma_f32_16x16x32_bf16 v[60:63], a[172:175], a[60:63], v[60:63]
  v_fmac_f32 v218, v20, v26
  v_fmac_f32 v219, v20, v27
  v_mfma_f32_16x16x32_bf16 v[56:59], a[172:175], a[56:59], v[56:59]
  ds_read_b64_tr_b16 a[160:161], v2 offset:28672
  v_fmac_f32 v220, v22, v24
  v_mfma_f32_16x16x32_bf16 v[56:59], a[168:171], a[40:43], v[56:59]
  s_add_u32 m0, s45, 81920
  v_fmac_f32 v221, v22, v25
  v_fmac_f32 v222, v22, v26
  v_mfma_f32_16x16x32_bf16 v[52:55], a[168:171], a[36:39], v[52:55]
  ds_read_b64_tr_b16 a[162:163], v2 offset:30720
  v_fmac_f32 v223, v22, v27
  v_mfma_f32_16x16x32_bf16 v[52:55], a[172:175], a[52:55], v[52:55]
  buffer_load_dwordx4 v11, s[28:31], s70 offen lds
  ds_read_b128 v[24:27], v12 offset:192
  v_mfma_f32_16x16x32_bf16 v[48:51], a[172:175], a[48:51], v[48:51]
  ds_read_b64_tr_b16 a[172:173], v3 offset:16384
  s_waitcnt lgkmcnt(9)
  v_mfma_f32_16x16x32_bf16 v[48:51], a[168:171], a[32:35], v[48:51]
  s_waitcnt lgkmcnt(6)
  s_add_u32 m0, s45, 90112
  v_fmac_f32 v208, v17, v28
  v_mfma_f32_16x16x32_bf16 v[128:131], a[176:179], a[0:3], v[128:131]
  ds_read_b64_tr_b16 a[174:175], v3 offset:18432
  v_fmac_f32 v209, v17, v29
  v_mfma_f32_16x16x32_bf16 v[128:131], a[180:183], a[16:19], v[128:131]
  buffer_load_dwordx4 v11, s[32:35], s70 offen lds
  v_fmac_f32 v210, v17, v30
  v_fmac_f32 v211, v17, v31
  v_mfma_f32_16x16x32_bf16 v[132:135], a[180:183], a[20:23], v[132:135]
  ds_read_b64_tr_b16 a[168:169], v3 offset:20480
  v_fmac_f32 v212, v19, v28
  v_mfma_f32_16x16x32_bf16 v[132:135], a[176:179], a[4:7], v[132:135]
  v_fmac_f32 v213, v19, v29
  v_fmac_f32 v214, v19, v30
  v_mfma_f32_16x16x32_bf16 v[136:139], a[176:179], a[8:11], v[136:139]
  ds_read_b64_tr_b16 a[170:171], v3 offset:22528
  v_fmac_f32 v215, v19, v31
  v_mfma_f32_16x16x32_bf16 v[136:139], a[180:183], a[24:27], v[136:139]
  s_add_u32 m0, s45, 86016
  s_add_u32 s61, s70, 229376
  v_fmac_f32 v216, v21, v28
  v_mfma_f32_16x16x32_bf16 v[140:143], a[180:183], a[28:31], v[140:143]
  ds_read_b64_tr_b16 a[180:181], v3 offset:24576
  v_fmac_f32 v217, v21, v29
  v_mfma_f32_16x16x32_bf16 v[140:143], a[176:179], a[12:15], v[140:143]
  s_waitcnt lgkmcnt(6)
  buffer_load_dwordx4 v11, s[28:31], s61 offen lds
  v_fmac_f32 v218, v21, v30
  v_mfma_f32_16x16x32_bf16 v[156:159], a[164:167], a[12:15], v[156:159]
  ds_read_b64_tr_b16 a[182:183], v3 offset:26624
  v_fmac_f32 v219, v21, v31
  v_mfma_f32_16x16x32_bf16 v[156:159], a[160:163], a[28:31], v[156:159]
  s_add_u32 m0, s45, 94208
  s_add_u32 s61, s70, 229376
  v_fmac_f32 v220, v23, v28
  v_mfma_f32_16x16x32_bf16 v[152:155], a[160:163], a[24:27], v[152:155]
  ds_read_b64_tr_b16 a[176:177], v3 offset:28672
  v_fmac_f32 v221, v23, v29
  v_mfma_f32_16x16x32_bf16 v[152:155], a[164:167], a[8:11], v[152:155]
  buffer_load_dwordx4 v11, s[32:35], s61 offen lds
  v_fmac_f32 v222, v23, v30
  v_fmac_f32 v223, v23, v31
  v_mfma_f32_16x16x32_bf16 v[148:151], a[164:167], a[4:7], v[148:151]
  ds_read_b64_tr_b16 a[178:179], v3 offset:30720
  v_mfma_f32_16x16x32_bf16 v[148:151], a[160:163], a[20:23], v[148:151]
  ds_read_b128 v[28:31], v12 offset:704
  v_mfma_f32_16x16x32_bf16 v[144:147], a[160:163], a[16:19], v[144:147]
  ds_read_b64_tr_b16 a[160:161], v4 offset:16384
  s_waitcnt lgkmcnt(10)
  v_mfma_f32_16x16x32_bf16 v[144:147], a[164:167], a[0:3], v[144:147]
  s_waitcnt lgkmcnt(6)
  s_add_u32 m0, s45, 65536
  v_fmac_f32 v224, v16, v24
  v_mfma_f32_16x16x32_bf16 v[160:163], a[172:175], a[0:3], v[160:163]
  ds_read_b64_tr_b16 a[162:163], v4 offset:18432
  v_fmac_f32 v225, v16, v25
  v_mfma_f32_16x16x32_bf16 v[160:163], a[168:171], a[16:19], v[160:163]
  buffer_load_dwordx4 v11, s[28:31], s71 offen lds
  v_fmac_f32 v226, v16, v26
  v_fmac_f32 v227, v16, v27
  v_mfma_f32_16x16x32_bf16 v[164:167], a[168:171], a[20:23], v[164:167]
  ds_read_b64_tr_b16 a[164:165], v4 offset:20480
  v_fmac_f32 v228, v18, v24
  v_mfma_f32_16x16x32_bf16 v[164:167], a[172:175], a[4:7], v[164:167]
  s_add_u32 m0, s45, 73728
  v_fmac_f32 v229, v18, v25
  v_fmac_f32 v230, v18, v26
  v_mfma_f32_16x16x32_bf16 v[168:171], a[172:175], a[8:11], v[168:171]
  ds_read_b64_tr_b16 a[166:167], v4 offset:22528
  v_fmac_f32 v231, v18, v27
  v_mfma_f32_16x16x32_bf16 v[168:171], a[168:171], a[24:27], v[168:171]
  buffer_load_dwordx4 v11, s[32:35], s71 offen lds
  v_fmac_f32 v232, v20, v24
  v_fmac_f32 v233, v20, v25
  v_mfma_f32_16x16x32_bf16 v[172:175], a[168:171], a[28:31], v[172:175]
  ds_read_b64_tr_b16 a[168:169], v4 offset:24576
  v_fmac_f32 v234, v20, v26
  v_mfma_f32_16x16x32_bf16 v[172:175], a[172:175], a[12:15], v[172:175]
  s_waitcnt lgkmcnt(6)
  v_fmac_f32 v235, v20, v27
  v_fmac_f32 v236, v22, v24
  v_mfma_f32_16x16x32_bf16 v[188:191], a[180:183], a[12:15], v[188:191]
  ds_read_b64_tr_b16 a[170:171], v4 offset:26624
  v_fmac_f32 v237, v22, v25
  v_mfma_f32_16x16x32_bf16 v[188:191], a[176:179], a[28:31], v[188:191]
  s_add_u32 m0, s45, 69632
  s_add_u32 s61, s71, 229376
  v_fmac_f32 v238, v22, v26
  v_mfma_f32_16x16x32_bf16 v[184:187], a[176:179], a[24:27], v[184:187]
  ds_read_b64_tr_b16 a[172:173], v4 offset:28672
  v_fmac_f32 v239, v22, v27
  v_mfma_f32_16x16x32_bf16 v[184:187], a[180:183], a[8:11], v[184:187]
  buffer_load_dwordx4 v11, s[28:31], s61 offen lds
  ds_read_b128 v[24:27], v12 offset:1216
  v_mfma_f32_16x16x32_bf16 v[180:183], a[180:183], a[4:7], v[180:183]
  ds_read_b64_tr_b16 a[174:175], v4 offset:30720
  s_waitcnt lgkmcnt(9)
  v_mfma_f32_16x16x32_bf16 v[180:183], a[176:179], a[20:23], v[180:183]
  s_add_u32 m0, s45, 77824
  s_add_u32 s61, s71, 229376
  v_fmac_f32 v224, v17, v28
  v_mfma_f32_16x16x32_bf16 v[176:179], a[176:179], a[16:19], v[176:179]
  ds_read_b64_tr_b16 a[176:177], v5 offset:16384
  v_fmac_f32 v225, v17, v29
  v_mfma_f32_16x16x32_bf16 v[176:179], a[180:183], a[0:3], v[176:179]
  s_waitcnt lgkmcnt(6)
  buffer_load_dwordx4 v11, s[32:35], s61 offen lds
  v_fmac_f32 v226, v17, v30
  v_mfma_f32_16x16x32_bf16 v[192:195], a[160:163], a[0:3], v[192:195]
  ds_read_b64_tr_b16 a[178:179], v5 offset:18432
  v_fmac_f32 v227, v17, v31
  v_mfma_f32_16x16x32_bf16 v[192:195], a[164:167], a[16:19], v[192:195]
  v_fmac_f32 v228, v19, v28
  v_fmac_f32 v229, v19, v29
  v_mfma_f32_16x16x32_bf16 v[196:199], a[164:167], a[20:23], v[196:199]
  ds_read_b64_tr_b16 a[180:181], v5 offset:20480
  v_fmac_f32 v230, v19, v30
  v_mfma_f32_16x16x32_bf16 v[196:199], a[160:163], a[4:7], v[196:199]
  s_add_u32 s62, s92, 6144
  v_fmac_f32 v231, v19, v31
  v_fmac_f32 v232, v21, v28
  v_mfma_f32_16x16x32_bf16 v[200:203], a[160:163], a[8:11], v[200:203]
  ds_read_b64_tr_b16 a[182:183], v5 offset:22528
  v_fmac_f32 v233, v21, v29
  v_mfma_f32_16x16x32_bf16 v[200:203], a[164:167], a[24:27], v[200:203]
  buffer_load_dword a253, v13, s[36:39], s62 offen
  v_fmac_f32 v234, v21, v30
  v_fmac_f32 v235, v21, v31
  v_mfma_f32_16x16x32_bf16 v[204:207], a[164:167], a[28:31], v[204:207]
  ds_read_b64_tr_b16 a[164:165], v5 offset:24576
  v_fmac_f32 v236, v23, v28
  v_mfma_f32_16x16x32_bf16 v[204:207], a[160:163], a[12:15], v[204:207]
  s_waitcnt lgkmcnt(5)
  v_fmac_f32 v237, v23, v29
  v_fmac_f32 v238, v23, v30
  v_mfma_f32_16x16x32_bf16 v[220:223], a[168:171], a[12:15], v[220:223]
  ds_read_b64_tr_b16 a[166:167], v5 offset:26624
  v_fmac_f32 v239, v23, v31
  v_mfma_f32_16x16x32_bf16 v[220:223], a[172:175], a[28:31], v[220:223]
  ds_read_b128 v[28:31], v12 offset:1728
  v_mfma_f32_16x16x32_bf16 v[216:219], a[172:175], a[24:27], v[216:219]
  ds_read_b64_tr_b16 a[160:161], v5 offset:28672
  v_mfma_f32_16x16x32_bf16 v[216:219], a[168:171], a[8:11], v[216:219]
  v_mfma_f32_16x16x32_bf16 v[212:215], a[168:171], a[4:7], v[212:215]
  ds_read_b64_tr_b16 a[162:163], v5 offset:30720
  v_mfma_f32_16x16x32_bf16 v[212:215], a[172:175], a[20:23], v[212:215]
  s_waitcnt vmcnt(24)
  s_barrier
  v_mfma_f32_16x16x32_bf16 v[208:211], a[172:175], a[16:19], v[208:211]
  ds_read_b64_tr_b16 a[172:173], v8 offset:32768
  v_mfma_f32_16x16x32_bf16 v[208:211], a[168:171], a[0:3], v[208:211]
  s_waitcnt lgkmcnt(6)
  buffer_load_dwordx4 a[212:215], v1, s[8:11], s79 offen offset:1024 sc1
  v_mfma_f32_16x16x32_bf16 v[224:227], a[176:179], a[0:3], v[224:227]
  ds_read_b64_tr_b16 a[174:175], v8 offset:34816
  v_mfma_f32_16x16x32_bf16 v[224:227], a[180:183], a[16:19], v[224:227]
  s_add_u32 s79, s79, 65536
  v_mfma_f32_16x16x32_bf16 v[228:231], a[180:183], a[20:23], v[228:231]
  ds_read_b64_tr_b16 a[168:169], v8 offset:36864
  v_mfma_f32_16x16x32_bf16 v[228:231], a[176:179], a[4:7], v[228:231]
  buffer_load_dwordx4 a[200:203], v1, s[8:11], s79 offen offset:0 sc1
  v_mfma_f32_16x16x32_bf16 v[232:235], a[176:179], a[8:11], v[232:235]
  ds_read_b64_tr_b16 a[170:171], v8 offset:38912
  v_mfma_f32_16x16x32_bf16 v[232:235], a[180:183], a[24:27], v[232:235]
  v_mfma_f32_16x16x32_bf16 v[236:239], a[180:183], a[28:31], v[236:239]
  ds_read_b64_tr_b16 a[180:181], v8 offset:40960
  v_mfma_f32_16x16x32_bf16 v[236:239], a[176:179], a[12:15], v[236:239]
  s_waitcnt lgkmcnt(5)
  v_mfma_f32_16x16x32_bf16 v[252:255], a[164:167], a[12:15], v[252:255]
  ds_read_b64_tr_b16 a[182:183], v8 offset:43008
  v_mfma_f32_16x16x32_bf16 v[252:255], a[160:163], a[28:31], v[252:255]
  buffer_load_dwordx4 a[216:219], v1, s[8:11], s79 offen offset:1024 sc1
  v_mfma_f32_16x16x32_bf16 v[248:251], a[160:163], a[24:27], v[248:251]
  ds_read_b64_tr_b16 a[176:177], v8 offset:45056
  v_mfma_f32_16x16x32_bf16 v[248:251], a[164:167], a[8:11], v[248:251]
  s_add_u32 m0, s45, 0
  v_mfma_f32_16x16x32_bf16 v[244:247], a[164:167], a[4:7], v[244:247]
  ds_read_b64_tr_b16 a[178:179], v8 offset:47104
  v_mfma_f32_16x16x32_bf16 v[244:247], a[160:163], a[20:23], v[244:247]
  buffer_load_dwordx4 v10, s[28:31], s67 offen lds
  v_mfma_f32_16x16x32_bf16 v[240:243], a[160:163], a[16:19], v[240:243]
  ds_read_b64_tr_b16 a[160:161], v8 offset:49152
  v_mfma_f32_16x16x32_bf16 v[240:243], a[164:167], a[0:3], v[240:243]
  s_waitcnt vmcnt(40) lgkmcnt(5)
  v_mfma_f32_16x16x32_bf16 v[32:35], a[172:175], a[64:67], v[32:35]
  ds_read_b64_tr_b16 a[162:163], v8 offset:51200
  v_mfma_f32_16x16x32_bf16 v[32:35], a[168:171], a[80:83], v[32:35]
  s_add_u32 m0, s45, 8192
  v_mfma_f32_16x16x32_bf16 v[36:39], a[168:171], a[84:87], v[36:39]
  ds_read_b64_tr_b16 a[164:165], v8 offset:53248
  s_waitcnt lgkmcnt(15)
  v_mfma_f32_16x16x32_bf16 v[36:39], a[172:175], a[68:71], v[36:39]
  buffer_load_dwordx4 v10, s[32:35], s67 offen lds
  v_fmac_f32 v240, v16, v24
  v_fmac_f32 v241, v16, v25
  v_mfma_f32_16x16x32_bf16 v[40:43], a[172:175], a[72:75], v[40:43]
  ds_read_b64_tr_b16 a[166:167], v8 offset:55296
  v_fmac_f32 v242, v16, v26
  v_mfma_f32_16x16x32_bf16 v[40:43], a[168:171], a[88:91], v[40:43]
  s_add_u32 m0, s45, 4096
  s_add_u32 s61, s67, 229376
  v_fmac_f32 v243, v16, v27
  v_mfma_f32_16x16x32_bf16 v[44:47], a[168:171], a[92:95], v[44:47]
  ds_read_b64_tr_b16 a[168:169], v8 offset:57344
  v_fmac_f32 v244, v18, v24
  v_mfma_f32_16x16x32_bf16 v[44:47], a[172:175], a[76:79], v[44:47]
  s_waitcnt lgkmcnt(5)
  buffer_load_dwordx4 v10, s[28:31], s61 offen lds
  v_fmac_f32 v245, v18, v25
  v_mfma_f32_16x16x32_bf16 v[60:63], a[180:183], a[76:79], v[60:63]
  ds_read_b64_tr_b16 a[170:171], v8 offset:59392
  v_fmac_f32 v246, v18, v26
  v_mfma_f32_16x16x32_bf16 v[60:63], a[176:179], a[92:95], v[60:63]
  s_add_u32 m0, s45, 12288
  s_add_u32 s61, s67, 229376
  v_fmac_f32 v247, v18, v27
  v_mfma_f32_16x16x32_bf16 v[56:59], a[176:179], a[88:91], v[56:59]
  ds_read_b64_tr_b16 a[172:173], v8 offset:61440
  v_fmac_f32 v248, v20, v24
  v_mfma_f32_16x16x32_bf16 v[56:59], a[180:183], a[72:75], v[56:59]
  buffer_load_dwordx4 v10, s[32:35], s61 offen lds
  v_fmac_f32 v249, v20, v25
  v_fmac_f32 v250, v20, v26
  v_mfma_f32_16x16x32_bf16 v[52:55], a[180:183], a[68:71], v[52:55]
  ds_read_b64_tr_b16 a[174:175], v8 offset:63488
  v_fmac_f32 v251, v20, v27
  v_mfma_f32_16x16x32_bf16 v[52:55], a[176:179], a[84:87], v[52:55]
  s_waitcnt vmcnt(8)
  s_barrier
  v_mfma_f32_16x16x32_bf16 v[48:51], a[176:179], a[80:83], v[48:51]
  ds_read_b64_tr_b16 a[176:177], v8 offset:16384
  s_add_u32 m0, s45, 32768
  v_mfma_f32_16x16x32_bf16 v[48:51], a[180:183], a[64:67], v[48:51]
  s_waitcnt vmcnt(30) lgkmcnt(5)
  buffer_load_dwordx4 v10, s[28:31], s68 offen lds
  v_fmac_f32 v252, v22, v24
  v_mfma_f32_16x16x32_bf16 v[32:35], a[160:163], a[96:99], v[32:35]
  ds_read_b64_tr_b16 a[178:179], v8 offset:18432
  v_fmac_f32 v253, v22, v25
  v_mfma_f32_16x16x32_bf16 v[32:35], a[164:167], a[112:115], v[32:35]
  s_add_u32 m0, s45, 40960
  v_fmac_f32 v254, v22, v26
  v_fmac_f32 v255, v22, v27
  v_mfma_f32_16x16x32_bf16 v[36:39], a[164:167], a[116:119], v[36:39]
  ds_read_b64_tr_b16 a[180:181], v8 offset:20480
  s_waitcnt lgkmcnt(15)
  v_mfma_f32_16x16x32_bf16 v[36:39], a[160:163], a[100:103], v[36:39]
  buffer_load_dwordx4 v10, s[32:35], s68 offen lds
  v_fmac_f32 v240, v17, v28
  v_fmac_f32 v241, v17, v29
  v_mfma_f32_16x16x32_bf16 v[40:43], a[160:163], a[104:107], v[40:43]
  ds_read_b64_tr_b16 a[182:183], v8 offset:22528
  v_fmac_f32 v242, v17, v30
  v_mfma_f32_16x16x32_bf16 v[40:43], a[164:167], a[120:123], v[40:43]
  s_add_u32 m0, s45, 36864
  s_add_u32 s61, s68, 229376
  v_fmac_f32 v243, v17, v31
  v_mfma_f32_16x16x32_bf16 v[44:47], a[164:167], a[124:127], v[44:47]
  ds_read_b64_tr_b16 a[164:165], v8 offset:24576
  v_fmac_f32 v244, v19, v28
  v_mfma_f32_16x16x32_bf16 v[44:47], a[160:163], a[108:111], v[44:47]
  s_waitcnt lgkmcnt(5)
  buffer_load_dwordx4 v10, s[28:31], s61 offen lds
  v_fmac_f32 v245, v19, v29
  v_mfma_f32_16x16x32_bf16 v[60:63], a[168:171], a[108:111], v[60:63]
  ds_read_b64_tr_b16 a[166:167], v8 offset:26624
  v_fmac_f32 v246, v19, v30
  v_mfma_f32_16x16x32_bf16 v[60:63], a[172:175], a[124:127], v[60:63]
  s_add_u32 m0, s45, 45056
  s_add_u32 s61, s68, 229376
  v_fmac_f32 v247, v19, v31
  v_mfma_f32_16x16x32_bf16 v[56:59], a[172:175], a[120:123], v[56:59]
  ds_read_b64_tr_b16 a[160:161], v8 offset:28672
  v_fmac_f32 v248, v21, v28
  v_mfma_f32_16x16x32_bf16 v[56:59], a[168:171], a[104:107], v[56:59]
  buffer_load_dwordx4 v10, s[32:35], s61 offen lds
  v_fmac_f32 v249, v21, v29
  v_fmac_f32 v250, v21, v30
  v_mfma_f32_16x16x32_bf16 v[52:55], a[168:171], a[100:103], v[52:55]
  ds_read_b64_tr_b16 a[162:163], v8 offset:30720
  v_fmac_f32 v251, v21, v31
  v_mfma_f32_16x16x32_bf16 v[52:55], a[172:175], a[116:119], v[52:55]
  s_add_u32 m0, s45, 49152
  v_fmac_f32 v252, v23, v28
  v_fmac_f32 v253, v23, v29
  v_mfma_f32_16x16x32_bf16 v[48:51], a[172:175], a[112:115], v[48:51]
  ds_read_b64_tr_b16 a[172:173], v8 offset:0
  v_fmac_f32 v254, v23, v30
  v_mfma_f32_16x16x32_bf16 v[48:51], a[168:171], a[96:99], v[48:51]
  s_waitcnt vmcnt(25) lgkmcnt(5)
  buffer_load_dwordx4 v10, s[28:31], s69 offen lds
  v_fmac_f32 v255, v23, v31
  v_mfma_f32_16x16x32_bf16 v[32:35], a[176:179], a[128:131], v[32:35]
  ds_read_b64_tr_b16 a[174:175], v8 offset:2048
  v_mfma_f32_16x16x32_bf16 v[32:35], a[180:183], a[144:147], v[32:35]
  s_add_u32 m0, s45, 57344
  v_rcp_f32 v16, v17
  v_mfma_f32_16x16x32_bf16 v[36:39], a[180:183], a[148:151], v[36:39]
  ds_read_b64_tr_b16 a[168:169], v8 offset:4096
  v_mfma_f32_16x16x32_bf16 v[36:39], a[176:179], a[132:135], v[36:39]
  buffer_load_dwordx4 v10, s[32:35], s69 offen lds
  v_rcp_f32 v18, v19
  v_mfma_f32_16x16x32_bf16 v[40:43], a[176:179], a[136:139], v[40:43]
  ds_read_b64_tr_b16 a[170:171], v8 offset:6144
  v_mfma_f32_16x16x32_bf16 v[40:43], a[180:183], a[152:155], v[40:43]
  s_add_u32 m0, s45, 53248
  s_add_u32 s61, s69, 229376
  v_mfma_f32_16x16x32_bf16 v[44:47], a[180:183], a[156:159], v[44:47]
  ds_read_b64_tr_b16 a[180:181], v8 offset:8192
  v_mfma_f32_16x16x32_bf16 v[44:47], a[176:179], a[140:143], v[44:47]
  s_waitcnt lgkmcnt(5)
  buffer_load_dwordx4 v10, s[28:31], s61 offen lds
  v_mfma_f32_16x16x32_bf16 v[60:63], a[164:167], a[140:143], v[60:63]
  ds_read_b64_tr_b16 a[182:183], v8 offset:10240
  v_rcp_f32 v20, v21
  v_mfma_f32_16x16x32_bf16 v[60:63], a[160:163], a[156:159], v[60:63]
  s_add_u32 m0, s45, 61440
  s_add_u32 s61, s69, 229376
  v_mfma_f32_16x16x32_bf16 v[56:59], a[160:163], a[152:155], v[56:59]
  ds_read_b64_tr_b16 a[176:177], v8 offset:12288
  v_mfma_f32_16x16x32_bf16 v[56:59], a[164:167], a[136:139], v[56:59]
  buffer_load_dwordx4 v10, s[32:35], s61 offen lds
  v_rcp_f32 v22, v23
  v_mfma_f32_16x16x32_bf16 v[52:55], a[164:167], a[132:135], v[52:55]
  ds_read_b64_tr_b16 a[178:179], v8 offset:14336
  v_mul_f32 v17, v17, v17
  v_mfma_f32_16x16x32_bf16 v[52:55], a[160:163], a[148:151], v[52:55]
  s_add_u32 s62, s92, 8192
  v_mul_f32 v19, v19, v19
  v_mul_f32 v21, v21, v21
HOP13:
  s_cbranch_execz HOP16
  v_mfma_f32_16x16x32_bf16 v[48:51], a[160:163], a[144:147], v[48:51]
  ds_read_b64_tr_b16 a[160:161], v6 offset:32768
  v_mul_f32 v23, v23, v23
  v_mfma_f32_16x16x32_bf16 v[48:51], a[164:167], a[128:131], v[48:51]
  s_waitcnt vmcnt(12) lgkmcnt(5)
  buffer_load_dword a253, v13, s[36:39], s62 offen
  v_mul_f32 v16, 0xbfb8aa3b, v16
  v_mfma_f32_16x16x32_bf16 v[32:35], a[172:175], a[188:191], v[32:35]
  ds_read_b64_tr_b16 a[162:163], v6 offset:34816
  v_mul_f32 v18, 0xbfb8aa3b, v18
  v_mfma_f32_16x16x32_bf16 v[32:35], a[168:171], a[204:207], v[32:35]
  v_mul_f32 v20, 0xbfb8aa3b, v20
  v_mul_f32 v22, 0xbfb8aa3b, v22
  v_mfma_f32_16x16x32_bf16 v[36:39], a[168:171], a[208:211], v[36:39]
  ds_read_b64_tr_b16 a[164:165], v6 offset:36864
  v_mfma_f32_16x16x32_bf16 v[36:39], a[172:175], a[192:195], v[36:39]
  v_mfma_f32_16x16x32_bf16 v[40:43], a[172:175], a[196:199], v[40:43]
  ds_read_b64_tr_b16 a[166:167], v6 offset:38912
  v_mfma_f32_16x16x32_bf16 v[40:43], a[168:171], a[212:215], v[40:43]
  s_add_u32 m0, s45, 16384
  v_mfma_f32_16x16x32_bf16 v[44:47], a[168:171], a[216:219], v[44:47]
  ds_read_b64_tr_b16 a[168:169], v6 offset:40960
  v_mfma_f32_16x16x32_bf16 v[44:47], a[172:175], a[200:203], v[44:47]
  s_waitcnt lgkmcnt(5)
  buffer_load_dwordx4 v10, s[28:31], s70 offen lds
  v_mfma_f32_16x16x32_bf16 v[60:63], a[180:183], a[200:203], v[60:63]
  ds_read_b64_tr_b16 a[170:171], v6 offset:43008
  v_mfma_f32_16x16x32_bf16 v[60:63], a[176:179], a[216:219], v[60:63]
  s_add_u32 m0, s45, 24576
  v_mfma_f32_16x16x32_bf16 v[56:59], a[176:179], a[212:215], v[56:59]
  ds_read_b64_tr_b16 a[172:173], v6 offset:45056
  v_mfma_f32_16x16x32_bf16 v[56:59], a[180:183], a[196:199], v[56:59]
  buffer_load_dwordx4 v10, s[32:35], s70 offen lds
  v_mfma_f32_16x16x32_bf16 v[52:55], a[180:183], a[192:195], v[52:55]
  ds_read_b64_tr_b16 a[174:175], v6 offset:47104
  v_mfma_f32_16x16x32_bf16 v[52:55], a[176:179], a[208:211], v[52:55]
  s_add_u32 m0, s45, 20480
  s_add_u32 s61, s70, 229376
  v_mfma_f32_16x16x32_bf16 v[48:51], a[176:179], a[204:207], v[48:51]
  ds_read_b64_tr_b16 a[176:177], v6 offset:49152
  v_mfma_f32_16x16x32_bf16 v[48:51], a[180:183], a[188:191], v[48:51]
  s_waitcnt lgkmcnt(5)
  buffer_load_dwordx4 v10, s[28:31], s61 offen lds
  v_mfma_f32_16x16x32_bf16 v[64:67], a[160:163], a[64:67], v[64:67]
  ds_read_b64_tr_b16 a[178:179], v6 offset:51200
  v_mfma_f32_16x16x32_bf16 v[64:67], a[164:167], a[80:83], v[64:67]
  s_add_u32 m0, s45, 28672
  s_add_u32 s61, s70, 229376
  v_mfma_f32_16x16x32_bf16 v[68:71], a[164:167], a[84:87], v[68:71]
  ds_read_b64_tr_b16 a[180:181], v6 offset:53248
  v_mul_f32 v24, v16, v32
  v_mul_f32 v25, v16, v33
  v_mfma_f32_16x16x32_bf16 v[68:71], a[160:163], a[68:71], v[68:71]
  buffer_load_dwordx4 v10, s[32:35], s61 offen lds
  v_mul_f32 v26, v16, v34
  v_mul_f32 v27, v16, v35
  v_mul_f32 v28, v18, v36
  v_mfma_f32_16x16x32_bf16 v[72:75], a[160:163], a[72:75], v[72:75]
  ds_read_b64_tr_b16 a[182:183], v6 offset:55296
  v_mul_f32 v29, v18, v37
  v_mfma_f32_16x16x32_bf16 v[72:75], a[164:167], a[88:91], v[72:75]
  v_mul_f32 v30, v18, v38
  v_mul_f32 v31, v18, v39
  v_mfma_f32_16x16x32_bf16 v[76:79], a[164:167], a[92:95], v[76:79]
  ds_read_b64_tr_b16 a[164:165], v6 offset:57344
  v_exp_f32 v24, v24
  v_mfma_f32_16x16x32_bf16 v[76:79], a[160:163], a[76:79], v[76:79]
  s_waitcnt lgkmcnt(5)
  v_mul_f32 v48, v32, v48
  v_exp_f32 v25, v25
  v_mfma_f32_16x16x32_bf16 v[92:95], a[168:171], a[76:79], v[92:95]
  ds_read_b64_tr_b16 a[166:167], v6 offset:59392
  v_mul_f32 v49, v33, v49
  v_mfma_f32_16x16x32_bf16 v[92:95], a[172:175], a[92:95], v[92:95]
  v_exp_f32 v26, v26
  v_mul_f32 v50, v34, v50
  v_mfma_f32_16x16x32_bf16 v[88:91], a[172:175], a[88:91], v[88:91]
  ds_read_b64_tr_b16 a[160:161], v6 offset:61440
  v_exp_f32 v27, v27
  v_mfma_f32_16x16x32_bf16 v[88:91], a[168:171], a[72:75], v[88:91]
  v_mul_f32 v51, v35, v51
  v_exp_f32 v28, v28
  v_mfma_f32_16x16x32_bf16 v[84:87], a[168:171], a[68:71], v[84:87]
  ds_read_b64_tr_b16 a[162:163], v6 offset:63488
  v_mul_f32 v52, v36, v52
  v_mfma_f32_16x16x32_bf16 v[84:87], a[172:175], a[84:87], v[84:87]
  v_exp_f32 v29, v29
  v_mul_f32 v53, v37, v53
  v_mfma_f32_16x16x32_bf16 v[80:83], a[172:175], a[80:83], v[80:83]
  ds_read_b64_tr_b16 a[172:173], v6 offset:16384
  v_exp_f32 v30, v30
  v_mfma_f32_16x16x32_bf16 v[80:83], a[168:171], a[64:67], v[80:83]
  s_waitcnt lgkmcnt(5)
  v_mul_f32 v54, v38, v54
  v_exp_f32 v31, v31
  v_mfma_f32_16x16x32_bf16 v[64:67], a[176:179], a[96:99], v[64:67]
  ds_read_b64_tr_b16 a[174:175], v6 offset:18432
  v_mul_f32 v55, v39, v55
  v_mfma_f32_16x16x32_bf16 v[64:67], a[180:183], a[112:115], v[64:67]
  v_fma_f32 v24, v24, v17, v17
  v_fma_f32 v25, v25, v17, v17
  v_mfma_f32_16x16x32_bf16 v[68:71], a[180:183], a[116:119], v[68:71]
  ds_read_b64_tr_b16 a[168:169], v6 offset:20480
  v_rcp_f32 v24, v24
  v_mfma_f32_16x16x32_bf16 v[68:71], a[176:179], a[100:103], v[68:71]
  v_fma_f32 v26, v26, v17, v17
  v_rcp_f32 v25, v25
  v_mfma_f32_16x16x32_bf16 v[72:75], a[176:179], a[104:107], v[72:75]
  ds_read_b64_tr_b16 a[170:171], v6 offset:22528
  v_fma_f32 v27, v27, v17, v17
  v_mfma_f32_16x16x32_bf16 v[72:75], a[180:183], a[120:123], v[72:75]
  v_rcp_f32 v26, v26
  v_fma_f32 v28, v28, v19, v19
  v_mfma_f32_16x16x32_bf16 v[76:79], a[180:183], a[124:127], v[76:79]
  ds_read_b64_tr_b16 a[180:181], v6 offset:24576
  v_rcp_f32 v27, v27
  v_mfma_f32_16x16x32_bf16 v[76:79], a[176:179], a[108:111], v[76:79]
  s_waitcnt lgkmcnt(5)
  v_fma_f32 v29, v29, v19, v19
  v_rcp_f32 v28, v28
  v_mfma_f32_16x16x32_bf16 v[92:95], a[164:167], a[108:111], v[92:95]
  ds_read_b64_tr_b16 a[182:183], v6 offset:26624
  v_fma_f32 v30, v30, v19, v19
  v_mfma_f32_16x16x32_bf16 v[92:95], a[160:163], a[124:127], v[92:95]
  v_rcp_f32 v29, v29
  v_fma_f32 v31, v31, v19, v19
  v_mfma_f32_16x16x32_bf16 v[88:91], a[160:163], a[120:123], v[88:91]
  ds_read_b64_tr_b16 a[176:177], v6 offset:28672
  v_rcp_f32 v30, v30
  v_mfma_f32_16x16x32_bf16 v[88:91], a[164:167], a[104:107], v[88:91]
  v_mul_f32 v48, v48, v24
  v_rcp_f32 v31, v31
  v_mfma_f32_16x16x32_bf16 v[84:87], a[164:167], a[100:103], v[84:87]
  ds_read_b64_tr_b16 a[178:179], v6 offset:30720
  v_mul_f32 v49, v49, v25
  v_mfma_f32_16x16x32_bf16 v[84:87], a[160:163], a[116:119], v[84:87]
  v_mul_f32 v50, v50, v26
  v_mul_f32 v51, v51, v27
  v_mul_f32 v52, v52, v28
  v_mfma_f32_16x16x32_bf16 v[80:83], a[160:163], a[112:115], v[80:83]
  ds_read_b64_tr_b16 a[160:161], v6 offset:0
  v_mul_f32 v53, v53, v29
  v_mul_f32 v54, v54, v30
  v_mfma_f32_16x16x32_bf16 v[80:83], a[164:167], a[96:99], v[80:83]
  s_waitcnt lgkmcnt(5)
  v_mul_f32 v55, v55, v31
  v_cvt_pk_bf16_f32 v32, v48, v49
  v_cvt_pk_bf16_f32 v33, v50, v51
  v_mfma_f32_16x16x32_bf16 v[64:67], a[172:175], a[128:131], v[64:67]
  ds_read_b64_tr_b16 a[162:163], v6 offset:2048
  v_mfma_f32_16x16x32_bf16 v[64:67], a[168:171], a[144:147], v[64:67]
  buffer_store_dwordx2 v[32:33], v1, s[8:11], s60 offen sc1
  v_mfma_f32_16x16x32_bf16 v[68:71], a[168:171], a[148:151], v[68:71]
  ds_read_b64_tr_b16 a[164:165], v6 offset:4096
  v_cvt_pk_bf16_f32 v36, v52, v53
  v_cvt_pk_bf16_f32 v37, v54, v55
  v_mfma_f32_16x16x32_bf16 v[68:71], a[172:175], a[132:135], v[68:71]
  s_add_u32 s55, s60, 262144
  buffer_store_dwordx2 v[36:37], v1, s[8:11], s55 offen sc1
  v_mfma_f32_16x16x32_bf16 v[72:75], a[172:175], a[136:139], v[72:75]
  ds_read_b64_tr_b16 a[166:167], v6 offset:6144
  s_add_u32 s62, s92, 10240
  v_mfma_f32_16x16x32_bf16 v[72:75], a[168:171], a[152:155], v[72:75]
  buffer_load_dword a253, v13, s[36:39], s62 offen
  v_mul_f32 v24, v20, v40
  v_mul_f32 v25, v20, v41
  v_mul_f32 v26, v20, v42
  v_mfma_f32_16x16x32_bf16 v[76:79], a[168:171], a[156:159], v[76:79]
  ds_read_b64_tr_b16 a[168:169], v6 offset:8192
  v_mul_f32 v27, v20, v43
  v_mul_f32 v28, v22, v44
  v_mfma_f32_16x16x32_bf16 v[76:79], a[172:175], a[140:143], v[76:79]
  s_waitcnt lgkmcnt(5)
  v_mul_f32 v29, v22, v45
  v_mul_f32 v30, v22, v46
  v_mul_f32 v31, v22, v47
  v_mfma_f32_16x16x32_bf16 v[92:95], a[180:183], a[140:143], v[92:95]
  ds_read_b64_tr_b16 a[170:171], v6 offset:10240
  v_mfma_f32_16x16x32_bf16 v[92:95], a[176:179], a[156:159], v[92:95]
  v_exp_f32 v24, v24
  v_mul_f32 v56, v40, v56
  v_mfma_f32_16x16x32_bf16 v[88:91], a[176:179], a[152:155], v[88:91]
  ds_read_b64_tr_b16 a[172:173], v6 offset:12288
  v_exp_f32 v25, v25
  v_mfma_f32_16x16x32_bf16 v[88:91], a[180:183], a[136:139], v[88:91]
  v_mul_f32 v57, v41, v57
  v_exp_f32 v26, v26
  v_mfma_f32_16x16x32_bf16 v[84:87], a[180:183], a[132:135], v[84:87]
  ds_read_b64_tr_b16 a[174:175], v6 offset:14336
  v_mul_f32 v58, v42, v58
  v_mfma_f32_16x16x32_bf16 v[84:87], a[176:179], a[148:151], v[84:87]
  v_exp_f32 v27, v27
  v_mul_f32 v59, v43, v59
  v_mfma_f32_16x16x32_bf16 v[80:83], a[176:179], a[144:147], v[80:83]
  ds_read_b64_tr_b16 a[176:177], v7 offset:32768
  v_exp_f32 v28, v28
  v_mfma_f32_16x16x32_bf16 v[80:83], a[180:183], a[128:131], v[80:83]
  s_waitcnt lgkmcnt(5)
  v_mul_f32 v60, v44, v60
  v_exp_f32 v29, v29
  v_mfma_f32_16x16x32_bf16 v[64:67], a[160:163], a[188:191], v[64:67]
  ds_read_b64_tr_b16 a[178:179], v7 offset:34816
  v_mul_f32 v61, v45, v61
  v_mfma_f32_16x16x32_bf16 v[64:67], a[164:167], a[204:207], v[64:67]
  v_exp_f32 v30, v30
  v_mul_f32 v62, v46, v62
  v_mfma_f32_16x16x32_bf16 v[68:71], a[164:167], a[208:211], v[68:71]
  ds_read_b64_tr_b16 a[180:181], v7 offset:36864
  v_exp_f32 v31, v31
  v_mfma_f32_16x16x32_bf16 v[68:71], a[160:163], a[192:195], v[68:71]
  v_mul_f32 v63, v47, v63
  v_fma_f32 v24, v24, v21, v21
  v_fma_f32 v25, v25, v21, v21
  v_mfma_f32_16x16x32_bf16 v[72:75], a[160:163], a[196:199], v[72:75]
  ds_read_b64_tr_b16 a[182:183], v7 offset:38912
  v_mfma_f32_16x16x32_bf16 v[72:75], a[164:167], a[212:215], v[72:75]
  v_rcp_f32 v24, v24
  v_fma_f32 v26, v26, v21, v21
  v_mfma_f32_16x16x32_bf16 v[76:79], a[164:167], a[216:219], v[76:79]
  ds_read_b64_tr_b16 a[164:165], v7 offset:40960
  v_rcp_f32 v25, v25
  v_mfma_f32_16x16x32_bf16 v[76:79], a[160:163], a[200:203], v[76:79]
  s_waitcnt lgkmcnt(5)
  v_fma_f32 v27, v27, v21, v21
  v_rcp_f32 v26, v26
  v_mfma_f32_16x16x32_bf16 v[92:95], a[168:171], a[200:203], v[92:95]
  ds_read_b64_tr_b16 a[166:167], v7 offset:43008
  v_fma_f32 v28, v28, v23, v23
  v_mfma_f32_16x16x32_bf16 v[92:95], a[172:175], a[216:219], v[92:95]
  v_rcp_f32 v27, v27
  v_fma_f32 v29, v29, v23, v23
  v_mfma_f32_16x16x32_bf16 v[88:91], a[172:175], a[212:215], v[88:91]
  ds_read_b64_tr_b16 a[160:161], v7 offset:45056
  v_rcp_f32 v28, v28
  v_mfma_f32_16x16x32_bf16 v[88:91], a[168:171], a[196:199], v[88:91]
  v_fma_f32 v30, v30, v23, v23
  v_rcp_f32 v29, v29
  v_mfma_f32_16x16x32_bf16 v[84:87], a[168:171], a[192:195], v[84:87]
  ds_read_b64_tr_b16 a[162:163], v7 offset:47104
  v_fma_f32 v31, v31, v23, v23
  v_mfma_f32_16x16x32_bf16 v[84:87], a[172:175], a[208:211], v[84:87]
  v_rcp_f32 v30, v30
  v_mul_f32 v56, v56, v24
  v_mfma_f32_16x16x32_bf16 v[80:83], a[172:175], a[204:207], v[80:83]
  ds_read_b64_tr_b16 a[172:173], v7 offset:49152
  v_rcp_f32 v31, v31
  v_mfma_f32_16x16x32_bf16 v[80:83], a[168:171], a[188:191], v[80:83]
  s_waitcnt lgkmcnt(5)
  v_mul_f32 v57, v57, v25
  v_mul_f32 v58, v58, v26
  v_mul_f32 v59, v59, v27
  v_mfma_f32_16x16x32_bf16 v[96:99], a[176:179], a[64:67], v[96:99]
  ds_read_b64_tr_b16 a[174:175], v7 offset:51200
  v_mul_f32 v60, v60, v28
  v_mfma_f32_16x16x32_bf16 v[96:99], a[180:183], a[80:83], v[96:99]
  v_mul_f32 v61, v61, v29
  v_mul_f32 v62, v62, v30
  v_mul_f32 v63, v63, v31
  v_mfma_f32_16x16x32_bf16 v[100:103], a[180:183], a[84:87], v[100:103]
  ds_read_b64_tr_b16 a[168:169], v7 offset:53248
  v_cvt_pk_bf16_f32 v40, v56, v57
  v_cvt_pk_bf16_f32 v41, v58, v59
  v_mfma_f32_16x16x32_bf16 v[100:103], a[176:179], a[68:71], v[100:103]
  s_add_u32 s55, s60, 524288
  buffer_store_dwordx2 v[40:41], v1, s[8:11], s55 offen sc1
  v_mfma_f32_16x16x32_bf16 v[104:107], a[176:179], a[72:75], v[104:107]
  ds_read_b64_tr_b16 a[170:171], v7 offset:55296
  v_cvt_pk_bf16_f32 v44, v60, v61
  v_mfma_f32_16x16x32_bf16 v[104:107], a[180:183], a[88:91], v[104:107]
  v_cvt_pk_bf16_f32 v45, v62, v63
  v_mfma_f32_16x16x32_bf16 v[108:111], a[180:183], a[92:95], v[108:111]
  ds_read_b64_tr_b16 a[180:181], v7 offset:57344
  v_mfma_f32_16x16x32_bf16 v[108:111], a[176:179], a[76:79], v[108:111]
  s_waitcnt lgkmcnt(5)
  s_add_u32 s55, s60, 786432
  buffer_store_dwordx2 v[44:45], v1, s[8:11], s55 offen sc1
  v_mfma_f32_16x16x32_bf16 v[124:127], a[164:167], a[76:79], v[124:127]
  ds_read_b64_tr_b16 a[182:183], v7 offset:59392
  v_mul_f32 v24, v16, v64
  v_mfma_f32_16x16x32_bf16 v[124:127], a[160:163], a[92:95], v[124:127]
  v_mul_f32 v25, v16, v65
  v_mul_f32 v26, v16, v66
  v_mul_f32 v27, v16, v67
  v_mfma_f32_16x16x32_bf16 v[120:123], a[160:163], a[88:91], v[120:123]
  ds_read_b64_tr_b16 a[176:177], v7 offset:61440
  v_mul_f32 v28, v18, v68
  v_mul_f32 v29, v18, v69
  v_mfma_f32_16x16x32_bf16 v[120:123], a[164:167], a[72:75], v[120:123]
  v_mul_f32 v30, v18, v70
  v_mul_f32 v31, v18, v71
  v_mfma_f32_16x16x32_bf16 v[116:119], a[164:167], a[68:71], v[116:119]
  ds_read_b64_tr_b16 a[178:179], v7 offset:63488
  v_mfma_f32_16x16x32_bf16 v[116:119], a[160:163], a[84:87], v[116:119]
  v_exp_f32 v24, v24
  v_mul_f32 v80, v64, v80
  v_mfma_f32_16x16x32_bf16 v[112:115], a[160:163], a[80:83], v[112:115]
  ds_read_b64_tr_b16 a[160:161], v7 offset:16384
  v_exp_f32 v25, v25
  v_mfma_f32_16x16x32_bf16 v[112:115], a[164:167], a[64:67], v[112:115]
  s_waitcnt lgkmcnt(5)
  v_mul_f32 v81, v65, v81
  v_exp_f32 v26, v26
  v_mfma_f32_16x16x32_bf16 v[96:99], a[172:175], a[96:99], v[96:99]
  ds_read_b64_tr_b16 a[162:163], v7 offset:18432
  v_mul_f32 v82, v66, v82
  v_mfma_f32_16x16x32_bf16 v[96:99], a[168:171], a[112:115], v[96:99]
  v_exp_f32 v27, v27
  v_mul_f32 v83, v67, v83
  v_mfma_f32_16x16x32_bf16 v[100:103], a[168:171], a[116:119], v[100:103]
  ds_read_b64_tr_b16 a[164:165], v7 offset:20480
  v_exp_f32 v28, v28
  v_mfma_f32_16x16x32_bf16 v[100:103], a[172:175], a[100:103], v[100:103]
  v_mul_f32 v84, v68, v84
  v_exp_f32 v29, v29
  v_mfma_f32_16x16x32_bf16 v[104:107], a[172:175], a[104:107], v[104:107]
  ds_read_b64_tr_b16 a[166:167], v7 offset:22528
  v_mul_f32 v85, v69, v85
  v_mfma_f32_16x16x32_bf16 v[104:107], a[168:171], a[120:123], v[104:107]
  v_lshrrev_b32 v48, 3, v0
  v_bfe_u32 v49, v48, 1, 2
  v_bfe_u32 v50, v0, 1, 2
  v_mfma_f32_16x16x32_bf16 v[108:111], a[168:171], a[124:127], v[108:111]
  ds_read_b64_tr_b16 a[168:169], v7 offset:24576
  v_xor_b32 v49, v49, v50
  v_lshlrev_b32 v49, 5, v49
  v_mfma_f32_16x16x32_bf16 v[108:111], a[172:175], a[108:111], v[108:111]
  s_waitcnt lgkmcnt(5)
  v_and_b32 v50, 1, v0
  v_lshl_add_u32 v49, v50, 4, v49
  s_lshl_b32 s53, s44, 3
  v_mfma_f32_16x16x32_bf16 v[124:127], a[180:183], a[108:111], v[124:127]
  ds_read_b64_tr_b16 a[170:171], v7 offset:26624
  v_add_u32 v48, s53, v48
  v_mfma_f32_16x16x32_bf16 v[124:127], a[176:179], a[124:127], v[124:127]
  v_lshl_add_u32 v48, v48, 11, v49
  s_mul_i32 s53, s52, 1835008
  s_lshl_b32 s54, s51, 7
  v_mfma_f32_16x16x32_bf16 v[120:123], a[176:179], a[120:123], v[120:123]
  ds_read_b64_tr_b16 a[172:173], v7 offset:28672
  s_add_u32 s53, s53, s54
  v_add_u32 v33, s53, v48
  v_mfma_f32_16x16x32_bf16 v[120:123], a[180:183], a[104:107], v[120:123]
  v_xor_b32 v32, 128, v33
  v_and_b32 v48, 3, v0
  v_bfe_u32 v49, v0, 2, 1
  v_mfma_f32_16x16x32_bf16 v[116:119], a[180:183], a[100:103], v[116:119]
  ds_read_b64_tr_b16 a[174:175], v7 offset:30720
  v_lshl_add_u32 v48, v48, 3, v49
  v_mfma_f32_16x16x32_bf16 v[116:119], a[176:179], a[116:119], v[116:119]
  v_lshlrev_b32 v37, 7, v48
  v_exp_f32 v30, v30
  v_mfma_f32_16x16x32_bf16 v[112:115], a[176:179], a[112:115], v[112:115]
  ds_read_b64_tr_b16 a[176:177], v7 offset:0
  v_mul_f32 v86, v70, v86
  v_mfma_f32_16x16x32_bf16 v[112:115], a[180:183], a[96:99], v[112:115]
  s_waitcnt lgkmcnt(5)
  v_exp_f32 v31, v31
  v_mul_f32 v87, v71, v87
  v_mfma_f32_16x16x32_bf16 v[96:99], a[160:163], a[128:131], v[96:99]
  ds_read_b64_tr_b16 a[178:179], v7 offset:2048
  v_fma_f32 v24, v24, v17, v17
  v_mfma_f32_16x16x32_bf16 v[96:99], a[164:167], a[144:147], v[96:99]
  v_fma_f32 v25, v25, v17, v17
  v_rcp_f32 v24, v24
  v_mfma_f32_16x16x32_bf16 v[100:103], a[164:167], a[148:151], v[100:103]
  ds_read_b64_tr_b16 a[180:181], v7 offset:4096
  v_fma_f32 v26, v26, v17, v17
  v_mfma_f32_16x16x32_bf16 v[100:103], a[160:163], a[132:135], v[100:103]
  v_rcp_f32 v25, v25
  v_fma_f32 v27, v27, v17, v17
  v_mfma_f32_16x16x32_bf16 v[104:107], a[160:163], a[136:139], v[104:107]
  ds_read_b64_tr_b16 a[182:183], v7 offset:6144
  v_mfma_f32_16x16x32_bf16 v[104:107], a[164:167], a[152:155], v[104:107]
  v_rcp_f32 v26, v26
  v_fma_f32 v28, v28, v19, v19
  v_mfma_f32_16x16x32_bf16 v[108:111], a[164:167], a[156:159], v[108:111]
  ds_read_b64_tr_b16 a[164:165], v7 offset:8192
  v_rcp_f32 v27, v27
  v_mfma_f32_16x16x32_bf16 v[108:111], a[160:163], a[140:143], v[108:111]
  s_waitcnt lgkmcnt(5)
  v_fma_f32 v29, v29, v19, v19
  v_rcp_f32 v28, v28
  v_mfma_f32_16x16x32_bf16 v[124:127], a[168:171], a[140:143], v[124:127]
  ds_read_b64_tr_b16 a[166:167], v7 offset:10240
  v_fma_f32 v30, v30, v19, v19
  v_mfma_f32_16x16x32_bf16 v[124:127], a[172:175], a[156:159], v[124:127]
  v_rcp_f32 v29, v29
  v_fma_f32 v31, v31, v19, v19
  v_mfma_f32_16x16x32_bf16 v[120:123], a[172:175], a[152:155], v[120:123]
  ds_read_b64_tr_b16 a[160:161], v7 offset:12288
  s_add_u32 s62, s92, 12288
  v_mfma_f32_16x16x32_bf16 v[120:123], a[168:171], a[136:139], v[120:123]
  buffer_load_dword a253, v13, s[36:39], s62 offen
  v_rcp_f32 v30, v30
  v_mul_f32 v80, v80, v24
  v_mfma_f32_16x16x32_bf16 v[116:119], a[168:171], a[132:135], v[116:119]
  ds_read_b64_tr_b16 a[162:163], v7 offset:14336
  v_mfma_f32_16x16x32_bf16 v[116:119], a[172:175], a[148:151], v[116:119]
  s_waitcnt vmcnt(19)
  s_barrier
  v_mfma_f32_16x16x32_bf16 v[112:115], a[172:175], a[144:147], v[112:115]
  ds_read_b64_tr_b16 a[172:173], v2 offset:0
  v_rcp_f32 v31, v31
  v_mfma_f32_16x16x32_bf16 v[112:115], a[168:171], a[128:131], v[112:115]
  s_waitcnt lgkmcnt(5)
  v_mul_f32 v81, v81, v25
  v_mul_f32 v82, v82, v26
  v_mul_f32 v83, v83, v27
  v_mfma_f32_16x16x32_bf16 v[96:99], a[176:179], a[188:191], v[96:99]
  ds_read_b64_tr_b16 a[174:175], v2 offset:2048
  v_mul_f32 v84, v84, v28
  v_mfma_f32_16x16x32_bf16 v[96:99], a[180:183], a[204:207], v[96:99]
  s_add_u32 m0, s45, 98304
  v_mul_f32 v85, v85, v29
  v_mul_f32 v86, v86, v30
  v_mul_f32 v87, v87, v31
  v_mfma_f32_16x16x32_bf16 v[100:103], a[180:183], a[208:211], v[100:103]
  ds_read_b64_tr_b16 a[168:169], v2 offset:4096
  v_cvt_pk_bf16_f32 v64, v80, v81
  v_cvt_pk_bf16_f32 v65, v82, v83
  v_mfma_f32_16x16x32_bf16 v[100:103], a[176:179], a[192:195], v[100:103]
  buffer_load_dwordx4 v10, s[28:31], s71 offen lds
  v_cvt_pk_bf16_f32 v68, v84, v85
  v_cvt_pk_bf16_f32 v69, v86, v87
  v_mul_f32 v24, v20, v72
  v_mfma_f32_16x16x32_bf16 v[104:107], a[176:179], a[196:199], v[104:107]
  ds_read_b64_tr_b16 a[170:171], v2 offset:6144
  v_mul_f32 v25, v20, v73
  v_mfma_f32_16x16x32_bf16 v[104:107], a[180:183], a[212:215], v[104:107]
  s_add_u32 m0, s45, 106496
  v_mul_f32 v26, v20, v74
  v_mul_f32 v27, v20, v75
  v_mul_f32 v28, v22, v76
  v_mfma_f32_16x16x32_bf16 v[108:111], a[180:183], a[216:219], v[108:111]
  ds_read_b64_tr_b16 a[180:181], v2 offset:8192
  v_mul_f32 v29, v22, v77
  v_mul_f32 v30, v22, v78
  v_mfma_f32_16x16x32_bf16 v[108:111], a[176:179], a[200:203], v[108:111]
  s_waitcnt lgkmcnt(5)
  buffer_load_dwordx4 v10, s[32:35], s71 offen lds
  v_mul_f32 v31, v22, v79
  v_mfma_f32_16x16x32_bf16 v[124:127], a[164:167], a[200:203], v[124:127]
  ds_read_b64_tr_b16 a[182:183], v2 offset:10240
  s_waitcnt vmcnt(8)
  s_barrier
  v_mfma_f32_16x16x32_bf16 v[124:127], a[160:163], a[216:219], v[124:127]
  s_add_u32 m0, s45, 102400
  s_add_u32 s61, s71, 229376
  v_exp_f32 v24, v24
  v_mfma_f32_16x16x32_bf16 v[120:123], a[160:163], a[212:215], v[120:123]
  ds_read_b64_tr_b16 a[176:177], v2 offset:12288
  v_mul_f32 v88, v72, v88
  v_mfma_f32_16x16x32_bf16 v[120:123], a[164:167], a[196:199], v[120:123]
  buffer_load_dwordx4 v10, s[28:31], s61 offen lds
  v_exp_f32 v25, v25
  v_mul_f32 v89, v73, v89
  v_mfma_f32_16x16x32_bf16 v[116:119], a[164:167], a[192:195], v[116:119]
  ds_read_b64_tr_b16 a[178:179], v2 offset:14336
  v_mfma_f32_16x16x32_bf16 v[116:119], a[160:163], a[208:211], v[116:119]
  s_add_u32 m0, s45, 110592
  s_add_u32 s61, s71, 229376
  v_exp_f32 v26, v26
  v_mfma_f32_16x16x32_bf16 v[112:115], a[160:163], a[204:207], v[112:115]
  ds_read_b64_tr_b16 a[160:161], v3 offset:0
  v_mul_f32 v90, v74, v90
  v_mfma_f32_16x16x32_bf16 v[112:115], a[164:167], a[188:191], v[112:115]
  s_waitcnt lgkmcnt(5)
  buffer_load_dwordx4 v10, s[32:35], s61 offen lds
  v_exp_f32 v27, v27
  v_mfma_f32_16x16x32_bf16 v[128:131], a[172:175], a[32:35], v[128:131]
  ds_read_b64_tr_b16 a[162:163], v3 offset:2048
  v_mul_f32 v91, v75, v91
  v_mfma_f32_16x16x32_bf16 v[128:131], a[168:171], a[48:51], v[128:131]
  v_exp_f32 v28, v28
  v_mul_f32 v92, v76, v92
  v_mfma_f32_16x16x32_bf16 v[132:135], a[168:171], a[52:55], v[132:135]
  ds_read_b64_tr_b16 a[164:165], v3 offset:4096
  v_exp_f32 v29, v29
  v_mfma_f32_16x16x32_bf16 v[132:135], a[172:175], a[36:39], v[132:135]
  v_mul_f32 v93, v77, v93
  v_exp_f32 v30, v30
  v_mfma_f32_16x16x32_bf16 v[136:139], a[172:175], a[40:43], v[136:139]
  ds_read_b64_tr_b16 a[166:167], v3 offset:6144
  v_mul_f32 v94, v78, v94
  v_mfma_f32_16x16x32_bf16 v[136:139], a[168:171], a[56:59], v[136:139]
  v_exp_f32 v31, v31
  v_mul_f32 v95, v79, v95
  v_mfma_f32_16x16x32_bf16 v[140:143], a[168:171], a[60:63], v[140:143]
  ds_read_b64_tr_b16 a[168:169], v3 offset:8192
  v_fma_f32 v24, v24, v21, v21
  v_fma_f32 v25, v25, v21, v21
  v_mfma_f32_16x16x32_bf16 v[140:143], a[172:175], a[44:47], v[140:143]
  s_waitcnt lgkmcnt(5)
  v_rcp_f32 v24, v24
  v_fma_f32 v26, v26, v21, v21
  v_mfma_f32_16x16x32_bf16 v[156:159], a[180:183], a[44:47], v[156:159]
  ds_read_b64_tr_b16 a[170:171], v3 offset:10240
  v_mfma_f32_16x16x32_bf16 v[156:159], a[176:179], a[60:63], v[156:159]
  v_rcp_f32 v25, v25
  v_fma_f32 v27, v27, v21, v21
  v_mfma_f32_16x16x32_bf16 v[152:155], a[176:179], a[56:59], v[152:155]
  ds_read_b64_tr_b16 a[172:173], v3 offset:12288
  v_rcp_f32 v26, v26
  v_mfma_f32_16x16x32_bf16 v[152:155], a[180:183], a[40:43], v[152:155]
  v_fma_f32 v28, v28, v23, v23
  v_rcp_f32 v27, v27
  v_mfma_f32_16x16x32_bf16 v[148:151], a[180:183], a[36:39], v[148:151]
  ds_read_b64_tr_b16 a[174:175], v3 offset:14336
  v_fma_f32 v29, v29, v23, v23
  v_mfma_f32_16x16x32_bf16 v[148:151], a[176:179], a[52:55], v[148:151]
  v_rcp_f32 v28, v28
  v_fma_f32 v30, v30, v23, v23
  v_mfma_f32_16x16x32_bf16 v[144:147], a[176:179], a[48:51], v[144:147]
  ds_read_b64_tr_b16 a[176:177], v4 offset:0
  v_rcp_f32 v29, v29
  v_mfma_f32_16x16x32_bf16 v[144:147], a[180:183], a[32:35], v[144:147]
  s_waitcnt lgkmcnt(5)
  v_fma_f32 v31, v31, v23, v23
  v_rcp_f32 v30, v30
  v_mfma_f32_16x16x32_bf16 v[160:163], a[160:163], a[32:35], v[160:163]
  ds_read_b64_tr_b16 a[178:179], v4 offset:2048
  v_mul_f32 v88, v88, v24
  v_mfma_f32_16x16x32_bf16 v[160:163], a[164:167], a[48:51], v[160:163]
  v_rcp_f32 v31, v31
  v_mul_f32 v89, v89, v25
  v_mfma_f32_16x16x32_bf16 v[164:167], a[164:167], a[52:55], v[164:167]
  ds_read_b64_tr_b16 a[180:181], v4 offset:4096
  v_mul_f32 v90, v90, v26
  v_mul_f32 v91, v91, v27
  v_mfma_f32_16x16x32_bf16 v[164:167], a[160:163], a[36:39], v[164:167]
  v_mul_f32 v92, v92, v28
  v_mul_f32 v93, v93, v29
  v_mul_f32 v94, v94, v30
  v_mfma_f32_16x16x32_bf16 v[168:171], a[160:163], a[40:43], v[168:171]
  ds_read_b64_tr_b16 a[182:183], v4 offset:6144
  v_mul_f32 v95, v95, v31
  v_mfma_f32_16x16x32_bf16 v[168:171], a[164:167], a[56:59], v[168:171]
  v_cvt_pk_bf16_f32 v72, v88, v89
  v_cvt_pk_bf16_f32 v73, v90, v91
  v_cvt_pk_bf16_f32 v76, v92, v93
  v_mfma_f32_16x16x32_bf16 v[172:175], a[164:167], a[60:63], v[172:175]
  ds_read_b64_tr_b16 a[164:165], v4 offset:8192
  v_cvt_pk_bf16_f32 v77, v94, v95
  v_mfma_f32_16x16x32_bf16 v[172:175], a[160:163], a[44:47], v[172:175]
  s_waitcnt lgkmcnt(5)
  v_mfma_f32_16x16x32_bf16 v[188:191], a[168:171], a[44:47], v[188:191]
  ds_read_b64_tr_b16 a[166:167], v4 offset:10240
  s_cmp_eq_u32 s91, 0
  s_cselect_b32 s72, 8, 1
  s_lshl_b32 s64, s72, 17
  s_lshl_b32 s72, s72, 11
  s_add_u32 s72, s72, s84
  s_add_u32 m0, s45, 114688
  v_mul_f32 v24, v16, v96
  v_mfma_f32_16x16x32_bf16 v[188:191], a[172:175], a[60:63], v[188:191]
  buffer_load_dwordx4 v32, s[36:39], s64 offen lds
  v_mul_f32 v25, v16, v97
  v_mul_f32 v26, v16, v98
  v_mul_f32 v27, v16, v99
  v_mfma_f32_16x16x32_bf16 v[184:187], a[172:175], a[56:59], v[184:187]
  ds_read_b64_tr_b16 a[160:161], v4 offset:12288
  v_mul_f32 v28, v18, v100
  v_mul_f32 v29, v18, v101
  v_mfma_f32_16x16x32_bf16 v[184:187], a[168:171], a[40:43], v[184:187]
  s_add_u32 m0, s45, 118784
  s_add_u32 s61, s64, 65536
  v_mul_f32 v30, v18, v102
  v_mul_f32 v31, v18, v103
  v_mfma_f32_16x16x32_bf16 v[180:183], a[168:171], a[36:39], v[180:183]
  ds_read_b64_tr_b16 a[162:163], v4 offset:14336
  v_exp_f32 v24, v24
  v_mfma_f32_16x16x32_bf16 v[180:183], a[172:175], a[52:55], v[180:183]
  buffer_load_dwordx4 v32, s[36:39], s61 offen lds
  v_mul_f32 v112, v96, v112
  v_exp_f32 v25, v25
  v_mfma_f32_16x16x32_bf16 v[176:179], a[172:175], a[48:51], v[176:179]
  ds_read_b64_tr_b16 a[172:173], v5 offset:0
  v_mul_f32 v113, v97, v113
  v_mfma_f32_16x16x32_bf16 v[176:179], a[168:171], a[32:35], v[176:179]
  s_waitcnt lgkmcnt(5)
  s_add_u32 m0, s45, 122880
  v_exp_f32 v26, v26
  v_mul_f32 v114, v98, v114
  v_mfma_f32_16x16x32_bf16 v[192:195], a[176:179], a[32:35], v[192:195]
  ds_read_b64_tr_b16 a[174:175], v5 offset:2048
  v_exp_f32 v27, v27
  v_mfma_f32_16x16x32_bf16 v[192:195], a[180:183], a[48:51], v[192:195]
  buffer_load_dwordx4 v33, s[36:39], s64 offen lds
  v_mul_f32 v115, v99, v115
  v_exp_f32 v28, v28
  v_mfma_f32_16x16x32_bf16 v[196:199], a[180:183], a[52:55], v[196:199]
  ds_read_b64_tr_b16 a[168:169], v5 offset:4096
  v_mul_f32 v116, v100, v116
  v_mfma_f32_16x16x32_bf16 v[196:199], a[176:179], a[36:39], v[196:199]
  s_add_u32 m0, s45, 126976
  s_add_u32 s61, s64, 65536
  v_exp_f32 v29, v29
  v_mul_f32 v117, v101, v117
  v_mfma_f32_16x16x32_bf16 v[200:203], a[176:179], a[40:43], v[200:203]
  ds_read_b64_tr_b16 a[170:171], v5 offset:6144
  v_exp_f32 v30, v30
  v_mfma_f32_16x16x32_bf16 v[200:203], a[180:183], a[56:59], v[200:203]
  buffer_load_dwordx4 v33, s[36:39], s61 offen lds
  v_mul_f32 v118, v102, v118
  v_exp_f32 v31, v31
  v_mfma_f32_16x16x32_bf16 v[204:207], a[180:183], a[60:63], v[204:207]
  ds_read_b64_tr_b16 a[180:181], v5 offset:8192
  v_mul_f32 v119, v103, v119
  v_fma_f32 v24, v24, v17, v17
  v_mfma_f32_16x16x32_bf16 v[204:207], a[176:179], a[44:47], v[204:207]
  s_waitcnt lgkmcnt(5)
  s_cmp_eq_u32 s91, 1
  s_cselect_b32 s73, 10, 3
  s_lshl_b32 s65, s73, 17
  s_lshl_b32 s73, s73, 11
  s_add_u32 s73, s73, s84
  s_add_u32 m0, s45, 81920
  v_fma_f32 v25, v25, v17, v17
  v_rcp_f32 v24, v24
  v_mfma_f32_16x16x32_bf16 v[220:223], a[164:167], a[44:47], v[220:223]
  ds_read_b64_tr_b16 a[182:183], v5 offset:10240
  v_fma_f32 v26, v26, v17, v17
  v_mfma_f32_16x16x32_bf16 v[220:223], a[160:163], a[60:63], v[220:223]
  buffer_load_dwordx4 v32, s[36:39], s65 offen lds
  v_rcp_f32 v25, v25
  v_fma_f32 v27, v27, v17, v17
  v_mfma_f32_16x16x32_bf16 v[216:219], a[160:163], a[56:59], v[216:219]
  ds_read_b64_tr_b16 a[176:177], v5 offset:12288
  v_rcp_f32 v26, v26
  v_mfma_f32_16x16x32_bf16 v[216:219], a[164:167], a[40:43], v[216:219]
HOP14:
  s_cbranch_execz HOP17
  s_add_u32 m0, s45, 86016
  s_add_u32 s61, s65, 65536
  v_fma_f32 v28, v28, v19, v19
  v_rcp_f32 v27, v27
  v_mfma_f32_16x16x32_bf16 v[212:215], a[164:167], a[36:39], v[212:215]
  ds_read_b64_tr_b16 a[178:179], v5 offset:14336
  v_fma_f32 v29, v29, v19, v19
  v_mfma_f32_16x16x32_bf16 v[212:215], a[160:163], a[52:55], v[212:215]
  buffer_load_dwordx4 v32, s[36:39], s61 offen lds
  v_rcp_f32 v28, v28
  v_fma_f32 v30, v30, v19, v19
  v_mfma_f32_16x16x32_bf16 v[208:211], a[160:163], a[48:51], v[208:211]
  ds_read_b64_tr_b16 a[160:161], v2 offset:32768
  v_rcp_f32 v29, v29
  v_mfma_f32_16x16x32_bf16 v[208:211], a[164:167], a[32:35], v[208:211]
  s_waitcnt lgkmcnt(5)
  s_add_u32 m0, s45, 90112
  v_fma_f32 v31, v31, v19, v19
  v_rcp_f32 v30, v30
  v_mfma_f32_16x16x32_bf16 v[224:227], a[172:175], a[32:35], v[224:227]
  ds_read_b64_tr_b16 a[162:163], v2 offset:34816
  v_mul_f32 v112, v112, v24
  v_mfma_f32_16x16x32_bf16 v[224:227], a[168:171], a[48:51], v[224:227]
  buffer_load_dwordx4 v33, s[36:39], s65 offen lds
  v_rcp_f32 v31, v31
  v_mul_f32 v113, v113, v25
  v_mfma_f32_16x16x32_bf16 v[228:231], a[168:171], a[52:55], v[228:231]
  ds_read_b64_tr_b16 a[164:165], v2 offset:36864
  v_mul_f32 v114, v114, v26
  v_mul_f32 v115, v115, v27
  v_mfma_f32_16x16x32_bf16 v[228:231], a[172:175], a[36:39], v[228:231]
  s_add_u32 m0, s45, 94208
  s_add_u32 s61, s65, 65536
  v_mul_f32 v116, v116, v28
  v_mul_f32 v117, v117, v29
  v_mul_f32 v118, v118, v30
  v_mfma_f32_16x16x32_bf16 v[232:235], a[172:175], a[40:43], v[232:235]
  ds_read_b64_tr_b16 a[166:167], v2 offset:38912
  v_mul_f32 v119, v119, v31
  v_cvt_pk_bf16_f32 v66, v112, v113
  v_mfma_f32_16x16x32_bf16 v[232:235], a[168:171], a[56:59], v[232:235]
  buffer_load_dwordx4 v33, s[36:39], s61 offen lds
  v_cvt_pk_bf16_f32 v67, v114, v115
  v_mfma_f32_16x16x32_bf16 v[236:239], a[168:171], a[60:63], v[236:239]
  ds_read_b64_tr_b16 a[168:169], v2 offset:40960
  v_mfma_f32_16x16x32_bf16 v[236:239], a[172:175], a[44:47], v[236:239]
  s_waitcnt lgkmcnt(5)
  s_cmp_eq_u32 s91, 2
  s_cselect_b32 s74, 12, 5
  s_lshl_b32 s66, s74, 17
  s_lshl_b32 s74, s74, 11
  s_add_u32 s74, s74, s84
  s_add_u32 m0, s45, 65536
  v_mfma_f32_16x16x32_bf16 v[252:255], a[180:183], a[44:47], v[252:255]
  ds_read_b64_tr_b16 a[170:171], v2 offset:43008
  buffer_store_dwordx4 v[64:67], v1, s[8:11], s59 offen offset:0 sc1
  v_mfma_f32_16x16x32_bf16 v[252:255], a[176:179], a[60:63], v[252:255]
  buffer_load_dwordx4 v32, s[36:39], s66 offen lds
  v_cvt_pk_bf16_f32 v70, v116, v117
  v_cvt_pk_bf16_f32 v71, v118, v119
  v_mfma_f32_16x16x32_bf16 v[248:251], a[176:179], a[56:59], v[248:251]
  ds_read_b64_tr_b16 a[172:173], v2 offset:45056
  v_mfma_f32_16x16x32_bf16 v[248:251], a[180:183], a[40:43], v[248:251]
  s_add_u32 m0, s45, 69632
  s_add_u32 s61, s66, 65536
  v_mfma_f32_16x16x32_bf16 v[244:247], a[180:183], a[36:39], v[244:247]
  ds_read_b64_tr_b16 a[174:175], v2 offset:47104
  s_add_u32 s55, s59, 262144
  buffer_store_dwordx4 v[68:71], v1, s[8:11], s55 offen offset:0 sc1
  v_mfma_f32_16x16x32_bf16 v[244:247], a[176:179], a[52:55], v[244:247]
  buffer_load_dwordx4 v32, s[36:39], s61 offen lds
  v_mul_f32 v24, v20, v104
  v_mul_f32 v25, v20, v105
  v_mul_f32 v26, v20, v106
  v_mfma_f32_16x16x32_bf16 v[240:243], a[176:179], a[48:51], v[240:243]
  ds_read_b64_tr_b16 a[176:177], v2 offset:49152
  v_mul_f32 v27, v20, v107
  v_mul_f32 v28, v22, v108
  v_mfma_f32_16x16x32_bf16 v[240:243], a[180:183], a[32:35], v[240:243]
  s_waitcnt lgkmcnt(5)
  s_add_u32 m0, s45, 73728
  v_mul_f32 v29, v22, v109
  v_mul_f32 v30, v22, v110
  v_mul_f32 v31, v22, v111
  v_mfma_f32_16x16x32_bf16 v[128:131], a[160:163], a[64:67], v[128:131]
  ds_read_b64_tr_b16 a[178:179], v2 offset:51200
  v_exp_f32 v24, v24
  v_mfma_f32_16x16x32_bf16 v[128:131], a[164:167], a[80:83], v[128:131]
  buffer_load_dwordx4 v33, s[36:39], s66 offen lds
  v_mul_f32 v120, v104, v120
  v_exp_f32 v25, v25
  v_mfma_f32_16x16x32_bf16 v[132:135], a[164:167], a[84:87], v[132:135]
  ds_read_b64_tr_b16 a[180:181], v2 offset:53248
  v_mul_f32 v121, v105, v121
  v_mfma_f32_16x16x32_bf16 v[132:135], a[160:163], a[68:71], v[132:135]
  s_add_u32 m0, s45, 77824
  s_add_u32 s61, s66, 65536
  v_exp_f32 v26, v26
  v_mul_f32 v122, v106, v122
  v_mfma_f32_16x16x32_bf16 v[136:139], a[160:163], a[72:75], v[136:139]
  ds_read_b64_tr_b16 a[182:183], v2 offset:55296
  v_exp_f32 v27, v27
  v_mfma_f32_16x16x32_bf16 v[136:139], a[164:167], a[88:91], v[136:139]
  buffer_load_dwordx4 v33, s[36:39], s61 offen lds
  v_mul_f32 v123, v107, v123
  v_exp_f32 v28, v28
  v_mfma_f32_16x16x32_bf16 v[140:143], a[164:167], a[92:95], v[140:143]
  ds_read_b64_tr_b16 a[164:165], v2 offset:57344
  v_mul_f32 v124, v108, v124
  v_mfma_f32_16x16x32_bf16 v[140:143], a[160:163], a[76:79], v[140:143]
  s_waitcnt lgkmcnt(5)
  v_exp_f32 v29, v29
  v_mul_f32 v125, v109, v125
  v_mfma_f32_16x16x32_bf16 v[156:159], a[168:171], a[76:79], v[156:159]
  ds_read_b64_tr_b16 a[166:167], v2 offset:59392
  v_exp_f32 v30, v30
  v_mfma_f32_16x16x32_bf16 v[156:159], a[172:175], a[92:95], v[156:159]
  v_mul_f32 v126, v110, v126
  v_exp_f32 v31, v31
  v_mfma_f32_16x16x32_bf16 v[152:155], a[172:175], a[88:91], v[152:155]
  ds_read_b64_tr_b16 a[160:161], v2 offset:61440
  v_mul_f32 v127, v111, v127
  v_fma_f32 v24, v24, v21, v21
  v_mfma_f32_16x16x32_bf16 v[152:155], a[168:171], a[72:75], v[152:155]
  v_fma_f32 v25, v25, v21, v21
  v_rcp_f32 v24, v24
  v_fma_f32 v26, v26, v21, v21
  v_mfma_f32_16x16x32_bf16 v[148:151], a[168:171], a[68:71], v[148:151]
  ds_read_b64_tr_b16 a[162:163], v2 offset:63488
  v_rcp_f32 v25, v25
  v_mfma_f32_16x16x32_bf16 v[148:151], a[172:175], a[84:87], v[148:151]
  v_fma_f32 v27, v27, v21, v21
  v_rcp_f32 v26, v26
  v_mfma_f32_16x16x32_bf16 v[144:147], a[172:175], a[80:83], v[144:147]
  ds_read_b64_tr_b16 a[172:173], v2 offset:16384
  v_fma_f32 v28, v28, v23, v23
  v_mfma_f32_16x16x32_bf16 v[144:147], a[168:171], a[64:67], v[144:147]
  s_waitcnt lgkmcnt(5)
  v_rcp_f32 v27, v27
  v_fma_f32 v29, v29, v23, v23
  v_mfma_f32_16x16x32_bf16 v[128:131], a[176:179], a[96:99], v[128:131]
  ds_read_b64_tr_b16 a[174:175], v2 offset:18432
  v_rcp_f32 v28, v28
  v_mfma_f32_16x16x32_bf16 v[128:131], a[180:183], a[112:115], v[128:131]
  v_fma_f32 v30, v30, v23, v23
  v_rcp_f32 v29, v29
  v_mfma_f32_16x16x32_bf16 v[132:135], a[180:183], a[116:119], v[132:135]
  ds_read_b64_tr_b16 a[168:169], v2 offset:20480
  v_fma_f32 v31, v31, v23, v23
  v_mfma_f32_16x16x32_bf16 v[132:135], a[176:179], a[100:103], v[132:135]
  v_rcp_f32 v30, v30
  v_mul_f32 v120, v120, v24
  v_mfma_f32_16x16x32_bf16 v[136:139], a[176:179], a[104:107], v[136:139]
  ds_read_b64_tr_b16 a[170:171], v2 offset:22528
  v_rcp_f32 v31, v31
  v_mfma_f32_16x16x32_bf16 v[136:139], a[180:183], a[120:123], v[136:139]
  v_mul_f32 v121, v121, v25
  v_mul_f32 v122, v122, v26
  v_mul_f32 v123, v123, v27
  v_mfma_f32_16x16x32_bf16 v[140:143], a[180:183], a[124:127], v[140:143]
  ds_read_b64_tr_b16 a[180:181], v2 offset:24576
  v_mul_f32 v124, v124, v28
  v_mul_f32 v125, v125, v29
  v_mfma_f32_16x16x32_bf16 v[140:143], a[176:179], a[108:111], v[140:143]
  s_waitcnt lgkmcnt(5)
  v_mul_f32 v126, v126, v30
  v_mul_f32 v127, v127, v31
  v_cvt_pk_bf16_f32 v74, v120, v121
  v_cvt_pk_bf16_f32 v75, v122, v123
  v_mfma_f32_16x16x32_bf16 v[156:159], a[164:167], a[108:111], v[156:159]
  ds_read_b64_tr_b16 a[182:183], v2 offset:26624
  v_mfma_f32_16x16x32_bf16 v[156:159], a[160:163], a[124:127], v[156:159]
  s_add_u32 s55, s59, 524288
  buffer_store_dwordx4 v[72:75], v1, s[8:11], s55 offen offset:0 sc1
  v_mfma_f32_16x16x32_bf16 v[152:155], a[160:163], a[120:123], v[152:155]
  ds_read_b64_tr_b16 a[176:177], v2 offset:28672
  v_cvt_pk_bf16_f32 v78, v124, v125
  v_cvt_pk_bf16_f32 v79, v126, v127
  v_mfma_f32_16x16x32_bf16 v[152:155], a[164:167], a[104:107], v[152:155]
  s_add_u32 s55, s59, 786432
  buffer_store_dwordx4 v[76:79], v1, s[8:11], s55 offen offset:0 sc1
  v_mfma_f32_16x16x32_bf16 v[148:151], a[164:167], a[100:103], v[148:151]
  ds_read_b64_tr_b16 a[178:179], v2 offset:30720
  v_mfma_f32_16x16x32_bf16 v[148:151], a[160:163], a[116:119], v[148:151]
  s_waitcnt vmcnt(16)
  s_barrier
  v_mfma_f32_16x16x32_bf16 v[144:147], a[160:163], a[112:115], v[144:147]
  ds_read_b64_tr_b16 a[160:161], v6 offset:32768
  s_cmp_eq_u32 s91, 0
  s_cselect_b32 s75, 1, 8
  s_lshl_b32 s67, s75, 17
  s_lshl_b32 s75, s75, 11
  s_add_u32 s75, s75, s84
  s_add_u32 m0, s45, 0
  v_mfma_f32_16x16x32_bf16 v[144:147], a[164:167], a[96:99], v[144:147]
  s_waitcnt lgkmcnt(5)
  buffer_load_dwordx4 v32, s[36:39], s67 offen lds
  v_mfma_f32_16x16x32_bf16 v[128:131], a[172:175], a[128:131], v[128:131]
  ds_read_b64_tr_b16 a[162:163], v6 offset:34816
  v_mfma_f32_16x16x32_bf16 v[128:131], a[168:171], a[144:147], v[128:131]
  s_add_u32 m0, s45, 4096
  s_add_u32 s61, s67, 65536
  v_mfma_f32_16x16x32_bf16 v[132:135], a[168:171], a[148:151], v[132:135]
  ds_read_b64_tr_b16 a[164:165], v6 offset:36864
  v_mfma_f32_16x16x32_bf16 v[132:135], a[172:175], a[132:135], v[132:135]
  buffer_load_dwordx4 v32, s[36:39], s61 offen lds
  v_mfma_f32_16x16x32_bf16 v[136:139], a[172:175], a[136:139], v[136:139]
  ds_read_b64_tr_b16 a[166:167], v6 offset:38912
  v_mfma_f32_16x16x32_bf16 v[136:139], a[168:171], a[152:155], v[136:139]
  s_add_u32 m0, s45, 8192
  v_mfma_f32_16x16x32_bf16 v[140:143], a[168:171], a[156:159], v[140:143]
  ds_read_b64_tr_b16 a[168:169], v6 offset:40960
  v_mfma_f32_16x16x32_bf16 v[140:143], a[172:175], a[140:143], v[140:143]
  s_waitcnt lgkmcnt(5)
  buffer_load_dwordx4 v33, s[36:39], s67 offen lds
  v_mfma_f32_16x16x32_bf16 v[156:159], a[180:183], a[140:143], v[156:159]
  ds_read_b64_tr_b16 a[170:171], v6 offset:43008
  v_mfma_f32_16x16x32_bf16 v[156:159], a[176:179], a[156:159], v[156:159]
  s_add_u32 m0, s45, 12288
  s_add_u32 s61, s67, 65536
  v_mfma_f32_16x16x32_bf16 v[152:155], a[176:179], a[152:155], v[152:155]
  ds_read_b64_tr_b16 a[172:173], v6 offset:45056
  v_mfma_f32_16x16x32_bf16 v[152:155], a[180:183], a[136:139], v[152:155]
  buffer_load_dwordx4 v33, s[36:39], s61 offen lds
  v_mfma_f32_16x16x32_bf16 v[148:151], a[180:183], a[132:135], v[148:151]
  ds_read_b64_tr_b16 a[174:175], v6 offset:47104
  v_mfma_f32_16x16x32_bf16 v[148:151], a[176:179], a[148:151], v[148:151]
  v_mfma_f32_16x16x32_bf16 v[144:147], a[176:179], a[144:147], v[144:147]
  ds_read_b64_tr_b16 a[176:177], v3 offset:32768
  v_mfma_f32_16x16x32_bf16 v[144:147], a[180:183], a[128:131], v[144:147]
  s_waitcnt lgkmcnt(5)
  v_mfma_f32_16x16x32_bf16 v[128:131], a[160:163], a[188:191], v[128:131]
  ds_read_b64_tr_b16 a[178:179], v3 offset:34816
  v_mfma_f32_16x16x32_bf16 v[128:131], a[164:167], a[204:207], v[128:131]
  v_mfma_f32_16x16x32_bf16 v[132:135], a[164:167], a[208:211], v[132:135]
  ds_read_b64_tr_b16 a[180:181], v3 offset:36864
  v_mfma_f32_16x16x32_bf16 v[132:135], a[160:163], a[192:195], v[132:135]
  v_mfma_f32_16x16x32_bf16 v[136:139], a[160:163], a[196:199], v[136:139]
  ds_read_b64_tr_b16 a[182:183], v3 offset:38912
  v_mfma_f32_16x16x32_bf16 v[136:139], a[164:167], a[212:215], v[136:139]
  v_mfma_f32_16x16x32_bf16 v[140:143], a[164:167], a[216:219], v[140:143]
  ds_read_b64_tr_b16 a[164:165], v3 offset:40960
  v_mfma_f32_16x16x32_bf16 v[140:143], a[160:163], a[200:203], v[140:143]
  s_waitcnt lgkmcnt(5)
  v_mfma_f32_16x16x32_bf16 v[156:159], a[168:171], a[200:203], v[156:159]
  ds_read_b64_tr_b16 a[166:167], v3 offset:43008
  v_mfma_f32_16x16x32_bf16 v[156:159], a[172:175], a[216:219], v[156:159]
  v_mfma_f32_16x16x32_bf16 v[152:155], a[172:175], a[212:215], v[152:155]
  ds_read_b64_tr_b16 a[160:161], v3 offset:45056
  v_mfma_f32_16x16x32_bf16 v[152:155], a[168:171], a[196:199], v[152:155]
  v_mfma_f32_16x16x32_bf16 v[148:151], a[168:171], a[192:195], v[148:151]
  ds_read_b64_tr_b16 a[162:163], v3 offset:47104
  v_mfma_f32_16x16x32_bf16 v[148:151], a[172:175], a[208:211], v[148:151]
  v_mfma_f32_16x16x32_bf16 v[144:147], a[172:175], a[204:207], v[144:147]
  ds_read_b64_tr_b16 a[172:173], v3 offset:49152
  v_mfma_f32_16x16x32_bf16 v[144:147], a[168:171], a[188:191], v[144:147]
  s_waitcnt lgkmcnt(5)
  v_mfma_f32_16x16x32_bf16 v[160:163], a[176:179], a[64:67], v[160:163]
  ds_read_b64_tr_b16 a[174:175], v3 offset:51200
  v_mfma_f32_16x16x32_bf16 v[160:163], a[180:183], a[80:83], v[160:163]
  v_mfma_f32_16x16x32_bf16 v[164:167], a[180:183], a[84:87], v[164:167]
  ds_read_b64_tr_b16 a[168:169], v3 offset:53248
  v_mul_f32 v24, v16, v128
  v_mfma_f32_16x16x32_bf16 v[164:167], a[176:179], a[68:71], v[164:167]
  v_mul_f32 v25, v16, v129
  v_mul_f32 v26, v16, v130
  v_mul_f32 v27, v16, v131
  v_mfma_f32_16x16x32_bf16 v[168:171], a[176:179], a[72:75], v[168:171]
  ds_read_b64_tr_b16 a[170:171], v3 offset:55296
  v_mul_f32 v28, v18, v132
  v_mfma_f32_16x16x32_bf16 v[168:171], a[180:183], a[88:91], v[168:171]
  v_mul_f32 v29, v18, v133
  v_mul_f32 v30, v18, v134
  v_mfma_f32_16x16x32_bf16 v[172:175], a[180:183], a[92:95], v[172:175]
  ds_read_b64_tr_b16 a[180:181], v3 offset:57344
  v_mul_f32 v31, v18, v135
  v_mfma_f32_16x16x32_bf16 v[172:175], a[176:179], a[76:79], v[172:175]
  s_waitcnt lgkmcnt(5)
  v_exp_f32 v24, v24
  v_mul_f32 v144, v128, v144
  v_mfma_f32_16x16x32_bf16 v[188:191], a[164:167], a[76:79], v[188:191]
  ds_read_b64_tr_b16 a[182:183], v3 offset:59392
  v_mfma_f32_16x16x32_bf16 v[188:191], a[160:163], a[92:95], v[188:191]
  v_exp_f32 v25, v25
  v_mfma_f32_16x16x32_bf16 v[184:187], a[160:163], a[88:91], v[184:187]
  ds_read_b64_tr_b16 a[176:177], v3 offset:61440
  v_mul_f32 v145, v129, v145
  v_mfma_f32_16x16x32_bf16 v[184:187], a[164:167], a[72:75], v[184:187]
  v_exp_f32 v26, v26
  v_mul_f32 v146, v130, v146
  v_mfma_f32_16x16x32_bf16 v[180:183], a[164:167], a[68:71], v[180:183]
  ds_read_b64_tr_b16 a[178:179], v3 offset:63488
  v_mfma_f32_16x16x32_bf16 v[180:183], a[160:163], a[84:87], v[180:183]
  v_exp_f32 v27, v27
  v_mfma_f32_16x16x32_bf16 v[176:179], a[160:163], a[80:83], v[176:179]
  ds_read_b64_tr_b16 a[160:161], v3 offset:16384
  v_mul_f32 v147, v131, v147
  v_mfma_f32_16x16x32_bf16 v[176:179], a[164:167], a[64:67], v[176:179]
  s_waitcnt lgkmcnt(5)
  v_exp_f32 v28, v28
  v_mul_f32 v148, v132, v148
  v_mfma_f32_16x16x32_bf16 v[160:163], a[172:175], a[96:99], v[160:163]
  ds_read_b64_tr_b16 a[162:163], v3 offset:18432
  v_mfma_f32_16x16x32_bf16 v[160:163], a[168:171], a[112:115], v[160:163]
  v_exp_f32 v29, v29
  v_mfma_f32_16x16x32_bf16 v[164:167], a[168:171], a[116:119], v[164:167]
  ds_read_b64_tr_b16 a[164:165], v3 offset:20480
  v_mul_f32 v149, v133, v149
  v_mfma_f32_16x16x32_bf16 v[164:167], a[172:175], a[100:103], v[164:167]
  v_exp_f32 v30, v30
  v_mul_f32 v150, v134, v150
  v_mfma_f32_16x16x32_bf16 v[168:171], a[172:175], a[104:107], v[168:171]
  ds_read_b64_tr_b16 a[166:167], v3 offset:22528
  v_add_u32 v38, s46, v0
  s_waitcnt vmcnt(4)
  s_barrier
  s_mov_b64 exec, 1
  buffer_store_dword v38, v0, s[8:11], s80 offen offset:0 sc1
  s_mov_b64 exec, -1
  v_mfma_f32_16x16x32_bf16 v[168:171], a[168:171], a[120:123], v[168:171]
  v_exp_f32 v31, v31
  v_mfma_f32_16x16x32_bf16 v[172:175], a[168:171], a[124:127], v[172:175]
  ds_read_b64_tr_b16 a[168:169], v3 offset:24576
  v_mul_f32 v151, v135, v151
  v_mfma_f32_16x16x32_bf16 v[172:175], a[172:175], a[108:111], v[172:175]
  s_waitcnt lgkmcnt(5)
  v_fma_f32 v24, v24, v17, v17
  v_fma_f32 v25, v25, v17, v17
  v_mfma_f32_16x16x32_bf16 v[188:191], a[180:183], a[108:111], v[188:191]
  ds_read_b64_tr_b16 a[170:171], v3 offset:26624
  v_mfma_f32_16x16x32_bf16 v[188:191], a[176:179], a[124:127], v[188:191]
  v_rcp_f32 v24, v24
  v_mfma_f32_16x16x32_bf16 v[184:187], a[176:179], a[120:123], v[184:187]
  ds_read_b64_tr_b16 a[172:173], v3 offset:28672
  v_fma_f32 v26, v26, v17, v17
  v_mfma_f32_16x16x32_bf16 v[184:187], a[180:183], a[104:107], v[184:187]
  v_rcp_f32 v25, v25
  v_fma_f32 v27, v27, v17, v17
  v_mfma_f32_16x16x32_bf16 v[180:183], a[180:183], a[100:103], v[180:183]
  ds_read_b64_tr_b16 a[174:175], v3 offset:30720
  v_mfma_f32_16x16x32_bf16 v[180:183], a[176:179], a[116:119], v[180:183]
  v_rcp_f32 v26, v26
  v_mfma_f32_16x16x32_bf16 v[176:179], a[176:179], a[112:115], v[176:179]
  ds_read_b64_tr_b16 a[176:177], v7 offset:32768
  v_fma_f32 v28, v28, v19, v19
  v_mfma_f32_16x16x32_bf16 v[176:179], a[180:183], a[96:99], v[176:179]
  s_waitcnt lgkmcnt(5)
  v_rcp_f32 v27, v27
  v_fma_f32 v29, v29, v19, v19
  v_mfma_f32_16x16x32_bf16 v[160:163], a[160:163], a[128:131], v[160:163]
  ds_read_b64_tr_b16 a[178:179], v7 offset:34816
  v_mfma_f32_16x16x32_bf16 v[160:163], a[164:167], a[144:147], v[160:163]
  v_rcp_f32 v28, v28
  v_mfma_f32_16x16x32_bf16 v[164:167], a[164:167], a[148:151], v[164:167]
  ds_read_b64_tr_b16 a[180:181], v7 offset:36864
  v_fma_f32 v30, v30, v19, v19
  v_mfma_f32_16x16x32_bf16 v[164:167], a[160:163], a[132:135], v[164:167]
  v_rcp_f32 v29, v29
  v_fma_f32 v31, v31, v19, v19
  v_mfma_f32_16x16x32_bf16 v[168:171], a[160:163], a[136:139], v[168:171]
  ds_read_b64_tr_b16 a[182:183], v7 offset:38912
  v_mfma_f32_16x16x32_bf16 v[168:171], a[164:167], a[152:155], v[168:171]
  v_rcp_f32 v30, v30
  v_mfma_f32_16x16x32_bf16 v[172:175], a[164:167], a[156:159], v[172:175]
  ds_read_b64_tr_b16 a[164:165], v7 offset:40960
  v_mul_f32 v144, v144, v24
  v_mfma_f32_16x16x32_bf16 v[172:175], a[160:163], a[140:143], v[172:175]
  s_waitcnt lgkmcnt(5)
  v_rcp_f32 v31, v31
  v_mul_f32 v145, v145, v25
  v_mfma_f32_16x16x32_bf16 v[188:191], a[168:171], a[140:143], v[188:191]
  ds_read_b64_tr_b16 a[166:167], v7 offset:43008
  v_mul_f32 v146, v146, v26
  v_mfma_f32_16x16x32_bf16 v[188:191], a[172:175], a[156:159], v[188:191]
  v_mul_f32 v147, v147, v27
  v_mul_f32 v148, v148, v28
  v_mfma_f32_16x16x32_bf16 v[184:187], a[172:175], a[152:155], v[184:187]
  ds_read_b64_tr_b16 a[160:161], v7 offset:45056
  v_mul_f32 v149, v149, v29
  v_mfma_f32_16x16x32_bf16 v[184:187], a[168:171], a[136:139], v[184:187]
  v_mul_f32 v150, v150, v30
  v_mul_f32 v151, v151, v31
  v_cvt_pk_bf16_f32 v128, v144, v145
  v_mfma_f32_16x16x32_bf16 v[180:183], a[168:171], a[132:135], v[180:183]
  ds_read_b64_tr_b16 a[162:163], v7 offset:47104
  v_cvt_pk_bf16_f32 v129, v146, v147
  v_mfma_f32_16x16x32_bf16 v[180:183], a[172:175], a[148:151], v[180:183]
  v_cvt_pk_bf16_f32 v132, v148, v149
  v_cvt_pk_bf16_f32 v133, v150, v151
  v_mfma_f32_16x16x32_bf16 v[176:179], a[172:175], a[144:147], v[176:179]
  ds_read_b64_tr_b16 a[172:173], v4 offset:32768
  v_mul_f32 v24, v20, v136
  v_mfma_f32_16x16x32_bf16 v[176:179], a[168:171], a[128:131], v[176:179]
  s_waitcnt lgkmcnt(5)
  v_mul_f32 v25, v20, v137
  v_mul_f32 v26, v20, v138
  v_mul_f32 v27, v20, v139
  v_mfma_f32_16x16x32_bf16 v[160:163], a[176:179], a[188:191], v[160:163]
  ds_read_b64_tr_b16 a[174:175], v4 offset:34816
  v_mul_f32 v28, v22, v140
  v_mfma_f32_16x16x32_bf16 v[160:163], a[180:183], a[204:207], v[160:163]
  v_mul_f32 v29, v22, v141
  v_mul_f32 v30, v22, v142
  v_mfma_f32_16x16x32_bf16 v[164:167], a[180:183], a[208:211], v[164:167]
  ds_read_b64_tr_b16 a[168:169], v4 offset:36864
  v_mul_f32 v31, v22, v143
  v_mfma_f32_16x16x32_bf16 v[164:167], a[176:179], a[192:195], v[164:167]
  v_exp_f32 v24, v24
  v_mul_f32 v152, v136, v152
  v_mfma_f32_16x16x32_bf16 v[168:171], a[176:179], a[196:199], v[168:171]
  ds_read_b64_tr_b16 a[170:171], v4 offset:38912
  v_mfma_f32_16x16x32_bf16 v[168:171], a[180:183], a[212:215], v[168:171]
  v_exp_f32 v25, v25
  v_mfma_f32_16x16x32_bf16 v[172:175], a[180:183], a[216:219], v[172:175]
  ds_read_b64_tr_b16 a[180:181], v4 offset:40960
  v_mul_f32 v153, v137, v153
  v_mfma_f32_16x16x32_bf16 v[172:175], a[176:179], a[200:203], v[172:175]
  s_waitcnt lgkmcnt(5)
  v_exp_f32 v26, v26
  v_mul_f32 v154, v138, v154
  v_mfma_f32_16x16x32_bf16 v[188:191], a[164:167], a[200:203], v[188:191]
  ds_read_b64_tr_b16 a[182:183], v4 offset:43008
  v_mfma_f32_16x16x32_bf16 v[188:191], a[160:163], a[216:219], v[188:191]
  v_exp_f32 v27, v27
  v_mfma_f32_16x16x32_bf16 v[184:187], a[160:163], a[212:215], v[184:187]
  ds_read_b64_tr_b16 a[176:177], v4 offset:45056
  v_mul_f32 v155, v139, v155
  v_mfma_f32_16x16x32_bf16 v[184:187], a[164:167], a[196:199], v[184:187]
  v_exp_f32 v28, v28
  v_mul_f32 v156, v140, v156
  v_mfma_f32_16x16x32_bf16 v[180:183], a[164:167], a[192:195], v[180:183]
  ds_read_b64_tr_b16 a[178:179], v4 offset:47104
  v_mfma_f32_16x16x32_bf16 v[180:183], a[160:163], a[208:211], v[180:183]
  v_exp_f32 v29, v29
  v_mfma_f32_16x16x32_bf16 v[176:179], a[160:163], a[204:207], v[176:179]
  ds_read_b64_tr_b16 a[160:161], v4 offset:49152
  v_mul_f32 v157, v141, v157
  v_mfma_f32_16x16x32_bf16 v[176:179], a[164:167], a[188:191], v[176:179]
  s_waitcnt lgkmcnt(5)
  v_exp_f32 v30, v30
  v_mul_f32 v158, v142, v158
  v_mfma_f32_16x16x32_bf16 v[192:195], a[172:175], a[64:67], v[192:195]
  ds_read_b64_tr_b16 a[162:163], v4 offset:51200
  v_mfma_f32_16x16x32_bf16 v[192:195], a[168:171], a[80:83], v[192:195]
  v_exp_f32 v31, v31
  v_mfma_f32_16x16x32_bf16 v[196:199], a[168:171], a[84:87], v[196:199]
  ds_read_b64_tr_b16 a[164:165], v4 offset:53248
  v_mul_f32 v159, v143, v159
  v_mfma_f32_16x16x32_bf16 v[196:199], a[172:175], a[68:71], v[196:199]
  v_fma_f32 v24, v24, v21, v21
  v_fma_f32 v25, v25, v21, v21
  v_mfma_f32_16x16x32_bf16 v[200:203], a[172:175], a[72:75], v[200:203]
  ds_read_b64_tr_b16 a[166:167], v4 offset:55296
  v_mfma_f32_16x16x32_bf16 v[200:203], a[168:171], a[88:91], v[200:203]
  v_rcp_f32 v24, v24
  v_mfma_f32_16x16x32_bf16 v[204:207], a[168:171], a[92:95], v[204:207]
  ds_read_b64_tr_b16 a[168:169], v4 offset:57344
  v_fma_f32 v26, v26, v21, v21
  v_mfma_f32_16x16x32_bf16 v[204:207], a[172:175], a[76:79], v[204:207]
  s_waitcnt lgkmcnt(5)
  v_rcp_f32 v25, v25
  v_fma_f32 v27, v27, v21, v21
  v_mfma_f32_16x16x32_bf16 v[220:223], a[180:183], a[76:79], v[220:223]
  ds_read_b64_tr_b16 a[170:171], v4 offset:59392
  v_mfma_f32_16x16x32_bf16 v[220:223], a[176:179], a[92:95], v[220:223]
  v_rcp_f32 v26, v26
  v_mfma_f32_16x16x32_bf16 v[216:219], a[176:179], a[88:91], v[216:219]
  ds_read_b64_tr_b16 a[172:173], v4 offset:61440
  v_fma_f32 v28, v28, v23, v23
  v_mfma_f32_16x16x32_bf16 v[216:219], a[180:183], a[72:75], v[216:219]
  v_rcp_f32 v27, v27
  v_fma_f32 v29, v29, v23, v23
  v_mfma_f32_16x16x32_bf16 v[212:215], a[180:183], a[68:71], v[212:215]
  ds_read_b64_tr_b16 a[174:175], v4 offset:63488
  v_mfma_f32_16x16x32_bf16 v[212:215], a[176:179], a[84:87], v[212:215]
  v_rcp_f32 v28, v28
  v_mfma_f32_16x16x32_bf16 v[208:211], a[176:179], a[80:83], v[208:211]
  ds_read_b64_tr_b16 a[176:177], v4 offset:16384
  v_fma_f32 v30, v30, v23, v23
  v_mfma_f32_16x16x32_bf16 v[208:211], a[180:183], a[64:67], v[208:211]
  s_waitcnt lgkmcnt(5)
  v_rcp_f32 v29, v29
  v_fma_f32 v31, v31, v23, v23
  v_mfma_f32_16x16x32_bf16 v[192:195], a[160:163], a[96:99], v[192:195]
  ds_read_b64_tr_b16 a[178:179], v4 offset:18432
  v_mfma_f32_16x16x32_bf16 v[192:195], a[164:167], a[112:115], v[192:195]
  v_rcp_f32 v30, v30
  v_mfma_f32_16x16x32_bf16 v[196:199], a[164:167], a[116:119], v[196:199]
  ds_read_b64_tr_b16 a[180:181], v4 offset:20480
  v_mul_f32 v152, v152, v24
  v_mfma_f32_16x16x32_bf16 v[196:199], a[160:163], a[100:103], v[196:199]
  v_rcp_f32 v31, v31
  v_mul_f32 v153, v153, v25
  v_mfma_f32_16x16x32_bf16 v[200:203], a[160:163], a[104:107], v[200:203]
  ds_read_b64_tr_b16 a[182:183], v4 offset:22528
  v_mul_f32 v154, v154, v26
  v_mfma_f32_16x16x32_bf16 v[200:203], a[164:167], a[120:123], v[200:203]
  v_mul_f32 v155, v155, v27
  v_mul_f32 v156, v156, v28
  v_mfma_f32_16x16x32_bf16 v[204:207], a[164:167], a[124:127], v[204:207]
  ds_read_b64_tr_b16 a[164:165], v4 offset:24576
  v_mul_f32 v157, v157, v29
  v_mfma_f32_16x16x32_bf16 v[204:207], a[160:163], a[108:111], v[204:207]
  s_waitcnt lgkmcnt(5)
  v_mul_f32 v158, v158, v30
  v_mul_f32 v159, v159, v31
  v_cvt_pk_bf16_f32 v136, v152, v153
  v_mfma_f32_16x16x32_bf16 v[220:223], a[168:171], a[108:111], v[220:223]
  ds_read_b64_tr_b16 a[166:167], v4 offset:26624
  v_cvt_pk_bf16_f32 v137, v154, v155
  v_mfma_f32_16x16x32_bf16 v[220:223], a[172:175], a[124:127], v[220:223]
  v_cvt_pk_bf16_f32 v140, v156, v157
  v_cvt_pk_bf16_f32 v141, v158, v159
  v_mfma_f32_16x16x32_bf16 v[216:219], a[172:175], a[120:123], v[216:219]
  ds_read_b64_tr_b16 a[160:161], v4 offset:28672
  v_mfma_f32_16x16x32_bf16 v[216:219], a[168:171], a[104:107], v[216:219]
  v_mfma_f32_16x16x32_bf16 v[212:215], a[168:171], a[100:103], v[212:215]
  ds_read_b64_tr_b16 a[162:163], v4 offset:30720
  s_cmp_lg_u32 s44, 0
  s_cbranch_scc1 PI18_adaLN_cond__sliding_local_dilated__swiglu_ffn__prompt_kernel
  buffer_load_dword v36, v37, s[8:11], s82 offen sc1
PI18_adaLN_cond__sliding_local_dilated__swiglu_ffn__prompt_kernel:
  v_mfma_f32_16x16x32_bf16 v[212:215], a[172:175], a[116:119], v[212:215]
  v_mul_f32 v24, v16, v160
  v_mul_f32 v25, v16, v161
  v_mfma_f32_16x16x32_bf16 v[208:211], a[172:175], a[112:115], v[208:211]
  ds_read_b64_tr_b16 a[172:173], v8 offset:32768
  v_mul_f32 v26, v16, v162
  v_mul_f32 v27, v16, v163
  v_mfma_f32_16x16x32_bf16 v[208:211], a[168:171], a[96:99], v[208:211]
  s_waitcnt lgkmcnt(5)
  v_mul_f32 v28, v18, v164
  v_mul_f32 v29, v18, v165
  v_mul_f32 v30, v18, v166
  v_mfma_f32_16x16x32_bf16 v[192:195], a[176:179], a[128:131], v[192:195]
  ds_read_b64_tr_b16 a[174:175], v8 offset:34816
  v_mul_f32 v31, v18, v167
  v_mfma_f32_16x16x32_bf16 v[192:195], a[180:183], a[144:147], v[192:195]
  v_exp_f32 v24, v24
  v_mul_f32 v176, v160, v176
  v_mfma_f32_16x16x32_bf16 v[196:199], a[180:183], a[148:151], v[196:199]
  ds_read_b64_tr_b16 a[168:169], v8 offset:36864
  v_mfma_f32_16x16x32_bf16 v[196:199], a[176:179], a[132:135], v[196:199]
  v_exp_f32 v25, v25
  v_mul_f32 v177, v161, v177
  v_mfma_f32_16x16x32_bf16 v[200:203], a[176:179], a[136:139], v[200:203]
  ds_read_b64_tr_b16 a[170:171], v8 offset:38912
  v_exp_f32 v26, v26
  v_mfma_f32_16x16x32_bf16 v[200:203], a[180:183], a[152:155], v[200:203]
  v_mul_f32 v178, v162, v178
  v_mfma_f32_16x16x32_bf16 v[204:207], a[180:183], a[156:159], v[204:207]
  ds_read_b64_tr_b16 a[180:181], v8 offset:40960
  v_exp_f32 v27, v27
  v_mfma_f32_16x16x32_bf16 v[204:207], a[176:179], a[140:143], v[204:207]
  s_waitcnt lgkmcnt(5)
  v_mul_f32 v179, v163, v179
  v_exp_f32 v28, v28
  v_mfma_f32_16x16x32_bf16 v[220:223], a[164:167], a[140:143], v[220:223]
  ds_read_b64_tr_b16 a[182:183], v8 offset:43008
  v_mul_f32 v180, v164, v180
  v_mfma_f32_16x16x32_bf16 v[220:223], a[160:163], a[156:159], v[220:223]
  v_exp_f32 v29, v29
  v_mul_f32 v181, v165, v181
  v_mfma_f32_16x16x32_bf16 v[216:219], a[160:163], a[152:155], v[216:219]
  ds_read_b64_tr_b16 a[176:177], v8 offset:45056
  v_mfma_f32_16x16x32_bf16 v[216:219], a[164:167], a[136:139], v[216:219]
  v_exp_f32 v30, v30
  v_mul_f32 v182, v166, v182
  v_mfma_f32_16x16x32_bf16 v[212:215], a[164:167], a[132:135], v[212:215]
  ds_read_b64_tr_b16 a[178:179], v8 offset:47104
  v_exp_f32 v31, v31
  v_mfma_f32_16x16x32_bf16 v[212:215], a[160:163], a[148:151], v[212:215]
  v_mul_f32 v183, v167, v183
  v_fma_f32 v24, v24, v17, v17
  v_mfma_f32_16x16x32_bf16 v[208:211], a[160:163], a[144:147], v[208:211]
  ds_read_b64_tr_b16 a[160:161], v5 offset:32768
  v_fma_f32 v25, v25, v17, v17
  v_mfma_f32_16x16x32_bf16 v[208:211], a[164:167], a[128:131], v[208:211]
  s_waitcnt lgkmcnt(5)
  v_rcp_f32 v24, v24
  v_fma_f32 v26, v26, v17, v17
  v_mfma_f32_16x16x32_bf16 v[192:195], a[172:175], a[188:191], v[192:195]
  ds_read_b64_tr_b16 a[162:163], v5 offset:34816
  v_mfma_f32_16x16x32_bf16 v[192:195], a[168:171], a[204:207], v[192:195]
  v_rcp_f32 v25, v25
  v_fma_f32 v27, v27, v17, v17
  v_mfma_f32_16x16x32_bf16 v[196:199], a[168:171], a[208:211], v[196:199]
  ds_read_b64_tr_b16 a[164:165], v5 offset:36864
  v_mfma_f32_16x16x32_bf16 v[196:199], a[172:175], a[192:195], v[196:199]
  v_rcp_f32 v26, v26
  v_fma_f32 v28, v28, v19, v19
  v_mfma_f32_16x16x32_bf16 v[200:203], a[172:175], a[196:199], v[200:203]
  ds_read_b64_tr_b16 a[166:167], v5 offset:38912
  v_rcp_f32 v27, v27
  v_mfma_f32_16x16x32_bf16 v[200:203], a[168:171], a[212:215], v[200:203]
  v_fma_f32 v29, v29, v19, v19
  v_mfma_f32_16x16x32_bf16 v[204:207], a[168:171], a[216:219], v[204:207]
  ds_read_b64_tr_b16 a[168:169], v5 offset:40960
  v_rcp_f32 v28, v28
  v_mfma_f32_16x16x32_bf16 v[204:207], a[172:175], a[200:203], v[204:207]
  s_waitcnt lgkmcnt(5)
  v_fma_f32 v30, v30, v19, v19
  v_rcp_f32 v29, v29
  v_mfma_f32_16x16x32_bf16 v[220:223], a[180:183], a[200:203], v[220:223]
  ds_read_b64_tr_b16 a[170:171], v5 offset:43008
  v_fma_f32 v31, v31, v19, v19
  v_mfma_f32_16x16x32_bf16 v[220:223], a[176:179], a[216:219], v[220:223]
  v_rcp_f32 v30, v30
  v_mul_f32 v176, v176, v24
  v_mfma_f32_16x16x32_bf16 v[216:219], a[176:179], a[212:215], v[216:219]
  ds_read_b64_tr_b16 a[172:173], v5 offset:45056
  v_mfma_f32_16x16x32_bf16 v[216:219], a[180:183], a[196:199], v[216:219]
  v_rcp_f32 v31, v31
  v_mul_f32 v177, v177, v25
  v_mfma_f32_16x16x32_bf16 v[212:215], a[180:183], a[192:195], v[212:215]
  ds_read_b64_tr_b16 a[174:175], v5 offset:47104
  v_mul_f32 v178, v178, v26
  v_mul_f32 v179, v179, v27
  v_mfma_f32_16x16x32_bf16 v[212:215], a[176:179], a[208:211], v[212:215]
  v_mul_f32 v180, v180, v28
  v_mul_f32 v181, v181, v29
HOP15:
  s_cbranch_execz HOP18
  v_mfma_f32_16x16x32_bf16 v[208:211], a[176:179], a[204:207], v[208:211]
  ds_read_b64_tr_b16 a[176:177], v5 offset:49152
  v_mul_f32 v182, v182, v30
  v_mul_f32 v183, v183, v31
  v_mfma_f32_16x16x32_bf16 v[208:211], a[180:183], a[188:191], v[208:211]
  s_waitcnt lgkmcnt(5)
  v_cvt_pk_bf16_f32 v130, v176, v177
  v_cvt_pk_bf16_f32 v131, v178, v179
  v_mfma_f32_16x16x32_bf16 v[224:227], a[160:163], a[64:67], v[224:227]
  ds_read_b64_tr_b16 a[178:179], v5 offset:51200
  v_mfma_f32_16x16x32_bf16 v[224:227], a[164:167], a[80:83], v[224:227]
  buffer_store_dwordx4 v[128:131], v1, s[8:11], s58 offen offset:0 sc1
  v_mfma_f32_16x16x32_bf16 v[228:231], a[164:167], a[84:87], v[228:231]
  ds_read_b64_tr_b16 a[180:181], v5 offset:53248
  v_cvt_pk_bf16_f32 v134, v180, v181
  v_mfma_f32_16x16x32_bf16 v[228:231], a[160:163], a[68:71], v[228:231]
  v_cvt_pk_bf16_f32 v135, v182, v183
  v_mfma_f32_16x16x32_bf16 v[232:235], a[160:163], a[72:75], v[232:235]
  ds_read_b64_tr_b16 a[182:183], v5 offset:55296
  s_cmp_lg_u32 s44, 0
  s_cbranch_scc1 PL19_adaLN_cond__sliding_local_dilated__swiglu_ffn__prompt_kernelx
  s_waitcnt vmcnt(1)
  v_cmp_ne_u32 vcc, s46, v36
  s_nop 4
  s_cbranch_vccz PL19_adaLN_cond__sliding_local_dilated__swiglu_ffn__prompt_kernelx
  s_mov_b32 s83, 60000
PL19_adaLN_cond__sliding_local_dilated__swiglu_ffn__prompt_kernel:
  buffer_load_dword v36, v37, s[8:11], s82 offen sc1
  s_sub_u32 s83, s83, 1
  s_cmp_eq_u32 s83, 0
  s_waitcnt vmcnt(0)
  s_cbranch_scc1 PL19_adaLN_cond__sliding_local_dilated__swiglu_ffn__prompt_kernelx
  v_cmp_ne_u32 vcc, s46, v36
  s_nop 4
  s_cbranch_vccnz PL19_adaLN_cond__sliding_local_dilated__swiglu_ffn__prompt_kernel
PL19_adaLN_cond__sliding_local_dilated__swiglu_ffn__prompt_kernelx:
  s_barrier
  v_mfma_f32_16x16x32_bf16 v[232:235], a[164:167], a[88:91], v[232:235]
  s_add_u32 s55, s58, 262144
  buffer_store_dwordx4 v[132:135], v1, s[8:11], s55 offen offset:0 sc1
  v_mfma_f32_16x16x32_bf16 v[236:239], a[164:167], a[92:95], v[236:239]
  ds_read_b64_tr_b16 a[164:165], v5 offset:57344
  v_mul_f32 v24, v20, v168
  v_mul_f32 v25, v20, v169
  v_mfma_f32_16x16x32_bf16 v[236:239], a[160:163], a[76:79], v[236:239]
  s_waitcnt lgkmcnt(5)
  buffer_load_dwordx4 a[220:223], v1, s[8:11], s72 offen offset:0 sc1
  v_mul_f32 v26, v20, v170
  v_mul_f32 v27, v20, v171
  v_mfma_f32_16x16x32_bf16 v[252:255], a[168:171], a[76:79], v[252:255]
  ds_read_b64_tr_b16 a[166:167], v5 offset:59392
  v_mul_f32 v28, v22, v172
  v_mfma_f32_16x16x32_bf16 v[252:255], a[172:175], a[92:95], v[252:255]
  v_mul_f32 v29, v22, v173
  v_mul_f32 v30, v22, v174
  v_mul_f32 v31, v22, v175
  v_mfma_f32_16x16x32_bf16 v[248:251], a[172:175], a[88:91], v[248:251]
  ds_read_b64_tr_b16 a[160:161], v5 offset:61440
  v_mfma_f32_16x16x32_bf16 v[248:251], a[168:171], a[72:75], v[248:251]
  buffer_load_dwordx4 a[236:239], v1, s[8:11], s72 offen offset:1024 sc1
  v_exp_f32 v24, v24
  v_mul_f32 v184, v168, v184
  v_mfma_f32_16x16x32_bf16 v[244:247], a[168:171], a[68:71], v[244:247]
  ds_read_b64_tr_b16 a[162:163], v5 offset:63488
  v_exp_f32 v25, v25
  v_mfma_f32_16x16x32_bf16 v[244:247], a[172:175], a[84:87], v[244:247]
  s_add_u32 s72, s72, 131072
  v_mul_f32 v185, v169, v185
  v_mfma_f32_16x16x32_bf16 v[240:243], a[172:175], a[80:83], v[240:243]
  ds_read_b64_tr_b16 a[172:173], v5 offset:16384
  v_exp_f32 v26, v26
  v_mfma_f32_16x16x32_bf16 v[240:243], a[168:171], a[64:67], v[240:243]
  s_waitcnt lgkmcnt(5)
  buffer_load_dwordx4 a[224:227], v1, s[8:11], s72 offen offset:0 sc1
  v_mul_f32 v186, v170, v186
  v_mfma_f32_16x16x32_bf16 v[224:227], a[176:179], a[96:99], v[224:227]
  ds_read_b64_tr_b16 a[174:175], v5 offset:18432
  v_mfma_f32_16x16x32_bf16 v[224:227], a[180:183], a[112:115], v[224:227]
  v_exp_f32 v27, v27
  v_mul_f32 v187, v171, v187
  v_mfma_f32_16x16x32_bf16 v[228:231], a[180:183], a[116:119], v[228:231]
  ds_read_b64_tr_b16 a[168:169], v5 offset:20480
  v_mfma_f32_16x16x32_bf16 v[228:231], a[176:179], a[100:103], v[228:231]
  buffer_load_dwordx4 a[240:243], v1, s[8:11], s72 offen offset:1024 sc1
  v_exp_f32 v28, v28
  v_mul_f32 v188, v172, v188
  v_mfma_f32_16x16x32_bf16 v[232:235], a[176:179], a[104:107], v[232:235]
  ds_read_b64_tr_b16 a[170:171], v5 offset:22528
  v_exp_f32 v29, v29
  v_mfma_f32_16x16x32_bf16 v[232:235], a[180:183], a[120:123], v[232:235]
  s_add_u32 s72, s72, s89
  v_mul_f32 v189, v173, v189
  v_mfma_f32_16x16x32_bf16 v[236:239], a[180:183], a[124:127], v[236:239]
  ds_read_b64_tr_b16 a[180:181], v5 offset:24576
  v_exp_f32 v30, v30
  v_mfma_f32_16x16x32_bf16 v[236:239], a[176:179], a[108:111], v[236:239]
  s_waitcnt lgkmcnt(5)
  buffer_load_dwordx4 a[228:231], v1, s[8:11], s72 offen offset:0 sc1
  v_mul_f32 v190, v174, v190
  v_mfma_f32_16x16x32_bf16 v[252:255], a[164:167], a[108:111], v[252:255]
  ds_read_b64_tr_b16 a[182:183], v5 offset:26624
  v_mfma_f32_16x16x32_bf16 v[252:255], a[160:163], a[124:127], v[252:255]
  v_exp_f32 v31, v31
  v_mul_f32 v191, v175, v191
  v_mfma_f32_16x16x32_bf16 v[248:251], a[160:163], a[120:123], v[248:251]
  ds_read_b64_tr_b16 a[176:177], v5 offset:28672
  v_fma_f32 v24, v24, v21, v21
  v_mfma_f32_16x16x32_bf16 v[248:251], a[164:167], a[104:107], v[248:251]
  buffer_load_dwordx4 a[244:247], v1, s[8:11], s72 offen offset:1024 sc1
  v_fma_f32 v25, v25, v21, v21
  v_rcp_f32 v24, v24
  v_mfma_f32_16x16x32_bf16 v[244:247], a[164:167], a[100:103], v[244:247]
  ds_read_b64_tr_b16 a[178:179], v5 offset:30720
  v_fma_f32 v26, v26, v21, v21
  v_mfma_f32_16x16x32_bf16 v[244:247], a[160:163], a[116:119], v[244:247]
  s_add_u32 s72, s72, 131072
  v_rcp_f32 v25, v25
  v_mfma_f32_16x16x32_bf16 v[240:243], a[160:163], a[112:115], v[240:243]
  ds_read_b64_tr_b16 a[160:161], v9 offset:32768
  v_fma_f32 v27, v27, v21, v21
  v_mfma_f32_16x16x32_bf16 v[240:243], a[164:167], a[96:99], v[240:243]
  s_waitcnt lgkmcnt(5)
  buffer_load_dwordx4 a[232:235], v1, s[8:11], s72 offen offset:0 sc1
  v_rcp_f32 v26, v26
  v_mfma_f32_16x16x32_bf16 v[224:227], a[172:175], a[128:131], v[224:227]
  ds_read_b64_tr_b16 a[162:163], v9 offset:34816
  v_fma_f32 v28, v28, v23, v23
  v_mfma_f32_16x16x32_bf16 v[224:227], a[168:171], a[144:147], v[224:227]
  v_rcp_f32 v27, v27
  v_fma_f32 v29, v29, v23, v23
  v_mfma_f32_16x16x32_bf16 v[228:231], a[168:171], a[148:151], v[228:231]
  ds_read_b64_tr_b16 a[164:165], v9 offset:36864
  v_mfma_f32_16x16x32_bf16 v[228:231], a[172:175], a[132:135], v[228:231]
  buffer_load_dwordx4 a[248:251], v1, s[8:11], s72 offen offset:1024 sc1
  v_rcp_f32 v28, v28
  v_fma_f32 v30, v30, v23, v23
  v_mfma_f32_16x16x32_bf16 v[232:235], a[172:175], a[136:139], v[232:235]
  ds_read_b64_tr_b16 a[166:167], v9 offset:38912
  v_rcp_f32 v29, v29
  v_mfma_f32_16x16x32_bf16 v[232:235], a[168:171], a[152:155], v[232:235]
  v_fma_f32 v31, v31, v23, v23
  v_mfma_f32_16x16x32_bf16 v[236:239], a[168:171], a[156:159], v[236:239]
  ds_read_b64_tr_b16 a[168:169], v9 offset:40960
  v_rcp_f32 v30, v30
  v_mfma_f32_16x16x32_bf16 v[236:239], a[172:175], a[140:143], v[236:239]
  s_waitcnt lgkmcnt(5)
  buffer_load_dwordx4 a[0:3], v1, s[8:11], s73 offen offset:0 sc1
  v_mul_f32 v184, v184, v24
  v_mfma_f32_16x16x32_bf16 v[252:255], a[180:183], a[140:143], v[252:255]
  ds_read_b64_tr_b16 a[170:171], v9 offset:43008
  v_mfma_f32_16x16x32_bf16 v[252:255], a[176:179], a[156:159], v[252:255]
  v_rcp_f32 v31, v31
  v_mul_f32 v185, v185, v25
  v_mfma_f32_16x16x32_bf16 v[248:251], a[176:179], a[152:155], v[248:251]
  ds_read_b64_tr_b16 a[172:173], v9 offset:45056
  v_mul_f32 v186, v186, v26
  v_mfma_f32_16x16x32_bf16 v[248:251], a[180:183], a[136:139], v[248:251]
  buffer_load_dwordx4 a[16:19], v1, s[8:11], s73 offen offset:1024 sc1
  v_mul_f32 v187, v187, v27
  v_mul_f32 v188, v188, v28
  v_mul_f32 v189, v189, v29
  v_mfma_f32_16x16x32_bf16 v[244:247], a[180:183], a[132:135], v[244:247]
  ds_read_b64_tr_b16 a[174:175], v9 offset:47104
  v_mul_f32 v190, v190, v30
  v_mul_f32 v191, v191, v31
  v_mfma_f32_16x16x32_bf16 v[244:247], a[176:179], a[148:151], v[244:247]
  s_waitcnt vmcnt(31)
  s_barrier
  v_mfma_f32_16x16x32_bf16 v[240:243], a[176:179], a[144:147], v[240:243]
  ds_read_b64_tr_b16 a[176:177], v6 offset:49152
  s_add_u32 s73, s73, 131072
  v_cvt_pk_bf16_f32 v138, v184, v185
  v_mfma_f32_16x16x32_bf16 v[240:243], a[180:183], a[128:131], v[240:243]
  s_waitcnt lgkmcnt(5)
  buffer_load_dwordx4 a[4:7], v1, s[8:11], s73 offen offset:0 sc1
  v_cvt_pk_bf16_f32 v139, v186, v187
  v_mfma_f32_16x16x32_bf16 v[224:227], a[160:163], a[188:191], v[224:227]
  ds_read_b64_tr_b16 a[178:179], v6 offset:51200
  v_mfma_f32_16x16x32_bf16 v[224:227], a[164:167], a[204:207], v[224:227]
  s_add_u32 s55, s58, 524288
  buffer_store_dwordx4 v[136:139], v1, s[8:11], s55 offen offset:0 sc1
  v_mfma_f32_16x16x32_bf16 v[228:231], a[164:167], a[208:211], v[228:231]
  ds_read_b64_tr_b16 a[180:181], v6 offset:53248
  v_cvt_pk_bf16_f32 v142, v188, v189
  v_mfma_f32_16x16x32_bf16 v[228:231], a[160:163], a[192:195], v[228:231]
  buffer_load_dwordx4 a[20:23], v1, s[8:11], s73 offen offset:1024 sc1
  v_cvt_pk_bf16_f32 v143, v190, v191
  v_mfma_f32_16x16x32_bf16 v[232:235], a[160:163], a[196:199], v[232:235]
  ds_read_b64_tr_b16 a[182:183], v6 offset:55296
  v_mfma_f32_16x16x32_bf16 v[232:235], a[164:167], a[212:215], v[232:235]
  s_add_u32 s73, s73, s89
  s_add_u32 s55, s58, 786432
  buffer_store_dwordx4 v[140:143], v1, s[8:11], s55 offen offset:0 sc1
  v_mfma_f32_16x16x32_bf16 v[236:239], a[164:167], a[216:219], v[236:239]
  ds_read_b64_tr_b16 a[164:165], v7 offset:49152
  v_mul_f32 v24, v16, v192
  v_mul_f32 v25, v16, v193
  v_mfma_f32_16x16x32_bf16 v[236:239], a[160:163], a[200:203], v[236:239]
  s_waitcnt lgkmcnt(5)
  buffer_load_dwordx4 a[8:11], v1, s[8:11], s73 offen offset:0 sc1
  v_mul_f32 v26, v16, v194
  v_mul_f32 v27, v16, v195
  v_mfma_f32_16x16x32_bf16 v[252:255], a[168:171], a[200:203], v[252:255]
  ds_read_b64_tr_b16 a[166:167], v7 offset:51200
  v_mul_f32 v28, v18, v196
  v_mfma_f32_16x16x32_bf16 v[252:255], a[172:175], a[216:219], v[252:255]
  v_mul_f32 v29, v18, v197
  s_waitcnt vmcnt(30)
  s_barrier
  v_mfma_f32_16x16x32_bf16 v[248:251], a[172:175], a[212:215], v[248:251]
  ds_read_b64_tr_b16 a[160:161], v7 offset:53248
  v_mul_f32 v30, v18, v198
  v_mfma_f32_16x16x32_bf16 v[248:251], a[168:171], a[196:199], v[248:251]
  buffer_load_dwordx4 a[24:27], v1, s[8:11], s73 offen offset:1024 sc1
  v_mul_f32 v31, v18, v199
  v_exp_f32 v24, v24
  v_mfma_f32_16x16x32_bf16 v[244:247], a[168:171], a[192:195], v[244:247]
  ds_read_b64_tr_b16 a[162:163], v7 offset:55296
  v_mul_f32 v208, v192, v208
  v_mfma_f32_16x16x32_bf16 v[244:247], a[172:175], a[208:211], v[244:247]
  s_add_u32 s73, s73, 131072
  v_exp_f32 v25, v25
  v_mfma_f32_16x16x32_bf16 v[240:243], a[172:175], a[204:207], v[240:243]
  ds_read_b64_tr_b16 a[172:173], v8 offset:49152
  v_mul_f32 v209, v193, v209
  v_mfma_f32_16x16x32_bf16 v[240:243], a[168:171], a[188:191], v[240:243]
  s_waitcnt vmcnt(8) lgkmcnt(5)
  buffer_load_dwordx4 a[12:15], v1, s[8:11], s73 offen offset:0 sc1
  v_exp_f32 v26, v26
  v_mfma_f32_16x16x32_bf16 v[64:67], a[176:179], a[220:223], 0
  ds_read_b64_tr_b16 a[174:175], v8 offset:51200
  v_mul_f32 v210, v194, v210
  v_mfma_f32_16x16x32_bf16 v[64:67], a[180:183], a[236:239], v[64:67]
  v_exp_f32 v27, v27
  v_mul_f32 v211, v195, v211
  v_mfma_f32_16x16x32_bf16 v[68:71], a[180:183], a[240:243], 0
  ds_read_b64_tr_b16 a[168:169], v8 offset:53248
  v_mfma_f32_16x16x32_bf16 v[68:71], a[176:179], a[224:227], v[68:71]
  buffer_load_dwordx4 a[28:31], v1, s[8:11], s73 offen offset:1024 sc1
  v_exp_f32 v28, v28
  v_mul_f32 v212, v196, v212
  v_mfma_f32_16x16x32_bf16 v[72:75], a[176:179], a[228:231], 0
  ds_read_b64_tr_b16 a[170:171], v8 offset:55296
  v_exp_f32 v29, v29
  v_mfma_f32_16x16x32_bf16 v[72:75], a[180:183], a[244:247], v[72:75]
  v_mul_f32 v213, v197, v213
  v_mfma_f32_16x16x32_bf16 v[76:79], a[180:183], a[248:251], 0
  ds_read_b64_tr_b16 a[180:181], v9 offset:49152
  v_exp_f32 v30, v30
  v_mfma_f32_16x16x32_bf16 v[76:79], a[176:179], a[232:235], v[76:79]
  s_waitcnt lgkmcnt(5)
  buffer_load_dwordx4 a[32:35], v1, s[8:11], s74 offen offset:0 sc1
  v_mul_f32 v214, v198, v214
  v_mfma_f32_16x16x32_bf16 v[92:95], a[164:167], a[232:235], 0
  ds_read_b64_tr_b16 a[182:183], v9 offset:51200
  v_mfma_f32_16x16x32_bf16 v[92:95], a[160:163], a[248:251], v[92:95]
  v_exp_f32 v31, v31
  v_mul_f32 v215, v199, v215
  v_mfma_f32_16x16x32_bf16 v[88:91], a[160:163], a[244:247], 0
  ds_read_b64_tr_b16 a[176:177], v9 offset:53248
  v_fma_f32 v24, v24, v17, v17
  v_mfma_f32_16x16x32_bf16 v[88:91], a[164:167], a[228:231], v[88:91]
  buffer_load_dwordx4 a[48:51], v1, s[8:11], s74 offen offset:1024 sc1
  v_fma_f32 v25, v25, v17, v17
  v_rcp_f32 v24, v24
  v_mfma_f32_16x16x32_bf16 v[84:87], a[164:167], a[224:227], 0
  ds_read_b64_tr_b16 a[178:179], v9 offset:55296
  v_fma_f32 v26, v26, v17, v17
  v_mfma_f32_16x16x32_bf16 v[84:87], a[160:163], a[240:243], v[84:87]
  v_rcp_f32 v25, v25
  v_mfma_f32_16x16x32_bf16 v[80:83], a[160:163], a[236:239], 0
  ds_read_b64_tr_b16 a[160:161], v6 offset:57344
  v_fma_f32 v27, v27, v17, v17
  v_mfma_f32_16x16x32_bf16 v[80:83], a[164:167], a[220:223], v[80:83]
  s_waitcnt lgkmcnt(5)
  s_add_u32 s74, s74, 131072
  v_rcp_f32 v26, v26
  v_mfma_f32_16x16x32_bf16 v[96:99], a[172:175], a[220:223], 0
  ds_read_b64_tr_b16 a[162:163], v6 offset:59392
  v_fma_f32 v28, v28, v19, v19
  v_mfma_f32_16x16x32_bf16 v[96:99], a[168:171], a[236:239], v[96:99]
  buffer_load_dwordx4 a[36:39], v1, s[8:11], s74 offen offset:0 sc1
  v_rcp_f32 v27, v27
  v_fma_f32 v29, v29, v19, v19
  v_mfma_f32_16x16x32_bf16 v[100:103], a[168:171], a[240:243], 0
  ds_read_b64_tr_b16 a[164:165], v6 offset:61440
  v_mfma_f32_16x16x32_bf16 v[100:103], a[172:175], a[224:227], v[100:103]
  v_rcp_f32 v28, v28
  v_fma_f32 v30, v30, v19, v19
  v_mfma_f32_16x16x32_bf16 v[104:107], a[172:175], a[228:231], 0
  ds_read_b64_tr_b16 a[166:167], v6 offset:63488
  v_rcp_f32 v29, v29
  v_mfma_f32_16x16x32_bf16 v[104:107], a[168:171], a[244:247], v[104:107]
  buffer_load_dwordx4 a[52:55], v1, s[8:11], s74 offen offset:1024 sc1
  v_fma_f32 v31, v31, v19, v19
  v_mfma_f32_16x16x32_bf16 v[108:111], a[168:171], a[248:251], 0
  ds_read_b64_tr_b16 a[168:169], v7 offset:57344
  v_rcp_f32 v30, v30
  v_mfma_f32_16x16x32_bf16 v[108:111], a[172:175], a[232:235], v[108:111]
  s_waitcnt lgkmcnt(5)
  s_add_u32 s74, s74, s89
  v_mul_f32 v208, v208, v24
  v_mfma_f32_16x16x32_bf16 v[124:127], a[180:183], a[232:235], 0
  ds_read_b64_tr_b16 a[170:171], v7 offset:59392
  v_mfma_f32_16x16x32_bf16 v[124:127], a[176:179], a[248:251], v[124:127]
  buffer_load_dwordx4 a[40:43], v1, s[8:11], s74 offen offset:0 sc1
  v_rcp_f32 v31, v31
  v_mul_f32 v209, v209, v25
  v_mfma_f32_16x16x32_bf16 v[120:123], a[176:179], a[244:247], 0
  ds_read_b64_tr_b16 a[172:173], v7 offset:61440
  v_mul_f32 v210, v210, v26
  v_mfma_f32_16x16x32_bf16 v[120:123], a[180:183], a[228:231], v[120:123]
  v_mul_f32 v211, v211, v27
  v_mul_f32 v212, v212, v28
  v_mul_f32 v213, v213, v29
  v_mfma_f32_16x16x32_bf16 v[116:119], a[180:183], a[224:227], 0
  ds_read_b64_tr_b16 a[174:175], v7 offset:63488
  v_mul_f32 v214, v214, v30
  v_mul_f32 v215, v215, v31
  v_mfma_f32_16x16x32_bf16 v[116:119], a[176:179], a[240:243], v[116:119]
  buffer_load_dwordx4 a[56:59], v1, s[8:11], s74 offen offset:1024 sc1
  v_cvt_pk_bf16_f32 v192, v208, v209
  v_cvt_pk_bf16_f32 v193, v210, v211
  v_mfma_f32_16x16x32_bf16 v[112:115], a[176:179], a[236:239], 0
  ds_read_b64_tr_b16 a[176:177], v8 offset:57344
  v_cvt_pk_bf16_f32 v196, v212, v213
  v_cvt_pk_bf16_f32 v197, v214, v215
  v_mfma_f32_16x16x32_bf16 v[112:115], a[180:183], a[220:223], v[112:115]
  s_waitcnt lgkmcnt(5)
  v_mul_f32 v24, v20, v200
  v_mul_f32 v25, v20, v201
  v_mul_f32 v26, v20, v202
  v_mfma_f32_16x16x32_bf16 v[128:131], a[160:163], a[220:223], 0
  ds_read_b64_tr_b16 a[178:179], v8 offset:59392
  v_mul_f32 v27, v20, v203
  v_mfma_f32_16x16x32_bf16 v[128:131], a[164:167], a[236:239], v[128:131]
  s_add_u32 s74, s74, 131072
  v_mul_f32 v28, v22, v204
  v_mul_f32 v29, v22, v205
  v_mul_f32 v30, v22, v206
  v_mfma_f32_16x16x32_bf16 v[132:135], a[164:167], a[240:243], 0
  ds_read_b64_tr_b16 a[180:181], v8 offset:61440
  v_mul_f32 v31, v22, v207
  v_mfma_f32_16x16x32_bf16 v[132:135], a[160:163], a[224:227], v[132:135]
  buffer_load_dwordx4 a[44:47], v1, s[8:11], s74 offen offset:0 sc1
  v_exp_f32 v24, v24
  v_mul_f32 v216, v200, v216
  v_mfma_f32_16x16x32_bf16 v[136:139], a[160:163], a[228:231], 0
  ds_read_b64_tr_b16 a[182:183], v8 offset:63488
  v_exp_f32 v25, v25
  v_mfma_f32_16x16x32_bf16 v[136:139], a[164:167], a[244:247], v[136:139]
  v_mul_f32 v217, v201, v217
  v_mfma_f32_16x16x32_bf16 v[140:143], a[164:167], a[248:251], 0
  ds_read_b64_tr_b16 a[164:165], v9 offset:57344
  v_exp_f32 v26, v26
  v_mfma_f32_16x16x32_bf16 v[140:143], a[160:163], a[232:235], v[140:143]
  s_waitcnt lgkmcnt(5)
  buffer_load_dwordx4 a[60:63], v1, s[8:11], s74 offen offset:1024 sc1
  v_mul_f32 v218, v202, v218
  v_mfma_f32_16x16x32_bf16 v[156:159], a[168:171], a[232:235], 0
  ds_read_b64_tr_b16 a[166:167], v9 offset:59392
  v_mfma_f32_16x16x32_bf16 v[156:159], a[172:175], a[248:251], v[156:159]
  v_exp_f32 v27, v27
  v_mul_f32 v219, v203, v219
  v_mfma_f32_16x16x32_bf16 v[152:155], a[172:175], a[244:247], 0
  ds_read_b64_tr_b16 a[160:161], v9 offset:61440
  v_mfma_f32_16x16x32_bf16 v[152:155], a[168:171], a[228:231], v[152:155]
  buffer_load_dwordx4 a[64:67], v1, s[8:11], s75 offen offset:0 sc1
  v_exp_f32 v28, v28
  v_mul_f32 v220, v204, v220
  v_mfma_f32_16x16x32_bf16 v[148:151], a[168:171], a[224:227], 0
  ds_read_b64_tr_b16 a[162:163], v9 offset:63488
  v_exp_f32 v29, v29
  v_mfma_f32_16x16x32_bf16 v[148:151], a[172:175], a[240:243], v[148:151]
  v_mul_f32 v221, v205, v221
  v_mfma_f32_16x16x32_bf16 v[144:147], a[172:175], a[236:239], 0
  ds_read_b64_tr_b16 a[172:173], v6 offset:16384
  v_exp_f32 v30, v30
  v_mfma_f32_16x16x32_bf16 v[144:147], a[168:171], a[220:223], v[144:147]
  s_waitcnt lgkmcnt(5)
  buffer_load_dwordx4 a[80:83], v1, s[8:11], s75 offen offset:1024 sc1
  v_mul_f32 v222, v206, v222
  v_mfma_f32_16x16x32_bf16 v[160:163], a[176:179], a[220:223], 0
  ds_read_b64_tr_b16 a[174:175], v6 offset:18432
  v_mfma_f32_16x16x32_bf16 v[160:163], a[180:183], a[236:239], v[160:163]
  v_exp_f32 v31, v31
  v_mul_f32 v223, v207, v223
  v_mfma_f32_16x16x32_bf16 v[164:167], a[180:183], a[240:243], 0
  ds_read_b64_tr_b16 a[168:169], v6 offset:20480
  v_fma_f32 v24, v24, v21, v21
  v_mfma_f32_16x16x32_bf16 v[164:167], a[176:179], a[224:227], v[164:167]
  s_add_u32 s75, s75, 131072
  v_fma_f32 v25, v25, v21, v21
  v_rcp_f32 v24, v24
  v_mfma_f32_16x16x32_bf16 v[168:171], a[176:179], a[228:231], 0
  ds_read_b64_tr_b16 a[170:171], v6 offset:22528
  v_fma_f32 v26, v26, v21, v21
  v_mfma_f32_16x16x32_bf16 v[168:171], a[180:183], a[244:247], v[168:171]
  buffer_load_dwordx4 a[68:71], v1, s[8:11], s75 offen offset:0 sc1
  v_rcp_f32 v25, v25
  v_mfma_f32_16x16x32_bf16 v[172:175], a[180:183], a[248:251], 0
  ds_read_b64_tr_b16 a[180:181], v7 offset:16384
  v_fma_f32 v27, v27, v21, v21
  v_mfma_f32_16x16x32_bf16 v[172:175], a[176:179], a[232:235], v[172:175]
  s_waitcnt lgkmcnt(5)
  v_rcp_f32 v26, v26
  v_fma_f32 v28, v28, v23, v23
  v_mfma_f32_16x16x32_bf16 v[188:191], a[164:167], a[232:235], 0
  ds_read_b64_tr_b16 a[182:183], v7 offset:18432
  v_mfma_f32_16x16x32_bf16 v[188:191], a[160:163], a[248:251], v[188:191]
  buffer_load_dwordx4 a[84:87], v1, s[8:11], s75 offen offset:1024 sc1
  v_rcp_f32 v27, v27
  v_fma_f32 v29, v29, v23, v23
  v_mfma_f32_16x16x32_bf16 v[184:187], a[160:163], a[244:247], 0
  ds_read_b64_tr_b16 a[176:177], v7 offset:20480
  v_mfma_f32_16x16x32_bf16 v[184:187], a[164:167], a[228:231], v[184:187]
  s_add_u32 s75, s75, s89
  v_rcp_f32 v28, v28
  v_fma_f32 v30, v30, v23, v23
  v_mfma_f32_16x16x32_bf16 v[180:183], a[164:167], a[224:227], 0
  ds_read_b64_tr_b16 a[178:179], v7 offset:22528
  v_rcp_f32 v29, v29
  v_mfma_f32_16x16x32_bf16 v[180:183], a[160:163], a[240:243], v[180:183]
  buffer_load_dwordx4 a[72:75], v1, s[8:11], s75 offen offset:0 sc1
  v_fma_f32 v31, v31, v23, v23
  v_mfma_f32_16x16x32_bf16 v[176:179], a[160:163], a[236:239], 0
  ds_read_b64_tr_b16 a[160:161], v8 offset:16384
  v_rcp_f32 v30, v30
  v_mfma_f32_16x16x32_bf16 v[176:179], a[164:167], a[220:223], v[176:179]
  s_waitcnt vmcnt(13) lgkmcnt(5)
  v_mul_f32 v216, v216, v24
  v_rcp_f32 v31, v31
  v_mfma_f32_16x16x32_bf16 v[64:67], a[172:175], a[0:3], v[64:67]
  ds_read_b64_tr_b16 a[162:163], v8 offset:18432
  v_mul_f32 v217, v217, v25
  v_mfma_f32_16x16x32_bf16 v[64:67], a[168:171], a[16:19], v[64:67]
  buffer_load_dwordx4 a[88:91], v1, s[8:11], s75 offen offset:1024 sc1
  v_mul_f32 v218, v218, v26
  v_mul_f32 v219, v219, v27
  v_mul_f32 v220, v220, v28
  v_mfma_f32_16x16x32_bf16 v[68:71], a[168:171], a[20:23], v[68:71]
  ds_read_b64_tr_b16 a[164:165], v8 offset:20480
  v_mul_f32 v221, v221, v29
  v_mfma_f32_16x16x32_bf16 v[68:71], a[172:175], a[4:7], v[68:71]
  v_mul_f32 v222, v222, v30
  v_mul_f32 v223, v223, v31
  v_cvt_pk_bf16_f32 v200, v216, v217
  v_mfma_f32_16x16x32_bf16 v[72:75], a[172:175], a[8:11], v[72:75]
  ds_read_b64_tr_b16 a[166:167], v8 offset:22528
  v_cvt_pk_bf16_f32 v201, v218, v219
  v_cvt_pk_bf16_f32 v204, v220, v221
  v_mfma_f32_16x16x32_bf16 v[72:75], a[168:171], a[24:27], v[72:75]
  s_add_u32 s75, s75, 131072
  v_cvt_pk_bf16_f32 v205, v222, v223
  v_mfma_f32_16x16x32_bf16 v[76:79], a[168:171], a[28:31], v[76:79]
  ds_read_b64_tr_b16 a[168:169], v9 offset:16384
  v_mul_f32 v24, v16, v224
  v_mul_f32 v25, v16, v225
  v_mfma_f32_16x16x32_bf16 v[76:79], a[172:175], a[12:15], v[76:79]
  s_waitcnt lgkmcnt(5)
  buffer_load_dwordx4 a[76:79], v1, s[8:11], s75 offen offset:0 sc1
  v_mul_f32 v26, v16, v226
  v_mul_f32 v27, v16, v227
  v_mul_f32 v28, v18, v228
  v_mfma_f32_16x16x32_bf16 v[92:95], a[180:183], a[12:15], v[92:95]
  ds_read_b64_tr_b16 a[170:171], v9 offset:18432
  v_mul_f32 v29, v18, v229
  v_mul_f32 v30, v18, v230
  v_mfma_f32_16x16x32_bf16 v[92:95], a[176:179], a[28:31], v[92:95]
  v_mul_f32 v31, v18, v231
  v_exp_f32 v24, v24
  v_mfma_f32_16x16x32_bf16 v[88:91], a[176:179], a[24:27], v[88:91]
  ds_read_b64_tr_b16 a[172:173], v9 offset:20480
  v_mul_f32 v240, v224, v240
  v_mfma_f32_16x16x32_bf16 v[88:91], a[180:183], a[8:11], v[88:91]
  buffer_load_dwordx4 a[92:95], v1, s[8:11], s75 offen offset:1024 sc1
  v_exp_f32 v25, v25
  v_mul_f32 v241, v225, v241
  v_mfma_f32_16x16x32_bf16 v[84:87], a[180:183], a[4:7], v[84:87]
  ds_read_b64_tr_b16 a[174:175], v9 offset:22528
  v_exp_f32 v26, v26
  v_mfma_f32_16x16x32_bf16 v[84:87], a[176:179], a[20:23], v[84:87]
  s_cmp_eq_u32 s91, 1
  s_cselect_b32 s76, 3, 10
  s_lshl_b32 s68, s76, 17
  s_lshl_b32 s76, s76, 11
  s_add_u32 s76, s76, s84
  s_add_u32 m0, s45, 32768
  v_mul_f32 v242, v226, v242
  v_exp_f32 v27, v27
  v_mfma_f32_16x16x32_bf16 v[80:83], a[176:179], a[16:19], v[80:83]
  ds_read_b64_tr_b16 a[176:177], v6 offset:24576
  v_mul_f32 v243, v227, v243
  v_mfma_f32_16x16x32_bf16 v[80:83], a[180:183], a[0:3], v[80:83]
  s_waitcnt lgkmcnt(5)
  buffer_load_dwordx4 v32, s[36:39], s68 offen lds
  v_exp_f32 v28, v28
  v_mul_f32 v244, v228, v244
  v_mfma_f32_16x16x32_bf16 v[96:99], a[160:163], a[0:3], v[96:99]
  ds_read_b64_tr_b16 a[178:179], v6 offset:26624
  v_exp_f32 v29, v29
  v_mfma_f32_16x16x32_bf16 v[96:99], a[164:167], a[16:19], v[96:99]
  s_add_u32 m0, s45, 36864
  s_add_u32 s61, s68, 65536
  v_mul_f32 v245, v229, v245
  v_mfma_f32_16x16x32_bf16 v[100:103], a[164:167], a[20:23], v[100:103]
  ds_read_b64_tr_b16 a[180:181], v6 offset:28672
  v_exp_f32 v30, v30
  v_mfma_f32_16x16x32_bf16 v[100:103], a[160:163], a[4:7], v[100:103]
  buffer_load_dwordx4 v32, s[36:39], s61 offen lds
  v_mul_f32 v246, v230, v246
  v_exp_f32 v31, v31
  v_mfma_f32_16x16x32_bf16 v[104:107], a[160:163], a[8:11], v[104:107]
  ds_read_b64_tr_b16 a[182:183], v6 offset:30720
  v_mul_f32 v247, v231, v247
  v_fma_f32 v24, v24, v17, v17
  v_mfma_f32_16x16x32_bf16 v[104:107], a[164:167], a[24:27], v[104:107]
  v_fma_f32 v25, v25, v17, v17
  v_rcp_f32 v24, v24
  v_mfma_f32_16x16x32_bf16 v[108:111], a[164:167], a[28:31], v[108:111]
  ds_read_b64_tr_b16 a[164:165], v7 offset:24576
  v_fma_f32 v26, v26, v17, v17
  v_mfma_f32_16x16x32_bf16 v[108:111], a[160:163], a[12:15], v[108:111]
  s_waitcnt lgkmcnt(5)
  s_add_u32 m0, s45, 40960
  v_rcp_f32 v25, v25
  v_fma_f32 v27, v27, v17, v17
  v_mfma_f32_16x16x32_bf16 v[124:127], a[168:171], a[12:15], v[124:127]
  ds_read_b64_tr_b16 a[166:167], v7 offset:26624
  v_rcp_f32 v26, v26
  v_mfma_f32_16x16x32_bf16 v[124:127], a[172:175], a[28:31], v[124:127]
  buffer_load_dwordx4 v33, s[36:39], s68 offen lds
  v_fma_f32 v28, v28, v19, v19
  v_rcp_f32 v27, v27
  v_mfma_f32_16x16x32_bf16 v[120:123], a[172:175], a[24:27], v[120:123]
  ds_read_b64_tr_b16 a[160:161], v7 offset:28672
  v_fma_f32 v29, v29, v19, v19
  v_mfma_f32_16x16x32_bf16 v[120:123], a[168:171], a[8:11], v[120:123]
  s_add_u32 m0, s45, 45056
  s_add_u32 s61, s68, 65536
  v_rcp_f32 v28, v28
  v_mfma_f32_16x16x32_bf16 v[116:119], a[168:171], a[4:7], v[116:119]
  ds_read_b64_tr_b16 a[162:163], v7 offset:30720
  v_fma_f32 v30, v30, v19, v19
  v_mfma_f32_16x16x32_bf16 v[116:119], a[172:175], a[20:23], v[116:119]
  buffer_load_dwordx4 v33, s[36:39], s61 offen lds
  v_rcp_f32 v29, v29
  v_fma_f32 v31, v31, v19, v19
  v_mfma_f32_16x16x32_bf16 v[112:115], a[172:175], a[16:19], v[112:115]
  ds_read_b64_tr_b16 a[172:173], v8 offset:24576
  v_rcp_f32 v30, v30
  v_mfma_f32_16x16x32_bf16 v[112:115], a[168:171], a[0:3], v[112:115]
  s_waitcnt lgkmcnt(5)
  s_cmp_eq_u32 s91, 2
  s_cselect_b32 s77, 5, 12
  s_lshl_b32 s69, s77, 17
  s_lshl_b32 s77, s77, 11
  s_add_u32 s77, s77, s84
  s_add_u32 m0, s45, 49152
  v_mul_f32 v240, v240, v24
  v_rcp_f32 v31, v31
  v_mfma_f32_16x16x32_bf16 v[128:131], a[176:179], a[0:3], v[128:131]
  ds_read_b64_tr_b16 a[174:175], v8 offset:26624
  v_mul_f32 v241, v241, v25
  v_mul_f32 v242, v242, v26
  v_mfma_f32_16x16x32_bf16 v[128:131], a[180:183], a[16:19], v[128:131]
  buffer_load_dwordx4 v32, s[36:39], s69 offen lds
  v_mul_f32 v243, v243, v27
  v_mul_f32 v244, v244, v28
  v_mul_f32 v245, v245, v29
  v_mfma_f32_16x16x32_bf16 v[132:135], a[180:183], a[20:23], v[132:135]
  ds_read_b64_tr_b16 a[168:169], v8 offset:28672
  v_mul_f32 v246, v246, v30
  v_mul_f32 v247, v247, v31
  v_mfma_f32_16x16x32_bf16 v[132:135], a[176:179], a[4:7], v[132:135]
  s_add_u32 m0, s45, 53248
  s_add_u32 s61, s69, 65536
  v_cvt_pk_bf16_f32 v194, v240, v241
  v_cvt_pk_bf16_f32 v195, v242, v243
  v_mfma_f32_16x16x32_bf16 v[136:139], a[176:179], a[8:11], v[136:139]
  ds_read_b64_tr_b16 a[170:171], v8 offset:30720
  v_mfma_f32_16x16x32_bf16 v[136:139], a[180:183], a[24:27], v[136:139]
  buffer_load_dwordx4 v32, s[36:39], s61 offen lds
  buffer_store_dwordx4 v[192:195], v1, s[8:11], s58 offen offset:1024 sc1
  v_mfma_f32_16x16x32_bf16 v[140:143], a[180:183], a[28:31], v[140:143]
  ds_read_b64_tr_b16 a[180:181], v9 offset:24576
  v_cvt_pk_bf16_f32 v198, v244, v245
  v_cvt_pk_bf16_f32 v199, v246, v247
  v_mfma_f32_16x16x32_bf16 v[140:143], a[176:179], a[12:15], v[140:143]
  s_waitcnt lgkmcnt(5)
  s_add_u32 s55, s58, 262144
  buffer_store_dwordx4 v[196:199], v1, s[8:11], s55 offen offset:1024 sc1
  v_mfma_f32_16x16x32_bf16 v[156:159], a[164:167], a[12:15], v[156:159]
  ds_read_b64_tr_b16 a[182:183], v9 offset:26624
  v_mul_f32 v24, v20, v232
  v_mul_f32 v25, v20, v233
  v_mfma_f32_16x16x32_bf16 v[156:159], a[160:163], a[28:31], v[156:159]
  s_add_u32 m0, s45, 57344
  v_mul_f32 v26, v20, v234
  v_mul_f32 v27, v20, v235
  v_mul_f32 v28, v22, v236
  v_mfma_f32_16x16x32_bf16 v[152:155], a[160:163], a[24:27], v[152:155]
  ds_read_b64_tr_b16 a[176:177], v9 offset:28672
  v_mul_f32 v29, v22, v237
  v_mul_f32 v30, v22, v238
  v_mfma_f32_16x16x32_bf16 v[152:155], a[164:167], a[8:11], v[152:155]
  buffer_load_dwordx4 v33, s[36:39], s69 offen lds
  v_mul_f32 v31, v22, v239
  v_exp_f32 v24, v24
  v_mfma_f32_16x16x32_bf16 v[148:151], a[164:167], a[4:7], v[148:151]
  ds_read_b64_tr_b16 a[178:179], v9 offset:30720
  v_mul_f32 v248, v232, v248
  v_mfma_f32_16x16x32_bf16 v[148:151], a[160:163], a[20:23], v[148:151]
  s_waitcnt vmcnt(46)
  s_barrier
  v_mfma_f32_16x16x32_bf16 v[144:147], a[160:163], a[16:19], v[144:147]
  ds_read_b64_tr_b16 a[160:161], v6 offset:0
  s_add_u32 m0, s45, 61440
  s_add_u32 s61, s69, 65536
  v_mfma_f32_16x16x32_bf16 v[144:147], a[164:167], a[0:3], v[144:147]
  s_waitcnt lgkmcnt(5)
  buffer_load_dwordx4 v33, s[36:39], s61 offen lds
  v_exp_f32 v25, v25
  v_mul_f32 v249, v233, v249
  v_mfma_f32_16x16x32_bf16 v[160:163], a[172:175], a[0:3], v[160:163]
  ds_read_b64_tr_b16 a[162:163], v6 offset:2048
  v_exp_f32 v26, v26
  v_mfma_f32_16x16x32_bf16 v[160:163], a[168:171], a[16:19], v[160:163]
  v_mul_f32 v250, v234, v250
  v_exp_f32 v27, v27
  v_mfma_f32_16x16x32_bf16 v[164:167], a[168:171], a[20:23], v[164:167]
HOP16:
  s_cbranch_execz HOP19
  ds_read_b64_tr_b16 a[164:165], v6 offset:4096
  v_mul_f32 v251, v235, v251
  v_mfma_f32_16x16x32_bf16 v[164:167], a[172:175], a[4:7], v[164:167]
  buffer_load_dwordx4 a[96:99], v1, s[8:11], s76 offen offset:0 sc1
  v_exp_f32 v28, v28
  v_mul_f32 v252, v236, v252
  v_mfma_f32_16x16x32_bf16 v[168:171], a[172:175], a[8:11], v[168:171]
  ds_read_b64_tr_b16 a[166:167], v6 offset:6144
  v_exp_f32 v29, v29
  v_mfma_f32_16x16x32_bf16 v[168:171], a[168:171], a[24:27], v[168:171]
  v_mul_f32 v253, v237, v253
  v_exp_f32 v30, v30
  v_mfma_f32_16x16x32_bf16 v[172:175], a[168:171], a[28:31], v[172:175]
  ds_read_b64_tr_b16 a[168:169], v7 offset:0
  v_mul_f32 v254, v238, v254
  v_mfma_f32_16x16x32_bf16 v[172:175], a[172:175], a[12:15], v[172:175]
  s_waitcnt lgkmcnt(5)
  buffer_load_dwordx4 a[112:115], v1, s[8:11], s76 offen offset:1024 sc1
  v_exp_f32 v31, v31
  v_mul_f32 v255, v239, v255
  v_mfma_f32_16x16x32_bf16 v[188:191], a[180:183], a[12:15], v[188:191]
  ds_read_b64_tr_b16 a[170:171], v7 offset:2048
  v_fma_f32 v24, v24, v21, v21
  v_fma_f32 v25, v25, v21, v21
  v_mfma_f32_16x16x32_bf16 v[188:191], a[176:179], a[28:31], v[188:191]
  v_rcp_f32 v24, v24
  v_fma_f32 v26, v26, v21, v21
  v_mfma_f32_16x16x32_bf16 v[184:187], a[176:179], a[24:27], v[184:187]
  ds_read_b64_tr_b16 a[172:173], v7 offset:4096
  v_rcp_f32 v25, v25
  v_mfma_f32_16x16x32_bf16 v[184:187], a[180:183], a[8:11], v[184:187]
  s_add_u32 s76, s76, 131072
  v_fma_f32 v27, v27, v21, v21
  v_rcp_f32 v26, v26
  v_mfma_f32_16x16x32_bf16 v[180:183], a[180:183], a[4:7], v[180:183]
  ds_read_b64_tr_b16 a[174:175], v7 offset:6144
  v_fma_f32 v28, v28, v23, v23
  v_mfma_f32_16x16x32_bf16 v[180:183], a[176:179], a[20:23], v[180:183]
  buffer_load_dwordx4 a[100:103], v1, s[8:11], s76 offen offset:0 sc1
  v_rcp_f32 v27, v27
  v_fma_f32 v29, v29, v23, v23
  v_mfma_f32_16x16x32_bf16 v[176:179], a[176:179], a[16:19], v[176:179]
  ds_read_b64_tr_b16 a[176:177], v8 offset:0
  v_rcp_f32 v28, v28
  v_mfma_f32_16x16x32_bf16 v[176:179], a[180:183], a[0:3], v[176:179]
  s_waitcnt vmcnt(21) lgkmcnt(5)
  v_fma_f32 v30, v30, v23, v23
  v_rcp_f32 v29, v29
  v_fma_f32 v31, v31, v23, v23
  v_mfma_f32_16x16x32_bf16 v[64:67], a[160:163], a[32:35], v[64:67]
  ds_read_b64_tr_b16 a[178:179], v8 offset:2048
  v_rcp_f32 v30, v30
  v_mfma_f32_16x16x32_bf16 v[64:67], a[164:167], a[48:51], v[64:67]
  buffer_load_dwordx4 a[116:119], v1, s[8:11], s76 offen offset:1024 sc1
  v_mul_f32 v248, v248, v24
  v_rcp_f32 v31, v31
  v_mfma_f32_16x16x32_bf16 v[68:71], a[164:167], a[52:55], v[68:71]
  ds_read_b64_tr_b16 a[180:181], v8 offset:4096
  v_mul_f32 v249, v249, v25
  v_mul_f32 v250, v250, v26
  v_mfma_f32_16x16x32_bf16 v[68:71], a[160:163], a[36:39], v[68:71]
  s_add_u32 s76, s76, s89
  v_mul_f32 v251, v251, v27
  v_mul_f32 v252, v252, v28
  v_mul_f32 v253, v253, v29
  v_mfma_f32_16x16x32_bf16 v[72:75], a[160:163], a[40:43], v[72:75]
  ds_read_b64_tr_b16 a[182:183], v8 offset:6144
  v_mul_f32 v254, v254, v30
  v_mul_f32 v255, v255, v31
  v_mfma_f32_16x16x32_bf16 v[72:75], a[164:167], a[56:59], v[72:75]
  buffer_load_dwordx4 a[104:107], v1, s[8:11], s76 offen offset:0 sc1
  v_cvt_pk_bf16_f32 v202, v248, v249
  v_cvt_pk_bf16_f32 v203, v250, v251
  v_mfma_f32_16x16x32_bf16 v[76:79], a[164:167], a[60:63], v[76:79]
  ds_read_b64_tr_b16 a[164:165], v9 offset:0
  v_mfma_f32_16x16x32_bf16 v[76:79], a[160:163], a[44:47], v[76:79]
  s_waitcnt lgkmcnt(5)
  s_add_u32 s55, s58, 524288
  buffer_store_dwordx4 v[200:203], v1, s[8:11], s55 offen offset:1024 sc1
  v_mfma_f32_16x16x32_bf16 v[92:95], a[168:171], a[44:47], v[92:95]
  ds_read_b64_tr_b16 a[166:167], v9 offset:2048
  v_cvt_pk_bf16_f32 v206, v252, v253
  v_cvt_pk_bf16_f32 v207, v254, v255
  v_mfma_f32_16x16x32_bf16 v[92:95], a[172:175], a[60:63], v[92:95]
  buffer_load_dwordx4 a[120:123], v1, s[8:11], s76 offen offset:1024 sc1
  s_add_u32 s55, s58, 786432
  buffer_store_dwordx4 v[204:207], v1, s[8:11], s55 offen offset:1024 sc1
  v_mfma_f32_16x16x32_bf16 v[88:91], a[172:175], a[56:59], v[88:91]
  ds_read_b64_tr_b16 a[160:161], v9 offset:4096
  v_mfma_f32_16x16x32_bf16 v[88:91], a[168:171], a[40:43], v[88:91]
  v_mfma_f32_16x16x32_bf16 v[84:87], a[168:171], a[36:39], v[84:87]
  ds_read_b64_tr_b16 a[162:163], v9 offset:6144
  s_sub_u32 s80, s80, 491520
  v_mfma_f32_16x16x32_bf16 v[84:87], a[172:175], a[52:55], v[84:87]
  s_add_u32 s76, s76, 131072
  v_mfma_f32_16x16x32_bf16 v[80:83], a[172:175], a[48:51], v[80:83]
  ds_read_b64_tr_b16 a[172:173], v6 offset:8192
  v_mfma_f32_16x16x32_bf16 v[80:83], a[168:171], a[32:35], v[80:83]
  s_waitcnt lgkmcnt(5)
  buffer_load_dwordx4 a[108:111], v1, s[8:11], s76 offen offset:0 sc1
  v_mfma_f32_16x16x32_bf16 v[96:99], a[176:179], a[32:35], v[96:99]
  ds_read_b64_tr_b16 a[174:175], v6 offset:10240
  v_mfma_f32_16x16x32_bf16 v[96:99], a[180:183], a[48:51], v[96:99]
  v_mfma_f32_16x16x32_bf16 v[100:103], a[180:183], a[52:55], v[100:103]
  ds_read_b64_tr_b16 a[168:169], v6 offset:12288
  v_mfma_f32_16x16x32_bf16 v[100:103], a[176:179], a[36:39], v[100:103]
  buffer_load_dwordx4 a[124:127], v1, s[8:11], s76 offen offset:1024 sc1
  v_mfma_f32_16x16x32_bf16 v[104:107], a[176:179], a[40:43], v[104:107]
  ds_read_b64_tr_b16 a[170:171], v6 offset:14336
  v_mfma_f32_16x16x32_bf16 v[104:107], a[180:183], a[56:59], v[104:107]
  v_mfma_f32_16x16x32_bf16 v[108:111], a[180:183], a[60:63], v[108:111]
  ds_read_b64_tr_b16 a[180:181], v7 offset:8192
  v_mfma_f32_16x16x32_bf16 v[108:111], a[176:179], a[44:47], v[108:111]
  s_waitcnt lgkmcnt(5)
  buffer_load_dwordx4 a[128:131], v1, s[8:11], s77 offen offset:0 sc1
  v_mfma_f32_16x16x32_bf16 v[124:127], a[164:167], a[44:47], v[124:127]
  ds_read_b64_tr_b16 a[182:183], v7 offset:10240
  v_mfma_f32_16x16x32_bf16 v[124:127], a[160:163], a[60:63], v[124:127]
  v_mfma_f32_16x16x32_bf16 v[120:123], a[160:163], a[56:59], v[120:123]
  ds_read_b64_tr_b16 a[176:177], v7 offset:12288
  v_mfma_f32_16x16x32_bf16 v[120:123], a[164:167], a[40:43], v[120:123]
  buffer_load_dwordx4 a[144:147], v1, s[8:11], s77 offen offset:1024 sc1
  v_mfma_f32_16x16x32_bf16 v[116:119], a[164:167], a[36:39], v[116:119]
  ds_read_b64_tr_b16 a[178:179], v7 offset:14336
  v_mfma_f32_16x16x32_bf16 v[116:119], a[160:163], a[52:55], v[116:119]
  v_mfma_f32_16x16x32_bf16 v[112:115], a[160:163], a[48:51], v[112:115]
  ds_read_b64_tr_b16 a[160:161], v8 offset:8192
  v_mfma_f32_16x16x32_bf16 v[112:115], a[164:167], a[32:35], v[112:115]
  s_waitcnt lgkmcnt(5)
  s_add_u32 s77, s77, 131072
  v_mfma_f32_16x16x32_bf16 v[128:131], a[172:175], a[32:35], v[128:131]
  ds_read_b64_tr_b16 a[162:163], v8 offset:10240
  v_mfma_f32_16x16x32_bf16 v[128:131], a[168:171], a[48:51], v[128:131]
  buffer_load_dwordx4 a[132:135], v1, s[8:11], s77 offen offset:0 sc1
  v_mfma_f32_16x16x32_bf16 v[132:135], a[168:171], a[52:55], v[132:135]
  ds_read_b64_tr_b16 a[164:165], v8 offset:12288
  v_mfma_f32_16x16x32_bf16 v[132:135], a[172:175], a[36:39], v[132:135]
  v_mfma_f32_16x16x32_bf16 v[136:139], a[172:175], a[40:43], v[136:139]
  ds_read_b64_tr_b16 a[166:167], v8 offset:14336
  v_mfma_f32_16x16x32_bf16 v[136:139], a[168:171], a[56:59], v[136:139]
  buffer_load_dwordx4 a[148:151], v1, s[8:11], s77 offen offset:1024 sc1
  v_mfma_f32_16x16x32_bf16 v[140:143], a[168:171], a[60:63], v[140:143]
  ds_read_b64_tr_b16 a[168:169], v9 offset:8192
  v_mfma_f32_16x16x32_bf16 v[140:143], a[172:175], a[44:47], v[140:143]
  s_waitcnt lgkmcnt(5)
  s_add_u32 s77, s77, s89
  v_mfma_f32_16x16x32_bf16 v[156:159], a[180:183], a[44:47], v[156:159]
  ds_read_b64_tr_b16 a[170:171], v9 offset:10240
  v_mfma_f32_16x16x32_bf16 v[156:159], a[176:179], a[60:63], v[156:159]
  buffer_load_dwordx4 a[136:139], v1, s[8:11], s77 offen offset:0 sc1
  v_mfma_f32_16x16x32_bf16 v[152:155], a[176:179], a[56:59], v[152:155]
  ds_read_b64_tr_b16 a[172:173], v9 offset:12288
  v_mfma_f32_16x16x32_bf16 v[152:155], a[180:183], a[40:43], v[152:155]
  v_mfma_f32_16x16x32_bf16 v[148:151], a[180:183], a[36:39], v[148:151]
  ds_read_b64_tr_b16 a[174:175], v9 offset:14336
  v_mfma_f32_16x16x32_bf16 v[148:151], a[176:179], a[52:55], v[148:151]
  buffer_load_dwordx4 a[152:155], v1, s[8:11], s77 offen offset:1024 sc1
  v_mfma_f32_16x16x32_bf16 v[144:147], a[176:179], a[48:51], v[144:147]
  ds_read_b64_tr_b16 a[176:177], v2 offset:0
  v_mfma_f32_16x16x32_bf16 v[144:147], a[180:183], a[32:35], v[144:147]
  s_waitcnt lgkmcnt(5)
  v_mfma_f32_16x16x32_bf16 v[160:163], a[160:163], a[32:35], v[160:163]
  ds_read_b64_tr_b16 a[178:179], v2 offset:2048
  v_mfma_f32_16x16x32_bf16 v[160:163], a[164:167], a[48:51], v[160:163]
  s_add_u32 s77, s77, 131072
  v_mfma_f32_16x16x32_bf16 v[164:167], a[164:167], a[52:55], v[164:167]
  ds_read_b64_tr_b16 a[180:181], v2 offset:4096
  v_mfma_f32_16x16x32_bf16 v[164:167], a[160:163], a[36:39], v[164:167]
  buffer_load_dwordx4 a[140:143], v1, s[8:11], s77 offen offset:0 sc1
  v_mfma_f32_16x16x32_bf16 v[168:171], a[160:163], a[40:43], v[168:171]
  ds_read_b64_tr_b16 a[182:183], v2 offset:6144
  v_mfma_f32_16x16x32_bf16 v[168:171], a[164:167], a[56:59], v[168:171]
  v_mfma_f32_16x16x32_bf16 v[172:175], a[164:167], a[60:63], v[172:175]
  ds_read_b64_tr_b16 a[164:165], v3 offset:0
  v_mfma_f32_16x16x32_bf16 v[172:175], a[160:163], a[44:47], v[172:175]
  s_waitcnt lgkmcnt(5)
  buffer_load_dwordx4 a[156:159], v1, s[8:11], s77 offen offset:1024 sc1
  v_mfma_f32_16x16x32_bf16 v[188:191], a[168:171], a[44:47], v[188:191]
  ds_read_b64_tr_b16 a[166:167], v3 offset:2048
  v_mfma_f32_16x16x32_bf16 v[188:191], a[172:175], a[60:63], v[188:191]
  s_cmp_eq_u32 s91, 0
  s_cselect_b32 s78, 7, 0
  s_lshl_b32 s70, s78, 17
  s_lshl_b32 s78, s78, 11
  s_add_u32 s78, s78, s84
  s_add_u32 m0, s45, 16384
  v_mfma_f32_16x16x32_bf16 v[184:187], a[172:175], a[56:59], v[184:187]
  ds_read_b64_tr_b16 a[160:161], v3 offset:4096
  v_mfma_f32_16x16x32_bf16 v[184:187], a[168:171], a[40:43], v[184:187]
  buffer_load_dwordx4 v32, s[36:39], s70 offen lds
  v_mfma_f32_16x16x32_bf16 v[180:183], a[168:171], a[36:39], v[180:183]
  ds_read_b64_tr_b16 a[162:163], v3 offset:6144
  v_mfma_f32_16x16x32_bf16 v[180:183], a[172:175], a[52:55], v[180:183]
  s_add_u32 m0, s45, 20480
  s_add_u32 s61, s70, 65536
  v_mfma_f32_16x16x32_bf16 v[176:179], a[172:175], a[48:51], v[176:179]
  ds_read_b64_tr_b16 a[172:173], v4 offset:0
  v_mfma_f32_16x16x32_bf16 v[176:179], a[168:171], a[32:35], v[176:179]
  s_waitcnt vmcnt(29) lgkmcnt(5)
  buffer_load_dwordx4 v32, s[36:39], s61 offen lds
  v_mfma_f32_16x16x32_bf16 v[64:67], a[176:179], a[64:67], v[64:67]
  ds_read_b64_tr_b16 a[174:175], v4 offset:2048
  v_mfma_f32_16x16x32_bf16 v[64:67], a[180:183], a[80:83], v[64:67]
  v_mfma_f32_16x16x32_bf16 v[68:71], a[180:183], a[84:87], v[68:71]
  ds_read_b64_tr_b16 a[168:169], v4 offset:4096
  v_mfma_f32_16x16x32_bf16 v[68:71], a[176:179], a[68:71], v[68:71]
  s_add_u32 m0, s45, 24576
  v_mfma_f32_16x16x32_bf16 v[72:75], a[176:179], a[72:75], v[72:75]
  ds_read_b64_tr_b16 a[170:171], v4 offset:6144
  v_mfma_f32_16x16x32_bf16 v[72:75], a[180:183], a[88:91], v[72:75]
  buffer_load_dwordx4 v33, s[36:39], s70 offen lds
  v_mfma_f32_16x16x32_bf16 v[76:79], a[180:183], a[92:95], v[76:79]
  ds_read_b64_tr_b16 a[180:181], v5 offset:0
  v_mfma_f32_16x16x32_bf16 v[76:79], a[176:179], a[76:79], v[76:79]
  s_waitcnt lgkmcnt(5)
  s_add_u32 m0, s45, 28672
  s_add_u32 s61, s70, 65536
  v_mfma_f32_16x16x32_bf16 v[92:95], a[164:167], a[76:79], v[92:95]
  ds_read_b64_tr_b16 a[182:183], v5 offset:2048
  v_mfma_f32_16x16x32_bf16 v[92:95], a[160:163], a[92:95], v[92:95]
  buffer_load_dwordx4 v33, s[36:39], s61 offen lds
  v_add_u32 v38, s46, v0
  s_waitcnt vmcnt(14)
  s_barrier
  s_mov_b64 exec, 1
  buffer_store_dword v38, v0, s[8:11], s80 offen offset:0 sc1
  s_mov_b64 exec, -1
  v_mfma_f32_16x16x32_bf16 v[88:91], a[160:163], a[88:91], v[88:91]
  ds_read_b64_tr_b16 a[176:177], v5 offset:4096
  s_lshl_b32 s53, s44, 8
  v_mfma_f32_16x16x32_bf16 v[88:91], a[164:167], a[72:75], v[88:91]
  s_cmp_eq_u32 s91, 1
  s_cselect_b32 s79, 9, 2
  s_lshl_b32 s71, s79, 17
  s_lshl_b32 s79, s79, 11
  s_add_u32 s79, s79, s84
  s_add_u32 m0, s45, 98304
  s_add_u32 s53, s53, 133120
  v_lshrrev_b32 v49, 4, v0
  v_mfma_f32_16x16x32_bf16 v[84:87], a[164:167], a[68:71], v[84:87]
  ds_read_b64_tr_b16 a[178:179], v5 offset:6144
  v_lshl_add_u32 v46, v49, 4, s53
  v_mfma_f32_16x16x32_bf16 v[84:87], a[160:163], a[84:87], v[84:87]
  buffer_load_dwordx4 v32, s[36:39], s71 offen lds
  v_lshlrev_b32 v47, 2, v0
  v_add_u32 v45, s53, v47
  v_mfma_f32_16x16x32_bf16 v[80:83], a[160:163], a[80:83], v[80:83]
  ds_read_b64_tr_b16 a[160:161], v2 offset:8192
  v_lshrrev_b32 v48, 3, v0
  v_mfma_f32_16x16x32_bf16 v[80:83], a[164:167], a[64:67], v[80:83]
  s_waitcnt lgkmcnt(5)
  s_add_u32 m0, s45, 102400
  s_add_u32 s61, s71, 65536
  v_mfma_f32_16x16x32_bf16 v[96:99], a[172:175], a[64:67], v[96:99]
  ds_read_b64_tr_b16 a[162:163], v2 offset:10240
  v_and_b32 v50, 7, v0
  v_mfma_f32_16x16x32_bf16 v[96:99], a[168:171], a[80:83], v[96:99]
  buffer_load_dwordx4 v32, s[36:39], s61 offen lds
  v_xor_b32 v51, v50, v48
  v_lshlrev_b32 v51, 4, v51
  v_mfma_f32_16x16x32_bf16 v[100:103], a[168:171], a[84:87], v[100:103]
  ds_read_b64_tr_b16 a[164:165], v2 offset:12288
  v_lshl_add_u32 v40, v48, 11, v51
  v_mfma_f32_16x16x32_bf16 v[100:103], a[172:175], a[68:71], v[100:103]
  v_bfe_u32 v48, v0, 4, 1
  v_lshrrev_b32 v51, 5, v0
  v_mfma_f32_16x16x32_bf16 v[104:107], a[172:175], a[72:75], v[104:107]
  ds_read_b64_tr_b16 a[166:167], v2 offset:14336
  v_lshl_add_u32 v48, v48, 1, v51
  v_mfma_f32_16x16x32_bf16 v[104:107], a[168:171], a[88:91], v[104:107]
  s_cmp_eq_u32 s91, 2
  s_cselect_b32 s72, 11, 4
  s_lshl_b32 s64, s72, 17
  s_lshl_b32 s72, s72, 11
  s_add_u32 s72, s72, s84
  s_add_u32 m0, s45, 114688
  v_xor_b32 v48, v48, v50
  v_lshlrev_b32 v48, 4, v48
  v_mfma_f32_16x16x32_bf16 v[108:111], a[168:171], a[92:95], v[108:111]
  ds_read_b64_tr_b16 a[168:169], v3 offset:8192
  v_and_b32 v50, 15, v0
  v_mfma_f32_16x16x32_bf16 v[108:111], a[172:175], a[76:79], v[108:111]
  s_waitcnt lgkmcnt(5)
  buffer_load_dwordx4 v32, s[36:39], s64 offen lds
  v_lshl_add_u32 v48, v50, 7, v48
  v_mfma_f32_16x16x32_bf16 v[124:127], a[180:183], a[76:79], v[124:127]
  ds_read_b64_tr_b16 a[170:171], v3 offset:10240
  v_add_u32 v42, s90, v48
  v_mfma_f32_16x16x32_bf16 v[124:127], a[176:179], a[92:95], v[124:127]
  s_add_u32 m0, s45, 118784
  s_add_u32 s61, s64, 65536
  v_xor_b32 v43, 64, v42
  v_mfma_f32_16x16x32_bf16 v[120:123], a[176:179], a[88:91], v[120:123]
  ds_read_b64_tr_b16 a[172:173], v3 offset:12288
  v_add_u32 v44, s90, v1
  v_mfma_f32_16x16x32_bf16 v[120:123], a[180:183], a[72:75], v[120:123]
  buffer_load_dwordx4 v32, s[36:39], s61 offen lds
  v_bfe_u32 v48, v0, 2, 2
  v_lshrrev_b32 v49, 4, v0
  v_mfma_f32_16x16x32_bf16 v[116:119], a[180:183], a[68:71], v[116:119]
  ds_read_b64_tr_b16 a[174:175], v3 offset:14336
  v_and_b32 v50, 1, v0
  v_mfma_f32_16x16x32_bf16 v[116:119], a[176:179], a[84:87], v[116:119]
  s_cmp_eq_u32 s91, 3
  s_cselect_b32 s73, 13, 6
  s_lshl_b32 s65, s73, 17
  s_lshl_b32 s73, s73, 11
  s_add_u32 s73, s73, s84
  s_add_u32 m0, s45, 81920
  v_lshlrev_b32 v50, 4, v50
  v_mov_b32 v51, 0xffff
  v_mfma_f32_16x16x32_bf16 v[112:115], a[176:179], a[80:83], v[112:115]
  ds_read_b64_tr_b16 a[176:177], v4 offset:8192
  v_lshlrev_b32 v50, v50, v51
  v_mfma_f32_16x16x32_bf16 v[112:115], a[180:183], a[64:67], v[112:115]
  s_waitcnt lgkmcnt(5)
  buffer_load_dwordx4 v32, s[36:39], s65 offen lds
  v_cmp_eq_u32 vcc, v48, v49
  v_mov_b32 v60, 0
  v_mov_b32 v61, 0
  v_cndmask_b32 v48, 0, v50, vcc
  v_mfma_f32_16x16x32_bf16 v[128:131], a[160:163], a[64:67], v[128:131]
  ds_read_b64_tr_b16 a[178:179], v4 offset:10240
  v_and_b32 v49, 2, v0
  v_mfma_f32_16x16x32_bf16 v[128:131], a[164:167], a[80:83], v[128:131]
  s_add_u32 m0, s45, 86016
  s_add_u32 s61, s65, 65536
  v_cmp_eq_u32 vcc, 0, v49
  v_mov_b32 v54, 0
  v_mov_b32 v55, 0
  v_cndmask_b32 v50, 0, v48, vcc
  v_mfma_f32_16x16x32_bf16 v[132:135], a[164:167], a[84:87], v[132:135]
  ds_read_b64_tr_b16 a[180:181], v4 offset:12288
  v_sub_u32 v51, v48, v50
  v_mfma_f32_16x16x32_bf16 v[132:135], a[160:163], a[68:71], v[132:135]
  buffer_load_dwordx4 v32, s[36:39], s61 offen lds
  v_mfma_f32_16x16x32_bf16 v[136:139], a[160:163], a[72:75], v[136:139]
  ds_read_b64_tr_b16 a[182:183], v4 offset:14336
  v_mfma_f32_16x16x32_bf16 v[136:139], a[164:167], a[88:91], v[136:139]
  v_mfma_f32_16x16x32_bf16 v[140:143], a[164:167], a[92:95], v[140:143]
  ds_read_b64_tr_b16 a[164:165], v5 offset:8192
  v_mfma_f32_16x16x32_bf16 v[140:143], a[160:163], a[76:79], v[140:143]
  s_waitcnt lgkmcnt(5)
  s_add_u32 m0, s45, 106496
  v_mfma_f32_16x16x32_bf16 v[156:159], a[168:171], a[76:79], v[156:159]
  ds_read_b64_tr_b16 a[166:167], v5 offset:10240
  v_mfma_f32_16x16x32_bf16 v[156:159], a[172:175], a[92:95], v[156:159]
  buffer_load_dwordx4 v33, s[36:39], s71 offen lds
  v_mfma_f32_16x16x32_bf16 v[152:155], a[172:175], a[88:91], v[152:155]
  ds_read_b64_tr_b16 a[160:161], v5 offset:12288
  v_mfma_f32_16x16x32_bf16 v[152:155], a[168:171], a[72:75], v[152:155]
  s_add_u32 m0, s45, 110592
  s_add_u32 s61, s71, 65536
  v_mfma_f32_16x16x32_bf16 v[148:151], a[168:171], a[68:71], v[148:151]
  ds_read_b64_tr_b16 a[162:163], v5 offset:14336
  buffer_load_dwordx4 v33, s[36:39], s61 offen lds
  v_mfma_f32_16x16x32_bf16 v[148:151], a[172:175], a[84:87], v[148:151]
  s_waitcnt vmcnt(31)
  s_barrier
  v_mfma_f32_16x16x32_bf16 v[144:147], a[172:175], a[80:83], v[144:147]
  ds_read_b64_tr_b16 a[172:173], v2 offset:32768
  v_mfma_f32_16x16x32_bf16 v[144:147], a[168:171], a[64:67], v[144:147]
  s_waitcnt lgkmcnt(5)
  s_cmp_eq_u32 s91, 0
  s_cselect_b32 s74, 0, 7
  s_lshl_b32 s66, s74, 17
  s_lshl_b32 s74, s74, 11
  s_add_u32 s74, s74, s84
  s_add_u32 m0, s45, 65536
  v_mfma_f32_16x16x32_bf16 v[160:163], a[176:179], a[64:67], v[160:163]
  ds_read_b64_tr_b16 a[174:175], v2 offset:34816
  v_mfma_f32_16x16x32_bf16 v[160:163], a[180:183], a[80:83], v[160:163]
  buffer_load_dwordx4 v32, s[36:39], s66 offen lds
  v_mfma_f32_16x16x32_bf16 v[164:167], a[180:183], a[84:87], v[164:167]
  ds_read_b64_tr_b16 a[168:169], v2 offset:36864
  v_mfma_f32_16x16x32_bf16 v[164:167], a[176:179], a[68:71], v[164:167]
  s_add_u32 m0, s45, 69632
  s_add_u32 s61, s66, 65536
  v_mfma_f32_16x16x32_bf16 v[168:171], a[176:179], a[72:75], v[168:171]
  ds_read_b64_tr_b16 a[170:171], v2 offset:38912
  v_mfma_f32_16x16x32_bf16 v[168:171], a[180:183], a[88:91], v[168:171]
  buffer_load_dwordx4 v32, s[36:39], s61 offen lds
  v_mfma_f32_16x16x32_bf16 v[172:175], a[180:183], a[92:95], v[172:175]
  ds_read_b64_tr_b16 a[180:181], v3 offset:32768
  v_mfma_f32_16x16x32_bf16 v[172:175], a[176:179], a[76:79], v[172:175]
  s_waitcnt lgkmcnt(5)
  v_mfma_f32_16x16x32_bf16 v[188:191], a[164:167], a[76:79], v[188:191]
  ds_read_b64_tr_b16 a[182:183], v3 offset:34816
  v_mfma_f32_16x16x32_bf16 v[188:191], a[160:163], a[92:95], v[188:191]
  s_add_u32 s62, s88, 0
  v_mfma_f32_16x16x32_bf16 v[184:187], a[160:163], a[88:91], v[184:187]
  ds_read_b64_tr_b16 a[176:177], v3 offset:36864
  v_mfma_f32_16x16x32_bf16 v[184:187], a[164:167], a[72:75], v[184:187]
  buffer_load_dword v240, v47, s[8:11], s62 offen sc1
  v_mfma_f32_16x16x32_bf16 v[180:183], a[164:167], a[68:71], v[180:183]
  ds_read_b64_tr_b16 a[178:179], v3 offset:38912
  v_mfma_f32_16x16x32_bf16 v[180:183], a[160:163], a[84:87], v[180:183]
  s_add_u32 s62, s88, 24576
  v_mfma_f32_16x16x32_bf16 v[176:179], a[160:163], a[80:83], v[176:179]
  ds_read_b64_tr_b16 a[160:161], v4 offset:32768
  v_mfma_f32_16x16x32_bf16 v[176:179], a[164:167], a[64:67], v[176:179]
  s_waitcnt vmcnt(24) lgkmcnt(5)
  buffer_load_dword v241, v47, s[8:11], s62 offen sc1
  v_mfma_f32_16x16x32_bf16 v[64:67], a[172:175], a[96:99], v[64:67]
  ds_read_b64_tr_b16 a[162:163], v4 offset:34816
  v_mfma_f32_16x16x32_bf16 v[64:67], a[168:171], a[112:115], v[64:67]
  s_add_u32 s62, s88, 49152
  v_mfma_f32_16x16x32_bf16 v[68:71], a[168:171], a[116:119], v[68:71]
  ds_read_b64_tr_b16 a[164:165], v4 offset:36864
  v_mfma_f32_16x16x32_bf16 v[68:71], a[172:175], a[100:103], v[68:71]
  buffer_load_dword v242, v47, s[8:11], s62 offen sc1
  v_mfma_f32_16x16x32_bf16 v[72:75], a[172:175], a[104:107], v[72:75]
  ds_read_b64_tr_b16 a[166:167], v4 offset:38912
  v_mfma_f32_16x16x32_bf16 v[72:75], a[168:171], a[120:123], v[72:75]
  s_add_u32 s62, s88, 73728
  v_mfma_f32_16x16x32_bf16 v[76:79], a[168:171], a[124:127], v[76:79]
  ds_read_b64_tr_b16 a[168:169], v5 offset:32768
  v_mfma_f32_16x16x32_bf16 v[76:79], a[172:175], a[108:111], v[76:79]
  s_waitcnt lgkmcnt(5)
  buffer_load_dword v243, v47, s[8:11], s62 offen sc1
  v_mfma_f32_16x16x32_bf16 v[92:95], a[180:183], a[108:111], v[92:95]
  ds_read_b64_tr_b16 a[170:171], v5 offset:34816
  v_mfma_f32_16x16x32_bf16 v[92:95], a[176:179], a[124:127], v[92:95]
  v_mfma_f32_16x16x32_bf16 v[88:91], a[176:179], a[120:123], v[88:91]
  ds_read_b64_tr_b16 a[172:173], v5 offset:36864
  v_mfma_f32_16x16x32_bf16 v[88:91], a[180:183], a[104:107], v[88:91]
  s_cmp_eq_u32 s91, 1
  s_cselect_b32 s75, 2, 9
  s_lshl_b32 s67, s75, 17
  s_lshl_b32 s75, s75, 11
  s_add_u32 s75, s75, s84
  s_add_u32 m0, s45, 0
  v_mfma_f32_16x16x32_bf16 v[84:87], a[180:183], a[100:103], v[84:87]
  ds_read_b64_tr_b16 a[174:175], v5 offset:38912
  v_mfma_f32_16x16x32_bf16 v[84:87], a[176:179], a[116:119], v[84:87]
  buffer_load_dwordx4 v32, s[36:39], s67 offen lds
  v_mfma_f32_16x16x32_bf16 v[80:83], a[176:179], a[112:115], v[80:83]
  ds_read_b64_tr_b16 a[176:177], v2 offset:40960
  v_mfma_f32_16x16x32_bf16 v[80:83], a[180:183], a[96:99], v[80:83]
  s_waitcnt lgkmcnt(5)
  s_add_u32 m0, s45, 4096
  s_add_u32 s61, s67, 65536
  v_mfma_f32_16x16x32_bf16 v[96:99], a[160:163], a[96:99], v[96:99]
  ds_read_b64_tr_b16 a[178:179], v2 offset:43008
  v_mfma_f32_16x16x32_bf16 v[96:99], a[164:167], a[112:115], v[96:99]
  s_sub_u32 s82, s82, 491520
  buffer_load_dwordx4 v32, s[36:39], s61 offen lds
  v_mfma_f32_16x16x32_bf16 v[100:103], a[164:167], a[116:119], v[100:103]
  ds_read_b64_tr_b16 a[180:181], v2 offset:45056
  s_cmp_lg_u32 s44, 0
  s_cbranch_scc1 PI20_adaLN_cond__sliding_local_dilated__swiglu_ffn__prompt_kernel
  buffer_load_dword v36, v37, s[8:11], s82 offen sc1
PI20_adaLN_cond__sliding_local_dilated__swiglu_ffn__prompt_kernel:
  v_mfma_f32_16x16x32_bf16 v[100:103], a[160:163], a[100:103], v[100:103]
  s_add_u32 m0, s45, 122880
  v_mfma_f32_16x16x32_bf16 v[104:107], a[160:163], a[104:107], v[104:107]
  ds_read_b64_tr_b16 a[182:183], v2 offset:47104
  v_mfma_f32_16x16x32_bf16 v[104:107], a[164:167], a[120:123], v[104:107]
  buffer_load_dwordx4 v33, s[36:39], s64 offen lds
  v_mfma_f32_16x16x32_bf16 v[108:111], a[164:167], a[124:127], v[108:111]
  ds_read_b64_tr_b16 a[164:165], v3 offset:40960
  v_mfma_f32_16x16x32_bf16 v[108:111], a[160:163], a[108:111], v[108:111]
  s_waitcnt lgkmcnt(5)
  s_add_u32 m0, s45, 126976
  s_add_u32 s61, s64, 65536
  v_mfma_f32_16x16x32_bf16 v[124:127], a[168:171], a[108:111], v[124:127]
  ds_read_b64_tr_b16 a[166:167], v3 offset:43008
  v_mfma_f32_16x16x32_bf16 v[124:127], a[172:175], a[124:127], v[124:127]
  buffer_load_dwordx4 v33, s[36:39], s61 offen lds
  v_mfma_f32_16x16x32_bf16 v[120:123], a[172:175], a[120:123], v[120:123]
  ds_read_b64_tr_b16 a[160:161], v3 offset:45056
  v_mfma_f32_16x16x32_bf16 v[120:123], a[168:171], a[104:107], v[120:123]
  v_mfma_f32_16x16x32_bf16 v[116:119], a[168:171], a[100:103], v[116:119]
  ds_read_b64_tr_b16 a[162:163], v3 offset:47104
  v_mfma_f32_16x16x32_bf16 v[116:119], a[172:175], a[116:119], v[116:119]
  s_add_u32 m0, s45, 90112
  v_mfma_f32_16x16x32_bf16 v[112:115], a[172:175], a[112:115], v[112:115]
  ds_read_b64_tr_b16 a[172:173], v4 offset:40960
  v_mfma_f32_16x16x32_bf16 v[112:115], a[168:171], a[96:99], v[112:115]
  s_waitcnt lgkmcnt(5)
  buffer_load_dwordx4 v33, s[36:39], s65 offen lds
  v_mfma_f32_16x16x32_bf16 v[128:131], a[176:179], a[96:99], v[128:131]
  ds_read_b64_tr_b16 a[174:175], v4 offset:43008
  v_mfma_f32_16x16x32_bf16 v[128:131], a[180:183], a[112:115], v[128:131]
  s_add_u32 m0, s45, 94208
  s_add_u32 s61, s65, 65536
  v_mfma_f32_16x16x32_bf16 v[132:135], a[180:183], a[116:119], v[132:135]
  ds_read_b64_tr_b16 a[168:169], v4 offset:45056
  v_mfma_f32_16x16x32_bf16 v[132:135], a[176:179], a[100:103], v[132:135]
  buffer_load_dwordx4 v33, s[36:39], s61 offen lds
  v_mfma_f32_16x16x32_bf16 v[136:139], a[176:179], a[104:107], v[136:139]
  ds_read_b64_tr_b16 a[170:171], v4 offset:47104
  v_mfma_f32_16x16x32_bf16 v[136:139], a[180:183], a[120:123], v[136:139]
  s_add_u32 m0, s45, 73728
  v_mfma_f32_16x16x32_bf16 v[140:143], a[180:183], a[124:127], v[140:143]
  ds_read_b64_tr_b16 a[180:181], v5 offset:40960
  v_mfma_f32_16x16x32_bf16 v[140:143], a[176:179], a[108:111], v[140:143]
  s_waitcnt lgkmcnt(5)
  buffer_load_dwordx4 v33, s[36:39], s66 offen lds
  v_mfma_f32_16x16x32_bf16 v[156:159], a[164:167], a[108:111], v[156:159]
  ds_read_b64_tr_b16 a[182:183], v5 offset:43008
  v_mfma_f32_16x16x32_bf16 v[156:159], a[160:163], a[124:127], v[156:159]
  s_add_u32 m0, s45, 77824
  s_add_u32 s61, s66, 65536
  v_mfma_f32_16x16x32_bf16 v[152:155], a[160:163], a[120:123], v[152:155]
  ds_read_b64_tr_b16 a[176:177], v5 offset:45056
  v_mfma_f32_16x16x32_bf16 v[152:155], a[164:167], a[104:107], v[152:155]
  buffer_load_dwordx4 v33, s[36:39], s61 offen lds
  v_mfma_f32_16x16x32_bf16 v[148:151], a[164:167], a[100:103], v[148:151]
  ds_read_b64_tr_b16 a[178:179], v5 offset:47104
  v_mfma_f32_16x16x32_bf16 v[148:151], a[160:163], a[116:119], v[148:151]
  v_mfma_f32_16x16x32_bf16 v[144:147], a[160:163], a[112:115], v[144:147]
  ds_read_b64_tr_b16 a[160:161], v2 offset:49152
  v_mfma_f32_16x16x32_bf16 v[144:147], a[164:167], a[96:99], v[144:147]
  s_waitcnt lgkmcnt(5)
  v_mfma_f32_16x16x32_bf16 v[160:163], a[172:175], a[96:99], v[160:163]
  ds_read_b64_tr_b16 a[162:163], v2 offset:51200
  v_mfma_f32_16x16x32_bf16 v[160:163], a[168:171], a[112:115], v[160:163]
  v_mfma_f32_16x16x32_bf16 v[164:167], a[168:171], a[116:119], v[164:167]
  ds_read_b64_tr_b16 a[164:165], v2 offset:53248
  v_mfma_f32_16x16x32_bf16 v[164:167], a[172:175], a[100:103], v[164:167]
  v_mfma_f32_16x16x32_bf16 v[168:171], a[172:175], a[104:107], v[168:171]
  ds_read_b64_tr_b16 a[166:167], v2 offset:55296
  v_mfma_f32_16x16x32_bf16 v[168:171], a[168:171], a[120:123], v[168:171]
  v_mfma_f32_16x16x32_bf16 v[172:175], a[168:171], a[124:127], v[172:175]
  ds_read_b64_tr_b16 a[168:169], v3 offset:49152
  v_mfma_f32_16x16x32_bf16 v[172:175], a[172:175], a[108:111], v[172:175]
  s_waitcnt lgkmcnt(5)
  v_mfma_f32_16x16x32_bf16 v[188:191], a[180:183], a[108:111], v[188:191]
  ds_read_b64_tr_b16 a[170:171], v3 offset:51200
  v_mfma_f32_16x16x32_bf16 v[188:191], a[176:179], a[124:127], v[188:191]
  v_mfma_f32_16x16x32_bf16 v[184:187], a[176:179], a[120:123], v[184:187]
  ds_read_b64_tr_b16 a[172:173], v3 offset:53248
  s_cmp_lg_u32 s44, 0
  s_cbranch_scc1 PL21_adaLN_cond__sliding_local_dilated__swiglu_ffn__prompt_kernelx
  s_waitcnt vmcnt(6)
  v_cmp_ne_u32 vcc, s46, v36
  s_nop 4
  s_cbranch_vccz PL21_adaLN_cond__sliding_local_dilated__swiglu_ffn__prompt_kernelx
  s_mov_b32 s83, 60000
PL21_adaLN_cond__sliding_local_dilated__swiglu_ffn__prompt_kernel:
  buffer_load_dword v36, v37, s[8:11], s82 offen sc1
  s_sub_u32 s83, s83, 1
  s_cmp_eq_u32 s83, 0
  s_waitcnt vmcnt(0)
  s_cbranch_scc1 PL21_adaLN_cond__sliding_local_dilated__swiglu_ffn__prompt_kernelx
  v_cmp_ne_u32 vcc, s46, v36
  s_nop 4
  s_cbranch_vccnz PL21_adaLN_cond__sliding_local_dilated__swiglu_ffn__prompt_kernel
PL21_adaLN_cond__sliding_local_dilated__swiglu_ffn__prompt_kernelx:
  s_barrier
  v_mfma_f32_16x16x32_bf16 v[184:187], a[180:183], a[104:107], v[184:187]
  v_mfma_f32_16x16x32_bf16 v[180:183], a[180:183], a[100:103], v[180:183]
  ds_read_b64_tr_b16 a[174:175], v3 offset:55296
  v_mfma_f32_16x16x32_bf16 v[180:183], a[176:179], a[116:119], v[180:183]
  buffer_load_dwordx4 a[188:191], v1, s[8:11], s78 offen offset:0 sc1
  v_mfma_f32_16x16x32_bf16 v[176:179], a[176:179], a[112:115], v[176:179]
  ds_read_b64_tr_b16 a[176:177], v4 offset:49152
  v_mfma_f32_16x16x32_bf16 v[176:179], a[180:183], a[96:99], v[176:179]
  s_waitcnt vmcnt(28) lgkmcnt(5)
  v_mfma_f32_16x16x32_bf16 v[64:67], a[160:163], a[128:131], v[64:67]
  ds_read_b64_tr_b16 a[178:179], v4 offset:51200
  v_mfma_f32_16x16x32_bf16 v[64:67], a[164:167], a[144:147], v[64:67]
  buffer_load_dwordx4 a[204:207], v1, s[8:11], s78 offen offset:1024 sc1
  v_mfma_f32_16x16x32_bf16 v[68:71], a[164:167], a[148:151], v[68:71]
  ds_read_b64_tr_b16 a[180:181], v4 offset:53248
  v_mfma_f32_16x16x32_bf16 v[68:71], a[160:163], a[132:135], v[68:71]
  s_add_u32 s78, s78, 131072
  v_mfma_f32_16x16x32_bf16 v[72:75], a[160:163], a[136:139], v[72:75]
  ds_read_b64_tr_b16 a[182:183], v4 offset:55296
  v_mfma_f32_16x16x32_bf16 v[72:75], a[164:167], a[152:155], v[72:75]
  buffer_load_dwordx4 a[192:195], v1, s[8:11], s78 offen offset:0 sc1
  v_mfma_f32_16x16x32_bf16 v[76:79], a[164:167], a[156:159], v[76:79]
  ds_read_b64_tr_b16 a[164:165], v5 offset:49152
  v_mfma_f32_16x16x32_bf16 v[76:79], a[160:163], a[140:143], v[76:79]
  s_waitcnt lgkmcnt(5)
  v_mfma_f32_16x16x32_bf16 v[92:95], a[168:171], a[140:143], v[92:95]
  ds_read_b64_tr_b16 a[166:167], v5 offset:51200
  v_mfma_f32_16x16x32_bf16 v[92:95], a[172:175], a[156:159], v[92:95]
  v_mfma_f32_16x16x32_bf16 v[88:91], a[172:175], a[152:155], v[88:91]
  ds_read_b64_tr_b16 a[160:161], v5 offset:53248
  v_mfma_f32_16x16x32_bf16 v[88:91], a[168:171], a[136:139], v[88:91]
  buffer_load_dwordx4 a[208:211], v1, s[8:11], s78 offen offset:1024 sc1
HOP17:
  s_cbranch_execz WRET1
  v_mfma_f32_16x16x32_bf16 v[84:87], a[168:171], a[132:135], v[84:87]
  ds_read_b64_tr_b16 a[162:163], v5 offset:55296
  v_mfma_f32_16x16x32_bf16 v[84:87], a[172:175], a[148:151], v[84:87]
  s_add_u32 s78, s78, s89
  v_mfma_f32_16x16x32_bf16 v[80:83], a[172:175], a[144:147], v[80:83]
  ds_read_b64_tr_b16 a[172:173], v2 offset:57344
  v_mfma_f32_16x16x32_bf16 v[80:83], a[168:171], a[128:131], v[80:83]
  s_waitcnt lgkmcnt(5)
  buffer_load_dwordx4 a[196:199], v1, s[8:11], s78 offen offset:0 sc1
  v_mfma_f32_16x16x32_bf16 v[96:99], a[176:179], a[128:131], v[96:99]
  ds_read_b64_tr_b16 a[174:175], v2 offset:59392
  v_mfma_f32_16x16x32_bf16 v[96:99], a[180:183], a[144:147], v[96:99]
  v_mfma_f32_16x16x32_bf16 v[100:103], a[180:183], a[148:151], v[100:103]
  ds_read_b64_tr_b16 a[168:169], v2 offset:61440
  v_mfma_f32_16x16x32_bf16 v[100:103], a[176:179], a[132:135], v[100:103]
  buffer_load_dwordx4 a[212:215], v1, s[8:11], s78 offen offset:1024 sc1
  v_mfma_f32_16x16x32_bf16 v[104:107], a[176:179], a[136:139], v[104:107]
  ds_read_b64_tr_b16 a[170:171], v2 offset:63488
  v_mfma_f32_16x16x32_bf16 v[104:107], a[180:183], a[152:155], v[104:107]
  s_add_u32 s78, s78, 131072
  v_mfma_f32_16x16x32_bf16 v[108:111], a[180:183], a[156:159], v[108:111]
  ds_read_b64_tr_b16 a[180:181], v3 offset:57344
  v_mfma_f32_16x16x32_bf16 v[108:111], a[176:179], a[140:143], v[108:111]
  s_waitcnt lgkmcnt(5)
  buffer_load_dwordx4 a[200:203], v1, s[8:11], s78 offen offset:0 sc1
  v_mfma_f32_16x16x32_bf16 v[124:127], a[164:167], a[140:143], v[124:127]
  ds_read_b64_tr_b16 a[182:183], v3 offset:59392
  v_mfma_f32_16x16x32_bf16 v[124:127], a[160:163], a[156:159], v[124:127]
  v_mfma_f32_16x16x32_bf16 v[120:123], a[160:163], a[152:155], v[120:123]
  ds_read_b64_tr_b16 a[176:177], v3 offset:61440
  v_mfma_f32_16x16x32_bf16 v[120:123], a[164:167], a[136:139], v[120:123]
  v_mfma_f32_16x16x32_bf16 v[116:119], a[164:167], a[132:135], v[116:119]
  ds_read_b64_tr_b16 a[178:179], v3 offset:63488
  v_mfma_f32_16x16x32_bf16 v[116:119], a[160:163], a[148:151], v[116:119]
  buffer_load_dwordx4 a[216:219], v1, s[8:11], s78 offen offset:1024 sc1
  v_mfma_f32_16x16x32_bf16 v[112:115], a[160:163], a[144:147], v[112:115]
  ds_read_b64_tr_b16 a[160:161], v4 offset:57344
  v_mfma_f32_16x16x32_bf16 v[112:115], a[164:167], a[128:131], v[112:115]
  s_waitcnt lgkmcnt(5)
  v_mfma_f32_16x16x32_bf16 v[128:131], a[172:175], a[128:131], v[128:131]
  ds_read_b64_tr_b16 a[162:163], v4 offset:59392
  v_mfma_f32_16x16x32_bf16 v[128:131], a[168:171], a[144:147], v[128:131]
  buffer_load_dwordx4 a[220:223], v1, s[8:11], s79 offen offset:0 sc1
  v_mfma_f32_16x16x32_bf16 v[132:135], a[168:171], a[148:151], v[132:135]
  ds_read_b64_tr_b16 a[164:165], v4 offset:61440
  v_mfma_f32_16x16x32_bf16 v[132:135], a[172:175], a[132:135], v[132:135]
  v_mfma_f32_16x16x32_bf16 v[136:139], a[172:175], a[136:139], v[136:139]
  ds_read_b64_tr_b16 a[166:167], v4 offset:63488
  v_mfma_f32_16x16x32_bf16 v[136:139], a[168:171], a[152:155], v[136:139]
  buffer_load_dwordx4 a[236:239], v1, s[8:11], s79 offen offset:1024 sc1
  v_mfma_f32_16x16x32_bf16 v[140:143], a[168:171], a[156:159], v[140:143]
  ds_read_b64_tr_b16 a[168:169], v5 offset:57344
  v_mfma_f32_16x16x32_bf16 v[140:143], a[172:175], a[140:143], v[140:143]
  s_waitcnt lgkmcnt(5)
  s_add_u32 s79, s79, 131072
  v_mfma_f32_16x16x32_bf16 v[156:159], a[180:183], a[140:143], v[156:159]
  ds_read_b64_tr_b16 a[170:171], v5 offset:59392
  v_mfma_f32_16x16x32_bf16 v[156:159], a[176:179], a[156:159], v[156:159]
  buffer_load_dwordx4 a[224:227], v1, s[8:11], s79 offen offset:0 sc1
  v_mfma_f32_16x16x32_bf16 v[152:155], a[176:179], a[152:155], v[152:155]
  ds_read_b64_tr_b16 a[172:173], v5 offset:61440
  v_mfma_f32_16x16x32_bf16 v[152:155], a[180:183], a[136:139], v[152:155]
  v_mfma_f32_16x16x32_bf16 v[148:151], a[180:183], a[132:135], v[148:151]
  ds_read_b64_tr_b16 a[174:175], v5 offset:63488
  v_mfma_f32_16x16x32_bf16 v[148:151], a[176:179], a[148:151], v[148:151]
  s_waitcnt vmcnt(34)
  s_barrier
  v_mfma_f32_16x16x32_bf16 v[144:147], a[176:179], a[144:147], v[144:147]
  ds_read_b64_tr_b16 a[176:177], v2 offset:16384
  v_mfma_f32_16x16x32_bf16 v[144:147], a[180:183], a[128:131], v[144:147]
  s_waitcnt lgkmcnt(5)
  buffer_load_dwordx4 a[240:243], v1, s[8:11], s79 offen offset:1024 sc1
  v_mfma_f32_16x16x32_bf16 v[160:163], a[160:163], a[128:131], v[160:163]
  ds_read_b64_tr_b16 a[178:179], v2 offset:18432
  v_mfma_f32_16x16x32_bf16 v[160:163], a[164:167], a[144:147], v[160:163]
  s_add_u32 s79, s79, s89
  v_mfma_f32_16x16x32_bf16 v[164:167], a[164:167], a[148:151], v[164:167]
  ds_read_b64_tr_b16 a[180:181], v2 offset:20480
  v_mfma_f32_16x16x32_bf16 v[164:167], a[160:163], a[132:135], v[164:167]
  buffer_load_dwordx4 a[228:231], v1, s[8:11], s79 offen offset:0 sc1
  v_mfma_f32_16x16x32_bf16 v[168:171], a[160:163], a[136:139], v[168:171]
  ds_read_b64_tr_b16 a[182:183], v2 offset:22528
  v_mfma_f32_16x16x32_bf16 v[168:171], a[164:167], a[152:155], v[168:171]
  v_mfma_f32_16x16x32_bf16 v[172:175], a[164:167], a[156:159], v[172:175]
  ds_read_b64_tr_b16 a[164:165], v3 offset:16384
  v_mfma_f32_16x16x32_bf16 v[172:175], a[160:163], a[140:143], v[172:175]
  s_waitcnt lgkmcnt(5)
  buffer_load_dwordx4 a[244:247], v1, s[8:11], s79 offen offset:1024 sc1
  v_mfma_f32_16x16x32_bf16 v[188:191], a[168:171], a[140:143], v[188:191]
  ds_read_b64_tr_b16 a[166:167], v3 offset:18432
  v_mfma_f32_16x16x32_bf16 v[188:191], a[172:175], a[156:159], v[188:191]
  s_add_u32 s79, s79, 131072
  v_mfma_f32_16x16x32_bf16 v[184:187], a[172:175], a[152:155], v[184:187]
  ds_read_b64_tr_b16 a[160:161], v3 offset:20480
  v_mfma_f32_16x16x32_bf16 v[184:187], a[168:171], a[136:139], v[184:187]
  buffer_load_dwordx4 a[232:235], v1, s[8:11], s79 offen offset:0 sc1
  ds_read_b128 v[192:195], v44 offset:0
  v_mfma_f32_16x16x32_bf16 v[180:183], a[168:171], a[132:135], v[180:183]
  ds_read_b64_tr_b16 a[162:163], v3 offset:22528
  v_mfma_f32_16x16x32_bf16 v[180:183], a[172:175], a[148:151], v[180:183]
  ds_read_b128 v[196:199], v44 offset:1024
  v_mfma_f32_16x16x32_bf16 v[176:179], a[172:175], a[144:147], v[176:179]
  ds_read_b64_tr_b16 a[172:173], v4 offset:16384
  v_mfma_f32_16x16x32_bf16 v[176:179], a[168:171], a[128:131], v[176:179]
  s_waitcnt vmcnt(7) lgkmcnt(7)
  ds_read_b128 v[200:203], v44 offset:2048
  v_mfma_f32_16x16x32_bf16 v[64:67], a[176:179], a[188:191], v[64:67]
  ds_read_b64_tr_b16 a[174:175], v4 offset:18432
  v_mfma_f32_16x16x32_bf16 v[64:67], a[180:183], a[204:207], v[64:67]
  buffer_load_dwordx4 a[248:251], v1, s[8:11], s79 offen offset:1024 sc1
  ds_read_b128 v[204:207], v44 offset:3072
  v_mfma_f32_16x16x32_bf16 v[68:71], a[180:183], a[208:211], v[68:71]
  ds_read_b64_tr_b16 a[168:169], v4 offset:20480
  s_waitcnt vmcnt(24)
  v_mfma_f32_16x16x32_bf16 v[68:71], a[176:179], a[192:195], v[68:71]
  v_add_f32 v240, v240, v241
  v_add_f32 v242, v242, v243
  v_mfma_f32_16x16x32_bf16 v[72:75], a[176:179], a[196:199], v[72:75]
  ds_read_b64_tr_b16 a[170:171], v4 offset:22528
  v_add_f32 v240, v240, v242
  v_mfma_f32_16x16x32_bf16 v[72:75], a[180:183], a[212:215], v[72:75]
  buffer_load_dwordx4 a[0:3], v1, s[8:11], s72 offen offset:0 sc1
  v_cvt_pk_bf16_f32 v240, v240, v240
  v_lshlrev_b32 v240, 16, v240
  v_mfma_f32_16x16x32_bf16 v[76:79], a[180:183], a[216:219], v[76:79]
  ds_read_b64_tr_b16 a[180:181], v5 offset:16384
  v_mfma_f32_16x16x32_bf16 v[76:79], a[176:179], a[200:203], v[76:79]
  s_waitcnt lgkmcnt(8)
  ds_write_b32 v45, v240
  v_mfma_f32_16x16x32_bf16 v[92:95], a[164:167], a[200:203], v[92:95]
  ds_read_b64_tr_b16 a[182:183], v5 offset:18432
  v_mfma_f32_16x16x32_bf16 v[92:95], a[160:163], a[216:219], v[92:95]
  buffer_load_dwordx4 a[16:19], v1, s[8:11], s72 offen offset:1024 sc1
  ds_read_b128 v[240:243], v46 offset:0
  v_mfma_f32_16x16x32_bf16 v[88:91], a[160:163], a[212:215], v[88:91]
  ds_read_b64_tr_b16 a[176:177], v5 offset:20480
  v_mfma_f32_16x16x32_bf16 v[88:91], a[164:167], a[196:199], v[88:91]
  s_add_u32 s72, s72, 131072
  ds_read_b128 v[244:247], v46 offset:64
  v_mfma_f32_16x16x32_bf16 v[84:87], a[164:167], a[192:195], v[84:87]
  ds_read_b64_tr_b16 a[178:179], v5 offset:22528
  v_mfma_f32_16x16x32_bf16 v[84:87], a[160:163], a[208:211], v[84:87]
  buffer_load_dwordx4 a[4:7], v1, s[8:11], s72 offen offset:0 sc1
  ds_read_b128 v[248:251], v46 offset:128
  v_mfma_f32_16x16x32_bf16 v[80:83], a[160:163], a[204:207], v[80:83]
  ds_read_b64_tr_b16 a[160:161], v2 offset:24576
  v_mfma_f32_16x16x32_bf16 v[80:83], a[164:167], a[188:191], v[80:83]
  s_waitcnt lgkmcnt(9)
  ds_read_b128 v[252:255], v46 offset:192
  v_mfma_f32_16x16x32_bf16 v[96:99], a[172:175], a[188:191], v[96:99]
  ds_read_b64_tr_b16 a[162:163], v2 offset:26624
  s_waitcnt lgkmcnt(13)
  v_mfma_f32_16x16x32_bf16 v[96:99], a[168:171], a[204:207], v[96:99]
  v_lshlrev_b32 v208, 16, v192
  v_and_b32 v209, 0xffff0000, v192
  v_mfma_f32_16x16x32_bf16 v[100:103], a[168:171], a[208:211], v[100:103]
  ds_read_b64_tr_b16 a[164:165], v2 offset:28672
  v_lshlrev_b32 v210, 16, v193
  v_mfma_f32_16x16x32_bf16 v[100:103], a[172:175], a[192:195], v[100:103]
  buffer_load_dwordx4 a[20:23], v1, s[8:11], s72 offen offset:1024 sc1
  v_and_b32 v211, 0xffff0000, v193
  v_lshlrev_b32 v212, 16, v194
  v_mfma_f32_16x16x32_bf16 v[104:107], a[172:175], a[196:199], v[104:107]
  ds_read_b64_tr_b16 a[166:167], v2 offset:30720
  v_and_b32 v213, 0xffff0000, v194
  v_mfma_f32_16x16x32_bf16 v[104:107], a[168:171], a[212:215], v[104:107]
  s_add_u32 s72, s72, s89
  v_lshlrev_b32 v214, 16, v195
  v_and_b32 v215, 0xffff0000, v195
  v_mfma_f32_16x16x32_bf16 v[108:111], a[168:171], a[216:219], v[108:111]
  ds_read_b64_tr_b16 a[168:169], v3 offset:24576
  v_lshlrev_b32 v216, 16, v196
  v_mfma_f32_16x16x32_bf16 v[108:111], a[172:175], a[200:203], v[108:111]
  s_waitcnt lgkmcnt(7)
  buffer_load_dwordx4 a[8:11], v1, s[8:11], s72 offen offset:0 sc1
  v_and_b32 v217, 0xffff0000, v196
  v_mfma_f32_16x16x32_bf16 v[124:127], a[180:183], a[200:203], v[124:127]
  ds_read_b64_tr_b16 a[170:171], v3 offset:26624
  v_lshlrev_b32 v218, 16, v197
  v_mfma_f32_16x16x32_bf16 v[124:127], a[176:179], a[216:219], v[124:127]
  v_and_b32 v219, 0xffff0000, v197
  v_lshlrev_b32 v220, 16, v198
  v_mfma_f32_16x16x32_bf16 v[120:123], a[176:179], a[212:215], v[120:123]
  ds_read_b64_tr_b16 a[172:173], v3 offset:28672
  v_and_b32 v221, 0xffff0000, v198
  v_mfma_f32_16x16x32_bf16 v[120:123], a[180:183], a[196:199], v[120:123]
  buffer_load_dwordx4 a[24:27], v1, s[8:11], s72 offen offset:1024 sc1
  v_lshlrev_b32 v222, 16, v199
  v_and_b32 v223, 0xffff0000, v199
  v_mfma_f32_16x16x32_bf16 v[116:119], a[180:183], a[192:195], v[116:119]
  ds_read_b64_tr_b16 a[174:175], v3 offset:30720
  v_lshlrev_b32 v224, 16, v200
  v_mfma_f32_16x16x32_bf16 v[116:119], a[176:179], a[208:211], v[116:119]
  s_add_u32 s72, s72, 131072
  v_and_b32 v225, 0xffff0000, v200
  v_lshlrev_b32 v226, 16, v201
  v_mfma_f32_16x16x32_bf16 v[112:115], a[176:179], a[204:207], v[112:115]
  ds_read_b64_tr_b16 a[176:177], v4 offset:24576
  v_and_b32 v227, 0xffff0000, v201
  v_mfma_f32_16x16x32_bf16 v[112:115], a[180:183], a[188:191], v[112:115]
  s_waitcnt lgkmcnt(5)
  buffer_load_dwordx4 a[12:15], v1, s[8:11], s72 offen offset:0 sc1
  v_lshlrev_b32 v228, 16, v202
  v_mfma_f32_16x16x32_bf16 v[128:131], a[160:163], a[188:191], v[128:131]
  ds_read_b64_tr_b16 a[178:179], v4 offset:26624
  v_and_b32 v229, 0xffff0000, v202
  v_mfma_f32_16x16x32_bf16 v[128:131], a[164:167], a[204:207], v[128:131]
  v_lshlrev_b32 v230, 16, v203
  v_and_b32 v231, 0xffff0000, v203
  v_mfma_f32_16x16x32_bf16 v[132:135], a[164:167], a[208:211], v[132:135]
  ds_read_b64_tr_b16 a[180:181], v4 offset:28672
  v_lshlrev_b32 v232, 16, v204
  v_mfma_f32_16x16x32_bf16 v[132:135], a[160:163], a[192:195], v[132:135]
  v_and_b32 v233, 0xffff0000, v204
  v_lshlrev_b32 v234, 16, v205
  v_mfma_f32_16x16x32_bf16 v[136:139], a[160:163], a[196:199], v[136:139]
  ds_read_b64_tr_b16 a[182:183], v4 offset:30720
  v_and_b32 v235, 0xffff0000, v205
  v_mfma_f32_16x16x32_bf16 v[136:139], a[164:167], a[212:215], v[136:139]
  buffer_load_dwordx4 a[28:31], v1, s[8:11], s72 offen offset:1024 sc1
  v_lshlrev_b32 v236, 16, v206
  v_and_b32 v237, 0xffff0000, v206
  v_mfma_f32_16x16x32_bf16 v[140:143], a[164:167], a[216:219], v[140:143]
  ds_read_b64_tr_b16 a[164:165], v5 offset:24576
  v_lshlrev_b32 v238, 16, v207
  v_mfma_f32_16x16x32_bf16 v[140:143], a[160:163], a[200:203], v[140:143]
  s_waitcnt lgkmcnt(5)
  s_cmp_eq_u32 s91, 2
  s_cselect_b32 s76, 4, 11
  s_lshl_b32 s68, s76, 17
  s_lshl_b32 s76, s76, 11
  s_add_u32 s76, s76, s84
  s_add_u32 m0, s45, 32768
  v_and_b32 v239, 0xffff0000, v207
  v_mfma_f32_16x16x32_bf16 v[156:159], a[168:171], a[200:203], v[156:159]
  ds_read_b64_tr_b16 a[166:167], v5 offset:26624
  v_mov_b32 v37, 0
  v_mfma_f32_16x16x32_bf16 v[156:159], a[172:175], a[216:219], v[156:159]
  buffer_load_dwordx4 v32, s[36:39], s68 offen lds
  s_waitcnt lgkmcnt(13)
  v_cvt_pk_bf16_f32 v52, v240, v241
  v_mfma_f32_16x16x32_bf16 v[152:155], a[172:175], a[212:215], v[152:155]
  ds_read_b64_tr_b16 a[160:161], v5 offset:28672
  v_and_b32 v52, v52, v50
  v_mfma_f32_16x16x32_bf16 v[152:155], a[168:171], a[196:199], v[152:155]
  s_add_u32 m0, s45, 36864
  s_add_u32 s61, s68, 65536
  v_cvt_pk_bf16_f32 v53, v242, v243
  v_mfma_f32_16x16x32_bf16 v[148:151], a[168:171], a[192:195], v[148:151]
  ds_read_b64_tr_b16 a[162:163], v5 offset:30720
  v_and_b32 v53, v53, v51
  v_mfma_f32_16x16x32_bf16 v[148:151], a[172:175], a[208:211], v[148:151]
  buffer_load_dwordx4 v32, s[36:39], s61 offen lds
  s_waitcnt vmcnt(44)
  s_barrier
  v_mfma_f32_16x16x32_bf16 v[144:147], a[172:175], a[204:207], v[144:147]
  ds_read_b64_tr_b16 a[172:173], v6 offset:32768
  v_cvt_pk_bf16_f32 v56, v244, v245
  v_mfma_f32_16x16x32_bf16 v[144:147], a[168:171], a[188:191], v[144:147]
  s_waitcnt lgkmcnt(5)
  s_cmp_eq_u32 s91, 3
  s_cselect_b32 s77, 6, 13
  s_lshl_b32 s69, s77, 17
  s_lshl_b32 s77, s77, 11
  s_add_u32 s77, s77, s84
  s_add_u32 m0, s45, 49152
  v_and_b32 v56, v56, v50
  v_mfma_f32_16x16x32_bf16 v[160:163], a[176:179], a[188:191], v[160:163]
  ds_read_b64_tr_b16 a[174:175], v6 offset:34816
  v_cvt_pk_bf16_f32 v57, v246, v247
  v_mfma_f32_16x16x32_bf16 v[160:163], a[180:183], a[204:207], v[160:163]
  buffer_load_dwordx4 v32, s[36:39], s69 offen lds
  v_and_b32 v57, v57, v51
  v_cvt_pk_bf16_f32 v58, v248, v249
  v_mfma_f32_16x16x32_bf16 v[164:167], a[180:183], a[208:211], v[164:167]
  ds_read_b64_tr_b16 a[168:169], v6 offset:36864
  v_and_b32 v58, v58, v50
  v_mfma_f32_16x16x32_bf16 v[164:167], a[176:179], a[192:195], v[164:167]
  v_cvt_pk_bf16_f32 v59, v250, v251
  v_and_b32 v59, v59, v51
  v_mfma_f32_16x16x32_bf16 v[168:171], a[176:179], a[196:199], v[168:171]
  ds_read_b64_tr_b16 a[170:171], v6 offset:38912
  v_cvt_pk_bf16_f32 v62, v252, v253
  v_mfma_f32_16x16x32_bf16 v[168:171], a[180:183], a[212:215], v[168:171]
  s_add_u32 m0, s45, 53248
  s_add_u32 s61, s69, 65536
  v_and_b32 v62, v62, v50
  v_mfma_f32_16x16x32_bf16 v[172:175], a[180:183], a[216:219], v[172:175]
  ds_read_b64_tr_b16 a[180:181], v7 offset:32768
  v_cvt_pk_bf16_f32 v63, v254, v255
  v_mfma_f32_16x16x32_bf16 v[172:175], a[176:179], a[200:203], v[172:175]
  s_waitcnt lgkmcnt(5)
  buffer_load_dwordx4 v32, s[36:39], s61 offen lds
  v_and_b32 v63, v63, v51
  v_mfma_f32_16x16x32_bf16 v[188:191], a[164:167], a[200:203], v[188:191]
  ds_read_b64_tr_b16 a[182:183], v7 offset:34816
  v_mfma_f32_16x16x32_bf16 v[188:191], a[160:163], a[216:219], v[188:191]
  v_mfma_f32_16x16x32_bf16 v[184:187], a[160:163], a[212:215], v[184:187]
  ds_read_b64_tr_b16 a[176:177], v7 offset:36864
  v_mfma_f32_16x16x32_bf16 v[184:187], a[164:167], a[196:199], v[184:187]
  buffer_load_dwordx4 a[32:35], v1, s[8:11], s73 offen offset:0 sc1
  v_mfma_f32_16x16x32_bf16 v[180:183], a[164:167], a[192:195], v[180:183]
  ds_read_b64_tr_b16 a[178:179], v7 offset:38912
  v_mfma_f32_16x16x32_bf16 v[180:183], a[160:163], a[208:211], v[180:183]
  v_mfma_f32_16x16x32_bf16 v[176:179], a[160:163], a[204:207], v[176:179]
  ds_read_b64_tr_b16 a[160:161], v8 offset:32768
  v_mfma_f32_16x16x32_bf16 v[176:179], a[164:167], a[188:191], v[176:179]
  s_waitcnt vmcnt(13) lgkmcnt(5)
  buffer_load_dwordx4 a[48:51], v1, s[8:11], s73 offen offset:1024 sc1
  v_mfma_f32_16x16x32_bf16 v[64:67], a[172:175], a[220:223], v[64:67]
  ds_read_b64_tr_b16 a[162:163], v8 offset:34816
  v_mfma_f32_16x16x32_bf16 v[64:67], a[168:171], a[236:239], v[64:67]
  s_add_u32 s73, s73, 131072
  v_mfma_f32_16x16x32_bf16 v[68:71], a[168:171], a[240:243], v[68:71]
  ds_read_b64_tr_b16 a[164:165], v8 offset:36864
  v_mfma_f32_16x16x32_bf16 v[68:71], a[172:175], a[224:227], v[68:71]
  buffer_load_dwordx4 a[36:39], v1, s[8:11], s73 offen offset:0 sc1
  v_mfma_f32_16x16x32_bf16 v[72:75], a[172:175], a[228:231], v[72:75]
  ds_read_b64_tr_b16 a[166:167], v8 offset:38912
  v_mfma_f32_16x16x32_bf16 v[72:75], a[168:171], a[244:247], v[72:75]
  v_mfma_f32_16x16x32_bf16 v[76:79], a[168:171], a[248:251], v[76:79]
  ds_read_b64_tr_b16 a[168:169], v9 offset:32768
  v_mfma_f32_16x16x32_bf16 v[76:79], a[172:175], a[232:235], v[76:79]
  s_waitcnt lgkmcnt(5)
  v_mfma_f32_16x16x32_bf16 v[92:95], a[180:183], a[232:235], v[92:95]
  ds_read_b64_tr_b16 a[170:171], v9 offset:34816
  v_mfma_f32_16x16x32_bf16 v[92:95], a[176:179], a[248:251], v[92:95]
  buffer_load_dwordx4 a[52:55], v1, s[8:11], s73 offen offset:1024 sc1
  v_mfma_f32_16x16x32_bf16 v[88:91], a[176:179], a[244:247], v[88:91]
  ds_read_b64_tr_b16 a[172:173], v9 offset:36864
  v_mfma_f32_16x16x32_bf16 v[88:91], a[180:183], a[228:231], v[88:91]
  s_add_u32 s73, s73, s89
  v_mfma_f32_16x16x32_bf16 v[84:87], a[180:183], a[224:227], v[84:87]
  ds_read_b64_tr_b16 a[174:175], v9 offset:38912
  v_mfma_f32_16x16x32_bf16 v[84:87], a[176:179], a[240:243], v[84:87]
  buffer_load_dwordx4 a[40:43], v1, s[8:11], s73 offen offset:0 sc1
  v_mfma_f32_16x16x32_bf16 v[80:83], a[176:179], a[236:239], v[80:83]
  ds_read_b64_tr_b16 a[176:177], v6 offset:49152
  v_mfma_f32_16x16x32_bf16 v[80:83], a[180:183], a[220:223], v[80:83]
  s_waitcnt lgkmcnt(5)
  v_mfma_f32_16x16x32_bf16 v[96:99], a[160:163], a[220:223], v[96:99]
  ds_read_b64_tr_b16 a[178:179], v6 offset:51200
  v_mfma_f32_16x16x32_bf16 v[96:99], a[164:167], a[236:239], v[96:99]
  buffer_load_dwordx4 a[56:59], v1, s[8:11], s73 offen offset:1024 sc1
  v_mfma_f32_16x16x32_bf16 v[100:103], a[164:167], a[240:243], v[100:103]
  ds_read_b64_tr_b16 a[180:181], v6 offset:53248
  v_mfma_f32_16x16x32_bf16 v[100:103], a[160:163], a[224:227], v[100:103]
  s_add_u32 s73, s73, 131072
  v_mfma_f32_16x16x32_bf16 v[104:107], a[160:163], a[228:231], v[104:107]
  ds_read_b64_tr_b16 a[182:183], v6 offset:55296
  v_mfma_f32_16x16x32_bf16 v[104:107], a[164:167], a[244:247], v[104:107]
  buffer_load_dwordx4 a[44:47], v1, s[8:11], s73 offen offset:0 sc1
  v_mfma_f32_16x16x32_bf16 v[108:111], a[164:167], a[248:251], v[108:111]
  ds_read_b64_tr_b16 a[164:165], v7 offset:49152
  v_mfma_f32_16x16x32_bf16 v[108:111], a[160:163], a[232:235], v[108:111]
  s_waitcnt lgkmcnt(5)
  v_mfma_f32_16x16x32_bf16 v[124:127], a[168:171], a[232:235], v[124:127]
  ds_read_b64_tr_b16 a[166:167], v7 offset:51200
  v_mfma_f32_16x16x32_bf16 v[124:127], a[172:175], a[248:251], v[124:127]
  v_mfma_f32_16x16x32_bf16 v[120:123], a[172:175], a[244:247], v[120:123]
  ds_read_b64_tr_b16 a[160:161], v7 offset:53248
  v_mfma_f32_16x16x32_bf16 v[120:123], a[168:171], a[228:231], v[120:123]
  buffer_load_dwordx4 a[60:63], v1, s[8:11], s73 offen offset:1024 sc1
  v_mfma_f32_16x16x32_bf16 v[116:119], a[168:171], a[224:227], v[116:119]
  ds_read_b64_tr_b16 a[162:163], v7 offset:55296
  v_mfma_f32_16x16x32_bf16 v[116:119], a[172:175], a[240:243], v[116:119]
  v_mfma_f32_16x16x32_bf16 v[112:115], a[172:175], a[236:239], v[112:115]
  ds_read_b64_tr_b16 a[172:173], v8 offset:49152
  v_mfma_f32_16x16x32_bf16 v[112:115], a[168:171], a[220:223], v[112:115]
  s_waitcnt vmcnt(12) lgkmcnt(5)
  buffer_load_dwordx4 a[64:67], v1, s[8:11], s74 offen offset:0 sc1
  v_mfma_f32_16x16x32_bf16 v[64:67], a[176:179], a[0:3], v[64:67]
  ds_read_b64_tr_b16 a[174:175], v8 offset:51200
  v_mfma_f32_16x16x32_bf16 v[64:67], a[180:183], a[16:19], v[64:67]
  v_mfma_f32_16x16x32_bf16 v[68:71], a[180:183], a[20:23], v[68:71]
  ds_read_b64_tr_b16 a[168:169], v8 offset:53248
  v_mfma_f32_16x16x32_bf16 v[68:71], a[176:179], a[4:7], v[68:71]
  buffer_load_dwordx4 a[80:83], v1, s[8:11], s74 offen offset:1024 sc1
  v_mfma_f32_16x16x32_bf16 v[72:75], a[176:179], a[8:11], v[72:75]
  ds_read_b64_tr_b16 a[170:171], v8 offset:55296
  v_mfma_f32_16x16x32_bf16 v[72:75], a[180:183], a[24:27], v[72:75]
  s_add_u32 s74, s74, 131072
  v_mfma_f32_16x16x32_bf16 v[76:79], a[180:183], a[28:31], v[76:79]
  ds_read_b64_tr_b16 a[180:181], v9 offset:49152
  v_mfma_f32_16x16x32_bf16 v[76:79], a[176:179], a[12:15], v[76:79]
  s_waitcnt lgkmcnt(5)
  buffer_load_dwordx4 a[68:71], v1, s[8:11], s74 offen offset:0 sc1
  v_mfma_f32_16x16x32_bf16 v[92:95], a[164:167], a[12:15], v[92:95]
  ds_read_b64_tr_b16 a[182:183], v9 offset:51200
  v_mfma_f32_16x16x32_bf16 v[92:95], a[160:163], a[28:31], v[92:95]
  v_mfma_f32_16x16x32_bf16 v[88:91], a[160:163], a[24:27], v[88:91]
  ds_read_b64_tr_b16 a[176:177], v9 offset:53248
  v_mfma_f32_16x16x32_bf16 v[88:91], a[164:167], a[8:11], v[88:91]
  v_mfma_f32_16x16x32_bf16 v[84:87], a[164:167], a[4:7], v[84:87]
  ds_read_b64_tr_b16 a[178:179], v9 offset:55296
  buffer_load_dwordx4 a[84:87], v1, s[8:11], s74 offen offset:1024 sc1
  v_mfma_f32_16x16x32_bf16 v[84:87], a[160:163], a[20:23], v[84:87]
  s_waitcnt vmcnt(12)
  s_barrier
  v_mfma_f32_16x16x32_bf16 v[80:83], a[160:163], a[16:19], v[80:83]
  ds_read_b64_tr_b16 a[160:161], v6 offset:16384
  v_mfma_f32_16x16x32_bf16 v[80:83], a[164:167], a[0:3], v[80:83]
  s_waitcnt lgkmcnt(5)
  s_add_u32 s74, s74, s89
  v_mfma_f32_16x16x32_bf16 v[96:99], a[172:175], a[0:3], v[96:99]
  ds_read_b64_tr_b16 a[162:163], v6 offset:18432
  v_mfma_f32_16x16x32_bf16 v[96:99], a[168:171], a[16:19], v[96:99]
  buffer_load_dwordx4 a[72:75], v1, s[8:11], s74 offen offset:0 sc1
  v_mfma_f32_16x16x32_bf16 v[100:103], a[168:171], a[20:23], v[100:103]
  ds_read_b64_tr_b16 a[164:165], v6 offset:20480
  v_mfma_f32_16x16x32_bf16 v[100:103], a[172:175], a[4:7], v[100:103]
  v_mfma_f32_16x16x32_bf16 v[104:107], a[172:175], a[8:11], v[104:107]
  ds_read_b64_tr_b16 a[166:167], v6 offset:22528
  v_mfma_f32_16x16x32_bf16 v[104:107], a[168:171], a[24:27], v[104:107]
  buffer_load_dwordx4 a[88:91], v1, s[8:11], s74 offen offset:1024 sc1
  v_mfma_f32_16x16x32_bf16 v[108:111], a[168:171], a[28:31], v[108:111]
  ds_read_b64_tr_b16 a[168:169], v7 offset:16384
  v_mfma_f32_16x16x32_bf16 v[108:111], a[172:175], a[12:15], v[108:111]
  s_waitcnt lgkmcnt(5)
  s_add_u32 s74, s74, 131072
  v_mfma_f32_16x16x32_bf16 v[124:127], a[180:183], a[12:15], v[124:127]
  ds_read_b64_tr_b16 a[170:171], v7 offset:18432
  v_mfma_f32_16x16x32_bf16 v[124:127], a[176:179], a[28:31], v[124:127]
  buffer_load_dwordx4 a[76:79], v1, s[8:11], s74 offen offset:0 sc1
  v_mfma_f32_16x16x32_bf16 v[120:123], a[176:179], a[24:27], v[120:123]
  ds_read_b64_tr_b16 a[172:173], v7 offset:20480
  v_mfma_f32_16x16x32_bf16 v[120:123], a[180:183], a[8:11], v[120:123]
  v_mfma_f32_16x16x32_bf16 v[116:119], a[180:183], a[4:7], v[116:119]
  ds_read_b64_tr_b16 a[174:175], v7 offset:22528
  v_mfma_f32_16x16x32_bf16 v[116:119], a[176:179], a[20:23], v[116:119]
  v_mfma_f32_16x16x32_bf16 v[112:115], a[176:179], a[16:19], v[112:115]
  ds_read_b64_tr_b16 a[176:177], v8 offset:16384
  v_mfma_f32_16x16x32_bf16 v[112:115], a[180:183], a[0:3], v[112:115]
  s_waitcnt vmcnt(7) lgkmcnt(5)
  buffer_load_dwordx4 a[92:95], v1, s[8:11], s74 offen offset:1024 sc1
  v_mfma_f32_16x16x32_bf16 v[64:67], a[160:163], a[32:35], v[64:67]
  ds_read_b64_tr_b16 a[178:179], v8 offset:18432
  v_mfma_f32_16x16x32_bf16 v[64:67], a[164:167], a[48:51], v[64:67]
  v_mfma_f32_16x16x32_bf16 v[68:71], a[164:167], a[52:55], v[68:71]
  ds_read_b64_tr_b16 a[180:181], v8 offset:20480
  v_mfma_f32_16x16x32_bf16 v[68:71], a[160:163], a[36:39], v[68:71]
  buffer_load_dwordx4 a[96:99], v1, s[8:11], s75 offen offset:0 sc1
  v_mfma_f32_16x16x32_bf16 v[72:75], a[160:163], a[40:43], v[72:75]
  ds_read_b64_tr_b16 a[182:183], v8 offset:22528
  v_mfma_f32_16x16x32_bf16 v[72:75], a[164:167], a[56:59], v[72:75]
  v_mfma_f32_16x16x32_bf16 v[76:79], a[164:167], a[60:63], v[76:79]
  ds_read_b64_tr_b16 a[164:165], v9 offset:16384
  v_mfma_f32_16x16x32_bf16 v[76:79], a[160:163], a[44:47], v[76:79]
  s_waitcnt lgkmcnt(5)
  buffer_load_dwordx4 a[112:115], v1, s[8:11], s75 offen offset:1024 sc1
  v_mfma_f32_16x16x32_bf16 v[92:95], a[168:171], a[44:47], v[92:95]
  ds_read_b64_tr_b16 a[166:167], v9 offset:18432
  v_mfma_f32_16x16x32_bf16 v[92:95], a[172:175], a[60:63], v[92:95]
  s_add_u32 s75, s75, 131072
  v_mfma_f32_16x16x32_bf16 v[88:91], a[172:175], a[56:59], v[88:91]
  ds_read_b64_tr_b16 a[160:161], v9 offset:20480
  v_mfma_f32_16x16x32_bf16 v[88:91], a[168:171], a[40:43], v[88:91]
  buffer_load_dwordx4 a[100:103], v1, s[8:11], s75 offen offset:0 sc1
  v_mfma_f32_16x16x32_bf16 v[84:87], a[168:171], a[36:39], v[84:87]
  ds_read_b64_tr_b16 a[162:163], v9 offset:22528
  v_mfma_f32_16x16x32_bf16 v[84:87], a[172:175], a[52:55], v[84:87]
  v_mfma_f32_16x16x32_bf16 v[80:83], a[172:175], a[48:51], v[80:83]
  ds_read_b64_tr_b16 a[172:173], v6 offset:0
  v_mfma_f32_16x16x32_bf16 v[80:83], a[168:171], a[32:35], v[80:83]
  s_waitcnt lgkmcnt(5)
  v_mfma_f32_16x16x32_bf16 v[96:99], a[176:179], a[32:35], v[96:99]
  ds_read_b64_tr_b16 a[174:175], v6 offset:2048
  v_mfma_f32_16x16x32_bf16 v[96:99], a[180:183], a[48:51], v[96:99]
  buffer_load_dwordx4 a[116:119], v1, s[8:11], s75 offen offset:1024 sc1
  v_mfma_f32_16x16x32_bf16 v[100:103], a[180:183], a[52:55], v[100:103]
  ds_read_b64_tr_b16 a[168:169], v6 offset:4096
  v_mfma_f32_16x16x32_bf16 v[100:103], a[176:179], a[36:39], v[100:103]
  s_add_u32 s75, s75, s89
  v_mfma_f32_16x16x32_bf16 v[104:107], a[176:179], a[40:43], v[104:107]
  ds_read_b64_tr_b16 a[170:171], v6 offset:6144
  v_mfma_f32_16x16x32_bf16 v[104:107], a[180:183], a[56:59], v[104:107]
  buffer_load_dwordx4 a[104:107], v1, s[8:11], s75 offen offset:0 sc1
  v_mfma_f32_16x16x32_bf16 v[108:111], a[180:183], a[60:63], v[108:111]
  ds_read_b64_tr_b16 a[180:181], v7 offset:0
  v_mfma_f32_16x16x32_bf16 v[108:111], a[176:179], a[44:47], v[108:111]
  s_waitcnt lgkmcnt(5)
  v_mfma_f32_16x16x32_bf16 v[124:127], a[164:167], a[44:47], v[124:127]
  ds_read_b64_tr_b16 a[182:183], v7 offset:2048
  v_mfma_f32_16x16x32_bf16 v[124:127], a[160:163], a[60:63], v[124:127]
  buffer_load_dwordx4 a[120:123], v1, s[8:11], s75 offen offset:1024 sc1
  v_mfma_f32_16x16x32_bf16 v[120:123], a[160:163], a[56:59], v[120:123]
  ds_read_b64_tr_b16 a[176:177], v7 offset:4096
  v_mfma_f32_16x16x32_bf16 v[120:123], a[164:167], a[40:43], v[120:123]
  s_add_u32 s75, s75, 131072
  v_mfma_f32_16x16x32_bf16 v[116:119], a[164:167], a[36:39], v[116:119]
  ds_read_b64_tr_b16 a[178:179], v7 offset:6144
  v_mfma_f32_16x16x32_bf16 v[116:119], a[160:163], a[52:55], v[116:119]
  buffer_load_dwordx4 a[108:111], v1, s[8:11], s75 offen offset:0 sc1
  v_mfma_f32_16x16x32_bf16 v[112:115], a[160:163], a[48:51], v[112:115]
  ds_read_b64_tr_b16 a[160:161], v8 offset:0
  v_mfma_f32_16x16x32_bf16 v[112:115], a[164:167], a[32:35], v[112:115]
  s_waitcnt vmcnt(7) lgkmcnt(5)
  v_mfma_f32_16x16x32_bf16 v[64:67], a[172:175], a[64:67], v[64:67]
  ds_read_b64_tr_b16 a[162:163], v8 offset:2048
  v_mfma_f32_16x16x32_bf16 v[64:67], a[168:171], a[80:83], v[64:67]
  v_mfma_f32_16x16x32_bf16 v[68:71], a[168:171], a[84:87], v[68:71]
  ds_read_b64_tr_b16 a[164:165], v8 offset:4096
  v_mfma_f32_16x16x32_bf16 v[68:71], a[172:175], a[68:71], v[68:71]
  buffer_load_dwordx4 a[124:127], v1, s[8:11], s75 offen offset:1024 sc1
  v_mfma_f32_16x16x32_bf16 v[72:75], a[172:175], a[72:75], v[72:75]
  ds_read_b64_tr_b16 a[166:167], v8 offset:6144
  v_mfma_f32_16x16x32_bf16 v[72:75], a[168:171], a[88:91], v[72:75]
  v_mfma_f32_16x16x32_bf16 v[76:79], a[168:171], a[92:95], v[76:79]
  ds_read_b64_tr_b16 a[168:169], v9 offset:0
  v_mfma_f32_16x16x32_bf16 v[76:79], a[172:175], a[76:79], v[76:79]
  s_waitcnt lgkmcnt(5)
  buffer_load_dwordx4 a[128:131], v1, s[8:11], s76 offen offset:0 sc1
  v_mfma_f32_16x16x32_bf16 v[92:95], a[180:183], a[76:79], v[92:95]
  ds_read_b64_tr_b16 a[170:171], v9 offset:2048
  v_mfma_f32_16x16x32_bf16 v[92:95], a[176:179], a[92:95], v[92:95]
  v_mfma_f32_16x16x32_bf16 v[88:91], a[176:179], a[88:91], v[88:91]
  ds_read_b64_tr_b16 a[172:173], v9 offset:4096
  v_mfma_f32_16x16x32_bf16 v[88:91], a[180:183], a[72:75], v[88:91]
  buffer_load_dwordx4 a[144:147], v1, s[8:11], s76 offen offset:1024 sc1
  v_mfma_f32_16x16x32_bf16 v[84:87], a[180:183], a[68:71], v[84:87]
  ds_read_b64_tr_b16 a[174:175], v9 offset:6144
  v_mfma_f32_16x16x32_bf16 v[84:87], a[176:179], a[84:87], v[84:87]
  s_add_u32 s76, s76, 131072
  v_mfma_f32_16x16x32_bf16 v[80:83], a[176:179], a[80:83], v[80:83]
  ds_read_b64_tr_b16 a[176:177], v2 offset:0
  v_mfma_f32_16x16x32_bf16 v[80:83], a[180:183], a[64:67], v[80:83]
  s_waitcnt lgkmcnt(5)
  buffer_load_dwordx4 a[132:135], v1, s[8:11], s76 offen offset:0 sc1
  v_mfma_f32_16x16x32_bf16 v[96:99], a[160:163], a[64:67], v[96:99]
  ds_read_b64_tr_b16 a[178:179], v2 offset:2048
  v_mfma_f32_16x16x32_bf16 v[96:99], a[164:167], a[80:83], v[96:99]
  v_mfma_f32_16x16x32_bf16 v[100:103], a[164:167], a[84:87], v[100:103]
  ds_read_b64_tr_b16 a[180:181], v2 offset:4096
  v_mfma_f32_16x16x32_bf16 v[100:103], a[160:163], a[68:71], v[100:103]
  v_mfma_f32_16x16x32_bf16 v[104:107], a[160:163], a[72:75], v[104:107]
  ds_read_b64_tr_b16 a[182:183], v2 offset:6144
  v_mfma_f32_16x16x32_bf16 v[104:107], a[164:167], a[88:91], v[104:107]
  buffer_load_dwordx4 a[148:151], v1, s[8:11], s76 offen offset:1024 sc1
  v_mfma_f32_16x16x32_bf16 v[108:111], a[164:167], a[92:95], v[108:111]
  ds_read_b64_tr_b16 a[164:165], v3 offset:0
  v_mfma_f32_16x16x32_bf16 v[108:111], a[160:163], a[76:79], v[108:111]
  s_waitcnt lgkmcnt(5)
  s_add_u32 s76, s76, s89
  v_mfma_f32_16x16x32_bf16 v[124:127], a[168:171], a[76:79], v[124:127]
  ds_read_b64_tr_b16 a[166:167], v3 offset:2048
  v_mfma_f32_16x16x32_bf16 v[124:127], a[172:175], a[92:95], v[124:127]
  buffer_load_dwordx4 a[136:139], v1, s[8:11], s76 offen offset:0 sc1
  v_mfma_f32_16x16x32_bf16 v[120:123], a[172:175], a[88:91], v[120:123]
  ds_read_b64_tr_b16 a[160:161], v3 offset:4096
  v_mfma_f32_16x16x32_bf16 v[120:123], a[168:171], a[72:75], v[120:123]
  v_mfma_f32_16x16x32_bf16 v[116:119], a[168:171], a[68:71], v[116:119]
  ds_read_b64_tr_b16 a[162:163], v3 offset:6144
  v_mfma_f32_16x16x32_bf16 v[116:119], a[172:175], a[84:87], v[116:119]
  buffer_load_dwordx4 a[152:155], v1, s[8:11], s76 offen offset:1024 sc1
HOP18:
  s_cbranch_execz WRET1
  v_mfma_f32_16x16x32_bf16 v[112:115], a[172:175], a[80:83], v[112:115]
  ds_read_b64_tr_b16 a[172:173], v4 offset:0
  v_mfma_f32_16x16x32_bf16 v[112:115], a[168:171], a[64:67], v[112:115]
  s_waitcnt vmcnt(6) lgkmcnt(5)
  s_add_u32 s76, s76, 131072
  v_mfma_f32_16x16x32_bf16 v[64:67], a[176:179], a[96:99], v[64:67]
  ds_read_b64_tr_b16 a[174:175], v4 offset:2048
  v_mfma_f32_16x16x32_bf16 v[64:67], a[180:183], a[112:115], v[64:67]
  buffer_load_dwordx4 a[140:143], v1, s[8:11], s76 offen offset:0 sc1
  v_mfma_f32_16x16x32_bf16 v[68:71], a[180:183], a[116:119], v[68:71]
  ds_read_b64_tr_b16 a[168:169], v4 offset:4096
  v_mfma_f32_16x16x32_bf16 v[68:71], a[176:179], a[100:103], v[68:71]
  v_mfma_f32_16x16x32_bf16 v[72:75], a[176:179], a[104:107], v[72:75]
  ds_read_b64_tr_b16 a[170:171], v4 offset:6144
  v_mfma_f32_16x16x32_bf16 v[72:75], a[180:183], a[120:123], v[72:75]
  v_mfma_f32_16x16x32_bf16 v[76:79], a[180:183], a[124:127], v[76:79]
  ds_read_b64_tr_b16 a[180:181], v5 offset:0
  v_mfma_f32_16x16x32_bf16 v[76:79], a[176:179], a[108:111], v[76:79]
  s_waitcnt lgkmcnt(5)
  buffer_load_dwordx4 a[156:159], v1, s[8:11], s76 offen offset:1024 sc1
  v_mfma_f32_16x16x32_bf16 v[92:95], a[164:167], a[108:111], v[92:95]
  ds_read_b64_tr_b16 a[182:183], v5 offset:2048
  v_mfma_f32_16x16x32_bf16 v[92:95], a[160:163], a[124:127], v[92:95]
  v_mfma_f32_16x16x32_bf16 v[88:91], a[160:163], a[120:123], v[88:91]
  ds_read_b64_tr_b16 a[176:177], v5 offset:4096
  v_mfma_f32_16x16x32_bf16 v[88:91], a[164:167], a[104:107], v[88:91]
  buffer_load_dwordx4 a[188:191], v1, s[8:11], s77 offen offset:0 sc1
  v_mfma_f32_16x16x32_bf16 v[84:87], a[164:167], a[100:103], v[84:87]
  ds_read_b64_tr_b16 a[178:179], v5 offset:6144
  v_mfma_f32_16x16x32_bf16 v[84:87], a[160:163], a[116:119], v[84:87]
  v_mfma_f32_16x16x32_bf16 v[80:83], a[160:163], a[112:115], v[80:83]
  ds_read_b64_tr_b16 a[160:161], v2 offset:32768
  v_mfma_f32_16x16x32_bf16 v[80:83], a[164:167], a[96:99], v[80:83]
  s_waitcnt lgkmcnt(5)
  buffer_load_dwordx4 a[204:207], v1, s[8:11], s77 offen offset:1024 sc1
  v_mfma_f32_16x16x32_bf16 v[96:99], a[172:175], a[96:99], v[96:99]
  ds_read_b64_tr_b16 a[162:163], v2 offset:34816
  v_mfma_f32_16x16x32_bf16 v[96:99], a[168:171], a[112:115], v[96:99]
  s_add_u32 s77, s77, 131072
  v_mfma_f32_16x16x32_bf16 v[100:103], a[168:171], a[116:119], v[100:103]
  ds_read_b64_tr_b16 a[164:165], v2 offset:36864
  v_mfma_f32_16x16x32_bf16 v[100:103], a[172:175], a[100:103], v[100:103]
  buffer_load_dwordx4 a[192:195], v1, s[8:11], s77 offen offset:0 sc1
  v_mfma_f32_16x16x32_bf16 v[104:107], a[172:175], a[104:107], v[104:107]
  ds_read_b64_tr_b16 a[166:167], v2 offset:38912
  v_mfma_f32_16x16x32_bf16 v[104:107], a[168:171], a[120:123], v[104:107]
  v_mfma_f32_16x16x32_bf16 v[108:111], a[168:171], a[124:127], v[108:111]
  ds_read_b64_tr_b16 a[168:169], v3 offset:32768
  v_mfma_f32_16x16x32_bf16 v[108:111], a[172:175], a[108:111], v[108:111]
  s_waitcnt lgkmcnt(5)
  v_mfma_f32_16x16x32_bf16 v[124:127], a[180:183], a[108:111], v[124:127]
  ds_read_b64_tr_b16 a[170:171], v3 offset:34816
  v_mfma_f32_16x16x32_bf16 v[124:127], a[176:179], a[124:127], v[124:127]
  buffer_load_dwordx4 a[208:211], v1, s[8:11], s77 offen offset:1024 sc1
  v_mfma_f32_16x16x32_bf16 v[120:123], a[176:179], a[120:123], v[120:123]
  ds_read_b64_tr_b16 a[172:173], v3 offset:36864
  v_mfma_f32_16x16x32_bf16 v[120:123], a[180:183], a[104:107], v[120:123]
  s_add_u32 s77, s77, s89
  v_mfma_f32_16x16x32_bf16 v[116:119], a[180:183], a[100:103], v[116:119]
  ds_read_b64_tr_b16 a[174:175], v3 offset:38912
  v_mfma_f32_16x16x32_bf16 v[116:119], a[176:179], a[116:119], v[116:119]
  buffer_load_dwordx4 a[196:199], v1, s[8:11], s77 offen offset:0 sc1
  v_mfma_f32_16x16x32_bf16 v[112:115], a[176:179], a[112:115], v[112:115]
  ds_read_b64_tr_b16 a[176:177], v4 offset:32768
  v_mfma_f32_16x16x32_bf16 v[112:115], a[180:183], a[96:99], v[112:115]
  s_waitcnt vmcnt(5) lgkmcnt(5)
  v_mfma_f32_16x16x32_bf16 v[64:67], a[160:163], a[128:131], v[64:67]
  ds_read_b64_tr_b16 a[178:179], v4 offset:34816
  v_mfma_f32_16x16x32_bf16 v[64:67], a[164:167], a[144:147], v[64:67]
  buffer_load_dwordx4 a[212:215], v1, s[8:11], s77 offen offset:1024 sc1
  v_mfma_f32_16x16x32_bf16 v[68:71], a[164:167], a[148:151], v[68:71]
  ds_read_b64_tr_b16 a[180:181], v4 offset:36864
  v_mfma_f32_16x16x32_bf16 v[68:71], a[160:163], a[132:135], v[68:71]
  s_add_u32 s77, s77, 131072
  v_mfma_f32_16x16x32_bf16 v[72:75], a[160:163], a[136:139], v[72:75]
  ds_read_b64_tr_b16 a[182:183], v4 offset:38912
  v_mfma_f32_16x16x32_bf16 v[72:75], a[164:167], a[152:155], v[72:75]
  buffer_load_dwordx4 a[200:203], v1, s[8:11], s77 offen offset:0 sc1
  v_mfma_f32_16x16x32_bf16 v[76:79], a[164:167], a[156:159], v[76:79]
  ds_read_b64_tr_b16 a[164:165], v5 offset:32768
  v_mfma_f32_16x16x32_bf16 v[76:79], a[160:163], a[140:143], v[76:79]
  s_waitcnt lgkmcnt(5)
  v_mfma_f32_16x16x32_bf16 v[92:95], a[168:171], a[140:143], v[92:95]
  ds_read_b64_tr_b16 a[166:167], v5 offset:34816
  v_mfma_f32_16x16x32_bf16 v[92:95], a[172:175], a[156:159], v[92:95]
  v_mfma_f32_16x16x32_bf16 v[88:91], a[172:175], a[152:155], v[88:91]
  ds_read_b64_tr_b16 a[160:161], v5 offset:36864
  v_mfma_f32_16x16x32_bf16 v[88:91], a[168:171], a[136:139], v[88:91]
  buffer_load_dwordx4 a[216:219], v1, s[8:11], s77 offen offset:1024 sc1
  v_mfma_f32_16x16x32_bf16 v[84:87], a[168:171], a[132:135], v[84:87]
  ds_read_b64_tr_b16 a[162:163], v5 offset:38912
  v_mfma_f32_16x16x32_bf16 v[84:87], a[172:175], a[148:151], v[84:87]
  s_add_u32 m0, s45, 8192
  v_mfma_f32_16x16x32_bf16 v[80:83], a[172:175], a[144:147], v[80:83]
  ds_read_b64_tr_b16 a[172:173], v2 offset:49152
  v_mfma_f32_16x16x32_bf16 v[80:83], a[168:171], a[128:131], v[80:83]
  s_waitcnt lgkmcnt(5)
  buffer_load_dwordx4 v33, s[36:39], s67 offen lds
  v_mfma_f32_16x16x32_bf16 v[96:99], a[176:179], a[128:131], v[96:99]
  ds_read_b64_tr_b16 a[174:175], v2 offset:51200
  v_mfma_f32_16x16x32_bf16 v[96:99], a[180:183], a[144:147], v[96:99]
  s_add_u32 m0, s45, 12288
  s_add_u32 s61, s67, 65536
  v_mfma_f32_16x16x32_bf16 v[100:103], a[180:183], a[148:151], v[100:103]
  ds_read_b64_tr_b16 a[168:169], v2 offset:53248
  v_mfma_f32_16x16x32_bf16 v[100:103], a[176:179], a[132:135], v[100:103]
  buffer_load_dwordx4 v33, s[36:39], s61 offen lds
  v_mfma_f32_16x16x32_bf16 v[104:107], a[176:179], a[136:139], v[104:107]
  ds_read_b64_tr_b16 a[170:171], v2 offset:55296
  v_mfma_f32_16x16x32_bf16 v[104:107], a[180:183], a[152:155], v[104:107]
  s_add_u32 m0, s45, 40960
  v_mfma_f32_16x16x32_bf16 v[108:111], a[180:183], a[156:159], v[108:111]
  ds_read_b64_tr_b16 a[180:181], v3 offset:49152
  v_mfma_f32_16x16x32_bf16 v[108:111], a[176:179], a[140:143], v[108:111]
  s_waitcnt lgkmcnt(5)
  buffer_load_dwordx4 v33, s[36:39], s68 offen lds
  v_mfma_f32_16x16x32_bf16 v[124:127], a[164:167], a[140:143], v[124:127]
  ds_read_b64_tr_b16 a[182:183], v3 offset:51200
  v_mfma_f32_16x16x32_bf16 v[124:127], a[160:163], a[156:159], v[124:127]
  v_mfma_f32_16x16x32_bf16 v[120:123], a[160:163], a[152:155], v[120:123]
  ds_read_b64_tr_b16 a[176:177], v3 offset:53248
  v_mfma_f32_16x16x32_bf16 v[120:123], a[164:167], a[136:139], v[120:123]
  s_add_u32 m0, s45, 45056
  s_add_u32 s61, s68, 65536
  v_mfma_f32_16x16x32_bf16 v[116:119], a[164:167], a[132:135], v[116:119]
  ds_read_b64_tr_b16 a[178:179], v3 offset:55296
  v_mfma_f32_16x16x32_bf16 v[116:119], a[160:163], a[148:151], v[116:119]
  buffer_load_dwordx4 v33, s[36:39], s61 offen lds
  v_mfma_f32_16x16x32_bf16 v[112:115], a[160:163], a[144:147], v[112:115]
  ds_read_b64_tr_b16 a[160:161], v4 offset:49152
  v_mfma_f32_16x16x32_bf16 v[112:115], a[164:167], a[128:131], v[112:115]
  s_waitcnt vmcnt(4) lgkmcnt(5)
  s_add_u32 m0, s45, 57344
  v_mfma_f32_16x16x32_bf16 v[64:67], a[172:175], a[188:191], v[64:67]
  ds_read_b64_tr_b16 a[162:163], v4 offset:51200
  v_mfma_f32_16x16x32_bf16 v[64:67], a[168:171], a[204:207], v[64:67]
  buffer_load_dwordx4 v33, s[36:39], s69 offen lds
  v_mfma_f32_16x16x32_bf16 v[68:71], a[168:171], a[208:211], v[68:71]
  ds_read_b64_tr_b16 a[164:165], v4 offset:53248
  v_mfma_f32_16x16x32_bf16 v[68:71], a[172:175], a[192:195], v[68:71]
  s_add_u32 m0, s45, 61440
  s_add_u32 s61, s69, 65536
  v_mfma_f32_16x16x32_bf16 v[72:75], a[172:175], a[196:199], v[72:75]
  ds_read_b64_tr_b16 a[166:167], v4 offset:55296
  v_mfma_f32_16x16x32_bf16 v[72:75], a[168:171], a[212:215], v[72:75]
  buffer_load_dwordx4 v33, s[36:39], s61 offen lds
  v_mfma_f32_16x16x32_bf16 v[76:79], a[168:171], a[216:219], v[76:79]
  ds_read_b64_tr_b16 a[168:169], v5 offset:49152
  v_mfma_f32_16x16x32_bf16 v[76:79], a[172:175], a[200:203], v[76:79]
  s_waitcnt lgkmcnt(5)
  v_mfma_f32_16x16x32_bf16 v[92:95], a[180:183], a[200:203], v[92:95]
  ds_read_b64_tr_b16 a[170:171], v5 offset:51200
  v_mfma_f32_16x16x32_bf16 v[92:95], a[176:179], a[216:219], v[92:95]
  v_mfma_f32_16x16x32_bf16 v[88:91], a[176:179], a[212:215], v[88:91]
  ds_read_b64_tr_b16 a[172:173], v5 offset:53248
  v_cvt_pk_bf16_f32 v72, v72, v73
  v_mfma_f32_16x16x32_bf16 v[88:91], a[180:183], a[196:199], v[88:91]
  v_cvt_pk_bf16_f32 v73, v74, v75
  v_cvt_pk_bf16_f32 v76, v76, v77
  v_mfma_f32_16x16x32_bf16 v[84:87], a[180:183], a[192:195], v[84:87]
  ds_read_b64_tr_b16 a[174:175], v5 offset:55296
  v_cvt_pk_bf16_f32 v77, v78, v79
  v_mfma_f32_16x16x32_bf16 v[84:87], a[176:179], a[208:211], v[84:87]
  v_cvt_pk_bf16_f32 v64, v64, v65
  v_cvt_pk_bf16_f32 v65, v66, v67
  v_mfma_f32_16x16x32_bf16 v[80:83], a[176:179], a[204:207], v[80:83]
  v_cvt_pk_bf16_f32 v68, v68, v69
  v_cvt_pk_bf16_f32 v69, v70, v71
  v_mfma_f32_16x16x32_bf16 v[80:83], a[180:183], a[188:191], v[80:83]
  s_waitcnt lgkmcnt(4)
  v_mfma_f32_16x16x32_bf16 v[96:99], a[160:163], a[188:191], v[96:99]
  v_mfma_f32_16x16x32_bf16 v[96:99], a[164:167], a[204:207], v[96:99]
  s_waitcnt vmcnt(0)
  s_barrier
  v_mfma_f32_16x16x32_bf16 v[100:103], a[164:167], a[208:211], v[100:103]
  ds_read_b64_tr_b16 v[16:17], v6 offset:40960
  v_cvt_pk_bf16_f32 v74, v88, v89
  v_mfma_f32_16x16x32_bf16 v[100:103], a[160:163], a[192:195], v[100:103]
  ds_read_b64_tr_b16 v[18:19], v6 offset:43008
  v_cvt_pk_bf16_f32 v75, v90, v91
  v_mfma_f32_16x16x32_bf16 v[104:107], a[160:163], a[196:199], v[104:107]
  ds_read_b64_tr_b16 v[20:21], v6 offset:45056
  v_mfma_f32_16x16x32_bf16 v[104:107], a[164:167], a[212:215], v[104:107]
  ds_read_b64_tr_b16 v[22:23], v6 offset:47104
  v_mfma_f32_16x16x32_bf16 v[108:111], a[164:167], a[216:219], v[108:111]
  ds_read_b64_tr_b16 v[24:25], v7 offset:40960
  s_add_u32 s87, s86, 0
  buffer_store_dwordx4 v[72:75], v1, s[8:11], s87 offen offset:0 sc1
  v_mfma_f32_16x16x32_bf16 v[108:111], a[160:163], a[200:203], v[108:111]
  s_waitcnt lgkmcnt(5)
  ds_read_b64_tr_b16 v[26:27], v7 offset:43008
  v_mfma_f32_16x16x32_bf16 v[124:127], a[168:171], a[200:203], v[124:127]
  ds_read_b64_tr_b16 v[28:29], v7 offset:45056
  v_cvt_pk_bf16_f32 v78, v92, v93
  v_mfma_f32_16x16x32_bf16 v[124:127], a[172:175], a[216:219], v[124:127]
  ds_read_b64_tr_b16 v[30:31], v7 offset:47104
  v_cvt_pk_bf16_f32 v79, v94, v95
  v_mfma_f32_16x16x32_bf16 v[120:123], a[172:175], a[212:215], v[120:123]
  ds_read_b64_tr_b16 a[176:177], v8 offset:40960
  v_mfma_f32_16x16x32_bf16 v[120:123], a[168:171], a[196:199], v[120:123]
  ds_read_b64_tr_b16 a[178:179], v8 offset:43008
  v_mfma_f32_16x16x32_bf16 v[116:119], a[168:171], a[192:195], v[116:119]
  ds_read_b64_tr_b16 a[180:181], v8 offset:45056
  s_add_u32 s87, s86, 0
  buffer_store_dwordx4 v[76:79], v1, s[8:11], s87 offen offset:2048 sc1
  v_mfma_f32_16x16x32_bf16 v[116:119], a[172:175], a[208:211], v[116:119]
  ds_read_b64_tr_b16 a[182:183], v8 offset:47104
  v_mfma_f32_16x16x32_bf16 v[112:115], a[172:175], a[204:207], v[112:115]
  ds_read_b64_tr_b16 a[164:165], v9 offset:40960
  v_cvt_pk_bf16_f32 v66, v80, v81
  v_mfma_f32_16x16x32_bf16 v[112:115], a[168:171], a[188:191], v[112:115]
  s_waitcnt lgkmcnt(9)
  ds_read_b64_tr_b16 a[166:167], v9 offset:43008
  v_mfma_f32_16x16x32_bf16 v[136:139], v[16:19], a[228:231], v[136:139]
  ds_read_b64_tr_b16 a[160:161], v9 offset:45056
  v_cvt_pk_bf16_f32 v67, v82, v83
  v_mfma_f32_16x16x32_bf16 v[136:139], v[20:23], a[244:247], v[136:139]
  ds_read_b64_tr_b16 a[162:163], v9 offset:47104
  v_mfma_f32_16x16x32_bf16 v[140:143], v[20:23], a[248:251], v[140:143]
  ds_read_b64_tr_b16 a[172:173], v6 offset:57344
  v_mfma_f32_16x16x32_bf16 v[140:143], v[16:19], a[232:235], v[140:143]
  s_waitcnt lgkmcnt(9)
  ds_read_b64_tr_b16 a[174:175], v6 offset:59392
  s_add_u32 s87, s86, 4096
  buffer_store_dwordx4 v[64:67], v1, s[8:11], s87 offen offset:0 sc1
  v_mfma_f32_16x16x32_bf16 v[156:159], v[24:27], a[232:235], v[156:159]
  ds_read_b64_tr_b16 a[168:169], v6 offset:61440
  v_mfma_f32_16x16x32_bf16 v[156:159], v[28:31], a[248:251], v[156:159]
  ds_read_b64_tr_b16 a[170:171], v6 offset:63488
  v_cvt_pk_bf16_f32 v70, v84, v85
  v_mfma_f32_16x16x32_bf16 v[152:155], v[28:31], a[244:247], v[152:155]
  ds_read_b64_tr_b16 v[20:21], v7 offset:57344
  v_cvt_pk_bf16_f32 v71, v86, v87
  v_mfma_f32_16x16x32_bf16 v[152:155], v[24:27], a[228:231], v[152:155]
  s_waitcnt lgkmcnt(9)
  ds_read_b64_tr_b16 v[22:23], v7 offset:59392
  v_mfma_f32_16x16x32_bf16 v[168:171], a[176:179], a[228:231], v[168:171]
  ds_read_b64_tr_b16 v[16:17], v7 offset:61440
  v_mfma_f32_16x16x32_bf16 v[168:171], a[180:183], a[244:247], v[168:171]
  ds_read_b64_tr_b16 v[18:19], v7 offset:63488
  s_add_u32 s87, s86, 4096
  buffer_store_dwordx4 v[68:71], v1, s[8:11], s87 offen offset:2048 sc1
  v_mfma_f32_16x16x32_bf16 v[172:175], a[180:183], a[248:251], v[172:175]
  ds_read_b64_tr_b16 v[28:29], v8 offset:57344
  v_mfma_f32_16x16x32_bf16 v[172:175], a[176:179], a[232:235], v[172:175]
  s_waitcnt lgkmcnt(9)
  ds_read_b64_tr_b16 v[30:31], v8 offset:59392
  v_mfma_f32_16x16x32_bf16 v[188:191], a[164:167], a[232:235], v[188:191]
  ds_read_b64_tr_b16 v[24:25], v8 offset:61440
  v_cvt_pk_bf16_f32 v104, v104, v105
  v_mfma_f32_16x16x32_bf16 v[188:191], a[160:163], a[248:251], v[188:191]
  ds_read_b64_tr_b16 v[26:27], v8 offset:63488
  v_cvt_pk_bf16_f32 v105, v106, v107
  v_mfma_f32_16x16x32_bf16 v[184:187], a[160:163], a[244:247], v[184:187]
  ds_read_b64_tr_b16 a[180:181], v9 offset:57344
  v_cvt_pk_bf16_f32 v108, v108, v109
  v_mfma_f32_16x16x32_bf16 v[184:187], a[164:167], a[228:231], v[184:187]
  s_waitcnt lgkmcnt(9)
  ds_read_b64_tr_b16 a[182:183], v9 offset:59392
  v_mfma_f32_16x16x32_bf16 v[136:139], a[172:175], a[8:11], v[136:139]
  ds_read_b64_tr_b16 a[176:177], v9 offset:61440
  v_cvt_pk_bf16_f32 v109, v110, v111
  v_mfma_f32_16x16x32_bf16 v[136:139], a[168:171], a[24:27], v[136:139]
  ds_read_b64_tr_b16 a[178:179], v9 offset:63488
  v_cvt_pk_bf16_f32 v96, v96, v97
  v_mfma_f32_16x16x32_bf16 v[140:143], a[168:171], a[28:31], v[140:143]
  ds_read_b64_tr_b16 a[160:161], v6 offset:24576
  v_cvt_pk_bf16_f32 v97, v98, v99
  v_mfma_f32_16x16x32_bf16 v[140:143], a[172:175], a[12:15], v[140:143]
  s_waitcnt lgkmcnt(9)
  ds_read_b64_tr_b16 a[162:163], v6 offset:26624
  v_mfma_f32_16x16x32_bf16 v[156:159], v[20:23], a[12:15], v[156:159]
  ds_read_b64_tr_b16 a[164:165], v6 offset:28672
  v_cvt_pk_bf16_f32 v100, v100, v101
  v_mfma_f32_16x16x32_bf16 v[156:159], v[16:19], a[28:31], v[156:159]
  ds_read_b64_tr_b16 a[166:167], v6 offset:30720
  v_cvt_pk_bf16_f32 v101, v102, v103
  v_mfma_f32_16x16x32_bf16 v[152:155], v[16:19], a[24:27], v[152:155]
  ds_read_b64_tr_b16 a[168:169], v7 offset:24576
  v_cvt_pk_bf16_f32 v106, v120, v121
  v_mfma_f32_16x16x32_bf16 v[152:155], v[20:23], a[8:11], v[152:155]
  s_waitcnt lgkmcnt(9)
  ds_read_b64_tr_b16 a[170:171], v7 offset:26624
  v_mfma_f32_16x16x32_bf16 v[168:171], v[28:31], a[8:11], v[168:171]
  ds_read_b64_tr_b16 a[172:173], v7 offset:28672
  v_cvt_pk_bf16_f32 v107, v122, v123
  v_mfma_f32_16x16x32_bf16 v[168:171], v[24:27], a[24:27], v[168:171]
  ds_read_b64_tr_b16 a[174:175], v7 offset:30720
  v_mfma_f32_16x16x32_bf16 v[172:175], v[24:27], a[28:31], v[172:175]
  ds_read_b64_tr_b16 v[16:17], v8 offset:24576
  v_mfma_f32_16x16x32_bf16 v[172:175], v[28:31], a[12:15], v[172:175]
  s_waitcnt lgkmcnt(9)
  ds_read_b64_tr_b16 v[18:19], v8 offset:26624
  s_add_u32 s87, s86, 0
  buffer_store_dwordx4 v[104:107], v1, s[8:11], s87 offen offset:1024 sc1
  v_mfma_f32_16x16x32_bf16 v[188:191], a[180:183], a[12:15], v[188:191]
  ds_read_b64_tr_b16 v[20:21], v8 offset:28672
  v_mfma_f32_16x16x32_bf16 v[188:191], a[176:179], a[28:31], v[188:191]
  ds_read_b64_tr_b16 v[22:23], v8 offset:30720
  v_cvt_pk_bf16_f32 v110, v124, v125
  v_mfma_f32_16x16x32_bf16 v[184:187], a[176:179], a[24:27], v[184:187]
  ds_read_b64_tr_b16 v[24:25], v9 offset:24576
  v_cvt_pk_bf16_f32 v111, v126, v127
  v_mfma_f32_16x16x32_bf16 v[184:187], a[180:183], a[8:11], v[184:187]
  s_waitcnt lgkmcnt(9)
  ds_read_b64_tr_b16 v[26:27], v9 offset:26624
  v_mfma_f32_16x16x32_bf16 v[136:139], a[160:163], a[40:43], v[136:139]
  ds_read_b64_tr_b16 v[28:29], v9 offset:28672
  v_mfma_f32_16x16x32_bf16 v[136:139], a[164:167], a[56:59], v[136:139]
  ds_read_b64_tr_b16 v[30:31], v9 offset:30720
  s_add_u32 s87, s86, 0
  buffer_store_dwordx4 v[108:111], v1, s[8:11], s87 offen offset:3072 sc1
  v_mfma_f32_16x16x32_bf16 v[140:143], a[164:167], a[60:63], v[140:143]
  ds_read_b64_tr_b16 a[176:177], v6 offset:8192
  v_mfma_f32_16x16x32_bf16 v[140:143], a[160:163], a[44:47], v[140:143]
  s_waitcnt lgkmcnt(9)
  ds_read_b64_tr_b16 a[178:179], v6 offset:10240
  v_mfma_f32_16x16x32_bf16 v[156:159], a[168:171], a[44:47], v[156:159]
  ds_read_b64_tr_b16 a[180:181], v6 offset:12288
  v_cvt_pk_bf16_f32 v98, v112, v113
  v_mfma_f32_16x16x32_bf16 v[156:159], a[172:175], a[60:63], v[156:159]
  ds_read_b64_tr_b16 a[182:183], v6 offset:14336
  v_cvt_pk_bf16_f32 v99, v114, v115
  v_mfma_f32_16x16x32_bf16 v[152:155], a[172:175], a[56:59], v[152:155]
  ds_read_b64_tr_b16 a[164:165], v7 offset:8192
  v_mfma_f32_16x16x32_bf16 v[152:155], a[168:171], a[40:43], v[152:155]
  s_waitcnt lgkmcnt(9)
  ds_read_b64_tr_b16 a[166:167], v7 offset:10240
  v_mfma_f32_16x16x32_bf16 v[168:171], v[16:19], a[40:43], v[168:171]
  ds_read_b64_tr_b16 a[160:161], v7 offset:12288
  s_add_u32 s87, s86, 4096
  buffer_store_dwordx4 v[96:99], v1, s[8:11], s87 offen offset:1024 sc1
  v_mfma_f32_16x16x32_bf16 v[168:171], v[20:23], a[56:59], v[168:171]
  ds_read_b64_tr_b16 a[162:163], v7 offset:14336
  v_mfma_f32_16x16x32_bf16 v[172:175], v[20:23], a[60:63], v[172:175]
  ds_read_b64_tr_b16 a[172:173], v8 offset:8192
  v_cvt_pk_bf16_f32 v102, v116, v117
  v_mfma_f32_16x16x32_bf16 v[172:175], v[16:19], a[44:47], v[172:175]
  s_waitcnt lgkmcnt(9)
  ds_read_b64_tr_b16 a[174:175], v8 offset:10240
  v_mfma_f32_16x16x32_bf16 v[188:191], v[24:27], a[44:47], v[188:191]
  ds_read_b64_tr_b16 a[168:169], v8 offset:12288
  v_cvt_pk_bf16_f32 v103, v118, v119
  v_mfma_f32_16x16x32_bf16 v[188:191], v[28:31], a[60:63], v[188:191]
  ds_read_b64_tr_b16 a[170:171], v8 offset:14336
  v_mfma_f32_16x16x32_bf16 v[184:187], v[28:31], a[56:59], v[184:187]
  ds_read_b64_tr_b16 v[20:21], v9 offset:8192
  v_mfma_f32_16x16x32_bf16 v[184:187], v[24:27], a[40:43], v[184:187]
  s_waitcnt lgkmcnt(9)
  ds_read_b64_tr_b16 v[22:23], v9 offset:10240
  s_add_u32 s87, s86, 4096
  buffer_store_dwordx4 v[100:103], v1, s[8:11], s87 offen offset:3072 sc1
  v_mfma_f32_16x16x32_bf16 v[136:139], a[176:179], a[72:75], v[136:139]
  ds_read_b64_tr_b16 v[16:17], v9 offset:12288
  v_mfma_f32_16x16x32_bf16 v[136:139], a[180:183], a[88:91], v[136:139]
  ds_read_b64_tr_b16 v[18:19], v9 offset:14336
  v_mfma_f32_16x16x32_bf16 v[140:143], a[180:183], a[92:95], v[140:143]
  ds_read_b64_tr_b16 v[28:29], v2 offset:8192
  v_mfma_f32_16x16x32_bf16 v[140:143], a[176:179], a[76:79], v[140:143]
  s_waitcnt lgkmcnt(9)
  ds_read_b64_tr_b16 v[30:31], v2 offset:10240
  v_mfma_f32_16x16x32_bf16 v[156:159], a[164:167], a[76:79], v[156:159]
  ds_read_b64_tr_b16 v[24:25], v2 offset:12288
  v_mfma_f32_16x16x32_bf16 v[156:159], a[160:163], a[92:95], v[156:159]
  ds_read_b64_tr_b16 v[26:27], v2 offset:14336
  v_mfma_f32_16x16x32_bf16 v[152:155], a[160:163], a[88:91], v[152:155]
  ds_read_b64_tr_b16 a[180:181], v3 offset:8192
  v_mfma_f32_16x16x32_bf16 v[152:155], a[164:167], a[72:75], v[152:155]
  s_waitcnt lgkmcnt(9)
  ds_read_b64_tr_b16 a[182:183], v3 offset:10240
  v_mfma_f32_16x16x32_bf16 v[168:171], a[172:175], a[72:75], v[168:171]
  ds_read_b64_tr_b16 a[176:177], v3 offset:12288
  v_mfma_f32_16x16x32_bf16 v[168:171], a[168:171], a[88:91], v[168:171]
  ds_read_b64_tr_b16 a[178:179], v3 offset:14336
  v_mfma_f32_16x16x32_bf16 v[172:175], a[168:171], a[92:95], v[172:175]
  ds_read_b64_tr_b16 a[160:161], v4 offset:8192
  v_mfma_f32_16x16x32_bf16 v[172:175], a[172:175], a[76:79], v[172:175]
  s_waitcnt lgkmcnt(9)
  ds_read_b64_tr_b16 a[162:163], v4 offset:10240
  v_mfma_f32_16x16x32_bf16 v[188:191], v[20:23], a[76:79], v[188:191]
  ds_read_b64_tr_b16 a[164:165], v4 offset:12288
  v_mfma_f32_16x16x32_bf16 v[188:191], v[16:19], a[92:95], v[188:191]
  ds_read_b64_tr_b16 a[166:167], v4 offset:14336
  v_mfma_f32_16x16x32_bf16 v[184:187], v[16:19], a[88:91], v[184:187]
  ds_read_b64_tr_b16 a[168:169], v5 offset:8192
  v_mfma_f32_16x16x32_bf16 v[184:187], v[20:23], a[72:75], v[184:187]
  s_waitcnt lgkmcnt(9)
  ds_read_b64_tr_b16 a[170:171], v5 offset:10240
  v_mfma_f32_16x16x32_bf16 v[136:139], v[28:31], a[104:107], v[136:139]
  ds_read_b64_tr_b16 a[172:173], v5 offset:12288
  v_mfma_f32_16x16x32_bf16 v[136:139], v[24:27], a[120:123], v[136:139]
  ds_read_b64_tr_b16 a[174:175], v5 offset:14336
  v_mfma_f32_16x16x32_bf16 v[140:143], v[24:27], a[124:127], v[140:143]
  ds_read_b64_tr_b16 v[16:17], v2 offset:40960
  v_mfma_f32_16x16x32_bf16 v[140:143], v[28:31], a[108:111], v[140:143]
  s_waitcnt lgkmcnt(9)
  ds_read_b64_tr_b16 v[18:19], v2 offset:43008
  v_mfma_f32_16x16x32_bf16 v[156:159], a[180:183], a[108:111], v[156:159]
  ds_read_b64_tr_b16 v[20:21], v2 offset:45056
  v_mfma_f32_16x16x32_bf16 v[156:159], a[176:179], a[124:127], v[156:159]
  ds_read_b64_tr_b16 v[22:23], v2 offset:47104
  v_mfma_f32_16x16x32_bf16 v[152:155], a[176:179], a[120:123], v[152:155]
  ds_read_b64_tr_b16 v[24:25], v3 offset:40960
  v_mfma_f32_16x16x32_bf16 v[152:155], a[180:183], a[104:107], v[152:155]
  s_waitcnt lgkmcnt(9)
  ds_read_b64_tr_b16 v[26:27], v3 offset:43008
  v_mfma_f32_16x16x32_bf16 v[168:171], a[160:163], a[104:107], v[168:171]
  ds_read_b64_tr_b16 v[28:29], v3 offset:45056
  v_mfma_f32_16x16x32_bf16 v[168:171], a[164:167], a[120:123], v[168:171]
  ds_read_b64_tr_b16 v[30:31], v3 offset:47104
  v_mfma_f32_16x16x32_bf16 v[172:175], a[164:167], a[124:127], v[172:175]
  ds_read_b64_tr_b16 a[176:177], v4 offset:40960
  v_mfma_f32_16x16x32_bf16 v[172:175], a[160:163], a[108:111], v[172:175]
  s_waitcnt lgkmcnt(9)
  ds_read_b64_tr_b16 a[178:179], v4 offset:43008
  v_mfma_f32_16x16x32_bf16 v[188:191], a[168:171], a[108:111], v[188:191]
  ds_read_b64_tr_b16 a[180:181], v4 offset:45056
  v_mfma_f32_16x16x32_bf16 v[188:191], a[172:175], a[124:127], v[188:191]
  ds_read_b64_tr_b16 a[182:183], v4 offset:47104
  v_mfma_f32_16x16x32_bf16 v[184:187], a[172:175], a[120:123], v[184:187]
  ds_read_b64_tr_b16 a[164:165], v5 offset:40960
  v_mfma_f32_16x16x32_bf16 v[184:187], a[168:171], a[104:107], v[184:187]
  s_waitcnt lgkmcnt(9)
  ds_read_b64_tr_b16 a[166:167], v5 offset:43008
  v_mfma_f32_16x16x32_bf16 v[136:139], v[16:19], a[136:139], v[136:139]
  ds_read_b64_tr_b16 a[160:161], v5 offset:45056
  v_mfma_f32_16x16x32_bf16 v[136:139], v[20:23], a[152:155], v[136:139]
  ds_read_b64_tr_b16 a[162:163], v5 offset:47104
  v_mfma_f32_16x16x32_bf16 v[140:143], v[20:23], a[156:159], v[140:143]
  ds_read_b64_tr_b16 a[172:173], v2 offset:57344
  v_mfma_f32_16x16x32_bf16 v[140:143], v[16:19], a[140:143], v[140:143]
  s_waitcnt lgkmcnt(9)
  ds_read_b64_tr_b16 a[174:175], v2 offset:59392
  v_mfma_f32_16x16x32_bf16 v[156:159], v[24:27], a[140:143], v[156:159]
  ds_read_b64_tr_b16 a[168:169], v2 offset:61440
  v_add_u32 v38, s46, v0
  s_waitcnt vmcnt(0)
  s_mov_b64 exec, 1
  buffer_store_dword v38, v0, s[8:11], s81 offen offset:0 sc1
  s_mov_b64 exec, -1
  v_mfma_f32_16x16x32_bf16 v[156:159], v[28:31], a[156:159], v[156:159]
  ds_read_b64_tr_b16 a[170:171], v2 offset:63488
  v_mfma_f32_16x16x32_bf16 v[152:155], v[28:31], a[152:155], v[152:155]
  ds_read_b64_tr_b16 v[20:21], v3 offset:57344
  v_mfma_f32_16x16x32_bf16 v[152:155], v[24:27], a[136:139], v[152:155]
  s_waitcnt lgkmcnt(9)
  ds_read_b64_tr_b16 v[22:23], v3 offset:59392
  v_mfma_f32_16x16x32_bf16 v[168:171], a[176:179], a[136:139], v[168:171]
  ds_read_b64_tr_b16 v[16:17], v3 offset:61440
  v_mfma_f32_16x16x32_bf16 v[168:171], a[180:183], a[152:155], v[168:171]
  ds_read_b64_tr_b16 v[18:19], v3 offset:63488
  v_mfma_f32_16x16x32_bf16 v[172:175], a[180:183], a[156:159], v[172:175]
  ds_read_b64_tr_b16 v[28:29], v4 offset:57344
  v_mfma_f32_16x16x32_bf16 v[172:175], a[176:179], a[140:143], v[172:175]
  s_waitcnt lgkmcnt(9)
  ds_read_b64_tr_b16 v[30:31], v4 offset:59392
  v_mfma_f32_16x16x32_bf16 v[188:191], a[164:167], a[140:143], v[188:191]
  ds_read_b64_tr_b16 v[24:25], v4 offset:61440
  v_mfma_f32_16x16x32_bf16 v[188:191], a[160:163], a[156:159], v[188:191]
  ds_read_b64_tr_b16 v[26:27], v4 offset:63488
  v_mfma_f32_16x16x32_bf16 v[184:187], a[160:163], a[152:155], v[184:187]
  ds_read_b64_tr_b16 a[180:181], v5 offset:57344
  v_mfma_f32_16x16x32_bf16 v[184:187], a[164:167], a[136:139], v[184:187]
  s_waitcnt lgkmcnt(9)
  ds_read_b64_tr_b16 a[182:183], v5 offset:59392
  v_mfma_f32_16x16x32_bf16 v[136:139], a[172:175], a[196:199], v[136:139]
  ds_read_b64_tr_b16 a[176:177], v5 offset:61440
  v_mfma_f32_16x16x32_bf16 v[136:139], a[168:171], a[212:215], v[136:139]
  ds_read_b64_tr_b16 a[178:179], v5 offset:63488
  v_mfma_f32_16x16x32_bf16 v[140:143], a[168:171], a[216:219], v[140:143]
  ds_read_b64_tr_b16 a[160:161], v6 offset:40960
  v_mfma_f32_16x16x32_bf16 v[140:143], a[172:175], a[200:203], v[140:143]
  s_waitcnt lgkmcnt(9)
  ds_read_b64_tr_b16 a[162:163], v6 offset:43008
  v_mfma_f32_16x16x32_bf16 v[156:159], v[20:23], a[200:203], v[156:159]
  ds_read_b64_tr_b16 a[164:165], v6 offset:45056
  v_mfma_f32_16x16x32_bf16 v[156:159], v[16:19], a[216:219], v[156:159]
  ds_read_b64_tr_b16 a[166:167], v6 offset:47104
  v_mfma_f32_16x16x32_bf16 v[152:155], v[16:19], a[212:215], v[152:155]
  ds_read_b64_tr_b16 a[168:169], v7 offset:40960
  v_cvt_pk_bf16_f32 v136, v136, v137
  v_cvt_pk_bf16_f32 v137, v138, v139
  v_cvt_pk_bf16_f32 v140, v140, v141
  v_cvt_pk_bf16_f32 v141, v142, v143
  v_mfma_f32_16x16x32_bf16 v[152:155], v[20:23], a[196:199], v[152:155]
  s_waitcnt lgkmcnt(9)
  ds_read_b64_tr_b16 a[170:171], v7 offset:43008
  v_mfma_f32_16x16x32_bf16 v[168:171], v[28:31], a[196:199], v[168:171]
  ds_read_b64_tr_b16 a[172:173], v7 offset:45056
  v_mfma_f32_16x16x32_bf16 v[168:171], v[24:27], a[212:215], v[168:171]
  ds_read_b64_tr_b16 a[174:175], v7 offset:47104
  v_mfma_f32_16x16x32_bf16 v[172:175], v[24:27], a[216:219], v[172:175]
  ds_read_b64_tr_b16 v[16:17], v8 offset:40960
  v_cvt_pk_bf16_f32 v138, v152, v153
  v_cvt_pk_bf16_f32 v139, v154, v155
  v_mfma_f32_16x16x32_bf16 v[172:175], v[28:31], a[200:203], v[172:175]
  s_waitcnt lgkmcnt(9)
  ds_read_b64_tr_b16 v[18:19], v8 offset:43008
  v_mfma_f32_16x16x32_bf16 v[188:191], a[180:183], a[200:203], v[188:191]
  ds_read_b64_tr_b16 v[20:21], v8 offset:45056
  v_mfma_f32_16x16x32_bf16 v[188:191], a[176:179], a[216:219], v[188:191]
  ds_read_b64_tr_b16 v[22:23], v8 offset:47104
  s_add_u32 s87, s86, 8192
  buffer_store_dwordx4 v[136:139], v1, s[8:11], s87 offen offset:0 sc1
  v_mfma_f32_16x16x32_bf16 v[184:187], a[176:179], a[212:215], v[184:187]
  ds_read_b64_tr_b16 v[24:25], v9 offset:40960
  v_cvt_pk_bf16_f32 v142, v156, v157
  v_cvt_pk_bf16_f32 v143, v158, v159
  v_mfma_f32_16x16x32_bf16 v[184:187], a[180:183], a[196:199], v[184:187]
  s_waitcnt lgkmcnt(9)
  ds_read_b64_tr_b16 v[26:27], v9 offset:43008
  v_mfma_f32_16x16x32_bf16 v[128:131], a[160:163], a[220:223], v[128:131]
  ds_read_b64_tr_b16 v[28:29], v9 offset:45056
  v_mfma_f32_16x16x32_bf16 v[128:131], a[164:167], a[236:239], v[128:131]
  ds_read_b64_tr_b16 v[30:31], v9 offset:47104
  s_add_u32 s87, s86, 8192
  buffer_store_dwordx4 v[140:143], v1, s[8:11], s87 offen offset:2048 sc1
  v_mfma_f32_16x16x32_bf16 v[132:135], a[164:167], a[240:243], v[132:135]
  ds_read_b64_tr_b16 a[176:177], v6 offset:57344
  v_cvt_pk_bf16_f32 v168, v168, v169
  v_cvt_pk_bf16_f32 v169, v170, v171
  v_cvt_pk_bf16_f32 v172, v172, v173
  v_cvt_pk_bf16_f32 v173, v174, v175
  v_mfma_f32_16x16x32_bf16 v[132:135], a[160:163], a[224:227], v[132:135]
  s_waitcnt lgkmcnt(9)
  ds_read_b64_tr_b16 a[178:179], v6 offset:59392
  v_cvt_pk_bf16_f32 v170, v184, v185
  v_cvt_pk_bf16_f32 v171, v186, v187
  v_mfma_f32_16x16x32_bf16 v[148:151], a[168:171], a[224:227], v[148:151]
  ds_read_b64_tr_b16 a[180:181], v6 offset:61440
  v_mfma_f32_16x16x32_bf16 v[148:151], a[172:175], a[240:243], v[148:151]
  ds_read_b64_tr_b16 a[182:183], v6 offset:63488
  v_mfma_f32_16x16x32_bf16 v[144:147], a[172:175], a[236:239], v[144:147]
  ds_read_b64_tr_b16 a[164:165], v7 offset:57344
  s_add_u32 s87, s86, 8192
  buffer_store_dwordx4 v[168:171], v1, s[8:11], s87 offen offset:1024 sc1
  v_mfma_f32_16x16x32_bf16 v[144:147], a[168:171], a[220:223], v[144:147]
  s_waitcnt lgkmcnt(9)
  ds_read_b64_tr_b16 a[166:167], v7 offset:59392
HOP19:
  s_cbranch_execz WRET1
  v_cvt_pk_bf16_f32 v174, v188, v189
  v_cvt_pk_bf16_f32 v175, v190, v191
  v_mfma_f32_16x16x32_bf16 v[160:163], v[16:19], a[220:223], v[160:163]
  ds_read_b64_tr_b16 a[160:161], v7 offset:61440
  v_mfma_f32_16x16x32_bf16 v[160:163], v[20:23], a[236:239], v[160:163]
  ds_read_b64_tr_b16 a[162:163], v7 offset:63488
  v_mfma_f32_16x16x32_bf16 v[164:167], v[20:23], a[240:243], v[164:167]
  ds_read_b64_tr_b16 a[172:173], v8 offset:57344
  s_add_u32 s87, s86, 8192
  buffer_store_dwordx4 v[172:175], v1, s[8:11], s87 offen offset:3072 sc1
  v_mfma_f32_16x16x32_bf16 v[164:167], v[16:19], a[224:227], v[164:167]
  s_waitcnt lgkmcnt(9)
  ds_read_b64_tr_b16 a[174:175], v8 offset:59392
  v_mfma_f32_16x16x32_bf16 v[180:183], v[24:27], a[224:227], v[180:183]
  ds_read_b64_tr_b16 a[168:169], v8 offset:61440
  v_mfma_f32_16x16x32_bf16 v[180:183], v[28:31], a[240:243], v[180:183]
  ds_read_b64_tr_b16 a[170:171], v8 offset:63488
  v_mfma_f32_16x16x32_bf16 v[176:179], v[28:31], a[236:239], v[176:179]
  ds_read_b64_tr_b16 v[20:21], v9 offset:57344
  v_mfma_f32_16x16x32_bf16 v[176:179], v[24:27], a[220:223], v[176:179]
  s_waitcnt lgkmcnt(9)
  ds_read_b64_tr_b16 v[22:23], v9 offset:59392
  v_mfma_f32_16x16x32_bf16 v[128:131], a[176:179], a[0:3], v[128:131]
  ds_read_b64_tr_b16 v[16:17], v9 offset:61440
  v_mfma_f32_16x16x32_bf16 v[128:131], a[180:183], a[16:19], v[128:131]
  ds_read_b64_tr_b16 v[18:19], v9 offset:63488
  v_mfma_f32_16x16x32_bf16 v[132:135], a[180:183], a[20:23], v[132:135]
  ds_read_b64_tr_b16 v[28:29], v6 offset:24576
  v_mfma_f32_16x16x32_bf16 v[132:135], a[176:179], a[4:7], v[132:135]
  s_waitcnt lgkmcnt(9)
  ds_read_b64_tr_b16 v[30:31], v6 offset:26624
  v_mfma_f32_16x16x32_bf16 v[148:151], a[164:167], a[4:7], v[148:151]
  ds_read_b64_tr_b16 v[24:25], v6 offset:28672
  v_mfma_f32_16x16x32_bf16 v[148:151], a[160:163], a[20:23], v[148:151]
  ds_read_b64_tr_b16 v[26:27], v6 offset:30720
  v_mfma_f32_16x16x32_bf16 v[144:147], a[160:163], a[16:19], v[144:147]
  ds_read_b64_tr_b16 a[180:181], v7 offset:24576
  v_mfma_f32_16x16x32_bf16 v[144:147], a[164:167], a[0:3], v[144:147]
  s_waitcnt lgkmcnt(9)
  ds_read_b64_tr_b16 a[182:183], v7 offset:26624
  v_mfma_f32_16x16x32_bf16 v[160:163], a[172:175], a[0:3], v[160:163]
  ds_read_b64_tr_b16 a[176:177], v7 offset:28672
  v_mfma_f32_16x16x32_bf16 v[160:163], a[168:171], a[16:19], v[160:163]
  ds_read_b64_tr_b16 a[178:179], v7 offset:30720
  v_mfma_f32_16x16x32_bf16 v[164:167], a[168:171], a[20:23], v[164:167]
  ds_read_b64_tr_b16 a[160:161], v8 offset:24576
  v_mfma_f32_16x16x32_bf16 v[164:167], a[172:175], a[4:7], v[164:167]
  s_waitcnt lgkmcnt(9)
  ds_read_b64_tr_b16 a[162:163], v8 offset:26624
  v_mfma_f32_16x16x32_bf16 v[180:183], v[20:23], a[4:7], v[180:183]
  ds_read_b64_tr_b16 a[164:165], v8 offset:28672
  v_mfma_f32_16x16x32_bf16 v[180:183], v[16:19], a[20:23], v[180:183]
  ds_read_b64_tr_b16 a[166:167], v8 offset:30720
  v_mfma_f32_16x16x32_bf16 v[176:179], v[16:19], a[16:19], v[176:179]
  ds_read_b64_tr_b16 a[168:169], v9 offset:24576
  v_mfma_f32_16x16x32_bf16 v[176:179], v[20:23], a[0:3], v[176:179]
  s_waitcnt lgkmcnt(9)
  ds_read_b64_tr_b16 a[170:171], v9 offset:26624
  v_mfma_f32_16x16x32_bf16 v[128:131], v[28:31], a[32:35], v[128:131]
  ds_read_b64_tr_b16 a[172:173], v9 offset:28672
  v_mfma_f32_16x16x32_bf16 v[128:131], v[24:27], a[48:51], v[128:131]
  ds_read_b64_tr_b16 a[174:175], v9 offset:30720
  v_mfma_f32_16x16x32_bf16 v[132:135], v[24:27], a[52:55], v[132:135]
  ds_read_b64_tr_b16 v[16:17], v6 offset:8192
  v_mfma_f32_16x16x32_bf16 v[132:135], v[28:31], a[36:39], v[132:135]
  s_waitcnt lgkmcnt(9)
  ds_read_b64_tr_b16 v[18:19], v6 offset:10240
  v_mfma_f32_16x16x32_bf16 v[148:151], a[180:183], a[36:39], v[148:151]
  ds_read_b64_tr_b16 v[20:21], v6 offset:12288
  v_mfma_f32_16x16x32_bf16 v[148:151], a[176:179], a[52:55], v[148:151]
  ds_read_b64_tr_b16 v[22:23], v6 offset:14336
  s_xor_b32 s84, s81, 1536
  s_add_u32 s84, s84, 0
  buffer_load_dword v34, v37, s[8:11], s84 offen sc1
  v_mfma_f32_16x16x32_bf16 v[144:147], a[176:179], a[48:51], v[144:147]
  ds_read_b64_tr_b16 v[24:25], v7 offset:8192
  s_xor_b32 s91, s81, 512
  s_add_u32 s91, s91, 0
  buffer_load_dword v39, v37, s[8:11], s91 offen sc1
  v_mfma_f32_16x16x32_bf16 v[144:147], a[180:183], a[32:35], v[144:147]
  s_waitcnt lgkmcnt(9)
  ds_read_b64_tr_b16 v[26:27], v7 offset:10240
  v_mfma_f32_16x16x32_bf16 v[160:163], a[160:163], a[32:35], v[160:163]
  ds_read_b64_tr_b16 v[28:29], v7 offset:12288
  v_mfma_f32_16x16x32_bf16 v[160:163], a[164:167], a[48:51], v[160:163]
  ds_read_b64_tr_b16 v[30:31], v7 offset:14336
  v_mfma_f32_16x16x32_bf16 v[164:167], a[164:167], a[52:55], v[164:167]
  ds_read_b64_tr_b16 a[176:177], v8 offset:8192
  v_mfma_f32_16x16x32_bf16 v[164:167], a[160:163], a[36:39], v[164:167]
  s_waitcnt lgkmcnt(9)
  ds_read_b64_tr_b16 a[178:179], v8 offset:10240
  v_mfma_f32_16x16x32_bf16 v[180:183], a[168:171], a[36:39], v[180:183]
  ds_read_b64_tr_b16 a[180:181], v8 offset:12288
  v_mfma_f32_16x16x32_bf16 v[180:183], a[172:175], a[52:55], v[180:183]
  ds_read_b64_tr_b16 a[182:183], v8 offset:14336
  v_mfma_f32_16x16x32_bf16 v[176:179], a[172:175], a[48:51], v[176:179]
  ds_read_b64_tr_b16 a[164:165], v9 offset:8192
  v_mfma_f32_16x16x32_bf16 v[176:179], a[168:171], a[32:35], v[176:179]
  s_waitcnt lgkmcnt(9)
  ds_read_b64_tr_b16 a[166:167], v9 offset:10240
  v_add_u32 v38, s46, v0
  s_waitcnt vmcnt(2)
  s_mov_b64 exec, 1
  buffer_store_dword v38, v0, s[8:11], s81 offen offset:16 sc1
  s_mov_b64 exec, -1
  v_mfma_f32_16x16x32_bf16 v[128:131], v[16:19], a[64:67], v[128:131]
  ds_read_b64_tr_b16 a[160:161], v9 offset:12288
  v_mfma_f32_16x16x32_bf16 v[128:131], v[20:23], a[80:83], v[128:131]
  ds_read_b64_tr_b16 a[162:163], v9 offset:14336
  v_mfma_f32_16x16x32_bf16 v[132:135], v[20:23], a[84:87], v[132:135]
  ds_read_b64_tr_b16 a[172:173], v2 offset:8192
  v_mfma_f32_16x16x32_bf16 v[132:135], v[16:19], a[68:71], v[132:135]
  s_waitcnt lgkmcnt(9)
  ds_read_b64_tr_b16 a[174:175], v2 offset:10240
  s_xor_b32 s82, s81, 1024
  s_add_u32 s82, s82, 16
  buffer_load_dword v36, v37, s[8:11], s82 offen sc1
  v_mfma_f32_16x16x32_bf16 v[148:151], v[24:27], a[68:71], v[148:151]
  ds_read_b64_tr_b16 a[168:169], v2 offset:12288
  v_mfma_f32_16x16x32_bf16 v[148:151], v[28:31], a[84:87], v[148:151]
  ds_read_b64_tr_b16 a[170:171], v2 offset:14336
  v_mfma_f32_16x16x32_bf16 v[144:147], v[28:31], a[80:83], v[144:147]
  ds_read_b64_tr_b16 v[20:21], v3 offset:8192
  v_mfma_f32_16x16x32_bf16 v[144:147], v[24:27], a[64:67], v[144:147]
  s_waitcnt lgkmcnt(9)
  ds_read_b64_tr_b16 v[22:23], v3 offset:10240
  v_mfma_f32_16x16x32_bf16 v[160:163], a[176:179], a[64:67], v[160:163]
  ds_read_b64_tr_b16 v[16:17], v3 offset:12288
  v_mfma_f32_16x16x32_bf16 v[160:163], a[180:183], a[80:83], v[160:163]
  ds_read_b64_tr_b16 v[18:19], v3 offset:14336
  v_mfma_f32_16x16x32_bf16 v[164:167], a[180:183], a[84:87], v[164:167]
  ds_read_b64_tr_b16 v[28:29], v4 offset:8192
  v_mfma_f32_16x16x32_bf16 v[164:167], a[176:179], a[68:71], v[164:167]
  s_waitcnt lgkmcnt(9)
  ds_read_b64_tr_b16 v[30:31], v4 offset:10240
  v_mfma_f32_16x16x32_bf16 v[180:183], a[164:167], a[68:71], v[180:183]
  ds_read_b64_tr_b16 v[24:25], v4 offset:12288
  v_mfma_f32_16x16x32_bf16 v[180:183], a[160:163], a[84:87], v[180:183]
  ds_read_b64_tr_b16 v[26:27], v4 offset:14336
  v_mfma_f32_16x16x32_bf16 v[176:179], a[160:163], a[80:83], v[176:179]
  ds_read_b64_tr_b16 a[180:181], v5 offset:8192
  v_mfma_f32_16x16x32_bf16 v[176:179], a[164:167], a[64:67], v[176:179]
  s_waitcnt lgkmcnt(9)
  ds_read_b64_tr_b16 a[182:183], v5 offset:10240
  v_mfma_f32_16x16x32_bf16 v[128:131], a[172:175], a[96:99], v[128:131]
  ds_read_b64_tr_b16 a[176:177], v5 offset:12288
  v_mfma_f32_16x16x32_bf16 v[128:131], a[168:171], a[112:115], v[128:131]
  ds_read_b64_tr_b16 a[178:179], v5 offset:14336
  s_waitcnt vmcnt(3)
  v_cmp_ne_u32 vcc, s46, v34
  s_nop 4
  s_cbranch_vccz PL22_adaLN_cond__sliding_local_dilated__swiglu_ffn__prompt_kernelx
  s_mov_b32 s83, 60000
PL22_adaLN_cond__sliding_local_dilated__swiglu_ffn__prompt_kernel:
  buffer_load_dword v34, v37, s[8:11], s84 offen sc1
  s_sub_u32 s83, s83, 1
  s_cmp_eq_u32 s83, 0
  s_waitcnt vmcnt(0)
  s_cbranch_scc1 PL22_adaLN_cond__sliding_local_dilated__swiglu_ffn__prompt_kernelx
  v_cmp_ne_u32 vcc, s46, v34
  s_nop 4
  s_cbranch_vccnz PL22_adaLN_cond__sliding_local_dilated__swiglu_ffn__prompt_kernel
PL22_adaLN_cond__sliding_local_dilated__swiglu_ffn__prompt_kernelx:
  v_mfma_f32_16x16x32_bf16 v[132:135], a[168:171], a[116:119], v[132:135]
  ds_read_b64_tr_b16 a[160:161], v2 offset:40960
  s_xor_b32 s55, s86, 196608
  s_add_u32 s55, s55, 0
  buffer_load_dwordx4 v[88:91], v1, s[8:11], s55 offen offset:0 sc1
  v_mfma_f32_16x16x32_bf16 v[132:135], a[172:175], a[100:103], v[132:135]
  s_waitcnt lgkmcnt(9)
  ds_read_b64_tr_b16 a[162:163], v2 offset:43008
  s_xor_b32 s55, s86, 196608
  s_add_u32 s55, s55, 0
  buffer_load_dwordx4 v[120:123], v1, s[8:11], s55 offen offset:1024 sc1
  v_mfma_f32_16x16x32_bf16 v[148:151], v[20:23], a[100:103], v[148:151]
  ds_read_b64_tr_b16 a[164:165], v2 offset:45056
  s_xor_b32 s55, s86, 196608
  s_add_u32 s55, s55, 0
  buffer_load_dwordx4 v[92:95], v1, s[8:11], s55 offen offset:2048 sc1
  v_mfma_f32_16x16x32_bf16 v[148:151], v[16:19], a[116:119], v[148:151]
  ds_read_b64_tr_b16 a[166:167], v2 offset:47104
  s_xor_b32 s55, s86, 196608
  s_add_u32 s55, s55, 0
  buffer_load_dwordx4 v[124:127], v1, s[8:11], s55 offen offset:3072 sc1
  v_mfma_f32_16x16x32_bf16 v[144:147], v[16:19], a[112:115], v[144:147]
  ds_read_b64_tr_b16 a[168:169], v3 offset:40960
  s_waitcnt vmcnt(6)
  v_cmp_ne_u32 vcc, s46, v39
  s_nop 4
  s_cbranch_vccz PL23_adaLN_cond__sliding_local_dilated__swiglu_ffn__prompt_kernelx
  s_mov_b32 s83, 60000
PL23_adaLN_cond__sliding_local_dilated__swiglu_ffn__prompt_kernel:
  buffer_load_dword v39, v37, s[8:11], s91 offen sc1
  s_sub_u32 s83, s83, 1
  s_cmp_eq_u32 s83, 0
  s_waitcnt vmcnt(0)
  s_cbranch_scc1 PL23_adaLN_cond__sliding_local_dilated__swiglu_ffn__prompt_kernelx
  v_cmp_ne_u32 vcc, s46, v39
  s_nop 4
  s_cbranch_vccnz PL23_adaLN_cond__sliding_local_dilated__swiglu_ffn__prompt_kernel
PL23_adaLN_cond__sliding_local_dilated__swiglu_ffn__prompt_kernelx:
  v_mfma_f32_16x16x32_bf16 v[144:147], v[20:23], a[96:99], v[144:147]
  s_waitcnt lgkmcnt(9)
  ds_read_b64_tr_b16 a[170:171], v3 offset:43008
  s_xor_b32 s55, s86, 65536
  s_add_u32 s55, s55, 4096
  buffer_load_dwordx4 v[80:83], v1, s[8:11], s55 offen offset:0 sc1
  v_mfma_f32_16x16x32_bf16 v[160:163], v[28:31], a[96:99], v[160:163]
  ds_read_b64_tr_b16 a[172:173], v3 offset:45056
  s_xor_b32 s55, s86, 65536
  s_add_u32 s55, s55, 4096
  buffer_load_dwordx4 v[112:115], v1, s[8:11], s55 offen offset:1024 sc1
  v_mfma_f32_16x16x32_bf16 v[160:163], v[24:27], a[112:115], v[160:163]
  ds_read_b64_tr_b16 a[174:175], v3 offset:47104
  s_xor_b32 s55, s86, 65536
  s_add_u32 s55, s55, 4096
  buffer_load_dwordx4 v[84:87], v1, s[8:11], s55 offen offset:2048 sc1
  v_mfma_f32_16x16x32_bf16 v[164:167], v[24:27], a[116:119], v[164:167]
  ds_read_b64_tr_b16 v[16:17], v4 offset:40960
  s_xor_b32 s55, s86, 65536
  s_add_u32 s55, s55, 4096
  buffer_load_dwordx4 v[116:119], v1, s[8:11], s55 offen offset:3072 sc1
  v_mfma_f32_16x16x32_bf16 v[164:167], v[28:31], a[100:103], v[164:167]
  s_waitcnt lgkmcnt(9)
  ds_read_b64_tr_b16 v[18:19], v4 offset:43008
  v_mfma_f32_16x16x32_bf16 v[180:183], a[180:183], a[100:103], v[180:183]
  ds_read_b64_tr_b16 v[20:21], v4 offset:45056
  v_mfma_f32_16x16x32_bf16 v[180:183], a[176:179], a[116:119], v[180:183]
  ds_read_b64_tr_b16 v[22:23], v4 offset:47104
  s_waitcnt vmcnt(8)
  v_cmp_ne_u32 vcc, s46, v36
  s_mov_b32 s87, 0
  s_nop 3
  s_cbranch_vccnz XL24_adaLN_cond__sliding_local_dilated__swiglu_ffn__prompt_kernel
  s_xor_b32 s55, s86, 131072
  s_add_u32 s55, s55, 8192
  buffer_load_dwordx4 v[152:155], v1, s[8:11], s55 offen offset:0 sc1
  buffer_load_dwordx4 v[184:187], v1, s[8:11], s55 offen offset:1024 sc1
  buffer_load_dwordx4 v[156:159], v1, s[8:11], s55 offen offset:2048 sc1
  buffer_load_dwordx4 v[188:191], v1, s[8:11], s55 offen offset:3072 sc1
  s_mov_b32 s87, 1
XL24_adaLN_cond__sliding_local_dilated__swiglu_ffn__prompt_kernel:
  v_mfma_f32_16x16x32_bf16 v[176:179], a[176:179], a[112:115], v[176:179]
  ds_read_b64_tr_b16 v[24:25], v5 offset:40960
  v_mfma_f32_16x16x32_bf16 v[176:179], a[180:183], a[96:99], v[176:179]
  s_waitcnt lgkmcnt(9)
  ds_read_b64_tr_b16 v[26:27], v5 offset:43008
  v_mfma_f32_16x16x32_bf16 v[128:131], a[160:163], a[128:131], v[128:131]
  ds_read_b64_tr_b16 v[28:29], v5 offset:45056
  v_mfma_f32_16x16x32_bf16 v[128:131], a[164:167], a[144:147], v[128:131]
  ds_read_b64_tr_b16 v[30:31], v5 offset:47104
  v_mfma_f32_16x16x32_bf16 v[132:135], a[164:167], a[148:151], v[132:135]
  ds_read_b64_tr_b16 a[176:177], v2 offset:57344
  v_mfma_f32_16x16x32_bf16 v[132:135], a[160:163], a[132:135], v[132:135]
  s_waitcnt lgkmcnt(9)
  ds_read_b64_tr_b16 a[178:179], v2 offset:59392
  v_mfma_f32_16x16x32_bf16 v[148:151], a[168:171], a[132:135], v[148:151]
  ds_read_b64_tr_b16 a[180:181], v2 offset:61440
  v_mfma_f32_16x16x32_bf16 v[148:151], a[172:175], a[148:151], v[148:151]
  ds_read_b64_tr_b16 a[182:183], v2 offset:63488
  v_mfma_f32_16x16x32_bf16 v[144:147], a[172:175], a[144:147], v[144:147]
  ds_read_b64_tr_b16 a[164:165], v3 offset:57344
  v_mfma_f32_16x16x32_bf16 v[144:147], a[168:171], a[128:131], v[144:147]
  s_waitcnt lgkmcnt(9)
  ds_read_b64_tr_b16 a[166:167], v3 offset:59392
  v_mfma_f32_16x16x32_bf16 v[160:163], v[16:19], a[128:131], v[160:163]
  ds_read_b64_tr_b16 a[160:161], v3 offset:61440
  v_mfma_f32_16x16x32_bf16 v[160:163], v[20:23], a[144:147], v[160:163]
  ds_read_b64_tr_b16 a[162:163], v3 offset:63488
  v_mfma_f32_16x16x32_bf16 v[164:167], v[20:23], a[148:151], v[164:167]
  ds_read_b64_tr_b16 a[172:173], v4 offset:57344
  v_mfma_f32_16x16x32_bf16 v[164:167], v[16:19], a[132:135], v[164:167]
  s_waitcnt lgkmcnt(9)
  ds_read_b64_tr_b16 a[174:175], v4 offset:59392
  v_mfma_f32_16x16x32_bf16 v[180:183], v[24:27], a[132:135], v[180:183]
  ds_read_b64_tr_b16 a[168:169], v4 offset:61440
  v_mfma_f32_16x16x32_bf16 v[180:183], v[28:31], a[148:151], v[180:183]
  ds_read_b64_tr_b16 a[170:171], v4 offset:63488
  v_mfma_f32_16x16x32_bf16 v[176:179], v[28:31], a[144:147], v[176:179]
  ds_read_b64_tr_b16 v[20:21], v5 offset:57344
  v_mfma_f32_16x16x32_bf16 v[176:179], v[24:27], a[128:131], v[176:179]
  s_waitcnt lgkmcnt(9)
  ds_read_b64_tr_b16 v[22:23], v5 offset:59392
  v_mfma_f32_16x16x32_bf16 v[128:131], a[176:179], a[188:191], v[128:131]
  ds_read_b64_tr_b16 v[16:17], v5 offset:61440
  v_mfma_f32_16x16x32_bf16 v[128:131], a[180:183], a[204:207], v[128:131]
  ds_read_b64_tr_b16 v[18:19], v5 offset:63488
  v_mfma_f32_16x16x32_bf16 v[132:135], a[180:183], a[208:211], v[132:135]
  v_mfma_f32_16x16x32_bf16 v[132:135], a[176:179], a[192:195], v[132:135]
  s_waitcnt lgkmcnt(8)
  v_mfma_f32_16x16x32_bf16 v[148:151], a[164:167], a[192:195], v[148:151]
  v_mfma_f32_16x16x32_bf16 v[148:151], a[160:163], a[208:211], v[148:151]
  v_mfma_f32_16x16x32_bf16 v[144:147], a[160:163], a[204:207], v[144:147]
  v_mfma_f32_16x16x32_bf16 v[144:147], a[164:167], a[188:191], v[144:147]
  s_waitcnt lgkmcnt(4)
  v_mfma_f32_16x16x32_bf16 v[160:163], a[172:175], a[188:191], v[160:163]
  v_mfma_f32_16x16x32_bf16 v[160:163], a[168:171], a[204:207], v[160:163]
  v_mfma_f32_16x16x32_bf16 v[164:167], a[168:171], a[208:211], v[164:167]
  v_mfma_f32_16x16x32_bf16 v[164:167], a[172:175], a[192:195], v[164:167]
  s_waitcnt lgkmcnt(0)
  v_mfma_f32_16x16x32_bf16 v[180:183], v[20:23], a[192:195], v[180:183]
  v_mfma_f32_16x16x32_bf16 v[180:183], v[16:19], a[208:211], v[180:183]
  v_mfma_f32_16x16x32_bf16 v[176:179], v[16:19], a[204:207], v[176:179]
  v_mfma_f32_16x16x32_bf16 v[176:179], v[20:23], a[188:191], v[176:179]
  s_waitcnt vmcnt(0)
  v_mfma_f32_16x16x32_bf16 v[208:211], v[52:55], v[88:91], v[208:211]
  v_mfma_f32_16x16x32_bf16 v[212:215], v[54:57], v[88:91], v[212:215]
  v_mfma_f32_16x16x32_bf16 v[216:219], v[58:61], v[120:123], v[216:219]
  v_mfma_f32_16x16x32_bf16 v[220:223], v[60:63], v[120:123], v[220:223]
  v_mfma_f32_16x16x32_bf16 v[224:227], v[52:55], v[92:95], v[224:227]
  v_mfma_f32_16x16x32_bf16 v[228:231], v[54:57], v[92:95], v[228:231]
  v_mfma_f32_16x16x32_bf16 v[232:235], v[58:61], v[124:127], v[232:235]
  v_mfma_f32_16x16x32_bf16 v[236:239], v[60:63], v[124:127], v[236:239]
  v_mfma_f32_16x16x32_bf16 v[208:211], v[52:55], v[80:83], v[208:211]
  v_mfma_f32_16x16x32_bf16 v[212:215], v[54:57], v[80:83], v[212:215]
  v_mfma_f32_16x16x32_bf16 v[216:219], v[58:61], v[112:115], v[216:219]
  v_mfma_f32_16x16x32_bf16 v[220:223], v[60:63], v[112:115], v[220:223]
  v_mfma_f32_16x16x32_bf16 v[224:227], v[52:55], v[84:87], v[224:227]
  v_mfma_f32_16x16x32_bf16 v[228:231], v[54:57], v[84:87], v[228:231]
  v_mfma_f32_16x16x32_bf16 v[232:235], v[58:61], v[116:119], v[232:235]
  v_mfma_f32_16x16x32_bf16 v[236:239], v[60:63], v[116:119], v[236:239]
  s_nop 0
  v_fmac_f32 v208, v240, v128
  v_fmac_f32 v209, v241, v129
  v_fmac_f32 v210, v242, v130
  v_fmac_f32 v211, v243, v131
  v_fmac_f32 v212, v244, v144
  v_fmac_f32 v213, v245, v145
  v_fmac_f32 v214, v246, v146
  v_fmac_f32 v215, v247, v147
  v_fmac_f32 v224, v240, v132
  v_fmac_f32 v225, v241, v133
  v_fmac_f32 v226, v242, v134
  v_fmac_f32 v227, v243, v135
  v_fmac_f32 v228, v244, v148
  v_fmac_f32 v229, v245, v149
  v_fmac_f32 v230, v246, v150
  v_fmac_f32 v231, v247, v151
  v_fmac_f32 v216, v248, v160
  v_fmac_f32 v217, v249, v161
  v_fmac_f32 v218, v250, v162
  v_fmac_f32 v219, v251, v163
  v_fmac_f32 v220, v252, v176
  v_fmac_f32 v221, v253, v177
  v_fmac_f32 v222, v254, v178
  v_fmac_f32 v223, v255, v179
  v_fmac_f32 v232, v248, v164
  v_fmac_f32 v233, v249, v165
  v_fmac_f32 v234, v250, v166
  v_fmac_f32 v235, v251, v167
  v_fmac_f32 v236, v252, v180
  v_fmac_f32 v237, v253, v181
  v_fmac_f32 v238, v254, v182
  v_fmac_f32 v239, v255, v183
  s_cmp_eq_u32 s87, 1
  s_cbranch_scc1 XA25_adaLN_cond__sliding_local_dilated__swiglu_ffn__prompt_kernelx
  s_mov_b32 s83, 60000
XA25_adaLN_cond__sliding_local_dilated__swiglu_ffn__prompt_kernel:
  buffer_load_dword v36, v37, s[8:11], s82 offen sc1
  s_sub_u32 s83, s83, 1
  s_cmp_eq_u32 s83, 0
  s_waitcnt vmcnt(0)
  s_cbranch_scc1 XA25_adaLN_cond__sliding_local_dilated__swiglu_ffn__prompt_kernely
  v_cmp_ne_u32 vcc, s46, v36
  s_nop 4
  s_cbranch_vccnz XA25_adaLN_cond__sliding_local_dilated__swiglu_ffn__prompt_kernel
XA25_adaLN_cond__sliding_local_dilated__swiglu_ffn__prompt_kernely:
  s_xor_b32 s55, s86, 131072
  s_add_u32 s55, s55, 8192
  buffer_load_dwordx4 v[152:155], v1, s[8:11], s55 offen offset:0 sc1
  buffer_load_dwordx4 v[184:187], v1, s[8:11], s55 offen offset:1024 sc1
  buffer_load_dwordx4 v[156:159], v1, s[8:11], s55 offen offset:2048 sc1
  buffer_load_dwordx4 v[188:191], v1, s[8:11], s55 offen offset:3072 sc1
XA25_adaLN_cond__sliding_local_dilated__swiglu_ffn__prompt_kernelx:
  s_waitcnt vmcnt(3)
  v_mfma_f32_16x16x32_bf16 v[208:211], v[52:55], v[152:155], v[208:211]
  v_mfma_f32_16x16x32_bf16 v[212:215], v[54:57], v[152:155], v[212:215]
  s_waitcnt vmcnt(2)
  v_mfma_f32_16x16x32_bf16 v[216:219], v[58:61], v[184:187], v[216:219]
  v_mfma_f32_16x16x32_bf16 v[220:223], v[60:63], v[184:187], v[220:223]
  s_waitcnt vmcnt(1)
  v_mfma_f32_16x16x32_bf16 v[224:227], v[52:55], v[156:159], v[224:227]
  v_mfma_f32_16x16x32_bf16 v[228:231], v[54:57], v[156:159], v[228:231]
  s_waitcnt vmcnt(0)
  v_mfma_f32_16x16x32_bf16 v[232:235], v[58:61], v[188:191], v[232:235]
  v_mfma_f32_16x16x32_bf16 v[236:239], v[60:63], v[188:191], v[236:239]
  v_cvt_pk_bf16_f32 v192, v208, v209
  v_cvt_pk_bf16_f32 v193, v210, v211
  v_cvt_pk_bf16_f32 v194, v212, v213
  v_cvt_pk_bf16_f32 v195, v214, v215
  s_nop 0
  v_permlane16_swap_b32 v192, v194
  v_permlane16_swap_b32 v193, v195
  ds_write_b128 v42, v[192:195] offset:0
  v_cvt_pk_bf16_f32 v196, v216, v217
  v_cvt_pk_bf16_f32 v197, v218, v219
  v_cvt_pk_bf16_f32 v198, v220, v221
  v_cvt_pk_bf16_f32 v199, v222, v223
  s_nop 0
  v_permlane16_swap_b32 v196, v198
  v_permlane16_swap_b32 v197, v199
  ds_write_b128 v43, v[196:199] offset:0
  ds_read_b128 v[208:211], v44 offset:0
  ds_read_b128 v[212:215], v44 offset:1024
  v_cvt_pk_bf16_f32 v200, v224, v225
  v_cvt_pk_bf16_f32 v201, v226, v227
  v_cvt_pk_bf16_f32 v202, v228, v229
  v_cvt_pk_bf16_f32 v203, v230, v231
  s_nop 0
  v_permlane16_swap_b32 v200, v202
  v_permlane16_swap_b32 v201, v203
  ds_write_b128 v42, v[200:203] offset:2048
  v_cvt_pk_bf16_f32 v204, v232, v233
  v_cvt_pk_bf16_f32 v205, v234, v235
  v_cvt_pk_bf16_f32 v206, v236, v237
  v_cvt_pk_bf16_f32 v207, v238, v239
  s_nop 0
  v_permlane16_swap_b32 v204, v206
  v_permlane16_swap_b32 v205, v207
  ds_write_b128 v43, v[204:207] offset:2048
  ds_read_b128 v[224:227], v44 offset:2048
  ds_read_b128 v[228:231], v44 offset:3072
  s_waitcnt lgkmcnt(5)
  buffer_store_dwordx4 v[208:211], v40, s[40:43], s85 offen sc1
  s_add_u32 s85, s85, 16384
  s_waitcnt lgkmcnt(4)
  buffer_store_dwordx4 v[212:215], v40, s[40:43], s85 offen sc1
  s_add_u32 s85, s85, 16384
  s_waitcnt lgkmcnt(1)
  buffer_store_dwordx4 v[224:227], v40, s[40:43], s85 offen sc1
  s_add_u32 s85, s85, 16384
  s_waitcnt lgkmcnt(0)
  buffer_store_dwordx4 v[228:231], v40, s[40:43], s85 offen sc1
E_adaLN_cond__sliding_local_dilated__swiglu_ffn__prompt_kernel:
X_adaLN_cond__sliding_local_dilated__swiglu_ffn__prompt_kernel:
  s_endpgm
code_end:
.fill 2048, 4, 0xBF800000
.section .rodata,"a"
.p2align 6
.amdhsa_kernel adaLN_cond__sliding_local_dilated__swiglu_ffn__prompt_kernel
  .amdhsa_next_free_vgpr 512
  .amdhsa_next_free_sgpr 102
  .amdhsa_accum_offset 256
  .amdhsa_group_segment_fixed_size 0
  .amdhsa_kernarg_size 96
  .amdhsa_user_sgpr_count 2
  .amdhsa_user_sgpr_kernarg_segment_ptr 1
  .amdhsa_system_sgpr_workgroup_id_x 1
  .amdhsa_float_denorm_mode_32 3
.end_amdhsa_kernel
```

```asm
; @launch grid=(256,1,1) block=(256,1,1) lds=163840
.amdgcn_target "amdgcn-amd-amdhsa--gfx950"
.text
.globl adaLN_cond__sliding_local_dilated__swiglu_ffn__prompt_kernel
.type adaLN_cond__sliding_local_dilated__swiglu_ffn__prompt_kernel,@function
.p2align 8
adaLN_cond__sliding_local_dilated__swiglu_ffn__prompt_kernel:
  s_cmp_ge_u32 s2, 256
  s_cbranch_scc1 X_adaLN_cond__sliding_local_dilated__swiglu_ffn__prompt_kernel
  s_load_dwordx2 s[4:5], s[0:1], 0
  s_load_dwordx2 s[8:9], s[0:1], 88
  s_load_dwordx2 s[12:13], s[0:1], 8
  s_load_dwordx2 s[16:17], s[0:1], 16
  s_load_dwordx2 s[20:21], s[0:1], 64
  s_load_dwordx2 s[24:25], s[0:1], 56
  s_load_dwordx2 s[28:29], s[0:1], 32
  s_load_dwordx2 s[32:33], s[0:1], 40
  s_load_dwordx2 s[36:37], s[0:1], 48
  s_load_dwordx2 s[40:41], s[0:1], 72
  v_lshrrev_b32 v21, 6, v0
  v_and_b32 v0, 63, v0
  v_readfirstlane_b32 s44, v21
  v_lshrrev_b32 v22, 3, v0
  v_bfe_u32 v11, v22, 1, 2
  v_bfe_u32 v23, v0, 1, 2
  v_xor_b32 v11, v11, v23
  v_lshlrev_b32 v11, 5, v11
  v_and_b32 v23, 1, v0
  v_lshl_add_u32 v11, v23, 4, v11
  s_lshl_b32 s45, s44, 10
  s_lshl_b32 s52, s44, 3
  v_add_u32 v10, s52, v22
  s_and_b32 s52, s2, 7
  s_lshl_b32 s52, s52, 7
  v_add_u32 v35, s52, v10
  v_mul_u32_u24 v35, 12288, v35
  s_lshr_b32 s53, s2, 3
  s_lshl_b32 s53, s53, 7
  v_add3_u32 v35, v35, v11, s53
  s_and_b32 s53, s44, 1
  s_lshl_b32 s53, s53, 6
  s_add_u32 s52, s52, s53
  v_add_lshl_u32 v16, s52, v0, 1
  s_and_b32 s52, s2, 7
  s_lshr_b32 s53, s2, 3
  s_and_b32 s51, s52, 3
  s_lshl_b32 s51, s51, 2
  s_and_b32 s50, s53, 3
  s_add_u32 s51, s51, s50
  s_lshr_b32 s50, s52, 2
  s_lshl_b32 s50, s50, 3
  s_lshr_b32 s53, s53, 2
  s_add_u32 s50, s50, s53
  s_lshl_b32 s54, s50, 4
  s_add_u32 s54, s54, s51
  v_and_b32 v21, 7, v0
  v_lshlrev_b32 v28, 11, v21
  v_lshl_add_u32 v28, v22, 4, v28
  v_mov_b32 v29, 851968
  s_lshr_b32 s38, s54, 1
  s_lshl_b32 s38, s38, 15
  s_and_b32 s53, s54, 1
  s_lshl_b32 s53, s53, 2
  s_add_u32 s53, s53, s44
  s_lshl_b32 s52, s53, 8
  s_add_u32 s30, s38, s52
  s_mov_b32 s6, 4194304
  s_mov_b32 s7, 0x20000
  s_mov_b32 s10, 134217728
  s_mov_b32 s11, 0x20000
  s_mov_b32 s14, 6291456
  s_mov_b32 s15, 0x20000
  s_mov_b32 s18, 2097152
  s_mov_b32 s19, 0x20000
  s_mov_b32 s22, 12582912
  s_mov_b32 s23, 0x20000
  s_mov_b32 s26, 2048
  s_mov_b32 s27, 0x20000
  s_waitcnt lgkmcnt(0)
  buffer_load_ushort v15, v16, s[24:27], 0 offen
  s_add_u32 m0, s45, 131072
  s_mov_b32 s68, 0
  buffer_load_dwordx4 v35, s[20:23], s68 offen nt lds
  s_add_u32 m0, s45, 135168
  s_add_u32 s68, s68, 393216
  buffer_load_dwordx4 v35, s[20:23], s68 offen nt lds
  s_add_u32 m0, s45, 139264
  s_add_u32 s68, s68, 393216
  buffer_load_dwordx4 v35, s[20:23], s68 offen nt lds
  s_add_u32 m0, s45, 143360
  s_add_u32 s68, s68, 393216
  buffer_load_dwordx4 v35, s[20:23], s68 offen nt lds
  buffer_load_dword v36, v29, s[8:11], 0 offen sc1
  s_and_b32 s52, s2, 3
  s_lshl_b32 s52, s52, 2
  s_add_u32 s52, s52, s44
  s_lshl_b32 s52, s52, 7
  v_lshlrev_b32 v23, 1, v0
  buffer_load_ushort v23, v23, s[24:27], s52 offen
  s_add_u32 s52, s30, 0
  buffer_load_dwordx4 v[44:47], v28, s[4:7], s52 offen offset:0 nt
  buffer_load_dwordx4 v[48:51], v28, s[4:7], s52 offen offset:128 nt
  s_add_u32 s52, s30, 16384
  buffer_load_dwordx4 v[52:55], v28, s[4:7], s52 offen offset:0 nt
  buffer_load_dwordx4 v[56:59], v28, s[4:7], s52 offen offset:128 nt
  s_branch BODY0
.p2align 12
BODY0:
  v_lshlrev_b32 v1, 4, v0
  v_add_u32 v2, 65536, v1
  v_add_u32 v13, 131072, v1
  s_lshl_b32 s66, s51, 1
  s_add_u32 s66, s66, s50
  v_mul_u32_u24 v9, 6144, v10
  s_lshl_b32 s52, s51, 7
  v_add3_u32 v9, v9, v11, s52
  s_lshl_b32 s52, s53, 12
  s_add_u32 s38, s38, s52
  s_add_u32 s39, s38, 41943040
  s_add_u32 s38, s38, 1048576
  s_lshl_b32 s34, s53, 9
  s_add_u32 s34, s34, 131072
  s_lshl_b32 s35, s53, 11
  s_add_u32 s35, s35, 819200
  s_lshr_b32 s83, s2, 3
  s_lshl_b32 s83, s83, 2
  s_add_u32 s83, s83, s44
  s_lshl_b32 s83, s83, 10
  s_getpc_b64 s[80:81]
CT1_adaLN_cond__sliding_local_dilated__swiglu_ffn__prompt_kernel:
  s_min_u32 s82, s83, code_end-CT1_adaLN_cond__sliding_local_dilated__swiglu_ffn__prompt_kernel
  s_add_u32 s80, s80, s82
  s_addc_u32 s81, s81, 0
  v_and_b32 v24, 0x70, v1
  v_lshlrev_b32 v24, 3, v24
  global_load_dword a253, v24, s[80:81]
  s_xor_b32 s30, s30, 1024
  s_add_u32 s52, s30, 0
  buffer_load_dwordx4 v[92:95], v28, s[4:7], s52 offen offset:0 nt
  buffer_load_dwordx4 v[96:99], v28, s[4:7], s52 offen offset:128 nt
  s_add_u32 s52, s30, 16384
  buffer_load_dwordx4 v[100:103], v28, s[4:7], s52 offen offset:0 nt
  buffer_load_dwordx4 v[104:107], v28, s[4:7], s52 offen offset:128 nt
  s_add_u32 s52, s44, 0
  s_sub_u32 s53, 5, s52
  s_bitcmp1_b32 s2, 2
  s_cselect_b32 s52, s53, s52
  s_lshr_b32 s53, s52, 1
  s_lshl_b32 s53, s53, 11
  s_and_b32 s52, s52, 1
  s_lshr_b32 s57, s2, 3
  s_lshl_b32 s57, s57, 1
  s_add_u32 s52, s52, s57
  s_mul_i32 s52, s52, 98304
  s_add_u32 s52, s52, s53
  s_and_b32 s53, s2, 3
  s_lshl_b32 s53, s53, 9
  s_add_u32 s52, s52, s53
  s_cmp_lt_u32 s44, 3
  s_cselect_b32 s52, s52, 1073741824
  v_lshrrev_b32 v16, 2, v0
  v_mul_u32_u24 v16, 5632, v16
  v_lshl_add_u32 v16, v0, 7, v16
  buffer_load_dword a252, v16, s[12:15], s52 offen
  v_lshrrev_b32 v41, 2, v0
  v_bfe_u32 v40, v41, 1, 2
  v_lshlrev_b32 v40, 5, v40
  v_lshl_add_u32 v40, v41, 7, v40
  v_and_b32 v41, 3, v0
  v_lshl_add_u32 v40, v41, 3, v40
  s_lshl_b32 s52, s44, 5
  v_xor_b32 v3, s52, v40
  s_and_b32 s52, s52, 64
  s_and_b32 s53, s44, 1
  s_lshl_b32 s53, s53, 14
  s_add_u32 s52, s52, s53
  v_xor_b32 v4, s52, v40
  v_xor_b32 v5, 32, v4
  v_add_u32 v6, 65536, v3
  v_add_u32 v7, 65536, v4
  v_add_u32 v8, 65536, v5
  v_add_u32 v35, 131072, v3
  v_lshrrev_b32 v30, 5, v0
  v_lshlrev_b32 v30, 6, v30
  v_bfe_u32 v40, v0, 2, 2
  v_lshl_add_u32 v30, v40, 4, v30
  v_bfe_u32 v40, v0, 4, 1
  v_lshl_add_u32 v30, v40, 3, v30
  v_lshl_add_u32 v30, v41, 1, v30
  s_lshl_b32 s52, s44, 7
  s_add_u32 s52, s52, 149504
  v_add_u32 v30, s52, v30
  v_lshrrev_b32 v32, 4, v0
  v_lshlrev_b32 v32, 4, v32
  v_add_u32 v31, 149504, v32
  v_and_b32 v40, 15, v0
  v_lshl_add_u32 v32, v40, 27, v32
  s_and_b32 s52, s2, 7
  s_lshl_b32 s52, s52, 13
  s_lshr_b32 s53, s2, 3
  s_lshl_b32 s53, s53, 8
  s_add_u32 s52, s52, s53
  s_lshl_b32 s53, s44, 6
  s_add_u32 s52, s52, s53
  s_add_u32 s42, s52, 131072
  s_lshl_b32 s53, s44, 28
  s_lshl_b32 s31, s2, 7
  s_add_u32 s31, s31, s53
  s_add_u32 s31, s31, 819200
  s_lshl_b32 s74, s54, 7
  s_add_u32 s74, s74, s53
  s_add_u32 s75, s74, 786432
  s_add_u32 s74, s74, 655360
  s_waitcnt vmcnt(16)
  v_lshlrev_b32 v15, 16, v15
  v_mul_f32 v16, 0xbfb8aa3b, v15
  v_exp_f32 v16, v16
  s_nop 0
  v_add_f32 v16, 1.0, v16
  v_rcp_f32 v16, v16
  s_nop 0
  v_mul_f32 v15, v15, v16
  v_cvt_pk_bf16_f32 v15, v15, v15
  ds_write_b16 v30, v15
  s_waitcnt vmcnt(12) lgkmcnt(0)
  s_barrier
  ds_read_b64_tr_b16 v[60:61], v35 offset:0
  ds_read_b64_tr_b16 v[62:63], v35 offset:2048
  ds_read_b128 v[76:79], v31 offset:0
  ds_read_b64_tr_b16 v[64:65], v35 offset:4096
  ds_read_b64_tr_b16 v[66:67], v35 offset:6144
  ds_read_b128 v[80:83], v31 offset:64
  ds_read_b64_tr_b16 v[68:69], v35 offset:8192
  ds_read_b64_tr_b16 v[70:71], v35 offset:10240
  ds_read_b128 v[84:87], v31 offset:128
  ds_read_b64_tr_b16 v[72:73], v35 offset:12288
  ds_read_b64_tr_b16 v[74:75], v35 offset:14336
  ds_read_b128 v[88:91], v31 offset:192
  s_waitcnt vmcnt(11)
  v_readfirstlane_b32 s46, v36
  s_nop 0
  s_add_u32 s46, s46, 8
  s_mul_i32 s52, s46, 0x13c6ef37
  v_mov_b32 v36, 0xff
  s_bfe_u32 s55, s52, 0x80000
  s_bfe_u32 s56, s52, 0x80008
  s_bfe_u32 s69, s52, 0x80010
  s_bfe_u32 s54, s52, 0x80018
  s_waitcnt lgkmcnt(9)
  v_mfma_f32_16x16x32_bf16 v[40:43], v[60:63], v[76:79], 0
  s_waitcnt lgkmcnt(6)
  v_mfma_f32_16x16x32_bf16 v[40:43], v[64:67], v[80:83], v[40:43]
  s_waitcnt lgkmcnt(3)
  v_mfma_f32_16x16x32_bf16 v[40:43], v[68:71], v[84:87], v[40:43]
  s_waitcnt lgkmcnt(0)
  v_mfma_f32_16x16x32_bf16 v[40:43], v[72:75], v[88:91], v[40:43]
  s_nop 7
  v_bfi_b32 v40, v36, s55, v40
  v_bfi_b32 v41, v36, s56, v41
  v_bfi_b32 v42, v36, s69, v42
  v_bfi_b32 v43, v36, s54, v43
  buffer_store_dwordx4 v[40:43], v32, s[8:11], s42 offen sc1
  s_add_u32 s52, s44, 3
  s_sub_u32 s53, 5, s52
  s_bitcmp1_b32 s2, 2
  s_cselect_b32 s52, s53, s52
  s_lshr_b32 s53, s52, 1
  s_lshl_b32 s53, s53, 11
  s_and_b32 s52, s52, 1
  s_lshr_b32 s57, s2, 3
  s_lshl_b32 s57, s57, 1
  s_add_u32 s52, s52, s57
  s_mul_i32 s52, s52, 98304
  s_add_u32 s52, s52, s53
  s_and_b32 s53, s2, 3
  s_lshl_b32 s53, s53, 9
  s_add_u32 s52, s52, s53
  s_cmp_lt_u32 s44, 3
  s_cselect_b32 s52, s52, 1073741824
  v_lshrrev_b32 v16, 2, v0
  v_mul_u32_u24 v16, 5632, v16
  v_lshl_add_u32 v16, v0, 7, v16
  buffer_load_dword a252, v16, s[12:15], s52 offen
  s_lshl_b32 s52, s50, 18
  s_add_u32 s52, s52, 1015808
  s_max_u32 s72, s52, 1048576
  s_lshr_b32 s53, s44, 1
  s_lshl_b32 s70, s53, 15
  s_add_u32 s52, s52, s70
  v_add_u32 v12, s52, v1
  s_lshl_b32 s53, s53, 11
  s_add_u32 s72, s72, s53
  s_lshl_b32 s70, s44, 12
  s_and_b32 s52, s70, 4096
  s_add_u32 s71, s52, s53
  s_and_b32 s52, s44, 1
  s_add_u32 s52, s52, s66
  s_add_u32 s58, s52, 0
  s_and_b32 s58, s58, 7
  s_lshl_b32 s58, s58, 12
  s_add_u32 s59, s52, 2
  s_and_b32 s59, s59, 7
  s_lshl_b32 s59, s59, 12
  s_add_u32 s60, s52, 4
  s_and_b32 s60, s60, 7
  s_lshl_b32 s60, s60, 12
  s_add_u32 s61, s52, 6
  s_and_b32 s61, s61, 7
  s_lshl_b32 s61, s61, 12
  s_lshl_b32 s52, s50, 4
  s_sub_u32 s52, s52, 2
  v_min_u32 v14, 17, v0
  v_add_u32 v14, s52, v14
  v_max_i32 v14, 0, v14
  v_lshlrev_b32 v14, 7, v14
  v_add_u32 v14, 786432, v14
  s_and_b32 s52, s2, 3
  s_lshl_b32 s52, s52, 8
  v_add_u32 v40, s52, v10
  v_mul_u32_u24 v40, 12288, v40
  s_lshr_b32 s53, s2, 2
  s_add_u32 s53, s53, 32
  s_lshl_b32 s53, s53, 7
  v_lshl_add_u32 v10, v10, 11, v11
  v_add3_u32 v11, v40, v11, s53
  s_and_b32 s52, s44, 1
  s_lshl_b32 s53, s50, 3
  s_add_u32 s53, s53, s52
  s_lshl_b32 s73, s53, 15
  s_lshl_b32 s53, s51, 1
  s_lshr_b32 s57, s44, 1
  s_add_u32 s53, s53, s57
  s_lshl_b32 s53, s53, 10
  s_add_u32 s73, s73, s53
  s_add_u32 s73, s73, 7340032
  s_mul_i32 s57, s57, 3072
  s_add_u32 s57, s57, 131072
  v_add_u32 v19, s57, v1
  s_lshl_b32 s53, s52, 3
  v_add_u32 v18, s53, v19
  s_lshl_b32 s53, s52, 10
  v_add_u32 v17, s53, v19
  v_lshrrev_b32 v40, 2, v0
  v_and_b32 v20, 3, v0
  v_lshl_add_u32 v40, v20, 4, v40
  v_lshl_add_u32 v20, v40, 4, s57
  s_mov_b32 s80, 0xfff0ffff
  s_mov_b32 s81, 0xf000ff00
  s_mov_b32 s82, 0xffe0fffe
  s_mov_b32 s83, 0xe000fe00
  s_mov_b32 s84, 0xffc0fffc
  s_mov_b32 s85, 0xc000fc00
  s_mov_b32 s86, 0xff80fff8
  s_mov_b32 s87, 0x8000f800
  s_mov_b32 s88, 0xaaaaaaaa
  s_mov_b32 s89, 0xaaaaaaaa
  s_mov_b32 s90, 0x000f0000
  s_mov_b32 s91, 0x0fff00ff
  s_mov_b32 s92, 0x003f0003
  s_mov_b32 s93, 0x3fff03ff
  v_mov_b32 v41, 0xffff
  v_mov_b32 v24, 0xffff0000
  v_cndmask_b32 v41, v41, v24, s[88:89]
  v_cndmask_b32 v24, 0, v41, s[90:91]
  v_cndmask_b32 v25, 0, v41, s[92:93]
  v_xor_b32 v26, v24, v41
  v_xor_b32 v27, v25, v41
  s_or_b32 s52, s52, s50
  s_cmp_eq_u32 s52, 0
  s_cselect_b64 s[90:91], s[90:91], 0
  s_cselect_b64 s[92:93], s[92:93], 0
  s_bfe_u32 s53, s2, 0x30003
  s_lshl_b32 s43, s53, 1
  s_and_b32 s52, s2, 1
  s_add_u32 s43, s43, s52
  s_and_b32 s79, s2, 4
  s_lshr_b32 s52, s2, 6
  s_add_u32 s79, s79, s52
  s_lshl_b32 s79, s79, 1
  s_add_u32 s67, s79, s53
  s_bfe_u32 s52, s2, 0x10001
  s_add_u32 s79, s79, s52
  s_and_b32 s52, s44, 1
  s_add_u32 s52, s52, s67
  s_add_u32 s62, s52, 0
  s_and_b32 s62, s62, 7
  s_lshl_b32 s62, s62, 12
  s_add_u32 s63, s52, 2
  s_and_b32 s63, s63, 7
  s_lshl_b32 s63, s63, 12
  s_add_u32 s64, s52, 4
  s_and_b32 s64, s64, 7
  s_lshl_b32 s64, s64, 12
  s_add_u32 s65, s52, 6
  s_and_b32 s65, s65, 7
  s_lshl_b32 s65, s65, 12
  s_lshl_b32 s52, s43, 7
  v_add_u32 v10, s52, v10
  s_lshl_b32 s52, s79, 18
  s_lshr_b32 s53, s44, 1
  s_lshl_b32 s53, s53, 15
  s_add_u32 s53, s52, s53
  s_add_u32 s78, s53, 7340032
  s_and_b32 s53, s44, 1
  s_lshl_b32 s53, s53, 15
  s_add_u32 s52, s52, s53
  s_lshl_b32 s53, s43, 1
  s_lshr_b32 s57, s44, 1
  s_add_u32 s53, s53, s57
  s_lshl_b32 s76, s53, 7
  s_lshl_b32 s53, s53, 10
  s_add_u32 s47, s52, s53
  s_lshr_b32 s53, s53, 1
  s_lshl_b32 s52, s79, 1
  s_and_b32 s57, s44, 1
  s_add_u32 s52, s52, s57
  s_lshl_b32 s52, s52, 14
  s_add_u32 s52, s52, s53
  s_add_u32 s48, s52, 6291456
  s_lshl_b32 s52, s79, 11
  s_lshl_b32 s53, s43, 7
  s_add_u32 s53, s53, s52
  s_lshl_b32 s57, s44, 28
  s_add_u32 s53, s53, s57
  s_add_u32 s49, s53, 753664
  s_add_u32 s77, s52, 655360
  s_lshl_b32 s53, s44, 4
  v_lshlrev_b32 v31, 6, v21
  v_add_u32 v31, 159744, v31
  v_add_u32 v30, s53, v31
  v_mov_b32 v34, 0x3f803f80
  v_mov_b32 v36, 0
  v_mov_b32 v37, 0
  v_mov_b32 v38, 0
  v_mov_b32 v39, 0
  s_waitcnt vmcnt(8)
  v_dot2c_f32_bf16 v36, v44, v34
  v_dot2c_f32_bf16 v37, v44, v44
  v_dot2c_f32_bf16 v38, v52, v34
  v_dot2c_f32_bf16 v39, v52, v52
  v_dot2c_f32_bf16 v36, v45, v34
  v_dot2c_f32_bf16 v37, v45, v45
  v_dot2c_f32_bf16 v38, v53, v34
  v_dot2c_f32_bf16 v39, v53, v53
  v_dot2c_f32_bf16 v36, v46, v34
  v_dot2c_f32_bf16 v37, v46, v46
  v_dot2c_f32_bf16 v38, v54, v34
  v_dot2c_f32_bf16 v39, v54, v54
  v_dot2c_f32_bf16 v36, v47, v34
  v_dot2c_f32_bf16 v37, v47, v47
  v_dot2c_f32_bf16 v38, v55, v34
  v_dot2c_f32_bf16 v39, v55, v55
  v_dot2c_f32_bf16 v36, v48, v34
  v_dot2c_f32_bf16 v37, v48, v48
  v_dot2c_f32_bf16 v38, v56, v34
  v_dot2c_f32_bf16 v39, v56, v56
  v_dot2c_f32_bf16 v36, v49, v34
  v_dot2c_f32_bf16 v37, v49, v49
  v_dot2c_f32_bf16 v38, v57, v34
  v_dot2c_f32_bf16 v39, v57, v57
  v_dot2c_f32_bf16 v36, v50, v34
  v_dot2c_f32_bf16 v37, v50, v50
  v_dot2c_f32_bf16 v38, v58, v34
  v_dot2c_f32_bf16 v39, v58, v58
  v_dot2c_f32_bf16 v36, v51, v34
  v_dot2c_f32_bf16 v37, v51, v51
  v_dot2c_f32_bf16 v38, v59, v34
  v_dot2c_f32_bf16 v39, v59, v59
  s_waitcnt vmcnt(3)
  v_dot2c_f32_bf16 v36, v92, v34
  v_dot2c_f32_bf16 v37, v92, v92
  v_dot2c_f32_bf16 v38, v100, v34
  v_dot2c_f32_bf16 v39, v100, v100
  v_dot2c_f32_bf16 v36, v93, v34
  v_dot2c_f32_bf16 v37, v93, v93
  v_dot2c_f32_bf16 v38, v101, v34
  v_dot2c_f32_bf16 v39, v101, v101
  v_dot2c_f32_bf16 v36, v94, v34
  v_dot2c_f32_bf16 v37, v94, v94
  v_dot2c_f32_bf16 v38, v102, v34
  v_dot2c_f32_bf16 v39, v102, v102
  v_dot2c_f32_bf16 v36, v95, v34
  v_dot2c_f32_bf16 v37, v95, v95
  v_dot2c_f32_bf16 v38, v103, v34
  v_dot2c_f32_bf16 v39, v103, v103
  v_dot2c_f32_bf16 v36, v96, v34
  v_dot2c_f32_bf16 v37, v96, v96
  v_dot2c_f32_bf16 v38, v104, v34
  v_dot2c_f32_bf16 v39, v104, v104
  v_dot2c_f32_bf16 v36, v97, v34
  v_dot2c_f32_bf16 v37, v97, v97
  v_dot2c_f32_bf16 v38, v105, v34
  v_dot2c_f32_bf16 v39, v105, v105
  v_dot2c_f32_bf16 v36, v98, v34
  v_dot2c_f32_bf16 v37, v98, v98
  v_dot2c_f32_bf16 v38, v106, v34
  v_dot2c_f32_bf16 v39, v106, v106
  v_dot2c_f32_bf16 v36, v99, v34
  v_dot2c_f32_bf16 v37, v99, v99
  v_dot2c_f32_bf16 v38, v107, v34
  v_dot2c_f32_bf16 v39, v107, v107
  s_nop 2
  v_add_f32_dpp v36, v36, v36 row_ror:8 row_mask:0xf bank_mask:0xf
  v_add_f32_dpp v37, v37, v37 row_ror:8 row_mask:0xf bank_mask:0xf
  v_add_f32_dpp v38, v38, v38 row_ror:8 row_mask:0xf bank_mask:0xf
  v_add_f32_dpp v39, v39, v39 row_ror:8 row_mask:0xf bank_mask:0xf
  v_mov_b32 v40, v36
  v_mov_b32 v41, v37
  v_mov_b32 v42, v38
  v_mov_b32 v43, v39
  v_permlane16_swap_b32 v36, v40
  v_permlane16_swap_b32 v37, v41
  v_permlane16_swap_b32 v38, v42
  v_permlane16_swap_b32 v39, v43
  v_add_f32 v36, v36, v40
  v_add_f32 v37, v37, v41
  v_add_f32 v38, v38, v42
  v_add_f32 v39, v39, v43
  v_mov_b32 v40, v36
  v_mov_b32 v41, v37
  v_mov_b32 v42, v38
  v_mov_b32 v43, v39
  v_permlane32_swap_b32 v36, v40
  v_permlane32_swap_b32 v37, v41
  v_permlane32_swap_b32 v38, v42
  v_permlane32_swap_b32 v39, v43
  v_add_f32 v36, v36, v40
  v_add_f32 v37, v37, v41
  v_add_f32 v38, v38, v42
  v_add_f32 v39, v39, v43
  ds_write_b128 v30, v[36:39]
  v_lshlrev_b32 v60, 16, v44
  v_and_b32 v61, 0xffff0000, v44
  v_lshlrev_b32 v62, 16, v45
  v_and_b32 v63, 0xffff0000, v45
  v_lshlrev_b32 v64, 16, v46
  v_and_b32 v65, 0xffff0000, v46
  v_lshlrev_b32 v66, 16, v47
  v_and_b32 v67, 0xffff0000, v47
  v_lshlrev_b32 v68, 16, v48
  v_and_b32 v69, 0xffff0000, v48
  v_lshlrev_b32 v70, 16, v49
  v_and_b32 v71, 0xffff0000, v49
  v_lshlrev_b32 v72, 16, v50
  v_and_b32 v73, 0xffff0000, v50
  v_lshlrev_b32 v74, 16, v51
  v_and_b32 v75, 0xffff0000, v51
  v_lshlrev_b32 v76, 16, v52
  v_and_b32 v77, 0xffff0000, v52
  v_lshlrev_b32 v78, 16, v53
  v_and_b32 v79, 0xffff0000, v53
  v_lshlrev_b32 v80, 16, v54
  v_and_b32 v81, 0xffff0000, v54
  v_lshlrev_b32 v82, 16, v55
  v_and_b32 v83, 0xffff0000, v55
  v_lshlrev_b32 v84, 16, v56
  v_and_b32 v85, 0xffff0000, v56
  v_lshlrev_b32 v86, 16, v57
  v_and_b32 v87, 0xffff0000, v57
  v_lshlrev_b32 v88, 16, v58
  v_and_b32 v89, 0xffff0000, v58
  v_lshlrev_b32 v90, 16, v59
  v_and_b32 v91, 0xffff0000, v59
  s_waitcnt lgkmcnt(0)
  s_barrier
  ds_read_b128 v[92:95], v31 offset:0
  ds_read_b128 v[96:99], v31 offset:16
  ds_read_b128 v[100:103], v31 offset:32
  ds_read_b128 v[104:107], v31 offset:48
  v_permlane16_swap_b32 v44, v46
  v_permlane16_swap_b32 v45, v47
  v_permlane16_swap_b32 v48, v50
  v_permlane16_swap_b32 v49, v51
  v_permlane16_swap_b32 v52, v54
  v_permlane16_swap_b32 v53, v55
  v_permlane16_swap_b32 v56, v58
  v_permlane16_swap_b32 v57, v59
  v_bfe_u32 v36, v0, 3, 1
  v_lshlrev_b32 v28, 9, v36
  v_bfe_u32 v36, v0, 4, 1
  v_lshl_add_u32 v28, v36, 8, v28
  v_lshrrev_b32 v34, 5, v0
  v_lshl_add_u32 v28, v34, 10, v28
  v_lshl_add_u32 v28, v21, 4, v28
  v_and_b32 v29, 31, v0
  v_lshlrev_b32 v29, 4, v29
  v_lshl_add_u32 v29, v34, 12, v29
  v_cvt_f32_u32 v34, v34
  s_add_u32 s53, s45, 151552
  v_add_u32 v32, s53, v1
  v_lshl_add_u32 v33, v22, 5, s53
  v_lshlrev_b32 v36, 14, v36
  v_and_b32 v35, 15, v0
  v_lshl_add_u32 v35, v35, 7, v36
  s_waitcnt lgkmcnt(0)
  v_add_f32 v92, v92, v100
  v_add_f32 v93, v93, v101
  v_add_f32 v94, v94, v102
  v_add_f32 v95, v95, v103
  v_add_f32 v96, v96, v104
  v_add_f32 v97, v97, v105
  v_add_f32 v98, v98, v106
  v_add_f32 v99, v99, v107
  v_add_f32 v92, v92, v96
  v_add_f32 v93, v93, v97
  v_add_f32 v94, v94, v98
  v_add_f32 v95, v95, v99
  v_mul_f32 v92, 0x3a800000, v92
  v_mul_f32 v94, 0x3a800000, v94
  v_mul_f32 v93, 0x3a800000, v93
  v_mul_f32 v95, 0x3a800000, v95
  v_fma_f32 v93, -v92, v92, v93
  v_fma_f32 v95, -v94, v94, v95
  v_max_f32 v93, 0, v93
  v_max_f32 v95, 0, v95
  v_cvt_pk_bf16_f32 v93, v93, v93
  v_cvt_pk_bf16_f32 v95, v95, v95
  v_lshlrev_b32 v93, 16, v93
  v_lshlrev_b32 v95, 16, v95
  v_add_f32 v93, 0x3727c5ac, v93
  v_add_f32 v95, 0x3727c5ac, v95
  v_cvt_pk_bf16_f32 v93, v93, v93
  v_cvt_pk_bf16_f32 v95, v95, v95
  v_lshlrev_b32 v93, 16, v93
  v_lshlrev_b32 v95, 16, v95
  v_sqrt_f32 v93, v93
  v_sqrt_f32 v95, v95
  v_cvt_pk_bf16_f32 v92, v92, v92
  v_cvt_pk_bf16_f32 v94, v94, v94
  v_lshlrev_b32 v92, 16, v92
  v_lshlrev_b32 v94, 16, v94
  v_cvt_pk_bf16_f32 v93, v93, v93
  v_cvt_pk_bf16_f32 v95, v95, v95
  v_lshlrev_b32 v93, 16, v93
  v_lshlrev_b32 v95, 16, v95
  v_rcp_f32 v93, v93
  v_rcp_f32 v95, v95
  v_mul_f32 v92, v92, v93
  v_mul_f32 v94, v94, v95
  v_fma_f32 v60, v60, v93, -v92
  v_fma_f32 v61, v61, v93, -v92
  v_fma_f32 v62, v62, v93, -v92
  v_fma_f32 v63, v63, v93, -v92
  v_fma_f32 v64, v64, v93, -v92
  v_fma_f32 v65, v65, v93, -v92
  v_fma_f32 v66, v66, v93, -v92
  v_fma_f32 v67, v67, v93, -v92
  v_fma_f32 v68, v68, v93, -v92
  v_fma_f32 v69, v69, v93, -v92
  v_fma_f32 v70, v70, v93, -v92
  v_fma_f32 v71, v71, v93, -v92
  v_fma_f32 v72, v72, v93, -v92
  v_fma_f32 v73, v73, v93, -v92
  v_fma_f32 v74, v74, v93, -v92
  v_fma_f32 v75, v75, v93, -v92
  v_fma_f32 v76, v76, v95, -v94
  v_fma_f32 v77, v77, v95, -v94
  v_fma_f32 v78, v78, v95, -v94
  v_fma_f32 v79, v79, v95, -v94
  v_fma_f32 v80, v80, v95, -v94
  v_fma_f32 v81, v81, v95, -v94
  v_fma_f32 v82, v82, v95, -v94
  v_fma_f32 v83, v83, v95, -v94
  v_fma_f32 v84, v84, v95, -v94
  v_fma_f32 v85, v85, v95, -v94
  v_fma_f32 v86, v86, v95, -v94
  v_fma_f32 v87, v87, v95, -v94
  v_fma_f32 v88, v88, v95, -v94
  v_fma_f32 v89, v89, v95, -v94
  v_fma_f32 v90, v90, v95, -v94
  v_fma_f32 v91, v91, v95, -v94
  s_waitcnt vmcnt(12)
  v_lshlrev_b32 v15, 16, v23
  v_mul_f32 v16, 0xbfb8aa3b, v15
  v_exp_f32 v16, v16
  v_lshrrev_b32 v21, 5, v0
  v_add_f32 v16, 1.0, v16
  v_rcp_f32 v16, v16
  v_lshlrev_b32 v21, 6, v21
  v_mul_f32 v15, v15, v16
  v_cvt_pk_bf16_f32 v16, v15, v15
  v_bfe_u32 v15, v0, 2, 2
  v_lshl_add_u32 v21, v15, 4, v21
  v_bfe_u32 v15, v0, 4, 1
  v_lshl_add_u32 v21, v15, 3, v21
  v_and_b32 v15, 3, v0
  v_lshl_add_u32 v21, v15, 1, v21
  s_lshl_b32 s53, s44, 7
  s_add_u32 s53, s53, 149504
  v_add_u32 v21, s53, v21
  s_mov_b64 exec, 0
  s_cmp_eq_u32 s44, 0
  s_cbranch_scc1 HOP0
  s_cmp_eq_u32 s44, 1
  s_cbranch_scc1 HOP1
  s_cmp_eq_u32 s44, 2
  s_cbranch_scc1 HOP2
  s_cmp_eq_u32 s44, 3
  s_cbranch_scc1 HOP3
WRET0:
  s_mov_b64 exec, -1
  s_add_u32 s52, s34, 0
  buffer_load_dwordx4 v[92:95], v29, s[8:11], s52 offen sc1
  s_add_u32 s52, s34, 8192
  buffer_load_dwordx4 v[96:99], v29, s[8:11], s52 offen sc1
  s_add_u32 s52, s34, 16384
  buffer_load_dwordx4 v[100:103], v29, s[8:11], s52 offen sc1
  s_add_u32 s52, s34, 24576
  buffer_load_dwordx4 v[104:107], v29, s[8:11], s52 offen sc1
  s_add_u32 s52, s34, 32768
  buffer_load_dwordx4 v[108:111], v29, s[8:11], s52 offen sc1
  s_add_u32 s52, s34, 40960
  buffer_load_dwordx4 v[112:115], v29, s[8:11], s52 offen sc1
  s_add_u32 s52, s34, 49152
  buffer_load_dwordx4 v[116:119], v29, s[8:11], s52 offen sc1
  s_add_u32 s52, s34, 57344
  buffer_load_dwordx4 v[120:123], v29, s[8:11], s52 offen sc1
  s_add_u32 m0, s45, 0
  s_add_u32 s68, s66, 0
  s_and_b32 s68, s68, 7
  s_mul_i32 s68, s68, 786432
  buffer_load_dwordx4 v9, s[12:15], s68 offen lds
  s_add_u32 m0, s45, 4096
  s_add_u32 s68, s68, 196608
  buffer_load_dwordx4 v9, s[12:15], s68 offen lds
  s_add_u32 m0, s45, 8192
  s_add_u32 s68, s68, 196608
  buffer_load_dwordx4 v9, s[12:15], s68 offen lds
  s_add_u32 m0, s45, 12288
  s_add_u32 s68, s68, 196608
  buffer_load_dwordx4 v9, s[12:15], s68 offen lds
  s_add_u32 m0, s45, 16384
  s_add_u32 s68, s66, 1
  s_and_b32 s68, s68, 7
  s_mul_i32 s68, s68, 786432
  buffer_load_dwordx4 v9, s[12:15], s68 offen lds
  s_add_u32 m0, s45, 20480
  s_add_u32 s68, s68, 196608
  buffer_load_dwordx4 v9, s[12:15], s68 offen lds
  s_add_u32 m0, s45, 24576
  s_add_u32 s68, s68, 196608
  buffer_load_dwordx4 v9, s[12:15], s68 offen lds
  s_add_u32 m0, s45, 28672
  s_add_u32 s68, s68, 196608
  buffer_load_dwordx4 v9, s[12:15], s68 offen lds
  s_mov_b32 s57, 20000
  s_branch MT2_adaLN_cond__sliding_local_dilated__swiglu_ffn__prompt_kernelt
MT2_adaLN_cond__sliding_local_dilated__swiglu_ffn__prompt_kernel:
  s_add_u32 s52, s34, 0
  buffer_load_dwordx4 v[92:95], v29, s[8:11], s52 offen sc1
  s_add_u32 s52, s34, 8192
  buffer_load_dwordx4 v[96:99], v29, s[8:11], s52 offen sc1
  s_add_u32 s52, s34, 16384
  buffer_load_dwordx4 v[100:103], v29, s[8:11], s52 offen sc1
  s_add_u32 s52, s34, 24576
  buffer_load_dwordx4 v[104:107], v29, s[8:11], s52 offen sc1
  s_add_u32 s52, s34, 32768
  buffer_load_dwordx4 v[108:111], v29, s[8:11], s52 offen sc1
  s_add_u32 s52, s34, 40960
  buffer_load_dwordx4 v[112:115], v29, s[8:11], s52 offen sc1
  s_add_u32 s52, s34, 49152
  buffer_load_dwordx4 v[116:119], v29, s[8:11], s52 offen sc1
  s_add_u32 s52, s34, 57344
  buffer_load_dwordx4 v[120:123], v29, s[8:11], s52 offen sc1
  s_waitcnt vmcnt(0)
MT2_adaLN_cond__sliding_local_dilated__swiglu_ffn__prompt_kernelt:
  s_waitcnt vmcnt(15)
  v_xor_b32 v92, s55, v92
  v_xor_b32 v93, s56, v93
  v_xor_b32 v94, s69, v94
  v_xor_b32 v95, s54, v95
  v_or3_b32 v36, v92, v93, 0
  v_or3_b32 v36, v94, v95, v36
  s_waitcnt vmcnt(14)
  v_xor_b32 v96, s55, v96
  v_xor_b32 v97, s56, v97
  v_xor_b32 v98, s69, v98
  v_xor_b32 v99, s54, v99
  v_or3_b32 v36, v96, v97, v36
  v_or3_b32 v36, v98, v99, v36
  s_waitcnt vmcnt(13)
  v_xor_b32 v100, s55, v100
  v_xor_b32 v101, s56, v101
  v_xor_b32 v102, s69, v102
  v_xor_b32 v103, s54, v103
  v_or3_b32 v36, v100, v101, v36
  v_or3_b32 v36, v102, v103, v36
  s_waitcnt vmcnt(12)
  v_xor_b32 v104, s55, v104
  v_xor_b32 v105, s56, v105
  v_xor_b32 v106, s69, v106
  v_xor_b32 v107, s54, v107
  v_or3_b32 v36, v104, v105, v36
  v_or3_b32 v36, v106, v107, v36
  s_waitcnt vmcnt(11)
  v_xor_b32 v108, s55, v108
  v_xor_b32 v109, s56, v109
  v_xor_b32 v110, s69, v110
  v_xor_b32 v111, s54, v111
  v_or3_b32 v36, v108, v109, v36
  v_or3_b32 v36, v110, v111, v36
  s_waitcnt vmcnt(10)
  v_xor_b32 v112, s55, v112
  v_xor_b32 v113, s56, v113
  v_xor_b32 v114, s69, v114
  v_xor_b32 v115, s54, v115
  v_or3_b32 v36, v112, v113, v36
  v_or3_b32 v36, v114, v115, v36
  s_waitcnt vmcnt(9)
  v_xor_b32 v116, s55, v116
  v_xor_b32 v117, s56, v117
  v_xor_b32 v118, s69, v118
  v_xor_b32 v119, s54, v119
  v_or3_b32 v36, v116, v117, v36
  v_or3_b32 v36, v118, v119, v36
  s_waitcnt vmcnt(8)
  v_xor_b32 v120, s55, v120
  v_xor_b32 v121, s56, v121
  v_xor_b32 v122, s69, v122
  v_xor_b32 v123, s54, v123
  v_or3_b32 v36, v120, v121, v36
  v_or3_b32 v36, v122, v123, v36
  v_and_b32 v36, 0xff, v36
  v_cmp_ne_u32 vcc, 0, v36
  s_sub_u32 s57, s57, 1
  s_cmp_eq_u32 s57, 0
  s_cbranch_scc1 MT2_adaLN_cond__sliding_local_dilated__swiglu_ffn__prompt_kernelx
  s_nop 1
  s_cbranch_vccnz MT2_adaLN_cond__sliding_local_dilated__swiglu_ffn__prompt_kernel
MT2_adaLN_cond__sliding_local_dilated__swiglu_ffn__prompt_kernelx:
  s_waitcnt vmcnt(14)
  v_pk_add_f32 v[92:93], v[92:93], v[96:97]
  v_pk_add_f32 v[94:95], v[94:95], v[98:99]
  s_waitcnt vmcnt(13)
  v_pk_add_f32 v[92:93], v[92:93], v[100:101]
  v_pk_add_f32 v[94:95], v[94:95], v[102:103]
  s_waitcnt vmcnt(12)
  v_pk_add_f32 v[92:93], v[92:93], v[104:105]
  v_pk_add_f32 v[94:95], v[94:95], v[106:107]
  s_waitcnt vmcnt(11)
  v_pk_add_f32 v[92:93], v[92:93], v[108:109]
  v_pk_add_f32 v[94:95], v[94:95], v[110:111]
  s_waitcnt vmcnt(10)
  v_pk_add_f32 v[92:93], v[92:93], v[112:113]
  v_pk_add_f32 v[94:95], v[94:95], v[114:115]
  s_waitcnt vmcnt(9)
  v_pk_add_f32 v[92:93], v[92:93], v[116:117]
  v_pk_add_f32 v[94:95], v[94:95], v[118:119]
  s_waitcnt vmcnt(8)
  v_pk_add_f32 v[92:93], v[92:93], v[120:121]
HOP0:
  s_cbranch_execz HOP4
  v_pk_add_f32 v[94:95], v[94:95], v[122:123]
  v_cvt_pk_bf16_f32 v96, v92, v93
  v_cvt_pk_bf16_f32 v97, v94, v95
  v_lshlrev_b32 v92, 16, v96
  v_and_b32 v93, 0xffff0000, v96
  v_lshlrev_b32 v94, 16, v97
  v_and_b32 v95, 0xffff0000, v97
  v_add_f32 v92, v34, v92
  v_add_f32 v93, v34, v93
  v_add_f32 v94, v34, v94
  v_add_f32 v95, v34, v95
  v_cvt_pk_bf16_f32 v96, v92, v93
  v_cvt_pk_bf16_f32 v97, v94, v95
  v_lshlrev_b32 v92, 16, v96
  v_and_b32 v93, 0xffff0000, v96
  v_lshlrev_b32 v94, 16, v97
  v_and_b32 v95, 0xffff0000, v97
  ds_write_b128 v32, v[92:95]
  ds_read_b128 v[92:95], v33 offset:512
  ds_read_b128 v[108:111], v33 offset:0
  ds_read_b128 v[96:99], v33 offset:528
  ds_read_b128 v[112:115], v33 offset:16
  ds_read_b128 v[100:103], v33 offset:768
  ds_read_b128 v[116:119], v33 offset:256
  ds_read_b128 v[104:107], v33 offset:784
  ds_read_b128 v[120:123], v33 offset:272
  s_waitcnt lgkmcnt(4)
  v_pk_fma_f32 v[60:61], v[60:61], v[92:93], v[108:109]
  v_pk_fma_f32 v[62:63], v[62:63], v[94:95], v[110:111]
  v_pk_fma_f32 v[64:65], v[64:65], v[96:97], v[112:113]
  v_pk_fma_f32 v[66:67], v[66:67], v[98:99], v[114:115]
  v_pk_fma_f32 v[76:77], v[76:77], v[92:93], v[108:109]
  v_pk_fma_f32 v[78:79], v[78:79], v[94:95], v[110:111]
  v_pk_fma_f32 v[80:81], v[80:81], v[96:97], v[112:113]
  v_pk_fma_f32 v[82:83], v[82:83], v[98:99], v[114:115]
  v_cvt_pk_bf16_f32 v60, v60, v61
  v_cvt_pk_bf16_f32 v61, v62, v63
  v_cvt_pk_bf16_f32 v62, v64, v65
  v_cvt_pk_bf16_f32 v63, v66, v67
  v_cvt_pk_bf16_f32 v76, v76, v77
  v_cvt_pk_bf16_f32 v77, v78, v79
  v_cvt_pk_bf16_f32 v78, v80, v81
  v_cvt_pk_bf16_f32 v79, v82, v83
  v_permlane16_swap_b32 v60, v62
  v_permlane16_swap_b32 v61, v63
  buffer_store_dwordx4 v[60:63], v28, s[8:11], s38 offen offset:0 sc1
  v_permlane16_swap_b32 v76, v78
  v_permlane16_swap_b32 v77, v79
  buffer_store_dwordx4 v[76:79], v28, s[8:11], s38 offen offset:128 sc1
  s_waitcnt lgkmcnt(0)
  v_pk_fma_f32 v[68:69], v[68:69], v[100:101], v[116:117]
  v_pk_fma_f32 v[70:71], v[70:71], v[102:103], v[118:119]
  v_pk_fma_f32 v[72:73], v[72:73], v[104:105], v[120:121]
  v_pk_fma_f32 v[74:75], v[74:75], v[106:107], v[122:123]
  v_pk_fma_f32 v[84:85], v[84:85], v[100:101], v[116:117]
  v_pk_fma_f32 v[86:87], v[86:87], v[102:103], v[118:119]
  v_pk_fma_f32 v[88:89], v[88:89], v[104:105], v[120:121]
  v_pk_fma_f32 v[90:91], v[90:91], v[106:107], v[122:123]
  v_cvt_pk_bf16_f32 v68, v68, v69
  v_cvt_pk_bf16_f32 v69, v70, v71
  v_cvt_pk_bf16_f32 v70, v72, v73
  v_cvt_pk_bf16_f32 v71, v74, v75
  v_cvt_pk_bf16_f32 v84, v84, v85
  v_cvt_pk_bf16_f32 v85, v86, v87
  v_cvt_pk_bf16_f32 v86, v88, v89
  v_cvt_pk_bf16_f32 v87, v90, v91
  v_permlane16_swap_b32 v68, v70
  v_permlane16_swap_b32 v69, v71
  buffer_store_dwordx4 v[68:71], v28, s[8:11], s38 offen offset:2048 sc1
  v_permlane16_swap_b32 v84, v86
  v_permlane16_swap_b32 v85, v87
  buffer_store_dwordx4 v[84:87], v28, s[8:11], s38 offen offset:2176 sc1
  buffer_store_dwordx4 v[44:47], v28, s[8:11], s39 offen offset:0 sc1
  buffer_store_dwordx4 v[48:51], v28, s[8:11], s39 offen offset:2048 sc1
  buffer_store_dwordx4 v[52:55], v28, s[8:11], s39 offen offset:128 sc1
  buffer_store_dwordx4 v[56:59], v28, s[8:11], s39 offen offset:2176 sc1
  s_add_u32 m0, s45, 32768
  s_add_u32 s68, s66, 0
  s_and_b32 s68, s68, 7
  s_mul_i32 s68, s68, 786432
  s_add_u32 s68, s68, 2048
  buffer_load_dwordx4 v9, s[12:15], s68 offen lds
  s_add_u32 m0, s45, 36864
  s_add_u32 s68, s68, 196608
  buffer_load_dwordx4 v9, s[12:15], s68 offen lds
  s_add_u32 m0, s45, 40960
  s_add_u32 s68, s68, 196608
  buffer_load_dwordx4 v9, s[12:15], s68 offen lds
  s_add_u32 m0, s45, 45056
  s_add_u32 s68, s68, 196608
  buffer_load_dwordx4 v9, s[12:15], s68 offen lds
  s_add_u32 m0, s45, 49152
  s_add_u32 s68, s66, 0
  s_and_b32 s68, s68, 7
  s_mul_i32 s68, s68, 786432
  s_add_u32 s68, s68, 4096
  buffer_load_dwordx4 v9, s[12:15], s68 offen lds
  s_add_u32 m0, s45, 53248
  s_add_u32 s68, s68, 196608
  buffer_load_dwordx4 v9, s[12:15], s68 offen lds
  s_add_u32 m0, s45, 57344
  s_add_u32 s68, s68, 196608
  buffer_load_dwordx4 v9, s[12:15], s68 offen lds
  s_add_u32 m0, s45, 61440
  s_add_u32 s68, s68, 196608
  buffer_load_dwordx4 v9, s[12:15], s68 offen lds
  v_add_u32 v15, s46, v0
  s_waitcnt vmcnt(12)
  s_barrier
  s_mov_b64 exec, 1
  buffer_store_dword v15, v0, s[8:11], s75 offen offset:0 sc1
  s_mov_b64 exec, -1
  s_waitcnt vmcnt(17) lgkmcnt(0)
  s_barrier
  s_add_u32 m0, s45, 65536
  s_add_u32 s68, s66, 1
  s_and_b32 s68, s68, 7
  s_mul_i32 s68, s68, 786432
  s_add_u32 s68, s68, 2048
  buffer_load_dwordx4 v9, s[12:15], s68 offen lds
  ds_read_b64_tr_b16 a[0:1], v3 offset:0
  ds_read_b64_tr_b16 a[2:3], v3 offset:2048
  s_add_u32 m0, s45, 69632
  s_add_u32 s68, s68, 196608
  buffer_load_dwordx4 v9, s[12:15], s68 offen lds
  ds_read_b64_tr_b16 a[12:13], v3 offset:4096
  ds_read_b64_tr_b16 a[14:15], v3 offset:6144
  s_add_u32 m0, s45, 73728
  s_add_u32 s68, s68, 196608
  buffer_load_dwordx4 v9, s[12:15], s68 offen lds
  ds_read_b64_tr_b16 a[24:25], v3 offset:8192
  ds_read_b64_tr_b16 a[26:27], v3 offset:10240
  s_add_u32 m0, s45, 77824
  s_add_u32 s68, s68, 196608
  buffer_load_dwordx4 v9, s[12:15], s68 offen lds
  ds_read_b64_tr_b16 a[36:37], v3 offset:12288
  ds_read_b64_tr_b16 a[38:39], v3 offset:14336
  s_add_u32 m0, s45, 81920
  s_add_u32 s68, s66, 1
  s_and_b32 s68, s68, 7
  s_mul_i32 s68, s68, 786432
  s_add_u32 s68, s68, 4096
  buffer_load_dwordx4 v9, s[12:15], s68 offen lds
  ds_read_b64_tr_b16 a[48:49], v3 offset:16384
  ds_read_b64_tr_b16 a[50:51], v3 offset:18432
  s_add_u32 m0, s45, 86016
  s_add_u32 s68, s68, 196608
  buffer_load_dwordx4 v9, s[12:15], s68 offen lds
  ds_read_b64_tr_b16 a[60:61], v3 offset:20480
  ds_read_b64_tr_b16 a[62:63], v3 offset:22528
  s_add_u32 m0, s45, 90112
  s_add_u32 s68, s68, 196608
  buffer_load_dwordx4 v9, s[12:15], s68 offen lds
  ds_read_b64_tr_b16 a[72:73], v3 offset:24576
  ds_read_b64_tr_b16 a[74:75], v3 offset:26624
  s_add_u32 m0, s45, 94208
  s_add_u32 s68, s68, 196608
  buffer_load_dwordx4 v9, s[12:15], s68 offen lds
  ds_read_b64_tr_b16 a[84:85], v3 offset:28672
  ds_read_b64_tr_b16 a[86:87], v3 offset:30720
  s_add_u32 m0, s45, 98304
  s_add_u32 s68, s66, 2
  s_and_b32 s68, s68, 7
  s_mul_i32 s68, s68, 786432
  buffer_load_dwordx4 v9, s[12:15], s68 offen lds
  s_add_u32 m0, s45, 102400
  s_add_u32 s68, s68, 196608
  buffer_load_dwordx4 v9, s[12:15], s68 offen lds
  s_add_u32 m0, s45, 106496
  s_add_u32 s68, s68, 196608
  buffer_load_dwordx4 v9, s[12:15], s68 offen lds
  s_add_u32 m0, s45, 110592
  s_add_u32 s68, s68, 196608
  buffer_load_dwordx4 v9, s[12:15], s68 offen lds
  s_add_u32 m0, s45, 114688
  s_add_u32 s68, s66, 3
  s_and_b32 s68, s68, 7
  s_mul_i32 s68, s68, 786432
  buffer_load_dwordx4 v9, s[12:15], s68 offen lds
  s_add_u32 m0, s45, 118784
  s_add_u32 s68, s68, 196608
  buffer_load_dwordx4 v9, s[12:15], s68 offen lds
  s_add_u32 m0, s45, 122880
  s_add_u32 s68, s68, 196608
  buffer_load_dwordx4 v9, s[12:15], s68 offen lds
  s_add_u32 m0, s45, 126976
  s_add_u32 s68, s68, 196608
  buffer_load_dwordx4 v9, s[12:15], s68 offen lds
  s_waitcnt vmcnt(17) lgkmcnt(0)
  s_barrier
  s_add_u32 m0, s45, 0
  s_add_u32 s68, s66, 2
  s_and_b32 s68, s68, 7
  s_mul_i32 s68, s68, 786432
  s_add_u32 s68, s68, 2048
  buffer_load_dwordx4 v9, s[12:15], s68 offen lds
  ds_read_b64_tr_b16 a[4:5], v4 offset:32768
  ds_read_b64_tr_b16 a[6:7], v4 offset:34816
  s_add_u32 m0, s45, 4096
  s_add_u32 s68, s68, 196608
  buffer_load_dwordx4 v9, s[12:15], s68 offen lds
  ds_read_b64_tr_b16 a[8:9], v5 offset:32768
  ds_read_b64_tr_b16 a[10:11], v5 offset:34816
  s_add_u32 m0, s45, 8192
  s_add_u32 s68, s68, 196608
  buffer_load_dwordx4 v9, s[12:15], s68 offen lds
  ds_read_b64_tr_b16 a[16:17], v4 offset:36864
  ds_read_b64_tr_b16 a[18:19], v4 offset:38912
  s_add_u32 m0, s45, 12288
  s_add_u32 s68, s68, 196608
  buffer_load_dwordx4 v9, s[12:15], s68 offen lds
  ds_read_b64_tr_b16 a[20:21], v5 offset:36864
  ds_read_b64_tr_b16 a[22:23], v5 offset:38912
  s_add_u32 m0, s45, 16384
  s_add_u32 s68, s66, 2
  s_and_b32 s68, s68, 7
  s_mul_i32 s68, s68, 786432
  s_add_u32 s68, s68, 4096
  buffer_load_dwordx4 v9, s[12:15], s68 offen lds
  ds_read_b64_tr_b16 a[28:29], v4 offset:40960
  ds_read_b64_tr_b16 a[30:31], v4 offset:43008
  s_add_u32 m0, s45, 20480
  s_add_u32 s68, s68, 196608
  buffer_load_dwordx4 v9, s[12:15], s68 offen lds
  ds_read_b64_tr_b16 a[32:33], v5 offset:40960
  ds_read_b64_tr_b16 a[34:35], v5 offset:43008
  s_add_u32 m0, s45, 24576
  s_add_u32 s68, s68, 196608
  buffer_load_dwordx4 v9, s[12:15], s68 offen lds
  ds_read_b64_tr_b16 a[40:41], v4 offset:45056
  ds_read_b64_tr_b16 a[42:43], v4 offset:47104
  s_add_u32 m0, s45, 28672
  s_add_u32 s68, s68, 196608
  buffer_load_dwordx4 v9, s[12:15], s68 offen lds
  ds_read_b64_tr_b16 a[44:45], v5 offset:45056
  ds_read_b64_tr_b16 a[46:47], v5 offset:47104
  s_waitcnt vmcnt(16) lgkmcnt(0)
  s_barrier
  s_add_u32 m0, s45, 32768
  s_add_u32 s68, s66, 3
  s_and_b32 s68, s68, 7
  s_mul_i32 s68, s68, 786432
  s_add_u32 s68, s68, 2048
  buffer_load_dwordx4 v9, s[12:15], s68 offen lds
  ds_read_b64_tr_b16 a[52:53], v7 offset:0
  ds_read_b64_tr_b16 a[54:55], v7 offset:2048
  s_add_u32 m0, s45, 36864
  s_add_u32 s68, s68, 196608
  buffer_load_dwordx4 v9, s[12:15], s68 offen lds
  ds_read_b64_tr_b16 a[56:57], v8 offset:0
  ds_read_b64_tr_b16 a[58:59], v8 offset:2048
  s_add_u32 m0, s45, 40960
  s_add_u32 s68, s68, 196608
  buffer_load_dwordx4 v9, s[12:15], s68 offen lds
  ds_read_b64_tr_b16 a[64:65], v7 offset:4096
  ds_read_b64_tr_b16 a[66:67], v7 offset:6144
  s_add_u32 m0, s45, 45056
  s_add_u32 s68, s68, 196608
  buffer_load_dwordx4 v9, s[12:15], s68 offen lds
  ds_read_b64_tr_b16 a[68:69], v8 offset:4096
  ds_read_b64_tr_b16 a[70:71], v8 offset:6144
  s_add_u32 m0, s45, 49152
  s_add_u32 s68, s66, 3
  s_and_b32 s68, s68, 7
  s_mul_i32 s68, s68, 786432
  s_add_u32 s68, s68, 4096
  buffer_load_dwordx4 v9, s[12:15], s68 offen lds
  ds_read_b64_tr_b16 a[76:77], v7 offset:8192
  ds_read_b64_tr_b16 a[78:79], v7 offset:10240
  s_add_u32 m0, s45, 53248
  s_add_u32 s68, s68, 196608
  buffer_load_dwordx4 v9, s[12:15], s68 offen lds
  ds_read_b64_tr_b16 a[80:81], v8 offset:8192
  ds_read_b64_tr_b16 a[82:83], v8 offset:10240
  s_add_u32 m0, s45, 57344
  s_add_u32 s68, s68, 196608
  buffer_load_dwordx4 v9, s[12:15], s68 offen lds
  ds_read_b64_tr_b16 a[88:89], v7 offset:12288
  ds_read_b64_tr_b16 a[90:91], v7 offset:14336
  s_add_u32 m0, s45, 61440
  s_add_u32 s68, s68, 196608
  buffer_load_dwordx4 v9, s[12:15], s68 offen lds
  ds_read_b64_tr_b16 a[92:93], v8 offset:12288
  ds_read_b64_tr_b16 a[94:95], v8 offset:14336
  s_lshl_b32 s57, s44, 28
  buffer_load_dword v36, v14, s[8:11], s57 offen sc1
  s_waitcnt vmcnt(17) lgkmcnt(0)
  s_barrier
  s_add_u32 m0, s45, 65536
  s_add_u32 s68, s66, 4
  s_and_b32 s68, s68, 7
  s_mul_i32 s68, s68, 786432
  buffer_load_dwordx4 v9, s[12:15], s68 offen lds
  ds_read_b64_tr_b16 a[96:97], v6 offset:32768
  ds_read_b64_tr_b16 a[98:99], v6 offset:34816
  s_add_u32 m0, s45, 69632
  s_add_u32 s68, s68, 196608
  buffer_load_dwordx4 v9, s[12:15], s68 offen lds
  ds_read_b64_tr_b16 a[108:109], v6 offset:36864
  ds_read_b64_tr_b16 a[110:111], v6 offset:38912
  s_add_u32 m0, s45, 73728
  s_add_u32 s68, s68, 196608
  buffer_load_dwordx4 v9, s[12:15], s68 offen lds
  ds_read_b64_tr_b16 a[120:121], v6 offset:40960
  ds_read_b64_tr_b16 a[122:123], v6 offset:43008
  s_add_u32 m0, s45, 77824
  s_add_u32 s68, s68, 196608
  buffer_load_dwordx4 v9, s[12:15], s68 offen lds
  ds_read_b64_tr_b16 a[132:133], v6 offset:45056
  ds_read_b64_tr_b16 a[134:135], v6 offset:47104
  s_add_u32 m0, s45, 81920
  s_add_u32 s68, s66, 5
  s_and_b32 s68, s68, 7
  s_mul_i32 s68, s68, 786432
  buffer_load_dwordx4 v9, s[12:15], s68 offen lds
  ds_read_b64_tr_b16 a[144:145], v6 offset:49152
  ds_read_b64_tr_b16 a[146:147], v6 offset:51200
  s_add_u32 m0, s45, 86016
  s_add_u32 s68, s68, 196608
  buffer_load_dwordx4 v9, s[12:15], s68 offen lds
  ds_read_b64_tr_b16 a[156:157], v6 offset:53248
  ds_read_b64_tr_b16 a[158:159], v6 offset:55296
  s_add_u32 m0, s45, 90112
  s_add_u32 s68, s68, 196608
  buffer_load_dwordx4 v9, s[12:15], s68 offen lds
  ds_read_b64_tr_b16 a[168:169], v6 offset:57344
  ds_read_b64_tr_b16 a[170:171], v6 offset:59392
  s_add_u32 m0, s45, 94208
  s_add_u32 s68, s68, 196608
  buffer_load_dwordx4 v9, s[12:15], s68 offen lds
  ds_read_b64_tr_b16 a[180:181], v6 offset:61440
  ds_read_b64_tr_b16 a[182:183], v6 offset:63488
  s_waitcnt vmcnt(17) lgkmcnt(0)
  s_barrier
  ds_read_b64_tr_b16 a[100:101], v4 offset:0
  ds_read_b64_tr_b16 a[102:103], v4 offset:2048
  ds_read_b64_tr_b16 a[104:105], v5 offset:0
  ds_read_b64_tr_b16 a[106:107], v5 offset:2048
  ds_read_b64_tr_b16 a[112:113], v4 offset:4096
  ds_read_b64_tr_b16 a[114:115], v4 offset:6144
  ds_read_b64_tr_b16 a[116:117], v5 offset:4096
  ds_read_b64_tr_b16 a[118:119], v5 offset:6144
  ds_read_b64_tr_b16 a[124:125], v4 offset:8192
  ds_read_b64_tr_b16 a[126:127], v4 offset:10240
  ds_read_b64_tr_b16 a[128:129], v5 offset:8192
  ds_read_b64_tr_b16 a[130:131], v5 offset:10240
  ds_read_b64_tr_b16 a[136:137], v4 offset:12288
  ds_read_b64_tr_b16 a[138:139], v4 offset:14336
  ds_read_b64_tr_b16 a[140:141], v5 offset:12288
  ds_read_b64_tr_b16 a[142:143], v5 offset:14336
  s_waitcnt vmcnt(8)
  s_cmp_lg_u32 s44, 0
  s_cbranch_scc1 PL3_adaLN_cond__sliding_local_dilated__swiglu_ffn__prompt_kernelx
  v_cmp_ne_u32 vcc, s46, v36
  s_nop 4
  s_cbranch_vccz PL3_adaLN_cond__sliding_local_dilated__swiglu_ffn__prompt_kernelx
  s_mov_b32 s57, 60000
PL3_adaLN_cond__sliding_local_dilated__swiglu_ffn__prompt_kernel:
  buffer_load_dword v36, v14, s[8:11], 0 offen sc1
  s_sub_u32 s57, s57, 1
  s_cmp_eq_u32 s57, 0
  s_waitcnt vmcnt(0)
  s_cbranch_scc1 PL3_adaLN_cond__sliding_local_dilated__swiglu_ffn__prompt_kernelx
  v_cmp_ne_u32 vcc, s46, v36
  s_nop 4
  s_cbranch_vccnz PL3_adaLN_cond__sliding_local_dilated__swiglu_ffn__prompt_kernel
PL3_adaLN_cond__sliding_local_dilated__swiglu_ffn__prompt_kernelx:
  s_barrier
  s_add_u32 m0, s70, 98304
  s_add_u32 s69, s58, 32768
  buffer_load_dwordx4 v12, s[8:11], s69 offen offset:0 sc1 lds
  buffer_load_dwordx4 v12, s[8:11], s69 offen offset:1024 sc1 lds
  buffer_load_dwordx4 v12, s[8:11], s69 offen offset:2048 sc1 lds
  buffer_load_dwordx4 v12, s[8:11], s69 offen offset:3072 sc1 lds
  s_add_u32 m0, s71, 131072
  s_add_u32 s69, s58, s72
  buffer_load_dwordx4 v1, s[8:11], s69 offen offset:0 sc1 lds
  buffer_load_dwordx4 v1, s[8:11], s69 offen offset:1024 sc1 lds
  s_add_u32 m0, s70, 114688
  s_add_u32 s69, s59, 32768
  buffer_load_dwordx4 v12, s[8:11], s69 offen offset:0 sc1 lds
  buffer_load_dwordx4 v12, s[8:11], s69 offen offset:1024 sc1 lds
  buffer_load_dwordx4 v12, s[8:11], s69 offen offset:2048 sc1 lds
  buffer_load_dwordx4 v12, s[8:11], s69 offen offset:3072 sc1 lds
  s_add_u32 m0, s71, 139264
  s_add_u32 s69, s59, s72
  buffer_load_dwordx4 v1, s[8:11], s69 offen offset:0 sc1 lds
  buffer_load_dwordx4 v1, s[8:11], s69 offen offset:1024 sc1 lds
  s_waitcnt vmcnt(21) lgkmcnt(0)
  s_barrier
  s_add_u32 m0, s45, 0
  s_add_u32 s68, s66, 4
  s_and_b32 s68, s68, 7
  s_mul_i32 s68, s68, 786432
  s_add_u32 s68, s68, 2048
  buffer_load_dwordx4 v9, s[12:15], s68 offen lds
  ds_read_b64_tr_b16 a[148:149], v4 offset:32768
  ds_read_b64_tr_b16 a[150:151], v4 offset:34816
  s_add_u32 m0, s45, 4096
  s_add_u32 s68, s68, 196608
  buffer_load_dwordx4 v9, s[12:15], s68 offen lds
  ds_read_b64_tr_b16 a[152:153], v5 offset:32768
  ds_read_b64_tr_b16 a[154:155], v5 offset:34816
  s_add_u32 m0, s45, 8192
  s_add_u32 s68, s68, 196608
  buffer_load_dwordx4 v9, s[12:15], s68 offen lds
  ds_read_b64_tr_b16 a[160:161], v4 offset:36864
  ds_read_b64_tr_b16 a[162:163], v4 offset:38912
  s_add_u32 m0, s45, 12288
  s_add_u32 s68, s68, 196608
  buffer_load_dwordx4 v9, s[12:15], s68 offen lds
  ds_read_b64_tr_b16 a[164:165], v5 offset:36864
  ds_read_b64_tr_b16 a[166:167], v5 offset:38912
  s_add_u32 m0, s45, 16384
  s_add_u32 s68, s66, 4
  s_and_b32 s68, s68, 7
  s_mul_i32 s68, s68, 786432
  s_add_u32 s68, s68, 4096
  buffer_load_dwordx4 v9, s[12:15], s68 offen lds
  ds_read_b64_tr_b16 a[172:173], v4 offset:40960
  ds_read_b64_tr_b16 a[174:175], v4 offset:43008
  s_add_u32 m0, s45, 20480
  s_add_u32 s68, s68, 196608
  buffer_load_dwordx4 v9, s[12:15], s68 offen lds
  ds_read_b64_tr_b16 a[176:177], v5 offset:40960
  ds_read_b64_tr_b16 a[178:179], v5 offset:43008
  s_add_u32 m0, s45, 24576
  s_add_u32 s68, s68, 196608
  buffer_load_dwordx4 v9, s[12:15], s68 offen lds
  ds_read_b64_tr_b16 a[184:185], v4 offset:45056
  ds_read_b64_tr_b16 a[186:187], v4 offset:47104
  s_add_u32 m0, s45, 28672
  s_add_u32 s68, s68, 196608
  buffer_load_dwordx4 v9, s[12:15], s68 offen lds
  ds_read_b64_tr_b16 a[188:189], v5 offset:45056
  ds_read_b64_tr_b16 a[190:191], v5 offset:47104
  s_waitcnt vmcnt(14) lgkmcnt(0)
  s_barrier
  ds_read_b128 v[76:79], v2 offset:32768
  ds_read_b128 v[80:83], v2 offset:33792
  ds_read_b128 v[84:87], v2 offset:40960
  ds_read_b128 v[88:91], v2 offset:41984
  ds_read_b128 v[92:95], v13 offset:0
  ds_read_b128 v[96:99], v13 offset:1024
  ds_read_b128 v[100:103], v2 offset:34816
  ds_read_b128 v[104:107], v2 offset:35840
  s_waitcnt lgkmcnt(2)
  v_mfma_f32_16x16x32_bf16 v[28:31], a[0:3], v[76:79], 0
  ds_read_b64_tr_b16 a[192:193], v6 offset:0
  s_add_u32 m0, s45, 32768
  s_add_u32 s68, s66, 5
  s_and_b32 s68, s68, 7
  s_mul_i32 s68, s68, 786432
  s_add_u32 s68, s68, 2048
  v_mfma_f32_16x16x32_bf16 v[28:31], a[12:15], v[80:83], v[28:31]
  ds_read_b128 v[108:111], v2 offset:43008
  buffer_load_dwordx4 v9, s[12:15], s68 offen lds
  v_mfma_f32_16x16x32_bf16 v[32:35], a[12:15], v[88:91], 0
  ds_read_b64_tr_b16 a[194:195], v6 offset:2048
  v_mfma_f32_16x16x32_bf16 v[32:35], a[0:3], v[84:87], v[32:35]
  ds_read_b64_tr_b16 a[204:205], v6 offset:4096
  v_mfma_f32_16x16x32_bf16 v[40:43], a[4:7], v[84:87], 0
  ds_read_b128 v[112:115], v2 offset:44032
  s_add_u32 m0, s45, 36864
  s_add_u32 s68, s68, 196608
  v_mfma_f32_16x16x32_bf16 v[40:43], a[16:19], v[88:91], v[40:43]
  ds_read_b64_tr_b16 a[206:207], v6 offset:6144
  buffer_load_dwordx4 v9, s[12:15], s68 offen lds
  v_mfma_f32_16x16x32_bf16 v[36:39], a[16:19], v[80:83], 0
  ds_read_b128 v[116:119], v13 offset:2048
  v_mfma_f32_16x16x32_bf16 v[36:39], a[4:7], v[76:79], v[36:39]
  ds_read_b64_tr_b16 a[216:217], v6 offset:8192
  v_mfma_f32_16x16x32_bf16 v[44:47], a[8:11], v[76:79], 0
  ds_read_b64_tr_b16 a[218:219], v6 offset:10240
  s_add_u32 m0, s45, 40960
  s_add_u32 s68, s68, 196608
  v_mfma_f32_16x16x32_bf16 v[44:47], a[20:23], v[80:83], v[44:47]
  ds_read_b128 v[120:123], v13 offset:3072
  buffer_load_dwordx4 v9, s[12:15], s68 offen lds
  v_mfma_f32_16x16x32_bf16 v[48:51], a[20:23], v[88:91], 0
  ds_read_b64_tr_b16 a[228:229], v6 offset:12288
  v_mfma_f32_16x16x32_bf16 v[48:51], a[8:11], v[84:87], v[48:51]
  ds_read_b64_tr_b16 a[230:231], v6 offset:14336
  v_mfma_f32_16x16x32_bf16 v[68:71], a[8:11], v[92:95], 0
  ds_read_b128 v[76:79], v2 offset:36864
  s_add_u32 m0, s45, 45056
  s_add_u32 s68, s68, 196608
  v_mfma_f32_16x16x32_bf16 v[68:71], a[20:23], v[96:99], v[68:71]
  ds_read_b64_tr_b16 a[240:241], v6 offset:16384
  buffer_load_dwordx4 v9, s[12:15], s68 offen lds
  v_mfma_f32_16x16x32_bf16 v[60:63], a[16:19], v[96:99], 0
  ds_read_b128 v[80:83], v2 offset:37888
  v_mfma_f32_16x16x32_bf16 v[60:63], a[4:7], v[92:95], v[60:63]
  s_waitcnt lgkmcnt(5)
  ds_read_b64_tr_b16 a[242:243], v6 offset:18432
  v_mfma_f32_16x16x32_bf16 v[28:31], a[24:27], v[100:103], v[28:31]
  ds_read_b64_tr_b16 v[124:125], v6 offset:20480
  s_add_u32 m0, s45, 49152
  s_add_u32 s68, s66, 5
  s_and_b32 s68, s68, 7
  s_mul_i32 s68, s68, 786432
  s_add_u32 s68, s68, 4096
  v_mfma_f32_16x16x32_bf16 v[28:31], a[36:39], v[104:107], v[28:31]
  ds_read_b128 v[88:91], v2 offset:45056
  buffer_load_dwordx4 v9, s[12:15], s68 offen lds
  v_mfma_f32_16x16x32_bf16 v[32:35], a[36:39], v[112:115], v[32:35]
  ds_read_b64_tr_b16 v[126:127], v6 offset:22528
  v_mfma_f32_16x16x32_bf16 v[32:35], a[24:27], v[108:111], v[32:35]
  ds_read_b64_tr_b16 v[136:137], v6 offset:24576
  v_mfma_f32_16x16x32_bf16 v[40:43], a[28:31], v[108:111], v[40:43]
  ds_read_b128 v[84:87], v2 offset:46080
  s_add_u32 m0, s45, 53248
  s_add_u32 s68, s68, 196608
  v_mfma_f32_16x16x32_bf16 v[40:43], a[40:43], v[112:115], v[40:43]
  ds_read_b64_tr_b16 v[138:139], v6 offset:26624
  buffer_load_dwordx4 v9, s[12:15], s68 offen lds
  v_mfma_f32_16x16x32_bf16 v[36:39], a[40:43], v[104:107], v[36:39]
  ds_read_b128 v[96:99], v13 offset:4096
  v_mfma_f32_16x16x32_bf16 v[36:39], a[28:31], v[100:103], v[36:39]
  ds_read_b64_tr_b16 v[148:149], v6 offset:28672
  v_mfma_f32_16x16x32_bf16 v[44:47], a[32:35], v[100:103], v[44:47]
  ds_read_b64_tr_b16 v[150:151], v6 offset:30720
  v_mfma_f32_16x16x32_bf16 v[44:47], a[44:47], v[104:107], v[44:47]
  ds_read_b128 v[92:95], v13 offset:5120
  s_add_u32 m0, s45, 57344
  s_add_u32 s68, s68, 196608
  v_mfma_f32_16x16x32_bf16 v[48:51], a[44:47], v[112:115], v[48:51]
  buffer_load_dwordx4 v9, s[12:15], s68 offen lds
  v_mfma_f32_16x16x32_bf16 v[48:51], a[32:35], v[108:111], v[48:51]
  s_add_u32 m0, s45, 61440
  s_add_u32 s68, s68, 196608
  v_mfma_f32_16x16x32_bf16 v[68:71], a[32:35], v[116:119], v[68:71]
  ds_read_b128 v[100:103], v2 offset:38912
  v_mfma_f32_16x16x32_bf16 v[68:71], a[44:47], v[120:123], v[68:71]
  buffer_load_dwordx4 v9, s[12:15], s68 offen lds
  v_mfma_f32_16x16x32_bf16 v[60:63], a[40:43], v[120:123], v[60:63]
  ds_read_b128 v[104:107], v2 offset:39936
  v_mfma_f32_16x16x32_bf16 v[60:63], a[28:31], v[116:119], v[60:63]
  s_waitcnt lgkmcnt(2)
  v_mfma_f32_16x16x32_bf16 v[28:31], a[48:51], v[76:79], v[28:31]
  s_add_u32 m0, s71, 147456
  s_add_u32 s69, s60, s72
  v_mfma_f32_16x16x32_bf16 v[28:31], a[60:63], v[80:83], v[28:31]
  ds_read_b128 v[112:115], v2 offset:47104
  v_mfma_f32_16x16x32_bf16 v[32:35], a[60:63], v[84:87], v[32:35]
  buffer_load_dwordx4 v1, s[8:11], s69 offen offset:0 sc1 lds
  v_mfma_f32_16x16x32_bf16 v[32:35], a[48:51], v[88:91], v[32:35]
  v_mfma_f32_16x16x32_bf16 v[40:43], a[52:55], v[88:91], v[40:43]
  ds_read_b128 v[108:111], v2 offset:48128
  v_mfma_f32_16x16x32_bf16 v[40:43], a[64:67], v[84:87], v[40:43]
  buffer_load_dwordx4 v1, s[8:11], s69 offen offset:1024 sc1 lds
  v_mfma_f32_16x16x32_bf16 v[36:39], a[64:67], v[80:83], v[36:39]
  ds_read_b128 v[120:123], v13 offset:6144
  v_mfma_f32_16x16x32_bf16 v[36:39], a[52:55], v[76:79], v[36:39]
  v_mfma_f32_16x16x32_bf16 v[44:47], a[56:59], v[76:79], v[44:47]
  s_add_u32 m0, s71, 155648
  s_add_u32 s69, s61, s72
  v_mfma_f32_16x16x32_bf16 v[44:47], a[68:71], v[80:83], v[44:47]
  ds_read_b128 v[116:119], v13 offset:7168
  v_mfma_f32_16x16x32_bf16 v[48:51], a[68:71], v[84:87], v[48:51]
HOP1:
  s_cbranch_execz HOP5
  buffer_load_dwordx4 v1, s[8:11], s69 offen offset:0 sc1 lds
  v_mfma_f32_16x16x32_bf16 v[48:51], a[56:59], v[88:91], v[48:51]
  s_waitcnt vmcnt(11) lgkmcnt(7)
  s_barrier
  v_mfma_f32_16x16x32_bf16 v[68:71], a[56:59], v[96:99], v[68:71]
  ds_read_b128 v[76:79], v2 offset:49152
  v_mfma_f32_16x16x32_bf16 v[68:71], a[68:71], v[92:95], v[68:71]
  ds_read_b64_tr_b16 a[196:197], v4 offset:0
  buffer_load_dwordx4 v1, s[8:11], s69 offen offset:1024 sc1 lds
  v_mfma_f32_16x16x32_bf16 v[60:63], a[64:67], v[92:95], v[60:63]
  ds_read_b128 v[80:83], v2 offset:50176
  v_mfma_f32_16x16x32_bf16 v[60:63], a[52:55], v[96:99], v[60:63]
  s_waitcnt lgkmcnt(3)
  ds_read_b64_tr_b16 a[198:199], v4 offset:2048
  v_mfma_f32_16x16x32_bf16 v[28:31], a[72:75], v[100:103], v[28:31]
  ds_read_b64_tr_b16 a[200:201], v5 offset:0
  s_add_u32 m0, s70, 65536
  s_add_u32 s69, s60, 32768
  v_mfma_f32_16x16x32_bf16 v[28:31], a[84:87], v[104:107], v[28:31]
  ds_read_b128 v[84:87], v2 offset:57344
  buffer_load_dwordx4 v12, s[8:11], s69 offen offset:0 sc1 lds
  v_mfma_f32_16x16x32_bf16 v[32:35], a[84:87], v[108:111], v[32:35]
  ds_read_b64_tr_b16 a[202:203], v5 offset:2048
  v_mfma_f32_16x16x32_bf16 v[32:35], a[72:75], v[112:115], v[32:35]
  ds_read_b64_tr_b16 a[208:209], v4 offset:4096
  v_mfma_f32_16x16x32_bf16 v[40:43], a[76:79], v[112:115], v[40:43]
  ds_read_b128 v[88:91], v2 offset:58368
  v_mfma_f32_16x16x32_bf16 v[40:43], a[88:91], v[108:111], v[40:43]
  ds_read_b64_tr_b16 a[210:211], v4 offset:6144
  buffer_load_dwordx4 v12, s[8:11], s69 offen offset:1024 sc1 lds
  v_mfma_f32_16x16x32_bf16 v[36:39], a[88:91], v[104:107], v[36:39]
  ds_read_b128 v[92:95], v13 offset:8192
  v_mfma_f32_16x16x32_bf16 v[36:39], a[76:79], v[100:103], v[36:39]
  ds_read_b64_tr_b16 a[212:213], v5 offset:4096
  v_mfma_f32_16x16x32_bf16 v[44:47], a[80:83], v[100:103], v[44:47]
  ds_read_b64_tr_b16 a[214:215], v5 offset:6144
  v_mfma_f32_16x16x32_bf16 v[44:47], a[92:95], v[104:107], v[44:47]
  ds_read_b128 v[96:99], v13 offset:9216
  buffer_load_dwordx4 v12, s[8:11], s69 offen offset:2048 sc1 lds
  v_mfma_f32_16x16x32_bf16 v[48:51], a[92:95], v[108:111], v[48:51]
  ds_read_b64_tr_b16 a[220:221], v4 offset:8192
  v_mfma_f32_16x16x32_bf16 v[48:51], a[80:83], v[112:115], v[48:51]
  ds_read_b64_tr_b16 a[222:223], v4 offset:10240
  v_mfma_f32_16x16x32_bf16 v[68:71], a[80:83], v[120:123], v[68:71]
  ds_read_b128 v[100:103], v2 offset:51200
  v_mfma_f32_16x16x32_bf16 v[68:71], a[92:95], v[116:119], v[68:71]
  ds_read_b64_tr_b16 a[224:225], v5 offset:8192
  buffer_load_dwordx4 v12, s[8:11], s69 offen offset:3072 sc1 lds
  v_mfma_f32_16x16x32_bf16 v[60:63], a[88:91], v[116:119], v[60:63]
  ds_read_b128 v[104:107], v2 offset:52224
  v_mfma_f32_16x16x32_bf16 v[60:63], a[76:79], v[120:123], v[60:63]
  s_waitcnt lgkmcnt(5)
  ds_read_b64_tr_b16 a[226:227], v5 offset:10240
  v_mfma_f32_16x16x32_bf16 v[28:31], a[96:99], v[76:79], v[28:31]
  ds_read_b64_tr_b16 a[232:233], v4 offset:12288
  s_add_u32 m0, s45, 81920
  s_add_u32 s68, s66, 6
  s_and_b32 s68, s68, 7
  s_mul_i32 s68, s68, 786432
  v_mfma_f32_16x16x32_bf16 v[28:31], a[108:111], v[80:83], v[28:31]
  ds_read_b128 v[108:111], v2 offset:59392
  buffer_load_dwordx4 v9, s[12:15], s68 offen lds
  v_mfma_f32_16x16x32_bf16 v[32:35], a[108:111], v[88:91], v[32:35]
  ds_read_b64_tr_b16 a[234:235], v4 offset:14336
  v_mfma_f32_16x16x32_bf16 v[32:35], a[96:99], v[84:87], v[32:35]
  ds_read_b64_tr_b16 a[236:237], v5 offset:12288
  v_mfma_f32_16x16x32_bf16 v[40:43], a[100:103], v[84:87], v[40:43]
  ds_read_b128 v[112:115], v2 offset:60416
  s_add_u32 m0, s45, 86016
  s_add_u32 s68, s68, 196608
  v_mfma_f32_16x16x32_bf16 v[40:43], a[112:115], v[88:91], v[40:43]
  ds_read_b64_tr_b16 a[238:239], v5 offset:14336
  buffer_load_dwordx4 v9, s[12:15], s68 offen lds
  v_mfma_f32_16x16x32_bf16 v[36:39], a[112:115], v[80:83], v[36:39]
  ds_read_b128 v[116:119], v13 offset:10240
  v_mfma_f32_16x16x32_bf16 v[36:39], a[100:103], v[76:79], v[36:39]
  v_mfma_f32_16x16x32_bf16 v[44:47], a[104:107], v[76:79], v[44:47]
  s_add_u32 m0, s45, 90112
  s_add_u32 s68, s68, 196608
  v_mfma_f32_16x16x32_bf16 v[44:47], a[116:119], v[80:83], v[44:47]
  ds_read_b128 v[120:123], v13 offset:11264
  v_mfma_f32_16x16x32_bf16 v[48:51], a[116:119], v[88:91], v[48:51]
  buffer_load_dwordx4 v9, s[12:15], s68 offen lds
  v_mfma_f32_16x16x32_bf16 v[48:51], a[104:107], v[84:87], v[48:51]
  s_waitcnt vmcnt(11) lgkmcnt(2)
  s_barrier
  v_mfma_f32_16x16x32_bf16 v[68:71], a[104:107], v[92:95], v[68:71]
  ds_read_b128 v[76:79], v2 offset:53248
  s_add_u32 m0, s45, 94208
  s_add_u32 s68, s68, 196608
  v_mfma_f32_16x16x32_bf16 v[68:71], a[116:119], v[96:99], v[68:71]
  ds_read_b64_tr_b16 a[244:245], v4 offset:32768
  buffer_load_dwordx4 v9, s[12:15], s68 offen lds
  v_mfma_f32_16x16x32_bf16 v[60:63], a[112:115], v[96:99], v[60:63]
  ds_read_b128 v[80:83], v2 offset:54272
  v_mfma_f32_16x16x32_bf16 v[60:63], a[100:103], v[92:95], v[60:63]
  s_waitcnt lgkmcnt(3)
  ds_read_b64_tr_b16 a[246:247], v4 offset:34816
  v_mfma_f32_16x16x32_bf16 v[28:31], a[120:123], v[100:103], v[28:31]
  ds_read_b64_tr_b16 a[248:249], v5 offset:32768
  s_add_u32 m0, s45, 98304
  s_add_u32 s68, s66, 7
  s_and_b32 s68, s68, 7
  s_mul_i32 s68, s68, 786432
  v_mfma_f32_16x16x32_bf16 v[28:31], a[132:135], v[104:107], v[28:31]
  ds_read_b128 v[88:91], v2 offset:61440
  buffer_load_dwordx4 v9, s[12:15], s68 offen lds
  v_mfma_f32_16x16x32_bf16 v[32:35], a[132:135], v[112:115], v[32:35]
  ds_read_b64_tr_b16 a[250:251], v5 offset:34816
  v_mfma_f32_16x16x32_bf16 v[32:35], a[120:123], v[108:111], v[32:35]
  ds_read_b64_tr_b16 v[128:129], v4 offset:36864
  v_mfma_f32_16x16x32_bf16 v[40:43], a[124:127], v[108:111], v[40:43]
  ds_read_b128 v[84:87], v2 offset:62464
  s_add_u32 m0, s45, 102400
  s_add_u32 s68, s68, 196608
  v_mfma_f32_16x16x32_bf16 v[40:43], a[136:139], v[112:115], v[40:43]
  ds_read_b64_tr_b16 v[130:131], v4 offset:38912
  buffer_load_dwordx4 v9, s[12:15], s68 offen lds
  v_mfma_f32_16x16x32_bf16 v[36:39], a[136:139], v[104:107], v[36:39]
  ds_read_b128 v[96:99], v13 offset:12288
  v_mfma_f32_16x16x32_bf16 v[36:39], a[124:127], v[100:103], v[36:39]
  ds_read_b64_tr_b16 v[132:133], v5 offset:36864
  v_mfma_f32_16x16x32_bf16 v[44:47], a[128:131], v[100:103], v[44:47]
  ds_read_b64_tr_b16 v[134:135], v5 offset:38912
  s_add_u32 m0, s45, 106496
  s_add_u32 s68, s68, 196608
  v_mfma_f32_16x16x32_bf16 v[44:47], a[140:143], v[104:107], v[44:47]
  ds_read_b128 v[92:95], v13 offset:13312
  buffer_load_dwordx4 v9, s[12:15], s68 offen lds
  v_mfma_f32_16x16x32_bf16 v[48:51], a[140:143], v[112:115], v[48:51]
  ds_read_b64_tr_b16 v[140:141], v4 offset:40960
  v_mfma_f32_16x16x32_bf16 v[48:51], a[128:131], v[108:111], v[48:51]
  ds_read_b64_tr_b16 v[142:143], v4 offset:43008
  v_mfma_f32_16x16x32_bf16 v[68:71], a[128:131], v[116:119], v[68:71]
  ds_read_b128 v[100:103], v2 offset:55296
  s_add_u32 m0, s45, 110592
  s_add_u32 s68, s68, 196608
  v_mfma_f32_16x16x32_bf16 v[68:71], a[140:143], v[120:123], v[68:71]
  ds_read_b64_tr_b16 v[144:145], v5 offset:40960
  buffer_load_dwordx4 v9, s[12:15], s68 offen lds
  v_mfma_f32_16x16x32_bf16 v[60:63], a[136:139], v[120:123], v[60:63]
  ds_read_b128 v[104:107], v2 offset:56320
  v_mfma_f32_16x16x32_bf16 v[60:63], a[124:127], v[116:119], v[60:63]
  s_waitcnt lgkmcnt(5)
  ds_read_b64_tr_b16 v[146:147], v5 offset:43008
  v_mfma_f32_16x16x32_bf16 v[28:31], a[144:147], v[76:79], v[28:31]
  ds_read_b64_tr_b16 v[152:153], v4 offset:45056
  s_add_u32 m0, s45, 0
  s_add_u32 s68, s66, 6
  s_and_b32 s68, s68, 7
  s_mul_i32 s68, s68, 786432
  s_add_u32 s68, s68, 2048
  v_mfma_f32_16x16x32_bf16 v[28:31], a[156:159], v[80:83], v[28:31]
  ds_read_b128 v[112:115], v2 offset:63488
  buffer_load_dwordx4 v9, s[12:15], s68 offen lds
  v_mfma_f32_16x16x32_bf16 v[32:35], a[156:159], v[84:87], v[32:35]
  ds_read_b64_tr_b16 v[154:155], v4 offset:47104
  v_mfma_f32_16x16x32_bf16 v[32:35], a[144:147], v[88:91], v[32:35]
  ds_read_b64_tr_b16 v[156:157], v5 offset:45056
  v_mfma_f32_16x16x32_bf16 v[40:43], a[148:151], v[88:91], v[40:43]
  ds_read_b128 v[108:111], v2 offset:64512
  s_add_u32 m0, s45, 4096
  s_add_u32 s68, s68, 196608
  v_mfma_f32_16x16x32_bf16 v[40:43], a[160:163], v[84:87], v[40:43]
  ds_read_b64_tr_b16 v[158:159], v5 offset:47104
  buffer_load_dwordx4 v9, s[12:15], s68 offen lds
  v_mfma_f32_16x16x32_bf16 v[36:39], a[160:163], v[80:83], v[36:39]
  ds_read_b128 v[120:123], v13 offset:14336
  v_mfma_f32_16x16x32_bf16 v[36:39], a[148:151], v[76:79], v[36:39]
  v_mfma_f32_16x16x32_bf16 v[44:47], a[152:155], v[76:79], v[44:47]
  s_add_u32 m0, s45, 8192
  s_add_u32 s68, s68, 196608
  v_mfma_f32_16x16x32_bf16 v[44:47], a[164:167], v[80:83], v[44:47]
  ds_read_b128 v[116:119], v13 offset:15360
  v_mfma_f32_16x16x32_bf16 v[48:51], a[164:167], v[84:87], v[48:51]
  buffer_load_dwordx4 v9, s[12:15], s68 offen lds
  v_mfma_f32_16x16x32_bf16 v[48:51], a[152:155], v[88:91], v[48:51]
  s_waitcnt vmcnt(3) lgkmcnt(2)
  s_barrier
  v_mfma_f32_16x16x32_bf16 v[68:71], a[152:155], v[96:99], v[68:71]
  ds_read_b128 v[76:79], v2 offset:0
  s_add_u32 m0, s45, 12288
  s_add_u32 s68, s68, 196608
  v_mfma_f32_16x16x32_bf16 v[68:71], a[164:167], v[92:95], v[68:71]
  ds_read_b64_tr_b16 v[160:161], v6 offset:16384
  buffer_load_dwordx4 v9, s[12:15], s68 offen lds
  v_mfma_f32_16x16x32_bf16 v[60:63], a[160:163], v[92:95], v[60:63]
  ds_read_b128 v[80:83], v2 offset:1024
  v_mfma_f32_16x16x32_bf16 v[60:63], a[148:151], v[96:99], v[60:63]
  s_waitcnt lgkmcnt(3)
  ds_read_b64_tr_b16 v[162:163], v6 offset:18432
  v_mfma_f32_16x16x32_bf16 v[28:31], a[168:171], v[100:103], v[28:31]
  ds_read_b64_tr_b16 v[172:173], v6 offset:20480
  s_add_u32 m0, s45, 16384
  s_add_u32 s68, s66, 6
  s_and_b32 s68, s68, 7
  s_mul_i32 s68, s68, 786432
  s_add_u32 s68, s68, 4096
  v_mfma_f32_16x16x32_bf16 v[28:31], a[180:183], v[104:107], v[28:31]
  ds_read_b128 v[84:87], v2 offset:8192
  buffer_load_dwordx4 v9, s[12:15], s68 offen lds
  v_mfma_f32_16x16x32_bf16 v[32:35], a[180:183], v[108:111], v[32:35]
  ds_read_b64_tr_b16 v[174:175], v6 offset:22528
  v_mfma_f32_16x16x32_bf16 v[32:35], a[168:171], v[112:115], v[32:35]
  ds_read_b64_tr_b16 v[184:185], v6 offset:24576
  v_mfma_f32_16x16x32_bf16 v[40:43], a[172:175], v[112:115], v[40:43]
  ds_read_b128 v[88:91], v2 offset:9216
  s_add_u32 m0, s45, 20480
  s_add_u32 s68, s68, 196608
  v_mfma_f32_16x16x32_bf16 v[40:43], a[184:187], v[108:111], v[40:43]
  ds_read_b64_tr_b16 v[186:187], v6 offset:26624
  buffer_load_dwordx4 v9, s[12:15], s68 offen lds
  v_mfma_f32_16x16x32_bf16 v[36:39], a[184:187], v[104:107], v[36:39]
  ds_read_b128 v[92:95], v13 offset:16384
  v_mfma_f32_16x16x32_bf16 v[36:39], a[172:175], v[100:103], v[36:39]
  ds_read_b64_tr_b16 v[196:197], v6 offset:28672
  v_mfma_f32_16x16x32_bf16 v[44:47], a[176:179], v[100:103], v[44:47]
  ds_read_b64_tr_b16 v[198:199], v6 offset:30720
  s_add_u32 m0, s45, 24576
  s_add_u32 s68, s68, 196608
  v_mfma_f32_16x16x32_bf16 v[44:47], a[188:191], v[104:107], v[44:47]
  ds_read_b128 v[96:99], v13 offset:17408
  buffer_load_dwordx4 v9, s[12:15], s68 offen lds
  v_mfma_f32_16x16x32_bf16 v[48:51], a[188:191], v[108:111], v[48:51]
  ds_read_b64_tr_b16 v[208:209], v6 offset:32768
  v_mfma_f32_16x16x32_bf16 v[48:51], a[176:179], v[112:115], v[48:51]
  ds_read_b64_tr_b16 v[210:211], v6 offset:34816
  v_mfma_f32_16x16x32_bf16 v[68:71], a[176:179], v[120:123], v[68:71]
  ds_read_b128 v[100:103], v2 offset:2048
  s_add_u32 m0, s45, 28672
  s_add_u32 s68, s68, 196608
  v_mfma_f32_16x16x32_bf16 v[68:71], a[188:191], v[116:119], v[68:71]
  ds_read_b64_tr_b16 v[220:221], v6 offset:36864
  buffer_load_dwordx4 v9, s[12:15], s68 offen lds
  v_mfma_f32_16x16x32_bf16 v[60:63], a[184:187], v[116:119], v[60:63]
  ds_read_b128 v[104:107], v2 offset:3072
  v_mfma_f32_16x16x32_bf16 v[60:63], a[172:175], v[120:123], v[60:63]
  s_waitcnt lgkmcnt(5)
  ds_read_b64_tr_b16 v[222:223], v6 offset:38912
  v_mfma_f32_16x16x32_bf16 v[28:31], a[192:195], v[76:79], v[28:31]
  ds_read_b64_tr_b16 v[232:233], v6 offset:40960
  s_add_u32 m0, s70, 32768
  s_add_u32 s69, s61, 32768
  v_mfma_f32_16x16x32_bf16 v[28:31], a[204:207], v[80:83], v[28:31]
  ds_read_b128 v[108:111], v2 offset:10240
  buffer_load_dwordx4 v12, s[8:11], s69 offen offset:0 sc1 lds
  v_mfma_f32_16x16x32_bf16 v[32:35], a[204:207], v[88:91], v[32:35]
  ds_read_b64_tr_b16 v[234:235], v6 offset:43008
  v_mfma_f32_16x16x32_bf16 v[32:35], a[192:195], v[84:87], v[32:35]
  ds_read_b64_tr_b16 v[244:245], v6 offset:45056
  v_mfma_f32_16x16x32_bf16 v[40:43], a[196:199], v[84:87], v[40:43]
  ds_read_b128 v[112:115], v2 offset:11264
  v_mfma_f32_16x16x32_bf16 v[40:43], a[208:211], v[88:91], v[40:43]
  ds_read_b64_tr_b16 v[246:247], v6 offset:47104
  buffer_load_dwordx4 v12, s[8:11], s69 offen offset:1024 sc1 lds
  v_mfma_f32_16x16x32_bf16 v[36:39], a[208:211], v[80:83], v[36:39]
  ds_read_b128 v[116:119], v13 offset:18432
  v_mfma_f32_16x16x32_bf16 v[36:39], a[196:199], v[76:79], v[36:39]
  v_mfma_f32_16x16x32_bf16 v[44:47], a[200:203], v[76:79], v[44:47]
  v_mfma_f32_16x16x32_bf16 v[44:47], a[212:215], v[80:83], v[44:47]
  ds_read_b128 v[120:123], v13 offset:19456
  v_mfma_f32_16x16x32_bf16 v[48:51], a[212:215], v[88:91], v[48:51]
  buffer_load_dwordx4 v12, s[8:11], s69 offen offset:2048 sc1 lds
  v_mfma_f32_16x16x32_bf16 v[48:51], a[200:203], v[84:87], v[48:51]
  s_waitcnt vmcnt(3) lgkmcnt(2)
  s_barrier
  v_mfma_f32_16x16x32_bf16 v[68:71], a[200:203], v[92:95], v[68:71]
  ds_read_b128 v[76:79], v2 offset:4096
  v_mfma_f32_16x16x32_bf16 v[68:71], a[212:215], v[96:99], v[68:71]
  ds_read_b64_tr_b16 v[164:165], v4 offset:0
  buffer_load_dwordx4 v12, s[8:11], s69 offen offset:3072 sc1 lds
  v_mfma_f32_16x16x32_bf16 v[60:63], a[208:211], v[96:99], v[60:63]
  ds_read_b128 v[80:83], v2 offset:5120
  v_mfma_f32_16x16x32_bf16 v[60:63], a[196:199], v[92:95], v[60:63]
  s_waitcnt lgkmcnt(3)
  ds_read_b64_tr_b16 v[166:167], v4 offset:2048
  v_mfma_f32_16x16x32_bf16 v[28:31], a[216:219], v[100:103], v[28:31]
  ds_read_b64_tr_b16 v[168:169], v5 offset:0
  s_add_u32 m0, s45, 81920
  s_add_u32 s68, s66, 7
  s_and_b32 s68, s68, 7
  s_mul_i32 s68, s68, 786432
  s_add_u32 s68, s68, 2048
  v_mfma_f32_16x16x32_bf16 v[28:31], a[228:231], v[104:107], v[28:31]
  ds_read_b128 v[88:91], v2 offset:12288
  buffer_load_dwordx4 v9, s[12:15], s68 offen lds
  v_mfma_f32_16x16x32_bf16 v[32:35], a[228:231], v[112:115], v[32:35]
  ds_read_b64_tr_b16 v[170:171], v5 offset:2048
  v_mfma_f32_16x16x32_bf16 v[32:35], a[216:219], v[108:111], v[32:35]
  ds_read_b64_tr_b16 v[176:177], v4 offset:4096
  v_mfma_f32_16x16x32_bf16 v[40:43], a[220:223], v[108:111], v[40:43]
  ds_read_b128 v[84:87], v2 offset:13312
  s_add_u32 m0, s45, 86016
  s_add_u32 s68, s68, 196608
  v_mfma_f32_16x16x32_bf16 v[40:43], a[232:235], v[112:115], v[40:43]
  ds_read_b64_tr_b16 v[178:179], v4 offset:6144
  buffer_load_dwordx4 v9, s[12:15], s68 offen lds
  v_mfma_f32_16x16x32_bf16 v[36:39], a[232:235], v[104:107], v[36:39]
  ds_read_b128 v[96:99], v13 offset:20480
  v_mfma_f32_16x16x32_bf16 v[36:39], a[220:223], v[100:103], v[36:39]
  ds_read_b64_tr_b16 v[180:181], v5 offset:4096
  v_mfma_f32_16x16x32_bf16 v[44:47], a[224:227], v[100:103], v[44:47]
  ds_read_b64_tr_b16 v[182:183], v5 offset:6144
  s_add_u32 m0, s45, 90112
  s_add_u32 s68, s68, 196608
  v_mfma_f32_16x16x32_bf16 v[44:47], a[236:239], v[104:107], v[44:47]
  ds_read_b128 v[92:95], v13 offset:21504
  buffer_load_dwordx4 v9, s[12:15], s68 offen lds
  v_mfma_f32_16x16x32_bf16 v[48:51], a[236:239], v[112:115], v[48:51]
  ds_read_b64_tr_b16 v[188:189], v4 offset:8192
  v_mfma_f32_16x16x32_bf16 v[48:51], a[224:227], v[108:111], v[48:51]
  ds_read_b64_tr_b16 v[190:191], v4 offset:10240
  v_mfma_f32_16x16x32_bf16 v[68:71], a[224:227], v[116:119], v[68:71]
  ds_read_b128 v[100:103], v2 offset:6144
  s_add_u32 m0, s45, 94208
  s_add_u32 s68, s68, 196608
  v_mfma_f32_16x16x32_bf16 v[68:71], a[236:239], v[120:123], v[68:71]
  ds_read_b64_tr_b16 v[192:193], v5 offset:8192
  buffer_load_dwordx4 v9, s[12:15], s68 offen lds
  v_mfma_f32_16x16x32_bf16 v[60:63], a[232:235], v[120:123], v[60:63]
  ds_read_b128 v[104:107], v2 offset:7168
  v_mfma_f32_16x16x32_bf16 v[60:63], a[220:223], v[116:119], v[60:63]
  s_waitcnt lgkmcnt(5)
  ds_read_b64_tr_b16 v[194:195], v5 offset:10240
  v_mfma_f32_16x16x32_bf16 v[28:31], a[240:243], v[76:79], v[28:31]
  ds_read_b64_tr_b16 v[200:201], v4 offset:12288
  s_add_u32 m0, s45, 98304
  s_add_u32 s68, s66, 7
  s_and_b32 s68, s68, 7
  s_mul_i32 s68, s68, 786432
  s_add_u32 s68, s68, 4096
  v_mfma_f32_16x16x32_bf16 v[28:31], v[124:127], v[80:83], v[28:31]
  ds_read_b128 v[112:115], v2 offset:14336
  buffer_load_dwordx4 v9, s[12:15], s68 offen lds
  v_mfma_f32_16x16x32_bf16 v[32:35], v[124:127], v[84:87], v[32:35]
  ds_read_b64_tr_b16 v[202:203], v4 offset:14336
  v_mfma_f32_16x16x32_bf16 v[32:35], a[240:243], v[88:91], v[32:35]
  ds_read_b64_tr_b16 v[204:205], v5 offset:12288
  v_mfma_f32_16x16x32_bf16 v[40:43], a[244:247], v[88:91], v[40:43]
  ds_read_b128 v[108:111], v2 offset:15360
  s_add_u32 m0, s45, 102400
  s_add_u32 s68, s68, 196608
  v_mfma_f32_16x16x32_bf16 v[40:43], v[128:131], v[84:87], v[40:43]
  ds_read_b64_tr_b16 v[206:207], v5 offset:14336
  buffer_load_dwordx4 v9, s[12:15], s68 offen lds
  v_mfma_f32_16x16x32_bf16 v[36:39], v[128:131], v[80:83], v[36:39]
  ds_read_b128 v[120:123], v13 offset:22528
  v_mfma_f32_16x16x32_bf16 v[36:39], a[244:247], v[76:79], v[36:39]
  v_mfma_f32_16x16x32_bf16 v[44:47], a[248:251], v[76:79], v[44:47]
  s_add_u32 m0, s45, 106496
  s_add_u32 s68, s68, 196608
  v_mfma_f32_16x16x32_bf16 v[44:47], v[132:135], v[80:83], v[44:47]
  ds_read_b128 v[116:119], v13 offset:23552
  v_mfma_f32_16x16x32_bf16 v[48:51], v[132:135], v[84:87], v[48:51]
  buffer_load_dwordx4 v9, s[12:15], s68 offen lds
  v_mfma_f32_16x16x32_bf16 v[48:51], a[248:251], v[88:91], v[48:51]
  s_waitcnt vmcnt(7) lgkmcnt(2)
  s_barrier
  v_mfma_f32_16x16x32_bf16 v[68:71], a[248:251], v[96:99], v[68:71]
  ds_read_b128 v[76:79], v1 offset:32768
  s_add_u32 m0, s45, 110592
  s_add_u32 s68, s68, 196608
  v_mfma_f32_16x16x32_bf16 v[68:71], v[132:135], v[92:95], v[68:71]
  buffer_load_dwordx4 v9, s[12:15], s68 offen lds
  v_mfma_f32_16x16x32_bf16 v[60:63], v[128:131], v[92:95], v[60:63]
  ds_read_b128 v[80:83], v1 offset:33792
  v_mfma_f32_16x16x32_bf16 v[60:63], a[244:247], v[96:99], v[60:63]
  s_waitcnt lgkmcnt(2)
  v_mfma_f32_16x16x32_bf16 v[28:31], v[136:139], v[100:103], v[28:31]
  s_add_u32 m0, s70, 49152
  s_add_u32 s69, s58, 98304
  v_mfma_f32_16x16x32_bf16 v[28:31], v[148:151], v[104:107], v[28:31]
  ds_read_b128 v[84:87], v1 offset:40960
  v_mfma_f32_16x16x32_bf16 v[32:35], v[148:151], v[108:111], v[32:35]
  buffer_load_dwordx4 v12, s[8:11], s69 offen offset:0 sc1 lds
  v_mfma_f32_16x16x32_bf16 v[32:35], v[136:139], v[112:115], v[32:35]
  v_mfma_f32_16x16x32_bf16 v[40:43], v[140:143], v[112:115], v[40:43]
  ds_read_b128 v[88:91], v1 offset:41984
  v_mfma_f32_16x16x32_bf16 v[40:43], v[152:155], v[108:111], v[40:43]
  buffer_load_dwordx4 v12, s[8:11], s69 offen offset:1024 sc1 lds
  v_mfma_f32_16x16x32_bf16 v[36:39], v[152:155], v[104:107], v[36:39]
  ds_read_b128 v[92:95], v13 offset:24576
  v_mfma_f32_16x16x32_bf16 v[36:39], v[140:143], v[100:103], v[36:39]
  v_mfma_f32_16x16x32_bf16 v[44:47], v[144:147], v[100:103], v[44:47]
  v_mfma_f32_16x16x32_bf16 v[44:47], v[156:159], v[104:107], v[44:47]
  ds_read_b128 v[96:99], v13 offset:25600
  v_mfma_f32_16x16x32_bf16 v[48:51], v[156:159], v[108:111], v[48:51]
  buffer_load_dwordx4 v12, s[8:11], s69 offen offset:2048 sc1 lds
  v_mfma_f32_16x16x32_bf16 v[48:51], v[144:147], v[112:115], v[48:51]
  s_waitcnt vmcnt(3)
  s_barrier
  v_mfma_f32_16x16x32_bf16 v[68:71], v[144:147], v[120:123], v[68:71]
  ds_read_b128 v[100:103], v1 offset:34816
  ds_write_b16 v21, v16
  v_mfma_f32_16x16x32_bf16 v[68:71], v[156:159], v[116:119], v[68:71]
  ds_read_b64_tr_b16 v[212:213], v7 offset:16384
  buffer_load_dwordx4 v12, s[8:11], s69 offen offset:3072 sc1 lds
  v_mfma_f32_16x16x32_bf16 v[60:63], v[152:155], v[116:119], v[60:63]
  ds_read_b128 v[104:107], v1 offset:35840
  v_mfma_f32_16x16x32_bf16 v[60:63], v[140:143], v[120:123], v[60:63]
  s_waitcnt lgkmcnt(4)
  ds_read_b64_tr_b16 v[214:215], v7 offset:18432
  v_mfma_f32_16x16x32_bf16 v[28:31], v[160:163], v[76:79], v[28:31]
  ds_read_b64_tr_b16 v[216:217], v8 offset:16384
  s_add_u32 m0, s70, 114688
  s_add_u32 s69, s59, 98304
  v_mfma_f32_16x16x32_bf16 v[28:31], v[172:175], v[80:83], v[28:31]
  ds_read_b128 v[108:111], v1 offset:43008
  buffer_load_dwordx4 v12, s[8:11], s69 offen offset:0 sc1 lds
  v_mfma_f32_16x16x32_bf16 v[32:35], v[172:175], v[88:91], v[32:35]
  ds_read_b64_tr_b16 v[218:219], v8 offset:18432
  v_mfma_f32_16x16x32_bf16 v[32:35], v[160:163], v[84:87], v[32:35]
  ds_read_b64_tr_b16 v[224:225], v7 offset:20480
  v_mfma_f32_16x16x32_bf16 v[40:43], v[164:167], v[84:87], v[40:43]
  ds_read_b128 v[112:115], v1 offset:44032
  v_mfma_f32_16x16x32_bf16 v[40:43], v[176:179], v[88:91], v[40:43]
  ds_read_b64_tr_b16 v[226:227], v7 offset:22528
  buffer_load_dwordx4 v12, s[8:11], s69 offen offset:1024 sc1 lds
  v_mfma_f32_16x16x32_bf16 v[36:39], v[176:179], v[80:83], v[36:39]
  ds_read_b128 v[116:119], v13 offset:26624
  v_mfma_f32_16x16x32_bf16 v[36:39], v[164:167], v[76:79], v[36:39]
  ds_read_b64_tr_b16 v[228:229], v8 offset:20480
  v_mfma_f32_16x16x32_bf16 v[44:47], v[168:171], v[76:79], v[44:47]
  ds_read_b64_tr_b16 v[230:231], v8 offset:22528
  v_mfma_f32_16x16x32_bf16 v[44:47], v[180:183], v[80:83], v[44:47]
  ds_read_b128 v[120:123], v13 offset:27648
  buffer_load_dwordx4 v12, s[8:11], s69 offen offset:2048 sc1 lds
  v_mfma_f32_16x16x32_bf16 v[48:51], v[180:183], v[88:91], v[48:51]
  ds_read_b64_tr_b16 v[236:237], v7 offset:24576
  v_mfma_f32_16x16x32_bf16 v[48:51], v[168:171], v[84:87], v[48:51]
  ds_read_b64_tr_b16 v[238:239], v7 offset:26624
  v_mfma_f32_16x16x32_bf16 v[68:71], v[168:171], v[92:95], v[68:71]
  ds_read_b128 v[76:79], v1 offset:36864
  v_mfma_f32_16x16x32_bf16 v[68:71], v[180:183], v[96:99], v[68:71]
  ds_read_b64_tr_b16 v[240:241], v8 offset:24576
  buffer_load_dwordx4 v12, s[8:11], s69 offen offset:3072 sc1 lds
  v_mfma_f32_16x16x32_bf16 v[60:63], v[176:179], v[96:99], v[60:63]
  ds_read_b128 v[80:83], v1 offset:37888
  v_mfma_f32_16x16x32_bf16 v[60:63], v[164:167], v[92:95], v[60:63]
  s_waitcnt lgkmcnt(5)
  ds_read_b64_tr_b16 v[242:243], v8 offset:26624
  v_mfma_f32_16x16x32_bf16 v[28:31], v[184:187], v[100:103], v[28:31]
  ds_read_b64_tr_b16 v[248:249], v7 offset:28672
  s_add_u32 m0, s70, 0
  s_add_u32 s69, s60, 98304
  v_mfma_f32_16x16x32_bf16 v[28:31], v[196:199], v[104:107], v[28:31]
  ds_read_b128 v[88:91], v1 offset:45056
  buffer_load_dwordx4 v12, s[8:11], s69 offen offset:0 sc1 lds
  v_mfma_f32_16x16x32_bf16 v[32:35], v[196:199], v[112:115], v[32:35]
  ds_read_b64_tr_b16 v[250:251], v7 offset:30720
  v_mfma_f32_16x16x32_bf16 v[32:35], v[184:187], v[108:111], v[32:35]
  ds_read_b64_tr_b16 v[252:253], v8 offset:28672
  v_mfma_f32_16x16x32_bf16 v[40:43], v[188:191], v[108:111], v[40:43]
  ds_read_b128 v[84:87], v1 offset:46080
  v_mfma_f32_16x16x32_bf16 v[40:43], v[200:203], v[112:115], v[40:43]
  ds_read_b64_tr_b16 v[254:255], v8 offset:30720
  buffer_load_dwordx4 v12, s[8:11], s69 offen offset:1024 sc1 lds
  v_mfma_f32_16x16x32_bf16 v[36:39], v[200:203], v[104:107], v[36:39]
  ds_read_b128 v[96:99], v13 offset:28672
  v_mfma_f32_16x16x32_bf16 v[36:39], v[188:191], v[100:103], v[36:39]
  v_mfma_f32_16x16x32_bf16 v[44:47], v[192:195], v[100:103], v[44:47]
  v_mfma_f32_16x16x32_bf16 v[44:47], v[204:207], v[104:107], v[44:47]
  ds_read_b128 v[92:95], v13 offset:29696
  v_mfma_f32_16x16x32_bf16 v[48:51], v[204:207], v[112:115], v[48:51]
  buffer_load_dwordx4 v12, s[8:11], s69 offen offset:2048 sc1 lds
  v_mfma_f32_16x16x32_bf16 v[48:51], v[192:195], v[108:111], v[48:51]
  v_mfma_f32_16x16x32_bf16 v[68:71], v[192:195], v[116:119], v[68:71]
  ds_read_b128 v[100:103], v1 offset:38912
  v_mfma_f32_16x16x32_bf16 v[68:71], v[204:207], v[120:123], v[68:71]
  buffer_load_dwordx4 v12, s[8:11], s69 offen offset:3072 sc1 lds
  v_mfma_f32_16x16x32_bf16 v[60:63], v[200:203], v[120:123], v[60:63]
  ds_read_b128 v[104:107], v1 offset:39936
  s_mov_b32 s30, 7340032
  v_mfma_f32_16x16x32_bf16 v[60:63], v[188:191], v[116:119], v[60:63]
  s_waitcnt lgkmcnt(2)
  s_mov_b32 s31, 131072
  s_mov_b32 s34, 7340032
  v_mfma_f32_16x16x32_bf16 v[28:31], v[208:211], v[76:79], v[28:31]
  s_add_u32 m0, s45, 16384
  s_mov_b32 s68, 0
  v_mfma_f32_16x16x32_bf16 v[28:31], v[220:223], v[80:83], v[28:31]
  ds_read_b128 v[112:115], v1 offset:47104
  s_mov_b32 s35, 131072
  v_mfma_f32_16x16x32_bf16 v[32:35], v[220:223], v[84:87], v[32:35]
  buffer_load_dwordx4 v11, s[20:23], s68 offen nt lds
  s_mov_b32 s38, 7340032
  s_mov_b32 s39, 131072
  v_mfma_f32_16x16x32_bf16 v[32:35], v[208:211], v[88:91], v[32:35]
  s_add_u32 m0, s45, 20480
  s_add_u32 s68, s68, 393216
  s_mov_b32 s42, 4194304
  v_mfma_f32_16x16x32_bf16 v[40:43], v[212:215], v[88:91], v[40:43]
  ds_read_b128 v[108:111], v1 offset:48128
  s_mov_b32 s43, 131072
  v_mfma_f32_16x16x32_bf16 v[40:43], v[224:227], v[84:87], v[40:43]
  buffer_load_dwordx4 v11, s[20:23], s68 offen nt lds
  v_add_u32 v9, s78, v1
  v_and_b32 v4, 0xffffbfff, v4
  v_mfma_f32_16x16x32_bf16 v[36:39], v[224:227], v[80:83], v[36:39]
  ds_read_b128 v[120:123], v13 offset:30720
  v_and_b32 v5, 0xffffbfff, v5
  v_mfma_f32_16x16x32_bf16 v[36:39], v[212:215], v[76:79], v[36:39]
  v_and_b32 v7, 0xffffbfff, v7
  v_and_b32 v8, 0xffffbfff, v8
  v_mfma_f32_16x16x32_bf16 v[44:47], v[216:219], v[76:79], v[44:47]
  s_add_u32 m0, s45, 24576
  s_add_u32 s68, s68, 393216
  s_lshl_b32 s52, s44, 13
  v_mfma_f32_16x16x32_bf16 v[44:47], v[228:231], v[80:83], v[44:47]
  ds_read_b128 v[116:119], v13 offset:31744
  s_and_b32 s52, s52, 8192
  v_mfma_f32_16x16x32_bf16 v[48:51], v[228:231], v[84:87], v[48:51]
  buffer_load_dwordx4 v11, s[20:23], s68 offen nt lds
  v_add_u32 v22, s52, v1
  v_add_u32 v23, s52, v2
  v_mfma_f32_16x16x32_bf16 v[48:51], v[216:219], v[88:91], v[48:51]
  s_waitcnt vmcnt(11) lgkmcnt(8)
  s_barrier
  v_mfma_f32_16x16x32_bf16 v[68:71], v[216:219], v[96:99], v[68:71]
  ds_read_b128 v[76:79], v1 offset:49152
  s_add_u32 m0, s45, 28672
  s_add_u32 s68, s68, 393216
  v_mfma_f32_16x16x32_bf16 v[68:71], v[228:231], v[92:95], v[68:71]
  buffer_load_dwordx4 v11, s[20:23], s68 offen nt lds
  v_and_b32 v14, 15, v0
  v_lshlrev_b32 v14, 7, v14
  v_mfma_f32_16x16x32_bf16 v[60:63], v[224:227], v[92:95], v[60:63]
  v_mfma_f32_16x16x32_bf16 v[60:63], v[212:215], v[96:99], v[60:63]
  s_waitcnt lgkmcnt(1)
  ds_read_b128 v[80:83], v1 offset:50176
  v_mfma_f32_16x16x32_bf16 v[28:31], v[232:235], v[100:103], v[28:31]
  v_mfma_f32_16x16x32_bf16 v[28:31], v[244:247], v[104:107], v[28:31]
  v_mfma_f32_16x16x32_bf16 v[32:35], v[244:247], v[108:111], v[32:35]
  ds_read_b128 v[84:87], v1 offset:57344
  v_mfma_f32_16x16x32_bf16 v[32:35], v[232:235], v[112:115], v[32:35]
  v_mfma_f32_16x16x32_bf16 v[40:43], v[236:239], v[112:115], v[40:43]
HOP2:
  s_cbranch_execz HOP6
  v_mfma_f32_16x16x32_bf16 v[40:43], v[248:251], v[108:111], v[40:43]
  ds_read_b128 v[88:91], v1 offset:58368
  v_mfma_f32_16x16x32_bf16 v[36:39], v[248:251], v[104:107], v[36:39]
  v_mfma_f32_16x16x32_bf16 v[36:39], v[236:239], v[100:103], v[36:39]
  v_mfma_f32_16x16x32_bf16 v[44:47], v[240:243], v[100:103], v[44:47]
  ds_read_b128 v[92:95], v1 offset:51200
  v_mfma_f32_16x16x32_bf16 v[44:47], v[252:255], v[104:107], v[44:47]
  v_mfma_f32_16x16x32_bf16 v[48:51], v[252:255], v[108:111], v[48:51]
  v_mfma_f32_16x16x32_bf16 v[48:51], v[240:243], v[112:115], v[48:51]
  ds_read_b128 v[96:99], v1 offset:52224
  v_mfma_f32_16x16x32_bf16 v[68:71], v[240:243], v[120:123], v[68:71]
  v_mfma_f32_16x16x32_bf16 v[68:71], v[252:255], v[116:119], v[68:71]
  v_mfma_f32_16x16x32_bf16 v[60:63], v[248:251], v[116:119], v[60:63]
  ds_read_b128 v[100:103], v1 offset:59392
  v_mfma_f32_16x16x32_bf16 v[60:63], v[236:239], v[120:123], v[60:63]
  s_waitcnt lgkmcnt(3)
  v_mfma_f32_16x16x32_bf16 v[52:55], a[0:3], v[76:79], 0
  v_mfma_f32_16x16x32_bf16 v[52:55], a[12:15], v[80:83], v[52:55]
  ds_read_b128 v[104:107], v1 offset:60416
  v_mfma_f32_16x16x32_bf16 v[56:59], a[12:15], v[88:91], 0
  s_nop 2
  v_cvt_pk_bf16_f32 v60, v60, v61
  v_cvt_pk_bf16_f32 v61, v62, v63
  v_cvt_pk_bf16_f32 v62, v68, v69
  v_cvt_pk_bf16_f32 v63, v70, v71
  ds_write_b128 v17, v[60:63] offset:1024
  v_mfma_f32_16x16x32_bf16 v[56:59], a[0:3], v[84:87], v[56:59]
  v_cvt_pk_bf16_f32 v28, v28, v29
  v_cvt_pk_bf16_f32 v29, v30, v31
  v_mfma_f32_16x16x32_bf16 v[64:67], a[4:7], v[84:87], 0
  ds_read_b128 v[108:111], v1 offset:53248
  v_mfma_f32_16x16x32_bf16 v[64:67], a[16:19], v[88:91], v[64:67]
  ds_write_b64 v18, v[28:29] offset:6144
  v_mfma_f32_16x16x32_bf16 v[60:63], a[16:19], v[80:83], 0
  v_cvt_pk_bf16_f32 v36, v36, v37
  v_cvt_pk_bf16_f32 v37, v38, v39
  v_mfma_f32_16x16x32_bf16 v[60:63], a[4:7], v[76:79], v[60:63]
  ds_read_b128 v[112:115], v1 offset:54272
  v_cvt_pk_bf16_f32 v38, v44, v45
  v_mfma_f32_16x16x32_bf16 v[68:71], a[8:11], v[76:79], 0
  v_cvt_pk_bf16_f32 v39, v46, v47
  v_mfma_f32_16x16x32_bf16 v[68:71], a[20:23], v[80:83], v[68:71]
  ds_write_b128 v17, v[36:39] offset:7168
  v_mfma_f32_16x16x32_bf16 v[72:75], a[20:23], v[88:91], 0
  ds_read_b128 v[76:79], v1 offset:61440
  v_cvt_pk_bf16_f32 v32, v32, v33
  v_mfma_f32_16x16x32_bf16 v[72:75], a[8:11], v[84:87], v[72:75]
  s_waitcnt lgkmcnt(6)
  v_cvt_pk_bf16_f32 v33, v34, v35
  v_mfma_f32_16x16x32_bf16 v[52:55], a[24:27], v[92:95], v[52:55]
  s_add_u32 m0, s70, 65536
  s_add_u32 s69, s61, 98304
  v_mfma_f32_16x16x32_bf16 v[52:55], a[36:39], v[96:99], v[52:55]
  ds_read_b128 v[80:83], v1 offset:62464
  v_mfma_f32_16x16x32_bf16 v[56:59], a[36:39], v[104:107], v[56:59]
  buffer_load_dwordx4 v12, s[8:11], s69 offen offset:0 sc1 lds
  ds_write_b64 v18, v[32:33] offset:12288
  v_mfma_f32_16x16x32_bf16 v[56:59], a[24:27], v[100:103], v[56:59]
  v_cvt_pk_bf16_f32 v40, v40, v41
  v_cvt_pk_bf16_f32 v41, v42, v43
  v_mfma_f32_16x16x32_bf16 v[64:67], a[28:31], v[100:103], v[64:67]
  ds_read_b128 v[88:91], v1 offset:55296
  v_cvt_pk_bf16_f32 v42, v48, v49
  v_mfma_f32_16x16x32_bf16 v[64:67], a[40:43], v[104:107], v[64:67]
  v_cvt_pk_bf16_f32 v43, v50, v51
  v_mfma_f32_16x16x32_bf16 v[60:63], a[40:43], v[96:99], v[60:63]
  buffer_load_dwordx4 v12, s[8:11], s69 offen offset:1024 sc1 lds
  ds_write_b128 v17, v[40:43] offset:13312
  v_mfma_f32_16x16x32_bf16 v[60:63], a[28:31], v[92:95], v[60:63]
  ds_read_b128 v[84:87], v1 offset:56320
  v_mfma_f32_16x16x32_bf16 v[68:71], a[32:35], v[92:95], v[68:71]
  s_bitcmp1_b32 s44, 0
  s_mov_b32 s52, 6144
  s_cselect_b32 s52, 12288, s52
  s_mov_b32 s53, 0
  s_cselect_b32 s53, 6144, s53
  v_mfma_f32_16x16x32_bf16 v[68:71], a[44:47], v[96:99], v[68:71]
  v_add_u32 v116, s52, v19
  v_add_u32 v117, s53, v19
  v_mfma_f32_16x16x32_bf16 v[72:75], a[44:47], v[104:107], v[72:75]
  ds_read_b128 v[92:95], v1 offset:63488
  v_add_u32 v118, s52, v20
  v_mfma_f32_16x16x32_bf16 v[72:75], a[32:35], v[100:103], v[72:75]
  s_waitcnt lgkmcnt(5)
  buffer_load_dwordx4 v12, s[8:11], s69 offen offset:2048 sc1 lds
  v_add_u32 v119, s53, v20
  v_mfma_f32_16x16x32_bf16 v[52:55], a[48:51], v[108:111], v[52:55]
  s_waitcnt vmcnt(11) lgkmcnt(2)
  s_barrier
  v_mfma_f32_16x16x32_bf16 v[52:55], a[60:63], v[112:115], v[52:55]
  ds_read_b128 v[96:99], v1 offset:64512
  v_mfma_f32_16x16x32_bf16 v[56:59], a[60:63], v[80:83], v[56:59]
  ds_read_b128 v[28:31], v116
  v_mfma_f32_16x16x32_bf16 v[56:59], a[48:51], v[76:79], v[56:59]
  ds_read_b128 v[32:35], v117 offset:1024
  v_mfma_f32_16x16x32_bf16 v[64:67], a[52:55], v[76:79], v[64:67]
  ds_read_b128 v[104:107], v2 offset:49152
  v_mfma_f32_16x16x32_bf16 v[64:67], a[64:67], v[80:83], v[64:67]
  buffer_load_dwordx4 v12, s[8:11], s69 offen offset:3072 sc1 lds
  ds_read_b128 v[36:39], v116 offset:1024
  v_mfma_f32_16x16x32_bf16 v[60:63], a[64:67], v[112:115], v[60:63]
  ds_read_b64_tr_b16 v[40:41], v119 offset:2048
  v_mfma_f32_16x16x32_bf16 v[60:63], a[52:55], v[108:111], v[60:63]
  ds_read_b128 v[100:103], v2 offset:50176
  v_mfma_f32_16x16x32_bf16 v[68:71], a[56:59], v[108:111], v[68:71]
  s_add_u32 m0, s70, 98304
  s_add_u32 s69, s58, 163840
  v_mfma_f32_16x16x32_bf16 v[68:71], a[68:71], v[112:115], v[68:71]
  buffer_load_dwordx4 v12, s[8:11], s69 offen offset:0 sc1 lds
  ds_read_b64_tr_b16 v[42:43], v118 offset:2048
  v_mfma_f32_16x16x32_bf16 v[72:75], a[68:71], v[80:83], v[72:75]
  ds_read_b128 v[108:111], v2 offset:57344
  v_mfma_f32_16x16x32_bf16 v[72:75], a[56:59], v[76:79], v[72:75]
  s_waitcnt lgkmcnt(8)
  ds_read_b64_tr_b16 v[44:45], v119 offset:2056
  v_mfma_f32_16x16x32_bf16 v[52:55], a[72:75], v[88:91], v[52:55]
  ds_read_b64_tr_b16 v[46:47], v118 offset:2056
  v_mfma_f32_16x16x32_bf16 v[52:55], a[84:87], v[84:87], v[52:55]
  ds_read_b128 v[112:115], v2 offset:58368
  v_mfma_f32_16x16x32_bf16 v[56:59], a[84:87], v[96:99], v[56:59]
  buffer_load_dwordx4 v12, s[8:11], s69 offen offset:1024 sc1 lds
  v_mfma_f32_16x16x32_bf16 v[56:59], a[72:75], v[92:95], v[56:59]
  v_mfma_f32_16x16x32_bf16 v[64:67], a[76:79], v[92:95], v[64:67]
  ds_read_b128 v[80:83], v2 offset:51200
  v_mfma_f32_16x16x32_bf16 v[64:67], a[88:91], v[96:99], v[64:67]
  s_waitcnt lgkmcnt(2)
  v_mfma_f32_16x16x32_bf16 v[116:119], v[32:35], v[28:31], 0
  v_mfma_f32_16x16x32_bf16 v[120:123], v[36:39], v[28:31], 0
  v_mfma_f32_16x16x32_bf16 v[60:63], a[88:91], v[84:87], v[60:63]
  v_mfma_f32_16x16x32_bf16 v[60:63], a[76:79], v[88:91], v[60:63]
  ds_read_b128 v[76:79], v2 offset:52224
  v_mfma_f32_16x16x32_bf16 v[68:71], a[80:83], v[88:91], v[68:71]
  buffer_load_dwordx4 v12, s[8:11], s69 offen offset:2048 sc1 lds
  v_mfma_f32_16x16x32_bf16 v[68:71], a[92:95], v[84:87], v[68:71]
  s_nop 1
  v_cndmask_b32 v48, v116, v120, s[80:81]
  v_cndmask_b32 v49, v117, v121, s[82:83]
  v_mfma_f32_16x16x32_bf16 v[72:75], a[92:95], v[96:99], v[72:75]
  ds_read_b128 v[88:91], v2 offset:59392
  v_cndmask_b32 v50, v118, v122, s[84:85]
  v_mfma_f32_16x16x32_bf16 v[72:75], a[80:83], v[92:95], v[72:75]
  s_waitcnt lgkmcnt(3)
  v_cndmask_b32 v51, v119, v123, s[86:87]
  v_cndmask_b32 v48, v48, v49, s[88:89]
  v_mfma_f32_16x16x32_bf16 v[52:55], a[96:99], v[104:107], v[52:55]
  buffer_load_dwordx4 v12, s[8:11], s69 offen offset:3072 sc1 lds
  v_cndmask_b32 v49, v50, v51, s[88:89]
  v_mul_f32 v48, 0x3e8293ee, v48
  v_mfma_f32_16x16x32_bf16 v[52:55], a[108:111], v[100:103], v[52:55]
  ds_read_b128 v[84:87], v2 offset:60416
  v_mul_f32 v49, 0x3e8293ee, v49
  v_mfma_f32_16x16x32_bf16 v[56:59], a[108:111], v[112:115], v[56:59]
  v_mov_b32 v50, 0xce6e6b28
  v_cndmask_b32 v48, v48, v50, s[90:91]
  v_mfma_f32_16x16x32_bf16 v[56:59], a[96:99], v[108:111], v[56:59]
  s_add_u32 m0, s45, 81920
  s_mov_b32 s68, 1572864
  v_mfma_f32_16x16x32_bf16 v[64:67], a[100:103], v[108:111], v[64:67]
  ds_read_b128 v[96:99], v2 offset:53248
  v_cndmask_b32 v49, v49, v50, s[92:93]
  v_mfma_f32_16x16x32_bf16 v[64:67], a[112:115], v[112:115], v[64:67]
  buffer_load_dwordx4 v11, s[20:23], s68 offen nt lds
  v_max_f32 v50, v48, v49
  v_mov_b32 v51, v50
  v_mfma_f32_16x16x32_bf16 v[60:63], a[112:115], v[100:103], v[60:63]
  s_nop 0
  v_permlane16_swap_b32 v50, v51
  v_mfma_f32_16x16x32_bf16 v[60:63], a[100:103], v[104:107], v[60:63]
  ds_read_b128 v[92:95], v2 offset:54272
  v_max_f32 v50, v50, v51
  v_mfma_f32_16x16x32_bf16 v[68:71], a[104:107], v[104:107], v[68:71]
  v_mov_b32 v51, v50
  v_mfma_f32_16x16x32_bf16 v[68:71], a[116:119], v[100:103], v[68:71]
  s_add_u32 m0, s45, 86016
  s_add_u32 s68, s68, 393216
  v_mfma_f32_16x16x32_bf16 v[72:75], a[116:119], v[112:115], v[72:75]
  ds_read_b128 v[104:107], v2 offset:61440
  v_mfma_f32_16x16x32_bf16 v[72:75], a[104:107], v[108:111], v[72:75]
  s_waitcnt lgkmcnt(3)
  buffer_load_dwordx4 v11, s[20:23], s68 offen nt lds
  v_mfma_f32_16x16x32_bf16 v[52:55], a[120:123], v[80:83], v[52:55]
  v_permlane32_swap_b32 v50, v51
  v_mfma_f32_16x16x32_bf16 v[52:55], a[132:135], v[76:79], v[52:55]
  ds_read_b128 v[100:103], v2 offset:62464
  v_max_f32 v50, v50, v51
  v_mfma_f32_16x16x32_bf16 v[56:59], a[132:135], v[84:87], v[56:59]
  s_add_u32 m0, s45, 90112
  s_add_u32 s68, s68, 393216
  v_sub_f32 v48, v48, v50
  v_mfma_f32_16x16x32_bf16 v[56:59], a[120:123], v[88:91], v[56:59]
  buffer_load_dwordx4 v11, s[20:23], s68 offen nt lds
  v_sub_f32 v49, v49, v50
  v_mfma_f32_16x16x32_bf16 v[64:67], a[124:127], v[88:91], v[64:67]
  ds_read_b128 v[112:115], v2 offset:55296
  v_mfma_f32_16x16x32_bf16 v[64:67], a[136:139], v[84:87], v[64:67]
  v_exp_f32 v48, v48
  v_mfma_f32_16x16x32_bf16 v[60:63], a[136:139], v[76:79], v[60:63]
  s_add_u32 m0, s45, 94208
  s_add_u32 s68, s68, 393216
  v_mfma_f32_16x16x32_bf16 v[60:63], a[124:127], v[80:83], v[60:63]
  ds_read_b128 v[108:111], v2 offset:56320
  v_mfma_f32_16x16x32_bf16 v[68:71], a[128:131], v[80:83], v[68:71]
  buffer_load_dwordx4 v11, s[20:23], s68 offen nt lds
  v_exp_f32 v49, v49
  v_mfma_f32_16x16x32_bf16 v[68:71], a[140:143], v[76:79], v[68:71]
  v_add_f32 v50, v48, v49
  v_mov_b32 v51, v50
  v_mfma_f32_16x16x32_bf16 v[72:75], a[140:143], v[84:87], v[72:75]
  ds_read_b128 v[80:83], v2 offset:63488
  v_mfma_f32_16x16x32_bf16 v[72:75], a[128:131], v[88:91], v[72:75]
  s_waitcnt lgkmcnt(3)
  v_permlane16_swap_b32 v50, v51
  v_mfma_f32_16x16x32_bf16 v[52:55], a[144:147], v[96:99], v[52:55]
  v_add_f32 v50, v50, v51
  v_mov_b32 v51, v50
  v_mfma_f32_16x16x32_bf16 v[52:55], a[156:159], v[92:95], v[52:55]
  ds_read_b128 v[76:79], v2 offset:64512
  v_mfma_f32_16x16x32_bf16 v[56:59], a[156:159], v[100:103], v[56:59]
  v_permlane32_swap_b32 v50, v51
  v_mfma_f32_16x16x32_bf16 v[56:59], a[144:147], v[104:107], v[56:59]
  s_waitcnt vmcnt(8)
  s_barrier
  v_mfma_f32_16x16x32_bf16 v[64:67], a[148:151], v[104:107], v[64:67]
  ds_read_b128 v[84:87], v1 offset:0
  v_add_f32 v50, v50, v51
  v_mfma_f32_16x16x32_bf16 v[64:67], a[160:163], v[100:103], v[64:67]
  v_rcp_f32 v50, v50
  v_mfma_f32_16x16x32_bf16 v[60:63], a[160:163], v[92:95], v[60:63]
  v_mul_f32 v48, v48, v50
  v_mul_f32 v49, v49, v50
  v_mfma_f32_16x16x32_bf16 v[60:63], a[148:151], v[96:99], v[60:63]
  ds_read_b128 v[88:91], v1 offset:1024
  v_cvt_pk_bf16_f32 v48, v48, v48
  v_mfma_f32_16x16x32_bf16 v[68:71], a[152:155], v[96:99], v[68:71]
  v_cvt_pk_bf16_f32 v49, v49, v49
  v_and_b32 v28, v24, v48
  v_mfma_f32_16x16x32_bf16 v[68:71], a[164:167], v[92:95], v[68:71]
  v_and_b32 v29, v25, v49
  v_and_b32 v30, v26, v48
  v_mfma_f32_16x16x32_bf16 v[72:75], a[164:167], v[100:103], v[72:75]
  ds_read_b128 v[96:99], v1 offset:8192
  v_and_b32 v31, v27, v49
  v_mfma_f32_16x16x32_bf16 v[72:75], a[152:155], v[104:107], v[72:75]
  s_waitcnt lgkmcnt(3)
  v_mfma_f32_16x16x32_bf16 v[32:35], v[40:43], v[28:31], 0
  v_mfma_f32_16x16x32_bf16 v[36:39], v[44:47], v[28:31], 0
  v_mfma_f32_16x16x32_bf16 v[52:55], a[168:171], v[112:115], v[52:55]
  v_mfma_f32_16x16x32_bf16 v[52:55], a[180:183], v[108:111], v[52:55]
  ds_read_b128 v[92:95], v1 offset:9216
  v_mfma_f32_16x16x32_bf16 v[56:59], a[180:183], v[76:79], v[56:59]
  v_mfma_f32_16x16x32_bf16 v[56:59], a[168:171], v[80:83], v[56:59]
  s_nop 1
  v_cvt_pk_bf16_f32 v116, v32, v33
  v_cvt_pk_bf16_f32 v117, v34, v35
  v_mfma_f32_16x16x32_bf16 v[64:67], a[172:175], v[80:83], v[64:67]
  ds_read_b128 v[100:103], v1 offset:2048
  v_cvt_pk_bf16_f32 v118, v36, v37
  v_mfma_f32_16x16x32_bf16 v[64:67], a[184:187], v[76:79], v[64:67]
  v_cvt_pk_bf16_f32 v119, v38, v39
  v_mfma_f32_16x16x32_bf16 v[60:63], a[184:187], v[108:111], v[60:63]
  buffer_store_dwordx4 v[116:119], v1, s[8:11], s73 offen sc1
  v_mfma_f32_16x16x32_bf16 v[60:63], a[172:175], v[112:115], v[60:63]
  ds_read_b128 v[104:107], v1 offset:3072
  s_add_u32 s73, s73, 65536
  v_mfma_f32_16x16x32_bf16 v[68:71], a[176:179], v[112:115], v[68:71]
  v_mfma_f32_16x16x32_bf16 v[68:71], a[188:191], v[108:111], v[68:71]
  v_mfma_f32_16x16x32_bf16 v[72:75], a[188:191], v[76:79], v[72:75]
  ds_read_b128 v[112:115], v1 offset:10240
  v_mfma_f32_16x16x32_bf16 v[72:75], a[176:179], v[80:83], v[72:75]
  s_waitcnt lgkmcnt(3)
  v_mfma_f32_16x16x32_bf16 v[52:55], a[192:195], v[84:87], v[52:55]
  v_mfma_f32_16x16x32_bf16 v[52:55], a[204:207], v[88:91], v[52:55]
  ds_read_b128 v[108:111], v1 offset:11264
  v_mfma_f32_16x16x32_bf16 v[56:59], a[204:207], v[92:95], v[56:59]
  v_mfma_f32_16x16x32_bf16 v[56:59], a[192:195], v[96:99], v[56:59]
  v_mfma_f32_16x16x32_bf16 v[64:67], a[196:199], v[96:99], v[64:67]
  ds_read_b128 v[76:79], v1 offset:4096
  v_lshrrev_b32 v40, 4, v0
  v_lshlrev_b32 v40, 4, v40
  v_mfma_f32_16x16x32_bf16 v[64:67], a[208:211], v[92:95], v[64:67]
  v_add_u32 v41, 149504, v40
  v_mfma_f32_16x16x32_bf16 v[60:63], a[208:211], v[88:91], v[60:63]
  ds_read_b64_tr_b16 v[116:117], v3 offset:16384
  v_mfma_f32_16x16x32_bf16 v[60:63], a[196:199], v[84:87], v[60:63]
  ds_read_b128 v[80:83], v1 offset:5120
  ds_read_b64_tr_b16 v[118:119], v3 offset:18432
  v_mfma_f32_16x16x32_bf16 v[68:71], a[200:203], v[84:87], v[68:71]
  ds_read_b128 v[28:31], v41 offset:0
  v_mfma_f32_16x16x32_bf16 v[68:71], a[212:215], v[88:91], v[68:71]
  v_mfma_f32_16x16x32_bf16 v[72:75], a[212:215], v[92:95], v[72:75]
  ds_read_b128 v[84:87], v1 offset:12288
  v_mfma_f32_16x16x32_bf16 v[72:75], a[200:203], v[96:99], v[72:75]
  s_waitcnt lgkmcnt(6)
  s_add_u32 m0, s70, 32768
  s_add_u32 s69, s59, 163840
  v_mfma_f32_16x16x32_bf16 v[52:55], a[216:219], v[100:103], v[52:55]
  buffer_load_dwordx4 v12, s[8:11], s69 offen offset:0 sc1 lds
  v_mfma_f32_16x16x32_bf16 v[52:55], a[228:231], v[104:107], v[52:55]
  ds_read_b128 v[88:91], v1 offset:13312
  v_mfma_f32_16x16x32_bf16 v[56:59], a[228:231], v[108:111], v[56:59]
  v_mfma_f32_16x16x32_bf16 v[56:59], a[216:219], v[112:115], v[56:59]
  v_mfma_f32_16x16x32_bf16 v[64:67], a[220:223], v[112:115], v[64:67]
  ds_read_b128 v[92:95], v1 offset:6144
  ds_read_b64_tr_b16 v[120:121], v3 offset:20480
  v_mfma_f32_16x16x32_bf16 v[64:67], a[232:235], v[108:111], v[64:67]
  ds_read_b64_tr_b16 v[122:123], v3 offset:22528
  s_waitcnt lgkmcnt(5)
  v_mfma_f32_16x16x32_bf16 v[36:39], v[116:119], v[28:31], 0
  v_mfma_f32_16x16x32_bf16 v[60:63], a[232:235], v[104:107], v[60:63]
  buffer_load_dwordx4 v12, s[8:11], s69 offen offset:1024 sc1 lds
  ds_read_b128 v[32:35], v41 offset:64
  v_mfma_f32_16x16x32_bf16 v[60:63], a[220:223], v[100:103], v[60:63]
  ds_read_b128 v[96:99], v1 offset:7168
  v_mfma_f32_16x16x32_bf16 v[68:71], a[224:227], v[100:103], v[68:71]
  v_mfma_f32_16x16x32_bf16 v[68:71], a[236:239], v[104:107], v[68:71]
  v_mfma_f32_16x16x32_bf16 v[72:75], a[236:239], v[108:111], v[72:75]
  ds_read_b128 v[100:103], v1 offset:14336
  v_mfma_f32_16x16x32_bf16 v[72:75], a[224:227], v[112:115], v[72:75]
  s_waitcnt lgkmcnt(6)
  buffer_load_dwordx4 v12, s[8:11], s69 offen offset:2048 sc1 lds
  v_mfma_f32_16x16x32_bf16 v[52:55], a[240:243], v[76:79], v[52:55]
  v_mfma_f32_16x16x32_bf16 v[52:55], v[124:127], v[80:83], v[52:55]
  ds_read_b128 v[104:107], v1 offset:15360
  v_mfma_f32_16x16x32_bf16 v[56:59], v[124:127], v[88:91], v[56:59]
  ds_read_b64_tr_b16 v[116:117], v3 offset:24576
  v_and_b32 v42, 15, v0
  v_mfma_f32_16x16x32_bf16 v[56:59], a[240:243], v[84:87], v[56:59]
  ds_read_b64_tr_b16 v[118:119], v3 offset:26624
  buffer_load_dwordx4 v12, s[8:11], s69 offen offset:3072 sc1 lds
  s_waitcnt lgkmcnt(5)
  v_mfma_f32_16x16x32_bf16 v[36:39], v[120:123], v[32:35], v[36:39]
  v_lshl_add_u32 v40, v42, 27, v40
  s_lshr_b32 s52, s2, 2
  v_mfma_f32_16x16x32_bf16 v[64:67], a[244:247], v[84:87], v[64:67]
  ds_read_b128 v[108:111], v2 offset:0
  ds_read_b128 v[28:31], v41 offset:128
  v_mfma_f32_16x16x32_bf16 v[64:67], v[128:131], v[88:91], v[64:67]
  s_lshl_b32 s54, s52, 7
  s_lshl_b32 s52, s52, 8
  s_and_b32 s53, s2, 3
  v_mfma_f32_16x16x32_bf16 v[60:63], v[128:131], v[80:83], v[60:63]
  s_add_u32 m0, s70, 49152
  s_add_u32 s69, s60, 163840
  s_mul_i32 s79, s53, 24576
  v_mfma_f32_16x16x32_bf16 v[60:63], a[244:247], v[76:79], v[60:63]
  ds_read_b128 v[112:115], v2 offset:1024
  s_add_u32 s52, s52, s79
  v_mfma_f32_16x16x32_bf16 v[68:71], a[248:251], v[76:79], v[68:71]
  buffer_load_dwordx4 v12, s[8:11], s69 offen offset:0 sc1 lds
  s_lshl_b32 s79, s44, 6
  s_add_u32 s52, s52, s79
  v_mfma_f32_16x16x32_bf16 v[68:71], v[132:135], v[80:83], v[68:71]
  s_add_u32 s52, s52, 8192
  s_lshl_b32 s53, s53, 2
  s_add_u32 s54, s54, s53
  v_mfma_f32_16x16x32_bf16 v[72:75], v[132:135], v[88:91], v[72:75]
  ds_read_b128 v[76:79], v2 offset:8192
  s_add_u32 s54, s54, 720896
  v_mfma_f32_16x16x32_bf16 v[72:75], a[248:251], v[84:87], v[72:75]
  s_waitcnt lgkmcnt(6)
  s_cmp_eq_u32 s44, 0
  s_cselect_b32 s79, s54, 1073741824
  v_mfma_f32_16x16x32_bf16 v[52:55], v[136:139], v[92:95], v[52:55]
  ds_read_b64_tr_b16 v[120:121], v3 offset:28672
  v_mfma_f32_16x16x32_bf16 v[52:55], v[148:151], v[96:99], v[52:55]
  ds_read_b128 v[80:83], v2 offset:9216
  ds_read_b64_tr_b16 v[122:123], v3 offset:30720
  s_waitcnt lgkmcnt(5)
  v_mfma_f32_16x16x32_bf16 v[36:39], v[116:119], v[28:31], v[36:39]
  v_mfma_f32_16x16x32_bf16 v[56:59], v[148:151], v[104:107], v[56:59]
  buffer_load_dwordx4 v12, s[8:11], s69 offen offset:1024 sc1 lds
  ds_read_b128 v[32:35], v41 offset:192
  v_mfma_f32_16x16x32_bf16 v[56:59], v[136:139], v[100:103], v[56:59]
  v_mfma_f32_16x16x32_bf16 v[64:67], v[140:143], v[100:103], v[64:67]
  ds_read_b128 v[88:91], v2 offset:2048
  v_mfma_f32_16x16x32_bf16 v[64:67], v[152:155], v[104:107], v[64:67]
  v_mfma_f32_16x16x32_bf16 v[60:63], v[152:155], v[96:99], v[60:63]
  buffer_load_dwordx4 v12, s[8:11], s69 offen offset:2048 sc1 lds
  v_mfma_f32_16x16x32_bf16 v[60:63], v[140:143], v[92:95], v[60:63]
  ds_read_b128 v[84:87], v2 offset:3072
  v_mfma_f32_16x16x32_bf16 v[68:71], v[144:147], v[92:95], v[68:71]
  v_mfma_f32_16x16x32_bf16 v[68:71], v[156:159], v[96:99], v[68:71]
  s_waitcnt vmcnt(8)
  s_barrier
  v_mfma_f32_16x16x32_bf16 v[72:75], v[156:159], v[104:107], v[72:75]
  ds_read_b128 v[92:95], v2 offset:10240
  ds_read_b64_tr_b16 v[116:117], v6 offset:16384
  v_mfma_f32_16x16x32_bf16 v[72:75], v[144:147], v[100:103], v[72:75]
  s_waitcnt lgkmcnt(6)
  ds_read_b64_tr_b16 v[118:119], v6 offset:18432
  s_waitcnt lgkmcnt(5)
  v_mfma_f32_16x16x32_bf16 v[36:39], v[120:123], v[32:35], v[36:39]
  v_mfma_f32_16x16x32_bf16 v[52:55], v[160:163], v[108:111], v[52:55]
  buffer_load_dwordx4 v12, s[8:11], s69 offen offset:3072 sc1 lds
  ds_read_b128 v[28:31], v41 offset:256
  v_mfma_f32_16x16x32_bf16 v[52:55], v[172:175], v[112:115], v[52:55]
  ds_read_b128 v[96:99], v2 offset:11264
  v_mfma_f32_16x16x32_bf16 v[56:59], v[172:175], v[80:83], v[56:59]
  v_mfma_f32_16x16x32_bf16 v[56:59], v[160:163], v[76:79], v[56:59]
  s_add_u32 m0, s70, 114688
  s_add_u32 s69, s61, 163840
  v_mfma_f32_16x16x32_bf16 v[64:67], v[164:167], v[76:79], v[64:67]
  ds_read_b128 v[104:107], v2 offset:4096
  v_mfma_f32_16x16x32_bf16 v[64:67], v[176:179], v[80:83], v[64:67]
  buffer_load_dwordx4 v12, s[8:11], s69 offen offset:0 sc1 lds
  v_mfma_f32_16x16x32_bf16 v[60:63], v[176:179], v[112:115], v[60:63]
  v_mfma_f32_16x16x32_bf16 v[60:63], v[164:167], v[108:111], v[60:63]
  ds_read_b128 v[100:103], v2 offset:5120
  v_mfma_f32_16x16x32_bf16 v[68:71], v[168:171], v[108:111], v[68:71]
  ds_read_b64_tr_b16 v[120:121], v6 offset:20480
  v_mfma_f32_16x16x32_bf16 v[68:71], v[180:183], v[112:115], v[68:71]
  ds_read_b64_tr_b16 v[122:123], v6 offset:22528
  buffer_load_dwordx4 v12, s[8:11], s69 offen offset:1024 sc1 lds
  s_waitcnt lgkmcnt(5)
  v_mfma_f32_16x16x32_bf16 v[36:39], v[116:119], v[28:31], v[36:39]
  v_mfma_f32_16x16x32_bf16 v[72:75], v[180:183], v[80:83], v[72:75]
  ds_read_b128 v[108:111], v2 offset:12288
  ds_read_b128 v[32:35], v41 offset:320
  v_mfma_f32_16x16x32_bf16 v[72:75], v[168:171], v[76:79], v[72:75]
  s_waitcnt lgkmcnt(6)
  v_mfma_f32_16x16x32_bf16 v[52:55], v[184:187], v[88:91], v[52:55]
  v_mfma_f32_16x16x32_bf16 v[52:55], v[196:199], v[84:87], v[52:55]
  ds_read_b128 v[112:115], v2 offset:13312
  v_mfma_f32_16x16x32_bf16 v[56:59], v[196:199], v[96:99], v[56:59]
  buffer_load_dwordx4 v12, s[8:11], s69 offen offset:2048 sc1 lds
  v_mfma_f32_16x16x32_bf16 v[56:59], v[184:187], v[92:95], v[56:59]
  v_mfma_f32_16x16x32_bf16 v[64:67], v[188:191], v[92:95], v[64:67]
  ds_read_b128 v[80:83], v2 offset:6144
  v_mfma_f32_16x16x32_bf16 v[64:67], v[200:203], v[96:99], v[64:67]
  v_mfma_f32_16x16x32_bf16 v[60:63], v[200:203], v[84:87], v[60:63]
  ds_read_b64_tr_b16 v[116:117], v6 offset:24576
  v_mfma_f32_16x16x32_bf16 v[60:63], v[188:191], v[88:91], v[60:63]
  ds_read_b128 v[76:79], v2 offset:7168
  ds_read_b64_tr_b16 v[118:119], v6 offset:26624
  s_waitcnt lgkmcnt(5)
  v_mfma_f32_16x16x32_bf16 v[36:39], v[120:123], v[32:35], v[36:39]
  v_mfma_f32_16x16x32_bf16 v[68:71], v[192:195], v[88:91], v[68:71]
  buffer_load_dwordx4 v12, s[8:11], s69 offen offset:3072 sc1 lds
  ds_read_b128 v[28:31], v41 offset:384
  v_mfma_f32_16x16x32_bf16 v[68:71], v[204:207], v[84:87], v[68:71]
  v_mfma_f32_16x16x32_bf16 v[72:75], v[204:207], v[96:99], v[72:75]
  ds_read_b128 v[88:91], v2 offset:14336
  v_mfma_f32_16x16x32_bf16 v[72:75], v[192:195], v[92:95], v[72:75]
  s_waitcnt lgkmcnt(6)
  s_add_u32 m0, s70, 0
  s_add_u32 s69, s58, 229376
  v_mfma_f32_16x16x32_bf16 v[52:55], v[208:211], v[104:107], v[52:55]
  buffer_load_dwordx4 v12, s[8:11], s69 offen offset:0 sc1 lds
  v_mfma_f32_16x16x32_bf16 v[52:55], v[220:223], v[100:103], v[52:55]
  ds_read_b128 v[84:87], v2 offset:15360
  v_mfma_f32_16x16x32_bf16 v[56:59], v[220:223], v[112:115], v[56:59]
  v_mfma_f32_16x16x32_bf16 v[56:59], v[208:211], v[108:111], v[56:59]
  v_mfma_f32_16x16x32_bf16 v[64:67], v[212:215], v[108:111], v[64:67]
  ds_read_b128 v[96:99], v2 offset:32768
  ds_read_b64_tr_b16 v[120:121], v6 offset:28672
  v_mfma_f32_16x16x32_bf16 v[64:67], v[224:227], v[112:115], v[64:67]
  ds_read_b64_tr_b16 v[122:123], v6 offset:30720
  s_waitcnt lgkmcnt(5)
  v_mfma_f32_16x16x32_bf16 v[36:39], v[116:119], v[28:31], v[36:39]
  v_mfma_f32_16x16x32_bf16 v[60:63], v[224:227], v[100:103], v[60:63]
  buffer_load_dwordx4 v12, s[8:11], s69 offen offset:1024 sc1 lds
  ds_read_b128 v[32:35], v41 offset:448
  v_mfma_f32_16x16x32_bf16 v[60:63], v[212:215], v[104:107], v[60:63]
  ds_read_b128 v[92:95], v2 offset:33792
  v_mfma_f32_16x16x32_bf16 v[68:71], v[216:219], v[104:107], v[68:71]
  v_mfma_f32_16x16x32_bf16 v[68:71], v[228:231], v[100:103], v[68:71]
  v_mfma_f32_16x16x32_bf16 v[72:75], v[228:231], v[112:115], v[72:75]
  ds_read_b128 v[104:107], v2 offset:40960
  v_mfma_f32_16x16x32_bf16 v[72:75], v[216:219], v[108:111], v[72:75]
  s_waitcnt lgkmcnt(6)
  buffer_load_dwordx4 v12, s[8:11], s69 offen offset:2048 sc1 lds
  v_mfma_f32_16x16x32_bf16 v[52:55], v[232:235], v[80:83], v[52:55]
  v_mfma_f32_16x16x32_bf16 v[52:55], v[244:247], v[76:79], v[52:55]
  ds_read_b128 v[100:103], v2 offset:41984
  v_mfma_f32_16x16x32_bf16 v[56:59], v[244:247], v[84:87], v[56:59]
  v_mfma_f32_16x16x32_bf16 v[56:59], v[232:235], v[88:91], v[56:59]
  buffer_load_dwordx4 v12, s[8:11], s69 offen offset:3072 sc1 lds
  s_waitcnt lgkmcnt(3)
  v_mfma_f32_16x16x32_bf16 v[36:39], v[120:123], v[32:35], v[36:39]
  v_mfma_f32_16x16x32_bf16 v[64:67], v[236:239], v[88:91], v[64:67]
  ds_read_b128 v[112:115], v2 offset:34816
  v_mfma_f32_16x16x32_bf16 v[64:67], v[248:251], v[84:87], v[64:67]
  v_mfma_f32_16x16x32_bf16 v[60:63], v[248:251], v[76:79], v[60:63]
  v_mfma_f32_16x16x32_bf16 v[60:63], v[236:239], v[80:83], v[60:63]
  ds_read_b128 v[108:111], v2 offset:35840
  v_mfma_f32_16x16x32_bf16 v[68:71], v[240:243], v[80:83], v[68:71]
  s_nop 0
  buffer_store_dwordx4 v[36:39], v40, s[8:11], s52 offen sc1
  v_mfma_f32_16x16x32_bf16 v[68:71], v[252:255], v[76:79], v[68:71]
  v_mfma_f32_16x16x32_bf16 v[72:75], v[252:255], v[84:87], v[72:75]
  ds_read_b128 v[80:83], v2 offset:43008
  v_mfma_f32_16x16x32_bf16 v[72:75], v[240:243], v[88:91], v[72:75]
  s_waitcnt lgkmcnt(3)
  v_mfma_f32_16x16x32_bf16 v[28:31], a[0:3], v[96:99], 0
  v_mfma_f32_16x16x32_bf16 v[28:31], a[12:15], v[92:95], v[28:31]
  ds_read_b128 v[76:79], v2 offset:44032
  v_mfma_f32_16x16x32_bf16 v[32:35], a[12:15], v[100:103], 0
  v_mfma_f32_16x16x32_bf16 v[32:35], a[0:3], v[104:107], v[32:35]
  v_cvt_pk_bf16_f32 v52, v52, v53
  v_cvt_pk_bf16_f32 v53, v54, v55
  v_mfma_f32_16x16x32_bf16 v[40:43], a[4:7], v[104:107], 0
  ds_read_b128 v[84:87], v2 offset:36864
  v_mfma_f32_16x16x32_bf16 v[40:43], a[16:19], v[100:103], v[40:43]
  ds_write_b64 v18, v[52:53] offset:0
  v_mfma_f32_16x16x32_bf16 v[36:39], a[16:19], v[92:95], 0
  v_cvt_pk_bf16_f32 v60, v60, v61
  v_cvt_pk_bf16_f32 v61, v62, v63
  v_mfma_f32_16x16x32_bf16 v[36:39], a[4:7], v[96:99], v[36:39]
  ds_read_b128 v[88:91], v2 offset:37888
  v_cvt_pk_bf16_f32 v62, v68, v69
  v_cvt_pk_bf16_f32 v63, v70, v71
  v_mfma_f32_16x16x32_bf16 v[44:47], a[8:11], v[96:99], 0
  ds_write_b128 v17, v[60:63] offset:1024
  v_mfma_f32_16x16x32_bf16 v[44:47], a[20:23], v[92:95], v[44:47]
  v_cvt_pk_bf16_f32 v56, v56, v57
  v_cvt_pk_bf16_f32 v57, v58, v59
  v_mfma_f32_16x16x32_bf16 v[48:51], a[20:23], v[100:103], 0
  ds_read_b128 v[96:99], v2 offset:45056
  v_mfma_f32_16x16x32_bf16 v[48:51], a[8:11], v[104:107], v[48:51]
  s_waitcnt lgkmcnt(5)
  ds_write_b64 v18, v[56:57] offset:6144
  v_mfma_f32_16x16x32_bf16 v[28:31], a[24:27], v[112:115], v[28:31]
  v_cvt_pk_bf16_f32 v64, v64, v65
  v_cvt_pk_bf16_f32 v65, v66, v67
  v_mfma_f32_16x16x32_bf16 v[28:31], a[36:39], v[108:111], v[28:31]
  ds_read_b128 v[92:95], v2 offset:46080
  v_cvt_pk_bf16_f32 v66, v72, v73
  v_mfma_f32_16x16x32_bf16 v[32:35], a[36:39], v[76:79], v[32:35]
  v_cvt_pk_bf16_f32 v67, v74, v75
  v_mfma_f32_16x16x32_bf16 v[32:35], a[24:27], v[80:83], v[32:35]
  ds_write_b128 v17, v[64:67] offset:7168
  v_mfma_f32_16x16x32_bf16 v[40:43], a[28:31], v[80:83], v[40:43]
  ds_read_b128 v[100:103], v2 offset:38912
  v_mfma_f32_16x16x32_bf16 v[40:43], a[40:43], v[76:79], v[40:43]
  s_bitcmp1_b32 s44, 0
  s_mov_b32 s52, 0
  s_cselect_b32 s52, 6144, s52
  s_mov_b32 s53, 12288
  s_cselect_b32 s53, 0, s53
  v_mfma_f32_16x16x32_bf16 v[36:39], a[40:43], v[108:111], v[36:39]
  v_add_u32 v116, s52, v19
  v_add_u32 v117, s53, v19
  v_mfma_f32_16x16x32_bf16 v[36:39], a[28:31], v[112:115], v[36:39]
  ds_read_b128 v[104:107], v2 offset:39936
  v_add_u32 v118, s52, v20
  v_mfma_f32_16x16x32_bf16 v[44:47], a[32:35], v[112:115], v[44:47]
  v_add_u32 v119, s53, v20
  v_mfma_f32_16x16x32_bf16 v[44:47], a[44:47], v[108:111], v[44:47]
  s_waitcnt vmcnt(13) lgkmcnt(2)
  s_barrier
  v_mfma_f32_16x16x32_bf16 v[48:51], a[44:47], v[76:79], v[48:51]
  ds_read_b128 v[112:115], v2 offset:47104
  v_mfma_f32_16x16x32_bf16 v[48:51], a[32:35], v[80:83], v[48:51]
  s_waitcnt lgkmcnt(4)
  s_add_u32 m0, s45, 16384
  s_add_u32 s68, s67, 0
  s_and_b32 s68, s68, 7
  s_mul_i32 s68, s68, 262144
  v_mfma_f32_16x16x32_bf16 v[28:31], a[48:51], v[84:87], v[28:31]
HOP3:
  s_cbranch_execz HOP7
  buffer_load_dwordx4 v10, s[16:19], s68 offen lds
  ds_read_b128 v[52:55], v116
  v_mfma_f32_16x16x32_bf16 v[28:31], a[60:63], v[88:91], v[28:31]
  ds_read_b128 v[108:111], v2 offset:48128
  v_mfma_f32_16x16x32_bf16 v[32:35], a[60:63], v[92:95], v[32:35]
  ds_read_b128 v[56:59], v117 offset:1024
  v_mfma_f32_16x16x32_bf16 v[32:35], a[48:51], v[96:99], v[32:35]
  s_add_u32 m0, s45, 20480
  s_add_u32 s68, s68, 65536
  v_mfma_f32_16x16x32_bf16 v[40:43], a[52:55], v[96:99], v[40:43]
  ds_read_b128 v[76:79], v1 offset:32768
  v_mfma_f32_16x16x32_bf16 v[40:43], a[64:67], v[92:95], v[40:43]
  buffer_load_dwordx4 v10, s[16:19], s68 offen lds
  ds_read_b128 v[60:63], v116 offset:1024
  v_mfma_f32_16x16x32_bf16 v[36:39], a[64:67], v[88:91], v[36:39]
  ds_read_b64_tr_b16 v[64:65], v119 offset:2048
  v_mfma_f32_16x16x32_bf16 v[36:39], a[52:55], v[84:87], v[36:39]
  ds_read_b128 v[80:83], v1 offset:33792
  v_mfma_f32_16x16x32_bf16 v[44:47], a[56:59], v[84:87], v[44:47]
  s_add_u32 m0, s45, 24576
  s_add_u32 s68, s68, 65536
  v_mfma_f32_16x16x32_bf16 v[44:47], a[68:71], v[88:91], v[44:47]
  buffer_load_dwordx4 v10, s[16:19], s68 offen lds
  ds_read_b64_tr_b16 v[66:67], v118 offset:2048
  v_mfma_f32_16x16x32_bf16 v[48:51], a[68:71], v[92:95], v[48:51]
  ds_read_b128 v[84:87], v1 offset:40960
  v_mfma_f32_16x16x32_bf16 v[48:51], a[56:59], v[96:99], v[48:51]
  s_waitcnt lgkmcnt(7)
  ds_read_b64_tr_b16 v[68:69], v119 offset:2056
  v_mfma_f32_16x16x32_bf16 v[28:31], a[72:75], v[100:103], v[28:31]
  s_add_u32 m0, s45, 28672
  s_add_u32 s68, s68, 65536
  v_mfma_f32_16x16x32_bf16 v[28:31], a[84:87], v[104:107], v[28:31]
  ds_read_b128 v[88:91], v1 offset:41984
  v_mfma_f32_16x16x32_bf16 v[32:35], a[84:87], v[108:111], v[32:35]
  buffer_load_dwordx4 v10, s[16:19], s68 offen lds
  ds_read_b64_tr_b16 v[70:71], v118 offset:2056
  v_mfma_f32_16x16x32_bf16 v[32:35], a[72:75], v[112:115], v[32:35]
  v_mfma_f32_16x16x32_bf16 v[40:43], a[76:79], v[112:115], v[40:43]
  ds_read_b128 v[92:95], v1 offset:34816
  v_mfma_f32_16x16x32_bf16 v[40:43], a[88:91], v[108:111], v[40:43]
  v_mfma_f32_16x16x32_bf16 v[36:39], a[88:91], v[104:107], v[36:39]
  s_add_u32 m0, s70, 65536
  s_add_u32 s69, s59, 229376
  v_mfma_f32_16x16x32_bf16 v[36:39], a[76:79], v[100:103], v[36:39]
  ds_read_b128 v[96:99], v1 offset:35840
  s_waitcnt lgkmcnt(2)
  v_mfma_f32_16x16x32_bf16 v[116:119], v[56:59], v[52:55], 0
  v_mfma_f32_16x16x32_bf16 v[120:123], v[60:63], v[52:55], 0
  v_mfma_f32_16x16x32_bf16 v[44:47], a[80:83], v[100:103], v[44:47]
  buffer_load_dwordx4 v12, s[8:11], s69 offen offset:0 sc1 lds
  v_mfma_f32_16x16x32_bf16 v[44:47], a[92:95], v[104:107], v[44:47]
  v_mfma_f32_16x16x32_bf16 v[48:51], a[92:95], v[108:111], v[48:51]
  ds_read_b128 v[100:103], v1 offset:43008
  v_mfma_f32_16x16x32_bf16 v[48:51], a[80:83], v[112:115], v[48:51]
  s_waitcnt lgkmcnt(4)
  s_nop 0
  v_cndmask_b32 v72, v116, v120, s[80:81]
  v_cndmask_b32 v73, v117, v121, s[82:83]
  v_mfma_f32_16x16x32_bf16 v[28:31], a[96:99], v[76:79], v[28:31]
  buffer_load_dwordx4 v12, s[8:11], s69 offen offset:1024 sc1 lds
  v_cndmask_b32 v74, v118, v122, s[84:85]
  v_cndmask_b32 v75, v119, v123, s[86:87]
  v_mfma_f32_16x16x32_bf16 v[28:31], a[108:111], v[80:83], v[28:31]
  ds_read_b128 v[104:107], v1 offset:44032
  v_cndmask_b32 v72, v72, v73, s[88:89]
  v_mfma_f32_16x16x32_bf16 v[32:35], a[108:111], v[88:91], v[32:35]
  v_cndmask_b32 v73, v74, v75, s[88:89]
  v_mul_f32 v72, 0x3e8293ee, v72
  v_mfma_f32_16x16x32_bf16 v[32:35], a[96:99], v[84:87], v[32:35]
  v_mul_f32 v73, 0x3e8293ee, v73
  v_max_f32 v74, v72, v73
  v_mfma_f32_16x16x32_bf16 v[40:43], a[100:103], v[84:87], v[40:43]
  ds_read_b128 v[108:111], v1 offset:36864
  v_mov_b32 v75, v74
  v_mfma_f32_16x16x32_bf16 v[40:43], a[112:115], v[88:91], v[40:43]
  buffer_load_dwordx4 v12, s[8:11], s69 offen offset:2048 sc1 lds
  v_permlane16_swap_b32 v74, v75
  v_mfma_f32_16x16x32_bf16 v[36:39], a[112:115], v[80:83], v[36:39]
  v_max_f32 v74, v74, v75
  v_mov_b32 v75, v74
  v_mfma_f32_16x16x32_bf16 v[36:39], a[100:103], v[76:79], v[36:39]
  ds_read_b128 v[112:115], v1 offset:37888
  v_mfma_f32_16x16x32_bf16 v[44:47], a[104:107], v[76:79], v[44:47]
  v_permlane32_swap_b32 v74, v75
  v_mfma_f32_16x16x32_bf16 v[44:47], a[116:119], v[80:83], v[44:47]
  v_max_f32 v74, v74, v75
  v_sub_f32 v72, v72, v74
  v_mfma_f32_16x16x32_bf16 v[48:51], a[116:119], v[88:91], v[48:51]
  ds_read_b128 v[76:79], v1 offset:45056
  v_sub_f32 v73, v73, v74
  v_mfma_f32_16x16x32_bf16 v[48:51], a[104:107], v[84:87], v[48:51]
  s_waitcnt lgkmcnt(3)
  buffer_load_dwordx4 v12, s[8:11], s69 offen offset:3072 sc1 lds
  v_mfma_f32_16x16x32_bf16 v[28:31], a[120:123], v[92:95], v[28:31]
  v_exp_f32 v72, v72
  v_mfma_f32_16x16x32_bf16 v[28:31], a[132:135], v[96:99], v[28:31]
  ds_read_b128 v[80:83], v1 offset:46080
  v_mfma_f32_16x16x32_bf16 v[32:35], a[132:135], v[104:107], v[32:35]
  s_add_u32 m0, s45, 81920
  s_add_u32 s68, s67, 1
  s_and_b32 s68, s68, 7
  s_mul_i32 s68, s68, 262144
  v_mfma_f32_16x16x32_bf16 v[32:35], a[120:123], v[100:103], v[32:35]
  buffer_load_dwordx4 v10, s[16:19], s68 offen lds
  v_exp_f32 v73, v73
  v_mfma_f32_16x16x32_bf16 v[40:43], a[124:127], v[100:103], v[40:43]
  ds_read_b128 v[88:91], v1 offset:38912
  v_add_f32 v74, v72, v73
  v_mfma_f32_16x16x32_bf16 v[40:43], a[136:139], v[104:107], v[40:43]
  v_mov_b32 v75, v74
  v_mfma_f32_16x16x32_bf16 v[36:39], a[136:139], v[96:99], v[36:39]
  s_add_u32 m0, s45, 86016
  s_add_u32 s68, s68, 65536
  v_mfma_f32_16x16x32_bf16 v[36:39], a[124:127], v[92:95], v[36:39]
  ds_read_b128 v[84:87], v1 offset:39936
  v_mfma_f32_16x16x32_bf16 v[44:47], a[128:131], v[92:95], v[44:47]
  buffer_load_dwordx4 v10, s[16:19], s68 offen lds
  v_permlane16_swap_b32 v74, v75
  v_mfma_f32_16x16x32_bf16 v[44:47], a[140:143], v[96:99], v[44:47]
  v_add_f32 v74, v74, v75
  v_mov_b32 v75, v74
  v_mfma_f32_16x16x32_bf16 v[48:51], a[140:143], v[104:107], v[48:51]
  ds_read_b128 v[92:95], v1 offset:47104
  v_mfma_f32_16x16x32_bf16 v[48:51], a[128:131], v[100:103], v[48:51]
  s_waitcnt lgkmcnt(3)
  v_permlane32_swap_b32 v74, v75
  v_mfma_f32_16x16x32_bf16 v[28:31], a[144:147], v[108:111], v[28:31]
  s_add_u32 m0, s45, 90112
  s_add_u32 s68, s68, 65536
  v_add_f32 v74, v74, v75
  v_mfma_f32_16x16x32_bf16 v[28:31], a[156:159], v[112:115], v[28:31]
  ds_read_b128 v[96:99], v1 offset:48128
  v_mfma_f32_16x16x32_bf16 v[32:35], a[156:159], v[80:83], v[32:35]
  buffer_load_dwordx4 v10, s[16:19], s68 offen lds
  v_rcp_f32 v74, v74
  v_mfma_f32_16x16x32_bf16 v[32:35], a[144:147], v[76:79], v[32:35]
  s_waitcnt vmcnt(11)
  s_barrier
  v_mfma_f32_16x16x32_bf16 v[40:43], a[148:151], v[76:79], v[40:43]
  ds_read_b128 v[104:107], v1 offset:49152
  v_mul_f32 v72, v72, v74
  v_add_u32 v15, s46, v0
  s_mov_b64 exec, 1
  buffer_store_dword v15, v0, s[8:11], s79 offen offset:0 sc1
  s_mov_b64 exec, -1
  v_mfma_f32_16x16x32_bf16 v[40:43], a[160:163], v[80:83], v[40:43]
  s_add_u32 m0, s45, 94208
  s_add_u32 s68, s68, 65536
  v_mul_f32 v73, v73, v74
  v_mfma_f32_16x16x32_bf16 v[36:39], a[160:163], v[112:115], v[36:39]
  buffer_load_dwordx4 v10, s[16:19], s68 offen lds
  v_cvt_pk_bf16_f32 v72, v72, v72
  v_cvt_pk_bf16_f32 v73, v73, v73
  v_mfma_f32_16x16x32_bf16 v[36:39], a[148:151], v[108:111], v[36:39]
  ds_read_b128 v[100:103], v1 offset:50176
  v_and_b32 v52, v24, v72
  v_mfma_f32_16x16x32_bf16 v[44:47], a[152:155], v[108:111], v[44:47]
  v_and_b32 v53, v25, v73
  v_and_b32 v54, v26, v72
  v_mfma_f32_16x16x32_bf16 v[44:47], a[164:167], v[112:115], v[44:47]
  v_and_b32 v55, v27, v73
  v_mfma_f32_16x16x32_bf16 v[48:51], a[164:167], v[80:83], v[48:51]
  ds_read_b128 v[108:111], v1 offset:57344
  v_mfma_f32_16x16x32_bf16 v[56:59], v[64:67], v[52:55], 0
  v_mfma_f32_16x16x32_bf16 v[60:63], v[68:71], v[52:55], 0
  v_mfma_f32_16x16x32_bf16 v[48:51], a[152:155], v[76:79], v[48:51]
  s_waitcnt lgkmcnt(3)
  s_add_u32 m0, s70, 98304
  s_add_u32 s69, s60, 229376
  v_mfma_f32_16x16x32_bf16 v[28:31], a[168:171], v[88:91], v[28:31]
  buffer_load_dwordx4 v12, s[8:11], s69 offen offset:0 sc1 lds
  v_mfma_f32_16x16x32_bf16 v[28:31], a[180:183], v[84:87], v[28:31]
  ds_read_b128 v[112:115], v1 offset:58368
  v_mfma_f32_16x16x32_bf16 v[32:35], a[180:183], v[96:99], v[32:35]
  v_cvt_pk_bf16_f32 v116, v56, v57
  v_cvt_pk_bf16_f32 v117, v58, v59
  v_mfma_f32_16x16x32_bf16 v[32:35], a[168:171], v[92:95], v[32:35]
  v_cvt_pk_bf16_f32 v118, v60, v61
  v_cvt_pk_bf16_f32 v119, v62, v63
  v_mfma_f32_16x16x32_bf16 v[40:43], a[172:175], v[92:95], v[40:43]
  ds_read_b128 v[80:83], v1 offset:51200
  v_mfma_f32_16x16x32_bf16 v[40:43], a[184:187], v[96:99], v[40:43]
  buffer_load_dwordx4 v12, s[8:11], s69 offen offset:1024 sc1 lds
  buffer_store_dwordx4 v[116:119], v1, s[8:11], s73 offen sc1
  v_mfma_f32_16x16x32_bf16 v[36:39], a[184:187], v[84:87], v[36:39]
  s_add_u32 s73, s73, 65536
  v_mfma_f32_16x16x32_bf16 v[36:39], a[172:175], v[88:91], v[36:39]
  ds_read_b128 v[76:79], v1 offset:52224
  v_mfma_f32_16x16x32_bf16 v[44:47], a[176:179], v[88:91], v[44:47]
  v_mfma_f32_16x16x32_bf16 v[44:47], a[188:191], v[84:87], v[44:47]
  buffer_load_dwordx4 v12, s[8:11], s69 offen offset:2048 sc1 lds
  v_mfma_f32_16x16x32_bf16 v[48:51], a[188:191], v[96:99], v[48:51]
  ds_read_b128 v[88:91], v1 offset:59392
  v_lshrrev_b32 v116, 3, v0
  v_mfma_f32_16x16x32_bf16 v[48:51], a[176:179], v[92:95], v[48:51]
  s_waitcnt lgkmcnt(3)
  v_bfe_u32 v117, v116, 1, 2
  v_bfe_u32 v118, v0, 1, 2
  v_mfma_f32_16x16x32_bf16 v[28:31], a[192:195], v[104:107], v[28:31]
  v_xor_b32 v117, v117, v118
  s_lshl_b32 s52, s44, 3
  v_mfma_f32_16x16x32_bf16 v[28:31], a[204:207], v[100:103], v[28:31]
  ds_read_b128 v[84:87], v1 offset:60416
  v_add_u32 v116, s52, v116
  v_mfma_f32_16x16x32_bf16 v[32:35], a[204:207], v[112:115], v[32:35]
  buffer_load_dwordx4 v12, s[8:11], s69 offen offset:3072 sc1 lds
  v_mul_u32_u24 v116, 7168, v116
  v_and_b32 v118, 1, v0
  v_mfma_f32_16x16x32_bf16 v[32:35], a[192:195], v[108:111], v[32:35]
  v_lshl_add_u32 v116, v118, 4, v116
  s_and_b32 s52, s2, 7
  v_mfma_f32_16x16x32_bf16 v[40:43], a[196:199], v[108:111], v[40:43]
  ds_read_b128 v[96:99], v1 offset:53248
  s_mul_i32 s52, s52, 896
  v_mfma_f32_16x16x32_bf16 v[40:43], a[208:211], v[112:115], v[40:43]
  v_add_u32 v116, s52, v116
  v_lshlrev_b32 v118, 5, v117
  v_mfma_f32_16x16x32_bf16 v[36:39], a[208:211], v[100:103], v[36:39]
  s_and_b32 s53, s2, 24
  s_lshl_b32 s52, s53, 5
  v_add3_u32 v16, v116, v118, s52
  v_mfma_f32_16x16x32_bf16 v[36:39], a[196:199], v[104:107], v[36:39]
  ds_read_b128 v[92:95], v1 offset:54272
  s_lshr_b32 s52, 0x0b070602, s53
  v_mfma_f32_16x16x32_bf16 v[44:47], a[200:203], v[104:107], v[44:47]
  s_and_b32 s52, s52, 15
  s_lshl_b32 s52, s52, 6
  v_add_u32 v118, s52, v118
  v_mfma_f32_16x16x32_bf16 v[44:47], a[212:215], v[100:103], v[44:47]
  s_lshr_b32 s52, 0x15140706, s53
  s_and_b32 s52, s52, 31
  s_lshl_b32 s52, s52, 5
  v_mfma_f32_16x16x32_bf16 v[48:51], a[212:215], v[112:115], v[48:51]
  ds_read_b128 v[104:107], v1 offset:61440
  v_mov_b32 v119, s52
  v_mfma_f32_16x16x32_bf16 v[48:51], a[200:203], v[108:111], v[48:51]
  s_waitcnt lgkmcnt(3)
  v_cmp_gt_u32 vcc, 2, v117
  s_nop 1
  v_cndmask_b32 v118, v119, v118, vcc
  v_mfma_f32_16x16x32_bf16 v[28:31], a[216:219], v[80:83], v[28:31]
  v_add_u32 v11, v116, v118
  v_mfma_f32_16x16x32_bf16 v[28:31], a[228:231], v[76:79], v[28:31]
  ds_read_b128 v[100:103], v1 offset:62464
  v_mfma_f32_16x16x32_bf16 v[32:35], a[228:231], v[84:87], v[32:35]
  v_mfma_f32_16x16x32_bf16 v[32:35], a[216:219], v[88:91], v[32:35]
  v_mfma_f32_16x16x32_bf16 v[40:43], a[220:223], v[88:91], v[40:43]
  ds_read_b128 v[112:115], v1 offset:55296
  v_mfma_f32_16x16x32_bf16 v[40:43], a[232:235], v[84:87], v[40:43]
  v_mfma_f32_16x16x32_bf16 v[36:39], a[232:235], v[76:79], v[36:39]
  v_mfma_f32_16x16x32_bf16 v[36:39], a[220:223], v[80:83], v[36:39]
  ds_read_b128 v[108:111], v1 offset:56320
  v_mfma_f32_16x16x32_bf16 v[44:47], a[224:227], v[80:83], v[44:47]
  v_mfma_f32_16x16x32_bf16 v[44:47], a[236:239], v[76:79], v[44:47]
  v_mfma_f32_16x16x32_bf16 v[48:51], a[236:239], v[84:87], v[48:51]
  ds_read_b128 v[80:83], v1 offset:63488
  v_mfma_f32_16x16x32_bf16 v[48:51], a[224:227], v[88:91], v[48:51]
  s_waitcnt lgkmcnt(3)
  v_mfma_f32_16x16x32_bf16 v[28:31], a[240:243], v[96:99], v[28:31]
  v_mfma_f32_16x16x32_bf16 v[28:31], v[124:127], v[92:95], v[28:31]
  ds_read_b128 v[76:79], v1 offset:64512
  v_mfma_f32_16x16x32_bf16 v[32:35], v[124:127], v[100:103], v[32:35]
  v_mfma_f32_16x16x32_bf16 v[32:35], a[240:243], v[104:107], v[32:35]
  s_waitcnt vmcnt(23)
  s_barrier
  v_mfma_f32_16x16x32_bf16 v[40:43], a[244:247], v[104:107], v[40:43]
  ds_read_b128 v[84:87], v2 offset:49152
  s_add_u32 m0, s45, 32768
  s_add_u32 s68, s67, 2
  s_and_b32 s68, s68, 7
  s_mul_i32 s68, s68, 262144
  v_mfma_f32_16x16x32_bf16 v[40:43], v[128:131], v[100:103], v[40:43]
  buffer_load_dwordx4 v10, s[16:19], s68 offen lds
  v_mfma_f32_16x16x32_bf16 v[36:39], v[128:131], v[92:95], v[36:39]
  v_mfma_f32_16x16x32_bf16 v[36:39], a[244:247], v[96:99], v[36:39]
  ds_read_b128 v[88:91], v2 offset:50176
  v_mfma_f32_16x16x32_bf16 v[44:47], a[248:251], v[96:99], v[44:47]
  v_mfma_f32_16x16x32_bf16 v[44:47], v[132:135], v[92:95], v[44:47]
  s_add_u32 m0, s45, 36864
  s_add_u32 s68, s68, 65536
  v_mfma_f32_16x16x32_bf16 v[48:51], v[132:135], v[100:103], v[48:51]
  ds_read_b128 v[96:99], v2 offset:57344
  v_mfma_f32_16x16x32_bf16 v[48:51], a[248:251], v[104:107], v[48:51]
  s_waitcnt lgkmcnt(3)
  buffer_load_dwordx4 v10, s[16:19], s68 offen lds
  v_mfma_f32_16x16x32_bf16 v[28:31], v[136:139], v[112:115], v[28:31]
  v_mfma_f32_16x16x32_bf16 v[28:31], v[148:151], v[108:111], v[28:31]
  ds_read_b128 v[92:95], v2 offset:58368
  v_mfma_f32_16x16x32_bf16 v[32:35], v[148:151], v[76:79], v[32:35]
  s_add_u32 m0, s45, 40960
  s_add_u32 s68, s68, 65536
  v_mfma_f32_16x16x32_bf16 v[32:35], v[136:139], v[80:83], v[32:35]
  buffer_load_dwordx4 v10, s[16:19], s68 offen lds
  v_mfma_f32_16x16x32_bf16 v[40:43], v[140:143], v[80:83], v[40:43]
  ds_read_b128 v[100:103], v2 offset:51200
  v_mfma_f32_16x16x32_bf16 v[40:43], v[152:155], v[76:79], v[40:43]
  v_mfma_f32_16x16x32_bf16 v[36:39], v[152:155], v[108:111], v[36:39]
  s_add_u32 m0, s45, 45056
  s_add_u32 s68, s68, 65536
  v_mfma_f32_16x16x32_bf16 v[36:39], v[140:143], v[112:115], v[36:39]
  ds_read_b128 v[104:107], v2 offset:52224
  v_mfma_f32_16x16x32_bf16 v[44:47], v[144:147], v[112:115], v[44:47]
  buffer_load_dwordx4 v10, s[16:19], s68 offen lds
  v_mfma_f32_16x16x32_bf16 v[44:47], v[156:159], v[108:111], v[44:47]
  v_mfma_f32_16x16x32_bf16 v[48:51], v[156:159], v[76:79], v[48:51]
  ds_read_b128 v[112:115], v2 offset:59392
  s_cmp_gt_u32 s44, 1
  s_cbranch_scc1 TH4_adaLN_cond__sliding_local_dilated__swiglu_ffn__prompt_kernel
  s_cmp_eq_u32 s44, 0
  s_cselect_b64 s[4:5], s[28:29], s[32:33]
  s_lshr_b32 s57, s2, 3
  s_mul_i32 s57, s57, 57344
  s_and_b32 vcc_lo, s2, 7
  s_mul_i32 vcc_lo, vcc_lo, 896
  s_add_u32 s57, s57, vcc_lo
  v_lshrrev_b32 v15, 3, v0
  v_mul_u32_u24 v15, 6144, v15
  v_lshl_add_u32 v15, v0, 7, v15
  s_mov_b32 exec_lo, 0x7f7f7f7f
  s_mov_b32 exec_hi, 0x7f7f7f7f
  buffer_load_dword a253, v15, s[4:7], s57 offen
  s_mov_b64 exec, -1
TH4_adaLN_cond__sliding_local_dilated__swiglu_ffn__prompt_kernel:
  v_mfma_f32_16x16x32_bf16 v[48:51], v[144:147], v[80:83], v[48:51]
  s_waitcnt lgkmcnt(3)
  v_mfma_f32_16x16x32_bf16 v[28:31], v[160:163], v[84:87], v[28:31]
  v_mfma_f32_16x16x32_bf16 v[28:31], v[172:175], v[88:91], v[28:31]
  ds_read_b128 v[108:111], v2 offset:60416
  v_mfma_f32_16x16x32_bf16 v[32:35], v[172:175], v[92:95], v[32:35]
  v_mfma_f32_16x16x32_bf16 v[32:35], v[160:163], v[96:99], v[32:35]
  v_mfma_f32_16x16x32_bf16 v[40:43], v[164:167], v[96:99], v[40:43]
  ds_read_b128 v[76:79], v2 offset:53248
  v_mfma_f32_16x16x32_bf16 v[40:43], v[176:179], v[92:95], v[40:43]
  v_mfma_f32_16x16x32_bf16 v[36:39], v[176:179], v[88:91], v[36:39]
  v_mfma_f32_16x16x32_bf16 v[36:39], v[164:167], v[84:87], v[36:39]
  ds_read_b128 v[80:83], v2 offset:54272
  v_mfma_f32_16x16x32_bf16 v[44:47], v[168:171], v[84:87], v[44:47]
  v_mfma_f32_16x16x32_bf16 v[44:47], v[180:183], v[88:91], v[44:47]
  v_mfma_f32_16x16x32_bf16 v[48:51], v[180:183], v[92:95], v[48:51]
  ds_read_b128 v[84:87], v2 offset:61440
  v_mfma_f32_16x16x32_bf16 v[48:51], v[168:171], v[96:99], v[48:51]
  s_waitcnt lgkmcnt(3)
  v_mfma_f32_16x16x32_bf16 v[28:31], v[184:187], v[100:103], v[28:31]
  v_mfma_f32_16x16x32_bf16 v[28:31], v[196:199], v[104:107], v[28:31]
  ds_read_b128 v[88:91], v2 offset:62464
  v_mfma_f32_16x16x32_bf16 v[32:35], v[196:199], v[108:111], v[32:35]
  v_mfma_f32_16x16x32_bf16 v[32:35], v[184:187], v[112:115], v[32:35]
  v_mfma_f32_16x16x32_bf16 v[40:43], v[188:191], v[112:115], v[40:43]
  ds_read_b128 v[92:95], v2 offset:55296
  v_mfma_f32_16x16x32_bf16 v[40:43], v[200:203], v[108:111], v[40:43]
  v_mfma_f32_16x16x32_bf16 v[36:39], v[200:203], v[104:107], v[36:39]
  v_mfma_f32_16x16x32_bf16 v[36:39], v[188:191], v[100:103], v[36:39]
  ds_read_b128 v[96:99], v2 offset:56320
  v_mfma_f32_16x16x32_bf16 v[44:47], v[192:195], v[100:103], v[44:47]
  v_mfma_f32_16x16x32_bf16 v[44:47], v[204:207], v[104:107], v[44:47]
  v_mfma_f32_16x16x32_bf16 v[48:51], v[204:207], v[108:111], v[48:51]
  ds_read_b128 v[100:103], v2 offset:63488
  v_mfma_f32_16x16x32_bf16 v[48:51], v[192:195], v[112:115], v[48:51]
  s_waitcnt lgkmcnt(3)
  v_mfma_f32_16x16x32_bf16 v[28:31], v[208:211], v[76:79], v[28:31]
  v_mfma_f32_16x16x32_bf16 v[28:31], v[220:223], v[80:83], v[28:31]
  ds_read_b128 v[104:107], v2 offset:64512
  v_mfma_f32_16x16x32_bf16 v[32:35], v[220:223], v[88:91], v[32:35]
  v_mfma_f32_16x16x32_bf16 v[32:35], v[208:211], v[84:87], v[32:35]
  s_waitcnt vmcnt(6)
  s_barrier
  v_add_u32 v15, s46, v0
  v_add_u32 v15, 1, v15
  s_mov_b64 exec, 1
  buffer_store_dword v15, v0, s[8:11], s74 offen offset:0 sc1
  s_mov_b64 exec, -1
  v_mfma_f32_16x16x32_bf16 v[40:43], v[212:215], v[84:87], v[40:43]
  ds_read_b128 v[108:111], v1 offset:0
  s_add_u32 m0, s45, 49152
  s_add_u32 s68, s67, 3
  s_and_b32 s68, s68, 7
  s_mul_i32 s68, s68, 262144
  v_mfma_f32_16x16x32_bf16 v[40:43], v[224:227], v[88:91], v[40:43]
  buffer_load_dwordx4 v10, s[16:19], s68 offen lds
  v_mfma_f32_16x16x32_bf16 v[36:39], v[224:227], v[80:83], v[36:39]
  v_mfma_f32_16x16x32_bf16 v[36:39], v[212:215], v[76:79], v[36:39]
  ds_read_b128 v[112:115], v1 offset:1024
  v_mfma_f32_16x16x32_bf16 v[44:47], v[216:219], v[76:79], v[44:47]
  s_add_u32 m0, s45, 53248
  s_add_u32 s68, s68, 65536
  v_mfma_f32_16x16x32_bf16 v[44:47], v[228:231], v[80:83], v[44:47]
  buffer_load_dwordx4 v10, s[16:19], s68 offen lds
  v_mfma_f32_16x16x32_bf16 v[48:51], v[228:231], v[88:91], v[48:51]
  ds_read_b128 v[76:79], v1 offset:8192
  v_mfma_f32_16x16x32_bf16 v[48:51], v[216:219], v[84:87], v[48:51]
  s_waitcnt lgkmcnt(3)
  s_add_u32 m0, s45, 57344
  s_add_u32 s68, s68, 65536
  v_mfma_f32_16x16x32_bf16 v[28:31], v[232:235], v[92:95], v[28:31]
  buffer_load_dwordx4 v10, s[16:19], s68 offen lds
  v_mfma_f32_16x16x32_bf16 v[28:31], v[244:247], v[96:99], v[28:31]
  ds_read_b128 v[80:83], v1 offset:9216
  v_mfma_f32_16x16x32_bf16 v[32:35], v[244:247], v[104:107], v[32:35]
  v_mfma_f32_16x16x32_bf16 v[32:35], v[232:235], v[100:103], v[32:35]
  s_add_u32 m0, s45, 61440
  s_add_u32 s68, s68, 65536
  v_mfma_f32_16x16x32_bf16 v[40:43], v[236:239], v[100:103], v[40:43]
  ds_read_b128 v[88:91], v1 offset:2048
  v_mfma_f32_16x16x32_bf16 v[40:43], v[248:251], v[104:107], v[40:43]
  buffer_load_dwordx4 v10, s[16:19], s68 offen lds
  v_mfma_f32_16x16x32_bf16 v[36:39], v[248:251], v[96:99], v[36:39]
  v_mfma_f32_16x16x32_bf16 v[36:39], v[236:239], v[92:95], v[36:39]
  ds_read_b128 v[84:87], v1 offset:3072
  v_mfma_f32_16x16x32_bf16 v[44:47], v[240:243], v[92:95], v[44:47]
  v_mfma_f32_16x16x32_bf16 v[44:47], v[252:255], v[96:99], v[44:47]
  v_mfma_f32_16x16x32_bf16 v[48:51], v[252:255], v[104:107], v[48:51]
  ds_read_b128 v[92:95], v1 offset:10240
  v_mfma_f32_16x16x32_bf16 v[48:51], v[240:243], v[100:103], v[48:51]
  s_waitcnt lgkmcnt(3)
  v_mfma_f32_16x16x32_bf16 v[52:55], a[0:3], v[108:111], 0
  v_mfma_f32_16x16x32_bf16 v[52:55], a[12:15], v[112:115], v[52:55]
  ds_read_b128 v[96:99], v1 offset:11264
  v_mfma_f32_16x16x32_bf16 v[56:59], a[12:15], v[80:83], 0
  v_mfma_f32_16x16x32_bf16 v[56:59], a[0:3], v[76:79], v[56:59]
  v_cvt_pk_bf16_f32 v28, v28, v29
  v_cvt_pk_bf16_f32 v29, v30, v31
  v_mfma_f32_16x16x32_bf16 v[64:67], a[4:7], v[76:79], 0
  ds_read_b128 v[104:107], v1 offset:4096
  v_mfma_f32_16x16x32_bf16 v[64:67], a[16:19], v[80:83], v[64:67]
  ds_write_b64 v18, v[28:29] offset:12288
  v_mfma_f32_16x16x32_bf16 v[60:63], a[16:19], v[112:115], 0
  v_cvt_pk_bf16_f32 v36, v36, v37
  v_cvt_pk_bf16_f32 v37, v38, v39
  v_mfma_f32_16x16x32_bf16 v[60:63], a[4:7], v[108:111], v[60:63]
  ds_read_b128 v[100:103], v1 offset:5120
  v_cvt_pk_bf16_f32 v38, v44, v45
  v_cvt_pk_bf16_f32 v39, v46, v47
  v_mfma_f32_16x16x32_bf16 v[68:71], a[8:11], v[108:111], 0
  ds_write_b128 v17, v[36:39] offset:13312
  v_mfma_f32_16x16x32_bf16 v[68:71], a[20:23], v[112:115], v[68:71]
  v_cvt_pk_bf16_f32 v32, v32, v33
  v_cvt_pk_bf16_f32 v33, v34, v35
  v_mfma_f32_16x16x32_bf16 v[72:75], a[20:23], v[80:83], 0
  ds_read_b128 v[108:111], v1 offset:12288
  v_mfma_f32_16x16x32_bf16 v[72:75], a[8:11], v[76:79], v[72:75]
  s_waitcnt lgkmcnt(5)
  ds_write_b64 v18, v[32:33] offset:0
  v_mfma_f32_16x16x32_bf16 v[52:55], a[24:27], v[88:91], v[52:55]
  v_cvt_pk_bf16_f32 v40, v40, v41
  v_cvt_pk_bf16_f32 v41, v42, v43
  v_mfma_f32_16x16x32_bf16 v[52:55], a[36:39], v[84:87], v[52:55]
  ds_read_b128 v[112:115], v1 offset:13312
  v_cvt_pk_bf16_f32 v42, v48, v49
  v_mfma_f32_16x16x32_bf16 v[56:59], a[36:39], v[96:99], v[56:59]
  v_cvt_pk_bf16_f32 v43, v50, v51
  v_mfma_f32_16x16x32_bf16 v[56:59], a[24:27], v[92:95], v[56:59]
  ds_write_b128 v17, v[40:43] offset:1024
  v_mfma_f32_16x16x32_bf16 v[64:67], a[28:31], v[92:95], v[64:67]
  ds_read_b128 v[80:83], v1 offset:6144
  v_mfma_f32_16x16x32_bf16 v[64:67], a[40:43], v[96:99], v[64:67]
  s_bitcmp1_b32 s44, 0
  s_mov_b32 s52, 12288
  s_cselect_b32 s52, 0, s52
  s_mov_b32 s53, 6144
  s_cselect_b32 s53, 12288, s53
  v_mfma_f32_16x16x32_bf16 v[60:63], a[40:43], v[84:87], v[60:63]
  v_add_u32 v116, s52, v19
  v_add_u32 v117, s53, v19
  v_mfma_f32_16x16x32_bf16 v[60:63], a[28:31], v[88:91], v[60:63]
  ds_read_b128 v[76:79], v1 offset:7168
  v_add_u32 v118, s52, v20
  v_mfma_f32_16x16x32_bf16 v[68:71], a[32:35], v[88:91], v[68:71]
  v_add_u32 v119, s53, v20
  v_mfma_f32_16x16x32_bf16 v[68:71], a[44:47], v[84:87], v[68:71]
  s_waitcnt vmcnt(19) lgkmcnt(2)
  s_barrier
  v_mfma_f32_16x16x32_bf16 v[72:75], a[44:47], v[96:99], v[72:75]
  ds_read_b128 v[88:91], v1 offset:14336
  s_add_u32 m0, s45, 114688
  s_add_u32 s68, s67, 4
  s_and_b32 s68, s68, 7
  s_mul_i32 s68, s68, 262144
  v_mfma_f32_16x16x32_bf16 v[72:75], a[32:35], v[92:95], v[72:75]
  s_waitcnt lgkmcnt(4)
  buffer_load_dwordx4 v10, s[16:19], s68 offen lds
  ds_read_b128 v[28:31], v116
  v_mfma_f32_16x16x32_bf16 v[52:55], a[48:51], v[104:107], v[52:55]
  ds_read_b64_tr_b16 a[0:1], v4 offset:16384
  ds_read_b128 v[32:35], v117 offset:1024
  v_mfma_f32_16x16x32_bf16 v[52:55], a[60:63], v[100:103], v[52:55]
  ds_read_b128 v[84:87], v1 offset:15360
  ds_read_b128 v[36:39], v116 offset:1024
  v_mfma_f32_16x16x32_bf16 v[56:59], a[60:63], v[112:115], v[56:59]
  ds_read_b64_tr_b16 a[2:3], v4 offset:18432
  s_add_u32 m0, s45, 118784
  s_add_u32 s68, s68, 65536
  v_mfma_f32_16x16x32_bf16 v[56:59], a[48:51], v[108:111], v[56:59]
  ds_read_b64_tr_b16 a[4:5], v5 offset:16384
  buffer_load_dwordx4 v10, s[16:19], s68 offen lds
  v_mfma_f32_16x16x32_bf16 v[64:67], a[52:55], v[108:111], v[64:67]
  ds_read_b128 v[96:99], v2 offset:0
  ds_read_b64_tr_b16 v[40:41], v119 offset:2048
  v_mfma_f32_16x16x32_bf16 v[64:67], a[64:67], v[112:115], v[64:67]
  ds_read_b64_tr_b16 a[6:7], v5 offset:18432
  s_add_u32 m0, s45, 122880
  s_add_u32 s68, s68, 65536
  v_mfma_f32_16x16x32_bf16 v[60:63], a[64:67], v[100:103], v[60:63]
  ds_read_b64_tr_b16 a[8:9], v4 offset:20480
  buffer_load_dwordx4 v10, s[16:19], s68 offen lds
  v_mfma_f32_16x16x32_bf16 v[60:63], a[52:55], v[104:107], v[60:63]
  ds_read_b128 v[92:95], v2 offset:1024
  ds_read_b64_tr_b16 v[42:43], v118 offset:2048
  v_mfma_f32_16x16x32_bf16 v[68:71], a[56:59], v[104:107], v[68:71]
  ds_read_b64_tr_b16 a[10:11], v4 offset:22528
  ds_read_b64_tr_b16 v[44:45], v119 offset:2056
  v_mfma_f32_16x16x32_bf16 v[68:71], a[68:71], v[100:103], v[68:71]
  ds_read_b64_tr_b16 a[12:13], v5 offset:20480
  s_add_u32 m0, s45, 126976
  s_add_u32 s68, s68, 65536
  v_mfma_f32_16x16x32_bf16 v[72:75], a[68:71], v[112:115], v[72:75]
  ds_read_b128 v[104:107], v2 offset:8192
  buffer_load_dwordx4 v10, s[16:19], s68 offen lds
  v_mfma_f32_16x16x32_bf16 v[72:75], a[56:59], v[108:111], v[72:75]
  s_waitcnt lgkmcnt(13)
  ds_read_b64_tr_b16 a[14:15], v5 offset:22528
  v_mfma_f32_16x16x32_bf16 v[52:55], a[72:75], v[80:83], v[52:55]
  ds_read_b64_tr_b16 a[16:17], v4 offset:24576
  ds_read_b64_tr_b16 v[46:47], v118 offset:2056
  v_mfma_f32_16x16x32_bf16 v[52:55], a[84:87], v[76:79], v[52:55]
  ds_read_b128 v[100:103], v2 offset:9216
  v_mfma_f32_16x16x32_bf16 v[56:59], a[84:87], v[84:87], v[56:59]
  ds_read_b64_tr_b16 a[18:19], v4 offset:26624
  v_mfma_f32_16x16x32_bf16 v[56:59], a[72:75], v[88:91], v[56:59]
  ds_read_b64_tr_b16 a[20:21], v5 offset:24576
  v_mfma_f32_16x16x32_bf16 v[64:67], a[76:79], v[88:91], v[64:67]
  ds_read_b128 v[112:115], v2 offset:2048
  v_mfma_f32_16x16x32_bf16 v[64:67], a[88:91], v[84:87], v[64:67]
  ds_read_b64_tr_b16 a[22:23], v5 offset:26624
  s_waitcnt lgkmcnt(5)
  v_mfma_f32_16x16x32_bf16 v[116:119], v[32:35], v[28:31], 0
  v_mfma_f32_16x16x32_bf16 v[120:123], v[36:39], v[28:31], 0
  v_mfma_f32_16x16x32_bf16 v[60:63], a[88:91], v[76:79], v[60:63]
  ds_read_b64_tr_b16 a[24:25], v4 offset:28672
  v_mfma_f32_16x16x32_bf16 v[60:63], a[76:79], v[80:83], v[60:63]
  ds_read_b128 v[108:111], v2 offset:3072
  v_mfma_f32_16x16x32_bf16 v[68:71], a[80:83], v[80:83], v[68:71]
  ds_read_b64_tr_b16 a[26:27], v4 offset:30720
  v_mfma_f32_16x16x32_bf16 v[68:71], a[92:95], v[76:79], v[68:71]
  ds_read_b64_tr_b16 a[28:29], v5 offset:28672
  v_cndmask_b32 v48, v116, v120, s[80:81]
  v_cndmask_b32 v49, v117, v121, s[82:83]
  v_mfma_f32_16x16x32_bf16 v[72:75], a[92:95], v[84:87], v[72:75]
  ds_read_b128 v[80:83], v2 offset:10240
  v_cndmask_b32 v50, v118, v122, s[84:85]
  v_cndmask_b32 v51, v119, v123, s[86:87]
  v_mfma_f32_16x16x32_bf16 v[72:75], a[80:83], v[88:91], v[72:75]
  s_waitcnt lgkmcnt(9)
  ds_read_b64_tr_b16 a[30:31], v5 offset:30720
  v_cndmask_b32 v48, v48, v49, s[88:89]
  v_mfma_f32_16x16x32_bf16 v[52:55], a[96:99], v[96:99], v[52:55]
  s_lshl_b32 s57, s44, 28
  s_add_u32 s57, s57, s77
  buffer_load_dword v13, v14, s[8:11], s57 offen sc1
  v_cndmask_b32 v49, v50, v51, s[88:89]
  v_mfma_f32_16x16x32_bf16 v[52:55], a[108:111], v[92:95], v[52:55]
  ds_read_b128 v[76:79], v2 offset:11264
  v_mul_f32 v48, 0x3e8293ee, v48
  v_mul_f32 v49, 0x3e8293ee, v49
  v_mfma_f32_16x16x32_bf16 v[56:59], a[108:111], v[100:103], v[56:59]
  v_max_f32 v50, v48, v49
HOP4:
  s_cbranch_execz HOP8
  v_mov_b32 v51, v50
  v_mfma_f32_16x16x32_bf16 v[56:59], a[96:99], v[104:107], v[56:59]
  s_nop 0
  v_permlane16_swap_b32 v50, v51
  v_max_f32 v50, v50, v51
  v_mfma_f32_16x16x32_bf16 v[64:67], a[100:103], v[104:107], v[64:67]
  ds_read_b128 v[84:87], v2 offset:4096
  s_waitcnt vmcnt(14)
  s_barrier
  v_mfma_f32_16x16x32_bf16 v[64:67], a[112:115], v[100:103], v[64:67]
  ds_read_b64_tr_b16 a[32:33], v7 offset:16384
  s_add_u32 m0, s70, 0
  s_add_u32 s69, s61, 229376
  v_mfma_f32_16x16x32_bf16 v[60:63], a[112:115], v[92:95], v[60:63]
  ds_read_b64_tr_b16 a[34:35], v7 offset:18432
  buffer_load_dwordx4 v12, s[8:11], s69 offen offset:0 sc1 lds
  v_mov_b32 v51, v50
  v_mfma_f32_16x16x32_bf16 v[60:63], a[100:103], v[96:99], v[60:63]
  ds_read_b128 v[88:91], v2 offset:5120
  v_permlane32_swap_b32 v50, v51
  v_mfma_f32_16x16x32_bf16 v[68:71], a[104:107], v[96:99], v[68:71]
  ds_read_b64_tr_b16 a[36:37], v8 offset:16384
  v_max_f32 v50, v50, v51
  v_sub_f32 v48, v48, v50
  v_mfma_f32_16x16x32_bf16 v[68:71], a[116:119], v[92:95], v[68:71]
  ds_read_b64_tr_b16 a[38:39], v8 offset:18432
  v_sub_f32 v49, v49, v50
  v_mfma_f32_16x16x32_bf16 v[72:75], a[116:119], v[100:103], v[72:75]
  ds_read_b128 v[96:99], v2 offset:12288
  buffer_load_dwordx4 v12, s[8:11], s69 offen offset:1024 sc1 lds
  v_mfma_f32_16x16x32_bf16 v[72:75], a[104:107], v[104:107], v[72:75]
  s_waitcnt lgkmcnt(7)
  ds_read_b64_tr_b16 a[40:41], v7 offset:20480
  v_mfma_f32_16x16x32_bf16 v[52:55], a[120:123], v[112:115], v[52:55]
  ds_read_b64_tr_b16 a[42:43], v7 offset:22528
  v_exp_f32 v48, v48
  v_mfma_f32_16x16x32_bf16 v[52:55], a[132:135], v[108:111], v[52:55]
  ds_read_b128 v[92:95], v2 offset:13312
  buffer_load_dwordx4 v12, s[8:11], s69 offen offset:2048 sc1 lds
  v_mfma_f32_16x16x32_bf16 v[56:59], a[132:135], v[76:79], v[56:59]
  ds_read_b64_tr_b16 a[44:45], v8 offset:20480
  v_exp_f32 v49, v49
  v_mfma_f32_16x16x32_bf16 v[56:59], a[120:123], v[80:83], v[56:59]
  ds_read_b64_tr_b16 a[46:47], v8 offset:22528
  v_add_f32 v50, v48, v49
  v_mov_b32 v51, v50
  v_mfma_f32_16x16x32_bf16 v[64:67], a[124:127], v[80:83], v[64:67]
  ds_read_b128 v[100:103], v2 offset:6144
  v_permlane16_swap_b32 v50, v51
  v_mfma_f32_16x16x32_bf16 v[64:67], a[136:139], v[76:79], v[64:67]
  ds_read_b64_tr_b16 a[48:49], v7 offset:24576
  buffer_load_dwordx4 v12, s[8:11], s69 offen offset:3072 sc1 lds
  v_add_f32 v50, v50, v51
  v_mfma_f32_16x16x32_bf16 v[60:63], a[136:139], v[108:111], v[60:63]
  ds_read_b64_tr_b16 a[50:51], v7 offset:26624
  v_mov_b32 v51, v50
  v_mfma_f32_16x16x32_bf16 v[60:63], a[124:127], v[112:115], v[60:63]
  ds_read_b128 v[104:107], v2 offset:7168
  v_permlane32_swap_b32 v50, v51
  v_mfma_f32_16x16x32_bf16 v[68:71], a[128:131], v[112:115], v[68:71]
  ds_read_b64_tr_b16 a[52:53], v8 offset:24576
  v_add_f32 v50, v50, v51
  v_mfma_f32_16x16x32_bf16 v[68:71], a[140:143], v[108:111], v[68:71]
  ds_read_b64_tr_b16 a[54:55], v8 offset:26624
  v_rcp_f32 v50, v50
  v_mfma_f32_16x16x32_bf16 v[72:75], a[140:143], v[76:79], v[72:75]
  ds_read_b128 v[112:115], v2 offset:14336
  v_mul_f32 v48, v48, v50
  v_mul_f32 v49, v49, v50
  v_mfma_f32_16x16x32_bf16 v[72:75], a[128:131], v[80:83], v[72:75]
  s_waitcnt lgkmcnt(9)
  ds_read_b64_tr_b16 a[56:57], v7 offset:28672
  v_cvt_pk_bf16_f32 v48, v48, v48
  v_mfma_f32_16x16x32_bf16 v[52:55], a[144:147], v[84:87], v[52:55]
  ds_read_b64_tr_b16 a[58:59], v7 offset:30720
  v_cvt_pk_bf16_f32 v49, v49, v49
  v_and_b32 v28, v24, v48
  v_mfma_f32_16x16x32_bf16 v[52:55], a[156:159], v[88:91], v[52:55]
  ds_read_b128 v[108:111], v2 offset:15360
  v_and_b32 v29, v25, v49
  v_and_b32 v30, v26, v48
  v_mfma_f32_16x16x32_bf16 v[56:59], a[156:159], v[92:95], v[56:59]
  ds_read_b64_tr_b16 a[60:61], v8 offset:28672
  v_and_b32 v31, v27, v49
  v_mfma_f32_16x16x32_bf16 v[56:59], a[144:147], v[96:99], v[56:59]
  ds_read_b64_tr_b16 a[62:63], v8 offset:30720
  v_mfma_f32_16x16x32_bf16 v[32:35], v[40:43], v[28:31], 0
  v_mfma_f32_16x16x32_bf16 v[36:39], v[44:47], v[28:31], 0
  v_mfma_f32_16x16x32_bf16 v[64:67], a[148:151], v[96:99], v[64:67]
  ds_read_b128 v[76:79], v2 offset:32768
  v_mfma_f32_16x16x32_bf16 v[64:67], a[160:163], v[92:95], v[64:67]
  v_mfma_f32_16x16x32_bf16 v[60:63], a[160:163], v[88:91], v[60:63]
  v_mfma_f32_16x16x32_bf16 v[60:63], a[148:151], v[84:87], v[60:63]
  ds_read_b128 v[80:83], v2 offset:33792
  s_nop 0
  v_cvt_pk_bf16_f32 v116, v32, v33
  v_cvt_pk_bf16_f32 v117, v34, v35
  v_mfma_f32_16x16x32_bf16 v[68:71], a[152:155], v[84:87], v[68:71]
  v_cvt_pk_bf16_f32 v118, v36, v37
  v_cvt_pk_bf16_f32 v119, v38, v39
  v_mfma_f32_16x16x32_bf16 v[68:71], a[164:167], v[88:91], v[68:71]
  buffer_store_dwordx4 v[116:119], v1, s[8:11], s73 offen sc1
  v_mfma_f32_16x16x32_bf16 v[72:75], a[164:167], v[92:95], v[72:75]
  ds_read_b128 v[84:87], v2 offset:40960
  s_add_u32 s73, s73, 65536
  v_mfma_f32_16x16x32_bf16 v[72:75], a[152:155], v[96:99], v[72:75]
  s_waitcnt lgkmcnt(5)
  s_waitcnt vmcnt(5)
  s_cmp_lg_u32 s44, 0
  s_cbranch_scc1 PL5_adaLN_cond__sliding_local_dilated__swiglu_ffn__prompt_kernelx
  v_subrev_u32 v13, s46, v13
  v_subrev_u32 v13, 1, v13
  v_cmp_lt_u32 vcc, 3, v13
  s_nop 4
  s_cbranch_vccz PL5_adaLN_cond__sliding_local_dilated__swiglu_ffn__prompt_kernelx
  s_mov_b32 s57, 60000
PL5_adaLN_cond__sliding_local_dilated__swiglu_ffn__prompt_kernel:
  buffer_load_dword v13, v14, s[8:11], s77 offen sc1
  s_sub_u32 s57, s57, 1
  s_cmp_eq_u32 s57, 0
  s_waitcnt vmcnt(0)
  s_cbranch_scc1 PL5_adaLN_cond__sliding_local_dilated__swiglu_ffn__prompt_kernelx
  v_subrev_u32 v13, s46, v13
  v_subrev_u32 v13, 1, v13
  v_cmp_lt_u32 vcc, 3, v13
  s_nop 4
  s_cbranch_vccnz PL5_adaLN_cond__sliding_local_dilated__swiglu_ffn__prompt_kernel
PL5_adaLN_cond__sliding_local_dilated__swiglu_ffn__prompt_kernelx:
  s_waitcnt vmcnt(10) lgkmcnt(3)
  s_barrier
  v_mfma_f32_16x16x32_bf16 v[52:55], a[168:171], v[100:103], v[52:55]
  ds_read_b64_tr_b16 a[64:65], v4 offset:32768
  s_add_u32 m0, s45, 16384
  s_add_u32 s68, s67, 5
  s_and_b32 s68, s68, 7
  s_mul_i32 s68, s68, 262144
  v_mfma_f32_16x16x32_bf16 v[52:55], a[180:183], v[104:107], v[52:55]
  ds_read_b128 v[88:91], v2 offset:41984
  ds_read_b64_tr_b16 a[66:67], v4 offset:34816
  v_mfma_f32_16x16x32_bf16 v[56:59], a[180:183], v[108:111], v[56:59]
  ds_read_b64_tr_b16 a[68:69], v5 offset:32768
  buffer_load_dwordx4 v10, s[16:19], s68 offen lds
  v_mfma_f32_16x16x32_bf16 v[56:59], a[168:171], v[112:115], v[56:59]
  ds_read_b64_tr_b16 a[70:71], v5 offset:34816
  ds_read_b64_tr_b16 a[72:73], v4 offset:36864
  v_mfma_f32_16x16x32_bf16 v[64:67], a[172:175], v[112:115], v[64:67]
  ds_read_b128 v[92:95], v2 offset:34816
  ds_read_b64_tr_b16 a[74:75], v4 offset:38912
  s_add_u32 m0, s45, 20480
  s_add_u32 s68, s68, 65536
  v_mfma_f32_16x16x32_bf16 v[64:67], a[184:187], v[108:111], v[64:67]
  ds_read_b64_tr_b16 a[76:77], v5 offset:36864
  buffer_load_dwordx4 v10, s[16:19], s68 offen lds
  v_mfma_f32_16x16x32_bf16 v[60:63], a[184:187], v[104:107], v[60:63]
  ds_read_b64_tr_b16 a[78:79], v5 offset:38912
  ds_read_b64_tr_b16 a[80:81], v4 offset:40960
  v_mfma_f32_16x16x32_bf16 v[60:63], a[172:175], v[100:103], v[60:63]
  ds_read_b128 v[96:99], v2 offset:35840
  ds_read_b64_tr_b16 a[82:83], v4 offset:43008
  s_add_u32 m0, s45, 24576
  s_add_u32 s68, s68, 65536
  v_mfma_f32_16x16x32_bf16 v[68:71], a[176:179], v[100:103], v[68:71]
  ds_read_b64_tr_b16 a[84:85], v5 offset:40960
  buffer_load_dwordx4 v10, s[16:19], s68 offen lds
  v_mfma_f32_16x16x32_bf16 v[68:71], a[188:191], v[104:107], v[68:71]
  ds_read_b64_tr_b16 a[86:87], v5 offset:43008
  ds_read_b64_tr_b16 a[88:89], v4 offset:45056
  v_mfma_f32_16x16x32_bf16 v[72:75], a[188:191], v[108:111], v[72:75]
  ds_read_b128 v[100:103], v2 offset:43008
  ds_read_b64_tr_b16 a[90:91], v4 offset:47104
  v_mfma_f32_16x16x32_bf16 v[72:75], a[176:179], v[112:115], v[72:75]
  s_waitcnt lgkmcnt(15)
  ds_read_b64_tr_b16 a[92:93], v5 offset:45056
  s_add_u32 m0, s45, 28672
  s_add_u32 s68, s68, 65536
  v_mfma_f32_16x16x32_bf16 v[52:55], a[192:195], v[76:79], v[52:55]
  ds_read_b64_tr_b16 a[94:95], v5 offset:47104
  ds_read_b64_tr_b16 a[96:97], v4 offset:49152
  buffer_load_dwordx4 v10, s[16:19], s68 offen lds
  v_mfma_f32_16x16x32_bf16 v[52:55], a[204:207], v[80:83], v[52:55]
  ds_read_b128 v[104:107], v2 offset:44032
  ds_read_b64_tr_b16 a[98:99], v4 offset:51200
  v_mfma_f32_16x16x32_bf16 v[56:59], a[204:207], v[88:91], v[56:59]
  ds_read_b64_tr_b16 a[100:101], v5 offset:49152
  s_add_u32 m0, s45, 81920
  s_add_u32 s68, s67, 6
  s_and_b32 s68, s68, 7
  s_mul_i32 s68, s68, 262144
  v_mfma_f32_16x16x32_bf16 v[56:59], a[192:195], v[84:87], v[56:59]
  ds_read_b64_tr_b16 a[102:103], v5 offset:51200
  ds_read_b64_tr_b16 a[104:105], v4 offset:53248
  buffer_load_dwordx4 v10, s[16:19], s68 offen lds
  v_mfma_f32_16x16x32_bf16 v[64:67], a[196:199], v[84:87], v[64:67]
  ds_read_b128 v[108:111], v2 offset:36864
  ds_read_b64_tr_b16 a[106:107], v4 offset:55296
  v_mfma_f32_16x16x32_bf16 v[64:67], a[208:211], v[88:91], v[64:67]
  ds_read_b64_tr_b16 a[108:109], v5 offset:53248
  v_mfma_f32_16x16x32_bf16 v[60:63], a[208:211], v[80:83], v[60:63]
  ds_read_b64_tr_b16 a[110:111], v5 offset:55296
  ds_read_b64_tr_b16 a[112:113], v4 offset:57344
  v_mfma_f32_16x16x32_bf16 v[60:63], a[196:199], v[76:79], v[60:63]
  ds_read_b128 v[112:115], v2 offset:37888
  ds_read_b64_tr_b16 a[114:115], v4 offset:59392
  s_add_u32 m0, s45, 86016
  s_add_u32 s68, s68, 65536
  v_mfma_f32_16x16x32_bf16 v[68:71], a[200:203], v[76:79], v[68:71]
  ds_read_b64_tr_b16 a[116:117], v5 offset:57344
  buffer_load_dwordx4 v10, s[16:19], s68 offen lds
  v_mfma_f32_16x16x32_bf16 v[68:71], a[212:215], v[80:83], v[68:71]
  ds_read_b64_tr_b16 a[118:119], v5 offset:59392
  ds_read_b64_tr_b16 a[120:121], v4 offset:61440
  v_mfma_f32_16x16x32_bf16 v[72:75], a[212:215], v[88:91], v[72:75]
  ds_read_b128 v[76:79], v2 offset:45056
  ds_read_b64_tr_b16 a[122:123], v4 offset:63488
  s_add_u32 m0, s45, 90112
  s_add_u32 s68, s68, 65536
  v_mfma_f32_16x16x32_bf16 v[72:75], a[200:203], v[84:87], v[72:75]
  s_waitcnt lgkmcnt(15)
  ds_read_b64_tr_b16 a[124:125], v5 offset:61440
  buffer_load_dwordx4 v10, s[16:19], s68 offen lds
  v_mfma_f32_16x16x32_bf16 v[52:55], a[216:219], v[92:95], v[52:55]
  ds_read_b64_tr_b16 a[126:127], v5 offset:63488
  v_mfma_f32_16x16x32_bf16 v[52:55], a[228:231], v[96:99], v[52:55]
  ds_read_b128 v[80:83], v2 offset:46080
  s_add_u32 m0, s45, 94208
  s_add_u32 s68, s68, 65536
  v_mfma_f32_16x16x32_bf16 v[56:59], a[228:231], v[104:107], v[56:59]
  buffer_load_dwordx4 v10, s[16:19], s68 offen lds
  v_mfma_f32_16x16x32_bf16 v[56:59], a[216:219], v[100:103], v[56:59]
  v_mfma_f32_16x16x32_bf16 v[64:67], a[220:223], v[100:103], v[64:67]
  ds_read_b128 v[88:91], v2 offset:38912
  v_mfma_f32_16x16x32_bf16 v[64:67], a[232:235], v[104:107], v[64:67]
  v_lshlrev_b32 v21, 7, v0
  v_add_u32 v21, 720896, v21
  v_mfma_f32_16x16x32_bf16 v[60:63], a[232:235], v[96:99], v[60:63]
  s_waitcnt vmcnt(4) lgkmcnt(2)
  s_barrier
  v_add_u32 v15, s46, v0
  v_add_u32 v15, 2, v15
  s_mov_b64 exec, 1
  buffer_store_dword v15, v0, s[8:11], s74 offen offset:0 sc1
  s_mov_b64 exec, -1
  v_mfma_f32_16x16x32_bf16 v[60:63], a[220:223], v[92:95], v[60:63]
  ds_read_b128 v[84:87], v2 offset:39936
  ds_read_b64_tr_b16 a[128:129], v7 offset:49152
  s_add_u32 m0, s45, 65536
  s_add_u32 s68, s67, 7
  s_and_b32 s68, s68, 7
  s_mul_i32 s68, s68, 262144
  v_mfma_f32_16x16x32_bf16 v[68:71], a[224:227], v[92:95], v[68:71]
  ds_read_b64_tr_b16 a[130:131], v7 offset:51200
  buffer_load_dwordx4 v10, s[16:19], s68 offen lds
  v_mfma_f32_16x16x32_bf16 v[68:71], a[236:239], v[96:99], v[68:71]
  ds_read_b64_tr_b16 a[132:133], v8 offset:49152
  v_mfma_f32_16x16x32_bf16 v[72:75], a[236:239], v[104:107], v[72:75]
  ds_read_b128 v[92:95], v2 offset:47104
  ds_read_b64_tr_b16 a[134:135], v8 offset:51200
  ds_read_b64_tr_b16 a[136:137], v7 offset:53248
  v_mfma_f32_16x16x32_bf16 v[72:75], a[224:227], v[100:103], v[72:75]
  s_waitcnt lgkmcnt(8)
  ds_read_b64_tr_b16 a[138:139], v7 offset:55296
  s_add_u32 m0, s45, 69632
  s_add_u32 s68, s68, 65536
  v_mfma_f32_16x16x32_bf16 v[52:55], a[240:243], v[108:111], v[52:55]
  ds_read_b64_tr_b16 a[140:141], v8 offset:53248
  buffer_load_dwordx4 v10, s[16:19], s68 offen lds
  v_mfma_f32_16x16x32_bf16 v[52:55], v[124:127], v[112:115], v[52:55]
  ds_read_b128 v[96:99], v2 offset:48128
  ds_read_b64_tr_b16 a[142:143], v8 offset:55296
  ds_read_b64_tr_b16 a[144:145], v7 offset:57344
  v_mfma_f32_16x16x32_bf16 v[56:59], v[124:127], v[80:83], v[56:59]
  ds_read_b64_tr_b16 a[146:147], v7 offset:59392
  s_add_u32 m0, s45, 73728
  s_add_u32 s68, s68, 65536
  v_mfma_f32_16x16x32_bf16 v[56:59], a[240:243], v[76:79], v[56:59]
  ds_read_b64_tr_b16 a[148:149], v8 offset:57344
  buffer_load_dwordx4 v10, s[16:19], s68 offen lds
  v_mfma_f32_16x16x32_bf16 v[64:67], a[244:247], v[76:79], v[64:67]
  ds_read_b128 v[104:107], v1 offset:0
  ds_read_b64_tr_b16 a[150:151], v8 offset:59392
  ds_read_b64_tr_b16 a[152:153], v7 offset:61440
  v_mfma_f32_16x16x32_bf16 v[64:67], v[128:131], v[80:83], v[64:67]
  ds_read_b64_tr_b16 a[154:155], v7 offset:63488
  v_mfma_f32_16x16x32_bf16 v[60:63], v[128:131], v[112:115], v[60:63]
  ds_read_b64_tr_b16 a[156:157], v8 offset:61440
  s_add_u32 m0, s45, 77824
  s_add_u32 s68, s68, 65536
  v_mfma_f32_16x16x32_bf16 v[60:63], a[244:247], v[108:111], v[60:63]
  ds_read_b128 v[100:103], v1 offset:1024
  ds_read_b64_tr_b16 a[158:159], v8 offset:63488
  ds_read_b64_tr_b16 a[160:161], v4 offset:16384
  v_mfma_f32_16x16x32_bf16 v[68:71], a[248:251], v[108:111], v[68:71]
  ds_read_b64_tr_b16 a[162:163], v4 offset:18432
  buffer_load_dwordx4 v10, s[16:19], s68 offen lds
  v_mfma_f32_16x16x32_bf16 v[68:71], v[132:135], v[112:115], v[68:71]
  ds_read_b64_tr_b16 a[164:165], v5 offset:16384
  s_add_u32 m0, s70, 32768
  s_add_u32 s69, s62, 0
  v_mfma_f32_16x16x32_bf16 v[72:75], v[132:135], v[80:83], v[72:75]
  ds_read_b128 v[108:111], v1 offset:8192
  ds_read_b64_tr_b16 a[166:167], v5 offset:18432
  ds_read_b64_tr_b16 a[168:169], v4 offset:20480
  s_lshl_b32 s57, s44, 28
  buffer_load_dwordx4 v[116:119], v21, s[8:11], s57 offen sc1
  v_mfma_f32_16x16x32_bf16 v[72:75], a[248:251], v[76:79], v[72:75]
  s_waitcnt lgkmcnt(15)
  ds_read_b64_tr_b16 a[170:171], v4 offset:22528
  buffer_load_dwordx4 v9, s[8:11], s69 offen offset:0 sc1 lds
  v_mfma_f32_16x16x32_bf16 v[52:55], v[136:139], v[88:91], v[52:55]
  ds_read_b64_tr_b16 a[172:173], v5 offset:20480
  v_mfma_f32_16x16x32_bf16 v[52:55], v[148:151], v[84:87], v[52:55]
  ds_read_b128 v[112:115], v1 offset:9216
  ds_read_b64_tr_b16 a[174:175], v5 offset:22528
  ds_read_b64_tr_b16 a[176:177], v4 offset:24576
  v_mfma_f32_16x16x32_bf16 v[56:59], v[148:151], v[96:99], v[56:59]
  ds_read_b64_tr_b16 a[178:179], v4 offset:26624
  buffer_load_dwordx4 v9, s[8:11], s69 offen offset:1024 sc1 lds
  v_mfma_f32_16x16x32_bf16 v[56:59], v[136:139], v[92:95], v[56:59]
  ds_read_b64_tr_b16 a[180:181], v5 offset:24576
  v_mfma_f32_16x16x32_bf16 v[64:67], v[140:143], v[92:95], v[64:67]
  ds_read_b128 v[80:83], v1 offset:2048
  ds_read_b64_tr_b16 a[182:183], v5 offset:26624
  ds_read_b64_tr_b16 a[184:185], v4 offset:28672
  v_mfma_f32_16x16x32_bf16 v[64:67], v[152:155], v[96:99], v[64:67]
  ds_read_b64_tr_b16 a[186:187], v4 offset:30720
  buffer_load_dwordx4 v9, s[8:11], s69 offen offset:2048 sc1 lds
  v_mfma_f32_16x16x32_bf16 v[60:63], v[152:155], v[84:87], v[60:63]
  ds_read_b64_tr_b16 a[188:189], v5 offset:28672
  v_mfma_f32_16x16x32_bf16 v[60:63], v[140:143], v[88:91], v[60:63]
  ds_read_b128 v[76:79], v1 offset:3072
  ds_read_b64_tr_b16 a[190:191], v5 offset:30720
  v_mfma_f32_16x16x32_bf16 v[68:71], v[144:147], v[88:91], v[68:71]
  v_mfma_f32_16x16x32_bf16 v[68:71], v[156:159], v[84:87], v[68:71]
  buffer_load_dwordx4 v9, s[8:11], s69 offen offset:3072 sc1 lds
  v_mfma_f32_16x16x32_bf16 v[72:75], v[156:159], v[96:99], v[72:75]
  ds_read_b128 v[88:91], v1 offset:10240
  v_mfma_f32_16x16x32_bf16 v[72:75], v[144:147], v[92:95], v[72:75]
  s_waitcnt lgkmcnt(12)
  s_add_u32 m0, s70, 49152
  s_add_u32 s69, s63, 0
  v_mfma_f32_16x16x32_bf16 v[52:55], v[160:163], v[104:107], v[52:55]
  buffer_load_dwordx4 v9, s[8:11], s69 offen offset:0 sc1 lds
  s_waitcnt vmcnt(6) lgkmcnt(15)
  s_barrier
  v_mfma_f32_16x16x32_bf16 v[52:55], v[172:175], v[100:103], v[52:55]
  ds_read_b128 v[84:87], v1 offset:11264
  ds_read_b64_tr_b16 a[192:193], v7 offset:16384
  v_mfma_f32_16x16x32_bf16 v[56:59], v[172:175], v[112:115], v[56:59]
  ds_read_b64_tr_b16 a[194:195], v7 offset:18432
  v_mfma_f32_16x16x32_bf16 v[56:59], v[160:163], v[108:111], v[56:59]
  ds_read_b64_tr_b16 a[196:197], v8 offset:16384
  v_mfma_f32_16x16x32_bf16 v[64:67], v[164:167], v[108:111], v[64:67]
  ds_read_b128 v[96:99], v1 offset:4096
  ds_read_b64_tr_b16 a[198:199], v8 offset:18432
  ds_read_b64_tr_b16 a[200:201], v7 offset:20480
  v_mfma_f32_16x16x32_bf16 v[64:67], v[176:179], v[112:115], v[64:67]
  ds_read_b64_tr_b16 a[202:203], v7 offset:22528
  buffer_load_dwordx4 v9, s[8:11], s69 offen offset:1024 sc1 lds
  v_mfma_f32_16x16x32_bf16 v[60:63], v[176:179], v[100:103], v[60:63]
  ds_read_b64_tr_b16 a[204:205], v8 offset:20480
  v_mfma_f32_16x16x32_bf16 v[60:63], v[164:167], v[104:107], v[60:63]
  ds_read_b128 v[92:95], v1 offset:5120
  ds_read_b64_tr_b16 a[206:207], v8 offset:22528
  ds_read_b64_tr_b16 a[208:209], v7 offset:24576
  v_mfma_f32_16x16x32_bf16 v[68:71], v[168:171], v[104:107], v[68:71]
  ds_read_b64_tr_b16 a[210:211], v7 offset:26624
  buffer_load_dwordx4 v9, s[8:11], s69 offen offset:2048 sc1 lds
  v_mfma_f32_16x16x32_bf16 v[68:71], v[180:183], v[100:103], v[68:71]
  ds_read_b64_tr_b16 a[212:213], v8 offset:24576
  v_mfma_f32_16x16x32_bf16 v[72:75], v[180:183], v[112:115], v[72:75]
  ds_read_b128 v[104:107], v1 offset:12288
  ds_read_b64_tr_b16 a[214:215], v8 offset:26624
  ds_read_b64_tr_b16 a[216:217], v7 offset:28672
  v_mfma_f32_16x16x32_bf16 v[72:75], v[168:171], v[108:111], v[72:75]
  s_waitcnt lgkmcnt(15)
  ds_read_b64_tr_b16 a[218:219], v7 offset:30720
  v_mfma_f32_16x16x32_bf16 v[52:55], v[184:187], v[80:83], v[52:55]
  ds_read_b64_tr_b16 a[220:221], v8 offset:28672
  buffer_load_dwordx4 v9, s[8:11], s69 offen offset:3072 sc1 lds
  s_add_u32 m0, s70, 98304
  s_add_u32 s69, s64, 0
  v_mfma_f32_16x16x32_bf16 v[52:55], v[196:199], v[76:79], v[52:55]
  ds_read_b128 v[100:103], v1 offset:13312
  ds_read_b64_tr_b16 a[222:223], v8 offset:30720
  ds_read_b64_tr_b16 a[224:225], v7 offset:0
  v_mfma_f32_16x16x32_bf16 v[56:59], v[196:199], v[84:87], v[56:59]
  ds_read_b64_tr_b16 a[226:227], v7 offset:2048
  buffer_load_dwordx4 v9, s[8:11], s69 offen offset:0 sc1 lds
  v_mfma_f32_16x16x32_bf16 v[56:59], v[184:187], v[88:91], v[56:59]
  ds_read_b64_tr_b16 a[228:229], v8 offset:0
  v_mfma_f32_16x16x32_bf16 v[64:67], v[188:191], v[88:91], v[64:67]
  ds_read_b128 v[112:115], v1 offset:6144
  ds_read_b64_tr_b16 a[230:231], v8 offset:2048
  ds_read_b64_tr_b16 a[232:233], v7 offset:4096
  v_mfma_f32_16x16x32_bf16 v[64:67], v[200:203], v[84:87], v[64:67]
  ds_read_b64_tr_b16 a[234:235], v7 offset:6144
  v_mfma_f32_16x16x32_bf16 v[60:63], v[200:203], v[76:79], v[60:63]
  ds_read_b64_tr_b16 a[236:237], v8 offset:4096
  buffer_load_dwordx4 v9, s[8:11], s69 offen offset:1024 sc1 lds
  v_mfma_f32_16x16x32_bf16 v[60:63], v[188:191], v[80:83], v[60:63]
  ds_read_b128 v[108:111], v1 offset:7168
  ds_read_b64_tr_b16 a[238:239], v8 offset:6144
  ds_read_b64_tr_b16 a[240:241], v7 offset:8192
  v_mfma_f32_16x16x32_bf16 v[68:71], v[192:195], v[80:83], v[68:71]
  ds_read_b64_tr_b16 a[242:243], v7 offset:10240
  v_mfma_f32_16x16x32_bf16 v[68:71], v[204:207], v[76:79], v[68:71]
  ds_read_b64_tr_b16 a[244:245], v8 offset:8192
  buffer_load_dwordx4 v9, s[8:11], s69 offen offset:2048 sc1 lds
  v_mfma_f32_16x16x32_bf16 v[72:75], v[204:207], v[84:87], v[72:75]
  ds_read_b128 v[80:83], v1 offset:14336
  ds_read_b64_tr_b16 a[246:247], v8 offset:10240
  ds_read_b64_tr_b16 a[248:249], v7 offset:12288
  v_mfma_f32_16x16x32_bf16 v[72:75], v[192:195], v[88:91], v[72:75]
  s_waitcnt lgkmcnt(15)
  ds_read_b64_tr_b16 a[250:251], v7 offset:14336
  v_mfma_f32_16x16x32_bf16 v[52:55], v[208:211], v[96:99], v[52:55]
  ds_read_b64_tr_b16 v[124:125], v8 offset:12288
  v_mfma_f32_16x16x32_bf16 v[52:55], v[220:223], v[92:95], v[52:55]
  ds_read_b128 v[76:79], v1 offset:15360
  ds_read_b64_tr_b16 v[126:127], v8 offset:14336
  v_mfma_f32_16x16x32_bf16 v[56:59], v[220:223], v[100:103], v[56:59]
  buffer_load_dwordx4 v9, s[8:11], s69 offen offset:3072 sc1 lds
  v_mfma_f32_16x16x32_bf16 v[56:59], v[208:211], v[104:107], v[56:59]
  s_add_u32 m0, s70, 114688
  s_add_u32 s69, s65, 0
  v_mfma_f32_16x16x32_bf16 v[64:67], v[212:215], v[104:107], v[64:67]
  buffer_load_dwordx4 v9, s[8:11], s69 offen offset:0 sc1 lds
  v_mfma_f32_16x16x32_bf16 v[64:67], v[224:227], v[100:103], v[64:67]
  v_mfma_f32_16x16x32_bf16 v[60:63], v[224:227], v[92:95], v[60:63]
  v_mfma_f32_16x16x32_bf16 v[60:63], v[212:215], v[96:99], v[60:63]
  s_waitcnt vmcnt(13)
  s_cmp_lg_u32 s44, 0
  s_cbranch_scc1 PL6_adaLN_cond__sliding_local_dilated__swiglu_ffn__prompt_kernelx
  v_bitop3_b32 v116, v116, v117, s46 bitop3:0x7e
  v_bitop3_b32 v118, v118, v119, s46 bitop3:0x7e
  v_or_b32 v116, v116, v118
  v_cmp_ne_u32 vcc, 0, v116
  s_nop 4
  s_cbranch_vccz PL6_adaLN_cond__sliding_local_dilated__swiglu_ffn__prompt_kernelx
  s_mov_b32 s57, 60000
PL6_adaLN_cond__sliding_local_dilated__swiglu_ffn__prompt_kernel:
  buffer_load_dwordx4 v[116:119], v21, s[8:11], 0 offen sc1
  s_sub_u32 s57, s57, 1
  s_cmp_eq_u32 s57, 0
  s_waitcnt vmcnt(0)
  s_cbranch_scc1 PL6_adaLN_cond__sliding_local_dilated__swiglu_ffn__prompt_kernelx
  v_bitop3_b32 v116, v116, v117, s46 bitop3:0x7e
  v_bitop3_b32 v118, v118, v119, s46 bitop3:0x7e
  v_or_b32 v116, v116, v118
  v_cmp_ne_u32 vcc, 0, v116
  s_nop 4
  s_cbranch_vccnz PL6_adaLN_cond__sliding_local_dilated__swiglu_ffn__prompt_kernel
PL6_adaLN_cond__sliding_local_dilated__swiglu_ffn__prompt_kernelx:
  s_waitcnt vmcnt(5) lgkmcnt(0)
  s_barrier
  v_mfma_f32_16x16x32_bf16 v[68:71], v[216:219], v[96:99], v[68:71]
  ds_read_b128 v[84:87], v22 offset:32768
  buffer_load_dwordx4 v9, s[8:11], s69 offen offset:1024 sc1 lds
  v_mfma_f32_16x16x32_bf16 v[68:71], v[228:231], v[92:95], v[68:71]
  v_and_b32 v21, 31, v0
  v_lshlrev_b32 v21, 2, v21
  v_lshrrev_b32 v181, 5, v0
  v_lshl_add_u32 v21, v181, 13, v21
  v_mfma_f32_16x16x32_bf16 v[72:75], v[228:231], v[100:103], v[72:75]
  ds_read_b128 v[88:91], v22 offset:33792
  v_mfma_f32_16x16x32_bf16 v[72:75], v[216:219], v[104:107], v[72:75]
  s_waitcnt lgkmcnt(3)
  buffer_load_dwordx4 v9, s[8:11], s69 offen offset:2048 sc1 lds
  v_mfma_f32_16x16x32_bf16 v[52:55], v[232:235], v[112:115], v[52:55]
  ds_read_b128 v[96:99], v22 offset:34816
  v_mfma_f32_16x16x32_bf16 v[52:55], v[244:247], v[108:111], v[52:55]
  v_mfma_f32_16x16x32_bf16 v[56:59], v[244:247], v[76:79], v[56:59]
  ds_read_b128 v[92:95], v22 offset:35840
  v_mfma_f32_16x16x32_bf16 v[56:59], v[232:235], v[80:83], v[56:59]
  buffer_load_dwordx4 v9, s[8:11], s69 offen offset:3072 sc1 lds
  v_mfma_f32_16x16x32_bf16 v[64:67], v[236:239], v[80:83], v[64:67]
  ds_read_b128 v[100:103], v22 offset:36864
  v_mfma_f32_16x16x32_bf16 v[64:67], v[248:251], v[76:79], v[64:67]
  s_add_u32 s56, s76, 8192
  v_mfma_f32_16x16x32_bf16 v[60:63], v[248:251], v[108:111], v[60:63]
  ds_read_b128 v[104:107], v22 offset:37888
  buffer_load_dword v160, v21, s[8:11], s56 offen sc1
  v_mfma_f32_16x16x32_bf16 v[60:63], v[236:239], v[112:115], v[60:63]
  s_add_u32 s56, s76, 32768
  v_mfma_f32_16x16x32_bf16 v[68:71], v[240:243], v[112:115], v[68:71]
  ds_read_b128 v[112:115], v22 offset:38912
  buffer_load_dword v161, v21, s[8:11], s56 offen sc1
  v_mfma_f32_16x16x32_bf16 v[68:71], v[252:255], v[108:111], v[68:71]
  s_add_u32 s56, s76, 57344
  v_mfma_f32_16x16x32_bf16 v[72:75], v[252:255], v[76:79], v[72:75]
  ds_read_b128 v[108:111], v22 offset:39936
  buffer_load_dword v162, v21, s[8:11], s56 offen sc1
  v_mfma_f32_16x16x32_bf16 v[72:75], v[240:243], v[80:83], v[72:75]
  s_waitcnt lgkmcnt(4)
  s_add_u32 s56, s76, 81920
  v_mfma_f32_16x16x32_bf16 v[128:131], a[0:3], v[84:87], 0
  ds_read_b128 v[76:79], v22 offset:49152
  buffer_load_dword v163, v21, s[8:11], s56 offen sc1
  s_add_u32 s56, s47, 41943040
  v_mfma_f32_16x16x32_bf16 v[128:131], a[8:11], v[88:91], v[128:131]
  buffer_load_dwordx4 v[144:147], v1, s[8:11], s56 offen sc1
  s_add_u32 s56, s47, 42008576
  v_mfma_f32_16x16x32_bf16 v[132:135], a[12:15], v[88:91], 0
  ds_read_b128 v[80:83], v22 offset:50176
  s_lshr_b32 s79, s2, 6
  s_lshl_b32 s79, s79, 2
  s_add_u32 s79, s79, s44
  s_lshl_b32 s79, s79, 8
  v_mfma_f32_16x16x32_bf16 v[132:135], a[4:7], v[84:87], v[132:135]
  buffer_load_dwordx4 v[148:151], v1, s[8:11], s56 offen sc1
  s_add_u32 s56, s47, 42074112
  v_cvt_pk_bf16_f32 v52, v52, v53
  v_cvt_pk_bf16_f32 v53, v54, v55
  ds_write_b64 v18, v[52:53] offset:6144
  v_cvt_pk_bf16_f32 v60, v60, v61
  v_cvt_pk_bf16_f32 v61, v62, v63
  v_mfma_f32_16x16x32_bf16 v[128:131], a[16:19], v[96:99], v[128:131]
  ds_read_b128 v[88:91], v22 offset:51200
  v_cvt_pk_bf16_f32 v62, v68, v69
  v_cvt_pk_bf16_f32 v63, v70, v71
  ds_write_b128 v17, v[60:63] offset:7168
  v_mfma_f32_16x16x32_bf16 v[128:131], a[24:27], v[92:95], v[128:131]
  buffer_load_dwordx4 v[152:155], v1, s[8:11], s56 offen sc1
  s_add_u32 s56, s47, 42139648
  v_cvt_pk_bf16_f32 v56, v56, v57
  v_cvt_pk_bf16_f32 v57, v58, v59
  ds_write_b64 v18, v[56:57] offset:12288
  v_cvt_pk_bf16_f32 v64, v64, v65
  v_cvt_pk_bf16_f32 v65, v66, v67
  v_mfma_f32_16x16x32_bf16 v[132:135], a[28:31], v[92:95], v[132:135]
  ds_read_b128 v[84:87], v22 offset:52224
  v_cvt_pk_bf16_f32 v66, v72, v73
  v_cvt_pk_bf16_f32 v67, v74, v75
  ds_write_b128 v17, v[64:67] offset:13312
  v_mfma_f32_16x16x32_bf16 v[132:135], a[20:23], v[96:99], v[132:135]
  s_waitcnt lgkmcnt(8)
  buffer_load_dwordx4 v[156:159], v1, s[8:11], s56 offen sc1
  s_add_u32 m0, s70, 16384
  s_add_u32 s69, s62, 65536
  s_bitcmp1_b32 s44, 0
  s_mov_b32 s52, 6144
  s_cselect_b32 s52, 12288, s52
  s_mov_b32 s53, 0
  s_cselect_b32 s53, 6144, s53
  v_add_u32 v116, s52, v19
  v_mfma_f32_16x16x32_bf16 v[128:131], a[32:35], v[100:103], v[128:131]
  ds_read_b128 v[92:95], v22 offset:53248
  v_add_u32 v117, s53, v19
  v_add_u32 v118, s52, v20
  v_add_u32 v119, s53, v20
  s_waitcnt vmcnt(8) lgkmcnt(1)
  s_barrier
  v_mfma_f32_16x16x32_bf16 v[128:131], a[40:43], v[104:107], v[128:131]
  buffer_load_dwordx4 v9, s[8:11], s69 offen offset:0 sc1 lds
  ds_read_b128 v[52:55], v116
  ds_read_b128 v[56:59], v117 offset:1024
  ds_read_b128 v[60:63], v116 offset:1024
  v_mfma_f32_16x16x32_bf16 v[132:135], a[44:47], v[104:107], v[132:135]
  ds_read_b128 v[96:99], v22 offset:54272
  ds_read_b64_tr_b16 v[64:65], v119 offset:2048
  ds_read_b64_tr_b16 v[66:67], v118 offset:2048
  ds_read_b64_tr_b16 v[68:69], v119 offset:2056
  v_mfma_f32_16x16x32_bf16 v[132:135], a[36:39], v[100:103], v[132:135]
  ds_read_b64_tr_b16 v[70:71], v118 offset:2056
  v_mfma_f32_16x16x32_bf16 v[128:131], a[48:51], v[112:115], v[128:131]
  ds_read_b128 v[104:107], v22 offset:55296
  s_lshl_b32 s57, s44, 28
  s_add_u32 s57, s57, s77
  buffer_load_dword v13, v14, s[8:11], s57 offen sc1
  v_mfma_f32_16x16x32_bf16 v[128:131], a[56:59], v[108:111], v[128:131]
  buffer_load_dwordx4 v9, s[8:11], s69 offen offset:1024 sc1 lds
  v_mfma_f32_16x16x32_bf16 v[132:135], a[60:63], v[108:111], v[132:135]
  ds_read_b128 v[100:103], v22 offset:56320
HOP5:
  s_cbranch_execz HOP9
  v_mfma_f32_16x16x32_bf16 v[132:135], a[52:55], v[112:115], v[132:135]
  s_waitcnt lgkmcnt(12)
  buffer_load_dwordx4 v9, s[8:11], s69 offen offset:2048 sc1 lds
  v_mfma_f32_16x16x32_bf16 v[128:131], a[64:67], v[76:79], v[128:131]
  ds_read_b128 v[108:111], v23 offset:32768
  s_waitcnt lgkmcnt(3)
  v_mfma_f32_16x16x32_bf16 v[116:119], v[56:59], v[52:55], 0
  v_mfma_f32_16x16x32_bf16 v[120:123], v[60:63], v[52:55], 0
  v_mfma_f32_16x16x32_bf16 v[128:131], a[72:75], v[80:83], v[128:131]
  v_mfma_f32_16x16x32_bf16 v[132:135], a[76:79], v[80:83], v[132:135]
  ds_read_b128 v[112:115], v23 offset:33792
  v_mfma_f32_16x16x32_bf16 v[132:135], a[68:71], v[76:79], v[132:135]
  buffer_load_dwordx4 v9, s[8:11], s69 offen offset:3072 sc1 lds
  s_add_u32 m0, s70, 81920
  s_add_u32 s69, s63, 65536
  v_mfma_f32_16x16x32_bf16 v[128:131], a[80:83], v[88:91], v[128:131]
  ds_read_b128 v[80:83], v23 offset:34816
  v_cndmask_b32 v72, v116, v120, s[80:81]
  v_cndmask_b32 v73, v117, v121, s[82:83]
  v_cndmask_b32 v74, v118, v122, s[84:85]
  v_cndmask_b32 v75, v119, v123, s[86:87]
  v_cndmask_b32 v72, v72, v73, s[88:89]
  v_cndmask_b32 v73, v74, v75, s[88:89]
  v_mfma_f32_16x16x32_bf16 v[128:131], a[88:91], v[84:87], v[128:131]
  buffer_load_dwordx4 v9, s[8:11], s69 offen offset:0 sc1 lds
  v_mul_f32 v72, 0x3e8293ee, v72
  v_mul_f32 v73, 0x3e8293ee, v73
  v_max_f32 v74, v72, v73
  v_mov_b32 v75, v74
  v_mfma_f32_16x16x32_bf16 v[132:135], a[92:95], v[84:87], v[132:135]
  ds_read_b128 v[76:79], v23 offset:35840
  v_permlane16_swap_b32 v74, v75
  v_max_f32 v74, v74, v75
  v_mov_b32 v75, v74
  v_mfma_f32_16x16x32_bf16 v[132:135], a[84:87], v[88:91], v[132:135]
  s_waitcnt lgkmcnt(4)
  v_permlane32_swap_b32 v74, v75
  v_max_f32 v74, v74, v75
  v_sub_f32 v72, v72, v74
  v_sub_f32 v73, v73, v74
  v_exp_f32 v72, v72
  v_mfma_f32_16x16x32_bf16 v[128:131], a[96:99], v[92:95], v[128:131]
  ds_read_b128 v[84:87], v23 offset:36864
  v_exp_f32 v73, v73
  v_mfma_f32_16x16x32_bf16 v[128:131], a[104:107], v[96:99], v[128:131]
  buffer_load_dwordx4 v9, s[8:11], s69 offen offset:1024 sc1 lds
  v_add_f32 v74, v72, v73
  v_mov_b32 v75, v74
  v_mfma_f32_16x16x32_bf16 v[132:135], a[108:111], v[96:99], v[132:135]
  ds_read_b128 v[88:91], v23 offset:37888
  v_permlane16_swap_b32 v74, v75
  v_add_f32 v74, v74, v75
  v_mov_b32 v75, v74
  v_mfma_f32_16x16x32_bf16 v[132:135], a[100:103], v[92:95], v[132:135]
  buffer_load_dwordx4 v9, s[8:11], s69 offen offset:2048 sc1 lds
  v_permlane32_swap_b32 v74, v75
  v_add_f32 v74, v74, v75
  v_rcp_f32 v74, v74
  v_mfma_f32_16x16x32_bf16 v[128:131], a[112:115], v[104:107], v[128:131]
  ds_read_b128 v[96:99], v23 offset:38912
  v_mul_f32 v72, v72, v74
  v_mul_f32 v73, v73, v74
  v_cvt_pk_bf16_f32 v72, v72, v72
  v_cvt_pk_bf16_f32 v73, v73, v73
  v_and_b32 v52, v24, v72
  v_and_b32 v53, v25, v73
  v_mfma_f32_16x16x32_bf16 v[128:131], a[120:123], v[100:103], v[128:131]
  v_and_b32 v54, v26, v72
  v_and_b32 v55, v27, v73
  v_mfma_f32_16x16x32_bf16 v[132:135], a[124:127], v[100:103], v[132:135]
  ds_read_b128 v[92:95], v23 offset:39936
  v_mfma_f32_16x16x32_bf16 v[56:59], v[64:67], v[52:55], 0
  v_mfma_f32_16x16x32_bf16 v[60:63], v[68:71], v[52:55], 0
  v_mfma_f32_16x16x32_bf16 v[132:135], a[116:119], v[104:107], v[132:135]
  s_waitcnt lgkmcnt(4)
  buffer_load_dwordx4 v9, s[8:11], s69 offen offset:3072 sc1 lds
  v_mfma_f32_16x16x32_bf16 v[128:131], a[128:131], v[108:111], v[128:131]
  ds_read_b128 v[100:103], v23 offset:49152
  s_add_u32 m0, s70, 65536
  s_add_u32 s69, s64, 65536
  v_mfma_f32_16x16x32_bf16 v[128:131], a[136:139], v[112:115], v[128:131]
  buffer_load_dwordx4 v9, s[8:11], s69 offen offset:0 sc1 lds
  v_mfma_f32_16x16x32_bf16 v[132:135], a[140:143], v[112:115], v[132:135]
  ds_read_b128 v[104:107], v23 offset:50176
  v_cvt_pk_bf16_f32 v116, v56, v57
  v_cvt_pk_bf16_f32 v117, v58, v59
  v_cvt_pk_bf16_f32 v118, v60, v61
  v_cvt_pk_bf16_f32 v119, v62, v63
  v_mfma_f32_16x16x32_bf16 v[132:135], a[132:135], v[108:111], v[132:135]
  buffer_store_dwordx4 v[116:119], v1, s[8:11], s73 offen sc1
  s_add_u32 s73, s73, 65536
  v_mfma_f32_16x16x32_bf16 v[128:131], a[144:147], v[80:83], v[128:131]
  ds_read_b128 v[112:115], v23 offset:51200
  v_mfma_f32_16x16x32_bf16 v[128:131], a[152:155], v[76:79], v[128:131]
  buffer_load_dwordx4 v9, s[8:11], s69 offen offset:1024 sc1 lds
  v_mfma_f32_16x16x32_bf16 v[132:135], a[156:159], v[76:79], v[132:135]
  ds_read_b128 v[108:111], v23 offset:52224
  v_mfma_f32_16x16x32_bf16 v[132:135], a[148:151], v[80:83], v[132:135]
  s_waitcnt lgkmcnt(4)
  buffer_load_dwordx4 v9, s[8:11], s69 offen offset:2048 sc1 lds
  v_mfma_f32_16x16x32_bf16 v[128:131], a[160:163], v[84:87], v[128:131]
  ds_read_b128 v[76:79], v23 offset:53248
  s_waitcnt vmcnt(17)
  v_add_f32 v160, v160, v161
  v_mfma_f32_16x16x32_bf16 v[128:131], a[168:171], v[88:91], v[128:131]
  v_add_f32 v162, v162, v163
  v_add_f32 v160, v160, v162
  v_cvt_pk_bf16_f32 v160, v160, v160
  v_mfma_f32_16x16x32_bf16 v[132:135], a[172:175], v[88:91], v[132:135]
  ds_read_b128 v[80:83], v23 offset:54272
  v_lshlrev_b32 v160, 16, v160
  v_cvt_f32_u32 v181, v181
  v_mfma_f32_16x16x32_bf16 v[132:135], a[164:167], v[84:87], v[132:135]
  buffer_load_dwordx4 v9, s[8:11], s69 offen offset:3072 sc1 lds
  s_add_u32 m0, s70, 0
  s_add_u32 s69, s65, 65536
  v_add_f32 v160, v160, v181
  v_mfma_f32_16x16x32_bf16 v[128:131], a[176:179], v[96:99], v[128:131]
  ds_read_b128 v[88:91], v23 offset:55296
  v_cvt_pk_bf16_f32 v160, v160, v160
  v_lshlrev_b32 v160, 16, v160
  v_mfma_f32_16x16x32_bf16 v[128:131], a[184:187], v[92:95], v[128:131]
  buffer_load_dwordx4 v9, s[8:11], s69 offen offset:0 sc1 lds
  s_lshl_b32 s54, s44, 8
  s_add_u32 s54, s54, 150528
  v_lshl_add_u32 v180, v0, 2, s54
  v_mfma_f32_16x16x32_bf16 v[132:135], a[188:191], v[92:95], v[132:135]
  ds_read_b128 v[84:87], v23 offset:56320
  v_lshrrev_b32 v161, 4, v0
  v_lshl_add_u32 v181, v161, 4, s54
  v_mfma_f32_16x16x32_bf16 v[132:135], a[180:183], v[96:99], v[132:135]
  s_waitcnt lgkmcnt(4)
  s_waitcnt vmcnt(13)
  s_cmp_lg_u32 s44, 0
  s_cbranch_scc1 PL7_adaLN_cond__sliding_local_dilated__swiglu_ffn__prompt_kernelx
  v_subrev_u32 v13, s46, v13
  v_subrev_u32 v13, 2, v13
  v_cmp_lt_u32 vcc, 3, v13
  s_nop 4
  s_cbranch_vccz PL7_adaLN_cond__sliding_local_dilated__swiglu_ffn__prompt_kernelx
  s_mov_b32 s57, 60000
PL7_adaLN_cond__sliding_local_dilated__swiglu_ffn__prompt_kernel:
  buffer_load_dword v13, v14, s[8:11], s77 offen sc1
  s_sub_u32 s57, s57, 1
  s_cmp_eq_u32 s57, 0
  s_waitcnt vmcnt(0)
  s_cbranch_scc1 PL7_adaLN_cond__sliding_local_dilated__swiglu_ffn__prompt_kernelx
  v_subrev_u32 v13, s46, v13
  v_subrev_u32 v13, 2, v13
  v_cmp_lt_u32 vcc, 3, v13
  s_nop 4
  s_cbranch_vccnz PL7_adaLN_cond__sliding_local_dilated__swiglu_ffn__prompt_kernel
PL7_adaLN_cond__sliding_local_dilated__swiglu_ffn__prompt_kernelx:
  s_waitcnt vmcnt(6)
  s_barrier
  v_mfma_f32_16x16x32_bf16 v[128:131], a[192:195], v[100:103], v[128:131]
  ds_read_b128 v[92:95], v22 offset:16384
  ds_write_b32 v180, v160
  v_mfma_f32_16x16x32_bf16 v[128:131], a[200:203], v[104:107], v[128:131]
  buffer_load_dwordx4 v9, s[8:11], s69 offen offset:1024 sc1 lds
  v_bfe_u32 v180, v0, 2, 2
  v_xor_b32 v180, v180, v161
  v_lshlrev_b32 v180, 27, v180
  v_mfma_f32_16x16x32_bf16 v[132:135], a[204:207], v[104:107], v[132:135]
  ds_read_b128 v[96:99], v22 offset:17408
  v_and_b32 v162, 15, v0
  v_lshl_add_u32 v180, v162, 4, v180
  v_mfma_f32_16x16x32_bf16 v[132:135], a[196:199], v[100:103], v[132:135]
  buffer_load_dwordx4 v9, s[8:11], s69 offen offset:2048 sc1 lds
  s_and_b32 s54, s44, 1
  s_lshl_b32 s54, s54, 11
  v_add_u32 v182, s54, v1
  v_mfma_f32_16x16x32_bf16 v[128:131], a[208:211], v[112:115], v[128:131]
  ds_read_b128 v[104:107], v22 offset:18432
  s_and_b32 s54, s44, 2
  s_lshl_b32 s54, s54, 9
  v_mfma_f32_16x16x32_bf16 v[128:131], a[216:219], v[108:111], v[128:131]
  s_add_u32 s54, s54, 135168
  v_add_u32 v182, s54, v182
  ds_read_b128 v[160:163], v181 offset:0
  v_mfma_f32_16x16x32_bf16 v[132:135], a[220:223], v[108:111], v[132:135]
  ds_read_b128 v[100:103], v22 offset:19456
  ds_read_b128 v[164:167], v181 offset:64
  v_mfma_f32_16x16x32_bf16 v[132:135], a[212:215], v[112:115], v[132:135]
  s_waitcnt lgkmcnt(7)
  buffer_load_dwordx4 v9, s[8:11], s69 offen offset:3072 sc1 lds
  ds_read_b128 v[168:171], v181 offset:128
  v_mfma_f32_16x16x32_bf16 v[128:131], a[224:227], v[76:79], v[128:131]
  ds_read_b128 v[108:111], v22 offset:20480
  s_add_u32 m0, s70, 32768
  s_add_u32 s69, s62, 131072
  v_mfma_f32_16x16x32_bf16 v[128:131], a[232:235], v[80:83], v[128:131]
  buffer_load_dwordx4 v9, s[8:11], s69 offen offset:0 sc1 lds
  ds_read_b128 v[172:175], v181 offset:192
  v_mov_b32 v176, 0x3f803f80
  v_mfma_f32_16x16x32_bf16 v[132:135], a[236:239], v[80:83], v[132:135]
  ds_read_b128 v[112:115], v22 offset:21504
  v_mov_b32 v177, 0x3f803f80
  v_mov_b32 v178, 0x3f803f80
  v_mfma_f32_16x16x32_bf16 v[132:135], a[228:231], v[76:79], v[132:135]
  v_mov_b32 v179, 0x3f803f80
  s_mov_b32 s90, 0xcccccccc
  s_mov_b32 s91, 0xcccccccc
  v_mfma_f32_16x16x32_bf16 v[128:131], a[240:243], v[88:91], v[128:131]
  ds_read_b128 v[80:83], v22 offset:22528
  v_lshrrev_b32 v220, 5, v0
  v_xor_b32 v220, 1, v220
  v_lshlrev_b32 v220, 12, v220
  v_mfma_f32_16x16x32_bf16 v[128:131], a[248:251], v[84:87], v[128:131]
  buffer_load_dwordx4 v9, s[8:11], s69 offen offset:1024 sc1 lds
  s_waitcnt vmcnt(23) lgkmcnt(2)
  v_lshlrev_b32 v184, 16, v144
  v_and_b32 v185, 0xffff0000, v144
  v_mfma_f32_16x16x32_bf16 v[132:135], v[124:127], v[84:87], v[132:135]
  ds_read_b128 v[76:79], v22 offset:23552
  v_and_b32 v221, 31, v0
  v_lshl_add_u32 v220, v221, 3, v220
  v_mfma_f32_16x16x32_bf16 v[132:135], a[244:247], v[88:91], v[132:135]
  s_waitcnt lgkmcnt(7)
  buffer_load_dwordx4 v9, s[8:11], s69 offen offset:2048 sc1 lds
  v_add_u32 v15, s46, v0
  v_add_u32 v15, 3, v15
  s_waitcnt vmcnt(10)
  s_barrier
  s_mov_b64 exec, 1
  buffer_store_dword v15, v0, s[8:11], s74 offen offset:0 sc1
  s_mov_b64 exec, -1
  v_mfma_f32_16x16x32_bf16 v[136:139], a[0:3], v[92:95], 0
  ds_read_b128 v[84:87], v23 offset:16384
  v_lshlrev_b32 v186, 16, v145
  v_and_b32 v187, 0xffff0000, v145
  v_mfma_f32_16x16x32_bf16 v[136:139], a[8:11], v[96:99], v[136:139]
  v_lshlrev_b32 v188, 16, v146
  v_and_b32 v189, 0xffff0000, v146
  v_lshlrev_b32 v190, 16, v147
  v_mfma_f32_16x16x32_bf16 v[140:143], a[12:15], v[96:99], 0
  ds_read_b128 v[88:91], v23 offset:17408
  v_and_b32 v191, 0xffff0000, v147
  v_fmac_f32 v184, v160, v128
  v_mfma_f32_16x16x32_bf16 v[140:143], a[4:7], v[92:95], v[140:143]
  buffer_load_dwordx4 v9, s[8:11], s69 offen offset:3072 sc1 lds
  s_add_u32 m0, s70, 49152
  s_add_u32 s69, s63, 131072
  v_fmac_f32 v185, v161, v129
  v_mfma_f32_16x16x32_bf16 v[136:139], a[16:19], v[104:107], v[136:139]
  ds_read_b128 v[96:99], v23 offset:18432
  v_fmac_f32 v186, v162, v130
  v_fmac_f32 v187, v163, v131
  v_mfma_f32_16x16x32_bf16 v[136:139], a[24:27], v[100:103], v[136:139]
  buffer_load_dwordx4 v9, s[8:11], s69 offen offset:0 sc1 lds
  v_fmac_f32 v188, v164, v132
  v_fmac_f32 v189, v165, v133
  v_fmac_f32 v190, v166, v134
  v_mfma_f32_16x16x32_bf16 v[140:143], a[28:31], v[100:103], v[140:143]
  ds_read_b128 v[92:95], v23 offset:19456
  v_fmac_f32 v191, v167, v135
  v_mul_f32 v128, v184, v168
  v_mfma_f32_16x16x32_bf16 v[140:143], a[20:23], v[104:107], v[140:143]
  s_waitcnt lgkmcnt(4)
  v_mul_f32 v129, v185, v169
  v_mul_f32 v130, v186, v170
  v_mul_f32 v131, v187, v171
  v_mfma_f32_16x16x32_bf16 v[136:139], a[32:35], v[108:111], v[136:139]
  ds_read_b128 v[100:103], v23 offset:20480
  v_mul_f32 v132, v188, v172
  v_mul_f32 v133, v189, v173
  v_mfma_f32_16x16x32_bf16 v[136:139], a[40:43], v[112:115], v[136:139]
  buffer_load_dwordx4 v9, s[8:11], s69 offen offset:1024 sc1 lds
  v_mul_f32 v134, v190, v174
  v_mul_f32 v135, v191, v175
  v_cvt_pk_bf16_f32 v196, v128, v129
  v_mfma_f32_16x16x32_bf16 v[140:143], a[44:47], v[112:115], v[140:143]
  ds_read_b128 v[104:107], v23 offset:21504
  v_cvt_pk_bf16_f32 v197, v130, v131
  v_cvt_pk_bf16_f32 v198, v132, v133
  v_mfma_f32_16x16x32_bf16 v[140:143], a[36:39], v[108:111], v[140:143]
  buffer_load_dwordx4 v9, s[8:11], s69 offen offset:2048 sc1 lds
  v_cvt_pk_bf16_f32 v199, v134, v135
  v_mfma_f32_16x16x32_bf16 v[136:139], a[48:51], v[80:83], v[136:139]
  ds_read_b128 v[112:115], v23 offset:22528
  v_mfma_f32_16x16x32_bf16 v[136:139], a[56:59], v[76:79], v[136:139]
  s_add_u32 s54, s47, 36700160
  buffer_store_dwordx4 v[196:199], v1, s[8:11], s54 offen sc1
  v_mfma_f32_16x16x32_bf16 v[140:143], a[60:63], v[76:79], v[140:143]
  ds_read_b128 v[108:111], v23 offset:23552
  buffer_load_dwordx4 v9, s[8:11], s69 offen offset:3072 sc1 lds
  v_cvt_pk_bf16_f32 v144, v184, v185
  v_mfma_f32_16x16x32_bf16 v[140:143], a[52:55], v[80:83], v[140:143]
  s_waitcnt lgkmcnt(4)
  v_cvt_pk_bf16_f32 v145, v186, v187
  s_waitcnt vmcnt(10)
  s_barrier
  v_mfma_f32_16x16x32_bf16 v[136:139], a[64:67], v[84:87], v[136:139]
  ds_read_b128 v[76:79], v23 offset:0
  s_add_u32 m0, s70, 98304
  s_add_u32 s69, s64, 131072
  v_mfma_f32_16x16x32_bf16 v[136:139], a[72:75], v[88:91], v[136:139]
  buffer_load_dwordx4 v9, s[8:11], s69 offen offset:0 sc1 lds
  v_cvt_pk_bf16_f32 v146, v188, v189
  v_cvt_pk_bf16_f32 v147, v190, v191
  v_mfma_f32_16x16x32_bf16 v[140:143], a[76:79], v[88:91], v[140:143]
  ds_read_b128 v[80:83], v23 offset:1024
  v_mfma_f32_16x16x32_bf16 v[224:227], v[176:179], v[144:147], 0
  v_mfma_f32_16x16x32_bf16 v[192:195], v[144:147], v[144:147], 0
  v_mfma_f32_16x16x32_bf16 v[140:143], a[68:71], v[84:87], v[140:143]
  v_mfma_f32_16x16x32_bf16 v[136:139], a[80:83], v[96:99], v[136:139]
  ds_read_b128 v[88:91], v23 offset:2048
  v_mfma_f32_16x16x32_bf16 v[136:139], a[88:91], v[92:95], v[136:139]
  buffer_load_dwordx4 v9, s[8:11], s69 offen offset:1024 sc1 lds
  s_nop 2
  v_cndmask_b32 v192, v192, v193, s[88:89]
  v_cndmask_b32 v194, v194, v195, s[88:89]
  v_cndmask_b32 v225, v192, v194, s[90:91]
  v_mfma_f32_16x16x32_bf16 v[140:143], a[92:95], v[92:95], v[140:143]
  ds_read_b128 v[84:87], v23 offset:3072
  v_mfma_f32_16x16x32_bf16 v[140:143], a[84:87], v[96:99], v[140:143]
  s_waitcnt lgkmcnt(4)
  buffer_load_dwordx4 v9, s[8:11], s69 offen offset:2048 sc1 lds
  v_mfma_f32_16x16x32_bf16 v[136:139], a[96:99], v[100:103], v[136:139]
  ds_read_b128 v[92:95], v23 offset:4096
  v_mfma_f32_16x16x32_bf16 v[136:139], a[104:107], v[104:107], v[136:139]
  v_mfma_f32_16x16x32_bf16 v[140:143], a[108:111], v[104:107], v[140:143]
  ds_read_b128 v[96:99], v23 offset:5120
  v_mfma_f32_16x16x32_bf16 v[140:143], a[100:103], v[100:103], v[140:143]
  buffer_load_dwordx4 v9, s[8:11], s69 offen offset:3072 sc1 lds
  s_add_u32 m0, s70, 114688
  s_add_u32 s69, s65, 131072
  v_mfma_f32_16x16x32_bf16 v[136:139], a[112:115], v[112:115], v[136:139]
  ds_read_b128 v[104:107], v23 offset:6144
  v_mfma_f32_16x16x32_bf16 v[136:139], a[120:123], v[108:111], v[136:139]
  buffer_load_dwordx4 v9, s[8:11], s69 offen offset:0 sc1 lds
  v_mfma_f32_16x16x32_bf16 v[140:143], a[124:127], v[108:111], v[140:143]
  ds_read_b128 v[100:103], v23 offset:7168
  v_mfma_f32_16x16x32_bf16 v[140:143], a[116:119], v[112:115], v[140:143]
  s_waitcnt lgkmcnt(4)
  v_mfma_f32_16x16x32_bf16 v[136:139], a[128:131], v[76:79], v[136:139]
  ds_read_b128 v[108:111], v22 offset:0
  v_mfma_f32_16x16x32_bf16 v[136:139], a[136:139], v[80:83], v[136:139]
  buffer_load_dwordx4 v9, s[8:11], s69 offen offset:1024 sc1 lds
  v_mfma_f32_16x16x32_bf16 v[140:143], a[140:143], v[80:83], v[140:143]
  ds_read_b128 v[112:115], v22 offset:1024
  v_mfma_f32_16x16x32_bf16 v[140:143], a[132:135], v[76:79], v[140:143]
  buffer_load_dwordx4 v9, s[8:11], s69 offen offset:2048 sc1 lds
  v_mfma_f32_16x16x32_bf16 v[136:139], a[144:147], v[88:91], v[136:139]
  ds_read_b128 v[80:83], v22 offset:2048
  v_mfma_f32_16x16x32_bf16 v[136:139], a[152:155], v[84:87], v[136:139]
  v_mfma_f32_16x16x32_bf16 v[140:143], a[156:159], v[84:87], v[140:143]
  ds_read_b128 v[76:79], v22 offset:3072
  v_mfma_f32_16x16x32_bf16 v[140:143], a[148:151], v[88:91], v[140:143]
  s_waitcnt lgkmcnt(4)
  buffer_load_dwordx4 v9, s[8:11], s69 offen offset:3072 sc1 lds
  v_mfma_f32_16x16x32_bf16 v[136:139], a[160:163], v[92:95], v[136:139]
  ds_read_b128 v[84:87], v22 offset:4096
  v_mfma_f32_16x16x32_bf16 v[136:139], a[168:171], v[96:99], v[136:139]
  s_or_b32 s57, s2, s44
  s_mov_b32 s57, 851968
  s_cselect_b32 s57, 1073741824, s57
  v_add_u32 v15, s46, v0
  s_mov_b64 exec, 1
  buffer_store_dword v15, v0, s[8:11], s57 offen offset:0 sc1
  s_mov_b64 exec, -1
  v_mfma_f32_16x16x32_bf16 v[140:143], a[172:175], v[96:99], v[140:143]
  ds_read_b128 v[88:91], v22 offset:5120
  v_mfma_f32_16x16x32_bf16 v[140:143], a[164:167], v[92:95], v[140:143]
  v_mfma_f32_16x16x32_bf16 v[136:139], a[176:179], v[104:107], v[136:139]
  ds_read_b128 v[96:99], v22 offset:6144
  s_lshl_b32 s57, s44, 28
  s_add_u32 s57, s57, s77
  buffer_load_dword v13, v14, s[8:11], s57 offen sc1
  v_mfma_f32_16x16x32_bf16 v[136:139], a[184:187], v[100:103], v[136:139]
  v_mfma_f32_16x16x32_bf16 v[140:143], a[188:191], v[100:103], v[140:143]
  ds_read_b128 v[92:95], v22 offset:7168
  v_mfma_f32_16x16x32_bf16 v[140:143], a[180:183], v[104:107], v[140:143]
  s_waitcnt lgkmcnt(4)
  s_waitcnt vmcnt(10)
  s_barrier
  v_mfma_f32_16x16x32_bf16 v[136:139], a[192:195], v[108:111], v[136:139]
  ds_read_b128 v[100:103], v22 offset:32768
  v_mfma_f32_16x16x32_bf16 v[136:139], a[200:203], v[112:115], v[136:139]
  v_mfma_f32_16x16x32_bf16 v[140:143], a[204:207], v[112:115], v[140:143]
  ds_read_b128 v[104:107], v22 offset:33792
  v_mfma_f32_16x16x32_bf16 v[140:143], a[196:199], v[108:111], v[140:143]
  v_mfma_f32_16x16x32_bf16 v[136:139], a[208:211], v[80:83], v[136:139]
  ds_read_b128 v[112:115], v22 offset:34816
  s_waitcnt vmcnt(40) lgkmcnt(15)
  v_lshlrev_b32 v184, 16, v148
  v_and_b32 v185, 0xffff0000, v148
  v_lshlrev_b32 v186, 16, v149
  v_mfma_f32_16x16x32_bf16 v[136:139], a[216:219], v[76:79], v[136:139]
  v_and_b32 v187, 0xffff0000, v149
  v_lshlrev_b32 v188, 16, v150
  v_and_b32 v189, 0xffff0000, v150
  v_lshlrev_b32 v190, 16, v151
  v_and_b32 v191, 0xffff0000, v151
  v_mfma_f32_16x16x32_bf16 v[140:143], a[220:223], v[76:79], v[140:143]
  ds_read_b128 v[108:111], v22 offset:35840
  v_mfma_f32_16x16x32_bf16 v[140:143], a[212:215], v[80:83], v[140:143]
  s_waitcnt lgkmcnt(4)
  v_mfma_f32_16x16x32_bf16 v[136:139], a[224:227], v[84:87], v[136:139]
  ds_read_b128 v[76:79], v22 offset:36864
  v_mfma_f32_16x16x32_bf16 v[136:139], a[232:235], v[88:91], v[136:139]
  v_mfma_f32_16x16x32_bf16 v[140:143], a[236:239], v[88:91], v[140:143]
  ds_read_b128 v[80:83], v22 offset:37888
  v_mfma_f32_16x16x32_bf16 v[140:143], a[228:231], v[84:87], v[140:143]
  v_mfma_f32_16x16x32_bf16 v[136:139], a[240:243], v[96:99], v[136:139]
  ds_read_b128 v[88:91], v22 offset:38912
  v_mfma_f32_16x16x32_bf16 v[136:139], a[248:251], v[92:95], v[136:139]
  v_mfma_f32_16x16x32_bf16 v[140:143], v[124:127], v[92:95], v[140:143]
  ds_read_b128 v[84:87], v22 offset:39936
  v_mfma_f32_16x16x32_bf16 v[140:143], a[244:247], v[96:99], v[140:143]
  s_waitcnt lgkmcnt(4)
  v_mfma_f32_16x16x32_bf16 v[128:131], a[0:3], v[100:103], 0
  ds_read_b128 v[92:95], v22 offset:49152
  v_mfma_f32_16x16x32_bf16 v[128:131], a[8:11], v[104:107], v[128:131]
  v_mfma_f32_16x16x32_bf16 v[132:135], a[12:15], v[104:107], 0
  ds_read_b128 v[96:99], v22 offset:50176
  v_fmac_f32 v184, v160, v136
  v_fmac_f32 v185, v161, v137
  v_fmac_f32 v186, v162, v138
  v_fmac_f32 v187, v163, v139
  v_mfma_f32_16x16x32_bf16 v[132:135], a[4:7], v[100:103], v[132:135]
  v_fmac_f32 v188, v164, v140
  v_fmac_f32 v189, v165, v141
  v_fmac_f32 v190, v166, v142
  v_fmac_f32 v191, v167, v143
  v_mul_f32 v136, v184, v168
  v_mfma_f32_16x16x32_bf16 v[128:131], a[16:19], v[112:115], v[128:131]
  ds_read_b128 v[104:107], v22 offset:51200
  v_mul_f32 v137, v185, v169
  v_mul_f32 v138, v186, v170
  v_mul_f32 v139, v187, v171
  v_mul_f32 v140, v188, v172
  v_mfma_f32_16x16x32_bf16 v[128:131], a[24:27], v[108:111], v[128:131]
  v_mul_f32 v141, v189, v173
  v_mul_f32 v142, v190, v174
  v_mul_f32 v143, v191, v175
  v_cvt_pk_bf16_f32 v200, v136, v137
  v_cvt_pk_bf16_f32 v201, v138, v139
  v_mfma_f32_16x16x32_bf16 v[132:135], a[28:31], v[108:111], v[132:135]
  ds_read_b128 v[100:103], v22 offset:52224
  v_cvt_pk_bf16_f32 v202, v140, v141
  v_cvt_pk_bf16_f32 v203, v142, v143
  v_mfma_f32_16x16x32_bf16 v[132:135], a[20:23], v[112:115], v[132:135]
  s_waitcnt lgkmcnt(4)
  s_add_u32 s54, s47, 36765696
  buffer_store_dwordx4 v[200:203], v1, s[8:11], s54 offen sc1
  v_mfma_f32_16x16x32_bf16 v[128:131], a[32:35], v[76:79], v[128:131]
  ds_read_b128 v[108:111], v22 offset:53248
  v_cvt_pk_bf16_f32 v148, v184, v185
  v_cvt_pk_bf16_f32 v149, v186, v187
  v_cvt_pk_bf16_f32 v150, v188, v189
  v_cvt_pk_bf16_f32 v151, v190, v191
  v_mfma_f32_16x16x32_bf16 v[128:131], a[40:43], v[80:83], v[128:131]
  s_nop 0
  v_mfma_f32_16x16x32_bf16 v[226:229], v[176:179], v[148:151], 0
  v_mfma_f32_16x16x32_bf16 v[192:195], v[148:151], v[148:151], 0
  v_mfma_f32_16x16x32_bf16 v[132:135], a[44:47], v[80:83], v[132:135]
  ds_read_b128 v[112:115], v22 offset:54272
  v_mfma_f32_16x16x32_bf16 v[132:135], a[36:39], v[76:79], v[132:135]
  v_mfma_f32_16x16x32_bf16 v[128:131], a[48:51], v[88:91], v[128:131]
  ds_read_b128 v[80:83], v22 offset:55296
  s_nop 2
  v_cndmask_b32 v192, v192, v193, s[88:89]
  v_cndmask_b32 v194, v194, v195, s[88:89]
  v_cndmask_b32 v227, v192, v194, s[90:91]
  v_mfma_f32_16x16x32_bf16 v[128:131], a[56:59], v[84:87], v[128:131]
  buffer_store_dwordx4 v[224:227], v180, s[8:11], s48 offen offset:0 sc1
  v_mfma_f32_16x16x32_bf16 v[132:135], a[60:63], v[84:87], v[132:135]
  ds_read_b128 v[76:79], v22 offset:56320
  v_mfma_f32_16x16x32_bf16 v[132:135], a[52:55], v[88:91], v[132:135]
  s_waitcnt lgkmcnt(4)
  s_waitcnt vmcnt(2)
  s_cmp_lg_u32 s44, 0
  s_cbranch_scc1 PL8_adaLN_cond__sliding_local_dilated__swiglu_ffn__prompt_kernelx
  v_subrev_u32 v13, s46, v13
  v_subrev_u32 v13, 3, v13
  v_cmp_lt_u32 vcc, 3, v13
  s_nop 4
  s_cbranch_vccz PL8_adaLN_cond__sliding_local_dilated__swiglu_ffn__prompt_kernelx
  s_mov_b32 s57, 60000
PL8_adaLN_cond__sliding_local_dilated__swiglu_ffn__prompt_kernel:
  buffer_load_dword v13, v14, s[8:11], s77 offen sc1
  s_sub_u32 s57, s57, 1
  s_cmp_eq_u32 s57, 0
  s_waitcnt vmcnt(0)
  s_cbranch_scc1 PL8_adaLN_cond__sliding_local_dilated__swiglu_ffn__prompt_kernelx
  v_subrev_u32 v13, s46, v13
  v_subrev_u32 v13, 3, v13
  v_cmp_lt_u32 vcc, 3, v13
  s_nop 4
  s_cbranch_vccnz PL8_adaLN_cond__sliding_local_dilated__swiglu_ffn__prompt_kernel
PL8_adaLN_cond__sliding_local_dilated__swiglu_ffn__prompt_kernelx:
  s_waitcnt vmcnt(4)
  s_barrier
  v_mfma_f32_16x16x32_bf16 v[128:131], a[64:67], v[92:95], v[128:131]
  ds_read_b128 v[84:87], v23 offset:32768
  s_add_u32 m0, s70, 16384
  s_add_u32 s69, s62, 196608
  v_mfma_f32_16x16x32_bf16 v[128:131], a[72:75], v[96:99], v[128:131]
  buffer_load_dwordx4 v9, s[8:11], s69 offen offset:0 sc1 lds
  v_mfma_f32_16x16x32_bf16 v[132:135], a[76:79], v[96:99], v[132:135]
  ds_read_b128 v[88:91], v23 offset:33792
  v_mfma_f32_16x16x32_bf16 v[132:135], a[68:71], v[92:95], v[132:135]
  buffer_load_dwordx4 v9, s[8:11], s69 offen offset:1024 sc1 lds
  v_mfma_f32_16x16x32_bf16 v[128:131], a[80:83], v[104:107], v[128:131]
  ds_read_b128 v[96:99], v23 offset:34816
  buffer_load_dwordx4 v9, s[8:11], s69 offen offset:2048 sc1 lds
  v_mfma_f32_16x16x32_bf16 v[128:131], a[88:91], v[100:103], v[128:131]
  v_mfma_f32_16x16x32_bf16 v[132:135], a[92:95], v[100:103], v[132:135]
  ds_read_b128 v[92:95], v23 offset:35840
  buffer_load_dwordx4 v9, s[8:11], s69 offen offset:3072 sc1 lds
  s_add_u32 m0, s70, 81920
  s_add_u32 s69, s63, 196608
  v_mfma_f32_16x16x32_bf16 v[132:135], a[84:87], v[104:107], v[132:135]
  s_waitcnt lgkmcnt(4)
  buffer_load_dwordx4 v9, s[8:11], s69 offen offset:0 sc1 lds
  v_mfma_f32_16x16x32_bf16 v[128:131], a[96:99], v[108:111], v[128:131]
  ds_read_b128 v[100:103], v23 offset:36864
  v_mfma_f32_16x16x32_bf16 v[128:131], a[104:107], v[112:115], v[128:131]
  buffer_load_dwordx4 v9, s[8:11], s69 offen offset:1024 sc1 lds
  v_mfma_f32_16x16x32_bf16 v[132:135], a[108:111], v[112:115], v[132:135]
  ds_read_b128 v[104:107], v23 offset:37888
  buffer_load_dwordx4 v9, s[8:11], s69 offen offset:2048 sc1 lds
  v_mfma_f32_16x16x32_bf16 v[132:135], a[100:103], v[108:111], v[132:135]
  v_mfma_f32_16x16x32_bf16 v[128:131], a[112:115], v[80:83], v[128:131]
  ds_read_b128 v[112:115], v23 offset:38912
  buffer_load_dwordx4 v9, s[8:11], s69 offen offset:3072 sc1 lds
  s_add_u32 m0, s70, 65536
  s_add_u32 s69, s64, 196608
  v_mfma_f32_16x16x32_bf16 v[128:131], a[120:123], v[76:79], v[128:131]
  buffer_load_dwordx4 v9, s[8:11], s69 offen offset:0 sc1 lds
  v_mfma_f32_16x16x32_bf16 v[132:135], a[124:127], v[76:79], v[132:135]
  ds_read_b128 v[108:111], v23 offset:39936
  v_mfma_f32_16x16x32_bf16 v[132:135], a[116:119], v[80:83], v[132:135]
  s_waitcnt lgkmcnt(4)
  buffer_load_dwordx4 v9, s[8:11], s69 offen offset:1024 sc1 lds
  v_mfma_f32_16x16x32_bf16 v[128:131], a[128:131], v[84:87], v[128:131]
  ds_read_b128 v[76:79], v23 offset:49152
  buffer_load_dwordx4 v9, s[8:11], s69 offen offset:2048 sc1 lds
  v_mfma_f32_16x16x32_bf16 v[128:131], a[136:139], v[88:91], v[128:131]
  v_mfma_f32_16x16x32_bf16 v[132:135], a[140:143], v[88:91], v[132:135]
  ds_read_b128 v[80:83], v23 offset:50176
  buffer_load_dwordx4 v9, s[8:11], s69 offen offset:3072 sc1 lds
  s_add_u32 m0, s70, 0
  s_add_u32 s69, s65, 196608
  v_mfma_f32_16x16x32_bf16 v[132:135], a[132:135], v[84:87], v[132:135]
  buffer_load_dwordx4 v9, s[8:11], s69 offen offset:0 sc1 lds
  v_mfma_f32_16x16x32_bf16 v[128:131], a[144:147], v[96:99], v[128:131]
  ds_read_b128 v[88:91], v23 offset:51200
  v_mfma_f32_16x16x32_bf16 v[128:131], a[152:155], v[92:95], v[128:131]
  buffer_load_dwordx4 v9, s[8:11], s69 offen offset:1024 sc1 lds
  v_mfma_f32_16x16x32_bf16 v[132:135], a[156:159], v[92:95], v[132:135]
  ds_read_b128 v[84:87], v23 offset:52224
  buffer_load_dwordx4 v9, s[8:11], s69 offen offset:2048 sc1 lds
  v_mfma_f32_16x16x32_bf16 v[132:135], a[148:151], v[96:99], v[132:135]
  s_waitcnt lgkmcnt(4)
  v_mfma_f32_16x16x32_bf16 v[128:131], a[160:163], v[100:103], v[128:131]
  ds_read_b128 v[92:95], v23 offset:53248
  v_mfma_f32_16x16x32_bf16 v[128:131], a[168:171], v[104:107], v[128:131]
  buffer_load_dwordx4 v9, s[8:11], s69 offen offset:3072 sc1 lds
  v_mfma_f32_16x16x32_bf16 v[132:135], a[172:175], v[104:107], v[132:135]
  ds_read_b128 v[96:99], v23 offset:54272
  v_mfma_f32_16x16x32_bf16 v[132:135], a[164:167], v[100:103], v[132:135]
  v_mfma_f32_16x16x32_bf16 v[128:131], a[176:179], v[112:115], v[128:131]
  ds_read_b128 v[104:107], v23 offset:55296
  v_mfma_f32_16x16x32_bf16 v[128:131], a[184:187], v[108:111], v[128:131]
  s_mov_b32 s55, 0
  s_add_u32 m0, s45, 32768
  s_sub_u32 s73, s49, 524288
  v_mfma_f32_16x16x32_bf16 v[132:135], a[188:191], v[108:111], v[132:135]
  ds_read_b128 v[100:103], v23 offset:56320
  buffer_load_dwordx4 v16, s[28:31], s55 offen lds
  v_mfma_f32_16x16x32_bf16 v[132:135], a[180:183], v[112:115], v[132:135]
  s_waitcnt lgkmcnt(4)
  s_waitcnt vmcnt(9)
  s_barrier
  v_add_u32 v15, s46, v0
  s_mov_b64 exec, 1
  buffer_store_dword v15, v0, s[8:11], s73 offen offset:0 sc1
  s_mov_b64 exec, -1
  v_mfma_f32_16x16x32_bf16 v[128:131], a[192:195], v[76:79], v[128:131]
  ds_read_b128 v[108:111], v22 offset:16384
  v_mfma_f32_16x16x32_bf16 v[128:131], a[200:203], v[80:83], v[128:131]
  v_mfma_f32_16x16x32_bf16 v[132:135], a[204:207], v[80:83], v[132:135]
  ds_read_b128 v[112:115], v22 offset:17408
  v_mfma_f32_16x16x32_bf16 v[132:135], a[196:199], v[76:79], v[132:135]
  s_mov_b32 s55, 0
  s_add_u32 m0, s45, 40960
  v_mfma_f32_16x16x32_bf16 v[128:131], a[208:211], v[88:91], v[128:131]
  ds_read_b128 v[80:83], v22 offset:18432
  s_waitcnt vmcnt(59) lgkmcnt(15)
  v_lshlrev_b32 v184, 16, v152
  v_mfma_f32_16x16x32_bf16 v[128:131], a[216:219], v[84:87], v[128:131]
  buffer_load_dwordx4 v16, s[32:35], s55 offen lds
  v_and_b32 v185, 0xffff0000, v152
  v_lshlrev_b32 v186, 16, v153
  v_and_b32 v187, 0xffff0000, v153
  v_mfma_f32_16x16x32_bf16 v[132:135], a[220:223], v[84:87], v[132:135]
  ds_read_b128 v[76:79], v22 offset:19456
  v_lshlrev_b32 v188, 16, v154
  v_and_b32 v189, 0xffff0000, v154
  v_mfma_f32_16x16x32_bf16 v[132:135], a[212:215], v[88:91], v[132:135]
  s_waitcnt lgkmcnt(4)
  v_lshlrev_b32 v190, 16, v155
  v_and_b32 v191, 0xffff0000, v155
  v_mfma_f32_16x16x32_bf16 v[128:131], a[224:227], v[92:95], v[128:131]
  ds_read_b128 v[84:87], v22 offset:20480
  v_mfma_f32_16x16x32_bf16 v[128:131], a[232:235], v[96:99], v[128:131]
HOP6:
  s_cbranch_execz HOP10
  s_mov_b32 s55, 229376
  s_add_u32 m0, s45, 36864
  v_mfma_f32_16x16x32_bf16 v[132:135], a[236:239], v[96:99], v[132:135]
  ds_read_b128 v[88:91], v22 offset:21504
  v_mfma_f32_16x16x32_bf16 v[132:135], a[228:231], v[92:95], v[132:135]
  buffer_load_dwordx4 v16, s[28:31], s55 offen lds
  v_mfma_f32_16x16x32_bf16 v[128:131], a[240:243], v[104:107], v[128:131]
  ds_read_b128 v[96:99], v22 offset:22528
  v_mfma_f32_16x16x32_bf16 v[128:131], a[248:251], v[100:103], v[128:131]
  v_mfma_f32_16x16x32_bf16 v[132:135], v[124:127], v[100:103], v[132:135]
  ds_read_b128 v[92:95], v22 offset:23552
  v_mfma_f32_16x16x32_bf16 v[132:135], a[244:247], v[104:107], v[132:135]
  s_waitcnt lgkmcnt(4)
  s_mov_b32 s55, 229376
  s_add_u32 m0, s45, 45056
  v_mfma_f32_16x16x32_bf16 v[136:139], a[0:3], v[108:111], 0
  ds_read_b128 v[100:103], v23 offset:16384
  v_mfma_f32_16x16x32_bf16 v[136:139], a[8:11], v[112:115], v[136:139]
  buffer_load_dwordx4 v16, s[32:35], s55 offen lds
  v_mfma_f32_16x16x32_bf16 v[140:143], a[12:15], v[112:115], 0
  ds_read_b128 v[104:107], v23 offset:17408
  v_fmac_f32 v184, v160, v128
  v_fmac_f32 v185, v161, v129
  v_mfma_f32_16x16x32_bf16 v[140:143], a[4:7], v[108:111], v[140:143]
  v_fmac_f32 v186, v162, v130
  v_fmac_f32 v187, v163, v131
  v_fmac_f32 v188, v164, v132
  v_mfma_f32_16x16x32_bf16 v[136:139], a[16:19], v[80:83], v[136:139]
  ds_read_b128 v[112:115], v23 offset:18432
  v_fmac_f32 v189, v165, v133
  v_fmac_f32 v190, v166, v134
  v_mfma_f32_16x16x32_bf16 v[136:139], a[24:27], v[76:79], v[136:139]
  s_add_u32 s56, s79, 12288
  v_fmac_f32 v191, v167, v135
  v_mul_f32 v128, v184, v168
  v_mul_f32 v129, v185, v169
  v_mfma_f32_16x16x32_bf16 v[140:143], a[28:31], v[76:79], v[140:143]
  ds_read_b128 v[108:111], v23 offset:19456
  v_mul_f32 v130, v186, v170
  v_mul_f32 v131, v187, v171
  v_mfma_f32_16x16x32_bf16 v[140:143], a[20:23], v[80:83], v[140:143]
  s_waitcnt lgkmcnt(4)
  buffer_load_dwordx2 v[212:213], v220, s[8:11], s56 offen sc1
  v_mul_f32 v132, v188, v172
  v_mul_f32 v133, v189, v173
  v_mfma_f32_16x16x32_bf16 v[136:139], a[32:35], v[84:87], v[136:139]
  ds_read_b128 v[76:79], v23 offset:20480
  s_add_u32 s56, s79, 36864
  v_mul_f32 v134, v190, v174
  v_mfma_f32_16x16x32_bf16 v[136:139], a[40:43], v[88:91], v[136:139]
  buffer_load_dwordx2 v[214:215], v220, s[8:11], s56 offen sc1
  v_mul_f32 v135, v191, v175
  v_cvt_pk_bf16_f32 v204, v128, v129
  v_cvt_pk_bf16_f32 v205, v130, v131
  v_mfma_f32_16x16x32_bf16 v[140:143], a[44:47], v[88:91], v[140:143]
  ds_read_b128 v[80:83], v23 offset:21504
  v_cvt_pk_bf16_f32 v206, v132, v133
  v_cvt_pk_bf16_f32 v207, v134, v135
  v_mfma_f32_16x16x32_bf16 v[140:143], a[36:39], v[84:87], v[140:143]
  s_add_u32 s56, s79, 61440
  s_add_u32 s54, s47, 36831232
  buffer_store_dwordx4 v[204:207], v1, s[8:11], s54 offen sc1
  v_mfma_f32_16x16x32_bf16 v[136:139], a[48:51], v[96:99], v[136:139]
  ds_read_b128 v[88:91], v23 offset:22528
  v_cvt_pk_bf16_f32 v152, v184, v185
  v_cvt_pk_bf16_f32 v153, v186, v187
  v_mfma_f32_16x16x32_bf16 v[136:139], a[56:59], v[92:95], v[136:139]
  buffer_load_dwordx2 v[216:217], v220, s[8:11], s56 offen sc1
  v_cvt_pk_bf16_f32 v154, v188, v189
  v_cvt_pk_bf16_f32 v155, v190, v191
  v_mfma_f32_16x16x32_bf16 v[140:143], a[60:63], v[92:95], v[140:143]
  ds_read_b128 v[84:87], v23 offset:23552
  s_add_u32 s56, s79, 86016
  v_mfma_f32_16x16x32_bf16 v[228:231], v[176:179], v[152:155], 0
  v_mfma_f32_16x16x32_bf16 v[192:195], v[152:155], v[152:155], 0
  v_mfma_f32_16x16x32_bf16 v[140:143], a[52:55], v[96:99], v[140:143]
  s_waitcnt lgkmcnt(4)
  s_waitcnt vmcnt(9)
  s_barrier
  v_mfma_f32_16x16x32_bf16 v[136:139], a[64:67], v[100:103], v[136:139]
  ds_read_b128 v[92:95], v23 offset:0
  buffer_load_dwordx2 v[218:219], v220, s[8:11], s56 offen sc1
  v_mfma_f32_16x16x32_bf16 v[136:139], a[72:75], v[104:107], v[136:139]
  s_mov_b32 s55, 0
  s_add_u32 m0, s45, 98304
  v_cndmask_b32 v192, v192, v193, s[88:89]
  v_cndmask_b32 v194, v194, v195, s[88:89]
  v_mfma_f32_16x16x32_bf16 v[140:143], a[76:79], v[104:107], v[140:143]
  ds_read_b128 v[96:99], v23 offset:1024
  v_cndmask_b32 v229, v192, v194, s[90:91]
  v_mfma_f32_16x16x32_bf16 v[140:143], a[68:71], v[100:103], v[140:143]
  buffer_load_dwordx4 v11, s[28:31], s55 offen lds
  v_mfma_f32_16x16x32_bf16 v[136:139], a[80:83], v[112:115], v[136:139]
  ds_read_b128 v[104:107], v23 offset:2048
  v_mfma_f32_16x16x32_bf16 v[136:139], a[88:91], v[108:111], v[136:139]
  v_mfma_f32_16x16x32_bf16 v[140:143], a[92:95], v[108:111], v[140:143]
  ds_read_b128 v[100:103], v23 offset:3072
  v_mfma_f32_16x16x32_bf16 v[140:143], a[84:87], v[112:115], v[140:143]
  s_waitcnt lgkmcnt(4)
  s_mov_b32 s55, 0
  s_add_u32 m0, s45, 106496
  v_mfma_f32_16x16x32_bf16 v[136:139], a[96:99], v[76:79], v[136:139]
  ds_read_b128 v[108:111], v23 offset:4096
  v_mfma_f32_16x16x32_bf16 v[136:139], a[104:107], v[80:83], v[136:139]
  buffer_load_dwordx4 v11, s[32:35], s55 offen lds
  v_mfma_f32_16x16x32_bf16 v[140:143], a[108:111], v[80:83], v[140:143]
  ds_read_b128 v[112:115], v23 offset:5120
  v_mfma_f32_16x16x32_bf16 v[140:143], a[100:103], v[76:79], v[140:143]
  v_mfma_f32_16x16x32_bf16 v[136:139], a[112:115], v[88:91], v[136:139]
  ds_read_b128 v[80:83], v23 offset:6144
  v_mfma_f32_16x16x32_bf16 v[136:139], a[120:123], v[84:87], v[136:139]
  s_mov_b32 s55, 229376
  s_add_u32 m0, s45, 102400
  v_mfma_f32_16x16x32_bf16 v[140:143], a[124:127], v[84:87], v[140:143]
  ds_read_b128 v[76:79], v23 offset:7168
  v_mfma_f32_16x16x32_bf16 v[140:143], a[116:119], v[88:91], v[140:143]
  s_waitcnt lgkmcnt(4)
  buffer_load_dwordx4 v11, s[28:31], s55 offen lds
  v_mfma_f32_16x16x32_bf16 v[136:139], a[128:131], v[92:95], v[136:139]
  ds_read_b128 v[84:87], v22 offset:0
  v_mfma_f32_16x16x32_bf16 v[136:139], a[136:139], v[96:99], v[136:139]
  v_mfma_f32_16x16x32_bf16 v[140:143], a[140:143], v[96:99], v[140:143]
  ds_read_b128 v[88:91], v22 offset:1024
  v_mfma_f32_16x16x32_bf16 v[140:143], a[132:135], v[92:95], v[140:143]
  s_mov_b32 s55, 229376
  s_add_u32 m0, s45, 110592
  v_mfma_f32_16x16x32_bf16 v[136:139], a[144:147], v[104:107], v[136:139]
  ds_read_b128 v[96:99], v22 offset:2048
  v_mfma_f32_16x16x32_bf16 v[136:139], a[152:155], v[100:103], v[136:139]
  buffer_load_dwordx4 v11, s[32:35], s55 offen lds
  v_mfma_f32_16x16x32_bf16 v[140:143], a[156:159], v[100:103], v[140:143]
  ds_read_b128 v[92:95], v22 offset:3072
  v_mfma_f32_16x16x32_bf16 v[140:143], a[148:151], v[104:107], v[140:143]
  s_waitcnt lgkmcnt(4)
  v_mfma_f32_16x16x32_bf16 v[136:139], a[160:163], v[108:111], v[136:139]
  ds_read_b128 v[100:103], v22 offset:4096
  v_mfma_f32_16x16x32_bf16 v[136:139], a[168:171], v[112:115], v[136:139]
  s_mov_b32 s55, 458752
  s_add_u32 m0, s45, 114688
  v_mfma_f32_16x16x32_bf16 v[140:143], a[172:175], v[112:115], v[140:143]
  ds_read_b128 v[104:107], v22 offset:5120
  v_mfma_f32_16x16x32_bf16 v[140:143], a[164:167], v[108:111], v[140:143]
  buffer_load_dwordx4 v11, s[28:31], s55 offen lds
  v_mfma_f32_16x16x32_bf16 v[136:139], a[176:179], v[80:83], v[136:139]
  ds_read_b128 v[112:115], v22 offset:6144
  s_waitcnt vmcnt(63) lgkmcnt(15)
  v_mfma_f32_16x16x32_bf16 v[136:139], a[184:187], v[76:79], v[136:139]
  v_lshlrev_b32 v184, 16, v156
  v_and_b32 v185, 0xffff0000, v156
  v_mfma_f32_16x16x32_bf16 v[140:143], a[188:191], v[76:79], v[140:143]
  ds_read_b128 v[108:111], v22 offset:7168
  v_lshlrev_b32 v186, 16, v157
  v_mfma_f32_16x16x32_bf16 v[140:143], a[180:183], v[80:83], v[140:143]
  s_waitcnt lgkmcnt(4)
  s_mov_b32 s55, 458752
  s_add_u32 m0, s45, 122880
  v_mfma_f32_16x16x32_bf16 v[136:139], a[192:195], v[84:87], v[136:139]
  buffer_load_dwordx4 v11, s[32:35], s55 offen lds
  v_and_b32 v187, 0xffff0000, v157
  v_lshlrev_b32 v188, 16, v158
  v_mfma_f32_16x16x32_bf16 v[136:139], a[200:203], v[88:91], v[136:139]
  v_and_b32 v189, 0xffff0000, v158
  v_lshlrev_b32 v190, 16, v159
  v_mfma_f32_16x16x32_bf16 v[140:143], a[204:207], v[88:91], v[140:143]
  v_and_b32 v191, 0xffff0000, v159
  v_mfma_f32_16x16x32_bf16 v[140:143], a[196:199], v[84:87], v[140:143]
  v_mfma_f32_16x16x32_bf16 v[136:139], a[208:211], v[96:99], v[136:139]
  v_mfma_f32_16x16x32_bf16 v[136:139], a[216:219], v[92:95], v[136:139]
  s_mov_b32 s55, 688128
  s_add_u32 m0, s45, 118784
  v_mfma_f32_16x16x32_bf16 v[140:143], a[220:223], v[92:95], v[140:143]
  buffer_load_dwordx4 v11, s[28:31], s55 offen lds
  v_mfma_f32_16x16x32_bf16 v[140:143], a[212:215], v[96:99], v[140:143]
  s_waitcnt lgkmcnt(0)
  v_mfma_f32_16x16x32_bf16 v[136:139], a[224:227], v[100:103], v[136:139]
  v_mfma_f32_16x16x32_bf16 v[136:139], a[232:235], v[104:107], v[136:139]
  v_mfma_f32_16x16x32_bf16 v[140:143], a[236:239], v[104:107], v[140:143]
  v_mfma_f32_16x16x32_bf16 v[140:143], a[228:231], v[100:103], v[140:143]
  s_mov_b32 s55, 688128
  s_add_u32 m0, s45, 126976
  v_mfma_f32_16x16x32_bf16 v[136:139], a[240:243], v[112:115], v[136:139]
  buffer_load_dwordx4 v11, s[32:35], s55 offen lds
  v_mfma_f32_16x16x32_bf16 v[136:139], a[248:251], v[108:111], v[136:139]
  v_mfma_f32_16x16x32_bf16 v[140:143], v[124:127], v[108:111], v[140:143]
  v_mfma_f32_16x16x32_bf16 v[140:143], a[244:247], v[112:115], v[140:143]
  s_nop 5
  v_fmac_f32 v184, v160, v136
  v_fmac_f32 v185, v161, v137
  v_fmac_f32 v186, v162, v138
  v_fmac_f32 v187, v163, v139
  v_fmac_f32 v188, v164, v140
  v_fmac_f32 v189, v165, v141
  v_fmac_f32 v190, v166, v142
  v_fmac_f32 v191, v167, v143
  v_mul_f32 v136, v184, v168
  v_mul_f32 v137, v185, v169
  v_mul_f32 v138, v186, v170
  v_mul_f32 v139, v187, v171
  v_mul_f32 v140, v188, v172
  v_mul_f32 v141, v189, v173
  v_mul_f32 v142, v190, v174
  v_mul_f32 v143, v191, v175
  v_cvt_pk_bf16_f32 v208, v136, v137
  v_cvt_pk_bf16_f32 v209, v138, v139
  v_cvt_pk_bf16_f32 v210, v140, v141
  v_cvt_pk_bf16_f32 v211, v142, v143
  s_add_u32 s54, s47, 36896768
  buffer_store_dwordx4 v[208:211], v1, s[8:11], s54 offen sc1
  v_cvt_pk_bf16_f32 v156, v184, v185
  v_cvt_pk_bf16_f32 v157, v186, v187
  v_cvt_pk_bf16_f32 v158, v188, v189
  v_cvt_pk_bf16_f32 v159, v190, v191
  s_nop 1
  v_mfma_f32_16x16x32_bf16 v[230:233], v[176:179], v[156:159], 0
  v_mfma_f32_16x16x32_bf16 v[192:195], v[156:159], v[156:159], 0
  s_nop 7
  v_cndmask_b32 v192, v192, v193, s[88:89]
  v_cndmask_b32 v194, v194, v195, s[88:89]
  v_cndmask_b32 v231, v192, v194, s[90:91]
  buffer_store_dwordx4 v[228:231], v180, s[8:11], s48 offen offset:256 sc1
  s_waitcnt lgkmcnt(0)
  s_and_b32 s52, s2, 7
  s_bfe_u32 s51, s2, 0x20003
  s_lshr_b32 s50, s2, 5
  s_add_u32 s56, s51, s50
  s_and_b32 s56, s56, 3
  s_lshl_b32 s53, s50, 1
  s_lshr_b32 s54, s44, 1
  s_add_u32 s53, s53, s54
  s_lshl_b32 s63, s53, 3
  s_and_b32 s55, s44, 1
  s_add_u32 s63, s63, s55
  s_lshl_b32 s57, s63, 15
  s_add_u32 s57, s57, 36700160
  s_lshl_b32 s53, s50, 12
  s_add_u32 s82, s53, 753664
  v_and_b32 v15, 31, v0
  v_lshlrev_b32 v15, 7, v15
  v_lshrrev_b32 v33, 2, v0
  v_bfe_u32 v32, v33, 1, 2
  v_lshlrev_b32 v32, 5, v32
  v_lshl_add_u32 v32, v33, 7, v32
  v_and_b32 v33, 3, v0
  v_lshl_add_u32 v2, v33, 3, v32
  v_xor_b32 v3, 32, v2
  v_xor_b32 v4, 64, v2
  v_xor_b32 v5, 96, v2
  v_add_u32 v6, 65536, v2
  v_add_u32 v7, 65536, v3
  v_add_u32 v8, 65536, v4
  s_lshl_b32 s80, s2, 7
  s_lshl_b32 s53, s44, 28
  s_add_u32 s80, s80, s53
  s_add_u32 s80, s80, 884736
  s_lshl_b32 s53, s2, 2
  s_add_u32 s53, s53, s44
  s_lshl_b32 s53, s53, 7
  s_add_u32 s81, s53, 917504
  s_sub_u32 s60, s82, 524288
  s_lshl_b32 s83, s44, 28
  s_add_u32 s83, s83, s60
  buffer_load_dword v13, v15, s[8:11], s83 offen sc1
  s_waitcnt vmcnt(11)
  v_add_f32 v212, v212, v214
  v_add_f32 v216, v216, v218
  v_add_f32 v212, v212, v216
  v_add_f32 v213, v213, v215
  v_add_f32 v217, v217, v219
  v_add_f32 v213, v213, v217
  v_lshrrev_b32 v32, 5, v0
  v_xor_b32 v33, 1, v32
  v_cvt_f32_u32 v33, v33
  v_cvt_pk_bf16_f32 v214, v212, v213
  v_lshlrev_b32 v212, 16, v214
  v_and_b32 v213, 0xffff0000, v214
  v_add_f32 v212, v212, v33
  v_add_f32 v213, v213, v33
  v_cvt_pk_bf16_f32 v214, v212, v213
  v_lshlrev_b32 v212, 16, v214
  v_and_b32 v213, 0xffff0000, v214
  v_lshrrev_b32 v215, 16, v214
  v_and_b32 v214, 0xffff, v214
  s_add_u32 s53, s45, 151552
  v_lshlrev_b32 v32, 8, v32
  v_lshl_add_u32 v32, v0, 3, v32
  v_add_u32 v32, s53, v32
  ds_write_b64 v32, v[214:215]
  ds_write_b64 v32, v[212:213] offset:256
  s_bitcmp1_b32 s2, 3
  s_cselect_b64 s[12:13], s[32:33], s[28:29]
  s_mov_b32 s14, 7340032
  s_mov_b32 s16, 0x03030303
  s_mov_b32 s17, 0x03030303
  s_mov_b32 s18, 0x0c0c0c0c
  s_mov_b32 s19, 0x0c0c0c0c
  s_mov_b32 s20, 0x30303030
  s_mov_b32 s21, 0x30303030
  s_mov_b32 s22, 0xc0c0c0c0
  s_mov_b32 s23, 0xc0c0c0c0
  s_waitcnt vmcnt(7)
  v_add_u32 v9, s46, v0
  s_waitcnt vmcnt(1)
  s_barrier
  s_mov_b64 exec, 1
  buffer_store_dword v9, v0, s[8:11], s49 offen offset:0 sc1
  s_mov_b64 exec, -1
  s_mov_b32 s55, 458752
  s_add_u32 m0, s45, 49152
  s_nop 0
  buffer_load_dwordx4 v16, s[28:31], s55 offen lds
  s_mov_b32 s55, 458752
  s_add_u32 m0, s45, 57344
  s_nop 0
  buffer_load_dwordx4 v16, s[32:35], s55 offen lds
  s_mov_b32 s55, 688128
  s_add_u32 m0, s45, 53248
  s_nop 0
  buffer_load_dwordx4 v16, s[28:31], s55 offen lds
  s_mov_b32 s55, 688128
  s_add_u32 m0, s45, 61440
  s_nop 0
  buffer_load_dwordx4 v16, s[32:35], s55 offen lds
  ds_write_b128 v182, v[144:147] offset:0
  ds_write_b128 v182, v[148:151] offset:4096
  ds_write_b128 v182, v[152:155] offset:8192
  ds_write_b128 v182, v[156:159] offset:12288
  v_mov_b32 v10, v16
  s_waitcnt vmcnt(5)
  s_cmp_lg_u32 s44, 0
  s_cbranch_scc1 PL9_adaLN_cond__sliding_local_dilated__swiglu_ffn__prompt_kernelx
  v_cmp_ne_u32 vcc, s46, v13
  s_nop 4
  s_cbranch_vccz PL9_adaLN_cond__sliding_local_dilated__swiglu_ffn__prompt_kernelx
  s_mov_b32 s83, 60000
PL9_adaLN_cond__sliding_local_dilated__swiglu_ffn__prompt_kernel:
  buffer_load_dword v13, v15, s[8:11], s60 offen sc1
  s_sub_u32 s83, s83, 1
  s_cmp_eq_u32 s83, 0
  s_waitcnt vmcnt(0)
  s_cbranch_scc1 PL9_adaLN_cond__sliding_local_dilated__swiglu_ffn__prompt_kernelx
  v_cmp_ne_u32 vcc, s46, v13
  s_nop 4
  s_cbranch_vccnz PL9_adaLN_cond__sliding_local_dilated__swiglu_ffn__prompt_kernel
PL9_adaLN_cond__sliding_local_dilated__swiglu_ffn__prompt_kernelx:
  s_barrier
  s_mov_b32 s64, 0
  s_add_u32 s72, s57, 0
  buffer_load_dwordx4 a[0:3], v1, s[8:11], s72 offen offset:0 sc1
  buffer_load_dwordx4 a[16:19], v1, s[8:11], s72 offen offset:1024 sc1
  s_add_u32 s72, s72, 65536
  buffer_load_dwordx4 a[4:7], v1, s[8:11], s72 offen offset:0 sc1
  buffer_load_dwordx4 a[20:23], v1, s[8:11], s72 offen offset:1024 sc1
  s_mov_b32 s65, 458752
  s_add_u32 s73, s57, 2048
  buffer_load_dwordx4 a[32:35], v1, s[8:11], s73 offen offset:0 sc1
  buffer_load_dwordx4 a[48:51], v1, s[8:11], s73 offen offset:1024 sc1
  s_add_u32 s73, s73, 65536
  buffer_load_dwordx4 a[36:39], v1, s[8:11], s73 offen offset:0 sc1
  buffer_load_dwordx4 a[52:55], v1, s[8:11], s73 offen offset:1024 sc1
  s_mov_b64 exec, 0
  s_cmp_eq_u32 s44, 0
  s_cbranch_scc1 HOP15
  s_cmp_eq_u32 s44, 1
  s_cbranch_scc1 HOP16
  s_cmp_eq_u32 s44, 2
  s_cbranch_scc1 HOP17
  s_cmp_eq_u32 s44, 3
  s_cbranch_scc1 HOP18
WRET1:
  s_mov_b64 exec, -1
  v_bfe_u32 v32, v0, 3, 1
  v_lshlrev_b32 v32, 9, v32
  v_and_b32 v33, 1, v0
  v_lshl_add_u32 v32, v33, 8, v32
  v_lshrrev_b32 v33, 4, v0
  v_lshl_add_u32 v32, v33, 6, v32
  v_add_u32 v14, s53, v32
  s_bfe_u32 s53, s2, 0x20004
  s_lshl_b32 s53, s53, 8
  v_and_b32 v32, 15, v0
  v_lshl_add_u32 v32, v32, 4, s53
  v_cmp_gt_u32 vcc, 896, v32
  v_mov_b32 v34, 1073741824
  v_mul_u32_u24 v33, 114688, v33
  v_cndmask_b32 v32, v34, v32, vcc
  s_lshr_b32 s53, s2, 6
  s_lshl_b32 s53, s53, 2
  s_add_u32 s53, s53, s44
  s_mul_i32 s53, s53, 458752
  s_mul_i32 s54, s52, 896
  s_add_u32 s53, s53, s54
  v_add3_u32 v13, v32, v33, s53
  ds_read_b64_tr_b16 a[160:161], v6 offset:32768
  ds_read_b64_tr_b16 a[162:163], v6 offset:34816
  ds_read_b64_tr_b16 a[164:165], v6 offset:36864
  ds_read_b64_tr_b16 a[166:167], v6 offset:38912
  ds_read_b64_tr_b16 a[168:169], v6 offset:40960
  ds_read_b64_tr_b16 a[170:171], v6 offset:43008
  ds_read_b64_tr_b16 a[172:173], v6 offset:45056
  ds_read_b64_tr_b16 a[174:175], v6 offset:47104
  ds_read_b64_tr_b16 a[176:177], v7 offset:32768
  ds_read_b64_tr_b16 a[178:179], v7 offset:34816
  ds_read_b64_tr_b16 a[180:181], v7 offset:36864
  ds_read_b64_tr_b16 a[182:183], v7 offset:38912
  ds_read_b64_tr_b16 a[188:189], v7 offset:40960
  ds_read_b64_tr_b16 a[190:191], v7 offset:43008
  ds_read_b64_tr_b16 a[192:193], v7 offset:45056
  ds_read_b64_tr_b16 a[194:195], v7 offset:47104
  s_waitcnt vmcnt(4) lgkmcnt(8)
  v_mfma_f32_16x16x32_bf16 v[64:67], a[160:163], a[0:3], 0
  ds_read_b64_tr_b16 a[196:197], v8 offset:32768
  s_mov_b32 s66, 917504
  s_add_u32 s74, s57, 4096
  s_add_u32 m0, s45, 81920
  v_mfma_f32_16x16x32_bf16 v[64:67], a[164:167], a[16:19], v[64:67]
  ds_read_b64_tr_b16 a[198:199], v8 offset:34816
  buffer_load_dwordx4 v11, s[28:31], s66 offen lds
  v_mfma_f32_16x16x32_bf16 v[68:71], a[164:167], a[20:23], 0
  ds_read_b64_tr_b16 a[200:201], v8 offset:36864
  v_mfma_f32_16x16x32_bf16 v[68:71], a[160:163], a[4:7], v[68:71]
  ds_read_b64_tr_b16 a[202:203], v8 offset:38912
  v_mfma_f32_16x16x32_bf16 v[84:87], a[168:171], a[4:7], 0
  ds_read_b64_tr_b16 a[204:205], v8 offset:40960
  s_add_u32 m0, s45, 90112
  v_mfma_f32_16x16x32_bf16 v[84:87], a[172:175], a[20:23], v[84:87]
  ds_read_b64_tr_b16 a[206:207], v8 offset:43008
  buffer_load_dwordx4 v11, s[32:35], s66 offen lds
  v_mfma_f32_16x16x32_bf16 v[80:83], a[172:175], a[16:19], 0
  ds_read_b64_tr_b16 a[208:209], v8 offset:45056
  v_mfma_f32_16x16x32_bf16 v[80:83], a[168:171], a[0:3], v[80:83]
  s_waitcnt lgkmcnt(7)
  ds_read_b64_tr_b16 a[210:211], v8 offset:47104
  v_mfma_f32_16x16x32_bf16 v[96:99], a[176:179], a[0:3], 0
  ds_read_b64_tr_b16 a[164:165], v2 offset:32768
  s_add_u32 m0, s45, 86016
  s_add_u32 s61, s66, 229376
  v_mfma_f32_16x16x32_bf16 v[96:99], a[180:183], a[16:19], v[96:99]
  ds_read_b64_tr_b16 a[166:167], v2 offset:34816
  buffer_load_dwordx4 v11, s[28:31], s61 offen lds
  v_mfma_f32_16x16x32_bf16 v[100:103], a[180:183], a[20:23], 0
  ds_read_b64_tr_b16 a[160:161], v2 offset:36864
  v_mfma_f32_16x16x32_bf16 v[100:103], a[176:179], a[4:7], v[100:103]
  ds_read_b64_tr_b16 a[162:163], v2 offset:38912
  v_mfma_f32_16x16x32_bf16 v[116:119], a[188:191], a[4:7], 0
  ds_read_b64_tr_b16 a[172:173], v2 offset:40960
  s_add_u32 m0, s45, 94208
  s_add_u32 s61, s66, 229376
  v_mfma_f32_16x16x32_bf16 v[116:119], a[192:195], a[20:23], v[116:119]
  ds_read_b64_tr_b16 a[174:175], v2 offset:43008
  buffer_load_dwordx4 v11, s[32:35], s61 offen lds
  v_mfma_f32_16x16x32_bf16 v[112:115], a[192:195], a[16:19], 0
  ds_read_b64_tr_b16 a[168:169], v2 offset:45056
  v_mfma_f32_16x16x32_bf16 v[112:115], a[188:191], a[0:3], v[112:115]
  s_waitcnt lgkmcnt(7)
  ds_read_b64_tr_b16 a[170:171], v2 offset:47104
  v_mfma_f32_16x16x32_bf16 v[32:35], a[196:199], a[0:3], 0
  ds_read_b64_tr_b16 a[180:181], v3 offset:32768
  s_add_u32 m0, s45, 16384
  v_mfma_f32_16x16x32_bf16 v[32:35], a[200:203], a[16:19], v[32:35]
  ds_read_b64_tr_b16 a[182:183], v3 offset:34816
  buffer_load_dwordx4 v10, s[28:31], s66 offen lds
  v_mfma_f32_16x16x32_bf16 v[36:39], a[200:203], a[20:23], 0
  ds_read_b64_tr_b16 a[176:177], v3 offset:36864
  v_mfma_f32_16x16x32_bf16 v[36:39], a[196:199], a[4:7], v[36:39]
  ds_read_b64_tr_b16 a[178:179], v3 offset:38912
  v_mfma_f32_16x16x32_bf16 v[52:55], a[204:207], a[4:7], 0
  ds_read_b64_tr_b16 a[192:193], v3 offset:40960
  s_add_u32 m0, s45, 24576
  v_mfma_f32_16x16x32_bf16 v[52:55], a[208:211], a[20:23], v[52:55]
  ds_read_b64_tr_b16 a[194:195], v3 offset:43008
  buffer_load_dwordx4 v10, s[32:35], s66 offen lds
  v_mfma_f32_16x16x32_bf16 v[48:51], a[208:211], a[16:19], 0
  ds_read_b64_tr_b16 a[188:189], v3 offset:45056
  s_lshl_b32 s58, s51, 12
  v_mfma_f32_16x16x32_bf16 v[48:51], a[204:207], a[0:3], v[48:51]
  s_waitcnt lgkmcnt(7)
  ds_read_b64_tr_b16 a[190:191], v3 offset:47104
  v_mfma_f32_16x16x32_bf16 v[128:131], a[164:167], a[0:3], 0
  ds_read_b64_tr_b16 a[200:201], v4 offset:32768
  s_add_u32 m0, s45, 20480
  s_add_u32 s61, s66, 229376
  v_mfma_f32_16x16x32_bf16 v[128:131], a[160:163], a[16:19], v[128:131]
  ds_read_b64_tr_b16 a[202:203], v4 offset:34816
  s_lshl_b32 s83, s44, 28
  s_add_u32 s83, s83, s82
  buffer_load_dword v9, v15, s[8:11], s83 offen sc1
  v_mfma_f32_16x16x32_bf16 v[132:135], a[160:163], a[20:23], 0
  ds_read_b64_tr_b16 a[196:197], v4 offset:36864
  buffer_load_dwordx4 v10, s[28:31], s61 offen lds
  v_mfma_f32_16x16x32_bf16 v[132:135], a[164:167], a[4:7], v[132:135]
  ds_read_b64_tr_b16 a[198:199], v4 offset:38912
  s_lshl_b32 s54, s51, 3
  v_mfma_f32_16x16x32_bf16 v[148:151], a[172:175], a[4:7], 0
  ds_read_b64_tr_b16 a[208:209], v4 offset:40960
  s_add_u32 m0, s45, 28672
  s_add_u32 s61, s66, 229376
  v_mfma_f32_16x16x32_bf16 v[148:151], a[168:171], a[20:23], v[148:151]
  ds_read_b64_tr_b16 a[210:211], v4 offset:43008
  buffer_load_dwordx4 v10, s[32:35], s61 offen lds
  v_mfma_f32_16x16x32_bf16 v[144:147], a[168:171], a[16:19], 0
  ds_read_b64_tr_b16 a[204:205], v4 offset:45056
  s_lshr_b32 s53, 0x0b070602, s54
  v_mfma_f32_16x16x32_bf16 v[144:147], a[172:175], a[0:3], v[144:147]
  s_waitcnt lgkmcnt(7)
  ds_read_b64_tr_b16 a[206:207], v4 offset:47104
  v_mfma_f32_16x16x32_bf16 v[160:163], a[180:183], a[0:3], 0
  ds_read_b64_tr_b16 a[160:161], v5 offset:32768
  v_mfma_f32_16x16x32_bf16 v[160:163], a[176:179], a[16:19], v[160:163]
  ds_read_b64_tr_b16 a[162:163], v5 offset:34816
  buffer_load_dwordx4 a[64:67], v1, s[8:11], s74 offen offset:0 sc1
  v_mfma_f32_16x16x32_bf16 v[164:167], a[176:179], a[20:23], 0
  ds_read_b64_tr_b16 a[164:165], v5 offset:36864
  s_and_b32 s53, s53, 15
  v_mfma_f32_16x16x32_bf16 v[164:167], a[180:183], a[4:7], v[164:167]
  ds_read_b64_tr_b16 a[166:167], v5 offset:38912
  s_lshl_b32 s59, s53, 10
  v_mfma_f32_16x16x32_bf16 v[180:183], a[192:195], a[4:7], 0
  ds_read_b64_tr_b16 a[168:169], v5 offset:40960
  s_lshr_b32 s53, s51, 1
  v_mfma_f32_16x16x32_bf16 v[180:183], a[188:191], a[20:23], v[180:183]
  ds_read_b64_tr_b16 a[170:171], v5 offset:43008
  buffer_load_dwordx4 a[80:83], v1, s[8:11], s74 offen offset:1024 sc1
  v_mfma_f32_16x16x32_bf16 v[176:179], a[188:191], a[16:19], 0
  ds_read_b64_tr_b16 a[172:173], v5 offset:45056
  s_mul_i32 s53, s53, 7168
  v_mfma_f32_16x16x32_bf16 v[176:179], a[192:195], a[0:3], v[176:179]
  s_waitcnt lgkmcnt(7)
  ds_read_b64_tr_b16 a[174:175], v5 offset:47104
  s_waitcnt vmcnt(19)
  s_barrier
  v_mfma_f32_16x16x32_bf16 v[192:195], a[200:203], a[0:3], 0
  ds_read_b64_tr_b16 a[176:177], v6 offset:49152
  s_add_u32 s74, s74, 65536
  v_mfma_f32_16x16x32_bf16 v[192:195], a[196:199], a[16:19], v[192:195]
  ds_read_b64_tr_b16 a[178:179], v6 offset:51200
  buffer_load_dwordx4 a[68:71], v1, s[8:11], s74 offen offset:0 sc1
  v_mfma_f32_16x16x32_bf16 v[196:199], a[196:199], a[20:23], 0
  ds_read_b64_tr_b16 a[180:181], v6 offset:53248
  s_and_b32 s54, s54, 8
  v_mfma_f32_16x16x32_bf16 v[196:199], a[200:203], a[4:7], v[196:199]
  ds_read_b64_tr_b16 a[182:183], v6 offset:55296
  s_add_u32 s53, s53, s54
  v_mfma_f32_16x16x32_bf16 v[212:215], a[208:211], a[4:7], 0
  ds_read_b64_tr_b16 a[188:189], v6 offset:57344
  s_add_u32 s60, s53, 3072
  v_mfma_f32_16x16x32_bf16 v[212:215], a[204:207], a[20:23], v[212:215]
  ds_read_b64_tr_b16 a[190:191], v6 offset:59392
  buffer_load_dwordx4 a[84:87], v1, s[8:11], s74 offen offset:1024 sc1
  v_mfma_f32_16x16x32_bf16 v[208:211], a[204:207], a[16:19], 0
  ds_read_b64_tr_b16 a[192:193], v6 offset:61440
  s_mul_i32 s53, s52, 14336
  v_mfma_f32_16x16x32_bf16 v[208:211], a[208:211], a[0:3], v[208:211]
  s_waitcnt lgkmcnt(7)
  ds_read_b64_tr_b16 a[194:195], v6 offset:63488
  v_mfma_f32_16x16x32_bf16 v[224:227], a[160:163], a[0:3], 0
  ds_read_b64_tr_b16 a[196:197], v7 offset:49152
  s_mov_b32 s67, 1376256
  s_add_u32 s75, s57, 6144
  s_add_u32 m0, s45, 65536
  v_mfma_f32_16x16x32_bf16 v[224:227], a[164:167], a[16:19], v[224:227]
  ds_read_b64_tr_b16 a[198:199], v7 offset:51200
  buffer_load_dwordx4 v11, s[28:31], s67 offen lds
  v_mfma_f32_16x16x32_bf16 v[228:231], a[164:167], a[20:23], 0
  ds_read_b64_tr_b16 a[200:201], v7 offset:53248
  s_mul_i32 s54, s63, 131072
  v_mfma_f32_16x16x32_bf16 v[228:231], a[160:163], a[4:7], v[228:231]
  ds_read_b64_tr_b16 a[202:203], v7 offset:55296
  s_add_u32 s53, s53, s54
  v_mfma_f32_16x16x32_bf16 v[244:247], a[168:171], a[4:7], 0
  ds_read_b64_tr_b16 a[204:205], v7 offset:57344
  s_add_u32 m0, s45, 73728
  v_mfma_f32_16x16x32_bf16 v[244:247], a[172:175], a[20:23], v[244:247]
  ds_read_b64_tr_b16 a[206:207], v7 offset:59392
  buffer_load_dwordx4 v11, s[32:35], s67 offen lds
  v_mfma_f32_16x16x32_bf16 v[240:243], a[172:175], a[16:19], 0
  ds_read_b64_tr_b16 a[208:209], v7 offset:61440
  s_add_u32 s53, s53, 19922944
  v_mfma_f32_16x16x32_bf16 v[240:243], a[168:171], a[0:3], v[240:243]
  s_waitcnt vmcnt(15) lgkmcnt(7)
  ds_read_b64_tr_b16 a[210:211], v7 offset:63488
  v_mfma_f32_16x16x32_bf16 v[64:67], a[176:179], a[32:35], v[64:67]
  ds_read_b64_tr_b16 a[164:165], v8 offset:49152
  s_add_u32 m0, s45, 69632
  s_add_u32 s61, s67, 229376
  v_mfma_f32_16x16x32_bf16 v[64:67], a[180:183], a[48:51], v[64:67]
  ds_read_b64_tr_b16 a[166:167], v8 offset:51200
  buffer_load_dwordx4 v11, s[28:31], s61 offen lds
  v_mfma_f32_16x16x32_bf16 v[68:71], a[180:183], a[52:55], v[68:71]
  ds_read_b64_tr_b16 a[160:161], v8 offset:53248
  s_add_u32 s58, s58, s53
  v_mfma_f32_16x16x32_bf16 v[68:71], a[176:179], a[36:39], v[68:71]
  ds_read_b64_tr_b16 a[162:163], v8 offset:55296
  s_add_u32 s59, s59, s53
  v_mfma_f32_16x16x32_bf16 v[84:87], a[188:191], a[36:39], v[84:87]
  ds_read_b64_tr_b16 a[172:173], v8 offset:57344
  s_add_u32 m0, s45, 77824
  s_add_u32 s61, s67, 229376
  v_mfma_f32_16x16x32_bf16 v[84:87], a[192:195], a[52:55], v[84:87]
  ds_read_b64_tr_b16 a[174:175], v8 offset:59392
  buffer_load_dwordx4 v11, s[32:35], s61 offen lds
HOP7:
  s_cbranch_execz HOP11
  v_mfma_f32_16x16x32_bf16 v[80:83], a[192:195], a[48:51], v[80:83]
  ds_read_b64_tr_b16 a[168:169], v8 offset:61440
  s_add_u32 s60, s60, s53
  v_mfma_f32_16x16x32_bf16 v[80:83], a[188:191], a[32:35], v[80:83]
  s_waitcnt lgkmcnt(7)
  ds_read_b64_tr_b16 a[170:171], v8 offset:63488
  v_mfma_f32_16x16x32_bf16 v[96:99], a[196:199], a[32:35], v[96:99]
  ds_read_b64_tr_b16 a[180:181], v2 offset:49152
  s_add_u32 m0, s45, 0
  v_mfma_f32_16x16x32_bf16 v[96:99], a[200:203], a[48:51], v[96:99]
  ds_read_b64_tr_b16 a[182:183], v2 offset:51200
  s_waitcnt vmcnt(10)
  s_cmp_lg_u32 s44, 0
  s_cbranch_scc1 PL10_adaLN_cond__sliding_local_dilated__swiglu_ffn__prompt_kernelx
  v_cmp_ne_u32 vcc, s46, v9
  s_nop 4
  s_cbranch_vccz PL10_adaLN_cond__sliding_local_dilated__swiglu_ffn__prompt_kernelx
  s_mov_b32 s83, 60000
PL10_adaLN_cond__sliding_local_dilated__swiglu_ffn__prompt_kernel:
  buffer_load_dword v9, v15, s[8:11], s82 offen sc1
  s_sub_u32 s83, s83, 1
  s_cmp_eq_u32 s83, 0
  s_waitcnt vmcnt(0)
  s_cbranch_scc1 PL10_adaLN_cond__sliding_local_dilated__swiglu_ffn__prompt_kernelx
  v_cmp_ne_u32 vcc, s46, v9
  s_nop 4
  s_cbranch_vccnz PL10_adaLN_cond__sliding_local_dilated__swiglu_ffn__prompt_kernel
PL10_adaLN_cond__sliding_local_dilated__swiglu_ffn__prompt_kernelx:
  s_barrier
  v_mfma_f32_16x16x32_bf16 v[100:103], a[200:203], a[52:55], v[100:103]
  ds_read_b64_tr_b16 a[176:177], v2 offset:53248
  buffer_load_dwordx4 v10, s[28:31], s67 offen lds
  v_mfma_f32_16x16x32_bf16 v[100:103], a[196:199], a[36:39], v[100:103]
  ds_read_b64_tr_b16 a[178:179], v2 offset:55296
  s_lshl_b32 s63, s50, 2
  v_mfma_f32_16x16x32_bf16 v[116:119], a[204:207], a[36:39], v[116:119]
  ds_read_b64_tr_b16 a[192:193], v2 offset:57344
  s_add_u32 m0, s45, 8192
  v_mfma_f32_16x16x32_bf16 v[116:119], a[208:211], a[52:55], v[116:119]
  ds_read_b64_tr_b16 a[194:195], v2 offset:59392
  buffer_load_dwordx4 v10, s[32:35], s67 offen lds
  v_mfma_f32_16x16x32_bf16 v[112:115], a[208:211], a[48:51], v[112:115]
  ds_read_b64_tr_b16 a[188:189], v2 offset:61440
  s_add_u32 s63, s63, s44
  v_mfma_f32_16x16x32_bf16 v[112:115], a[204:207], a[32:35], v[112:115]
  s_waitcnt lgkmcnt(7)
  ds_read_b64_tr_b16 a[190:191], v2 offset:63488
  v_mfma_f32_16x16x32_bf16 v[32:35], a[164:167], a[32:35], v[32:35]
  ds_read_b64_tr_b16 a[200:201], v3 offset:49152
  s_add_u32 m0, s45, 4096
  s_add_u32 s61, s67, 229376
  v_mfma_f32_16x16x32_bf16 v[32:35], a[160:163], a[48:51], v[32:35]
  ds_read_b64_tr_b16 a[202:203], v3 offset:51200
  buffer_load_dwordx4 v10, s[28:31], s61 offen lds
  v_mfma_f32_16x16x32_bf16 v[36:39], a[160:163], a[52:55], v[36:39]
  ds_read_b64_tr_b16 a[196:197], v3 offset:53248
  s_lshl_b32 s63, s63, 14
  v_mfma_f32_16x16x32_bf16 v[36:39], a[164:167], a[36:39], v[36:39]
  ds_read_b64_tr_b16 a[198:199], v3 offset:55296
  s_add_u32 s63, s63, 6291456
  v_mfma_f32_16x16x32_bf16 v[52:55], a[172:175], a[36:39], v[52:55]
  ds_read_b64_tr_b16 a[208:209], v3 offset:57344
  s_add_u32 m0, s45, 12288
  s_add_u32 s61, s67, 229376
  v_mfma_f32_16x16x32_bf16 v[52:55], a[168:171], a[52:55], v[52:55]
  ds_read_b64_tr_b16 a[210:211], v3 offset:59392
  buffer_load_dwordx4 v10, s[32:35], s61 offen lds
  v_mfma_f32_16x16x32_bf16 v[48:51], a[168:171], a[48:51], v[48:51]
  ds_read_b64_tr_b16 a[204:205], v3 offset:61440
  v_and_b32 v12, 0x300, v1
  v_mfma_f32_16x16x32_bf16 v[48:51], a[172:175], a[32:35], v[48:51]
  s_waitcnt lgkmcnt(7)
  ds_read_b64_tr_b16 a[206:207], v3 offset:63488
  v_mfma_f32_16x16x32_bf16 v[128:131], a[180:183], a[32:35], v[128:131]
  ds_read_b64_tr_b16 a[160:161], v4 offset:49152
  s_add_u32 s72, s72, 65536
  v_mfma_f32_16x16x32_bf16 v[128:131], a[176:179], a[48:51], v[128:131]
  ds_read_b64_tr_b16 a[162:163], v4 offset:51200
  buffer_load_dwordx4 a[8:11], v1, s[8:11], s72 offen offset:0 sc1
  v_mfma_f32_16x16x32_bf16 v[132:135], a[176:179], a[52:55], v[132:135]
  ds_read_b64_tr_b16 a[164:165], v4 offset:53248
  v_add_u32 v12, v12, v1
  v_mfma_f32_16x16x32_bf16 v[132:135], a[180:183], a[36:39], v[132:135]
  ds_read_b64_tr_b16 a[166:167], v4 offset:55296
  buffer_load_dwordx4 a[24:27], v1, s[8:11], s72 offen offset:1024 sc1
  v_mfma_f32_16x16x32_bf16 v[148:151], a[192:195], a[36:39], v[148:151]
  ds_read_b64_tr_b16 a[168:169], v4 offset:57344
  s_add_u32 s72, s72, 65536
  v_mfma_f32_16x16x32_bf16 v[148:151], a[188:191], a[52:55], v[148:151]
  ds_read_b64_tr_b16 a[170:171], v4 offset:59392
  buffer_load_dwordx4 a[12:15], v1, s[8:11], s72 offen offset:0 sc1
  v_mfma_f32_16x16x32_bf16 v[144:147], a[188:191], a[48:51], v[144:147]
  ds_read_b64_tr_b16 a[172:173], v4 offset:61440
  v_mfma_f32_16x16x32_bf16 v[144:147], a[192:195], a[32:35], v[144:147]
  s_waitcnt lgkmcnt(7)
  ds_read_b64_tr_b16 a[174:175], v4 offset:63488
  buffer_load_dwordx4 a[28:31], v1, s[8:11], s72 offen offset:1024 sc1
  v_mfma_f32_16x16x32_bf16 v[160:163], a[200:203], a[32:35], v[160:163]
  ds_read_b64_tr_b16 a[176:177], v5 offset:49152
  s_add_u32 s73, s73, 65536
  v_mfma_f32_16x16x32_bf16 v[160:163], a[196:199], a[48:51], v[160:163]
  ds_read_b64_tr_b16 a[178:179], v5 offset:51200
  buffer_load_dwordx4 a[40:43], v1, s[8:11], s73 offen offset:0 sc1
  v_mfma_f32_16x16x32_bf16 v[164:167], a[196:199], a[52:55], v[164:167]
  ds_read_b64_tr_b16 a[180:181], v5 offset:53248
  v_mfma_f32_16x16x32_bf16 v[164:167], a[200:203], a[36:39], v[164:167]
  ds_read_b64_tr_b16 a[182:183], v5 offset:55296
  buffer_load_dwordx4 a[56:59], v1, s[8:11], s73 offen offset:1024 sc1
  v_mfma_f32_16x16x32_bf16 v[180:183], a[208:211], a[36:39], v[180:183]
  ds_read_b64_tr_b16 a[188:189], v5 offset:57344
  s_add_u32 s73, s73, 65536
  v_mfma_f32_16x16x32_bf16 v[180:183], a[204:207], a[52:55], v[180:183]
  ds_read_b64_tr_b16 a[190:191], v5 offset:59392
  buffer_load_dwordx4 a[44:47], v1, s[8:11], s73 offen offset:0 sc1
  v_mfma_f32_16x16x32_bf16 v[176:179], a[204:207], a[48:51], v[176:179]
  ds_read_b64_tr_b16 a[192:193], v5 offset:61440
  v_mfma_f32_16x16x32_bf16 v[176:179], a[208:211], a[32:35], v[176:179]
  s_waitcnt lgkmcnt(7)
  ds_read_b64_tr_b16 a[194:195], v5 offset:63488
  buffer_load_dwordx4 a[60:63], v1, s[8:11], s73 offen offset:1024 sc1
  v_mfma_f32_16x16x32_bf16 v[192:195], a[160:163], a[32:35], v[192:195]
  ds_read_b64_tr_b16 a[196:197], v6 offset:32768
  s_add_u32 s74, s74, 65536
  v_mfma_f32_16x16x32_bf16 v[192:195], a[164:167], a[48:51], v[192:195]
  ds_read_b64_tr_b16 a[198:199], v6 offset:34816
  buffer_load_dwordx4 a[72:75], v1, s[8:11], s74 offen offset:0 sc1
  v_mfma_f32_16x16x32_bf16 v[196:199], a[164:167], a[52:55], v[196:199]
  ds_read_b64_tr_b16 a[200:201], v6 offset:36864
  v_mfma_f32_16x16x32_bf16 v[196:199], a[160:163], a[36:39], v[196:199]
  ds_read_b64_tr_b16 a[202:203], v6 offset:38912
  v_mfma_f32_16x16x32_bf16 v[212:215], a[168:171], a[36:39], v[212:215]
  ds_read_b64_tr_b16 a[204:205], v6 offset:40960
  s_mov_b32 s62, 0
  v_mfma_f32_16x16x32_bf16 v[212:215], a[172:175], a[52:55], v[212:215]
  ds_read_b64_tr_b16 a[206:207], v6 offset:43008
  buffer_load_dwordx4 a[220:223], v13, s[12:15], s62 offen
  v_mfma_f32_16x16x32_bf16 v[208:211], a[172:175], a[48:51], v[208:211]
  ds_read_b64_tr_b16 a[208:209], v6 offset:45056
  s_mov_b32 s62, 7168
  v_mfma_f32_16x16x32_bf16 v[208:211], a[168:171], a[32:35], v[208:211]
  s_waitcnt lgkmcnt(7)
  ds_read_b64_tr_b16 a[210:211], v6 offset:47104
  buffer_load_dwordx4 a[224:227], v13, s[12:15], s62 offen
  v_mfma_f32_16x16x32_bf16 v[224:227], a[176:179], a[32:35], v[224:227]
  ds_read_b64_tr_b16 a[164:165], v7 offset:32768
  s_mov_b32 s62, 14336
  v_mfma_f32_16x16x32_bf16 v[224:227], a[180:183], a[48:51], v[224:227]
  ds_read_b64_tr_b16 a[166:167], v7 offset:34816
  buffer_load_dwordx4 a[228:231], v13, s[12:15], s62 offen
  s_mov_b32 s62, 21504
  v_mfma_f32_16x16x32_bf16 v[228:231], a[180:183], a[52:55], v[228:231]
  ds_read_b64_tr_b16 a[160:161], v7 offset:36864
  buffer_load_dwordx4 a[232:235], v13, s[12:15], s62 offen
  v_mfma_f32_16x16x32_bf16 v[228:231], a[176:179], a[36:39], v[228:231]
  ds_read_b64_tr_b16 a[162:163], v7 offset:38912
  v_mfma_f32_16x16x32_bf16 v[244:247], a[188:191], a[36:39], v[244:247]
  ds_read_b64_tr_b16 a[172:173], v7 offset:40960
  v_mfma_f32_16x16x32_bf16 v[244:247], a[192:195], a[52:55], v[244:247]
  ds_read_b64_tr_b16 a[174:175], v7 offset:43008
  v_mfma_f32_16x16x32_bf16 v[240:243], a[192:195], a[48:51], v[240:243]
  ds_read_b64_tr_b16 a[168:169], v7 offset:45056
  v_mfma_f32_16x16x32_bf16 v[240:243], a[188:191], a[32:35], v[240:243]
  s_waitcnt vmcnt(9) lgkmcnt(7)
  ds_read_b64_tr_b16 a[170:171], v7 offset:47104
  v_mfma_f32_16x16x32_bf16 v[72:75], a[196:199], a[8:11], 0
  ds_read_b64_tr_b16 a[180:181], v8 offset:32768
  v_mfma_f32_16x16x32_bf16 v[72:75], a[200:203], a[24:27], v[72:75]
  ds_read_b64_tr_b16 a[182:183], v8 offset:34816
  v_mfma_f32_16x16x32_bf16 v[76:79], a[200:203], a[28:31], 0
  ds_read_b64_tr_b16 a[176:177], v8 offset:36864
  v_mfma_f32_16x16x32_bf16 v[76:79], a[196:199], a[12:15], v[76:79]
  ds_read_b64_tr_b16 a[178:179], v8 offset:38912
  v_mfma_f32_16x16x32_bf16 v[92:95], a[204:207], a[12:15], 0
  ds_read_b64_tr_b16 a[192:193], v8 offset:40960
  v_mfma_f32_16x16x32_bf16 v[92:95], a[208:211], a[28:31], v[92:95]
  ds_read_b64_tr_b16 a[194:195], v8 offset:43008
  v_mfma_f32_16x16x32_bf16 v[88:91], a[208:211], a[24:27], 0
  ds_read_b64_tr_b16 a[188:189], v8 offset:45056
  v_mfma_f32_16x16x32_bf16 v[88:91], a[204:207], a[8:11], v[88:91]
  s_waitcnt lgkmcnt(7)
  ds_read_b64_tr_b16 a[190:191], v8 offset:47104
  v_mfma_f32_16x16x32_bf16 v[104:107], a[164:167], a[8:11], 0
  ds_read_b64_tr_b16 a[200:201], v2 offset:32768
  v_mfma_f32_16x16x32_bf16 v[104:107], a[160:163], a[24:27], v[104:107]
  ds_read_b64_tr_b16 a[202:203], v2 offset:34816
  v_mfma_f32_16x16x32_bf16 v[108:111], a[160:163], a[28:31], 0
  ds_read_b64_tr_b16 a[196:197], v2 offset:36864
  v_mfma_f32_16x16x32_bf16 v[108:111], a[164:167], a[12:15], v[108:111]
  ds_read_b64_tr_b16 a[198:199], v2 offset:38912
  v_mfma_f32_16x16x32_bf16 v[124:127], a[172:175], a[12:15], 0
  ds_read_b64_tr_b16 a[208:209], v2 offset:40960
  v_mfma_f32_16x16x32_bf16 v[124:127], a[168:171], a[28:31], v[124:127]
  ds_read_b64_tr_b16 a[210:211], v2 offset:43008
  v_mfma_f32_16x16x32_bf16 v[120:123], a[168:171], a[24:27], 0
  ds_read_b64_tr_b16 a[204:205], v2 offset:45056
  v_mfma_f32_16x16x32_bf16 v[120:123], a[172:175], a[8:11], v[120:123]
  s_waitcnt lgkmcnt(7)
  ds_read_b64_tr_b16 a[206:207], v2 offset:47104
  v_mfma_f32_16x16x32_bf16 v[40:43], a[180:183], a[8:11], 0
  ds_read_b64_tr_b16 a[160:161], v3 offset:32768
  v_mfma_f32_16x16x32_bf16 v[40:43], a[176:179], a[24:27], v[40:43]
  ds_read_b64_tr_b16 a[162:163], v3 offset:34816
  v_mfma_f32_16x16x32_bf16 v[44:47], a[176:179], a[28:31], 0
  ds_read_b64_tr_b16 a[164:165], v3 offset:36864
  buffer_load_dwordx4 a[88:91], v1, s[8:11], s74 offen offset:1024 sc1
  v_mfma_f32_16x16x32_bf16 v[44:47], a[180:183], a[12:15], v[44:47]
  ds_read_b64_tr_b16 a[166:167], v3 offset:38912
  v_mfma_f32_16x16x32_bf16 v[60:63], a[192:195], a[12:15], 0
  ds_read_b64_tr_b16 a[168:169], v3 offset:40960
  v_mfma_f32_16x16x32_bf16 v[60:63], a[188:191], a[28:31], v[60:63]
  ds_read_b64_tr_b16 a[170:171], v3 offset:43008
  v_mfma_f32_16x16x32_bf16 v[56:59], a[188:191], a[24:27], 0
  ds_read_b64_tr_b16 a[172:173], v3 offset:45056
  s_add_u32 s74, s74, 65536
  v_mfma_f32_16x16x32_bf16 v[56:59], a[192:195], a[8:11], v[56:59]
  s_waitcnt lgkmcnt(7)
  ds_read_b64_tr_b16 a[174:175], v3 offset:47104
  v_mfma_f32_16x16x32_bf16 v[136:139], a[200:203], a[8:11], 0
  ds_read_b64_tr_b16 a[176:177], v4 offset:32768
  buffer_load_dwordx4 a[76:79], v1, s[8:11], s74 offen offset:0 sc1
  v_mfma_f32_16x16x32_bf16 v[136:139], a[196:199], a[24:27], v[136:139]
  ds_read_b64_tr_b16 a[178:179], v4 offset:34816
  v_mfma_f32_16x16x32_bf16 v[140:143], a[196:199], a[28:31], 0
  ds_read_b64_tr_b16 a[180:181], v4 offset:36864
  v_mfma_f32_16x16x32_bf16 v[140:143], a[200:203], a[12:15], v[140:143]
  ds_read_b64_tr_b16 a[182:183], v4 offset:38912
  v_mfma_f32_16x16x32_bf16 v[156:159], a[208:211], a[12:15], 0
  ds_read_b64_tr_b16 a[188:189], v4 offset:40960
  buffer_load_dwordx4 a[92:95], v1, s[8:11], s74 offen offset:1024 sc1
  v_mfma_f32_16x16x32_bf16 v[156:159], a[204:207], a[28:31], v[156:159]
  ds_read_b64_tr_b16 a[190:191], v4 offset:43008
  v_mfma_f32_16x16x32_bf16 v[152:155], a[204:207], a[24:27], 0
  ds_read_b64_tr_b16 a[192:193], v4 offset:45056
  v_mfma_f32_16x16x32_bf16 v[152:155], a[208:211], a[8:11], v[152:155]
  s_waitcnt lgkmcnt(7)
  ds_read_b64_tr_b16 a[194:195], v4 offset:47104
  v_mfma_f32_16x16x32_bf16 v[168:171], a[160:163], a[8:11], 0
  ds_read_b64_tr_b16 a[196:197], v5 offset:32768
  v_mfma_f32_16x16x32_bf16 v[168:171], a[164:167], a[24:27], v[168:171]
  ds_read_b64_tr_b16 a[198:199], v5 offset:34816
  buffer_load_dwordx4 a[96:99], v1, s[8:11], s75 offen offset:0 sc1
  v_mfma_f32_16x16x32_bf16 v[172:175], a[164:167], a[28:31], 0
  ds_read_b64_tr_b16 a[200:201], v5 offset:36864
  v_mfma_f32_16x16x32_bf16 v[172:175], a[160:163], a[12:15], v[172:175]
  ds_read_b64_tr_b16 a[202:203], v5 offset:38912
  v_mfma_f32_16x16x32_bf16 v[188:191], a[168:171], a[12:15], 0
  ds_read_b64_tr_b16 a[204:205], v5 offset:40960
  v_mfma_f32_16x16x32_bf16 v[188:191], a[172:175], a[28:31], v[188:191]
  ds_read_b64_tr_b16 a[206:207], v5 offset:43008
  v_mfma_f32_16x16x32_bf16 v[184:187], a[172:175], a[24:27], 0
  ds_read_b64_tr_b16 a[208:209], v5 offset:45056
  buffer_load_dwordx4 a[112:115], v1, s[8:11], s75 offen offset:1024 sc1
  v_mfma_f32_16x16x32_bf16 v[184:187], a[168:171], a[8:11], v[184:187]
  s_waitcnt lgkmcnt(7)
  ds_read_b64_tr_b16 a[210:211], v5 offset:47104
  v_mfma_f32_16x16x32_bf16 v[200:203], a[176:179], a[8:11], 0
  ds_read_b64_tr_b16 a[164:165], v6 offset:49152
  v_mfma_f32_16x16x32_bf16 v[200:203], a[180:183], a[24:27], v[200:203]
  ds_read_b64_tr_b16 a[166:167], v6 offset:51200
  v_mfma_f32_16x16x32_bf16 v[204:207], a[180:183], a[28:31], 0
  ds_read_b64_tr_b16 a[160:161], v6 offset:53248
  s_add_u32 s75, s75, 65536
  v_mfma_f32_16x16x32_bf16 v[204:207], a[176:179], a[12:15], v[204:207]
  ds_read_b64_tr_b16 a[162:163], v6 offset:55296
  buffer_load_dwordx4 a[100:103], v1, s[8:11], s75 offen offset:0 sc1
  v_mfma_f32_16x16x32_bf16 v[220:223], a[188:191], a[12:15], 0
  ds_read_b64_tr_b16 a[172:173], v6 offset:57344
  v_mfma_f32_16x16x32_bf16 v[220:223], a[192:195], a[28:31], v[220:223]
  ds_read_b64_tr_b16 a[174:175], v6 offset:59392
  v_mfma_f32_16x16x32_bf16 v[216:219], a[192:195], a[24:27], 0
  ds_read_b64_tr_b16 a[168:169], v6 offset:61440
  v_mfma_f32_16x16x32_bf16 v[216:219], a[188:191], a[8:11], v[216:219]
  s_waitcnt lgkmcnt(7)
  ds_read_b64_tr_b16 a[170:171], v6 offset:63488
  v_mfma_f32_16x16x32_bf16 v[232:235], a[196:199], a[8:11], 0
  ds_read_b64_tr_b16 a[180:181], v7 offset:49152
  buffer_load_dwordx4 a[116:119], v1, s[8:11], s75 offen offset:1024 sc1
  v_mfma_f32_16x16x32_bf16 v[232:235], a[200:203], a[24:27], v[232:235]
  ds_read_b64_tr_b16 a[182:183], v7 offset:51200
  v_mfma_f32_16x16x32_bf16 v[236:239], a[200:203], a[28:31], 0
  ds_read_b64_tr_b16 a[176:177], v7 offset:53248
  v_mfma_f32_16x16x32_bf16 v[236:239], a[196:199], a[12:15], v[236:239]
  ds_read_b64_tr_b16 a[178:179], v7 offset:55296
  s_add_u32 s75, s75, 65536
  v_mfma_f32_16x16x32_bf16 v[252:255], a[204:207], a[12:15], 0
  ds_read_b64_tr_b16 a[192:193], v7 offset:57344
  s_barrier
  v_mfma_f32_16x16x32_bf16 v[252:255], a[208:211], a[28:31], v[252:255]
  ds_read_b64_tr_b16 a[194:195], v7 offset:59392
  buffer_load_dwordx4 a[104:107], v1, s[8:11], s75 offen offset:0 sc1
  v_mfma_f32_16x16x32_bf16 v[248:251], a[208:211], a[24:27], 0
  ds_read_b64_tr_b16 a[188:189], v7 offset:61440
  v_mfma_f32_16x16x32_bf16 v[248:251], a[204:207], a[8:11], v[248:251]
  s_waitcnt vmcnt(13) lgkmcnt(7)
  ds_read_b64_tr_b16 a[190:191], v7 offset:63488
  v_mfma_f32_16x16x32_bf16 v[72:75], a[164:167], a[40:43], v[72:75]
  ds_read_b64_tr_b16 a[200:201], v8 offset:49152
  v_mfma_f32_16x16x32_bf16 v[72:75], a[160:163], a[56:59], v[72:75]
  ds_read_b64_tr_b16 a[202:203], v8 offset:51200
  v_mfma_f32_16x16x32_bf16 v[76:79], a[160:163], a[60:63], v[76:79]
  ds_read_b64_tr_b16 a[196:197], v8 offset:53248
  buffer_load_dwordx4 a[120:123], v1, s[8:11], s75 offen offset:1024 sc1
  v_mfma_f32_16x16x32_bf16 v[76:79], a[164:167], a[44:47], v[76:79]
  ds_read_b64_tr_b16 a[198:199], v8 offset:55296
  v_mfma_f32_16x16x32_bf16 v[92:95], a[172:175], a[44:47], v[92:95]
  ds_read_b64_tr_b16 a[208:209], v8 offset:57344
  v_mfma_f32_16x16x32_bf16 v[92:95], a[168:171], a[60:63], v[92:95]
  ds_read_b64_tr_b16 a[210:211], v8 offset:59392
  v_mfma_f32_16x16x32_bf16 v[88:91], a[168:171], a[56:59], v[88:91]
  ds_read_b64_tr_b16 a[204:205], v8 offset:61440
  s_mov_b32 s62, 28672
  v_mfma_f32_16x16x32_bf16 v[88:91], a[172:175], a[40:43], v[88:91]
  s_waitcnt lgkmcnt(7)
  ds_read_b64_tr_b16 a[206:207], v8 offset:63488
  buffer_load_dwordx4 a[236:239], v13, s[12:15], s62 offen
  v_mfma_f32_16x16x32_bf16 v[104:107], a[180:183], a[40:43], v[104:107]
  ds_read_b64_tr_b16 a[160:161], v2 offset:49152
  s_mov_b32 s62, 35840
  v_mfma_f32_16x16x32_bf16 v[104:107], a[176:179], a[56:59], v[104:107]
  ds_read_b64_tr_b16 a[162:163], v2 offset:51200
  buffer_load_dwordx4 a[240:243], v13, s[12:15], s62 offen
  v_mfma_f32_16x16x32_bf16 v[108:111], a[176:179], a[60:63], v[108:111]
  ds_read_b64_tr_b16 a[164:165], v2 offset:53248
  s_mov_b32 s62, 43008
  v_mfma_f32_16x16x32_bf16 v[108:111], a[180:183], a[44:47], v[108:111]
  ds_read_b64_tr_b16 a[166:167], v2 offset:55296
  buffer_load_dwordx4 a[244:247], v13, s[12:15], s62 offen
  v_mfma_f32_16x16x32_bf16 v[124:127], a[192:195], a[44:47], v[124:127]
  ds_read_b64_tr_b16 a[168:169], v2 offset:57344
  s_mov_b32 s62, 50176
  v_mfma_f32_16x16x32_bf16 v[124:127], a[188:191], a[60:63], v[124:127]
  ds_read_b64_tr_b16 a[170:171], v2 offset:59392
  buffer_load_dwordx4 a[248:251], v13, s[12:15], s62 offen
  v_mfma_f32_16x16x32_bf16 v[120:123], a[188:191], a[56:59], v[120:123]
  ds_read_b64_tr_b16 a[172:173], v2 offset:61440
  v_mfma_f32_16x16x32_bf16 v[120:123], a[192:195], a[40:43], v[120:123]
  s_waitcnt lgkmcnt(7)
  ds_read_b64_tr_b16 a[174:175], v2 offset:63488
  v_mfma_f32_16x16x32_bf16 v[40:43], a[200:203], a[40:43], v[40:43]
  ds_read_b64_tr_b16 a[176:177], v3 offset:49152
  v_mfma_f32_16x16x32_bf16 v[40:43], a[196:199], a[56:59], v[40:43]
  ds_read_b64_tr_b16 a[178:179], v3 offset:51200
  v_mfma_f32_16x16x32_bf16 v[44:47], a[196:199], a[60:63], v[44:47]
  ds_read_b64_tr_b16 a[180:181], v3 offset:53248
  v_mfma_f32_16x16x32_bf16 v[44:47], a[200:203], a[44:47], v[44:47]
  ds_read_b64_tr_b16 a[182:183], v3 offset:55296
  v_mfma_f32_16x16x32_bf16 v[60:63], a[208:211], a[44:47], v[60:63]
  ds_read_b64_tr_b16 a[188:189], v3 offset:57344
  v_mfma_f32_16x16x32_bf16 v[60:63], a[204:207], a[60:63], v[60:63]
  ds_read_b64_tr_b16 a[190:191], v3 offset:59392
  v_mfma_f32_16x16x32_bf16 v[56:59], a[204:207], a[56:59], v[56:59]
  ds_read_b64_tr_b16 a[192:193], v3 offset:61440
  v_mfma_f32_16x16x32_bf16 v[56:59], a[208:211], a[40:43], v[56:59]
  s_waitcnt lgkmcnt(7)
  ds_read_b64_tr_b16 a[194:195], v3 offset:63488
  v_mfma_f32_16x16x32_bf16 v[136:139], a[160:163], a[40:43], v[136:139]
  ds_read_b64_tr_b16 a[196:197], v4 offset:49152
  v_mfma_f32_16x16x32_bf16 v[136:139], a[164:167], a[56:59], v[136:139]
  ds_read_b64_tr_b16 a[198:199], v4 offset:51200
  v_mfma_f32_16x16x32_bf16 v[140:143], a[164:167], a[60:63], v[140:143]
  ds_read_b64_tr_b16 a[200:201], v4 offset:53248
  v_mfma_f32_16x16x32_bf16 v[140:143], a[160:163], a[44:47], v[140:143]
  ds_read_b64_tr_b16 a[202:203], v4 offset:55296
  v_mfma_f32_16x16x32_bf16 v[156:159], a[168:171], a[44:47], v[156:159]
  ds_read_b64_tr_b16 a[204:205], v4 offset:57344
  v_mfma_f32_16x16x32_bf16 v[156:159], a[172:175], a[60:63], v[156:159]
  ds_read_b64_tr_b16 a[206:207], v4 offset:59392
  v_mfma_f32_16x16x32_bf16 v[152:155], a[172:175], a[56:59], v[152:155]
  ds_read_b64_tr_b16 a[208:209], v4 offset:61440
  v_mfma_f32_16x16x32_bf16 v[152:155], a[168:171], a[40:43], v[152:155]
  s_waitcnt lgkmcnt(7)
  ds_read_b64_tr_b16 a[210:211], v4 offset:63488
  v_mfma_f32_16x16x32_bf16 v[168:171], a[176:179], a[40:43], v[168:171]
  ds_read_b64_tr_b16 a[164:165], v5 offset:49152
  ds_read_b128 v[24:27], v14 offset:0
  v_mfma_f32_16x16x32_bf16 v[168:171], a[180:183], a[56:59], v[168:171]
  ds_read_b64_tr_b16 a[166:167], v5 offset:51200
  v_mfma_f32_16x16x32_bf16 v[172:175], a[180:183], a[60:63], v[172:175]
  ds_read_b64_tr_b16 a[160:161], v5 offset:53248
  v_mfma_f32_16x16x32_bf16 v[172:175], a[176:179], a[44:47], v[172:175]
  ds_read_b64_tr_b16 a[162:163], v5 offset:55296
  v_mfma_f32_16x16x32_bf16 v[188:191], a[188:191], a[44:47], v[188:191]
  ds_read_b64_tr_b16 a[172:173], v5 offset:57344
  v_mfma_f32_16x16x32_bf16 v[188:191], a[192:195], a[60:63], v[188:191]
  ds_read_b64_tr_b16 a[174:175], v5 offset:59392
  s_waitcnt vmcnt(38)
  s_barrier
  v_mfma_f32_16x16x32_bf16 v[184:187], a[192:195], a[56:59], v[184:187]
  ds_read_b64_tr_b16 a[168:169], v5 offset:61440
  ds_read_b64_tr_b16 a[180:181], v6 offset:16384
  v_mfma_f32_16x16x32_bf16 v[184:187], a[188:191], a[40:43], v[184:187]
  s_waitcnt lgkmcnt(9)
  ds_read_b64_tr_b16 a[170:171], v5 offset:63488
  v_mfma_f32_16x16x32_bf16 v[200:203], a[196:199], a[40:43], v[200:203]
  ds_read_b64_tr_b16 a[182:183], v6 offset:18432
  s_waitcnt vmcnt(13) lgkmcnt(9)
  v_mfma_f32_16x16x32_bf16 v[200:203], a[200:203], a[56:59], v[200:203]
  s_add_u32 s75, s75, 65536
  v_cndmask_b32 v28, 0, v24, s[16:17]
  v_cndmask_b32 v29, 0, v24, s[18:19]
  v_mfma_f32_16x16x32_bf16 v[204:207], a[200:203], a[60:63], v[204:207]
  ds_read_b64_tr_b16 a[176:177], v6 offset:20480
  v_cndmask_b32 v30, 0, v24, s[20:21]
  v_mfma_f32_16x16x32_bf16 v[204:207], a[196:199], a[44:47], v[204:207]
  buffer_load_dwordx4 a[108:111], v1, s[8:11], s75 offen offset:0 sc1
  v_cndmask_b32 v31, 0, v24, s[22:23]
  v_mfma_f32_16x16x32_bf16 v[220:223], a[204:207], a[44:47], v[220:223]
  ds_read_b64_tr_b16 a[178:179], v6 offset:22528
  v_mfma_f32_16x16x32_bf16 a[184:187], v[28:31], a[220:223], 0
  v_cndmask_b32 v28, 0, v25, s[16:17]
  v_cndmask_b32 v29, 0, v25, s[18:19]
  v_mfma_f32_16x16x32_bf16 v[220:223], a[208:211], a[60:63], v[220:223]
  v_cndmask_b32 v30, 0, v25, s[20:21]
  v_cndmask_b32 v31, 0, v25, s[22:23]
  v_mfma_f32_16x16x32_bf16 v[216:219], a[208:211], a[56:59], v[216:219]
  ds_read_b64_tr_b16 a[192:193], v6 offset:24576
  v_mfma_f32_16x16x32_bf16 a[184:187], v[28:31], a[224:227], a[184:187]
  v_cndmask_b32 v28, 0, v26, s[16:17]
  v_cndmask_b32 v29, 0, v26, s[18:19]
  v_mfma_f32_16x16x32_bf16 v[216:219], a[204:207], a[40:43], v[216:219]
  s_waitcnt lgkmcnt(4)
  v_cndmask_b32 v30, 0, v26, s[20:21]
  v_cndmask_b32 v31, 0, v26, s[22:23]
  v_mfma_f32_16x16x32_bf16 v[232:235], a[164:167], a[40:43], v[232:235]
  ds_read_b64_tr_b16 a[194:195], v6 offset:26624
  v_mfma_f32_16x16x32_bf16 a[184:187], v[28:31], a[228:231], a[184:187]
  v_cndmask_b32 v28, 0, v27, s[16:17]
  v_cndmask_b32 v29, 0, v27, s[18:19]
  v_mfma_f32_16x16x32_bf16 v[232:235], a[160:163], a[56:59], v[232:235]
  buffer_load_dwordx4 a[124:127], v1, s[8:11], s75 offen offset:1024 sc1
  v_cndmask_b32 v30, 0, v27, s[20:21]
  v_cndmask_b32 v31, 0, v27, s[22:23]
  v_mfma_f32_16x16x32_bf16 v[236:239], a[160:163], a[60:63], v[236:239]
  ds_read_b64_tr_b16 a[188:189], v6 offset:28672
  v_mfma_f32_16x16x32_bf16 a[184:187], v[28:31], a[232:235], a[184:187]
  v_mfma_f32_16x16x32_bf16 v[236:239], a[164:167], a[44:47], v[236:239]
  s_cmp_eq_u32 s56, 0
  s_cselect_b32 s76, 8, 4
  s_mul_i32 s68, s76, 458752
  s_lshl_b32 s76, s76, 11
  s_add_u32 s76, s76, s57
  s_add_u32 m0, s45, 98304
  v_mfma_f32_16x16x32_bf16 v[252:255], a[172:175], a[44:47], v[252:255]
  ds_read_b64_tr_b16 a[190:191], v6 offset:30720
  v_mfma_f32_16x16x32_bf16 v[252:255], a[168:171], a[60:63], v[252:255]
  buffer_load_dwordx4 v11, s[28:31], s68 offen lds
  v_mfma_f32_16x16x32_bf16 v[248:251], a[168:171], a[56:59], v[248:251]
  ds_read_b64_tr_b16 a[200:201], v7 offset:16384
  v_mfma_f32_16x16x32_bf16 v[248:251], a[172:175], a[40:43], v[248:251]
  s_waitcnt vmcnt(13) lgkmcnt(5)
  v_mfma_f32_16x16x32_bf16 v[64:67], a[180:183], a[64:67], v[64:67]
  ds_read_b64_tr_b16 a[202:203], v7 offset:18432
  v_mfma_f32_16x16x32_bf16 v[64:67], a[176:179], a[80:83], v[64:67]
  s_add_u32 m0, s45, 106496
  v_mfma_f32_16x16x32_bf16 v[68:71], a[176:179], a[84:87], v[68:71]
  ds_read_b64_tr_b16 a[196:197], v7 offset:20480
  v_mfma_f32_16x16x32_bf16 v[68:71], a[180:183], a[68:71], v[68:71]
  buffer_load_dwordx4 v11, s[32:35], s68 offen lds
  v_mfma_f32_16x16x32_bf16 v[72:75], a[180:183], a[72:75], v[72:75]
  ds_read_b64_tr_b16 a[198:199], v7 offset:22528
  v_mfma_f32_16x16x32_bf16 v[72:75], a[176:179], a[88:91], v[72:75]
  s_add_u32 m0, s45, 102400
  s_add_u32 s61, s68, 229376
  v_mfma_f32_16x16x32_bf16 v[76:79], a[176:179], a[92:95], v[76:79]
  ds_read_b64_tr_b16 a[160:161], v7 offset:24576
  v_mfma_f32_16x16x32_bf16 v[76:79], a[180:183], a[76:79], v[76:79]
  s_waitcnt lgkmcnt(5)
  buffer_load_dwordx4 v11, s[28:31], s61 offen lds
  v_mfma_f32_16x16x32_bf16 v[92:95], a[192:195], a[76:79], v[92:95]
  ds_read_b64_tr_b16 a[162:163], v7 offset:26624
  v_mfma_f32_16x16x32_bf16 v[92:95], a[188:191], a[92:95], v[92:95]
  v_mfma_f32_16x16x32_bf16 v[88:91], a[188:191], a[88:91], v[88:91]
  ds_read_b64_tr_b16 a[164:165], v7 offset:28672
  v_mfma_f32_16x16x32_bf16 v[88:91], a[192:195], a[72:75], v[88:91]
  s_add_u32 m0, s45, 110592
  s_add_u32 s61, s68, 229376
  v_mfma_f32_16x16x32_bf16 v[84:87], a[192:195], a[68:71], v[84:87]
  ds_read_b64_tr_b16 a[166:167], v7 offset:30720
  v_mfma_f32_16x16x32_bf16 v[84:87], a[188:191], a[84:87], v[84:87]
  buffer_load_dwordx4 v11, s[32:35], s61 offen lds
  v_mfma_f32_16x16x32_bf16 v[80:83], a[188:191], a[80:83], v[80:83]
  ds_read_b64_tr_b16 a[168:169], v8 offset:16384
  v_mfma_f32_16x16x32_bf16 v[80:83], a[192:195], a[64:67], v[80:83]
  s_waitcnt lgkmcnt(5)
  s_add_u32 m0, s45, 32768
  v_mfma_f32_16x16x32_bf16 v[96:99], a[200:203], a[64:67], v[96:99]
  ds_read_b64_tr_b16 a[170:171], v8 offset:18432
  v_mfma_f32_16x16x32_bf16 v[96:99], a[196:199], a[80:83], v[96:99]
  buffer_load_dwordx4 v10, s[28:31], s68 offen lds
  v_mfma_f32_16x16x32_bf16 v[100:103], a[196:199], a[84:87], v[100:103]
  ds_read_b64_tr_b16 a[172:173], v8 offset:20480
  v_mfma_f32_16x16x32_bf16 v[100:103], a[200:203], a[68:71], v[100:103]
  v_mfma_f32_16x16x32_bf16 v[104:107], a[200:203], a[72:75], v[104:107]
  ds_read_b64_tr_b16 a[174:175], v8 offset:22528
  v_mfma_f32_16x16x32_bf16 v[104:107], a[196:199], a[88:91], v[104:107]
  s_add_u32 m0, s45, 40960
  v_mfma_f32_16x16x32_bf16 v[108:111], a[196:199], a[92:95], v[108:111]
  ds_read_b64_tr_b16 a[176:177], v8 offset:24576
  v_mfma_f32_16x16x32_bf16 v[108:111], a[200:203], a[76:79], v[108:111]
  s_waitcnt lgkmcnt(5)
  buffer_load_dwordx4 v10, s[32:35], s68 offen lds
  v_mfma_f32_16x16x32_bf16 v[124:127], a[160:163], a[76:79], v[124:127]
  ds_read_b64_tr_b16 a[178:179], v8 offset:26624
  v_mfma_f32_16x16x32_bf16 v[124:127], a[164:167], a[92:95], v[124:127]
  s_add_u32 m0, s45, 36864
  s_add_u32 s61, s68, 229376
  v_mfma_f32_16x16x32_bf16 v[120:123], a[164:167], a[88:91], v[120:123]
  ds_read_b64_tr_b16 a[180:181], v8 offset:28672
  v_mfma_f32_16x16x32_bf16 v[120:123], a[160:163], a[72:75], v[120:123]
  buffer_load_dwordx4 v10, s[28:31], s61 offen lds
  v_mfma_f32_16x16x32_bf16 v[116:119], a[160:163], a[68:71], v[116:119]
  ds_read_b64_tr_b16 a[182:183], v8 offset:30720
  v_mfma_f32_16x16x32_bf16 v[116:119], a[164:167], a[84:87], v[116:119]
  v_mfma_f32_16x16x32_bf16 v[112:115], a[164:167], a[80:83], v[112:115]
  ds_read_b64_tr_b16 a[164:165], v2 offset:16384
  v_mfma_f32_16x16x32_bf16 v[112:115], a[160:163], a[64:67], v[112:115]
  s_waitcnt lgkmcnt(5)
  s_add_u32 m0, s45, 45056
  s_add_u32 s61, s68, 229376
  v_mfma_f32_16x16x32_bf16 v[32:35], a[168:171], a[64:67], v[32:35]
  ds_read_b64_tr_b16 a[166:167], v2 offset:18432
  v_mfma_f32_16x16x32_bf16 v[32:35], a[172:175], a[80:83], v[32:35]
  buffer_load_dwordx4 v10, s[32:35], s61 offen lds
  v_mfma_f32_16x16x32_bf16 v[36:39], a[172:175], a[84:87], v[36:39]
  ds_read_b64_tr_b16 a[160:161], v2 offset:20480
  v_mfma_f32_16x16x32_bf16 v[36:39], a[168:171], a[68:71], v[36:39]
  v_mfma_f32_16x16x32_bf16 v[40:43], a[168:171], a[72:75], v[40:43]
  ds_read_b64_tr_b16 a[162:163], v2 offset:22528
  s_mov_b32 s62, 57344
  v_mfma_f32_16x16x32_bf16 v[40:43], a[172:175], a[88:91], v[40:43]
  buffer_load_dwordx4 a[220:223], v13, s[12:15], s62 offen
  s_mov_b32 s62, 64512
  v_mfma_f32_16x16x32_bf16 v[44:47], a[172:175], a[92:95], v[44:47]
  ds_read_b64_tr_b16 a[172:173], v2 offset:24576
  v_mfma_f32_16x16x32_bf16 v[44:47], a[168:171], a[76:79], v[44:47]
  s_waitcnt lgkmcnt(5)
  buffer_load_dwordx4 a[224:227], v13, s[12:15], s62 offen
  v_mfma_f32_16x16x32_bf16 v[60:63], a[176:179], a[76:79], v[60:63]
  ds_read_b64_tr_b16 a[174:175], v2 offset:26624
  s_mov_b32 s62, 71680
  v_mfma_f32_16x16x32_bf16 v[60:63], a[180:183], a[92:95], v[60:63]
HOP8:
  s_cbranch_execz HOP12
  buffer_load_dwordx4 a[228:231], v13, s[12:15], s62 offen
  s_mov_b32 s62, 78848
  v_mfma_f32_16x16x32_bf16 v[56:59], a[180:183], a[88:91], v[56:59]
  ds_read_b64_tr_b16 a[168:169], v2 offset:28672
  v_mfma_f32_16x16x32_bf16 v[56:59], a[176:179], a[72:75], v[56:59]
  buffer_load_dwordx4 a[232:235], v13, s[12:15], s62 offen
  ds_read_b128 v[24:27], v14 offset:16
  v_mfma_f32_16x16x32_bf16 v[52:55], a[176:179], a[68:71], v[52:55]
  ds_read_b64_tr_b16 a[170:171], v2 offset:30720
  v_mfma_f32_16x16x32_bf16 v[52:55], a[180:183], a[84:87], v[52:55]
  v_mfma_f32_16x16x32_bf16 v[48:51], a[180:183], a[80:83], v[48:51]
  ds_read_b64_tr_b16 a[180:181], v3 offset:16384
  v_mfma_f32_16x16x32_bf16 v[48:51], a[176:179], a[64:67], v[48:51]
  s_waitcnt lgkmcnt(6)
  v_mfma_f32_16x16x32_bf16 v[128:131], a[164:167], a[64:67], v[128:131]
  ds_read_b64_tr_b16 a[182:183], v3 offset:18432
  v_mfma_f32_16x16x32_bf16 v[128:131], a[160:163], a[80:83], v[128:131]
  s_waitcnt vmcnt(14) lgkmcnt(3)
  v_cndmask_b32 v28, 0, v24, s[16:17]
  v_cndmask_b32 v29, 0, v24, s[18:19]
  v_mfma_f32_16x16x32_bf16 v[132:135], a[160:163], a[84:87], v[132:135]
  ds_read_b64_tr_b16 a[176:177], v3 offset:20480
  v_cndmask_b32 v30, 0, v24, s[20:21]
  v_mfma_f32_16x16x32_bf16 v[132:135], a[164:167], a[68:71], v[132:135]
  v_cndmask_b32 v31, 0, v24, s[22:23]
  v_mfma_f32_16x16x32_bf16 v[136:139], a[164:167], a[72:75], v[136:139]
  ds_read_b64_tr_b16 a[178:179], v3 offset:22528
  v_mfma_f32_16x16x32_bf16 a[184:187], v[28:31], a[236:239], a[184:187]
  v_cndmask_b32 v28, 0, v25, s[16:17]
  v_cndmask_b32 v29, 0, v25, s[18:19]
  v_mfma_f32_16x16x32_bf16 v[136:139], a[160:163], a[88:91], v[136:139]
  v_cndmask_b32 v30, 0, v25, s[20:21]
  v_cndmask_b32 v31, 0, v25, s[22:23]
  v_mfma_f32_16x16x32_bf16 v[140:143], a[160:163], a[92:95], v[140:143]
  ds_read_b64_tr_b16 a[160:161], v3 offset:24576
  v_mfma_f32_16x16x32_bf16 a[184:187], v[28:31], a[240:243], a[184:187]
  v_cndmask_b32 v28, 0, v26, s[16:17]
  v_cndmask_b32 v29, 0, v26, s[18:19]
  v_mfma_f32_16x16x32_bf16 v[140:143], a[164:167], a[76:79], v[140:143]
  s_waitcnt lgkmcnt(5)
  v_cndmask_b32 v30, 0, v26, s[20:21]
  v_cndmask_b32 v31, 0, v26, s[22:23]
  v_mfma_f32_16x16x32_bf16 v[156:159], a[172:175], a[76:79], v[156:159]
  ds_read_b64_tr_b16 a[162:163], v3 offset:26624
  v_mfma_f32_16x16x32_bf16 a[184:187], v[28:31], a[244:247], a[184:187]
  v_cndmask_b32 v28, 0, v27, s[16:17]
  v_cndmask_b32 v29, 0, v27, s[18:19]
  v_mfma_f32_16x16x32_bf16 v[156:159], a[168:171], a[92:95], v[156:159]
  v_cndmask_b32 v30, 0, v27, s[20:21]
  v_cndmask_b32 v31, 0, v27, s[22:23]
  v_mfma_f32_16x16x32_bf16 v[152:155], a[168:171], a[88:91], v[152:155]
  ds_read_b64_tr_b16 a[164:165], v3 offset:28672
  v_mfma_f32_16x16x32_bf16 a[184:187], v[28:31], a[248:251], a[184:187]
  v_mfma_f32_16x16x32_bf16 v[152:155], a[172:175], a[72:75], v[152:155]
  v_mfma_f32_16x16x32_bf16 v[148:151], a[172:175], a[68:71], v[148:151]
  ds_read_b64_tr_b16 a[166:167], v3 offset:30720
  v_mfma_f32_16x16x32_bf16 v[148:151], a[168:171], a[84:87], v[148:151]
  v_mfma_f32_16x16x32_bf16 v[144:147], a[168:171], a[80:83], v[144:147]
  ds_read_b64_tr_b16 a[168:169], v4 offset:16384
  v_mfma_f32_16x16x32_bf16 v[144:147], a[172:175], a[64:67], v[144:147]
  s_waitcnt lgkmcnt(5)
  v_mfma_f32_16x16x32_bf16 v[160:163], a[180:183], a[64:67], v[160:163]
  ds_read_b64_tr_b16 a[170:171], v4 offset:18432
  v_mfma_f32_16x16x32_bf16 v[160:163], a[176:179], a[80:83], v[160:163]
  v_mfma_f32_16x16x32_bf16 v[164:167], a[176:179], a[84:87], v[164:167]
  ds_read_b64_tr_b16 a[172:173], v4 offset:20480
  v_mfma_f32_16x16x32_bf16 v[164:167], a[180:183], a[68:71], v[164:167]
  v_mfma_f32_16x16x32_bf16 v[168:171], a[180:183], a[72:75], v[168:171]
  ds_read_b64_tr_b16 a[174:175], v4 offset:22528
  v_mfma_f32_16x16x32_bf16 v[168:171], a[176:179], a[88:91], v[168:171]
  v_mfma_f32_16x16x32_bf16 v[172:175], a[176:179], a[92:95], v[172:175]
  ds_read_b64_tr_b16 a[176:177], v4 offset:24576
  v_mfma_f32_16x16x32_bf16 v[172:175], a[180:183], a[76:79], v[172:175]
  s_waitcnt lgkmcnt(5)
  v_mfma_f32_16x16x32_bf16 v[188:191], a[160:163], a[76:79], v[188:191]
  ds_read_b64_tr_b16 a[178:179], v4 offset:26624
  v_mfma_f32_16x16x32_bf16 v[188:191], a[164:167], a[92:95], v[188:191]
  buffer_load_dwordx4 a[128:131], v1, s[8:11], s76 offen offset:0 sc1
  v_mfma_f32_16x16x32_bf16 v[184:187], a[164:167], a[88:91], v[184:187]
  ds_read_b64_tr_b16 a[180:181], v4 offset:28672
  v_mfma_f32_16x16x32_bf16 v[184:187], a[160:163], a[72:75], v[184:187]
  v_mfma_f32_16x16x32_bf16 v[180:183], a[160:163], a[68:71], v[180:183]
  ds_read_b64_tr_b16 a[182:183], v4 offset:30720
  v_mfma_f32_16x16x32_bf16 v[180:183], a[164:167], a[84:87], v[180:183]
  s_add_u32 s62, s63, 0
  v_mfma_f32_16x16x32_bf16 v[176:179], a[164:167], a[80:83], v[176:179]
  ds_read_b64_tr_b16 a[164:165], v5 offset:16384
  v_mfma_f32_16x16x32_bf16 v[176:179], a[160:163], a[64:67], v[176:179]
  s_waitcnt lgkmcnt(5)
  buffer_load_dwordx4 a[188:191], v12, s[8:11], s62 offen offset:0 sc1
  v_mfma_f32_16x16x32_bf16 v[192:195], a[168:171], a[64:67], v[192:195]
  ds_read_b64_tr_b16 a[166:167], v5 offset:18432
  v_mfma_f32_16x16x32_bf16 v[192:195], a[172:175], a[80:83], v[192:195]
  s_add_u32 s62, s63, 0
  v_mfma_f32_16x16x32_bf16 v[196:199], a[172:175], a[84:87], v[196:199]
  ds_read_b64_tr_b16 a[160:161], v5 offset:20480
  v_mfma_f32_16x16x32_bf16 v[196:199], a[168:171], a[68:71], v[196:199]
  buffer_load_dwordx4 a[192:195], v12, s[8:11], s62 offen offset:256 sc1
  v_mfma_f32_16x16x32_bf16 v[200:203], a[168:171], a[72:75], v[200:203]
  ds_read_b64_tr_b16 a[162:163], v5 offset:22528
  v_mfma_f32_16x16x32_bf16 v[200:203], a[172:175], a[88:91], v[200:203]
  v_mfma_f32_16x16x32_bf16 v[204:207], a[172:175], a[92:95], v[204:207]
  ds_read_b64_tr_b16 a[172:173], v5 offset:24576
  v_mfma_f32_16x16x32_bf16 v[204:207], a[168:171], a[76:79], v[204:207]
  s_waitcnt lgkmcnt(5)
  s_add_u32 s62, s63, 2048
  v_mfma_f32_16x16x32_bf16 v[220:223], a[176:179], a[76:79], v[220:223]
  ds_read_b64_tr_b16 a[174:175], v5 offset:26624
  v_mfma_f32_16x16x32_bf16 v[220:223], a[180:183], a[92:95], v[220:223]
  buffer_load_dwordx4 a[196:199], v12, s[8:11], s62 offen offset:0 sc1
  v_mfma_f32_16x16x32_bf16 v[216:219], a[180:183], a[88:91], v[216:219]
  ds_read_b64_tr_b16 a[168:169], v5 offset:28672
  v_mfma_f32_16x16x32_bf16 v[216:219], a[176:179], a[72:75], v[216:219]
  s_add_u32 s62, s63, 2048
  v_mfma_f32_16x16x32_bf16 v[212:215], a[176:179], a[68:71], v[212:215]
  ds_read_b64_tr_b16 a[170:171], v5 offset:30720
  v_mfma_f32_16x16x32_bf16 v[212:215], a[180:183], a[84:87], v[212:215]
  buffer_load_dwordx4 a[200:203], v12, s[8:11], s62 offen offset:256 sc1
  s_waitcnt vmcnt(45)
  s_barrier
  v_mfma_f32_16x16x32_bf16 v[208:211], a[180:183], a[80:83], v[208:211]
  ds_read_b64_tr_b16 a[180:181], v6 offset:0
  v_mfma_f32_16x16x32_bf16 v[208:211], a[176:179], a[64:67], v[208:211]
  s_waitcnt lgkmcnt(5)
  v_mfma_f32_16x16x32_bf16 v[224:227], a[164:167], a[64:67], v[224:227]
  ds_read_b64_tr_b16 a[182:183], v6 offset:2048
  v_mfma_f32_16x16x32_bf16 v[224:227], a[160:163], a[80:83], v[224:227]
  s_add_u32 s62, s63, 4096
  v_mfma_f32_16x16x32_bf16 v[228:231], a[160:163], a[84:87], v[228:231]
  ds_read_b64_tr_b16 a[176:177], v6 offset:4096
  v_mfma_f32_16x16x32_bf16 v[228:231], a[164:167], a[68:71], v[228:231]
  buffer_load_dwordx4 a[204:207], v12, s[8:11], s62 offen offset:0 sc1
  v_mfma_f32_16x16x32_bf16 v[232:235], a[164:167], a[72:75], v[232:235]
  ds_read_b64_tr_b16 a[178:179], v6 offset:6144
  v_mfma_f32_16x16x32_bf16 v[232:235], a[160:163], a[88:91], v[232:235]
  s_add_u32 s62, s63, 4096
  v_mfma_f32_16x16x32_bf16 v[236:239], a[160:163], a[92:95], v[236:239]
  ds_read_b64_tr_b16 a[160:161], v6 offset:8192
  v_mfma_f32_16x16x32_bf16 v[236:239], a[164:167], a[76:79], v[236:239]
  s_waitcnt lgkmcnt(5)
  buffer_load_dwordx4 a[208:211], v12, s[8:11], s62 offen offset:256 sc1
  v_mfma_f32_16x16x32_bf16 v[252:255], a[172:175], a[76:79], v[252:255]
  ds_read_b64_tr_b16 a[162:163], v6 offset:10240
  v_mfma_f32_16x16x32_bf16 v[252:255], a[168:171], a[92:95], v[252:255]
  v_mfma_f32_16x16x32_bf16 v[248:251], a[168:171], a[88:91], v[248:251]
  ds_read_b64_tr_b16 a[164:165], v6 offset:12288
  v_mfma_f32_16x16x32_bf16 v[248:251], a[172:175], a[72:75], v[248:251]
  s_add_u32 s62, s63, 6144
  v_mfma_f32_16x16x32_bf16 v[244:247], a[172:175], a[68:71], v[244:247]
  ds_read_b64_tr_b16 a[166:167], v6 offset:14336
  v_mfma_f32_16x16x32_bf16 v[244:247], a[168:171], a[84:87], v[244:247]
  buffer_load_dwordx4 a[212:215], v12, s[8:11], s62 offen offset:0 sc1
  v_mfma_f32_16x16x32_bf16 v[240:243], a[168:171], a[80:83], v[240:243]
  ds_read_b64_tr_b16 a[168:169], v7 offset:0
  v_mfma_f32_16x16x32_bf16 v[240:243], a[172:175], a[64:67], v[240:243]
  s_waitcnt vmcnt(20) lgkmcnt(5)
  s_add_u32 s62, s63, 6144
  v_mfma_f32_16x16x32_bf16 v[64:67], a[180:183], a[96:99], v[64:67]
  ds_read_b64_tr_b16 a[170:171], v7 offset:2048
  v_mfma_f32_16x16x32_bf16 v[64:67], a[176:179], a[112:115], v[64:67]
  buffer_load_dwordx4 a[216:219], v12, s[8:11], s62 offen offset:256 sc1
  v_mfma_f32_16x16x32_bf16 v[68:71], a[176:179], a[116:119], v[68:71]
  ds_read_b64_tr_b16 a[172:173], v7 offset:4096
  v_mfma_f32_16x16x32_bf16 v[68:71], a[180:183], a[100:103], v[68:71]
  v_mfma_f32_16x16x32_bf16 v[72:75], a[180:183], a[104:107], v[72:75]
  ds_read_b64_tr_b16 a[174:175], v7 offset:6144
  v_mfma_f32_16x16x32_bf16 v[72:75], a[176:179], a[120:123], v[72:75]
  v_mfma_f32_16x16x32_bf16 v[76:79], a[176:179], a[124:127], v[76:79]
  ds_read_b64_tr_b16 a[176:177], v7 offset:8192
  v_mfma_f32_16x16x32_bf16 v[76:79], a[180:183], a[108:111], v[76:79]
  s_waitcnt lgkmcnt(5)
  buffer_load_dwordx4 a[144:147], v1, s[8:11], s76 offen offset:1024 sc1
  v_mfma_f32_16x16x32_bf16 v[92:95], a[160:163], a[108:111], v[92:95]
  ds_read_b64_tr_b16 a[178:179], v7 offset:10240
  v_mfma_f32_16x16x32_bf16 v[92:95], a[164:167], a[124:127], v[92:95]
  s_add_u32 s76, s76, 65536
  v_mfma_f32_16x16x32_bf16 v[88:91], a[164:167], a[120:123], v[88:91]
  ds_read_b64_tr_b16 a[180:181], v7 offset:12288
  v_mfma_f32_16x16x32_bf16 v[88:91], a[160:163], a[104:107], v[88:91]
  buffer_load_dwordx4 a[132:135], v1, s[8:11], s76 offen offset:0 sc1
  v_mfma_f32_16x16x32_bf16 v[84:87], a[160:163], a[100:103], v[84:87]
  ds_read_b64_tr_b16 a[182:183], v7 offset:14336
  v_mfma_f32_16x16x32_bf16 v[84:87], a[164:167], a[116:119], v[84:87]
  v_mfma_f32_16x16x32_bf16 v[80:83], a[164:167], a[112:115], v[80:83]
  ds_read_b64_tr_b16 a[164:165], v8 offset:0
  v_mfma_f32_16x16x32_bf16 v[80:83], a[160:163], a[96:99], v[80:83]
  s_waitcnt lgkmcnt(5)
  s_mov_b32 s62, 86016
  v_mfma_f32_16x16x32_bf16 v[96:99], a[168:171], a[96:99], v[96:99]
  ds_read_b64_tr_b16 a[166:167], v8 offset:2048
  buffer_load_dwordx4 a[236:239], v13, s[12:15], s62 offen
  v_mfma_f32_16x16x32_bf16 v[96:99], a[172:175], a[112:115], v[96:99]
  s_mov_b32 s62, 93184
  v_mfma_f32_16x16x32_bf16 v[100:103], a[172:175], a[116:119], v[100:103]
  ds_read_b64_tr_b16 a[160:161], v8 offset:4096
  buffer_load_dwordx4 a[240:243], v13, s[12:15], s62 offen
  v_mfma_f32_16x16x32_bf16 v[100:103], a[168:171], a[100:103], v[100:103]
  s_mov_b32 s62, 100352
  ds_read_b128 v[24:27], v14 offset:32
  v_mfma_f32_16x16x32_bf16 v[104:107], a[168:171], a[104:107], v[104:107]
  ds_read_b64_tr_b16 a[162:163], v8 offset:6144
  buffer_load_dwordx4 a[244:247], v13, s[12:15], s62 offen
  v_mfma_f32_16x16x32_bf16 v[104:107], a[172:175], a[120:123], v[104:107]
  s_mov_b32 s62, 107520
  v_mfma_f32_16x16x32_bf16 v[108:111], a[172:175], a[124:127], v[108:111]
  ds_read_b64_tr_b16 a[172:173], v8 offset:8192
  v_mfma_f32_16x16x32_bf16 v[108:111], a[168:171], a[108:111], v[108:111]
  s_waitcnt lgkmcnt(6)
  buffer_load_dwordx4 a[248:251], v13, s[12:15], s62 offen
  v_mfma_f32_16x16x32_bf16 v[124:127], a[176:179], a[108:111], v[124:127]
  ds_read_b64_tr_b16 a[174:175], v8 offset:10240
  v_mfma_f32_16x16x32_bf16 v[124:127], a[180:183], a[124:127], v[124:127]
  s_waitcnt vmcnt(15) lgkmcnt(3)
  v_cndmask_b32 v28, 0, v24, s[16:17]
  v_cndmask_b32 v29, 0, v24, s[18:19]
  v_mfma_f32_16x16x32_bf16 v[120:123], a[180:183], a[120:123], v[120:123]
  ds_read_b64_tr_b16 a[168:169], v8 offset:12288
  v_cndmask_b32 v30, 0, v24, s[20:21]
  v_mfma_f32_16x16x32_bf16 v[120:123], a[176:179], a[104:107], v[120:123]
  v_cndmask_b32 v31, 0, v24, s[22:23]
  v_mfma_f32_16x16x32_bf16 v[116:119], a[176:179], a[100:103], v[116:119]
  ds_read_b64_tr_b16 a[170:171], v8 offset:14336
  v_mfma_f32_16x16x32_bf16 a[184:187], v[28:31], a[220:223], a[184:187]
  v_cndmask_b32 v28, 0, v25, s[16:17]
  v_cndmask_b32 v29, 0, v25, s[18:19]
  v_mfma_f32_16x16x32_bf16 v[116:119], a[180:183], a[116:119], v[116:119]
  v_cndmask_b32 v30, 0, v25, s[20:21]
  v_cndmask_b32 v31, 0, v25, s[22:23]
  v_mfma_f32_16x16x32_bf16 v[112:115], a[180:183], a[112:115], v[112:115]
  ds_read_b64_tr_b16 a[180:181], v2 offset:0
  v_mfma_f32_16x16x32_bf16 a[184:187], v[28:31], a[224:227], a[184:187]
  v_cndmask_b32 v28, 0, v26, s[16:17]
  v_cndmask_b32 v29, 0, v26, s[18:19]
  v_mfma_f32_16x16x32_bf16 v[112:115], a[176:179], a[96:99], v[112:115]
  s_waitcnt lgkmcnt(5)
  v_cndmask_b32 v30, 0, v26, s[20:21]
  v_cndmask_b32 v31, 0, v26, s[22:23]
  v_mfma_f32_16x16x32_bf16 v[32:35], a[164:167], a[96:99], v[32:35]
  ds_read_b64_tr_b16 a[182:183], v2 offset:2048
  v_mfma_f32_16x16x32_bf16 a[184:187], v[28:31], a[228:231], a[184:187]
  v_cndmask_b32 v28, 0, v27, s[16:17]
  v_cndmask_b32 v29, 0, v27, s[18:19]
  v_mfma_f32_16x16x32_bf16 v[32:35], a[160:163], a[112:115], v[32:35]
  v_cndmask_b32 v30, 0, v27, s[20:21]
  v_cndmask_b32 v31, 0, v27, s[22:23]
  v_mfma_f32_16x16x32_bf16 v[36:39], a[160:163], a[116:119], v[36:39]
  ds_read_b64_tr_b16 a[176:177], v2 offset:4096
  v_mfma_f32_16x16x32_bf16 a[184:187], v[28:31], a[232:235], a[184:187]
  v_mfma_f32_16x16x32_bf16 v[36:39], a[164:167], a[100:103], v[36:39]
  v_mfma_f32_16x16x32_bf16 v[40:43], a[164:167], a[104:107], v[40:43]
  ds_read_b64_tr_b16 a[178:179], v2 offset:6144
  v_mfma_f32_16x16x32_bf16 v[40:43], a[160:163], a[120:123], v[40:43]
  v_mfma_f32_16x16x32_bf16 v[44:47], a[160:163], a[124:127], v[44:47]
  ds_read_b64_tr_b16 a[160:161], v2 offset:8192
  v_mfma_f32_16x16x32_bf16 v[44:47], a[164:167], a[108:111], v[44:47]
  s_waitcnt lgkmcnt(5)
  v_mfma_f32_16x16x32_bf16 v[60:63], a[172:175], a[108:111], v[60:63]
  ds_read_b64_tr_b16 a[162:163], v2 offset:10240
  v_mfma_f32_16x16x32_bf16 v[60:63], a[168:171], a[124:127], v[60:63]
  v_mfma_f32_16x16x32_bf16 v[56:59], a[168:171], a[120:123], v[56:59]
  ds_read_b64_tr_b16 a[164:165], v2 offset:12288
  v_mfma_f32_16x16x32_bf16 v[56:59], a[172:175], a[104:107], v[56:59]
  v_mfma_f32_16x16x32_bf16 v[52:55], a[172:175], a[100:103], v[52:55]
  ds_read_b64_tr_b16 a[166:167], v2 offset:14336
  v_mfma_f32_16x16x32_bf16 v[52:55], a[168:171], a[116:119], v[52:55]
  v_mfma_f32_16x16x32_bf16 v[48:51], a[168:171], a[112:115], v[48:51]
  ds_read_b64_tr_b16 a[168:169], v3 offset:0
  v_mfma_f32_16x16x32_bf16 v[48:51], a[172:175], a[96:99], v[48:51]
  s_waitcnt lgkmcnt(5)
  v_mfma_f32_16x16x32_bf16 v[128:131], a[180:183], a[96:99], v[128:131]
  ds_read_b64_tr_b16 a[170:171], v3 offset:2048
  v_mfma_f32_16x16x32_bf16 v[128:131], a[176:179], a[112:115], v[128:131]
  v_mfma_f32_16x16x32_bf16 v[132:135], a[176:179], a[116:119], v[132:135]
  ds_read_b64_tr_b16 a[172:173], v3 offset:4096
  v_mfma_f32_16x16x32_bf16 v[132:135], a[180:183], a[100:103], v[132:135]
  v_mfma_f32_16x16x32_bf16 v[136:139], a[180:183], a[104:107], v[136:139]
  ds_read_b64_tr_b16 a[174:175], v3 offset:6144
  v_mfma_f32_16x16x32_bf16 v[136:139], a[176:179], a[120:123], v[136:139]
  buffer_load_dwordx4 a[148:151], v1, s[8:11], s76 offen offset:1024 sc1
  v_mfma_f32_16x16x32_bf16 v[140:143], a[176:179], a[124:127], v[140:143]
  ds_read_b64_tr_b16 a[176:177], v3 offset:8192
  v_mfma_f32_16x16x32_bf16 v[140:143], a[180:183], a[108:111], v[140:143]
  s_waitcnt lgkmcnt(5)
  s_add_u32 s76, s76, 65536
  v_mfma_f32_16x16x32_bf16 v[156:159], a[160:163], a[108:111], v[156:159]
  ds_read_b64_tr_b16 a[178:179], v3 offset:10240
  v_mfma_f32_16x16x32_bf16 v[156:159], a[164:167], a[124:127], v[156:159]
  buffer_load_dwordx4 a[136:139], v1, s[8:11], s76 offen offset:0 sc1
  v_mfma_f32_16x16x32_bf16 v[152:155], a[164:167], a[120:123], v[152:155]
  ds_read_b64_tr_b16 a[180:181], v3 offset:12288
  v_mfma_f32_16x16x32_bf16 v[152:155], a[160:163], a[104:107], v[152:155]
  v_mfma_f32_16x16x32_bf16 v[148:151], a[160:163], a[100:103], v[148:151]
  ds_read_b64_tr_b16 a[182:183], v3 offset:14336
  v_mfma_f32_16x16x32_bf16 v[148:151], a[164:167], a[116:119], v[148:151]
  v_mfma_f32_16x16x32_bf16 v[144:147], a[164:167], a[112:115], v[144:147]
  ds_read_b64_tr_b16 a[164:165], v4 offset:0
  v_mfma_f32_16x16x32_bf16 v[144:147], a[160:163], a[96:99], v[144:147]
  s_waitcnt lgkmcnt(5)
  buffer_load_dwordx4 a[152:155], v1, s[8:11], s76 offen offset:1024 sc1
  v_mfma_f32_16x16x32_bf16 v[160:163], a[168:171], a[96:99], v[160:163]
  ds_read_b64_tr_b16 a[166:167], v4 offset:2048
  s_waitcnt vmcnt(9)
  v_mfma_f32_16x16x32_bf16 v[160:163], a[172:175], a[112:115], v[160:163]
  s_add_u32 s76, s76, 65536
  v_accvgpr_read_b32 v16, a188
  v_accvgpr_read_b32 v17, a189
  v_mfma_f32_16x16x32_bf16 v[164:167], a[172:175], a[116:119], v[164:167]
  ds_read_b64_tr_b16 a[160:161], v4 offset:4096
  v_accvgpr_read_b32 v18, a190
  v_mfma_f32_16x16x32_bf16 v[164:167], a[168:171], a[100:103], v[164:167]
  buffer_load_dwordx4 a[140:143], v1, s[8:11], s76 offen offset:0 sc1
  v_accvgpr_read_b32 v19, a191
  v_accvgpr_read_b32 v20, a192
  v_mfma_f32_16x16x32_bf16 v[168:171], a[168:171], a[104:107], v[168:171]
  ds_read_b64_tr_b16 a[162:163], v4 offset:6144
  v_accvgpr_read_b32 v21, a193
  v_mfma_f32_16x16x32_bf16 v[168:171], a[172:175], a[120:123], v[168:171]
  v_accvgpr_read_b32 v22, a194
  v_accvgpr_read_b32 v23, a195
  v_mfma_f32_16x16x32_bf16 v[172:175], a[172:175], a[124:127], v[172:175]
  ds_read_b64_tr_b16 a[172:173], v4 offset:8192
  v_accvgpr_read_b32 v24, a196
  v_mfma_f32_16x16x32_bf16 v[172:175], a[168:171], a[108:111], v[172:175]
  s_waitcnt lgkmcnt(5)
  v_accvgpr_read_b32 v25, a197
  v_accvgpr_read_b32 v26, a198
  v_mfma_f32_16x16x32_bf16 v[188:191], a[176:179], a[108:111], v[188:191]
  ds_read_b64_tr_b16 a[174:175], v4 offset:10240
  v_accvgpr_read_b32 v27, a199
  v_mfma_f32_16x16x32_bf16 v[188:191], a[180:183], a[124:127], v[188:191]
  buffer_load_dwordx4 a[156:159], v1, s[8:11], s76 offen offset:1024 sc1
  v_accvgpr_read_b32 v28, a200
  v_accvgpr_read_b32 v29, a201
  v_mfma_f32_16x16x32_bf16 v[184:187], a[180:183], a[120:123], v[184:187]
  ds_read_b64_tr_b16 a[168:169], v4 offset:12288
  v_accvgpr_read_b32 v30, a202
  v_mfma_f32_16x16x32_bf16 v[184:187], a[176:179], a[104:107], v[184:187]
  s_cmp_eq_u32 s56, 1
  s_cselect_b32 s77, 9, 5
  s_mul_i32 s69, s77, 458752
  s_lshl_b32 s77, s77, 11
  s_add_u32 s77, s77, s57
  s_add_u32 m0, s45, 114688
  v_accvgpr_read_b32 v31, a203
  v_add_f32 v16, v16, v24
  v_mfma_f32_16x16x32_bf16 v[180:183], a[176:179], a[100:103], v[180:183]
  ds_read_b64_tr_b16 a[170:171], v4 offset:14336
  v_add_f32 v17, v17, v25
  v_mfma_f32_16x16x32_bf16 v[180:183], a[180:183], a[116:119], v[180:183]
  buffer_load_dwordx4 v11, s[28:31], s69 offen lds
  v_add_f32 v18, v18, v26
  v_add_f32 v19, v19, v27
  v_mfma_f32_16x16x32_bf16 v[176:179], a[180:183], a[112:115], v[176:179]
  ds_read_b64_tr_b16 a[180:181], v5 offset:0
  v_add_f32 v20, v20, v28
  v_mfma_f32_16x16x32_bf16 v[176:179], a[176:179], a[96:99], v[176:179]
  s_waitcnt lgkmcnt(5)
  v_add_f32 v21, v21, v29
  v_add_f32 v22, v22, v30
  v_mfma_f32_16x16x32_bf16 v[192:195], a[164:167], a[96:99], v[192:195]
  ds_read_b64_tr_b16 a[182:183], v5 offset:2048
  v_add_f32 v23, v23, v31
  v_mfma_f32_16x16x32_bf16 v[192:195], a[160:163], a[112:115], v[192:195]
  s_add_u32 m0, s45, 122880
  v_accvgpr_read_b32 v24, a204
  v_accvgpr_read_b32 v25, a205
  v_mfma_f32_16x16x32_bf16 v[196:199], a[160:163], a[116:119], v[196:199]
  ds_read_b64_tr_b16 a[176:177], v5 offset:4096
  v_accvgpr_read_b32 v26, a206
  v_mfma_f32_16x16x32_bf16 v[196:199], a[164:167], a[100:103], v[196:199]
  buffer_load_dwordx4 v11, s[32:35], s69 offen lds
  v_accvgpr_read_b32 v27, a207
  v_accvgpr_read_b32 v28, a208
  v_mfma_f32_16x16x32_bf16 v[200:203], a[164:167], a[104:107], v[200:203]
  ds_read_b64_tr_b16 a[178:179], v5 offset:6144
  v_accvgpr_read_b32 v29, a209
  v_mfma_f32_16x16x32_bf16 v[200:203], a[160:163], a[120:123], v[200:203]
  s_add_u32 m0, s45, 118784
  s_add_u32 s61, s69, 229376
  v_accvgpr_read_b32 v30, a210
  v_mfma_f32_16x16x32_bf16 v[204:207], a[160:163], a[124:127], v[204:207]
  ds_read_b64_tr_b16 a[160:161], v5 offset:8192
  v_accvgpr_read_b32 v31, a211
  v_mfma_f32_16x16x32_bf16 v[204:207], a[164:167], a[108:111], v[204:207]
  s_waitcnt lgkmcnt(5)
  buffer_load_dwordx4 v11, s[28:31], s61 offen lds
  v_add_f32 v16, v16, v24
  v_mfma_f32_16x16x32_bf16 v[220:223], a[172:175], a[108:111], v[220:223]
  ds_read_b64_tr_b16 a[162:163], v5 offset:10240
  v_add_f32 v17, v17, v25
  v_mfma_f32_16x16x32_bf16 v[220:223], a[168:171], a[124:127], v[220:223]
  v_add_f32 v18, v18, v26
  v_add_f32 v19, v19, v27
  v_mfma_f32_16x16x32_bf16 v[216:219], a[168:171], a[120:123], v[216:219]
  ds_read_b64_tr_b16 a[164:165], v5 offset:12288
  v_add_f32 v20, v20, v28
  v_mfma_f32_16x16x32_bf16 v[216:219], a[172:175], a[104:107], v[216:219]
  s_add_u32 m0, s45, 126976
  s_add_u32 s61, s69, 229376
  v_add_f32 v21, v21, v29
  v_mfma_f32_16x16x32_bf16 v[212:215], a[172:175], a[100:103], v[212:215]
  ds_read_b64_tr_b16 a[166:167], v5 offset:14336
  buffer_load_dwordx4 v11, s[32:35], s61 offen lds
  v_mfma_f32_16x16x32_bf16 v[212:215], a[168:171], a[116:119], v[212:215]
  s_waitcnt vmcnt(28)
  s_barrier
  v_mfma_f32_16x16x32_bf16 v[208:211], a[168:171], a[112:115], v[208:211]
  ds_read_b64_tr_b16 a[168:169], v6 offset:32768
  v_add_f32 v22, v22, v30
  v_mfma_f32_16x16x32_bf16 v[208:211], a[172:175], a[96:99], v[208:211]
  s_waitcnt lgkmcnt(5)
  s_add_u32 m0, s45, 49152
  v_add_f32 v23, v23, v31
  v_mfma_f32_16x16x32_bf16 v[224:227], a[180:183], a[96:99], v[224:227]
  ds_read_b64_tr_b16 a[170:171], v6 offset:34816
  v_accvgpr_read_b32 v24, a212
  v_mfma_f32_16x16x32_bf16 v[224:227], a[176:179], a[112:115], v[224:227]
  buffer_load_dwordx4 v10, s[28:31], s69 offen lds
  v_accvgpr_read_b32 v25, a213
  v_accvgpr_read_b32 v26, a214
  v_mfma_f32_16x16x32_bf16 v[228:231], a[176:179], a[116:119], v[228:231]
  ds_read_b64_tr_b16 a[172:173], v6 offset:36864
  v_accvgpr_read_b32 v27, a215
  v_mfma_f32_16x16x32_bf16 v[228:231], a[180:183], a[100:103], v[228:231]
  v_accvgpr_read_b32 v28, a216
  v_accvgpr_read_b32 v29, a217
  v_mfma_f32_16x16x32_bf16 v[232:235], a[180:183], a[104:107], v[232:235]
  ds_read_b64_tr_b16 a[174:175], v6 offset:38912
  v_accvgpr_read_b32 v30, a218
  v_mfma_f32_16x16x32_bf16 v[232:235], a[176:179], a[120:123], v[232:235]
  s_add_u32 m0, s45, 57344
  v_accvgpr_read_b32 v31, a219
  v_add_f32 v16, v16, v24
  v_mfma_f32_16x16x32_bf16 v[236:239], a[176:179], a[124:127], v[236:239]
  ds_read_b64_tr_b16 a[176:177], v6 offset:40960
  v_add_f32 v17, v17, v25
  v_mfma_f32_16x16x32_bf16 v[236:239], a[180:183], a[108:111], v[236:239]
  s_waitcnt lgkmcnt(5)
  buffer_load_dwordx4 v10, s[32:35], s69 offen lds
  v_add_f32 v18, v18, v26
  v_mfma_f32_16x16x32_bf16 v[252:255], a[160:163], a[108:111], v[252:255]
  ds_read_b64_tr_b16 a[178:179], v6 offset:43008
  v_add_f32 v19, v19, v27
  v_mfma_f32_16x16x32_bf16 v[252:255], a[164:167], a[124:127], v[252:255]
  s_add_u32 m0, s45, 53248
  s_add_u32 s61, s69, 229376
  v_add_f32 v20, v20, v28
  v_mfma_f32_16x16x32_bf16 v[248:251], a[164:167], a[120:123], v[248:251]
  ds_read_b64_tr_b16 a[180:181], v6 offset:45056
  v_add_f32 v21, v21, v29
  v_mfma_f32_16x16x32_bf16 v[248:251], a[160:163], a[104:107], v[248:251]
  buffer_load_dwordx4 v10, s[28:31], s61 offen lds
  v_add_f32 v22, v22, v30
  v_add_f32 v23, v23, v31
  v_mfma_f32_16x16x32_bf16 v[244:247], a[160:163], a[100:103], v[244:247]
  ds_read_b64_tr_b16 a[182:183], v6 offset:47104
  v_mfma_f32_16x16x32_bf16 v[244:247], a[164:167], a[116:119], v[244:247]
  ds_read_b128 v[24:27], v14 offset:48
  v_mfma_f32_16x16x32_bf16 v[240:243], a[164:167], a[112:115], v[240:243]
  ds_read_b64_tr_b16 a[164:165], v7 offset:32768
  v_mfma_f32_16x16x32_bf16 v[240:243], a[160:163], a[96:99], v[240:243]
  s_waitcnt vmcnt(7) lgkmcnt(6)
  s_add_u32 m0, s45, 61440
  s_add_u32 s61, s69, 229376
  v_mfma_f32_16x16x32_bf16 v[64:67], a[168:171], a[128:131], v[64:67]
  ds_read_b64_tr_b16 a[166:167], v7 offset:34816
  v_mfma_f32_16x16x32_bf16 v[64:67], a[172:175], a[144:147], v[64:67]
  buffer_load_dwordx4 v10, s[32:35], s61 offen lds
  v_mfma_f32_16x16x32_bf16 v[68:71], a[172:175], a[148:151], v[68:71]
  ds_read_b64_tr_b16 a[160:161], v7 offset:36864
  v_mfma_f32_16x16x32_bf16 v[68:71], a[168:171], a[132:135], v[68:71]
  s_waitcnt vmcnt(13) lgkmcnt(3)
  v_cndmask_b32 v28, 0, v24, s[16:17]
  v_mfma_f32_16x16x32_bf16 v[72:75], a[168:171], a[136:139], v[72:75]
  ds_read_b64_tr_b16 a[162:163], v7 offset:38912
  v_cndmask_b32 v29, 0, v24, s[18:19]
  v_mfma_f32_16x16x32_bf16 v[72:75], a[172:175], a[152:155], v[72:75]
  buffer_load_dwordx4 a[0:3], v1, s[8:11], s77 offen offset:0 sc1
  v_cndmask_b32 v30, 0, v24, s[20:21]
  v_cndmask_b32 v31, 0, v24, s[22:23]
  v_mfma_f32_16x16x32_bf16 v[76:79], a[172:175], a[156:159], v[76:79]
  ds_read_b64_tr_b16 a[172:173], v7 offset:40960
  v_mfma_f32_16x16x32_bf16 a[184:187], v[28:31], a[236:239], a[184:187]
  v_cndmask_b32 v28, 0, v25, s[16:17]
  v_cndmask_b32 v29, 0, v25, s[18:19]
  v_mfma_f32_16x16x32_bf16 v[76:79], a[168:171], a[140:143], v[76:79]
  s_waitcnt lgkmcnt(6)
  v_cndmask_b32 v30, 0, v25, s[20:21]
  v_cndmask_b32 v31, 0, v25, s[22:23]
  v_mfma_f32_16x16x32_bf16 v[92:95], a[176:179], a[140:143], v[92:95]
  ds_read_b64_tr_b16 a[174:175], v7 offset:43008
  v_mfma_f32_16x16x32_bf16 a[184:187], v[28:31], a[240:243], a[184:187]
  v_cndmask_b32 v28, 0, v26, s[16:17]
  v_cndmask_b32 v29, 0, v26, s[18:19]
  v_mfma_f32_16x16x32_bf16 v[92:95], a[180:183], a[156:159], v[92:95]
  v_cndmask_b32 v30, 0, v26, s[20:21]
  v_cndmask_b32 v31, 0, v26, s[22:23]
  v_mfma_f32_16x16x32_bf16 v[88:91], a[180:183], a[152:155], v[88:91]
  ds_read_b64_tr_b16 a[168:169], v7 offset:45056
  v_mfma_f32_16x16x32_bf16 a[184:187], v[28:31], a[244:247], a[184:187]
  v_cndmask_b32 v28, 0, v27, s[16:17]
  v_cndmask_b32 v29, 0, v27, s[18:19]
  v_mfma_f32_16x16x32_bf16 v[88:91], a[176:179], a[136:139], v[88:91]
  buffer_load_dwordx4 a[16:19], v1, s[8:11], s77 offen offset:1024 sc1
  v_cndmask_b32 v30, 0, v27, s[20:21]
  v_cndmask_b32 v31, 0, v27, s[22:23]
  v_mfma_f32_16x16x32_bf16 v[84:87], a[176:179], a[132:135], v[84:87]
  ds_read_b64_tr_b16 a[170:171], v7 offset:47104
  v_mfma_f32_16x16x32_bf16 a[184:187], v[28:31], a[248:251], a[184:187]
  v_mfma_f32_16x16x32_bf16 v[84:87], a[180:183], a[148:151], v[84:87]
  s_add_u32 s77, s77, 65536
  v_mfma_f32_16x16x32_bf16 v[80:83], a[180:183], a[144:147], v[80:83]
  ds_read_b64_tr_b16 a[180:181], v8 offset:32768
  v_mfma_f32_16x16x32_bf16 v[80:83], a[176:179], a[128:131], v[80:83]
  s_waitcnt lgkmcnt(5)
  buffer_load_dwordx4 a[4:7], v1, s[8:11], s77 offen offset:0 sc1
  v_mfma_f32_16x16x32_bf16 v[96:99], a[164:167], a[128:131], v[96:99]
  ds_read_b64_tr_b16 a[182:183], v8 offset:34816
  s_bfe_u32 s53, s2, 0x20004
  v_mfma_f32_16x16x32_bf16 v[96:99], a[160:163], a[144:147], v[96:99]
  s_lshl_b32 s53, s53, 9
  v_and_b32 v14, 15, v0
  v_lshl_add_u32 v14, v14, 5, s53
  v_mfma_f32_16x16x32_bf16 v[100:103], a[160:163], a[148:151], v[100:103]
  ds_read_b64_tr_b16 a[176:177], v8 offset:36864
  v_cmp_gt_u32 vcc, 1792, v14
  v_mov_b32 v15, 134217728
  v_bfe_u32 v13, v0, 4, 1
  v_cndmask_b32 v14, v15, v14, vcc
  v_mfma_f32_16x16x32_bf16 v[100:103], a[164:167], a[132:135], v[100:103]
  v_lshl_add_u32 v14, v13, 4, v14
  v_lshrrev_b32 v13, 5, v0
  v_mfma_f32_16x16x32_bf16 v[104:107], a[164:167], a[136:139], v[104:107]
  ds_read_b64_tr_b16 a[178:179], v8 offset:38912
  v_mul_u32_u24 v13, 14336, v13
  v_mfma_f32_16x16x32_bf16 v[104:107], a[160:163], a[152:155], v[104:107]
  buffer_load_dwordx4 a[20:23], v1, s[8:11], s77 offen offset:1024 sc1
  v_add_u32 v14, v14, v13
  s_lshr_b32 s53, s2, 6
  v_mfma_f32_16x16x32_bf16 v[108:111], a[160:163], a[156:159], v[108:111]
  ds_read_b64_tr_b16 a[160:161], v8 offset:40960
  s_lshl_b32 s53, s53, 2
  v_mfma_f32_16x16x32_bf16 v[108:111], a[164:167], a[140:143], v[108:111]
  s_waitcnt lgkmcnt(5)
  s_add_u32 s62, s63, 8192
  s_add_u32 s53, s53, s44
  v_mfma_f32_16x16x32_bf16 v[124:127], a[172:175], a[140:143], v[124:127]
HOP9:
  s_cbranch_execz HOP13
  ds_read_b64_tr_b16 a[162:163], v8 offset:43008
  s_lshl_b32 s53, s53, 1
  v_mfma_f32_16x16x32_bf16 v[124:127], a[168:171], a[156:159], v[124:127]
  buffer_load_dwordx4 a[188:191], v12, s[8:11], s62 offen offset:0 sc1
  s_bfe_u32 s54, s2, 0x10003
  s_add_u32 s53, s53, s54
  v_mfma_f32_16x16x32_bf16 v[120:123], a[168:171], a[152:155], v[120:123]
  ds_read_b64_tr_b16 a[164:165], v8 offset:45056
  s_mul_i32 s53, s53, 28672
  v_mfma_f32_16x16x32_bf16 v[120:123], a[172:175], a[136:139], v[120:123]
  s_mul_i32 s54, s52, 1792
  s_add_u32 s53, s53, s54
  s_add_u32 s53, s53, 46137344
  v_mfma_f32_16x16x32_bf16 v[116:119], a[172:175], a[132:135], v[116:119]
  ds_read_b64_tr_b16 a[166:167], v8 offset:47104
  v_mfma_f32_16x16x32_bf16 v[116:119], a[168:171], a[148:151], v[116:119]
  s_add_u32 s62, s63, 8192
  buffer_store_dwordx4 a[184:187], v14, s[8:11], s53 offen sc1
  v_mfma_f32_16x16x32_bf16 v[112:115], a[168:171], a[144:147], v[112:115]
  ds_read_b64_tr_b16 a[168:169], v2 offset:32768
  s_lshl_b32 s53, s52, 7
  v_mfma_f32_16x16x32_bf16 v[112:115], a[172:175], a[128:131], v[112:115]
  s_waitcnt lgkmcnt(5)
  buffer_load_dwordx4 a[192:195], v12, s[8:11], s62 offen offset:256 sc1
  s_add_u32 s53, s53, 884736
  v_mfma_f32_16x16x32_bf16 v[32:35], a[180:183], a[128:131], v[32:35]
  ds_read_b64_tr_b16 a[170:171], v2 offset:34816
  v_and_b32 v13, 31, v0
  v_mfma_f32_16x16x32_bf16 v[32:35], a[176:179], a[144:147], v[32:35]
  s_add_u32 s62, s63, 10240
  v_min_u32 v15, 27, v13
  v_lshl_add_u32 v13, v13, 10, s53
  v_mfma_f32_16x16x32_bf16 v[36:39], a[176:179], a[148:151], v[36:39]
  ds_read_b64_tr_b16 a[172:173], v2 offset:36864
  v_lshlrev_b32 v15, 4, v15
  v_mfma_f32_16x16x32_bf16 v[36:39], a[180:183], a[132:135], v[36:39]
  buffer_load_dwordx4 a[196:199], v12, s[8:11], s62 offen offset:0 sc1
  s_lshl_b32 s53, s51, 9
  v_mov_b32 v14, s53
  v_mfma_f32_16x16x32_bf16 v[40:43], a[180:183], a[136:139], v[40:43]
  ds_read_b64_tr_b16 a[174:175], v2 offset:38912
  s_lshl_b32 s55, s51, 3
  v_mfma_f32_16x16x32_bf16 v[40:43], a[176:179], a[152:155], v[40:43]
  s_lshr_b32 s53, 0x0b070602, s55
  s_and_b32 s53, s53, 15
  s_lshl_b32 s53, s53, 7
  v_mfma_f32_16x16x32_bf16 v[44:47], a[176:179], a[156:159], v[44:47]
  ds_read_b64_tr_b16 a[176:177], v2 offset:40960
  s_sub_u32 s53, s53, 256
  v_mfma_f32_16x16x32_bf16 v[44:47], a[180:183], a[140:143], v[44:47]
  s_waitcnt lgkmcnt(5)
  s_add_u32 s62, s63, 10240
  v_mov_b32 v24, s53
  v_mfma_f32_16x16x32_bf16 v[60:63], a[160:163], a[140:143], v[60:63]
  ds_read_b64_tr_b16 a[178:179], v2 offset:43008
  v_mfma_f32_16x16x32_bf16 v[60:63], a[164:167], a[156:159], v[60:63]
  buffer_load_dwordx4 a[200:203], v12, s[8:11], s62 offen offset:256 sc1
  v_cmp_gt_u32 vcc, 256, v15
  s_nop 1
  v_cndmask_b32 v14, v24, v14, vcc
  v_mfma_f32_16x16x32_bf16 v[56:59], a[164:167], a[152:155], v[56:59]
  ds_read_b64_tr_b16 a[180:181], v2 offset:45056
  s_lshr_b32 s53, 0x15140706, s55
  v_mfma_f32_16x16x32_bf16 v[56:59], a[160:163], a[136:139], v[56:59]
  s_add_u32 s62, s63, 12288
  s_and_b32 s53, s53, 31
  s_lshl_b32 s53, s53, 6
  v_mfma_f32_16x16x32_bf16 v[52:55], a[160:163], a[132:135], v[52:55]
  ds_read_b64_tr_b16 a[182:183], v2 offset:47104
  s_sub_u32 s53, s53, 384
  v_mfma_f32_16x16x32_bf16 v[52:55], a[164:167], a[148:151], v[52:55]
  buffer_load_dwordx4 a[204:207], v12, s[8:11], s62 offen offset:0 sc1
  v_mov_b32 v24, s53
  v_mfma_f32_16x16x32_bf16 v[48:51], a[164:167], a[144:147], v[48:51]
  ds_read_b64_tr_b16 a[164:165], v3 offset:32768
  v_mfma_f32_16x16x32_bf16 v[48:51], a[160:163], a[128:131], v[48:51]
  s_waitcnt lgkmcnt(5)
  v_cmp_gt_u32 vcc, 384, v15
  s_nop 1
  v_cndmask_b32 v14, v24, v14, vcc
  v_mfma_f32_16x16x32_bf16 v[128:131], a[168:171], a[128:131], v[128:131]
  ds_read_b64_tr_b16 a[166:167], v3 offset:34816
  v_lshrrev_b32 v24, 5, v0
  v_mfma_f32_16x16x32_bf16 v[128:131], a[172:175], a[144:147], v[128:131]
  s_add_u32 s62, s63, 12288
  v_mul_u32_u24 v24, 57344, v24
  v_add3_u32 v14, v14, v15, v24
  v_mfma_f32_16x16x32_bf16 v[132:135], a[172:175], a[148:151], v[132:135]
  ds_read_b64_tr_b16 a[160:161], v3 offset:36864
  s_mul_i32 s53, s44, 14336
  v_mfma_f32_16x16x32_bf16 v[132:135], a[168:171], a[132:135], v[132:135]
  buffer_load_dwordx4 a[208:211], v12, s[8:11], s62 offen offset:256 sc1
  s_add_u32 s53, s53, s54
  s_add_u32 s53, s53, 46137344
  v_mfma_f32_16x16x32_bf16 v[136:139], a[168:171], a[136:139], v[136:139]
  ds_read_b64_tr_b16 a[162:163], v3 offset:38912
  v_add_u32 v14, s53, v14
  v_mfma_f32_16x16x32_bf16 v[136:139], a[172:175], a[152:155], v[136:139]
  s_add_u32 s62, s63, 14336
  s_lshl_b32 s53, s44, 9
  s_add_u32 s53, s53, 131072
  v_mfma_f32_16x16x32_bf16 v[140:143], a[172:175], a[156:159], v[140:143]
  ds_read_b64_tr_b16 a[172:173], v3 offset:40960
  v_add_u32 v15, s53, v15
  v_mfma_f32_16x16x32_bf16 v[140:143], a[168:171], a[140:143], v[140:143]
  s_waitcnt lgkmcnt(5)
  buffer_load_dwordx4 a[212:215], v12, s[8:11], s62 offen offset:0 sc1
  s_and_b32 s50, s2, 4
  v_mfma_f32_16x16x32_bf16 v[156:159], a[176:179], a[140:143], v[156:159]
  ds_read_b64_tr_b16 a[174:175], v3 offset:43008
  s_lshr_b32 s53, s2, 6
  v_mfma_f32_16x16x32_bf16 v[156:159], a[180:183], a[156:159], v[156:159]
  s_add_u32 s50, s50, s53
  s_bfe_u32 s51, s2, 0x30003
  s_and_b32 s52, s2, 3
  v_mfma_f32_16x16x32_bf16 v[152:155], a[180:183], a[152:155], v[152:155]
  ds_read_b64_tr_b16 a[168:169], v3 offset:45056
  s_add_u32 s91, s50, s51
  v_mfma_f32_16x16x32_bf16 v[152:155], a[176:179], a[136:139], v[152:155]
  s_add_u32 s62, s63, 14336
  s_and_b32 s91, s91, 3
  s_lshl_b32 s53, s50, 4
  v_mfma_f32_16x16x32_bf16 v[148:151], a[176:179], a[132:135], v[148:151]
  ds_read_b64_tr_b16 a[170:171], v3 offset:47104
  s_and_b32 s54, s52, 2
  v_mfma_f32_16x16x32_bf16 v[148:151], a[180:183], a[148:151], v[148:151]
  buffer_load_dwordx4 a[216:219], v12, s[8:11], s62 offen offset:256 sc1
  s_mul_i32 s89, s54, 4293918720
  s_add_u32 s89, s89, 917504
  v_mfma_f32_16x16x32_bf16 v[144:147], a[180:183], a[144:147], v[144:147]
  ds_read_b64_tr_b16 a[180:181], v4 offset:32768
  s_lshl_b32 s54, s54, 2
  v_mfma_f32_16x16x32_bf16 v[144:147], a[176:179], a[128:131], v[144:147]
  s_waitcnt lgkmcnt(5)
  s_add_u32 s77, s77, 65536
  s_add_u32 s53, s53, s54
  v_mfma_f32_16x16x32_bf16 v[160:163], a[164:167], a[128:131], v[160:163]
  ds_read_b64_tr_b16 a[182:183], v4 offset:34816
  s_lshl_b32 s54, s44, 1
  v_mfma_f32_16x16x32_bf16 v[160:163], a[160:163], a[144:147], v[160:163]
  buffer_load_dwordx4 a[8:11], v1, s[8:11], s77 offen offset:0 sc1
  s_add_u32 s53, s53, s54
  s_mul_i32 s84, s53, 131072
  v_mfma_f32_16x16x32_bf16 v[164:167], a[160:163], a[148:151], v[164:167]
  ds_read_b64_tr_b16 a[176:177], v4 offset:36864
  s_mul_i32 s54, s52, 28672
  v_mfma_f32_16x16x32_bf16 v[164:167], a[164:167], a[132:135], v[164:167]
  s_add_u32 s84, s84, s54
  s_add_u32 s84, s84, 19922944
  s_lshl_b32 s85, s53, 15
  v_mfma_f32_16x16x32_bf16 v[168:171], a[164:167], a[136:139], v[168:171]
  ds_read_b64_tr_b16 a[178:179], v4 offset:38912
  s_lshl_b32 s51, s51, 1
  v_mfma_f32_16x16x32_bf16 v[168:171], a[160:163], a[152:155], v[168:171]
  s_and_b32 s54, s52, 1
  s_add_u32 s51, s51, s54
  s_lshl_b32 s53, s51, 7
  v_mfma_f32_16x16x32_bf16 v[172:175], a[160:163], a[156:159], v[172:175]
  ds_read_b64_tr_b16 a[160:161], v4 offset:40960
  s_add_u32 s85, s85, s53
  v_mfma_f32_16x16x32_bf16 v[172:175], a[164:167], a[140:143], v[172:175]
  s_waitcnt lgkmcnt(5)
  buffer_load_dwordx4 a[24:27], v1, s[8:11], s77 offen offset:1024 sc1
  s_lshl_b32 s88, s51, 8
  v_mfma_f32_16x16x32_bf16 v[188:191], a[172:175], a[140:143], v[188:191]
  ds_read_b64_tr_b16 a[162:163], v4 offset:43008
  s_add_u32 s88, s88, 20480
  v_mfma_f32_16x16x32_bf16 v[188:191], a[168:171], a[156:159], v[188:191]
  s_add_u32 s77, s77, 65536
  s_lshl_b32 s53, s50, 12
  s_lshl_b32 s54, s52, 8
  v_mfma_f32_16x16x32_bf16 v[184:187], a[168:171], a[152:155], v[184:187]
  ds_read_b64_tr_b16 a[164:165], v4 offset:45056
  s_add_u32 s53, s53, s54
  v_mfma_f32_16x16x32_bf16 v[184:187], a[172:175], a[136:139], v[184:187]
  buffer_load_dwordx4 a[12:15], v1, s[8:11], s77 offen offset:0 sc1
  s_add_u32 s82, s53, 688128
  s_lshl_b32 s90, s44, 12
  v_mfma_f32_16x16x32_bf16 v[180:183], a[172:175], a[132:135], v[180:183]
  ds_read_b64_tr_b16 a[166:167], v4 offset:47104
  s_add_u32 s90, s90, 135168
  v_mfma_f32_16x16x32_bf16 v[180:183], a[168:171], a[148:151], v[180:183]
  s_lshl_b32 s86, s2, 16
  s_lshl_b32 s53, s44, 14
  s_add_u32 s86, s86, s53
  v_mfma_f32_16x16x32_bf16 v[176:179], a[168:171], a[144:147], v[176:179]
  ds_read_b64_tr_b16 a[168:169], v5 offset:32768
  s_add_u32 s86, s86, 67108864
  v_mfma_f32_16x16x32_bf16 v[176:179], a[172:175], a[128:131], v[176:179]
  s_waitcnt lgkmcnt(5)
  s_lshr_b32 s53, s2, 3
  s_lshl_b32 s53, s53, 2
  v_mfma_f32_16x16x32_bf16 v[192:195], a[180:183], a[128:131], v[192:195]
  ds_read_b64_tr_b16 a[170:171], v5 offset:34816
  s_add_u32 s53, s53, s44
  v_mfma_f32_16x16x32_bf16 v[192:195], a[176:179], a[144:147], v[192:195]
  buffer_load_dwordx4 a[28:31], v1, s[8:11], s77 offen offset:1024 sc1
  s_mul_i32 s92, s53, 14336
  s_mul_i32 s53, s52, 1835008
  v_mfma_f32_16x16x32_bf16 v[196:199], a[176:179], a[148:151], v[196:199]
  ds_read_b64_tr_b16 a[172:173], v5 offset:36864
  s_add_u32 s92, s92, s53
  v_mfma_f32_16x16x32_bf16 v[196:199], a[180:183], a[132:135], v[196:199]
  s_cmp_eq_u32 s56, 2
  s_cselect_b32 s78, 10, 6
  s_mul_i32 s70, s78, 458752
  s_lshl_b32 s78, s78, 11
  s_add_u32 s78, s78, s57
  s_add_u32 m0, s45, 81920
  s_nop 0
  v_mfma_f32_16x16x32_bf16 v[200:203], a[180:183], a[136:139], v[200:203]
  ds_read_b64_tr_b16 a[174:175], v5 offset:38912
  v_mfma_f32_16x16x32_bf16 v[200:203], a[176:179], a[152:155], v[200:203]
  buffer_load_dwordx4 v11, s[28:31], s70 offen lds
  v_mfma_f32_16x16x32_bf16 v[204:207], a[176:179], a[156:159], v[204:207]
  ds_read_b64_tr_b16 a[176:177], v5 offset:40960
  v_mfma_f32_16x16x32_bf16 v[204:207], a[180:183], a[140:143], v[204:207]
  s_waitcnt lgkmcnt(5)
  v_mfma_f32_16x16x32_bf16 v[220:223], a[160:163], a[140:143], v[220:223]
  ds_read_b64_tr_b16 a[178:179], v5 offset:43008
  v_mfma_f32_16x16x32_bf16 v[220:223], a[164:167], a[156:159], v[220:223]
  s_add_u32 m0, s45, 90112
  v_mfma_f32_16x16x32_bf16 v[216:219], a[164:167], a[152:155], v[216:219]
  ds_read_b64_tr_b16 a[180:181], v5 offset:45056
  v_mfma_f32_16x16x32_bf16 v[216:219], a[160:163], a[136:139], v[216:219]
  buffer_load_dwordx4 v11, s[32:35], s70 offen lds
  v_mfma_f32_16x16x32_bf16 v[212:215], a[160:163], a[132:135], v[212:215]
  ds_read_b64_tr_b16 a[182:183], v5 offset:47104
  v_add_u32 v9, s46, v0
  s_waitcnt vmcnt(13)
  s_barrier
  s_mov_b64 exec, 1
  buffer_store_dword v9, v0, s[8:11], s80 offen offset:0 sc1
  s_mov_b64 exec, -1
  s_sub_u32 s80, s80, 196608
  v_mfma_f32_16x16x32_bf16 v[212:215], a[164:167], a[148:151], v[212:215]
  s_waitcnt vmcnt(20)
  s_barrier
  v_mfma_f32_16x16x32_bf16 v[208:211], a[164:167], a[144:147], v[208:211]
  ds_read_b64_tr_b16 a[164:165], v6 offset:49152
  s_add_u32 m0, s45, 86016
  s_add_u32 s61, s70, 229376
  v_mfma_f32_16x16x32_bf16 v[208:211], a[160:163], a[128:131], v[208:211]
  s_waitcnt lgkmcnt(5)
  buffer_load_dwordx4 v11, s[28:31], s61 offen lds
  v_mfma_f32_16x16x32_bf16 v[224:227], a[168:171], a[128:131], v[224:227]
  ds_read_b64_tr_b16 a[166:167], v6 offset:51200
  v_mfma_f32_16x16x32_bf16 v[224:227], a[172:175], a[144:147], v[224:227]
  v_mfma_f32_16x16x32_bf16 v[228:231], a[172:175], a[148:151], v[228:231]
  ds_read_b64_tr_b16 a[160:161], v6 offset:53248
  v_mfma_f32_16x16x32_bf16 v[228:231], a[168:171], a[132:135], v[228:231]
  s_add_u32 m0, s45, 94208
  s_add_u32 s61, s70, 229376
  v_mfma_f32_16x16x32_bf16 v[232:235], a[168:171], a[136:139], v[232:235]
  ds_read_b64_tr_b16 a[162:163], v6 offset:55296
  v_mfma_f32_16x16x32_bf16 v[232:235], a[172:175], a[152:155], v[232:235]
  buffer_load_dwordx4 v11, s[32:35], s61 offen lds
  v_mfma_f32_16x16x32_bf16 v[236:239], a[172:175], a[156:159], v[236:239]
  ds_read_b64_tr_b16 a[172:173], v6 offset:57344
  v_mfma_f32_16x16x32_bf16 v[236:239], a[168:171], a[140:143], v[236:239]
  s_waitcnt lgkmcnt(5)
  s_add_u32 m0, s45, 16384
  v_mfma_f32_16x16x32_bf16 v[252:255], a[176:179], a[140:143], v[252:255]
  ds_read_b64_tr_b16 a[174:175], v6 offset:59392
  v_mfma_f32_16x16x32_bf16 v[252:255], a[180:183], a[156:159], v[252:255]
  buffer_load_dwordx4 v10, s[28:31], s70 offen lds
  v_mfma_f32_16x16x32_bf16 v[248:251], a[180:183], a[152:155], v[248:251]
  ds_read_b64_tr_b16 a[168:169], v6 offset:61440
  v_mfma_f32_16x16x32_bf16 v[248:251], a[176:179], a[136:139], v[248:251]
  v_mfma_f32_16x16x32_bf16 v[244:247], a[176:179], a[132:135], v[244:247]
  ds_read_b64_tr_b16 a[170:171], v6 offset:63488
  v_mfma_f32_16x16x32_bf16 v[244:247], a[180:183], a[148:151], v[244:247]
  s_add_u32 m0, s45, 24576
  v_mfma_f32_16x16x32_bf16 v[240:243], a[180:183], a[144:147], v[240:243]
  ds_read_b64_tr_b16 a[180:181], v7 offset:49152
  v_mfma_f32_16x16x32_bf16 v[240:243], a[176:179], a[128:131], v[240:243]
  s_waitcnt vmcnt(6) lgkmcnt(5)
  buffer_load_dwordx4 v10, s[32:35], s70 offen lds
  v_mfma_f32_16x16x32_bf16 v[64:67], a[164:167], a[0:3], v[64:67]
  ds_read_b64_tr_b16 a[182:183], v7 offset:51200
  v_mfma_f32_16x16x32_bf16 v[64:67], a[160:163], a[16:19], v[64:67]
  s_add_u32 m0, s45, 20480
  s_add_u32 s61, s70, 229376
  v_mfma_f32_16x16x32_bf16 v[68:71], a[160:163], a[20:23], v[68:71]
  ds_read_b64_tr_b16 a[176:177], v7 offset:53248
  v_mfma_f32_16x16x32_bf16 v[68:71], a[164:167], a[4:7], v[68:71]
  buffer_load_dwordx4 v10, s[28:31], s61 offen lds
  v_mfma_f32_16x16x32_bf16 v[72:75], a[164:167], a[8:11], v[72:75]
  ds_read_b64_tr_b16 a[178:179], v7 offset:55296
  v_mfma_f32_16x16x32_bf16 v[72:75], a[160:163], a[24:27], v[72:75]
  v_mfma_f32_16x16x32_bf16 v[76:79], a[160:163], a[28:31], v[76:79]
  ds_read_b64_tr_b16 a[160:161], v7 offset:57344
  v_mfma_f32_16x16x32_bf16 v[76:79], a[164:167], a[12:15], v[76:79]
  s_waitcnt lgkmcnt(5)
  s_add_u32 m0, s45, 28672
  s_add_u32 s61, s70, 229376
  v_mfma_f32_16x16x32_bf16 v[92:95], a[172:175], a[12:15], v[92:95]
  ds_read_b64_tr_b16 a[162:163], v7 offset:59392
  v_mfma_f32_16x16x32_bf16 v[92:95], a[168:171], a[28:31], v[92:95]
  buffer_load_dwordx4 v10, s[32:35], s61 offen lds
  v_mfma_f32_16x16x32_bf16 v[88:91], a[168:171], a[24:27], v[88:91]
  ds_read_b64_tr_b16 a[164:165], v7 offset:61440
  s_waitcnt vmcnt(13)
  v_mfma_f32_16x16x32_bf16 v[88:91], a[172:175], a[8:11], v[88:91]
  v_accvgpr_read_b32 v24, a188
  v_accvgpr_read_b32 v25, a189
  v_mfma_f32_16x16x32_bf16 v[84:87], a[172:175], a[4:7], v[84:87]
  ds_read_b64_tr_b16 a[166:167], v7 offset:63488
  v_accvgpr_read_b32 v26, a190
  v_mfma_f32_16x16x32_bf16 v[84:87], a[168:171], a[20:23], v[84:87]
  buffer_load_dwordx4 a[32:35], v1, s[8:11], s78 offen offset:0 sc1
  v_accvgpr_read_b32 v27, a191
  v_accvgpr_read_b32 v28, a192
  v_mfma_f32_16x16x32_bf16 v[80:83], a[168:171], a[16:19], v[80:83]
  ds_read_b64_tr_b16 a[168:169], v8 offset:49152
  v_accvgpr_read_b32 v29, a193
  v_mfma_f32_16x16x32_bf16 v[80:83], a[172:175], a[0:3], v[80:83]
  s_waitcnt lgkmcnt(5)
  v_accvgpr_read_b32 v30, a194
  v_accvgpr_read_b32 v31, a195
  v_mfma_f32_16x16x32_bf16 v[96:99], a[180:183], a[0:3], v[96:99]
  ds_read_b64_tr_b16 a[170:171], v8 offset:51200
  v_add_f32 v16, v16, v24
  v_mfma_f32_16x16x32_bf16 v[96:99], a[176:179], a[16:19], v[96:99]
  v_add_f32 v17, v17, v25
  v_add_f32 v18, v18, v26
  v_mfma_f32_16x16x32_bf16 v[100:103], a[176:179], a[20:23], v[100:103]
  ds_read_b64_tr_b16 a[172:173], v8 offset:53248
  v_add_f32 v19, v19, v27
  v_mfma_f32_16x16x32_bf16 v[100:103], a[180:183], a[4:7], v[100:103]
  buffer_load_dwordx4 a[48:51], v1, s[8:11], s78 offen offset:1024 sc1
  v_add_f32 v20, v20, v28
  v_add_f32 v21, v21, v29
  v_mfma_f32_16x16x32_bf16 v[104:107], a[180:183], a[8:11], v[104:107]
  ds_read_b64_tr_b16 a[174:175], v8 offset:55296
  v_add_f32 v22, v22, v30
  v_mfma_f32_16x16x32_bf16 v[104:107], a[176:179], a[24:27], v[104:107]
  s_add_u32 s78, s78, 65536
  v_add_f32 v23, v23, v31
  v_accvgpr_read_b32 v24, a196
  v_mfma_f32_16x16x32_bf16 v[108:111], a[176:179], a[28:31], v[108:111]
  ds_read_b64_tr_b16 a[176:177], v8 offset:57344
  v_accvgpr_read_b32 v25, a197
  v_mfma_f32_16x16x32_bf16 v[108:111], a[180:183], a[12:15], v[108:111]
  s_waitcnt lgkmcnt(5)
  buffer_load_dwordx4 a[36:39], v1, s[8:11], s78 offen offset:0 sc1
  v_accvgpr_read_b32 v26, a198
  v_mfma_f32_16x16x32_bf16 v[124:127], a[160:163], a[12:15], v[124:127]
  ds_read_b64_tr_b16 a[178:179], v8 offset:59392
  v_accvgpr_read_b32 v27, a199
  v_mfma_f32_16x16x32_bf16 v[124:127], a[164:167], a[28:31], v[124:127]
  v_accvgpr_read_b32 v28, a200
  v_accvgpr_read_b32 v29, a201
  v_mfma_f32_16x16x32_bf16 v[120:123], a[164:167], a[24:27], v[120:123]
  ds_read_b64_tr_b16 a[180:181], v8 offset:61440
  v_accvgpr_read_b32 v30, a202
  v_mfma_f32_16x16x32_bf16 v[120:123], a[160:163], a[8:11], v[120:123]
  v_accvgpr_read_b32 v31, a203
  v_add_f32 v16, v16, v24
  v_mfma_f32_16x16x32_bf16 v[116:119], a[160:163], a[4:7], v[116:119]
  ds_read_b64_tr_b16 a[182:183], v8 offset:63488
  v_add_f32 v17, v17, v25
  v_mfma_f32_16x16x32_bf16 v[116:119], a[164:167], a[20:23], v[116:119]
  buffer_load_dwordx4 a[52:55], v1, s[8:11], s78 offen offset:1024 sc1
  v_add_f32 v18, v18, v26
  v_add_f32 v19, v19, v27
  v_mfma_f32_16x16x32_bf16 v[112:115], a[164:167], a[16:19], v[112:115]
  ds_read_b64_tr_b16 a[164:165], v2 offset:49152
  v_add_f32 v20, v20, v28
  v_mfma_f32_16x16x32_bf16 v[112:115], a[160:163], a[0:3], v[112:115]
  s_waitcnt lgkmcnt(5)
  s_add_u32 s78, s78, 65536
  v_add_f32 v21, v21, v29
  v_mfma_f32_16x16x32_bf16 v[32:35], a[168:171], a[0:3], v[32:35]
  ds_read_b64_tr_b16 a[166:167], v2 offset:51200
  v_add_f32 v22, v22, v30
  v_mfma_f32_16x16x32_bf16 v[32:35], a[172:175], a[16:19], v[32:35]
  buffer_load_dwordx4 a[40:43], v1, s[8:11], s78 offen offset:0 sc1
  v_add_f32 v23, v23, v31
  v_accvgpr_read_b32 v24, a204
  v_mfma_f32_16x16x32_bf16 v[36:39], a[172:175], a[20:23], v[36:39]
  ds_read_b64_tr_b16 a[160:161], v2 offset:53248
  v_accvgpr_read_b32 v25, a205
  v_mfma_f32_16x16x32_bf16 v[36:39], a[168:171], a[4:7], v[36:39]
  v_accvgpr_read_b32 v26, a206
  v_accvgpr_read_b32 v27, a207
  v_mfma_f32_16x16x32_bf16 v[40:43], a[168:171], a[8:11], v[40:43]
  ds_read_b64_tr_b16 a[162:163], v2 offset:55296
  v_accvgpr_read_b32 v28, a208
  v_mfma_f32_16x16x32_bf16 v[40:43], a[172:175], a[24:27], v[40:43]
  v_accvgpr_read_b32 v29, a209
  v_accvgpr_read_b32 v30, a210
  v_mfma_f32_16x16x32_bf16 v[44:47], a[172:175], a[28:31], v[44:47]
  ds_read_b64_tr_b16 a[172:173], v2 offset:57344
  v_accvgpr_read_b32 v31, a211
  v_mfma_f32_16x16x32_bf16 v[44:47], a[168:171], a[12:15], v[44:47]
  s_waitcnt lgkmcnt(5)
  buffer_load_dwordx4 a[56:59], v1, s[8:11], s78 offen offset:1024 sc1
  v_add_f32 v16, v16, v24
  v_mfma_f32_16x16x32_bf16 v[60:63], a[176:179], a[12:15], v[60:63]
  ds_read_b64_tr_b16 a[174:175], v2 offset:59392
  v_add_f32 v17, v17, v25
  v_mfma_f32_16x16x32_bf16 v[60:63], a[180:183], a[28:31], v[60:63]
  s_add_u32 s78, s78, 65536
  v_add_f32 v18, v18, v26
  v_add_f32 v19, v19, v27
  v_mfma_f32_16x16x32_bf16 v[56:59], a[180:183], a[24:27], v[56:59]
  ds_read_b64_tr_b16 a[168:169], v2 offset:61440
  v_add_f32 v20, v20, v28
  v_mfma_f32_16x16x32_bf16 v[56:59], a[176:179], a[8:11], v[56:59]
  buffer_load_dwordx4 a[44:47], v1, s[8:11], s78 offen offset:0 sc1
  v_add_f32 v21, v21, v29
  v_add_f32 v22, v22, v30
  v_mfma_f32_16x16x32_bf16 v[52:55], a[176:179], a[4:7], v[52:55]
  ds_read_b64_tr_b16 a[170:171], v2 offset:63488
  v_add_f32 v23, v23, v31
  v_mfma_f32_16x16x32_bf16 v[52:55], a[180:183], a[20:23], v[52:55]
  v_accvgpr_read_b32 v24, a212
  v_accvgpr_read_b32 v25, a213
  v_mfma_f32_16x16x32_bf16 v[48:51], a[180:183], a[16:19], v[48:51]
  ds_read_b64_tr_b16 a[180:181], v3 offset:49152
  v_accvgpr_read_b32 v26, a214
  v_mfma_f32_16x16x32_bf16 v[48:51], a[176:179], a[0:3], v[48:51]
  s_waitcnt lgkmcnt(5)
  v_accvgpr_read_b32 v27, a215
  v_accvgpr_read_b32 v28, a216
  v_mfma_f32_16x16x32_bf16 v[128:131], a[164:167], a[0:3], v[128:131]
  ds_read_b64_tr_b16 a[182:183], v3 offset:51200
  v_accvgpr_read_b32 v29, a217
  v_mfma_f32_16x16x32_bf16 v[128:131], a[160:163], a[16:19], v[128:131]
  buffer_load_dwordx4 a[60:63], v1, s[8:11], s78 offen offset:1024 sc1
  v_accvgpr_read_b32 v30, a218
  v_accvgpr_read_b32 v31, a219
  v_mfma_f32_16x16x32_bf16 v[132:135], a[160:163], a[20:23], v[132:135]
  ds_read_b64_tr_b16 a[176:177], v3 offset:53248
  v_add_f32 v16, v16, v24
  v_mfma_f32_16x16x32_bf16 v[132:135], a[164:167], a[4:7], v[132:135]
  s_cmp_eq_u32 s56, 3
  s_cselect_b32 s79, 11, 7
  s_mul_i32 s71, s79, 458752
  s_lshl_b32 s79, s79, 11
  s_add_u32 s79, s79, s57
  s_add_u32 m0, s45, 65536
  v_add_f32 v17, v17, v25
  v_add_f32 v18, v18, v26
  v_mfma_f32_16x16x32_bf16 v[136:139], a[164:167], a[8:11], v[136:139]
  ds_read_b64_tr_b16 a[178:179], v3 offset:55296
  v_add_f32 v19, v19, v27
  v_mfma_f32_16x16x32_bf16 v[136:139], a[160:163], a[24:27], v[136:139]
  buffer_load_dwordx4 v11, s[28:31], s71 offen lds
  v_add_f32 v20, v20, v28
  v_add_f32 v21, v21, v29
  v_mfma_f32_16x16x32_bf16 v[140:143], a[160:163], a[28:31], v[140:143]
  ds_read_b64_tr_b16 a[160:161], v3 offset:57344
  v_add_f32 v22, v22, v30
  v_mfma_f32_16x16x32_bf16 v[140:143], a[164:167], a[12:15], v[140:143]
  s_waitcnt lgkmcnt(5)
  v_add_f32 v23, v23, v31
  v_mov_b32 v24, v16
  v_mfma_f32_16x16x32_bf16 v[156:159], a[172:175], a[12:15], v[156:159]
  ds_read_b64_tr_b16 a[162:163], v3 offset:59392
  v_mov_b32 v25, v17
  v_mfma_f32_16x16x32_bf16 v[156:159], a[168:171], a[28:31], v[156:159]
  s_add_u32 m0, s45, 73728
  v_mov_b32 v26, v18
  v_mov_b32 v27, v19
  v_mfma_f32_16x16x32_bf16 v[152:155], a[168:171], a[24:27], v[152:155]
  ds_read_b64_tr_b16 a[164:165], v3 offset:61440
  v_mov_b32 v28, v20
  v_mfma_f32_16x16x32_bf16 v[152:155], a[172:175], a[8:11], v[152:155]
  buffer_load_dwordx4 v11, s[32:35], s71 offen lds
  v_mov_b32 v29, v21
  v_mov_b32 v30, v22
  v_mfma_f32_16x16x32_bf16 v[148:151], a[172:175], a[4:7], v[148:151]
  ds_read_b64_tr_b16 a[166:167], v3 offset:63488
  v_mov_b32 v31, v23
  v_mfma_f32_16x16x32_bf16 v[148:151], a[168:171], a[20:23], v[148:151]
  s_add_u32 m0, s45, 69632
  s_add_u32 s61, s71, 229376
  v_mfma_f32_16x16x32_bf16 v[144:147], a[168:171], a[16:19], v[144:147]
  ds_read_b64_tr_b16 a[168:169], v4 offset:49152
  v_mfma_f32_16x16x32_bf16 v[144:147], a[172:175], a[0:3], v[144:147]
  s_waitcnt lgkmcnt(5)
  buffer_load_dwordx4 v11, s[28:31], s61 offen lds
  v_mfma_f32_16x16x32_bf16 v[160:163], a[180:183], a[0:3], v[160:163]
  ds_read_b64_tr_b16 a[170:171], v4 offset:51200
  v_mfma_f32_16x16x32_bf16 v[160:163], a[176:179], a[16:19], v[160:163]
  v_permlane16_swap_b32 v16, v24
  v_mfma_f32_16x16x32_bf16 v[164:167], a[176:179], a[20:23], v[164:167]
  ds_read_b64_tr_b16 a[172:173], v4 offset:53248
  v_mfma_f32_16x16x32_bf16 v[164:167], a[180:183], a[4:7], v[164:167]
  s_add_u32 m0, s45, 77824
  s_add_u32 s61, s71, 229376
  v_mfma_f32_16x16x32_bf16 v[168:171], a[180:183], a[8:11], v[168:171]
  ds_read_b64_tr_b16 a[174:175], v4 offset:55296
  v_mfma_f32_16x16x32_bf16 v[168:171], a[176:179], a[24:27], v[168:171]
  buffer_load_dwordx4 v11, s[32:35], s61 offen lds
  v_permlane16_swap_b32 v17, v25
  v_mfma_f32_16x16x32_bf16 v[172:175], a[176:179], a[28:31], v[172:175]
  ds_read_b64_tr_b16 a[176:177], v4 offset:57344
  v_mfma_f32_16x16x32_bf16 v[172:175], a[180:183], a[12:15], v[172:175]
  s_waitcnt lgkmcnt(5)
  s_add_u32 m0, s45, 0
  v_mfma_f32_16x16x32_bf16 v[188:191], a[160:163], a[12:15], v[188:191]
  ds_read_b64_tr_b16 a[178:179], v4 offset:59392
  v_mfma_f32_16x16x32_bf16 v[188:191], a[164:167], a[28:31], v[188:191]
  buffer_load_dwordx4 v10, s[28:31], s71 offen lds
  v_permlane16_swap_b32 v18, v26
  v_mfma_f32_16x16x32_bf16 v[184:187], a[164:167], a[24:27], v[184:187]
  ds_read_b64_tr_b16 a[180:181], v4 offset:61440
  v_mfma_f32_16x16x32_bf16 v[184:187], a[160:163], a[8:11], v[184:187]
  v_permlane16_swap_b32 v19, v27
  v_mfma_f32_16x16x32_bf16 v[180:183], a[160:163], a[4:7], v[180:183]
  ds_read_b64_tr_b16 a[182:183], v4 offset:63488
  v_mfma_f32_16x16x32_bf16 v[180:183], a[164:167], a[20:23], v[180:183]
  s_add_u32 m0, s45, 8192
  v_permlane16_swap_b32 v20, v28
  v_mfma_f32_16x16x32_bf16 v[176:179], a[164:167], a[16:19], v[176:179]
  ds_read_b64_tr_b16 a[164:165], v5 offset:49152
  v_mfma_f32_16x16x32_bf16 v[176:179], a[160:163], a[0:3], v[176:179]
  s_waitcnt lgkmcnt(5)
  buffer_load_dwordx4 v10, s[32:35], s71 offen lds
  v_mfma_f32_16x16x32_bf16 v[192:195], a[168:171], a[0:3], v[192:195]
  ds_read_b64_tr_b16 a[166:167], v5 offset:51200
  v_mfma_f32_16x16x32_bf16 v[192:195], a[172:175], a[16:19], v[192:195]
  s_add_u32 m0, s45, 4096
  s_add_u32 s61, s71, 229376
  v_mfma_f32_16x16x32_bf16 v[196:199], a[172:175], a[20:23], v[196:199]
  ds_read_b64_tr_b16 a[160:161], v5 offset:53248
  v_permlane16_swap_b32 v21, v29
  v_mfma_f32_16x16x32_bf16 v[196:199], a[168:171], a[4:7], v[196:199]
  buffer_load_dwordx4 v10, s[28:31], s61 offen lds
  v_permlane16_swap_b32 v22, v30
  v_mfma_f32_16x16x32_bf16 v[200:203], a[168:171], a[8:11], v[200:203]
  ds_read_b64_tr_b16 a[162:163], v5 offset:55296
  v_mfma_f32_16x16x32_bf16 v[200:203], a[172:175], a[24:27], v[200:203]
  v_permlane16_swap_b32 v23, v31
  v_mfma_f32_16x16x32_bf16 v[204:207], a[172:175], a[28:31], v[204:207]
  ds_read_b64_tr_b16 a[172:173], v5 offset:57344
  v_add_f32 v16, v16, v24
  v_mfma_f32_16x16x32_bf16 v[204:207], a[168:171], a[12:15], v[204:207]
  s_waitcnt lgkmcnt(5)
  s_add_u32 m0, s45, 12288
  s_add_u32 s61, s71, 229376
  v_mfma_f32_16x16x32_bf16 v[220:223], a[176:179], a[12:15], v[220:223]
  ds_read_b64_tr_b16 a[174:175], v5 offset:59392
  v_add_f32 v17, v17, v25
  v_mfma_f32_16x16x32_bf16 v[220:223], a[180:183], a[28:31], v[220:223]
  buffer_load_dwordx4 v10, s[32:35], s61 offen lds
  v_add_f32 v18, v18, v26
  v_add_f32 v19, v19, v27
  v_mfma_f32_16x16x32_bf16 v[216:219], a[180:183], a[24:27], v[216:219]
  ds_read_b64_tr_b16 a[168:169], v5 offset:61440
  v_add_f32 v20, v20, v28
  v_mfma_f32_16x16x32_bf16 v[216:219], a[176:179], a[8:11], v[216:219]
  v_add_f32 v21, v21, v29
  v_add_f32 v22, v22, v30
  v_mfma_f32_16x16x32_bf16 v[212:215], a[176:179], a[4:7], v[212:215]
  ds_read_b64_tr_b16 a[170:171], v5 offset:63488
  v_add_f32 v23, v23, v31
  v_mfma_f32_16x16x32_bf16 v[212:215], a[180:183], a[20:23], v[212:215]
  buffer_load_dwordx4 a[64:67], v1, s[8:11], s79 offen offset:0 sc1
  s_waitcnt vmcnt(17)
  s_barrier
  v_mfma_f32_16x16x32_bf16 v[208:211], a[180:183], a[16:19], v[208:211]
  ds_read_b64_tr_b16 a[180:181], v6 offset:16384
  v_mov_b32 v24, v16
  v_mfma_f32_16x16x32_bf16 v[208:211], a[176:179], a[0:3], v[208:211]
  s_waitcnt lgkmcnt(5)
  v_mov_b32 v25, v17
  v_mov_b32 v26, v18
  v_mfma_f32_16x16x32_bf16 v[224:227], a[164:167], a[0:3], v[224:227]
  ds_read_b64_tr_b16 a[182:183], v6 offset:18432
  v_mov_b32 v27, v19
  v_mfma_f32_16x16x32_bf16 v[224:227], a[160:163], a[16:19], v[224:227]
  v_mov_b32 v28, v20
  v_mov_b32 v29, v21
  v_mfma_f32_16x16x32_bf16 v[228:231], a[160:163], a[20:23], v[228:231]
  ds_read_b64_tr_b16 a[176:177], v6 offset:20480
  v_mov_b32 v30, v22
  v_mfma_f32_16x16x32_bf16 v[228:231], a[164:167], a[4:7], v[228:231]
  buffer_load_dwordx4 a[80:83], v1, s[8:11], s79 offen offset:1024 sc1
  v_mov_b32 v31, v23
  v_mfma_f32_16x16x32_bf16 v[232:235], a[164:167], a[8:11], v[232:235]
  ds_read_b64_tr_b16 a[178:179], v6 offset:22528
  v_mfma_f32_16x16x32_bf16 v[232:235], a[160:163], a[24:27], v[232:235]
  s_add_u32 s79, s79, 65536
  v_permlane32_swap_b32 v16, v24
  v_mfma_f32_16x16x32_bf16 v[236:239], a[160:163], a[28:31], v[236:239]
  ds_read_b64_tr_b16 a[160:161], v6 offset:24576
  v_mfma_f32_16x16x32_bf16 v[236:239], a[164:167], a[12:15], v[236:239]
  s_waitcnt lgkmcnt(5)
  buffer_load_dwordx4 a[68:71], v1, s[8:11], s79 offen offset:0 sc1
  v_mfma_f32_16x16x32_bf16 v[252:255], a[172:175], a[12:15], v[252:255]
HOP10:
  s_cbranch_execz HOP14
  ds_read_b64_tr_b16 a[162:163], v6 offset:26624
  v_mfma_f32_16x16x32_bf16 v[252:255], a[168:171], a[28:31], v[252:255]
  v_permlane32_swap_b32 v17, v25
  v_mfma_f32_16x16x32_bf16 v[248:251], a[168:171], a[24:27], v[248:251]
  ds_read_b64_tr_b16 a[164:165], v6 offset:28672
  v_mfma_f32_16x16x32_bf16 v[248:251], a[172:175], a[8:11], v[248:251]
  v_permlane32_swap_b32 v18, v26
  v_mfma_f32_16x16x32_bf16 v[244:247], a[172:175], a[4:7], v[244:247]
  ds_read_b64_tr_b16 a[166:167], v6 offset:30720
  v_mfma_f32_16x16x32_bf16 v[244:247], a[168:171], a[20:23], v[244:247]
  buffer_load_dwordx4 a[84:87], v1, s[8:11], s79 offen offset:1024 sc1
  v_permlane32_swap_b32 v19, v27
  v_mfma_f32_16x16x32_bf16 v[240:243], a[168:171], a[16:19], v[240:243]
  ds_read_b64_tr_b16 a[168:169], v7 offset:16384
  v_mfma_f32_16x16x32_bf16 v[240:243], a[172:175], a[0:3], v[240:243]
  s_waitcnt vmcnt(12) lgkmcnt(5)
  s_add_u32 s79, s79, 65536
  v_mfma_f32_16x16x32_bf16 v[64:67], a[180:183], a[32:35], v[64:67]
  ds_read_b64_tr_b16 a[170:171], v7 offset:18432
  v_mfma_f32_16x16x32_bf16 v[64:67], a[176:179], a[48:51], v[64:67]
  buffer_load_dwordx4 a[72:75], v1, s[8:11], s79 offen offset:0 sc1
  v_permlane32_swap_b32 v20, v28
  v_mfma_f32_16x16x32_bf16 v[68:71], a[176:179], a[52:55], v[68:71]
  ds_read_b64_tr_b16 a[172:173], v7 offset:20480
  v_mfma_f32_16x16x32_bf16 v[68:71], a[180:183], a[36:39], v[68:71]
  v_permlane32_swap_b32 v21, v29
  v_mfma_f32_16x16x32_bf16 v[72:75], a[180:183], a[40:43], v[72:75]
  ds_read_b64_tr_b16 a[174:175], v7 offset:22528
  v_mfma_f32_16x16x32_bf16 v[72:75], a[176:179], a[56:59], v[72:75]
  v_permlane32_swap_b32 v22, v30
  v_mfma_f32_16x16x32_bf16 v[76:79], a[176:179], a[60:63], v[76:79]
  ds_read_b64_tr_b16 a[176:177], v7 offset:24576
  v_mfma_f32_16x16x32_bf16 v[76:79], a[180:183], a[44:47], v[76:79]
  s_waitcnt lgkmcnt(5)
  buffer_load_dwordx4 a[88:91], v1, s[8:11], s79 offen offset:1024 sc1
  v_mfma_f32_16x16x32_bf16 v[92:95], a[160:163], a[44:47], v[92:95]
  ds_read_b64_tr_b16 a[178:179], v7 offset:26624
  v_mfma_f32_16x16x32_bf16 v[92:95], a[164:167], a[60:63], v[92:95]
  s_add_u32 s79, s79, 65536
  v_permlane32_swap_b32 v23, v31
  v_mfma_f32_16x16x32_bf16 v[88:91], a[164:167], a[56:59], v[88:91]
  ds_read_b64_tr_b16 a[180:181], v7 offset:28672
  v_add_f32 v16, v16, v24
  v_mfma_f32_16x16x32_bf16 v[88:91], a[160:163], a[40:43], v[88:91]
  buffer_load_dwordx4 a[76:79], v1, s[8:11], s79 offen offset:0 sc1
  v_add_f32 v17, v17, v25
  v_add_f32 v18, v18, v26
  v_mfma_f32_16x16x32_bf16 v[84:87], a[160:163], a[36:39], v[84:87]
  ds_read_b64_tr_b16 a[182:183], v7 offset:30720
  v_add_f32 v19, v19, v27
  v_mfma_f32_16x16x32_bf16 v[84:87], a[164:167], a[52:55], v[84:87]
  s_lshl_b32 s83, s44, 28
  buffer_load_dword v9, v13, s[8:11], s83 offen sc1
  v_mfma_f32_16x16x32_bf16 v[80:83], a[164:167], a[48:51], v[80:83]
  ds_read_b64_tr_b16 a[164:165], v8 offset:16384
  v_add_f32 v20, v20, v28
  v_mfma_f32_16x16x32_bf16 v[80:83], a[160:163], a[32:35], v[80:83]
  s_waitcnt lgkmcnt(5)
  v_add_f32 v21, v21, v29
  v_add_f32 v22, v22, v30
  v_mfma_f32_16x16x32_bf16 v[96:99], a[168:171], a[32:35], v[96:99]
  ds_read_b64_tr_b16 a[166:167], v8 offset:18432
  v_add_f32 v23, v23, v31
  v_mfma_f32_16x16x32_bf16 v[96:99], a[172:175], a[48:51], v[96:99]
  buffer_load_dwordx4 a[92:95], v1, s[8:11], s79 offen offset:1024 sc1
  v_mul_f32 v16, 0x3a800000, v16
  v_mul_f32 v18, 0x3a800000, v18
  v_mfma_f32_16x16x32_bf16 v[100:103], a[172:175], a[52:55], v[100:103]
  ds_read_b64_tr_b16 a[160:161], v8 offset:20480
  v_mul_f32 v20, 0x3a800000, v20
  v_mfma_f32_16x16x32_bf16 v[100:103], a[168:171], a[36:39], v[100:103]
  s_cmp_eq_u32 s56, 0
  s_cselect_b32 s72, 12, 8
  s_mul_i32 s64, s72, 458752
  s_lshl_b32 s72, s72, 11
  s_add_u32 s72, s72, s57
  s_add_u32 m0, s45, 98304
  v_mul_f32 v22, 0x3a800000, v22
  v_mul_f32 v17, 0x3a800000, v17
  v_mfma_f32_16x16x32_bf16 v[104:107], a[168:171], a[40:43], v[104:107]
  ds_read_b64_tr_b16 a[162:163], v8 offset:22528
  v_mul_f32 v19, 0x3a800000, v19
  v_mfma_f32_16x16x32_bf16 v[104:107], a[172:175], a[56:59], v[104:107]
  buffer_load_dwordx4 v11, s[28:31], s64 offen lds
  v_mul_f32 v21, 0x3a800000, v21
  v_mul_f32 v23, 0x3a800000, v23
  v_mfma_f32_16x16x32_bf16 v[108:111], a[172:175], a[60:63], v[108:111]
  ds_read_b64_tr_b16 a[172:173], v8 offset:24576
  v_fma_f32 v17, -v16, v16, v17
  v_mfma_f32_16x16x32_bf16 v[108:111], a[168:171], a[44:47], v[108:111]
  s_waitcnt lgkmcnt(5)
  v_fma_f32 v19, -v18, v18, v19
  v_fma_f32 v21, -v20, v20, v21
  v_mfma_f32_16x16x32_bf16 v[124:127], a[176:179], a[44:47], v[124:127]
  ds_read_b64_tr_b16 a[174:175], v8 offset:26624
  v_fma_f32 v23, -v22, v22, v23
  v_mfma_f32_16x16x32_bf16 v[124:127], a[180:183], a[60:63], v[124:127]
  s_add_u32 m0, s45, 106496
  v_max_f32 v17, 0, v17
  v_max_f32 v19, 0, v19
  v_mfma_f32_16x16x32_bf16 v[120:123], a[180:183], a[56:59], v[120:123]
  ds_read_b64_tr_b16 a[168:169], v8 offset:28672
  v_max_f32 v21, 0, v21
  v_mfma_f32_16x16x32_bf16 v[120:123], a[176:179], a[40:43], v[120:123]
  buffer_load_dwordx4 v11, s[32:35], s64 offen lds
  v_max_f32 v23, 0, v23
  v_cvt_pk_bf16_f32 v17, v17, v17
  v_mfma_f32_16x16x32_bf16 v[116:119], a[176:179], a[36:39], v[116:119]
  ds_read_b64_tr_b16 a[170:171], v8 offset:30720
  v_cvt_pk_bf16_f32 v19, v19, v19
  v_mfma_f32_16x16x32_bf16 v[116:119], a[180:183], a[52:55], v[116:119]
  s_add_u32 m0, s45, 102400
  s_add_u32 s61, s64, 229376
  v_cvt_pk_bf16_f32 v21, v21, v21
  v_mfma_f32_16x16x32_bf16 v[112:115], a[180:183], a[48:51], v[112:115]
  ds_read_b64_tr_b16 a[180:181], v2 offset:16384
  v_cvt_pk_bf16_f32 v23, v23, v23
  v_mfma_f32_16x16x32_bf16 v[112:115], a[176:179], a[32:35], v[112:115]
  s_waitcnt lgkmcnt(5)
  buffer_load_dwordx4 v11, s[28:31], s61 offen lds
  v_lshlrev_b32 v17, 16, v17
  v_mfma_f32_16x16x32_bf16 v[32:35], a[164:167], a[32:35], v[32:35]
  ds_read_b64_tr_b16 a[182:183], v2 offset:18432
  v_lshlrev_b32 v19, 16, v19
  v_mfma_f32_16x16x32_bf16 v[32:35], a[160:163], a[48:51], v[32:35]
  v_lshlrev_b32 v21, 16, v21
  v_lshlrev_b32 v23, 16, v23
  v_mfma_f32_16x16x32_bf16 v[36:39], a[160:163], a[52:55], v[36:39]
  ds_read_b64_tr_b16 a[176:177], v2 offset:20480
  v_add_f32 v17, 0x3727c5ac, v17
  v_mfma_f32_16x16x32_bf16 v[36:39], a[164:167], a[36:39], v[36:39]
  s_add_u32 m0, s45, 110592
  s_add_u32 s61, s64, 229376
  v_add_f32 v19, 0x3727c5ac, v19
  v_mfma_f32_16x16x32_bf16 v[40:43], a[164:167], a[40:43], v[40:43]
  ds_read_b64_tr_b16 a[178:179], v2 offset:22528
  v_add_f32 v21, 0x3727c5ac, v21
  v_mfma_f32_16x16x32_bf16 v[40:43], a[160:163], a[56:59], v[40:43]
  buffer_load_dwordx4 v11, s[32:35], s61 offen lds
  v_add_f32 v23, 0x3727c5ac, v23
  v_cvt_pk_bf16_f32 v17, v17, v17
  v_mfma_f32_16x16x32_bf16 v[44:47], a[160:163], a[60:63], v[44:47]
  ds_read_b64_tr_b16 a[160:161], v2 offset:24576
  v_cvt_pk_bf16_f32 v19, v19, v19
  v_mfma_f32_16x16x32_bf16 v[44:47], a[164:167], a[44:47], v[44:47]
  s_waitcnt lgkmcnt(5)
  s_add_u32 m0, s45, 32768
  v_cvt_pk_bf16_f32 v21, v21, v21
  v_mfma_f32_16x16x32_bf16 v[60:63], a[172:175], a[44:47], v[60:63]
  ds_read_b64_tr_b16 a[162:163], v2 offset:26624
  v_cvt_pk_bf16_f32 v23, v23, v23
  v_mfma_f32_16x16x32_bf16 v[60:63], a[168:171], a[60:63], v[60:63]
  buffer_load_dwordx4 v10, s[28:31], s64 offen lds
  v_lshlrev_b32 v17, 16, v17
  v_lshlrev_b32 v19, 16, v19
  v_mfma_f32_16x16x32_bf16 v[56:59], a[168:171], a[56:59], v[56:59]
  ds_read_b64_tr_b16 a[164:165], v2 offset:28672
  v_lshlrev_b32 v21, 16, v21
  v_mfma_f32_16x16x32_bf16 v[56:59], a[172:175], a[40:43], v[56:59]
  v_lshlrev_b32 v23, 16, v23
  v_mfma_f32_16x16x32_bf16 v[52:55], a[172:175], a[36:39], v[52:55]
  ds_read_b64_tr_b16 a[166:167], v2 offset:30720
  v_mfma_f32_16x16x32_bf16 v[52:55], a[168:171], a[52:55], v[52:55]
  s_add_u32 m0, s45, 40960
  v_sqrt_f32 v17, v17
  v_mfma_f32_16x16x32_bf16 v[48:51], a[168:171], a[48:51], v[48:51]
  ds_read_b64_tr_b16 a[168:169], v3 offset:16384
  v_mfma_f32_16x16x32_bf16 v[48:51], a[172:175], a[32:35], v[48:51]
  s_waitcnt lgkmcnt(5)
  buffer_load_dwordx4 v10, s[32:35], s64 offen lds
  v_mfma_f32_16x16x32_bf16 v[128:131], a[180:183], a[32:35], v[128:131]
  ds_read_b64_tr_b16 a[170:171], v3 offset:18432
  v_mfma_f32_16x16x32_bf16 v[128:131], a[176:179], a[48:51], v[128:131]
  s_add_u32 m0, s45, 36864
  s_add_u32 s61, s64, 229376
  v_mfma_f32_16x16x32_bf16 v[132:135], a[176:179], a[52:55], v[132:135]
  ds_read_b64_tr_b16 a[172:173], v3 offset:20480
  v_sqrt_f32 v19, v19
  v_mfma_f32_16x16x32_bf16 v[132:135], a[180:183], a[36:39], v[132:135]
  buffer_load_dwordx4 v10, s[28:31], s61 offen lds
  v_sqrt_f32 v21, v21
  v_mfma_f32_16x16x32_bf16 v[136:139], a[180:183], a[40:43], v[136:139]
  ds_read_b64_tr_b16 a[174:175], v3 offset:22528
  v_mfma_f32_16x16x32_bf16 v[136:139], a[176:179], a[56:59], v[136:139]
  s_waitcnt vmcnt(8)
  s_cmp_lg_u32 s44, 0
  s_cbranch_scc1 PL11_adaLN_cond__sliding_local_dilated__swiglu_ffn__prompt_kernelx
  v_cmp_ne_u32 vcc, s46, v9
  s_nop 4
  s_cbranch_vccz PL11_adaLN_cond__sliding_local_dilated__swiglu_ffn__prompt_kernelx
  s_mov_b32 s83, 60000
PL11_adaLN_cond__sliding_local_dilated__swiglu_ffn__prompt_kernel:
  buffer_load_dword v9, v13, s[8:11], 0 offen sc1
  s_sub_u32 s83, s83, 1
  s_cmp_eq_u32 s83, 0
  s_waitcnt vmcnt(0)
  s_cbranch_scc1 PL11_adaLN_cond__sliding_local_dilated__swiglu_ffn__prompt_kernelx
  v_cmp_ne_u32 vcc, s46, v9
  s_nop 4
  s_cbranch_vccnz PL11_adaLN_cond__sliding_local_dilated__swiglu_ffn__prompt_kernel
PL11_adaLN_cond__sliding_local_dilated__swiglu_ffn__prompt_kernelx:
  s_barrier
  v_mfma_f32_16x16x32_bf16 v[140:143], a[176:179], a[60:63], v[140:143]
  ds_read_b64_tr_b16 a[176:177], v3 offset:24576
  v_mfma_f32_16x16x32_bf16 v[140:143], a[180:183], a[44:47], v[140:143]
  s_waitcnt lgkmcnt(5)
  s_add_u32 m0, s45, 45056
  s_add_u32 s61, s64, 229376
  v_mfma_f32_16x16x32_bf16 v[156:159], a[160:163], a[44:47], v[156:159]
  ds_read_b64_tr_b16 a[178:179], v3 offset:26624
  v_sqrt_f32 v23, v23
  v_mfma_f32_16x16x32_bf16 v[156:159], a[164:167], a[60:63], v[156:159]
  buffer_load_dwordx4 v10, s[32:35], s61 offen lds
  v_cvt_pk_bf16_f32 v16, v16, v16
  v_cvt_pk_bf16_f32 v18, v18, v18
  v_mfma_f32_16x16x32_bf16 v[152:155], a[164:167], a[56:59], v[152:155]
  ds_read_b64_tr_b16 a[180:181], v3 offset:28672
  v_cvt_pk_bf16_f32 v20, v20, v20
  v_mfma_f32_16x16x32_bf16 v[152:155], a[160:163], a[40:43], v[152:155]
  s_mov_b32 s62, 0
  v_cvt_pk_bf16_f32 v22, v22, v22
  v_lshlrev_b32 v16, 16, v16
  v_mfma_f32_16x16x32_bf16 v[148:151], a[160:163], a[36:39], v[148:151]
  ds_read_b64_tr_b16 a[182:183], v3 offset:30720
  v_lshlrev_b32 v18, 16, v18
  v_mfma_f32_16x16x32_bf16 v[148:151], a[164:167], a[52:55], v[148:151]
  buffer_load_dwordx4 a[220:223], v14, s[8:11], s62 offen sc1
  v_lshlrev_b32 v20, 16, v20
  v_lshlrev_b32 v22, 16, v22
  v_mfma_f32_16x16x32_bf16 v[144:147], a[164:167], a[48:51], v[144:147]
  ds_read_b64_tr_b16 a[164:165], v4 offset:16384
  v_cvt_pk_bf16_f32 v17, v17, v17
  v_mfma_f32_16x16x32_bf16 v[144:147], a[160:163], a[32:35], v[144:147]
  s_waitcnt lgkmcnt(5)
  s_mov_b32 s62, 114688
  v_cvt_pk_bf16_f32 v19, v19, v19
  v_mfma_f32_16x16x32_bf16 v[160:163], a[168:171], a[32:35], v[160:163]
  ds_read_b64_tr_b16 a[166:167], v4 offset:18432
  buffer_load_dwordx4 a[224:227], v14, s[8:11], s62 offen sc1
  v_mfma_f32_16x16x32_bf16 v[160:163], a[172:175], a[48:51], v[160:163]
  s_mov_b32 s62, 229376
  v_cvt_pk_bf16_f32 v21, v21, v21
  v_cvt_pk_bf16_f32 v23, v23, v23
  v_mfma_f32_16x16x32_bf16 v[164:167], a[172:175], a[52:55], v[164:167]
  ds_read_b64_tr_b16 a[160:161], v4 offset:20480
  buffer_load_dwordx4 a[228:231], v14, s[8:11], s62 offen sc1
  v_mfma_f32_16x16x32_bf16 v[164:167], a[168:171], a[36:39], v[164:167]
  s_mov_b32 s62, 344064
  v_lshlrev_b32 v17, 16, v17
  v_lshlrev_b32 v19, 16, v19
  v_mfma_f32_16x16x32_bf16 v[168:171], a[168:171], a[40:43], v[168:171]
  ds_read_b64_tr_b16 a[162:163], v4 offset:22528
  v_lshlrev_b32 v21, 16, v21
  v_mfma_f32_16x16x32_bf16 v[168:171], a[172:175], a[56:59], v[168:171]
  buffer_load_dwordx4 a[232:235], v14, s[8:11], s62 offen sc1
  s_mov_b32 s62, 458752
  v_lshlrev_b32 v23, 16, v23
  v_mfma_f32_16x16x32_bf16 v[172:175], a[172:175], a[60:63], v[172:175]
  ds_read_b64_tr_b16 a[172:173], v4 offset:24576
  v_sub_f32 v16, 0, v16
  v_mfma_f32_16x16x32_bf16 v[172:175], a[168:171], a[44:47], v[172:175]
  s_waitcnt lgkmcnt(5)
  buffer_load_dwordx4 a[236:239], v14, s[8:11], s62 offen sc1
  v_sub_f32 v18, 0, v18
  v_mfma_f32_16x16x32_bf16 v[188:191], a[176:179], a[44:47], v[188:191]
  ds_read_b64_tr_b16 a[174:175], v4 offset:26624
  v_sub_f32 v20, 0, v20
  v_mfma_f32_16x16x32_bf16 v[188:191], a[180:183], a[60:63], v[188:191]
  s_mov_b32 s62, 573440
  v_sub_f32 v22, 0, v22
  v_lshrrev_b32 v12, 8, v1
  v_mfma_f32_16x16x32_bf16 v[184:187], a[180:183], a[56:59], v[184:187]
  ds_read_b64_tr_b16 a[168:169], v4 offset:28672
  buffer_load_dwordx4 a[240:243], v14, s[8:11], s62 offen sc1
  v_mfma_f32_16x16x32_bf16 v[184:187], a[176:179], a[40:43], v[184:187]
  s_mov_b32 s62, 688128
  v_lshlrev_b32 v12, 4, v12
  v_add_u32 v12, 131072, v12
  v_mfma_f32_16x16x32_bf16 v[180:183], a[176:179], a[36:39], v[180:183]
  ds_read_b64_tr_b16 a[170:171], v4 offset:30720
  buffer_load_dwordx4 a[244:247], v14, s[8:11], s62 offen sc1
  v_mfma_f32_16x16x32_bf16 v[180:183], a[180:183], a[52:55], v[180:183]
  s_mov_b32 s62, 802816
  v_mfma_f32_16x16x32_bf16 v[176:179], a[180:183], a[48:51], v[176:179]
  ds_read_b64_tr_b16 a[180:181], v5 offset:16384
  v_mfma_f32_16x16x32_bf16 v[176:179], a[176:179], a[32:35], v[176:179]
  s_waitcnt lgkmcnt(5)
  buffer_load_dwordx4 a[248:251], v14, s[8:11], s62 offen sc1
  v_mfma_f32_16x16x32_bf16 v[192:195], a[164:167], a[32:35], v[192:195]
  ds_read_b64_tr_b16 a[182:183], v5 offset:18432
  v_mfma_f32_16x16x32_bf16 v[192:195], a[160:163], a[48:51], v[192:195]
  buffer_load_dwordx4 a[96:99], v1, s[8:11], s72 offen offset:0 sc1
  v_mfma_f32_16x16x32_bf16 v[196:199], a[160:163], a[52:55], v[196:199]
  ds_read_b64_tr_b16 a[176:177], v5 offset:20480
  v_mfma_f32_16x16x32_bf16 v[196:199], a[164:167], a[36:39], v[196:199]
  v_mfma_f32_16x16x32_bf16 v[200:203], a[164:167], a[40:43], v[200:203]
  ds_read_b64_tr_b16 a[178:179], v5 offset:22528
  v_mfma_f32_16x16x32_bf16 v[200:203], a[160:163], a[56:59], v[200:203]
  v_mfma_f32_16x16x32_bf16 v[204:207], a[160:163], a[60:63], v[204:207]
  ds_read_b64_tr_b16 a[160:161], v5 offset:24576
  v_mfma_f32_16x16x32_bf16 v[204:207], a[164:167], a[44:47], v[204:207]
  s_waitcnt lgkmcnt(5)
  buffer_load_dwordx4 a[112:115], v1, s[8:11], s72 offen offset:1024 sc1
  v_mfma_f32_16x16x32_bf16 v[220:223], a[172:175], a[44:47], v[220:223]
  ds_read_b64_tr_b16 a[162:163], v5 offset:26624
  v_mfma_f32_16x16x32_bf16 v[220:223], a[168:171], a[60:63], v[220:223]
  s_add_u32 s72, s72, 65536
  v_mfma_f32_16x16x32_bf16 v[216:219], a[168:171], a[56:59], v[216:219]
  ds_read_b64_tr_b16 a[164:165], v5 offset:28672
  v_mfma_f32_16x16x32_bf16 v[216:219], a[172:175], a[40:43], v[216:219]
  buffer_load_dwordx4 a[100:103], v1, s[8:11], s72 offen offset:0 sc1
  v_mfma_f32_16x16x32_bf16 v[212:215], a[172:175], a[36:39], v[212:215]
  ds_read_b64_tr_b16 a[166:167], v5 offset:30720
  v_mfma_f32_16x16x32_bf16 v[212:215], a[168:171], a[52:55], v[212:215]
  s_waitcnt vmcnt(28)
  s_barrier
  v_mfma_f32_16x16x32_bf16 v[208:211], a[168:171], a[48:51], v[208:211]
  ds_read_b64_tr_b16 a[168:169], v6 offset:0
  v_mfma_f32_16x16x32_bf16 v[208:211], a[172:175], a[32:35], v[208:211]
  s_waitcnt lgkmcnt(5)
  v_mfma_f32_16x16x32_bf16 v[224:227], a[180:183], a[32:35], v[224:227]
  ds_read_b64_tr_b16 a[170:171], v6 offset:2048
  v_mfma_f32_16x16x32_bf16 v[224:227], a[176:179], a[48:51], v[224:227]
  buffer_load_dwordx4 a[116:119], v1, s[8:11], s72 offen offset:1024 sc1
  v_mfma_f32_16x16x32_bf16 v[228:231], a[176:179], a[52:55], v[228:231]
  ds_read_b64_tr_b16 a[172:173], v6 offset:4096
  v_mfma_f32_16x16x32_bf16 v[228:231], a[180:183], a[36:39], v[228:231]
  s_add_u32 s72, s72, 65536
  v_mfma_f32_16x16x32_bf16 v[232:235], a[180:183], a[40:43], v[232:235]
  ds_read_b64_tr_b16 a[174:175], v6 offset:6144
  v_mfma_f32_16x16x32_bf16 v[232:235], a[176:179], a[56:59], v[232:235]
  buffer_load_dwordx4 a[104:107], v1, s[8:11], s72 offen offset:0 sc1
  v_mfma_f32_16x16x32_bf16 v[236:239], a[176:179], a[60:63], v[236:239]
  ds_read_b64_tr_b16 a[176:177], v6 offset:8192
  v_mfma_f32_16x16x32_bf16 v[236:239], a[180:183], a[44:47], v[236:239]
  s_waitcnt lgkmcnt(5)
  v_mfma_f32_16x16x32_bf16 v[252:255], a[160:163], a[44:47], v[252:255]
  ds_read_b64_tr_b16 a[178:179], v6 offset:10240
  v_mfma_f32_16x16x32_bf16 v[252:255], a[164:167], a[60:63], v[252:255]
  v_mfma_f32_16x16x32_bf16 v[248:251], a[164:167], a[56:59], v[248:251]
  ds_read_b64_tr_b16 a[180:181], v6 offset:12288
  v_mfma_f32_16x16x32_bf16 v[248:251], a[160:163], a[40:43], v[248:251]
  buffer_load_dwordx4 a[120:123], v1, s[8:11], s72 offen offset:1024 sc1
  v_mfma_f32_16x16x32_bf16 v[244:247], a[160:163], a[36:39], v[244:247]
  ds_read_b64_tr_b16 a[182:183], v6 offset:14336
  v_mfma_f32_16x16x32_bf16 v[244:247], a[164:167], a[52:55], v[244:247]
  s_add_u32 s72, s72, 65536
  v_mfma_f32_16x16x32_bf16 v[240:243], a[164:167], a[48:51], v[240:243]
  ds_read_b64_tr_b16 a[164:165], v7 offset:0
  v_mfma_f32_16x16x32_bf16 v[240:243], a[160:163], a[32:35], v[240:243]
  s_waitcnt vmcnt(22) lgkmcnt(5)
  buffer_load_dwordx4 a[108:111], v1, s[8:11], s72 offen offset:0 sc1
  v_mfma_f32_16x16x32_bf16 v[64:67], a[168:171], a[64:67], v[64:67]
  ds_read_b64_tr_b16 a[166:167], v7 offset:2048
  v_mfma_f32_16x16x32_bf16 v[64:67], a[172:175], a[80:83], v[64:67]
  v_mfma_f32_16x16x32_bf16 v[68:71], a[172:175], a[84:87], v[68:71]
  ds_read_b64_tr_b16 a[160:161], v7 offset:4096
  v_mfma_f32_16x16x32_bf16 v[68:71], a[168:171], a[68:71], v[68:71]
  v_mfma_f32_16x16x32_bf16 v[72:75], a[168:171], a[72:75], v[72:75]
  ds_read_b64_tr_b16 a[162:163], v7 offset:6144
  v_mfma_f32_16x16x32_bf16 v[72:75], a[172:175], a[88:91], v[72:75]
  buffer_load_dwordx4 a[124:127], v1, s[8:11], s72 offen offset:1024 sc1
  v_mfma_f32_16x16x32_bf16 v[76:79], a[172:175], a[92:95], v[76:79]
  ds_read_b64_tr_b16 a[172:173], v7 offset:8192
  s_waitcnt vmcnt(8)
  v_mfma_f32_16x16x32_bf16 v[76:79], a[168:171], a[76:79], v[76:79]
  s_waitcnt lgkmcnt(5)
  s_cmp_eq_u32 s56, 1
  s_cselect_b32 s73, 13, 9
  s_mul_i32 s65, s73, 458752
  s_lshl_b32 s73, s73, 11
  s_add_u32 s73, s73, s57
  s_add_u32 m0, s45, 114688
  v_accvgpr_read_b32 v24, a220
  v_accvgpr_read_b32 v25, a221
  v_mfma_f32_16x16x32_bf16 v[92:95], a[176:179], a[76:79], v[92:95]
  ds_read_b64_tr_b16 a[174:175], v7 offset:10240
  v_accvgpr_read_b32 v26, a222
  v_mfma_f32_16x16x32_bf16 v[92:95], a[180:183], a[92:95], v[92:95]
  buffer_load_dwordx4 v11, s[28:31], s65 offen lds
  v_accvgpr_read_b32 v27, a223
  v_accvgpr_read_b32 v28, a224
  v_mfma_f32_16x16x32_bf16 v[88:91], a[180:183], a[88:91], v[88:91]
  ds_read_b64_tr_b16 a[168:169], v7 offset:12288
  v_accvgpr_read_b32 v29, a225
  v_mfma_f32_16x16x32_bf16 v[88:91], a[176:179], a[72:75], v[88:91]
  v_accvgpr_read_b32 v30, a226
  v_accvgpr_read_b32 v31, a227
  v_mfma_f32_16x16x32_bf16 v[84:87], a[176:179], a[68:71], v[84:87]
  ds_read_b64_tr_b16 a[170:171], v7 offset:14336
  v_add_f32 v24, v24, v28
  v_mfma_f32_16x16x32_bf16 v[84:87], a[180:183], a[84:87], v[84:87]
  s_add_u32 m0, s45, 122880
  v_add_f32 v25, v25, v29
  v_add_f32 v26, v26, v30
  v_mfma_f32_16x16x32_bf16 v[80:83], a[180:183], a[80:83], v[80:83]
  ds_read_b64_tr_b16 a[180:181], v8 offset:0
  v_add_f32 v27, v27, v31
  v_mfma_f32_16x16x32_bf16 v[80:83], a[176:179], a[64:67], v[80:83]
  s_waitcnt lgkmcnt(5)
  buffer_load_dwordx4 v11, s[32:35], s65 offen lds
  v_accvgpr_read_b32 v28, a228
  v_accvgpr_read_b32 v29, a229
  v_mfma_f32_16x16x32_bf16 v[96:99], a[164:167], a[64:67], v[96:99]
  ds_read_b64_tr_b16 a[182:183], v8 offset:2048
  v_accvgpr_read_b32 v30, a230
  v_mfma_f32_16x16x32_bf16 v[96:99], a[160:163], a[80:83], v[96:99]
  s_add_u32 m0, s45, 118784
  s_add_u32 s61, s65, 229376
  v_accvgpr_read_b32 v31, a231
  v_mfma_f32_16x16x32_bf16 v[100:103], a[160:163], a[84:87], v[100:103]
  ds_read_b64_tr_b16 a[176:177], v8 offset:4096
  v_add_f32 v24, v24, v28
  v_mfma_f32_16x16x32_bf16 v[100:103], a[164:167], a[68:71], v[100:103]
  buffer_load_dwordx4 v11, s[28:31], s61 offen lds
  v_add_f32 v25, v25, v29
  v_add_f32 v26, v26, v30
  v_mfma_f32_16x16x32_bf16 v[104:107], a[164:167], a[72:75], v[104:107]
  ds_read_b64_tr_b16 a[178:179], v8 offset:6144
  v_add_f32 v27, v27, v31
  v_mfma_f32_16x16x32_bf16 v[104:107], a[160:163], a[88:91], v[104:107]
  v_accvgpr_read_b32 v28, a232
  v_accvgpr_read_b32 v29, a233
  v_mfma_f32_16x16x32_bf16 v[108:111], a[160:163], a[92:95], v[108:111]
  ds_read_b64_tr_b16 a[160:161], v8 offset:8192
  v_accvgpr_read_b32 v30, a234
  v_mfma_f32_16x16x32_bf16 v[108:111], a[164:167], a[76:79], v[108:111]
  s_waitcnt lgkmcnt(5)
  s_add_u32 m0, s45, 126976
  s_add_u32 s61, s65, 229376
  v_accvgpr_read_b32 v31, a235
  v_mfma_f32_16x16x32_bf16 v[124:127], a[172:175], a[76:79], v[124:127]
  ds_read_b64_tr_b16 a[162:163], v8 offset:10240
  v_add_f32 v24, v24, v28
  v_mfma_f32_16x16x32_bf16 v[124:127], a[168:171], a[92:95], v[124:127]
  buffer_load_dwordx4 v11, s[32:35], s61 offen lds
  v_add_f32 v25, v25, v29
  v_add_f32 v26, v26, v30
  v_mfma_f32_16x16x32_bf16 v[120:123], a[168:171], a[88:91], v[120:123]
  ds_read_b64_tr_b16 a[164:165], v8 offset:12288
  v_add_f32 v27, v27, v31
  v_mfma_f32_16x16x32_bf16 v[120:123], a[172:175], a[72:75], v[120:123]
  s_add_u32 m0, s45, 49152
  v_accvgpr_read_b32 v28, a236
  v_accvgpr_read_b32 v29, a237
  v_mfma_f32_16x16x32_bf16 v[116:119], a[172:175], a[68:71], v[116:119]
  ds_read_b64_tr_b16 a[166:167], v8 offset:14336
  v_accvgpr_read_b32 v30, a238
  v_mfma_f32_16x16x32_bf16 v[116:119], a[168:171], a[84:87], v[116:119]
  buffer_load_dwordx4 v10, s[28:31], s65 offen lds
  v_accvgpr_read_b32 v31, a239
  v_add_f32 v24, v24, v28
  v_mfma_f32_16x16x32_bf16 v[112:115], a[168:171], a[80:83], v[112:115]
  ds_read_b64_tr_b16 a[168:169], v2 offset:0
  v_add_f32 v25, v25, v29
  v_mfma_f32_16x16x32_bf16 v[112:115], a[172:175], a[64:67], v[112:115]
  s_waitcnt lgkmcnt(5)
  v_add_f32 v26, v26, v30
  v_add_f32 v27, v27, v31
  v_accvgpr_read_b32 v28, a240
  v_mfma_f32_16x16x32_bf16 v[32:35], a[180:183], a[64:67], v[32:35]
  ds_read_b64_tr_b16 a[170:171], v2 offset:2048
  v_accvgpr_read_b32 v29, a241
  v_mfma_f32_16x16x32_bf16 v[32:35], a[176:179], a[80:83], v[32:35]
  s_add_u32 m0, s45, 57344
  v_accvgpr_read_b32 v30, a242
  v_accvgpr_read_b32 v31, a243
  v_mfma_f32_16x16x32_bf16 v[36:39], a[176:179], a[84:87], v[36:39]
  ds_read_b64_tr_b16 a[172:173], v2 offset:4096
  v_add_f32 v24, v24, v28
  v_mfma_f32_16x16x32_bf16 v[36:39], a[180:183], a[68:71], v[36:39]
  buffer_load_dwordx4 v10, s[32:35], s65 offen lds
  v_add_f32 v25, v25, v29
  v_add_f32 v26, v26, v30
  v_mfma_f32_16x16x32_bf16 v[40:43], a[180:183], a[72:75], v[40:43]
  ds_read_b64_tr_b16 a[174:175], v2 offset:6144
  v_add_f32 v27, v27, v31
  v_mfma_f32_16x16x32_bf16 v[40:43], a[176:179], a[88:91], v[40:43]
  s_add_u32 m0, s45, 53248
  s_add_u32 s61, s65, 229376
  v_accvgpr_read_b32 v28, a244
  v_mfma_f32_16x16x32_bf16 v[44:47], a[176:179], a[92:95], v[44:47]
  ds_read_b64_tr_b16 a[176:177], v2 offset:8192
  v_accvgpr_read_b32 v29, a245
  v_mfma_f32_16x16x32_bf16 v[44:47], a[180:183], a[76:79], v[44:47]
  s_waitcnt lgkmcnt(5)
  buffer_load_dwordx4 v10, s[28:31], s61 offen lds
  v_accvgpr_read_b32 v30, a246
  v_accvgpr_read_b32 v31, a247
  v_mfma_f32_16x16x32_bf16 v[60:63], a[160:163], a[76:79], v[60:63]
  ds_read_b64_tr_b16 a[178:179], v2 offset:10240
  v_add_f32 v24, v24, v28
  v_mfma_f32_16x16x32_bf16 v[60:63], a[164:167], a[92:95], v[60:63]
  v_add_f32 v25, v25, v29
  v_add_f32 v26, v26, v30
  v_mfma_f32_16x16x32_bf16 v[56:59], a[164:167], a[88:91], v[56:59]
  ds_read_b64_tr_b16 a[180:181], v2 offset:12288
  v_add_f32 v27, v27, v31
  v_mfma_f32_16x16x32_bf16 v[56:59], a[160:163], a[72:75], v[56:59]
  s_add_u32 m0, s45, 61440
  s_add_u32 s61, s65, 229376
  v_accvgpr_read_b32 v28, a248
  v_mfma_f32_16x16x32_bf16 v[52:55], a[160:163], a[68:71], v[52:55]
  ds_read_b64_tr_b16 a[182:183], v2 offset:14336
  v_accvgpr_read_b32 v29, a249
  v_mfma_f32_16x16x32_bf16 v[52:55], a[164:167], a[84:87], v[52:55]
  buffer_load_dwordx4 v10, s[32:35], s61 offen lds
  v_accvgpr_read_b32 v30, a250
  v_accvgpr_read_b32 v31, a251
  v_mfma_f32_16x16x32_bf16 v[48:51], a[164:167], a[80:83], v[48:51]
  ds_read_b64_tr_b16 a[164:165], v3 offset:0
  v_add_f32 v24, v24, v28
  v_mfma_f32_16x16x32_bf16 v[48:51], a[160:163], a[64:67], v[48:51]
  s_waitcnt lgkmcnt(5)
  v_add_f32 v25, v25, v29
  v_add_f32 v26, v26, v30
  v_mfma_f32_16x16x32_bf16 v[128:131], a[168:171], a[64:67], v[128:131]
  ds_read_b64_tr_b16 a[166:167], v3 offset:2048
  v_add_f32 v27, v27, v31
  v_mfma_f32_16x16x32_bf16 v[128:131], a[172:175], a[80:83], v[128:131]
  buffer_load_dwordx4 a[128:131], v1, s[8:11], s73 offen offset:0 sc1
  v_mov_b32 v28, v24
  v_mov_b32 v29, v25
  v_mfma_f32_16x16x32_bf16 v[132:135], a[172:175], a[84:87], v[132:135]
  ds_read_b64_tr_b16 a[160:161], v3 offset:4096
  v_mov_b32 v30, v26
  v_mfma_f32_16x16x32_bf16 v[132:135], a[168:171], a[68:71], v[132:135]
  v_mov_b32 v31, v27
  v_mfma_f32_16x16x32_bf16 v[136:139], a[168:171], a[72:75], v[136:139]
  ds_read_b64_tr_b16 a[162:163], v3 offset:6144
  v_mfma_f32_16x16x32_bf16 v[136:139], a[172:175], a[88:91], v[136:139]
  v_permlane32_swap_b32 v24, v28
  v_mfma_f32_16x16x32_bf16 v[140:143], a[172:175], a[92:95], v[140:143]
  ds_read_b64_tr_b16 a[172:173], v3 offset:8192
  v_mfma_f32_16x16x32_bf16 v[140:143], a[168:171], a[76:79], v[140:143]
  s_waitcnt lgkmcnt(5)
  buffer_load_dwordx4 a[144:147], v1, s[8:11], s73 offen offset:1024 sc1
  v_permlane32_swap_b32 v25, v29
  v_mfma_f32_16x16x32_bf16 v[156:159], a[176:179], a[76:79], v[156:159]
  ds_read_b64_tr_b16 a[174:175], v3 offset:10240
  v_mfma_f32_16x16x32_bf16 v[156:159], a[180:183], a[92:95], v[156:159]
  s_add_u32 s73, s73, 65536
  v_permlane32_swap_b32 v26, v30
  v_mfma_f32_16x16x32_bf16 v[152:155], a[180:183], a[88:91], v[152:155]
  ds_read_b64_tr_b16 a[168:169], v3 offset:12288
  v_mfma_f32_16x16x32_bf16 v[152:155], a[176:179], a[72:75], v[152:155]
  buffer_load_dwordx4 a[132:135], v1, s[8:11], s73 offen offset:0 sc1
  v_permlane32_swap_b32 v27, v31
  v_mfma_f32_16x16x32_bf16 v[148:151], a[176:179], a[68:71], v[148:151]
  ds_read_b64_tr_b16 a[170:171], v3 offset:14336
  v_lshrrev_b32 v13, 8, v1
  v_lshlrev_b32 v13, 28, v13
  v_mfma_f32_16x16x32_bf16 v[148:151], a[180:183], a[84:87], v[148:151]
  v_lshl_add_u32 v13, v1, 3, v13
  v_xor_b32 v9, 96, v6
  v_mfma_f32_16x16x32_bf16 v[144:147], a[180:183], a[80:83], v[144:147]
  ds_read_b64_tr_b16 a[180:181], v4 offset:0
  v_add_f32 v24, v24, v28
  v_mfma_f32_16x16x32_bf16 v[144:147], a[176:179], a[64:67], v[144:147]
  s_waitcnt lgkmcnt(5)
  v_add_f32 v25, v25, v29
  v_add_f32 v26, v26, v30
  v_add_f32 v27, v27, v31
  v_mfma_f32_16x16x32_bf16 v[160:163], a[164:167], a[64:67], v[160:163]
  ds_read_b64_tr_b16 a[182:183], v4 offset:2048
  v_mfma_f32_16x16x32_bf16 v[160:163], a[160:163], a[80:83], v[160:163]
  buffer_load_dwordx4 a[148:151], v1, s[8:11], s73 offen offset:1024 sc1
  ds_write_b128 v15, v[24:27]
  v_mfma_f32_16x16x32_bf16 v[164:167], a[160:163], a[84:87], v[164:167]
  ds_read_b64_tr_b16 a[176:177], v4 offset:4096
  v_mfma_f32_16x16x32_bf16 v[164:167], a[164:167], a[68:71], v[164:167]
  s_add_u32 s73, s73, 65536
  v_mfma_f32_16x16x32_bf16 v[168:171], a[164:167], a[72:75], v[168:171]
  ds_read_b64_tr_b16 a[178:179], v4 offset:6144
  s_waitcnt lgkmcnt(2)
  s_barrier
  v_mfma_f32_16x16x32_bf16 v[168:171], a[160:163], a[88:91], v[168:171]
  buffer_load_dwordx4 a[136:139], v1, s[8:11], s73 offen offset:0 sc1
  ds_read_b128 v[24:27], v12 offset:384
  v_mfma_f32_16x16x32_bf16 v[172:175], a[160:163], a[92:95], v[172:175]
  ds_read_b64_tr_b16 a[160:161], v4 offset:8192
  v_mfma_f32_16x16x32_bf16 v[172:175], a[164:167], a[76:79], v[172:175]
  s_waitcnt lgkmcnt(7)
  ds_read_b128 v[28:31], v12 offset:896
HOP11:
  s_cbranch_execz WRET0
  v_mfma_f32_16x16x32_bf16 v[188:191], a[172:175], a[76:79], v[188:191]
  ds_read_b64_tr_b16 a[162:163], v4 offset:10240
  v_mfma_f32_16x16x32_bf16 v[188:191], a[168:171], a[92:95], v[188:191]
  v_mfma_f32_16x16x32_bf16 v[184:187], a[168:171], a[88:91], v[184:187]
  ds_read_b64_tr_b16 a[164:165], v4 offset:12288
  v_mfma_f32_16x16x32_bf16 v[184:187], a[172:175], a[72:75], v[184:187]
  buffer_load_dwordx4 a[152:155], v1, s[8:11], s73 offen offset:1024 sc1
  v_mfma_f32_16x16x32_bf16 v[180:183], a[172:175], a[68:71], v[180:183]
  ds_read_b64_tr_b16 a[166:167], v4 offset:14336
  v_mfma_f32_16x16x32_bf16 v[180:183], a[168:171], a[84:87], v[180:183]
  s_add_u32 s73, s73, 65536
  s_waitcnt lgkmcnt(5)
  v_fmac_f32 v32, v16, v24
  v_mfma_f32_16x16x32_bf16 v[176:179], a[168:171], a[80:83], v[176:179]
  ds_read_b64_tr_b16 a[168:169], v5 offset:0
  v_fmac_f32 v33, v16, v25
  v_mfma_f32_16x16x32_bf16 v[176:179], a[172:175], a[64:67], v[176:179]
  s_waitcnt lgkmcnt(7)
  buffer_load_dwordx4 a[140:143], v1, s[8:11], s73 offen offset:0 sc1
  v_fmac_f32 v34, v16, v26
  v_mfma_f32_16x16x32_bf16 v[192:195], a[180:183], a[64:67], v[192:195]
  ds_read_b64_tr_b16 a[170:171], v5 offset:2048
  v_fmac_f32 v35, v16, v27
  v_mfma_f32_16x16x32_bf16 v[192:195], a[176:179], a[80:83], v[192:195]
  v_fmac_f32 v36, v18, v24
  v_fmac_f32 v37, v18, v25
  v_mfma_f32_16x16x32_bf16 v[196:199], a[176:179], a[84:87], v[196:199]
  ds_read_b64_tr_b16 a[172:173], v5 offset:4096
  v_fmac_f32 v38, v18, v26
  v_mfma_f32_16x16x32_bf16 v[196:199], a[180:183], a[68:71], v[196:199]
  v_fmac_f32 v39, v18, v27
  v_fmac_f32 v40, v20, v24
  v_mfma_f32_16x16x32_bf16 v[200:203], a[180:183], a[72:75], v[200:203]
  ds_read_b64_tr_b16 a[174:175], v5 offset:6144
  v_fmac_f32 v41, v20, v25
  v_mfma_f32_16x16x32_bf16 v[200:203], a[176:179], a[88:91], v[200:203]
  buffer_load_dwordx4 a[156:159], v1, s[8:11], s73 offen offset:1024 sc1
  v_fmac_f32 v42, v20, v26
  v_fmac_f32 v43, v20, v27
  v_mfma_f32_16x16x32_bf16 v[204:207], a[176:179], a[92:95], v[204:207]
  ds_read_b64_tr_b16 a[176:177], v5 offset:8192
  v_fmac_f32 v44, v22, v24
  v_mfma_f32_16x16x32_bf16 v[204:207], a[180:183], a[76:79], v[204:207]
  s_waitcnt lgkmcnt(5)
  s_cmp_eq_u32 s56, 2
  s_cselect_b32 s74, 14, 10
  s_mul_i32 s66, s74, 458752
  s_lshl_b32 s74, s74, 11
  s_add_u32 s74, s74, s57
  s_add_u32 m0, s45, 81920
  v_fmac_f32 v45, v22, v25
  v_mfma_f32_16x16x32_bf16 v[220:223], a[160:163], a[76:79], v[220:223]
  ds_read_b64_tr_b16 a[178:179], v5 offset:10240
  v_fmac_f32 v46, v22, v26
  v_mfma_f32_16x16x32_bf16 v[220:223], a[164:167], a[92:95], v[220:223]
  buffer_load_dwordx4 v11, s[28:31], s66 offen lds
  v_fmac_f32 v47, v22, v27
  v_mfma_f32_16x16x32_bf16 v[216:219], a[164:167], a[88:91], v[216:219]
  ds_read_b64_tr_b16 a[180:181], v5 offset:12288
  v_mfma_f32_16x16x32_bf16 v[216:219], a[160:163], a[72:75], v[216:219]
  ds_read_b128 v[24:27], v12 offset:1408
  s_waitcnt lgkmcnt(11)
  v_mfma_f32_16x16x32_bf16 v[212:215], a[160:163], a[68:71], v[212:215]
  ds_read_b64_tr_b16 a[182:183], v5 offset:14336
  v_fmac_f32 v32, v17, v28
  v_mfma_f32_16x16x32_bf16 v[212:215], a[164:167], a[84:87], v[212:215]
  s_waitcnt vmcnt(33)
  s_barrier
  v_mfma_f32_16x16x32_bf16 v[208:211], a[164:167], a[80:83], v[208:211]
  ds_read_b64_tr_b16 a[164:165], v6 offset:32768
  s_add_u32 m0, s45, 90112
  v_mfma_f32_16x16x32_bf16 v[208:211], a[160:163], a[64:67], v[208:211]
  s_waitcnt lgkmcnt(6)
  buffer_load_dwordx4 v11, s[32:35], s66 offen lds
  v_fmac_f32 v33, v17, v29
  v_mfma_f32_16x16x32_bf16 v[224:227], a[168:171], a[64:67], v[224:227]
  ds_read_b64_tr_b16 a[166:167], v6 offset:34816
  v_fmac_f32 v34, v17, v30
  v_mfma_f32_16x16x32_bf16 v[224:227], a[172:175], a[80:83], v[224:227]
  s_add_u32 m0, s45, 86016
  s_add_u32 s61, s66, 229376
  v_fmac_f32 v35, v17, v31
  v_mfma_f32_16x16x32_bf16 v[228:231], a[172:175], a[84:87], v[228:231]
  ds_read_b64_tr_b16 a[160:161], v6 offset:36864
  v_fmac_f32 v36, v19, v28
  v_mfma_f32_16x16x32_bf16 v[228:231], a[168:171], a[68:71], v[228:231]
  buffer_load_dwordx4 v11, s[28:31], s61 offen lds
  v_fmac_f32 v37, v19, v29
  v_fmac_f32 v38, v19, v30
  v_mfma_f32_16x16x32_bf16 v[232:235], a[168:171], a[72:75], v[232:235]
  ds_read_b64_tr_b16 a[162:163], v6 offset:38912
  v_fmac_f32 v39, v19, v31
  v_mfma_f32_16x16x32_bf16 v[232:235], a[172:175], a[88:91], v[232:235]
  v_fmac_f32 v40, v21, v28
  v_fmac_f32 v41, v21, v29
  v_mfma_f32_16x16x32_bf16 v[236:239], a[172:175], a[92:95], v[236:239]
  ds_read_b64_tr_b16 a[172:173], v6 offset:40960
  v_fmac_f32 v42, v21, v30
  v_mfma_f32_16x16x32_bf16 v[236:239], a[168:171], a[76:79], v[236:239]
  s_waitcnt lgkmcnt(5)
  s_add_u32 m0, s45, 94208
  s_add_u32 s61, s66, 229376
  v_mfma_f32_16x16x32_bf16 v[252:255], a[176:179], a[76:79], v[252:255]
  ds_read_b64_tr_b16 a[174:175], v6 offset:43008
  v_fmac_f32 v43, v21, v31
  v_mfma_f32_16x16x32_bf16 v[252:255], a[180:183], a[92:95], v[252:255]
  buffer_load_dwordx4 v11, s[32:35], s61 offen lds
  v_fmac_f32 v44, v23, v28
  v_fmac_f32 v45, v23, v29
  v_mfma_f32_16x16x32_bf16 v[248:251], a[180:183], a[88:91], v[248:251]
  ds_read_b64_tr_b16 a[168:169], v6 offset:45056
  v_fmac_f32 v46, v23, v30
  v_mfma_f32_16x16x32_bf16 v[248:251], a[176:179], a[72:75], v[248:251]
  s_cmp_eq_u32 s56, 3
  s_cselect_b32 s75, 15, 11
  s_mul_i32 s67, s75, 458752
  s_lshl_b32 s75, s75, 11
  s_add_u32 s75, s75, s57
  s_add_u32 m0, s45, 65536
  v_fmac_f32 v47, v23, v31
  v_mfma_f32_16x16x32_bf16 v[244:247], a[176:179], a[68:71], v[244:247]
  ds_read_b64_tr_b16 a[170:171], v6 offset:47104
  v_mfma_f32_16x16x32_bf16 v[244:247], a[180:183], a[84:87], v[244:247]
  buffer_load_dwordx4 v11, s[28:31], s67 offen lds
  ds_read_b128 v[28:31], v12 offset:1920
  v_mfma_f32_16x16x32_bf16 v[240:243], a[180:183], a[80:83], v[240:243]
  ds_read_b64_tr_b16 a[180:181], v7 offset:32768
  s_waitcnt lgkmcnt(11)
  v_mfma_f32_16x16x32_bf16 v[240:243], a[176:179], a[64:67], v[240:243]
  s_waitcnt vmcnt(21) lgkmcnt(6)
  v_fmac_f32 v48, v16, v24
  v_fmac_f32 v49, v16, v25
  v_mfma_f32_16x16x32_bf16 v[64:67], a[164:167], a[96:99], v[64:67]
  ds_read_b64_tr_b16 a[182:183], v7 offset:34816
  v_fmac_f32 v50, v16, v26
  v_mfma_f32_16x16x32_bf16 v[64:67], a[160:163], a[112:115], v[64:67]
  s_add_u32 m0, s45, 73728
  v_fmac_f32 v51, v16, v27
  v_fmac_f32 v52, v18, v24
  v_mfma_f32_16x16x32_bf16 v[68:71], a[160:163], a[116:119], v[68:71]
  ds_read_b64_tr_b16 a[176:177], v7 offset:36864
  v_fmac_f32 v53, v18, v25
  v_mfma_f32_16x16x32_bf16 v[68:71], a[164:167], a[100:103], v[68:71]
  buffer_load_dwordx4 v11, s[32:35], s67 offen lds
  v_fmac_f32 v54, v18, v26
  v_fmac_f32 v55, v18, v27
  v_mfma_f32_16x16x32_bf16 v[72:75], a[164:167], a[104:107], v[72:75]
  ds_read_b64_tr_b16 a[178:179], v7 offset:38912
  v_fmac_f32 v56, v20, v24
  v_mfma_f32_16x16x32_bf16 v[72:75], a[160:163], a[120:123], v[72:75]
  s_add_u32 m0, s45, 69632
  s_add_u32 s61, s67, 229376
  v_fmac_f32 v57, v20, v25
  v_mfma_f32_16x16x32_bf16 v[76:79], a[160:163], a[124:127], v[76:79]
  ds_read_b64_tr_b16 a[160:161], v7 offset:40960
  v_fmac_f32 v58, v20, v26
  v_mfma_f32_16x16x32_bf16 v[76:79], a[164:167], a[108:111], v[76:79]
  s_waitcnt lgkmcnt(6)
  buffer_load_dwordx4 v11, s[28:31], s61 offen lds
  v_fmac_f32 v59, v20, v27
  v_mfma_f32_16x16x32_bf16 v[92:95], a[172:175], a[108:111], v[92:95]
  ds_read_b64_tr_b16 a[162:163], v7 offset:43008
  v_fmac_f32 v60, v22, v24
  v_mfma_f32_16x16x32_bf16 v[92:95], a[168:171], a[124:127], v[92:95]
  v_fmac_f32 v61, v22, v25
  v_fmac_f32 v62, v22, v26
  v_mfma_f32_16x16x32_bf16 v[88:91], a[168:171], a[120:123], v[88:91]
  ds_read_b64_tr_b16 a[164:165], v7 offset:45056
  v_fmac_f32 v63, v22, v27
  v_mfma_f32_16x16x32_bf16 v[88:91], a[172:175], a[104:107], v[88:91]
  s_add_u32 m0, s45, 77824
  s_add_u32 s61, s67, 229376
  v_mfma_f32_16x16x32_bf16 v[84:87], a[172:175], a[100:103], v[84:87]
  ds_read_b64_tr_b16 a[166:167], v7 offset:47104
  v_mfma_f32_16x16x32_bf16 v[84:87], a[168:171], a[116:119], v[84:87]
  buffer_load_dwordx4 v11, s[32:35], s61 offen lds
  ds_read_b128 v[24:27], v12 offset:256
  v_mfma_f32_16x16x32_bf16 v[80:83], a[168:171], a[112:115], v[80:83]
  ds_read_b64_tr_b16 a[168:169], v8 offset:32768
  s_waitcnt lgkmcnt(10)
  v_mfma_f32_16x16x32_bf16 v[80:83], a[172:175], a[96:99], v[80:83]
  s_waitcnt lgkmcnt(6)
  s_add_u32 m0, s45, 16384
  v_fmac_f32 v48, v17, v28
  v_mfma_f32_16x16x32_bf16 v[96:99], a[180:183], a[96:99], v[96:99]
  ds_read_b64_tr_b16 a[170:171], v8 offset:34816
  v_fmac_f32 v49, v17, v29
  v_mfma_f32_16x16x32_bf16 v[96:99], a[176:179], a[112:115], v[96:99]
  buffer_load_dwordx4 v10, s[28:31], s66 offen lds
  v_fmac_f32 v50, v17, v30
  v_fmac_f32 v51, v17, v31
  v_mfma_f32_16x16x32_bf16 v[100:103], a[176:179], a[116:119], v[100:103]
  ds_read_b64_tr_b16 a[172:173], v8 offset:36864
  v_fmac_f32 v52, v19, v28
  v_mfma_f32_16x16x32_bf16 v[100:103], a[180:183], a[100:103], v[100:103]
  v_fmac_f32 v53, v19, v29
  v_fmac_f32 v54, v19, v30
  v_mfma_f32_16x16x32_bf16 v[104:107], a[180:183], a[104:107], v[104:107]
  ds_read_b64_tr_b16 a[174:175], v8 offset:38912
  v_fmac_f32 v55, v19, v31
  v_mfma_f32_16x16x32_bf16 v[104:107], a[176:179], a[120:123], v[104:107]
  s_add_u32 m0, s45, 24576
  v_fmac_f32 v56, v21, v28
  v_fmac_f32 v57, v21, v29
  v_mfma_f32_16x16x32_bf16 v[108:111], a[176:179], a[124:127], v[108:111]
  ds_read_b64_tr_b16 a[176:177], v8 offset:40960
  v_fmac_f32 v58, v21, v30
  v_mfma_f32_16x16x32_bf16 v[108:111], a[180:183], a[108:111], v[108:111]
  s_waitcnt lgkmcnt(6)
  buffer_load_dwordx4 v10, s[32:35], s66 offen lds
  v_fmac_f32 v59, v21, v31
  v_mfma_f32_16x16x32_bf16 v[124:127], a[160:163], a[108:111], v[124:127]
  ds_read_b64_tr_b16 a[178:179], v8 offset:43008
  v_fmac_f32 v60, v23, v28
  v_mfma_f32_16x16x32_bf16 v[124:127], a[164:167], a[124:127], v[124:127]
  s_add_u32 m0, s45, 20480
  s_add_u32 s61, s66, 229376
  v_fmac_f32 v61, v23, v29
  v_mfma_f32_16x16x32_bf16 v[120:123], a[164:167], a[120:123], v[120:123]
  ds_read_b64_tr_b16 a[180:181], v8 offset:45056
  v_fmac_f32 v62, v23, v30
  v_mfma_f32_16x16x32_bf16 v[120:123], a[160:163], a[104:107], v[120:123]
  buffer_load_dwordx4 v10, s[28:31], s61 offen lds
  v_fmac_f32 v63, v23, v31
  v_mfma_f32_16x16x32_bf16 v[116:119], a[160:163], a[100:103], v[116:119]
  ds_read_b64_tr_b16 a[182:183], v8 offset:47104
  v_mfma_f32_16x16x32_bf16 v[116:119], a[164:167], a[116:119], v[116:119]
  ds_read_b128 v[28:31], v12 offset:768
  v_mfma_f32_16x16x32_bf16 v[112:115], a[164:167], a[112:115], v[112:115]
  ds_read_b64_tr_b16 a[164:165], v2 offset:32768
  s_waitcnt lgkmcnt(10)
  v_mfma_f32_16x16x32_bf16 v[112:115], a[160:163], a[96:99], v[112:115]
  s_waitcnt lgkmcnt(6)
  s_add_u32 m0, s45, 28672
  s_add_u32 s61, s66, 229376
  v_mfma_f32_16x16x32_bf16 v[32:35], a[168:171], a[96:99], v[32:35]
  ds_read_b64_tr_b16 a[166:167], v2 offset:34816
  v_fmac_f32 v64, v16, v24
  v_mfma_f32_16x16x32_bf16 v[32:35], a[172:175], a[112:115], v[32:35]
  buffer_load_dwordx4 v10, s[32:35], s61 offen lds
  v_fmac_f32 v65, v16, v25
  v_fmac_f32 v66, v16, v26
  v_mfma_f32_16x16x32_bf16 v[36:39], a[172:175], a[116:119], v[36:39]
  ds_read_b64_tr_b16 a[160:161], v2 offset:36864
  v_fmac_f32 v67, v16, v27
  v_mfma_f32_16x16x32_bf16 v[36:39], a[168:171], a[100:103], v[36:39]
  v_fmac_f32 v68, v18, v24
  v_fmac_f32 v69, v18, v25
  v_mfma_f32_16x16x32_bf16 v[40:43], a[168:171], a[104:107], v[40:43]
  ds_read_b64_tr_b16 a[162:163], v2 offset:38912
  v_fmac_f32 v70, v18, v26
  v_mfma_f32_16x16x32_bf16 v[40:43], a[172:175], a[120:123], v[40:43]
  buffer_load_dwordx4 a[0:3], v1, s[8:11], s74 offen offset:0 sc1
  v_fmac_f32 v71, v18, v27
  v_fmac_f32 v72, v20, v24
  v_mfma_f32_16x16x32_bf16 v[44:47], a[172:175], a[124:127], v[44:47]
  ds_read_b64_tr_b16 a[172:173], v2 offset:40960
  v_fmac_f32 v73, v20, v25
  v_mfma_f32_16x16x32_bf16 v[44:47], a[168:171], a[108:111], v[44:47]
  s_waitcnt lgkmcnt(6)
  v_fmac_f32 v74, v20, v26
  v_fmac_f32 v75, v20, v27
  v_mfma_f32_16x16x32_bf16 v[60:63], a[176:179], a[108:111], v[60:63]
  ds_read_b64_tr_b16 a[174:175], v2 offset:43008
  v_fmac_f32 v76, v22, v24
  v_mfma_f32_16x16x32_bf16 v[60:63], a[180:183], a[124:127], v[60:63]
  v_fmac_f32 v77, v22, v25
  v_fmac_f32 v78, v22, v26
  v_mfma_f32_16x16x32_bf16 v[56:59], a[180:183], a[120:123], v[56:59]
  ds_read_b64_tr_b16 a[168:169], v2 offset:45056
  v_fmac_f32 v79, v22, v27
  v_mfma_f32_16x16x32_bf16 v[56:59], a[176:179], a[104:107], v[56:59]
  buffer_load_dwordx4 a[16:19], v1, s[8:11], s74 offen offset:1024 sc1
  ds_read_b128 v[24:27], v12 offset:1280
  v_mfma_f32_16x16x32_bf16 v[52:55], a[176:179], a[100:103], v[52:55]
  ds_read_b64_tr_b16 a[170:171], v2 offset:47104
  s_waitcnt lgkmcnt(9)
  v_mfma_f32_16x16x32_bf16 v[52:55], a[180:183], a[116:119], v[52:55]
  s_add_u32 s74, s74, 65536
  v_fmac_f32 v64, v17, v28
  v_fmac_f32 v65, v17, v29
  v_mfma_f32_16x16x32_bf16 v[48:51], a[180:183], a[112:115], v[48:51]
  ds_read_b64_tr_b16 a[180:181], v3 offset:32768
  v_fmac_f32 v66, v17, v30
  v_mfma_f32_16x16x32_bf16 v[48:51], a[176:179], a[96:99], v[48:51]
  s_waitcnt lgkmcnt(6)
  buffer_load_dwordx4 a[4:7], v1, s[8:11], s74 offen offset:0 sc1
  v_fmac_f32 v67, v17, v31
  v_mfma_f32_16x16x32_bf16 v[128:131], a[164:167], a[96:99], v[128:131]
  ds_read_b64_tr_b16 a[182:183], v3 offset:34816
  v_fmac_f32 v68, v19, v28
  v_mfma_f32_16x16x32_bf16 v[128:131], a[160:163], a[112:115], v[128:131]
  v_fmac_f32 v69, v19, v29
  v_fmac_f32 v70, v19, v30
  v_mfma_f32_16x16x32_bf16 v[132:135], a[160:163], a[116:119], v[132:135]
  ds_read_b64_tr_b16 a[176:177], v3 offset:36864
  v_fmac_f32 v71, v19, v31
  v_mfma_f32_16x16x32_bf16 v[132:135], a[164:167], a[100:103], v[132:135]
  v_fmac_f32 v72, v21, v28
  v_fmac_f32 v73, v21, v29
  v_mfma_f32_16x16x32_bf16 v[136:139], a[164:167], a[104:107], v[136:139]
  ds_read_b64_tr_b16 a[178:179], v3 offset:38912
  v_fmac_f32 v74, v21, v30
  v_mfma_f32_16x16x32_bf16 v[136:139], a[160:163], a[120:123], v[136:139]
  buffer_load_dwordx4 a[20:23], v1, s[8:11], s74 offen offset:1024 sc1
  v_fmac_f32 v75, v21, v31
  v_fmac_f32 v76, v23, v28
  v_mfma_f32_16x16x32_bf16 v[140:143], a[160:163], a[124:127], v[140:143]
  ds_read_b64_tr_b16 a[160:161], v3 offset:40960
  v_fmac_f32 v77, v23, v29
  v_mfma_f32_16x16x32_bf16 v[140:143], a[164:167], a[108:111], v[140:143]
  s_waitcnt lgkmcnt(5)
  s_add_u32 s74, s74, 65536
  v_fmac_f32 v78, v23, v30
  v_mfma_f32_16x16x32_bf16 v[156:159], a[172:175], a[108:111], v[156:159]
  ds_read_b64_tr_b16 a[162:163], v3 offset:43008
  v_fmac_f32 v79, v23, v31
  v_mfma_f32_16x16x32_bf16 v[156:159], a[168:171], a[124:127], v[156:159]
  buffer_load_dwordx4 a[8:11], v1, s[8:11], s74 offen offset:0 sc1
  ds_read_b128 v[28:31], v12 offset:1792
  v_mfma_f32_16x16x32_bf16 v[152:155], a[168:171], a[120:123], v[152:155]
  ds_read_b64_tr_b16 a[164:165], v3 offset:45056
  v_mfma_f32_16x16x32_bf16 v[152:155], a[172:175], a[104:107], v[152:155]
  v_mfma_f32_16x16x32_bf16 v[148:151], a[172:175], a[100:103], v[148:151]
  ds_read_b64_tr_b16 a[166:167], v3 offset:47104
  s_waitcnt lgkmcnt(10)
  v_mfma_f32_16x16x32_bf16 v[148:151], a[168:171], a[116:119], v[148:151]
  v_fmac_f32 v80, v16, v24
  v_fmac_f32 v81, v16, v25
  v_mfma_f32_16x16x32_bf16 v[144:147], a[168:171], a[112:115], v[144:147]
  ds_read_b64_tr_b16 a[168:169], v4 offset:32768
  v_fmac_f32 v82, v16, v26
  v_mfma_f32_16x16x32_bf16 v[144:147], a[172:175], a[96:99], v[144:147]
  s_waitcnt lgkmcnt(6)
  buffer_load_dwordx4 a[24:27], v1, s[8:11], s74 offen offset:1024 sc1
  v_fmac_f32 v83, v16, v27
  v_mfma_f32_16x16x32_bf16 v[160:163], a[180:183], a[96:99], v[160:163]
  ds_read_b64_tr_b16 a[170:171], v4 offset:34816
  v_fmac_f32 v84, v18, v24
  v_mfma_f32_16x16x32_bf16 v[160:163], a[176:179], a[112:115], v[160:163]
  s_add_u32 s74, s74, 65536
  v_fmac_f32 v85, v18, v25
  v_fmac_f32 v86, v18, v26
  v_mfma_f32_16x16x32_bf16 v[164:167], a[176:179], a[116:119], v[164:167]
  ds_read_b64_tr_b16 a[172:173], v4 offset:36864
  v_fmac_f32 v87, v18, v27
  v_mfma_f32_16x16x32_bf16 v[164:167], a[180:183], a[100:103], v[164:167]
  buffer_load_dwordx4 a[12:15], v1, s[8:11], s74 offen offset:0 sc1
  v_fmac_f32 v88, v20, v24
  v_fmac_f32 v89, v20, v25
  v_mfma_f32_16x16x32_bf16 v[168:171], a[180:183], a[104:107], v[168:171]
  ds_read_b64_tr_b16 a[174:175], v4 offset:38912
  v_fmac_f32 v90, v20, v26
  v_mfma_f32_16x16x32_bf16 v[168:171], a[176:179], a[120:123], v[168:171]
  v_fmac_f32 v91, v20, v27
  v_fmac_f32 v92, v22, v24
  v_mfma_f32_16x16x32_bf16 v[172:175], a[176:179], a[124:127], v[172:175]
  ds_read_b64_tr_b16 a[176:177], v4 offset:40960
  v_fmac_f32 v93, v22, v25
  v_mfma_f32_16x16x32_bf16 v[172:175], a[180:183], a[108:111], v[172:175]
  s_waitcnt lgkmcnt(5)
  v_fmac_f32 v94, v22, v26
  v_fmac_f32 v95, v22, v27
  v_mfma_f32_16x16x32_bf16 v[188:191], a[160:163], a[108:111], v[188:191]
  ds_read_b64_tr_b16 a[178:179], v4 offset:43008
  v_mfma_f32_16x16x32_bf16 v[188:191], a[164:167], a[124:127], v[188:191]
  buffer_load_dwordx4 a[28:31], v1, s[8:11], s74 offen offset:1024 sc1
  ds_read_b128 v[24:27], v12 offset:320
  v_mfma_f32_16x16x32_bf16 v[184:187], a[164:167], a[120:123], v[184:187]
  ds_read_b64_tr_b16 a[180:181], v4 offset:45056
  s_waitcnt lgkmcnt(10)
  v_mfma_f32_16x16x32_bf16 v[184:187], a[160:163], a[104:107], v[184:187]
  v_fmac_f32 v80, v17, v28
  v_fmac_f32 v81, v17, v29
  v_mfma_f32_16x16x32_bf16 v[180:183], a[160:163], a[100:103], v[180:183]
  ds_read_b64_tr_b16 a[182:183], v4 offset:47104
  v_fmac_f32 v82, v17, v30
  v_mfma_f32_16x16x32_bf16 v[180:183], a[164:167], a[116:119], v[180:183]
  buffer_load_dwordx4 a[32:35], v1, s[8:11], s75 offen offset:0 sc1
  v_fmac_f32 v83, v17, v31
  v_fmac_f32 v84, v19, v28
  v_mfma_f32_16x16x32_bf16 v[176:179], a[164:167], a[112:115], v[176:179]
  ds_read_b64_tr_b16 a[164:165], v5 offset:32768
  v_fmac_f32 v85, v19, v29
  v_mfma_f32_16x16x32_bf16 v[176:179], a[160:163], a[96:99], v[176:179]
  s_waitcnt lgkmcnt(6)
  v_fmac_f32 v86, v19, v30
  v_fmac_f32 v87, v19, v31
  v_mfma_f32_16x16x32_bf16 v[192:195], a[168:171], a[96:99], v[192:195]
  ds_read_b64_tr_b16 a[166:167], v5 offset:34816
  v_fmac_f32 v88, v21, v28
  v_mfma_f32_16x16x32_bf16 v[192:195], a[172:175], a[112:115], v[192:195]
  v_fmac_f32 v89, v21, v29
  v_fmac_f32 v90, v21, v30
  v_mfma_f32_16x16x32_bf16 v[196:199], a[172:175], a[116:119], v[196:199]
  ds_read_b64_tr_b16 a[160:161], v5 offset:36864
  v_fmac_f32 v91, v21, v31
  v_mfma_f32_16x16x32_bf16 v[196:199], a[168:171], a[100:103], v[196:199]
  buffer_load_dwordx4 a[48:51], v1, s[8:11], s75 offen offset:1024 sc1
  v_fmac_f32 v92, v23, v28
  v_fmac_f32 v93, v23, v29
  v_mfma_f32_16x16x32_bf16 v[200:203], a[168:171], a[104:107], v[200:203]
  ds_read_b64_tr_b16 a[162:163], v5 offset:38912
  v_fmac_f32 v94, v23, v30
  v_mfma_f32_16x16x32_bf16 v[200:203], a[172:175], a[120:123], v[200:203]
  s_add_u32 s75, s75, 65536
  v_fmac_f32 v95, v23, v31
  v_mfma_f32_16x16x32_bf16 v[204:207], a[172:175], a[124:127], v[204:207]
  ds_read_b64_tr_b16 a[172:173], v5 offset:40960
  v_mfma_f32_16x16x32_bf16 v[204:207], a[168:171], a[108:111], v[204:207]
  s_waitcnt lgkmcnt(5)
  buffer_load_dwordx4 a[36:39], v1, s[8:11], s75 offen offset:0 sc1
  v_mfma_f32_16x16x32_bf16 v[220:223], a[176:179], a[108:111], v[220:223]
  ds_read_b64_tr_b16 a[174:175], v5 offset:43008
  v_mfma_f32_16x16x32_bf16 v[220:223], a[180:183], a[124:127], v[220:223]
  ds_read_b128 v[28:31], v12 offset:832
  v_mfma_f32_16x16x32_bf16 v[216:219], a[180:183], a[120:123], v[216:219]
  ds_read_b64_tr_b16 a[168:169], v5 offset:45056
  s_waitcnt lgkmcnt(10)
  v_mfma_f32_16x16x32_bf16 v[216:219], a[176:179], a[104:107], v[216:219]
  v_fmac_f32 v96, v16, v24
  v_fmac_f32 v97, v16, v25
  v_mfma_f32_16x16x32_bf16 v[212:215], a[176:179], a[100:103], v[212:215]
  ds_read_b64_tr_b16 a[170:171], v5 offset:47104
  buffer_load_dwordx4 a[52:55], v1, s[8:11], s75 offen offset:1024 sc1
  v_mfma_f32_16x16x32_bf16 v[212:215], a[180:183], a[116:119], v[212:215]
  s_waitcnt vmcnt(32)
  s_barrier
  v_mfma_f32_16x16x32_bf16 v[208:211], a[180:183], a[112:115], v[208:211]
  ds_read_b64_tr_b16 a[180:181], v6 offset:49152
  v_fmac_f32 v98, v16, v26
  v_mfma_f32_16x16x32_bf16 v[208:211], a[176:179], a[96:99], v[208:211]
  s_waitcnt lgkmcnt(6)
  s_add_u32 s75, s75, 65536
  v_fmac_f32 v99, v16, v27
  v_mfma_f32_16x16x32_bf16 v[224:227], a[164:167], a[96:99], v[224:227]
  ds_read_b64_tr_b16 a[182:183], v6 offset:51200
  v_fmac_f32 v100, v18, v24
  v_mfma_f32_16x16x32_bf16 v[224:227], a[160:163], a[112:115], v[224:227]
  buffer_load_dwordx4 a[40:43], v1, s[8:11], s75 offen offset:0 sc1
  v_fmac_f32 v101, v18, v25
  v_fmac_f32 v102, v18, v26
  v_mfma_f32_16x16x32_bf16 v[228:231], a[160:163], a[116:119], v[228:231]
  ds_read_b64_tr_b16 a[176:177], v6 offset:53248
  v_fmac_f32 v103, v18, v27
  v_mfma_f32_16x16x32_bf16 v[228:231], a[164:167], a[100:103], v[228:231]
  v_fmac_f32 v104, v20, v24
  v_fmac_f32 v105, v20, v25
  v_mfma_f32_16x16x32_bf16 v[232:235], a[164:167], a[104:107], v[232:235]
  ds_read_b64_tr_b16 a[178:179], v6 offset:55296
  v_fmac_f32 v106, v20, v26
  v_mfma_f32_16x16x32_bf16 v[232:235], a[160:163], a[120:123], v[232:235]
  v_fmac_f32 v107, v20, v27
  v_fmac_f32 v108, v22, v24
  v_mfma_f32_16x16x32_bf16 v[236:239], a[160:163], a[124:127], v[236:239]
  ds_read_b64_tr_b16 a[160:161], v6 offset:57344
  v_fmac_f32 v109, v22, v25
  v_mfma_f32_16x16x32_bf16 v[236:239], a[164:167], a[108:111], v[236:239]
  s_waitcnt lgkmcnt(5)
  buffer_load_dwordx4 a[56:59], v1, s[8:11], s75 offen offset:1024 sc1
  v_fmac_f32 v110, v22, v26
  v_mfma_f32_16x16x32_bf16 v[252:255], a[172:175], a[108:111], v[252:255]
  ds_read_b64_tr_b16 a[162:163], v6 offset:59392
  v_fmac_f32 v111, v22, v27
  v_mfma_f32_16x16x32_bf16 v[252:255], a[168:171], a[124:127], v[252:255]
  s_add_u32 s75, s75, 65536
  ds_read_b128 v[24:27], v12 offset:0
  v_mfma_f32_16x16x32_bf16 v[248:251], a[168:171], a[120:123], v[248:251]
  ds_read_b64_tr_b16 a[164:165], v6 offset:61440
  s_waitcnt lgkmcnt(10)
  v_mfma_f32_16x16x32_bf16 v[248:251], a[172:175], a[104:107], v[248:251]
  buffer_load_dwordx4 a[44:47], v1, s[8:11], s75 offen offset:0 sc1
  v_fmac_f32 v96, v17, v28
  v_fmac_f32 v97, v17, v29
  v_mfma_f32_16x16x32_bf16 v[244:247], a[172:175], a[100:103], v[244:247]
  ds_read_b64_tr_b16 a[166:167], v6 offset:63488
  v_fmac_f32 v98, v17, v30
  v_mfma_f32_16x16x32_bf16 v[244:247], a[168:171], a[116:119], v[244:247]
  v_fmac_f32 v99, v17, v31
  v_fmac_f32 v100, v19, v28
  v_mfma_f32_16x16x32_bf16 v[240:243], a[168:171], a[112:115], v[240:243]
  ds_read_b64_tr_b16 a[168:169], v7 offset:49152
  v_fmac_f32 v101, v19, v29
  v_mfma_f32_16x16x32_bf16 v[240:243], a[172:175], a[96:99], v[240:243]
  s_waitcnt vmcnt(27) lgkmcnt(6)
  v_fmac_f32 v102, v19, v30
  v_fmac_f32 v103, v19, v31
  v_mfma_f32_16x16x32_bf16 v[64:67], a[180:183], a[128:131], v[64:67]
  ds_read_b64_tr_b16 a[170:171], v7 offset:51200
  v_fmac_f32 v104, v21, v28
  v_mfma_f32_16x16x32_bf16 v[64:67], a[176:179], a[144:147], v[64:67]
  buffer_load_dwordx4 a[60:63], v1, s[8:11], s75 offen offset:1024 sc1
  v_fmac_f32 v105, v21, v29
  v_fmac_f32 v106, v21, v30
  v_mfma_f32_16x16x32_bf16 v[68:71], a[176:179], a[148:151], v[68:71]
  ds_read_b64_tr_b16 a[172:173], v7 offset:53248
  v_fmac_f32 v107, v21, v31
  v_mfma_f32_16x16x32_bf16 v[68:71], a[180:183], a[132:135], v[68:71]
  s_cmp_eq_u32 s56, 0
  s_cselect_b32 s76, 4, 12
  s_mul_i32 s68, s76, 458752
  s_lshl_b32 s76, s76, 11
  s_add_u32 s76, s76, s57
  s_add_u32 m0, s45, 98304
  v_fmac_f32 v108, v23, v28
  v_fmac_f32 v109, v23, v29
  v_mfma_f32_16x16x32_bf16 v[72:75], a[180:183], a[136:139], v[72:75]
  ds_read_b64_tr_b16 a[174:175], v7 offset:55296
  v_fmac_f32 v110, v23, v30
  v_mfma_f32_16x16x32_bf16 v[72:75], a[176:179], a[152:155], v[72:75]
  buffer_load_dwordx4 v11, s[28:31], s68 offen lds
  v_fmac_f32 v111, v23, v31
  v_mfma_f32_16x16x32_bf16 v[76:79], a[176:179], a[156:159], v[76:79]
  ds_read_b64_tr_b16 a[176:177], v7 offset:57344
  v_mfma_f32_16x16x32_bf16 v[76:79], a[180:183], a[140:143], v[76:79]
  s_waitcnt lgkmcnt(5)
  ds_read_b128 v[28:31], v12 offset:512
  v_mfma_f32_16x16x32_bf16 v[92:95], a[160:163], a[140:143], v[92:95]
  ds_read_b64_tr_b16 a[178:179], v7 offset:59392
  s_waitcnt lgkmcnt(9)
  v_mfma_f32_16x16x32_bf16 v[92:95], a[164:167], a[156:159], v[92:95]
  s_add_u32 m0, s45, 106496
  v_fmac_f32 v128, v16, v24
  v_fmac_f32 v129, v16, v25
  v_mfma_f32_16x16x32_bf16 v[88:91], a[164:167], a[152:155], v[88:91]
  ds_read_b64_tr_b16 a[180:181], v7 offset:61440
  v_fmac_f32 v130, v16, v26
  v_mfma_f32_16x16x32_bf16 v[88:91], a[160:163], a[136:139], v[88:91]
  buffer_load_dwordx4 v11, s[32:35], s68 offen lds
  v_fmac_f32 v131, v16, v27
  v_fmac_f32 v132, v18, v24
  v_mfma_f32_16x16x32_bf16 v[84:87], a[160:163], a[132:135], v[84:87]
  ds_read_b64_tr_b16 a[182:183], v7 offset:63488
  v_fmac_f32 v133, v18, v25
  v_mfma_f32_16x16x32_bf16 v[84:87], a[164:167], a[148:151], v[84:87]
  s_add_u32 m0, s45, 102400
  s_add_u32 s61, s68, 229376
  v_fmac_f32 v134, v18, v26
  v_mfma_f32_16x16x32_bf16 v[80:83], a[164:167], a[144:147], v[80:83]
  ds_read_b64_tr_b16 a[164:165], v8 offset:49152
  v_fmac_f32 v135, v18, v27
  v_mfma_f32_16x16x32_bf16 v[80:83], a[160:163], a[128:131], v[80:83]
  s_waitcnt lgkmcnt(6)
  buffer_load_dwordx4 v11, s[28:31], s61 offen lds
  v_fmac_f32 v136, v20, v24
  v_mfma_f32_16x16x32_bf16 v[96:99], a[168:171], a[128:131], v[96:99]
  ds_read_b64_tr_b16 a[166:167], v8 offset:51200
  v_fmac_f32 v137, v20, v25
  v_mfma_f32_16x16x32_bf16 v[96:99], a[172:175], a[144:147], v[96:99]
  v_fmac_f32 v138, v20, v26
  v_fmac_f32 v139, v20, v27
  v_mfma_f32_16x16x32_bf16 v[100:103], a[172:175], a[148:151], v[100:103]
  ds_read_b64_tr_b16 a[160:161], v8 offset:53248
  v_fmac_f32 v140, v22, v24
  v_mfma_f32_16x16x32_bf16 v[100:103], a[168:171], a[132:135], v[100:103]
  s_add_u32 m0, s45, 110592
  s_add_u32 s61, s68, 229376
  v_fmac_f32 v141, v22, v25
  v_mfma_f32_16x16x32_bf16 v[104:107], a[168:171], a[136:139], v[104:107]
  ds_read_b64_tr_b16 a[162:163], v8 offset:55296
  v_fmac_f32 v142, v22, v26
  v_mfma_f32_16x16x32_bf16 v[104:107], a[172:175], a[152:155], v[104:107]
  buffer_load_dwordx4 v11, s[32:35], s61 offen lds
  v_fmac_f32 v143, v22, v27
  v_mfma_f32_16x16x32_bf16 v[108:111], a[172:175], a[156:159], v[108:111]
  ds_read_b64_tr_b16 a[172:173], v8 offset:57344
  v_mfma_f32_16x16x32_bf16 v[108:111], a[168:171], a[140:143], v[108:111]
  s_waitcnt lgkmcnt(5)
  s_add_u32 s62, s92, 0
  v_mfma_f32_16x16x32_bf16 v[124:127], a[176:179], a[140:143], v[124:127]
  ds_read_b64_tr_b16 a[174:175], v8 offset:59392
  v_mfma_f32_16x16x32_bf16 v[124:127], a[180:183], a[156:159], v[124:127]
  buffer_load_dword a253, v13, s[36:39], s62 offen
  ds_read_b128 v[24:27], v12 offset:1344
  v_mfma_f32_16x16x32_bf16 v[120:123], a[180:183], a[152:155], v[120:123]
  ds_read_b64_tr_b16 a[168:169], v8 offset:61440
  s_waitcnt lgkmcnt(11)
  v_mfma_f32_16x16x32_bf16 v[120:123], a[176:179], a[136:139], v[120:123]
  v_fmac_f32 v128, v17, v28
  v_fmac_f32 v129, v17, v29
  v_mfma_f32_16x16x32_bf16 v[116:119], a[176:179], a[132:135], v[116:119]
  ds_read_b64_tr_b16 a[170:171], v8 offset:63488
  v_fmac_f32 v130, v17, v30
  v_mfma_f32_16x16x32_bf16 v[116:119], a[180:183], a[148:151], v[116:119]
  v_fmac_f32 v131, v17, v31
  v_fmac_f32 v132, v19, v28
  v_mfma_f32_16x16x32_bf16 v[112:115], a[180:183], a[144:147], v[112:115]
  ds_read_b64_tr_b16 a[180:181], v2 offset:49152
  v_fmac_f32 v133, v19, v29
  v_mfma_f32_16x16x32_bf16 v[112:115], a[176:179], a[128:131], v[112:115]
  s_waitcnt lgkmcnt(6)
  v_fmac_f32 v134, v19, v30
  v_fmac_f32 v135, v19, v31
  v_mfma_f32_16x16x32_bf16 v[32:35], a[164:167], a[128:131], v[32:35]
  ds_read_b64_tr_b16 a[182:183], v2 offset:51200
  v_fmac_f32 v136, v21, v28
  v_mfma_f32_16x16x32_bf16 v[32:35], a[160:163], a[144:147], v[32:35]
  v_fmac_f32 v137, v21, v29
  v_fmac_f32 v138, v21, v30
  v_mfma_f32_16x16x32_bf16 v[36:39], a[160:163], a[148:151], v[36:39]
  ds_read_b64_tr_b16 a[176:177], v2 offset:53248
  v_fmac_f32 v139, v21, v31
  v_mfma_f32_16x16x32_bf16 v[36:39], a[164:167], a[132:135], v[36:39]
  buffer_load_dwordx4 a[64:67], v1, s[8:11], s76 offen offset:0 sc1
  v_fmac_f32 v140, v23, v28
  v_fmac_f32 v141, v23, v29
  v_mfma_f32_16x16x32_bf16 v[40:43], a[164:167], a[136:139], v[40:43]
  ds_read_b64_tr_b16 a[178:179], v2 offset:55296
  v_fmac_f32 v142, v23, v30
  v_mfma_f32_16x16x32_bf16 v[40:43], a[160:163], a[152:155], v[40:43]
  v_fmac_f32 v143, v23, v31
  v_mfma_f32_16x16x32_bf16 v[44:47], a[160:163], a[156:159], v[44:47]
  ds_read_b64_tr_b16 a[160:161], v2 offset:57344
  v_mfma_f32_16x16x32_bf16 v[44:47], a[164:167], a[140:143], v[44:47]
  s_waitcnt lgkmcnt(5)
  ds_read_b128 v[28:31], v12 offset:1856
  v_mfma_f32_16x16x32_bf16 v[60:63], a[172:175], a[140:143], v[60:63]
  ds_read_b64_tr_b16 a[162:163], v2 offset:59392
  s_waitcnt lgkmcnt(9)
  v_mfma_f32_16x16x32_bf16 v[60:63], a[168:171], a[156:159], v[60:63]
  buffer_load_dwordx4 a[80:83], v1, s[8:11], s76 offen offset:1024 sc1
  v_fmac_f32 v112, v16, v24
  v_fmac_f32 v113, v16, v25
  v_mfma_f32_16x16x32_bf16 v[56:59], a[168:171], a[152:155], v[56:59]
  ds_read_b64_tr_b16 a[164:165], v2 offset:61440
  v_fmac_f32 v114, v16, v26
  v_mfma_f32_16x16x32_bf16 v[56:59], a[172:175], a[136:139], v[56:59]
  s_add_u32 s76, s76, 65536
  v_fmac_f32 v115, v16, v27
  v_fmac_f32 v116, v18, v24
  v_mfma_f32_16x16x32_bf16 v[52:55], a[172:175], a[132:135], v[52:55]
  ds_read_b64_tr_b16 a[166:167], v2 offset:63488
  v_fmac_f32 v117, v18, v25
  v_mfma_f32_16x16x32_bf16 v[52:55], a[168:171], a[148:151], v[52:55]
  buffer_load_dwordx4 a[68:71], v1, s[8:11], s76 offen offset:0 sc1
  v_fmac_f32 v118, v18, v26
  v_fmac_f32 v119, v18, v27
  v_mfma_f32_16x16x32_bf16 v[48:51], a[168:171], a[144:147], v[48:51]
HOP12:
  s_cbranch_execz WRET0
  ds_read_b64_tr_b16 a[168:169], v3 offset:49152
  v_fmac_f32 v120, v20, v24
  v_mfma_f32_16x16x32_bf16 v[48:51], a[172:175], a[128:131], v[48:51]
  s_waitcnt lgkmcnt(6)
  v_fmac_f32 v121, v20, v25
  v_fmac_f32 v122, v20, v26
  v_mfma_f32_16x16x32_bf16 v[128:131], a[180:183], a[128:131], v[128:131]
  ds_read_b64_tr_b16 a[170:171], v3 offset:51200
  v_fmac_f32 v123, v20, v27
  v_mfma_f32_16x16x32_bf16 v[128:131], a[176:179], a[144:147], v[128:131]
  v_fmac_f32 v124, v22, v24
  v_fmac_f32 v125, v22, v25
  v_mfma_f32_16x16x32_bf16 v[132:135], a[176:179], a[148:151], v[132:135]
  ds_read_b64_tr_b16 a[172:173], v3 offset:53248
  v_fmac_f32 v126, v22, v26
  v_mfma_f32_16x16x32_bf16 v[132:135], a[180:183], a[132:135], v[132:135]
  buffer_load_dwordx4 a[84:87], v1, s[8:11], s76 offen offset:1024 sc1
  v_fmac_f32 v127, v22, v27
  v_mfma_f32_16x16x32_bf16 v[136:139], a[180:183], a[136:139], v[136:139]
  ds_read_b64_tr_b16 a[174:175], v3 offset:55296
  v_mfma_f32_16x16x32_bf16 v[136:139], a[176:179], a[152:155], v[136:139]
  s_add_u32 s76, s76, 65536
  ds_read_b128 v[24:27], v12 offset:1024
  v_mfma_f32_16x16x32_bf16 v[140:143], a[176:179], a[156:159], v[140:143]
  ds_read_b64_tr_b16 a[176:177], v3 offset:57344
  s_waitcnt lgkmcnt(9)
  v_mfma_f32_16x16x32_bf16 v[140:143], a[180:183], a[140:143], v[140:143]
  s_waitcnt lgkmcnt(6)
  buffer_load_dwordx4 a[72:75], v1, s[8:11], s76 offen offset:0 sc1
  v_fmac_f32 v112, v17, v28
  v_mfma_f32_16x16x32_bf16 v[156:159], a[160:163], a[140:143], v[156:159]
  ds_read_b64_tr_b16 a[178:179], v3 offset:59392
  v_fmac_f32 v113, v17, v29
  v_mfma_f32_16x16x32_bf16 v[156:159], a[164:167], a[156:159], v[156:159]
  v_fmac_f32 v114, v17, v30
  v_fmac_f32 v115, v17, v31
  v_mfma_f32_16x16x32_bf16 v[152:155], a[164:167], a[152:155], v[152:155]
  ds_read_b64_tr_b16 a[180:181], v3 offset:61440
  v_fmac_f32 v116, v19, v28
  v_mfma_f32_16x16x32_bf16 v[152:155], a[160:163], a[136:139], v[152:155]
  v_fmac_f32 v117, v19, v29
  v_fmac_f32 v118, v19, v30
  v_mfma_f32_16x16x32_bf16 v[148:151], a[160:163], a[132:135], v[148:151]
  ds_read_b64_tr_b16 a[182:183], v3 offset:63488
  v_fmac_f32 v119, v19, v31
  v_mfma_f32_16x16x32_bf16 v[148:151], a[164:167], a[148:151], v[148:151]
  buffer_load_dwordx4 a[88:91], v1, s[8:11], s76 offen offset:1024 sc1
  v_fmac_f32 v120, v21, v28
  v_fmac_f32 v121, v21, v29
  v_mfma_f32_16x16x32_bf16 v[144:147], a[164:167], a[144:147], v[144:147]
  ds_read_b64_tr_b16 a[164:165], v4 offset:49152
  v_fmac_f32 v122, v21, v30
  v_mfma_f32_16x16x32_bf16 v[144:147], a[160:163], a[128:131], v[144:147]
  s_waitcnt lgkmcnt(6)
  s_add_u32 s76, s76, 65536
  v_fmac_f32 v123, v21, v31
  v_mfma_f32_16x16x32_bf16 v[160:163], a[168:171], a[128:131], v[160:163]
  ds_read_b64_tr_b16 a[166:167], v4 offset:51200
  v_fmac_f32 v124, v23, v28
  v_mfma_f32_16x16x32_bf16 v[160:163], a[172:175], a[144:147], v[160:163]
  buffer_load_dwordx4 a[76:79], v1, s[8:11], s76 offen offset:0 sc1
  v_fmac_f32 v125, v23, v29
  v_fmac_f32 v126, v23, v30
  v_mfma_f32_16x16x32_bf16 v[164:167], a[172:175], a[148:151], v[164:167]
  ds_read_b64_tr_b16 a[160:161], v4 offset:53248
  v_fmac_f32 v127, v23, v31
  v_mfma_f32_16x16x32_bf16 v[164:167], a[168:171], a[132:135], v[164:167]
  ds_read_b128 v[28:31], v12 offset:1536
  v_mfma_f32_16x16x32_bf16 v[168:171], a[168:171], a[136:139], v[168:171]
  ds_read_b64_tr_b16 a[162:163], v4 offset:55296
  v_mfma_f32_16x16x32_bf16 v[168:171], a[172:175], a[152:155], v[168:171]
  v_mfma_f32_16x16x32_bf16 v[172:175], a[172:175], a[156:159], v[172:175]
  ds_read_b64_tr_b16 a[172:173], v4 offset:57344
  s_waitcnt lgkmcnt(10)
  v_mfma_f32_16x16x32_bf16 v[172:175], a[168:171], a[140:143], v[172:175]
  s_waitcnt lgkmcnt(6)
  buffer_load_dwordx4 a[92:95], v1, s[8:11], s76 offen offset:1024 sc1
  v_fmac_f32 v144, v16, v24
  v_mfma_f32_16x16x32_bf16 v[188:191], a[176:179], a[140:143], v[188:191]
  ds_read_b64_tr_b16 a[174:175], v4 offset:59392
  v_fmac_f32 v145, v16, v25
  v_mfma_f32_16x16x32_bf16 v[188:191], a[180:183], a[156:159], v[188:191]
  s_cmp_eq_u32 s56, 1
  s_cselect_b32 s77, 5, 13
  s_mul_i32 s69, s77, 458752
  s_lshl_b32 s77, s77, 11
  s_add_u32 s77, s77, s57
  v_fmac_f32 v146, v16, v26
  v_fmac_f32 v147, v16, v27
  v_mfma_f32_16x16x32_bf16 v[184:187], a[180:183], a[152:155], v[184:187]
  ds_read_b64_tr_b16 a[168:169], v4 offset:61440
  v_fmac_f32 v148, v18, v24
  v_mfma_f32_16x16x32_bf16 v[184:187], a[176:179], a[136:139], v[184:187]
  buffer_load_dwordx4 a[96:99], v1, s[8:11], s77 offen offset:0 sc1
  v_fmac_f32 v149, v18, v25
  v_fmac_f32 v150, v18, v26
  v_mfma_f32_16x16x32_bf16 v[180:183], a[176:179], a[132:135], v[180:183]
  ds_read_b64_tr_b16 a[170:171], v4 offset:63488
  v_fmac_f32 v151, v18, v27
  v_mfma_f32_16x16x32_bf16 v[180:183], a[180:183], a[148:151], v[180:183]
  v_fmac_f32 v152, v20, v24
  v_fmac_f32 v153, v20, v25
  v_mfma_f32_16x16x32_bf16 v[176:179], a[180:183], a[144:147], v[176:179]
  ds_read_b64_tr_b16 a[180:181], v5 offset:49152
  v_fmac_f32 v154, v20, v26
  v_mfma_f32_16x16x32_bf16 v[176:179], a[176:179], a[128:131], v[176:179]
  s_waitcnt lgkmcnt(5)
  v_fmac_f32 v155, v20, v27
  v_fmac_f32 v156, v22, v24
  v_mfma_f32_16x16x32_bf16 v[192:195], a[164:167], a[128:131], v[192:195]
  ds_read_b64_tr_b16 a[182:183], v5 offset:51200
  v_fmac_f32 v157, v22, v25
  v_mfma_f32_16x16x32_bf16 v[192:195], a[160:163], a[144:147], v[192:195]
  buffer_load_dwordx4 a[112:115], v1, s[8:11], s77 offen offset:1024 sc1
  v_fmac_f32 v158, v22, v26
  v_fmac_f32 v159, v22, v27
  v_mfma_f32_16x16x32_bf16 v[196:199], a[160:163], a[148:151], v[196:199]
  ds_read_b64_tr_b16 a[176:177], v5 offset:53248
  v_mfma_f32_16x16x32_bf16 v[196:199], a[164:167], a[132:135], v[196:199]
  s_add_u32 s77, s77, 65536
  ds_read_b128 v[24:27], v12 offset:64
  v_mfma_f32_16x16x32_bf16 v[200:203], a[164:167], a[136:139], v[200:203]
  ds_read_b64_tr_b16 a[178:179], v5 offset:55296
  s_waitcnt lgkmcnt(10)
  v_mfma_f32_16x16x32_bf16 v[200:203], a[160:163], a[152:155], v[200:203]
  buffer_load_dwordx4 a[100:103], v1, s[8:11], s77 offen offset:0 sc1
  v_fmac_f32 v144, v17, v28
  v_fmac_f32 v145, v17, v29
  v_mfma_f32_16x16x32_bf16 v[204:207], a[160:163], a[156:159], v[204:207]
  ds_read_b64_tr_b16 a[160:161], v5 offset:57344
  v_fmac_f32 v146, v17, v30
  v_mfma_f32_16x16x32_bf16 v[204:207], a[164:167], a[140:143], v[204:207]
  s_waitcnt lgkmcnt(6)
  v_fmac_f32 v147, v17, v31
  v_fmac_f32 v148, v19, v28
  v_mfma_f32_16x16x32_bf16 v[220:223], a[172:175], a[140:143], v[220:223]
  ds_read_b64_tr_b16 a[162:163], v5 offset:59392
  v_fmac_f32 v149, v19, v29
  v_mfma_f32_16x16x32_bf16 v[220:223], a[168:171], a[156:159], v[220:223]
  v_fmac_f32 v150, v19, v30
  v_fmac_f32 v151, v19, v31
  v_mfma_f32_16x16x32_bf16 v[216:219], a[168:171], a[152:155], v[216:219]
  ds_read_b64_tr_b16 a[164:165], v5 offset:61440
  v_fmac_f32 v152, v21, v28
  v_mfma_f32_16x16x32_bf16 v[216:219], a[172:175], a[136:139], v[216:219]
  buffer_load_dwordx4 a[116:119], v1, s[8:11], s77 offen offset:1024 sc1
  v_fmac_f32 v153, v21, v29
  v_fmac_f32 v154, v21, v30
  v_mfma_f32_16x16x32_bf16 v[212:215], a[172:175], a[132:135], v[212:215]
  ds_read_b64_tr_b16 a[166:167], v5 offset:63488
  v_fmac_f32 v155, v21, v31
  v_mfma_f32_16x16x32_bf16 v[212:215], a[168:171], a[148:151], v[212:215]
  s_waitcnt vmcnt(33)
  s_barrier
  v_mfma_f32_16x16x32_bf16 v[208:211], a[168:171], a[144:147], v[208:211]
  ds_read_b64_tr_b16 a[168:169], v6 offset:16384
  s_add_u32 s62, s92, 2048
  v_mfma_f32_16x16x32_bf16 v[208:211], a[172:175], a[128:131], v[208:211]
  s_waitcnt lgkmcnt(5)
  buffer_load_dword a253, v13, s[36:39], s62 offen
  v_fmac_f32 v156, v23, v28
  v_mfma_f32_16x16x32_bf16 v[224:227], a[180:183], a[128:131], v[224:227]
  ds_read_b64_tr_b16 a[170:171], v6 offset:18432
  v_fmac_f32 v157, v23, v29
  v_mfma_f32_16x16x32_bf16 v[224:227], a[176:179], a[144:147], v[224:227]
  v_fmac_f32 v158, v23, v30
  v_fmac_f32 v159, v23, v31
  v_mfma_f32_16x16x32_bf16 v[228:231], a[176:179], a[148:151], v[228:231]
  ds_read_b64_tr_b16 a[172:173], v6 offset:20480
  v_mfma_f32_16x16x32_bf16 v[228:231], a[180:183], a[132:135], v[228:231]
  ds_read_b128 v[28:31], v12 offset:576
  v_mfma_f32_16x16x32_bf16 v[232:235], a[180:183], a[136:139], v[232:235]
  ds_read_b64_tr_b16 a[174:175], v6 offset:22528
  s_waitcnt lgkmcnt(10)
  v_mfma_f32_16x16x32_bf16 v[232:235], a[176:179], a[152:155], v[232:235]
  v_fmac_f32 v160, v16, v24
  v_fmac_f32 v161, v16, v25
  v_mfma_f32_16x16x32_bf16 v[236:239], a[176:179], a[156:159], v[236:239]
  ds_read_b64_tr_b16 a[176:177], v6 offset:24576
  v_fmac_f32 v162, v16, v26
  v_mfma_f32_16x16x32_bf16 v[236:239], a[180:183], a[140:143], v[236:239]
  s_waitcnt lgkmcnt(6)
  s_add_u32 m0, s45, 114688
  v_fmac_f32 v163, v16, v27
  v_mfma_f32_16x16x32_bf16 v[252:255], a[160:163], a[140:143], v[252:255]
  ds_read_b64_tr_b16 a[178:179], v6 offset:26624
  v_fmac_f32 v164, v18, v24
  v_mfma_f32_16x16x32_bf16 v[252:255], a[164:167], a[156:159], v[252:255]
  buffer_load_dwordx4 v11, s[28:31], s69 offen lds
  v_fmac_f32 v165, v18, v25
  v_fmac_f32 v166, v18, v26
  v_mfma_f32_16x16x32_bf16 v[248:251], a[164:167], a[152:155], v[248:251]
  ds_read_b64_tr_b16 a[180:181], v6 offset:28672
  v_fmac_f32 v167, v18, v27
  v_mfma_f32_16x16x32_bf16 v[248:251], a[160:163], a[136:139], v[248:251]
  v_fmac_f32 v168, v20, v24
  v_fmac_f32 v169, v20, v25
  v_mfma_f32_16x16x32_bf16 v[244:247], a[160:163], a[132:135], v[244:247]
  ds_read_b64_tr_b16 a[182:183], v6 offset:30720
  v_fmac_f32 v170, v20, v26
  v_mfma_f32_16x16x32_bf16 v[244:247], a[164:167], a[148:151], v[244:247]
  s_add_u32 m0, s45, 122880
  v_fmac_f32 v171, v20, v27
  v_fmac_f32 v172, v22, v24
  v_mfma_f32_16x16x32_bf16 v[240:243], a[164:167], a[144:147], v[240:243]
  ds_read_b64_tr_b16 a[164:165], v7 offset:16384
  v_fmac_f32 v173, v22, v25
  v_mfma_f32_16x16x32_bf16 v[240:243], a[160:163], a[128:131], v[240:243]
  s_waitcnt vmcnt(27) lgkmcnt(5)
  buffer_load_dwordx4 v11, s[32:35], s69 offen lds
  v_fmac_f32 v174, v22, v26
  v_mfma_f32_16x16x32_bf16 v[64:67], a[168:171], a[0:3], v[64:67]
  ds_read_b64_tr_b16 a[166:167], v7 offset:18432
  v_fmac_f32 v175, v22, v27
  v_mfma_f32_16x16x32_bf16 v[64:67], a[172:175], a[16:19], v[64:67]
  s_add_u32 m0, s45, 118784
  s_add_u32 s61, s69, 229376
  v_mfma_f32_16x16x32_bf16 v[68:71], a[172:175], a[20:23], v[68:71]
  ds_read_b64_tr_b16 a[160:161], v7 offset:20480
  v_mfma_f32_16x16x32_bf16 v[68:71], a[168:171], a[4:7], v[68:71]
  buffer_load_dwordx4 v11, s[28:31], s61 offen lds
  ds_read_b128 v[24:27], v12 offset:1088
  v_mfma_f32_16x16x32_bf16 v[72:75], a[168:171], a[8:11], v[72:75]
  ds_read_b64_tr_b16 a[162:163], v7 offset:22528
  s_waitcnt lgkmcnt(10)
  v_mfma_f32_16x16x32_bf16 v[72:75], a[172:175], a[24:27], v[72:75]
  v_fmac_f32 v160, v17, v28
  v_fmac_f32 v161, v17, v29
  v_mfma_f32_16x16x32_bf16 v[76:79], a[172:175], a[28:31], v[76:79]
  ds_read_b64_tr_b16 a[172:173], v7 offset:24576
  v_fmac_f32 v162, v17, v30
  v_mfma_f32_16x16x32_bf16 v[76:79], a[168:171], a[12:15], v[76:79]
  s_waitcnt lgkmcnt(6)
  s_add_u32 m0, s45, 126976
  s_add_u32 s61, s69, 229376
  v_mfma_f32_16x16x32_bf16 v[92:95], a[176:179], a[12:15], v[92:95]
  ds_read_b64_tr_b16 a[174:175], v7 offset:26624
  v_fmac_f32 v163, v17, v31
  v_mfma_f32_16x16x32_bf16 v[92:95], a[180:183], a[28:31], v[92:95]
  buffer_load_dwordx4 v11, s[32:35], s61 offen lds
  v_fmac_f32 v164, v19, v28
  v_fmac_f32 v165, v19, v29
  v_mfma_f32_16x16x32_bf16 v[88:91], a[180:183], a[24:27], v[88:91]
  ds_read_b64_tr_b16 a[168:169], v7 offset:28672
  v_fmac_f32 v166, v19, v30
  v_mfma_f32_16x16x32_bf16 v[88:91], a[176:179], a[8:11], v[88:91]
  s_add_u32 s77, s77, 65536
  v_fmac_f32 v167, v19, v31
  v_fmac_f32 v168, v21, v28
  v_mfma_f32_16x16x32_bf16 v[84:87], a[176:179], a[4:7], v[84:87]
  ds_read_b64_tr_b16 a[170:171], v7 offset:30720
  v_fmac_f32 v169, v21, v29
  v_mfma_f32_16x16x32_bf16 v[84:87], a[180:183], a[20:23], v[84:87]
  buffer_load_dwordx4 a[104:107], v1, s[8:11], s77 offen offset:0 sc1
  v_fmac_f32 v170, v21, v30
  v_fmac_f32 v171, v21, v31
  v_mfma_f32_16x16x32_bf16 v[80:83], a[180:183], a[16:19], v[80:83]
  ds_read_b64_tr_b16 a[180:181], v8 offset:16384
  v_fmac_f32 v172, v23, v28
  v_mfma_f32_16x16x32_bf16 v[80:83], a[176:179], a[0:3], v[80:83]
  s_waitcnt lgkmcnt(5)
  v_fmac_f32 v173, v23, v29
  v_fmac_f32 v174, v23, v30
  v_mfma_f32_16x16x32_bf16 v[96:99], a[164:167], a[0:3], v[96:99]
  ds_read_b64_tr_b16 a[182:183], v8 offset:18432
  v_fmac_f32 v175, v23, v31
  v_mfma_f32_16x16x32_bf16 v[96:99], a[160:163], a[16:19], v[96:99]
  ds_read_b128 v[28:31], v12 offset:1600
  v_mfma_f32_16x16x32_bf16 v[100:103], a[160:163], a[20:23], v[100:103]
  ds_read_b64_tr_b16 a[176:177], v8 offset:20480
  s_waitcnt lgkmcnt(9)
  v_mfma_f32_16x16x32_bf16 v[100:103], a[164:167], a[4:7], v[100:103]
  buffer_load_dwordx4 a[120:123], v1, s[8:11], s77 offen offset:1024 sc1
  v_fmac_f32 v176, v16, v24
  v_fmac_f32 v177, v16, v25
  v_mfma_f32_16x16x32_bf16 v[104:107], a[164:167], a[8:11], v[104:107]
  ds_read_b64_tr_b16 a[178:179], v8 offset:22528
  v_fmac_f32 v178, v16, v26
  v_mfma_f32_16x16x32_bf16 v[104:107], a[160:163], a[24:27], v[104:107]
  s_add_u32 s77, s77, 65536
  v_fmac_f32 v179, v16, v27
  v_fmac_f32 v180, v18, v24
  v_mfma_f32_16x16x32_bf16 v[108:111], a[160:163], a[28:31], v[108:111]
  ds_read_b64_tr_b16 a[160:161], v8 offset:24576
  v_fmac_f32 v181, v18, v25
  v_mfma_f32_16x16x32_bf16 v[108:111], a[164:167], a[12:15], v[108:111]
  s_waitcnt lgkmcnt(6)
  buffer_load_dwordx4 a[108:111], v1, s[8:11], s77 offen offset:0 sc1
  v_fmac_f32 v182, v18, v26
  v_mfma_f32_16x16x32_bf16 v[124:127], a[172:175], a[12:15], v[124:127]
  ds_read_b64_tr_b16 a[162:163], v8 offset:26624
  v_fmac_f32 v183, v18, v27
  v_mfma_f32_16x16x32_bf16 v[124:127], a[168:171], a[28:31], v[124:127]
  v_fmac_f32 v184, v20, v24
  v_fmac_f32 v185, v20, v25
  v_mfma_f32_16x16x32_bf16 v[120:123], a[168:171], a[24:27], v[120:123]
  ds_read_b64_tr_b16 a[164:165], v8 offset:28672
  v_fmac_f32 v186, v20, v26
  v_mfma_f32_16x16x32_bf16 v[120:123], a[172:175], a[8:11], v[120:123]
  v_fmac_f32 v187, v20, v27
  v_fmac_f32 v188, v22, v24
  v_mfma_f32_16x16x32_bf16 v[116:119], a[172:175], a[4:7], v[116:119]
  ds_read_b64_tr_b16 a[166:167], v8 offset:30720
  v_fmac_f32 v189, v22, v25
  v_mfma_f32_16x16x32_bf16 v[116:119], a[168:171], a[20:23], v[116:119]
  buffer_load_dwordx4 a[124:127], v1, s[8:11], s77 offen offset:1024 sc1
  v_fmac_f32 v190, v22, v26
  v_fmac_f32 v191, v22, v27
  v_mfma_f32_16x16x32_bf16 v[112:115], a[168:171], a[16:19], v[112:115]
  ds_read_b64_tr_b16 a[168:169], v6 offset:0
  v_mfma_f32_16x16x32_bf16 v[112:115], a[172:175], a[0:3], v[112:115]
  s_waitcnt lgkmcnt(5)
  s_cmp_eq_u32 s56, 2
  s_cselect_b32 s78, 6, 14
  s_mul_i32 s70, s78, 458752
  s_lshl_b32 s78, s78, 11
  s_add_u32 s78, s78, s57
  v_mfma_f32_16x16x32_bf16 v[32:35], a[180:183], a[0:3], v[32:35]
  ds_read_b64_tr_b16 a[170:171], v6 offset:2048
  v_mfma_f32_16x16x32_bf16 v[32:35], a[176:179], a[16:19], v[32:35]
  buffer_load_dwordx4 a[128:131], v1, s[8:11], s78 offen offset:0 sc1
  ds_read_b128 v[24:27], v12 offset:128
  v_mfma_f32_16x16x32_bf16 v[36:39], a[176:179], a[20:23], v[36:39]
  ds_read_b64_tr_b16 a[172:173], v6 offset:4096
  s_waitcnt lgkmcnt(10)
  v_mfma_f32_16x16x32_bf16 v[36:39], a[180:183], a[4:7], v[36:39]
  v_fmac_f32 v176, v17, v28
  v_fmac_f32 v177, v17, v29
  v_mfma_f32_16x16x32_bf16 v[40:43], a[180:183], a[8:11], v[40:43]
  ds_read_b64_tr_b16 a[174:175], v6 offset:6144
  v_fmac_f32 v178, v17, v30
  v_mfma_f32_16x16x32_bf16 v[40:43], a[176:179], a[24:27], v[40:43]
  v_fmac_f32 v179, v17, v31
  v_fmac_f32 v180, v19, v28
  v_mfma_f32_16x16x32_bf16 v[44:47], a[176:179], a[28:31], v[44:47]
  ds_read_b64_tr_b16 a[176:177], v6 offset:8192
  v_fmac_f32 v181, v19, v29
  v_mfma_f32_16x16x32_bf16 v[44:47], a[180:183], a[12:15], v[44:47]
  s_waitcnt lgkmcnt(6)
  buffer_load_dwordx4 a[144:147], v1, s[8:11], s78 offen offset:1024 sc1
  v_fmac_f32 v182, v19, v30
  v_mfma_f32_16x16x32_bf16 v[60:63], a[160:163], a[12:15], v[60:63]
  ds_read_b64_tr_b16 a[178:179], v6 offset:10240
  v_fmac_f32 v183, v19, v31
  v_mfma_f32_16x16x32_bf16 v[60:63], a[164:167], a[28:31], v[60:63]
  s_add_u32 s78, s78, 65536
  v_fmac_f32 v184, v21, v28
  v_fmac_f32 v185, v21, v29
  v_mfma_f32_16x16x32_bf16 v[56:59], a[164:167], a[24:27], v[56:59]
  ds_read_b64_tr_b16 a[180:181], v6 offset:12288
  v_fmac_f32 v186, v21, v30
  v_mfma_f32_16x16x32_bf16 v[56:59], a[160:163], a[8:11], v[56:59]
  buffer_load_dwordx4 a[132:135], v1, s[8:11], s78 offen offset:0 sc1
  v_fmac_f32 v187, v21, v31
  v_fmac_f32 v188, v23, v28
  v_mfma_f32_16x16x32_bf16 v[52:55], a[160:163], a[4:7], v[52:55]
  ds_read_b64_tr_b16 a[182:183], v6 offset:14336
  v_fmac_f32 v189, v23, v29
  v_mfma_f32_16x16x32_bf16 v[52:55], a[164:167], a[20:23], v[52:55]
  v_fmac_f32 v190, v23, v30
  v_fmac_f32 v191, v23, v31
  v_mfma_f32_16x16x32_bf16 v[48:51], a[164:167], a[16:19], v[48:51]
  ds_read_b64_tr_b16 a[164:165], v7 offset:0
  v_mfma_f32_16x16x32_bf16 v[48:51], a[160:163], a[0:3], v[48:51]
  s_waitcnt vmcnt(29) lgkmcnt(5)
  ds_read_b128 v[28:31], v12 offset:640
  v_mfma_f32_16x16x32_bf16 v[64:67], a[168:171], a[32:35], v[64:67]
  ds_read_b64_tr_b16 a[166:167], v7 offset:2048
  s_waitcnt lgkmcnt(9)
  v_mfma_f32_16x16x32_bf16 v[64:67], a[172:175], a[48:51], v[64:67]
  buffer_load_dwordx4 a[148:151], v1, s[8:11], s78 offen offset:1024 sc1
  v_fmac_f32 v192, v16, v24
  v_fmac_f32 v193, v16, v25
  v_mfma_f32_16x16x32_bf16 v[68:71], a[172:175], a[52:55], v[68:71]
  ds_read_b64_tr_b16 a[160:161], v7 offset:4096
  v_fmac_f32 v194, v16, v26
  v_mfma_f32_16x16x32_bf16 v[68:71], a[168:171], a[36:39], v[68:71]
  s_add_u32 s62, s92, 4096
  v_fmac_f32 v195, v16, v27
  v_fmac_f32 v196, v18, v24
  v_mfma_f32_16x16x32_bf16 v[72:75], a[168:171], a[40:43], v[72:75]
  ds_read_b64_tr_b16 a[162:163], v7 offset:6144
  v_fmac_f32 v197, v18, v25
  v_mfma_f32_16x16x32_bf16 v[72:75], a[172:175], a[56:59], v[72:75]
  buffer_load_dword a253, v13, s[36:39], s62 offen
  v_fmac_f32 v198, v18, v26
  v_fmac_f32 v199, v18, v27
  v_mfma_f32_16x16x32_bf16 v[76:79], a[172:175], a[60:63], v[76:79]
  ds_read_b64_tr_b16 a[172:173], v7 offset:8192
  v_fmac_f32 v200, v20, v24
  v_mfma_f32_16x16x32_bf16 v[76:79], a[168:171], a[44:47], v[76:79]
  s_waitcnt lgkmcnt(6)
  v_fmac_f32 v201, v20, v25
  v_fmac_f32 v202, v20, v26
  v_mfma_f32_16x16x32_bf16 v[92:95], a[176:179], a[44:47], v[92:95]
  ds_read_b64_tr_b16 a[174:175], v7 offset:10240
  v_fmac_f32 v203, v20, v27
  v_mfma_f32_16x16x32_bf16 v[92:95], a[180:183], a[60:63], v[92:95]
  v_fmac_f32 v204, v22, v24
  v_fmac_f32 v205, v22, v25
  v_mfma_f32_16x16x32_bf16 v[88:91], a[180:183], a[56:59], v[88:91]
  ds_read_b64_tr_b16 a[168:169], v7 offset:12288
  v_fmac_f32 v206, v22, v26
  v_mfma_f32_16x16x32_bf16 v[88:91], a[176:179], a[40:43], v[88:91]
  v_fmac_f32 v207, v22, v27
  v_mfma_f32_16x16x32_bf16 v[84:87], a[176:179], a[36:39], v[84:87]
  ds_read_b64_tr_b16 a[170:171], v7 offset:14336
  v_mfma_f32_16x16x32_bf16 v[84:87], a[180:183], a[52:55], v[84:87]
  s_add_u32 s78, s78, 65536
  ds_read_b128 v[24:27], v12 offset:1152
  v_mfma_f32_16x16x32_bf16 v[80:83], a[180:183], a[48:51], v[80:83]
  ds_read_b64_tr_b16 a[180:181], v8 offset:0
  s_waitcnt lgkmcnt(9)
  v_mfma_f32_16x16x32_bf16 v[80:83], a[176:179], a[32:35], v[80:83]
  s_waitcnt lgkmcnt(6)
  buffer_load_dwordx4 a[136:139], v1, s[8:11], s78 offen offset:0 sc1
  v_fmac_f32 v192, v17, v28
  v_mfma_f32_16x16x32_bf16 v[96:99], a[164:167], a[32:35], v[96:99]
  ds_read_b64_tr_b16 a[182:183], v8 offset:2048
  v_fmac_f32 v193, v17, v29
  v_mfma_f32_16x16x32_bf16 v[96:99], a[160:163], a[48:51], v[96:99]
  v_fmac_f32 v194, v17, v30
  v_fmac_f32 v195, v17, v31
  v_mfma_f32_16x16x32_bf16 v[100:103], a[160:163], a[52:55], v[100:103]
  ds_read_b64_tr_b16 a[176:177], v8 offset:4096
  v_fmac_f32 v196, v19, v28
  v_mfma_f32_16x16x32_bf16 v[100:103], a[164:167], a[36:39], v[100:103]
  v_fmac_f32 v197, v19, v29
  v_fmac_f32 v198, v19, v30
  v_mfma_f32_16x16x32_bf16 v[104:107], a[164:167], a[40:43], v[104:107]
  ds_read_b64_tr_b16 a[178:179], v8 offset:6144
  v_fmac_f32 v199, v19, v31
  v_mfma_f32_16x16x32_bf16 v[104:107], a[160:163], a[56:59], v[104:107]
  buffer_load_dwordx4 a[152:155], v1, s[8:11], s78 offen offset:1024 sc1
  v_fmac_f32 v200, v21, v28
  v_fmac_f32 v201, v21, v29
  v_mfma_f32_16x16x32_bf16 v[108:111], a[160:163], a[60:63], v[108:111]
  ds_read_b64_tr_b16 a[160:161], v8 offset:8192
  v_fmac_f32 v202, v21, v30
  v_mfma_f32_16x16x32_bf16 v[108:111], a[164:167], a[44:47], v[108:111]
  s_waitcnt lgkmcnt(6)
  s_add_u32 s78, s78, 65536
  v_fmac_f32 v203, v21, v31
  v_mfma_f32_16x16x32_bf16 v[124:127], a[172:175], a[44:47], v[124:127]
  ds_read_b64_tr_b16 a[162:163], v8 offset:10240
  v_fmac_f32 v204, v23, v28
  v_mfma_f32_16x16x32_bf16 v[124:127], a[168:171], a[60:63], v[124:127]
  buffer_load_dwordx4 a[140:143], v1, s[8:11], s78 offen offset:0 sc1
  v_fmac_f32 v205, v23, v29
  v_fmac_f32 v206, v23, v30
  v_mfma_f32_16x16x32_bf16 v[120:123], a[168:171], a[56:59], v[120:123]
  ds_read_b64_tr_b16 a[164:165], v8 offset:12288
  v_fmac_f32 v207, v23, v31
  v_mfma_f32_16x16x32_bf16 v[120:123], a[172:175], a[40:43], v[120:123]
  ds_read_b128 v[28:31], v12 offset:1664
  v_mfma_f32_16x16x32_bf16 v[116:119], a[172:175], a[36:39], v[116:119]
  ds_read_b64_tr_b16 a[166:167], v8 offset:14336
  v_mfma_f32_16x16x32_bf16 v[116:119], a[168:171], a[52:55], v[116:119]
  v_mfma_f32_16x16x32_bf16 v[112:115], a[168:171], a[48:51], v[112:115]
  ds_read_b64_tr_b16 a[168:169], v2 offset:16384
  s_waitcnt lgkmcnt(10)
  v_mfma_f32_16x16x32_bf16 v[112:115], a[172:175], a[32:35], v[112:115]
  s_waitcnt lgkmcnt(6)
  buffer_load_dwordx4 a[156:159], v1, s[8:11], s78 offen offset:1024 sc1
  v_fmac_f32 v208, v16, v24
  v_mfma_f32_16x16x32_bf16 v[32:35], a[180:183], a[32:35], v[32:35]
  ds_read_b64_tr_b16 a[170:171], v2 offset:18432
  v_fmac_f32 v209, v16, v25
  v_mfma_f32_16x16x32_bf16 v[32:35], a[176:179], a[48:51], v[32:35]
  s_cmp_eq_u32 s56, 3
  s_cselect_b32 s79, 7, 15
  s_mul_i32 s71, s79, 458752
  s_lshl_b32 s79, s79, 11
  s_add_u32 s79, s79, s57
  v_fmac_f32 v210, v16, v26
  v_fmac_f32 v211, v16, v27
  v_mfma_f32_16x16x32_bf16 v[36:39], a[176:179], a[52:55], v[36:39]
  ds_read_b64_tr_b16 a[172:173], v2 offset:20480
  v_fmac_f32 v212, v18, v24
  v_mfma_f32_16x16x32_bf16 v[36:39], a[180:183], a[36:39], v[36:39]
  buffer_load_dwordx4 a[188:191], v1, s[8:11], s79 offen offset:0 sc1
  v_fmac_f32 v213, v18, v25
  v_fmac_f32 v214, v18, v26
  v_mfma_f32_16x16x32_bf16 v[40:43], a[180:183], a[40:43], v[40:43]
  ds_read_b64_tr_b16 a[174:175], v2 offset:22528
  v_fmac_f32 v215, v18, v27
  v_mfma_f32_16x16x32_bf16 v[40:43], a[176:179], a[56:59], v[40:43]
  v_fmac_f32 v216, v20, v24
  v_fmac_f32 v217, v20, v25
  v_mfma_f32_16x16x32_bf16 v[44:47], a[176:179], a[60:63], v[44:47]
  ds_read_b64_tr_b16 a[176:177], v2 offset:24576
  v_fmac_f32 v218, v20, v26
  v_mfma_f32_16x16x32_bf16 v[44:47], a[180:183], a[44:47], v[44:47]
  s_waitcnt lgkmcnt(5)
  v_fmac_f32 v219, v20, v27
  v_fmac_f32 v220, v22, v24
  v_mfma_f32_16x16x32_bf16 v[60:63], a[160:163], a[44:47], v[60:63]
  ds_read_b64_tr_b16 a[178:179], v2 offset:26624
  s_barrier
  v_mfma_f32_16x16x32_bf16 v[60:63], a[164:167], a[60:63], v[60:63]
  buffer_load_dwordx4 a[204:207], v1, s[8:11], s79 offen offset:1024 sc1
  v_fmac_f32 v221, v22, v25
  v_fmac_f32 v222, v22, v26
  v_mfma_f32_16x16x32_bf16 v[56:59], a[164:167], a[56:59], v[56:59]
  ds_read_b64_tr_b16 a[180:181], v2 offset:28672
  v_fmac_f32 v223, v22, v27
  v_mfma_f32_16x16x32_bf16 v[56:59], a[160:163], a[40:43], v[56:59]
  s_add_u32 m0, s45, 81920
  ds_read_b128 v[24:27], v12 offset:192
  v_mfma_f32_16x16x32_bf16 v[52:55], a[160:163], a[36:39], v[52:55]
  ds_read_b64_tr_b16 a[182:183], v2 offset:30720
  s_waitcnt lgkmcnt(10)
  v_mfma_f32_16x16x32_bf16 v[52:55], a[164:167], a[52:55], v[52:55]
  buffer_load_dwordx4 v11, s[28:31], s70 offen lds
  v_fmac_f32 v208, v17, v28
  v_fmac_f32 v209, v17, v29
  v_mfma_f32_16x16x32_bf16 v[48:51], a[164:167], a[48:51], v[48:51]
  ds_read_b64_tr_b16 a[164:165], v3 offset:16384
  v_fmac_f32 v210, v17, v30
  v_mfma_f32_16x16x32_bf16 v[48:51], a[160:163], a[32:35], v[48:51]
  s_waitcnt lgkmcnt(6)
  v_fmac_f32 v211, v17, v31
  v_fmac_f32 v212, v19, v28
  v_mfma_f32_16x16x32_bf16 v[128:131], a[168:171], a[0:3], v[128:131]
  ds_read_b64_tr_b16 a[166:167], v3 offset:18432
  v_fmac_f32 v213, v19, v29
  v_mfma_f32_16x16x32_bf16 v[128:131], a[172:175], a[16:19], v[128:131]
  s_add_u32 m0, s45, 90112
  v_fmac_f32 v214, v19, v30
  v_fmac_f32 v215, v19, v31
  v_mfma_f32_16x16x32_bf16 v[132:135], a[172:175], a[20:23], v[132:135]
  ds_read_b64_tr_b16 a[160:161], v3 offset:20480
  v_fmac_f32 v216, v21, v28
  v_mfma_f32_16x16x32_bf16 v[132:135], a[168:171], a[4:7], v[132:135]
  buffer_load_dwordx4 v11, s[32:35], s70 offen lds
  v_fmac_f32 v217, v21, v29
  v_fmac_f32 v218, v21, v30
  v_mfma_f32_16x16x32_bf16 v[136:139], a[168:171], a[8:11], v[136:139]
  ds_read_b64_tr_b16 a[162:163], v3 offset:22528
  v_fmac_f32 v219, v21, v31
  v_mfma_f32_16x16x32_bf16 v[136:139], a[172:175], a[24:27], v[136:139]
  s_add_u32 m0, s45, 86016
  s_add_u32 s61, s70, 229376
  v_fmac_f32 v220, v23, v28
  v_mfma_f32_16x16x32_bf16 v[140:143], a[172:175], a[28:31], v[140:143]
  ds_read_b64_tr_b16 a[172:173], v3 offset:24576
  v_fmac_f32 v221, v23, v29
  v_mfma_f32_16x16x32_bf16 v[140:143], a[168:171], a[12:15], v[140:143]
  s_waitcnt lgkmcnt(5)
  buffer_load_dwordx4 v11, s[28:31], s61 offen lds
  v_fmac_f32 v222, v23, v30
  v_mfma_f32_16x16x32_bf16 v[156:159], a[176:179], a[12:15], v[156:159]
  ds_read_b64_tr_b16 a[174:175], v3 offset:26624
  v_fmac_f32 v223, v23, v31
  v_mfma_f32_16x16x32_bf16 v[156:159], a[180:183], a[28:31], v[156:159]
  ds_read_b128 v[28:31], v12 offset:704
  v_mfma_f32_16x16x32_bf16 v[152:155], a[180:183], a[24:27], v[152:155]
  ds_read_b64_tr_b16 a[168:169], v3 offset:28672
  v_mfma_f32_16x16x32_bf16 v[152:155], a[176:179], a[8:11], v[152:155]
  s_add_u32 m0, s45, 94208
  s_add_u32 s61, s70, 229376
  v_mfma_f32_16x16x32_bf16 v[148:151], a[176:179], a[4:7], v[148:151]
  ds_read_b64_tr_b16 a[170:171], v3 offset:30720
  s_waitcnt lgkmcnt(10)
  v_mfma_f32_16x16x32_bf16 v[148:151], a[180:183], a[20:23], v[148:151]
  buffer_load_dwordx4 v11, s[32:35], s61 offen lds
  v_fmac_f32 v224, v16, v24
  v_fmac_f32 v225, v16, v25
  v_mfma_f32_16x16x32_bf16 v[144:147], a[180:183], a[16:19], v[144:147]
  ds_read_b64_tr_b16 a[180:181], v4 offset:16384
  v_fmac_f32 v226, v16, v26
  v_mfma_f32_16x16x32_bf16 v[144:147], a[176:179], a[0:3], v[144:147]
  s_waitcnt lgkmcnt(6)
  s_add_u32 m0, s45, 65536
  v_fmac_f32 v227, v16, v27
  v_mfma_f32_16x16x32_bf16 v[160:163], a[164:167], a[0:3], v[160:163]
  ds_read_b64_tr_b16 a[182:183], v4 offset:18432
  v_fmac_f32 v228, v18, v24
  v_mfma_f32_16x16x32_bf16 v[160:163], a[160:163], a[16:19], v[160:163]
  buffer_load_dwordx4 v11, s[28:31], s71 offen lds
  v_fmac_f32 v229, v18, v25
  v_fmac_f32 v230, v18, v26
  v_mfma_f32_16x16x32_bf16 v[164:167], a[160:163], a[20:23], v[164:167]
  ds_read_b64_tr_b16 a[176:177], v4 offset:20480
  v_fmac_f32 v231, v18, v27
  v_mfma_f32_16x16x32_bf16 v[164:167], a[164:167], a[4:7], v[164:167]
  v_fmac_f32 v232, v20, v24
  v_fmac_f32 v233, v20, v25
  v_mfma_f32_16x16x32_bf16 v[168:171], a[164:167], a[8:11], v[168:171]
  ds_read_b64_tr_b16 a[178:179], v4 offset:22528
  v_fmac_f32 v234, v20, v26
  v_mfma_f32_16x16x32_bf16 v[168:171], a[160:163], a[24:27], v[168:171]
  s_add_u32 m0, s45, 73728
  v_fmac_f32 v235, v20, v27
  v_fmac_f32 v236, v22, v24
  v_mfma_f32_16x16x32_bf16 v[172:175], a[160:163], a[28:31], v[172:175]
  ds_read_b64_tr_b16 a[160:161], v4 offset:24576
  v_fmac_f32 v237, v22, v25
  v_mfma_f32_16x16x32_bf16 v[172:175], a[164:167], a[12:15], v[172:175]
  s_waitcnt lgkmcnt(5)
  buffer_load_dwordx4 v11, s[32:35], s71 offen lds
  v_fmac_f32 v238, v22, v26
  v_mfma_f32_16x16x32_bf16 v[188:191], a[172:175], a[12:15], v[188:191]
  ds_read_b64_tr_b16 a[162:163], v4 offset:26624
  v_fmac_f32 v239, v22, v27
  v_mfma_f32_16x16x32_bf16 v[188:191], a[168:171], a[28:31], v[188:191]
  s_add_u32 m0, s45, 69632
  s_add_u32 s61, s71, 229376
  v_mfma_f32_16x16x32_bf16 v[184:187], a[168:171], a[24:27], v[184:187]
  ds_read_b64_tr_b16 a[164:165], v4 offset:28672
  v_mfma_f32_16x16x32_bf16 v[184:187], a[172:175], a[8:11], v[184:187]
  buffer_load_dwordx4 v11, s[28:31], s61 offen lds
  ds_read_b128 v[24:27], v12 offset:1216
  v_mfma_f32_16x16x32_bf16 v[180:183], a[172:175], a[4:7], v[180:183]
  ds_read_b64_tr_b16 a[166:167], v4 offset:30720
  s_waitcnt lgkmcnt(11)
  v_mfma_f32_16x16x32_bf16 v[180:183], a[168:171], a[20:23], v[180:183]
  v_fmac_f32 v224, v17, v28
  v_fmac_f32 v225, v17, v29
  v_mfma_f32_16x16x32_bf16 v[176:179], a[168:171], a[16:19], v[176:179]
  ds_read_b64_tr_b16 a[168:169], v5 offset:16384
  v_fmac_f32 v226, v17, v30
  v_mfma_f32_16x16x32_bf16 v[176:179], a[172:175], a[0:3], v[176:179]
  s_waitcnt lgkmcnt(6)
  s_add_u32 m0, s45, 77824
  s_add_u32 s61, s71, 229376
  v_mfma_f32_16x16x32_bf16 v[192:195], a[180:183], a[0:3], v[192:195]
  ds_read_b64_tr_b16 a[170:171], v5 offset:18432
  v_fmac_f32 v227, v17, v31
  v_mfma_f32_16x16x32_bf16 v[192:195], a[176:179], a[16:19], v[192:195]
  buffer_load_dwordx4 v11, s[32:35], s61 offen lds
  v_fmac_f32 v228, v19, v28
  v_fmac_f32 v229, v19, v29
  v_mfma_f32_16x16x32_bf16 v[196:199], a[176:179], a[20:23], v[196:199]
  ds_read_b64_tr_b16 a[172:173], v5 offset:20480
  v_fmac_f32 v230, v19, v30
  v_mfma_f32_16x16x32_bf16 v[196:199], a[180:183], a[4:7], v[196:199]
  s_add_u32 s62, s92, 6144
  v_fmac_f32 v231, v19, v31
  v_fmac_f32 v232, v21, v28
  v_mfma_f32_16x16x32_bf16 v[200:203], a[180:183], a[8:11], v[200:203]
  ds_read_b64_tr_b16 a[174:175], v5 offset:22528
  v_fmac_f32 v233, v21, v29
HOP13:
  s_cbranch_execz WRET0
  v_mfma_f32_16x16x32_bf16 v[200:203], a[176:179], a[24:27], v[200:203]
  buffer_load_dword a253, v13, s[36:39], s62 offen
  v_fmac_f32 v234, v21, v30
  v_fmac_f32 v235, v21, v31
  v_mfma_f32_16x16x32_bf16 v[204:207], a[176:179], a[28:31], v[204:207]
  ds_read_b64_tr_b16 a[176:177], v5 offset:24576
  v_fmac_f32 v236, v23, v28
  v_mfma_f32_16x16x32_bf16 v[204:207], a[180:183], a[12:15], v[204:207]
  s_waitcnt lgkmcnt(5)
  v_fmac_f32 v237, v23, v29
  v_fmac_f32 v238, v23, v30
  v_mfma_f32_16x16x32_bf16 v[220:223], a[160:163], a[12:15], v[220:223]
  ds_read_b64_tr_b16 a[178:179], v5 offset:26624
  v_fmac_f32 v239, v23, v31
  v_mfma_f32_16x16x32_bf16 v[220:223], a[164:167], a[28:31], v[220:223]
  ds_read_b128 v[28:31], v12 offset:1728
  v_mfma_f32_16x16x32_bf16 v[216:219], a[164:167], a[24:27], v[216:219]
  ds_read_b64_tr_b16 a[180:181], v5 offset:28672
  v_mfma_f32_16x16x32_bf16 v[216:219], a[160:163], a[8:11], v[216:219]
  v_mfma_f32_16x16x32_bf16 v[212:215], a[160:163], a[4:7], v[212:215]
  ds_read_b64_tr_b16 a[182:183], v5 offset:30720
  v_mfma_f32_16x16x32_bf16 v[212:215], a[164:167], a[20:23], v[212:215]
  s_waitcnt vmcnt(24)
  s_barrier
  v_mfma_f32_16x16x32_bf16 v[208:211], a[164:167], a[16:19], v[208:211]
  ds_read_b64_tr_b16 a[164:165], v8 offset:32768
  s_add_u32 s79, s79, 65536
  v_mfma_f32_16x16x32_bf16 v[208:211], a[160:163], a[0:3], v[208:211]
  s_waitcnt lgkmcnt(6)
  buffer_load_dwordx4 a[192:195], v1, s[8:11], s79 offen offset:0 sc1
  v_mfma_f32_16x16x32_bf16 v[224:227], a[168:171], a[0:3], v[224:227]
  ds_read_b64_tr_b16 a[166:167], v8 offset:34816
  v_mfma_f32_16x16x32_bf16 v[224:227], a[172:175], a[16:19], v[224:227]
  v_mfma_f32_16x16x32_bf16 v[228:231], a[172:175], a[20:23], v[228:231]
  ds_read_b64_tr_b16 a[160:161], v8 offset:36864
  v_mfma_f32_16x16x32_bf16 v[228:231], a[168:171], a[4:7], v[228:231]
  v_mfma_f32_16x16x32_bf16 v[232:235], a[168:171], a[8:11], v[232:235]
  ds_read_b64_tr_b16 a[162:163], v8 offset:38912
  v_mfma_f32_16x16x32_bf16 v[232:235], a[172:175], a[24:27], v[232:235]
  buffer_load_dwordx4 a[208:211], v1, s[8:11], s79 offen offset:1024 sc1
  v_mfma_f32_16x16x32_bf16 v[236:239], a[172:175], a[28:31], v[236:239]
  ds_read_b64_tr_b16 a[172:173], v8 offset:40960
  v_mfma_f32_16x16x32_bf16 v[236:239], a[168:171], a[12:15], v[236:239]
  s_waitcnt lgkmcnt(5)
  s_add_u32 s79, s79, 65536
  v_mfma_f32_16x16x32_bf16 v[252:255], a[176:179], a[12:15], v[252:255]
  ds_read_b64_tr_b16 a[174:175], v8 offset:43008
  v_mfma_f32_16x16x32_bf16 v[252:255], a[180:183], a[28:31], v[252:255]
  buffer_load_dwordx4 a[196:199], v1, s[8:11], s79 offen offset:0 sc1
  v_mfma_f32_16x16x32_bf16 v[248:251], a[180:183], a[24:27], v[248:251]
  ds_read_b64_tr_b16 a[168:169], v8 offset:45056
  v_mfma_f32_16x16x32_bf16 v[248:251], a[176:179], a[8:11], v[248:251]
  v_mfma_f32_16x16x32_bf16 v[244:247], a[176:179], a[4:7], v[244:247]
  ds_read_b64_tr_b16 a[170:171], v8 offset:47104
  v_mfma_f32_16x16x32_bf16 v[244:247], a[180:183], a[20:23], v[244:247]
  v_mfma_f32_16x16x32_bf16 v[240:243], a[180:183], a[16:19], v[240:243]
  ds_read_b64_tr_b16 a[180:181], v8 offset:49152
  v_mfma_f32_16x16x32_bf16 v[240:243], a[176:179], a[0:3], v[240:243]
  s_waitcnt vmcnt(36) lgkmcnt(5)
  buffer_load_dwordx4 a[212:215], v1, s[8:11], s79 offen offset:1024 sc1
  v_mfma_f32_16x16x32_bf16 v[32:35], a[164:167], a[64:67], v[32:35]
  ds_read_b64_tr_b16 a[182:183], v8 offset:51200
  v_mfma_f32_16x16x32_bf16 v[32:35], a[160:163], a[80:83], v[32:35]
  s_add_u32 s79, s79, 65536
  v_mfma_f32_16x16x32_bf16 v[36:39], a[160:163], a[84:87], v[36:39]
  ds_read_b64_tr_b16 a[176:177], v8 offset:53248
  s_waitcnt lgkmcnt(15)
  v_mfma_f32_16x16x32_bf16 v[36:39], a[164:167], a[68:71], v[36:39]
  buffer_load_dwordx4 a[200:203], v1, s[8:11], s79 offen offset:0 sc1
  v_fmac_f32 v240, v16, v24
  v_fmac_f32 v241, v16, v25
  v_mfma_f32_16x16x32_bf16 v[40:43], a[164:167], a[72:75], v[40:43]
  ds_read_b64_tr_b16 a[178:179], v8 offset:55296
  v_fmac_f32 v242, v16, v26
  v_mfma_f32_16x16x32_bf16 v[40:43], a[160:163], a[88:91], v[40:43]
  v_fmac_f32 v243, v16, v27
  v_fmac_f32 v244, v18, v24
  v_mfma_f32_16x16x32_bf16 v[44:47], a[160:163], a[92:95], v[44:47]
  ds_read_b64_tr_b16 a[160:161], v8 offset:57344
  v_fmac_f32 v245, v18, v25
  v_mfma_f32_16x16x32_bf16 v[44:47], a[164:167], a[76:79], v[44:47]
  s_waitcnt lgkmcnt(5)
  buffer_load_dwordx4 a[216:219], v1, s[8:11], s79 offen offset:1024 sc1
  v_fmac_f32 v246, v18, v26
  v_mfma_f32_16x16x32_bf16 v[60:63], a[172:175], a[76:79], v[60:63]
  ds_read_b64_tr_b16 a[162:163], v8 offset:59392
  v_fmac_f32 v247, v18, v27
  v_mfma_f32_16x16x32_bf16 v[60:63], a[168:171], a[92:95], v[60:63]
  s_add_u32 m0, s45, 0
  v_fmac_f32 v248, v20, v24
  v_fmac_f32 v249, v20, v25
  v_mfma_f32_16x16x32_bf16 v[56:59], a[168:171], a[88:91], v[56:59]
  ds_read_b64_tr_b16 a[164:165], v8 offset:61440
  v_fmac_f32 v250, v20, v26
  v_mfma_f32_16x16x32_bf16 v[56:59], a[172:175], a[72:75], v[56:59]
  buffer_load_dwordx4 v10, s[28:31], s67 offen lds
  v_fmac_f32 v251, v20, v27
  v_fmac_f32 v252, v22, v24
  v_mfma_f32_16x16x32_bf16 v[52:55], a[172:175], a[68:71], v[52:55]
  ds_read_b64_tr_b16 a[166:167], v8 offset:63488
  v_fmac_f32 v253, v22, v25
  v_mfma_f32_16x16x32_bf16 v[52:55], a[168:171], a[84:87], v[52:55]
  s_waitcnt vmcnt(8)
  s_barrier
  v_mfma_f32_16x16x32_bf16 v[48:51], a[168:171], a[80:83], v[48:51]
  ds_read_b64_tr_b16 a[168:169], v8 offset:16384
  s_add_u32 m0, s45, 8192
  v_mfma_f32_16x16x32_bf16 v[48:51], a[172:175], a[64:67], v[48:51]
  s_waitcnt vmcnt(27) lgkmcnt(5)
  buffer_load_dwordx4 v10, s[32:35], s67 offen lds
  v_fmac_f32 v254, v22, v26
  v_mfma_f32_16x16x32_bf16 v[32:35], a[180:183], a[96:99], v[32:35]
  ds_read_b64_tr_b16 a[170:171], v8 offset:18432
  v_fmac_f32 v255, v22, v27
  v_mfma_f32_16x16x32_bf16 v[32:35], a[176:179], a[112:115], v[32:35]
  s_add_u32 m0, s45, 4096
  s_add_u32 s61, s67, 229376
  s_waitcnt lgkmcnt(15)
  v_mfma_f32_16x16x32_bf16 v[36:39], a[176:179], a[116:119], v[36:39]
  ds_read_b64_tr_b16 a[172:173], v8 offset:20480
  v_fmac_f32 v240, v17, v28
  v_mfma_f32_16x16x32_bf16 v[36:39], a[180:183], a[100:103], v[36:39]
  buffer_load_dwordx4 v10, s[28:31], s61 offen lds
  v_fmac_f32 v241, v17, v29
  v_fmac_f32 v242, v17, v30
  v_mfma_f32_16x16x32_bf16 v[40:43], a[180:183], a[104:107], v[40:43]
  ds_read_b64_tr_b16 a[174:175], v8 offset:22528
  v_fmac_f32 v243, v17, v31
  v_mfma_f32_16x16x32_bf16 v[40:43], a[176:179], a[120:123], v[40:43]
  s_add_u32 m0, s45, 12288
  s_add_u32 s61, s67, 229376
  v_fmac_f32 v244, v19, v28
  v_mfma_f32_16x16x32_bf16 v[44:47], a[176:179], a[124:127], v[44:47]
  ds_read_b64_tr_b16 a[176:177], v8 offset:24576
  v_fmac_f32 v245, v19, v29
  v_mfma_f32_16x16x32_bf16 v[44:47], a[180:183], a[108:111], v[44:47]
  s_waitcnt lgkmcnt(5)
  buffer_load_dwordx4 v10, s[32:35], s61 offen lds
  v_fmac_f32 v246, v19, v30
  v_mfma_f32_16x16x32_bf16 v[60:63], a[160:163], a[108:111], v[60:63]
  ds_read_b64_tr_b16 a[178:179], v8 offset:26624
  v_fmac_f32 v247, v19, v31
  v_mfma_f32_16x16x32_bf16 v[60:63], a[164:167], a[124:127], v[60:63]
  s_add_u32 m0, s45, 32768
  v_fmac_f32 v248, v21, v28
  v_fmac_f32 v249, v21, v29
  v_mfma_f32_16x16x32_bf16 v[56:59], a[164:167], a[120:123], v[56:59]
  ds_read_b64_tr_b16 a[180:181], v8 offset:28672
  v_fmac_f32 v250, v21, v30
  v_mfma_f32_16x16x32_bf16 v[56:59], a[160:163], a[104:107], v[56:59]
  buffer_load_dwordx4 v10, s[28:31], s68 offen lds
  v_fmac_f32 v251, v21, v31
  v_fmac_f32 v252, v23, v28
  v_mfma_f32_16x16x32_bf16 v[52:55], a[160:163], a[100:103], v[52:55]
  ds_read_b64_tr_b16 a[182:183], v8 offset:30720
  v_fmac_f32 v253, v23, v29
  v_mfma_f32_16x16x32_bf16 v[52:55], a[164:167], a[116:119], v[52:55]
  s_add_u32 m0, s45, 40960
  v_fmac_f32 v254, v23, v30
  v_fmac_f32 v255, v23, v31
  v_mfma_f32_16x16x32_bf16 v[48:51], a[164:167], a[112:115], v[48:51]
  ds_read_b64_tr_b16 a[164:165], v8 offset:0
  v_mfma_f32_16x16x32_bf16 v[48:51], a[160:163], a[96:99], v[48:51]
  s_waitcnt vmcnt(22) lgkmcnt(5)
  buffer_load_dwordx4 v10, s[32:35], s68 offen lds
  v_mfma_f32_16x16x32_bf16 v[32:35], a[168:171], a[128:131], v[32:35]
  ds_read_b64_tr_b16 a[166:167], v8 offset:2048
  v_mfma_f32_16x16x32_bf16 v[32:35], a[172:175], a[144:147], v[32:35]
  s_add_u32 m0, s45, 36864
  s_add_u32 s61, s68, 229376
  v_mfma_f32_16x16x32_bf16 v[36:39], a[172:175], a[148:151], v[36:39]
  ds_read_b64_tr_b16 a[160:161], v8 offset:4096
  v_mfma_f32_16x16x32_bf16 v[36:39], a[168:171], a[132:135], v[36:39]
  buffer_load_dwordx4 v10, s[28:31], s61 offen lds
  v_rcp_f32 v16, v17
  v_mfma_f32_16x16x32_bf16 v[40:43], a[168:171], a[136:139], v[40:43]
  ds_read_b64_tr_b16 a[162:163], v8 offset:6144
  v_mfma_f32_16x16x32_bf16 v[40:43], a[172:175], a[152:155], v[40:43]
  s_add_u32 m0, s45, 45056
  s_add_u32 s61, s68, 229376
  v_mfma_f32_16x16x32_bf16 v[44:47], a[172:175], a[156:159], v[44:47]
  ds_read_b64_tr_b16 a[172:173], v8 offset:8192
  v_mfma_f32_16x16x32_bf16 v[44:47], a[168:171], a[140:143], v[44:47]
  s_waitcnt lgkmcnt(5)
  buffer_load_dwordx4 v10, s[32:35], s61 offen lds
  v_mfma_f32_16x16x32_bf16 v[60:63], a[176:179], a[140:143], v[60:63]
  ds_read_b64_tr_b16 a[174:175], v8 offset:10240
  v_rcp_f32 v18, v19
  v_mfma_f32_16x16x32_bf16 v[60:63], a[180:183], a[156:159], v[60:63]
  s_add_u32 s62, s92, 8192
  v_rcp_f32 v20, v21
  v_mfma_f32_16x16x32_bf16 v[56:59], a[180:183], a[152:155], v[56:59]
  ds_read_b64_tr_b16 a[168:169], v8 offset:12288
  v_mfma_f32_16x16x32_bf16 v[56:59], a[176:179], a[136:139], v[56:59]
  buffer_load_dword a253, v13, s[36:39], s62 offen
  v_rcp_f32 v22, v23
  v_mfma_f32_16x16x32_bf16 v[52:55], a[176:179], a[132:135], v[52:55]
  ds_read_b64_tr_b16 a[170:171], v8 offset:14336
  v_mul_f32 v17, v17, v17
  v_mfma_f32_16x16x32_bf16 v[52:55], a[180:183], a[148:151], v[52:55]
  v_mul_f32 v19, v19, v19
  v_mul_f32 v21, v21, v21
  v_mfma_f32_16x16x32_bf16 v[48:51], a[180:183], a[144:147], v[48:51]
  ds_read_b64_tr_b16 a[180:181], v6 offset:32768
  v_mul_f32 v23, v23, v23
  v_mfma_f32_16x16x32_bf16 v[48:51], a[176:179], a[128:131], v[48:51]
  s_waitcnt vmcnt(9) lgkmcnt(5)
  v_mul_f32 v16, 0xbfb8aa3b, v16
  v_mul_f32 v18, 0xbfb8aa3b, v18
  v_mfma_f32_16x16x32_bf16 v[32:35], a[164:167], a[188:191], v[32:35]
  ds_read_b64_tr_b16 a[182:183], v6 offset:34816
  v_mul_f32 v20, 0xbfb8aa3b, v20
  v_mfma_f32_16x16x32_bf16 v[32:35], a[160:163], a[204:207], v[32:35]
  s_add_u32 m0, s45, 49152
  v_mul_f32 v22, 0xbfb8aa3b, v22
  v_mfma_f32_16x16x32_bf16 v[36:39], a[160:163], a[208:211], v[36:39]
  ds_read_b64_tr_b16 a[176:177], v6 offset:36864
  v_mfma_f32_16x16x32_bf16 v[36:39], a[164:167], a[192:195], v[36:39]
  buffer_load_dwordx4 v10, s[28:31], s69 offen lds
  v_mfma_f32_16x16x32_bf16 v[40:43], a[164:167], a[196:199], v[40:43]
  ds_read_b64_tr_b16 a[178:179], v6 offset:38912
  v_mfma_f32_16x16x32_bf16 v[40:43], a[160:163], a[212:215], v[40:43]
  s_add_u32 m0, s45, 57344
  v_mfma_f32_16x16x32_bf16 v[44:47], a[160:163], a[216:219], v[44:47]
  ds_read_b64_tr_b16 a[160:161], v6 offset:40960
  v_mfma_f32_16x16x32_bf16 v[44:47], a[164:167], a[200:203], v[44:47]
  s_waitcnt lgkmcnt(5)
  buffer_load_dwordx4 v10, s[32:35], s69 offen lds
  v_mfma_f32_16x16x32_bf16 v[60:63], a[172:175], a[200:203], v[60:63]
  ds_read_b64_tr_b16 a[162:163], v6 offset:43008
  v_mfma_f32_16x16x32_bf16 v[60:63], a[168:171], a[216:219], v[60:63]
  s_add_u32 m0, s45, 53248
  s_add_u32 s61, s69, 229376
  v_mfma_f32_16x16x32_bf16 v[56:59], a[168:171], a[212:215], v[56:59]
  ds_read_b64_tr_b16 a[164:165], v6 offset:45056
  v_mfma_f32_16x16x32_bf16 v[56:59], a[172:175], a[196:199], v[56:59]
  buffer_load_dwordx4 v10, s[28:31], s61 offen lds
  v_mfma_f32_16x16x32_bf16 v[52:55], a[172:175], a[192:195], v[52:55]
  ds_read_b64_tr_b16 a[166:167], v6 offset:47104
  v_mfma_f32_16x16x32_bf16 v[52:55], a[168:171], a[208:211], v[52:55]
  s_add_u32 m0, s45, 61440
  s_add_u32 s61, s69, 229376
  v_mfma_f32_16x16x32_bf16 v[48:51], a[168:171], a[204:207], v[48:51]
  ds_read_b64_tr_b16 a[168:169], v6 offset:49152
  v_mfma_f32_16x16x32_bf16 v[48:51], a[172:175], a[188:191], v[48:51]
  s_waitcnt lgkmcnt(5)
  buffer_load_dwordx4 v10, s[32:35], s61 offen lds
  v_mfma_f32_16x16x32_bf16 v[64:67], a[180:183], a[64:67], v[64:67]
  ds_read_b64_tr_b16 a[170:171], v6 offset:51200
  v_mfma_f32_16x16x32_bf16 v[64:67], a[176:179], a[80:83], v[64:67]
  s_add_u32 m0, s45, 16384
  v_mfma_f32_16x16x32_bf16 v[68:71], a[176:179], a[84:87], v[68:71]
  ds_read_b64_tr_b16 a[172:173], v6 offset:53248
  v_mul_f32 v24, v16, v32
  v_mul_f32 v25, v16, v33
  v_mfma_f32_16x16x32_bf16 v[68:71], a[180:183], a[68:71], v[68:71]
  buffer_load_dwordx4 v10, s[28:31], s70 offen lds
  v_mul_f32 v26, v16, v34
  v_mul_f32 v27, v16, v35
  v_mul_f32 v28, v18, v36
  v_mfma_f32_16x16x32_bf16 v[72:75], a[180:183], a[72:75], v[72:75]
  ds_read_b64_tr_b16 a[174:175], v6 offset:55296
  v_mul_f32 v29, v18, v37
  v_mul_f32 v30, v18, v38
  v_mfma_f32_16x16x32_bf16 v[72:75], a[176:179], a[88:91], v[72:75]
  s_add_u32 m0, s45, 24576
  v_mul_f32 v31, v18, v39
  v_exp_f32 v24, v24
  v_mfma_f32_16x16x32_bf16 v[76:79], a[176:179], a[92:95], v[76:79]
  ds_read_b64_tr_b16 a[176:177], v6 offset:57344
  v_mul_f32 v48, v32, v48
  v_mfma_f32_16x16x32_bf16 v[76:79], a[180:183], a[76:79], v[76:79]
  s_waitcnt lgkmcnt(5)
  buffer_load_dwordx4 v10, s[32:35], s70 offen lds
  v_exp_f32 v25, v25
  v_mfma_f32_16x16x32_bf16 v[92:95], a[160:163], a[76:79], v[92:95]
  ds_read_b64_tr_b16 a[178:179], v6 offset:59392
  v_mul_f32 v49, v33, v49
  v_mfma_f32_16x16x32_bf16 v[92:95], a[164:167], a[92:95], v[92:95]
  s_add_u32 m0, s45, 20480
  s_add_u32 s61, s70, 229376
  v_exp_f32 v26, v26
  v_mfma_f32_16x16x32_bf16 v[88:91], a[164:167], a[88:91], v[88:91]
  ds_read_b64_tr_b16 a[180:181], v6 offset:61440
  v_mul_f32 v50, v34, v50
  v_mfma_f32_16x16x32_bf16 v[88:91], a[160:163], a[72:75], v[88:91]
  buffer_load_dwordx4 v10, s[28:31], s61 offen lds
  v_exp_f32 v27, v27
  v_mul_f32 v51, v35, v51
  v_mfma_f32_16x16x32_bf16 v[84:87], a[160:163], a[68:71], v[84:87]
  ds_read_b64_tr_b16 a[182:183], v6 offset:63488
  v_exp_f32 v28, v28
  v_mfma_f32_16x16x32_bf16 v[84:87], a[164:167], a[84:87], v[84:87]
  s_add_u32 m0, s45, 28672
  s_add_u32 s61, s70, 229376
  v_mul_f32 v52, v36, v52
  v_mfma_f32_16x16x32_bf16 v[80:83], a[164:167], a[80:83], v[80:83]
  ds_read_b64_tr_b16 a[164:165], v6 offset:16384
  v_exp_f32 v29, v29
  v_mfma_f32_16x16x32_bf16 v[80:83], a[160:163], a[64:67], v[80:83]
  s_waitcnt lgkmcnt(5)
  buffer_load_dwordx4 v10, s[32:35], s61 offen lds
  v_mul_f32 v53, v37, v53
  v_mfma_f32_16x16x32_bf16 v[64:67], a[168:171], a[96:99], v[64:67]
  ds_read_b64_tr_b16 a[166:167], v6 offset:18432
  v_exp_f32 v30, v30
  v_mfma_f32_16x16x32_bf16 v[64:67], a[172:175], a[112:115], v[64:67]
  v_mul_f32 v54, v38, v54
  v_exp_f32 v31, v31
  v_mfma_f32_16x16x32_bf16 v[68:71], a[172:175], a[116:119], v[68:71]
  ds_read_b64_tr_b16 a[160:161], v6 offset:20480
  v_mul_f32 v55, v39, v55
  v_fma_f32 v24, v24, v17, v17
  v_mfma_f32_16x16x32_bf16 v[68:71], a[168:171], a[100:103], v[68:71]
  v_fma_f32 v25, v25, v17, v17
  v_rcp_f32 v24, v24
  v_mfma_f32_16x16x32_bf16 v[72:75], a[168:171], a[104:107], v[72:75]
  ds_read_b64_tr_b16 a[162:163], v6 offset:22528
  v_fma_f32 v26, v26, v17, v17
  v_mfma_f32_16x16x32_bf16 v[72:75], a[172:175], a[120:123], v[72:75]
  v_rcp_f32 v25, v25
  v_fma_f32 v27, v27, v17, v17
  v_mfma_f32_16x16x32_bf16 v[76:79], a[172:175], a[124:127], v[76:79]
  ds_read_b64_tr_b16 a[172:173], v6 offset:24576
  v_rcp_f32 v26, v26
  v_mfma_f32_16x16x32_bf16 v[76:79], a[168:171], a[108:111], v[76:79]
  s_waitcnt lgkmcnt(5)
  v_fma_f32 v28, v28, v19, v19
  v_rcp_f32 v27, v27
  v_mfma_f32_16x16x32_bf16 v[92:95], a[176:179], a[108:111], v[92:95]
  ds_read_b64_tr_b16 a[174:175], v6 offset:26624
  v_fma_f32 v29, v29, v19, v19
  v_mfma_f32_16x16x32_bf16 v[92:95], a[180:183], a[124:127], v[92:95]
  v_rcp_f32 v28, v28
  v_fma_f32 v30, v30, v19, v19
  v_mfma_f32_16x16x32_bf16 v[88:91], a[180:183], a[120:123], v[88:91]
  ds_read_b64_tr_b16 a[168:169], v6 offset:28672
  v_rcp_f32 v29, v29
  v_mfma_f32_16x16x32_bf16 v[88:91], a[176:179], a[104:107], v[88:91]
  v_fma_f32 v31, v31, v19, v19
  v_rcp_f32 v30, v30
  v_mfma_f32_16x16x32_bf16 v[84:87], a[176:179], a[100:103], v[84:87]
  ds_read_b64_tr_b16 a[170:171], v6 offset:30720
  v_mul_f32 v48, v48, v24
  v_mfma_f32_16x16x32_bf16 v[84:87], a[180:183], a[116:119], v[84:87]
  v_rcp_f32 v31, v31
  v_mul_f32 v49, v49, v25
  v_mfma_f32_16x16x32_bf16 v[80:83], a[180:183], a[112:115], v[80:83]
  ds_read_b64_tr_b16 a[180:181], v6 offset:0
  v_mul_f32 v50, v50, v26
  v_mul_f32 v51, v51, v27
  v_mfma_f32_16x16x32_bf16 v[80:83], a[176:179], a[96:99], v[80:83]
  s_waitcnt lgkmcnt(5)
  v_mul_f32 v52, v52, v28
  v_mul_f32 v53, v53, v29
  v_mul_f32 v54, v54, v30
  v_mfma_f32_16x16x32_bf16 v[64:67], a[164:167], a[128:131], v[64:67]
  ds_read_b64_tr_b16 a[182:183], v6 offset:2048
  v_mul_f32 v55, v55, v31
  v_cvt_pk_bf16_f32 v32, v48, v49
  v_mfma_f32_16x16x32_bf16 v[64:67], a[160:163], a[144:147], v[64:67]
  v_cvt_pk_bf16_f32 v33, v50, v51
  v_mfma_f32_16x16x32_bf16 v[68:71], a[160:163], a[148:151], v[68:71]
  ds_read_b64_tr_b16 a[176:177], v6 offset:4096
  v_mfma_f32_16x16x32_bf16 v[68:71], a[164:167], a[132:135], v[68:71]
  buffer_store_dwordx2 v[32:33], v1, s[8:11], s60 offen sc1
  v_mfma_f32_16x16x32_bf16 v[72:75], a[164:167], a[136:139], v[72:75]
  ds_read_b64_tr_b16 a[178:179], v6 offset:6144
  s_add_u32 s62, s92, 10240
  v_cvt_pk_bf16_f32 v36, v52, v53
  v_mfma_f32_16x16x32_bf16 v[72:75], a[160:163], a[152:155], v[72:75]
  buffer_load_dword a253, v13, s[36:39], s62 offen
  v_cvt_pk_bf16_f32 v37, v54, v55
  v_mfma_f32_16x16x32_bf16 v[76:79], a[160:163], a[156:159], v[76:79]
  ds_read_b64_tr_b16 a[160:161], v6 offset:8192
  v_mfma_f32_16x16x32_bf16 v[76:79], a[164:167], a[140:143], v[76:79]
  s_waitcnt lgkmcnt(5)
  s_add_u32 s55, s60, 262144
  buffer_store_dwordx2 v[36:37], v1, s[8:11], s55 offen sc1
  v_mfma_f32_16x16x32_bf16 v[92:95], a[172:175], a[140:143], v[92:95]
  ds_read_b64_tr_b16 a[162:163], v6 offset:10240
  v_mul_f32 v24, v20, v40
  v_mul_f32 v25, v20, v41
  v_mfma_f32_16x16x32_bf16 v[92:95], a[168:171], a[156:159], v[92:95]
  v_mul_f32 v26, v20, v42
  v_mul_f32 v27, v20, v43
  v_mul_f32 v28, v22, v44
  v_mfma_f32_16x16x32_bf16 v[88:91], a[168:171], a[152:155], v[88:91]
  ds_read_b64_tr_b16 a[164:165], v6 offset:12288
  v_mul_f32 v29, v22, v45
  v_mul_f32 v30, v22, v46
  v_mfma_f32_16x16x32_bf16 v[88:91], a[172:175], a[136:139], v[88:91]
  v_mul_f32 v31, v22, v47
  v_exp_f32 v24, v24
  v_mfma_f32_16x16x32_bf16 v[84:87], a[172:175], a[132:135], v[84:87]
  ds_read_b64_tr_b16 a[166:167], v6 offset:14336
  v_mul_f32 v56, v40, v56
  v_mfma_f32_16x16x32_bf16 v[84:87], a[168:171], a[148:151], v[84:87]
  v_exp_f32 v25, v25
  v_mul_f32 v57, v41, v57
  v_mfma_f32_16x16x32_bf16 v[80:83], a[168:171], a[144:147], v[80:83]
  ds_read_b64_tr_b16 a[168:169], v7 offset:32768
  v_exp_f32 v26, v26
  v_mfma_f32_16x16x32_bf16 v[80:83], a[172:175], a[128:131], v[80:83]
  s_waitcnt lgkmcnt(5)
  v_mul_f32 v58, v42, v58
  v_exp_f32 v27, v27
  v_mfma_f32_16x16x32_bf16 v[64:67], a[180:183], a[188:191], v[64:67]
  ds_read_b64_tr_b16 a[170:171], v7 offset:34816
  v_mul_f32 v59, v43, v59
  v_mfma_f32_16x16x32_bf16 v[64:67], a[176:179], a[204:207], v[64:67]
  v_exp_f32 v28, v28
  v_mul_f32 v60, v44, v60
  v_mfma_f32_16x16x32_bf16 v[68:71], a[176:179], a[208:211], v[68:71]
  ds_read_b64_tr_b16 a[172:173], v7 offset:36864
  v_exp_f32 v29, v29
  v_mfma_f32_16x16x32_bf16 v[68:71], a[180:183], a[192:195], v[68:71]
  v_mul_f32 v61, v45, v61
  v_exp_f32 v30, v30
  v_mfma_f32_16x16x32_bf16 v[72:75], a[180:183], a[196:199], v[72:75]
  ds_read_b64_tr_b16 a[174:175], v7 offset:38912
  v_mul_f32 v62, v46, v62
  v_mfma_f32_16x16x32_bf16 v[72:75], a[176:179], a[212:215], v[72:75]
  v_exp_f32 v31, v31
  v_mul_f32 v63, v47, v63
  v_mfma_f32_16x16x32_bf16 v[76:79], a[176:179], a[216:219], v[76:79]
  ds_read_b64_tr_b16 a[176:177], v7 offset:40960
  v_fma_f32 v24, v24, v21, v21
  v_fma_f32 v25, v25, v21, v21
  v_mfma_f32_16x16x32_bf16 v[76:79], a[180:183], a[200:203], v[76:79]
  s_waitcnt lgkmcnt(5)
  v_rcp_f32 v24, v24
  v_fma_f32 v26, v26, v21, v21
  v_mfma_f32_16x16x32_bf16 v[92:95], a[160:163], a[200:203], v[92:95]
  ds_read_b64_tr_b16 a[178:179], v7 offset:43008
  v_rcp_f32 v25, v25
  v_mfma_f32_16x16x32_bf16 v[92:95], a[164:167], a[216:219], v[92:95]
  v_fma_f32 v27, v27, v21, v21
  v_rcp_f32 v26, v26
  v_mfma_f32_16x16x32_bf16 v[88:91], a[164:167], a[212:215], v[88:91]
  ds_read_b64_tr_b16 a[180:181], v7 offset:45056
  v_fma_f32 v28, v28, v23, v23
  v_mfma_f32_16x16x32_bf16 v[88:91], a[160:163], a[196:199], v[88:91]
  v_rcp_f32 v27, v27
  v_fma_f32 v29, v29, v23, v23
  v_mfma_f32_16x16x32_bf16 v[84:87], a[160:163], a[192:195], v[84:87]
  ds_read_b64_tr_b16 a[182:183], v7 offset:47104
  v_rcp_f32 v28, v28
  v_mfma_f32_16x16x32_bf16 v[84:87], a[164:167], a[208:211], v[84:87]
  v_fma_f32 v30, v30, v23, v23
  v_rcp_f32 v29, v29
  v_mfma_f32_16x16x32_bf16 v[80:83], a[164:167], a[204:207], v[80:83]
  ds_read_b64_tr_b16 a[164:165], v7 offset:49152
  v_fma_f32 v31, v31, v23, v23
  v_mfma_f32_16x16x32_bf16 v[80:83], a[160:163], a[188:191], v[80:83]
  s_waitcnt lgkmcnt(5)
  v_rcp_f32 v30, v30
  v_mul_f32 v56, v56, v24
  v_mfma_f32_16x16x32_bf16 v[96:99], a[168:171], a[64:67], v[96:99]
  ds_read_b64_tr_b16 a[166:167], v7 offset:51200
  v_rcp_f32 v31, v31
  v_mfma_f32_16x16x32_bf16 v[96:99], a[172:175], a[80:83], v[96:99]
  v_mul_f32 v57, v57, v25
  v_mul_f32 v58, v58, v26
  v_mul_f32 v59, v59, v27
  v_mfma_f32_16x16x32_bf16 v[100:103], a[172:175], a[84:87], v[100:103]
  ds_read_b64_tr_b16 a[160:161], v7 offset:53248
  v_mul_f32 v60, v60, v28
  v_mul_f32 v61, v61, v29
  v_mfma_f32_16x16x32_bf16 v[100:103], a[168:171], a[68:71], v[100:103]
  v_mul_f32 v62, v62, v30
  v_mul_f32 v63, v63, v31
  v_cvt_pk_bf16_f32 v40, v56, v57
  v_mfma_f32_16x16x32_bf16 v[104:107], a[168:171], a[72:75], v[104:107]
  ds_read_b64_tr_b16 a[162:163], v7 offset:55296
  v_cvt_pk_bf16_f32 v41, v58, v59
  v_mfma_f32_16x16x32_bf16 v[104:107], a[172:175], a[88:91], v[104:107]
  s_add_u32 s55, s60, 524288
  buffer_store_dwordx2 v[40:41], v1, s[8:11], s55 offen sc1
  v_mfma_f32_16x16x32_bf16 v[108:111], a[172:175], a[92:95], v[108:111]
  ds_read_b64_tr_b16 a[172:173], v7 offset:57344
  v_cvt_pk_bf16_f32 v44, v60, v61
  v_cvt_pk_bf16_f32 v45, v62, v63
  v_mfma_f32_16x16x32_bf16 v[108:111], a[168:171], a[76:79], v[108:111]
  s_waitcnt lgkmcnt(5)
  s_add_u32 s55, s60, 786432
  buffer_store_dwordx2 v[44:45], v1, s[8:11], s55 offen sc1
  v_mfma_f32_16x16x32_bf16 v[124:127], a[176:179], a[76:79], v[124:127]
  ds_read_b64_tr_b16 a[174:175], v7 offset:59392
  v_mul_f32 v24, v16, v64
  v_mfma_f32_16x16x32_bf16 v[124:127], a[180:183], a[92:95], v[124:127]
  v_mul_f32 v25, v16, v65
  v_mul_f32 v26, v16, v66
  v_mul_f32 v27, v16, v67
  v_mfma_f32_16x16x32_bf16 v[120:123], a[180:183], a[88:91], v[120:123]
  ds_read_b64_tr_b16 a[168:169], v7 offset:61440
  v_mul_f32 v28, v18, v68
  v_mul_f32 v29, v18, v69
  v_mfma_f32_16x16x32_bf16 v[120:123], a[176:179], a[72:75], v[120:123]
  v_mul_f32 v30, v18, v70
  v_mul_f32 v31, v18, v71
  v_mfma_f32_16x16x32_bf16 v[116:119], a[176:179], a[68:71], v[116:119]
  ds_read_b64_tr_b16 a[170:171], v7 offset:63488
  v_mfma_f32_16x16x32_bf16 v[116:119], a[180:183], a[84:87], v[116:119]
  v_exp_f32 v24, v24
  v_mul_f32 v80, v64, v80
  v_mfma_f32_16x16x32_bf16 v[112:115], a[180:183], a[80:83], v[112:115]
  ds_read_b64_tr_b16 a[180:181], v7 offset:16384
  v_exp_f32 v25, v25
  v_mfma_f32_16x16x32_bf16 v[112:115], a[176:179], a[64:67], v[112:115]
  s_waitcnt lgkmcnt(5)
  v_mul_f32 v81, v65, v81
  v_exp_f32 v26, v26
  v_mfma_f32_16x16x32_bf16 v[96:99], a[164:167], a[96:99], v[96:99]
  ds_read_b64_tr_b16 a[182:183], v7 offset:18432
  v_mul_f32 v82, v66, v82
  v_mfma_f32_16x16x32_bf16 v[96:99], a[160:163], a[112:115], v[96:99]
  v_exp_f32 v27, v27
  v_mul_f32 v83, v67, v83
  v_mfma_f32_16x16x32_bf16 v[100:103], a[160:163], a[116:119], v[100:103]
  ds_read_b64_tr_b16 a[176:177], v7 offset:20480
  v_exp_f32 v28, v28
  v_mfma_f32_16x16x32_bf16 v[100:103], a[164:167], a[100:103], v[100:103]
  v_mul_f32 v84, v68, v84
  v_exp_f32 v29, v29
  v_mfma_f32_16x16x32_bf16 v[104:107], a[164:167], a[104:107], v[104:107]
  ds_read_b64_tr_b16 a[178:179], v7 offset:22528
  v_mul_f32 v85, v69, v85
  v_mfma_f32_16x16x32_bf16 v[104:107], a[160:163], a[120:123], v[104:107]
  v_lshrrev_b32 v48, 3, v0
  v_bfe_u32 v49, v48, 1, 2
  v_bfe_u32 v50, v0, 1, 2
  v_mfma_f32_16x16x32_bf16 v[108:111], a[160:163], a[124:127], v[108:111]
  ds_read_b64_tr_b16 a[160:161], v7 offset:24576
  v_xor_b32 v49, v49, v50
  v_lshlrev_b32 v49, 5, v49
  v_mfma_f32_16x16x32_bf16 v[108:111], a[164:167], a[108:111], v[108:111]
  s_waitcnt lgkmcnt(5)
  v_and_b32 v50, 1, v0
  v_lshl_add_u32 v49, v50, 4, v49
  s_lshl_b32 s53, s44, 3
  v_mfma_f32_16x16x32_bf16 v[124:127], a[172:175], a[108:111], v[124:127]
  ds_read_b64_tr_b16 a[162:163], v7 offset:26624
  v_add_u32 v48, s53, v48
  v_mfma_f32_16x16x32_bf16 v[124:127], a[168:171], a[124:127], v[124:127]
  v_lshl_add_u32 v48, v48, 11, v49
  s_mul_i32 s53, s52, 1835008
  s_lshl_b32 s54, s51, 7
  v_mfma_f32_16x16x32_bf16 v[120:123], a[168:171], a[120:123], v[120:123]
  ds_read_b64_tr_b16 a[164:165], v7 offset:28672
  s_add_u32 s53, s53, s54
  v_add_u32 v33, s53, v48
  v_mfma_f32_16x16x32_bf16 v[120:123], a[172:175], a[104:107], v[120:123]
  v_xor_b32 v32, 128, v33
  v_and_b32 v48, 3, v0
  v_bfe_u32 v49, v0, 2, 1
  v_mfma_f32_16x16x32_bf16 v[116:119], a[172:175], a[100:103], v[116:119]
  ds_read_b64_tr_b16 a[166:167], v7 offset:30720
  v_lshl_add_u32 v48, v48, 3, v49
  v_mfma_f32_16x16x32_bf16 v[116:119], a[168:171], a[116:119], v[116:119]
  v_lshlrev_b32 v37, 7, v48
  v_exp_f32 v30, v30
  v_mfma_f32_16x16x32_bf16 v[112:115], a[168:171], a[112:115], v[112:115]
  ds_read_b64_tr_b16 a[168:169], v7 offset:0
  v_mul_f32 v86, v70, v86
  v_mfma_f32_16x16x32_bf16 v[112:115], a[172:175], a[96:99], v[112:115]
  s_waitcnt lgkmcnt(5)
  v_exp_f32 v31, v31
  v_mul_f32 v87, v71, v87
  v_mfma_f32_16x16x32_bf16 v[96:99], a[180:183], a[128:131], v[96:99]
  ds_read_b64_tr_b16 a[170:171], v7 offset:2048
  v_fma_f32 v24, v24, v17, v17
  v_mfma_f32_16x16x32_bf16 v[96:99], a[176:179], a[144:147], v[96:99]
  v_fma_f32 v25, v25, v17, v17
  v_rcp_f32 v24, v24
  v_mfma_f32_16x16x32_bf16 v[100:103], a[176:179], a[148:151], v[100:103]
  ds_read_b64_tr_b16 a[172:173], v7 offset:4096
  v_fma_f32 v26, v26, v17, v17
  v_mfma_f32_16x16x32_bf16 v[100:103], a[180:183], a[132:135], v[100:103]
  v_rcp_f32 v25, v25
  v_fma_f32 v27, v27, v17, v17
  v_mfma_f32_16x16x32_bf16 v[104:107], a[180:183], a[136:139], v[104:107]
  ds_read_b64_tr_b16 a[174:175], v7 offset:6144
  v_mfma_f32_16x16x32_bf16 v[104:107], a[176:179], a[152:155], v[104:107]
  v_rcp_f32 v26, v26
  v_fma_f32 v28, v28, v19, v19
  v_mfma_f32_16x16x32_bf16 v[108:111], a[176:179], a[156:159], v[108:111]
  ds_read_b64_tr_b16 a[176:177], v7 offset:8192
  v_rcp_f32 v27, v27
  v_mfma_f32_16x16x32_bf16 v[108:111], a[180:183], a[140:143], v[108:111]
  s_waitcnt lgkmcnt(5)
  v_fma_f32 v29, v29, v19, v19
  v_rcp_f32 v28, v28
  v_mfma_f32_16x16x32_bf16 v[124:127], a[160:163], a[140:143], v[124:127]
  ds_read_b64_tr_b16 a[178:179], v7 offset:10240
  v_fma_f32 v30, v30, v19, v19
  v_mfma_f32_16x16x32_bf16 v[124:127], a[164:167], a[156:159], v[124:127]
  v_rcp_f32 v29, v29
  v_fma_f32 v31, v31, v19, v19
  v_mfma_f32_16x16x32_bf16 v[120:123], a[164:167], a[152:155], v[120:123]
  ds_read_b64_tr_b16 a[180:181], v7 offset:12288
  s_add_u32 s62, s92, 12288
  v_mfma_f32_16x16x32_bf16 v[120:123], a[160:163], a[136:139], v[120:123]
  buffer_load_dword a253, v13, s[36:39], s62 offen
  v_rcp_f32 v30, v30
  v_mul_f32 v80, v80, v24
  v_mfma_f32_16x16x32_bf16 v[116:119], a[160:163], a[132:135], v[116:119]
  ds_read_b64_tr_b16 a[182:183], v7 offset:14336
  v_mfma_f32_16x16x32_bf16 v[116:119], a[164:167], a[148:151], v[116:119]
  s_waitcnt vmcnt(19)
  s_barrier
  v_mfma_f32_16x16x32_bf16 v[112:115], a[164:167], a[144:147], v[112:115]
  ds_read_b64_tr_b16 a[164:165], v2 offset:0
HOP14:
  s_cbranch_execz WRET0
  v_rcp_f32 v31, v31
  v_mfma_f32_16x16x32_bf16 v[112:115], a[160:163], a[128:131], v[112:115]
  s_waitcnt lgkmcnt(5)
  v_mul_f32 v81, v81, v25
  v_mul_f32 v82, v82, v26
  v_mul_f32 v83, v83, v27
  v_mfma_f32_16x16x32_bf16 v[96:99], a[168:171], a[188:191], v[96:99]
  ds_read_b64_tr_b16 a[166:167], v2 offset:2048
  v_mul_f32 v84, v84, v28
  v_mfma_f32_16x16x32_bf16 v[96:99], a[172:175], a[204:207], v[96:99]
  s_add_u32 m0, s45, 98304
  v_mul_f32 v85, v85, v29
  v_mul_f32 v86, v86, v30
  v_mul_f32 v87, v87, v31
  v_mfma_f32_16x16x32_bf16 v[100:103], a[172:175], a[208:211], v[100:103]
  ds_read_b64_tr_b16 a[160:161], v2 offset:4096
  v_cvt_pk_bf16_f32 v64, v80, v81
  v_cvt_pk_bf16_f32 v65, v82, v83
  v_mfma_f32_16x16x32_bf16 v[100:103], a[168:171], a[192:195], v[100:103]
  buffer_load_dwordx4 v10, s[28:31], s71 offen lds
  v_cvt_pk_bf16_f32 v68, v84, v85
  v_cvt_pk_bf16_f32 v69, v86, v87
  v_mul_f32 v24, v20, v72
  v_mfma_f32_16x16x32_bf16 v[104:107], a[168:171], a[196:199], v[104:107]
  ds_read_b64_tr_b16 a[162:163], v2 offset:6144
  v_mul_f32 v25, v20, v73
  v_mfma_f32_16x16x32_bf16 v[104:107], a[172:175], a[212:215], v[104:107]
  s_add_u32 m0, s45, 106496
  v_mul_f32 v26, v20, v74
  v_mul_f32 v27, v20, v75
  v_mul_f32 v28, v22, v76
  v_mfma_f32_16x16x32_bf16 v[108:111], a[172:175], a[216:219], v[108:111]
  ds_read_b64_tr_b16 a[172:173], v2 offset:8192
  v_mul_f32 v29, v22, v77
  v_mul_f32 v30, v22, v78
  v_mfma_f32_16x16x32_bf16 v[108:111], a[168:171], a[200:203], v[108:111]
  s_waitcnt lgkmcnt(5)
  buffer_load_dwordx4 v10, s[32:35], s71 offen lds
  v_mul_f32 v31, v22, v79
  v_mfma_f32_16x16x32_bf16 v[124:127], a[176:179], a[200:203], v[124:127]
  ds_read_b64_tr_b16 a[174:175], v2 offset:10240
  s_waitcnt vmcnt(8)
  s_barrier
  v_mfma_f32_16x16x32_bf16 v[124:127], a[180:183], a[216:219], v[124:127]
  s_add_u32 m0, s45, 102400
  s_add_u32 s61, s71, 229376
  v_exp_f32 v24, v24
  v_mfma_f32_16x16x32_bf16 v[120:123], a[180:183], a[212:215], v[120:123]
  ds_read_b64_tr_b16 a[168:169], v2 offset:12288
  v_mul_f32 v88, v72, v88
  v_mfma_f32_16x16x32_bf16 v[120:123], a[176:179], a[196:199], v[120:123]
  buffer_load_dwordx4 v10, s[28:31], s61 offen lds
  v_exp_f32 v25, v25
  v_mul_f32 v89, v73, v89
  v_mfma_f32_16x16x32_bf16 v[116:119], a[176:179], a[192:195], v[116:119]
  ds_read_b64_tr_b16 a[170:171], v2 offset:14336
  v_mfma_f32_16x16x32_bf16 v[116:119], a[180:183], a[208:211], v[116:119]
  s_add_u32 m0, s45, 110592
  s_add_u32 s61, s71, 229376
  v_exp_f32 v26, v26
  v_mfma_f32_16x16x32_bf16 v[112:115], a[180:183], a[204:207], v[112:115]
  ds_read_b64_tr_b16 a[180:181], v3 offset:0
  v_mul_f32 v90, v74, v90
  v_mfma_f32_16x16x32_bf16 v[112:115], a[176:179], a[188:191], v[112:115]
  s_waitcnt lgkmcnt(5)
  buffer_load_dwordx4 v10, s[32:35], s61 offen lds
  v_exp_f32 v27, v27
  v_mfma_f32_16x16x32_bf16 v[128:131], a[164:167], a[32:35], v[128:131]
  ds_read_b64_tr_b16 a[182:183], v3 offset:2048
  v_mul_f32 v91, v75, v91
  v_mfma_f32_16x16x32_bf16 v[128:131], a[160:163], a[48:51], v[128:131]
  v_exp_f32 v28, v28
  v_mul_f32 v92, v76, v92
  v_mfma_f32_16x16x32_bf16 v[132:135], a[160:163], a[52:55], v[132:135]
  ds_read_b64_tr_b16 a[176:177], v3 offset:4096
  v_exp_f32 v29, v29
  v_mfma_f32_16x16x32_bf16 v[132:135], a[164:167], a[36:39], v[132:135]
  v_mul_f32 v93, v77, v93
  v_exp_f32 v30, v30
  v_mfma_f32_16x16x32_bf16 v[136:139], a[164:167], a[40:43], v[136:139]
  ds_read_b64_tr_b16 a[178:179], v3 offset:6144
  v_mul_f32 v94, v78, v94
  v_mfma_f32_16x16x32_bf16 v[136:139], a[160:163], a[56:59], v[136:139]
  v_exp_f32 v31, v31
  v_mul_f32 v95, v79, v95
  v_mfma_f32_16x16x32_bf16 v[140:143], a[160:163], a[60:63], v[140:143]
  ds_read_b64_tr_b16 a[160:161], v3 offset:8192
  v_fma_f32 v24, v24, v21, v21
  v_fma_f32 v25, v25, v21, v21
  v_mfma_f32_16x16x32_bf16 v[140:143], a[164:167], a[44:47], v[140:143]
  s_waitcnt lgkmcnt(5)
  v_rcp_f32 v24, v24
  v_fma_f32 v26, v26, v21, v21
  v_mfma_f32_16x16x32_bf16 v[156:159], a[172:175], a[44:47], v[156:159]
  ds_read_b64_tr_b16 a[162:163], v3 offset:10240
  v_mfma_f32_16x16x32_bf16 v[156:159], a[168:171], a[60:63], v[156:159]
  v_rcp_f32 v25, v25
  v_fma_f32 v27, v27, v21, v21
  v_mfma_f32_16x16x32_bf16 v[152:155], a[168:171], a[56:59], v[152:155]
  ds_read_b64_tr_b16 a[164:165], v3 offset:12288
  v_rcp_f32 v26, v26
  v_mfma_f32_16x16x32_bf16 v[152:155], a[172:175], a[40:43], v[152:155]
  v_fma_f32 v28, v28, v23, v23
  v_rcp_f32 v27, v27
  v_mfma_f32_16x16x32_bf16 v[148:151], a[172:175], a[36:39], v[148:151]
  ds_read_b64_tr_b16 a[166:167], v3 offset:14336
  v_fma_f32 v29, v29, v23, v23
  v_mfma_f32_16x16x32_bf16 v[148:151], a[168:171], a[52:55], v[148:151]
  v_rcp_f32 v28, v28
  v_fma_f32 v30, v30, v23, v23
  v_mfma_f32_16x16x32_bf16 v[144:147], a[168:171], a[48:51], v[144:147]
  ds_read_b64_tr_b16 a[168:169], v4 offset:0
  v_rcp_f32 v29, v29
  v_mfma_f32_16x16x32_bf16 v[144:147], a[172:175], a[32:35], v[144:147]
  s_waitcnt lgkmcnt(5)
  v_fma_f32 v31, v31, v23, v23
  v_rcp_f32 v30, v30
  v_mfma_f32_16x16x32_bf16 v[160:163], a[180:183], a[32:35], v[160:163]
  ds_read_b64_tr_b16 a[170:171], v4 offset:2048
  v_mul_f32 v88, v88, v24
  v_mfma_f32_16x16x32_bf16 v[160:163], a[176:179], a[48:51], v[160:163]
  v_rcp_f32 v31, v31
  v_mul_f32 v89, v89, v25
  v_mfma_f32_16x16x32_bf16 v[164:167], a[176:179], a[52:55], v[164:167]
  ds_read_b64_tr_b16 a[172:173], v4 offset:4096
  v_mul_f32 v90, v90, v26
  v_mul_f32 v91, v91, v27
  v_mfma_f32_16x16x32_bf16 v[164:167], a[180:183], a[36:39], v[164:167]
  v_mul_f32 v92, v92, v28
  v_mul_f32 v93, v93, v29
  v_mul_f32 v94, v94, v30
  v_mfma_f32_16x16x32_bf16 v[168:171], a[180:183], a[40:43], v[168:171]
  ds_read_b64_tr_b16 a[174:175], v4 offset:6144
  v_mul_f32 v95, v95, v31
  v_mfma_f32_16x16x32_bf16 v[168:171], a[176:179], a[56:59], v[168:171]
  v_cvt_pk_bf16_f32 v72, v88, v89
  v_cvt_pk_bf16_f32 v73, v90, v91
  v_cvt_pk_bf16_f32 v76, v92, v93
  v_mfma_f32_16x16x32_bf16 v[172:175], a[176:179], a[60:63], v[172:175]
  ds_read_b64_tr_b16 a[176:177], v4 offset:8192
  v_cvt_pk_bf16_f32 v77, v94, v95
  v_mfma_f32_16x16x32_bf16 v[172:175], a[180:183], a[44:47], v[172:175]
  s_waitcnt lgkmcnt(5)
  v_mfma_f32_16x16x32_bf16 v[188:191], a[160:163], a[44:47], v[188:191]
  ds_read_b64_tr_b16 a[178:179], v4 offset:10240
  s_cmp_eq_u32 s91, 0
  s_cselect_b32 s72, 8, 1
  s_lshl_b32 s64, s72, 17
  s_lshl_b32 s72, s72, 11
  s_add_u32 s72, s72, s84
  s_add_u32 m0, s45, 114688
  v_mul_f32 v24, v16, v96
  v_mfma_f32_16x16x32_bf16 v[188:191], a[164:167], a[60:63], v[188:191]
  buffer_load_dwordx4 v32, s[36:39], s64 offen lds
  v_mul_f32 v25, v16, v97
  v_mul_f32 v26, v16, v98
  v_mul_f32 v27, v16, v99
  v_mfma_f32_16x16x32_bf16 v[184:187], a[164:167], a[56:59], v[184:187]
  ds_read_b64_tr_b16 a[180:181], v4 offset:12288
  v_mul_f32 v28, v18, v100
  v_mul_f32 v29, v18, v101
  v_mfma_f32_16x16x32_bf16 v[184:187], a[160:163], a[40:43], v[184:187]
  s_add_u32 m0, s45, 118784
  s_add_u32 s61, s64, 65536
  v_mul_f32 v30, v18, v102
  v_mul_f32 v31, v18, v103
  v_mfma_f32_16x16x32_bf16 v[180:183], a[160:163], a[36:39], v[180:183]
  ds_read_b64_tr_b16 a[182:183], v4 offset:14336
  v_exp_f32 v24, v24
  v_mfma_f32_16x16x32_bf16 v[180:183], a[164:167], a[52:55], v[180:183]
  buffer_load_dwordx4 v32, s[36:39], s61 offen lds
  v_mul_f32 v112, v96, v112
  v_exp_f32 v25, v25
  v_mfma_f32_16x16x32_bf16 v[176:179], a[164:167], a[48:51], v[176:179]
  ds_read_b64_tr_b16 a[164:165], v5 offset:0
  v_mul_f32 v113, v97, v113
  v_mfma_f32_16x16x32_bf16 v[176:179], a[160:163], a[32:35], v[176:179]
  s_waitcnt lgkmcnt(5)
  s_add_u32 m0, s45, 122880
  v_exp_f32 v26, v26
  v_mul_f32 v114, v98, v114
  v_mfma_f32_16x16x32_bf16 v[192:195], a[168:171], a[32:35], v[192:195]
  ds_read_b64_tr_b16 a[166:167], v5 offset:2048
  v_exp_f32 v27, v27
  v_mfma_f32_16x16x32_bf16 v[192:195], a[172:175], a[48:51], v[192:195]
  buffer_load_dwordx4 v33, s[36:39], s64 offen lds
  v_mul_f32 v115, v99, v115
  v_exp_f32 v28, v28
  v_mfma_f32_16x16x32_bf16 v[196:199], a[172:175], a[52:55], v[196:199]
  ds_read_b64_tr_b16 a[160:161], v5 offset:4096
  v_mul_f32 v116, v100, v116
  v_mfma_f32_16x16x32_bf16 v[196:199], a[168:171], a[36:39], v[196:199]
  s_add_u32 m0, s45, 126976
  s_add_u32 s61, s64, 65536
  v_exp_f32 v29, v29
  v_mul_f32 v117, v101, v117
  v_mfma_f32_16x16x32_bf16 v[200:203], a[168:171], a[40:43], v[200:203]
  ds_read_b64_tr_b16 a[162:163], v5 offset:6144
  v_exp_f32 v30, v30
  v_mfma_f32_16x16x32_bf16 v[200:203], a[172:175], a[56:59], v[200:203]
  buffer_load_dwordx4 v33, s[36:39], s61 offen lds
  v_mul_f32 v118, v102, v118
  v_exp_f32 v31, v31
  v_mfma_f32_16x16x32_bf16 v[204:207], a[172:175], a[60:63], v[204:207]
  ds_read_b64_tr_b16 a[172:173], v5 offset:8192
  v_mul_f32 v119, v103, v119
  v_fma_f32 v24, v24, v17, v17
  v_mfma_f32_16x16x32_bf16 v[204:207], a[168:171], a[44:47], v[204:207]
  s_waitcnt lgkmcnt(5)
  s_cmp_eq_u32 s91, 1
  s_cselect_b32 s73, 10, 3
  s_lshl_b32 s65, s73, 17
  s_lshl_b32 s73, s73, 11
  s_add_u32 s73, s73, s84
  s_add_u32 m0, s45, 81920
  v_fma_f32 v25, v25, v17, v17
  v_rcp_f32 v24, v24
  v_mfma_f32_16x16x32_bf16 v[220:223], a[176:179], a[44:47], v[220:223]
  ds_read_b64_tr_b16 a[174:175], v5 offset:10240
  v_fma_f32 v26, v26, v17, v17
  v_mfma_f32_16x16x32_bf16 v[220:223], a[180:183], a[60:63], v[220:223]
  buffer_load_dwordx4 v32, s[36:39], s65 offen lds
  v_rcp_f32 v25, v25
  v_fma_f32 v27, v27, v17, v17
  v_mfma_f32_16x16x32_bf16 v[216:219], a[180:183], a[56:59], v[216:219]
  ds_read_b64_tr_b16 a[168:169], v5 offset:12288
  v_rcp_f32 v26, v26
  v_mfma_f32_16x16x32_bf16 v[216:219], a[176:179], a[40:43], v[216:219]
  s_add_u32 m0, s45, 86016
  s_add_u32 s61, s65, 65536
  v_fma_f32 v28, v28, v19, v19
  v_rcp_f32 v27, v27
  v_mfma_f32_16x16x32_bf16 v[212:215], a[176:179], a[36:39], v[212:215]
  ds_read_b64_tr_b16 a[170:171], v5 offset:14336
  v_fma_f32 v29, v29, v19, v19
  v_mfma_f32_16x16x32_bf16 v[212:215], a[180:183], a[52:55], v[212:215]
  buffer_load_dwordx4 v32, s[36:39], s61 offen lds
  v_rcp_f32 v28, v28
  v_fma_f32 v30, v30, v19, v19
  v_mfma_f32_16x16x32_bf16 v[208:211], a[180:183], a[48:51], v[208:211]
  ds_read_b64_tr_b16 a[180:181], v2 offset:32768
  v_rcp_f32 v29, v29
  v_mfma_f32_16x16x32_bf16 v[208:211], a[176:179], a[32:35], v[208:211]
  s_waitcnt lgkmcnt(5)
  s_add_u32 m0, s45, 90112
  v_fma_f32 v31, v31, v19, v19
  v_rcp_f32 v30, v30
  v_mfma_f32_16x16x32_bf16 v[224:227], a[164:167], a[32:35], v[224:227]
  ds_read_b64_tr_b16 a[182:183], v2 offset:34816
  v_mul_f32 v112, v112, v24
  v_mfma_f32_16x16x32_bf16 v[224:227], a[160:163], a[48:51], v[224:227]
  buffer_load_dwordx4 v33, s[36:39], s65 offen lds
  v_rcp_f32 v31, v31
  v_mul_f32 v113, v113, v25
  v_mfma_f32_16x16x32_bf16 v[228:231], a[160:163], a[52:55], v[228:231]
  ds_read_b64_tr_b16 a[176:177], v2 offset:36864
  v_mul_f32 v114, v114, v26
  v_mul_f32 v115, v115, v27
  v_mfma_f32_16x16x32_bf16 v[228:231], a[164:167], a[36:39], v[228:231]
  s_add_u32 m0, s45, 94208
  s_add_u32 s61, s65, 65536
  v_mul_f32 v116, v116, v28
  v_mul_f32 v117, v117, v29
  v_mul_f32 v118, v118, v30
  v_mfma_f32_16x16x32_bf16 v[232:235], a[164:167], a[40:43], v[232:235]
  ds_read_b64_tr_b16 a[178:179], v2 offset:38912
  v_mul_f32 v119, v119, v31
  v_cvt_pk_bf16_f32 v66, v112, v113
  v_mfma_f32_16x16x32_bf16 v[232:235], a[160:163], a[56:59], v[232:235]
  buffer_load_dwordx4 v33, s[36:39], s61 offen lds
  v_cvt_pk_bf16_f32 v67, v114, v115
  v_mfma_f32_16x16x32_bf16 v[236:239], a[160:163], a[60:63], v[236:239]
  ds_read_b64_tr_b16 a[160:161], v2 offset:40960
  v_mfma_f32_16x16x32_bf16 v[236:239], a[164:167], a[44:47], v[236:239]
  s_waitcnt lgkmcnt(5)
  s_cmp_eq_u32 s91, 2
  s_cselect_b32 s74, 12, 5
  s_lshl_b32 s66, s74, 17
  s_lshl_b32 s74, s74, 11
  s_add_u32 s74, s74, s84
  s_add_u32 m0, s45, 65536
  v_mfma_f32_16x16x32_bf16 v[252:255], a[172:175], a[44:47], v[252:255]
  ds_read_b64_tr_b16 a[162:163], v2 offset:43008
  buffer_store_dwordx4 v[64:67], v1, s[8:11], s59 offen offset:0 sc1
  v_mfma_f32_16x16x32_bf16 v[252:255], a[168:171], a[60:63], v[252:255]
  buffer_load_dwordx4 v32, s[36:39], s66 offen lds
  v_cvt_pk_bf16_f32 v70, v116, v117
  v_cvt_pk_bf16_f32 v71, v118, v119
  v_mfma_f32_16x16x32_bf16 v[248:251], a[168:171], a[56:59], v[248:251]
  ds_read_b64_tr_b16 a[164:165], v2 offset:45056
  v_mfma_f32_16x16x32_bf16 v[248:251], a[172:175], a[40:43], v[248:251]
  s_add_u32 m0, s45, 69632
  s_add_u32 s61, s66, 65536
  v_mfma_f32_16x16x32_bf16 v[244:247], a[172:175], a[36:39], v[244:247]
  ds_read_b64_tr_b16 a[166:167], v2 offset:47104
  s_add_u32 s55, s59, 262144
  buffer_store_dwordx4 v[68:71], v1, s[8:11], s55 offen offset:0 sc1
  v_mfma_f32_16x16x32_bf16 v[244:247], a[168:171], a[52:55], v[244:247]
  buffer_load_dwordx4 v32, s[36:39], s61 offen lds
  v_mul_f32 v24, v20, v104
  v_mul_f32 v25, v20, v105
  v_mul_f32 v26, v20, v106
  v_mfma_f32_16x16x32_bf16 v[240:243], a[168:171], a[48:51], v[240:243]
  ds_read_b64_tr_b16 a[168:169], v2 offset:49152
  v_mul_f32 v27, v20, v107
  v_mul_f32 v28, v22, v108
  v_mfma_f32_16x16x32_bf16 v[240:243], a[172:175], a[32:35], v[240:243]
  s_waitcnt lgkmcnt(5)
  s_add_u32 m0, s45, 73728
  v_mul_f32 v29, v22, v109
  v_mul_f32 v30, v22, v110
  v_mul_f32 v31, v22, v111
  v_mfma_f32_16x16x32_bf16 v[128:131], a[180:183], a[64:67], v[128:131]
  ds_read_b64_tr_b16 a[170:171], v2 offset:51200
  v_exp_f32 v24, v24
  v_mfma_f32_16x16x32_bf16 v[128:131], a[176:179], a[80:83], v[128:131]
  buffer_load_dwordx4 v33, s[36:39], s66 offen lds
  v_mul_f32 v120, v104, v120
  v_exp_f32 v25, v25
  v_mfma_f32_16x16x32_bf16 v[132:135], a[176:179], a[84:87], v[132:135]
  ds_read_b64_tr_b16 a[172:173], v2 offset:53248
  v_mul_f32 v121, v105, v121
  v_mfma_f32_16x16x32_bf16 v[132:135], a[180:183], a[68:71], v[132:135]
  s_add_u32 m0, s45, 77824
  s_add_u32 s61, s66, 65536
  v_exp_f32 v26, v26
  v_mul_f32 v122, v106, v122
  v_mfma_f32_16x16x32_bf16 v[136:139], a[180:183], a[72:75], v[136:139]
  ds_read_b64_tr_b16 a[174:175], v2 offset:55296
  v_exp_f32 v27, v27
  v_mfma_f32_16x16x32_bf16 v[136:139], a[176:179], a[88:91], v[136:139]
  buffer_load_dwordx4 v33, s[36:39], s61 offen lds
  v_mul_f32 v123, v107, v123
  v_exp_f32 v28, v28
  v_mfma_f32_16x16x32_bf16 v[140:143], a[176:179], a[92:95], v[140:143]
  ds_read_b64_tr_b16 a[176:177], v2 offset:57344
  v_mul_f32 v124, v108, v124
  v_mfma_f32_16x16x32_bf16 v[140:143], a[180:183], a[76:79], v[140:143]
  s_waitcnt lgkmcnt(5)
  v_exp_f32 v29, v29
  v_mul_f32 v125, v109, v125
  v_mfma_f32_16x16x32_bf16 v[156:159], a[160:163], a[76:79], v[156:159]
  ds_read_b64_tr_b16 a[178:179], v2 offset:59392
  v_exp_f32 v30, v30
  v_mfma_f32_16x16x32_bf16 v[156:159], a[164:167], a[92:95], v[156:159]
  v_mul_f32 v126, v110, v126
  v_exp_f32 v31, v31
  v_mfma_f32_16x16x32_bf16 v[152:155], a[164:167], a[88:91], v[152:155]
  ds_read_b64_tr_b16 a[180:181], v2 offset:61440
  v_mul_f32 v127, v111, v127
  v_fma_f32 v24, v24, v21, v21
  v_mfma_f32_16x16x32_bf16 v[152:155], a[160:163], a[72:75], v[152:155]
  v_fma_f32 v25, v25, v21, v21
  v_rcp_f32 v24, v24
  v_fma_f32 v26, v26, v21, v21
  v_mfma_f32_16x16x32_bf16 v[148:151], a[160:163], a[68:71], v[148:151]
  ds_read_b64_tr_b16 a[182:183], v2 offset:63488
  v_rcp_f32 v25, v25
  v_mfma_f32_16x16x32_bf16 v[148:151], a[164:167], a[84:87], v[148:151]
  v_fma_f32 v27, v27, v21, v21
  v_rcp_f32 v26, v26
  v_mfma_f32_16x16x32_bf16 v[144:147], a[164:167], a[80:83], v[144:147]
  ds_read_b64_tr_b16 a[164:165], v2 offset:16384
  v_fma_f32 v28, v28, v23, v23
  v_mfma_f32_16x16x32_bf16 v[144:147], a[160:163], a[64:67], v[144:147]
  s_waitcnt lgkmcnt(5)
  v_rcp_f32 v27, v27
  v_fma_f32 v29, v29, v23, v23
  v_mfma_f32_16x16x32_bf16 v[128:131], a[168:171], a[96:99], v[128:131]
  ds_read_b64_tr_b16 a[166:167], v2 offset:18432
  v_rcp_f32 v28, v28
  v_mfma_f32_16x16x32_bf16 v[128:131], a[172:175], a[112:115], v[128:131]
  v_fma_f32 v30, v30, v23, v23
  v_rcp_f32 v29, v29
  v_mfma_f32_16x16x32_bf16 v[132:135], a[172:175], a[116:119], v[132:135]
  ds_read_b64_tr_b16 a[160:161], v2 offset:20480
  v_fma_f32 v31, v31, v23, v23
  v_mfma_f32_16x16x32_bf16 v[132:135], a[168:171], a[100:103], v[132:135]
  v_rcp_f32 v30, v30
  v_mul_f32 v120, v120, v24
  v_mfma_f32_16x16x32_bf16 v[136:139], a[168:171], a[104:107], v[136:139]
  ds_read_b64_tr_b16 a[162:163], v2 offset:22528
  v_rcp_f32 v31, v31
  v_mfma_f32_16x16x32_bf16 v[136:139], a[172:175], a[120:123], v[136:139]
  v_mul_f32 v121, v121, v25
  v_mul_f32 v122, v122, v26
  v_mul_f32 v123, v123, v27
  v_mfma_f32_16x16x32_bf16 v[140:143], a[172:175], a[124:127], v[140:143]
  ds_read_b64_tr_b16 a[172:173], v2 offset:24576
  v_mul_f32 v124, v124, v28
  v_mul_f32 v125, v125, v29
  v_mfma_f32_16x16x32_bf16 v[140:143], a[168:171], a[108:111], v[140:143]
  s_waitcnt lgkmcnt(5)
  v_mul_f32 v126, v126, v30
  v_mul_f32 v127, v127, v31
  v_cvt_pk_bf16_f32 v74, v120, v121
  v_cvt_pk_bf16_f32 v75, v122, v123
  v_mfma_f32_16x16x32_bf16 v[156:159], a[176:179], a[108:111], v[156:159]
  ds_read_b64_tr_b16 a[174:175], v2 offset:26624
  v_mfma_f32_16x16x32_bf16 v[156:159], a[180:183], a[124:127], v[156:159]
  s_add_u32 s55, s59, 524288
  buffer_store_dwordx4 v[72:75], v1, s[8:11], s55 offen offset:0 sc1
  v_mfma_f32_16x16x32_bf16 v[152:155], a[180:183], a[120:123], v[152:155]
  ds_read_b64_tr_b16 a[168:169], v2 offset:28672
  v_cvt_pk_bf16_f32 v78, v124, v125
  v_cvt_pk_bf16_f32 v79, v126, v127
  v_mfma_f32_16x16x32_bf16 v[152:155], a[176:179], a[104:107], v[152:155]
  s_add_u32 s55, s59, 786432
  buffer_store_dwordx4 v[76:79], v1, s[8:11], s55 offen offset:0 sc1
  v_mfma_f32_16x16x32_bf16 v[148:151], a[176:179], a[100:103], v[148:151]
  ds_read_b64_tr_b16 a[170:171], v2 offset:30720
  v_mfma_f32_16x16x32_bf16 v[148:151], a[180:183], a[116:119], v[148:151]
  s_waitcnt vmcnt(16)
  s_barrier
  v_mfma_f32_16x16x32_bf16 v[144:147], a[180:183], a[112:115], v[144:147]
  ds_read_b64_tr_b16 a[180:181], v6 offset:32768
  s_cmp_eq_u32 s91, 0
  s_cselect_b32 s75, 1, 8
  s_lshl_b32 s67, s75, 17
  s_lshl_b32 s75, s75, 11
  s_add_u32 s75, s75, s84
  s_add_u32 m0, s45, 0
  v_mfma_f32_16x16x32_bf16 v[144:147], a[176:179], a[96:99], v[144:147]
  s_waitcnt lgkmcnt(5)
  buffer_load_dwordx4 v32, s[36:39], s67 offen lds
  v_mfma_f32_16x16x32_bf16 v[128:131], a[164:167], a[128:131], v[128:131]
  ds_read_b64_tr_b16 a[182:183], v6 offset:34816
  v_mfma_f32_16x16x32_bf16 v[128:131], a[160:163], a[144:147], v[128:131]
  s_add_u32 m0, s45, 4096
  s_add_u32 s61, s67, 65536
  v_mfma_f32_16x16x32_bf16 v[132:135], a[160:163], a[148:151], v[132:135]
  ds_read_b64_tr_b16 a[176:177], v6 offset:36864
  v_mfma_f32_16x16x32_bf16 v[132:135], a[164:167], a[132:135], v[132:135]
  buffer_load_dwordx4 v32, s[36:39], s61 offen lds
  v_mfma_f32_16x16x32_bf16 v[136:139], a[164:167], a[136:139], v[136:139]
  ds_read_b64_tr_b16 a[178:179], v6 offset:38912
  v_mfma_f32_16x16x32_bf16 v[136:139], a[160:163], a[152:155], v[136:139]
  s_add_u32 m0, s45, 8192
  v_mfma_f32_16x16x32_bf16 v[140:143], a[160:163], a[156:159], v[140:143]
  ds_read_b64_tr_b16 a[160:161], v6 offset:40960
  v_mfma_f32_16x16x32_bf16 v[140:143], a[164:167], a[140:143], v[140:143]
  s_waitcnt lgkmcnt(5)
  buffer_load_dwordx4 v33, s[36:39], s67 offen lds
  v_mfma_f32_16x16x32_bf16 v[156:159], a[172:175], a[140:143], v[156:159]
  ds_read_b64_tr_b16 a[162:163], v6 offset:43008
  v_mfma_f32_16x16x32_bf16 v[156:159], a[168:171], a[156:159], v[156:159]
  s_add_u32 m0, s45, 12288
  s_add_u32 s61, s67, 65536
  v_mfma_f32_16x16x32_bf16 v[152:155], a[168:171], a[152:155], v[152:155]
  ds_read_b64_tr_b16 a[164:165], v6 offset:45056
  v_mfma_f32_16x16x32_bf16 v[152:155], a[172:175], a[136:139], v[152:155]
  buffer_load_dwordx4 v33, s[36:39], s61 offen lds
  v_mfma_f32_16x16x32_bf16 v[148:151], a[172:175], a[132:135], v[148:151]
  ds_read_b64_tr_b16 a[166:167], v6 offset:47104
  v_mfma_f32_16x16x32_bf16 v[148:151], a[168:171], a[148:151], v[148:151]
  v_mfma_f32_16x16x32_bf16 v[144:147], a[168:171], a[144:147], v[144:147]
  ds_read_b64_tr_b16 a[168:169], v3 offset:32768
  v_mfma_f32_16x16x32_bf16 v[144:147], a[172:175], a[128:131], v[144:147]
  s_waitcnt lgkmcnt(5)
  v_mfma_f32_16x16x32_bf16 v[128:131], a[180:183], a[188:191], v[128:131]
  ds_read_b64_tr_b16 a[170:171], v3 offset:34816
  v_mfma_f32_16x16x32_bf16 v[128:131], a[176:179], a[204:207], v[128:131]
  v_mfma_f32_16x16x32_bf16 v[132:135], a[176:179], a[208:211], v[132:135]
  ds_read_b64_tr_b16 a[172:173], v3 offset:36864
  v_mfma_f32_16x16x32_bf16 v[132:135], a[180:183], a[192:195], v[132:135]
  v_mfma_f32_16x16x32_bf16 v[136:139], a[180:183], a[196:199], v[136:139]
  ds_read_b64_tr_b16 a[174:175], v3 offset:38912
  v_mfma_f32_16x16x32_bf16 v[136:139], a[176:179], a[212:215], v[136:139]
  v_mfma_f32_16x16x32_bf16 v[140:143], a[176:179], a[216:219], v[140:143]
  ds_read_b64_tr_b16 a[176:177], v3 offset:40960
  v_mfma_f32_16x16x32_bf16 v[140:143], a[180:183], a[200:203], v[140:143]
  s_waitcnt lgkmcnt(5)
  v_mfma_f32_16x16x32_bf16 v[156:159], a[160:163], a[200:203], v[156:159]
  ds_read_b64_tr_b16 a[178:179], v3 offset:43008
  v_mfma_f32_16x16x32_bf16 v[156:159], a[164:167], a[216:219], v[156:159]
  v_mfma_f32_16x16x32_bf16 v[152:155], a[164:167], a[212:215], v[152:155]
  ds_read_b64_tr_b16 a[180:181], v3 offset:45056
  v_mfma_f32_16x16x32_bf16 v[152:155], a[160:163], a[196:199], v[152:155]
  v_mfma_f32_16x16x32_bf16 v[148:151], a[160:163], a[192:195], v[148:151]
  ds_read_b64_tr_b16 a[182:183], v3 offset:47104
  v_mfma_f32_16x16x32_bf16 v[148:151], a[164:167], a[208:211], v[148:151]
  v_mfma_f32_16x16x32_bf16 v[144:147], a[164:167], a[204:207], v[144:147]
  ds_read_b64_tr_b16 a[164:165], v3 offset:49152
  v_mfma_f32_16x16x32_bf16 v[144:147], a[160:163], a[188:191], v[144:147]
  s_waitcnt lgkmcnt(5)
  v_mfma_f32_16x16x32_bf16 v[160:163], a[168:171], a[64:67], v[160:163]
  ds_read_b64_tr_b16 a[166:167], v3 offset:51200
  v_mfma_f32_16x16x32_bf16 v[160:163], a[172:175], a[80:83], v[160:163]
  v_mfma_f32_16x16x32_bf16 v[164:167], a[172:175], a[84:87], v[164:167]
  ds_read_b64_tr_b16 a[160:161], v3 offset:53248
  v_mul_f32 v24, v16, v128
  v_mfma_f32_16x16x32_bf16 v[164:167], a[168:171], a[68:71], v[164:167]
  v_mul_f32 v25, v16, v129
  v_mul_f32 v26, v16, v130
  v_mul_f32 v27, v16, v131
  v_mfma_f32_16x16x32_bf16 v[168:171], a[168:171], a[72:75], v[168:171]
  ds_read_b64_tr_b16 a[162:163], v3 offset:55296
  v_mul_f32 v28, v18, v132
  v_mfma_f32_16x16x32_bf16 v[168:171], a[172:175], a[88:91], v[168:171]
  v_mul_f32 v29, v18, v133
  v_mul_f32 v30, v18, v134
  v_mfma_f32_16x16x32_bf16 v[172:175], a[172:175], a[92:95], v[172:175]
  ds_read_b64_tr_b16 a[172:173], v3 offset:57344
  v_mul_f32 v31, v18, v135
  v_mfma_f32_16x16x32_bf16 v[172:175], a[168:171], a[76:79], v[172:175]
  s_waitcnt lgkmcnt(5)
  v_exp_f32 v24, v24
  v_mul_f32 v144, v128, v144
  v_mfma_f32_16x16x32_bf16 v[188:191], a[176:179], a[76:79], v[188:191]
  ds_read_b64_tr_b16 a[174:175], v3 offset:59392
  v_mfma_f32_16x16x32_bf16 v[188:191], a[180:183], a[92:95], v[188:191]
  v_exp_f32 v25, v25
  v_mfma_f32_16x16x32_bf16 v[184:187], a[180:183], a[88:91], v[184:187]
  ds_read_b64_tr_b16 a[168:169], v3 offset:61440
  v_mul_f32 v145, v129, v145
  v_mfma_f32_16x16x32_bf16 v[184:187], a[176:179], a[72:75], v[184:187]
  v_exp_f32 v26, v26
  v_mul_f32 v146, v130, v146
  v_mfma_f32_16x16x32_bf16 v[180:183], a[176:179], a[68:71], v[180:183]
  ds_read_b64_tr_b16 a[170:171], v3 offset:63488
  v_mfma_f32_16x16x32_bf16 v[180:183], a[180:183], a[84:87], v[180:183]
  v_exp_f32 v27, v27
  v_mfma_f32_16x16x32_bf16 v[176:179], a[180:183], a[80:83], v[176:179]
  ds_read_b64_tr_b16 a[180:181], v3 offset:16384
  v_mul_f32 v147, v131, v147
  v_mfma_f32_16x16x32_bf16 v[176:179], a[176:179], a[64:67], v[176:179]
  s_waitcnt lgkmcnt(5)
  v_exp_f32 v28, v28
  v_mul_f32 v148, v132, v148
  v_mfma_f32_16x16x32_bf16 v[160:163], a[164:167], a[96:99], v[160:163]
  ds_read_b64_tr_b16 a[182:183], v3 offset:18432
  v_mfma_f32_16x16x32_bf16 v[160:163], a[160:163], a[112:115], v[160:163]
  v_exp_f32 v29, v29
  v_mfma_f32_16x16x32_bf16 v[164:167], a[160:163], a[116:119], v[164:167]
  ds_read_b64_tr_b16 a[176:177], v3 offset:20480
  v_mul_f32 v149, v133, v149
  v_mfma_f32_16x16x32_bf16 v[164:167], a[164:167], a[100:103], v[164:167]
  v_exp_f32 v30, v30
  v_mul_f32 v150, v134, v150
  v_mfma_f32_16x16x32_bf16 v[168:171], a[164:167], a[104:107], v[168:171]
  ds_read_b64_tr_b16 a[178:179], v3 offset:22528
  v_add_u32 v38, s46, v0
  s_waitcnt vmcnt(4)
  s_barrier
  s_mov_b64 exec, 1
  buffer_store_dword v38, v0, s[8:11], s80 offen offset:0 sc1
  s_mov_b64 exec, -1
  v_mfma_f32_16x16x32_bf16 v[168:171], a[160:163], a[120:123], v[168:171]
  v_exp_f32 v31, v31
  v_mfma_f32_16x16x32_bf16 v[172:175], a[160:163], a[124:127], v[172:175]
  ds_read_b64_tr_b16 a[160:161], v3 offset:24576
  v_mul_f32 v151, v135, v151
  v_mfma_f32_16x16x32_bf16 v[172:175], a[164:167], a[108:111], v[172:175]
  s_waitcnt lgkmcnt(5)
  v_fma_f32 v24, v24, v17, v17
  v_fma_f32 v25, v25, v17, v17
  v_mfma_f32_16x16x32_bf16 v[188:191], a[172:175], a[108:111], v[188:191]
  ds_read_b64_tr_b16 a[162:163], v3 offset:26624
  v_mfma_f32_16x16x32_bf16 v[188:191], a[168:171], a[124:127], v[188:191]
  v_rcp_f32 v24, v24
  v_mfma_f32_16x16x32_bf16 v[184:187], a[168:171], a[120:123], v[184:187]
  ds_read_b64_tr_b16 a[164:165], v3 offset:28672
  v_fma_f32 v26, v26, v17, v17
  v_mfma_f32_16x16x32_bf16 v[184:187], a[172:175], a[104:107], v[184:187]
  v_rcp_f32 v25, v25
  v_fma_f32 v27, v27, v17, v17
  v_mfma_f32_16x16x32_bf16 v[180:183], a[172:175], a[100:103], v[180:183]
  ds_read_b64_tr_b16 a[166:167], v3 offset:30720
  v_mfma_f32_16x16x32_bf16 v[180:183], a[168:171], a[116:119], v[180:183]
  v_rcp_f32 v26, v26
  v_mfma_f32_16x16x32_bf16 v[176:179], a[168:171], a[112:115], v[176:179]
  ds_read_b64_tr_b16 a[168:169], v7 offset:32768
  v_fma_f32 v28, v28, v19, v19
  v_mfma_f32_16x16x32_bf16 v[176:179], a[172:175], a[96:99], v[176:179]
  s_waitcnt lgkmcnt(5)
  v_rcp_f32 v27, v27
  v_fma_f32 v29, v29, v19, v19
  v_mfma_f32_16x16x32_bf16 v[160:163], a[180:183], a[128:131], v[160:163]
  ds_read_b64_tr_b16 a[170:171], v7 offset:34816
  v_mfma_f32_16x16x32_bf16 v[160:163], a[176:179], a[144:147], v[160:163]
  v_rcp_f32 v28, v28
  v_mfma_f32_16x16x32_bf16 v[164:167], a[176:179], a[148:151], v[164:167]
  ds_read_b64_tr_b16 a[172:173], v7 offset:36864
  v_fma_f32 v30, v30, v19, v19
  v_mfma_f32_16x16x32_bf16 v[164:167], a[180:183], a[132:135], v[164:167]
  v_rcp_f32 v29, v29
  v_fma_f32 v31, v31, v19, v19
  v_mfma_f32_16x16x32_bf16 v[168:171], a[180:183], a[136:139], v[168:171]
  ds_read_b64_tr_b16 a[174:175], v7 offset:38912
  v_mfma_f32_16x16x32_bf16 v[168:171], a[176:179], a[152:155], v[168:171]
  v_rcp_f32 v30, v30
  v_mfma_f32_16x16x32_bf16 v[172:175], a[176:179], a[156:159], v[172:175]
  ds_read_b64_tr_b16 a[176:177], v7 offset:40960
  v_mul_f32 v144, v144, v24
  v_mfma_f32_16x16x32_bf16 v[172:175], a[180:183], a[140:143], v[172:175]
  s_waitcnt lgkmcnt(5)
  v_rcp_f32 v31, v31
  v_mul_f32 v145, v145, v25
  v_mfma_f32_16x16x32_bf16 v[188:191], a[160:163], a[140:143], v[188:191]
  ds_read_b64_tr_b16 a[178:179], v7 offset:43008
  v_mul_f32 v146, v146, v26
  v_mfma_f32_16x16x32_bf16 v[188:191], a[164:167], a[156:159], v[188:191]
  v_mul_f32 v147, v147, v27
  v_mul_f32 v148, v148, v28
  v_mfma_f32_16x16x32_bf16 v[184:187], a[164:167], a[152:155], v[184:187]
  ds_read_b64_tr_b16 a[180:181], v7 offset:45056
  v_mul_f32 v149, v149, v29
  v_mfma_f32_16x16x32_bf16 v[184:187], a[160:163], a[136:139], v[184:187]
  v_mul_f32 v150, v150, v30
  v_mul_f32 v151, v151, v31
  v_cvt_pk_bf16_f32 v128, v144, v145
  v_mfma_f32_16x16x32_bf16 v[180:183], a[160:163], a[132:135], v[180:183]
  ds_read_b64_tr_b16 a[182:183], v7 offset:47104
  v_cvt_pk_bf16_f32 v129, v146, v147
  v_mfma_f32_16x16x32_bf16 v[180:183], a[164:167], a[148:151], v[180:183]
  v_cvt_pk_bf16_f32 v132, v148, v149
  v_cvt_pk_bf16_f32 v133, v150, v151
  v_mfma_f32_16x16x32_bf16 v[176:179], a[164:167], a[144:147], v[176:179]
  ds_read_b64_tr_b16 a[164:165], v4 offset:32768
  v_mul_f32 v24, v20, v136
  v_mfma_f32_16x16x32_bf16 v[176:179], a[160:163], a[128:131], v[176:179]
  s_waitcnt lgkmcnt(5)
  v_mul_f32 v25, v20, v137
  v_mul_f32 v26, v20, v138
  v_mul_f32 v27, v20, v139
HOP15:
  s_cbranch_execz HOP19
  v_mfma_f32_16x16x32_bf16 v[160:163], a[168:171], a[188:191], v[160:163]
  ds_read_b64_tr_b16 a[166:167], v4 offset:34816
  v_mul_f32 v28, v22, v140
  v_mfma_f32_16x16x32_bf16 v[160:163], a[172:175], a[204:207], v[160:163]
  v_mul_f32 v29, v22, v141
  v_mul_f32 v30, v22, v142
  v_mfma_f32_16x16x32_bf16 v[164:167], a[172:175], a[208:211], v[164:167]
  ds_read_b64_tr_b16 a[160:161], v4 offset:36864
  v_mul_f32 v31, v22, v143
  v_mfma_f32_16x16x32_bf16 v[164:167], a[168:171], a[192:195], v[164:167]
  v_exp_f32 v24, v24
  v_mul_f32 v152, v136, v152
  v_mfma_f32_16x16x32_bf16 v[168:171], a[168:171], a[196:199], v[168:171]
  ds_read_b64_tr_b16 a[162:163], v4 offset:38912
  v_mfma_f32_16x16x32_bf16 v[168:171], a[172:175], a[212:215], v[168:171]
  v_exp_f32 v25, v25
  v_mfma_f32_16x16x32_bf16 v[172:175], a[172:175], a[216:219], v[172:175]
  ds_read_b64_tr_b16 a[172:173], v4 offset:40960
  v_mul_f32 v153, v137, v153
  v_mfma_f32_16x16x32_bf16 v[172:175], a[168:171], a[200:203], v[172:175]
  s_waitcnt lgkmcnt(5)
  v_exp_f32 v26, v26
  v_mul_f32 v154, v138, v154
  v_mfma_f32_16x16x32_bf16 v[188:191], a[176:179], a[200:203], v[188:191]
  ds_read_b64_tr_b16 a[174:175], v4 offset:43008
  v_mfma_f32_16x16x32_bf16 v[188:191], a[180:183], a[216:219], v[188:191]
  v_exp_f32 v27, v27
  v_mfma_f32_16x16x32_bf16 v[184:187], a[180:183], a[212:215], v[184:187]
  ds_read_b64_tr_b16 a[168:169], v4 offset:45056
  v_mul_f32 v155, v139, v155
  v_mfma_f32_16x16x32_bf16 v[184:187], a[176:179], a[196:199], v[184:187]
  v_exp_f32 v28, v28
  v_mul_f32 v156, v140, v156
  v_mfma_f32_16x16x32_bf16 v[180:183], a[176:179], a[192:195], v[180:183]
  ds_read_b64_tr_b16 a[170:171], v4 offset:47104
  v_mfma_f32_16x16x32_bf16 v[180:183], a[180:183], a[208:211], v[180:183]
  v_exp_f32 v29, v29
  v_mfma_f32_16x16x32_bf16 v[176:179], a[180:183], a[204:207], v[176:179]
  ds_read_b64_tr_b16 a[180:181], v4 offset:49152
  v_mul_f32 v157, v141, v157
  v_mfma_f32_16x16x32_bf16 v[176:179], a[176:179], a[188:191], v[176:179]
  s_waitcnt lgkmcnt(5)
  v_exp_f32 v30, v30
  v_mul_f32 v158, v142, v158
  v_mfma_f32_16x16x32_bf16 v[192:195], a[164:167], a[64:67], v[192:195]
  ds_read_b64_tr_b16 a[182:183], v4 offset:51200
  v_mfma_f32_16x16x32_bf16 v[192:195], a[160:163], a[80:83], v[192:195]
  v_exp_f32 v31, v31
  v_mfma_f32_16x16x32_bf16 v[196:199], a[160:163], a[84:87], v[196:199]
  ds_read_b64_tr_b16 a[176:177], v4 offset:53248
  v_mul_f32 v159, v143, v159
  v_mfma_f32_16x16x32_bf16 v[196:199], a[164:167], a[68:71], v[196:199]
  v_fma_f32 v24, v24, v21, v21
  v_fma_f32 v25, v25, v21, v21
  v_mfma_f32_16x16x32_bf16 v[200:203], a[164:167], a[72:75], v[200:203]
  ds_read_b64_tr_b16 a[178:179], v4 offset:55296
  v_mfma_f32_16x16x32_bf16 v[200:203], a[160:163], a[88:91], v[200:203]
  v_rcp_f32 v24, v24
  v_mfma_f32_16x16x32_bf16 v[204:207], a[160:163], a[92:95], v[204:207]
  ds_read_b64_tr_b16 a[160:161], v4 offset:57344
  v_fma_f32 v26, v26, v21, v21
  v_mfma_f32_16x16x32_bf16 v[204:207], a[164:167], a[76:79], v[204:207]
  s_waitcnt lgkmcnt(5)
  v_rcp_f32 v25, v25
  v_fma_f32 v27, v27, v21, v21
  v_mfma_f32_16x16x32_bf16 v[220:223], a[172:175], a[76:79], v[220:223]
  ds_read_b64_tr_b16 a[162:163], v4 offset:59392
  v_mfma_f32_16x16x32_bf16 v[220:223], a[168:171], a[92:95], v[220:223]
  v_rcp_f32 v26, v26
  v_mfma_f32_16x16x32_bf16 v[216:219], a[168:171], a[88:91], v[216:219]
  ds_read_b64_tr_b16 a[164:165], v4 offset:61440
  v_fma_f32 v28, v28, v23, v23
  v_mfma_f32_16x16x32_bf16 v[216:219], a[172:175], a[72:75], v[216:219]
  v_rcp_f32 v27, v27
  v_fma_f32 v29, v29, v23, v23
  v_mfma_f32_16x16x32_bf16 v[212:215], a[172:175], a[68:71], v[212:215]
  ds_read_b64_tr_b16 a[166:167], v4 offset:63488
  v_mfma_f32_16x16x32_bf16 v[212:215], a[168:171], a[84:87], v[212:215]
  v_rcp_f32 v28, v28
  v_mfma_f32_16x16x32_bf16 v[208:211], a[168:171], a[80:83], v[208:211]
  ds_read_b64_tr_b16 a[168:169], v4 offset:16384
  v_fma_f32 v30, v30, v23, v23
  v_mfma_f32_16x16x32_bf16 v[208:211], a[172:175], a[64:67], v[208:211]
  s_waitcnt lgkmcnt(5)
  v_rcp_f32 v29, v29
  v_fma_f32 v31, v31, v23, v23
  v_mfma_f32_16x16x32_bf16 v[192:195], a[180:183], a[96:99], v[192:195]
  ds_read_b64_tr_b16 a[170:171], v4 offset:18432
  v_mfma_f32_16x16x32_bf16 v[192:195], a[176:179], a[112:115], v[192:195]
  v_rcp_f32 v30, v30
  v_mfma_f32_16x16x32_bf16 v[196:199], a[176:179], a[116:119], v[196:199]
  ds_read_b64_tr_b16 a[172:173], v4 offset:20480
  v_mul_f32 v152, v152, v24
  v_mfma_f32_16x16x32_bf16 v[196:199], a[180:183], a[100:103], v[196:199]
  v_rcp_f32 v31, v31
  v_mul_f32 v153, v153, v25
  v_mfma_f32_16x16x32_bf16 v[200:203], a[180:183], a[104:107], v[200:203]
  ds_read_b64_tr_b16 a[174:175], v4 offset:22528
  v_mul_f32 v154, v154, v26
  v_mfma_f32_16x16x32_bf16 v[200:203], a[176:179], a[120:123], v[200:203]
  v_mul_f32 v155, v155, v27
  v_mul_f32 v156, v156, v28
  v_mfma_f32_16x16x32_bf16 v[204:207], a[176:179], a[124:127], v[204:207]
  ds_read_b64_tr_b16 a[176:177], v4 offset:24576
  v_mul_f32 v157, v157, v29
  v_mfma_f32_16x16x32_bf16 v[204:207], a[180:183], a[108:111], v[204:207]
  s_waitcnt lgkmcnt(5)
  v_mul_f32 v158, v158, v30
  v_mul_f32 v159, v159, v31
  v_cvt_pk_bf16_f32 v136, v152, v153
  v_mfma_f32_16x16x32_bf16 v[220:223], a[160:163], a[108:111], v[220:223]
  ds_read_b64_tr_b16 a[178:179], v4 offset:26624
  v_cvt_pk_bf16_f32 v137, v154, v155
  v_mfma_f32_16x16x32_bf16 v[220:223], a[164:167], a[124:127], v[220:223]
  v_cvt_pk_bf16_f32 v140, v156, v157
  v_cvt_pk_bf16_f32 v141, v158, v159
  v_mfma_f32_16x16x32_bf16 v[216:219], a[164:167], a[120:123], v[216:219]
  ds_read_b64_tr_b16 a[180:181], v4 offset:28672
  v_mfma_f32_16x16x32_bf16 v[216:219], a[160:163], a[104:107], v[216:219]
  v_mfma_f32_16x16x32_bf16 v[212:215], a[160:163], a[100:103], v[212:215]
  ds_read_b64_tr_b16 a[182:183], v4 offset:30720
  s_lshl_b32 s83, s44, 28
  s_add_u32 s83, s83, s82
  buffer_load_dword v36, v37, s[8:11], s83 offen sc1
  v_mfma_f32_16x16x32_bf16 v[212:215], a[164:167], a[116:119], v[212:215]
  v_mul_f32 v24, v16, v160
  v_mul_f32 v25, v16, v161
  v_mfma_f32_16x16x32_bf16 v[208:211], a[164:167], a[112:115], v[208:211]
  ds_read_b64_tr_b16 a[164:165], v8 offset:32768
  v_mul_f32 v26, v16, v162
  v_mul_f32 v27, v16, v163
  v_mfma_f32_16x16x32_bf16 v[208:211], a[160:163], a[96:99], v[208:211]
  s_waitcnt lgkmcnt(5)
  v_mul_f32 v28, v18, v164
  v_mul_f32 v29, v18, v165
  v_mul_f32 v30, v18, v166
  v_mfma_f32_16x16x32_bf16 v[192:195], a[168:171], a[128:131], v[192:195]
  ds_read_b64_tr_b16 a[166:167], v8 offset:34816
  v_mul_f32 v31, v18, v167
  v_mfma_f32_16x16x32_bf16 v[192:195], a[172:175], a[144:147], v[192:195]
  v_exp_f32 v24, v24
  v_mul_f32 v176, v160, v176
  v_mfma_f32_16x16x32_bf16 v[196:199], a[172:175], a[148:151], v[196:199]
  ds_read_b64_tr_b16 a[160:161], v8 offset:36864
  v_mfma_f32_16x16x32_bf16 v[196:199], a[168:171], a[132:135], v[196:199]
  v_exp_f32 v25, v25
  v_mul_f32 v177, v161, v177
  v_mfma_f32_16x16x32_bf16 v[200:203], a[168:171], a[136:139], v[200:203]
  ds_read_b64_tr_b16 a[162:163], v8 offset:38912
  v_exp_f32 v26, v26
  v_mfma_f32_16x16x32_bf16 v[200:203], a[172:175], a[152:155], v[200:203]
  v_mul_f32 v178, v162, v178
  v_mfma_f32_16x16x32_bf16 v[204:207], a[172:175], a[156:159], v[204:207]
  ds_read_b64_tr_b16 a[172:173], v8 offset:40960
  v_exp_f32 v27, v27
  v_mfma_f32_16x16x32_bf16 v[204:207], a[168:171], a[140:143], v[204:207]
  s_waitcnt lgkmcnt(5)
  v_mul_f32 v179, v163, v179
  v_exp_f32 v28, v28
  v_mfma_f32_16x16x32_bf16 v[220:223], a[176:179], a[140:143], v[220:223]
  ds_read_b64_tr_b16 a[174:175], v8 offset:43008
  v_mul_f32 v180, v164, v180
  v_mfma_f32_16x16x32_bf16 v[220:223], a[180:183], a[156:159], v[220:223]
  v_exp_f32 v29, v29
  v_mul_f32 v181, v165, v181
  v_mfma_f32_16x16x32_bf16 v[216:219], a[180:183], a[152:155], v[216:219]
  ds_read_b64_tr_b16 a[168:169], v8 offset:45056
  v_mfma_f32_16x16x32_bf16 v[216:219], a[176:179], a[136:139], v[216:219]
  v_exp_f32 v30, v30
  v_mul_f32 v182, v166, v182
  v_mfma_f32_16x16x32_bf16 v[212:215], a[176:179], a[132:135], v[212:215]
  ds_read_b64_tr_b16 a[170:171], v8 offset:47104
  v_exp_f32 v31, v31
  v_mfma_f32_16x16x32_bf16 v[212:215], a[180:183], a[148:151], v[212:215]
  v_mul_f32 v183, v167, v183
  v_fma_f32 v24, v24, v17, v17
  v_mfma_f32_16x16x32_bf16 v[208:211], a[180:183], a[144:147], v[208:211]
  ds_read_b64_tr_b16 a[180:181], v5 offset:32768
  v_fma_f32 v25, v25, v17, v17
  v_mfma_f32_16x16x32_bf16 v[208:211], a[176:179], a[128:131], v[208:211]
  s_waitcnt lgkmcnt(5)
  v_rcp_f32 v24, v24
  v_fma_f32 v26, v26, v17, v17
  v_mfma_f32_16x16x32_bf16 v[192:195], a[164:167], a[188:191], v[192:195]
  ds_read_b64_tr_b16 a[182:183], v5 offset:34816
  v_mfma_f32_16x16x32_bf16 v[192:195], a[160:163], a[204:207], v[192:195]
  v_rcp_f32 v25, v25
  v_fma_f32 v27, v27, v17, v17
  v_mfma_f32_16x16x32_bf16 v[196:199], a[160:163], a[208:211], v[196:199]
  ds_read_b64_tr_b16 a[176:177], v5 offset:36864
  v_mfma_f32_16x16x32_bf16 v[196:199], a[164:167], a[192:195], v[196:199]
  v_rcp_f32 v26, v26
  v_fma_f32 v28, v28, v19, v19
  v_mfma_f32_16x16x32_bf16 v[200:203], a[164:167], a[196:199], v[200:203]
  ds_read_b64_tr_b16 a[178:179], v5 offset:38912
  v_rcp_f32 v27, v27
  v_mfma_f32_16x16x32_bf16 v[200:203], a[160:163], a[212:215], v[200:203]
  v_fma_f32 v29, v29, v19, v19
  v_mfma_f32_16x16x32_bf16 v[204:207], a[160:163], a[216:219], v[204:207]
  ds_read_b64_tr_b16 a[160:161], v5 offset:40960
  v_rcp_f32 v28, v28
  v_mfma_f32_16x16x32_bf16 v[204:207], a[164:167], a[200:203], v[204:207]
  s_waitcnt lgkmcnt(5)
  v_fma_f32 v30, v30, v19, v19
  v_rcp_f32 v29, v29
  v_mfma_f32_16x16x32_bf16 v[220:223], a[172:175], a[200:203], v[220:223]
  ds_read_b64_tr_b16 a[162:163], v5 offset:43008
  v_fma_f32 v31, v31, v19, v19
  v_mfma_f32_16x16x32_bf16 v[220:223], a[168:171], a[216:219], v[220:223]
  v_rcp_f32 v30, v30
  v_mul_f32 v176, v176, v24
  v_mfma_f32_16x16x32_bf16 v[216:219], a[168:171], a[212:215], v[216:219]
  ds_read_b64_tr_b16 a[164:165], v5 offset:45056
  v_mfma_f32_16x16x32_bf16 v[216:219], a[172:175], a[196:199], v[216:219]
  v_rcp_f32 v31, v31
  v_mul_f32 v177, v177, v25
  v_mfma_f32_16x16x32_bf16 v[212:215], a[172:175], a[192:195], v[212:215]
  ds_read_b64_tr_b16 a[166:167], v5 offset:47104
  v_mul_f32 v178, v178, v26
  v_mul_f32 v179, v179, v27
  v_mfma_f32_16x16x32_bf16 v[212:215], a[168:171], a[208:211], v[212:215]
  v_mul_f32 v180, v180, v28
  v_mul_f32 v181, v181, v29
  v_mfma_f32_16x16x32_bf16 v[208:211], a[168:171], a[204:207], v[208:211]
  ds_read_b64_tr_b16 a[168:169], v5 offset:49152
  v_mul_f32 v182, v182, v30
  v_mul_f32 v183, v183, v31
  v_mfma_f32_16x16x32_bf16 v[208:211], a[172:175], a[188:191], v[208:211]
  s_waitcnt lgkmcnt(5)
  v_cvt_pk_bf16_f32 v130, v176, v177
  v_cvt_pk_bf16_f32 v131, v178, v179
  v_mfma_f32_16x16x32_bf16 v[224:227], a[180:183], a[64:67], v[224:227]
  ds_read_b64_tr_b16 a[170:171], v5 offset:51200
  v_mfma_f32_16x16x32_bf16 v[224:227], a[176:179], a[80:83], v[224:227]
  buffer_store_dwordx4 v[128:131], v1, s[8:11], s58 offen offset:0 sc1
  v_mfma_f32_16x16x32_bf16 v[228:231], a[176:179], a[84:87], v[228:231]
  ds_read_b64_tr_b16 a[172:173], v5 offset:53248
  v_cvt_pk_bf16_f32 v134, v180, v181
  v_mfma_f32_16x16x32_bf16 v[228:231], a[180:183], a[68:71], v[228:231]
  v_cvt_pk_bf16_f32 v135, v182, v183
  v_mfma_f32_16x16x32_bf16 v[232:235], a[180:183], a[72:75], v[232:235]
  ds_read_b64_tr_b16 a[174:175], v5 offset:55296
  s_waitcnt vmcnt(1)
  s_cmp_lg_u32 s44, 0
  s_cbranch_scc1 PL12_adaLN_cond__sliding_local_dilated__swiglu_ffn__prompt_kernelx
  v_cmp_ne_u32 vcc, s46, v36
  s_nop 4
  s_cbranch_vccz PL12_adaLN_cond__sliding_local_dilated__swiglu_ffn__prompt_kernelx
  s_mov_b32 s83, 60000
PL12_adaLN_cond__sliding_local_dilated__swiglu_ffn__prompt_kernel:
  buffer_load_dword v36, v37, s[8:11], s82 offen sc1
  s_sub_u32 s83, s83, 1
  s_cmp_eq_u32 s83, 0
  s_waitcnt vmcnt(0)
  s_cbranch_scc1 PL12_adaLN_cond__sliding_local_dilated__swiglu_ffn__prompt_kernelx
  v_cmp_ne_u32 vcc, s46, v36
  s_nop 4
  s_cbranch_vccnz PL12_adaLN_cond__sliding_local_dilated__swiglu_ffn__prompt_kernel
PL12_adaLN_cond__sliding_local_dilated__swiglu_ffn__prompt_kernelx:
  s_barrier
  v_mfma_f32_16x16x32_bf16 v[232:235], a[176:179], a[88:91], v[232:235]
  s_add_u32 s55, s58, 262144
  buffer_store_dwordx4 v[132:135], v1, s[8:11], s55 offen offset:0 sc1
  v_mfma_f32_16x16x32_bf16 v[236:239], a[176:179], a[92:95], v[236:239]
  ds_read_b64_tr_b16 a[176:177], v5 offset:57344
  v_mul_f32 v24, v20, v168
  v_mul_f32 v25, v20, v169
  v_mfma_f32_16x16x32_bf16 v[236:239], a[180:183], a[76:79], v[236:239]
  s_waitcnt lgkmcnt(5)
  buffer_load_dwordx4 a[220:223], v1, s[8:11], s72 offen offset:0 sc1
  v_mul_f32 v26, v20, v170
  v_mul_f32 v27, v20, v171
  v_mfma_f32_16x16x32_bf16 v[252:255], a[160:163], a[76:79], v[252:255]
  ds_read_b64_tr_b16 a[178:179], v5 offset:59392
  v_mul_f32 v28, v22, v172
  v_mfma_f32_16x16x32_bf16 v[252:255], a[164:167], a[92:95], v[252:255]
  v_mul_f32 v29, v22, v173
  v_mul_f32 v30, v22, v174
  v_mul_f32 v31, v22, v175
  v_mfma_f32_16x16x32_bf16 v[248:251], a[164:167], a[88:91], v[248:251]
  ds_read_b64_tr_b16 a[180:181], v5 offset:61440
  v_mfma_f32_16x16x32_bf16 v[248:251], a[160:163], a[72:75], v[248:251]
  buffer_load_dwordx4 a[236:239], v1, s[8:11], s72 offen offset:1024 sc1
  v_exp_f32 v24, v24
  v_mul_f32 v184, v168, v184
  v_mfma_f32_16x16x32_bf16 v[244:247], a[160:163], a[68:71], v[244:247]
  ds_read_b64_tr_b16 a[182:183], v5 offset:63488
  v_exp_f32 v25, v25
  v_mfma_f32_16x16x32_bf16 v[244:247], a[164:167], a[84:87], v[244:247]
  s_add_u32 s72, s72, 131072
  v_mul_f32 v185, v169, v185
  v_mfma_f32_16x16x32_bf16 v[240:243], a[164:167], a[80:83], v[240:243]
  ds_read_b64_tr_b16 a[164:165], v5 offset:16384
  v_exp_f32 v26, v26
  v_mfma_f32_16x16x32_bf16 v[240:243], a[160:163], a[64:67], v[240:243]
  s_waitcnt lgkmcnt(5)
  buffer_load_dwordx4 a[224:227], v1, s[8:11], s72 offen offset:0 sc1
  v_mul_f32 v186, v170, v186
  v_mfma_f32_16x16x32_bf16 v[224:227], a[168:171], a[96:99], v[224:227]
  ds_read_b64_tr_b16 a[166:167], v5 offset:18432
  v_mfma_f32_16x16x32_bf16 v[224:227], a[172:175], a[112:115], v[224:227]
  v_exp_f32 v27, v27
  v_mul_f32 v187, v171, v187
  v_mfma_f32_16x16x32_bf16 v[228:231], a[172:175], a[116:119], v[228:231]
  ds_read_b64_tr_b16 a[160:161], v5 offset:20480
  v_mfma_f32_16x16x32_bf16 v[228:231], a[168:171], a[100:103], v[228:231]
  buffer_load_dwordx4 a[240:243], v1, s[8:11], s72 offen offset:1024 sc1
  v_exp_f32 v28, v28
  v_mul_f32 v188, v172, v188
  v_mfma_f32_16x16x32_bf16 v[232:235], a[168:171], a[104:107], v[232:235]
  ds_read_b64_tr_b16 a[162:163], v5 offset:22528
  v_exp_f32 v29, v29
  v_mfma_f32_16x16x32_bf16 v[232:235], a[172:175], a[120:123], v[232:235]
  s_add_u32 s72, s72, s89
  v_mul_f32 v189, v173, v189
  v_mfma_f32_16x16x32_bf16 v[236:239], a[172:175], a[124:127], v[236:239]
  ds_read_b64_tr_b16 a[172:173], v5 offset:24576
  v_exp_f32 v30, v30
  v_mfma_f32_16x16x32_bf16 v[236:239], a[168:171], a[108:111], v[236:239]
  s_waitcnt lgkmcnt(5)
  buffer_load_dwordx4 a[228:231], v1, s[8:11], s72 offen offset:0 sc1
  v_mul_f32 v190, v174, v190
  v_mfma_f32_16x16x32_bf16 v[252:255], a[176:179], a[108:111], v[252:255]
  ds_read_b64_tr_b16 a[174:175], v5 offset:26624
  v_mfma_f32_16x16x32_bf16 v[252:255], a[180:183], a[124:127], v[252:255]
  v_exp_f32 v31, v31
  v_mul_f32 v191, v175, v191
  v_mfma_f32_16x16x32_bf16 v[248:251], a[180:183], a[120:123], v[248:251]
  ds_read_b64_tr_b16 a[168:169], v5 offset:28672
  v_fma_f32 v24, v24, v21, v21
  v_mfma_f32_16x16x32_bf16 v[248:251], a[176:179], a[104:107], v[248:251]
  buffer_load_dwordx4 a[244:247], v1, s[8:11], s72 offen offset:1024 sc1
  v_fma_f32 v25, v25, v21, v21
  v_rcp_f32 v24, v24
  v_mfma_f32_16x16x32_bf16 v[244:247], a[176:179], a[100:103], v[244:247]
  ds_read_b64_tr_b16 a[170:171], v5 offset:30720
  v_fma_f32 v26, v26, v21, v21
  v_mfma_f32_16x16x32_bf16 v[244:247], a[180:183], a[116:119], v[244:247]
  s_add_u32 s72, s72, 131072
  v_rcp_f32 v25, v25
  v_mfma_f32_16x16x32_bf16 v[240:243], a[180:183], a[112:115], v[240:243]
  ds_read_b64_tr_b16 a[180:181], v9 offset:32768
  v_fma_f32 v27, v27, v21, v21
  v_mfma_f32_16x16x32_bf16 v[240:243], a[176:179], a[96:99], v[240:243]
  s_waitcnt lgkmcnt(5)
  buffer_load_dwordx4 a[232:235], v1, s[8:11], s72 offen offset:0 sc1
  v_rcp_f32 v26, v26
  v_mfma_f32_16x16x32_bf16 v[224:227], a[164:167], a[128:131], v[224:227]
  ds_read_b64_tr_b16 a[182:183], v9 offset:34816
  v_fma_f32 v28, v28, v23, v23
  v_mfma_f32_16x16x32_bf16 v[224:227], a[160:163], a[144:147], v[224:227]
  v_rcp_f32 v27, v27
  v_fma_f32 v29, v29, v23, v23
  v_mfma_f32_16x16x32_bf16 v[228:231], a[160:163], a[148:151], v[228:231]
  ds_read_b64_tr_b16 a[176:177], v9 offset:36864
  v_mfma_f32_16x16x32_bf16 v[228:231], a[164:167], a[132:135], v[228:231]
  buffer_load_dwordx4 a[248:251], v1, s[8:11], s72 offen offset:1024 sc1
  v_rcp_f32 v28, v28
  v_fma_f32 v30, v30, v23, v23
  v_mfma_f32_16x16x32_bf16 v[232:235], a[164:167], a[136:139], v[232:235]
  ds_read_b64_tr_b16 a[178:179], v9 offset:38912
  v_rcp_f32 v29, v29
  v_mfma_f32_16x16x32_bf16 v[232:235], a[160:163], a[152:155], v[232:235]
  v_fma_f32 v31, v31, v23, v23
  v_mfma_f32_16x16x32_bf16 v[236:239], a[160:163], a[156:159], v[236:239]
  ds_read_b64_tr_b16 a[160:161], v9 offset:40960
  v_rcp_f32 v30, v30
  v_mfma_f32_16x16x32_bf16 v[236:239], a[164:167], a[140:143], v[236:239]
  s_waitcnt lgkmcnt(5)
  buffer_load_dwordx4 a[0:3], v1, s[8:11], s73 offen offset:0 sc1
  v_mul_f32 v184, v184, v24
  v_mfma_f32_16x16x32_bf16 v[252:255], a[172:175], a[140:143], v[252:255]
  ds_read_b64_tr_b16 a[162:163], v9 offset:43008
  v_mfma_f32_16x16x32_bf16 v[252:255], a[168:171], a[156:159], v[252:255]
  v_rcp_f32 v31, v31
  v_mul_f32 v185, v185, v25
  v_mfma_f32_16x16x32_bf16 v[248:251], a[168:171], a[152:155], v[248:251]
  ds_read_b64_tr_b16 a[164:165], v9 offset:45056
  v_mul_f32 v186, v186, v26
  v_mfma_f32_16x16x32_bf16 v[248:251], a[172:175], a[136:139], v[248:251]
  buffer_load_dwordx4 a[16:19], v1, s[8:11], s73 offen offset:1024 sc1
  v_mul_f32 v187, v187, v27
  v_mul_f32 v188, v188, v28
  v_mul_f32 v189, v189, v29
  v_mfma_f32_16x16x32_bf16 v[244:247], a[172:175], a[132:135], v[244:247]
  ds_read_b64_tr_b16 a[166:167], v9 offset:47104
  v_mul_f32 v190, v190, v30
  v_mul_f32 v191, v191, v31
  v_mfma_f32_16x16x32_bf16 v[244:247], a[168:171], a[148:151], v[244:247]
  s_waitcnt vmcnt(32)
  s_barrier
  v_mfma_f32_16x16x32_bf16 v[240:243], a[168:171], a[144:147], v[240:243]
  ds_read_b64_tr_b16 a[168:169], v6 offset:49152
  s_add_u32 s73, s73, 131072
  v_cvt_pk_bf16_f32 v138, v184, v185
  v_mfma_f32_16x16x32_bf16 v[240:243], a[172:175], a[128:131], v[240:243]
  s_waitcnt lgkmcnt(5)
  buffer_load_dwordx4 a[4:7], v1, s[8:11], s73 offen offset:0 sc1
  v_cvt_pk_bf16_f32 v139, v186, v187
  v_mfma_f32_16x16x32_bf16 v[224:227], a[180:183], a[188:191], v[224:227]
  ds_read_b64_tr_b16 a[170:171], v6 offset:51200
  v_mfma_f32_16x16x32_bf16 v[224:227], a[176:179], a[204:207], v[224:227]
  s_add_u32 s55, s58, 524288
  buffer_store_dwordx4 v[136:139], v1, s[8:11], s55 offen offset:0 sc1
  v_mfma_f32_16x16x32_bf16 v[228:231], a[176:179], a[208:211], v[228:231]
  ds_read_b64_tr_b16 a[172:173], v6 offset:53248
  v_cvt_pk_bf16_f32 v142, v188, v189
  v_mfma_f32_16x16x32_bf16 v[228:231], a[180:183], a[192:195], v[228:231]
  buffer_load_dwordx4 a[20:23], v1, s[8:11], s73 offen offset:1024 sc1
  v_cvt_pk_bf16_f32 v143, v190, v191
  v_mfma_f32_16x16x32_bf16 v[232:235], a[180:183], a[196:199], v[232:235]
  ds_read_b64_tr_b16 a[174:175], v6 offset:55296
  v_mfma_f32_16x16x32_bf16 v[232:235], a[176:179], a[212:215], v[232:235]
  s_add_u32 s73, s73, s89
  s_add_u32 s55, s58, 786432
  buffer_store_dwordx4 v[140:143], v1, s[8:11], s55 offen offset:0 sc1
  v_mfma_f32_16x16x32_bf16 v[236:239], a[176:179], a[216:219], v[236:239]
  ds_read_b64_tr_b16 a[176:177], v7 offset:49152
  v_mul_f32 v24, v16, v192
  v_mul_f32 v25, v16, v193
  v_mfma_f32_16x16x32_bf16 v[236:239], a[180:183], a[200:203], v[236:239]
  s_waitcnt lgkmcnt(5)
  buffer_load_dwordx4 a[8:11], v1, s[8:11], s73 offen offset:0 sc1
  v_mul_f32 v26, v16, v194
  v_mul_f32 v27, v16, v195
  v_mfma_f32_16x16x32_bf16 v[252:255], a[160:163], a[200:203], v[252:255]
  ds_read_b64_tr_b16 a[178:179], v7 offset:51200
  v_mul_f32 v28, v18, v196
  v_mfma_f32_16x16x32_bf16 v[252:255], a[164:167], a[216:219], v[252:255]
  v_mul_f32 v29, v18, v197
  s_waitcnt vmcnt(31)
  s_barrier
  v_mfma_f32_16x16x32_bf16 v[248:251], a[164:167], a[212:215], v[248:251]
  ds_read_b64_tr_b16 a[180:181], v7 offset:53248
  v_mul_f32 v30, v18, v198
  v_mfma_f32_16x16x32_bf16 v[248:251], a[160:163], a[196:199], v[248:251]
  buffer_load_dwordx4 a[24:27], v1, s[8:11], s73 offen offset:1024 sc1
  v_mul_f32 v31, v18, v199
  v_exp_f32 v24, v24
  v_mfma_f32_16x16x32_bf16 v[244:247], a[160:163], a[192:195], v[244:247]
  ds_read_b64_tr_b16 a[182:183], v7 offset:55296
  v_mul_f32 v208, v192, v208
  v_mfma_f32_16x16x32_bf16 v[244:247], a[164:167], a[208:211], v[244:247]
  s_add_u32 s73, s73, 131072
  v_exp_f32 v25, v25
  v_mfma_f32_16x16x32_bf16 v[240:243], a[164:167], a[204:207], v[240:243]
  ds_read_b64_tr_b16 a[164:165], v8 offset:49152
  v_mul_f32 v209, v193, v209
  v_mfma_f32_16x16x32_bf16 v[240:243], a[160:163], a[188:191], v[240:243]
  s_waitcnt vmcnt(8) lgkmcnt(5)
  buffer_load_dwordx4 a[12:15], v1, s[8:11], s73 offen offset:0 sc1
  v_exp_f32 v26, v26
  v_mfma_f32_16x16x32_bf16 v[64:67], a[168:171], a[220:223], 0
  ds_read_b64_tr_b16 a[166:167], v8 offset:51200
  v_mul_f32 v210, v194, v210
  v_mfma_f32_16x16x32_bf16 v[64:67], a[172:175], a[236:239], v[64:67]
  v_exp_f32 v27, v27
  v_mul_f32 v211, v195, v211
  v_mfma_f32_16x16x32_bf16 v[68:71], a[172:175], a[240:243], 0
  ds_read_b64_tr_b16 a[160:161], v8 offset:53248
  v_mfma_f32_16x16x32_bf16 v[68:71], a[168:171], a[224:227], v[68:71]
  buffer_load_dwordx4 a[28:31], v1, s[8:11], s73 offen offset:1024 sc1
  v_exp_f32 v28, v28
  v_mul_f32 v212, v196, v212
  v_mfma_f32_16x16x32_bf16 v[72:75], a[168:171], a[228:231], 0
  ds_read_b64_tr_b16 a[162:163], v8 offset:55296
  v_exp_f32 v29, v29
  v_mfma_f32_16x16x32_bf16 v[72:75], a[172:175], a[244:247], v[72:75]
  v_mul_f32 v213, v197, v213
  v_mfma_f32_16x16x32_bf16 v[76:79], a[172:175], a[248:251], 0
  ds_read_b64_tr_b16 a[172:173], v9 offset:49152
  v_exp_f32 v30, v30
  v_mfma_f32_16x16x32_bf16 v[76:79], a[168:171], a[232:235], v[76:79]
  s_waitcnt lgkmcnt(5)
  buffer_load_dwordx4 a[32:35], v1, s[8:11], s74 offen offset:0 sc1
  v_mul_f32 v214, v198, v214
  v_mfma_f32_16x16x32_bf16 v[92:95], a[176:179], a[232:235], 0
  ds_read_b64_tr_b16 a[174:175], v9 offset:51200
  v_mfma_f32_16x16x32_bf16 v[92:95], a[180:183], a[248:251], v[92:95]
  v_exp_f32 v31, v31
  v_mul_f32 v215, v199, v215
  v_mfma_f32_16x16x32_bf16 v[88:91], a[180:183], a[244:247], 0
  ds_read_b64_tr_b16 a[168:169], v9 offset:53248
  v_fma_f32 v24, v24, v17, v17
  v_mfma_f32_16x16x32_bf16 v[88:91], a[176:179], a[228:231], v[88:91]
  buffer_load_dwordx4 a[48:51], v1, s[8:11], s74 offen offset:1024 sc1
  v_fma_f32 v25, v25, v17, v17
  v_rcp_f32 v24, v24
  v_mfma_f32_16x16x32_bf16 v[84:87], a[176:179], a[224:227], 0
  ds_read_b64_tr_b16 a[170:171], v9 offset:55296
  v_fma_f32 v26, v26, v17, v17
  v_mfma_f32_16x16x32_bf16 v[84:87], a[180:183], a[240:243], v[84:87]
  v_rcp_f32 v25, v25
  v_mfma_f32_16x16x32_bf16 v[80:83], a[180:183], a[236:239], 0
  ds_read_b64_tr_b16 a[180:181], v6 offset:57344
  v_fma_f32 v27, v27, v17, v17
  v_mfma_f32_16x16x32_bf16 v[80:83], a[176:179], a[220:223], v[80:83]
  s_waitcnt lgkmcnt(5)
  s_add_u32 s74, s74, 131072
  v_rcp_f32 v26, v26
  v_mfma_f32_16x16x32_bf16 v[96:99], a[164:167], a[220:223], 0
  ds_read_b64_tr_b16 a[182:183], v6 offset:59392
  v_fma_f32 v28, v28, v19, v19
  v_mfma_f32_16x16x32_bf16 v[96:99], a[160:163], a[236:239], v[96:99]
  buffer_load_dwordx4 a[36:39], v1, s[8:11], s74 offen offset:0 sc1
  v_rcp_f32 v27, v27
  v_fma_f32 v29, v29, v19, v19
  v_mfma_f32_16x16x32_bf16 v[100:103], a[160:163], a[240:243], 0
  ds_read_b64_tr_b16 a[176:177], v6 offset:61440
  v_mfma_f32_16x16x32_bf16 v[100:103], a[164:167], a[224:227], v[100:103]
  v_rcp_f32 v28, v28
  v_fma_f32 v30, v30, v19, v19
  v_mfma_f32_16x16x32_bf16 v[104:107], a[164:167], a[228:231], 0
  ds_read_b64_tr_b16 a[178:179], v6 offset:63488
  v_rcp_f32 v29, v29
  v_mfma_f32_16x16x32_bf16 v[104:107], a[160:163], a[244:247], v[104:107]
  buffer_load_dwordx4 a[52:55], v1, s[8:11], s74 offen offset:1024 sc1
  v_fma_f32 v31, v31, v19, v19
  v_mfma_f32_16x16x32_bf16 v[108:111], a[160:163], a[248:251], 0
  ds_read_b64_tr_b16 a[160:161], v7 offset:57344
  v_rcp_f32 v30, v30
  v_mfma_f32_16x16x32_bf16 v[108:111], a[164:167], a[232:235], v[108:111]
  s_waitcnt lgkmcnt(5)
  s_add_u32 s74, s74, s89
  v_mul_f32 v208, v208, v24
  v_mfma_f32_16x16x32_bf16 v[124:127], a[172:175], a[232:235], 0
  ds_read_b64_tr_b16 a[162:163], v7 offset:59392
  v_mfma_f32_16x16x32_bf16 v[124:127], a[168:171], a[248:251], v[124:127]
  buffer_load_dwordx4 a[40:43], v1, s[8:11], s74 offen offset:0 sc1
  v_rcp_f32 v31, v31
  v_mul_f32 v209, v209, v25
  v_mfma_f32_16x16x32_bf16 v[120:123], a[168:171], a[244:247], 0
  ds_read_b64_tr_b16 a[164:165], v7 offset:61440
  v_mul_f32 v210, v210, v26
  v_mfma_f32_16x16x32_bf16 v[120:123], a[172:175], a[228:231], v[120:123]
  v_mul_f32 v211, v211, v27
  v_mul_f32 v212, v212, v28
  v_mul_f32 v213, v213, v29
  v_mfma_f32_16x16x32_bf16 v[116:119], a[172:175], a[224:227], 0
  ds_read_b64_tr_b16 a[166:167], v7 offset:63488
  v_mul_f32 v214, v214, v30
  v_mul_f32 v215, v215, v31
  v_mfma_f32_16x16x32_bf16 v[116:119], a[168:171], a[240:243], v[116:119]
  buffer_load_dwordx4 a[56:59], v1, s[8:11], s74 offen offset:1024 sc1
  v_cvt_pk_bf16_f32 v192, v208, v209
  v_cvt_pk_bf16_f32 v193, v210, v211
  v_mfma_f32_16x16x32_bf16 v[112:115], a[168:171], a[236:239], 0
  ds_read_b64_tr_b16 a[168:169], v8 offset:57344
  v_cvt_pk_bf16_f32 v196, v212, v213
  v_cvt_pk_bf16_f32 v197, v214, v215
  v_mfma_f32_16x16x32_bf16 v[112:115], a[172:175], a[220:223], v[112:115]
  s_waitcnt lgkmcnt(5)
  v_mul_f32 v24, v20, v200
  v_mul_f32 v25, v20, v201
  v_mul_f32 v26, v20, v202
  v_mfma_f32_16x16x32_bf16 v[128:131], a[180:183], a[220:223], 0
  ds_read_b64_tr_b16 a[170:171], v8 offset:59392
  v_mul_f32 v27, v20, v203
  v_mfma_f32_16x16x32_bf16 v[128:131], a[176:179], a[236:239], v[128:131]
  s_add_u32 s74, s74, 131072
  v_mul_f32 v28, v22, v204
  v_mul_f32 v29, v22, v205
  v_mul_f32 v30, v22, v206
  v_mfma_f32_16x16x32_bf16 v[132:135], a[176:179], a[240:243], 0
  ds_read_b64_tr_b16 a[172:173], v8 offset:61440
  v_mul_f32 v31, v22, v207
  v_mfma_f32_16x16x32_bf16 v[132:135], a[180:183], a[224:227], v[132:135]
  buffer_load_dwordx4 a[44:47], v1, s[8:11], s74 offen offset:0 sc1
  v_exp_f32 v24, v24
  v_mul_f32 v216, v200, v216
  v_mfma_f32_16x16x32_bf16 v[136:139], a[180:183], a[228:231], 0
  ds_read_b64_tr_b16 a[174:175], v8 offset:63488
  v_exp_f32 v25, v25
  v_mfma_f32_16x16x32_bf16 v[136:139], a[176:179], a[244:247], v[136:139]
  v_mul_f32 v217, v201, v217
  v_mfma_f32_16x16x32_bf16 v[140:143], a[176:179], a[248:251], 0
  ds_read_b64_tr_b16 a[176:177], v9 offset:57344
  v_exp_f32 v26, v26
  v_mfma_f32_16x16x32_bf16 v[140:143], a[180:183], a[232:235], v[140:143]
  s_waitcnt lgkmcnt(5)
  buffer_load_dwordx4 a[60:63], v1, s[8:11], s74 offen offset:1024 sc1
  v_mul_f32 v218, v202, v218
  v_mfma_f32_16x16x32_bf16 v[156:159], a[160:163], a[232:235], 0
  ds_read_b64_tr_b16 a[178:179], v9 offset:59392
  v_mfma_f32_16x16x32_bf16 v[156:159], a[164:167], a[248:251], v[156:159]
  v_exp_f32 v27, v27
  v_mul_f32 v219, v203, v219
  v_mfma_f32_16x16x32_bf16 v[152:155], a[164:167], a[244:247], 0
  ds_read_b64_tr_b16 a[180:181], v9 offset:61440
  v_mfma_f32_16x16x32_bf16 v[152:155], a[160:163], a[228:231], v[152:155]
  buffer_load_dwordx4 a[64:67], v1, s[8:11], s75 offen offset:0 sc1
  v_exp_f32 v28, v28
  v_mul_f32 v220, v204, v220
  v_mfma_f32_16x16x32_bf16 v[148:151], a[160:163], a[224:227], 0
  ds_read_b64_tr_b16 a[182:183], v9 offset:63488
  v_exp_f32 v29, v29
  v_mfma_f32_16x16x32_bf16 v[148:151], a[164:167], a[240:243], v[148:151]
  v_mul_f32 v221, v205, v221
  v_mfma_f32_16x16x32_bf16 v[144:147], a[164:167], a[236:239], 0
  ds_read_b64_tr_b16 a[164:165], v6 offset:16384
  v_exp_f32 v30, v30
  v_mfma_f32_16x16x32_bf16 v[144:147], a[160:163], a[220:223], v[144:147]
  s_waitcnt lgkmcnt(5)
  buffer_load_dwordx4 a[80:83], v1, s[8:11], s75 offen offset:1024 sc1
  v_mul_f32 v222, v206, v222
  v_mfma_f32_16x16x32_bf16 v[160:163], a[168:171], a[220:223], 0
  ds_read_b64_tr_b16 a[166:167], v6 offset:18432
  v_mfma_f32_16x16x32_bf16 v[160:163], a[172:175], a[236:239], v[160:163]
  v_exp_f32 v31, v31
  v_mul_f32 v223, v207, v223
  v_mfma_f32_16x16x32_bf16 v[164:167], a[172:175], a[240:243], 0
  ds_read_b64_tr_b16 a[160:161], v6 offset:20480
  v_fma_f32 v24, v24, v21, v21
  v_mfma_f32_16x16x32_bf16 v[164:167], a[168:171], a[224:227], v[164:167]
  s_add_u32 s75, s75, 131072
  v_fma_f32 v25, v25, v21, v21
  v_rcp_f32 v24, v24
  v_mfma_f32_16x16x32_bf16 v[168:171], a[168:171], a[228:231], 0
  ds_read_b64_tr_b16 a[162:163], v6 offset:22528
  v_fma_f32 v26, v26, v21, v21
  v_mfma_f32_16x16x32_bf16 v[168:171], a[172:175], a[244:247], v[168:171]
  buffer_load_dwordx4 a[68:71], v1, s[8:11], s75 offen offset:0 sc1
  v_rcp_f32 v25, v25
  v_mfma_f32_16x16x32_bf16 v[172:175], a[172:175], a[248:251], 0
  ds_read_b64_tr_b16 a[172:173], v7 offset:16384
  v_fma_f32 v27, v27, v21, v21
  v_mfma_f32_16x16x32_bf16 v[172:175], a[168:171], a[232:235], v[172:175]
  s_waitcnt lgkmcnt(5)
  v_rcp_f32 v26, v26
HOP16:
  s_cbranch_execz HOP20
  v_fma_f32 v28, v28, v23, v23
  v_mfma_f32_16x16x32_bf16 v[188:191], a[176:179], a[232:235], 0
  ds_read_b64_tr_b16 a[174:175], v7 offset:18432
  v_mfma_f32_16x16x32_bf16 v[188:191], a[180:183], a[248:251], v[188:191]
  buffer_load_dwordx4 a[84:87], v1, s[8:11], s75 offen offset:1024 sc1
  v_rcp_f32 v27, v27
  v_fma_f32 v29, v29, v23, v23
  v_mfma_f32_16x16x32_bf16 v[184:187], a[180:183], a[244:247], 0
  ds_read_b64_tr_b16 a[168:169], v7 offset:20480
  v_mfma_f32_16x16x32_bf16 v[184:187], a[176:179], a[228:231], v[184:187]
  s_add_u32 s75, s75, s89
  v_rcp_f32 v28, v28
  v_fma_f32 v30, v30, v23, v23
  v_mfma_f32_16x16x32_bf16 v[180:183], a[176:179], a[224:227], 0
  ds_read_b64_tr_b16 a[170:171], v7 offset:22528
  v_rcp_f32 v29, v29
  v_mfma_f32_16x16x32_bf16 v[180:183], a[180:183], a[240:243], v[180:183]
  buffer_load_dwordx4 a[72:75], v1, s[8:11], s75 offen offset:0 sc1
  v_fma_f32 v31, v31, v23, v23
  v_mfma_f32_16x16x32_bf16 v[176:179], a[180:183], a[236:239], 0
  ds_read_b64_tr_b16 a[180:181], v8 offset:16384
  v_rcp_f32 v30, v30
  v_mfma_f32_16x16x32_bf16 v[176:179], a[176:179], a[220:223], v[176:179]
  s_waitcnt vmcnt(13) lgkmcnt(5)
  v_mul_f32 v216, v216, v24
  v_rcp_f32 v31, v31
  v_mfma_f32_16x16x32_bf16 v[64:67], a[164:167], a[0:3], v[64:67]
  ds_read_b64_tr_b16 a[182:183], v8 offset:18432
  v_mul_f32 v217, v217, v25
  v_mfma_f32_16x16x32_bf16 v[64:67], a[160:163], a[16:19], v[64:67]
  buffer_load_dwordx4 a[88:91], v1, s[8:11], s75 offen offset:1024 sc1
  v_mul_f32 v218, v218, v26
  v_mul_f32 v219, v219, v27
  v_mul_f32 v220, v220, v28
  v_mfma_f32_16x16x32_bf16 v[68:71], a[160:163], a[20:23], v[68:71]
  ds_read_b64_tr_b16 a[176:177], v8 offset:20480
  v_mul_f32 v221, v221, v29
  v_mfma_f32_16x16x32_bf16 v[68:71], a[164:167], a[4:7], v[68:71]
  v_mul_f32 v222, v222, v30
  v_mul_f32 v223, v223, v31
  v_cvt_pk_bf16_f32 v200, v216, v217
  v_mfma_f32_16x16x32_bf16 v[72:75], a[164:167], a[8:11], v[72:75]
  ds_read_b64_tr_b16 a[178:179], v8 offset:22528
  v_cvt_pk_bf16_f32 v201, v218, v219
  v_cvt_pk_bf16_f32 v204, v220, v221
  v_mfma_f32_16x16x32_bf16 v[72:75], a[160:163], a[24:27], v[72:75]
  s_add_u32 s75, s75, 131072
  v_cvt_pk_bf16_f32 v205, v222, v223
  v_mfma_f32_16x16x32_bf16 v[76:79], a[160:163], a[28:31], v[76:79]
  ds_read_b64_tr_b16 a[160:161], v9 offset:16384
  v_mul_f32 v24, v16, v224
  v_mul_f32 v25, v16, v225
  v_mfma_f32_16x16x32_bf16 v[76:79], a[164:167], a[12:15], v[76:79]
  s_waitcnt lgkmcnt(5)
  buffer_load_dwordx4 a[76:79], v1, s[8:11], s75 offen offset:0 sc1
  v_mul_f32 v26, v16, v226
  v_mul_f32 v27, v16, v227
  v_mul_f32 v28, v18, v228
  v_mfma_f32_16x16x32_bf16 v[92:95], a[172:175], a[12:15], v[92:95]
  ds_read_b64_tr_b16 a[162:163], v9 offset:18432
  v_mul_f32 v29, v18, v229
  v_mul_f32 v30, v18, v230
  v_mfma_f32_16x16x32_bf16 v[92:95], a[168:171], a[28:31], v[92:95]
  v_mul_f32 v31, v18, v231
  v_exp_f32 v24, v24
  v_mfma_f32_16x16x32_bf16 v[88:91], a[168:171], a[24:27], v[88:91]
  ds_read_b64_tr_b16 a[164:165], v9 offset:20480
  v_mul_f32 v240, v224, v240
  v_mfma_f32_16x16x32_bf16 v[88:91], a[172:175], a[8:11], v[88:91]
  buffer_load_dwordx4 a[92:95], v1, s[8:11], s75 offen offset:1024 sc1
  v_exp_f32 v25, v25
  v_mul_f32 v241, v225, v241
  v_mfma_f32_16x16x32_bf16 v[84:87], a[172:175], a[4:7], v[84:87]
  ds_read_b64_tr_b16 a[166:167], v9 offset:22528
  v_exp_f32 v26, v26
  v_mfma_f32_16x16x32_bf16 v[84:87], a[168:171], a[20:23], v[84:87]
  s_cmp_eq_u32 s91, 1
  s_cselect_b32 s76, 3, 10
  s_lshl_b32 s68, s76, 17
  s_lshl_b32 s76, s76, 11
  s_add_u32 s76, s76, s84
  s_add_u32 m0, s45, 32768
  v_mul_f32 v242, v226, v242
  v_exp_f32 v27, v27
  v_mfma_f32_16x16x32_bf16 v[80:83], a[168:171], a[16:19], v[80:83]
  ds_read_b64_tr_b16 a[168:169], v6 offset:24576
  v_mul_f32 v243, v227, v243
  v_mfma_f32_16x16x32_bf16 v[80:83], a[172:175], a[0:3], v[80:83]
  s_waitcnt lgkmcnt(5)
  buffer_load_dwordx4 v32, s[36:39], s68 offen lds
  v_exp_f32 v28, v28
  v_mul_f32 v244, v228, v244
  v_mfma_f32_16x16x32_bf16 v[96:99], a[180:183], a[0:3], v[96:99]
  ds_read_b64_tr_b16 a[170:171], v6 offset:26624
  v_exp_f32 v29, v29
  v_mfma_f32_16x16x32_bf16 v[96:99], a[176:179], a[16:19], v[96:99]
  s_add_u32 m0, s45, 36864
  s_add_u32 s61, s68, 65536
  v_mul_f32 v245, v229, v245
  v_mfma_f32_16x16x32_bf16 v[100:103], a[176:179], a[20:23], v[100:103]
  ds_read_b64_tr_b16 a[172:173], v6 offset:28672
  v_exp_f32 v30, v30
  v_mfma_f32_16x16x32_bf16 v[100:103], a[180:183], a[4:7], v[100:103]
  buffer_load_dwordx4 v32, s[36:39], s61 offen lds
  v_mul_f32 v246, v230, v246
  v_exp_f32 v31, v31
  v_mfma_f32_16x16x32_bf16 v[104:107], a[180:183], a[8:11], v[104:107]
  ds_read_b64_tr_b16 a[174:175], v6 offset:30720
  v_mul_f32 v247, v231, v247
  v_fma_f32 v24, v24, v17, v17
  v_mfma_f32_16x16x32_bf16 v[104:107], a[176:179], a[24:27], v[104:107]
  v_fma_f32 v25, v25, v17, v17
  v_rcp_f32 v24, v24
  v_mfma_f32_16x16x32_bf16 v[108:111], a[176:179], a[28:31], v[108:111]
  ds_read_b64_tr_b16 a[176:177], v7 offset:24576
  v_fma_f32 v26, v26, v17, v17
  v_mfma_f32_16x16x32_bf16 v[108:111], a[180:183], a[12:15], v[108:111]
  s_waitcnt lgkmcnt(5)
  s_add_u32 m0, s45, 40960
  v_rcp_f32 v25, v25
  v_fma_f32 v27, v27, v17, v17
  v_mfma_f32_16x16x32_bf16 v[124:127], a[160:163], a[12:15], v[124:127]
  ds_read_b64_tr_b16 a[178:179], v7 offset:26624
  v_rcp_f32 v26, v26
  v_mfma_f32_16x16x32_bf16 v[124:127], a[164:167], a[28:31], v[124:127]
  buffer_load_dwordx4 v33, s[36:39], s68 offen lds
  v_fma_f32 v28, v28, v19, v19
  v_rcp_f32 v27, v27
  v_mfma_f32_16x16x32_bf16 v[120:123], a[164:167], a[24:27], v[120:123]
  ds_read_b64_tr_b16 a[180:181], v7 offset:28672
  v_fma_f32 v29, v29, v19, v19
  v_mfma_f32_16x16x32_bf16 v[120:123], a[160:163], a[8:11], v[120:123]
  s_add_u32 m0, s45, 45056
  s_add_u32 s61, s68, 65536
  v_rcp_f32 v28, v28
  v_mfma_f32_16x16x32_bf16 v[116:119], a[160:163], a[4:7], v[116:119]
  ds_read_b64_tr_b16 a[182:183], v7 offset:30720
  v_fma_f32 v30, v30, v19, v19
  v_mfma_f32_16x16x32_bf16 v[116:119], a[164:167], a[20:23], v[116:119]
  buffer_load_dwordx4 v33, s[36:39], s61 offen lds
  v_rcp_f32 v29, v29
  v_fma_f32 v31, v31, v19, v19
  v_mfma_f32_16x16x32_bf16 v[112:115], a[164:167], a[16:19], v[112:115]
  ds_read_b64_tr_b16 a[164:165], v8 offset:24576
  v_rcp_f32 v30, v30
  v_mfma_f32_16x16x32_bf16 v[112:115], a[160:163], a[0:3], v[112:115]
  s_waitcnt lgkmcnt(5)
  s_cmp_eq_u32 s91, 2
  s_cselect_b32 s77, 5, 12
  s_lshl_b32 s69, s77, 17
  s_lshl_b32 s77, s77, 11
  s_add_u32 s77, s77, s84
  s_add_u32 m0, s45, 49152
  v_mul_f32 v240, v240, v24
  v_rcp_f32 v31, v31
  v_mfma_f32_16x16x32_bf16 v[128:131], a[168:171], a[0:3], v[128:131]
  ds_read_b64_tr_b16 a[166:167], v8 offset:26624
  v_mul_f32 v241, v241, v25
  v_mul_f32 v242, v242, v26
  v_mfma_f32_16x16x32_bf16 v[128:131], a[172:175], a[16:19], v[128:131]
  buffer_load_dwordx4 v32, s[36:39], s69 offen lds
  v_mul_f32 v243, v243, v27
  v_mul_f32 v244, v244, v28
  v_mul_f32 v245, v245, v29
  v_mfma_f32_16x16x32_bf16 v[132:135], a[172:175], a[20:23], v[132:135]
  ds_read_b64_tr_b16 a[160:161], v8 offset:28672
  v_mul_f32 v246, v246, v30
  v_mul_f32 v247, v247, v31
  v_mfma_f32_16x16x32_bf16 v[132:135], a[168:171], a[4:7], v[132:135]
  s_add_u32 m0, s45, 53248
  s_add_u32 s61, s69, 65536
  v_cvt_pk_bf16_f32 v194, v240, v241
  v_cvt_pk_bf16_f32 v195, v242, v243
  v_mfma_f32_16x16x32_bf16 v[136:139], a[168:171], a[8:11], v[136:139]
  ds_read_b64_tr_b16 a[162:163], v8 offset:30720
  v_mfma_f32_16x16x32_bf16 v[136:139], a[172:175], a[24:27], v[136:139]
  buffer_load_dwordx4 v32, s[36:39], s61 offen lds
  buffer_store_dwordx4 v[192:195], v1, s[8:11], s58 offen offset:1024 sc1
  v_mfma_f32_16x16x32_bf16 v[140:143], a[172:175], a[28:31], v[140:143]
  ds_read_b64_tr_b16 a[172:173], v9 offset:24576
  v_cvt_pk_bf16_f32 v198, v244, v245
  v_cvt_pk_bf16_f32 v199, v246, v247
  v_mfma_f32_16x16x32_bf16 v[140:143], a[168:171], a[12:15], v[140:143]
  s_waitcnt lgkmcnt(5)
  s_add_u32 s55, s58, 262144
  buffer_store_dwordx4 v[196:199], v1, s[8:11], s55 offen offset:1024 sc1
  v_mfma_f32_16x16x32_bf16 v[156:159], a[176:179], a[12:15], v[156:159]
  ds_read_b64_tr_b16 a[174:175], v9 offset:26624
  v_mul_f32 v24, v20, v232
  v_mul_f32 v25, v20, v233
  v_mfma_f32_16x16x32_bf16 v[156:159], a[180:183], a[28:31], v[156:159]
  s_add_u32 m0, s45, 57344
  v_mul_f32 v26, v20, v234
  v_mul_f32 v27, v20, v235
  v_mul_f32 v28, v22, v236
  v_mfma_f32_16x16x32_bf16 v[152:155], a[180:183], a[24:27], v[152:155]
  ds_read_b64_tr_b16 a[168:169], v9 offset:28672
  v_mul_f32 v29, v22, v237
  v_mul_f32 v30, v22, v238
  v_mfma_f32_16x16x32_bf16 v[152:155], a[176:179], a[8:11], v[152:155]
  buffer_load_dwordx4 v33, s[36:39], s69 offen lds
  v_mul_f32 v31, v22, v239
  v_exp_f32 v24, v24
  v_mfma_f32_16x16x32_bf16 v[148:151], a[176:179], a[4:7], v[148:151]
  ds_read_b64_tr_b16 a[170:171], v9 offset:30720
  v_mul_f32 v248, v232, v248
  v_mfma_f32_16x16x32_bf16 v[148:151], a[180:183], a[20:23], v[148:151]
  s_waitcnt vmcnt(47)
  s_barrier
  v_mfma_f32_16x16x32_bf16 v[144:147], a[180:183], a[16:19], v[144:147]
  ds_read_b64_tr_b16 a[180:181], v6 offset:0
  s_add_u32 m0, s45, 61440
  s_add_u32 s61, s69, 65536
  v_mfma_f32_16x16x32_bf16 v[144:147], a[176:179], a[0:3], v[144:147]
  s_waitcnt lgkmcnt(5)
  buffer_load_dwordx4 v33, s[36:39], s61 offen lds
  v_exp_f32 v25, v25
  v_mul_f32 v249, v233, v249
  v_mfma_f32_16x16x32_bf16 v[160:163], a[164:167], a[0:3], v[160:163]
  ds_read_b64_tr_b16 a[182:183], v6 offset:2048
  v_exp_f32 v26, v26
  v_mfma_f32_16x16x32_bf16 v[160:163], a[160:163], a[16:19], v[160:163]
  v_mul_f32 v250, v234, v250
  v_exp_f32 v27, v27
  v_mfma_f32_16x16x32_bf16 v[164:167], a[160:163], a[20:23], v[164:167]
  ds_read_b64_tr_b16 a[176:177], v6 offset:4096
  v_mul_f32 v251, v235, v251
  v_mfma_f32_16x16x32_bf16 v[164:167], a[164:167], a[4:7], v[164:167]
  buffer_load_dwordx4 a[96:99], v1, s[8:11], s76 offen offset:0 sc1
  v_exp_f32 v28, v28
  v_mul_f32 v252, v236, v252
  v_mfma_f32_16x16x32_bf16 v[168:171], a[164:167], a[8:11], v[168:171]
  ds_read_b64_tr_b16 a[178:179], v6 offset:6144
  v_exp_f32 v29, v29
  v_mfma_f32_16x16x32_bf16 v[168:171], a[160:163], a[24:27], v[168:171]
  v_mul_f32 v253, v237, v253
  v_exp_f32 v30, v30
  v_mfma_f32_16x16x32_bf16 v[172:175], a[160:163], a[28:31], v[172:175]
  ds_read_b64_tr_b16 a[160:161], v7 offset:0
  v_mul_f32 v254, v238, v254
  v_mfma_f32_16x16x32_bf16 v[172:175], a[164:167], a[12:15], v[172:175]
  s_waitcnt lgkmcnt(5)
  buffer_load_dwordx4 a[112:115], v1, s[8:11], s76 offen offset:1024 sc1
  v_exp_f32 v31, v31
  v_mul_f32 v255, v239, v255
  v_mfma_f32_16x16x32_bf16 v[188:191], a[172:175], a[12:15], v[188:191]
  ds_read_b64_tr_b16 a[162:163], v7 offset:2048
  v_fma_f32 v24, v24, v21, v21
  v_fma_f32 v25, v25, v21, v21
  v_mfma_f32_16x16x32_bf16 v[188:191], a[168:171], a[28:31], v[188:191]
  v_rcp_f32 v24, v24
  v_fma_f32 v26, v26, v21, v21
  v_mfma_f32_16x16x32_bf16 v[184:187], a[168:171], a[24:27], v[184:187]
  ds_read_b64_tr_b16 a[164:165], v7 offset:4096
  v_rcp_f32 v25, v25
  v_mfma_f32_16x16x32_bf16 v[184:187], a[172:175], a[8:11], v[184:187]
  s_add_u32 s76, s76, 131072
  v_fma_f32 v27, v27, v21, v21
  v_rcp_f32 v26, v26
  v_mfma_f32_16x16x32_bf16 v[180:183], a[172:175], a[4:7], v[180:183]
  ds_read_b64_tr_b16 a[166:167], v7 offset:6144
  v_fma_f32 v28, v28, v23, v23
  v_mfma_f32_16x16x32_bf16 v[180:183], a[168:171], a[20:23], v[180:183]
  buffer_load_dwordx4 a[100:103], v1, s[8:11], s76 offen offset:0 sc1
  v_rcp_f32 v27, v27
  v_fma_f32 v29, v29, v23, v23
  v_mfma_f32_16x16x32_bf16 v[176:179], a[168:171], a[16:19], v[176:179]
  ds_read_b64_tr_b16 a[168:169], v8 offset:0
  v_rcp_f32 v28, v28
  v_mfma_f32_16x16x32_bf16 v[176:179], a[172:175], a[0:3], v[176:179]
  s_waitcnt vmcnt(21) lgkmcnt(5)
  v_fma_f32 v30, v30, v23, v23
  v_rcp_f32 v29, v29
  v_fma_f32 v31, v31, v23, v23
  v_mfma_f32_16x16x32_bf16 v[64:67], a[180:183], a[32:35], v[64:67]
  ds_read_b64_tr_b16 a[170:171], v8 offset:2048
  v_rcp_f32 v30, v30
  v_mfma_f32_16x16x32_bf16 v[64:67], a[176:179], a[48:51], v[64:67]
  buffer_load_dwordx4 a[116:119], v1, s[8:11], s76 offen offset:1024 sc1
  v_mul_f32 v248, v248, v24
  v_rcp_f32 v31, v31
  v_mfma_f32_16x16x32_bf16 v[68:71], a[176:179], a[52:55], v[68:71]
  ds_read_b64_tr_b16 a[172:173], v8 offset:4096
  v_mul_f32 v249, v249, v25
  v_mul_f32 v250, v250, v26
  v_mfma_f32_16x16x32_bf16 v[68:71], a[180:183], a[36:39], v[68:71]
  s_add_u32 s76, s76, s89
  v_mul_f32 v251, v251, v27
  v_mul_f32 v252, v252, v28
  v_mul_f32 v253, v253, v29
  v_mfma_f32_16x16x32_bf16 v[72:75], a[180:183], a[40:43], v[72:75]
  ds_read_b64_tr_b16 a[174:175], v8 offset:6144
  v_mul_f32 v254, v254, v30
  v_mul_f32 v255, v255, v31
  v_mfma_f32_16x16x32_bf16 v[72:75], a[176:179], a[56:59], v[72:75]
  buffer_load_dwordx4 a[104:107], v1, s[8:11], s76 offen offset:0 sc1
  v_cvt_pk_bf16_f32 v202, v248, v249
  v_cvt_pk_bf16_f32 v203, v250, v251
  v_mfma_f32_16x16x32_bf16 v[76:79], a[176:179], a[60:63], v[76:79]
  ds_read_b64_tr_b16 a[176:177], v9 offset:0
  v_mfma_f32_16x16x32_bf16 v[76:79], a[180:183], a[44:47], v[76:79]
  s_waitcnt lgkmcnt(5)
  s_add_u32 s55, s58, 524288
  buffer_store_dwordx4 v[200:203], v1, s[8:11], s55 offen offset:1024 sc1
  v_mfma_f32_16x16x32_bf16 v[92:95], a[160:163], a[44:47], v[92:95]
  ds_read_b64_tr_b16 a[178:179], v9 offset:2048
  v_cvt_pk_bf16_f32 v206, v252, v253
  v_cvt_pk_bf16_f32 v207, v254, v255
  v_mfma_f32_16x16x32_bf16 v[92:95], a[164:167], a[60:63], v[92:95]
  buffer_load_dwordx4 a[120:123], v1, s[8:11], s76 offen offset:1024 sc1
  s_add_u32 s55, s58, 786432
  buffer_store_dwordx4 v[204:207], v1, s[8:11], s55 offen offset:1024 sc1
  v_mfma_f32_16x16x32_bf16 v[88:91], a[164:167], a[56:59], v[88:91]
  ds_read_b64_tr_b16 a[180:181], v9 offset:4096
  v_mfma_f32_16x16x32_bf16 v[88:91], a[160:163], a[40:43], v[88:91]
  v_mfma_f32_16x16x32_bf16 v[84:87], a[160:163], a[36:39], v[84:87]
  ds_read_b64_tr_b16 a[182:183], v9 offset:6144
  s_sub_u32 s80, s80, 491520
  v_mfma_f32_16x16x32_bf16 v[84:87], a[164:167], a[52:55], v[84:87]
  s_add_u32 s76, s76, 131072
  v_mfma_f32_16x16x32_bf16 v[80:83], a[164:167], a[48:51], v[80:83]
  ds_read_b64_tr_b16 a[164:165], v6 offset:8192
  v_mfma_f32_16x16x32_bf16 v[80:83], a[160:163], a[32:35], v[80:83]
  s_waitcnt lgkmcnt(5)
  buffer_load_dwordx4 a[108:111], v1, s[8:11], s76 offen offset:0 sc1
  v_mfma_f32_16x16x32_bf16 v[96:99], a[168:171], a[32:35], v[96:99]
  ds_read_b64_tr_b16 a[166:167], v6 offset:10240
  v_mfma_f32_16x16x32_bf16 v[96:99], a[172:175], a[48:51], v[96:99]
  v_mfma_f32_16x16x32_bf16 v[100:103], a[172:175], a[52:55], v[100:103]
  ds_read_b64_tr_b16 a[160:161], v6 offset:12288
  v_mfma_f32_16x16x32_bf16 v[100:103], a[168:171], a[36:39], v[100:103]
  buffer_load_dwordx4 a[124:127], v1, s[8:11], s76 offen offset:1024 sc1
  v_mfma_f32_16x16x32_bf16 v[104:107], a[168:171], a[40:43], v[104:107]
  ds_read_b64_tr_b16 a[162:163], v6 offset:14336
  v_mfma_f32_16x16x32_bf16 v[104:107], a[172:175], a[56:59], v[104:107]
  v_mfma_f32_16x16x32_bf16 v[108:111], a[172:175], a[60:63], v[108:111]
  ds_read_b64_tr_b16 a[172:173], v7 offset:8192
  v_mfma_f32_16x16x32_bf16 v[108:111], a[168:171], a[44:47], v[108:111]
  s_waitcnt lgkmcnt(5)
  buffer_load_dwordx4 a[128:131], v1, s[8:11], s77 offen offset:0 sc1
  v_mfma_f32_16x16x32_bf16 v[124:127], a[176:179], a[44:47], v[124:127]
  ds_read_b64_tr_b16 a[174:175], v7 offset:10240
  v_mfma_f32_16x16x32_bf16 v[124:127], a[180:183], a[60:63], v[124:127]
  v_mfma_f32_16x16x32_bf16 v[120:123], a[180:183], a[56:59], v[120:123]
  ds_read_b64_tr_b16 a[168:169], v7 offset:12288
  v_mfma_f32_16x16x32_bf16 v[120:123], a[176:179], a[40:43], v[120:123]
  buffer_load_dwordx4 a[144:147], v1, s[8:11], s77 offen offset:1024 sc1
  v_mfma_f32_16x16x32_bf16 v[116:119], a[176:179], a[36:39], v[116:119]
  ds_read_b64_tr_b16 a[170:171], v7 offset:14336
  v_mfma_f32_16x16x32_bf16 v[116:119], a[180:183], a[52:55], v[116:119]
  v_mfma_f32_16x16x32_bf16 v[112:115], a[180:183], a[48:51], v[112:115]
  ds_read_b64_tr_b16 a[180:181], v8 offset:8192
  v_mfma_f32_16x16x32_bf16 v[112:115], a[176:179], a[32:35], v[112:115]
  s_waitcnt lgkmcnt(5)
  s_add_u32 s77, s77, 131072
  v_mfma_f32_16x16x32_bf16 v[128:131], a[164:167], a[32:35], v[128:131]
  ds_read_b64_tr_b16 a[182:183], v8 offset:10240
  v_mfma_f32_16x16x32_bf16 v[128:131], a[160:163], a[48:51], v[128:131]
  buffer_load_dwordx4 a[132:135], v1, s[8:11], s77 offen offset:0 sc1
  v_mfma_f32_16x16x32_bf16 v[132:135], a[160:163], a[52:55], v[132:135]
  ds_read_b64_tr_b16 a[176:177], v8 offset:12288
  v_mfma_f32_16x16x32_bf16 v[132:135], a[164:167], a[36:39], v[132:135]
  v_mfma_f32_16x16x32_bf16 v[136:139], a[164:167], a[40:43], v[136:139]
  ds_read_b64_tr_b16 a[178:179], v8 offset:14336
  v_mfma_f32_16x16x32_bf16 v[136:139], a[160:163], a[56:59], v[136:139]
  buffer_load_dwordx4 a[148:151], v1, s[8:11], s77 offen offset:1024 sc1
  v_mfma_f32_16x16x32_bf16 v[140:143], a[160:163], a[60:63], v[140:143]
  ds_read_b64_tr_b16 a[160:161], v9 offset:8192
  v_mfma_f32_16x16x32_bf16 v[140:143], a[164:167], a[44:47], v[140:143]
  s_waitcnt lgkmcnt(5)
  s_add_u32 s77, s77, s89
  v_mfma_f32_16x16x32_bf16 v[156:159], a[172:175], a[44:47], v[156:159]
  ds_read_b64_tr_b16 a[162:163], v9 offset:10240
  v_mfma_f32_16x16x32_bf16 v[156:159], a[168:171], a[60:63], v[156:159]
  buffer_load_dwordx4 a[136:139], v1, s[8:11], s77 offen offset:0 sc1
  v_mfma_f32_16x16x32_bf16 v[152:155], a[168:171], a[56:59], v[152:155]
  ds_read_b64_tr_b16 a[164:165], v9 offset:12288
  v_mfma_f32_16x16x32_bf16 v[152:155], a[172:175], a[40:43], v[152:155]
  v_mfma_f32_16x16x32_bf16 v[148:151], a[172:175], a[36:39], v[148:151]
  ds_read_b64_tr_b16 a[166:167], v9 offset:14336
  v_mfma_f32_16x16x32_bf16 v[148:151], a[168:171], a[52:55], v[148:151]
  buffer_load_dwordx4 a[152:155], v1, s[8:11], s77 offen offset:1024 sc1
  v_mfma_f32_16x16x32_bf16 v[144:147], a[168:171], a[48:51], v[144:147]
  ds_read_b64_tr_b16 a[168:169], v2 offset:0
  v_mfma_f32_16x16x32_bf16 v[144:147], a[172:175], a[32:35], v[144:147]
  s_waitcnt lgkmcnt(5)
  v_mfma_f32_16x16x32_bf16 v[160:163], a[180:183], a[32:35], v[160:163]
  ds_read_b64_tr_b16 a[170:171], v2 offset:2048
  v_mfma_f32_16x16x32_bf16 v[160:163], a[176:179], a[48:51], v[160:163]
  s_add_u32 s77, s77, 131072
  v_mfma_f32_16x16x32_bf16 v[164:167], a[176:179], a[52:55], v[164:167]
  ds_read_b64_tr_b16 a[172:173], v2 offset:4096
  v_mfma_f32_16x16x32_bf16 v[164:167], a[180:183], a[36:39], v[164:167]
  buffer_load_dwordx4 a[140:143], v1, s[8:11], s77 offen offset:0 sc1
  v_mfma_f32_16x16x32_bf16 v[168:171], a[180:183], a[40:43], v[168:171]
  ds_read_b64_tr_b16 a[174:175], v2 offset:6144
  v_mfma_f32_16x16x32_bf16 v[168:171], a[176:179], a[56:59], v[168:171]
  v_mfma_f32_16x16x32_bf16 v[172:175], a[176:179], a[60:63], v[172:175]
  ds_read_b64_tr_b16 a[176:177], v3 offset:0
  v_mfma_f32_16x16x32_bf16 v[172:175], a[180:183], a[44:47], v[172:175]
  s_waitcnt lgkmcnt(5)
  buffer_load_dwordx4 a[156:159], v1, s[8:11], s77 offen offset:1024 sc1
  v_mfma_f32_16x16x32_bf16 v[188:191], a[160:163], a[44:47], v[188:191]
  ds_read_b64_tr_b16 a[178:179], v3 offset:2048
  v_mfma_f32_16x16x32_bf16 v[188:191], a[164:167], a[60:63], v[188:191]
  s_cmp_eq_u32 s91, 0
  s_cselect_b32 s78, 7, 0
  s_lshl_b32 s70, s78, 17
  s_lshl_b32 s78, s78, 11
  s_add_u32 s78, s78, s84
  s_add_u32 m0, s45, 16384
  v_mfma_f32_16x16x32_bf16 v[184:187], a[164:167], a[56:59], v[184:187]
  ds_read_b64_tr_b16 a[180:181], v3 offset:4096
  v_mfma_f32_16x16x32_bf16 v[184:187], a[160:163], a[40:43], v[184:187]
  buffer_load_dwordx4 v32, s[36:39], s70 offen lds
  v_mfma_f32_16x16x32_bf16 v[180:183], a[160:163], a[36:39], v[180:183]
  ds_read_b64_tr_b16 a[182:183], v3 offset:6144
  v_mfma_f32_16x16x32_bf16 v[180:183], a[164:167], a[52:55], v[180:183]
  s_add_u32 m0, s45, 20480
  s_add_u32 s61, s70, 65536
  v_mfma_f32_16x16x32_bf16 v[176:179], a[164:167], a[48:51], v[176:179]
  ds_read_b64_tr_b16 a[164:165], v4 offset:0
  v_mfma_f32_16x16x32_bf16 v[176:179], a[160:163], a[32:35], v[176:179]
  s_waitcnt vmcnt(29) lgkmcnt(5)
  buffer_load_dwordx4 v32, s[36:39], s61 offen lds
  v_mfma_f32_16x16x32_bf16 v[64:67], a[168:171], a[64:67], v[64:67]
  ds_read_b64_tr_b16 a[166:167], v4 offset:2048
  v_mfma_f32_16x16x32_bf16 v[64:67], a[172:175], a[80:83], v[64:67]
  v_mfma_f32_16x16x32_bf16 v[68:71], a[172:175], a[84:87], v[68:71]
  ds_read_b64_tr_b16 a[160:161], v4 offset:4096
  v_mfma_f32_16x16x32_bf16 v[68:71], a[168:171], a[68:71], v[68:71]
  s_add_u32 m0, s45, 24576
  v_mfma_f32_16x16x32_bf16 v[72:75], a[168:171], a[72:75], v[72:75]
  ds_read_b64_tr_b16 a[162:163], v4 offset:6144
  v_mfma_f32_16x16x32_bf16 v[72:75], a[172:175], a[88:91], v[72:75]
  buffer_load_dwordx4 v33, s[36:39], s70 offen lds
  v_mfma_f32_16x16x32_bf16 v[76:79], a[172:175], a[92:95], v[76:79]
  ds_read_b64_tr_b16 a[172:173], v5 offset:0
  v_mfma_f32_16x16x32_bf16 v[76:79], a[168:171], a[76:79], v[76:79]
  s_waitcnt lgkmcnt(5)
  s_add_u32 m0, s45, 28672
  s_add_u32 s61, s70, 65536
  v_mfma_f32_16x16x32_bf16 v[92:95], a[176:179], a[76:79], v[92:95]
  ds_read_b64_tr_b16 a[174:175], v5 offset:2048
  v_mfma_f32_16x16x32_bf16 v[92:95], a[180:183], a[92:95], v[92:95]
  buffer_load_dwordx4 v33, s[36:39], s61 offen lds
  v_add_u32 v38, s46, v0
  s_waitcnt vmcnt(14)
  s_barrier
  s_mov_b64 exec, 1
  buffer_store_dword v38, v0, s[8:11], s80 offen offset:0 sc1
  s_mov_b64 exec, -1
  v_mfma_f32_16x16x32_bf16 v[88:91], a[180:183], a[88:91], v[88:91]
  ds_read_b64_tr_b16 a[168:169], v5 offset:4096
  s_lshl_b32 s53, s44, 8
  v_mfma_f32_16x16x32_bf16 v[88:91], a[176:179], a[72:75], v[88:91]
  s_cmp_eq_u32 s91, 1
  s_cselect_b32 s79, 9, 2
  s_lshl_b32 s71, s79, 17
  s_lshl_b32 s79, s79, 11
  s_add_u32 s79, s79, s84
  s_add_u32 m0, s45, 98304
  s_add_u32 s53, s53, 133120
  v_lshrrev_b32 v49, 4, v0
  v_mfma_f32_16x16x32_bf16 v[84:87], a[176:179], a[68:71], v[84:87]
  ds_read_b64_tr_b16 a[170:171], v5 offset:6144
  v_lshl_add_u32 v46, v49, 4, s53
  v_mfma_f32_16x16x32_bf16 v[84:87], a[180:183], a[84:87], v[84:87]
  buffer_load_dwordx4 v32, s[36:39], s71 offen lds
  v_lshlrev_b32 v47, 2, v0
  v_add_u32 v45, s53, v47
  v_mfma_f32_16x16x32_bf16 v[80:83], a[180:183], a[80:83], v[80:83]
  ds_read_b64_tr_b16 a[180:181], v2 offset:8192
  v_lshrrev_b32 v48, 3, v0
  v_mfma_f32_16x16x32_bf16 v[80:83], a[176:179], a[64:67], v[80:83]
  s_waitcnt lgkmcnt(5)
  s_add_u32 m0, s45, 102400
  s_add_u32 s61, s71, 65536
  v_mfma_f32_16x16x32_bf16 v[96:99], a[164:167], a[64:67], v[96:99]
  ds_read_b64_tr_b16 a[182:183], v2 offset:10240
  v_and_b32 v50, 7, v0
  v_mfma_f32_16x16x32_bf16 v[96:99], a[160:163], a[80:83], v[96:99]
  buffer_load_dwordx4 v32, s[36:39], s61 offen lds
  v_xor_b32 v51, v50, v48
  v_lshlrev_b32 v51, 4, v51
  v_mfma_f32_16x16x32_bf16 v[100:103], a[160:163], a[84:87], v[100:103]
  ds_read_b64_tr_b16 a[176:177], v2 offset:12288
  v_lshl_add_u32 v40, v48, 11, v51
  v_mfma_f32_16x16x32_bf16 v[100:103], a[164:167], a[68:71], v[100:103]
  v_bfe_u32 v48, v0, 4, 1
  v_lshrrev_b32 v51, 5, v0
  v_mfma_f32_16x16x32_bf16 v[104:107], a[164:167], a[72:75], v[104:107]
  ds_read_b64_tr_b16 a[178:179], v2 offset:14336
  v_lshl_add_u32 v48, v48, 1, v51
  v_mfma_f32_16x16x32_bf16 v[104:107], a[160:163], a[88:91], v[104:107]
  s_cmp_eq_u32 s91, 2
  s_cselect_b32 s72, 11, 4
  s_lshl_b32 s64, s72, 17
  s_lshl_b32 s72, s72, 11
  s_add_u32 s72, s72, s84
  s_add_u32 m0, s45, 114688
  v_xor_b32 v48, v48, v50
  v_lshlrev_b32 v48, 4, v48
  v_mfma_f32_16x16x32_bf16 v[108:111], a[160:163], a[92:95], v[108:111]
  ds_read_b64_tr_b16 a[160:161], v3 offset:8192
  v_and_b32 v50, 15, v0
  v_mfma_f32_16x16x32_bf16 v[108:111], a[164:167], a[76:79], v[108:111]
  s_waitcnt lgkmcnt(5)
  buffer_load_dwordx4 v32, s[36:39], s64 offen lds
  v_lshl_add_u32 v48, v50, 7, v48
  v_mfma_f32_16x16x32_bf16 v[124:127], a[172:175], a[76:79], v[124:127]
  ds_read_b64_tr_b16 a[162:163], v3 offset:10240
  v_add_u32 v42, s90, v48
  v_mfma_f32_16x16x32_bf16 v[124:127], a[168:171], a[92:95], v[124:127]
  s_add_u32 m0, s45, 118784
  s_add_u32 s61, s64, 65536
  v_xor_b32 v43, 64, v42
  v_mfma_f32_16x16x32_bf16 v[120:123], a[168:171], a[88:91], v[120:123]
  ds_read_b64_tr_b16 a[164:165], v3 offset:12288
  v_add_u32 v44, s90, v1
  v_mfma_f32_16x16x32_bf16 v[120:123], a[172:175], a[72:75], v[120:123]
  buffer_load_dwordx4 v32, s[36:39], s61 offen lds
  v_bfe_u32 v48, v0, 2, 2
  v_lshrrev_b32 v49, 4, v0
  v_mfma_f32_16x16x32_bf16 v[116:119], a[172:175], a[68:71], v[116:119]
  ds_read_b64_tr_b16 a[166:167], v3 offset:14336
  v_and_b32 v50, 1, v0
  v_mfma_f32_16x16x32_bf16 v[116:119], a[168:171], a[84:87], v[116:119]
  s_cmp_eq_u32 s91, 3
  s_cselect_b32 s73, 13, 6
  s_lshl_b32 s65, s73, 17
  s_lshl_b32 s73, s73, 11
  s_add_u32 s73, s73, s84
  s_add_u32 m0, s45, 81920
  v_lshlrev_b32 v50, 4, v50
  v_mov_b32 v51, 0xffff
  v_mfma_f32_16x16x32_bf16 v[112:115], a[168:171], a[80:83], v[112:115]
  ds_read_b64_tr_b16 a[168:169], v4 offset:8192
  v_lshlrev_b32 v50, v50, v51
  v_mfma_f32_16x16x32_bf16 v[112:115], a[172:175], a[64:67], v[112:115]
  s_waitcnt lgkmcnt(5)
  buffer_load_dwordx4 v32, s[36:39], s65 offen lds
  v_cmp_eq_u32 vcc, v48, v49
  v_mov_b32 v60, 0
  v_mov_b32 v61, 0
  v_cndmask_b32 v48, 0, v50, vcc
  v_mfma_f32_16x16x32_bf16 v[128:131], a[180:183], a[64:67], v[128:131]
  ds_read_b64_tr_b16 a[170:171], v4 offset:10240
  v_and_b32 v49, 2, v0
  v_mfma_f32_16x16x32_bf16 v[128:131], a[176:179], a[80:83], v[128:131]
  s_add_u32 m0, s45, 86016
  s_add_u32 s61, s65, 65536
  v_cmp_eq_u32 vcc, 0, v49
  v_mov_b32 v54, 0
  v_mov_b32 v55, 0
  v_cndmask_b32 v50, 0, v48, vcc
  v_mfma_f32_16x16x32_bf16 v[132:135], a[176:179], a[84:87], v[132:135]
  ds_read_b64_tr_b16 a[172:173], v4 offset:12288
  v_sub_u32 v51, v48, v50
  v_mfma_f32_16x16x32_bf16 v[132:135], a[180:183], a[68:71], v[132:135]
  buffer_load_dwordx4 v32, s[36:39], s61 offen lds
  v_mfma_f32_16x16x32_bf16 v[136:139], a[180:183], a[72:75], v[136:139]
  ds_read_b64_tr_b16 a[174:175], v4 offset:14336
  v_mfma_f32_16x16x32_bf16 v[136:139], a[176:179], a[88:91], v[136:139]
  v_mfma_f32_16x16x32_bf16 v[140:143], a[176:179], a[92:95], v[140:143]
  ds_read_b64_tr_b16 a[176:177], v5 offset:8192
  v_mfma_f32_16x16x32_bf16 v[140:143], a[180:183], a[76:79], v[140:143]
  s_waitcnt lgkmcnt(5)
  s_add_u32 m0, s45, 106496
  v_mfma_f32_16x16x32_bf16 v[156:159], a[160:163], a[76:79], v[156:159]
  ds_read_b64_tr_b16 a[178:179], v5 offset:10240
  v_mfma_f32_16x16x32_bf16 v[156:159], a[164:167], a[92:95], v[156:159]
  buffer_load_dwordx4 v33, s[36:39], s71 offen lds
  v_mfma_f32_16x16x32_bf16 v[152:155], a[164:167], a[88:91], v[152:155]
  ds_read_b64_tr_b16 a[180:181], v5 offset:12288
  v_mfma_f32_16x16x32_bf16 v[152:155], a[160:163], a[72:75], v[152:155]
  s_add_u32 m0, s45, 110592
  s_add_u32 s61, s71, 65536
  v_mfma_f32_16x16x32_bf16 v[148:151], a[160:163], a[68:71], v[148:151]
  ds_read_b64_tr_b16 a[182:183], v5 offset:14336
  buffer_load_dwordx4 v33, s[36:39], s61 offen lds
  v_mfma_f32_16x16x32_bf16 v[148:151], a[164:167], a[84:87], v[148:151]
  s_waitcnt vmcnt(31)
  s_barrier
  v_mfma_f32_16x16x32_bf16 v[144:147], a[164:167], a[80:83], v[144:147]
  ds_read_b64_tr_b16 a[164:165], v2 offset:32768
  v_mfma_f32_16x16x32_bf16 v[144:147], a[160:163], a[64:67], v[144:147]
  s_waitcnt lgkmcnt(5)
  s_cmp_eq_u32 s91, 0
  s_cselect_b32 s74, 0, 7
  s_lshl_b32 s66, s74, 17
  s_lshl_b32 s74, s74, 11
  s_add_u32 s74, s74, s84
  s_add_u32 m0, s45, 65536
  v_mfma_f32_16x16x32_bf16 v[160:163], a[168:171], a[64:67], v[160:163]
  ds_read_b64_tr_b16 a[166:167], v2 offset:34816
  v_mfma_f32_16x16x32_bf16 v[160:163], a[172:175], a[80:83], v[160:163]
  buffer_load_dwordx4 v32, s[36:39], s66 offen lds
  v_mfma_f32_16x16x32_bf16 v[164:167], a[172:175], a[84:87], v[164:167]
  ds_read_b64_tr_b16 a[160:161], v2 offset:36864
  v_mfma_f32_16x16x32_bf16 v[164:167], a[168:171], a[68:71], v[164:167]
  s_add_u32 m0, s45, 69632
  s_add_u32 s61, s66, 65536
  v_mfma_f32_16x16x32_bf16 v[168:171], a[168:171], a[72:75], v[168:171]
  ds_read_b64_tr_b16 a[162:163], v2 offset:38912
  v_mfma_f32_16x16x32_bf16 v[168:171], a[172:175], a[88:91], v[168:171]
  buffer_load_dwordx4 v32, s[36:39], s61 offen lds
  v_mfma_f32_16x16x32_bf16 v[172:175], a[172:175], a[92:95], v[172:175]
HOP17:
  s_cbranch_execz WRET1
  ds_read_b64_tr_b16 a[172:173], v3 offset:32768
  v_mfma_f32_16x16x32_bf16 v[172:175], a[168:171], a[76:79], v[172:175]
  s_waitcnt lgkmcnt(5)
  v_mfma_f32_16x16x32_bf16 v[188:191], a[176:179], a[76:79], v[188:191]
  ds_read_b64_tr_b16 a[174:175], v3 offset:34816
  v_mfma_f32_16x16x32_bf16 v[188:191], a[180:183], a[92:95], v[188:191]
  s_add_u32 s62, s88, 0
  v_mfma_f32_16x16x32_bf16 v[184:187], a[180:183], a[88:91], v[184:187]
  ds_read_b64_tr_b16 a[168:169], v3 offset:36864
  v_mfma_f32_16x16x32_bf16 v[184:187], a[176:179], a[72:75], v[184:187]
  buffer_load_dword v240, v47, s[8:11], s62 offen sc1
  v_mfma_f32_16x16x32_bf16 v[180:183], a[176:179], a[68:71], v[180:183]
  ds_read_b64_tr_b16 a[170:171], v3 offset:38912
  v_mfma_f32_16x16x32_bf16 v[180:183], a[180:183], a[84:87], v[180:183]
  s_add_u32 s62, s88, 24576
  v_mfma_f32_16x16x32_bf16 v[176:179], a[180:183], a[80:83], v[176:179]
  ds_read_b64_tr_b16 a[180:181], v4 offset:32768
  v_mfma_f32_16x16x32_bf16 v[176:179], a[176:179], a[64:67], v[176:179]
  s_waitcnt vmcnt(24) lgkmcnt(5)
  buffer_load_dword v241, v47, s[8:11], s62 offen sc1
  v_mfma_f32_16x16x32_bf16 v[64:67], a[164:167], a[96:99], v[64:67]
  ds_read_b64_tr_b16 a[182:183], v4 offset:34816
  v_mfma_f32_16x16x32_bf16 v[64:67], a[160:163], a[112:115], v[64:67]
  s_add_u32 s62, s88, 49152
  v_mfma_f32_16x16x32_bf16 v[68:71], a[160:163], a[116:119], v[68:71]
  ds_read_b64_tr_b16 a[176:177], v4 offset:36864
  v_mfma_f32_16x16x32_bf16 v[68:71], a[164:167], a[100:103], v[68:71]
  buffer_load_dword v242, v47, s[8:11], s62 offen sc1
  v_mfma_f32_16x16x32_bf16 v[72:75], a[164:167], a[104:107], v[72:75]
  ds_read_b64_tr_b16 a[178:179], v4 offset:38912
  v_mfma_f32_16x16x32_bf16 v[72:75], a[160:163], a[120:123], v[72:75]
  s_add_u32 s62, s88, 73728
  v_mfma_f32_16x16x32_bf16 v[76:79], a[160:163], a[124:127], v[76:79]
  ds_read_b64_tr_b16 a[160:161], v5 offset:32768
  v_mfma_f32_16x16x32_bf16 v[76:79], a[164:167], a[108:111], v[76:79]
  s_waitcnt lgkmcnt(5)
  buffer_load_dword v243, v47, s[8:11], s62 offen sc1
  v_mfma_f32_16x16x32_bf16 v[92:95], a[172:175], a[108:111], v[92:95]
  ds_read_b64_tr_b16 a[162:163], v5 offset:34816
  v_mfma_f32_16x16x32_bf16 v[92:95], a[168:171], a[124:127], v[92:95]
  v_mfma_f32_16x16x32_bf16 v[88:91], a[168:171], a[120:123], v[88:91]
  ds_read_b64_tr_b16 a[164:165], v5 offset:36864
  v_mfma_f32_16x16x32_bf16 v[88:91], a[172:175], a[104:107], v[88:91]
  s_cmp_eq_u32 s91, 1
  s_cselect_b32 s75, 2, 9
  s_lshl_b32 s67, s75, 17
  s_lshl_b32 s75, s75, 11
  s_add_u32 s75, s75, s84
  s_add_u32 m0, s45, 0
  v_mfma_f32_16x16x32_bf16 v[84:87], a[172:175], a[100:103], v[84:87]
  ds_read_b64_tr_b16 a[166:167], v5 offset:38912
  v_mfma_f32_16x16x32_bf16 v[84:87], a[168:171], a[116:119], v[84:87]
  buffer_load_dwordx4 v32, s[36:39], s67 offen lds
  v_mfma_f32_16x16x32_bf16 v[80:83], a[168:171], a[112:115], v[80:83]
  ds_read_b64_tr_b16 a[168:169], v2 offset:40960
  v_mfma_f32_16x16x32_bf16 v[80:83], a[172:175], a[96:99], v[80:83]
  s_waitcnt lgkmcnt(5)
  s_add_u32 m0, s45, 4096
  s_add_u32 s61, s67, 65536
  v_mfma_f32_16x16x32_bf16 v[96:99], a[180:183], a[96:99], v[96:99]
  ds_read_b64_tr_b16 a[170:171], v2 offset:43008
  v_mfma_f32_16x16x32_bf16 v[96:99], a[176:179], a[112:115], v[96:99]
  s_sub_u32 s82, s82, 491520
  buffer_load_dwordx4 v32, s[36:39], s61 offen lds
  v_mfma_f32_16x16x32_bf16 v[100:103], a[176:179], a[116:119], v[100:103]
  ds_read_b64_tr_b16 a[172:173], v2 offset:45056
  s_lshl_b32 s83, s44, 28
  s_add_u32 s83, s83, s82
  buffer_load_dword v36, v37, s[8:11], s83 offen sc1
  v_mfma_f32_16x16x32_bf16 v[100:103], a[180:183], a[100:103], v[100:103]
  s_add_u32 m0, s45, 122880
  v_mfma_f32_16x16x32_bf16 v[104:107], a[180:183], a[104:107], v[104:107]
  ds_read_b64_tr_b16 a[174:175], v2 offset:47104
  v_mfma_f32_16x16x32_bf16 v[104:107], a[176:179], a[120:123], v[104:107]
  buffer_load_dwordx4 v33, s[36:39], s64 offen lds
  v_mfma_f32_16x16x32_bf16 v[108:111], a[176:179], a[124:127], v[108:111]
  ds_read_b64_tr_b16 a[176:177], v3 offset:40960
  v_mfma_f32_16x16x32_bf16 v[108:111], a[180:183], a[108:111], v[108:111]
  s_waitcnt lgkmcnt(5)
  s_add_u32 m0, s45, 126976
  s_add_u32 s61, s64, 65536
  v_mfma_f32_16x16x32_bf16 v[124:127], a[160:163], a[108:111], v[124:127]
  ds_read_b64_tr_b16 a[178:179], v3 offset:43008
  v_mfma_f32_16x16x32_bf16 v[124:127], a[164:167], a[124:127], v[124:127]
  buffer_load_dwordx4 v33, s[36:39], s61 offen lds
  v_mfma_f32_16x16x32_bf16 v[120:123], a[164:167], a[120:123], v[120:123]
  ds_read_b64_tr_b16 a[180:181], v3 offset:45056
  v_mfma_f32_16x16x32_bf16 v[120:123], a[160:163], a[104:107], v[120:123]
  v_mfma_f32_16x16x32_bf16 v[116:119], a[160:163], a[100:103], v[116:119]
  ds_read_b64_tr_b16 a[182:183], v3 offset:47104
  v_mfma_f32_16x16x32_bf16 v[116:119], a[164:167], a[116:119], v[116:119]
  s_add_u32 m0, s45, 90112
  v_mfma_f32_16x16x32_bf16 v[112:115], a[164:167], a[112:115], v[112:115]
  ds_read_b64_tr_b16 a[164:165], v4 offset:40960
  v_mfma_f32_16x16x32_bf16 v[112:115], a[160:163], a[96:99], v[112:115]
  s_waitcnt lgkmcnt(5)
  buffer_load_dwordx4 v33, s[36:39], s65 offen lds
  v_mfma_f32_16x16x32_bf16 v[128:131], a[168:171], a[96:99], v[128:131]
  ds_read_b64_tr_b16 a[166:167], v4 offset:43008
  v_mfma_f32_16x16x32_bf16 v[128:131], a[172:175], a[112:115], v[128:131]
  s_add_u32 m0, s45, 94208
  s_add_u32 s61, s65, 65536
  v_mfma_f32_16x16x32_bf16 v[132:135], a[172:175], a[116:119], v[132:135]
  ds_read_b64_tr_b16 a[160:161], v4 offset:45056
  v_mfma_f32_16x16x32_bf16 v[132:135], a[168:171], a[100:103], v[132:135]
  buffer_load_dwordx4 v33, s[36:39], s61 offen lds
  v_mfma_f32_16x16x32_bf16 v[136:139], a[168:171], a[104:107], v[136:139]
  ds_read_b64_tr_b16 a[162:163], v4 offset:47104
  v_mfma_f32_16x16x32_bf16 v[136:139], a[172:175], a[120:123], v[136:139]
  s_add_u32 m0, s45, 73728
  v_mfma_f32_16x16x32_bf16 v[140:143], a[172:175], a[124:127], v[140:143]
  ds_read_b64_tr_b16 a[172:173], v5 offset:40960
  v_mfma_f32_16x16x32_bf16 v[140:143], a[168:171], a[108:111], v[140:143]
  s_waitcnt lgkmcnt(5)
  buffer_load_dwordx4 v33, s[36:39], s66 offen lds
  v_mfma_f32_16x16x32_bf16 v[156:159], a[176:179], a[108:111], v[156:159]
  ds_read_b64_tr_b16 a[174:175], v5 offset:43008
  v_mfma_f32_16x16x32_bf16 v[156:159], a[180:183], a[124:127], v[156:159]
  s_add_u32 m0, s45, 77824
  s_add_u32 s61, s66, 65536
  v_mfma_f32_16x16x32_bf16 v[152:155], a[180:183], a[120:123], v[152:155]
  ds_read_b64_tr_b16 a[168:169], v5 offset:45056
  v_mfma_f32_16x16x32_bf16 v[152:155], a[176:179], a[104:107], v[152:155]
  buffer_load_dwordx4 v33, s[36:39], s61 offen lds
  v_mfma_f32_16x16x32_bf16 v[148:151], a[176:179], a[100:103], v[148:151]
  ds_read_b64_tr_b16 a[170:171], v5 offset:47104
  v_mfma_f32_16x16x32_bf16 v[148:151], a[180:183], a[116:119], v[148:151]
  v_mfma_f32_16x16x32_bf16 v[144:147], a[180:183], a[112:115], v[144:147]
  ds_read_b64_tr_b16 a[180:181], v2 offset:49152
  v_mfma_f32_16x16x32_bf16 v[144:147], a[176:179], a[96:99], v[144:147]
  s_waitcnt lgkmcnt(5)
  v_mfma_f32_16x16x32_bf16 v[160:163], a[164:167], a[96:99], v[160:163]
  ds_read_b64_tr_b16 a[182:183], v2 offset:51200
  v_mfma_f32_16x16x32_bf16 v[160:163], a[160:163], a[112:115], v[160:163]
  v_mfma_f32_16x16x32_bf16 v[164:167], a[160:163], a[116:119], v[164:167]
  ds_read_b64_tr_b16 a[176:177], v2 offset:53248
  v_mfma_f32_16x16x32_bf16 v[164:167], a[164:167], a[100:103], v[164:167]
  v_mfma_f32_16x16x32_bf16 v[168:171], a[164:167], a[104:107], v[168:171]
  ds_read_b64_tr_b16 a[178:179], v2 offset:55296
  v_mfma_f32_16x16x32_bf16 v[168:171], a[160:163], a[120:123], v[168:171]
  v_mfma_f32_16x16x32_bf16 v[172:175], a[160:163], a[124:127], v[172:175]
  ds_read_b64_tr_b16 a[160:161], v3 offset:49152
  v_mfma_f32_16x16x32_bf16 v[172:175], a[164:167], a[108:111], v[172:175]
  s_waitcnt lgkmcnt(5)
  v_mfma_f32_16x16x32_bf16 v[188:191], a[172:175], a[108:111], v[188:191]
  ds_read_b64_tr_b16 a[162:163], v3 offset:51200
  v_mfma_f32_16x16x32_bf16 v[188:191], a[168:171], a[124:127], v[188:191]
  v_mfma_f32_16x16x32_bf16 v[184:187], a[168:171], a[120:123], v[184:187]
  ds_read_b64_tr_b16 a[164:165], v3 offset:53248
  s_waitcnt vmcnt(6)
  s_cmp_lg_u32 s44, 0
  s_cbranch_scc1 PL13_adaLN_cond__sliding_local_dilated__swiglu_ffn__prompt_kernelx
  v_cmp_ne_u32 vcc, s46, v36
  s_nop 4
  s_cbranch_vccz PL13_adaLN_cond__sliding_local_dilated__swiglu_ffn__prompt_kernelx
  s_mov_b32 s83, 60000
PL13_adaLN_cond__sliding_local_dilated__swiglu_ffn__prompt_kernel:
  buffer_load_dword v36, v37, s[8:11], s82 offen sc1
  s_sub_u32 s83, s83, 1
  s_cmp_eq_u32 s83, 0
  s_waitcnt vmcnt(0)
  s_cbranch_scc1 PL13_adaLN_cond__sliding_local_dilated__swiglu_ffn__prompt_kernelx
  v_cmp_ne_u32 vcc, s46, v36
  s_nop 4
  s_cbranch_vccnz PL13_adaLN_cond__sliding_local_dilated__swiglu_ffn__prompt_kernel
PL13_adaLN_cond__sliding_local_dilated__swiglu_ffn__prompt_kernelx:
  s_barrier
  v_mfma_f32_16x16x32_bf16 v[184:187], a[172:175], a[104:107], v[184:187]
  v_mfma_f32_16x16x32_bf16 v[180:183], a[172:175], a[100:103], v[180:183]
  ds_read_b64_tr_b16 a[166:167], v3 offset:55296
  v_mfma_f32_16x16x32_bf16 v[180:183], a[168:171], a[116:119], v[180:183]
  buffer_load_dwordx4 a[188:191], v1, s[8:11], s78 offen offset:0 sc1
  v_mfma_f32_16x16x32_bf16 v[176:179], a[168:171], a[112:115], v[176:179]
  ds_read_b64_tr_b16 a[168:169], v4 offset:49152
  v_mfma_f32_16x16x32_bf16 v[176:179], a[172:175], a[96:99], v[176:179]
  s_waitcnt vmcnt(29) lgkmcnt(5)
  v_mfma_f32_16x16x32_bf16 v[64:67], a[180:183], a[128:131], v[64:67]
  ds_read_b64_tr_b16 a[170:171], v4 offset:51200
  v_mfma_f32_16x16x32_bf16 v[64:67], a[176:179], a[144:147], v[64:67]
  buffer_load_dwordx4 a[204:207], v1, s[8:11], s78 offen offset:1024 sc1
  v_mfma_f32_16x16x32_bf16 v[68:71], a[176:179], a[148:151], v[68:71]
  ds_read_b64_tr_b16 a[172:173], v4 offset:53248
  v_mfma_f32_16x16x32_bf16 v[68:71], a[180:183], a[132:135], v[68:71]
  s_add_u32 s78, s78, 131072
  v_mfma_f32_16x16x32_bf16 v[72:75], a[180:183], a[136:139], v[72:75]
  ds_read_b64_tr_b16 a[174:175], v4 offset:55296
  v_mfma_f32_16x16x32_bf16 v[72:75], a[176:179], a[152:155], v[72:75]
  buffer_load_dwordx4 a[192:195], v1, s[8:11], s78 offen offset:0 sc1
  v_mfma_f32_16x16x32_bf16 v[76:79], a[176:179], a[156:159], v[76:79]
  ds_read_b64_tr_b16 a[176:177], v5 offset:49152
  v_mfma_f32_16x16x32_bf16 v[76:79], a[180:183], a[140:143], v[76:79]
  s_waitcnt lgkmcnt(5)
  v_mfma_f32_16x16x32_bf16 v[92:95], a[160:163], a[140:143], v[92:95]
  ds_read_b64_tr_b16 a[178:179], v5 offset:51200
  v_mfma_f32_16x16x32_bf16 v[92:95], a[164:167], a[156:159], v[92:95]
  v_mfma_f32_16x16x32_bf16 v[88:91], a[164:167], a[152:155], v[88:91]
  ds_read_b64_tr_b16 a[180:181], v5 offset:53248
  v_mfma_f32_16x16x32_bf16 v[88:91], a[160:163], a[136:139], v[88:91]
  buffer_load_dwordx4 a[208:211], v1, s[8:11], s78 offen offset:1024 sc1
  v_mfma_f32_16x16x32_bf16 v[84:87], a[160:163], a[132:135], v[84:87]
  ds_read_b64_tr_b16 a[182:183], v5 offset:55296
  v_mfma_f32_16x16x32_bf16 v[84:87], a[164:167], a[148:151], v[84:87]
  s_add_u32 s78, s78, s89
  v_mfma_f32_16x16x32_bf16 v[80:83], a[164:167], a[144:147], v[80:83]
  ds_read_b64_tr_b16 a[164:165], v2 offset:57344
  v_mfma_f32_16x16x32_bf16 v[80:83], a[160:163], a[128:131], v[80:83]
  s_waitcnt lgkmcnt(5)
  buffer_load_dwordx4 a[196:199], v1, s[8:11], s78 offen offset:0 sc1
  v_mfma_f32_16x16x32_bf16 v[96:99], a[168:171], a[128:131], v[96:99]
  ds_read_b64_tr_b16 a[166:167], v2 offset:59392
  v_mfma_f32_16x16x32_bf16 v[96:99], a[172:175], a[144:147], v[96:99]
  v_mfma_f32_16x16x32_bf16 v[100:103], a[172:175], a[148:151], v[100:103]
  ds_read_b64_tr_b16 a[160:161], v2 offset:61440
  v_mfma_f32_16x16x32_bf16 v[100:103], a[168:171], a[132:135], v[100:103]
  buffer_load_dwordx4 a[212:215], v1, s[8:11], s78 offen offset:1024 sc1
  v_mfma_f32_16x16x32_bf16 v[104:107], a[168:171], a[136:139], v[104:107]
  ds_read_b64_tr_b16 a[162:163], v2 offset:63488
  v_mfma_f32_16x16x32_bf16 v[104:107], a[172:175], a[152:155], v[104:107]
  s_add_u32 s78, s78, 131072
  v_mfma_f32_16x16x32_bf16 v[108:111], a[172:175], a[156:159], v[108:111]
  ds_read_b64_tr_b16 a[172:173], v3 offset:57344
  v_mfma_f32_16x16x32_bf16 v[108:111], a[168:171], a[140:143], v[108:111]
  s_waitcnt lgkmcnt(5)
  buffer_load_dwordx4 a[200:203], v1, s[8:11], s78 offen offset:0 sc1
  v_mfma_f32_16x16x32_bf16 v[124:127], a[176:179], a[140:143], v[124:127]
  ds_read_b64_tr_b16 a[174:175], v3 offset:59392
  v_mfma_f32_16x16x32_bf16 v[124:127], a[180:183], a[156:159], v[124:127]
  v_mfma_f32_16x16x32_bf16 v[120:123], a[180:183], a[152:155], v[120:123]
  ds_read_b64_tr_b16 a[168:169], v3 offset:61440
  v_mfma_f32_16x16x32_bf16 v[120:123], a[176:179], a[136:139], v[120:123]
  v_mfma_f32_16x16x32_bf16 v[116:119], a[176:179], a[132:135], v[116:119]
  ds_read_b64_tr_b16 a[170:171], v3 offset:63488
  v_mfma_f32_16x16x32_bf16 v[116:119], a[180:183], a[148:151], v[116:119]
  buffer_load_dwordx4 a[216:219], v1, s[8:11], s78 offen offset:1024 sc1
  v_mfma_f32_16x16x32_bf16 v[112:115], a[180:183], a[144:147], v[112:115]
  ds_read_b64_tr_b16 a[180:181], v4 offset:57344
  v_mfma_f32_16x16x32_bf16 v[112:115], a[176:179], a[128:131], v[112:115]
  s_waitcnt lgkmcnt(5)
  v_mfma_f32_16x16x32_bf16 v[128:131], a[164:167], a[128:131], v[128:131]
  ds_read_b64_tr_b16 a[182:183], v4 offset:59392
  v_mfma_f32_16x16x32_bf16 v[128:131], a[160:163], a[144:147], v[128:131]
  buffer_load_dwordx4 a[220:223], v1, s[8:11], s79 offen offset:0 sc1
  v_mfma_f32_16x16x32_bf16 v[132:135], a[160:163], a[148:151], v[132:135]
  ds_read_b64_tr_b16 a[176:177], v4 offset:61440
  v_mfma_f32_16x16x32_bf16 v[132:135], a[164:167], a[132:135], v[132:135]
  v_mfma_f32_16x16x32_bf16 v[136:139], a[164:167], a[136:139], v[136:139]
  ds_read_b64_tr_b16 a[178:179], v4 offset:63488
  v_mfma_f32_16x16x32_bf16 v[136:139], a[160:163], a[152:155], v[136:139]
  buffer_load_dwordx4 a[236:239], v1, s[8:11], s79 offen offset:1024 sc1
  v_mfma_f32_16x16x32_bf16 v[140:143], a[160:163], a[156:159], v[140:143]
  ds_read_b64_tr_b16 a[160:161], v5 offset:57344
  v_mfma_f32_16x16x32_bf16 v[140:143], a[164:167], a[140:143], v[140:143]
  s_waitcnt lgkmcnt(5)
  s_add_u32 s79, s79, 131072
  v_mfma_f32_16x16x32_bf16 v[156:159], a[172:175], a[140:143], v[156:159]
  ds_read_b64_tr_b16 a[162:163], v5 offset:59392
  v_mfma_f32_16x16x32_bf16 v[156:159], a[168:171], a[156:159], v[156:159]
  buffer_load_dwordx4 a[224:227], v1, s[8:11], s79 offen offset:0 sc1
  v_mfma_f32_16x16x32_bf16 v[152:155], a[168:171], a[152:155], v[152:155]
  ds_read_b64_tr_b16 a[164:165], v5 offset:61440
  v_mfma_f32_16x16x32_bf16 v[152:155], a[172:175], a[136:139], v[152:155]
  v_mfma_f32_16x16x32_bf16 v[148:151], a[172:175], a[132:135], v[148:151]
  ds_read_b64_tr_b16 a[166:167], v5 offset:63488
  v_mfma_f32_16x16x32_bf16 v[148:151], a[168:171], a[148:151], v[148:151]
  s_waitcnt vmcnt(35)
  s_barrier
  v_mfma_f32_16x16x32_bf16 v[144:147], a[168:171], a[144:147], v[144:147]
  ds_read_b64_tr_b16 a[168:169], v2 offset:16384
  v_mfma_f32_16x16x32_bf16 v[144:147], a[172:175], a[128:131], v[144:147]
  s_waitcnt lgkmcnt(5)
  buffer_load_dwordx4 a[240:243], v1, s[8:11], s79 offen offset:1024 sc1
  v_mfma_f32_16x16x32_bf16 v[160:163], a[180:183], a[128:131], v[160:163]
  ds_read_b64_tr_b16 a[170:171], v2 offset:18432
  v_mfma_f32_16x16x32_bf16 v[160:163], a[176:179], a[144:147], v[160:163]
  s_add_u32 s79, s79, s89
  v_mfma_f32_16x16x32_bf16 v[164:167], a[176:179], a[148:151], v[164:167]
  ds_read_b64_tr_b16 a[172:173], v2 offset:20480
  v_mfma_f32_16x16x32_bf16 v[164:167], a[180:183], a[132:135], v[164:167]
  buffer_load_dwordx4 a[228:231], v1, s[8:11], s79 offen offset:0 sc1
  v_mfma_f32_16x16x32_bf16 v[168:171], a[180:183], a[136:139], v[168:171]
  ds_read_b64_tr_b16 a[174:175], v2 offset:22528
  v_mfma_f32_16x16x32_bf16 v[168:171], a[176:179], a[152:155], v[168:171]
  v_mfma_f32_16x16x32_bf16 v[172:175], a[176:179], a[156:159], v[172:175]
  ds_read_b64_tr_b16 a[176:177], v3 offset:16384
  v_mfma_f32_16x16x32_bf16 v[172:175], a[180:183], a[140:143], v[172:175]
  s_waitcnt lgkmcnt(5)
  buffer_load_dwordx4 a[244:247], v1, s[8:11], s79 offen offset:1024 sc1
  v_mfma_f32_16x16x32_bf16 v[188:191], a[160:163], a[140:143], v[188:191]
  ds_read_b64_tr_b16 a[178:179], v3 offset:18432
  v_mfma_f32_16x16x32_bf16 v[188:191], a[164:167], a[156:159], v[188:191]
  s_add_u32 s79, s79, 131072
  v_mfma_f32_16x16x32_bf16 v[184:187], a[164:167], a[152:155], v[184:187]
  ds_read_b64_tr_b16 a[180:181], v3 offset:20480
  v_mfma_f32_16x16x32_bf16 v[184:187], a[160:163], a[136:139], v[184:187]
  buffer_load_dwordx4 a[232:235], v1, s[8:11], s79 offen offset:0 sc1
  ds_read_b128 v[192:195], v44 offset:0
  v_mfma_f32_16x16x32_bf16 v[180:183], a[160:163], a[132:135], v[180:183]
  ds_read_b64_tr_b16 a[182:183], v3 offset:22528
  v_mfma_f32_16x16x32_bf16 v[180:183], a[164:167], a[148:151], v[180:183]
  ds_read_b128 v[196:199], v44 offset:1024
  v_mfma_f32_16x16x32_bf16 v[176:179], a[164:167], a[144:147], v[176:179]
  ds_read_b64_tr_b16 a[164:165], v4 offset:16384
  v_mfma_f32_16x16x32_bf16 v[176:179], a[160:163], a[128:131], v[176:179]
  s_waitcnt vmcnt(7) lgkmcnt(7)
  ds_read_b128 v[200:203], v44 offset:2048
  v_mfma_f32_16x16x32_bf16 v[64:67], a[168:171], a[188:191], v[64:67]
  ds_read_b64_tr_b16 a[166:167], v4 offset:18432
  v_mfma_f32_16x16x32_bf16 v[64:67], a[172:175], a[204:207], v[64:67]
  buffer_load_dwordx4 a[248:251], v1, s[8:11], s79 offen offset:1024 sc1
  ds_read_b128 v[204:207], v44 offset:3072
  v_mfma_f32_16x16x32_bf16 v[68:71], a[172:175], a[208:211], v[68:71]
  ds_read_b64_tr_b16 a[160:161], v4 offset:20480
  s_waitcnt vmcnt(25)
  v_mfma_f32_16x16x32_bf16 v[68:71], a[168:171], a[192:195], v[68:71]
  v_add_f32 v240, v240, v241
  v_add_f32 v242, v242, v243
  v_mfma_f32_16x16x32_bf16 v[72:75], a[168:171], a[196:199], v[72:75]
  ds_read_b64_tr_b16 a[162:163], v4 offset:22528
  v_add_f32 v240, v240, v242
  v_mfma_f32_16x16x32_bf16 v[72:75], a[172:175], a[212:215], v[72:75]
  buffer_load_dwordx4 a[0:3], v1, s[8:11], s72 offen offset:0 sc1
  v_cvt_pk_bf16_f32 v240, v240, v240
  v_lshlrev_b32 v240, 16, v240
  v_mfma_f32_16x16x32_bf16 v[76:79], a[172:175], a[216:219], v[76:79]
  ds_read_b64_tr_b16 a[172:173], v5 offset:16384
  v_mfma_f32_16x16x32_bf16 v[76:79], a[168:171], a[200:203], v[76:79]
  s_waitcnt lgkmcnt(8)
  ds_write_b32 v45, v240
  v_mfma_f32_16x16x32_bf16 v[92:95], a[176:179], a[200:203], v[92:95]
  ds_read_b64_tr_b16 a[174:175], v5 offset:18432
  v_mfma_f32_16x16x32_bf16 v[92:95], a[180:183], a[216:219], v[92:95]
  buffer_load_dwordx4 a[16:19], v1, s[8:11], s72 offen offset:1024 sc1
  ds_read_b128 v[240:243], v46 offset:0
  v_mfma_f32_16x16x32_bf16 v[88:91], a[180:183], a[212:215], v[88:91]
  ds_read_b64_tr_b16 a[168:169], v5 offset:20480
  v_mfma_f32_16x16x32_bf16 v[88:91], a[176:179], a[196:199], v[88:91]
  s_add_u32 s72, s72, 131072
  ds_read_b128 v[244:247], v46 offset:64
  v_mfma_f32_16x16x32_bf16 v[84:87], a[176:179], a[192:195], v[84:87]
  ds_read_b64_tr_b16 a[170:171], v5 offset:22528
  v_mfma_f32_16x16x32_bf16 v[84:87], a[180:183], a[208:211], v[84:87]
  buffer_load_dwordx4 a[4:7], v1, s[8:11], s72 offen offset:0 sc1
  ds_read_b128 v[248:251], v46 offset:128
  v_mfma_f32_16x16x32_bf16 v[80:83], a[180:183], a[204:207], v[80:83]
  ds_read_b64_tr_b16 a[180:181], v2 offset:24576
  v_mfma_f32_16x16x32_bf16 v[80:83], a[176:179], a[188:191], v[80:83]
  s_waitcnt lgkmcnt(9)
  ds_read_b128 v[252:255], v46 offset:192
  v_mfma_f32_16x16x32_bf16 v[96:99], a[164:167], a[188:191], v[96:99]
  ds_read_b64_tr_b16 a[182:183], v2 offset:26624
  s_waitcnt lgkmcnt(13)
  v_mfma_f32_16x16x32_bf16 v[96:99], a[160:163], a[204:207], v[96:99]
  v_lshlrev_b32 v208, 16, v192
  v_and_b32 v209, 0xffff0000, v192
  v_mfma_f32_16x16x32_bf16 v[100:103], a[160:163], a[208:211], v[100:103]
  ds_read_b64_tr_b16 a[176:177], v2 offset:28672
  v_lshlrev_b32 v210, 16, v193
  v_mfma_f32_16x16x32_bf16 v[100:103], a[164:167], a[192:195], v[100:103]
  buffer_load_dwordx4 a[20:23], v1, s[8:11], s72 offen offset:1024 sc1
  v_and_b32 v211, 0xffff0000, v193
  v_lshlrev_b32 v212, 16, v194
  v_mfma_f32_16x16x32_bf16 v[104:107], a[164:167], a[196:199], v[104:107]
  ds_read_b64_tr_b16 a[178:179], v2 offset:30720
  v_and_b32 v213, 0xffff0000, v194
  v_mfma_f32_16x16x32_bf16 v[104:107], a[160:163], a[212:215], v[104:107]
  s_add_u32 s72, s72, s89
  v_lshlrev_b32 v214, 16, v195
  v_and_b32 v215, 0xffff0000, v195
  v_mfma_f32_16x16x32_bf16 v[108:111], a[160:163], a[216:219], v[108:111]
  ds_read_b64_tr_b16 a[160:161], v3 offset:24576
  v_lshlrev_b32 v216, 16, v196
  v_mfma_f32_16x16x32_bf16 v[108:111], a[164:167], a[200:203], v[108:111]
  s_waitcnt lgkmcnt(7)
  buffer_load_dwordx4 a[8:11], v1, s[8:11], s72 offen offset:0 sc1
  v_and_b32 v217, 0xffff0000, v196
  v_mfma_f32_16x16x32_bf16 v[124:127], a[172:175], a[200:203], v[124:127]
  ds_read_b64_tr_b16 a[162:163], v3 offset:26624
  v_lshlrev_b32 v218, 16, v197
  v_mfma_f32_16x16x32_bf16 v[124:127], a[168:171], a[216:219], v[124:127]
  v_and_b32 v219, 0xffff0000, v197
  v_lshlrev_b32 v220, 16, v198
  v_mfma_f32_16x16x32_bf16 v[120:123], a[168:171], a[212:215], v[120:123]
  ds_read_b64_tr_b16 a[164:165], v3 offset:28672
  v_and_b32 v221, 0xffff0000, v198
  v_mfma_f32_16x16x32_bf16 v[120:123], a[172:175], a[196:199], v[120:123]
  buffer_load_dwordx4 a[24:27], v1, s[8:11], s72 offen offset:1024 sc1
  v_lshlrev_b32 v222, 16, v199
  v_and_b32 v223, 0xffff0000, v199
  v_mfma_f32_16x16x32_bf16 v[116:119], a[172:175], a[192:195], v[116:119]
  ds_read_b64_tr_b16 a[166:167], v3 offset:30720
  v_lshlrev_b32 v224, 16, v200
  v_mfma_f32_16x16x32_bf16 v[116:119], a[168:171], a[208:211], v[116:119]
  s_add_u32 s72, s72, 131072
  v_and_b32 v225, 0xffff0000, v200
  v_lshlrev_b32 v226, 16, v201
  v_mfma_f32_16x16x32_bf16 v[112:115], a[168:171], a[204:207], v[112:115]
  ds_read_b64_tr_b16 a[168:169], v4 offset:24576
  v_and_b32 v227, 0xffff0000, v201
  v_mfma_f32_16x16x32_bf16 v[112:115], a[172:175], a[188:191], v[112:115]
  s_waitcnt lgkmcnt(5)
  buffer_load_dwordx4 a[12:15], v1, s[8:11], s72 offen offset:0 sc1
  v_lshlrev_b32 v228, 16, v202
  v_mfma_f32_16x16x32_bf16 v[128:131], a[180:183], a[188:191], v[128:131]
  ds_read_b64_tr_b16 a[170:171], v4 offset:26624
  v_and_b32 v229, 0xffff0000, v202
  v_mfma_f32_16x16x32_bf16 v[128:131], a[176:179], a[204:207], v[128:131]
  v_lshlrev_b32 v230, 16, v203
  v_and_b32 v231, 0xffff0000, v203
  v_mfma_f32_16x16x32_bf16 v[132:135], a[176:179], a[208:211], v[132:135]
  ds_read_b64_tr_b16 a[172:173], v4 offset:28672
  v_lshlrev_b32 v232, 16, v204
  v_mfma_f32_16x16x32_bf16 v[132:135], a[180:183], a[192:195], v[132:135]
  v_and_b32 v233, 0xffff0000, v204
  v_lshlrev_b32 v234, 16, v205
  v_mfma_f32_16x16x32_bf16 v[136:139], a[180:183], a[196:199], v[136:139]
  ds_read_b64_tr_b16 a[174:175], v4 offset:30720
  v_and_b32 v235, 0xffff0000, v205
  v_mfma_f32_16x16x32_bf16 v[136:139], a[176:179], a[212:215], v[136:139]
  buffer_load_dwordx4 a[28:31], v1, s[8:11], s72 offen offset:1024 sc1
  v_lshlrev_b32 v236, 16, v206
  v_and_b32 v237, 0xffff0000, v206
  v_mfma_f32_16x16x32_bf16 v[140:143], a[176:179], a[216:219], v[140:143]
  ds_read_b64_tr_b16 a[176:177], v5 offset:24576
  v_lshlrev_b32 v238, 16, v207
  v_mfma_f32_16x16x32_bf16 v[140:143], a[180:183], a[200:203], v[140:143]
  s_waitcnt lgkmcnt(5)
  s_cmp_eq_u32 s91, 2
  s_cselect_b32 s76, 4, 11
  s_lshl_b32 s68, s76, 17
  s_lshl_b32 s76, s76, 11
  s_add_u32 s76, s76, s84
  s_add_u32 m0, s45, 32768
  v_and_b32 v239, 0xffff0000, v207
  v_mfma_f32_16x16x32_bf16 v[156:159], a[160:163], a[200:203], v[156:159]
  ds_read_b64_tr_b16 a[178:179], v5 offset:26624
  v_mov_b32 v37, 0
  v_mfma_f32_16x16x32_bf16 v[156:159], a[164:167], a[216:219], v[156:159]
  buffer_load_dwordx4 v32, s[36:39], s68 offen lds
  s_waitcnt lgkmcnt(13)
  v_cvt_pk_bf16_f32 v52, v240, v241
  v_mfma_f32_16x16x32_bf16 v[152:155], a[164:167], a[212:215], v[152:155]
  ds_read_b64_tr_b16 a[180:181], v5 offset:28672
  v_and_b32 v52, v52, v50
  v_mfma_f32_16x16x32_bf16 v[152:155], a[160:163], a[196:199], v[152:155]
  s_add_u32 m0, s45, 36864
  s_add_u32 s61, s68, 65536
  v_cvt_pk_bf16_f32 v53, v242, v243
  v_mfma_f32_16x16x32_bf16 v[148:151], a[160:163], a[192:195], v[148:151]
  ds_read_b64_tr_b16 a[182:183], v5 offset:30720
  v_and_b32 v53, v53, v51
  v_mfma_f32_16x16x32_bf16 v[148:151], a[164:167], a[208:211], v[148:151]
  buffer_load_dwordx4 v32, s[36:39], s61 offen lds
  s_waitcnt vmcnt(45)
  s_barrier
  v_mfma_f32_16x16x32_bf16 v[144:147], a[164:167], a[204:207], v[144:147]
  ds_read_b64_tr_b16 a[164:165], v6 offset:32768
  v_cvt_pk_bf16_f32 v56, v244, v245
  v_mfma_f32_16x16x32_bf16 v[144:147], a[160:163], a[188:191], v[144:147]
  s_waitcnt lgkmcnt(5)
  s_cmp_eq_u32 s91, 3
  s_cselect_b32 s77, 6, 13
  s_lshl_b32 s69, s77, 17
  s_lshl_b32 s77, s77, 11
  s_add_u32 s77, s77, s84
  s_add_u32 m0, s45, 49152
  v_and_b32 v56, v56, v50
  v_mfma_f32_16x16x32_bf16 v[160:163], a[168:171], a[188:191], v[160:163]
  ds_read_b64_tr_b16 a[166:167], v6 offset:34816
  v_cvt_pk_bf16_f32 v57, v246, v247
  v_mfma_f32_16x16x32_bf16 v[160:163], a[172:175], a[204:207], v[160:163]
  buffer_load_dwordx4 v32, s[36:39], s69 offen lds
  v_and_b32 v57, v57, v51
  v_cvt_pk_bf16_f32 v58, v248, v249
  v_mfma_f32_16x16x32_bf16 v[164:167], a[172:175], a[208:211], v[164:167]
  ds_read_b64_tr_b16 a[160:161], v6 offset:36864
  v_and_b32 v58, v58, v50
  v_mfma_f32_16x16x32_bf16 v[164:167], a[168:171], a[192:195], v[164:167]
  v_cvt_pk_bf16_f32 v59, v250, v251
  v_and_b32 v59, v59, v51
  v_mfma_f32_16x16x32_bf16 v[168:171], a[168:171], a[196:199], v[168:171]
  ds_read_b64_tr_b16 a[162:163], v6 offset:38912
  v_cvt_pk_bf16_f32 v62, v252, v253
  v_mfma_f32_16x16x32_bf16 v[168:171], a[172:175], a[212:215], v[168:171]
  s_add_u32 m0, s45, 53248
  s_add_u32 s61, s69, 65536
  v_and_b32 v62, v62, v50
  v_mfma_f32_16x16x32_bf16 v[172:175], a[172:175], a[216:219], v[172:175]
  ds_read_b64_tr_b16 a[172:173], v7 offset:32768
  v_cvt_pk_bf16_f32 v63, v254, v255
  v_mfma_f32_16x16x32_bf16 v[172:175], a[168:171], a[200:203], v[172:175]
  s_waitcnt lgkmcnt(5)
  buffer_load_dwordx4 v32, s[36:39], s61 offen lds
  v_and_b32 v63, v63, v51
  v_mfma_f32_16x16x32_bf16 v[188:191], a[176:179], a[200:203], v[188:191]
  ds_read_b64_tr_b16 a[174:175], v7 offset:34816
  v_mfma_f32_16x16x32_bf16 v[188:191], a[180:183], a[216:219], v[188:191]
  v_mfma_f32_16x16x32_bf16 v[184:187], a[180:183], a[212:215], v[184:187]
  ds_read_b64_tr_b16 a[168:169], v7 offset:36864
  v_mfma_f32_16x16x32_bf16 v[184:187], a[176:179], a[196:199], v[184:187]
  buffer_load_dwordx4 a[32:35], v1, s[8:11], s73 offen offset:0 sc1
  v_mfma_f32_16x16x32_bf16 v[180:183], a[176:179], a[192:195], v[180:183]
  ds_read_b64_tr_b16 a[170:171], v7 offset:38912
  v_mfma_f32_16x16x32_bf16 v[180:183], a[180:183], a[208:211], v[180:183]
  v_mfma_f32_16x16x32_bf16 v[176:179], a[180:183], a[204:207], v[176:179]
  ds_read_b64_tr_b16 a[180:181], v8 offset:32768
  v_mfma_f32_16x16x32_bf16 v[176:179], a[176:179], a[188:191], v[176:179]
  s_waitcnt vmcnt(13) lgkmcnt(5)
  buffer_load_dwordx4 a[48:51], v1, s[8:11], s73 offen offset:1024 sc1
  v_mfma_f32_16x16x32_bf16 v[64:67], a[164:167], a[220:223], v[64:67]
  ds_read_b64_tr_b16 a[182:183], v8 offset:34816
  v_mfma_f32_16x16x32_bf16 v[64:67], a[160:163], a[236:239], v[64:67]
  s_add_u32 s73, s73, 131072
  v_mfma_f32_16x16x32_bf16 v[68:71], a[160:163], a[240:243], v[68:71]
  ds_read_b64_tr_b16 a[176:177], v8 offset:36864
  v_mfma_f32_16x16x32_bf16 v[68:71], a[164:167], a[224:227], v[68:71]
  buffer_load_dwordx4 a[36:39], v1, s[8:11], s73 offen offset:0 sc1
  v_mfma_f32_16x16x32_bf16 v[72:75], a[164:167], a[228:231], v[72:75]
  ds_read_b64_tr_b16 a[178:179], v8 offset:38912
  v_mfma_f32_16x16x32_bf16 v[72:75], a[160:163], a[244:247], v[72:75]
  v_mfma_f32_16x16x32_bf16 v[76:79], a[160:163], a[248:251], v[76:79]
  ds_read_b64_tr_b16 a[160:161], v9 offset:32768
  v_mfma_f32_16x16x32_bf16 v[76:79], a[164:167], a[232:235], v[76:79]
  s_waitcnt lgkmcnt(5)
  v_mfma_f32_16x16x32_bf16 v[92:95], a[172:175], a[232:235], v[92:95]
  ds_read_b64_tr_b16 a[162:163], v9 offset:34816
  v_mfma_f32_16x16x32_bf16 v[92:95], a[168:171], a[248:251], v[92:95]
  buffer_load_dwordx4 a[52:55], v1, s[8:11], s73 offen offset:1024 sc1
  v_mfma_f32_16x16x32_bf16 v[88:91], a[168:171], a[244:247], v[88:91]
  ds_read_b64_tr_b16 a[164:165], v9 offset:36864
  v_mfma_f32_16x16x32_bf16 v[88:91], a[172:175], a[228:231], v[88:91]
  s_add_u32 s73, s73, s89
  v_mfma_f32_16x16x32_bf16 v[84:87], a[172:175], a[224:227], v[84:87]
  ds_read_b64_tr_b16 a[166:167], v9 offset:38912
  v_mfma_f32_16x16x32_bf16 v[84:87], a[168:171], a[240:243], v[84:87]
  buffer_load_dwordx4 a[40:43], v1, s[8:11], s73 offen offset:0 sc1
  v_mfma_f32_16x16x32_bf16 v[80:83], a[168:171], a[236:239], v[80:83]
  ds_read_b64_tr_b16 a[168:169], v6 offset:49152
  v_mfma_f32_16x16x32_bf16 v[80:83], a[172:175], a[220:223], v[80:83]
  s_waitcnt lgkmcnt(5)
  v_mfma_f32_16x16x32_bf16 v[96:99], a[180:183], a[220:223], v[96:99]
  ds_read_b64_tr_b16 a[170:171], v6 offset:51200
  v_mfma_f32_16x16x32_bf16 v[96:99], a[176:179], a[236:239], v[96:99]
  buffer_load_dwordx4 a[56:59], v1, s[8:11], s73 offen offset:1024 sc1
  v_mfma_f32_16x16x32_bf16 v[100:103], a[176:179], a[240:243], v[100:103]
  ds_read_b64_tr_b16 a[172:173], v6 offset:53248
  v_mfma_f32_16x16x32_bf16 v[100:103], a[180:183], a[224:227], v[100:103]
  s_add_u32 s73, s73, 131072
  v_mfma_f32_16x16x32_bf16 v[104:107], a[180:183], a[228:231], v[104:107]
  ds_read_b64_tr_b16 a[174:175], v6 offset:55296
  v_mfma_f32_16x16x32_bf16 v[104:107], a[176:179], a[244:247], v[104:107]
  buffer_load_dwordx4 a[44:47], v1, s[8:11], s73 offen offset:0 sc1
  v_mfma_f32_16x16x32_bf16 v[108:111], a[176:179], a[248:251], v[108:111]
  ds_read_b64_tr_b16 a[176:177], v7 offset:49152
  v_mfma_f32_16x16x32_bf16 v[108:111], a[180:183], a[232:235], v[108:111]
  s_waitcnt lgkmcnt(5)
  v_mfma_f32_16x16x32_bf16 v[124:127], a[160:163], a[232:235], v[124:127]
  ds_read_b64_tr_b16 a[178:179], v7 offset:51200
  v_mfma_f32_16x16x32_bf16 v[124:127], a[164:167], a[248:251], v[124:127]
  v_mfma_f32_16x16x32_bf16 v[120:123], a[164:167], a[244:247], v[120:123]
  ds_read_b64_tr_b16 a[180:181], v7 offset:53248
  v_mfma_f32_16x16x32_bf16 v[120:123], a[160:163], a[228:231], v[120:123]
  buffer_load_dwordx4 a[60:63], v1, s[8:11], s73 offen offset:1024 sc1
  v_mfma_f32_16x16x32_bf16 v[116:119], a[160:163], a[224:227], v[116:119]
  ds_read_b64_tr_b16 a[182:183], v7 offset:55296
HOP18:
  s_cbranch_execz WRET1
  v_mfma_f32_16x16x32_bf16 v[116:119], a[164:167], a[240:243], v[116:119]
  v_mfma_f32_16x16x32_bf16 v[112:115], a[164:167], a[236:239], v[112:115]
  ds_read_b64_tr_b16 a[164:165], v8 offset:49152
  v_mfma_f32_16x16x32_bf16 v[112:115], a[160:163], a[220:223], v[112:115]
  s_waitcnt vmcnt(12) lgkmcnt(5)
  buffer_load_dwordx4 a[64:67], v1, s[8:11], s74 offen offset:0 sc1
  v_mfma_f32_16x16x32_bf16 v[64:67], a[168:171], a[0:3], v[64:67]
  ds_read_b64_tr_b16 a[166:167], v8 offset:51200
  v_mfma_f32_16x16x32_bf16 v[64:67], a[172:175], a[16:19], v[64:67]
  v_mfma_f32_16x16x32_bf16 v[68:71], a[172:175], a[20:23], v[68:71]
  ds_read_b64_tr_b16 a[160:161], v8 offset:53248
  v_mfma_f32_16x16x32_bf16 v[68:71], a[168:171], a[4:7], v[68:71]
  buffer_load_dwordx4 a[80:83], v1, s[8:11], s74 offen offset:1024 sc1
  v_mfma_f32_16x16x32_bf16 v[72:75], a[168:171], a[8:11], v[72:75]
  ds_read_b64_tr_b16 a[162:163], v8 offset:55296
  v_mfma_f32_16x16x32_bf16 v[72:75], a[172:175], a[24:27], v[72:75]
  s_add_u32 s74, s74, 131072
  v_mfma_f32_16x16x32_bf16 v[76:79], a[172:175], a[28:31], v[76:79]
  ds_read_b64_tr_b16 a[172:173], v9 offset:49152
  v_mfma_f32_16x16x32_bf16 v[76:79], a[168:171], a[12:15], v[76:79]
  s_waitcnt lgkmcnt(5)
  buffer_load_dwordx4 a[68:71], v1, s[8:11], s74 offen offset:0 sc1
  v_mfma_f32_16x16x32_bf16 v[92:95], a[176:179], a[12:15], v[92:95]
  ds_read_b64_tr_b16 a[174:175], v9 offset:51200
  v_mfma_f32_16x16x32_bf16 v[92:95], a[180:183], a[28:31], v[92:95]
  v_mfma_f32_16x16x32_bf16 v[88:91], a[180:183], a[24:27], v[88:91]
  ds_read_b64_tr_b16 a[168:169], v9 offset:53248
  v_mfma_f32_16x16x32_bf16 v[88:91], a[176:179], a[8:11], v[88:91]
  v_mfma_f32_16x16x32_bf16 v[84:87], a[176:179], a[4:7], v[84:87]
  ds_read_b64_tr_b16 a[170:171], v9 offset:55296
  buffer_load_dwordx4 a[84:87], v1, s[8:11], s74 offen offset:1024 sc1
  v_mfma_f32_16x16x32_bf16 v[84:87], a[180:183], a[20:23], v[84:87]
  s_waitcnt vmcnt(12)
  s_barrier
  v_mfma_f32_16x16x32_bf16 v[80:83], a[180:183], a[16:19], v[80:83]
  ds_read_b64_tr_b16 a[180:181], v6 offset:16384
  v_mfma_f32_16x16x32_bf16 v[80:83], a[176:179], a[0:3], v[80:83]
  s_waitcnt lgkmcnt(5)
  s_add_u32 s74, s74, s89
  v_mfma_f32_16x16x32_bf16 v[96:99], a[164:167], a[0:3], v[96:99]
  ds_read_b64_tr_b16 a[182:183], v6 offset:18432
  v_mfma_f32_16x16x32_bf16 v[96:99], a[160:163], a[16:19], v[96:99]
  buffer_load_dwordx4 a[72:75], v1, s[8:11], s74 offen offset:0 sc1
  v_mfma_f32_16x16x32_bf16 v[100:103], a[160:163], a[20:23], v[100:103]
  ds_read_b64_tr_b16 a[176:177], v6 offset:20480
  v_mfma_f32_16x16x32_bf16 v[100:103], a[164:167], a[4:7], v[100:103]
  v_mfma_f32_16x16x32_bf16 v[104:107], a[164:167], a[8:11], v[104:107]
  ds_read_b64_tr_b16 a[178:179], v6 offset:22528
  v_mfma_f32_16x16x32_bf16 v[104:107], a[160:163], a[24:27], v[104:107]
  buffer_load_dwordx4 a[88:91], v1, s[8:11], s74 offen offset:1024 sc1
  v_mfma_f32_16x16x32_bf16 v[108:111], a[160:163], a[28:31], v[108:111]
  ds_read_b64_tr_b16 a[160:161], v7 offset:16384
  v_mfma_f32_16x16x32_bf16 v[108:111], a[164:167], a[12:15], v[108:111]
  s_waitcnt lgkmcnt(5)
  s_add_u32 s74, s74, 131072
  v_mfma_f32_16x16x32_bf16 v[124:127], a[172:175], a[12:15], v[124:127]
  ds_read_b64_tr_b16 a[162:163], v7 offset:18432
  v_mfma_f32_16x16x32_bf16 v[124:127], a[168:171], a[28:31], v[124:127]
  buffer_load_dwordx4 a[76:79], v1, s[8:11], s74 offen offset:0 sc1
  v_mfma_f32_16x16x32_bf16 v[120:123], a[168:171], a[24:27], v[120:123]
  ds_read_b64_tr_b16 a[164:165], v7 offset:20480
  v_mfma_f32_16x16x32_bf16 v[120:123], a[172:175], a[8:11], v[120:123]
  v_mfma_f32_16x16x32_bf16 v[116:119], a[172:175], a[4:7], v[116:119]
  ds_read_b64_tr_b16 a[166:167], v7 offset:22528
  v_mfma_f32_16x16x32_bf16 v[116:119], a[168:171], a[20:23], v[116:119]
  v_mfma_f32_16x16x32_bf16 v[112:115], a[168:171], a[16:19], v[112:115]
  ds_read_b64_tr_b16 a[168:169], v8 offset:16384
  v_mfma_f32_16x16x32_bf16 v[112:115], a[172:175], a[0:3], v[112:115]
  s_waitcnt vmcnt(7) lgkmcnt(5)
  buffer_load_dwordx4 a[92:95], v1, s[8:11], s74 offen offset:1024 sc1
  v_mfma_f32_16x16x32_bf16 v[64:67], a[180:183], a[32:35], v[64:67]
  ds_read_b64_tr_b16 a[170:171], v8 offset:18432
  v_mfma_f32_16x16x32_bf16 v[64:67], a[176:179], a[48:51], v[64:67]
  v_mfma_f32_16x16x32_bf16 v[68:71], a[176:179], a[52:55], v[68:71]
  ds_read_b64_tr_b16 a[172:173], v8 offset:20480
  v_mfma_f32_16x16x32_bf16 v[68:71], a[180:183], a[36:39], v[68:71]
  buffer_load_dwordx4 a[96:99], v1, s[8:11], s75 offen offset:0 sc1
  v_mfma_f32_16x16x32_bf16 v[72:75], a[180:183], a[40:43], v[72:75]
  ds_read_b64_tr_b16 a[174:175], v8 offset:22528
  v_mfma_f32_16x16x32_bf16 v[72:75], a[176:179], a[56:59], v[72:75]
  v_mfma_f32_16x16x32_bf16 v[76:79], a[176:179], a[60:63], v[76:79]
  ds_read_b64_tr_b16 a[176:177], v9 offset:16384
  v_mfma_f32_16x16x32_bf16 v[76:79], a[180:183], a[44:47], v[76:79]
  s_waitcnt lgkmcnt(5)
  buffer_load_dwordx4 a[112:115], v1, s[8:11], s75 offen offset:1024 sc1
  v_mfma_f32_16x16x32_bf16 v[92:95], a[160:163], a[44:47], v[92:95]
  ds_read_b64_tr_b16 a[178:179], v9 offset:18432
  v_mfma_f32_16x16x32_bf16 v[92:95], a[164:167], a[60:63], v[92:95]
  s_add_u32 s75, s75, 131072
  v_mfma_f32_16x16x32_bf16 v[88:91], a[164:167], a[56:59], v[88:91]
  ds_read_b64_tr_b16 a[180:181], v9 offset:20480
  v_mfma_f32_16x16x32_bf16 v[88:91], a[160:163], a[40:43], v[88:91]
  buffer_load_dwordx4 a[100:103], v1, s[8:11], s75 offen offset:0 sc1
  v_mfma_f32_16x16x32_bf16 v[84:87], a[160:163], a[36:39], v[84:87]
  ds_read_b64_tr_b16 a[182:183], v9 offset:22528
  v_mfma_f32_16x16x32_bf16 v[84:87], a[164:167], a[52:55], v[84:87]
  v_mfma_f32_16x16x32_bf16 v[80:83], a[164:167], a[48:51], v[80:83]
  ds_read_b64_tr_b16 a[164:165], v6 offset:0
  v_mfma_f32_16x16x32_bf16 v[80:83], a[160:163], a[32:35], v[80:83]
  s_waitcnt lgkmcnt(5)
  v_mfma_f32_16x16x32_bf16 v[96:99], a[168:171], a[32:35], v[96:99]
  ds_read_b64_tr_b16 a[166:167], v6 offset:2048
  v_mfma_f32_16x16x32_bf16 v[96:99], a[172:175], a[48:51], v[96:99]
  buffer_load_dwordx4 a[116:119], v1, s[8:11], s75 offen offset:1024 sc1
  v_mfma_f32_16x16x32_bf16 v[100:103], a[172:175], a[52:55], v[100:103]
  ds_read_b64_tr_b16 a[160:161], v6 offset:4096
  v_mfma_f32_16x16x32_bf16 v[100:103], a[168:171], a[36:39], v[100:103]
  s_add_u32 s75, s75, s89
  v_mfma_f32_16x16x32_bf16 v[104:107], a[168:171], a[40:43], v[104:107]
  ds_read_b64_tr_b16 a[162:163], v6 offset:6144
  v_mfma_f32_16x16x32_bf16 v[104:107], a[172:175], a[56:59], v[104:107]
  buffer_load_dwordx4 a[104:107], v1, s[8:11], s75 offen offset:0 sc1
  v_mfma_f32_16x16x32_bf16 v[108:111], a[172:175], a[60:63], v[108:111]
  ds_read_b64_tr_b16 a[172:173], v7 offset:0
  v_mfma_f32_16x16x32_bf16 v[108:111], a[168:171], a[44:47], v[108:111]
  s_waitcnt lgkmcnt(5)
  v_mfma_f32_16x16x32_bf16 v[124:127], a[176:179], a[44:47], v[124:127]
  ds_read_b64_tr_b16 a[174:175], v7 offset:2048
  v_mfma_f32_16x16x32_bf16 v[124:127], a[180:183], a[60:63], v[124:127]
  buffer_load_dwordx4 a[120:123], v1, s[8:11], s75 offen offset:1024 sc1
  v_mfma_f32_16x16x32_bf16 v[120:123], a[180:183], a[56:59], v[120:123]
  ds_read_b64_tr_b16 a[168:169], v7 offset:4096
  v_mfma_f32_16x16x32_bf16 v[120:123], a[176:179], a[40:43], v[120:123]
  s_add_u32 s75, s75, 131072
  v_mfma_f32_16x16x32_bf16 v[116:119], a[176:179], a[36:39], v[116:119]
  ds_read_b64_tr_b16 a[170:171], v7 offset:6144
  v_mfma_f32_16x16x32_bf16 v[116:119], a[180:183], a[52:55], v[116:119]
  buffer_load_dwordx4 a[108:111], v1, s[8:11], s75 offen offset:0 sc1
  v_mfma_f32_16x16x32_bf16 v[112:115], a[180:183], a[48:51], v[112:115]
  ds_read_b64_tr_b16 a[180:181], v8 offset:0
  v_mfma_f32_16x16x32_bf16 v[112:115], a[176:179], a[32:35], v[112:115]
  s_waitcnt vmcnt(7) lgkmcnt(5)
  v_mfma_f32_16x16x32_bf16 v[64:67], a[164:167], a[64:67], v[64:67]
  ds_read_b64_tr_b16 a[182:183], v8 offset:2048
  v_mfma_f32_16x16x32_bf16 v[64:67], a[160:163], a[80:83], v[64:67]
  v_mfma_f32_16x16x32_bf16 v[68:71], a[160:163], a[84:87], v[68:71]
  ds_read_b64_tr_b16 a[176:177], v8 offset:4096
  v_mfma_f32_16x16x32_bf16 v[68:71], a[164:167], a[68:71], v[68:71]
  buffer_load_dwordx4 a[124:127], v1, s[8:11], s75 offen offset:1024 sc1
  v_mfma_f32_16x16x32_bf16 v[72:75], a[164:167], a[72:75], v[72:75]
  ds_read_b64_tr_b16 a[178:179], v8 offset:6144
  v_mfma_f32_16x16x32_bf16 v[72:75], a[160:163], a[88:91], v[72:75]
  v_mfma_f32_16x16x32_bf16 v[76:79], a[160:163], a[92:95], v[76:79]
  ds_read_b64_tr_b16 a[160:161], v9 offset:0
  v_mfma_f32_16x16x32_bf16 v[76:79], a[164:167], a[76:79], v[76:79]
  s_waitcnt lgkmcnt(5)
  buffer_load_dwordx4 a[128:131], v1, s[8:11], s76 offen offset:0 sc1
  v_mfma_f32_16x16x32_bf16 v[92:95], a[172:175], a[76:79], v[92:95]
  ds_read_b64_tr_b16 a[162:163], v9 offset:2048
  v_mfma_f32_16x16x32_bf16 v[92:95], a[168:171], a[92:95], v[92:95]
  v_mfma_f32_16x16x32_bf16 v[88:91], a[168:171], a[88:91], v[88:91]
  ds_read_b64_tr_b16 a[164:165], v9 offset:4096
  v_mfma_f32_16x16x32_bf16 v[88:91], a[172:175], a[72:75], v[88:91]
  buffer_load_dwordx4 a[144:147], v1, s[8:11], s76 offen offset:1024 sc1
  v_mfma_f32_16x16x32_bf16 v[84:87], a[172:175], a[68:71], v[84:87]
  ds_read_b64_tr_b16 a[166:167], v9 offset:6144
  v_mfma_f32_16x16x32_bf16 v[84:87], a[168:171], a[84:87], v[84:87]
  s_add_u32 s76, s76, 131072
  v_mfma_f32_16x16x32_bf16 v[80:83], a[168:171], a[80:83], v[80:83]
  ds_read_b64_tr_b16 a[168:169], v2 offset:0
  v_mfma_f32_16x16x32_bf16 v[80:83], a[172:175], a[64:67], v[80:83]
  s_waitcnt lgkmcnt(5)
  buffer_load_dwordx4 a[132:135], v1, s[8:11], s76 offen offset:0 sc1
  v_mfma_f32_16x16x32_bf16 v[96:99], a[180:183], a[64:67], v[96:99]
  ds_read_b64_tr_b16 a[170:171], v2 offset:2048
  v_mfma_f32_16x16x32_bf16 v[96:99], a[176:179], a[80:83], v[96:99]
  v_mfma_f32_16x16x32_bf16 v[100:103], a[176:179], a[84:87], v[100:103]
  ds_read_b64_tr_b16 a[172:173], v2 offset:4096
  v_mfma_f32_16x16x32_bf16 v[100:103], a[180:183], a[68:71], v[100:103]
  v_mfma_f32_16x16x32_bf16 v[104:107], a[180:183], a[72:75], v[104:107]
  ds_read_b64_tr_b16 a[174:175], v2 offset:6144
  v_mfma_f32_16x16x32_bf16 v[104:107], a[176:179], a[88:91], v[104:107]
  buffer_load_dwordx4 a[148:151], v1, s[8:11], s76 offen offset:1024 sc1
  v_mfma_f32_16x16x32_bf16 v[108:111], a[176:179], a[92:95], v[108:111]
  ds_read_b64_tr_b16 a[176:177], v3 offset:0
  v_mfma_f32_16x16x32_bf16 v[108:111], a[180:183], a[76:79], v[108:111]
  s_waitcnt lgkmcnt(5)
  s_add_u32 s76, s76, s89
  v_mfma_f32_16x16x32_bf16 v[124:127], a[160:163], a[76:79], v[124:127]
  ds_read_b64_tr_b16 a[178:179], v3 offset:2048
  v_mfma_f32_16x16x32_bf16 v[124:127], a[164:167], a[92:95], v[124:127]
  buffer_load_dwordx4 a[136:139], v1, s[8:11], s76 offen offset:0 sc1
  v_mfma_f32_16x16x32_bf16 v[120:123], a[164:167], a[88:91], v[120:123]
  ds_read_b64_tr_b16 a[180:181], v3 offset:4096
  v_mfma_f32_16x16x32_bf16 v[120:123], a[160:163], a[72:75], v[120:123]
  v_mfma_f32_16x16x32_bf16 v[116:119], a[160:163], a[68:71], v[116:119]
  ds_read_b64_tr_b16 a[182:183], v3 offset:6144
  v_mfma_f32_16x16x32_bf16 v[116:119], a[164:167], a[84:87], v[116:119]
  buffer_load_dwordx4 a[152:155], v1, s[8:11], s76 offen offset:1024 sc1
  v_mfma_f32_16x16x32_bf16 v[112:115], a[164:167], a[80:83], v[112:115]
  ds_read_b64_tr_b16 a[164:165], v4 offset:0
  v_mfma_f32_16x16x32_bf16 v[112:115], a[160:163], a[64:67], v[112:115]
  s_waitcnt vmcnt(6) lgkmcnt(5)
  s_add_u32 s76, s76, 131072
  v_mfma_f32_16x16x32_bf16 v[64:67], a[168:171], a[96:99], v[64:67]
  ds_read_b64_tr_b16 a[166:167], v4 offset:2048
  v_mfma_f32_16x16x32_bf16 v[64:67], a[172:175], a[112:115], v[64:67]
  buffer_load_dwordx4 a[140:143], v1, s[8:11], s76 offen offset:0 sc1
  v_mfma_f32_16x16x32_bf16 v[68:71], a[172:175], a[116:119], v[68:71]
  ds_read_b64_tr_b16 a[160:161], v4 offset:4096
  v_mfma_f32_16x16x32_bf16 v[68:71], a[168:171], a[100:103], v[68:71]
  v_mfma_f32_16x16x32_bf16 v[72:75], a[168:171], a[104:107], v[72:75]
  ds_read_b64_tr_b16 a[162:163], v4 offset:6144
  v_mfma_f32_16x16x32_bf16 v[72:75], a[172:175], a[120:123], v[72:75]
  v_mfma_f32_16x16x32_bf16 v[76:79], a[172:175], a[124:127], v[76:79]
  ds_read_b64_tr_b16 a[172:173], v5 offset:0
  v_mfma_f32_16x16x32_bf16 v[76:79], a[168:171], a[108:111], v[76:79]
  s_waitcnt lgkmcnt(5)
  buffer_load_dwordx4 a[156:159], v1, s[8:11], s76 offen offset:1024 sc1
  v_mfma_f32_16x16x32_bf16 v[92:95], a[176:179], a[108:111], v[92:95]
  ds_read_b64_tr_b16 a[174:175], v5 offset:2048
  v_mfma_f32_16x16x32_bf16 v[92:95], a[180:183], a[124:127], v[92:95]
  v_mfma_f32_16x16x32_bf16 v[88:91], a[180:183], a[120:123], v[88:91]
  ds_read_b64_tr_b16 a[168:169], v5 offset:4096
  v_mfma_f32_16x16x32_bf16 v[88:91], a[176:179], a[104:107], v[88:91]
  buffer_load_dwordx4 a[188:191], v1, s[8:11], s77 offen offset:0 sc1
  v_mfma_f32_16x16x32_bf16 v[84:87], a[176:179], a[100:103], v[84:87]
  ds_read_b64_tr_b16 a[170:171], v5 offset:6144
  v_mfma_f32_16x16x32_bf16 v[84:87], a[180:183], a[116:119], v[84:87]
  v_mfma_f32_16x16x32_bf16 v[80:83], a[180:183], a[112:115], v[80:83]
  ds_read_b64_tr_b16 a[180:181], v2 offset:32768
  v_mfma_f32_16x16x32_bf16 v[80:83], a[176:179], a[96:99], v[80:83]
  s_waitcnt lgkmcnt(5)
  buffer_load_dwordx4 a[204:207], v1, s[8:11], s77 offen offset:1024 sc1
  v_mfma_f32_16x16x32_bf16 v[96:99], a[164:167], a[96:99], v[96:99]
  ds_read_b64_tr_b16 a[182:183], v2 offset:34816
  v_mfma_f32_16x16x32_bf16 v[96:99], a[160:163], a[112:115], v[96:99]
  s_add_u32 s77, s77, 131072
  v_mfma_f32_16x16x32_bf16 v[100:103], a[160:163], a[116:119], v[100:103]
  ds_read_b64_tr_b16 a[176:177], v2 offset:36864
  v_mfma_f32_16x16x32_bf16 v[100:103], a[164:167], a[100:103], v[100:103]
  buffer_load_dwordx4 a[192:195], v1, s[8:11], s77 offen offset:0 sc1
  v_mfma_f32_16x16x32_bf16 v[104:107], a[164:167], a[104:107], v[104:107]
  ds_read_b64_tr_b16 a[178:179], v2 offset:38912
  v_mfma_f32_16x16x32_bf16 v[104:107], a[160:163], a[120:123], v[104:107]
  v_mfma_f32_16x16x32_bf16 v[108:111], a[160:163], a[124:127], v[108:111]
  ds_read_b64_tr_b16 a[160:161], v3 offset:32768
  v_mfma_f32_16x16x32_bf16 v[108:111], a[164:167], a[108:111], v[108:111]
  s_waitcnt lgkmcnt(5)
  v_mfma_f32_16x16x32_bf16 v[124:127], a[172:175], a[108:111], v[124:127]
  ds_read_b64_tr_b16 a[162:163], v3 offset:34816
  v_mfma_f32_16x16x32_bf16 v[124:127], a[168:171], a[124:127], v[124:127]
  buffer_load_dwordx4 a[208:211], v1, s[8:11], s77 offen offset:1024 sc1
  v_mfma_f32_16x16x32_bf16 v[120:123], a[168:171], a[120:123], v[120:123]
  ds_read_b64_tr_b16 a[164:165], v3 offset:36864
  v_mfma_f32_16x16x32_bf16 v[120:123], a[172:175], a[104:107], v[120:123]
  s_add_u32 s77, s77, s89
  v_mfma_f32_16x16x32_bf16 v[116:119], a[172:175], a[100:103], v[116:119]
  ds_read_b64_tr_b16 a[166:167], v3 offset:38912
  v_mfma_f32_16x16x32_bf16 v[116:119], a[168:171], a[116:119], v[116:119]
  buffer_load_dwordx4 a[196:199], v1, s[8:11], s77 offen offset:0 sc1
  v_mfma_f32_16x16x32_bf16 v[112:115], a[168:171], a[112:115], v[112:115]
  ds_read_b64_tr_b16 a[168:169], v4 offset:32768
  v_mfma_f32_16x16x32_bf16 v[112:115], a[172:175], a[96:99], v[112:115]
  s_waitcnt vmcnt(5) lgkmcnt(5)
  v_mfma_f32_16x16x32_bf16 v[64:67], a[180:183], a[128:131], v[64:67]
  ds_read_b64_tr_b16 a[170:171], v4 offset:34816
  v_mfma_f32_16x16x32_bf16 v[64:67], a[176:179], a[144:147], v[64:67]
  buffer_load_dwordx4 a[212:215], v1, s[8:11], s77 offen offset:1024 sc1
  v_mfma_f32_16x16x32_bf16 v[68:71], a[176:179], a[148:151], v[68:71]
  ds_read_b64_tr_b16 a[172:173], v4 offset:36864
  v_mfma_f32_16x16x32_bf16 v[68:71], a[180:183], a[132:135], v[68:71]
  s_add_u32 s77, s77, 131072
  v_mfma_f32_16x16x32_bf16 v[72:75], a[180:183], a[136:139], v[72:75]
  ds_read_b64_tr_b16 a[174:175], v4 offset:38912
  v_mfma_f32_16x16x32_bf16 v[72:75], a[176:179], a[152:155], v[72:75]
  buffer_load_dwordx4 a[200:203], v1, s[8:11], s77 offen offset:0 sc1
  v_mfma_f32_16x16x32_bf16 v[76:79], a[176:179], a[156:159], v[76:79]
  ds_read_b64_tr_b16 a[176:177], v5 offset:32768
  v_mfma_f32_16x16x32_bf16 v[76:79], a[180:183], a[140:143], v[76:79]
  s_waitcnt lgkmcnt(5)
  v_mfma_f32_16x16x32_bf16 v[92:95], a[160:163], a[140:143], v[92:95]
  ds_read_b64_tr_b16 a[178:179], v5 offset:34816
  v_mfma_f32_16x16x32_bf16 v[92:95], a[164:167], a[156:159], v[92:95]
  v_mfma_f32_16x16x32_bf16 v[88:91], a[164:167], a[152:155], v[88:91]
  ds_read_b64_tr_b16 a[180:181], v5 offset:36864
  v_mfma_f32_16x16x32_bf16 v[88:91], a[160:163], a[136:139], v[88:91]
  buffer_load_dwordx4 a[216:219], v1, s[8:11], s77 offen offset:1024 sc1
  v_mfma_f32_16x16x32_bf16 v[84:87], a[160:163], a[132:135], v[84:87]
  ds_read_b64_tr_b16 a[182:183], v5 offset:38912
  v_mfma_f32_16x16x32_bf16 v[84:87], a[164:167], a[148:151], v[84:87]
  s_add_u32 m0, s45, 8192
  v_mfma_f32_16x16x32_bf16 v[80:83], a[164:167], a[144:147], v[80:83]
  ds_read_b64_tr_b16 a[164:165], v2 offset:49152
  v_mfma_f32_16x16x32_bf16 v[80:83], a[160:163], a[128:131], v[80:83]
  s_waitcnt lgkmcnt(5)
  buffer_load_dwordx4 v33, s[36:39], s67 offen lds
  v_mfma_f32_16x16x32_bf16 v[96:99], a[168:171], a[128:131], v[96:99]
  ds_read_b64_tr_b16 a[166:167], v2 offset:51200
  v_mfma_f32_16x16x32_bf16 v[96:99], a[172:175], a[144:147], v[96:99]
  s_add_u32 m0, s45, 12288
  s_add_u32 s61, s67, 65536
  v_mfma_f32_16x16x32_bf16 v[100:103], a[172:175], a[148:151], v[100:103]
  ds_read_b64_tr_b16 a[160:161], v2 offset:53248
  v_mfma_f32_16x16x32_bf16 v[100:103], a[168:171], a[132:135], v[100:103]
  buffer_load_dwordx4 v33, s[36:39], s61 offen lds
  v_mfma_f32_16x16x32_bf16 v[104:107], a[168:171], a[136:139], v[104:107]
  ds_read_b64_tr_b16 a[162:163], v2 offset:55296
  v_mfma_f32_16x16x32_bf16 v[104:107], a[172:175], a[152:155], v[104:107]
  s_add_u32 m0, s45, 40960
  v_mfma_f32_16x16x32_bf16 v[108:111], a[172:175], a[156:159], v[108:111]
  ds_read_b64_tr_b16 a[172:173], v3 offset:49152
  v_mfma_f32_16x16x32_bf16 v[108:111], a[168:171], a[140:143], v[108:111]
  s_waitcnt lgkmcnt(5)
  buffer_load_dwordx4 v33, s[36:39], s68 offen lds
  v_mfma_f32_16x16x32_bf16 v[124:127], a[176:179], a[140:143], v[124:127]
  ds_read_b64_tr_b16 a[174:175], v3 offset:51200
  v_mfma_f32_16x16x32_bf16 v[124:127], a[180:183], a[156:159], v[124:127]
  v_mfma_f32_16x16x32_bf16 v[120:123], a[180:183], a[152:155], v[120:123]
  ds_read_b64_tr_b16 a[168:169], v3 offset:53248
  v_mfma_f32_16x16x32_bf16 v[120:123], a[176:179], a[136:139], v[120:123]
  s_add_u32 m0, s45, 45056
  s_add_u32 s61, s68, 65536
  v_mfma_f32_16x16x32_bf16 v[116:119], a[176:179], a[132:135], v[116:119]
  ds_read_b64_tr_b16 a[170:171], v3 offset:55296
  v_mfma_f32_16x16x32_bf16 v[116:119], a[180:183], a[148:151], v[116:119]
  buffer_load_dwordx4 v33, s[36:39], s61 offen lds
  v_mfma_f32_16x16x32_bf16 v[112:115], a[180:183], a[144:147], v[112:115]
  ds_read_b64_tr_b16 a[180:181], v4 offset:49152
  v_mfma_f32_16x16x32_bf16 v[112:115], a[176:179], a[128:131], v[112:115]
  s_waitcnt vmcnt(4) lgkmcnt(5)
  s_add_u32 m0, s45, 57344
  v_mfma_f32_16x16x32_bf16 v[64:67], a[164:167], a[188:191], v[64:67]
  ds_read_b64_tr_b16 a[182:183], v4 offset:51200
  v_mfma_f32_16x16x32_bf16 v[64:67], a[160:163], a[204:207], v[64:67]
  buffer_load_dwordx4 v33, s[36:39], s69 offen lds
  v_mfma_f32_16x16x32_bf16 v[68:71], a[160:163], a[208:211], v[68:71]
  ds_read_b64_tr_b16 a[176:177], v4 offset:53248
  v_mfma_f32_16x16x32_bf16 v[68:71], a[164:167], a[192:195], v[68:71]
  s_add_u32 m0, s45, 61440
  s_add_u32 s61, s69, 65536
  v_mfma_f32_16x16x32_bf16 v[72:75], a[164:167], a[196:199], v[72:75]
  ds_read_b64_tr_b16 a[178:179], v4 offset:55296
  v_mfma_f32_16x16x32_bf16 v[72:75], a[160:163], a[212:215], v[72:75]
  buffer_load_dwordx4 v33, s[36:39], s61 offen lds
  v_mfma_f32_16x16x32_bf16 v[76:79], a[160:163], a[216:219], v[76:79]
  ds_read_b64_tr_b16 a[160:161], v5 offset:49152
  v_mfma_f32_16x16x32_bf16 v[76:79], a[164:167], a[200:203], v[76:79]
  s_waitcnt lgkmcnt(5)
  v_mfma_f32_16x16x32_bf16 v[92:95], a[172:175], a[200:203], v[92:95]
  ds_read_b64_tr_b16 a[162:163], v5 offset:51200
  v_mfma_f32_16x16x32_bf16 v[92:95], a[168:171], a[216:219], v[92:95]
  v_mfma_f32_16x16x32_bf16 v[88:91], a[168:171], a[212:215], v[88:91]
  ds_read_b64_tr_b16 a[164:165], v5 offset:53248
  v_cvt_pk_bf16_f32 v72, v72, v73
  v_mfma_f32_16x16x32_bf16 v[88:91], a[172:175], a[196:199], v[88:91]
  v_cvt_pk_bf16_f32 v73, v74, v75
  v_cvt_pk_bf16_f32 v76, v76, v77
  v_mfma_f32_16x16x32_bf16 v[84:87], a[172:175], a[192:195], v[84:87]
  ds_read_b64_tr_b16 a[166:167], v5 offset:55296
  v_cvt_pk_bf16_f32 v77, v78, v79
  v_mfma_f32_16x16x32_bf16 v[84:87], a[168:171], a[208:211], v[84:87]
  v_cvt_pk_bf16_f32 v64, v64, v65
  v_cvt_pk_bf16_f32 v65, v66, v67
  v_mfma_f32_16x16x32_bf16 v[80:83], a[168:171], a[204:207], v[80:83]
  v_cvt_pk_bf16_f32 v68, v68, v69
  v_cvt_pk_bf16_f32 v69, v70, v71
  v_mfma_f32_16x16x32_bf16 v[80:83], a[172:175], a[188:191], v[80:83]
  s_waitcnt lgkmcnt(4)
  s_waitcnt vmcnt(0)
  s_barrier
  v_mfma_f32_16x16x32_bf16 v[96:99], a[180:183], a[188:191], v[96:99]
  ds_read_b64_tr_b16 v[16:17], v6 offset:40960
  v_mfma_f32_16x16x32_bf16 v[96:99], a[176:179], a[204:207], v[96:99]
  ds_read_b64_tr_b16 v[18:19], v6 offset:43008
  v_mfma_f32_16x16x32_bf16 v[100:103], a[176:179], a[208:211], v[100:103]
  ds_read_b64_tr_b16 v[20:21], v6 offset:45056
  v_cvt_pk_bf16_f32 v74, v88, v89
  v_mfma_f32_16x16x32_bf16 v[100:103], a[180:183], a[192:195], v[100:103]
  ds_read_b64_tr_b16 v[22:23], v6 offset:47104
  v_cvt_pk_bf16_f32 v75, v90, v91
  v_mfma_f32_16x16x32_bf16 v[104:107], a[180:183], a[196:199], v[104:107]
  ds_read_b64_tr_b16 v[24:25], v7 offset:40960
  v_mfma_f32_16x16x32_bf16 v[104:107], a[176:179], a[212:215], v[104:107]
  ds_read_b64_tr_b16 v[26:27], v7 offset:43008
  v_mfma_f32_16x16x32_bf16 v[108:111], a[176:179], a[216:219], v[108:111]
  ds_read_b64_tr_b16 v[28:29], v7 offset:45056
  s_add_u32 s87, s86, 0
  buffer_store_dwordx4 v[72:75], v1, s[8:11], s87 offen offset:0 sc1
  v_mfma_f32_16x16x32_bf16 v[108:111], a[180:183], a[200:203], v[108:111]
  s_waitcnt lgkmcnt(7)
  ds_read_b64_tr_b16 v[30:31], v7 offset:47104
  v_mfma_f32_16x16x32_bf16 v[124:127], a[160:163], a[200:203], v[124:127]
  ds_read_b64_tr_b16 a[168:169], v8 offset:40960
  v_cvt_pk_bf16_f32 v78, v92, v93
  v_mfma_f32_16x16x32_bf16 v[124:127], a[164:167], a[216:219], v[124:127]
  ds_read_b64_tr_b16 a[170:171], v8 offset:43008
  v_cvt_pk_bf16_f32 v79, v94, v95
  v_mfma_f32_16x16x32_bf16 v[120:123], a[164:167], a[212:215], v[120:123]
  ds_read_b64_tr_b16 a[172:173], v8 offset:45056
  v_mfma_f32_16x16x32_bf16 v[120:123], a[160:163], a[196:199], v[120:123]
  ds_read_b64_tr_b16 a[174:175], v8 offset:47104
  v_mfma_f32_16x16x32_bf16 v[116:119], a[160:163], a[192:195], v[116:119]
  ds_read_b64_tr_b16 a[176:177], v9 offset:40960
  s_add_u32 s87, s86, 0
  buffer_store_dwordx4 v[76:79], v1, s[8:11], s87 offen offset:2048 sc1
  v_mfma_f32_16x16x32_bf16 v[116:119], a[164:167], a[208:211], v[116:119]
  ds_read_b64_tr_b16 a[178:179], v9 offset:43008
  v_mfma_f32_16x16x32_bf16 v[112:115], a[164:167], a[204:207], v[112:115]
  ds_read_b64_tr_b16 a[180:181], v9 offset:45056
  v_cvt_pk_bf16_f32 v66, v80, v81
  v_mfma_f32_16x16x32_bf16 v[112:115], a[160:163], a[188:191], v[112:115]
  s_waitcnt lgkmcnt(7)
  ds_read_b64_tr_b16 a[182:183], v9 offset:47104
  v_mfma_f32_16x16x32_bf16 v[136:139], v[16:19], a[228:231], v[136:139]
  ds_read_b64_tr_b16 a[164:165], v6 offset:57344
  v_cvt_pk_bf16_f32 v67, v82, v83
  v_mfma_f32_16x16x32_bf16 v[136:139], v[20:23], a[244:247], v[136:139]
  ds_read_b64_tr_b16 a[166:167], v6 offset:59392
  v_mfma_f32_16x16x32_bf16 v[140:143], v[20:23], a[248:251], v[140:143]
  ds_read_b64_tr_b16 a[160:161], v6 offset:61440
  v_mfma_f32_16x16x32_bf16 v[140:143], v[16:19], a[232:235], v[140:143]
  ds_read_b64_tr_b16 a[162:163], v6 offset:63488
  s_add_u32 s87, s86, 4096
  buffer_store_dwordx4 v[64:67], v1, s[8:11], s87 offen offset:0 sc1
  v_mfma_f32_16x16x32_bf16 v[156:159], v[24:27], a[232:235], v[156:159]
  ds_read_b64_tr_b16 v[20:21], v7 offset:57344
  v_mfma_f32_16x16x32_bf16 v[156:159], v[28:31], a[248:251], v[156:159]
  ds_read_b64_tr_b16 v[22:23], v7 offset:59392
  v_cvt_pk_bf16_f32 v70, v84, v85
  v_mfma_f32_16x16x32_bf16 v[152:155], v[28:31], a[244:247], v[152:155]
  ds_read_b64_tr_b16 v[16:17], v7 offset:61440
  v_cvt_pk_bf16_f32 v71, v86, v87
  v_mfma_f32_16x16x32_bf16 v[152:155], v[24:27], a[228:231], v[152:155]
  s_waitcnt lgkmcnt(7)
  ds_read_b64_tr_b16 v[18:19], v7 offset:63488
  v_mfma_f32_16x16x32_bf16 v[168:171], a[168:171], a[228:231], v[168:171]
  ds_read_b64_tr_b16 v[28:29], v8 offset:57344
  v_mfma_f32_16x16x32_bf16 v[168:171], a[172:175], a[244:247], v[168:171]
  ds_read_b64_tr_b16 v[30:31], v8 offset:59392
  s_add_u32 s87, s86, 4096
  buffer_store_dwordx4 v[68:71], v1, s[8:11], s87 offen offset:2048 sc1
  v_mfma_f32_16x16x32_bf16 v[172:175], a[172:175], a[248:251], v[172:175]
  ds_read_b64_tr_b16 v[24:25], v8 offset:61440
  v_mfma_f32_16x16x32_bf16 v[172:175], a[168:171], a[232:235], v[172:175]
  ds_read_b64_tr_b16 v[26:27], v8 offset:63488
  v_cvt_pk_bf16_f32 v104, v104, v105
  v_mfma_f32_16x16x32_bf16 v[188:191], a[176:179], a[232:235], v[188:191]
  ds_read_b64_tr_b16 a[172:173], v9 offset:57344
  v_cvt_pk_bf16_f32 v105, v106, v107
  v_mfma_f32_16x16x32_bf16 v[188:191], a[180:183], a[248:251], v[188:191]
  ds_read_b64_tr_b16 a[174:175], v9 offset:59392
  v_cvt_pk_bf16_f32 v108, v108, v109
  v_mfma_f32_16x16x32_bf16 v[184:187], a[180:183], a[244:247], v[184:187]
  ds_read_b64_tr_b16 a[168:169], v9 offset:61440
  v_cvt_pk_bf16_f32 v109, v110, v111
  v_mfma_f32_16x16x32_bf16 v[184:187], a[176:179], a[228:231], v[184:187]
  s_waitcnt lgkmcnt(7)
  ds_read_b64_tr_b16 a[170:171], v9 offset:63488
  v_mfma_f32_16x16x32_bf16 v[136:139], a[164:167], a[8:11], v[136:139]
  ds_read_b64_tr_b16 a[180:181], v6 offset:24576
  v_cvt_pk_bf16_f32 v96, v96, v97
  v_mfma_f32_16x16x32_bf16 v[136:139], a[160:163], a[24:27], v[136:139]
  ds_read_b64_tr_b16 a[182:183], v6 offset:26624
  v_cvt_pk_bf16_f32 v97, v98, v99
  v_mfma_f32_16x16x32_bf16 v[140:143], a[160:163], a[28:31], v[140:143]
  ds_read_b64_tr_b16 a[176:177], v6 offset:28672
  v_cvt_pk_bf16_f32 v100, v100, v101
  v_mfma_f32_16x16x32_bf16 v[140:143], a[164:167], a[12:15], v[140:143]
  ds_read_b64_tr_b16 a[178:179], v6 offset:30720
  v_cvt_pk_bf16_f32 v101, v102, v103
  v_mfma_f32_16x16x32_bf16 v[156:159], v[20:23], a[12:15], v[156:159]
  ds_read_b64_tr_b16 a[160:161], v7 offset:24576
  v_cvt_pk_bf16_f32 v106, v120, v121
  v_mfma_f32_16x16x32_bf16 v[156:159], v[16:19], a[28:31], v[156:159]
  ds_read_b64_tr_b16 a[162:163], v7 offset:26624
  v_cvt_pk_bf16_f32 v107, v122, v123
  v_mfma_f32_16x16x32_bf16 v[152:155], v[16:19], a[24:27], v[152:155]
  ds_read_b64_tr_b16 a[164:165], v7 offset:28672
  v_mfma_f32_16x16x32_bf16 v[152:155], v[20:23], a[8:11], v[152:155]
  s_waitcnt lgkmcnt(7)
  ds_read_b64_tr_b16 a[166:167], v7 offset:30720
  v_mfma_f32_16x16x32_bf16 v[168:171], v[28:31], a[8:11], v[168:171]
  ds_read_b64_tr_b16 v[16:17], v8 offset:24576
  s_add_u32 s87, s86, 0
  buffer_store_dwordx4 v[104:107], v1, s[8:11], s87 offen offset:1024 sc1
  v_mfma_f32_16x16x32_bf16 v[168:171], v[24:27], a[24:27], v[168:171]
  ds_read_b64_tr_b16 v[18:19], v8 offset:26624
  v_mfma_f32_16x16x32_bf16 v[172:175], v[24:27], a[28:31], v[172:175]
  ds_read_b64_tr_b16 v[20:21], v8 offset:28672
  v_cvt_pk_bf16_f32 v110, v124, v125
  v_mfma_f32_16x16x32_bf16 v[172:175], v[28:31], a[12:15], v[172:175]
  ds_read_b64_tr_b16 v[22:23], v8 offset:30720
  v_cvt_pk_bf16_f32 v111, v126, v127
  v_mfma_f32_16x16x32_bf16 v[188:191], a[172:175], a[12:15], v[188:191]
  ds_read_b64_tr_b16 v[24:25], v9 offset:24576
  v_mfma_f32_16x16x32_bf16 v[188:191], a[168:171], a[28:31], v[188:191]
  ds_read_b64_tr_b16 v[26:27], v9 offset:26624
  v_mfma_f32_16x16x32_bf16 v[184:187], a[168:171], a[24:27], v[184:187]
  ds_read_b64_tr_b16 v[28:29], v9 offset:28672
  s_add_u32 s87, s86, 0
  buffer_store_dwordx4 v[108:111], v1, s[8:11], s87 offen offset:3072 sc1
  v_mfma_f32_16x16x32_bf16 v[184:187], a[172:175], a[8:11], v[184:187]
  s_waitcnt lgkmcnt(7)
  ds_read_b64_tr_b16 v[30:31], v9 offset:30720
  v_mfma_f32_16x16x32_bf16 v[136:139], a[180:183], a[40:43], v[136:139]
  ds_read_b64_tr_b16 a[168:169], v6 offset:8192
  v_cvt_pk_bf16_f32 v98, v112, v113
  v_mfma_f32_16x16x32_bf16 v[136:139], a[176:179], a[56:59], v[136:139]
  ds_read_b64_tr_b16 a[170:171], v6 offset:10240
  v_cvt_pk_bf16_f32 v99, v114, v115
  v_mfma_f32_16x16x32_bf16 v[140:143], a[176:179], a[60:63], v[140:143]
  ds_read_b64_tr_b16 a[172:173], v6 offset:12288
  v_mfma_f32_16x16x32_bf16 v[140:143], a[180:183], a[44:47], v[140:143]
  ds_read_b64_tr_b16 a[174:175], v6 offset:14336
  v_mfma_f32_16x16x32_bf16 v[156:159], a[160:163], a[44:47], v[156:159]
  ds_read_b64_tr_b16 a[176:177], v7 offset:8192
  s_add_u32 s87, s86, 4096
  buffer_store_dwordx4 v[96:99], v1, s[8:11], s87 offen offset:1024 sc1
  v_mfma_f32_16x16x32_bf16 v[156:159], a[164:167], a[60:63], v[156:159]
  ds_read_b64_tr_b16 a[178:179], v7 offset:10240
  v_mfma_f32_16x16x32_bf16 v[152:155], a[164:167], a[56:59], v[152:155]
  ds_read_b64_tr_b16 a[180:181], v7 offset:12288
  v_cvt_pk_bf16_f32 v102, v116, v117
  v_mfma_f32_16x16x32_bf16 v[152:155], a[160:163], a[40:43], v[152:155]
  s_waitcnt lgkmcnt(7)
  ds_read_b64_tr_b16 a[182:183], v7 offset:14336
  v_mfma_f32_16x16x32_bf16 v[168:171], v[16:19], a[40:43], v[168:171]
  ds_read_b64_tr_b16 a[164:165], v8 offset:8192
  v_cvt_pk_bf16_f32 v103, v118, v119
  v_mfma_f32_16x16x32_bf16 v[168:171], v[20:23], a[56:59], v[168:171]
  ds_read_b64_tr_b16 a[166:167], v8 offset:10240
  v_mfma_f32_16x16x32_bf16 v[172:175], v[20:23], a[60:63], v[172:175]
  ds_read_b64_tr_b16 a[160:161], v8 offset:12288
  v_mfma_f32_16x16x32_bf16 v[172:175], v[16:19], a[44:47], v[172:175]
  ds_read_b64_tr_b16 a[162:163], v8 offset:14336
  s_add_u32 s87, s86, 4096
  buffer_store_dwordx4 v[100:103], v1, s[8:11], s87 offen offset:3072 sc1
  v_mfma_f32_16x16x32_bf16 v[188:191], v[24:27], a[44:47], v[188:191]
  ds_read_b64_tr_b16 v[20:21], v9 offset:8192
  v_mfma_f32_16x16x32_bf16 v[188:191], v[28:31], a[60:63], v[188:191]
  ds_read_b64_tr_b16 v[22:23], v9 offset:10240
  v_mfma_f32_16x16x32_bf16 v[184:187], v[28:31], a[56:59], v[184:187]
HOP19:
  s_cbranch_execz WRET1
  ds_read_b64_tr_b16 v[16:17], v9 offset:12288
  v_mfma_f32_16x16x32_bf16 v[184:187], v[24:27], a[40:43], v[184:187]
  s_waitcnt lgkmcnt(7)
  ds_read_b64_tr_b16 v[18:19], v9 offset:14336
  v_mfma_f32_16x16x32_bf16 v[136:139], a[168:171], a[72:75], v[136:139]
  ds_read_b64_tr_b16 v[28:29], v2 offset:8192
  v_mfma_f32_16x16x32_bf16 v[136:139], a[172:175], a[88:91], v[136:139]
  ds_read_b64_tr_b16 v[30:31], v2 offset:10240
  v_mfma_f32_16x16x32_bf16 v[140:143], a[172:175], a[92:95], v[140:143]
  ds_read_b64_tr_b16 v[24:25], v2 offset:12288
  v_mfma_f32_16x16x32_bf16 v[140:143], a[168:171], a[76:79], v[140:143]
  ds_read_b64_tr_b16 v[26:27], v2 offset:14336
  v_mfma_f32_16x16x32_bf16 v[156:159], a[176:179], a[76:79], v[156:159]
  ds_read_b64_tr_b16 a[172:173], v3 offset:8192
  v_mfma_f32_16x16x32_bf16 v[156:159], a[180:183], a[92:95], v[156:159]
  ds_read_b64_tr_b16 a[174:175], v3 offset:10240
  v_mfma_f32_16x16x32_bf16 v[152:155], a[180:183], a[88:91], v[152:155]
  ds_read_b64_tr_b16 a[168:169], v3 offset:12288
  v_mfma_f32_16x16x32_bf16 v[152:155], a[176:179], a[72:75], v[152:155]
  s_waitcnt lgkmcnt(7)
  ds_read_b64_tr_b16 a[170:171], v3 offset:14336
  v_mfma_f32_16x16x32_bf16 v[168:171], a[164:167], a[72:75], v[168:171]
  ds_read_b64_tr_b16 a[180:181], v4 offset:8192
  v_mfma_f32_16x16x32_bf16 v[168:171], a[160:163], a[88:91], v[168:171]
  ds_read_b64_tr_b16 a[182:183], v4 offset:10240
  v_mfma_f32_16x16x32_bf16 v[172:175], a[160:163], a[92:95], v[172:175]
  ds_read_b64_tr_b16 a[176:177], v4 offset:12288
  v_mfma_f32_16x16x32_bf16 v[172:175], a[164:167], a[76:79], v[172:175]
  ds_read_b64_tr_b16 a[178:179], v4 offset:14336
  v_mfma_f32_16x16x32_bf16 v[188:191], v[20:23], a[76:79], v[188:191]
  ds_read_b64_tr_b16 a[160:161], v5 offset:8192
  v_mfma_f32_16x16x32_bf16 v[188:191], v[16:19], a[92:95], v[188:191]
  ds_read_b64_tr_b16 a[162:163], v5 offset:10240
  v_mfma_f32_16x16x32_bf16 v[184:187], v[16:19], a[88:91], v[184:187]
  ds_read_b64_tr_b16 a[164:165], v5 offset:12288
  v_mfma_f32_16x16x32_bf16 v[184:187], v[20:23], a[72:75], v[184:187]
  s_waitcnt lgkmcnt(7)
  ds_read_b64_tr_b16 a[166:167], v5 offset:14336
  v_mfma_f32_16x16x32_bf16 v[136:139], v[28:31], a[104:107], v[136:139]
  ds_read_b64_tr_b16 v[16:17], v2 offset:40960
  v_mfma_f32_16x16x32_bf16 v[136:139], v[24:27], a[120:123], v[136:139]
  ds_read_b64_tr_b16 v[18:19], v2 offset:43008
  v_mfma_f32_16x16x32_bf16 v[140:143], v[24:27], a[124:127], v[140:143]
  ds_read_b64_tr_b16 v[20:21], v2 offset:45056
  v_mfma_f32_16x16x32_bf16 v[140:143], v[28:31], a[108:111], v[140:143]
  ds_read_b64_tr_b16 v[22:23], v2 offset:47104
  v_mfma_f32_16x16x32_bf16 v[156:159], a[172:175], a[108:111], v[156:159]
  ds_read_b64_tr_b16 v[24:25], v3 offset:40960
  v_mfma_f32_16x16x32_bf16 v[156:159], a[168:171], a[124:127], v[156:159]
  ds_read_b64_tr_b16 v[26:27], v3 offset:43008
  v_mfma_f32_16x16x32_bf16 v[152:155], a[168:171], a[120:123], v[152:155]
  ds_read_b64_tr_b16 v[28:29], v3 offset:45056
  v_mfma_f32_16x16x32_bf16 v[152:155], a[172:175], a[104:107], v[152:155]
  s_waitcnt lgkmcnt(7)
  ds_read_b64_tr_b16 v[30:31], v3 offset:47104
  v_mfma_f32_16x16x32_bf16 v[168:171], a[180:183], a[104:107], v[168:171]
  ds_read_b64_tr_b16 a[168:169], v4 offset:40960
  v_mfma_f32_16x16x32_bf16 v[168:171], a[176:179], a[120:123], v[168:171]
  ds_read_b64_tr_b16 a[170:171], v4 offset:43008
  v_mfma_f32_16x16x32_bf16 v[172:175], a[176:179], a[124:127], v[172:175]
  ds_read_b64_tr_b16 a[172:173], v4 offset:45056
  v_mfma_f32_16x16x32_bf16 v[172:175], a[180:183], a[108:111], v[172:175]
  ds_read_b64_tr_b16 a[174:175], v4 offset:47104
  v_mfma_f32_16x16x32_bf16 v[188:191], a[160:163], a[108:111], v[188:191]
  ds_read_b64_tr_b16 a[176:177], v5 offset:40960
  v_mfma_f32_16x16x32_bf16 v[188:191], a[164:167], a[124:127], v[188:191]
  ds_read_b64_tr_b16 a[178:179], v5 offset:43008
  v_mfma_f32_16x16x32_bf16 v[184:187], a[164:167], a[120:123], v[184:187]
  ds_read_b64_tr_b16 a[180:181], v5 offset:45056
  v_mfma_f32_16x16x32_bf16 v[184:187], a[160:163], a[104:107], v[184:187]
  s_waitcnt lgkmcnt(7)
  ds_read_b64_tr_b16 a[182:183], v5 offset:47104
  v_mfma_f32_16x16x32_bf16 v[136:139], v[16:19], a[136:139], v[136:139]
  ds_read_b64_tr_b16 a[164:165], v2 offset:57344
  v_mfma_f32_16x16x32_bf16 v[136:139], v[20:23], a[152:155], v[136:139]
  ds_read_b64_tr_b16 a[166:167], v2 offset:59392
  v_mfma_f32_16x16x32_bf16 v[140:143], v[20:23], a[156:159], v[140:143]
  ds_read_b64_tr_b16 a[160:161], v2 offset:61440
  v_mfma_f32_16x16x32_bf16 v[140:143], v[16:19], a[140:143], v[140:143]
  ds_read_b64_tr_b16 a[162:163], v2 offset:63488
  v_mfma_f32_16x16x32_bf16 v[156:159], v[24:27], a[140:143], v[156:159]
  ds_read_b64_tr_b16 v[20:21], v3 offset:57344
  v_add_u32 v38, s46, v0
  s_waitcnt vmcnt(0)
  s_mov_b64 exec, 1
  buffer_store_dword v38, v0, s[8:11], s81 offen offset:0 sc1
  s_mov_b64 exec, -1
  v_mfma_f32_16x16x32_bf16 v[156:159], v[28:31], a[156:159], v[156:159]
  ds_read_b64_tr_b16 v[22:23], v3 offset:59392
  v_mfma_f32_16x16x32_bf16 v[152:155], v[28:31], a[152:155], v[152:155]
  ds_read_b64_tr_b16 v[16:17], v3 offset:61440
  v_mfma_f32_16x16x32_bf16 v[152:155], v[24:27], a[136:139], v[152:155]
  s_waitcnt lgkmcnt(7)
  ds_read_b64_tr_b16 v[18:19], v3 offset:63488
  v_mfma_f32_16x16x32_bf16 v[168:171], a[168:171], a[136:139], v[168:171]
  ds_read_b64_tr_b16 v[28:29], v4 offset:57344
  v_mfma_f32_16x16x32_bf16 v[168:171], a[172:175], a[152:155], v[168:171]
  ds_read_b64_tr_b16 v[30:31], v4 offset:59392
  v_mfma_f32_16x16x32_bf16 v[172:175], a[172:175], a[156:159], v[172:175]
  ds_read_b64_tr_b16 v[24:25], v4 offset:61440
  v_mfma_f32_16x16x32_bf16 v[172:175], a[168:171], a[140:143], v[172:175]
  ds_read_b64_tr_b16 v[26:27], v4 offset:63488
  v_mfma_f32_16x16x32_bf16 v[188:191], a[176:179], a[140:143], v[188:191]
  ds_read_b64_tr_b16 a[172:173], v5 offset:57344
  v_mfma_f32_16x16x32_bf16 v[188:191], a[180:183], a[156:159], v[188:191]
  ds_read_b64_tr_b16 a[174:175], v5 offset:59392
  v_mfma_f32_16x16x32_bf16 v[184:187], a[180:183], a[152:155], v[184:187]
  ds_read_b64_tr_b16 a[168:169], v5 offset:61440
  v_mfma_f32_16x16x32_bf16 v[184:187], a[176:179], a[136:139], v[184:187]
  s_waitcnt lgkmcnt(7)
  ds_read_b64_tr_b16 a[170:171], v5 offset:63488
  v_mfma_f32_16x16x32_bf16 v[136:139], a[164:167], a[196:199], v[136:139]
  ds_read_b64_tr_b16 a[180:181], v6 offset:40960
  v_mfma_f32_16x16x32_bf16 v[136:139], a[160:163], a[212:215], v[136:139]
  ds_read_b64_tr_b16 a[182:183], v6 offset:43008
  v_mfma_f32_16x16x32_bf16 v[140:143], a[160:163], a[216:219], v[140:143]
  ds_read_b64_tr_b16 a[176:177], v6 offset:45056
  v_mfma_f32_16x16x32_bf16 v[140:143], a[164:167], a[200:203], v[140:143]
  ds_read_b64_tr_b16 a[178:179], v6 offset:47104
  v_mfma_f32_16x16x32_bf16 v[156:159], v[20:23], a[200:203], v[156:159]
  ds_read_b64_tr_b16 a[160:161], v7 offset:40960
  v_mfma_f32_16x16x32_bf16 v[156:159], v[16:19], a[216:219], v[156:159]
  ds_read_b64_tr_b16 a[162:163], v7 offset:43008
  v_mfma_f32_16x16x32_bf16 v[152:155], v[16:19], a[212:215], v[152:155]
  ds_read_b64_tr_b16 a[164:165], v7 offset:45056
  v_cvt_pk_bf16_f32 v136, v136, v137
  v_cvt_pk_bf16_f32 v137, v138, v139
  v_cvt_pk_bf16_f32 v140, v140, v141
  v_cvt_pk_bf16_f32 v141, v142, v143
  v_mfma_f32_16x16x32_bf16 v[152:155], v[20:23], a[196:199], v[152:155]
  s_waitcnt lgkmcnt(7)
  ds_read_b64_tr_b16 a[166:167], v7 offset:47104
  v_mfma_f32_16x16x32_bf16 v[168:171], v[28:31], a[196:199], v[168:171]
  ds_read_b64_tr_b16 v[16:17], v8 offset:40960
  v_mfma_f32_16x16x32_bf16 v[168:171], v[24:27], a[212:215], v[168:171]
  ds_read_b64_tr_b16 v[18:19], v8 offset:43008
  v_mfma_f32_16x16x32_bf16 v[172:175], v[24:27], a[216:219], v[172:175]
  ds_read_b64_tr_b16 v[20:21], v8 offset:45056
  v_cvt_pk_bf16_f32 v138, v152, v153
  v_cvt_pk_bf16_f32 v139, v154, v155
  v_mfma_f32_16x16x32_bf16 v[172:175], v[28:31], a[200:203], v[172:175]
  ds_read_b64_tr_b16 v[22:23], v8 offset:47104
  v_mfma_f32_16x16x32_bf16 v[188:191], a[172:175], a[200:203], v[188:191]
  ds_read_b64_tr_b16 v[24:25], v9 offset:40960
  v_mfma_f32_16x16x32_bf16 v[188:191], a[168:171], a[216:219], v[188:191]
  ds_read_b64_tr_b16 v[26:27], v9 offset:43008
  s_add_u32 s87, s86, 8192
  buffer_store_dwordx4 v[136:139], v1, s[8:11], s87 offen offset:0 sc1
  v_mfma_f32_16x16x32_bf16 v[184:187], a[168:171], a[212:215], v[184:187]
  ds_read_b64_tr_b16 v[28:29], v9 offset:45056
  v_cvt_pk_bf16_f32 v142, v156, v157
  v_cvt_pk_bf16_f32 v143, v158, v159
  v_mfma_f32_16x16x32_bf16 v[184:187], a[172:175], a[196:199], v[184:187]
  s_waitcnt lgkmcnt(7)
  ds_read_b64_tr_b16 v[30:31], v9 offset:47104
  v_mfma_f32_16x16x32_bf16 v[128:131], a[180:183], a[220:223], v[128:131]
  ds_read_b64_tr_b16 a[168:169], v6 offset:57344
  v_mfma_f32_16x16x32_bf16 v[128:131], a[176:179], a[236:239], v[128:131]
  ds_read_b64_tr_b16 a[170:171], v6 offset:59392
  s_add_u32 s87, s86, 8192
  buffer_store_dwordx4 v[140:143], v1, s[8:11], s87 offen offset:2048 sc1
  v_mfma_f32_16x16x32_bf16 v[132:135], a[176:179], a[240:243], v[132:135]
  ds_read_b64_tr_b16 a[172:173], v6 offset:61440
  v_cvt_pk_bf16_f32 v168, v168, v169
  v_cvt_pk_bf16_f32 v169, v170, v171
  v_cvt_pk_bf16_f32 v172, v172, v173
  v_cvt_pk_bf16_f32 v173, v174, v175
  v_mfma_f32_16x16x32_bf16 v[132:135], a[180:183], a[224:227], v[132:135]
  ds_read_b64_tr_b16 a[174:175], v6 offset:63488
  v_cvt_pk_bf16_f32 v170, v184, v185
  v_cvt_pk_bf16_f32 v171, v186, v187
  v_mfma_f32_16x16x32_bf16 v[148:151], a[160:163], a[224:227], v[148:151]
  ds_read_b64_tr_b16 a[176:177], v7 offset:57344
  v_mfma_f32_16x16x32_bf16 v[148:151], a[164:167], a[240:243], v[148:151]
  ds_read_b64_tr_b16 a[178:179], v7 offset:59392
  v_mfma_f32_16x16x32_bf16 v[144:147], a[164:167], a[236:239], v[144:147]
  ds_read_b64_tr_b16 a[180:181], v7 offset:61440
  s_add_u32 s87, s86, 8192
  buffer_store_dwordx4 v[168:171], v1, s[8:11], s87 offen offset:1024 sc1
  v_mfma_f32_16x16x32_bf16 v[144:147], a[160:163], a[220:223], v[144:147]
  s_waitcnt lgkmcnt(7)
  ds_read_b64_tr_b16 a[182:183], v7 offset:63488
  v_cvt_pk_bf16_f32 v174, v188, v189
  v_cvt_pk_bf16_f32 v175, v190, v191
  v_mfma_f32_16x16x32_bf16 v[160:163], v[16:19], a[220:223], v[160:163]
  ds_read_b64_tr_b16 a[164:165], v8 offset:57344
  v_mfma_f32_16x16x32_bf16 v[160:163], v[20:23], a[236:239], v[160:163]
  ds_read_b64_tr_b16 a[166:167], v8 offset:59392
  v_mfma_f32_16x16x32_bf16 v[164:167], v[20:23], a[240:243], v[164:167]
  ds_read_b64_tr_b16 a[160:161], v8 offset:61440
  s_add_u32 s87, s86, 8192
  buffer_store_dwordx4 v[172:175], v1, s[8:11], s87 offen offset:3072 sc1
  v_mfma_f32_16x16x32_bf16 v[164:167], v[16:19], a[224:227], v[164:167]
  ds_read_b64_tr_b16 a[162:163], v8 offset:63488
  v_mfma_f32_16x16x32_bf16 v[180:183], v[24:27], a[224:227], v[180:183]
  ds_read_b64_tr_b16 v[20:21], v9 offset:57344
  v_mfma_f32_16x16x32_bf16 v[180:183], v[28:31], a[240:243], v[180:183]
  ds_read_b64_tr_b16 v[22:23], v9 offset:59392
  v_mfma_f32_16x16x32_bf16 v[176:179], v[28:31], a[236:239], v[176:179]
  ds_read_b64_tr_b16 v[16:17], v9 offset:61440
  v_mfma_f32_16x16x32_bf16 v[176:179], v[24:27], a[220:223], v[176:179]
  s_waitcnt lgkmcnt(7)
  ds_read_b64_tr_b16 v[18:19], v9 offset:63488
  v_mfma_f32_16x16x32_bf16 v[128:131], a[168:171], a[0:3], v[128:131]
  ds_read_b64_tr_b16 v[28:29], v6 offset:24576
  v_mfma_f32_16x16x32_bf16 v[128:131], a[172:175], a[16:19], v[128:131]
  ds_read_b64_tr_b16 v[30:31], v6 offset:26624
  v_mfma_f32_16x16x32_bf16 v[132:135], a[172:175], a[20:23], v[132:135]
  ds_read_b64_tr_b16 v[24:25], v6 offset:28672
  v_mfma_f32_16x16x32_bf16 v[132:135], a[168:171], a[4:7], v[132:135]
  ds_read_b64_tr_b16 v[26:27], v6 offset:30720
  v_mfma_f32_16x16x32_bf16 v[148:151], a[176:179], a[4:7], v[148:151]
  ds_read_b64_tr_b16 a[172:173], v7 offset:24576
  v_mfma_f32_16x16x32_bf16 v[148:151], a[180:183], a[20:23], v[148:151]
  ds_read_b64_tr_b16 a[174:175], v7 offset:26624
  v_mfma_f32_16x16x32_bf16 v[144:147], a[180:183], a[16:19], v[144:147]
  ds_read_b64_tr_b16 a[168:169], v7 offset:28672
  v_mfma_f32_16x16x32_bf16 v[144:147], a[176:179], a[0:3], v[144:147]
  s_waitcnt lgkmcnt(7)
  ds_read_b64_tr_b16 a[170:171], v7 offset:30720
  v_mfma_f32_16x16x32_bf16 v[160:163], a[164:167], a[0:3], v[160:163]
  ds_read_b64_tr_b16 a[180:181], v8 offset:24576
  v_mfma_f32_16x16x32_bf16 v[160:163], a[160:163], a[16:19], v[160:163]
  ds_read_b64_tr_b16 a[182:183], v8 offset:26624
  v_mfma_f32_16x16x32_bf16 v[164:167], a[160:163], a[20:23], v[164:167]
  ds_read_b64_tr_b16 a[176:177], v8 offset:28672
  v_mfma_f32_16x16x32_bf16 v[164:167], a[164:167], a[4:7], v[164:167]
  ds_read_b64_tr_b16 a[178:179], v8 offset:30720
  v_mfma_f32_16x16x32_bf16 v[180:183], v[20:23], a[4:7], v[180:183]
  ds_read_b64_tr_b16 a[160:161], v9 offset:24576
  v_mfma_f32_16x16x32_bf16 v[180:183], v[16:19], a[20:23], v[180:183]
  ds_read_b64_tr_b16 a[162:163], v9 offset:26624
  v_mfma_f32_16x16x32_bf16 v[176:179], v[16:19], a[16:19], v[176:179]
  ds_read_b64_tr_b16 a[164:165], v9 offset:28672
  v_mfma_f32_16x16x32_bf16 v[176:179], v[20:23], a[0:3], v[176:179]
  s_waitcnt lgkmcnt(7)
  ds_read_b64_tr_b16 a[166:167], v9 offset:30720
  v_mfma_f32_16x16x32_bf16 v[128:131], v[28:31], a[32:35], v[128:131]
  ds_read_b64_tr_b16 v[16:17], v6 offset:8192
  v_mfma_f32_16x16x32_bf16 v[128:131], v[24:27], a[48:51], v[128:131]
  ds_read_b64_tr_b16 v[18:19], v6 offset:10240
  v_mfma_f32_16x16x32_bf16 v[132:135], v[24:27], a[52:55], v[132:135]
  ds_read_b64_tr_b16 v[20:21], v6 offset:12288
  v_mfma_f32_16x16x32_bf16 v[132:135], v[28:31], a[36:39], v[132:135]
  ds_read_b64_tr_b16 v[22:23], v6 offset:14336
  v_mfma_f32_16x16x32_bf16 v[148:151], a[172:175], a[36:39], v[148:151]
  ds_read_b64_tr_b16 v[24:25], v7 offset:8192
  v_mfma_f32_16x16x32_bf16 v[148:151], a[168:171], a[52:55], v[148:151]
  ds_read_b64_tr_b16 v[26:27], v7 offset:10240
  s_xor_b32 s84, s81, 1536
  s_add_u32 s84, s84, 0
  buffer_load_dword v34, v37, s[8:11], s84 offen sc1
  v_mfma_f32_16x16x32_bf16 v[144:147], a[168:171], a[48:51], v[144:147]
  ds_read_b64_tr_b16 v[28:29], v7 offset:12288
  s_xor_b32 s91, s81, 512
  s_add_u32 s91, s91, 0
  buffer_load_dword v39, v37, s[8:11], s91 offen sc1
  v_mfma_f32_16x16x32_bf16 v[144:147], a[172:175], a[32:35], v[144:147]
  s_waitcnt lgkmcnt(7)
  ds_read_b64_tr_b16 v[30:31], v7 offset:14336
  v_mfma_f32_16x16x32_bf16 v[160:163], a[180:183], a[32:35], v[160:163]
  ds_read_b64_tr_b16 a[168:169], v8 offset:8192
  v_mfma_f32_16x16x32_bf16 v[160:163], a[176:179], a[48:51], v[160:163]
  ds_read_b64_tr_b16 a[170:171], v8 offset:10240
  v_mfma_f32_16x16x32_bf16 v[164:167], a[176:179], a[52:55], v[164:167]
  ds_read_b64_tr_b16 a[172:173], v8 offset:12288
  v_mfma_f32_16x16x32_bf16 v[164:167], a[180:183], a[36:39], v[164:167]
  ds_read_b64_tr_b16 a[174:175], v8 offset:14336
  v_mfma_f32_16x16x32_bf16 v[180:183], a[160:163], a[36:39], v[180:183]
  ds_read_b64_tr_b16 a[176:177], v9 offset:8192
  v_mfma_f32_16x16x32_bf16 v[180:183], a[164:167], a[52:55], v[180:183]
  ds_read_b64_tr_b16 a[178:179], v9 offset:10240
  v_mfma_f32_16x16x32_bf16 v[176:179], a[164:167], a[48:51], v[176:179]
  ds_read_b64_tr_b16 a[180:181], v9 offset:12288
  v_mfma_f32_16x16x32_bf16 v[176:179], a[160:163], a[32:35], v[176:179]
  s_waitcnt lgkmcnt(7)
  ds_read_b64_tr_b16 a[182:183], v9 offset:14336
  v_add_u32 v38, s46, v0
  s_waitcnt vmcnt(2)
  s_mov_b64 exec, 1
  buffer_store_dword v38, v0, s[8:11], s81 offen offset:16 sc1
  s_mov_b64 exec, -1
  v_mfma_f32_16x16x32_bf16 v[128:131], v[16:19], a[64:67], v[128:131]
  ds_read_b64_tr_b16 a[164:165], v2 offset:8192
  v_mfma_f32_16x16x32_bf16 v[128:131], v[20:23], a[80:83], v[128:131]
  ds_read_b64_tr_b16 a[166:167], v2 offset:10240
  v_mfma_f32_16x16x32_bf16 v[132:135], v[20:23], a[84:87], v[132:135]
  ds_read_b64_tr_b16 a[160:161], v2 offset:12288
  v_mfma_f32_16x16x32_bf16 v[132:135], v[16:19], a[68:71], v[132:135]
  ds_read_b64_tr_b16 a[162:163], v2 offset:14336
  s_xor_b32 s82, s81, 1024
  s_add_u32 s82, s82, 16
  buffer_load_dword v36, v37, s[8:11], s82 offen sc1
  v_mfma_f32_16x16x32_bf16 v[148:151], v[24:27], a[68:71], v[148:151]
  ds_read_b64_tr_b16 v[20:21], v3 offset:8192
  v_mfma_f32_16x16x32_bf16 v[148:151], v[28:31], a[84:87], v[148:151]
  ds_read_b64_tr_b16 v[22:23], v3 offset:10240
  v_mfma_f32_16x16x32_bf16 v[144:147], v[28:31], a[80:83], v[144:147]
  ds_read_b64_tr_b16 v[16:17], v3 offset:12288
  v_mfma_f32_16x16x32_bf16 v[144:147], v[24:27], a[64:67], v[144:147]
  s_waitcnt lgkmcnt(7)
  ds_read_b64_tr_b16 v[18:19], v3 offset:14336
  v_mfma_f32_16x16x32_bf16 v[160:163], a[168:171], a[64:67], v[160:163]
  ds_read_b64_tr_b16 v[28:29], v4 offset:8192
  v_mfma_f32_16x16x32_bf16 v[160:163], a[172:175], a[80:83], v[160:163]
  ds_read_b64_tr_b16 v[30:31], v4 offset:10240
  v_mfma_f32_16x16x32_bf16 v[164:167], a[172:175], a[84:87], v[164:167]
  ds_read_b64_tr_b16 v[24:25], v4 offset:12288
  v_mfma_f32_16x16x32_bf16 v[164:167], a[168:171], a[68:71], v[164:167]
  ds_read_b64_tr_b16 v[26:27], v4 offset:14336
  v_mfma_f32_16x16x32_bf16 v[180:183], a[176:179], a[68:71], v[180:183]
  ds_read_b64_tr_b16 a[172:173], v5 offset:8192
  v_mfma_f32_16x16x32_bf16 v[180:183], a[180:183], a[84:87], v[180:183]
  ds_read_b64_tr_b16 a[174:175], v5 offset:10240
  v_mfma_f32_16x16x32_bf16 v[176:179], a[180:183], a[80:83], v[176:179]
  ds_read_b64_tr_b16 a[168:169], v5 offset:12288
  v_mfma_f32_16x16x32_bf16 v[176:179], a[176:179], a[64:67], v[176:179]
  s_waitcnt lgkmcnt(7)
  ds_read_b64_tr_b16 a[170:171], v5 offset:14336
  v_mfma_f32_16x16x32_bf16 v[128:131], a[164:167], a[96:99], v[128:131]
  ds_read_b64_tr_b16 a[180:181], v2 offset:40960
  v_mfma_f32_16x16x32_bf16 v[128:131], a[160:163], a[112:115], v[128:131]
  ds_read_b64_tr_b16 a[182:183], v2 offset:43008
  s_waitcnt vmcnt(3)
  v_cmp_ne_u32 vcc, s46, v34
  s_nop 4
  s_cbranch_vccz PL14_adaLN_cond__sliding_local_dilated__swiglu_ffn__prompt_kernelx
  s_mov_b32 s83, 60000
PL14_adaLN_cond__sliding_local_dilated__swiglu_ffn__prompt_kernel:
  buffer_load_dword v34, v37, s[8:11], s84 offen sc1
  s_sub_u32 s83, s83, 1
  s_cmp_eq_u32 s83, 0
  s_waitcnt vmcnt(0)
  s_cbranch_scc1 PL14_adaLN_cond__sliding_local_dilated__swiglu_ffn__prompt_kernelx
  v_cmp_ne_u32 vcc, s46, v34
  s_nop 4
  s_cbranch_vccnz PL14_adaLN_cond__sliding_local_dilated__swiglu_ffn__prompt_kernel
PL14_adaLN_cond__sliding_local_dilated__swiglu_ffn__prompt_kernelx:
  v_mfma_f32_16x16x32_bf16 v[132:135], a[160:163], a[116:119], v[132:135]
  ds_read_b64_tr_b16 a[176:177], v2 offset:45056
  s_xor_b32 s55, s86, 196608
  s_add_u32 s55, s55, 0
  buffer_load_dwordx4 v[88:91], v1, s[8:11], s55 offen offset:0 sc1
  v_mfma_f32_16x16x32_bf16 v[132:135], a[164:167], a[100:103], v[132:135]
  ds_read_b64_tr_b16 a[178:179], v2 offset:47104
  s_xor_b32 s55, s86, 196608
  s_add_u32 s55, s55, 0
  buffer_load_dwordx4 v[120:123], v1, s[8:11], s55 offen offset:1024 sc1
  v_mfma_f32_16x16x32_bf16 v[148:151], v[20:23], a[100:103], v[148:151]
  ds_read_b64_tr_b16 a[160:161], v3 offset:40960
  s_xor_b32 s55, s86, 196608
  s_add_u32 s55, s55, 0
  buffer_load_dwordx4 v[92:95], v1, s[8:11], s55 offen offset:2048 sc1
  v_mfma_f32_16x16x32_bf16 v[148:151], v[16:19], a[116:119], v[148:151]
  ds_read_b64_tr_b16 a[162:163], v3 offset:43008
  s_xor_b32 s55, s86, 196608
  s_add_u32 s55, s55, 0
  buffer_load_dwordx4 v[124:127], v1, s[8:11], s55 offen offset:3072 sc1
  v_mfma_f32_16x16x32_bf16 v[144:147], v[16:19], a[112:115], v[144:147]
  ds_read_b64_tr_b16 a[164:165], v3 offset:45056
  s_waitcnt vmcnt(6)
  v_cmp_ne_u32 vcc, s46, v39
  s_nop 4
  s_cbranch_vccz PL15_adaLN_cond__sliding_local_dilated__swiglu_ffn__prompt_kernelx
  s_mov_b32 s83, 60000
PL15_adaLN_cond__sliding_local_dilated__swiglu_ffn__prompt_kernel:
  buffer_load_dword v39, v37, s[8:11], s91 offen sc1
  s_sub_u32 s83, s83, 1
  s_cmp_eq_u32 s83, 0
  s_waitcnt vmcnt(0)
  s_cbranch_scc1 PL15_adaLN_cond__sliding_local_dilated__swiglu_ffn__prompt_kernelx
  v_cmp_ne_u32 vcc, s46, v39
  s_nop 4
  s_cbranch_vccnz PL15_adaLN_cond__sliding_local_dilated__swiglu_ffn__prompt_kernel
PL15_adaLN_cond__sliding_local_dilated__swiglu_ffn__prompt_kernelx:
  v_mfma_f32_16x16x32_bf16 v[144:147], v[20:23], a[96:99], v[144:147]
  s_waitcnt lgkmcnt(7)
  ds_read_b64_tr_b16 a[166:167], v3 offset:47104
  s_xor_b32 s55, s86, 65536
  s_add_u32 s55, s55, 4096
  buffer_load_dwordx4 v[80:83], v1, s[8:11], s55 offen offset:0 sc1
  v_mfma_f32_16x16x32_bf16 v[160:163], v[28:31], a[96:99], v[160:163]
  ds_read_b64_tr_b16 v[16:17], v4 offset:40960
  s_xor_b32 s55, s86, 65536
  s_add_u32 s55, s55, 4096
  buffer_load_dwordx4 v[112:115], v1, s[8:11], s55 offen offset:1024 sc1
  v_mfma_f32_16x16x32_bf16 v[160:163], v[24:27], a[112:115], v[160:163]
  ds_read_b64_tr_b16 v[18:19], v4 offset:43008
  s_xor_b32 s55, s86, 65536
  s_add_u32 s55, s55, 4096
  buffer_load_dwordx4 v[84:87], v1, s[8:11], s55 offen offset:2048 sc1
  v_mfma_f32_16x16x32_bf16 v[164:167], v[24:27], a[116:119], v[164:167]
  ds_read_b64_tr_b16 v[20:21], v4 offset:45056
  s_xor_b32 s55, s86, 65536
  s_add_u32 s55, s55, 4096
  buffer_load_dwordx4 v[116:119], v1, s[8:11], s55 offen offset:3072 sc1
  v_mfma_f32_16x16x32_bf16 v[164:167], v[28:31], a[100:103], v[164:167]
  ds_read_b64_tr_b16 v[22:23], v4 offset:47104
  v_mfma_f32_16x16x32_bf16 v[180:183], a[172:175], a[100:103], v[180:183]
  ds_read_b64_tr_b16 v[24:25], v5 offset:40960
  v_mfma_f32_16x16x32_bf16 v[180:183], a[168:171], a[116:119], v[180:183]
  ds_read_b64_tr_b16 v[26:27], v5 offset:43008
  s_waitcnt vmcnt(8)
  v_cmp_ne_u32 vcc, s46, v36
  s_mov_b32 s87, 0
  s_nop 3
  s_cbranch_vccnz XL16_adaLN_cond__sliding_local_dilated__swiglu_ffn__prompt_kernel
  s_xor_b32 s55, s86, 131072
  s_add_u32 s55, s55, 8192
  buffer_load_dwordx4 v[152:155], v1, s[8:11], s55 offen offset:0 sc1
  buffer_load_dwordx4 v[184:187], v1, s[8:11], s55 offen offset:1024 sc1
  buffer_load_dwordx4 v[156:159], v1, s[8:11], s55 offen offset:2048 sc1
  buffer_load_dwordx4 v[188:191], v1, s[8:11], s55 offen offset:3072 sc1
  s_mov_b32 s87, 1
XL16_adaLN_cond__sliding_local_dilated__swiglu_ffn__prompt_kernel:
  v_mfma_f32_16x16x32_bf16 v[176:179], a[168:171], a[112:115], v[176:179]
  ds_read_b64_tr_b16 v[28:29], v5 offset:45056
  v_mfma_f32_16x16x32_bf16 v[176:179], a[172:175], a[96:99], v[176:179]
  s_waitcnt lgkmcnt(7)
  ds_read_b64_tr_b16 v[30:31], v5 offset:47104
  v_mfma_f32_16x16x32_bf16 v[128:131], a[180:183], a[128:131], v[128:131]
  ds_read_b64_tr_b16 a[168:169], v2 offset:57344
  v_mfma_f32_16x16x32_bf16 v[128:131], a[176:179], a[144:147], v[128:131]
  ds_read_b64_tr_b16 a[170:171], v2 offset:59392
  v_mfma_f32_16x16x32_bf16 v[132:135], a[176:179], a[148:151], v[132:135]
  ds_read_b64_tr_b16 a[172:173], v2 offset:61440
  v_mfma_f32_16x16x32_bf16 v[132:135], a[180:183], a[132:135], v[132:135]
  ds_read_b64_tr_b16 a[174:175], v2 offset:63488
  v_mfma_f32_16x16x32_bf16 v[148:151], a[160:163], a[132:135], v[148:151]
  ds_read_b64_tr_b16 a[176:177], v3 offset:57344
  v_mfma_f32_16x16x32_bf16 v[148:151], a[164:167], a[148:151], v[148:151]
  ds_read_b64_tr_b16 a[178:179], v3 offset:59392
  v_mfma_f32_16x16x32_bf16 v[144:147], a[164:167], a[144:147], v[144:147]
  ds_read_b64_tr_b16 a[180:181], v3 offset:61440
  v_mfma_f32_16x16x32_bf16 v[144:147], a[160:163], a[128:131], v[144:147]
  s_waitcnt lgkmcnt(7)
  ds_read_b64_tr_b16 a[182:183], v3 offset:63488
  v_mfma_f32_16x16x32_bf16 v[160:163], v[16:19], a[128:131], v[160:163]
  ds_read_b64_tr_b16 a[164:165], v4 offset:57344
  v_mfma_f32_16x16x32_bf16 v[160:163], v[20:23], a[144:147], v[160:163]
  ds_read_b64_tr_b16 a[166:167], v4 offset:59392
  v_mfma_f32_16x16x32_bf16 v[164:167], v[20:23], a[148:151], v[164:167]
  ds_read_b64_tr_b16 a[160:161], v4 offset:61440
  v_mfma_f32_16x16x32_bf16 v[164:167], v[16:19], a[132:135], v[164:167]
  ds_read_b64_tr_b16 a[162:163], v4 offset:63488
  v_mfma_f32_16x16x32_bf16 v[180:183], v[24:27], a[132:135], v[180:183]
  ds_read_b64_tr_b16 v[20:21], v5 offset:57344
  v_mfma_f32_16x16x32_bf16 v[180:183], v[28:31], a[148:151], v[180:183]
  ds_read_b64_tr_b16 v[22:23], v5 offset:59392
  v_mfma_f32_16x16x32_bf16 v[176:179], v[28:31], a[144:147], v[176:179]
  ds_read_b64_tr_b16 v[16:17], v5 offset:61440
  v_mfma_f32_16x16x32_bf16 v[176:179], v[24:27], a[128:131], v[176:179]
  s_waitcnt lgkmcnt(7)
  ds_read_b64_tr_b16 v[18:19], v5 offset:63488
  v_mfma_f32_16x16x32_bf16 v[128:131], a[168:171], a[188:191], v[128:131]
  v_mfma_f32_16x16x32_bf16 v[128:131], a[172:175], a[204:207], v[128:131]
  v_mfma_f32_16x16x32_bf16 v[132:135], a[172:175], a[208:211], v[132:135]
  v_mfma_f32_16x16x32_bf16 v[132:135], a[168:171], a[192:195], v[132:135]
  v_mfma_f32_16x16x32_bf16 v[148:151], a[176:179], a[192:195], v[148:151]
  v_mfma_f32_16x16x32_bf16 v[148:151], a[180:183], a[208:211], v[148:151]
  v_mfma_f32_16x16x32_bf16 v[144:147], a[180:183], a[204:207], v[144:147]
  v_mfma_f32_16x16x32_bf16 v[144:147], a[176:179], a[188:191], v[144:147]
  s_waitcnt lgkmcnt(0)
  v_mfma_f32_16x16x32_bf16 v[160:163], a[164:167], a[188:191], v[160:163]
  v_mfma_f32_16x16x32_bf16 v[160:163], a[160:163], a[204:207], v[160:163]
  v_mfma_f32_16x16x32_bf16 v[164:167], a[160:163], a[208:211], v[164:167]
  v_mfma_f32_16x16x32_bf16 v[164:167], a[164:167], a[192:195], v[164:167]
  v_mfma_f32_16x16x32_bf16 v[180:183], v[20:23], a[192:195], v[180:183]
  v_mfma_f32_16x16x32_bf16 v[180:183], v[16:19], a[208:211], v[180:183]
  v_mfma_f32_16x16x32_bf16 v[176:179], v[16:19], a[204:207], v[176:179]
  v_mfma_f32_16x16x32_bf16 v[176:179], v[20:23], a[188:191], v[176:179]
  s_waitcnt vmcnt(0)
  v_mfma_f32_16x16x32_bf16 v[208:211], v[52:55], v[88:91], v[208:211]
  v_mfma_f32_16x16x32_bf16 v[212:215], v[54:57], v[88:91], v[212:215]
  v_mfma_f32_16x16x32_bf16 v[216:219], v[58:61], v[120:123], v[216:219]
  v_mfma_f32_16x16x32_bf16 v[220:223], v[60:63], v[120:123], v[220:223]
  v_mfma_f32_16x16x32_bf16 v[224:227], v[52:55], v[92:95], v[224:227]
  v_mfma_f32_16x16x32_bf16 v[228:231], v[54:57], v[92:95], v[228:231]
  v_mfma_f32_16x16x32_bf16 v[232:235], v[58:61], v[124:127], v[232:235]
  v_mfma_f32_16x16x32_bf16 v[236:239], v[60:63], v[124:127], v[236:239]
  v_mfma_f32_16x16x32_bf16 v[208:211], v[52:55], v[80:83], v[208:211]
  v_mfma_f32_16x16x32_bf16 v[212:215], v[54:57], v[80:83], v[212:215]
  v_mfma_f32_16x16x32_bf16 v[216:219], v[58:61], v[112:115], v[216:219]
  v_mfma_f32_16x16x32_bf16 v[220:223], v[60:63], v[112:115], v[220:223]
  v_mfma_f32_16x16x32_bf16 v[224:227], v[52:55], v[84:87], v[224:227]
  v_mfma_f32_16x16x32_bf16 v[228:231], v[54:57], v[84:87], v[228:231]
  v_mfma_f32_16x16x32_bf16 v[232:235], v[58:61], v[116:119], v[232:235]
  v_mfma_f32_16x16x32_bf16 v[236:239], v[60:63], v[116:119], v[236:239]
  s_nop 0
  v_fmac_f32 v208, v240, v128
  v_fmac_f32 v209, v241, v129
  v_fmac_f32 v210, v242, v130
  v_fmac_f32 v211, v243, v131
  v_fmac_f32 v212, v244, v144
  v_fmac_f32 v213, v245, v145
  v_fmac_f32 v214, v246, v146
  v_fmac_f32 v215, v247, v147
  v_fmac_f32 v224, v240, v132
  v_fmac_f32 v225, v241, v133
  v_fmac_f32 v226, v242, v134
  v_fmac_f32 v227, v243, v135
  v_fmac_f32 v228, v244, v148
  v_fmac_f32 v229, v245, v149
  v_fmac_f32 v230, v246, v150
  v_fmac_f32 v231, v247, v151
  v_fmac_f32 v216, v248, v160
  v_fmac_f32 v217, v249, v161
  v_fmac_f32 v218, v250, v162
  v_fmac_f32 v219, v251, v163
  v_fmac_f32 v220, v252, v176
  v_fmac_f32 v221, v253, v177
  v_fmac_f32 v222, v254, v178
  v_fmac_f32 v223, v255, v179
  v_fmac_f32 v232, v248, v164
  v_fmac_f32 v233, v249, v165
  v_fmac_f32 v234, v250, v166
  v_fmac_f32 v235, v251, v167
  v_fmac_f32 v236, v252, v180
  v_fmac_f32 v237, v253, v181
  v_fmac_f32 v238, v254, v182
  v_fmac_f32 v239, v255, v183
  s_cmp_eq_u32 s87, 1
  s_cbranch_scc1 XA17_adaLN_cond__sliding_local_dilated__swiglu_ffn__prompt_kernelx
  s_mov_b32 s83, 60000
XA17_adaLN_cond__sliding_local_dilated__swiglu_ffn__prompt_kernel:
  buffer_load_dword v36, v37, s[8:11], s82 offen sc1
  s_sub_u32 s83, s83, 1
  s_cmp_eq_u32 s83, 0
  s_waitcnt vmcnt(0)
  s_cbranch_scc1 XA17_adaLN_cond__sliding_local_dilated__swiglu_ffn__prompt_kernely
  v_cmp_ne_u32 vcc, s46, v36
  s_nop 4
  s_cbranch_vccnz XA17_adaLN_cond__sliding_local_dilated__swiglu_ffn__prompt_kernel
XA17_adaLN_cond__sliding_local_dilated__swiglu_ffn__prompt_kernely:
  s_xor_b32 s55, s86, 131072
  s_add_u32 s55, s55, 8192
  buffer_load_dwordx4 v[152:155], v1, s[8:11], s55 offen offset:0 sc1
  buffer_load_dwordx4 v[184:187], v1, s[8:11], s55 offen offset:1024 sc1
  buffer_load_dwordx4 v[156:159], v1, s[8:11], s55 offen offset:2048 sc1
  buffer_load_dwordx4 v[188:191], v1, s[8:11], s55 offen offset:3072 sc1
XA17_adaLN_cond__sliding_local_dilated__swiglu_ffn__prompt_kernelx:
  s_waitcnt vmcnt(3)
  v_mfma_f32_16x16x32_bf16 v[208:211], v[52:55], v[152:155], v[208:211]
  v_mfma_f32_16x16x32_bf16 v[212:215], v[54:57], v[152:155], v[212:215]
  s_waitcnt vmcnt(2)
  v_mfma_f32_16x16x32_bf16 v[216:219], v[58:61], v[184:187], v[216:219]
  v_mfma_f32_16x16x32_bf16 v[220:223], v[60:63], v[184:187], v[220:223]
  s_waitcnt vmcnt(1)
  v_mfma_f32_16x16x32_bf16 v[224:227], v[52:55], v[156:159], v[224:227]
  v_mfma_f32_16x16x32_bf16 v[228:231], v[54:57], v[156:159], v[228:231]
  s_waitcnt vmcnt(0)
  v_mfma_f32_16x16x32_bf16 v[232:235], v[58:61], v[188:191], v[232:235]
  v_mfma_f32_16x16x32_bf16 v[236:239], v[60:63], v[188:191], v[236:239]
  v_cvt_pk_bf16_f32 v192, v208, v209
  v_cvt_pk_bf16_f32 v193, v210, v211
  v_cvt_pk_bf16_f32 v194, v212, v213
  v_cvt_pk_bf16_f32 v195, v214, v215
  s_nop 0
  v_permlane16_swap_b32 v192, v194
  v_permlane16_swap_b32 v193, v195
  ds_write_b128 v42, v[192:195] offset:0
  v_cvt_pk_bf16_f32 v196, v216, v217
  v_cvt_pk_bf16_f32 v197, v218, v219
  v_cvt_pk_bf16_f32 v198, v220, v221
  v_cvt_pk_bf16_f32 v199, v222, v223
  s_nop 0
  v_permlane16_swap_b32 v196, v198
  v_permlane16_swap_b32 v197, v199
  ds_write_b128 v43, v[196:199] offset:0
  ds_read_b128 v[208:211], v44 offset:0
  ds_read_b128 v[212:215], v44 offset:1024
  v_cvt_pk_bf16_f32 v200, v224, v225
  v_cvt_pk_bf16_f32 v201, v226, v227
  v_cvt_pk_bf16_f32 v202, v228, v229
  v_cvt_pk_bf16_f32 v203, v230, v231
  s_nop 0
  v_permlane16_swap_b32 v200, v202
  v_permlane16_swap_b32 v201, v203
  ds_write_b128 v42, v[200:203] offset:2048
  v_cvt_pk_bf16_f32 v204, v232, v233
HOP20:
  s_cbranch_execz WRET1
  v_cvt_pk_bf16_f32 v205, v234, v235
  v_cvt_pk_bf16_f32 v206, v236, v237
  v_cvt_pk_bf16_f32 v207, v238, v239
  s_nop 0
  v_permlane16_swap_b32 v204, v206
  v_permlane16_swap_b32 v205, v207
  ds_write_b128 v43, v[204:207] offset:2048
  ds_read_b128 v[224:227], v44 offset:2048
  ds_read_b128 v[228:231], v44 offset:3072
  s_waitcnt lgkmcnt(5)
  buffer_store_dwordx4 v[208:211], v40, s[40:43], s85 offen sc1
  s_add_u32 s85, s85, 16384
  s_waitcnt lgkmcnt(4)
  buffer_store_dwordx4 v[212:215], v40, s[40:43], s85 offen sc1
  s_add_u32 s85, s85, 16384
  s_waitcnt lgkmcnt(1)
  buffer_store_dwordx4 v[224:227], v40, s[40:43], s85 offen sc1
  s_add_u32 s85, s85, 16384
  s_waitcnt lgkmcnt(0)
  buffer_store_dwordx4 v[228:231], v40, s[40:43], s85 offen sc1
E_adaLN_cond__sliding_local_dilated__swiglu_ffn__prompt_kernel:
X_adaLN_cond__sliding_local_dilated__swiglu_ffn__prompt_kernel:
  s_endpgm
code_end:
.fill 2048, 4, 0xBF800000
.section .rodata,"a"
.p2align 6
.amdhsa_kernel adaLN_cond__sliding_local_dilated__swiglu_ffn__prompt_kernel
  .amdhsa_next_free_vgpr 512
  .amdhsa_next_free_sgpr 102
  .amdhsa_accum_offset 256
  .amdhsa_group_segment_fixed_size 0
  .amdhsa_kernarg_size 96
  .amdhsa_user_sgpr_count 2
  .amdhsa_user_sgpr_kernarg_segment_ptr 1
  .amdhsa_system_sgpr_workgroup_id_x 1
  .amdhsa_float_denorm_mode_32 3
.end_amdhsa_kernel
```

```asm
; @launch grid=(256,1,1) block=(256,1,1) lds=163840
.amdgcn_target "amdgcn-amd-amdhsa--gfx950"
.text
.globl adaLN_cond__sliding_local_dilated__swiglu_ffn__prompt_kernel
.type adaLN_cond__sliding_local_dilated__swiglu_ffn__prompt_kernel,@function
.p2align 8
adaLN_cond__sliding_local_dilated__swiglu_ffn__prompt_kernel:
  s_cmp_ge_u32 s2, 256
  s_cbranch_scc1 X_adaLN_cond__sliding_local_dilated__swiglu_ffn__prompt_kernel
  s_load_dwordx2 s[4:5], s[0:1], 0
  s_load_dwordx2 s[8:9], s[0:1], 88
  s_load_dwordx2 s[12:13], s[0:1], 8
  s_load_dwordx2 s[16:17], s[0:1], 16
  s_load_dwordx2 s[20:21], s[0:1], 64
  s_load_dwordx2 s[24:25], s[0:1], 56
  s_load_dwordx2 s[28:29], s[0:1], 32
  s_load_dwordx2 s[32:33], s[0:1], 40
  s_load_dwordx2 s[36:37], s[0:1], 48
  s_load_dwordx2 s[40:41], s[0:1], 72
  v_lshrrev_b32 v21, 6, v0
  v_and_b32 v0, 63, v0
  v_readfirstlane_b32 s44, v21
  v_lshrrev_b32 v22, 3, v0
  v_bfe_u32 v11, v22, 1, 2
  v_bfe_u32 v23, v0, 1, 2
  v_xor_b32 v11, v11, v23
  v_lshlrev_b32 v11, 5, v11
  v_and_b32 v23, 1, v0
  v_lshl_add_u32 v11, v23, 4, v11
  s_lshl_b32 s45, s44, 10
  s_lshl_b32 s52, s44, 3
  v_add_u32 v10, s52, v22
  s_and_b32 s52, s2, 7
  s_lshl_b32 s52, s52, 7
  v_add_u32 v35, s52, v10
  v_mul_u32_u24 v35, 12288, v35
  s_lshr_b32 s53, s2, 3
  s_lshl_b32 s53, s53, 7
  v_add3_u32 v35, v35, v11, s53
  s_and_b32 s53, s44, 1
  s_lshl_b32 s53, s53, 6
  s_add_u32 s52, s52, s53
  v_add_lshl_u32 v16, s52, v0, 1
  s_and_b32 s52, s2, 7
  s_lshr_b32 s53, s2, 3
  s_and_b32 s51, s52, 3
  s_lshl_b32 s51, s51, 2
  s_and_b32 s50, s53, 3
  s_add_u32 s51, s51, s50
  s_lshr_b32 s50, s52, 2
  s_lshl_b32 s50, s50, 3
  s_lshr_b32 s53, s53, 2
  s_add_u32 s50, s50, s53
  s_lshl_b32 s54, s50, 4
  s_add_u32 s54, s54, s51
  v_and_b32 v21, 7, v0
  v_lshlrev_b32 v28, 11, v21
  v_lshl_add_u32 v28, v22, 4, v28
  v_mov_b32 v29, 851968
  s_lshr_b32 s38, s54, 1
  s_lshl_b32 s38, s38, 15
  s_and_b32 s53, s54, 1
  s_lshl_b32 s53, s53, 2
  s_add_u32 s53, s53, s44
  s_lshl_b32 s52, s53, 8
  s_add_u32 s30, s38, s52
  s_mov_b32 s6, 4194304
  s_mov_b32 s7, 0x20000
  s_mov_b32 s10, 134217728
  s_mov_b32 s11, 0x20000
  s_mov_b32 s14, 6291456
  s_mov_b32 s15, 0x20000
  s_mov_b32 s18, 2097152
  s_mov_b32 s19, 0x20000
  s_mov_b32 s22, 12582912
  s_mov_b32 s23, 0x20000
  s_mov_b32 s26, 2048
  s_mov_b32 s27, 0x20000
  s_waitcnt lgkmcnt(0)
  buffer_load_ushort v15, v16, s[24:27], 0 offen
  s_add_u32 m0, s45, 131072
  s_mov_b32 s68, 0
  buffer_load_dwordx4 v35, s[20:23], s68 offen nt lds
  s_add_u32 m0, s45, 135168
  s_add_u32 s68, s68, 393216
  buffer_load_dwordx4 v35, s[20:23], s68 offen nt lds
  s_add_u32 m0, s45, 139264
  s_add_u32 s68, s68, 393216
  buffer_load_dwordx4 v35, s[20:23], s68 offen nt lds
  s_add_u32 m0, s45, 143360
  s_add_u32 s68, s68, 393216
  buffer_load_dwordx4 v35, s[20:23], s68 offen nt lds
  buffer_load_dword v36, v29, s[8:11], 0 offen sc1
  s_and_b32 s52, s2, 3
  s_lshl_b32 s52, s52, 2
  s_add_u32 s52, s52, s44
  s_lshl_b32 s52, s52, 7
  v_lshlrev_b32 v23, 1, v0
  buffer_load_ushort v23, v23, s[24:27], s52 offen
  s_add_u32 s52, s30, 0
  buffer_load_dwordx4 v[44:47], v28, s[4:7], s52 offen offset:0 nt
  buffer_load_dwordx4 v[48:51], v28, s[4:7], s52 offen offset:128 nt
  s_add_u32 s52, s30, 16384
  buffer_load_dwordx4 v[52:55], v28, s[4:7], s52 offen offset:0 nt
  buffer_load_dwordx4 v[56:59], v28, s[4:7], s52 offen offset:128 nt
  s_branch BODY0
.p2align 12
BODY0:
  v_lshlrev_b32 v1, 4, v0
  v_add_u32 v2, 65536, v1
  v_add_u32 v13, 131072, v1
  s_lshl_b32 s66, s51, 1
  s_add_u32 s66, s66, s50
  v_mul_u32_u24 v9, 6144, v10
  s_lshl_b32 s52, s51, 7
  v_add3_u32 v9, v9, v11, s52
  s_lshl_b32 s52, s53, 12
  s_add_u32 s38, s38, s52
  s_add_u32 s39, s38, 41943040
  s_add_u32 s38, s38, 1048576
  s_lshl_b32 s34, s53, 9
  s_add_u32 s34, s34, 131072
  s_lshl_b32 s35, s53, 11
  s_add_u32 s35, s35, 819200
  s_lshr_b32 s83, s2, 3
  s_lshl_b32 s83, s83, 2
  s_add_u32 s83, s83, s44
  s_lshl_b32 s83, s83, 10
  s_getpc_b64 s[80:81]
CT1_adaLN_cond__sliding_local_dilated__swiglu_ffn__prompt_kernel:
  s_min_u32 s82, s83, code_end-CT1_adaLN_cond__sliding_local_dilated__swiglu_ffn__prompt_kernel
  s_add_u32 s80, s80, s82
  s_addc_u32 s81, s81, 0
  v_and_b32 v24, 0x70, v1
  v_lshlrev_b32 v24, 3, v24
  global_load_dword a253, v24, s[80:81]
  s_xor_b32 s30, s30, 1024
  s_add_u32 s52, s30, 0
  buffer_load_dwordx4 v[92:95], v28, s[4:7], s52 offen offset:0 nt
  buffer_load_dwordx4 v[96:99], v28, s[4:7], s52 offen offset:128 nt
  s_add_u32 s52, s30, 16384
  buffer_load_dwordx4 v[100:103], v28, s[4:7], s52 offen offset:0 nt
  buffer_load_dwordx4 v[104:107], v28, s[4:7], s52 offen offset:128 nt
  s_add_u32 s52, s44, 0
  s_sub_u32 s53, 5, s52
  s_bitcmp1_b32 s2, 2
  s_cselect_b32 s52, s53, s52
  s_lshr_b32 s53, s52, 1
  s_lshl_b32 s53, s53, 11
  s_and_b32 s52, s52, 1
  s_lshr_b32 s57, s2, 3
  s_lshl_b32 s57, s57, 1
  s_add_u32 s52, s52, s57
  s_mul_i32 s52, s52, 98304
  s_add_u32 s52, s52, s53
  s_and_b32 s53, s2, 3
  s_lshl_b32 s53, s53, 9
  s_add_u32 s52, s52, s53
  s_cmp_lt_u32 s44, 3
  s_cselect_b32 s52, s52, 1073741824
  v_lshrrev_b32 v16, 2, v0
  v_mul_u32_u24 v16, 5632, v16
  v_lshl_add_u32 v16, v0, 7, v16
  buffer_load_dword a252, v16, s[12:15], s52 offen
  v_lshrrev_b32 v41, 2, v0
  v_bfe_u32 v40, v41, 1, 2
  v_lshlrev_b32 v40, 5, v40
  v_lshl_add_u32 v40, v41, 7, v40
  v_and_b32 v41, 3, v0
  v_lshl_add_u32 v40, v41, 3, v40
  s_lshl_b32 s52, s44, 5
  v_xor_b32 v3, s52, v40
  s_and_b32 s52, s52, 64
  s_and_b32 s53, s44, 1
  s_lshl_b32 s53, s53, 14
  s_add_u32 s52, s52, s53
  v_xor_b32 v4, s52, v40
  v_xor_b32 v5, 32, v4
  v_add_u32 v6, 65536, v3
  v_add_u32 v7, 65536, v4
  v_add_u32 v8, 65536, v5
  v_add_u32 v35, 131072, v3
  v_lshrrev_b32 v30, 5, v0
  v_lshlrev_b32 v30, 6, v30
  v_bfe_u32 v40, v0, 2, 2
  v_lshl_add_u32 v30, v40, 4, v30
  v_bfe_u32 v40, v0, 4, 1
  v_lshl_add_u32 v30, v40, 3, v30
  v_lshl_add_u32 v30, v41, 1, v30
  s_lshl_b32 s52, s44, 7
  s_add_u32 s52, s52, 160768
  v_add_u32 v30, s52, v30
  v_lshrrev_b32 v32, 4, v0
  v_lshlrev_b32 v32, 4, v32
  v_add_u32 v31, 160768, v32
  v_and_b32 v40, 15, v0
  v_lshl_add_u32 v32, v40, 27, v32
  s_and_b32 s52, s2, 7
  s_lshl_b32 s52, s52, 13
  s_lshr_b32 s53, s2, 3
  s_lshl_b32 s53, s53, 8
  s_add_u32 s52, s52, s53
  s_lshl_b32 s53, s44, 6
  s_add_u32 s52, s52, s53
  s_add_u32 s42, s52, 131072
  s_lshl_b32 s53, s44, 28
  s_lshl_b32 s31, s2, 7
  s_add_u32 s31, s31, s53
  s_add_u32 s31, s31, 819200
  s_lshl_b32 s74, s54, 7
  s_add_u32 s74, s74, s53
  s_add_u32 s75, s74, 786432
  s_add_u32 s74, s74, 655360
  s_waitcnt vmcnt(16)
  v_lshlrev_b32 v15, 16, v15
  v_mul_f32 v16, 0xbfb8aa3b, v15
  v_exp_f32 v16, v16
  s_nop 0
  v_add_f32 v16, 1.0, v16
  v_rcp_f32 v16, v16
  s_nop 0
  v_mul_f32 v15, v15, v16
  v_cvt_pk_bf16_f32 v15, v15, v15
  ds_write_b16 v30, v15
  s_waitcnt vmcnt(12) lgkmcnt(0)
  s_barrier
  ds_read_b64_tr_b16 v[60:61], v35 offset:0
  ds_read_b64_tr_b16 v[62:63], v35 offset:2048
  ds_read_b128 v[76:79], v31 offset:0
  ds_read_b64_tr_b16 v[64:65], v35 offset:4096
  ds_read_b64_tr_b16 v[66:67], v35 offset:6144
  ds_read_b128 v[80:83], v31 offset:64
  ds_read_b64_tr_b16 v[68:69], v35 offset:8192
  ds_read_b64_tr_b16 v[70:71], v35 offset:10240
  ds_read_b128 v[84:87], v31 offset:128
  ds_read_b64_tr_b16 v[72:73], v35 offset:12288
  ds_read_b64_tr_b16 v[74:75], v35 offset:14336
  ds_read_b128 v[88:91], v31 offset:192
  s_waitcnt vmcnt(11)
  v_readfirstlane_b32 s46, v36
  s_nop 0
  s_add_u32 s46, s46, 8
  s_mul_i32 s52, s46, 0x13c6ef37
  v_mov_b32 v36, 0xff
  s_bfe_u32 s55, s52, 0x80000
  s_bfe_u32 s56, s52, 0x80008
  s_bfe_u32 s69, s52, 0x80010
  s_bfe_u32 s54, s52, 0x80018
  s_waitcnt lgkmcnt(9)
  v_mfma_f32_16x16x32_bf16 v[40:43], v[60:63], v[76:79], 0
  s_waitcnt lgkmcnt(6)
  v_mfma_f32_16x16x32_bf16 v[40:43], v[64:67], v[80:83], v[40:43]
  s_waitcnt lgkmcnt(3)
  v_mfma_f32_16x16x32_bf16 v[40:43], v[68:71], v[84:87], v[40:43]
  s_waitcnt lgkmcnt(0)
  v_mfma_f32_16x16x32_bf16 v[40:43], v[72:75], v[88:91], v[40:43]
  s_nop 7
  v_bfi_b32 v40, v36, s55, v40
  v_bfi_b32 v41, v36, s56, v41
  v_bfi_b32 v42, v36, s69, v42
  v_bfi_b32 v43, v36, s54, v43
  buffer_store_dwordx4 v[40:43], v32, s[8:11], s42 offen sc1
  s_add_u32 s52, s44, 3
  s_sub_u32 s53, 5, s52
  s_bitcmp1_b32 s2, 2
  s_cselect_b32 s52, s53, s52
  s_lshr_b32 s53, s52, 1
  s_lshl_b32 s53, s53, 11
  s_and_b32 s52, s52, 1
  s_lshr_b32 s57, s2, 3
  s_lshl_b32 s57, s57, 1
  s_add_u32 s52, s52, s57
  s_mul_i32 s52, s52, 98304
  s_add_u32 s52, s52, s53
  s_and_b32 s53, s2, 3
  s_lshl_b32 s53, s53, 9
  s_add_u32 s52, s52, s53
  s_cmp_lt_u32 s44, 3
  s_cselect_b32 s52, s52, 1073741824
  v_lshrrev_b32 v16, 2, v0
  v_mul_u32_u24 v16, 5632, v16
  v_lshl_add_u32 v16, v0, 7, v16
  buffer_load_dword a252, v16, s[12:15], s52 offen
  s_lshl_b32 s52, s50, 18
  s_add_u32 s52, s52, 1015808
  s_max_u32 s72, s52, 1048576
  s_lshr_b32 s53, s44, 1
  s_lshl_b32 s70, s53, 15
  s_add_u32 s52, s52, s70
  v_add_u32 v12, s52, v1
  s_lshl_b32 s53, s53, 11
  s_add_u32 s72, s72, s53
  s_lshl_b32 s70, s44, 12
  s_and_b32 s52, s70, 4096
  s_add_u32 s71, s52, s53
  s_and_b32 s52, s44, 1
  s_add_u32 s52, s52, s66
  s_add_u32 s58, s52, 0
  s_and_b32 s58, s58, 7
  s_lshl_b32 s58, s58, 12
  s_add_u32 s59, s52, 2
  s_and_b32 s59, s59, 7
  s_lshl_b32 s59, s59, 12
  s_add_u32 s60, s52, 4
  s_and_b32 s60, s60, 7
  s_lshl_b32 s60, s60, 12
  s_add_u32 s61, s52, 6
  s_and_b32 s61, s61, 7
  s_lshl_b32 s61, s61, 12
  s_lshl_b32 s52, s50, 4
  s_sub_u32 s52, s52, 2
  v_min_u32 v14, 17, v0
  v_add_u32 v14, s52, v14
  v_max_i32 v14, 0, v14
  v_lshlrev_b32 v14, 7, v14
  v_add_u32 v14, 786432, v14
  s_and_b32 s52, s2, 3
  s_lshl_b32 s52, s52, 8
  v_add_u32 v40, s52, v10
  v_mul_u32_u24 v40, 12288, v40
  s_lshr_b32 s53, s2, 2
  s_add_u32 s53, s53, 32
  s_lshl_b32 s53, s53, 7
  v_lshl_add_u32 v10, v10, 11, v11
  v_add3_u32 v11, v40, v11, s53
  s_and_b32 s52, s44, 1
  s_lshl_b32 s53, s50, 3
  s_add_u32 s53, s53, s52
  s_lshl_b32 s73, s53, 15
  s_lshl_b32 s53, s51, 1
  s_lshr_b32 s57, s44, 1
  s_add_u32 s53, s53, s57
  s_lshl_b32 s53, s53, 10
  s_add_u32 s73, s73, s53
  s_add_u32 s73, s73, 7340032
  s_mul_i32 s57, s57, 3072
  s_add_u32 s57, s57, 131072
  v_add_u32 v19, s57, v1
  s_lshl_b32 s53, s52, 3
  v_add_u32 v18, s53, v19
  s_lshl_b32 s53, s52, 10
  v_add_u32 v17, s53, v19
  v_lshrrev_b32 v40, 2, v0
  v_and_b32 v20, 3, v0
  v_lshl_add_u32 v40, v20, 4, v40
  v_lshl_add_u32 v20, v40, 4, s57
  s_mov_b32 s80, 0xfff0ffff
  s_mov_b32 s81, 0xf000ff00
  s_mov_b32 s82, 0xffe0fffe
  s_mov_b32 s83, 0xe000fe00
  s_mov_b32 s84, 0xffc0fffc
  s_mov_b32 s85, 0xc000fc00
  s_mov_b32 s86, 0xff80fff8
  s_mov_b32 s87, 0x8000f800
  s_mov_b32 s88, 0xaaaaaaaa
  s_mov_b32 s89, 0xaaaaaaaa
  s_mov_b32 s90, 0x000f0000
  s_mov_b32 s91, 0x0fff00ff
  s_mov_b32 s92, 0x003f0003
  s_mov_b32 s93, 0x3fff03ff
  v_mov_b32 v41, 0xffff
  v_mov_b32 v24, 0xffff0000
  v_cndmask_b32 v41, v41, v24, s[88:89]
  v_cndmask_b32 v24, 0, v41, s[90:91]
  v_cndmask_b32 v25, 0, v41, s[92:93]
  v_xor_b32 v26, v24, v41
  v_xor_b32 v27, v25, v41
  s_or_b32 s52, s52, s50
  s_cmp_eq_u32 s52, 0
  s_cselect_b64 s[90:91], s[90:91], 0
  s_cselect_b64 s[92:93], s[92:93], 0
  s_bfe_u32 s53, s2, 0x30003
  s_lshl_b32 s43, s53, 1
  s_and_b32 s52, s2, 1
  s_add_u32 s43, s43, s52
  s_and_b32 s79, s2, 4
  s_lshr_b32 s52, s2, 6
  s_add_u32 s79, s79, s52
  s_lshl_b32 s79, s79, 1
  s_add_u32 s67, s79, s53
  s_bfe_u32 s52, s2, 0x10001
  s_add_u32 s79, s79, s52
  s_and_b32 s52, s44, 1
  s_add_u32 s52, s52, s67
  s_add_u32 s62, s52, 0
  s_and_b32 s62, s62, 7
  s_lshl_b32 s62, s62, 12
  s_add_u32 s63, s52, 2
  s_and_b32 s63, s63, 7
  s_lshl_b32 s63, s63, 12
  s_add_u32 s64, s52, 4
  s_and_b32 s64, s64, 7
  s_lshl_b32 s64, s64, 12
  s_add_u32 s65, s52, 6
  s_and_b32 s65, s65, 7
  s_lshl_b32 s65, s65, 12
  s_lshl_b32 s52, s43, 7
  v_add_u32 v10, s52, v10
  s_lshl_b32 s52, s79, 18
  s_lshr_b32 s53, s44, 1
  s_lshl_b32 s53, s53, 15
  s_add_u32 s53, s52, s53
  s_add_u32 s78, s53, 7340032
  s_and_b32 s53, s44, 1
  s_lshl_b32 s53, s53, 15
  s_add_u32 s52, s52, s53
  s_lshl_b32 s53, s43, 1
  s_lshr_b32 s57, s44, 1
  s_add_u32 s53, s53, s57
  s_lshl_b32 s76, s53, 7
  s_lshl_b32 s53, s53, 10
  s_add_u32 s47, s52, s53
  s_lshr_b32 s53, s53, 1
  s_lshl_b32 s52, s79, 1
  s_and_b32 s57, s44, 1
  s_add_u32 s52, s52, s57
  s_lshl_b32 s52, s52, 14
  s_add_u32 s52, s52, s53
  s_add_u32 s48, s52, 6291456
  s_lshl_b32 s52, s79, 11
  s_lshl_b32 s53, s43, 7
  s_add_u32 s53, s53, s52
  s_lshl_b32 s57, s44, 28
  s_add_u32 s53, s53, s57
  s_add_u32 s49, s53, 753664
  s_add_u32 s77, s52, 655360
  s_lshl_b32 s53, s44, 4
  v_lshlrev_b32 v31, 6, v21
  v_add_u32 v31, 159744, v31
  v_add_u32 v30, s53, v31
  v_mov_b32 v34, 0x3f803f80
  v_mov_b32 v36, 0
  v_mov_b32 v37, 0
  v_mov_b32 v38, 0
  v_mov_b32 v39, 0
  s_waitcnt vmcnt(8)
  v_dot2c_f32_bf16 v36, v44, v34
  v_dot2c_f32_bf16 v37, v44, v44
  v_dot2c_f32_bf16 v38, v52, v34
  v_dot2c_f32_bf16 v39, v52, v52
  v_dot2c_f32_bf16 v36, v45, v34
  v_dot2c_f32_bf16 v37, v45, v45
  v_dot2c_f32_bf16 v38, v53, v34
  v_dot2c_f32_bf16 v39, v53, v53
  v_dot2c_f32_bf16 v36, v46, v34
  v_dot2c_f32_bf16 v37, v46, v46
  v_dot2c_f32_bf16 v38, v54, v34
  v_dot2c_f32_bf16 v39, v54, v54
  v_dot2c_f32_bf16 v36, v47, v34
  v_dot2c_f32_bf16 v37, v47, v47
  v_dot2c_f32_bf16 v38, v55, v34
  v_dot2c_f32_bf16 v39, v55, v55
  v_dot2c_f32_bf16 v36, v48, v34
  v_dot2c_f32_bf16 v37, v48, v48
  v_dot2c_f32_bf16 v38, v56, v34
  v_dot2c_f32_bf16 v39, v56, v56
  v_dot2c_f32_bf16 v36, v49, v34
  v_dot2c_f32_bf16 v37, v49, v49
  v_dot2c_f32_bf16 v38, v57, v34
  v_dot2c_f32_bf16 v39, v57, v57
  v_dot2c_f32_bf16 v36, v50, v34
  v_dot2c_f32_bf16 v37, v50, v50
  v_dot2c_f32_bf16 v38, v58, v34
  v_dot2c_f32_bf16 v39, v58, v58
  v_dot2c_f32_bf16 v36, v51, v34
  v_dot2c_f32_bf16 v37, v51, v51
  v_dot2c_f32_bf16 v38, v59, v34
  v_dot2c_f32_bf16 v39, v59, v59
  s_waitcnt vmcnt(3)
  v_dot2c_f32_bf16 v36, v92, v34
  v_dot2c_f32_bf16 v37, v92, v92
  v_dot2c_f32_bf16 v38, v100, v34
  v_dot2c_f32_bf16 v39, v100, v100
  v_dot2c_f32_bf16 v36, v93, v34
  v_dot2c_f32_bf16 v37, v93, v93
  v_dot2c_f32_bf16 v38, v101, v34
  v_dot2c_f32_bf16 v39, v101, v101
  v_dot2c_f32_bf16 v36, v94, v34
  v_dot2c_f32_bf16 v37, v94, v94
  v_dot2c_f32_bf16 v38, v102, v34
  v_dot2c_f32_bf16 v39, v102, v102
  v_dot2c_f32_bf16 v36, v95, v34
  v_dot2c_f32_bf16 v37, v95, v95
  v_dot2c_f32_bf16 v38, v103, v34
  v_dot2c_f32_bf16 v39, v103, v103
  v_dot2c_f32_bf16 v36, v96, v34
  v_dot2c_f32_bf16 v37, v96, v96
  v_dot2c_f32_bf16 v38, v104, v34
  v_dot2c_f32_bf16 v39, v104, v104
  v_dot2c_f32_bf16 v36, v97, v34
  v_dot2c_f32_bf16 v37, v97, v97
  v_dot2c_f32_bf16 v38, v105, v34
  v_dot2c_f32_bf16 v39, v105, v105
  v_dot2c_f32_bf16 v36, v98, v34
  v_dot2c_f32_bf16 v37, v98, v98
  v_dot2c_f32_bf16 v38, v106, v34
  v_dot2c_f32_bf16 v39, v106, v106
  v_dot2c_f32_bf16 v36, v99, v34
  v_dot2c_f32_bf16 v37, v99, v99
  v_dot2c_f32_bf16 v38, v107, v34
  v_dot2c_f32_bf16 v39, v107, v107
  s_nop 2
  v_add_f32_dpp v36, v36, v36 row_ror:8 row_mask:0xf bank_mask:0xf
  v_add_f32_dpp v37, v37, v37 row_ror:8 row_mask:0xf bank_mask:0xf
  v_add_f32_dpp v38, v38, v38 row_ror:8 row_mask:0xf bank_mask:0xf
  v_add_f32_dpp v39, v39, v39 row_ror:8 row_mask:0xf bank_mask:0xf
  v_mov_b32 v40, v36
  v_mov_b32 v41, v37
  v_mov_b32 v42, v38
  v_mov_b32 v43, v39
  v_permlane16_swap_b32 v36, v40
  v_permlane16_swap_b32 v37, v41
  v_permlane16_swap_b32 v38, v42
  v_permlane16_swap_b32 v39, v43
  v_add_f32 v36, v36, v40
  v_add_f32 v37, v37, v41
  v_add_f32 v38, v38, v42
  v_add_f32 v39, v39, v43
  v_mov_b32 v40, v36
  v_mov_b32 v41, v37
  v_mov_b32 v42, v38
  v_mov_b32 v43, v39
  v_permlane32_swap_b32 v36, v40
  v_permlane32_swap_b32 v37, v41
  v_permlane32_swap_b32 v38, v42
  v_permlane32_swap_b32 v39, v43
  v_add_f32 v36, v36, v40
  v_add_f32 v37, v37, v41
  v_add_f32 v38, v38, v42
  v_add_f32 v39, v39, v43
  ds_write_b128 v30, v[36:39]
  v_lshlrev_b32 v60, 16, v44
  v_and_b32 v61, 0xffff0000, v44
  v_lshlrev_b32 v62, 16, v45
  v_and_b32 v63, 0xffff0000, v45
  v_lshlrev_b32 v64, 16, v46
  v_and_b32 v65, 0xffff0000, v46
  v_lshlrev_b32 v66, 16, v47
  v_and_b32 v67, 0xffff0000, v47
  v_lshlrev_b32 v68, 16, v48
  v_and_b32 v69, 0xffff0000, v48
  v_lshlrev_b32 v70, 16, v49
  v_and_b32 v71, 0xffff0000, v49
  v_lshlrev_b32 v72, 16, v50
  v_and_b32 v73, 0xffff0000, v50
  v_lshlrev_b32 v74, 16, v51
  v_and_b32 v75, 0xffff0000, v51
  v_lshlrev_b32 v76, 16, v52
  v_and_b32 v77, 0xffff0000, v52
  v_lshlrev_b32 v78, 16, v53
  v_and_b32 v79, 0xffff0000, v53
  v_lshlrev_b32 v80, 16, v54
  v_and_b32 v81, 0xffff0000, v54
  v_lshlrev_b32 v82, 16, v55
  v_and_b32 v83, 0xffff0000, v55
  v_lshlrev_b32 v84, 16, v56
  v_and_b32 v85, 0xffff0000, v56
  v_lshlrev_b32 v86, 16, v57
  v_and_b32 v87, 0xffff0000, v57
  v_lshlrev_b32 v88, 16, v58
  v_and_b32 v89, 0xffff0000, v58
  v_lshlrev_b32 v90, 16, v59
  v_and_b32 v91, 0xffff0000, v59
  s_waitcnt lgkmcnt(0)
  s_barrier
  ds_read_b128 v[92:95], v31 offset:0
  ds_read_b128 v[96:99], v31 offset:16
  ds_read_b128 v[100:103], v31 offset:32
  ds_read_b128 v[104:107], v31 offset:48
  v_permlane16_swap_b32 v44, v46
  v_permlane16_swap_b32 v45, v47
  v_permlane16_swap_b32 v48, v50
  v_permlane16_swap_b32 v49, v51
  v_permlane16_swap_b32 v52, v54
  v_permlane16_swap_b32 v53, v55
  v_permlane16_swap_b32 v56, v58
  v_permlane16_swap_b32 v57, v59
  v_bfe_u32 v36, v0, 3, 1
  v_lshlrev_b32 v28, 9, v36
  v_bfe_u32 v36, v0, 4, 1
  v_lshl_add_u32 v28, v36, 8, v28
  v_lshrrev_b32 v34, 5, v0
  v_lshl_add_u32 v28, v34, 10, v28
  v_lshl_add_u32 v28, v21, 4, v28
  v_and_b32 v29, 31, v0
  v_lshlrev_b32 v29, 4, v29
  v_lshl_add_u32 v29, v34, 12, v29
  v_cvt_f32_u32 v34, v34
  s_add_u32 s53, s45, 151552
  v_add_u32 v32, s53, v1
  v_lshl_add_u32 v33, v22, 5, s53
  v_lshlrev_b32 v36, 14, v36
  v_and_b32 v35, 15, v0
  v_lshl_add_u32 v35, v35, 7, v36
  s_waitcnt lgkmcnt(0)
  v_add_f32 v92, v92, v100
  v_add_f32 v93, v93, v101
  v_add_f32 v94, v94, v102
  v_add_f32 v95, v95, v103
  v_add_f32 v96, v96, v104
  v_add_f32 v97, v97, v105
  v_add_f32 v98, v98, v106
  v_add_f32 v99, v99, v107
  v_add_f32 v92, v92, v96
  v_add_f32 v93, v93, v97
  v_add_f32 v94, v94, v98
  v_add_f32 v95, v95, v99
  v_mul_f32 v92, 0x3a800000, v92
  v_mul_f32 v94, 0x3a800000, v94
  v_mul_f32 v93, 0x3a800000, v93
  v_mul_f32 v95, 0x3a800000, v95
  v_fma_f32 v93, -v92, v92, v93
  v_fma_f32 v95, -v94, v94, v95
  v_max_f32 v93, 0, v93
  v_max_f32 v95, 0, v95
  v_cvt_pk_bf16_f32 v93, v93, v93
  v_cvt_pk_bf16_f32 v95, v95, v95
  v_lshlrev_b32 v93, 16, v93
  v_lshlrev_b32 v95, 16, v95
  v_add_f32 v93, 0x3727c5ac, v93
  v_add_f32 v95, 0x3727c5ac, v95
  v_cvt_pk_bf16_f32 v93, v93, v93
  v_cvt_pk_bf16_f32 v95, v95, v95
  v_lshlrev_b32 v93, 16, v93
  v_lshlrev_b32 v95, 16, v95
  v_sqrt_f32 v93, v93
  v_sqrt_f32 v95, v95
  v_cvt_pk_bf16_f32 v92, v92, v92
  v_cvt_pk_bf16_f32 v94, v94, v94
  v_lshlrev_b32 v92, 16, v92
  v_lshlrev_b32 v94, 16, v94
  v_cvt_pk_bf16_f32 v93, v93, v93
  v_cvt_pk_bf16_f32 v95, v95, v95
  v_lshlrev_b32 v93, 16, v93
  v_lshlrev_b32 v95, 16, v95
  v_rcp_f32 v93, v93
  v_rcp_f32 v95, v95
  v_mul_f32 v92, v92, v93
  v_mul_f32 v94, v94, v95
  v_fma_f32 v60, v60, v93, -v92
  v_fma_f32 v61, v61, v93, -v92
  v_fma_f32 v62, v62, v93, -v92
  v_fma_f32 v63, v63, v93, -v92
  v_fma_f32 v64, v64, v93, -v92
  v_fma_f32 v65, v65, v93, -v92
  v_fma_f32 v66, v66, v93, -v92
  v_fma_f32 v67, v67, v93, -v92
  v_fma_f32 v68, v68, v93, -v92
  v_fma_f32 v69, v69, v93, -v92
  v_fma_f32 v70, v70, v93, -v92
  v_fma_f32 v71, v71, v93, -v92
  v_fma_f32 v72, v72, v93, -v92
  v_fma_f32 v73, v73, v93, -v92
  v_fma_f32 v74, v74, v93, -v92
  v_fma_f32 v75, v75, v93, -v92
  v_fma_f32 v76, v76, v95, -v94
  v_fma_f32 v77, v77, v95, -v94
  v_fma_f32 v78, v78, v95, -v94
  v_fma_f32 v79, v79, v95, -v94
  v_fma_f32 v80, v80, v95, -v94
  v_fma_f32 v81, v81, v95, -v94
  v_fma_f32 v82, v82, v95, -v94
  v_fma_f32 v83, v83, v95, -v94
  v_fma_f32 v84, v84, v95, -v94
  v_fma_f32 v85, v85, v95, -v94
  v_fma_f32 v86, v86, v95, -v94
  v_fma_f32 v87, v87, v95, -v94
  v_fma_f32 v88, v88, v95, -v94
  v_fma_f32 v89, v89, v95, -v94
  v_fma_f32 v90, v90, v95, -v94
  v_fma_f32 v91, v91, v95, -v94
  s_waitcnt vmcnt(12)
  v_lshlrev_b32 v15, 16, v23
  v_mul_f32 v16, 0xbfb8aa3b, v15
  v_exp_f32 v16, v16
  v_lshrrev_b32 v21, 5, v0
  v_add_f32 v16, 1.0, v16
  v_rcp_f32 v16, v16
  v_lshlrev_b32 v21, 6, v21
  v_mul_f32 v15, v15, v16
  v_cvt_pk_bf16_f32 v16, v15, v15
  v_bfe_u32 v15, v0, 2, 2
  v_lshl_add_u32 v21, v15, 4, v21
  v_bfe_u32 v15, v0, 4, 1
  v_lshl_add_u32 v21, v15, 3, v21
  v_and_b32 v15, 3, v0
  v_lshl_add_u32 v21, v15, 1, v21
  s_lshl_b32 s53, s44, 7
  s_add_u32 s53, s53, 160768
  v_add_u32 v21, s53, v21
  s_mov_b64 exec, 0
  s_cmp_eq_u32 s44, 0
  s_cbranch_scc1 HOP0
  s_cmp_eq_u32 s44, 1
  s_cbranch_scc1 HOP1
  s_cmp_eq_u32 s44, 2
  s_cbranch_scc1 HOP2
  s_cmp_eq_u32 s44, 3
  s_cbranch_scc1 HOP3
WRET0:
  s_mov_b64 exec, -1
  s_add_u32 s52, s34, 0
  buffer_load_dwordx4 v[92:95], v29, s[8:11], s52 offen sc1
  s_add_u32 s52, s34, 8192
  buffer_load_dwordx4 v[96:99], v29, s[8:11], s52 offen sc1
  s_add_u32 s52, s34, 16384
  buffer_load_dwordx4 v[100:103], v29, s[8:11], s52 offen sc1
  s_add_u32 s52, s34, 24576
  buffer_load_dwordx4 v[104:107], v29, s[8:11], s52 offen sc1
  s_add_u32 s52, s34, 32768
  buffer_load_dwordx4 v[108:111], v29, s[8:11], s52 offen sc1
  s_add_u32 s52, s34, 40960
  buffer_load_dwordx4 v[112:115], v29, s[8:11], s52 offen sc1
  s_add_u32 s52, s34, 49152
  buffer_load_dwordx4 v[116:119], v29, s[8:11], s52 offen sc1
  s_add_u32 s52, s34, 57344
  buffer_load_dwordx4 v[120:123], v29, s[8:11], s52 offen sc1
  s_add_u32 m0, s45, 0
  s_add_u32 s68, s66, 0
  s_and_b32 s68, s68, 7
  s_mul_i32 s68, s68, 786432
  buffer_load_dwordx4 v9, s[12:15], s68 offen lds
  s_add_u32 m0, s45, 4096
  s_add_u32 s68, s68, 196608
  buffer_load_dwordx4 v9, s[12:15], s68 offen lds
  s_add_u32 m0, s45, 8192
  s_add_u32 s68, s68, 196608
  buffer_load_dwordx4 v9, s[12:15], s68 offen lds
  s_add_u32 m0, s45, 12288
  s_add_u32 s68, s68, 196608
  buffer_load_dwordx4 v9, s[12:15], s68 offen lds
  s_add_u32 m0, s45, 16384
  s_add_u32 s68, s66, 1
  s_and_b32 s68, s68, 7
  s_mul_i32 s68, s68, 786432
  buffer_load_dwordx4 v9, s[12:15], s68 offen lds
  s_add_u32 m0, s45, 20480
  s_add_u32 s68, s68, 196608
  buffer_load_dwordx4 v9, s[12:15], s68 offen lds
  s_add_u32 m0, s45, 24576
  s_add_u32 s68, s68, 196608
  buffer_load_dwordx4 v9, s[12:15], s68 offen lds
  s_add_u32 m0, s45, 28672
  s_add_u32 s68, s68, 196608
  buffer_load_dwordx4 v9, s[12:15], s68 offen lds
  s_mov_b32 s57, 20000
  s_branch MT2_adaLN_cond__sliding_local_dilated__swiglu_ffn__prompt_kernelt
MT2_adaLN_cond__sliding_local_dilated__swiglu_ffn__prompt_kernel:
  s_add_u32 s52, s34, 0
  buffer_load_dwordx4 v[92:95], v29, s[8:11], s52 offen sc1
  s_add_u32 s52, s34, 8192
  buffer_load_dwordx4 v[96:99], v29, s[8:11], s52 offen sc1
  s_add_u32 s52, s34, 16384
  buffer_load_dwordx4 v[100:103], v29, s[8:11], s52 offen sc1
  s_add_u32 s52, s34, 24576
  buffer_load_dwordx4 v[104:107], v29, s[8:11], s52 offen sc1
  s_add_u32 s52, s34, 32768
  buffer_load_dwordx4 v[108:111], v29, s[8:11], s52 offen sc1
  s_add_u32 s52, s34, 40960
  buffer_load_dwordx4 v[112:115], v29, s[8:11], s52 offen sc1
  s_add_u32 s52, s34, 49152
  buffer_load_dwordx4 v[116:119], v29, s[8:11], s52 offen sc1
  s_add_u32 s52, s34, 57344
  buffer_load_dwordx4 v[120:123], v29, s[8:11], s52 offen sc1
  s_waitcnt vmcnt(0)
MT2_adaLN_cond__sliding_local_dilated__swiglu_ffn__prompt_kernelt:
  s_waitcnt vmcnt(15)
  v_xor_b32 v92, s55, v92
  v_xor_b32 v93, s56, v93
  v_xor_b32 v94, s69, v94
  v_xor_b32 v95, s54, v95
  v_or3_b32 v36, v92, v93, 0
  v_or3_b32 v36, v94, v95, v36
  s_waitcnt vmcnt(14)
  v_xor_b32 v96, s55, v96
  v_xor_b32 v97, s56, v97
  v_xor_b32 v98, s69, v98
  v_xor_b32 v99, s54, v99
  v_or3_b32 v36, v96, v97, v36
  v_or3_b32 v36, v98, v99, v36
  s_waitcnt vmcnt(13)
  v_xor_b32 v100, s55, v100
  v_xor_b32 v101, s56, v101
  v_xor_b32 v102, s69, v102
  v_xor_b32 v103, s54, v103
  v_or3_b32 v36, v100, v101, v36
  v_or3_b32 v36, v102, v103, v36
  s_waitcnt vmcnt(12)
  v_xor_b32 v104, s55, v104
  v_xor_b32 v105, s56, v105
  v_xor_b32 v106, s69, v106
  v_xor_b32 v107, s54, v107
  v_or3_b32 v36, v104, v105, v36
  v_or3_b32 v36, v106, v107, v36
  s_waitcnt vmcnt(11)
  v_xor_b32 v108, s55, v108
  v_xor_b32 v109, s56, v109
  v_xor_b32 v110, s69, v110
  v_xor_b32 v111, s54, v111
  v_or3_b32 v36, v108, v109, v36
  v_or3_b32 v36, v110, v111, v36
  s_waitcnt vmcnt(10)
  v_xor_b32 v112, s55, v112
  v_xor_b32 v113, s56, v113
  v_xor_b32 v114, s69, v114
  v_xor_b32 v115, s54, v115
  v_or3_b32 v36, v112, v113, v36
  v_or3_b32 v36, v114, v115, v36
  s_waitcnt vmcnt(9)
  v_xor_b32 v116, s55, v116
  v_xor_b32 v117, s56, v117
  v_xor_b32 v118, s69, v118
  v_xor_b32 v119, s54, v119
  v_or3_b32 v36, v116, v117, v36
  v_or3_b32 v36, v118, v119, v36
  s_waitcnt vmcnt(8)
  v_xor_b32 v120, s55, v120
  v_xor_b32 v121, s56, v121
  v_xor_b32 v122, s69, v122
  v_xor_b32 v123, s54, v123
  v_or3_b32 v36, v120, v121, v36
  v_or3_b32 v36, v122, v123, v36
  v_and_b32 v36, 0xff, v36
  v_cmp_ne_u32 vcc, 0, v36
  s_sub_u32 s57, s57, 1
  s_cmp_eq_u32 s57, 0
  s_cbranch_scc1 MT2_adaLN_cond__sliding_local_dilated__swiglu_ffn__prompt_kernelx
  s_nop 1
  s_cbranch_vccnz MT2_adaLN_cond__sliding_local_dilated__swiglu_ffn__prompt_kernel
MT2_adaLN_cond__sliding_local_dilated__swiglu_ffn__prompt_kernelx:
  s_waitcnt vmcnt(14)
  v_pk_add_f32 v[92:93], v[92:93], v[96:97]
  v_pk_add_f32 v[94:95], v[94:95], v[98:99]
  s_waitcnt vmcnt(13)
  v_pk_add_f32 v[92:93], v[92:93], v[100:101]
  v_pk_add_f32 v[94:95], v[94:95], v[102:103]
  s_waitcnt vmcnt(12)
  v_pk_add_f32 v[92:93], v[92:93], v[104:105]
  v_pk_add_f32 v[94:95], v[94:95], v[106:107]
  s_waitcnt vmcnt(11)
  v_pk_add_f32 v[92:93], v[92:93], v[108:109]
  v_pk_add_f32 v[94:95], v[94:95], v[110:111]
  s_waitcnt vmcnt(10)
  v_pk_add_f32 v[92:93], v[92:93], v[112:113]
  v_pk_add_f32 v[94:95], v[94:95], v[114:115]
  s_waitcnt vmcnt(9)
  v_pk_add_f32 v[92:93], v[92:93], v[116:117]
  v_pk_add_f32 v[94:95], v[94:95], v[118:119]
  s_waitcnt vmcnt(8)
  v_pk_add_f32 v[92:93], v[92:93], v[120:121]
HOP0:
  s_cbranch_execz HOP4
  v_pk_add_f32 v[94:95], v[94:95], v[122:123]
  v_cvt_pk_bf16_f32 v96, v92, v93
  v_cvt_pk_bf16_f32 v97, v94, v95
  v_lshlrev_b32 v92, 16, v96
  v_and_b32 v93, 0xffff0000, v96
  v_lshlrev_b32 v94, 16, v97
  v_and_b32 v95, 0xffff0000, v97
  v_add_f32 v92, v34, v92
  v_add_f32 v93, v34, v93
  v_add_f32 v94, v34, v94
  v_add_f32 v95, v34, v95
  v_cvt_pk_bf16_f32 v96, v92, v93
  v_cvt_pk_bf16_f32 v97, v94, v95
  v_lshlrev_b32 v92, 16, v96
  v_and_b32 v93, 0xffff0000, v96
  v_lshlrev_b32 v94, 16, v97
  v_and_b32 v95, 0xffff0000, v97
  ds_write_b128 v32, v[92:95]
  ds_read_b128 v[92:95], v33 offset:512
  ds_read_b128 v[108:111], v33 offset:0
  ds_read_b128 v[96:99], v33 offset:528
  ds_read_b128 v[112:115], v33 offset:16
  ds_read_b128 v[100:103], v33 offset:768
  ds_read_b128 v[116:119], v33 offset:256
  ds_read_b128 v[104:107], v33 offset:784
  ds_read_b128 v[120:123], v33 offset:272
  s_waitcnt lgkmcnt(4)
  v_pk_fma_f32 v[60:61], v[60:61], v[92:93], v[108:109]
  v_pk_fma_f32 v[62:63], v[62:63], v[94:95], v[110:111]
  v_pk_fma_f32 v[64:65], v[64:65], v[96:97], v[112:113]
  v_pk_fma_f32 v[66:67], v[66:67], v[98:99], v[114:115]
  v_pk_fma_f32 v[76:77], v[76:77], v[92:93], v[108:109]
  v_pk_fma_f32 v[78:79], v[78:79], v[94:95], v[110:111]
  v_pk_fma_f32 v[80:81], v[80:81], v[96:97], v[112:113]
  v_pk_fma_f32 v[82:83], v[82:83], v[98:99], v[114:115]
  v_cvt_pk_bf16_f32 v60, v60, v61
  v_cvt_pk_bf16_f32 v61, v62, v63
  v_cvt_pk_bf16_f32 v62, v64, v65
  v_cvt_pk_bf16_f32 v63, v66, v67
  v_cvt_pk_bf16_f32 v76, v76, v77
  v_cvt_pk_bf16_f32 v77, v78, v79
  v_cvt_pk_bf16_f32 v78, v80, v81
  v_cvt_pk_bf16_f32 v79, v82, v83
  v_permlane16_swap_b32 v60, v62
  v_permlane16_swap_b32 v61, v63
  buffer_store_dwordx4 v[60:63], v28, s[8:11], s38 offen offset:0 sc1
  v_permlane16_swap_b32 v76, v78
  v_permlane16_swap_b32 v77, v79
  buffer_store_dwordx4 v[76:79], v28, s[8:11], s38 offen offset:128 sc1
  s_waitcnt lgkmcnt(0)
  v_pk_fma_f32 v[68:69], v[68:69], v[100:101], v[116:117]
  v_pk_fma_f32 v[70:71], v[70:71], v[102:103], v[118:119]
  v_pk_fma_f32 v[72:73], v[72:73], v[104:105], v[120:121]
  v_pk_fma_f32 v[74:75], v[74:75], v[106:107], v[122:123]
  v_pk_fma_f32 v[84:85], v[84:85], v[100:101], v[116:117]
  v_pk_fma_f32 v[86:87], v[86:87], v[102:103], v[118:119]
  v_pk_fma_f32 v[88:89], v[88:89], v[104:105], v[120:121]
  v_pk_fma_f32 v[90:91], v[90:91], v[106:107], v[122:123]
  v_cvt_pk_bf16_f32 v68, v68, v69
  v_cvt_pk_bf16_f32 v69, v70, v71
  v_cvt_pk_bf16_f32 v70, v72, v73
  v_cvt_pk_bf16_f32 v71, v74, v75
  v_cvt_pk_bf16_f32 v84, v84, v85
  v_cvt_pk_bf16_f32 v85, v86, v87
  v_cvt_pk_bf16_f32 v86, v88, v89
  v_cvt_pk_bf16_f32 v87, v90, v91
  v_permlane16_swap_b32 v68, v70
  v_permlane16_swap_b32 v69, v71
  buffer_store_dwordx4 v[68:71], v28, s[8:11], s38 offen offset:2048 sc1
  v_permlane16_swap_b32 v84, v86
  v_permlane16_swap_b32 v85, v87
  buffer_store_dwordx4 v[84:87], v28, s[8:11], s38 offen offset:2176 sc1
  buffer_store_dwordx4 v[44:47], v28, s[8:11], s39 offen offset:0 sc1
  buffer_store_dwordx4 v[48:51], v28, s[8:11], s39 offen offset:2048 sc1
  buffer_store_dwordx4 v[52:55], v28, s[8:11], s39 offen offset:128 sc1
  buffer_store_dwordx4 v[56:59], v28, s[8:11], s39 offen offset:2176 sc1
  s_add_u32 m0, s45, 32768
  s_add_u32 s68, s66, 0
  s_and_b32 s68, s68, 7
  s_mul_i32 s68, s68, 786432
  s_add_u32 s68, s68, 2048
  buffer_load_dwordx4 v9, s[12:15], s68 offen lds
  s_add_u32 m0, s45, 36864
  s_add_u32 s68, s68, 196608
  buffer_load_dwordx4 v9, s[12:15], s68 offen lds
  s_add_u32 m0, s45, 40960
  s_add_u32 s68, s68, 196608
  buffer_load_dwordx4 v9, s[12:15], s68 offen lds
  s_add_u32 m0, s45, 45056
  s_add_u32 s68, s68, 196608
  buffer_load_dwordx4 v9, s[12:15], s68 offen lds
  s_add_u32 m0, s45, 49152
  s_add_u32 s68, s66, 0
  s_and_b32 s68, s68, 7
  s_mul_i32 s68, s68, 786432
  s_add_u32 s68, s68, 4096
  buffer_load_dwordx4 v9, s[12:15], s68 offen lds
  s_add_u32 m0, s45, 53248
  s_add_u32 s68, s68, 196608
  buffer_load_dwordx4 v9, s[12:15], s68 offen lds
  s_add_u32 m0, s45, 57344
  s_add_u32 s68, s68, 196608
  buffer_load_dwordx4 v9, s[12:15], s68 offen lds
  s_add_u32 m0, s45, 61440
  s_add_u32 s68, s68, 196608
  buffer_load_dwordx4 v9, s[12:15], s68 offen lds
  v_add_u32 v15, s46, v0
  s_waitcnt vmcnt(12)
  s_barrier
  s_mov_b64 exec, 1
  buffer_store_dword v15, v0, s[8:11], s75 offen offset:0 sc1
  s_mov_b64 exec, -1
  s_waitcnt vmcnt(17) lgkmcnt(0)
  s_barrier
  s_add_u32 m0, s45, 65536
  s_add_u32 s68, s66, 1
  s_and_b32 s68, s68, 7
  s_mul_i32 s68, s68, 786432
  s_add_u32 s68, s68, 2048
  buffer_load_dwordx4 v9, s[12:15], s68 offen lds
  ds_read_b64_tr_b16 a[0:1], v3 offset:0
  ds_read_b64_tr_b16 a[2:3], v3 offset:2048
  s_add_u32 m0, s45, 69632
  s_add_u32 s68, s68, 196608
  buffer_load_dwordx4 v9, s[12:15], s68 offen lds
  ds_read_b64_tr_b16 a[12:13], v3 offset:4096
  ds_read_b64_tr_b16 a[14:15], v3 offset:6144
  s_add_u32 m0, s45, 73728
  s_add_u32 s68, s68, 196608
  buffer_load_dwordx4 v9, s[12:15], s68 offen lds
  ds_read_b64_tr_b16 a[24:25], v3 offset:8192
  ds_read_b64_tr_b16 a[26:27], v3 offset:10240
  s_add_u32 m0, s45, 77824
  s_add_u32 s68, s68, 196608
  buffer_load_dwordx4 v9, s[12:15], s68 offen lds
  ds_read_b64_tr_b16 a[36:37], v3 offset:12288
  ds_read_b64_tr_b16 a[38:39], v3 offset:14336
  s_add_u32 m0, s45, 81920
  s_add_u32 s68, s66, 1
  s_and_b32 s68, s68, 7
  s_mul_i32 s68, s68, 786432
  s_add_u32 s68, s68, 4096
  buffer_load_dwordx4 v9, s[12:15], s68 offen lds
  ds_read_b64_tr_b16 a[48:49], v3 offset:16384
  ds_read_b64_tr_b16 a[50:51], v3 offset:18432
  s_add_u32 m0, s45, 86016
  s_add_u32 s68, s68, 196608
  buffer_load_dwordx4 v9, s[12:15], s68 offen lds
  ds_read_b64_tr_b16 a[60:61], v3 offset:20480
  ds_read_b64_tr_b16 a[62:63], v3 offset:22528
  s_add_u32 m0, s45, 90112
  s_add_u32 s68, s68, 196608
  buffer_load_dwordx4 v9, s[12:15], s68 offen lds
  ds_read_b64_tr_b16 a[72:73], v3 offset:24576
  ds_read_b64_tr_b16 a[74:75], v3 offset:26624
  s_add_u32 m0, s45, 94208
  s_add_u32 s68, s68, 196608
  buffer_load_dwordx4 v9, s[12:15], s68 offen lds
  ds_read_b64_tr_b16 a[84:85], v3 offset:28672
  ds_read_b64_tr_b16 a[86:87], v3 offset:30720
  s_add_u32 m0, s45, 98304
  s_add_u32 s68, s66, 2
  s_and_b32 s68, s68, 7
  s_mul_i32 s68, s68, 786432
  buffer_load_dwordx4 v9, s[12:15], s68 offen lds
  s_add_u32 m0, s45, 102400
  s_add_u32 s68, s68, 196608
  buffer_load_dwordx4 v9, s[12:15], s68 offen lds
  s_add_u32 m0, s45, 106496
  s_add_u32 s68, s68, 196608
  buffer_load_dwordx4 v9, s[12:15], s68 offen lds
  s_add_u32 m0, s45, 110592
  s_add_u32 s68, s68, 196608
  buffer_load_dwordx4 v9, s[12:15], s68 offen lds
  s_add_u32 m0, s45, 114688
  s_add_u32 s68, s66, 3
  s_and_b32 s68, s68, 7
  s_mul_i32 s68, s68, 786432
  buffer_load_dwordx4 v9, s[12:15], s68 offen lds
  s_add_u32 m0, s45, 118784
  s_add_u32 s68, s68, 196608
  buffer_load_dwordx4 v9, s[12:15], s68 offen lds
  s_add_u32 m0, s45, 122880
  s_add_u32 s68, s68, 196608
  buffer_load_dwordx4 v9, s[12:15], s68 offen lds
  s_add_u32 m0, s45, 126976
  s_add_u32 s68, s68, 196608
  buffer_load_dwordx4 v9, s[12:15], s68 offen lds
  s_waitcnt vmcnt(17) lgkmcnt(0)
  s_barrier
  s_add_u32 m0, s45, 0
  s_add_u32 s68, s66, 2
  s_and_b32 s68, s68, 7
  s_mul_i32 s68, s68, 786432
  s_add_u32 s68, s68, 2048
  buffer_load_dwordx4 v9, s[12:15], s68 offen lds
  ds_read_b64_tr_b16 a[4:5], v4 offset:32768
  ds_read_b64_tr_b16 a[6:7], v4 offset:34816
  s_add_u32 m0, s45, 4096
  s_add_u32 s68, s68, 196608
  buffer_load_dwordx4 v9, s[12:15], s68 offen lds
  ds_read_b64_tr_b16 a[8:9], v5 offset:32768
  ds_read_b64_tr_b16 a[10:11], v5 offset:34816
  s_add_u32 m0, s45, 8192
  s_add_u32 s68, s68, 196608
  buffer_load_dwordx4 v9, s[12:15], s68 offen lds
  ds_read_b64_tr_b16 a[16:17], v4 offset:36864
  ds_read_b64_tr_b16 a[18:19], v4 offset:38912
  s_add_u32 m0, s45, 12288
  s_add_u32 s68, s68, 196608
  buffer_load_dwordx4 v9, s[12:15], s68 offen lds
  ds_read_b64_tr_b16 a[20:21], v5 offset:36864
  ds_read_b64_tr_b16 a[22:23], v5 offset:38912
  s_add_u32 m0, s45, 16384
  s_add_u32 s68, s66, 2
  s_and_b32 s68, s68, 7
  s_mul_i32 s68, s68, 786432
  s_add_u32 s68, s68, 4096
  buffer_load_dwordx4 v9, s[12:15], s68 offen lds
  ds_read_b64_tr_b16 a[28:29], v4 offset:40960
  ds_read_b64_tr_b16 a[30:31], v4 offset:43008
  s_add_u32 m0, s45, 20480
  s_add_u32 s68, s68, 196608
  buffer_load_dwordx4 v9, s[12:15], s68 offen lds
  ds_read_b64_tr_b16 a[32:33], v5 offset:40960
  ds_read_b64_tr_b16 a[34:35], v5 offset:43008
  s_add_u32 m0, s45, 24576
  s_add_u32 s68, s68, 196608
  buffer_load_dwordx4 v9, s[12:15], s68 offen lds
  ds_read_b64_tr_b16 a[40:41], v4 offset:45056
  ds_read_b64_tr_b16 a[42:43], v4 offset:47104
  s_add_u32 m0, s45, 28672
  s_add_u32 s68, s68, 196608
  buffer_load_dwordx4 v9, s[12:15], s68 offen lds
  ds_read_b64_tr_b16 a[44:45], v5 offset:45056
  ds_read_b64_tr_b16 a[46:47], v5 offset:47104
  s_waitcnt vmcnt(16) lgkmcnt(0)
  s_barrier
  s_add_u32 m0, s45, 32768
  s_add_u32 s68, s66, 3
  s_and_b32 s68, s68, 7
  s_mul_i32 s68, s68, 786432
  s_add_u32 s68, s68, 2048
  buffer_load_dwordx4 v9, s[12:15], s68 offen lds
  ds_read_b64_tr_b16 a[52:53], v7 offset:0
  ds_read_b64_tr_b16 a[54:55], v7 offset:2048
  s_add_u32 m0, s45, 36864
  s_add_u32 s68, s68, 196608
  buffer_load_dwordx4 v9, s[12:15], s68 offen lds
  ds_read_b64_tr_b16 a[56:57], v8 offset:0
  ds_read_b64_tr_b16 a[58:59], v8 offset:2048
  s_add_u32 m0, s45, 40960
  s_add_u32 s68, s68, 196608
  buffer_load_dwordx4 v9, s[12:15], s68 offen lds
  ds_read_b64_tr_b16 a[64:65], v7 offset:4096
  ds_read_b64_tr_b16 a[66:67], v7 offset:6144
  s_add_u32 m0, s45, 45056
  s_add_u32 s68, s68, 196608
  buffer_load_dwordx4 v9, s[12:15], s68 offen lds
  ds_read_b64_tr_b16 a[68:69], v8 offset:4096
  ds_read_b64_tr_b16 a[70:71], v8 offset:6144
  s_add_u32 m0, s45, 49152
  s_add_u32 s68, s66, 3
  s_and_b32 s68, s68, 7
  s_mul_i32 s68, s68, 786432
  s_add_u32 s68, s68, 4096
  buffer_load_dwordx4 v9, s[12:15], s68 offen lds
  ds_read_b64_tr_b16 a[76:77], v7 offset:8192
  ds_read_b64_tr_b16 a[78:79], v7 offset:10240
  s_add_u32 m0, s45, 53248
  s_add_u32 s68, s68, 196608
  buffer_load_dwordx4 v9, s[12:15], s68 offen lds
  ds_read_b64_tr_b16 a[80:81], v8 offset:8192
  ds_read_b64_tr_b16 a[82:83], v8 offset:10240
  s_add_u32 m0, s45, 57344
  s_add_u32 s68, s68, 196608
  buffer_load_dwordx4 v9, s[12:15], s68 offen lds
  ds_read_b64_tr_b16 a[88:89], v7 offset:12288
  ds_read_b64_tr_b16 a[90:91], v7 offset:14336
  s_add_u32 m0, s45, 61440
  s_add_u32 s68, s68, 196608
  buffer_load_dwordx4 v9, s[12:15], s68 offen lds
  ds_read_b64_tr_b16 a[92:93], v8 offset:12288
  ds_read_b64_tr_b16 a[94:95], v8 offset:14336
  s_lshl_b32 s57, s44, 28
  buffer_load_dword v36, v14, s[8:11], s57 offen sc1
  s_waitcnt vmcnt(17) lgkmcnt(0)
  s_barrier
  s_add_u32 m0, s45, 65536
  s_add_u32 s68, s66, 4
  s_and_b32 s68, s68, 7
  s_mul_i32 s68, s68, 786432
  buffer_load_dwordx4 v9, s[12:15], s68 offen lds
  ds_read_b64_tr_b16 a[96:97], v6 offset:32768
  ds_read_b64_tr_b16 a[98:99], v6 offset:34816
  s_add_u32 m0, s45, 69632
  s_add_u32 s68, s68, 196608
  buffer_load_dwordx4 v9, s[12:15], s68 offen lds
  ds_read_b64_tr_b16 a[108:109], v6 offset:36864
  ds_read_b64_tr_b16 a[110:111], v6 offset:38912
  s_add_u32 m0, s45, 73728
  s_add_u32 s68, s68, 196608
  buffer_load_dwordx4 v9, s[12:15], s68 offen lds
  ds_read_b64_tr_b16 a[120:121], v6 offset:40960
  ds_read_b64_tr_b16 a[122:123], v6 offset:43008
  s_add_u32 m0, s45, 77824
  s_add_u32 s68, s68, 196608
  buffer_load_dwordx4 v9, s[12:15], s68 offen lds
  ds_read_b64_tr_b16 a[132:133], v6 offset:45056
  ds_read_b64_tr_b16 a[134:135], v6 offset:47104
  s_add_u32 m0, s45, 81920
  s_add_u32 s68, s66, 5
  s_and_b32 s68, s68, 7
  s_mul_i32 s68, s68, 786432
  buffer_load_dwordx4 v9, s[12:15], s68 offen lds
  ds_read_b64_tr_b16 a[144:145], v6 offset:49152
  ds_read_b64_tr_b16 a[146:147], v6 offset:51200
  s_add_u32 m0, s45, 86016
  s_add_u32 s68, s68, 196608
  buffer_load_dwordx4 v9, s[12:15], s68 offen lds
  ds_read_b64_tr_b16 a[156:157], v6 offset:53248
  ds_read_b64_tr_b16 a[158:159], v6 offset:55296
  s_add_u32 m0, s45, 90112
  s_add_u32 s68, s68, 196608
  buffer_load_dwordx4 v9, s[12:15], s68 offen lds
  ds_read_b64_tr_b16 a[168:169], v6 offset:57344
  ds_read_b64_tr_b16 a[170:171], v6 offset:59392
  s_add_u32 m0, s45, 94208
  s_add_u32 s68, s68, 196608
  buffer_load_dwordx4 v9, s[12:15], s68 offen lds
  ds_read_b64_tr_b16 a[180:181], v6 offset:61440
  ds_read_b64_tr_b16 a[182:183], v6 offset:63488
  s_waitcnt vmcnt(17) lgkmcnt(0)
  s_barrier
  ds_read_b64_tr_b16 a[100:101], v4 offset:0
  ds_read_b64_tr_b16 a[102:103], v4 offset:2048
  ds_read_b64_tr_b16 a[104:105], v5 offset:0
  ds_read_b64_tr_b16 a[106:107], v5 offset:2048
  ds_read_b64_tr_b16 a[112:113], v4 offset:4096
  ds_read_b64_tr_b16 a[114:115], v4 offset:6144
  ds_read_b64_tr_b16 a[116:117], v5 offset:4096
  ds_read_b64_tr_b16 a[118:119], v5 offset:6144
  ds_read_b64_tr_b16 a[124:125], v4 offset:8192
  ds_read_b64_tr_b16 a[126:127], v4 offset:10240
  ds_read_b64_tr_b16 a[128:129], v5 offset:8192
  ds_read_b64_tr_b16 a[130:131], v5 offset:10240
  ds_read_b64_tr_b16 a[136:137], v4 offset:12288
  ds_read_b64_tr_b16 a[138:139], v4 offset:14336
  ds_read_b64_tr_b16 a[140:141], v5 offset:12288
  ds_read_b64_tr_b16 a[142:143], v5 offset:14336
  s_waitcnt vmcnt(8)
  s_cmp_lg_u32 s44, 0
  s_cbranch_scc1 PL3_adaLN_cond__sliding_local_dilated__swiglu_ffn__prompt_kernelx
  v_cmp_ne_u32 vcc, s46, v36
  s_nop 4
  s_cbranch_vccz PL3_adaLN_cond__sliding_local_dilated__swiglu_ffn__prompt_kernelx
  s_mov_b32 s57, 60000
PL3_adaLN_cond__sliding_local_dilated__swiglu_ffn__prompt_kernel:
  buffer_load_dword v36, v14, s[8:11], 0 offen sc1
  s_sub_u32 s57, s57, 1
  s_cmp_eq_u32 s57, 0
  s_waitcnt vmcnt(0)
  s_cbranch_scc1 PL3_adaLN_cond__sliding_local_dilated__swiglu_ffn__prompt_kernelx
  v_cmp_ne_u32 vcc, s46, v36
  s_nop 4
  s_cbranch_vccnz PL3_adaLN_cond__sliding_local_dilated__swiglu_ffn__prompt_kernel
PL3_adaLN_cond__sliding_local_dilated__swiglu_ffn__prompt_kernelx:
  s_barrier
  s_add_u32 m0, s70, 98304
  s_add_u32 s69, s58, 32768
  buffer_load_dwordx4 v12, s[8:11], s69 offen offset:0 sc1 lds
  buffer_load_dwordx4 v12, s[8:11], s69 offen offset:1024 sc1 lds
  buffer_load_dwordx4 v12, s[8:11], s69 offen offset:2048 sc1 lds
  buffer_load_dwordx4 v12, s[8:11], s69 offen offset:3072 sc1 lds
  s_add_u32 m0, s71, 131072
  s_add_u32 s69, s58, s72
  buffer_load_dwordx4 v1, s[8:11], s69 offen offset:0 sc1 lds
  buffer_load_dwordx4 v1, s[8:11], s69 offen offset:1024 sc1 lds
  s_add_u32 m0, s70, 114688
  s_add_u32 s69, s59, 32768
  buffer_load_dwordx4 v12, s[8:11], s69 offen offset:0 sc1 lds
  buffer_load_dwordx4 v12, s[8:11], s69 offen offset:1024 sc1 lds
  buffer_load_dwordx4 v12, s[8:11], s69 offen offset:2048 sc1 lds
  buffer_load_dwordx4 v12, s[8:11], s69 offen offset:3072 sc1 lds
  s_add_u32 m0, s71, 139264
  s_add_u32 s69, s59, s72
  buffer_load_dwordx4 v1, s[8:11], s69 offen offset:0 sc1 lds
  buffer_load_dwordx4 v1, s[8:11], s69 offen offset:1024 sc1 lds
  s_waitcnt vmcnt(21) lgkmcnt(0)
  s_barrier
  s_add_u32 m0, s45, 0
  s_add_u32 s68, s66, 4
  s_and_b32 s68, s68, 7
  s_mul_i32 s68, s68, 786432
  s_add_u32 s68, s68, 2048
  buffer_load_dwordx4 v9, s[12:15], s68 offen lds
  ds_read_b64_tr_b16 a[148:149], v4 offset:32768
  ds_read_b64_tr_b16 a[150:151], v4 offset:34816
  s_add_u32 m0, s45, 4096
  s_add_u32 s68, s68, 196608
  buffer_load_dwordx4 v9, s[12:15], s68 offen lds
  ds_read_b64_tr_b16 a[152:153], v5 offset:32768
  ds_read_b64_tr_b16 a[154:155], v5 offset:34816
  s_add_u32 m0, s45, 8192
  s_add_u32 s68, s68, 196608
  buffer_load_dwordx4 v9, s[12:15], s68 offen lds
  ds_read_b64_tr_b16 a[160:161], v4 offset:36864
  ds_read_b64_tr_b16 a[162:163], v4 offset:38912
  s_add_u32 m0, s45, 12288
  s_add_u32 s68, s68, 196608
  buffer_load_dwordx4 v9, s[12:15], s68 offen lds
  ds_read_b64_tr_b16 a[164:165], v5 offset:36864
  ds_read_b64_tr_b16 a[166:167], v5 offset:38912
  s_add_u32 m0, s45, 16384
  s_add_u32 s68, s66, 4
  s_and_b32 s68, s68, 7
  s_mul_i32 s68, s68, 786432
  s_add_u32 s68, s68, 4096
  buffer_load_dwordx4 v9, s[12:15], s68 offen lds
  ds_read_b64_tr_b16 a[172:173], v4 offset:40960
  ds_read_b64_tr_b16 a[174:175], v4 offset:43008
  s_add_u32 m0, s45, 20480
  s_add_u32 s68, s68, 196608
  buffer_load_dwordx4 v9, s[12:15], s68 offen lds
  ds_read_b64_tr_b16 a[176:177], v5 offset:40960
  ds_read_b64_tr_b16 a[178:179], v5 offset:43008
  s_add_u32 m0, s45, 24576
  s_add_u32 s68, s68, 196608
  buffer_load_dwordx4 v9, s[12:15], s68 offen lds
  ds_read_b64_tr_b16 a[184:185], v4 offset:45056
  ds_read_b64_tr_b16 a[186:187], v4 offset:47104
  s_add_u32 m0, s45, 28672
  s_add_u32 s68, s68, 196608
  buffer_load_dwordx4 v9, s[12:15], s68 offen lds
  ds_read_b64_tr_b16 a[188:189], v5 offset:45056
  ds_read_b64_tr_b16 a[190:191], v5 offset:47104
  s_waitcnt vmcnt(14) lgkmcnt(0)
  s_barrier
  ds_read_b128 v[76:79], v2 offset:32768
  ds_read_b128 v[80:83], v2 offset:33792
  ds_read_b128 v[84:87], v2 offset:40960
  ds_read_b128 v[88:91], v2 offset:41984
  ds_read_b128 v[92:95], v13 offset:0
  ds_read_b128 v[96:99], v13 offset:1024
  ds_read_b128 v[100:103], v2 offset:34816
  ds_read_b128 v[104:107], v2 offset:35840
  s_waitcnt lgkmcnt(2)
  v_mfma_f32_16x16x32_bf16 v[28:31], a[0:3], v[76:79], 0
  ds_read_b64_tr_b16 a[192:193], v6 offset:0
  s_add_u32 m0, s45, 32768
  s_add_u32 s68, s66, 5
  s_and_b32 s68, s68, 7
  s_mul_i32 s68, s68, 786432
  s_add_u32 s68, s68, 2048
  v_mfma_f32_16x16x32_bf16 v[28:31], a[12:15], v[80:83], v[28:31]
  ds_read_b128 v[108:111], v2 offset:43008
  buffer_load_dwordx4 v9, s[12:15], s68 offen lds
  v_mfma_f32_16x16x32_bf16 v[32:35], a[12:15], v[88:91], 0
  ds_read_b64_tr_b16 a[194:195], v6 offset:2048
  v_mfma_f32_16x16x32_bf16 v[32:35], a[0:3], v[84:87], v[32:35]
  ds_read_b64_tr_b16 a[204:205], v6 offset:4096
  v_mfma_f32_16x16x32_bf16 v[40:43], a[4:7], v[84:87], 0
  ds_read_b128 v[112:115], v2 offset:44032
  s_add_u32 m0, s45, 36864
  s_add_u32 s68, s68, 196608
  v_mfma_f32_16x16x32_bf16 v[40:43], a[16:19], v[88:91], v[40:43]
  ds_read_b64_tr_b16 a[206:207], v6 offset:6144
  buffer_load_dwordx4 v9, s[12:15], s68 offen lds
  v_mfma_f32_16x16x32_bf16 v[36:39], a[16:19], v[80:83], 0
  ds_read_b128 v[116:119], v13 offset:2048
  v_mfma_f32_16x16x32_bf16 v[36:39], a[4:7], v[76:79], v[36:39]
  ds_read_b64_tr_b16 a[216:217], v6 offset:8192
  v_mfma_f32_16x16x32_bf16 v[44:47], a[8:11], v[76:79], 0
  ds_read_b64_tr_b16 a[218:219], v6 offset:10240
  s_add_u32 m0, s45, 40960
  s_add_u32 s68, s68, 196608
  v_mfma_f32_16x16x32_bf16 v[44:47], a[20:23], v[80:83], v[44:47]
  ds_read_b128 v[120:123], v13 offset:3072
  buffer_load_dwordx4 v9, s[12:15], s68 offen lds
  v_mfma_f32_16x16x32_bf16 v[48:51], a[20:23], v[88:91], 0
  ds_read_b64_tr_b16 a[228:229], v6 offset:12288
  v_mfma_f32_16x16x32_bf16 v[48:51], a[8:11], v[84:87], v[48:51]
  ds_read_b64_tr_b16 a[230:231], v6 offset:14336
  v_mfma_f32_16x16x32_bf16 v[68:71], a[8:11], v[92:95], 0
  ds_read_b128 v[76:79], v2 offset:36864
  s_add_u32 m0, s45, 45056
  s_add_u32 s68, s68, 196608
  v_mfma_f32_16x16x32_bf16 v[68:71], a[20:23], v[96:99], v[68:71]
  ds_read_b64_tr_b16 a[240:241], v6 offset:16384
  buffer_load_dwordx4 v9, s[12:15], s68 offen lds
  v_mfma_f32_16x16x32_bf16 v[60:63], a[16:19], v[96:99], 0
  ds_read_b128 v[80:83], v2 offset:37888
  v_mfma_f32_16x16x32_bf16 v[60:63], a[4:7], v[92:95], v[60:63]
  s_waitcnt lgkmcnt(5)
  ds_read_b64_tr_b16 a[242:243], v6 offset:18432
  v_mfma_f32_16x16x32_bf16 v[28:31], a[24:27], v[100:103], v[28:31]
  ds_read_b64_tr_b16 v[124:125], v6 offset:20480
  s_add_u32 m0, s45, 49152
  s_add_u32 s68, s66, 5
  s_and_b32 s68, s68, 7
  s_mul_i32 s68, s68, 786432
  s_add_u32 s68, s68, 4096
  v_mfma_f32_16x16x32_bf16 v[28:31], a[36:39], v[104:107], v[28:31]
  ds_read_b128 v[88:91], v2 offset:45056
  buffer_load_dwordx4 v9, s[12:15], s68 offen lds
  v_mfma_f32_16x16x32_bf16 v[32:35], a[36:39], v[112:115], v[32:35]
  ds_read_b64_tr_b16 v[126:127], v6 offset:22528
  v_mfma_f32_16x16x32_bf16 v[32:35], a[24:27], v[108:111], v[32:35]
  ds_read_b64_tr_b16 v[136:137], v6 offset:24576
  v_mfma_f32_16x16x32_bf16 v[40:43], a[28:31], v[108:111], v[40:43]
  ds_read_b128 v[84:87], v2 offset:46080
  s_add_u32 m0, s45, 53248
  s_add_u32 s68, s68, 196608
  v_mfma_f32_16x16x32_bf16 v[40:43], a[40:43], v[112:115], v[40:43]
  ds_read_b64_tr_b16 v[138:139], v6 offset:26624
  buffer_load_dwordx4 v9, s[12:15], s68 offen lds
  v_mfma_f32_16x16x32_bf16 v[36:39], a[40:43], v[104:107], v[36:39]
  ds_read_b128 v[96:99], v13 offset:4096
  v_mfma_f32_16x16x32_bf16 v[36:39], a[28:31], v[100:103], v[36:39]
  ds_read_b64_tr_b16 v[148:149], v6 offset:28672
  v_mfma_f32_16x16x32_bf16 v[44:47], a[32:35], v[100:103], v[44:47]
  ds_read_b64_tr_b16 v[150:151], v6 offset:30720
  v_mfma_f32_16x16x32_bf16 v[44:47], a[44:47], v[104:107], v[44:47]
  ds_read_b128 v[92:95], v13 offset:5120
  s_add_u32 m0, s45, 57344
  s_add_u32 s68, s68, 196608
  v_mfma_f32_16x16x32_bf16 v[48:51], a[44:47], v[112:115], v[48:51]
  buffer_load_dwordx4 v9, s[12:15], s68 offen lds
  v_mfma_f32_16x16x32_bf16 v[48:51], a[32:35], v[108:111], v[48:51]
  s_add_u32 m0, s45, 61440
  s_add_u32 s68, s68, 196608
  v_mfma_f32_16x16x32_bf16 v[68:71], a[32:35], v[116:119], v[68:71]
  ds_read_b128 v[100:103], v2 offset:38912
  v_mfma_f32_16x16x32_bf16 v[68:71], a[44:47], v[120:123], v[68:71]
  buffer_load_dwordx4 v9, s[12:15], s68 offen lds
  v_mfma_f32_16x16x32_bf16 v[60:63], a[40:43], v[120:123], v[60:63]
  ds_read_b128 v[104:107], v2 offset:39936
  v_mfma_f32_16x16x32_bf16 v[60:63], a[28:31], v[116:119], v[60:63]
  s_waitcnt lgkmcnt(2)
  v_mfma_f32_16x16x32_bf16 v[28:31], a[48:51], v[76:79], v[28:31]
  s_add_u32 m0, s71, 147456
  s_add_u32 s69, s60, s72
  v_mfma_f32_16x16x32_bf16 v[28:31], a[60:63], v[80:83], v[28:31]
  ds_read_b128 v[112:115], v2 offset:47104
  v_mfma_f32_16x16x32_bf16 v[32:35], a[60:63], v[84:87], v[32:35]
  buffer_load_dwordx4 v1, s[8:11], s69 offen offset:0 sc1 lds
  v_mfma_f32_16x16x32_bf16 v[32:35], a[48:51], v[88:91], v[32:35]
  v_mfma_f32_16x16x32_bf16 v[40:43], a[52:55], v[88:91], v[40:43]
  ds_read_b128 v[108:111], v2 offset:48128
  v_mfma_f32_16x16x32_bf16 v[40:43], a[64:67], v[84:87], v[40:43]
  buffer_load_dwordx4 v1, s[8:11], s69 offen offset:1024 sc1 lds
  v_mfma_f32_16x16x32_bf16 v[36:39], a[64:67], v[80:83], v[36:39]
  ds_read_b128 v[120:123], v13 offset:6144
  v_mfma_f32_16x16x32_bf16 v[36:39], a[52:55], v[76:79], v[36:39]
  v_mfma_f32_16x16x32_bf16 v[44:47], a[56:59], v[76:79], v[44:47]
  s_add_u32 m0, s71, 155648
  s_add_u32 s69, s61, s72
  v_mfma_f32_16x16x32_bf16 v[44:47], a[68:71], v[80:83], v[44:47]
  ds_read_b128 v[116:119], v13 offset:7168
  v_mfma_f32_16x16x32_bf16 v[48:51], a[68:71], v[84:87], v[48:51]
HOP1:
  s_cbranch_execz HOP5
  buffer_load_dwordx4 v1, s[8:11], s69 offen offset:0 sc1 lds
  v_mfma_f32_16x16x32_bf16 v[48:51], a[56:59], v[88:91], v[48:51]
  s_waitcnt vmcnt(11) lgkmcnt(7)
  s_barrier
  v_mfma_f32_16x16x32_bf16 v[68:71], a[56:59], v[96:99], v[68:71]
  ds_read_b128 v[76:79], v2 offset:49152
  v_mfma_f32_16x16x32_bf16 v[68:71], a[68:71], v[92:95], v[68:71]
  ds_read_b64_tr_b16 a[196:197], v4 offset:0
  buffer_load_dwordx4 v1, s[8:11], s69 offen offset:1024 sc1 lds
  v_mfma_f32_16x16x32_bf16 v[60:63], a[64:67], v[92:95], v[60:63]
  ds_read_b128 v[80:83], v2 offset:50176
  v_mfma_f32_16x16x32_bf16 v[60:63], a[52:55], v[96:99], v[60:63]
  s_waitcnt lgkmcnt(3)
  ds_read_b64_tr_b16 a[198:199], v4 offset:2048
  v_mfma_f32_16x16x32_bf16 v[28:31], a[72:75], v[100:103], v[28:31]
  ds_read_b64_tr_b16 a[200:201], v5 offset:0
  s_add_u32 m0, s70, 65536
  s_add_u32 s69, s60, 32768
  v_mfma_f32_16x16x32_bf16 v[28:31], a[84:87], v[104:107], v[28:31]
  ds_read_b128 v[84:87], v2 offset:57344
  buffer_load_dwordx4 v12, s[8:11], s69 offen offset:0 sc1 lds
  v_mfma_f32_16x16x32_bf16 v[32:35], a[84:87], v[108:111], v[32:35]
  ds_read_b64_tr_b16 a[202:203], v5 offset:2048
  v_mfma_f32_16x16x32_bf16 v[32:35], a[72:75], v[112:115], v[32:35]
  ds_read_b64_tr_b16 a[208:209], v4 offset:4096
  v_mfma_f32_16x16x32_bf16 v[40:43], a[76:79], v[112:115], v[40:43]
  ds_read_b128 v[88:91], v2 offset:58368
  v_mfma_f32_16x16x32_bf16 v[40:43], a[88:91], v[108:111], v[40:43]
  ds_read_b64_tr_b16 a[210:211], v4 offset:6144
  buffer_load_dwordx4 v12, s[8:11], s69 offen offset:1024 sc1 lds
  v_mfma_f32_16x16x32_bf16 v[36:39], a[88:91], v[104:107], v[36:39]
  ds_read_b128 v[92:95], v13 offset:8192
  v_mfma_f32_16x16x32_bf16 v[36:39], a[76:79], v[100:103], v[36:39]
  ds_read_b64_tr_b16 a[212:213], v5 offset:4096
  v_mfma_f32_16x16x32_bf16 v[44:47], a[80:83], v[100:103], v[44:47]
  ds_read_b64_tr_b16 a[214:215], v5 offset:6144
  v_mfma_f32_16x16x32_bf16 v[44:47], a[92:95], v[104:107], v[44:47]
  ds_read_b128 v[96:99], v13 offset:9216
  buffer_load_dwordx4 v12, s[8:11], s69 offen offset:2048 sc1 lds
  v_mfma_f32_16x16x32_bf16 v[48:51], a[92:95], v[108:111], v[48:51]
  ds_read_b64_tr_b16 a[220:221], v4 offset:8192
  v_mfma_f32_16x16x32_bf16 v[48:51], a[80:83], v[112:115], v[48:51]
  ds_read_b64_tr_b16 a[222:223], v4 offset:10240
  v_mfma_f32_16x16x32_bf16 v[68:71], a[80:83], v[120:123], v[68:71]
  ds_read_b128 v[100:103], v2 offset:51200
  v_mfma_f32_16x16x32_bf16 v[68:71], a[92:95], v[116:119], v[68:71]
  ds_read_b64_tr_b16 a[224:225], v5 offset:8192
  buffer_load_dwordx4 v12, s[8:11], s69 offen offset:3072 sc1 lds
  v_mfma_f32_16x16x32_bf16 v[60:63], a[88:91], v[116:119], v[60:63]
  ds_read_b128 v[104:107], v2 offset:52224
  v_mfma_f32_16x16x32_bf16 v[60:63], a[76:79], v[120:123], v[60:63]
  s_waitcnt lgkmcnt(5)
  ds_read_b64_tr_b16 a[226:227], v5 offset:10240
  v_mfma_f32_16x16x32_bf16 v[28:31], a[96:99], v[76:79], v[28:31]
  ds_read_b64_tr_b16 a[232:233], v4 offset:12288
  s_add_u32 m0, s45, 81920
  s_add_u32 s68, s66, 6
  s_and_b32 s68, s68, 7
  s_mul_i32 s68, s68, 786432
  v_mfma_f32_16x16x32_bf16 v[28:31], a[108:111], v[80:83], v[28:31]
  ds_read_b128 v[108:111], v2 offset:59392
  buffer_load_dwordx4 v9, s[12:15], s68 offen lds
  v_mfma_f32_16x16x32_bf16 v[32:35], a[108:111], v[88:91], v[32:35]
  ds_read_b64_tr_b16 a[234:235], v4 offset:14336
  v_mfma_f32_16x16x32_bf16 v[32:35], a[96:99], v[84:87], v[32:35]
  ds_read_b64_tr_b16 a[236:237], v5 offset:12288
  v_mfma_f32_16x16x32_bf16 v[40:43], a[100:103], v[84:87], v[40:43]
  ds_read_b128 v[112:115], v2 offset:60416
  s_add_u32 m0, s45, 86016
  s_add_u32 s68, s68, 196608
  v_mfma_f32_16x16x32_bf16 v[40:43], a[112:115], v[88:91], v[40:43]
  ds_read_b64_tr_b16 a[238:239], v5 offset:14336
  buffer_load_dwordx4 v9, s[12:15], s68 offen lds
  v_mfma_f32_16x16x32_bf16 v[36:39], a[112:115], v[80:83], v[36:39]
  ds_read_b128 v[116:119], v13 offset:10240
  v_mfma_f32_16x16x32_bf16 v[36:39], a[100:103], v[76:79], v[36:39]
  v_mfma_f32_16x16x32_bf16 v[44:47], a[104:107], v[76:79], v[44:47]
  s_add_u32 m0, s45, 90112
  s_add_u32 s68, s68, 196608
  v_mfma_f32_16x16x32_bf16 v[44:47], a[116:119], v[80:83], v[44:47]
  ds_read_b128 v[120:123], v13 offset:11264
  v_mfma_f32_16x16x32_bf16 v[48:51], a[116:119], v[88:91], v[48:51]
  buffer_load_dwordx4 v9, s[12:15], s68 offen lds
  v_mfma_f32_16x16x32_bf16 v[48:51], a[104:107], v[84:87], v[48:51]
  s_waitcnt vmcnt(11) lgkmcnt(2)
  s_barrier
  v_mfma_f32_16x16x32_bf16 v[68:71], a[104:107], v[92:95], v[68:71]
  ds_read_b128 v[76:79], v2 offset:53248
  s_add_u32 m0, s45, 94208
  s_add_u32 s68, s68, 196608
  v_mfma_f32_16x16x32_bf16 v[68:71], a[116:119], v[96:99], v[68:71]
  ds_read_b64_tr_b16 a[244:245], v4 offset:32768
  buffer_load_dwordx4 v9, s[12:15], s68 offen lds
  v_mfma_f32_16x16x32_bf16 v[60:63], a[112:115], v[96:99], v[60:63]
  ds_read_b128 v[80:83], v2 offset:54272
  v_mfma_f32_16x16x32_bf16 v[60:63], a[100:103], v[92:95], v[60:63]
  s_waitcnt lgkmcnt(3)
  ds_read_b64_tr_b16 a[246:247], v4 offset:34816
  v_mfma_f32_16x16x32_bf16 v[28:31], a[120:123], v[100:103], v[28:31]
  ds_read_b64_tr_b16 a[248:249], v5 offset:32768
  s_add_u32 m0, s45, 98304
  s_add_u32 s68, s66, 7
  s_and_b32 s68, s68, 7
  s_mul_i32 s68, s68, 786432
  v_mfma_f32_16x16x32_bf16 v[28:31], a[132:135], v[104:107], v[28:31]
  ds_read_b128 v[88:91], v2 offset:61440
  buffer_load_dwordx4 v9, s[12:15], s68 offen lds
  v_mfma_f32_16x16x32_bf16 v[32:35], a[132:135], v[112:115], v[32:35]
  ds_read_b64_tr_b16 a[250:251], v5 offset:34816
  v_mfma_f32_16x16x32_bf16 v[32:35], a[120:123], v[108:111], v[32:35]
  ds_read_b64_tr_b16 v[128:129], v4 offset:36864
  v_mfma_f32_16x16x32_bf16 v[40:43], a[124:127], v[108:111], v[40:43]
  ds_read_b128 v[84:87], v2 offset:62464
  s_add_u32 m0, s45, 102400
  s_add_u32 s68, s68, 196608
  v_mfma_f32_16x16x32_bf16 v[40:43], a[136:139], v[112:115], v[40:43]
  ds_read_b64_tr_b16 v[130:131], v4 offset:38912
  buffer_load_dwordx4 v9, s[12:15], s68 offen lds
  v_mfma_f32_16x16x32_bf16 v[36:39], a[136:139], v[104:107], v[36:39]
  ds_read_b128 v[96:99], v13 offset:12288
  v_mfma_f32_16x16x32_bf16 v[36:39], a[124:127], v[100:103], v[36:39]
  ds_read_b64_tr_b16 v[132:133], v5 offset:36864
  v_mfma_f32_16x16x32_bf16 v[44:47], a[128:131], v[100:103], v[44:47]
  ds_read_b64_tr_b16 v[134:135], v5 offset:38912
  s_add_u32 m0, s45, 106496
  s_add_u32 s68, s68, 196608
  v_mfma_f32_16x16x32_bf16 v[44:47], a[140:143], v[104:107], v[44:47]
  ds_read_b128 v[92:95], v13 offset:13312
  buffer_load_dwordx4 v9, s[12:15], s68 offen lds
  v_mfma_f32_16x16x32_bf16 v[48:51], a[140:143], v[112:115], v[48:51]
  ds_read_b64_tr_b16 v[140:141], v4 offset:40960
  v_mfma_f32_16x16x32_bf16 v[48:51], a[128:131], v[108:111], v[48:51]
  ds_read_b64_tr_b16 v[142:143], v4 offset:43008
  v_mfma_f32_16x16x32_bf16 v[68:71], a[128:131], v[116:119], v[68:71]
  ds_read_b128 v[100:103], v2 offset:55296
  s_add_u32 m0, s45, 110592
  s_add_u32 s68, s68, 196608
  v_mfma_f32_16x16x32_bf16 v[68:71], a[140:143], v[120:123], v[68:71]
  ds_read_b64_tr_b16 v[144:145], v5 offset:40960
  buffer_load_dwordx4 v9, s[12:15], s68 offen lds
  v_mfma_f32_16x16x32_bf16 v[60:63], a[136:139], v[120:123], v[60:63]
  ds_read_b128 v[104:107], v2 offset:56320
  v_mfma_f32_16x16x32_bf16 v[60:63], a[124:127], v[116:119], v[60:63]
  s_waitcnt lgkmcnt(5)
  ds_read_b64_tr_b16 v[146:147], v5 offset:43008
  v_mfma_f32_16x16x32_bf16 v[28:31], a[144:147], v[76:79], v[28:31]
  ds_read_b64_tr_b16 v[152:153], v4 offset:45056
  s_add_u32 m0, s45, 0
  s_add_u32 s68, s66, 6
  s_and_b32 s68, s68, 7
  s_mul_i32 s68, s68, 786432
  s_add_u32 s68, s68, 2048
  v_mfma_f32_16x16x32_bf16 v[28:31], a[156:159], v[80:83], v[28:31]
  ds_read_b128 v[112:115], v2 offset:63488
  buffer_load_dwordx4 v9, s[12:15], s68 offen lds
  v_mfma_f32_16x16x32_bf16 v[32:35], a[156:159], v[84:87], v[32:35]
  ds_read_b64_tr_b16 v[154:155], v4 offset:47104
  v_mfma_f32_16x16x32_bf16 v[32:35], a[144:147], v[88:91], v[32:35]
  ds_read_b64_tr_b16 v[156:157], v5 offset:45056
  v_mfma_f32_16x16x32_bf16 v[40:43], a[148:151], v[88:91], v[40:43]
  ds_read_b128 v[108:111], v2 offset:64512
  s_add_u32 m0, s45, 4096
  s_add_u32 s68, s68, 196608
  v_mfma_f32_16x16x32_bf16 v[40:43], a[160:163], v[84:87], v[40:43]
  ds_read_b64_tr_b16 v[158:159], v5 offset:47104
  buffer_load_dwordx4 v9, s[12:15], s68 offen lds
  v_mfma_f32_16x16x32_bf16 v[36:39], a[160:163], v[80:83], v[36:39]
  ds_read_b128 v[120:123], v13 offset:14336
  v_mfma_f32_16x16x32_bf16 v[36:39], a[148:151], v[76:79], v[36:39]
  v_mfma_f32_16x16x32_bf16 v[44:47], a[152:155], v[76:79], v[44:47]
  s_add_u32 m0, s45, 8192
  s_add_u32 s68, s68, 196608
  v_mfma_f32_16x16x32_bf16 v[44:47], a[164:167], v[80:83], v[44:47]
  ds_read_b128 v[116:119], v13 offset:15360
  v_mfma_f32_16x16x32_bf16 v[48:51], a[164:167], v[84:87], v[48:51]
  buffer_load_dwordx4 v9, s[12:15], s68 offen lds
  v_mfma_f32_16x16x32_bf16 v[48:51], a[152:155], v[88:91], v[48:51]
  s_waitcnt vmcnt(3) lgkmcnt(2)
  s_barrier
  v_mfma_f32_16x16x32_bf16 v[68:71], a[152:155], v[96:99], v[68:71]
  ds_read_b128 v[76:79], v2 offset:0
  s_add_u32 m0, s45, 12288
  s_add_u32 s68, s68, 196608
  v_mfma_f32_16x16x32_bf16 v[68:71], a[164:167], v[92:95], v[68:71]
  ds_read_b64_tr_b16 v[160:161], v6 offset:16384
  buffer_load_dwordx4 v9, s[12:15], s68 offen lds
  v_mfma_f32_16x16x32_bf16 v[60:63], a[160:163], v[92:95], v[60:63]
  ds_read_b128 v[80:83], v2 offset:1024
  v_mfma_f32_16x16x32_bf16 v[60:63], a[148:151], v[96:99], v[60:63]
  s_waitcnt lgkmcnt(3)
  ds_read_b64_tr_b16 v[162:163], v6 offset:18432
  v_mfma_f32_16x16x32_bf16 v[28:31], a[168:171], v[100:103], v[28:31]
  ds_read_b64_tr_b16 v[172:173], v6 offset:20480
  s_add_u32 m0, s45, 16384
  s_add_u32 s68, s66, 6
  s_and_b32 s68, s68, 7
  s_mul_i32 s68, s68, 786432
  s_add_u32 s68, s68, 4096
  v_mfma_f32_16x16x32_bf16 v[28:31], a[180:183], v[104:107], v[28:31]
  ds_read_b128 v[84:87], v2 offset:8192
  buffer_load_dwordx4 v9, s[12:15], s68 offen lds
  v_mfma_f32_16x16x32_bf16 v[32:35], a[180:183], v[108:111], v[32:35]
  ds_read_b64_tr_b16 v[174:175], v6 offset:22528
  v_mfma_f32_16x16x32_bf16 v[32:35], a[168:171], v[112:115], v[32:35]
  ds_read_b64_tr_b16 v[184:185], v6 offset:24576
  v_mfma_f32_16x16x32_bf16 v[40:43], a[172:175], v[112:115], v[40:43]
  ds_read_b128 v[88:91], v2 offset:9216
  s_add_u32 m0, s45, 20480
  s_add_u32 s68, s68, 196608
  v_mfma_f32_16x16x32_bf16 v[40:43], a[184:187], v[108:111], v[40:43]
  ds_read_b64_tr_b16 v[186:187], v6 offset:26624
  buffer_load_dwordx4 v9, s[12:15], s68 offen lds
  v_mfma_f32_16x16x32_bf16 v[36:39], a[184:187], v[104:107], v[36:39]
  ds_read_b128 v[92:95], v13 offset:16384
  v_mfma_f32_16x16x32_bf16 v[36:39], a[172:175], v[100:103], v[36:39]
  ds_read_b64_tr_b16 v[196:197], v6 offset:28672
  v_mfma_f32_16x16x32_bf16 v[44:47], a[176:179], v[100:103], v[44:47]
  ds_read_b64_tr_b16 v[198:199], v6 offset:30720
  s_add_u32 m0, s45, 24576
  s_add_u32 s68, s68, 196608
  v_mfma_f32_16x16x32_bf16 v[44:47], a[188:191], v[104:107], v[44:47]
  ds_read_b128 v[96:99], v13 offset:17408
  buffer_load_dwordx4 v9, s[12:15], s68 offen lds
  v_mfma_f32_16x16x32_bf16 v[48:51], a[188:191], v[108:111], v[48:51]
  ds_read_b64_tr_b16 v[208:209], v6 offset:32768
  v_mfma_f32_16x16x32_bf16 v[48:51], a[176:179], v[112:115], v[48:51]
  ds_read_b64_tr_b16 v[210:211], v6 offset:34816
  v_mfma_f32_16x16x32_bf16 v[68:71], a[176:179], v[120:123], v[68:71]
  ds_read_b128 v[100:103], v2 offset:2048
  s_add_u32 m0, s45, 28672
  s_add_u32 s68, s68, 196608
  v_mfma_f32_16x16x32_bf16 v[68:71], a[188:191], v[116:119], v[68:71]
  ds_read_b64_tr_b16 v[220:221], v6 offset:36864
  buffer_load_dwordx4 v9, s[12:15], s68 offen lds
  v_mfma_f32_16x16x32_bf16 v[60:63], a[184:187], v[116:119], v[60:63]
  ds_read_b128 v[104:107], v2 offset:3072
  v_mfma_f32_16x16x32_bf16 v[60:63], a[172:175], v[120:123], v[60:63]
  s_waitcnt lgkmcnt(5)
  ds_read_b64_tr_b16 v[222:223], v6 offset:38912
  v_mfma_f32_16x16x32_bf16 v[28:31], a[192:195], v[76:79], v[28:31]
  ds_read_b64_tr_b16 v[232:233], v6 offset:40960
  s_add_u32 m0, s70, 32768
  s_add_u32 s69, s61, 32768
  v_mfma_f32_16x16x32_bf16 v[28:31], a[204:207], v[80:83], v[28:31]
  ds_read_b128 v[108:111], v2 offset:10240
  buffer_load_dwordx4 v12, s[8:11], s69 offen offset:0 sc1 lds
  v_mfma_f32_16x16x32_bf16 v[32:35], a[204:207], v[88:91], v[32:35]
  ds_read_b64_tr_b16 v[234:235], v6 offset:43008
  v_mfma_f32_16x16x32_bf16 v[32:35], a[192:195], v[84:87], v[32:35]
  ds_read_b64_tr_b16 v[244:245], v6 offset:45056
  v_mfma_f32_16x16x32_bf16 v[40:43], a[196:199], v[84:87], v[40:43]
  ds_read_b128 v[112:115], v2 offset:11264
  v_mfma_f32_16x16x32_bf16 v[40:43], a[208:211], v[88:91], v[40:43]
  ds_read_b64_tr_b16 v[246:247], v6 offset:47104
  buffer_load_dwordx4 v12, s[8:11], s69 offen offset:1024 sc1 lds
  v_mfma_f32_16x16x32_bf16 v[36:39], a[208:211], v[80:83], v[36:39]
  ds_read_b128 v[116:119], v13 offset:18432
  v_mfma_f32_16x16x32_bf16 v[36:39], a[196:199], v[76:79], v[36:39]
  v_mfma_f32_16x16x32_bf16 v[44:47], a[200:203], v[76:79], v[44:47]
  v_mfma_f32_16x16x32_bf16 v[44:47], a[212:215], v[80:83], v[44:47]
  ds_read_b128 v[120:123], v13 offset:19456
  v_mfma_f32_16x16x32_bf16 v[48:51], a[212:215], v[88:91], v[48:51]
  buffer_load_dwordx4 v12, s[8:11], s69 offen offset:2048 sc1 lds
  v_mfma_f32_16x16x32_bf16 v[48:51], a[200:203], v[84:87], v[48:51]
  s_waitcnt vmcnt(3) lgkmcnt(2)
  s_barrier
  v_mfma_f32_16x16x32_bf16 v[68:71], a[200:203], v[92:95], v[68:71]
  ds_read_b128 v[76:79], v2 offset:4096
  v_mfma_f32_16x16x32_bf16 v[68:71], a[212:215], v[96:99], v[68:71]
  ds_read_b64_tr_b16 v[164:165], v4 offset:0
  buffer_load_dwordx4 v12, s[8:11], s69 offen offset:3072 sc1 lds
  v_mfma_f32_16x16x32_bf16 v[60:63], a[208:211], v[96:99], v[60:63]
  ds_read_b128 v[80:83], v2 offset:5120
  v_mfma_f32_16x16x32_bf16 v[60:63], a[196:199], v[92:95], v[60:63]
  s_waitcnt lgkmcnt(3)
  ds_read_b64_tr_b16 v[166:167], v4 offset:2048
  v_mfma_f32_16x16x32_bf16 v[28:31], a[216:219], v[100:103], v[28:31]
  ds_read_b64_tr_b16 v[168:169], v5 offset:0
  s_add_u32 m0, s45, 81920
  s_add_u32 s68, s66, 7
  s_and_b32 s68, s68, 7
  s_mul_i32 s68, s68, 786432
  s_add_u32 s68, s68, 2048
  v_mfma_f32_16x16x32_bf16 v[28:31], a[228:231], v[104:107], v[28:31]
  ds_read_b128 v[88:91], v2 offset:12288
  buffer_load_dwordx4 v9, s[12:15], s68 offen lds
  v_mfma_f32_16x16x32_bf16 v[32:35], a[228:231], v[112:115], v[32:35]
  ds_read_b64_tr_b16 v[170:171], v5 offset:2048
  v_mfma_f32_16x16x32_bf16 v[32:35], a[216:219], v[108:111], v[32:35]
  ds_read_b64_tr_b16 v[176:177], v4 offset:4096
  v_mfma_f32_16x16x32_bf16 v[40:43], a[220:223], v[108:111], v[40:43]
  ds_read_b128 v[84:87], v2 offset:13312
  s_add_u32 m0, s45, 86016
  s_add_u32 s68, s68, 196608
  v_mfma_f32_16x16x32_bf16 v[40:43], a[232:235], v[112:115], v[40:43]
  ds_read_b64_tr_b16 v[178:179], v4 offset:6144
  buffer_load_dwordx4 v9, s[12:15], s68 offen lds
  v_mfma_f32_16x16x32_bf16 v[36:39], a[232:235], v[104:107], v[36:39]
  ds_read_b128 v[96:99], v13 offset:20480
  v_mfma_f32_16x16x32_bf16 v[36:39], a[220:223], v[100:103], v[36:39]
  ds_read_b64_tr_b16 v[180:181], v5 offset:4096
  v_mfma_f32_16x16x32_bf16 v[44:47], a[224:227], v[100:103], v[44:47]
  ds_read_b64_tr_b16 v[182:183], v5 offset:6144
  s_add_u32 m0, s45, 90112
  s_add_u32 s68, s68, 196608
  v_mfma_f32_16x16x32_bf16 v[44:47], a[236:239], v[104:107], v[44:47]
  ds_read_b128 v[92:95], v13 offset:21504
  buffer_load_dwordx4 v9, s[12:15], s68 offen lds
  v_mfma_f32_16x16x32_bf16 v[48:51], a[236:239], v[112:115], v[48:51]
  ds_read_b64_tr_b16 v[188:189], v4 offset:8192
  v_mfma_f32_16x16x32_bf16 v[48:51], a[224:227], v[108:111], v[48:51]
  ds_read_b64_tr_b16 v[190:191], v4 offset:10240
  v_mfma_f32_16x16x32_bf16 v[68:71], a[224:227], v[116:119], v[68:71]
  ds_read_b128 v[100:103], v2 offset:6144
  s_add_u32 m0, s45, 94208
  s_add_u32 s68, s68, 196608
  v_mfma_f32_16x16x32_bf16 v[68:71], a[236:239], v[120:123], v[68:71]
  ds_read_b64_tr_b16 v[192:193], v5 offset:8192
  buffer_load_dwordx4 v9, s[12:15], s68 offen lds
  v_mfma_f32_16x16x32_bf16 v[60:63], a[232:235], v[120:123], v[60:63]
  ds_read_b128 v[104:107], v2 offset:7168
  v_mfma_f32_16x16x32_bf16 v[60:63], a[220:223], v[116:119], v[60:63]
  s_waitcnt lgkmcnt(5)
  ds_read_b64_tr_b16 v[194:195], v5 offset:10240
  v_mfma_f32_16x16x32_bf16 v[28:31], a[240:243], v[76:79], v[28:31]
  ds_read_b64_tr_b16 v[200:201], v4 offset:12288
  s_add_u32 m0, s45, 98304
  s_add_u32 s68, s66, 7
  s_and_b32 s68, s68, 7
  s_mul_i32 s68, s68, 786432
  s_add_u32 s68, s68, 4096
  v_mfma_f32_16x16x32_bf16 v[28:31], v[124:127], v[80:83], v[28:31]
  ds_read_b128 v[112:115], v2 offset:14336
  buffer_load_dwordx4 v9, s[12:15], s68 offen lds
  v_mfma_f32_16x16x32_bf16 v[32:35], v[124:127], v[84:87], v[32:35]
  ds_read_b64_tr_b16 v[202:203], v4 offset:14336
  v_mfma_f32_16x16x32_bf16 v[32:35], a[240:243], v[88:91], v[32:35]
  ds_read_b64_tr_b16 v[204:205], v5 offset:12288
  v_mfma_f32_16x16x32_bf16 v[40:43], a[244:247], v[88:91], v[40:43]
  ds_read_b128 v[108:111], v2 offset:15360
  s_add_u32 m0, s45, 102400
  s_add_u32 s68, s68, 196608
  v_mfma_f32_16x16x32_bf16 v[40:43], v[128:131], v[84:87], v[40:43]
  ds_read_b64_tr_b16 v[206:207], v5 offset:14336
  buffer_load_dwordx4 v9, s[12:15], s68 offen lds
  v_mfma_f32_16x16x32_bf16 v[36:39], v[128:131], v[80:83], v[36:39]
  ds_read_b128 v[120:123], v13 offset:22528
  v_mfma_f32_16x16x32_bf16 v[36:39], a[244:247], v[76:79], v[36:39]
  v_mfma_f32_16x16x32_bf16 v[44:47], a[248:251], v[76:79], v[44:47]
  s_add_u32 m0, s45, 106496
  s_add_u32 s68, s68, 196608
  v_mfma_f32_16x16x32_bf16 v[44:47], v[132:135], v[80:83], v[44:47]
  ds_read_b128 v[116:119], v13 offset:23552
  v_mfma_f32_16x16x32_bf16 v[48:51], v[132:135], v[84:87], v[48:51]
  buffer_load_dwordx4 v9, s[12:15], s68 offen lds
  v_mfma_f32_16x16x32_bf16 v[48:51], a[248:251], v[88:91], v[48:51]
  s_waitcnt vmcnt(7) lgkmcnt(2)
  s_barrier
  v_mfma_f32_16x16x32_bf16 v[68:71], a[248:251], v[96:99], v[68:71]
  ds_read_b128 v[76:79], v1 offset:32768
  s_add_u32 m0, s45, 110592
  s_add_u32 s68, s68, 196608
  v_mfma_f32_16x16x32_bf16 v[68:71], v[132:135], v[92:95], v[68:71]
  buffer_load_dwordx4 v9, s[12:15], s68 offen lds
  v_mfma_f32_16x16x32_bf16 v[60:63], v[128:131], v[92:95], v[60:63]
  ds_read_b128 v[80:83], v1 offset:33792
  v_mfma_f32_16x16x32_bf16 v[60:63], a[244:247], v[96:99], v[60:63]
  s_waitcnt lgkmcnt(2)
  v_mfma_f32_16x16x32_bf16 v[28:31], v[136:139], v[100:103], v[28:31]
  s_add_u32 m0, s70, 49152
  s_add_u32 s69, s58, 98304
  v_mfma_f32_16x16x32_bf16 v[28:31], v[148:151], v[104:107], v[28:31]
  ds_read_b128 v[84:87], v1 offset:40960
  v_mfma_f32_16x16x32_bf16 v[32:35], v[148:151], v[108:111], v[32:35]
  buffer_load_dwordx4 v12, s[8:11], s69 offen offset:0 sc1 lds
  v_mfma_f32_16x16x32_bf16 v[32:35], v[136:139], v[112:115], v[32:35]
  v_mfma_f32_16x16x32_bf16 v[40:43], v[140:143], v[112:115], v[40:43]
  ds_read_b128 v[88:91], v1 offset:41984
  v_mfma_f32_16x16x32_bf16 v[40:43], v[152:155], v[108:111], v[40:43]
  buffer_load_dwordx4 v12, s[8:11], s69 offen offset:1024 sc1 lds
  v_mfma_f32_16x16x32_bf16 v[36:39], v[152:155], v[104:107], v[36:39]
  ds_read_b128 v[92:95], v13 offset:24576
  v_mfma_f32_16x16x32_bf16 v[36:39], v[140:143], v[100:103], v[36:39]
  v_mfma_f32_16x16x32_bf16 v[44:47], v[144:147], v[100:103], v[44:47]
  v_mfma_f32_16x16x32_bf16 v[44:47], v[156:159], v[104:107], v[44:47]
  ds_read_b128 v[96:99], v13 offset:25600
  v_mfma_f32_16x16x32_bf16 v[48:51], v[156:159], v[108:111], v[48:51]
  buffer_load_dwordx4 v12, s[8:11], s69 offen offset:2048 sc1 lds
  v_mfma_f32_16x16x32_bf16 v[48:51], v[144:147], v[112:115], v[48:51]
  s_waitcnt vmcnt(3)
  s_barrier
  v_mfma_f32_16x16x32_bf16 v[68:71], v[144:147], v[120:123], v[68:71]
  ds_read_b128 v[100:103], v1 offset:34816
  v_mfma_f32_16x16x32_bf16 v[68:71], v[156:159], v[116:119], v[68:71]
  ds_read_b64_tr_b16 v[212:213], v7 offset:16384
  buffer_load_dwordx4 v12, s[8:11], s69 offen offset:3072 sc1 lds
  v_mfma_f32_16x16x32_bf16 v[60:63], v[152:155], v[116:119], v[60:63]
  ds_read_b128 v[104:107], v1 offset:35840
  v_mfma_f32_16x16x32_bf16 v[60:63], v[140:143], v[120:123], v[60:63]
  s_waitcnt lgkmcnt(3)
  ds_read_b64_tr_b16 v[214:215], v7 offset:18432
  v_mfma_f32_16x16x32_bf16 v[28:31], v[160:163], v[76:79], v[28:31]
  ds_read_b64_tr_b16 v[216:217], v8 offset:16384
  s_add_u32 m0, s70, 114688
  s_add_u32 s69, s59, 98304
  v_mfma_f32_16x16x32_bf16 v[28:31], v[172:175], v[80:83], v[28:31]
  ds_read_b128 v[108:111], v1 offset:43008
  buffer_load_dwordx4 v12, s[8:11], s69 offen offset:0 sc1 lds
  v_mfma_f32_16x16x32_bf16 v[32:35], v[172:175], v[88:91], v[32:35]
  ds_read_b64_tr_b16 v[218:219], v8 offset:18432
  v_mfma_f32_16x16x32_bf16 v[32:35], v[160:163], v[84:87], v[32:35]
  ds_read_b64_tr_b16 v[224:225], v7 offset:20480
  v_mfma_f32_16x16x32_bf16 v[40:43], v[164:167], v[84:87], v[40:43]
  ds_read_b128 v[112:115], v1 offset:44032
  v_mfma_f32_16x16x32_bf16 v[40:43], v[176:179], v[88:91], v[40:43]
  ds_read_b64_tr_b16 v[226:227], v7 offset:22528
  buffer_load_dwordx4 v12, s[8:11], s69 offen offset:1024 sc1 lds
  v_mfma_f32_16x16x32_bf16 v[36:39], v[176:179], v[80:83], v[36:39]
  ds_read_b128 v[116:119], v13 offset:26624
  v_mfma_f32_16x16x32_bf16 v[36:39], v[164:167], v[76:79], v[36:39]
  ds_read_b64_tr_b16 v[228:229], v8 offset:20480
  v_mfma_f32_16x16x32_bf16 v[44:47], v[168:171], v[76:79], v[44:47]
  ds_read_b64_tr_b16 v[230:231], v8 offset:22528
  v_mfma_f32_16x16x32_bf16 v[44:47], v[180:183], v[80:83], v[44:47]
  ds_read_b128 v[120:123], v13 offset:27648
  buffer_load_dwordx4 v12, s[8:11], s69 offen offset:2048 sc1 lds
  v_mfma_f32_16x16x32_bf16 v[48:51], v[180:183], v[88:91], v[48:51]
  ds_read_b64_tr_b16 v[236:237], v7 offset:24576
  v_mfma_f32_16x16x32_bf16 v[48:51], v[168:171], v[84:87], v[48:51]
  ds_read_b64_tr_b16 v[238:239], v7 offset:26624
  v_mfma_f32_16x16x32_bf16 v[68:71], v[168:171], v[92:95], v[68:71]
  ds_read_b128 v[76:79], v1 offset:36864
  v_mfma_f32_16x16x32_bf16 v[68:71], v[180:183], v[96:99], v[68:71]
  ds_read_b64_tr_b16 v[240:241], v8 offset:24576
  buffer_load_dwordx4 v12, s[8:11], s69 offen offset:3072 sc1 lds
  v_mfma_f32_16x16x32_bf16 v[60:63], v[176:179], v[96:99], v[60:63]
  ds_read_b128 v[80:83], v1 offset:37888
  v_mfma_f32_16x16x32_bf16 v[60:63], v[164:167], v[92:95], v[60:63]
  s_waitcnt lgkmcnt(5)
  ds_read_b64_tr_b16 v[242:243], v8 offset:26624
  v_mfma_f32_16x16x32_bf16 v[28:31], v[184:187], v[100:103], v[28:31]
  ds_read_b64_tr_b16 v[248:249], v7 offset:28672
  s_add_u32 m0, s70, 0
  s_add_u32 s69, s60, 98304
  v_mfma_f32_16x16x32_bf16 v[28:31], v[196:199], v[104:107], v[28:31]
  ds_read_b128 v[88:91], v1 offset:45056
  buffer_load_dwordx4 v12, s[8:11], s69 offen offset:0 sc1 lds
  v_mfma_f32_16x16x32_bf16 v[32:35], v[196:199], v[112:115], v[32:35]
  ds_read_b64_tr_b16 v[250:251], v7 offset:30720
  v_mfma_f32_16x16x32_bf16 v[32:35], v[184:187], v[108:111], v[32:35]
  ds_read_b64_tr_b16 v[252:253], v8 offset:28672
  v_mfma_f32_16x16x32_bf16 v[40:43], v[188:191], v[108:111], v[40:43]
  ds_read_b128 v[84:87], v1 offset:46080
  v_mfma_f32_16x16x32_bf16 v[40:43], v[200:203], v[112:115], v[40:43]
  ds_read_b64_tr_b16 v[254:255], v8 offset:30720
  buffer_load_dwordx4 v12, s[8:11], s69 offen offset:1024 sc1 lds
  v_mfma_f32_16x16x32_bf16 v[36:39], v[200:203], v[104:107], v[36:39]
  ds_read_b128 v[96:99], v13 offset:28672
  v_mfma_f32_16x16x32_bf16 v[36:39], v[188:191], v[100:103], v[36:39]
  v_mfma_f32_16x16x32_bf16 v[44:47], v[192:195], v[100:103], v[44:47]
  v_mfma_f32_16x16x32_bf16 v[44:47], v[204:207], v[104:107], v[44:47]
  ds_read_b128 v[92:95], v13 offset:29696
  v_mfma_f32_16x16x32_bf16 v[48:51], v[204:207], v[112:115], v[48:51]
  buffer_load_dwordx4 v12, s[8:11], s69 offen offset:2048 sc1 lds
  v_mfma_f32_16x16x32_bf16 v[48:51], v[192:195], v[108:111], v[48:51]
  v_mfma_f32_16x16x32_bf16 v[68:71], v[192:195], v[116:119], v[68:71]
  ds_read_b128 v[100:103], v1 offset:38912
  v_mfma_f32_16x16x32_bf16 v[68:71], v[204:207], v[120:123], v[68:71]
  buffer_load_dwordx4 v12, s[8:11], s69 offen offset:3072 sc1 lds
  v_mfma_f32_16x16x32_bf16 v[60:63], v[200:203], v[120:123], v[60:63]
  ds_read_b128 v[104:107], v1 offset:39936
  s_mov_b32 s30, 7340032
  v_mfma_f32_16x16x32_bf16 v[60:63], v[188:191], v[116:119], v[60:63]
  s_waitcnt lgkmcnt(2)
  s_mov_b32 s31, 131072
  s_mov_b32 s34, 7340032
  v_mfma_f32_16x16x32_bf16 v[28:31], v[208:211], v[76:79], v[28:31]
  s_add_u32 m0, s45, 16384
  s_mov_b32 s68, 0
  v_mfma_f32_16x16x32_bf16 v[28:31], v[220:223], v[80:83], v[28:31]
  ds_read_b128 v[112:115], v1 offset:47104
  s_mov_b32 s35, 131072
  v_mfma_f32_16x16x32_bf16 v[32:35], v[220:223], v[84:87], v[32:35]
  buffer_load_dwordx4 v11, s[20:23], s68 offen nt lds
  s_mov_b32 s38, 7340032
  s_mov_b32 s39, 131072
  v_mfma_f32_16x16x32_bf16 v[32:35], v[208:211], v[88:91], v[32:35]
  s_add_u32 m0, s45, 20480
  s_add_u32 s68, s68, 393216
  s_mov_b32 s42, 4194304
  v_mfma_f32_16x16x32_bf16 v[40:43], v[212:215], v[88:91], v[40:43]
  ds_read_b128 v[108:111], v1 offset:48128
  s_mov_b32 s43, 131072
  v_mfma_f32_16x16x32_bf16 v[40:43], v[224:227], v[84:87], v[40:43]
  buffer_load_dwordx4 v11, s[20:23], s68 offen nt lds
  v_add_u32 v9, s78, v1
  v_and_b32 v4, 0xffffbfff, v4
  v_mfma_f32_16x16x32_bf16 v[36:39], v[224:227], v[80:83], v[36:39]
  ds_read_b128 v[120:123], v13 offset:30720
  v_and_b32 v5, 0xffffbfff, v5
  v_mfma_f32_16x16x32_bf16 v[36:39], v[212:215], v[76:79], v[36:39]
  v_and_b32 v7, 0xffffbfff, v7
  v_and_b32 v8, 0xffffbfff, v8
  v_mfma_f32_16x16x32_bf16 v[44:47], v[216:219], v[76:79], v[44:47]
  s_add_u32 m0, s45, 24576
  s_add_u32 s68, s68, 393216
  s_lshl_b32 s52, s44, 13
  v_mfma_f32_16x16x32_bf16 v[44:47], v[228:231], v[80:83], v[44:47]
  ds_read_b128 v[116:119], v13 offset:31744
  s_and_b32 s52, s52, 8192
  v_mfma_f32_16x16x32_bf16 v[48:51], v[228:231], v[84:87], v[48:51]
  buffer_load_dwordx4 v11, s[20:23], s68 offen nt lds
  v_add_u32 v22, s52, v1
  v_add_u32 v23, s52, v2
  v_mfma_f32_16x16x32_bf16 v[48:51], v[216:219], v[88:91], v[48:51]
  s_waitcnt vmcnt(11) lgkmcnt(8)
  s_barrier
  v_mfma_f32_16x16x32_bf16 v[68:71], v[216:219], v[96:99], v[68:71]
  ds_read_b128 v[76:79], v1 offset:49152
  s_add_u32 m0, s45, 28672
  s_add_u32 s68, s68, 393216
  v_mfma_f32_16x16x32_bf16 v[68:71], v[228:231], v[92:95], v[68:71]
  buffer_load_dwordx4 v11, s[20:23], s68 offen nt lds
  v_and_b32 v14, 15, v0
  v_lshlrev_b32 v14, 7, v14
  v_mfma_f32_16x16x32_bf16 v[60:63], v[224:227], v[92:95], v[60:63]
  v_mfma_f32_16x16x32_bf16 v[60:63], v[212:215], v[96:99], v[60:63]
  s_waitcnt lgkmcnt(1)
  ds_read_b128 v[80:83], v1 offset:50176
  v_mfma_f32_16x16x32_bf16 v[28:31], v[232:235], v[100:103], v[28:31]
  v_mfma_f32_16x16x32_bf16 v[28:31], v[244:247], v[104:107], v[28:31]
  v_mfma_f32_16x16x32_bf16 v[32:35], v[244:247], v[108:111], v[32:35]
  ds_read_b128 v[84:87], v1 offset:57344
  v_mfma_f32_16x16x32_bf16 v[32:35], v[232:235], v[112:115], v[32:35]
  v_mfma_f32_16x16x32_bf16 v[40:43], v[236:239], v[112:115], v[40:43]
  v_mfma_f32_16x16x32_bf16 v[40:43], v[248:251], v[108:111], v[40:43]
HOP2:
  s_cbranch_execz HOP6
  ds_read_b128 v[88:91], v1 offset:58368
  v_mfma_f32_16x16x32_bf16 v[36:39], v[248:251], v[104:107], v[36:39]
  v_mfma_f32_16x16x32_bf16 v[36:39], v[236:239], v[100:103], v[36:39]
  v_mfma_f32_16x16x32_bf16 v[44:47], v[240:243], v[100:103], v[44:47]
  ds_read_b128 v[92:95], v1 offset:51200
  v_mfma_f32_16x16x32_bf16 v[44:47], v[252:255], v[104:107], v[44:47]
  v_mfma_f32_16x16x32_bf16 v[48:51], v[252:255], v[108:111], v[48:51]
  v_mfma_f32_16x16x32_bf16 v[48:51], v[240:243], v[112:115], v[48:51]
  ds_read_b128 v[96:99], v1 offset:52224
  v_mfma_f32_16x16x32_bf16 v[68:71], v[240:243], v[120:123], v[68:71]
  v_mfma_f32_16x16x32_bf16 v[68:71], v[252:255], v[116:119], v[68:71]
  v_mfma_f32_16x16x32_bf16 v[60:63], v[248:251], v[116:119], v[60:63]
  ds_read_b128 v[100:103], v1 offset:59392
  v_mfma_f32_16x16x32_bf16 v[60:63], v[236:239], v[120:123], v[60:63]
  s_waitcnt lgkmcnt(3)
  v_mfma_f32_16x16x32_bf16 v[52:55], a[0:3], v[76:79], 0
  v_mfma_f32_16x16x32_bf16 v[52:55], a[12:15], v[80:83], v[52:55]
  ds_read_b128 v[104:107], v1 offset:60416
  v_mfma_f32_16x16x32_bf16 v[56:59], a[12:15], v[88:91], 0
  s_nop 2
  v_cvt_pk_bf16_f32 v60, v60, v61
  v_cvt_pk_bf16_f32 v61, v62, v63
  v_cvt_pk_bf16_f32 v62, v68, v69
  v_cvt_pk_bf16_f32 v63, v70, v71
  ds_write_b128 v17, v[60:63] offset:1024
  v_mfma_f32_16x16x32_bf16 v[56:59], a[0:3], v[84:87], v[56:59]
  v_cvt_pk_bf16_f32 v28, v28, v29
  v_cvt_pk_bf16_f32 v29, v30, v31
  v_mfma_f32_16x16x32_bf16 v[64:67], a[4:7], v[84:87], 0
  ds_read_b128 v[108:111], v1 offset:53248
  v_mfma_f32_16x16x32_bf16 v[64:67], a[16:19], v[88:91], v[64:67]
  ds_write_b64 v18, v[28:29] offset:6144
  v_mfma_f32_16x16x32_bf16 v[60:63], a[16:19], v[80:83], 0
  v_cvt_pk_bf16_f32 v36, v36, v37
  v_cvt_pk_bf16_f32 v37, v38, v39
  v_mfma_f32_16x16x32_bf16 v[60:63], a[4:7], v[76:79], v[60:63]
  ds_read_b128 v[112:115], v1 offset:54272
  v_cvt_pk_bf16_f32 v38, v44, v45
  v_mfma_f32_16x16x32_bf16 v[68:71], a[8:11], v[76:79], 0
  v_cvt_pk_bf16_f32 v39, v46, v47
  v_mfma_f32_16x16x32_bf16 v[68:71], a[20:23], v[80:83], v[68:71]
  ds_write_b128 v17, v[36:39] offset:7168
  v_mfma_f32_16x16x32_bf16 v[72:75], a[20:23], v[88:91], 0
  ds_read_b128 v[76:79], v1 offset:61440
  v_cvt_pk_bf16_f32 v32, v32, v33
  v_mfma_f32_16x16x32_bf16 v[72:75], a[8:11], v[84:87], v[72:75]
  s_waitcnt lgkmcnt(6)
  v_cvt_pk_bf16_f32 v33, v34, v35
  v_mfma_f32_16x16x32_bf16 v[52:55], a[24:27], v[92:95], v[52:55]
  s_add_u32 m0, s70, 65536
  s_add_u32 s69, s61, 98304
  v_mfma_f32_16x16x32_bf16 v[52:55], a[36:39], v[96:99], v[52:55]
  ds_read_b128 v[80:83], v1 offset:62464
  v_mfma_f32_16x16x32_bf16 v[56:59], a[36:39], v[104:107], v[56:59]
  buffer_load_dwordx4 v12, s[8:11], s69 offen offset:0 sc1 lds
  ds_write_b64 v18, v[32:33] offset:12288
  v_mfma_f32_16x16x32_bf16 v[56:59], a[24:27], v[100:103], v[56:59]
  v_cvt_pk_bf16_f32 v40, v40, v41
  v_cvt_pk_bf16_f32 v41, v42, v43
  v_mfma_f32_16x16x32_bf16 v[64:67], a[28:31], v[100:103], v[64:67]
  ds_read_b128 v[88:91], v1 offset:55296
  v_cvt_pk_bf16_f32 v42, v48, v49
  v_mfma_f32_16x16x32_bf16 v[64:67], a[40:43], v[104:107], v[64:67]
  v_cvt_pk_bf16_f32 v43, v50, v51
  v_mfma_f32_16x16x32_bf16 v[60:63], a[40:43], v[96:99], v[60:63]
  buffer_load_dwordx4 v12, s[8:11], s69 offen offset:1024 sc1 lds
  ds_write_b128 v17, v[40:43] offset:13312
  v_mfma_f32_16x16x32_bf16 v[60:63], a[28:31], v[92:95], v[60:63]
  ds_read_b128 v[84:87], v1 offset:56320
  v_mfma_f32_16x16x32_bf16 v[68:71], a[32:35], v[92:95], v[68:71]
  s_bitcmp1_b32 s44, 0
  s_mov_b32 s52, 6144
  s_cselect_b32 s52, 12288, s52
  s_mov_b32 s53, 0
  s_cselect_b32 s53, 6144, s53
  v_mfma_f32_16x16x32_bf16 v[68:71], a[44:47], v[96:99], v[68:71]
  v_add_u32 v116, s52, v19
  v_add_u32 v117, s53, v19
  v_mfma_f32_16x16x32_bf16 v[72:75], a[44:47], v[104:107], v[72:75]
  ds_read_b128 v[92:95], v1 offset:63488
  v_add_u32 v118, s52, v20
  v_mfma_f32_16x16x32_bf16 v[72:75], a[32:35], v[100:103], v[72:75]
  s_waitcnt lgkmcnt(5)
  buffer_load_dwordx4 v12, s[8:11], s69 offen offset:2048 sc1 lds
  v_add_u32 v119, s53, v20
  v_mfma_f32_16x16x32_bf16 v[52:55], a[48:51], v[108:111], v[52:55]
  s_waitcnt vmcnt(11) lgkmcnt(2)
  s_barrier
  v_mfma_f32_16x16x32_bf16 v[52:55], a[60:63], v[112:115], v[52:55]
  ds_read_b128 v[96:99], v1 offset:64512
  ds_write_b16 v21, v16
  v_mfma_f32_16x16x32_bf16 v[56:59], a[60:63], v[80:83], v[56:59]
  ds_read_b128 v[28:31], v116
  v_mfma_f32_16x16x32_bf16 v[56:59], a[48:51], v[76:79], v[56:59]
  ds_read_b128 v[32:35], v117 offset:1024
  v_mfma_f32_16x16x32_bf16 v[64:67], a[52:55], v[76:79], v[64:67]
  ds_read_b128 v[104:107], v2 offset:49152
  v_mfma_f32_16x16x32_bf16 v[64:67], a[64:67], v[80:83], v[64:67]
  buffer_load_dwordx4 v12, s[8:11], s69 offen offset:3072 sc1 lds
  ds_read_b128 v[36:39], v116 offset:1024
  v_mfma_f32_16x16x32_bf16 v[60:63], a[64:67], v[112:115], v[60:63]
  ds_read_b64_tr_b16 v[40:41], v119 offset:2048
  v_mfma_f32_16x16x32_bf16 v[60:63], a[52:55], v[108:111], v[60:63]
  ds_read_b128 v[100:103], v2 offset:50176
  v_mfma_f32_16x16x32_bf16 v[68:71], a[56:59], v[108:111], v[68:71]
  s_add_u32 m0, s70, 98304
  s_add_u32 s69, s58, 163840
  v_mfma_f32_16x16x32_bf16 v[68:71], a[68:71], v[112:115], v[68:71]
  buffer_load_dwordx4 v12, s[8:11], s69 offen offset:0 sc1 lds
  ds_read_b64_tr_b16 v[42:43], v118 offset:2048
  v_mfma_f32_16x16x32_bf16 v[72:75], a[68:71], v[80:83], v[72:75]
  ds_read_b128 v[108:111], v2 offset:57344
  v_mfma_f32_16x16x32_bf16 v[72:75], a[56:59], v[76:79], v[72:75]
  s_waitcnt lgkmcnt(9)
  ds_read_b64_tr_b16 v[44:45], v119 offset:2056
  v_mfma_f32_16x16x32_bf16 v[52:55], a[72:75], v[88:91], v[52:55]
  ds_read_b64_tr_b16 v[46:47], v118 offset:2056
  v_mfma_f32_16x16x32_bf16 v[52:55], a[84:87], v[84:87], v[52:55]
  ds_read_b128 v[112:115], v2 offset:58368
  v_mfma_f32_16x16x32_bf16 v[56:59], a[84:87], v[96:99], v[56:59]
  buffer_load_dwordx4 v12, s[8:11], s69 offen offset:1024 sc1 lds
  v_mfma_f32_16x16x32_bf16 v[56:59], a[72:75], v[92:95], v[56:59]
  v_mfma_f32_16x16x32_bf16 v[64:67], a[76:79], v[92:95], v[64:67]
  ds_read_b128 v[80:83], v2 offset:51200
  v_mfma_f32_16x16x32_bf16 v[64:67], a[88:91], v[96:99], v[64:67]
  s_waitcnt lgkmcnt(2)
  v_mfma_f32_16x16x32_bf16 v[116:119], v[32:35], v[28:31], 0
  v_mfma_f32_16x16x32_bf16 v[120:123], v[36:39], v[28:31], 0
  v_mfma_f32_16x16x32_bf16 v[60:63], a[88:91], v[84:87], v[60:63]
  v_mfma_f32_16x16x32_bf16 v[60:63], a[76:79], v[88:91], v[60:63]
  ds_read_b128 v[76:79], v2 offset:52224
  v_mfma_f32_16x16x32_bf16 v[68:71], a[80:83], v[88:91], v[68:71]
  buffer_load_dwordx4 v12, s[8:11], s69 offen offset:2048 sc1 lds
  v_mfma_f32_16x16x32_bf16 v[68:71], a[92:95], v[84:87], v[68:71]
  s_nop 1
  v_cndmask_b32 v48, v116, v120, s[80:81]
  v_cndmask_b32 v49, v117, v121, s[82:83]
  v_mfma_f32_16x16x32_bf16 v[72:75], a[92:95], v[96:99], v[72:75]
  ds_read_b128 v[88:91], v2 offset:59392
  v_cndmask_b32 v50, v118, v122, s[84:85]
  v_mfma_f32_16x16x32_bf16 v[72:75], a[80:83], v[92:95], v[72:75]
  s_waitcnt lgkmcnt(3)
  v_cndmask_b32 v51, v119, v123, s[86:87]
  v_cndmask_b32 v48, v48, v49, s[88:89]
  v_mfma_f32_16x16x32_bf16 v[52:55], a[96:99], v[104:107], v[52:55]
  buffer_load_dwordx4 v12, s[8:11], s69 offen offset:3072 sc1 lds
  v_cndmask_b32 v49, v50, v51, s[88:89]
  v_mul_f32 v48, 0x3e8293ee, v48
  v_mfma_f32_16x16x32_bf16 v[52:55], a[108:111], v[100:103], v[52:55]
  ds_read_b128 v[84:87], v2 offset:60416
  v_mul_f32 v49, 0x3e8293ee, v49
  v_mfma_f32_16x16x32_bf16 v[56:59], a[108:111], v[112:115], v[56:59]
  v_mov_b32 v50, 0xce6e6b28
  v_cndmask_b32 v48, v48, v50, s[90:91]
  v_mfma_f32_16x16x32_bf16 v[56:59], a[96:99], v[108:111], v[56:59]
  s_add_u32 m0, s45, 81920
  s_mov_b32 s68, 1572864
  v_mfma_f32_16x16x32_bf16 v[64:67], a[100:103], v[108:111], v[64:67]
  ds_read_b128 v[96:99], v2 offset:53248
  v_cndmask_b32 v49, v49, v50, s[92:93]
  v_mfma_f32_16x16x32_bf16 v[64:67], a[112:115], v[112:115], v[64:67]
  buffer_load_dwordx4 v11, s[20:23], s68 offen nt lds
  v_max_f32 v50, v48, v49
  v_mov_b32 v51, v50
  v_mfma_f32_16x16x32_bf16 v[60:63], a[112:115], v[100:103], v[60:63]
  s_nop 0
  v_permlane16_swap_b32 v50, v51
  v_mfma_f32_16x16x32_bf16 v[60:63], a[100:103], v[104:107], v[60:63]
  ds_read_b128 v[92:95], v2 offset:54272
  v_max_f32 v50, v50, v51
  v_mfma_f32_16x16x32_bf16 v[68:71], a[104:107], v[104:107], v[68:71]
  v_mov_b32 v51, v50
  v_mfma_f32_16x16x32_bf16 v[68:71], a[116:119], v[100:103], v[68:71]
  s_add_u32 m0, s45, 86016
  s_add_u32 s68, s68, 393216
  v_mfma_f32_16x16x32_bf16 v[72:75], a[116:119], v[112:115], v[72:75]
  ds_read_b128 v[104:107], v2 offset:61440
  v_mfma_f32_16x16x32_bf16 v[72:75], a[104:107], v[108:111], v[72:75]
  s_waitcnt lgkmcnt(3)
  buffer_load_dwordx4 v11, s[20:23], s68 offen nt lds
  v_mfma_f32_16x16x32_bf16 v[52:55], a[120:123], v[80:83], v[52:55]
  v_permlane32_swap_b32 v50, v51
  v_mfma_f32_16x16x32_bf16 v[52:55], a[132:135], v[76:79], v[52:55]
  ds_read_b128 v[100:103], v2 offset:62464
  v_max_f32 v50, v50, v51
  v_mfma_f32_16x16x32_bf16 v[56:59], a[132:135], v[84:87], v[56:59]
  s_add_u32 m0, s45, 90112
  s_add_u32 s68, s68, 393216
  v_sub_f32 v48, v48, v50
  v_mfma_f32_16x16x32_bf16 v[56:59], a[120:123], v[88:91], v[56:59]
  buffer_load_dwordx4 v11, s[20:23], s68 offen nt lds
  v_sub_f32 v49, v49, v50
  v_mfma_f32_16x16x32_bf16 v[64:67], a[124:127], v[88:91], v[64:67]
  ds_read_b128 v[112:115], v2 offset:55296
  v_mfma_f32_16x16x32_bf16 v[64:67], a[136:139], v[84:87], v[64:67]
  v_exp_f32 v48, v48
  v_mfma_f32_16x16x32_bf16 v[60:63], a[136:139], v[76:79], v[60:63]
  s_add_u32 m0, s45, 94208
  s_add_u32 s68, s68, 393216
  v_mfma_f32_16x16x32_bf16 v[60:63], a[124:127], v[80:83], v[60:63]
  ds_read_b128 v[108:111], v2 offset:56320
  v_mfma_f32_16x16x32_bf16 v[68:71], a[128:131], v[80:83], v[68:71]
  buffer_load_dwordx4 v11, s[20:23], s68 offen nt lds
  v_exp_f32 v49, v49
  v_mfma_f32_16x16x32_bf16 v[68:71], a[140:143], v[76:79], v[68:71]
  v_add_f32 v50, v48, v49
  v_mov_b32 v51, v50
  v_mfma_f32_16x16x32_bf16 v[72:75], a[140:143], v[84:87], v[72:75]
  ds_read_b128 v[80:83], v2 offset:63488
  v_mfma_f32_16x16x32_bf16 v[72:75], a[128:131], v[88:91], v[72:75]
  s_waitcnt lgkmcnt(3)
  v_permlane16_swap_b32 v50, v51
  v_mfma_f32_16x16x32_bf16 v[52:55], a[144:147], v[96:99], v[52:55]
  v_add_f32 v50, v50, v51
  v_mov_b32 v51, v50
  v_mfma_f32_16x16x32_bf16 v[52:55], a[156:159], v[92:95], v[52:55]
  ds_read_b128 v[76:79], v2 offset:64512
  v_mfma_f32_16x16x32_bf16 v[56:59], a[156:159], v[100:103], v[56:59]
  v_permlane32_swap_b32 v50, v51
  v_mfma_f32_16x16x32_bf16 v[56:59], a[144:147], v[104:107], v[56:59]
  s_waitcnt vmcnt(8) lgkmcnt(15)
  s_barrier
  v_mfma_f32_16x16x32_bf16 v[64:67], a[148:151], v[104:107], v[64:67]
  ds_read_b128 v[84:87], v1 offset:0
  v_add_f32 v50, v50, v51
  v_mfma_f32_16x16x32_bf16 v[64:67], a[160:163], v[100:103], v[64:67]
  v_rcp_f32 v50, v50
  v_mfma_f32_16x16x32_bf16 v[60:63], a[160:163], v[92:95], v[60:63]
  v_mul_f32 v48, v48, v50
  v_mul_f32 v49, v49, v50
  v_mfma_f32_16x16x32_bf16 v[60:63], a[148:151], v[96:99], v[60:63]
  ds_read_b128 v[88:91], v1 offset:1024
  v_cvt_pk_bf16_f32 v48, v48, v48
  v_mfma_f32_16x16x32_bf16 v[68:71], a[152:155], v[96:99], v[68:71]
  v_cvt_pk_bf16_f32 v49, v49, v49
  v_and_b32 v28, v24, v48
  v_mfma_f32_16x16x32_bf16 v[68:71], a[164:167], v[92:95], v[68:71]
  v_and_b32 v29, v25, v49
  v_and_b32 v30, v26, v48
  v_mfma_f32_16x16x32_bf16 v[72:75], a[164:167], v[100:103], v[72:75]
  ds_read_b128 v[96:99], v1 offset:8192
  v_and_b32 v31, v27, v49
  v_mfma_f32_16x16x32_bf16 v[72:75], a[152:155], v[104:107], v[72:75]
  s_waitcnt lgkmcnt(3)
  v_mfma_f32_16x16x32_bf16 v[32:35], v[40:43], v[28:31], 0
  v_mfma_f32_16x16x32_bf16 v[36:39], v[44:47], v[28:31], 0
  v_mfma_f32_16x16x32_bf16 v[52:55], a[168:171], v[112:115], v[52:55]
  v_mfma_f32_16x16x32_bf16 v[52:55], a[180:183], v[108:111], v[52:55]
  ds_read_b128 v[92:95], v1 offset:9216
  v_mfma_f32_16x16x32_bf16 v[56:59], a[180:183], v[76:79], v[56:59]
  v_mfma_f32_16x16x32_bf16 v[56:59], a[168:171], v[80:83], v[56:59]
  s_nop 1
  v_cvt_pk_bf16_f32 v116, v32, v33
  v_cvt_pk_bf16_f32 v117, v34, v35
  v_mfma_f32_16x16x32_bf16 v[64:67], a[172:175], v[80:83], v[64:67]
  ds_read_b128 v[100:103], v1 offset:2048
  v_cvt_pk_bf16_f32 v118, v36, v37
  v_mfma_f32_16x16x32_bf16 v[64:67], a[184:187], v[76:79], v[64:67]
  v_cvt_pk_bf16_f32 v119, v38, v39
  v_mfma_f32_16x16x32_bf16 v[60:63], a[184:187], v[108:111], v[60:63]
  buffer_store_dwordx4 v[116:119], v1, s[8:11], s73 offen sc1
  v_mfma_f32_16x16x32_bf16 v[60:63], a[172:175], v[112:115], v[60:63]
  ds_read_b128 v[104:107], v1 offset:3072
  s_add_u32 s73, s73, 65536
  v_mfma_f32_16x16x32_bf16 v[68:71], a[176:179], v[112:115], v[68:71]
  v_mfma_f32_16x16x32_bf16 v[68:71], a[188:191], v[108:111], v[68:71]
  v_mfma_f32_16x16x32_bf16 v[72:75], a[188:191], v[76:79], v[72:75]
  ds_read_b128 v[112:115], v1 offset:10240
  v_mfma_f32_16x16x32_bf16 v[72:75], a[176:179], v[80:83], v[72:75]
  s_waitcnt lgkmcnt(3)
  v_mfma_f32_16x16x32_bf16 v[52:55], a[192:195], v[84:87], v[52:55]
  v_mfma_f32_16x16x32_bf16 v[52:55], a[204:207], v[88:91], v[52:55]
  ds_read_b128 v[108:111], v1 offset:11264
  v_mfma_f32_16x16x32_bf16 v[56:59], a[204:207], v[92:95], v[56:59]
  v_mfma_f32_16x16x32_bf16 v[56:59], a[192:195], v[96:99], v[56:59]
  v_mfma_f32_16x16x32_bf16 v[64:67], a[196:199], v[96:99], v[64:67]
  ds_read_b128 v[76:79], v1 offset:4096
  v_lshrrev_b32 v40, 4, v0
  v_lshlrev_b32 v40, 4, v40
  v_mfma_f32_16x16x32_bf16 v[64:67], a[208:211], v[92:95], v[64:67]
  v_add_u32 v41, 160768, v40
  v_mfma_f32_16x16x32_bf16 v[60:63], a[208:211], v[88:91], v[60:63]
  ds_read_b64_tr_b16 v[116:117], v3 offset:16384
  v_mfma_f32_16x16x32_bf16 v[60:63], a[196:199], v[84:87], v[60:63]
  ds_read_b128 v[80:83], v1 offset:5120
  ds_read_b64_tr_b16 v[118:119], v3 offset:18432
  v_mfma_f32_16x16x32_bf16 v[68:71], a[200:203], v[84:87], v[68:71]
  ds_read_b128 v[28:31], v41 offset:0
  v_mfma_f32_16x16x32_bf16 v[68:71], a[212:215], v[88:91], v[68:71]
  v_mfma_f32_16x16x32_bf16 v[72:75], a[212:215], v[92:95], v[72:75]
  ds_read_b128 v[84:87], v1 offset:12288
  v_mfma_f32_16x16x32_bf16 v[72:75], a[200:203], v[96:99], v[72:75]
  s_waitcnt lgkmcnt(6)
  s_add_u32 m0, s70, 32768
  s_add_u32 s69, s59, 163840
  v_mfma_f32_16x16x32_bf16 v[52:55], a[216:219], v[100:103], v[52:55]
  buffer_load_dwordx4 v12, s[8:11], s69 offen offset:0 sc1 lds
  v_mfma_f32_16x16x32_bf16 v[52:55], a[228:231], v[104:107], v[52:55]
  ds_read_b128 v[88:91], v1 offset:13312
  v_mfma_f32_16x16x32_bf16 v[56:59], a[228:231], v[108:111], v[56:59]
  v_mfma_f32_16x16x32_bf16 v[56:59], a[216:219], v[112:115], v[56:59]
  v_mfma_f32_16x16x32_bf16 v[64:67], a[220:223], v[112:115], v[64:67]
  ds_read_b128 v[92:95], v1 offset:6144
  ds_read_b64_tr_b16 v[120:121], v3 offset:20480
  v_mfma_f32_16x16x32_bf16 v[64:67], a[232:235], v[108:111], v[64:67]
  ds_read_b64_tr_b16 v[122:123], v3 offset:22528
  s_waitcnt lgkmcnt(5)
  v_mfma_f32_16x16x32_bf16 v[36:39], v[116:119], v[28:31], 0
  v_mfma_f32_16x16x32_bf16 v[60:63], a[232:235], v[104:107], v[60:63]
  buffer_load_dwordx4 v12, s[8:11], s69 offen offset:1024 sc1 lds
  ds_read_b128 v[32:35], v41 offset:64
  v_mfma_f32_16x16x32_bf16 v[60:63], a[220:223], v[100:103], v[60:63]
  ds_read_b128 v[96:99], v1 offset:7168
  v_mfma_f32_16x16x32_bf16 v[68:71], a[224:227], v[100:103], v[68:71]
  v_mfma_f32_16x16x32_bf16 v[68:71], a[236:239], v[104:107], v[68:71]
  v_mfma_f32_16x16x32_bf16 v[72:75], a[236:239], v[108:111], v[72:75]
  ds_read_b128 v[100:103], v1 offset:14336
  v_mfma_f32_16x16x32_bf16 v[72:75], a[224:227], v[112:115], v[72:75]
  s_waitcnt lgkmcnt(6)
  buffer_load_dwordx4 v12, s[8:11], s69 offen offset:2048 sc1 lds
  v_mfma_f32_16x16x32_bf16 v[52:55], a[240:243], v[76:79], v[52:55]
  v_mfma_f32_16x16x32_bf16 v[52:55], v[124:127], v[80:83], v[52:55]
  ds_read_b128 v[104:107], v1 offset:15360
  v_mfma_f32_16x16x32_bf16 v[56:59], v[124:127], v[88:91], v[56:59]
  ds_read_b64_tr_b16 v[116:117], v3 offset:24576
  v_and_b32 v42, 15, v0
  v_mfma_f32_16x16x32_bf16 v[56:59], a[240:243], v[84:87], v[56:59]
  ds_read_b64_tr_b16 v[118:119], v3 offset:26624
  buffer_load_dwordx4 v12, s[8:11], s69 offen offset:3072 sc1 lds
  s_waitcnt lgkmcnt(5)
  v_mfma_f32_16x16x32_bf16 v[36:39], v[120:123], v[32:35], v[36:39]
  v_lshl_add_u32 v40, v42, 27, v40
  s_lshr_b32 s52, s2, 2
  v_mfma_f32_16x16x32_bf16 v[64:67], a[244:247], v[84:87], v[64:67]
  ds_read_b128 v[108:111], v2 offset:0
  ds_read_b128 v[28:31], v41 offset:128
  v_mfma_f32_16x16x32_bf16 v[64:67], v[128:131], v[88:91], v[64:67]
  s_lshl_b32 s54, s52, 7
  s_lshl_b32 s52, s52, 8
  s_and_b32 s53, s2, 3
  v_mfma_f32_16x16x32_bf16 v[60:63], v[128:131], v[80:83], v[60:63]
  s_add_u32 m0, s70, 49152
  s_add_u32 s69, s60, 163840
  s_mul_i32 s79, s53, 24576
  v_mfma_f32_16x16x32_bf16 v[60:63], a[244:247], v[76:79], v[60:63]
  ds_read_b128 v[112:115], v2 offset:1024
  s_add_u32 s52, s52, s79
  v_mfma_f32_16x16x32_bf16 v[68:71], a[248:251], v[76:79], v[68:71]
  buffer_load_dwordx4 v12, s[8:11], s69 offen offset:0 sc1 lds
  s_lshl_b32 s79, s44, 6
  s_add_u32 s52, s52, s79
  v_mfma_f32_16x16x32_bf16 v[68:71], v[132:135], v[80:83], v[68:71]
  s_add_u32 s52, s52, 8192
  s_lshl_b32 s53, s53, 2
  s_add_u32 s54, s54, s53
  v_mfma_f32_16x16x32_bf16 v[72:75], v[132:135], v[88:91], v[72:75]
  ds_read_b128 v[76:79], v2 offset:8192
  s_add_u32 s54, s54, 720896
  v_mfma_f32_16x16x32_bf16 v[72:75], a[248:251], v[84:87], v[72:75]
  s_waitcnt lgkmcnt(6)
  s_cmp_eq_u32 s44, 0
  s_cselect_b32 s79, s54, 1073741824
  v_mfma_f32_16x16x32_bf16 v[52:55], v[136:139], v[92:95], v[52:55]
  ds_read_b64_tr_b16 v[120:121], v3 offset:28672
  v_mfma_f32_16x16x32_bf16 v[52:55], v[148:151], v[96:99], v[52:55]
  ds_read_b128 v[80:83], v2 offset:9216
  ds_read_b64_tr_b16 v[122:123], v3 offset:30720
  s_waitcnt lgkmcnt(5)
  v_mfma_f32_16x16x32_bf16 v[36:39], v[116:119], v[28:31], v[36:39]
  v_mfma_f32_16x16x32_bf16 v[56:59], v[148:151], v[104:107], v[56:59]
  buffer_load_dwordx4 v12, s[8:11], s69 offen offset:1024 sc1 lds
  ds_read_b128 v[32:35], v41 offset:192
  v_mfma_f32_16x16x32_bf16 v[56:59], v[136:139], v[100:103], v[56:59]
  v_mfma_f32_16x16x32_bf16 v[64:67], v[140:143], v[100:103], v[64:67]
  ds_read_b128 v[88:91], v2 offset:2048
  v_mfma_f32_16x16x32_bf16 v[64:67], v[152:155], v[104:107], v[64:67]
  v_mfma_f32_16x16x32_bf16 v[60:63], v[152:155], v[96:99], v[60:63]
  buffer_load_dwordx4 v12, s[8:11], s69 offen offset:2048 sc1 lds
  v_mfma_f32_16x16x32_bf16 v[60:63], v[140:143], v[92:95], v[60:63]
  ds_read_b128 v[84:87], v2 offset:3072
  v_mfma_f32_16x16x32_bf16 v[68:71], v[144:147], v[92:95], v[68:71]
  v_mfma_f32_16x16x32_bf16 v[68:71], v[156:159], v[96:99], v[68:71]
  s_waitcnt vmcnt(8)
  s_barrier
  v_mfma_f32_16x16x32_bf16 v[72:75], v[156:159], v[104:107], v[72:75]
  ds_read_b128 v[92:95], v2 offset:10240
  ds_read_b64_tr_b16 v[116:117], v6 offset:16384
  v_mfma_f32_16x16x32_bf16 v[72:75], v[144:147], v[100:103], v[72:75]
  s_waitcnt lgkmcnt(6)
  ds_read_b64_tr_b16 v[118:119], v6 offset:18432
  s_waitcnt lgkmcnt(5)
  v_mfma_f32_16x16x32_bf16 v[36:39], v[120:123], v[32:35], v[36:39]
  v_mfma_f32_16x16x32_bf16 v[52:55], v[160:163], v[108:111], v[52:55]
  buffer_load_dwordx4 v12, s[8:11], s69 offen offset:3072 sc1 lds
  ds_read_b128 v[28:31], v41 offset:256
  v_mfma_f32_16x16x32_bf16 v[52:55], v[172:175], v[112:115], v[52:55]
  ds_read_b128 v[96:99], v2 offset:11264
  v_mfma_f32_16x16x32_bf16 v[56:59], v[172:175], v[80:83], v[56:59]
  v_mfma_f32_16x16x32_bf16 v[56:59], v[160:163], v[76:79], v[56:59]
  s_add_u32 m0, s70, 114688
  s_add_u32 s69, s61, 163840
  v_mfma_f32_16x16x32_bf16 v[64:67], v[164:167], v[76:79], v[64:67]
  ds_read_b128 v[104:107], v2 offset:4096
  v_mfma_f32_16x16x32_bf16 v[64:67], v[176:179], v[80:83], v[64:67]
  buffer_load_dwordx4 v12, s[8:11], s69 offen offset:0 sc1 lds
  v_mfma_f32_16x16x32_bf16 v[60:63], v[176:179], v[112:115], v[60:63]
  v_mfma_f32_16x16x32_bf16 v[60:63], v[164:167], v[108:111], v[60:63]
  ds_read_b128 v[100:103], v2 offset:5120
  v_mfma_f32_16x16x32_bf16 v[68:71], v[168:171], v[108:111], v[68:71]
  ds_read_b64_tr_b16 v[120:121], v6 offset:20480
  v_mfma_f32_16x16x32_bf16 v[68:71], v[180:183], v[112:115], v[68:71]
  ds_read_b64_tr_b16 v[122:123], v6 offset:22528
  buffer_load_dwordx4 v12, s[8:11], s69 offen offset:1024 sc1 lds
  s_waitcnt lgkmcnt(5)
  v_mfma_f32_16x16x32_bf16 v[36:39], v[116:119], v[28:31], v[36:39]
  v_mfma_f32_16x16x32_bf16 v[72:75], v[180:183], v[80:83], v[72:75]
  ds_read_b128 v[108:111], v2 offset:12288
  ds_read_b128 v[32:35], v41 offset:320
  v_mfma_f32_16x16x32_bf16 v[72:75], v[168:171], v[76:79], v[72:75]
  s_waitcnt lgkmcnt(6)
  v_mfma_f32_16x16x32_bf16 v[52:55], v[184:187], v[88:91], v[52:55]
  v_mfma_f32_16x16x32_bf16 v[52:55], v[196:199], v[84:87], v[52:55]
  ds_read_b128 v[112:115], v2 offset:13312
  v_mfma_f32_16x16x32_bf16 v[56:59], v[196:199], v[96:99], v[56:59]
  buffer_load_dwordx4 v12, s[8:11], s69 offen offset:2048 sc1 lds
  v_mfma_f32_16x16x32_bf16 v[56:59], v[184:187], v[92:95], v[56:59]
  v_mfma_f32_16x16x32_bf16 v[64:67], v[188:191], v[92:95], v[64:67]
  ds_read_b128 v[80:83], v2 offset:6144
  v_mfma_f32_16x16x32_bf16 v[64:67], v[200:203], v[96:99], v[64:67]
  v_mfma_f32_16x16x32_bf16 v[60:63], v[200:203], v[84:87], v[60:63]
  ds_read_b64_tr_b16 v[116:117], v6 offset:24576
  v_mfma_f32_16x16x32_bf16 v[60:63], v[188:191], v[88:91], v[60:63]
  ds_read_b128 v[76:79], v2 offset:7168
  ds_read_b64_tr_b16 v[118:119], v6 offset:26624
  s_waitcnt lgkmcnt(5)
  v_mfma_f32_16x16x32_bf16 v[36:39], v[120:123], v[32:35], v[36:39]
  v_mfma_f32_16x16x32_bf16 v[68:71], v[192:195], v[88:91], v[68:71]
  buffer_load_dwordx4 v12, s[8:11], s69 offen offset:3072 sc1 lds
  ds_read_b128 v[28:31], v41 offset:384
  v_mfma_f32_16x16x32_bf16 v[68:71], v[204:207], v[84:87], v[68:71]
  v_mfma_f32_16x16x32_bf16 v[72:75], v[204:207], v[96:99], v[72:75]
  ds_read_b128 v[88:91], v2 offset:14336
  v_mfma_f32_16x16x32_bf16 v[72:75], v[192:195], v[92:95], v[72:75]
  s_waitcnt lgkmcnt(6)
  s_add_u32 m0, s70, 0
  s_add_u32 s69, s58, 229376
  v_mfma_f32_16x16x32_bf16 v[52:55], v[208:211], v[104:107], v[52:55]
  buffer_load_dwordx4 v12, s[8:11], s69 offen offset:0 sc1 lds
  v_mfma_f32_16x16x32_bf16 v[52:55], v[220:223], v[100:103], v[52:55]
  ds_read_b128 v[84:87], v2 offset:15360
  v_mfma_f32_16x16x32_bf16 v[56:59], v[220:223], v[112:115], v[56:59]
  v_mfma_f32_16x16x32_bf16 v[56:59], v[208:211], v[108:111], v[56:59]
  v_mfma_f32_16x16x32_bf16 v[64:67], v[212:215], v[108:111], v[64:67]
  ds_read_b128 v[96:99], v2 offset:32768
  ds_read_b64_tr_b16 v[120:121], v6 offset:28672
  v_mfma_f32_16x16x32_bf16 v[64:67], v[224:227], v[112:115], v[64:67]
  ds_read_b64_tr_b16 v[122:123], v6 offset:30720
  s_waitcnt lgkmcnt(5)
  v_mfma_f32_16x16x32_bf16 v[36:39], v[116:119], v[28:31], v[36:39]
  v_mfma_f32_16x16x32_bf16 v[60:63], v[224:227], v[100:103], v[60:63]
  buffer_load_dwordx4 v12, s[8:11], s69 offen offset:1024 sc1 lds
  ds_read_b128 v[32:35], v41 offset:448
  v_mfma_f32_16x16x32_bf16 v[60:63], v[212:215], v[104:107], v[60:63]
  ds_read_b128 v[92:95], v2 offset:33792
  v_mfma_f32_16x16x32_bf16 v[68:71], v[216:219], v[104:107], v[68:71]
  v_mfma_f32_16x16x32_bf16 v[68:71], v[228:231], v[100:103], v[68:71]
  v_mfma_f32_16x16x32_bf16 v[72:75], v[228:231], v[112:115], v[72:75]
  ds_read_b128 v[104:107], v2 offset:40960
  v_mfma_f32_16x16x32_bf16 v[72:75], v[216:219], v[108:111], v[72:75]
  s_waitcnt lgkmcnt(6)
  buffer_load_dwordx4 v12, s[8:11], s69 offen offset:2048 sc1 lds
  v_mfma_f32_16x16x32_bf16 v[52:55], v[232:235], v[80:83], v[52:55]
  v_mfma_f32_16x16x32_bf16 v[52:55], v[244:247], v[76:79], v[52:55]
  ds_read_b128 v[100:103], v2 offset:41984
  v_mfma_f32_16x16x32_bf16 v[56:59], v[244:247], v[84:87], v[56:59]
  v_mfma_f32_16x16x32_bf16 v[56:59], v[232:235], v[88:91], v[56:59]
  buffer_load_dwordx4 v12, s[8:11], s69 offen offset:3072 sc1 lds
  s_waitcnt lgkmcnt(3)
  v_mfma_f32_16x16x32_bf16 v[36:39], v[120:123], v[32:35], v[36:39]
  v_mfma_f32_16x16x32_bf16 v[64:67], v[236:239], v[88:91], v[64:67]
  ds_read_b128 v[112:115], v2 offset:34816
  v_mfma_f32_16x16x32_bf16 v[64:67], v[248:251], v[84:87], v[64:67]
  v_mfma_f32_16x16x32_bf16 v[60:63], v[248:251], v[76:79], v[60:63]
  v_mfma_f32_16x16x32_bf16 v[60:63], v[236:239], v[80:83], v[60:63]
  ds_read_b128 v[108:111], v2 offset:35840
  v_mfma_f32_16x16x32_bf16 v[68:71], v[240:243], v[80:83], v[68:71]
  s_nop 0
  buffer_store_dwordx4 v[36:39], v40, s[8:11], s52 offen sc1
  v_mfma_f32_16x16x32_bf16 v[68:71], v[252:255], v[76:79], v[68:71]
  v_mfma_f32_16x16x32_bf16 v[72:75], v[252:255], v[84:87], v[72:75]
  ds_read_b128 v[80:83], v2 offset:43008
  v_mfma_f32_16x16x32_bf16 v[72:75], v[240:243], v[88:91], v[72:75]
  s_waitcnt lgkmcnt(3)
  v_mfma_f32_16x16x32_bf16 v[28:31], a[0:3], v[96:99], 0
  v_mfma_f32_16x16x32_bf16 v[28:31], a[12:15], v[92:95], v[28:31]
  ds_read_b128 v[76:79], v2 offset:44032
  v_mfma_f32_16x16x32_bf16 v[32:35], a[12:15], v[100:103], 0
  v_mfma_f32_16x16x32_bf16 v[32:35], a[0:3], v[104:107], v[32:35]
  v_cvt_pk_bf16_f32 v52, v52, v53
  v_cvt_pk_bf16_f32 v53, v54, v55
  v_mfma_f32_16x16x32_bf16 v[40:43], a[4:7], v[104:107], 0
  ds_read_b128 v[84:87], v2 offset:36864
  v_mfma_f32_16x16x32_bf16 v[40:43], a[16:19], v[100:103], v[40:43]
  ds_write_b64 v18, v[52:53] offset:0
  v_mfma_f32_16x16x32_bf16 v[36:39], a[16:19], v[92:95], 0
  v_cvt_pk_bf16_f32 v60, v60, v61
  v_cvt_pk_bf16_f32 v61, v62, v63
  v_mfma_f32_16x16x32_bf16 v[36:39], a[4:7], v[96:99], v[36:39]
  ds_read_b128 v[88:91], v2 offset:37888
  v_cvt_pk_bf16_f32 v62, v68, v69
  v_cvt_pk_bf16_f32 v63, v70, v71
  v_mfma_f32_16x16x32_bf16 v[44:47], a[8:11], v[96:99], 0
  ds_write_b128 v17, v[60:63] offset:1024
  v_mfma_f32_16x16x32_bf16 v[44:47], a[20:23], v[92:95], v[44:47]
  v_cvt_pk_bf16_f32 v56, v56, v57
  v_cvt_pk_bf16_f32 v57, v58, v59
  v_mfma_f32_16x16x32_bf16 v[48:51], a[20:23], v[100:103], 0
  ds_read_b128 v[96:99], v2 offset:45056
  v_mfma_f32_16x16x32_bf16 v[48:51], a[8:11], v[104:107], v[48:51]
  s_waitcnt lgkmcnt(5)
  ds_write_b64 v18, v[56:57] offset:6144
  v_mfma_f32_16x16x32_bf16 v[28:31], a[24:27], v[112:115], v[28:31]
  v_cvt_pk_bf16_f32 v64, v64, v65
  v_cvt_pk_bf16_f32 v65, v66, v67
  v_mfma_f32_16x16x32_bf16 v[28:31], a[36:39], v[108:111], v[28:31]
  ds_read_b128 v[92:95], v2 offset:46080
  v_cvt_pk_bf16_f32 v66, v72, v73
  v_mfma_f32_16x16x32_bf16 v[32:35], a[36:39], v[76:79], v[32:35]
  v_cvt_pk_bf16_f32 v67, v74, v75
  v_mfma_f32_16x16x32_bf16 v[32:35], a[24:27], v[80:83], v[32:35]
  ds_write_b128 v17, v[64:67] offset:7168
  v_mfma_f32_16x16x32_bf16 v[40:43], a[28:31], v[80:83], v[40:43]
  ds_read_b128 v[100:103], v2 offset:38912
  v_mfma_f32_16x16x32_bf16 v[40:43], a[40:43], v[76:79], v[40:43]
  s_bitcmp1_b32 s44, 0
  s_mov_b32 s52, 0
  s_cselect_b32 s52, 6144, s52
  s_mov_b32 s53, 12288
  s_cselect_b32 s53, 0, s53
  v_mfma_f32_16x16x32_bf16 v[36:39], a[40:43], v[108:111], v[36:39]
  v_add_u32 v116, s52, v19
  v_add_u32 v117, s53, v19
  v_mfma_f32_16x16x32_bf16 v[36:39], a[28:31], v[112:115], v[36:39]
  ds_read_b128 v[104:107], v2 offset:39936
  v_add_u32 v118, s52, v20
  v_mfma_f32_16x16x32_bf16 v[44:47], a[32:35], v[112:115], v[44:47]
  v_add_u32 v119, s53, v20
  v_mfma_f32_16x16x32_bf16 v[44:47], a[44:47], v[108:111], v[44:47]
  s_waitcnt vmcnt(13) lgkmcnt(2)
  s_barrier
  v_mfma_f32_16x16x32_bf16 v[48:51], a[44:47], v[76:79], v[48:51]
  ds_read_b128 v[112:115], v2 offset:47104
  v_mfma_f32_16x16x32_bf16 v[48:51], a[32:35], v[80:83], v[48:51]
  s_waitcnt lgkmcnt(4)
  s_add_u32 m0, s45, 16384
  s_add_u32 s68, s67, 0
  s_and_b32 s68, s68, 7
  s_mul_i32 s68, s68, 262144
  v_mfma_f32_16x16x32_bf16 v[28:31], a[48:51], v[84:87], v[28:31]
HOP3:
  s_cbranch_execz HOP7
  buffer_load_dwordx4 v10, s[16:19], s68 offen lds
  ds_read_b128 v[52:55], v116
  v_mfma_f32_16x16x32_bf16 v[28:31], a[60:63], v[88:91], v[28:31]
  ds_read_b128 v[108:111], v2 offset:48128
  v_mfma_f32_16x16x32_bf16 v[32:35], a[60:63], v[92:95], v[32:35]
  ds_read_b128 v[56:59], v117 offset:1024
  v_mfma_f32_16x16x32_bf16 v[32:35], a[48:51], v[96:99], v[32:35]
  s_add_u32 m0, s45, 20480
  s_add_u32 s68, s68, 65536
  v_mfma_f32_16x16x32_bf16 v[40:43], a[52:55], v[96:99], v[40:43]
  ds_read_b128 v[76:79], v1 offset:32768
  v_mfma_f32_16x16x32_bf16 v[40:43], a[64:67], v[92:95], v[40:43]
  buffer_load_dwordx4 v10, s[16:19], s68 offen lds
  ds_read_b128 v[60:63], v116 offset:1024
  v_mfma_f32_16x16x32_bf16 v[36:39], a[64:67], v[88:91], v[36:39]
  ds_read_b64_tr_b16 v[64:65], v119 offset:2048
  v_mfma_f32_16x16x32_bf16 v[36:39], a[52:55], v[84:87], v[36:39]
  ds_read_b128 v[80:83], v1 offset:33792
  v_mfma_f32_16x16x32_bf16 v[44:47], a[56:59], v[84:87], v[44:47]
  s_add_u32 m0, s45, 24576
  s_add_u32 s68, s68, 65536
  v_mfma_f32_16x16x32_bf16 v[44:47], a[68:71], v[88:91], v[44:47]
  buffer_load_dwordx4 v10, s[16:19], s68 offen lds
  ds_read_b64_tr_b16 v[66:67], v118 offset:2048
  v_mfma_f32_16x16x32_bf16 v[48:51], a[68:71], v[92:95], v[48:51]
  ds_read_b128 v[84:87], v1 offset:40960
  v_mfma_f32_16x16x32_bf16 v[48:51], a[56:59], v[96:99], v[48:51]
  s_waitcnt lgkmcnt(7)
  ds_read_b64_tr_b16 v[68:69], v119 offset:2056
  v_mfma_f32_16x16x32_bf16 v[28:31], a[72:75], v[100:103], v[28:31]
  s_add_u32 m0, s45, 28672
  s_add_u32 s68, s68, 65536
  v_mfma_f32_16x16x32_bf16 v[28:31], a[84:87], v[104:107], v[28:31]
  ds_read_b128 v[88:91], v1 offset:41984
  v_mfma_f32_16x16x32_bf16 v[32:35], a[84:87], v[108:111], v[32:35]
  buffer_load_dwordx4 v10, s[16:19], s68 offen lds
  ds_read_b64_tr_b16 v[70:71], v118 offset:2056
  v_mfma_f32_16x16x32_bf16 v[32:35], a[72:75], v[112:115], v[32:35]
  v_mfma_f32_16x16x32_bf16 v[40:43], a[76:79], v[112:115], v[40:43]
  ds_read_b128 v[92:95], v1 offset:34816
  v_mfma_f32_16x16x32_bf16 v[40:43], a[88:91], v[108:111], v[40:43]
  v_mfma_f32_16x16x32_bf16 v[36:39], a[88:91], v[104:107], v[36:39]
  s_add_u32 m0, s70, 65536
  s_add_u32 s69, s59, 229376
  v_mfma_f32_16x16x32_bf16 v[36:39], a[76:79], v[100:103], v[36:39]
  ds_read_b128 v[96:99], v1 offset:35840
  s_waitcnt lgkmcnt(2)
  v_mfma_f32_16x16x32_bf16 v[116:119], v[56:59], v[52:55], 0
  v_mfma_f32_16x16x32_bf16 v[120:123], v[60:63], v[52:55], 0
  v_mfma_f32_16x16x32_bf16 v[44:47], a[80:83], v[100:103], v[44:47]
  buffer_load_dwordx4 v12, s[8:11], s69 offen offset:0 sc1 lds
  v_mfma_f32_16x16x32_bf16 v[44:47], a[92:95], v[104:107], v[44:47]
  v_mfma_f32_16x16x32_bf16 v[48:51], a[92:95], v[108:111], v[48:51]
  ds_read_b128 v[100:103], v1 offset:43008
  v_mfma_f32_16x16x32_bf16 v[48:51], a[80:83], v[112:115], v[48:51]
  s_waitcnt lgkmcnt(4)
  s_nop 0
  v_cndmask_b32 v72, v116, v120, s[80:81]
  v_cndmask_b32 v73, v117, v121, s[82:83]
  v_mfma_f32_16x16x32_bf16 v[28:31], a[96:99], v[76:79], v[28:31]
  buffer_load_dwordx4 v12, s[8:11], s69 offen offset:1024 sc1 lds
  v_cndmask_b32 v74, v118, v122, s[84:85]
  v_cndmask_b32 v75, v119, v123, s[86:87]
  v_mfma_f32_16x16x32_bf16 v[28:31], a[108:111], v[80:83], v[28:31]
  ds_read_b128 v[104:107], v1 offset:44032
  v_cndmask_b32 v72, v72, v73, s[88:89]
  v_mfma_f32_16x16x32_bf16 v[32:35], a[108:111], v[88:91], v[32:35]
  v_cndmask_b32 v73, v74, v75, s[88:89]
  v_mul_f32 v72, 0x3e8293ee, v72
  v_mfma_f32_16x16x32_bf16 v[32:35], a[96:99], v[84:87], v[32:35]
  v_mul_f32 v73, 0x3e8293ee, v73
  v_max_f32 v74, v72, v73
  v_mfma_f32_16x16x32_bf16 v[40:43], a[100:103], v[84:87], v[40:43]
  ds_read_b128 v[108:111], v1 offset:36864
  v_mov_b32 v75, v74
  v_mfma_f32_16x16x32_bf16 v[40:43], a[112:115], v[88:91], v[40:43]
  buffer_load_dwordx4 v12, s[8:11], s69 offen offset:2048 sc1 lds
  v_permlane16_swap_b32 v74, v75
  v_mfma_f32_16x16x32_bf16 v[36:39], a[112:115], v[80:83], v[36:39]
  v_max_f32 v74, v74, v75
  v_mov_b32 v75, v74
  v_mfma_f32_16x16x32_bf16 v[36:39], a[100:103], v[76:79], v[36:39]
  ds_read_b128 v[112:115], v1 offset:37888
  v_mfma_f32_16x16x32_bf16 v[44:47], a[104:107], v[76:79], v[44:47]
  v_permlane32_swap_b32 v74, v75
  v_mfma_f32_16x16x32_bf16 v[44:47], a[116:119], v[80:83], v[44:47]
  v_max_f32 v74, v74, v75
  v_sub_f32 v72, v72, v74
  v_mfma_f32_16x16x32_bf16 v[48:51], a[116:119], v[88:91], v[48:51]
  ds_read_b128 v[76:79], v1 offset:45056
  v_sub_f32 v73, v73, v74
  v_mfma_f32_16x16x32_bf16 v[48:51], a[104:107], v[84:87], v[48:51]
  s_waitcnt lgkmcnt(3)
  buffer_load_dwordx4 v12, s[8:11], s69 offen offset:3072 sc1 lds
  v_mfma_f32_16x16x32_bf16 v[28:31], a[120:123], v[92:95], v[28:31]
  v_exp_f32 v72, v72
  v_mfma_f32_16x16x32_bf16 v[28:31], a[132:135], v[96:99], v[28:31]
  ds_read_b128 v[80:83], v1 offset:46080
  v_mfma_f32_16x16x32_bf16 v[32:35], a[132:135], v[104:107], v[32:35]
  s_add_u32 m0, s45, 81920
  s_add_u32 s68, s67, 1
  s_and_b32 s68, s68, 7
  s_mul_i32 s68, s68, 262144
  v_mfma_f32_16x16x32_bf16 v[32:35], a[120:123], v[100:103], v[32:35]
  buffer_load_dwordx4 v10, s[16:19], s68 offen lds
  v_exp_f32 v73, v73
  v_mfma_f32_16x16x32_bf16 v[40:43], a[124:127], v[100:103], v[40:43]
  ds_read_b128 v[88:91], v1 offset:38912
  v_add_f32 v74, v72, v73
  v_mfma_f32_16x16x32_bf16 v[40:43], a[136:139], v[104:107], v[40:43]
  v_mov_b32 v75, v74
  v_mfma_f32_16x16x32_bf16 v[36:39], a[136:139], v[96:99], v[36:39]
  s_add_u32 m0, s45, 86016
  s_add_u32 s68, s68, 65536
  v_mfma_f32_16x16x32_bf16 v[36:39], a[124:127], v[92:95], v[36:39]
  ds_read_b128 v[84:87], v1 offset:39936
  v_mfma_f32_16x16x32_bf16 v[44:47], a[128:131], v[92:95], v[44:47]
  buffer_load_dwordx4 v10, s[16:19], s68 offen lds
  v_permlane16_swap_b32 v74, v75
  v_mfma_f32_16x16x32_bf16 v[44:47], a[140:143], v[96:99], v[44:47]
  v_add_f32 v74, v74, v75
  v_mov_b32 v75, v74
  v_mfma_f32_16x16x32_bf16 v[48:51], a[140:143], v[104:107], v[48:51]
  ds_read_b128 v[92:95], v1 offset:47104
  v_mfma_f32_16x16x32_bf16 v[48:51], a[128:131], v[100:103], v[48:51]
  s_waitcnt lgkmcnt(3)
  v_permlane32_swap_b32 v74, v75
  v_mfma_f32_16x16x32_bf16 v[28:31], a[144:147], v[108:111], v[28:31]
  s_add_u32 m0, s45, 90112
  s_add_u32 s68, s68, 65536
  v_add_f32 v74, v74, v75
  v_mfma_f32_16x16x32_bf16 v[28:31], a[156:159], v[112:115], v[28:31]
  ds_read_b128 v[96:99], v1 offset:48128
  v_mfma_f32_16x16x32_bf16 v[32:35], a[156:159], v[80:83], v[32:35]
  buffer_load_dwordx4 v10, s[16:19], s68 offen lds
  v_rcp_f32 v74, v74
  v_mfma_f32_16x16x32_bf16 v[32:35], a[144:147], v[76:79], v[32:35]
  s_waitcnt vmcnt(11)
  s_barrier
  v_mfma_f32_16x16x32_bf16 v[40:43], a[148:151], v[76:79], v[40:43]
  ds_read_b128 v[104:107], v1 offset:49152
  v_mul_f32 v72, v72, v74
  v_add_u32 v15, s46, v0
  s_mov_b64 exec, 1
  buffer_store_dword v15, v0, s[8:11], s79 offen offset:0 sc1
  s_mov_b64 exec, -1
  v_mfma_f32_16x16x32_bf16 v[40:43], a[160:163], v[80:83], v[40:43]
  s_add_u32 m0, s45, 94208
  s_add_u32 s68, s68, 65536
  v_mul_f32 v73, v73, v74
  v_mfma_f32_16x16x32_bf16 v[36:39], a[160:163], v[112:115], v[36:39]
  buffer_load_dwordx4 v10, s[16:19], s68 offen lds
  v_cvt_pk_bf16_f32 v72, v72, v72
  v_cvt_pk_bf16_f32 v73, v73, v73
  v_mfma_f32_16x16x32_bf16 v[36:39], a[148:151], v[108:111], v[36:39]
  ds_read_b128 v[100:103], v1 offset:50176
  v_and_b32 v52, v24, v72
  v_mfma_f32_16x16x32_bf16 v[44:47], a[152:155], v[108:111], v[44:47]
  v_and_b32 v53, v25, v73
  v_and_b32 v54, v26, v72
  v_mfma_f32_16x16x32_bf16 v[44:47], a[164:167], v[112:115], v[44:47]
  v_and_b32 v55, v27, v73
  v_mfma_f32_16x16x32_bf16 v[48:51], a[164:167], v[80:83], v[48:51]
  ds_read_b128 v[108:111], v1 offset:57344
  v_mfma_f32_16x16x32_bf16 v[56:59], v[64:67], v[52:55], 0
  v_mfma_f32_16x16x32_bf16 v[60:63], v[68:71], v[52:55], 0
  v_mfma_f32_16x16x32_bf16 v[48:51], a[152:155], v[76:79], v[48:51]
  s_waitcnt lgkmcnt(3)
  s_add_u32 m0, s70, 98304
  s_add_u32 s69, s60, 229376
  v_mfma_f32_16x16x32_bf16 v[28:31], a[168:171], v[88:91], v[28:31]
  buffer_load_dwordx4 v12, s[8:11], s69 offen offset:0 sc1 lds
  v_mfma_f32_16x16x32_bf16 v[28:31], a[180:183], v[84:87], v[28:31]
  ds_read_b128 v[112:115], v1 offset:58368
  v_mfma_f32_16x16x32_bf16 v[32:35], a[180:183], v[96:99], v[32:35]
  v_cvt_pk_bf16_f32 v116, v56, v57
  v_cvt_pk_bf16_f32 v117, v58, v59
  v_mfma_f32_16x16x32_bf16 v[32:35], a[168:171], v[92:95], v[32:35]
  v_cvt_pk_bf16_f32 v118, v60, v61
  v_cvt_pk_bf16_f32 v119, v62, v63
  v_mfma_f32_16x16x32_bf16 v[40:43], a[172:175], v[92:95], v[40:43]
  ds_read_b128 v[80:83], v1 offset:51200
  v_mfma_f32_16x16x32_bf16 v[40:43], a[184:187], v[96:99], v[40:43]
  buffer_load_dwordx4 v12, s[8:11], s69 offen offset:1024 sc1 lds
  buffer_store_dwordx4 v[116:119], v1, s[8:11], s73 offen sc1
  v_mfma_f32_16x16x32_bf16 v[36:39], a[184:187], v[84:87], v[36:39]
  s_add_u32 s73, s73, 65536
  v_mfma_f32_16x16x32_bf16 v[36:39], a[172:175], v[88:91], v[36:39]
  ds_read_b128 v[76:79], v1 offset:52224
  v_mfma_f32_16x16x32_bf16 v[44:47], a[176:179], v[88:91], v[44:47]
  v_mfma_f32_16x16x32_bf16 v[44:47], a[188:191], v[84:87], v[44:47]
  buffer_load_dwordx4 v12, s[8:11], s69 offen offset:2048 sc1 lds
  v_mfma_f32_16x16x32_bf16 v[48:51], a[188:191], v[96:99], v[48:51]
  ds_read_b128 v[88:91], v1 offset:59392
  v_mfma_f32_16x16x32_bf16 v[48:51], a[176:179], v[92:95], v[48:51]
  s_waitcnt lgkmcnt(3)
  v_mfma_f32_16x16x32_bf16 v[28:31], a[192:195], v[104:107], v[28:31]
  v_mfma_f32_16x16x32_bf16 v[28:31], a[204:207], v[100:103], v[28:31]
  ds_read_b128 v[84:87], v1 offset:60416
  v_mfma_f32_16x16x32_bf16 v[32:35], a[204:207], v[112:115], v[32:35]
  buffer_load_dwordx4 v12, s[8:11], s69 offen offset:3072 sc1 lds
  v_mfma_f32_16x16x32_bf16 v[32:35], a[192:195], v[108:111], v[32:35]
  v_mfma_f32_16x16x32_bf16 v[40:43], a[196:199], v[108:111], v[40:43]
  ds_read_b128 v[96:99], v1 offset:53248
  v_mfma_f32_16x16x32_bf16 v[40:43], a[208:211], v[112:115], v[40:43]
  v_mfma_f32_16x16x32_bf16 v[36:39], a[208:211], v[100:103], v[36:39]
  v_lshrrev_b32 v116, 3, v0
  v_bfe_u32 v117, v116, 1, 2
  v_mfma_f32_16x16x32_bf16 v[36:39], a[196:199], v[104:107], v[36:39]
  ds_read_b128 v[92:95], v1 offset:54272
  v_bfe_u32 v118, v0, 1, 2
  v_mfma_f32_16x16x32_bf16 v[44:47], a[200:203], v[104:107], v[44:47]
  v_xor_b32 v117, v117, v118
  s_lshl_b32 s52, s44, 3
  v_mfma_f32_16x16x32_bf16 v[44:47], a[212:215], v[100:103], v[44:47]
  v_add_u32 v116, s52, v116
  v_mul_u32_u24 v116, 7168, v116
  v_mfma_f32_16x16x32_bf16 v[48:51], a[212:215], v[112:115], v[48:51]
  ds_read_b128 v[104:107], v1 offset:61440
  v_and_b32 v118, 1, v0
  v_mfma_f32_16x16x32_bf16 v[48:51], a[200:203], v[108:111], v[48:51]
  s_waitcnt lgkmcnt(3)
  v_lshl_add_u32 v116, v118, 4, v116
  s_and_b32 s52, s2, 7
  v_mfma_f32_16x16x32_bf16 v[28:31], a[216:219], v[80:83], v[28:31]
  s_mul_i32 s52, s52, 896
  v_add_u32 v116, s52, v116
  v_lshlrev_b32 v118, 5, v117
  v_mfma_f32_16x16x32_bf16 v[28:31], a[228:231], v[76:79], v[28:31]
  ds_read_b128 v[100:103], v1 offset:62464
  s_and_b32 s53, s2, 24
  v_mfma_f32_16x16x32_bf16 v[32:35], a[228:231], v[84:87], v[32:35]
  s_lshl_b32 s52, s53, 5
  v_add3_u32 v16, v116, v118, s52
  s_lshr_b32 s52, 0x0b070602, s53
  v_mfma_f32_16x16x32_bf16 v[32:35], a[216:219], v[88:91], v[32:35]
  s_and_b32 s52, s52, 15
  s_lshl_b32 s52, s52, 6
  v_add_u32 v118, s52, v118
  v_mfma_f32_16x16x32_bf16 v[40:43], a[220:223], v[88:91], v[40:43]
  ds_read_b128 v[112:115], v1 offset:55296
  s_lshr_b32 s52, 0x15140706, s53
  v_mfma_f32_16x16x32_bf16 v[40:43], a[232:235], v[84:87], v[40:43]
  s_and_b32 s52, s52, 31
  s_lshl_b32 s52, s52, 5
  v_mov_b32 v119, s52
  v_mfma_f32_16x16x32_bf16 v[36:39], a[232:235], v[76:79], v[36:39]
  v_cmp_gt_u32 vcc, 2, v117
  s_nop 1
  v_cndmask_b32 v118, v119, v118, vcc
  v_mfma_f32_16x16x32_bf16 v[36:39], a[220:223], v[80:83], v[36:39]
  ds_read_b128 v[108:111], v1 offset:56320
  v_add_u32 v11, v116, v118
  v_mfma_f32_16x16x32_bf16 v[44:47], a[224:227], v[80:83], v[44:47]
  v_mfma_f32_16x16x32_bf16 v[44:47], a[236:239], v[76:79], v[44:47]
  v_mfma_f32_16x16x32_bf16 v[48:51], a[236:239], v[84:87], v[48:51]
  ds_read_b128 v[80:83], v1 offset:63488
  v_mfma_f32_16x16x32_bf16 v[48:51], a[224:227], v[88:91], v[48:51]
  s_waitcnt lgkmcnt(3)
  v_mfma_f32_16x16x32_bf16 v[28:31], a[240:243], v[96:99], v[28:31]
  v_mfma_f32_16x16x32_bf16 v[28:31], v[124:127], v[92:95], v[28:31]
  ds_read_b128 v[76:79], v1 offset:64512
  v_mfma_f32_16x16x32_bf16 v[32:35], v[124:127], v[100:103], v[32:35]
  v_mfma_f32_16x16x32_bf16 v[32:35], a[240:243], v[104:107], v[32:35]
  s_waitcnt vmcnt(23)
  s_barrier
  v_mfma_f32_16x16x32_bf16 v[40:43], a[244:247], v[104:107], v[40:43]
  ds_read_b128 v[84:87], v2 offset:49152
  s_add_u32 m0, s45, 32768
  s_add_u32 s68, s67, 2
  s_and_b32 s68, s68, 7
  s_mul_i32 s68, s68, 262144
  v_mfma_f32_16x16x32_bf16 v[40:43], v[128:131], v[100:103], v[40:43]
  buffer_load_dwordx4 v10, s[16:19], s68 offen lds
  v_mfma_f32_16x16x32_bf16 v[36:39], v[128:131], v[92:95], v[36:39]
  v_mfma_f32_16x16x32_bf16 v[36:39], a[244:247], v[96:99], v[36:39]
  ds_read_b128 v[88:91], v2 offset:50176
  v_mfma_f32_16x16x32_bf16 v[44:47], a[248:251], v[96:99], v[44:47]
  v_mfma_f32_16x16x32_bf16 v[44:47], v[132:135], v[92:95], v[44:47]
  s_add_u32 m0, s45, 36864
  s_add_u32 s68, s68, 65536
  v_mfma_f32_16x16x32_bf16 v[48:51], v[132:135], v[100:103], v[48:51]
  ds_read_b128 v[96:99], v2 offset:57344
  v_mfma_f32_16x16x32_bf16 v[48:51], a[248:251], v[104:107], v[48:51]
  s_waitcnt lgkmcnt(3)
  buffer_load_dwordx4 v10, s[16:19], s68 offen lds
  v_mfma_f32_16x16x32_bf16 v[28:31], v[136:139], v[112:115], v[28:31]
  v_mfma_f32_16x16x32_bf16 v[28:31], v[148:151], v[108:111], v[28:31]
  ds_read_b128 v[92:95], v2 offset:58368
  v_mfma_f32_16x16x32_bf16 v[32:35], v[148:151], v[76:79], v[32:35]
  s_add_u32 m0, s45, 40960
  s_add_u32 s68, s68, 65536
  v_mfma_f32_16x16x32_bf16 v[32:35], v[136:139], v[80:83], v[32:35]
  buffer_load_dwordx4 v10, s[16:19], s68 offen lds
  v_mfma_f32_16x16x32_bf16 v[40:43], v[140:143], v[80:83], v[40:43]
  ds_read_b128 v[100:103], v2 offset:51200
  v_mfma_f32_16x16x32_bf16 v[40:43], v[152:155], v[76:79], v[40:43]
  s_add_u32 m0, s45, 45056
  s_add_u32 s68, s68, 65536
  v_mfma_f32_16x16x32_bf16 v[36:39], v[152:155], v[108:111], v[36:39]
  buffer_load_dwordx4 v10, s[16:19], s68 offen lds
  v_mfma_f32_16x16x32_bf16 v[36:39], v[140:143], v[112:115], v[36:39]
  ds_read_b128 v[104:107], v2 offset:52224
  v_mfma_f32_16x16x32_bf16 v[44:47], v[144:147], v[112:115], v[44:47]
  v_mfma_f32_16x16x32_bf16 v[44:47], v[156:159], v[108:111], v[44:47]
  v_mfma_f32_16x16x32_bf16 v[48:51], v[156:159], v[76:79], v[48:51]
  ds_read_b128 v[112:115], v2 offset:59392
  s_cmp_gt_u32 s44, 1
  s_cbranch_scc1 TH4_adaLN_cond__sliding_local_dilated__swiglu_ffn__prompt_kernel
  s_cmp_eq_u32 s44, 0
  s_cselect_b64 s[4:5], s[28:29], s[32:33]
  s_lshr_b32 s57, s2, 3
  s_mul_i32 s57, s57, 57344
  s_and_b32 vcc_lo, s2, 7
  s_mul_i32 vcc_lo, vcc_lo, 896
  s_add_u32 s57, s57, vcc_lo
  v_lshrrev_b32 v15, 3, v0
  v_mul_u32_u24 v15, 6144, v15
  v_lshl_add_u32 v15, v0, 7, v15
  s_mov_b32 exec_lo, 0x7f7f7f7f
  s_mov_b32 exec_hi, 0x7f7f7f7f
  buffer_load_dword a253, v15, s[4:7], s57 offen
  s_mov_b64 exec, -1
TH4_adaLN_cond__sliding_local_dilated__swiglu_ffn__prompt_kernel:
  v_mfma_f32_16x16x32_bf16 v[48:51], v[144:147], v[80:83], v[48:51]
  s_waitcnt lgkmcnt(3)
  v_mfma_f32_16x16x32_bf16 v[28:31], v[160:163], v[84:87], v[28:31]
  v_mfma_f32_16x16x32_bf16 v[28:31], v[172:175], v[88:91], v[28:31]
  ds_read_b128 v[108:111], v2 offset:60416
  v_mfma_f32_16x16x32_bf16 v[32:35], v[172:175], v[92:95], v[32:35]
  v_mfma_f32_16x16x32_bf16 v[32:35], v[160:163], v[96:99], v[32:35]
  v_mfma_f32_16x16x32_bf16 v[40:43], v[164:167], v[96:99], v[40:43]
  ds_read_b128 v[76:79], v2 offset:53248
  v_mfma_f32_16x16x32_bf16 v[40:43], v[176:179], v[92:95], v[40:43]
  v_mfma_f32_16x16x32_bf16 v[36:39], v[176:179], v[88:91], v[36:39]
  v_mfma_f32_16x16x32_bf16 v[36:39], v[164:167], v[84:87], v[36:39]
  ds_read_b128 v[80:83], v2 offset:54272
  v_mfma_f32_16x16x32_bf16 v[44:47], v[168:171], v[84:87], v[44:47]
  v_mfma_f32_16x16x32_bf16 v[44:47], v[180:183], v[88:91], v[44:47]
  v_mfma_f32_16x16x32_bf16 v[48:51], v[180:183], v[92:95], v[48:51]
  ds_read_b128 v[84:87], v2 offset:61440
  v_mfma_f32_16x16x32_bf16 v[48:51], v[168:171], v[96:99], v[48:51]
  s_waitcnt lgkmcnt(3)
  v_mfma_f32_16x16x32_bf16 v[28:31], v[184:187], v[100:103], v[28:31]
  v_mfma_f32_16x16x32_bf16 v[28:31], v[196:199], v[104:107], v[28:31]
  ds_read_b128 v[88:91], v2 offset:62464
  v_mfma_f32_16x16x32_bf16 v[32:35], v[196:199], v[108:111], v[32:35]
  v_mfma_f32_16x16x32_bf16 v[32:35], v[184:187], v[112:115], v[32:35]
  v_mfma_f32_16x16x32_bf16 v[40:43], v[188:191], v[112:115], v[40:43]
  ds_read_b128 v[92:95], v2 offset:55296
  v_mfma_f32_16x16x32_bf16 v[40:43], v[200:203], v[108:111], v[40:43]
  v_mfma_f32_16x16x32_bf16 v[36:39], v[200:203], v[104:107], v[36:39]
  v_mfma_f32_16x16x32_bf16 v[36:39], v[188:191], v[100:103], v[36:39]
  ds_read_b128 v[96:99], v2 offset:56320
  v_mfma_f32_16x16x32_bf16 v[44:47], v[192:195], v[100:103], v[44:47]
  v_mfma_f32_16x16x32_bf16 v[44:47], v[204:207], v[104:107], v[44:47]
  v_mfma_f32_16x16x32_bf16 v[48:51], v[204:207], v[108:111], v[48:51]
  ds_read_b128 v[100:103], v2 offset:63488
  v_mfma_f32_16x16x32_bf16 v[48:51], v[192:195], v[112:115], v[48:51]
  s_waitcnt lgkmcnt(3)
  v_mfma_f32_16x16x32_bf16 v[28:31], v[208:211], v[76:79], v[28:31]
  v_mfma_f32_16x16x32_bf16 v[28:31], v[220:223], v[80:83], v[28:31]
  ds_read_b128 v[104:107], v2 offset:64512
  v_mfma_f32_16x16x32_bf16 v[32:35], v[220:223], v[88:91], v[32:35]
  v_mfma_f32_16x16x32_bf16 v[32:35], v[208:211], v[84:87], v[32:35]
  s_waitcnt vmcnt(6)
  s_barrier
  v_add_u32 v15, s46, v0
  v_add_u32 v15, 1, v15
  s_mov_b64 exec, 1
  buffer_store_dword v15, v0, s[8:11], s74 offen offset:0 sc1
  s_mov_b64 exec, -1
  v_mfma_f32_16x16x32_bf16 v[40:43], v[212:215], v[84:87], v[40:43]
  ds_read_b128 v[108:111], v1 offset:0
  s_add_u32 m0, s45, 49152
  s_add_u32 s68, s67, 3
  s_and_b32 s68, s68, 7
  s_mul_i32 s68, s68, 262144
  v_mfma_f32_16x16x32_bf16 v[40:43], v[224:227], v[88:91], v[40:43]
  buffer_load_dwordx4 v10, s[16:19], s68 offen lds
  v_mfma_f32_16x16x32_bf16 v[36:39], v[224:227], v[80:83], v[36:39]
  s_add_u32 m0, s45, 53248
  s_add_u32 s68, s68, 65536
  v_mfma_f32_16x16x32_bf16 v[36:39], v[212:215], v[76:79], v[36:39]
  ds_read_b128 v[112:115], v1 offset:1024
  v_mfma_f32_16x16x32_bf16 v[44:47], v[216:219], v[76:79], v[44:47]
  buffer_load_dwordx4 v10, s[16:19], s68 offen lds
  v_mfma_f32_16x16x32_bf16 v[44:47], v[228:231], v[80:83], v[44:47]
  v_mfma_f32_16x16x32_bf16 v[48:51], v[228:231], v[88:91], v[48:51]
  ds_read_b128 v[76:79], v1 offset:8192
  v_mfma_f32_16x16x32_bf16 v[48:51], v[216:219], v[84:87], v[48:51]
  s_waitcnt lgkmcnt(3)
  s_add_u32 m0, s45, 57344
  s_add_u32 s68, s68, 65536
  v_mfma_f32_16x16x32_bf16 v[28:31], v[232:235], v[92:95], v[28:31]
  buffer_load_dwordx4 v10, s[16:19], s68 offen lds
  s_add_u32 m0, s45, 61440
  s_add_u32 s68, s68, 65536
  v_mfma_f32_16x16x32_bf16 v[28:31], v[244:247], v[96:99], v[28:31]
  ds_read_b128 v[80:83], v1 offset:9216
  v_mfma_f32_16x16x32_bf16 v[32:35], v[244:247], v[104:107], v[32:35]
  buffer_load_dwordx4 v10, s[16:19], s68 offen lds
  v_mfma_f32_16x16x32_bf16 v[32:35], v[232:235], v[100:103], v[32:35]
  v_mfma_f32_16x16x32_bf16 v[40:43], v[236:239], v[100:103], v[40:43]
  ds_read_b128 v[88:91], v1 offset:2048
  v_mfma_f32_16x16x32_bf16 v[40:43], v[248:251], v[104:107], v[40:43]
  v_mfma_f32_16x16x32_bf16 v[36:39], v[248:251], v[96:99], v[36:39]
  v_mfma_f32_16x16x32_bf16 v[36:39], v[236:239], v[92:95], v[36:39]
  ds_read_b128 v[84:87], v1 offset:3072
  v_mfma_f32_16x16x32_bf16 v[44:47], v[240:243], v[92:95], v[44:47]
  v_mfma_f32_16x16x32_bf16 v[44:47], v[252:255], v[96:99], v[44:47]
  v_mfma_f32_16x16x32_bf16 v[48:51], v[252:255], v[104:107], v[48:51]
  ds_read_b128 v[92:95], v1 offset:10240
  v_mfma_f32_16x16x32_bf16 v[48:51], v[240:243], v[100:103], v[48:51]
  s_waitcnt lgkmcnt(3)
  v_mfma_f32_16x16x32_bf16 v[52:55], a[0:3], v[108:111], 0
  v_mfma_f32_16x16x32_bf16 v[52:55], a[12:15], v[112:115], v[52:55]
  ds_read_b128 v[96:99], v1 offset:11264
  v_mfma_f32_16x16x32_bf16 v[56:59], a[12:15], v[80:83], 0
  v_mfma_f32_16x16x32_bf16 v[56:59], a[0:3], v[76:79], v[56:59]
  v_cvt_pk_bf16_f32 v28, v28, v29
  v_cvt_pk_bf16_f32 v29, v30, v31
  v_mfma_f32_16x16x32_bf16 v[64:67], a[4:7], v[76:79], 0
  ds_read_b128 v[104:107], v1 offset:4096
  v_mfma_f32_16x16x32_bf16 v[64:67], a[16:19], v[80:83], v[64:67]
  ds_write_b64 v18, v[28:29] offset:12288
  v_mfma_f32_16x16x32_bf16 v[60:63], a[16:19], v[112:115], 0
  v_cvt_pk_bf16_f32 v36, v36, v37
  v_cvt_pk_bf16_f32 v37, v38, v39
  v_mfma_f32_16x16x32_bf16 v[60:63], a[4:7], v[108:111], v[60:63]
  ds_read_b128 v[100:103], v1 offset:5120
  v_cvt_pk_bf16_f32 v38, v44, v45
  v_cvt_pk_bf16_f32 v39, v46, v47
  v_mfma_f32_16x16x32_bf16 v[68:71], a[8:11], v[108:111], 0
  ds_write_b128 v17, v[36:39] offset:13312
  v_mfma_f32_16x16x32_bf16 v[68:71], a[20:23], v[112:115], v[68:71]
  v_cvt_pk_bf16_f32 v32, v32, v33
  v_cvt_pk_bf16_f32 v33, v34, v35
  v_mfma_f32_16x16x32_bf16 v[72:75], a[20:23], v[80:83], 0
  ds_read_b128 v[108:111], v1 offset:12288
  v_mfma_f32_16x16x32_bf16 v[72:75], a[8:11], v[76:79], v[72:75]
  s_waitcnt lgkmcnt(5)
  ds_write_b64 v18, v[32:33] offset:0
  v_mfma_f32_16x16x32_bf16 v[52:55], a[24:27], v[88:91], v[52:55]
  v_cvt_pk_bf16_f32 v40, v40, v41
  v_cvt_pk_bf16_f32 v41, v42, v43
  v_mfma_f32_16x16x32_bf16 v[52:55], a[36:39], v[84:87], v[52:55]
  ds_read_b128 v[112:115], v1 offset:13312
  v_cvt_pk_bf16_f32 v42, v48, v49
  v_mfma_f32_16x16x32_bf16 v[56:59], a[36:39], v[96:99], v[56:59]
  v_cvt_pk_bf16_f32 v43, v50, v51
  v_mfma_f32_16x16x32_bf16 v[56:59], a[24:27], v[92:95], v[56:59]
  ds_write_b128 v17, v[40:43] offset:1024
  v_mfma_f32_16x16x32_bf16 v[64:67], a[28:31], v[92:95], v[64:67]
  ds_read_b128 v[80:83], v1 offset:6144
  v_mfma_f32_16x16x32_bf16 v[64:67], a[40:43], v[96:99], v[64:67]
  s_bitcmp1_b32 s44, 0
  s_mov_b32 s52, 12288
  s_cselect_b32 s52, 0, s52
  s_mov_b32 s53, 6144
  s_cselect_b32 s53, 12288, s53
  v_mfma_f32_16x16x32_bf16 v[60:63], a[40:43], v[84:87], v[60:63]
  v_add_u32 v116, s52, v19
  v_add_u32 v117, s53, v19
  v_mfma_f32_16x16x32_bf16 v[60:63], a[28:31], v[88:91], v[60:63]
  ds_read_b128 v[76:79], v1 offset:7168
  v_add_u32 v118, s52, v20
  v_mfma_f32_16x16x32_bf16 v[68:71], a[32:35], v[88:91], v[68:71]
  v_add_u32 v119, s53, v20
  v_mfma_f32_16x16x32_bf16 v[68:71], a[44:47], v[84:87], v[68:71]
  s_waitcnt vmcnt(19) lgkmcnt(2)
  s_barrier
  v_mfma_f32_16x16x32_bf16 v[72:75], a[44:47], v[96:99], v[72:75]
  ds_read_b128 v[88:91], v1 offset:14336
  s_add_u32 m0, s45, 114688
  s_add_u32 s68, s67, 4
  s_and_b32 s68, s68, 7
  s_mul_i32 s68, s68, 262144
  v_mfma_f32_16x16x32_bf16 v[72:75], a[32:35], v[92:95], v[72:75]
  s_waitcnt lgkmcnt(4)
  buffer_load_dwordx4 v10, s[16:19], s68 offen lds
  ds_read_b128 v[28:31], v116
  v_mfma_f32_16x16x32_bf16 v[52:55], a[48:51], v[104:107], v[52:55]
  ds_read_b64_tr_b16 a[0:1], v4 offset:16384
  ds_read_b128 v[32:35], v117 offset:1024
  v_mfma_f32_16x16x32_bf16 v[52:55], a[60:63], v[100:103], v[52:55]
  ds_read_b128 v[84:87], v1 offset:15360
  s_add_u32 m0, s45, 118784
  s_add_u32 s68, s68, 65536
  v_mfma_f32_16x16x32_bf16 v[56:59], a[60:63], v[112:115], v[56:59]
  ds_read_b64_tr_b16 a[2:3], v4 offset:18432
  buffer_load_dwordx4 v10, s[16:19], s68 offen lds
  v_mfma_f32_16x16x32_bf16 v[56:59], a[48:51], v[108:111], v[56:59]
  ds_read_b64_tr_b16 a[4:5], v5 offset:16384
  ds_read_b128 v[36:39], v116 offset:1024
  v_mfma_f32_16x16x32_bf16 v[64:67], a[52:55], v[108:111], v[64:67]
  ds_read_b128 v[96:99], v2 offset:0
  s_add_u32 m0, s45, 122880
  s_add_u32 s68, s68, 65536
  v_mfma_f32_16x16x32_bf16 v[64:67], a[64:67], v[112:115], v[64:67]
  ds_read_b64_tr_b16 a[6:7], v5 offset:18432
  buffer_load_dwordx4 v10, s[16:19], s68 offen lds
  v_mfma_f32_16x16x32_bf16 v[60:63], a[64:67], v[100:103], v[60:63]
  ds_read_b64_tr_b16 a[8:9], v4 offset:20480
  ds_read_b64_tr_b16 v[40:41], v119 offset:2048
  v_mfma_f32_16x16x32_bf16 v[60:63], a[52:55], v[104:107], v[60:63]
  ds_read_b128 v[92:95], v2 offset:1024
  s_add_u32 m0, s45, 126976
  s_add_u32 s68, s68, 65536
  v_mfma_f32_16x16x32_bf16 v[68:71], a[56:59], v[104:107], v[68:71]
  ds_read_b64_tr_b16 a[10:11], v4 offset:22528
  buffer_load_dwordx4 v10, s[16:19], s68 offen lds
  v_mfma_f32_16x16x32_bf16 v[68:71], a[68:71], v[100:103], v[68:71]
  ds_read_b64_tr_b16 a[12:13], v5 offset:20480
  ds_read_b64_tr_b16 v[42:43], v118 offset:2048
  v_mfma_f32_16x16x32_bf16 v[72:75], a[68:71], v[112:115], v[72:75]
  ds_read_b128 v[104:107], v2 offset:8192
  ds_read_b64_tr_b16 v[44:45], v119 offset:2056
  v_mfma_f32_16x16x32_bf16 v[72:75], a[56:59], v[108:111], v[72:75]
  s_waitcnt lgkmcnt(13)
  ds_read_b64_tr_b16 a[14:15], v5 offset:22528
  v_mfma_f32_16x16x32_bf16 v[52:55], a[72:75], v[80:83], v[52:55]
  ds_read_b64_tr_b16 a[16:17], v4 offset:24576
  ds_read_b64_tr_b16 v[46:47], v118 offset:2056
  v_mfma_f32_16x16x32_bf16 v[52:55], a[84:87], v[76:79], v[52:55]
  ds_read_b128 v[100:103], v2 offset:9216
  v_mfma_f32_16x16x32_bf16 v[56:59], a[84:87], v[84:87], v[56:59]
  ds_read_b64_tr_b16 a[18:19], v4 offset:26624
  v_mfma_f32_16x16x32_bf16 v[56:59], a[72:75], v[88:91], v[56:59]
  ds_read_b64_tr_b16 a[20:21], v5 offset:24576
  v_mfma_f32_16x16x32_bf16 v[64:67], a[76:79], v[88:91], v[64:67]
  ds_read_b128 v[112:115], v2 offset:2048
  v_mfma_f32_16x16x32_bf16 v[64:67], a[88:91], v[84:87], v[64:67]
  ds_read_b64_tr_b16 a[22:23], v5 offset:26624
  s_waitcnt lgkmcnt(5)
  v_mfma_f32_16x16x32_bf16 v[116:119], v[32:35], v[28:31], 0
  v_mfma_f32_16x16x32_bf16 v[120:123], v[36:39], v[28:31], 0
  v_mfma_f32_16x16x32_bf16 v[60:63], a[88:91], v[76:79], v[60:63]
  ds_read_b64_tr_b16 a[24:25], v4 offset:28672
  v_mfma_f32_16x16x32_bf16 v[60:63], a[76:79], v[80:83], v[60:63]
  ds_read_b128 v[108:111], v2 offset:3072
  v_mfma_f32_16x16x32_bf16 v[68:71], a[80:83], v[80:83], v[68:71]
  ds_read_b64_tr_b16 a[26:27], v4 offset:30720
  v_mfma_f32_16x16x32_bf16 v[68:71], a[92:95], v[76:79], v[68:71]
  ds_read_b64_tr_b16 a[28:29], v5 offset:28672
  v_cndmask_b32 v48, v116, v120, s[80:81]
  v_cndmask_b32 v49, v117, v121, s[82:83]
  v_mfma_f32_16x16x32_bf16 v[72:75], a[92:95], v[84:87], v[72:75]
  ds_read_b128 v[80:83], v2 offset:10240
  v_cndmask_b32 v50, v118, v122, s[84:85]
  v_cndmask_b32 v51, v119, v123, s[86:87]
  v_mfma_f32_16x16x32_bf16 v[72:75], a[80:83], v[88:91], v[72:75]
  s_waitcnt lgkmcnt(9)
  ds_read_b64_tr_b16 a[30:31], v5 offset:30720
  v_cndmask_b32 v48, v48, v49, s[88:89]
  v_mfma_f32_16x16x32_bf16 v[52:55], a[96:99], v[96:99], v[52:55]
  s_lshl_b32 s57, s44, 28
  s_add_u32 s57, s57, s77
  buffer_load_dword v13, v14, s[8:11], s57 offen sc1
  v_cndmask_b32 v49, v50, v51, s[88:89]
  v_mfma_f32_16x16x32_bf16 v[52:55], a[108:111], v[92:95], v[52:55]
  ds_read_b128 v[76:79], v2 offset:11264
  v_mul_f32 v48, 0x3e8293ee, v48
  v_mul_f32 v49, 0x3e8293ee, v49
  v_mfma_f32_16x16x32_bf16 v[56:59], a[108:111], v[100:103], v[56:59]
  v_max_f32 v50, v48, v49
HOP4:
  s_cbranch_execz HOP8
  v_mov_b32 v51, v50
  v_mfma_f32_16x16x32_bf16 v[56:59], a[96:99], v[104:107], v[56:59]
  s_nop 0
  v_permlane16_swap_b32 v50, v51
  v_max_f32 v50, v50, v51
  v_mfma_f32_16x16x32_bf16 v[64:67], a[100:103], v[104:107], v[64:67]
  ds_read_b128 v[84:87], v2 offset:4096
  s_waitcnt vmcnt(14)
  s_barrier
  v_mfma_f32_16x16x32_bf16 v[64:67], a[112:115], v[100:103], v[64:67]
  ds_read_b64_tr_b16 a[32:33], v7 offset:16384
  s_add_u32 m0, s70, 0
  s_add_u32 s69, s61, 229376
  v_mfma_f32_16x16x32_bf16 v[60:63], a[112:115], v[92:95], v[60:63]
  ds_read_b64_tr_b16 a[34:35], v7 offset:18432
  buffer_load_dwordx4 v12, s[8:11], s69 offen offset:0 sc1 lds
  v_mov_b32 v51, v50
  v_mfma_f32_16x16x32_bf16 v[60:63], a[100:103], v[96:99], v[60:63]
  ds_read_b128 v[88:91], v2 offset:5120
  v_permlane32_swap_b32 v50, v51
  v_mfma_f32_16x16x32_bf16 v[68:71], a[104:107], v[96:99], v[68:71]
  ds_read_b64_tr_b16 a[36:37], v8 offset:16384
  v_max_f32 v50, v50, v51
  v_sub_f32 v48, v48, v50
  v_mfma_f32_16x16x32_bf16 v[68:71], a[116:119], v[92:95], v[68:71]
  ds_read_b64_tr_b16 a[38:39], v8 offset:18432
  buffer_load_dwordx4 v12, s[8:11], s69 offen offset:1024 sc1 lds
  v_sub_f32 v49, v49, v50
  v_mfma_f32_16x16x32_bf16 v[72:75], a[116:119], v[100:103], v[72:75]
  ds_read_b128 v[96:99], v2 offset:12288
  v_exp_f32 v48, v48
  v_mfma_f32_16x16x32_bf16 v[72:75], a[104:107], v[104:107], v[72:75]
  s_waitcnt lgkmcnt(7)
  ds_read_b64_tr_b16 a[40:41], v7 offset:20480
  v_mfma_f32_16x16x32_bf16 v[52:55], a[120:123], v[112:115], v[52:55]
  ds_read_b64_tr_b16 a[42:43], v7 offset:22528
  buffer_load_dwordx4 v12, s[8:11], s69 offen offset:2048 sc1 lds
  v_mfma_f32_16x16x32_bf16 v[52:55], a[132:135], v[108:111], v[52:55]
  ds_read_b128 v[92:95], v2 offset:13312
  v_exp_f32 v49, v49
  v_mfma_f32_16x16x32_bf16 v[56:59], a[132:135], v[76:79], v[56:59]
  ds_read_b64_tr_b16 a[44:45], v8 offset:20480
  v_add_f32 v50, v48, v49
  v_mov_b32 v51, v50
  v_mfma_f32_16x16x32_bf16 v[56:59], a[120:123], v[80:83], v[56:59]
  ds_read_b64_tr_b16 a[46:47], v8 offset:22528
  buffer_load_dwordx4 v12, s[8:11], s69 offen offset:3072 sc1 lds
  v_mfma_f32_16x16x32_bf16 v[64:67], a[124:127], v[80:83], v[64:67]
  ds_read_b128 v[100:103], v2 offset:6144
  v_permlane16_swap_b32 v50, v51
  v_mfma_f32_16x16x32_bf16 v[64:67], a[136:139], v[76:79], v[64:67]
  ds_read_b64_tr_b16 a[48:49], v7 offset:24576
  v_add_f32 v50, v50, v51
  v_mov_b32 v51, v50
  v_mfma_f32_16x16x32_bf16 v[60:63], a[136:139], v[108:111], v[60:63]
  ds_read_b64_tr_b16 a[50:51], v7 offset:26624
  v_permlane32_swap_b32 v50, v51
  v_mfma_f32_16x16x32_bf16 v[60:63], a[124:127], v[112:115], v[60:63]
  ds_read_b128 v[104:107], v2 offset:7168
  v_add_f32 v50, v50, v51
  v_mfma_f32_16x16x32_bf16 v[68:71], a[128:131], v[112:115], v[68:71]
  ds_read_b64_tr_b16 a[52:53], v8 offset:24576
  v_rcp_f32 v50, v50
  v_mfma_f32_16x16x32_bf16 v[68:71], a[140:143], v[108:111], v[68:71]
  ds_read_b64_tr_b16 a[54:55], v8 offset:26624
  v_mul_f32 v48, v48, v50
  v_mul_f32 v49, v49, v50
  v_mfma_f32_16x16x32_bf16 v[72:75], a[140:143], v[76:79], v[72:75]
  ds_read_b128 v[112:115], v2 offset:14336
  v_cvt_pk_bf16_f32 v48, v48, v48
  v_cvt_pk_bf16_f32 v49, v49, v49
  v_mfma_f32_16x16x32_bf16 v[72:75], a[128:131], v[80:83], v[72:75]
  s_waitcnt lgkmcnt(9)
  ds_read_b64_tr_b16 a[56:57], v7 offset:28672
  v_and_b32 v28, v24, v48
  v_mfma_f32_16x16x32_bf16 v[52:55], a[144:147], v[84:87], v[52:55]
  ds_read_b64_tr_b16 a[58:59], v7 offset:30720
  v_and_b32 v29, v25, v49
  v_and_b32 v30, v26, v48
  v_mfma_f32_16x16x32_bf16 v[52:55], a[156:159], v[88:91], v[52:55]
  ds_read_b128 v[108:111], v2 offset:15360
  v_and_b32 v31, v27, v49
  v_mfma_f32_16x16x32_bf16 v[56:59], a[156:159], v[92:95], v[56:59]
  ds_read_b64_tr_b16 a[60:61], v8 offset:28672
  v_mfma_f32_16x16x32_bf16 v[32:35], v[40:43], v[28:31], 0
  v_mfma_f32_16x16x32_bf16 v[36:39], v[44:47], v[28:31], 0
  v_mfma_f32_16x16x32_bf16 v[56:59], a[144:147], v[96:99], v[56:59]
  ds_read_b64_tr_b16 a[62:63], v8 offset:30720
  v_mfma_f32_16x16x32_bf16 v[64:67], a[148:151], v[96:99], v[64:67]
  ds_read_b128 v[76:79], v2 offset:32768
  v_mfma_f32_16x16x32_bf16 v[64:67], a[160:163], v[92:95], v[64:67]
  v_mfma_f32_16x16x32_bf16 v[60:63], a[160:163], v[88:91], v[60:63]
  s_nop 0
  v_cvt_pk_bf16_f32 v116, v32, v33
  v_cvt_pk_bf16_f32 v117, v34, v35
  v_cvt_pk_bf16_f32 v118, v36, v37
  v_mfma_f32_16x16x32_bf16 v[60:63], a[148:151], v[84:87], v[60:63]
  ds_read_b128 v[80:83], v2 offset:33792
  v_cvt_pk_bf16_f32 v119, v38, v39
  v_mfma_f32_16x16x32_bf16 v[68:71], a[152:155], v[84:87], v[68:71]
  buffer_store_dwordx4 v[116:119], v1, s[8:11], s73 offen sc1
  v_mfma_f32_16x16x32_bf16 v[68:71], a[164:167], v[88:91], v[68:71]
  s_add_u32 s73, s73, 65536
  v_mfma_f32_16x16x32_bf16 v[72:75], a[164:167], v[92:95], v[72:75]
  ds_read_b128 v[84:87], v2 offset:40960
  v_mfma_f32_16x16x32_bf16 v[72:75], a[152:155], v[96:99], v[72:75]
  s_waitcnt lgkmcnt(5)
  s_waitcnt vmcnt(5)
  s_cmp_lg_u32 s44, 0
  s_cbranch_scc1 PL5_adaLN_cond__sliding_local_dilated__swiglu_ffn__prompt_kernelx
  v_subrev_u32 v13, s46, v13
  v_subrev_u32 v13, 1, v13
  v_cmp_lt_u32 vcc, 3, v13
  s_nop 4
  s_cbranch_vccz PL5_adaLN_cond__sliding_local_dilated__swiglu_ffn__prompt_kernelx
  s_mov_b32 s57, 60000
PL5_adaLN_cond__sliding_local_dilated__swiglu_ffn__prompt_kernel:
  buffer_load_dword v13, v14, s[8:11], s77 offen sc1
  s_sub_u32 s57, s57, 1
  s_cmp_eq_u32 s57, 0
  s_waitcnt vmcnt(0)
  s_cbranch_scc1 PL5_adaLN_cond__sliding_local_dilated__swiglu_ffn__prompt_kernelx
  v_subrev_u32 v13, s46, v13
  v_subrev_u32 v13, 1, v13
  v_cmp_lt_u32 vcc, 3, v13
  s_nop 4
  s_cbranch_vccnz PL5_adaLN_cond__sliding_local_dilated__swiglu_ffn__prompt_kernel
PL5_adaLN_cond__sliding_local_dilated__swiglu_ffn__prompt_kernelx:
  s_waitcnt vmcnt(10) lgkmcnt(3)
  s_barrier
  v_mfma_f32_16x16x32_bf16 v[52:55], a[168:171], v[100:103], v[52:55]
  ds_read_b64_tr_b16 a[64:65], v4 offset:32768
  s_add_u32 m0, s45, 16384
  s_add_u32 s68, s67, 5
  s_and_b32 s68, s68, 7
  s_mul_i32 s68, s68, 262144
  v_mfma_f32_16x16x32_bf16 v[52:55], a[180:183], v[104:107], v[52:55]
  ds_read_b128 v[88:91], v2 offset:41984
  ds_read_b64_tr_b16 a[66:67], v4 offset:34816
  v_mfma_f32_16x16x32_bf16 v[56:59], a[180:183], v[108:111], v[56:59]
  ds_read_b64_tr_b16 a[68:69], v5 offset:32768
  buffer_load_dwordx4 v10, s[16:19], s68 offen lds
  v_mfma_f32_16x16x32_bf16 v[56:59], a[168:171], v[112:115], v[56:59]
  ds_read_b64_tr_b16 a[70:71], v5 offset:34816
  ds_read_b64_tr_b16 a[72:73], v4 offset:36864
  v_mfma_f32_16x16x32_bf16 v[64:67], a[172:175], v[112:115], v[64:67]
  ds_read_b128 v[92:95], v2 offset:34816
  ds_read_b64_tr_b16 a[74:75], v4 offset:38912
  s_add_u32 m0, s45, 20480
  s_add_u32 s68, s68, 65536
  v_mfma_f32_16x16x32_bf16 v[64:67], a[184:187], v[108:111], v[64:67]
  ds_read_b64_tr_b16 a[76:77], v5 offset:36864
  buffer_load_dwordx4 v10, s[16:19], s68 offen lds
  v_mfma_f32_16x16x32_bf16 v[60:63], a[184:187], v[104:107], v[60:63]
  ds_read_b64_tr_b16 a[78:79], v5 offset:38912
  ds_read_b64_tr_b16 a[80:81], v4 offset:40960
  v_mfma_f32_16x16x32_bf16 v[60:63], a[172:175], v[100:103], v[60:63]
  ds_read_b128 v[96:99], v2 offset:35840
  ds_read_b64_tr_b16 a[82:83], v4 offset:43008
  s_add_u32 m0, s45, 24576
  s_add_u32 s68, s68, 65536
  v_mfma_f32_16x16x32_bf16 v[68:71], a[176:179], v[100:103], v[68:71]
  ds_read_b64_tr_b16 a[84:85], v5 offset:40960
  buffer_load_dwordx4 v10, s[16:19], s68 offen lds
  v_mfma_f32_16x16x32_bf16 v[68:71], a[188:191], v[104:107], v[68:71]
  ds_read_b64_tr_b16 a[86:87], v5 offset:43008
  ds_read_b64_tr_b16 a[88:89], v4 offset:45056
  v_mfma_f32_16x16x32_bf16 v[72:75], a[188:191], v[108:111], v[72:75]
  ds_read_b128 v[100:103], v2 offset:43008
  ds_read_b64_tr_b16 a[90:91], v4 offset:47104
  s_add_u32 m0, s45, 28672
  s_add_u32 s68, s68, 65536
  v_mfma_f32_16x16x32_bf16 v[72:75], a[176:179], v[112:115], v[72:75]
  s_waitcnt lgkmcnt(15)
  ds_read_b64_tr_b16 a[92:93], v5 offset:45056
  buffer_load_dwordx4 v10, s[16:19], s68 offen lds
  v_mfma_f32_16x16x32_bf16 v[52:55], a[192:195], v[76:79], v[52:55]
  ds_read_b64_tr_b16 a[94:95], v5 offset:47104
  ds_read_b64_tr_b16 a[96:97], v4 offset:49152
  v_mfma_f32_16x16x32_bf16 v[52:55], a[204:207], v[80:83], v[52:55]
  ds_read_b128 v[104:107], v2 offset:44032
  ds_read_b64_tr_b16 a[98:99], v4 offset:51200
  s_add_u32 m0, s45, 81920
  s_add_u32 s68, s67, 6
  s_and_b32 s68, s68, 7
  s_mul_i32 s68, s68, 262144
  v_mfma_f32_16x16x32_bf16 v[56:59], a[204:207], v[88:91], v[56:59]
  ds_read_b64_tr_b16 a[100:101], v5 offset:49152
  buffer_load_dwordx4 v10, s[16:19], s68 offen lds
  v_mfma_f32_16x16x32_bf16 v[56:59], a[192:195], v[84:87], v[56:59]
  ds_read_b64_tr_b16 a[102:103], v5 offset:51200
  ds_read_b64_tr_b16 a[104:105], v4 offset:53248
  v_mfma_f32_16x16x32_bf16 v[64:67], a[196:199], v[84:87], v[64:67]
  ds_read_b128 v[108:111], v2 offset:36864
  ds_read_b64_tr_b16 a[106:107], v4 offset:55296
  s_add_u32 m0, s45, 86016
  s_add_u32 s68, s68, 65536
  v_mfma_f32_16x16x32_bf16 v[64:67], a[208:211], v[88:91], v[64:67]
  ds_read_b64_tr_b16 a[108:109], v5 offset:53248
  buffer_load_dwordx4 v10, s[16:19], s68 offen lds
  v_mfma_f32_16x16x32_bf16 v[60:63], a[208:211], v[80:83], v[60:63]
  ds_read_b64_tr_b16 a[110:111], v5 offset:55296
  ds_read_b64_tr_b16 a[112:113], v4 offset:57344
  v_mfma_f32_16x16x32_bf16 v[60:63], a[196:199], v[76:79], v[60:63]
  ds_read_b128 v[112:115], v2 offset:37888
  ds_read_b64_tr_b16 a[114:115], v4 offset:59392
  s_add_u32 m0, s45, 90112
  s_add_u32 s68, s68, 65536
  v_mfma_f32_16x16x32_bf16 v[68:71], a[200:203], v[76:79], v[68:71]
  ds_read_b64_tr_b16 a[116:117], v5 offset:57344
  buffer_load_dwordx4 v10, s[16:19], s68 offen lds
  v_mfma_f32_16x16x32_bf16 v[68:71], a[212:215], v[80:83], v[68:71]
  ds_read_b64_tr_b16 a[118:119], v5 offset:59392
  ds_read_b64_tr_b16 a[120:121], v4 offset:61440
  v_mfma_f32_16x16x32_bf16 v[72:75], a[212:215], v[88:91], v[72:75]
  ds_read_b128 v[76:79], v2 offset:45056
  ds_read_b64_tr_b16 a[122:123], v4 offset:63488
  s_add_u32 m0, s45, 94208
  s_add_u32 s68, s68, 65536
  v_mfma_f32_16x16x32_bf16 v[72:75], a[200:203], v[84:87], v[72:75]
  s_waitcnt lgkmcnt(15)
  ds_read_b64_tr_b16 a[124:125], v5 offset:61440
  buffer_load_dwordx4 v10, s[16:19], s68 offen lds
  v_mfma_f32_16x16x32_bf16 v[52:55], a[216:219], v[92:95], v[52:55]
  ds_read_b64_tr_b16 a[126:127], v5 offset:63488
  v_mfma_f32_16x16x32_bf16 v[52:55], a[228:231], v[96:99], v[52:55]
  ds_read_b128 v[80:83], v2 offset:46080
  v_mfma_f32_16x16x32_bf16 v[56:59], a[228:231], v[104:107], v[56:59]
  v_mfma_f32_16x16x32_bf16 v[56:59], a[216:219], v[100:103], v[56:59]
  v_mfma_f32_16x16x32_bf16 v[64:67], a[220:223], v[100:103], v[64:67]
  ds_read_b128 v[88:91], v2 offset:38912
  v_mfma_f32_16x16x32_bf16 v[64:67], a[232:235], v[104:107], v[64:67]
  v_lshlrev_b32 v21, 7, v0
  v_add_u32 v21, 720896, v21
  v_mfma_f32_16x16x32_bf16 v[60:63], a[232:235], v[96:99], v[60:63]
  s_waitcnt vmcnt(4) lgkmcnt(2)
  s_barrier
  v_add_u32 v15, s46, v0
  v_add_u32 v15, 2, v15
  s_mov_b64 exec, 1
  buffer_store_dword v15, v0, s[8:11], s74 offen offset:0 sc1
  s_mov_b64 exec, -1
  v_mfma_f32_16x16x32_bf16 v[60:63], a[220:223], v[92:95], v[60:63]
  ds_read_b128 v[84:87], v2 offset:39936
  ds_read_b64_tr_b16 a[128:129], v7 offset:49152
  s_add_u32 m0, s45, 65536
  s_add_u32 s68, s67, 7
  s_and_b32 s68, s68, 7
  s_mul_i32 s68, s68, 262144
  v_mfma_f32_16x16x32_bf16 v[68:71], a[224:227], v[92:95], v[68:71]
  ds_read_b64_tr_b16 a[130:131], v7 offset:51200
  buffer_load_dwordx4 v10, s[16:19], s68 offen lds
  v_mfma_f32_16x16x32_bf16 v[68:71], a[236:239], v[96:99], v[68:71]
  ds_read_b64_tr_b16 a[132:133], v8 offset:49152
  v_mfma_f32_16x16x32_bf16 v[72:75], a[236:239], v[104:107], v[72:75]
  ds_read_b128 v[92:95], v2 offset:47104
  ds_read_b64_tr_b16 a[134:135], v8 offset:51200
  ds_read_b64_tr_b16 a[136:137], v7 offset:53248
  v_mfma_f32_16x16x32_bf16 v[72:75], a[224:227], v[100:103], v[72:75]
  s_waitcnt lgkmcnt(8)
  ds_read_b64_tr_b16 a[138:139], v7 offset:55296
  s_add_u32 m0, s45, 69632
  s_add_u32 s68, s68, 65536
  v_mfma_f32_16x16x32_bf16 v[52:55], a[240:243], v[108:111], v[52:55]
  ds_read_b64_tr_b16 a[140:141], v8 offset:53248
  buffer_load_dwordx4 v10, s[16:19], s68 offen lds
  s_add_u32 m0, s45, 73728
  s_add_u32 s68, s68, 65536
  v_mfma_f32_16x16x32_bf16 v[52:55], v[124:127], v[112:115], v[52:55]
  ds_read_b128 v[96:99], v2 offset:48128
  ds_read_b64_tr_b16 a[142:143], v8 offset:55296
  ds_read_b64_tr_b16 a[144:145], v7 offset:57344
  v_mfma_f32_16x16x32_bf16 v[56:59], v[124:127], v[80:83], v[56:59]
  ds_read_b64_tr_b16 a[146:147], v7 offset:59392
  buffer_load_dwordx4 v10, s[16:19], s68 offen lds
  v_mfma_f32_16x16x32_bf16 v[56:59], a[240:243], v[76:79], v[56:59]
  ds_read_b64_tr_b16 a[148:149], v8 offset:57344
  s_add_u32 m0, s45, 77824
  s_add_u32 s68, s68, 65536
  v_mfma_f32_16x16x32_bf16 v[64:67], a[244:247], v[76:79], v[64:67]
  ds_read_b128 v[104:107], v1 offset:0
  ds_read_b64_tr_b16 a[150:151], v8 offset:59392
  ds_read_b64_tr_b16 a[152:153], v7 offset:61440
  v_mfma_f32_16x16x32_bf16 v[64:67], v[128:131], v[80:83], v[64:67]
  ds_read_b64_tr_b16 a[154:155], v7 offset:63488
  buffer_load_dwordx4 v10, s[16:19], s68 offen lds
  v_mfma_f32_16x16x32_bf16 v[60:63], v[128:131], v[112:115], v[60:63]
  ds_read_b64_tr_b16 a[156:157], v8 offset:61440
  s_add_u32 m0, s70, 32768
  s_add_u32 s69, s62, 0
  v_mfma_f32_16x16x32_bf16 v[60:63], a[244:247], v[108:111], v[60:63]
  ds_read_b128 v[100:103], v1 offset:1024
  ds_read_b64_tr_b16 a[158:159], v8 offset:63488
  ds_read_b64_tr_b16 a[160:161], v4 offset:16384
  v_mfma_f32_16x16x32_bf16 v[68:71], a[248:251], v[108:111], v[68:71]
  ds_read_b64_tr_b16 a[162:163], v4 offset:18432
  buffer_load_dwordx4 v9, s[8:11], s69 offen offset:0 sc1 lds
  v_mfma_f32_16x16x32_bf16 v[68:71], v[132:135], v[112:115], v[68:71]
  ds_read_b64_tr_b16 a[164:165], v5 offset:16384
  v_mfma_f32_16x16x32_bf16 v[72:75], v[132:135], v[80:83], v[72:75]
  ds_read_b128 v[108:111], v1 offset:8192
  ds_read_b64_tr_b16 a[166:167], v5 offset:18432
  ds_read_b64_tr_b16 a[168:169], v4 offset:20480
  s_lshl_b32 s57, s44, 28
  buffer_load_dwordx4 v[116:119], v21, s[8:11], s57 offen sc1
  v_mfma_f32_16x16x32_bf16 v[72:75], a[248:251], v[76:79], v[72:75]
  s_waitcnt lgkmcnt(15)
  ds_read_b64_tr_b16 a[170:171], v4 offset:22528
  v_mfma_f32_16x16x32_bf16 v[52:55], v[136:139], v[88:91], v[52:55]
  ds_read_b64_tr_b16 a[172:173], v5 offset:20480
  buffer_load_dwordx4 v9, s[8:11], s69 offen offset:1024 sc1 lds
  v_mfma_f32_16x16x32_bf16 v[52:55], v[148:151], v[84:87], v[52:55]
  ds_read_b128 v[112:115], v1 offset:9216
  ds_read_b64_tr_b16 a[174:175], v5 offset:22528
  ds_read_b64_tr_b16 a[176:177], v4 offset:24576
  v_mfma_f32_16x16x32_bf16 v[56:59], v[148:151], v[96:99], v[56:59]
  ds_read_b64_tr_b16 a[178:179], v4 offset:26624
  buffer_load_dwordx4 v9, s[8:11], s69 offen offset:2048 sc1 lds
  v_mfma_f32_16x16x32_bf16 v[56:59], v[136:139], v[92:95], v[56:59]
  ds_read_b64_tr_b16 a[180:181], v5 offset:24576
  v_mfma_f32_16x16x32_bf16 v[64:67], v[140:143], v[92:95], v[64:67]
  ds_read_b128 v[80:83], v1 offset:2048
  ds_read_b64_tr_b16 a[182:183], v5 offset:26624
  ds_read_b64_tr_b16 a[184:185], v4 offset:28672
  v_mfma_f32_16x16x32_bf16 v[64:67], v[152:155], v[96:99], v[64:67]
  ds_read_b64_tr_b16 a[186:187], v4 offset:30720
  buffer_load_dwordx4 v9, s[8:11], s69 offen offset:3072 sc1 lds
  v_mfma_f32_16x16x32_bf16 v[60:63], v[152:155], v[84:87], v[60:63]
  ds_read_b64_tr_b16 a[188:189], v5 offset:28672
  s_add_u32 m0, s70, 49152
  s_add_u32 s69, s63, 0
  v_mfma_f32_16x16x32_bf16 v[60:63], v[140:143], v[88:91], v[60:63]
  ds_read_b128 v[76:79], v1 offset:3072
  ds_read_b64_tr_b16 a[190:191], v5 offset:30720
  v_mfma_f32_16x16x32_bf16 v[68:71], v[144:147], v[88:91], v[68:71]
  buffer_load_dwordx4 v9, s[8:11], s69 offen offset:0 sc1 lds
  v_mfma_f32_16x16x32_bf16 v[68:71], v[156:159], v[84:87], v[68:71]
  v_mfma_f32_16x16x32_bf16 v[72:75], v[156:159], v[96:99], v[72:75]
  ds_read_b128 v[88:91], v1 offset:10240
  v_mfma_f32_16x16x32_bf16 v[72:75], v[144:147], v[92:95], v[72:75]
  s_waitcnt lgkmcnt(12)
  buffer_load_dwordx4 v9, s[8:11], s69 offen offset:1024 sc1 lds
  v_mfma_f32_16x16x32_bf16 v[52:55], v[160:163], v[104:107], v[52:55]
  s_waitcnt vmcnt(7) lgkmcnt(15)
  s_barrier
  v_mfma_f32_16x16x32_bf16 v[52:55], v[172:175], v[100:103], v[52:55]
  ds_read_b128 v[84:87], v1 offset:11264
  ds_read_b64_tr_b16 a[192:193], v7 offset:16384
  v_mfma_f32_16x16x32_bf16 v[56:59], v[172:175], v[112:115], v[56:59]
  ds_read_b64_tr_b16 a[194:195], v7 offset:18432
  buffer_load_dwordx4 v9, s[8:11], s69 offen offset:2048 sc1 lds
  v_mfma_f32_16x16x32_bf16 v[56:59], v[160:163], v[108:111], v[56:59]
  ds_read_b64_tr_b16 a[196:197], v8 offset:16384
  v_mfma_f32_16x16x32_bf16 v[64:67], v[164:167], v[108:111], v[64:67]
  ds_read_b128 v[96:99], v1 offset:4096
  ds_read_b64_tr_b16 a[198:199], v8 offset:18432
  ds_read_b64_tr_b16 a[200:201], v7 offset:20480
  v_mfma_f32_16x16x32_bf16 v[64:67], v[176:179], v[112:115], v[64:67]
  ds_read_b64_tr_b16 a[202:203], v7 offset:22528
  buffer_load_dwordx4 v9, s[8:11], s69 offen offset:3072 sc1 lds
  v_mfma_f32_16x16x32_bf16 v[60:63], v[176:179], v[100:103], v[60:63]
  ds_read_b64_tr_b16 a[204:205], v8 offset:20480
  s_add_u32 m0, s70, 98304
  s_add_u32 s69, s64, 0
  v_mfma_f32_16x16x32_bf16 v[60:63], v[164:167], v[104:107], v[60:63]
  ds_read_b128 v[92:95], v1 offset:5120
  ds_read_b64_tr_b16 a[206:207], v8 offset:22528
  ds_read_b64_tr_b16 a[208:209], v7 offset:24576
  v_mfma_f32_16x16x32_bf16 v[68:71], v[168:171], v[104:107], v[68:71]
  ds_read_b64_tr_b16 a[210:211], v7 offset:26624
  buffer_load_dwordx4 v9, s[8:11], s69 offen offset:0 sc1 lds
  v_mfma_f32_16x16x32_bf16 v[68:71], v[180:183], v[100:103], v[68:71]
  ds_read_b64_tr_b16 a[212:213], v8 offset:24576
  v_mfma_f32_16x16x32_bf16 v[72:75], v[180:183], v[112:115], v[72:75]
  ds_read_b128 v[104:107], v1 offset:12288
  ds_read_b64_tr_b16 a[214:215], v8 offset:26624
  ds_read_b64_tr_b16 a[216:217], v7 offset:28672
  v_mfma_f32_16x16x32_bf16 v[72:75], v[168:171], v[108:111], v[72:75]
  s_waitcnt lgkmcnt(15)
  ds_read_b64_tr_b16 a[218:219], v7 offset:30720
  v_mfma_f32_16x16x32_bf16 v[52:55], v[184:187], v[80:83], v[52:55]
  ds_read_b64_tr_b16 a[220:221], v8 offset:28672
  buffer_load_dwordx4 v9, s[8:11], s69 offen offset:1024 sc1 lds
  v_mfma_f32_16x16x32_bf16 v[52:55], v[196:199], v[76:79], v[52:55]
  ds_read_b128 v[100:103], v1 offset:13312
  ds_read_b64_tr_b16 a[222:223], v8 offset:30720
  ds_read_b64_tr_b16 a[224:225], v7 offset:0
  v_mfma_f32_16x16x32_bf16 v[56:59], v[196:199], v[84:87], v[56:59]
  ds_read_b64_tr_b16 a[226:227], v7 offset:2048
  buffer_load_dwordx4 v9, s[8:11], s69 offen offset:2048 sc1 lds
  v_mfma_f32_16x16x32_bf16 v[56:59], v[184:187], v[88:91], v[56:59]
  ds_read_b64_tr_b16 a[228:229], v8 offset:0
  v_mfma_f32_16x16x32_bf16 v[64:67], v[188:191], v[88:91], v[64:67]
  ds_read_b128 v[112:115], v1 offset:6144
  ds_read_b64_tr_b16 a[230:231], v8 offset:2048
  ds_read_b64_tr_b16 a[232:233], v7 offset:4096
  v_mfma_f32_16x16x32_bf16 v[64:67], v[200:203], v[84:87], v[64:67]
  ds_read_b64_tr_b16 a[234:235], v7 offset:6144
  buffer_load_dwordx4 v9, s[8:11], s69 offen offset:3072 sc1 lds
  v_mfma_f32_16x16x32_bf16 v[60:63], v[200:203], v[76:79], v[60:63]
  ds_read_b64_tr_b16 a[236:237], v8 offset:4096
  s_add_u32 m0, s70, 114688
  s_add_u32 s69, s65, 0
  v_mfma_f32_16x16x32_bf16 v[60:63], v[188:191], v[80:83], v[60:63]
  ds_read_b128 v[108:111], v1 offset:7168
  ds_read_b64_tr_b16 a[238:239], v8 offset:6144
  ds_read_b64_tr_b16 a[240:241], v7 offset:8192
  v_mfma_f32_16x16x32_bf16 v[68:71], v[192:195], v[80:83], v[68:71]
  ds_read_b64_tr_b16 a[242:243], v7 offset:10240
  buffer_load_dwordx4 v9, s[8:11], s69 offen offset:0 sc1 lds
  v_mfma_f32_16x16x32_bf16 v[68:71], v[204:207], v[76:79], v[68:71]
  ds_read_b64_tr_b16 a[244:245], v8 offset:8192
  v_mfma_f32_16x16x32_bf16 v[72:75], v[204:207], v[84:87], v[72:75]
  ds_read_b128 v[80:83], v1 offset:14336
  ds_read_b64_tr_b16 a[246:247], v8 offset:10240
  ds_read_b64_tr_b16 a[248:249], v7 offset:12288
  v_mfma_f32_16x16x32_bf16 v[72:75], v[192:195], v[88:91], v[72:75]
  s_waitcnt lgkmcnt(15)
  ds_read_b64_tr_b16 a[250:251], v7 offset:14336
  v_mfma_f32_16x16x32_bf16 v[52:55], v[208:211], v[96:99], v[52:55]
  ds_read_b64_tr_b16 v[124:125], v8 offset:12288
  buffer_load_dwordx4 v9, s[8:11], s69 offen offset:1024 sc1 lds
  v_mfma_f32_16x16x32_bf16 v[52:55], v[220:223], v[92:95], v[52:55]
  ds_read_b128 v[76:79], v1 offset:15360
  ds_read_b64_tr_b16 v[126:127], v8 offset:14336
  v_mfma_f32_16x16x32_bf16 v[56:59], v[220:223], v[100:103], v[56:59]
  buffer_load_dwordx4 v9, s[8:11], s69 offen offset:2048 sc1 lds
  v_mfma_f32_16x16x32_bf16 v[56:59], v[208:211], v[104:107], v[56:59]
  v_mfma_f32_16x16x32_bf16 v[64:67], v[212:215], v[104:107], v[64:67]
  v_mfma_f32_16x16x32_bf16 v[64:67], v[224:227], v[100:103], v[64:67]
  buffer_load_dwordx4 v9, s[8:11], s69 offen offset:3072 sc1 lds
  v_mfma_f32_16x16x32_bf16 v[60:63], v[224:227], v[92:95], v[60:63]
  v_mfma_f32_16x16x32_bf16 v[60:63], v[212:215], v[96:99], v[60:63]
  s_waitcnt vmcnt(15)
  s_cmp_lg_u32 s44, 0
  s_cbranch_scc1 PL6_adaLN_cond__sliding_local_dilated__swiglu_ffn__prompt_kernelx
  v_bitop3_b32 v116, v116, v117, s46 bitop3:0x7e
  v_bitop3_b32 v118, v118, v119, s46 bitop3:0x7e
  v_or_b32 v116, v116, v118
  v_cmp_ne_u32 vcc, 0, v116
  s_nop 4
  s_cbranch_vccz PL6_adaLN_cond__sliding_local_dilated__swiglu_ffn__prompt_kernelx
  s_mov_b32 s57, 60000
PL6_adaLN_cond__sliding_local_dilated__swiglu_ffn__prompt_kernel:
  buffer_load_dwordx4 v[116:119], v21, s[8:11], 0 offen sc1
  s_sub_u32 s57, s57, 1
  s_cmp_eq_u32 s57, 0
  s_waitcnt vmcnt(0)
  s_cbranch_scc1 PL6_adaLN_cond__sliding_local_dilated__swiglu_ffn__prompt_kernelx
  v_bitop3_b32 v116, v116, v117, s46 bitop3:0x7e
  v_bitop3_b32 v118, v118, v119, s46 bitop3:0x7e
  v_or_b32 v116, v116, v118
  v_cmp_ne_u32 vcc, 0, v116
  s_nop 4
  s_cbranch_vccnz PL6_adaLN_cond__sliding_local_dilated__swiglu_ffn__prompt_kernel
PL6_adaLN_cond__sliding_local_dilated__swiglu_ffn__prompt_kernelx:
  s_waitcnt vmcnt(8) lgkmcnt(0)
  s_barrier
  v_mfma_f32_16x16x32_bf16 v[68:71], v[216:219], v[96:99], v[68:71]
  ds_read_b128 v[84:87], v22 offset:32768
  s_add_u32 m0, s70, 16384
  s_add_u32 s69, s62, 65536
  v_mfma_f32_16x16x32_bf16 v[68:71], v[228:231], v[92:95], v[68:71]
  v_and_b32 v21, 31, v0
  v_lshlrev_b32 v21, 2, v21
  v_lshrrev_b32 v181, 5, v0
  v_lshl_add_u32 v21, v181, 13, v21
  v_mfma_f32_16x16x32_bf16 v[72:75], v[228:231], v[100:103], v[72:75]
  ds_read_b128 v[88:91], v22 offset:33792
  buffer_load_dwordx4 v9, s[8:11], s69 offen offset:0 sc1 lds
  v_mfma_f32_16x16x32_bf16 v[72:75], v[216:219], v[104:107], v[72:75]
  s_waitcnt lgkmcnt(3)
  v_mfma_f32_16x16x32_bf16 v[52:55], v[232:235], v[112:115], v[52:55]
  ds_read_b128 v[96:99], v22 offset:34816
  v_mfma_f32_16x16x32_bf16 v[52:55], v[244:247], v[108:111], v[52:55]
  buffer_load_dwordx4 v9, s[8:11], s69 offen offset:1024 sc1 lds
  v_mfma_f32_16x16x32_bf16 v[56:59], v[244:247], v[76:79], v[56:59]
  ds_read_b128 v[92:95], v22 offset:35840
  v_mfma_f32_16x16x32_bf16 v[56:59], v[232:235], v[80:83], v[56:59]
  buffer_load_dwordx4 v9, s[8:11], s69 offen offset:2048 sc1 lds
  v_mfma_f32_16x16x32_bf16 v[64:67], v[236:239], v[80:83], v[64:67]
  ds_read_b128 v[100:103], v22 offset:36864
  v_mfma_f32_16x16x32_bf16 v[64:67], v[248:251], v[76:79], v[64:67]
  v_mfma_f32_16x16x32_bf16 v[60:63], v[248:251], v[108:111], v[60:63]
  ds_read_b128 v[104:107], v22 offset:37888
  v_mfma_f32_16x16x32_bf16 v[60:63], v[236:239], v[112:115], v[60:63]
  buffer_load_dwordx4 v9, s[8:11], s69 offen offset:3072 sc1 lds
  s_add_u32 s56, s76, 8192
  v_mfma_f32_16x16x32_bf16 v[68:71], v[240:243], v[112:115], v[68:71]
  ds_read_b128 v[112:115], v22 offset:38912
  v_mfma_f32_16x16x32_bf16 v[68:71], v[252:255], v[108:111], v[68:71]
  buffer_load_dword v160, v21, s[8:11], s56 offen sc1
  s_add_u32 s56, s76, 32768
  v_mfma_f32_16x16x32_bf16 v[72:75], v[252:255], v[76:79], v[72:75]
  ds_read_b128 v[108:111], v22 offset:39936
  v_mfma_f32_16x16x32_bf16 v[72:75], v[240:243], v[80:83], v[72:75]
  s_waitcnt lgkmcnt(4)
  buffer_load_dword v161, v21, s[8:11], s56 offen sc1
  s_add_u32 s56, s76, 57344
  v_mfma_f32_16x16x32_bf16 v[128:131], a[0:3], v[84:87], 0
  ds_read_b128 v[76:79], v22 offset:49152
  buffer_load_dword v162, v21, s[8:11], s56 offen sc1
  v_mfma_f32_16x16x32_bf16 v[128:131], a[8:11], v[88:91], v[128:131]
  s_add_u32 s56, s76, 81920
  v_mfma_f32_16x16x32_bf16 v[132:135], a[12:15], v[88:91], 0
  ds_read_b128 v[80:83], v22 offset:50176
  s_lshr_b32 s79, s2, 6
  s_lshl_b32 s79, s79, 2
  s_add_u32 s79, s79, s44
  s_lshl_b32 s79, s79, 8
  buffer_load_dword v163, v21, s[8:11], s56 offen sc1
  s_add_u32 s56, s47, 41943040
  v_mfma_f32_16x16x32_bf16 v[132:135], a[4:7], v[84:87], v[132:135]
  buffer_load_dwordx4 v[144:147], v1, s[8:11], s56 offen sc1
  s_add_u32 s56, s47, 42008576
  v_cvt_pk_bf16_f32 v52, v52, v53
  v_cvt_pk_bf16_f32 v53, v54, v55
  ds_write_b64 v18, v[52:53] offset:6144
  v_cvt_pk_bf16_f32 v60, v60, v61
  v_cvt_pk_bf16_f32 v61, v62, v63
  v_mfma_f32_16x16x32_bf16 v[128:131], a[16:19], v[96:99], v[128:131]
  ds_read_b128 v[88:91], v22 offset:51200
  v_cvt_pk_bf16_f32 v62, v68, v69
  v_cvt_pk_bf16_f32 v63, v70, v71
  ds_write_b128 v17, v[60:63] offset:7168
  v_mfma_f32_16x16x32_bf16 v[128:131], a[24:27], v[92:95], v[128:131]
  buffer_load_dwordx4 v[148:151], v1, s[8:11], s56 offen sc1
  s_add_u32 s56, s47, 42074112
  v_cvt_pk_bf16_f32 v56, v56, v57
  v_cvt_pk_bf16_f32 v57, v58, v59
  ds_write_b64 v18, v[56:57] offset:12288
  v_cvt_pk_bf16_f32 v64, v64, v65
  v_cvt_pk_bf16_f32 v65, v66, v67
  v_mfma_f32_16x16x32_bf16 v[132:135], a[28:31], v[92:95], v[132:135]
  ds_read_b128 v[84:87], v22 offset:52224
  v_cvt_pk_bf16_f32 v66, v72, v73
  v_cvt_pk_bf16_f32 v67, v74, v75
  ds_write_b128 v17, v[64:67] offset:13312
  v_mfma_f32_16x16x32_bf16 v[132:135], a[20:23], v[96:99], v[132:135]
  s_waitcnt lgkmcnt(8)
  buffer_load_dwordx4 v[152:155], v1, s[8:11], s56 offen sc1
  s_add_u32 s56, s47, 42139648
  s_bitcmp1_b32 s44, 0
  s_mov_b32 s52, 6144
  s_cselect_b32 s52, 12288, s52
  s_mov_b32 s53, 0
  s_cselect_b32 s53, 6144, s53
  v_add_u32 v116, s52, v19
  v_add_u32 v117, s53, v19
  v_mfma_f32_16x16x32_bf16 v[128:131], a[32:35], v[100:103], v[128:131]
  ds_read_b128 v[92:95], v22 offset:53248
  v_add_u32 v118, s52, v20
  v_add_u32 v119, s53, v20
  s_waitcnt vmcnt(11) lgkmcnt(1)
  s_barrier
  v_mfma_f32_16x16x32_bf16 v[128:131], a[40:43], v[104:107], v[128:131]
  buffer_load_dwordx4 v[156:159], v1, s[8:11], s56 offen sc1
  s_add_u32 m0, s70, 81920
  s_add_u32 s69, s63, 65536
  ds_read_b128 v[52:55], v116
  ds_read_b128 v[56:59], v117 offset:1024
  v_mfma_f32_16x16x32_bf16 v[132:135], a[44:47], v[104:107], v[132:135]
  ds_read_b128 v[96:99], v22 offset:54272
  ds_read_b128 v[60:63], v116 offset:1024
  ds_read_b64_tr_b16 v[64:65], v119 offset:2048
  ds_read_b64_tr_b16 v[66:67], v118 offset:2048
  v_mfma_f32_16x16x32_bf16 v[132:135], a[36:39], v[100:103], v[132:135]
  buffer_load_dwordx4 v9, s[8:11], s69 offen offset:0 sc1 lds
  ds_read_b64_tr_b16 v[68:69], v119 offset:2056
  ds_read_b64_tr_b16 v[70:71], v118 offset:2056
  v_mfma_f32_16x16x32_bf16 v[128:131], a[48:51], v[112:115], v[128:131]
  ds_read_b128 v[104:107], v22 offset:55296
HOP5:
  s_cbranch_execz HOP9
  s_lshl_b32 s57, s44, 28
  s_add_u32 s57, s57, s77
  buffer_load_dword v13, v14, s[8:11], s57 offen sc1
  v_mfma_f32_16x16x32_bf16 v[128:131], a[56:59], v[108:111], v[128:131]
  v_mfma_f32_16x16x32_bf16 v[132:135], a[60:63], v[108:111], v[132:135]
  ds_read_b128 v[100:103], v22 offset:56320
  v_mfma_f32_16x16x32_bf16 v[132:135], a[52:55], v[112:115], v[132:135]
  s_waitcnt lgkmcnt(12)
  buffer_load_dwordx4 v9, s[8:11], s69 offen offset:1024 sc1 lds
  v_mfma_f32_16x16x32_bf16 v[128:131], a[64:67], v[76:79], v[128:131]
  ds_read_b128 v[108:111], v23 offset:32768
  s_waitcnt lgkmcnt(3)
  v_mfma_f32_16x16x32_bf16 v[116:119], v[56:59], v[52:55], 0
  v_mfma_f32_16x16x32_bf16 v[120:123], v[60:63], v[52:55], 0
  v_mfma_f32_16x16x32_bf16 v[128:131], a[72:75], v[80:83], v[128:131]
  buffer_load_dwordx4 v9, s[8:11], s69 offen offset:2048 sc1 lds
  v_mfma_f32_16x16x32_bf16 v[132:135], a[76:79], v[80:83], v[132:135]
  ds_read_b128 v[112:115], v23 offset:33792
  v_mfma_f32_16x16x32_bf16 v[132:135], a[68:71], v[76:79], v[132:135]
  v_mfma_f32_16x16x32_bf16 v[128:131], a[80:83], v[88:91], v[128:131]
  ds_read_b128 v[80:83], v23 offset:34816
  s_nop 0
  v_cndmask_b32 v72, v116, v120, s[80:81]
  v_cndmask_b32 v73, v117, v121, s[82:83]
  v_cndmask_b32 v74, v118, v122, s[84:85]
  v_cndmask_b32 v75, v119, v123, s[86:87]
  v_cndmask_b32 v72, v72, v73, s[88:89]
  v_cndmask_b32 v73, v74, v75, s[88:89]
  v_mfma_f32_16x16x32_bf16 v[128:131], a[88:91], v[84:87], v[128:131]
  buffer_load_dwordx4 v9, s[8:11], s69 offen offset:3072 sc1 lds
  s_add_u32 m0, s70, 65536
  s_add_u32 s69, s64, 65536
  v_mul_f32 v72, 0x3e8293ee, v72
  v_mul_f32 v73, 0x3e8293ee, v73
  v_max_f32 v74, v72, v73
  v_mov_b32 v75, v74
  v_mfma_f32_16x16x32_bf16 v[132:135], a[92:95], v[84:87], v[132:135]
  ds_read_b128 v[76:79], v23 offset:35840
  v_permlane16_swap_b32 v74, v75
  v_max_f32 v74, v74, v75
  v_mov_b32 v75, v74
  v_mfma_f32_16x16x32_bf16 v[132:135], a[84:87], v[88:91], v[132:135]
  s_waitcnt lgkmcnt(4)
  buffer_load_dwordx4 v9, s[8:11], s69 offen offset:0 sc1 lds
  v_permlane32_swap_b32 v74, v75
  v_max_f32 v74, v74, v75
  v_sub_f32 v72, v72, v74
  v_sub_f32 v73, v73, v74
  v_mfma_f32_16x16x32_bf16 v[128:131], a[96:99], v[92:95], v[128:131]
  ds_read_b128 v[84:87], v23 offset:36864
  v_exp_f32 v72, v72
  v_exp_f32 v73, v73
  v_mfma_f32_16x16x32_bf16 v[128:131], a[104:107], v[96:99], v[128:131]
  v_add_f32 v74, v72, v73
  v_mov_b32 v75, v74
  v_mfma_f32_16x16x32_bf16 v[132:135], a[108:111], v[96:99], v[132:135]
  ds_read_b128 v[88:91], v23 offset:37888
  v_permlane16_swap_b32 v74, v75
  v_add_f32 v74, v74, v75
  v_mov_b32 v75, v74
  v_mfma_f32_16x16x32_bf16 v[132:135], a[100:103], v[92:95], v[132:135]
  buffer_load_dwordx4 v9, s[8:11], s69 offen offset:1024 sc1 lds
  v_permlane32_swap_b32 v74, v75
  v_add_f32 v74, v74, v75
  v_rcp_f32 v74, v74
  v_mfma_f32_16x16x32_bf16 v[128:131], a[112:115], v[104:107], v[128:131]
  ds_read_b128 v[96:99], v23 offset:38912
  v_mul_f32 v72, v72, v74
  v_mul_f32 v73, v73, v74
  v_cvt_pk_bf16_f32 v72, v72, v72
  v_cvt_pk_bf16_f32 v73, v73, v73
  v_and_b32 v52, v24, v72
  v_and_b32 v53, v25, v73
  v_mfma_f32_16x16x32_bf16 v[128:131], a[120:123], v[100:103], v[128:131]
  buffer_load_dwordx4 v9, s[8:11], s69 offen offset:2048 sc1 lds
  v_and_b32 v54, v26, v72
  v_and_b32 v55, v27, v73
  v_mfma_f32_16x16x32_bf16 v[132:135], a[124:127], v[100:103], v[132:135]
  ds_read_b128 v[92:95], v23 offset:39936
  v_mfma_f32_16x16x32_bf16 v[56:59], v[64:67], v[52:55], 0
  v_mfma_f32_16x16x32_bf16 v[60:63], v[68:71], v[52:55], 0
  v_mfma_f32_16x16x32_bf16 v[132:135], a[116:119], v[104:107], v[132:135]
  s_waitcnt lgkmcnt(4)
  v_mfma_f32_16x16x32_bf16 v[128:131], a[128:131], v[108:111], v[128:131]
  ds_read_b128 v[100:103], v23 offset:49152
  v_mfma_f32_16x16x32_bf16 v[128:131], a[136:139], v[112:115], v[128:131]
  buffer_load_dwordx4 v9, s[8:11], s69 offen offset:3072 sc1 lds
  s_add_u32 m0, s70, 0
  s_add_u32 s69, s65, 65536
  v_mfma_f32_16x16x32_bf16 v[132:135], a[140:143], v[112:115], v[132:135]
  ds_read_b128 v[104:107], v23 offset:50176
  v_cvt_pk_bf16_f32 v116, v56, v57
  v_cvt_pk_bf16_f32 v117, v58, v59
  v_cvt_pk_bf16_f32 v118, v60, v61
  v_cvt_pk_bf16_f32 v119, v62, v63
  v_mfma_f32_16x16x32_bf16 v[132:135], a[132:135], v[108:111], v[132:135]
  buffer_load_dwordx4 v9, s[8:11], s69 offen offset:0 sc1 lds
  buffer_store_dwordx4 v[116:119], v1, s[8:11], s73 offen sc1
  s_add_u32 s73, s73, 65536
  v_mfma_f32_16x16x32_bf16 v[128:131], a[144:147], v[80:83], v[128:131]
  ds_read_b128 v[112:115], v23 offset:51200
  v_mfma_f32_16x16x32_bf16 v[128:131], a[152:155], v[76:79], v[128:131]
  v_mfma_f32_16x16x32_bf16 v[132:135], a[156:159], v[76:79], v[132:135]
  ds_read_b128 v[108:111], v23 offset:52224
  v_mfma_f32_16x16x32_bf16 v[132:135], a[148:151], v[80:83], v[132:135]
  s_waitcnt lgkmcnt(4)
  buffer_load_dwordx4 v9, s[8:11], s69 offen offset:1024 sc1 lds
  v_mfma_f32_16x16x32_bf16 v[128:131], a[160:163], v[84:87], v[128:131]
  ds_read_b128 v[76:79], v23 offset:53248
  s_waitcnt vmcnt(16)
  v_add_f32 v160, v160, v161
  v_mfma_f32_16x16x32_bf16 v[128:131], a[168:171], v[88:91], v[128:131]
  buffer_load_dwordx4 v9, s[8:11], s69 offen offset:2048 sc1 lds
  v_add_f32 v162, v162, v163
  v_add_f32 v160, v160, v162
  v_cvt_pk_bf16_f32 v160, v160, v160
  v_mfma_f32_16x16x32_bf16 v[132:135], a[172:175], v[88:91], v[132:135]
  ds_read_b128 v[80:83], v23 offset:54272
  v_lshlrev_b32 v160, 16, v160
  v_cvt_f32_u32 v181, v181
  v_mfma_f32_16x16x32_bf16 v[132:135], a[164:167], v[84:87], v[132:135]
  v_add_f32 v160, v160, v181
  v_cvt_pk_bf16_f32 v160, v160, v160
  v_lshlrev_b32 v160, 16, v160
  v_mfma_f32_16x16x32_bf16 v[128:131], a[176:179], v[96:99], v[128:131]
  ds_read_b128 v[88:91], v23 offset:55296
  s_lshl_b32 s54, s44, 8
  s_add_u32 s54, s54, 161792
  v_mfma_f32_16x16x32_bf16 v[128:131], a[184:187], v[92:95], v[128:131]
  buffer_load_dwordx4 v9, s[8:11], s69 offen offset:3072 sc1 lds
  v_lshl_add_u32 v180, v0, 2, s54
  v_lshrrev_b32 v161, 4, v0
  v_lshl_add_u32 v181, v161, 4, s54
  v_mfma_f32_16x16x32_bf16 v[132:135], a[188:191], v[92:95], v[132:135]
  ds_read_b128 v[84:87], v23 offset:56320
  ds_write_b32 v180, v160
  v_mfma_f32_16x16x32_bf16 v[132:135], a[180:183], v[96:99], v[132:135]
  s_waitcnt lgkmcnt(5)
  s_waitcnt vmcnt(12)
  s_cmp_lg_u32 s44, 0
  s_cbranch_scc1 PL7_adaLN_cond__sliding_local_dilated__swiglu_ffn__prompt_kernelx
  v_subrev_u32 v13, s46, v13
  v_subrev_u32 v13, 2, v13
  v_cmp_lt_u32 vcc, 3, v13
  s_nop 4
  s_cbranch_vccz PL7_adaLN_cond__sliding_local_dilated__swiglu_ffn__prompt_kernelx
  s_mov_b32 s57, 60000
PL7_adaLN_cond__sliding_local_dilated__swiglu_ffn__prompt_kernel:
  buffer_load_dword v13, v14, s[8:11], s77 offen sc1
  s_sub_u32 s57, s57, 1
  s_cmp_eq_u32 s57, 0
  s_waitcnt vmcnt(0)
  s_cbranch_scc1 PL7_adaLN_cond__sliding_local_dilated__swiglu_ffn__prompt_kernelx
  v_subrev_u32 v13, s46, v13
  v_subrev_u32 v13, 2, v13
  v_cmp_lt_u32 vcc, 3, v13
  s_nop 4
  s_cbranch_vccnz PL7_adaLN_cond__sliding_local_dilated__swiglu_ffn__prompt_kernel
PL7_adaLN_cond__sliding_local_dilated__swiglu_ffn__prompt_kernelx:
  s_waitcnt vmcnt(9)
  s_barrier
  v_mfma_f32_16x16x32_bf16 v[128:131], a[192:195], v[100:103], v[128:131]
  ds_read_b128 v[92:95], v22 offset:16384
  s_add_u32 m0, s70, 32768
  s_add_u32 s69, s62, 131072
  v_mfma_f32_16x16x32_bf16 v[128:131], a[200:203], v[104:107], v[128:131]
  buffer_load_dwordx4 v9, s[8:11], s69 offen offset:0 sc1 lds
  v_bfe_u32 v180, v0, 2, 2
  v_xor_b32 v180, v180, v161
  v_lshlrev_b32 v180, 27, v180
  v_mfma_f32_16x16x32_bf16 v[132:135], a[204:207], v[104:107], v[132:135]
  ds_read_b128 v[96:99], v22 offset:17408
  v_and_b32 v162, 15, v0
  v_lshl_add_u32 v180, v162, 4, v180
  v_mfma_f32_16x16x32_bf16 v[132:135], a[196:199], v[100:103], v[132:135]
  s_and_b32 s54, s44, 1
  s_lshl_b32 s54, s54, 11
  v_add_u32 v182, s54, v1
  s_and_b32 s54, s44, 2
  v_mfma_f32_16x16x32_bf16 v[128:131], a[208:211], v[112:115], v[128:131]
  ds_read_b128 v[104:107], v22 offset:18432
  s_lshl_b32 s54, s54, 9
  s_add_u32 s54, s54, 135168
  v_mfma_f32_16x16x32_bf16 v[128:131], a[216:219], v[108:111], v[128:131]
  buffer_load_dwordx4 v9, s[8:11], s69 offen offset:1024 sc1 lds
  v_add_u32 v182, s54, v182
  ds_read_b128 v[160:163], v181 offset:0
  v_mfma_f32_16x16x32_bf16 v[132:135], a[220:223], v[108:111], v[132:135]
  ds_read_b128 v[100:103], v22 offset:19456
  ds_read_b128 v[164:167], v181 offset:64
  v_mfma_f32_16x16x32_bf16 v[132:135], a[212:215], v[112:115], v[132:135]
  s_waitcnt lgkmcnt(7)
  buffer_load_dwordx4 v9, s[8:11], s69 offen offset:2048 sc1 lds
  ds_read_b128 v[168:171], v181 offset:128
  v_mfma_f32_16x16x32_bf16 v[128:131], a[224:227], v[76:79], v[128:131]
  ds_read_b128 v[108:111], v22 offset:20480
  ds_read_b128 v[172:175], v181 offset:192
  v_mfma_f32_16x16x32_bf16 v[128:131], a[232:235], v[80:83], v[128:131]
  v_mov_b32 v176, 0x3f803f80
  v_mov_b32 v177, 0x3f803f80
  v_mov_b32 v178, 0x3f803f80
  v_mfma_f32_16x16x32_bf16 v[132:135], a[236:239], v[80:83], v[132:135]
  ds_read_b128 v[112:115], v22 offset:21504
  v_mov_b32 v179, 0x3f803f80
  s_mov_b32 s90, 0xcccccccc
  v_mfma_f32_16x16x32_bf16 v[132:135], a[228:231], v[76:79], v[132:135]
  buffer_load_dwordx4 v9, s[8:11], s69 offen offset:3072 sc1 lds
  s_add_u32 m0, s70, 49152
  s_add_u32 s69, s63, 131072
  s_mov_b32 s91, 0xcccccccc
  v_mfma_f32_16x16x32_bf16 v[128:131], a[240:243], v[88:91], v[128:131]
  ds_read_b128 v[80:83], v22 offset:22528
  v_lshrrev_b32 v220, 5, v0
  v_xor_b32 v220, 1, v220
  v_lshlrev_b32 v220, 12, v220
  v_mfma_f32_16x16x32_bf16 v[128:131], a[248:251], v[84:87], v[128:131]
  buffer_load_dwordx4 v9, s[8:11], s69 offen offset:0 sc1 lds
  s_waitcnt vmcnt(22) lgkmcnt(2)
  v_lshlrev_b32 v184, 16, v144
  v_and_b32 v185, 0xffff0000, v144
  v_mfma_f32_16x16x32_bf16 v[132:135], v[124:127], v[84:87], v[132:135]
  ds_read_b128 v[76:79], v22 offset:23552
  v_and_b32 v221, 31, v0
  v_lshl_add_u32 v220, v221, 3, v220
  v_mfma_f32_16x16x32_bf16 v[132:135], a[244:247], v[88:91], v[132:135]
  s_waitcnt lgkmcnt(7)
  v_add_u32 v15, s46, v0
  v_add_u32 v15, 3, v15
  s_waitcnt vmcnt(8)
  s_barrier
  s_mov_b64 exec, 1
  buffer_store_dword v15, v0, s[8:11], s74 offen offset:0 sc1
  s_mov_b64 exec, -1
  v_mfma_f32_16x16x32_bf16 v[136:139], a[0:3], v[92:95], 0
  ds_read_b128 v[84:87], v23 offset:16384
  v_lshlrev_b32 v186, 16, v145
  v_and_b32 v187, 0xffff0000, v145
  v_mfma_f32_16x16x32_bf16 v[136:139], a[8:11], v[96:99], v[136:139]
  buffer_load_dwordx4 v9, s[8:11], s69 offen offset:1024 sc1 lds
  v_lshlrev_b32 v188, 16, v146
  v_and_b32 v189, 0xffff0000, v146
  v_lshlrev_b32 v190, 16, v147
  v_mfma_f32_16x16x32_bf16 v[140:143], a[12:15], v[96:99], 0
  ds_read_b128 v[88:91], v23 offset:17408
  v_and_b32 v191, 0xffff0000, v147
  v_fmac_f32 v184, v160, v128
  v_mfma_f32_16x16x32_bf16 v[140:143], a[4:7], v[92:95], v[140:143]
  buffer_load_dwordx4 v9, s[8:11], s69 offen offset:2048 sc1 lds
  v_fmac_f32 v185, v161, v129
  v_fmac_f32 v186, v162, v130
  v_fmac_f32 v187, v163, v131
  v_mfma_f32_16x16x32_bf16 v[136:139], a[16:19], v[104:107], v[136:139]
  ds_read_b128 v[96:99], v23 offset:18432
  v_fmac_f32 v188, v164, v132
  v_fmac_f32 v189, v165, v133
  v_mfma_f32_16x16x32_bf16 v[136:139], a[24:27], v[100:103], v[136:139]
  v_fmac_f32 v190, v166, v134
  v_fmac_f32 v191, v167, v135
  v_mul_f32 v128, v184, v168
  v_mfma_f32_16x16x32_bf16 v[140:143], a[28:31], v[100:103], v[140:143]
  ds_read_b128 v[92:95], v23 offset:19456
  v_mul_f32 v129, v185, v169
  v_mul_f32 v130, v186, v170
  v_mfma_f32_16x16x32_bf16 v[140:143], a[20:23], v[104:107], v[140:143]
  s_waitcnt lgkmcnt(4)
  buffer_load_dwordx4 v9, s[8:11], s69 offen offset:3072 sc1 lds
  v_mul_f32 v131, v187, v171
  v_mul_f32 v132, v188, v172
  v_mfma_f32_16x16x32_bf16 v[136:139], a[32:35], v[108:111], v[136:139]
  ds_read_b128 v[100:103], v23 offset:20480
  s_add_u32 m0, s70, 98304
  s_add_u32 s69, s64, 131072
  v_mfma_f32_16x16x32_bf16 v[136:139], a[40:43], v[112:115], v[136:139]
  buffer_load_dwordx4 v9, s[8:11], s69 offen offset:0 sc1 lds
  v_mul_f32 v133, v189, v173
  v_mul_f32 v134, v190, v174
  v_mul_f32 v135, v191, v175
  v_mfma_f32_16x16x32_bf16 v[140:143], a[44:47], v[112:115], v[140:143]
  ds_read_b128 v[104:107], v23 offset:21504
  v_cvt_pk_bf16_f32 v196, v128, v129
  v_cvt_pk_bf16_f32 v197, v130, v131
  v_mfma_f32_16x16x32_bf16 v[140:143], a[36:39], v[108:111], v[140:143]
  v_cvt_pk_bf16_f32 v198, v132, v133
  v_cvt_pk_bf16_f32 v199, v134, v135
  v_mfma_f32_16x16x32_bf16 v[136:139], a[48:51], v[80:83], v[136:139]
  ds_read_b128 v[112:115], v23 offset:22528
  v_mfma_f32_16x16x32_bf16 v[136:139], a[56:59], v[76:79], v[136:139]
  buffer_load_dwordx4 v9, s[8:11], s69 offen offset:1024 sc1 lds
  s_add_u32 s54, s47, 36700160
  buffer_store_dwordx4 v[196:199], v1, s[8:11], s54 offen sc1
  v_mfma_f32_16x16x32_bf16 v[140:143], a[60:63], v[76:79], v[140:143]
  ds_read_b128 v[108:111], v23 offset:23552
  v_cvt_pk_bf16_f32 v144, v184, v185
  v_cvt_pk_bf16_f32 v145, v186, v187
  v_mfma_f32_16x16x32_bf16 v[140:143], a[52:55], v[80:83], v[140:143]
  s_waitcnt lgkmcnt(4)
  v_cvt_pk_bf16_f32 v146, v188, v189
  s_waitcnt vmcnt(12)
  s_barrier
  v_mfma_f32_16x16x32_bf16 v[136:139], a[64:67], v[84:87], v[136:139]
  ds_read_b128 v[76:79], v23 offset:0
  buffer_load_dwordx4 v9, s[8:11], s69 offen offset:2048 sc1 lds
  v_cvt_pk_bf16_f32 v147, v190, v191
  v_mfma_f32_16x16x32_bf16 v[136:139], a[72:75], v[88:91], v[136:139]
  s_nop 0
  v_mfma_f32_16x16x32_bf16 v[224:227], v[176:179], v[144:147], 0
  v_mfma_f32_16x16x32_bf16 v[192:195], v[144:147], v[144:147], 0
  v_mfma_f32_16x16x32_bf16 v[140:143], a[76:79], v[88:91], v[140:143]
  ds_read_b128 v[80:83], v23 offset:1024
  v_mfma_f32_16x16x32_bf16 v[140:143], a[68:71], v[84:87], v[140:143]
  buffer_load_dwordx4 v9, s[8:11], s69 offen offset:3072 sc1 lds
  s_add_u32 m0, s70, 114688
  s_add_u32 s69, s65, 131072
  v_mfma_f32_16x16x32_bf16 v[136:139], a[80:83], v[96:99], v[136:139]
  ds_read_b128 v[88:91], v23 offset:2048
  v_cndmask_b32 v192, v192, v193, s[88:89]
  v_cndmask_b32 v194, v194, v195, s[88:89]
  v_mfma_f32_16x16x32_bf16 v[136:139], a[88:91], v[92:95], v[136:139]
  buffer_load_dwordx4 v9, s[8:11], s69 offen offset:0 sc1 lds
  v_cndmask_b32 v225, v192, v194, s[90:91]
  v_mfma_f32_16x16x32_bf16 v[140:143], a[92:95], v[92:95], v[140:143]
  ds_read_b128 v[84:87], v23 offset:3072
  v_mfma_f32_16x16x32_bf16 v[140:143], a[84:87], v[96:99], v[140:143]
  s_waitcnt lgkmcnt(4)
  v_mfma_f32_16x16x32_bf16 v[136:139], a[96:99], v[100:103], v[136:139]
  ds_read_b128 v[92:95], v23 offset:4096
  v_mfma_f32_16x16x32_bf16 v[136:139], a[104:107], v[104:107], v[136:139]
  buffer_load_dwordx4 v9, s[8:11], s69 offen offset:1024 sc1 lds
  v_mfma_f32_16x16x32_bf16 v[140:143], a[108:111], v[104:107], v[140:143]
  ds_read_b128 v[96:99], v23 offset:5120
  v_mfma_f32_16x16x32_bf16 v[140:143], a[100:103], v[100:103], v[140:143]
  buffer_load_dwordx4 v9, s[8:11], s69 offen offset:2048 sc1 lds
  v_mfma_f32_16x16x32_bf16 v[136:139], a[112:115], v[112:115], v[136:139]
  ds_read_b128 v[104:107], v23 offset:6144
  v_mfma_f32_16x16x32_bf16 v[136:139], a[120:123], v[108:111], v[136:139]
  v_mfma_f32_16x16x32_bf16 v[140:143], a[124:127], v[108:111], v[140:143]
  ds_read_b128 v[100:103], v23 offset:7168
  v_mfma_f32_16x16x32_bf16 v[140:143], a[116:119], v[112:115], v[140:143]
  s_waitcnt lgkmcnt(4)
  buffer_load_dwordx4 v9, s[8:11], s69 offen offset:3072 sc1 lds
  v_mfma_f32_16x16x32_bf16 v[136:139], a[128:131], v[76:79], v[136:139]
  ds_read_b128 v[108:111], v22 offset:0
  v_mfma_f32_16x16x32_bf16 v[136:139], a[136:139], v[80:83], v[136:139]
  v_mfma_f32_16x16x32_bf16 v[140:143], a[140:143], v[80:83], v[140:143]
  ds_read_b128 v[112:115], v22 offset:1024
  v_mfma_f32_16x16x32_bf16 v[140:143], a[132:135], v[76:79], v[140:143]
  v_mfma_f32_16x16x32_bf16 v[136:139], a[144:147], v[88:91], v[136:139]
  ds_read_b128 v[80:83], v22 offset:2048
  v_mfma_f32_16x16x32_bf16 v[136:139], a[152:155], v[84:87], v[136:139]
  v_mfma_f32_16x16x32_bf16 v[140:143], a[156:159], v[84:87], v[140:143]
  ds_read_b128 v[76:79], v22 offset:3072
  v_mfma_f32_16x16x32_bf16 v[140:143], a[148:151], v[88:91], v[140:143]
  s_waitcnt lgkmcnt(4)
  v_mfma_f32_16x16x32_bf16 v[136:139], a[160:163], v[92:95], v[136:139]
  ds_read_b128 v[84:87], v22 offset:4096
  v_mfma_f32_16x16x32_bf16 v[136:139], a[168:171], v[96:99], v[136:139]
  s_or_b32 s57, s2, s44
  s_mov_b32 s57, 851968
  s_cselect_b32 s57, 1073741824, s57
  v_add_u32 v15, s46, v0
  s_mov_b64 exec, 1
  buffer_store_dword v15, v0, s[8:11], s57 offen offset:0 sc1
  s_mov_b64 exec, -1
  v_mfma_f32_16x16x32_bf16 v[140:143], a[172:175], v[96:99], v[140:143]
  ds_read_b128 v[88:91], v22 offset:5120
  v_mfma_f32_16x16x32_bf16 v[140:143], a[164:167], v[92:95], v[140:143]
  v_mfma_f32_16x16x32_bf16 v[136:139], a[176:179], v[104:107], v[136:139]
  ds_read_b128 v[96:99], v22 offset:6144
  s_lshl_b32 s57, s44, 28
  s_add_u32 s57, s57, s77
  buffer_load_dword v13, v14, s[8:11], s57 offen sc1
  v_mfma_f32_16x16x32_bf16 v[136:139], a[184:187], v[100:103], v[136:139]
  v_mfma_f32_16x16x32_bf16 v[140:143], a[188:191], v[100:103], v[140:143]
  ds_read_b128 v[92:95], v22 offset:7168
  v_mfma_f32_16x16x32_bf16 v[140:143], a[180:183], v[104:107], v[140:143]
  s_waitcnt lgkmcnt(4)
  s_waitcnt vmcnt(11)
  s_barrier
  v_mfma_f32_16x16x32_bf16 v[136:139], a[192:195], v[108:111], v[136:139]
  ds_read_b128 v[100:103], v22 offset:32768
  v_mfma_f32_16x16x32_bf16 v[136:139], a[200:203], v[112:115], v[136:139]
  v_mfma_f32_16x16x32_bf16 v[140:143], a[204:207], v[112:115], v[140:143]
  ds_read_b128 v[104:107], v22 offset:33792
  v_mfma_f32_16x16x32_bf16 v[140:143], a[196:199], v[108:111], v[140:143]
  v_mfma_f32_16x16x32_bf16 v[136:139], a[208:211], v[80:83], v[136:139]
  ds_read_b128 v[112:115], v22 offset:34816
  s_waitcnt vmcnt(36) lgkmcnt(15)
  v_lshlrev_b32 v184, 16, v148
  v_and_b32 v185, 0xffff0000, v148
  v_lshlrev_b32 v186, 16, v149
  v_mfma_f32_16x16x32_bf16 v[136:139], a[216:219], v[76:79], v[136:139]
  v_and_b32 v187, 0xffff0000, v149
  v_lshlrev_b32 v188, 16, v150
  v_and_b32 v189, 0xffff0000, v150
  v_lshlrev_b32 v190, 16, v151
  v_and_b32 v191, 0xffff0000, v151
  v_mfma_f32_16x16x32_bf16 v[140:143], a[220:223], v[76:79], v[140:143]
  ds_read_b128 v[108:111], v22 offset:35840
  v_mfma_f32_16x16x32_bf16 v[140:143], a[212:215], v[80:83], v[140:143]
  s_waitcnt lgkmcnt(4)
  v_mfma_f32_16x16x32_bf16 v[136:139], a[224:227], v[84:87], v[136:139]
  ds_read_b128 v[76:79], v22 offset:36864
  v_mfma_f32_16x16x32_bf16 v[136:139], a[232:235], v[88:91], v[136:139]
  v_mfma_f32_16x16x32_bf16 v[140:143], a[236:239], v[88:91], v[140:143]
  ds_read_b128 v[80:83], v22 offset:37888
  v_mfma_f32_16x16x32_bf16 v[140:143], a[228:231], v[84:87], v[140:143]
  v_mfma_f32_16x16x32_bf16 v[136:139], a[240:243], v[96:99], v[136:139]
  ds_read_b128 v[88:91], v22 offset:38912
  v_mfma_f32_16x16x32_bf16 v[136:139], a[248:251], v[92:95], v[136:139]
  v_mfma_f32_16x16x32_bf16 v[140:143], v[124:127], v[92:95], v[140:143]
  ds_read_b128 v[84:87], v22 offset:39936
  v_mfma_f32_16x16x32_bf16 v[140:143], a[244:247], v[96:99], v[140:143]
  s_waitcnt lgkmcnt(4)
  v_mfma_f32_16x16x32_bf16 v[128:131], a[0:3], v[100:103], 0
  ds_read_b128 v[92:95], v22 offset:49152
  v_mfma_f32_16x16x32_bf16 v[128:131], a[8:11], v[104:107], v[128:131]
  v_mfma_f32_16x16x32_bf16 v[132:135], a[12:15], v[104:107], 0
  ds_read_b128 v[96:99], v22 offset:50176
  v_fmac_f32 v184, v160, v136
  v_fmac_f32 v185, v161, v137
  v_fmac_f32 v186, v162, v138
  v_fmac_f32 v187, v163, v139
  v_mfma_f32_16x16x32_bf16 v[132:135], a[4:7], v[100:103], v[132:135]
  v_fmac_f32 v188, v164, v140
  v_fmac_f32 v189, v165, v141
  v_fmac_f32 v190, v166, v142
  v_fmac_f32 v191, v167, v143
  v_mul_f32 v136, v184, v168
  v_mfma_f32_16x16x32_bf16 v[128:131], a[16:19], v[112:115], v[128:131]
  ds_read_b128 v[104:107], v22 offset:51200
  v_mul_f32 v137, v185, v169
  v_mul_f32 v138, v186, v170
  v_mul_f32 v139, v187, v171
  v_mul_f32 v140, v188, v172
  v_mfma_f32_16x16x32_bf16 v[128:131], a[24:27], v[108:111], v[128:131]
  v_mul_f32 v141, v189, v173
  v_mul_f32 v142, v190, v174
  v_mul_f32 v143, v191, v175
  v_cvt_pk_bf16_f32 v200, v136, v137
  v_cvt_pk_bf16_f32 v201, v138, v139
  v_mfma_f32_16x16x32_bf16 v[132:135], a[28:31], v[108:111], v[132:135]
  ds_read_b128 v[100:103], v22 offset:52224
  v_cvt_pk_bf16_f32 v202, v140, v141
  v_cvt_pk_bf16_f32 v203, v142, v143
  v_mfma_f32_16x16x32_bf16 v[132:135], a[20:23], v[112:115], v[132:135]
  s_waitcnt lgkmcnt(4)
  s_add_u32 s54, s47, 36765696
  buffer_store_dwordx4 v[200:203], v1, s[8:11], s54 offen sc1
  v_mfma_f32_16x16x32_bf16 v[128:131], a[32:35], v[76:79], v[128:131]
  ds_read_b128 v[108:111], v22 offset:53248
  v_cvt_pk_bf16_f32 v148, v184, v185
  v_cvt_pk_bf16_f32 v149, v186, v187
  v_cvt_pk_bf16_f32 v150, v188, v189
  v_cvt_pk_bf16_f32 v151, v190, v191
  v_mfma_f32_16x16x32_bf16 v[128:131], a[40:43], v[80:83], v[128:131]
  s_nop 0
  v_mfma_f32_16x16x32_bf16 v[226:229], v[176:179], v[148:151], 0
  v_mfma_f32_16x16x32_bf16 v[192:195], v[148:151], v[148:151], 0
  v_mfma_f32_16x16x32_bf16 v[132:135], a[44:47], v[80:83], v[132:135]
  ds_read_b128 v[112:115], v22 offset:54272
  v_mfma_f32_16x16x32_bf16 v[132:135], a[36:39], v[76:79], v[132:135]
  v_mfma_f32_16x16x32_bf16 v[128:131], a[48:51], v[88:91], v[128:131]
  ds_read_b128 v[80:83], v22 offset:55296
  s_nop 2
  v_cndmask_b32 v192, v192, v193, s[88:89]
  v_cndmask_b32 v194, v194, v195, s[88:89]
  v_cndmask_b32 v227, v192, v194, s[90:91]
  v_mfma_f32_16x16x32_bf16 v[128:131], a[56:59], v[84:87], v[128:131]
  buffer_store_dwordx4 v[224:227], v180, s[8:11], s48 offen offset:0 sc1
  v_mfma_f32_16x16x32_bf16 v[132:135], a[60:63], v[84:87], v[132:135]
  ds_read_b128 v[76:79], v22 offset:56320
  v_mfma_f32_16x16x32_bf16 v[132:135], a[52:55], v[88:91], v[132:135]
  s_waitcnt lgkmcnt(4)
  s_waitcnt vmcnt(2)
  s_cmp_lg_u32 s44, 0
  s_cbranch_scc1 PL8_adaLN_cond__sliding_local_dilated__swiglu_ffn__prompt_kernelx
  v_subrev_u32 v13, s46, v13
  v_subrev_u32 v13, 3, v13
  v_cmp_lt_u32 vcc, 3, v13
  s_nop 4
  s_cbranch_vccz PL8_adaLN_cond__sliding_local_dilated__swiglu_ffn__prompt_kernelx
  s_mov_b32 s57, 60000
PL8_adaLN_cond__sliding_local_dilated__swiglu_ffn__prompt_kernel:
  buffer_load_dword v13, v14, s[8:11], s77 offen sc1
  s_sub_u32 s57, s57, 1
  s_cmp_eq_u32 s57, 0
  s_waitcnt vmcnt(0)
  s_cbranch_scc1 PL8_adaLN_cond__sliding_local_dilated__swiglu_ffn__prompt_kernelx
  v_subrev_u32 v13, s46, v13
  v_subrev_u32 v13, 3, v13
  v_cmp_lt_u32 vcc, 3, v13
  s_nop 4
  s_cbranch_vccnz PL8_adaLN_cond__sliding_local_dilated__swiglu_ffn__prompt_kernel
PL8_adaLN_cond__sliding_local_dilated__swiglu_ffn__prompt_kernelx:
  s_waitcnt vmcnt(4)
  s_barrier
  v_mfma_f32_16x16x32_bf16 v[128:131], a[64:67], v[92:95], v[128:131]
  ds_read_b128 v[84:87], v23 offset:32768
  s_add_u32 m0, s70, 16384
  s_add_u32 s69, s62, 196608
  v_mfma_f32_16x16x32_bf16 v[128:131], a[72:75], v[96:99], v[128:131]
  buffer_load_dwordx4 v9, s[8:11], s69 offen offset:0 sc1 lds
  v_mfma_f32_16x16x32_bf16 v[132:135], a[76:79], v[96:99], v[132:135]
  ds_read_b128 v[88:91], v23 offset:33792
  v_mfma_f32_16x16x32_bf16 v[132:135], a[68:71], v[92:95], v[132:135]
  buffer_load_dwordx4 v9, s[8:11], s69 offen offset:1024 sc1 lds
  v_mfma_f32_16x16x32_bf16 v[128:131], a[80:83], v[104:107], v[128:131]
  ds_read_b128 v[96:99], v23 offset:34816
  buffer_load_dwordx4 v9, s[8:11], s69 offen offset:2048 sc1 lds
  v_mfma_f32_16x16x32_bf16 v[128:131], a[88:91], v[100:103], v[128:131]
  v_mfma_f32_16x16x32_bf16 v[132:135], a[92:95], v[100:103], v[132:135]
  ds_read_b128 v[92:95], v23 offset:35840
  buffer_load_dwordx4 v9, s[8:11], s69 offen offset:3072 sc1 lds
  s_add_u32 m0, s70, 81920
  s_add_u32 s69, s63, 196608
  v_mfma_f32_16x16x32_bf16 v[132:135], a[84:87], v[104:107], v[132:135]
  s_waitcnt lgkmcnt(4)
  buffer_load_dwordx4 v9, s[8:11], s69 offen offset:0 sc1 lds
  v_mfma_f32_16x16x32_bf16 v[128:131], a[96:99], v[108:111], v[128:131]
  ds_read_b128 v[100:103], v23 offset:36864
  v_mfma_f32_16x16x32_bf16 v[128:131], a[104:107], v[112:115], v[128:131]
  buffer_load_dwordx4 v9, s[8:11], s69 offen offset:1024 sc1 lds
  v_mfma_f32_16x16x32_bf16 v[132:135], a[108:111], v[112:115], v[132:135]
  ds_read_b128 v[104:107], v23 offset:37888
  buffer_load_dwordx4 v9, s[8:11], s69 offen offset:2048 sc1 lds
  v_mfma_f32_16x16x32_bf16 v[132:135], a[100:103], v[108:111], v[132:135]
  v_mfma_f32_16x16x32_bf16 v[128:131], a[112:115], v[80:83], v[128:131]
  ds_read_b128 v[112:115], v23 offset:38912
  buffer_load_dwordx4 v9, s[8:11], s69 offen offset:3072 sc1 lds
  s_add_u32 m0, s70, 65536
  s_add_u32 s69, s64, 196608
  v_mfma_f32_16x16x32_bf16 v[128:131], a[120:123], v[76:79], v[128:131]
  buffer_load_dwordx4 v9, s[8:11], s69 offen offset:0 sc1 lds
  v_mfma_f32_16x16x32_bf16 v[132:135], a[124:127], v[76:79], v[132:135]
  ds_read_b128 v[108:111], v23 offset:39936
  v_mfma_f32_16x16x32_bf16 v[132:135], a[116:119], v[80:83], v[132:135]
  s_waitcnt lgkmcnt(4)
  buffer_load_dwordx4 v9, s[8:11], s69 offen offset:1024 sc1 lds
  v_mfma_f32_16x16x32_bf16 v[128:131], a[128:131], v[84:87], v[128:131]
  ds_read_b128 v[76:79], v23 offset:49152
  buffer_load_dwordx4 v9, s[8:11], s69 offen offset:2048 sc1 lds
  v_mfma_f32_16x16x32_bf16 v[128:131], a[136:139], v[88:91], v[128:131]
  v_mfma_f32_16x16x32_bf16 v[132:135], a[140:143], v[88:91], v[132:135]
  ds_read_b128 v[80:83], v23 offset:50176
  buffer_load_dwordx4 v9, s[8:11], s69 offen offset:3072 sc1 lds
  s_add_u32 m0, s70, 0
  s_add_u32 s69, s65, 196608
  v_mfma_f32_16x16x32_bf16 v[132:135], a[132:135], v[84:87], v[132:135]
  buffer_load_dwordx4 v9, s[8:11], s69 offen offset:0 sc1 lds
  v_mfma_f32_16x16x32_bf16 v[128:131], a[144:147], v[96:99], v[128:131]
  ds_read_b128 v[88:91], v23 offset:51200
  v_mfma_f32_16x16x32_bf16 v[128:131], a[152:155], v[92:95], v[128:131]
  buffer_load_dwordx4 v9, s[8:11], s69 offen offset:1024 sc1 lds
  v_mfma_f32_16x16x32_bf16 v[132:135], a[156:159], v[92:95], v[132:135]
  ds_read_b128 v[84:87], v23 offset:52224
  buffer_load_dwordx4 v9, s[8:11], s69 offen offset:2048 sc1 lds
  v_mfma_f32_16x16x32_bf16 v[132:135], a[148:151], v[96:99], v[132:135]
  s_waitcnt lgkmcnt(4)
  v_mfma_f32_16x16x32_bf16 v[128:131], a[160:163], v[100:103], v[128:131]
  ds_read_b128 v[92:95], v23 offset:53248
  v_mfma_f32_16x16x32_bf16 v[128:131], a[168:171], v[104:107], v[128:131]
  buffer_load_dwordx4 v9, s[8:11], s69 offen offset:3072 sc1 lds
  v_mfma_f32_16x16x32_bf16 v[132:135], a[172:175], v[104:107], v[132:135]
  ds_read_b128 v[96:99], v23 offset:54272
  v_mfma_f32_16x16x32_bf16 v[132:135], a[164:167], v[100:103], v[132:135]
  v_mfma_f32_16x16x32_bf16 v[128:131], a[176:179], v[112:115], v[128:131]
  ds_read_b128 v[104:107], v23 offset:55296
  v_mfma_f32_16x16x32_bf16 v[128:131], a[184:187], v[108:111], v[128:131]
  s_mov_b32 s55, 0
  s_add_u32 m0, s45, 32768
  s_sub_u32 s73, s49, 524288
  v_mfma_f32_16x16x32_bf16 v[132:135], a[188:191], v[108:111], v[132:135]
  ds_read_b128 v[100:103], v23 offset:56320
  buffer_load_dwordx4 v16, s[28:31], s55 offen lds
  v_mfma_f32_16x16x32_bf16 v[132:135], a[180:183], v[112:115], v[132:135]
  s_waitcnt lgkmcnt(4)
  s_waitcnt vmcnt(9)
  s_barrier
  v_add_u32 v15, s46, v0
  s_mov_b64 exec, 1
  buffer_store_dword v15, v0, s[8:11], s73 offen offset:0 sc1
  s_mov_b64 exec, -1
  v_mfma_f32_16x16x32_bf16 v[128:131], a[192:195], v[76:79], v[128:131]
  ds_read_b128 v[108:111], v22 offset:16384
  v_mfma_f32_16x16x32_bf16 v[128:131], a[200:203], v[80:83], v[128:131]
  v_mfma_f32_16x16x32_bf16 v[132:135], a[204:207], v[80:83], v[132:135]
  ds_read_b128 v[112:115], v22 offset:17408
  v_mfma_f32_16x16x32_bf16 v[132:135], a[196:199], v[76:79], v[132:135]
  s_mov_b32 s55, 0
  s_add_u32 m0, s45, 40960
  v_mfma_f32_16x16x32_bf16 v[128:131], a[208:211], v[88:91], v[128:131]
  ds_read_b128 v[80:83], v22 offset:18432
  s_waitcnt vmcnt(55) lgkmcnt(15)
  v_lshlrev_b32 v184, 16, v152
  v_mfma_f32_16x16x32_bf16 v[128:131], a[216:219], v[84:87], v[128:131]
  buffer_load_dwordx4 v16, s[32:35], s55 offen lds
  v_and_b32 v185, 0xffff0000, v152
  v_lshlrev_b32 v186, 16, v153
  v_and_b32 v187, 0xffff0000, v153
  v_mfma_f32_16x16x32_bf16 v[132:135], a[220:223], v[84:87], v[132:135]
  ds_read_b128 v[76:79], v22 offset:19456
  v_lshlrev_b32 v188, 16, v154
  v_and_b32 v189, 0xffff0000, v154
  v_mfma_f32_16x16x32_bf16 v[132:135], a[212:215], v[88:91], v[132:135]
  s_waitcnt lgkmcnt(4)
  v_lshlrev_b32 v190, 16, v155
  v_and_b32 v191, 0xffff0000, v155
  v_mfma_f32_16x16x32_bf16 v[128:131], a[224:227], v[92:95], v[128:131]
  ds_read_b128 v[84:87], v22 offset:20480
  v_mfma_f32_16x16x32_bf16 v[128:131], a[232:235], v[96:99], v[128:131]
HOP6:
  s_cbranch_execz HOP10
  s_mov_b32 s55, 229376
  s_add_u32 m0, s45, 36864
  v_mfma_f32_16x16x32_bf16 v[132:135], a[236:239], v[96:99], v[132:135]
  ds_read_b128 v[88:91], v22 offset:21504
  v_mfma_f32_16x16x32_bf16 v[132:135], a[228:231], v[92:95], v[132:135]
  buffer_load_dwordx4 v16, s[28:31], s55 offen lds
  v_mfma_f32_16x16x32_bf16 v[128:131], a[240:243], v[104:107], v[128:131]
  ds_read_b128 v[96:99], v22 offset:22528
  v_mfma_f32_16x16x32_bf16 v[128:131], a[248:251], v[100:103], v[128:131]
  v_mfma_f32_16x16x32_bf16 v[132:135], v[124:127], v[100:103], v[132:135]
  ds_read_b128 v[92:95], v22 offset:23552
  v_mfma_f32_16x16x32_bf16 v[132:135], a[244:247], v[104:107], v[132:135]
  s_waitcnt lgkmcnt(4)
  s_mov_b32 s55, 229376
  s_add_u32 m0, s45, 45056
  v_mfma_f32_16x16x32_bf16 v[136:139], a[0:3], v[108:111], 0
  ds_read_b128 v[100:103], v23 offset:16384
  v_mfma_f32_16x16x32_bf16 v[136:139], a[8:11], v[112:115], v[136:139]
  buffer_load_dwordx4 v16, s[32:35], s55 offen lds
  v_mfma_f32_16x16x32_bf16 v[140:143], a[12:15], v[112:115], 0
  ds_read_b128 v[104:107], v23 offset:17408
  v_fmac_f32 v184, v160, v128
  v_fmac_f32 v185, v161, v129
  v_mfma_f32_16x16x32_bf16 v[140:143], a[4:7], v[108:111], v[140:143]
  v_fmac_f32 v186, v162, v130
  v_fmac_f32 v187, v163, v131
  v_fmac_f32 v188, v164, v132
  v_mfma_f32_16x16x32_bf16 v[136:139], a[16:19], v[80:83], v[136:139]
  ds_read_b128 v[112:115], v23 offset:18432
  v_fmac_f32 v189, v165, v133
  v_fmac_f32 v190, v166, v134
  v_mfma_f32_16x16x32_bf16 v[136:139], a[24:27], v[76:79], v[136:139]
  s_add_u32 s56, s79, 12288
  v_fmac_f32 v191, v167, v135
  v_mul_f32 v128, v184, v168
  v_mul_f32 v129, v185, v169
  v_mfma_f32_16x16x32_bf16 v[140:143], a[28:31], v[76:79], v[140:143]
  ds_read_b128 v[108:111], v23 offset:19456
  v_mul_f32 v130, v186, v170
  v_mul_f32 v131, v187, v171
  v_mfma_f32_16x16x32_bf16 v[140:143], a[20:23], v[80:83], v[140:143]
  s_waitcnt lgkmcnt(4)
  buffer_load_dwordx2 v[212:213], v220, s[8:11], s56 offen sc1
  v_mul_f32 v132, v188, v172
  v_mul_f32 v133, v189, v173
  v_mfma_f32_16x16x32_bf16 v[136:139], a[32:35], v[84:87], v[136:139]
  ds_read_b128 v[76:79], v23 offset:20480
  s_add_u32 s56, s79, 36864
  v_mul_f32 v134, v190, v174
  v_mfma_f32_16x16x32_bf16 v[136:139], a[40:43], v[88:91], v[136:139]
  buffer_load_dwordx2 v[214:215], v220, s[8:11], s56 offen sc1
  v_mul_f32 v135, v191, v175
  v_cvt_pk_bf16_f32 v204, v128, v129
  v_cvt_pk_bf16_f32 v205, v130, v131
  v_mfma_f32_16x16x32_bf16 v[140:143], a[44:47], v[88:91], v[140:143]
  ds_read_b128 v[80:83], v23 offset:21504
  v_cvt_pk_bf16_f32 v206, v132, v133
  v_cvt_pk_bf16_f32 v207, v134, v135
  v_mfma_f32_16x16x32_bf16 v[140:143], a[36:39], v[84:87], v[140:143]
  s_add_u32 s56, s79, 61440
  s_add_u32 s54, s47, 36831232
  buffer_store_dwordx4 v[204:207], v1, s[8:11], s54 offen sc1
  v_mfma_f32_16x16x32_bf16 v[136:139], a[48:51], v[96:99], v[136:139]
  ds_read_b128 v[88:91], v23 offset:22528
  v_cvt_pk_bf16_f32 v152, v184, v185
  v_cvt_pk_bf16_f32 v153, v186, v187
  v_mfma_f32_16x16x32_bf16 v[136:139], a[56:59], v[92:95], v[136:139]
  buffer_load_dwordx2 v[216:217], v220, s[8:11], s56 offen sc1
  v_cvt_pk_bf16_f32 v154, v188, v189
  v_cvt_pk_bf16_f32 v155, v190, v191
  v_mfma_f32_16x16x32_bf16 v[140:143], a[60:63], v[92:95], v[140:143]
  ds_read_b128 v[84:87], v23 offset:23552
  s_add_u32 s56, s79, 86016
  v_mfma_f32_16x16x32_bf16 v[228:231], v[176:179], v[152:155], 0
  v_mfma_f32_16x16x32_bf16 v[192:195], v[152:155], v[152:155], 0
  v_mfma_f32_16x16x32_bf16 v[140:143], a[52:55], v[96:99], v[140:143]
  s_waitcnt lgkmcnt(4)
  s_waitcnt vmcnt(9)
  s_barrier
  v_mfma_f32_16x16x32_bf16 v[136:139], a[64:67], v[100:103], v[136:139]
  ds_read_b128 v[92:95], v23 offset:0
  buffer_load_dwordx2 v[218:219], v220, s[8:11], s56 offen sc1
  v_mfma_f32_16x16x32_bf16 v[136:139], a[72:75], v[104:107], v[136:139]
  s_mov_b32 s55, 0
  s_add_u32 m0, s45, 98304
  v_cndmask_b32 v192, v192, v193, s[88:89]
  v_cndmask_b32 v194, v194, v195, s[88:89]
  v_mfma_f32_16x16x32_bf16 v[140:143], a[76:79], v[104:107], v[140:143]
  ds_read_b128 v[96:99], v23 offset:1024
  v_cndmask_b32 v229, v192, v194, s[90:91]
  v_mfma_f32_16x16x32_bf16 v[140:143], a[68:71], v[100:103], v[140:143]
  buffer_load_dwordx4 v11, s[28:31], s55 offen lds
  v_mfma_f32_16x16x32_bf16 v[136:139], a[80:83], v[112:115], v[136:139]
  ds_read_b128 v[104:107], v23 offset:2048
  v_mfma_f32_16x16x32_bf16 v[136:139], a[88:91], v[108:111], v[136:139]
  v_mfma_f32_16x16x32_bf16 v[140:143], a[92:95], v[108:111], v[140:143]
  ds_read_b128 v[100:103], v23 offset:3072
  v_mfma_f32_16x16x32_bf16 v[140:143], a[84:87], v[112:115], v[140:143]
  s_waitcnt lgkmcnt(4)
  s_mov_b32 s55, 0
  s_add_u32 m0, s45, 106496
  v_mfma_f32_16x16x32_bf16 v[136:139], a[96:99], v[76:79], v[136:139]
  ds_read_b128 v[108:111], v23 offset:4096
  v_mfma_f32_16x16x32_bf16 v[136:139], a[104:107], v[80:83], v[136:139]
  buffer_load_dwordx4 v11, s[32:35], s55 offen lds
  v_mfma_f32_16x16x32_bf16 v[140:143], a[108:111], v[80:83], v[140:143]
  ds_read_b128 v[112:115], v23 offset:5120
  v_mfma_f32_16x16x32_bf16 v[140:143], a[100:103], v[76:79], v[140:143]
  v_mfma_f32_16x16x32_bf16 v[136:139], a[112:115], v[88:91], v[136:139]
  ds_read_b128 v[80:83], v23 offset:6144
  v_mfma_f32_16x16x32_bf16 v[136:139], a[120:123], v[84:87], v[136:139]
  s_mov_b32 s55, 229376
  s_add_u32 m0, s45, 102400
  v_mfma_f32_16x16x32_bf16 v[140:143], a[124:127], v[84:87], v[140:143]
  ds_read_b128 v[76:79], v23 offset:7168
  v_mfma_f32_16x16x32_bf16 v[140:143], a[116:119], v[88:91], v[140:143]
  s_waitcnt lgkmcnt(4)
  buffer_load_dwordx4 v11, s[28:31], s55 offen lds
  v_mfma_f32_16x16x32_bf16 v[136:139], a[128:131], v[92:95], v[136:139]
  ds_read_b128 v[84:87], v22 offset:0
  v_mfma_f32_16x16x32_bf16 v[136:139], a[136:139], v[96:99], v[136:139]
  v_mfma_f32_16x16x32_bf16 v[140:143], a[140:143], v[96:99], v[140:143]
  ds_read_b128 v[88:91], v22 offset:1024
  v_mfma_f32_16x16x32_bf16 v[140:143], a[132:135], v[92:95], v[140:143]
  s_mov_b32 s55, 229376
  s_add_u32 m0, s45, 110592
  v_mfma_f32_16x16x32_bf16 v[136:139], a[144:147], v[104:107], v[136:139]
  ds_read_b128 v[96:99], v22 offset:2048
  v_mfma_f32_16x16x32_bf16 v[136:139], a[152:155], v[100:103], v[136:139]
  buffer_load_dwordx4 v11, s[32:35], s55 offen lds
  v_mfma_f32_16x16x32_bf16 v[140:143], a[156:159], v[100:103], v[140:143]
  ds_read_b128 v[92:95], v22 offset:3072
  v_mfma_f32_16x16x32_bf16 v[140:143], a[148:151], v[104:107], v[140:143]
  s_waitcnt lgkmcnt(4)
  v_mfma_f32_16x16x32_bf16 v[136:139], a[160:163], v[108:111], v[136:139]
  ds_read_b128 v[100:103], v22 offset:4096
  v_mfma_f32_16x16x32_bf16 v[136:139], a[168:171], v[112:115], v[136:139]
  s_mov_b32 s55, 458752
  s_add_u32 m0, s45, 114688
  v_mfma_f32_16x16x32_bf16 v[140:143], a[172:175], v[112:115], v[140:143]
  ds_read_b128 v[104:107], v22 offset:5120
  v_mfma_f32_16x16x32_bf16 v[140:143], a[164:167], v[108:111], v[140:143]
  buffer_load_dwordx4 v11, s[28:31], s55 offen lds
  v_mfma_f32_16x16x32_bf16 v[136:139], a[176:179], v[80:83], v[136:139]
  ds_read_b128 v[112:115], v22 offset:6144
  s_waitcnt vmcnt(63) lgkmcnt(15)
  v_mfma_f32_16x16x32_bf16 v[136:139], a[184:187], v[76:79], v[136:139]
  v_lshlrev_b32 v184, 16, v156
  v_and_b32 v185, 0xffff0000, v156
  v_mfma_f32_16x16x32_bf16 v[140:143], a[188:191], v[76:79], v[140:143]
  ds_read_b128 v[108:111], v22 offset:7168
  v_lshlrev_b32 v186, 16, v157
  v_mfma_f32_16x16x32_bf16 v[140:143], a[180:183], v[80:83], v[140:143]
  s_waitcnt lgkmcnt(4)
  s_mov_b32 s55, 458752
  s_add_u32 m0, s45, 122880
  v_mfma_f32_16x16x32_bf16 v[136:139], a[192:195], v[84:87], v[136:139]
  buffer_load_dwordx4 v11, s[32:35], s55 offen lds
  v_and_b32 v187, 0xffff0000, v157
  v_lshlrev_b32 v188, 16, v158
  v_mfma_f32_16x16x32_bf16 v[136:139], a[200:203], v[88:91], v[136:139]
  v_and_b32 v189, 0xffff0000, v158
  v_lshlrev_b32 v190, 16, v159
  v_mfma_f32_16x16x32_bf16 v[140:143], a[204:207], v[88:91], v[140:143]
  v_and_b32 v191, 0xffff0000, v159
  v_mfma_f32_16x16x32_bf16 v[140:143], a[196:199], v[84:87], v[140:143]
  v_mfma_f32_16x16x32_bf16 v[136:139], a[208:211], v[96:99], v[136:139]
  v_mfma_f32_16x16x32_bf16 v[136:139], a[216:219], v[92:95], v[136:139]
  s_mov_b32 s55, 688128
  s_add_u32 m0, s45, 118784
  v_mfma_f32_16x16x32_bf16 v[140:143], a[220:223], v[92:95], v[140:143]
  buffer_load_dwordx4 v11, s[28:31], s55 offen lds
  v_mfma_f32_16x16x32_bf16 v[140:143], a[212:215], v[96:99], v[140:143]
  s_waitcnt lgkmcnt(0)
  v_mfma_f32_16x16x32_bf16 v[136:139], a[224:227], v[100:103], v[136:139]
  v_mfma_f32_16x16x32_bf16 v[136:139], a[232:235], v[104:107], v[136:139]
  v_mfma_f32_16x16x32_bf16 v[140:143], a[236:239], v[104:107], v[140:143]
  v_mfma_f32_16x16x32_bf16 v[140:143], a[228:231], v[100:103], v[140:143]
  s_mov_b32 s55, 688128
  s_add_u32 m0, s45, 126976
  v_mfma_f32_16x16x32_bf16 v[136:139], a[240:243], v[112:115], v[136:139]
  buffer_load_dwordx4 v11, s[32:35], s55 offen lds
  v_mfma_f32_16x16x32_bf16 v[136:139], a[248:251], v[108:111], v[136:139]
  v_mfma_f32_16x16x32_bf16 v[140:143], v[124:127], v[108:111], v[140:143]
  v_mfma_f32_16x16x32_bf16 v[140:143], a[244:247], v[112:115], v[140:143]
  s_nop 5
  v_fmac_f32 v184, v160, v136
  v_fmac_f32 v185, v161, v137
  v_fmac_f32 v186, v162, v138
  v_fmac_f32 v187, v163, v139
  v_fmac_f32 v188, v164, v140
  v_fmac_f32 v189, v165, v141
  v_fmac_f32 v190, v166, v142
  v_fmac_f32 v191, v167, v143
  v_mul_f32 v136, v184, v168
  v_mul_f32 v137, v185, v169
  v_mul_f32 v138, v186, v170
  v_mul_f32 v139, v187, v171
  v_mul_f32 v140, v188, v172
  v_mul_f32 v141, v189, v173
  v_mul_f32 v142, v190, v174
  v_mul_f32 v143, v191, v175
  v_cvt_pk_bf16_f32 v208, v136, v137
  v_cvt_pk_bf16_f32 v209, v138, v139
  v_cvt_pk_bf16_f32 v210, v140, v141
  v_cvt_pk_bf16_f32 v211, v142, v143
  s_add_u32 s54, s47, 36896768
  buffer_store_dwordx4 v[208:211], v1, s[8:11], s54 offen sc1
  v_cvt_pk_bf16_f32 v156, v184, v185
  v_cvt_pk_bf16_f32 v157, v186, v187
  v_cvt_pk_bf16_f32 v158, v188, v189
  v_cvt_pk_bf16_f32 v159, v190, v191
  s_nop 1
  v_mfma_f32_16x16x32_bf16 v[230:233], v[176:179], v[156:159], 0
  v_mfma_f32_16x16x32_bf16 v[192:195], v[156:159], v[156:159], 0
  s_nop 7
  v_cndmask_b32 v192, v192, v193, s[88:89]
  v_cndmask_b32 v194, v194, v195, s[88:89]
  v_cndmask_b32 v231, v192, v194, s[90:91]
  buffer_store_dwordx4 v[228:231], v180, s[8:11], s48 offen offset:256 sc1
  s_waitcnt lgkmcnt(0)
  s_and_b32 s52, s2, 7
  s_bfe_u32 s51, s2, 0x20003
  s_lshr_b32 s50, s2, 5
  s_add_u32 s56, s51, s50
  s_and_b32 s56, s56, 3
  s_lshl_b32 s53, s50, 1
  s_lshr_b32 s54, s44, 1
  s_add_u32 s53, s53, s54
  s_lshl_b32 s63, s53, 3
  s_and_b32 s55, s44, 1
  s_add_u32 s63, s63, s55
  s_lshl_b32 s57, s63, 15
  s_add_u32 s57, s57, 36700160
  s_lshl_b32 s53, s50, 12
  s_add_u32 s82, s53, 753664
  v_and_b32 v15, 31, v0
  v_lshlrev_b32 v15, 7, v15
  v_lshrrev_b32 v33, 2, v0
  v_bfe_u32 v32, v33, 1, 2
  v_lshlrev_b32 v32, 5, v32
  v_lshl_add_u32 v32, v33, 7, v32
  v_and_b32 v33, 3, v0
  v_lshl_add_u32 v2, v33, 3, v32
  v_xor_b32 v3, 32, v2
  v_xor_b32 v4, 64, v2
  v_xor_b32 v5, 96, v2
  v_add_u32 v6, 65536, v2
  v_add_u32 v7, 65536, v3
  v_add_u32 v8, 65536, v4
  s_lshl_b32 s80, s2, 7
  s_lshl_b32 s53, s44, 28
  s_add_u32 s80, s80, s53
  s_add_u32 s80, s80, 884736
  s_lshl_b32 s53, s2, 2
  s_add_u32 s53, s53, s44
  s_lshl_b32 s53, s53, 7
  s_add_u32 s81, s53, 917504
  s_sub_u32 s60, s82, 524288
  s_lshl_b32 s83, s44, 28
  s_add_u32 s83, s83, s60
  buffer_load_dword v13, v15, s[8:11], s83 offen sc1
  s_waitcnt vmcnt(11)
  v_add_f32 v212, v212, v214
  v_add_f32 v216, v216, v218
  v_add_f32 v212, v212, v216
  v_add_f32 v213, v213, v215
  v_add_f32 v217, v217, v219
  v_add_f32 v213, v213, v217
  v_lshrrev_b32 v32, 5, v0
  v_xor_b32 v33, 1, v32
  v_cvt_f32_u32 v33, v33
  v_cvt_pk_bf16_f32 v214, v212, v213
  v_lshlrev_b32 v212, 16, v214
  v_and_b32 v213, 0xffff0000, v214
  v_add_f32 v212, v212, v33
  v_add_f32 v213, v213, v33
  v_cvt_pk_bf16_f32 v214, v212, v213
  v_lshlrev_b32 v212, 16, v214
  v_and_b32 v213, 0xffff0000, v214
  v_lshrrev_b32 v215, 16, v214
  v_and_b32 v214, 0xffff, v214
  s_add_u32 s53, s45, 151552
  v_lshlrev_b32 v32, 8, v32
  v_lshl_add_u32 v32, v0, 3, v32
  v_add_u32 v32, s53, v32
  ds_write_b64 v32, v[214:215]
  ds_write_b64 v32, v[212:213] offset:256
  s_bitcmp1_b32 s2, 3
  s_cselect_b64 s[12:13], s[32:33], s[28:29]
  s_mov_b32 s14, 7340032
  s_mov_b32 s16, 0x03030303
  s_mov_b32 s17, 0x03030303
  s_mov_b32 s18, 0x0c0c0c0c
  s_mov_b32 s19, 0x0c0c0c0c
  s_mov_b32 s20, 0x30303030
  s_mov_b32 s21, 0x30303030
  s_mov_b32 s22, 0xc0c0c0c0
  s_mov_b32 s23, 0xc0c0c0c0
  s_waitcnt vmcnt(7)
  v_add_u32 v9, s46, v0
  s_waitcnt vmcnt(1)
  s_barrier
  s_mov_b64 exec, 1
  buffer_store_dword v9, v0, s[8:11], s49 offen offset:0 sc1
  s_mov_b64 exec, -1
  s_mov_b32 s55, 458752
  s_add_u32 m0, s45, 49152
  s_nop 0
  buffer_load_dwordx4 v16, s[28:31], s55 offen lds
  s_mov_b32 s55, 458752
  s_add_u32 m0, s45, 57344
  s_nop 0
  buffer_load_dwordx4 v16, s[32:35], s55 offen lds
  s_mov_b32 s55, 688128
  s_add_u32 m0, s45, 53248
  s_nop 0
  buffer_load_dwordx4 v16, s[28:31], s55 offen lds
  s_mov_b32 s55, 688128
  s_add_u32 m0, s45, 61440
  s_nop 0
  buffer_load_dwordx4 v16, s[32:35], s55 offen lds
  ds_write_b128 v182, v[144:147] offset:0
  ds_write_b128 v182, v[148:151] offset:4096
  ds_write_b128 v182, v[152:155] offset:8192
  ds_write_b128 v182, v[156:159] offset:12288
  v_mov_b32 v10, v16
  s_waitcnt vmcnt(5)
  s_cmp_lg_u32 s44, 0
  s_cbranch_scc1 PL9_adaLN_cond__sliding_local_dilated__swiglu_ffn__prompt_kernelx
  v_cmp_ne_u32 vcc, s46, v13
  s_nop 4
  s_cbranch_vccz PL9_adaLN_cond__sliding_local_dilated__swiglu_ffn__prompt_kernelx
  s_mov_b32 s83, 60000
PL9_adaLN_cond__sliding_local_dilated__swiglu_ffn__prompt_kernel:
  buffer_load_dword v13, v15, s[8:11], s60 offen sc1
  s_sub_u32 s83, s83, 1
  s_cmp_eq_u32 s83, 0
  s_waitcnt vmcnt(0)
  s_cbranch_scc1 PL9_adaLN_cond__sliding_local_dilated__swiglu_ffn__prompt_kernelx
  v_cmp_ne_u32 vcc, s46, v13
  s_nop 4
  s_cbranch_vccnz PL9_adaLN_cond__sliding_local_dilated__swiglu_ffn__prompt_kernel
PL9_adaLN_cond__sliding_local_dilated__swiglu_ffn__prompt_kernelx:
  s_barrier
  s_mov_b32 s64, 0
  s_add_u32 s72, s57, 0
  buffer_load_dwordx4 a[0:3], v1, s[8:11], s72 offen offset:0 sc1
  buffer_load_dwordx4 a[16:19], v1, s[8:11], s72 offen offset:1024 sc1
  s_add_u32 s72, s72, 65536
  buffer_load_dwordx4 a[4:7], v1, s[8:11], s72 offen offset:0 sc1
  buffer_load_dwordx4 a[20:23], v1, s[8:11], s72 offen offset:1024 sc1
  s_mov_b32 s65, 458752
  s_add_u32 s73, s57, 2048
  buffer_load_dwordx4 a[32:35], v1, s[8:11], s73 offen offset:0 sc1
  buffer_load_dwordx4 a[48:51], v1, s[8:11], s73 offen offset:1024 sc1
  s_add_u32 s73, s73, 65536
  buffer_load_dwordx4 a[36:39], v1, s[8:11], s73 offen offset:0 sc1
  buffer_load_dwordx4 a[52:55], v1, s[8:11], s73 offen offset:1024 sc1
  s_mov_b64 exec, 0
  s_cmp_eq_u32 s44, 0
  s_cbranch_scc1 HOP15
  s_cmp_eq_u32 s44, 1
  s_cbranch_scc1 HOP16
  s_cmp_eq_u32 s44, 2
  s_cbranch_scc1 HOP17
  s_cmp_eq_u32 s44, 3
  s_cbranch_scc1 HOP18
WRET1:
  s_mov_b64 exec, -1
  v_bfe_u32 v32, v0, 3, 1
  v_lshlrev_b32 v32, 9, v32
  v_and_b32 v33, 1, v0
  v_lshl_add_u32 v32, v33, 8, v32
  v_lshrrev_b32 v33, 4, v0
  v_lshl_add_u32 v32, v33, 6, v32
  v_add_u32 v14, s53, v32
  s_bfe_u32 s53, s2, 0x20004
  s_lshl_b32 s53, s53, 8
  v_and_b32 v32, 15, v0
  v_lshl_add_u32 v32, v32, 4, s53
  v_cmp_gt_u32 vcc, 896, v32
  v_mov_b32 v34, 1073741824
  v_mul_u32_u24 v33, 114688, v33
  v_cndmask_b32 v32, v34, v32, vcc
  s_lshr_b32 s53, s2, 6
  s_lshl_b32 s53, s53, 2
  s_add_u32 s53, s53, s44
  s_mul_i32 s53, s53, 458752
  s_mul_i32 s54, s52, 896
  s_add_u32 s53, s53, s54
  v_add3_u32 v13, v32, v33, s53
  ds_read_b64_tr_b16 a[160:161], v6 offset:32768
  ds_read_b64_tr_b16 a[162:163], v6 offset:34816
  ds_read_b64_tr_b16 a[164:165], v6 offset:36864
  ds_read_b64_tr_b16 a[166:167], v6 offset:38912
  ds_read_b64_tr_b16 a[168:169], v6 offset:40960
  ds_read_b64_tr_b16 a[170:171], v6 offset:43008
  ds_read_b64_tr_b16 a[172:173], v6 offset:45056
  ds_read_b64_tr_b16 a[174:175], v6 offset:47104
  ds_read_b64_tr_b16 a[176:177], v7 offset:32768
  ds_read_b64_tr_b16 a[178:179], v7 offset:34816
  ds_read_b64_tr_b16 a[180:181], v7 offset:36864
  ds_read_b64_tr_b16 a[182:183], v7 offset:38912
  ds_read_b64_tr_b16 a[188:189], v7 offset:40960
  ds_read_b64_tr_b16 a[190:191], v7 offset:43008
  ds_read_b64_tr_b16 a[192:193], v7 offset:45056
  ds_read_b64_tr_b16 a[194:195], v7 offset:47104
  s_waitcnt vmcnt(4) lgkmcnt(8)
  v_mfma_f32_16x16x32_bf16 v[64:67], a[160:163], a[0:3], 0
  ds_read_b64_tr_b16 a[196:197], v8 offset:32768
  s_mov_b32 s66, 917504
  s_add_u32 s74, s57, 4096
  s_add_u32 m0, s45, 81920
  v_mfma_f32_16x16x32_bf16 v[64:67], a[164:167], a[16:19], v[64:67]
  ds_read_b64_tr_b16 a[198:199], v8 offset:34816
  buffer_load_dwordx4 v11, s[28:31], s66 offen lds
  v_mfma_f32_16x16x32_bf16 v[68:71], a[164:167], a[20:23], 0
  ds_read_b64_tr_b16 a[200:201], v8 offset:36864
  v_mfma_f32_16x16x32_bf16 v[68:71], a[160:163], a[4:7], v[68:71]
  ds_read_b64_tr_b16 a[202:203], v8 offset:38912
  v_mfma_f32_16x16x32_bf16 v[84:87], a[168:171], a[4:7], 0
  ds_read_b64_tr_b16 a[204:205], v8 offset:40960
  s_add_u32 m0, s45, 90112
  v_mfma_f32_16x16x32_bf16 v[84:87], a[172:175], a[20:23], v[84:87]
  ds_read_b64_tr_b16 a[206:207], v8 offset:43008
  buffer_load_dwordx4 v11, s[32:35], s66 offen lds
  v_mfma_f32_16x16x32_bf16 v[80:83], a[172:175], a[16:19], 0
  ds_read_b64_tr_b16 a[208:209], v8 offset:45056
  v_mfma_f32_16x16x32_bf16 v[80:83], a[168:171], a[0:3], v[80:83]
  s_waitcnt lgkmcnt(7)
  ds_read_b64_tr_b16 a[210:211], v8 offset:47104
  v_mfma_f32_16x16x32_bf16 v[96:99], a[176:179], a[0:3], 0
  ds_read_b64_tr_b16 a[164:165], v2 offset:32768
  s_add_u32 m0, s45, 86016
  s_add_u32 s61, s66, 229376
  v_mfma_f32_16x16x32_bf16 v[96:99], a[180:183], a[16:19], v[96:99]
  ds_read_b64_tr_b16 a[166:167], v2 offset:34816
  buffer_load_dwordx4 v11, s[28:31], s61 offen lds
  v_mfma_f32_16x16x32_bf16 v[100:103], a[180:183], a[20:23], 0
  ds_read_b64_tr_b16 a[160:161], v2 offset:36864
  v_mfma_f32_16x16x32_bf16 v[100:103], a[176:179], a[4:7], v[100:103]
  ds_read_b64_tr_b16 a[162:163], v2 offset:38912
  v_mfma_f32_16x16x32_bf16 v[116:119], a[188:191], a[4:7], 0
  ds_read_b64_tr_b16 a[172:173], v2 offset:40960
  s_add_u32 m0, s45, 94208
  s_add_u32 s61, s66, 229376
  v_mfma_f32_16x16x32_bf16 v[116:119], a[192:195], a[20:23], v[116:119]
  ds_read_b64_tr_b16 a[174:175], v2 offset:43008
  buffer_load_dwordx4 v11, s[32:35], s61 offen lds
  v_mfma_f32_16x16x32_bf16 v[112:115], a[192:195], a[16:19], 0
  ds_read_b64_tr_b16 a[168:169], v2 offset:45056
  v_mfma_f32_16x16x32_bf16 v[112:115], a[188:191], a[0:3], v[112:115]
  s_waitcnt lgkmcnt(7)
  ds_read_b64_tr_b16 a[170:171], v2 offset:47104
  v_mfma_f32_16x16x32_bf16 v[32:35], a[196:199], a[0:3], 0
  ds_read_b64_tr_b16 a[180:181], v3 offset:32768
  s_add_u32 m0, s45, 16384
  v_mfma_f32_16x16x32_bf16 v[32:35], a[200:203], a[16:19], v[32:35]
  ds_read_b64_tr_b16 a[182:183], v3 offset:34816
  buffer_load_dwordx4 v10, s[28:31], s66 offen lds
  v_mfma_f32_16x16x32_bf16 v[36:39], a[200:203], a[20:23], 0
  ds_read_b64_tr_b16 a[176:177], v3 offset:36864
  v_mfma_f32_16x16x32_bf16 v[36:39], a[196:199], a[4:7], v[36:39]
  ds_read_b64_tr_b16 a[178:179], v3 offset:38912
  v_mfma_f32_16x16x32_bf16 v[52:55], a[204:207], a[4:7], 0
  ds_read_b64_tr_b16 a[192:193], v3 offset:40960
  s_add_u32 m0, s45, 24576
  v_mfma_f32_16x16x32_bf16 v[52:55], a[208:211], a[20:23], v[52:55]
  ds_read_b64_tr_b16 a[194:195], v3 offset:43008
  buffer_load_dwordx4 v10, s[32:35], s66 offen lds
  v_mfma_f32_16x16x32_bf16 v[48:51], a[208:211], a[16:19], 0
  ds_read_b64_tr_b16 a[188:189], v3 offset:45056
  s_lshl_b32 s58, s51, 12
  v_mfma_f32_16x16x32_bf16 v[48:51], a[204:207], a[0:3], v[48:51]
  s_waitcnt lgkmcnt(7)
  ds_read_b64_tr_b16 a[190:191], v3 offset:47104
  v_mfma_f32_16x16x32_bf16 v[128:131], a[164:167], a[0:3], 0
  ds_read_b64_tr_b16 a[200:201], v4 offset:32768
  s_add_u32 m0, s45, 20480
  s_add_u32 s61, s66, 229376
  v_mfma_f32_16x16x32_bf16 v[128:131], a[160:163], a[16:19], v[128:131]
  ds_read_b64_tr_b16 a[202:203], v4 offset:34816
  s_lshl_b32 s83, s44, 28
  s_add_u32 s83, s83, s82
  buffer_load_dword v9, v15, s[8:11], s83 offen sc1
  v_mfma_f32_16x16x32_bf16 v[132:135], a[160:163], a[20:23], 0
  ds_read_b64_tr_b16 a[196:197], v4 offset:36864
  buffer_load_dwordx4 v10, s[28:31], s61 offen lds
  v_mfma_f32_16x16x32_bf16 v[132:135], a[164:167], a[4:7], v[132:135]
  ds_read_b64_tr_b16 a[198:199], v4 offset:38912
  s_lshl_b32 s54, s51, 3
  v_mfma_f32_16x16x32_bf16 v[148:151], a[172:175], a[4:7], 0
  ds_read_b64_tr_b16 a[208:209], v4 offset:40960
  s_add_u32 m0, s45, 28672
  s_add_u32 s61, s66, 229376
  v_mfma_f32_16x16x32_bf16 v[148:151], a[168:171], a[20:23], v[148:151]
  ds_read_b64_tr_b16 a[210:211], v4 offset:43008
  buffer_load_dwordx4 v10, s[32:35], s61 offen lds
  v_mfma_f32_16x16x32_bf16 v[144:147], a[168:171], a[16:19], 0
  ds_read_b64_tr_b16 a[204:205], v4 offset:45056
  s_lshr_b32 s53, 0x0b070602, s54
  v_mfma_f32_16x16x32_bf16 v[144:147], a[172:175], a[0:3], v[144:147]
  s_waitcnt lgkmcnt(7)
  ds_read_b64_tr_b16 a[206:207], v4 offset:47104
  v_mfma_f32_16x16x32_bf16 v[160:163], a[180:183], a[0:3], 0
  ds_read_b64_tr_b16 a[160:161], v5 offset:32768
  v_mfma_f32_16x16x32_bf16 v[160:163], a[176:179], a[16:19], v[160:163]
  ds_read_b64_tr_b16 a[162:163], v5 offset:34816
  buffer_load_dwordx4 a[64:67], v1, s[8:11], s74 offen offset:0 sc1
  v_mfma_f32_16x16x32_bf16 v[164:167], a[176:179], a[20:23], 0
  ds_read_b64_tr_b16 a[164:165], v5 offset:36864
  s_and_b32 s53, s53, 15
  v_mfma_f32_16x16x32_bf16 v[164:167], a[180:183], a[4:7], v[164:167]
  ds_read_b64_tr_b16 a[166:167], v5 offset:38912
  s_lshl_b32 s59, s53, 10
  v_mfma_f32_16x16x32_bf16 v[180:183], a[192:195], a[4:7], 0
  ds_read_b64_tr_b16 a[168:169], v5 offset:40960
  s_lshr_b32 s53, s51, 1
  v_mfma_f32_16x16x32_bf16 v[180:183], a[188:191], a[20:23], v[180:183]
  ds_read_b64_tr_b16 a[170:171], v5 offset:43008
  buffer_load_dwordx4 a[80:83], v1, s[8:11], s74 offen offset:1024 sc1
  v_mfma_f32_16x16x32_bf16 v[176:179], a[188:191], a[16:19], 0
  ds_read_b64_tr_b16 a[172:173], v5 offset:45056
  s_mul_i32 s53, s53, 7168
  v_mfma_f32_16x16x32_bf16 v[176:179], a[192:195], a[0:3], v[176:179]
  s_waitcnt lgkmcnt(7)
  ds_read_b64_tr_b16 a[174:175], v5 offset:47104
  s_waitcnt vmcnt(19)
  s_barrier
  v_mfma_f32_16x16x32_bf16 v[192:195], a[200:203], a[0:3], 0
  ds_read_b64_tr_b16 a[176:177], v6 offset:49152
  s_add_u32 s74, s74, 65536
  v_mfma_f32_16x16x32_bf16 v[192:195], a[196:199], a[16:19], v[192:195]
  ds_read_b64_tr_b16 a[178:179], v6 offset:51200
  buffer_load_dwordx4 a[68:71], v1, s[8:11], s74 offen offset:0 sc1
  v_mfma_f32_16x16x32_bf16 v[196:199], a[196:199], a[20:23], 0
  ds_read_b64_tr_b16 a[180:181], v6 offset:53248
  s_and_b32 s54, s54, 8
  v_mfma_f32_16x16x32_bf16 v[196:199], a[200:203], a[4:7], v[196:199]
  ds_read_b64_tr_b16 a[182:183], v6 offset:55296
  s_add_u32 s53, s53, s54
  v_mfma_f32_16x16x32_bf16 v[212:215], a[208:211], a[4:7], 0
  ds_read_b64_tr_b16 a[188:189], v6 offset:57344
  s_add_u32 s60, s53, 3072
  v_mfma_f32_16x16x32_bf16 v[212:215], a[204:207], a[20:23], v[212:215]
  ds_read_b64_tr_b16 a[190:191], v6 offset:59392
  buffer_load_dwordx4 a[84:87], v1, s[8:11], s74 offen offset:1024 sc1
  v_mfma_f32_16x16x32_bf16 v[208:211], a[204:207], a[16:19], 0
  ds_read_b64_tr_b16 a[192:193], v6 offset:61440
  s_mul_i32 s53, s52, 14336
  v_mfma_f32_16x16x32_bf16 v[208:211], a[208:211], a[0:3], v[208:211]
  s_waitcnt lgkmcnt(7)
  ds_read_b64_tr_b16 a[194:195], v6 offset:63488
  v_mfma_f32_16x16x32_bf16 v[224:227], a[160:163], a[0:3], 0
  ds_read_b64_tr_b16 a[196:197], v7 offset:49152
  s_mov_b32 s67, 1376256
  s_add_u32 s75, s57, 6144
  s_add_u32 m0, s45, 65536
  v_mfma_f32_16x16x32_bf16 v[224:227], a[164:167], a[16:19], v[224:227]
  ds_read_b64_tr_b16 a[198:199], v7 offset:51200
  buffer_load_dwordx4 v11, s[28:31], s67 offen lds
  v_mfma_f32_16x16x32_bf16 v[228:231], a[164:167], a[20:23], 0
  ds_read_b64_tr_b16 a[200:201], v7 offset:53248
  s_mul_i32 s54, s63, 131072
  v_mfma_f32_16x16x32_bf16 v[228:231], a[160:163], a[4:7], v[228:231]
  ds_read_b64_tr_b16 a[202:203], v7 offset:55296
  s_add_u32 s53, s53, s54
  v_mfma_f32_16x16x32_bf16 v[244:247], a[168:171], a[4:7], 0
  ds_read_b64_tr_b16 a[204:205], v7 offset:57344
  s_add_u32 m0, s45, 73728
  v_mfma_f32_16x16x32_bf16 v[244:247], a[172:175], a[20:23], v[244:247]
  ds_read_b64_tr_b16 a[206:207], v7 offset:59392
  buffer_load_dwordx4 v11, s[32:35], s67 offen lds
  v_mfma_f32_16x16x32_bf16 v[240:243], a[172:175], a[16:19], 0
  ds_read_b64_tr_b16 a[208:209], v7 offset:61440
  s_add_u32 s53, s53, 19922944
  v_mfma_f32_16x16x32_bf16 v[240:243], a[168:171], a[0:3], v[240:243]
  s_waitcnt vmcnt(15) lgkmcnt(7)
  ds_read_b64_tr_b16 a[210:211], v7 offset:63488
  v_mfma_f32_16x16x32_bf16 v[64:67], a[176:179], a[32:35], v[64:67]
  ds_read_b64_tr_b16 a[164:165], v8 offset:49152
  s_add_u32 m0, s45, 69632
  s_add_u32 s61, s67, 229376
  v_mfma_f32_16x16x32_bf16 v[64:67], a[180:183], a[48:51], v[64:67]
  ds_read_b64_tr_b16 a[166:167], v8 offset:51200
  buffer_load_dwordx4 v11, s[28:31], s61 offen lds
  v_mfma_f32_16x16x32_bf16 v[68:71], a[180:183], a[52:55], v[68:71]
  ds_read_b64_tr_b16 a[160:161], v8 offset:53248
  s_add_u32 s58, s58, s53
  v_mfma_f32_16x16x32_bf16 v[68:71], a[176:179], a[36:39], v[68:71]
  ds_read_b64_tr_b16 a[162:163], v8 offset:55296
  s_add_u32 s59, s59, s53
  v_mfma_f32_16x16x32_bf16 v[84:87], a[188:191], a[36:39], v[84:87]
  ds_read_b64_tr_b16 a[172:173], v8 offset:57344
  s_add_u32 m0, s45, 77824
  s_add_u32 s61, s67, 229376
  v_mfma_f32_16x16x32_bf16 v[84:87], a[192:195], a[52:55], v[84:87]
  ds_read_b64_tr_b16 a[174:175], v8 offset:59392
HOP7:
  s_cbranch_execz HOP11
  buffer_load_dwordx4 v11, s[32:35], s61 offen lds
  v_mfma_f32_16x16x32_bf16 v[80:83], a[192:195], a[48:51], v[80:83]
  ds_read_b64_tr_b16 a[168:169], v8 offset:61440
  s_add_u32 s60, s60, s53
  v_mfma_f32_16x16x32_bf16 v[80:83], a[188:191], a[32:35], v[80:83]
  s_waitcnt lgkmcnt(7)
  ds_read_b64_tr_b16 a[170:171], v8 offset:63488
  v_mfma_f32_16x16x32_bf16 v[96:99], a[196:199], a[32:35], v[96:99]
  ds_read_b64_tr_b16 a[180:181], v2 offset:49152
  s_add_u32 m0, s45, 0
  v_mfma_f32_16x16x32_bf16 v[96:99], a[200:203], a[48:51], v[96:99]
  ds_read_b64_tr_b16 a[182:183], v2 offset:51200
  s_waitcnt vmcnt(10)
  s_cmp_lg_u32 s44, 0
  s_cbranch_scc1 PL10_adaLN_cond__sliding_local_dilated__swiglu_ffn__prompt_kernelx
  v_cmp_ne_u32 vcc, s46, v9
  s_nop 4
  s_cbranch_vccz PL10_adaLN_cond__sliding_local_dilated__swiglu_ffn__prompt_kernelx
  s_mov_b32 s83, 60000
PL10_adaLN_cond__sliding_local_dilated__swiglu_ffn__prompt_kernel:
  buffer_load_dword v9, v15, s[8:11], s82 offen sc1
  s_sub_u32 s83, s83, 1
  s_cmp_eq_u32 s83, 0
  s_waitcnt vmcnt(0)
  s_cbranch_scc1 PL10_adaLN_cond__sliding_local_dilated__swiglu_ffn__prompt_kernelx
  v_cmp_ne_u32 vcc, s46, v9
  s_nop 4
  s_cbranch_vccnz PL10_adaLN_cond__sliding_local_dilated__swiglu_ffn__prompt_kernel
PL10_adaLN_cond__sliding_local_dilated__swiglu_ffn__prompt_kernelx:
  s_barrier
  v_mfma_f32_16x16x32_bf16 v[100:103], a[200:203], a[52:55], v[100:103]
  ds_read_b64_tr_b16 a[176:177], v2 offset:53248
  buffer_load_dwordx4 v10, s[28:31], s67 offen lds
  v_mfma_f32_16x16x32_bf16 v[100:103], a[196:199], a[36:39], v[100:103]
  ds_read_b64_tr_b16 a[178:179], v2 offset:55296
  s_lshl_b32 s63, s50, 2
  v_mfma_f32_16x16x32_bf16 v[116:119], a[204:207], a[36:39], v[116:119]
  ds_read_b64_tr_b16 a[192:193], v2 offset:57344
  s_add_u32 m0, s45, 8192
  v_mfma_f32_16x16x32_bf16 v[116:119], a[208:211], a[52:55], v[116:119]
  ds_read_b64_tr_b16 a[194:195], v2 offset:59392
  buffer_load_dwordx4 v10, s[32:35], s67 offen lds
  v_mfma_f32_16x16x32_bf16 v[112:115], a[208:211], a[48:51], v[112:115]
  ds_read_b64_tr_b16 a[188:189], v2 offset:61440
  s_add_u32 s63, s63, s44
  v_mfma_f32_16x16x32_bf16 v[112:115], a[204:207], a[32:35], v[112:115]
  s_waitcnt lgkmcnt(7)
  ds_read_b64_tr_b16 a[190:191], v2 offset:63488
  v_mfma_f32_16x16x32_bf16 v[32:35], a[164:167], a[32:35], v[32:35]
  ds_read_b64_tr_b16 a[200:201], v3 offset:49152
  s_add_u32 m0, s45, 4096
  s_add_u32 s61, s67, 229376
  v_mfma_f32_16x16x32_bf16 v[32:35], a[160:163], a[48:51], v[32:35]
  ds_read_b64_tr_b16 a[202:203], v3 offset:51200
  buffer_load_dwordx4 v10, s[28:31], s61 offen lds
  v_mfma_f32_16x16x32_bf16 v[36:39], a[160:163], a[52:55], v[36:39]
  ds_read_b64_tr_b16 a[196:197], v3 offset:53248
  s_lshl_b32 s63, s63, 14
  v_mfma_f32_16x16x32_bf16 v[36:39], a[164:167], a[36:39], v[36:39]
  ds_read_b64_tr_b16 a[198:199], v3 offset:55296
  s_add_u32 s63, s63, 6291456
  v_mfma_f32_16x16x32_bf16 v[52:55], a[172:175], a[36:39], v[52:55]
  ds_read_b64_tr_b16 a[208:209], v3 offset:57344
  s_add_u32 m0, s45, 12288
  s_add_u32 s61, s67, 229376
  v_mfma_f32_16x16x32_bf16 v[52:55], a[168:171], a[52:55], v[52:55]
  ds_read_b64_tr_b16 a[210:211], v3 offset:59392
  buffer_load_dwordx4 v10, s[32:35], s61 offen lds
  v_mfma_f32_16x16x32_bf16 v[48:51], a[168:171], a[48:51], v[48:51]
  ds_read_b64_tr_b16 a[204:205], v3 offset:61440
  v_and_b32 v12, 0x300, v1
  v_mfma_f32_16x16x32_bf16 v[48:51], a[172:175], a[32:35], v[48:51]
  s_waitcnt lgkmcnt(7)
  ds_read_b64_tr_b16 a[206:207], v3 offset:63488
  v_mfma_f32_16x16x32_bf16 v[128:131], a[180:183], a[32:35], v[128:131]
  ds_read_b64_tr_b16 a[160:161], v4 offset:49152
  s_add_u32 s72, s72, 65536
  v_mfma_f32_16x16x32_bf16 v[128:131], a[176:179], a[48:51], v[128:131]
  ds_read_b64_tr_b16 a[162:163], v4 offset:51200
  buffer_load_dwordx4 a[8:11], v1, s[8:11], s72 offen offset:0 sc1
  v_mfma_f32_16x16x32_bf16 v[132:135], a[176:179], a[52:55], v[132:135]
  ds_read_b64_tr_b16 a[164:165], v4 offset:53248
  v_add_u32 v12, v12, v1
  v_mfma_f32_16x16x32_bf16 v[132:135], a[180:183], a[36:39], v[132:135]
  ds_read_b64_tr_b16 a[166:167], v4 offset:55296
  buffer_load_dwordx4 a[24:27], v1, s[8:11], s72 offen offset:1024 sc1
  v_mfma_f32_16x16x32_bf16 v[148:151], a[192:195], a[36:39], v[148:151]
  ds_read_b64_tr_b16 a[168:169], v4 offset:57344
  s_add_u32 s72, s72, 65536
  v_mfma_f32_16x16x32_bf16 v[148:151], a[188:191], a[52:55], v[148:151]
  ds_read_b64_tr_b16 a[170:171], v4 offset:59392
  buffer_load_dwordx4 a[12:15], v1, s[8:11], s72 offen offset:0 sc1
  v_mfma_f32_16x16x32_bf16 v[144:147], a[188:191], a[48:51], v[144:147]
  ds_read_b64_tr_b16 a[172:173], v4 offset:61440
  v_mfma_f32_16x16x32_bf16 v[144:147], a[192:195], a[32:35], v[144:147]
  s_waitcnt lgkmcnt(7)
  ds_read_b64_tr_b16 a[174:175], v4 offset:63488
  buffer_load_dwordx4 a[28:31], v1, s[8:11], s72 offen offset:1024 sc1
  v_mfma_f32_16x16x32_bf16 v[160:163], a[200:203], a[32:35], v[160:163]
  ds_read_b64_tr_b16 a[176:177], v5 offset:49152
  s_add_u32 s73, s73, 65536
  v_mfma_f32_16x16x32_bf16 v[160:163], a[196:199], a[48:51], v[160:163]
  ds_read_b64_tr_b16 a[178:179], v5 offset:51200
  buffer_load_dwordx4 a[40:43], v1, s[8:11], s73 offen offset:0 sc1
  v_mfma_f32_16x16x32_bf16 v[164:167], a[196:199], a[52:55], v[164:167]
  ds_read_b64_tr_b16 a[180:181], v5 offset:53248
  v_mfma_f32_16x16x32_bf16 v[164:167], a[200:203], a[36:39], v[164:167]
  ds_read_b64_tr_b16 a[182:183], v5 offset:55296
  buffer_load_dwordx4 a[56:59], v1, s[8:11], s73 offen offset:1024 sc1
  v_mfma_f32_16x16x32_bf16 v[180:183], a[208:211], a[36:39], v[180:183]
  ds_read_b64_tr_b16 a[188:189], v5 offset:57344
  s_add_u32 s73, s73, 65536
  v_mfma_f32_16x16x32_bf16 v[180:183], a[204:207], a[52:55], v[180:183]
  ds_read_b64_tr_b16 a[190:191], v5 offset:59392
  buffer_load_dwordx4 a[44:47], v1, s[8:11], s73 offen offset:0 sc1
  v_mfma_f32_16x16x32_bf16 v[176:179], a[204:207], a[48:51], v[176:179]
  ds_read_b64_tr_b16 a[192:193], v5 offset:61440
  v_mfma_f32_16x16x32_bf16 v[176:179], a[208:211], a[32:35], v[176:179]
  s_waitcnt lgkmcnt(7)
  ds_read_b64_tr_b16 a[194:195], v5 offset:63488
  buffer_load_dwordx4 a[60:63], v1, s[8:11], s73 offen offset:1024 sc1
  v_mfma_f32_16x16x32_bf16 v[192:195], a[160:163], a[32:35], v[192:195]
  ds_read_b64_tr_b16 a[196:197], v6 offset:32768
  s_add_u32 s74, s74, 65536
  v_mfma_f32_16x16x32_bf16 v[192:195], a[164:167], a[48:51], v[192:195]
  ds_read_b64_tr_b16 a[198:199], v6 offset:34816
  buffer_load_dwordx4 a[72:75], v1, s[8:11], s74 offen offset:0 sc1
  v_mfma_f32_16x16x32_bf16 v[196:199], a[164:167], a[52:55], v[196:199]
  ds_read_b64_tr_b16 a[200:201], v6 offset:36864
  v_mfma_f32_16x16x32_bf16 v[196:199], a[160:163], a[36:39], v[196:199]
  ds_read_b64_tr_b16 a[202:203], v6 offset:38912
  v_mfma_f32_16x16x32_bf16 v[212:215], a[168:171], a[36:39], v[212:215]
  ds_read_b64_tr_b16 a[204:205], v6 offset:40960
  s_mov_b32 s62, 0
  v_mfma_f32_16x16x32_bf16 v[212:215], a[172:175], a[52:55], v[212:215]
  ds_read_b64_tr_b16 a[206:207], v6 offset:43008
  buffer_load_dwordx4 a[220:223], v13, s[12:15], s62 offen
  v_mfma_f32_16x16x32_bf16 v[208:211], a[172:175], a[48:51], v[208:211]
  ds_read_b64_tr_b16 a[208:209], v6 offset:45056
  s_mov_b32 s62, 7168
  v_mfma_f32_16x16x32_bf16 v[208:211], a[168:171], a[32:35], v[208:211]
  s_waitcnt lgkmcnt(7)
  ds_read_b64_tr_b16 a[210:211], v6 offset:47104
  buffer_load_dwordx4 a[224:227], v13, s[12:15], s62 offen
  v_mfma_f32_16x16x32_bf16 v[224:227], a[176:179], a[32:35], v[224:227]
  ds_read_b64_tr_b16 a[164:165], v7 offset:32768
  s_mov_b32 s62, 14336
  v_mfma_f32_16x16x32_bf16 v[224:227], a[180:183], a[48:51], v[224:227]
  ds_read_b64_tr_b16 a[166:167], v7 offset:34816
  buffer_load_dwordx4 a[228:231], v13, s[12:15], s62 offen
  s_mov_b32 s62, 21504
  v_mfma_f32_16x16x32_bf16 v[228:231], a[180:183], a[52:55], v[228:231]
  ds_read_b64_tr_b16 a[160:161], v7 offset:36864
  buffer_load_dwordx4 a[232:235], v13, s[12:15], s62 offen
  v_mfma_f32_16x16x32_bf16 v[228:231], a[176:179], a[36:39], v[228:231]
  ds_read_b64_tr_b16 a[162:163], v7 offset:38912
  v_mfma_f32_16x16x32_bf16 v[244:247], a[188:191], a[36:39], v[244:247]
  ds_read_b64_tr_b16 a[172:173], v7 offset:40960
  v_mfma_f32_16x16x32_bf16 v[244:247], a[192:195], a[52:55], v[244:247]
  ds_read_b64_tr_b16 a[174:175], v7 offset:43008
  v_mfma_f32_16x16x32_bf16 v[240:243], a[192:195], a[48:51], v[240:243]
  ds_read_b64_tr_b16 a[168:169], v7 offset:45056
  v_mfma_f32_16x16x32_bf16 v[240:243], a[188:191], a[32:35], v[240:243]
  s_waitcnt vmcnt(9) lgkmcnt(7)
  ds_read_b64_tr_b16 a[170:171], v7 offset:47104
  v_mfma_f32_16x16x32_bf16 v[72:75], a[196:199], a[8:11], 0
  ds_read_b64_tr_b16 a[180:181], v8 offset:32768
  v_mfma_f32_16x16x32_bf16 v[72:75], a[200:203], a[24:27], v[72:75]
  ds_read_b64_tr_b16 a[182:183], v8 offset:34816
  v_mfma_f32_16x16x32_bf16 v[76:79], a[200:203], a[28:31], 0
  ds_read_b64_tr_b16 a[176:177], v8 offset:36864
  v_mfma_f32_16x16x32_bf16 v[76:79], a[196:199], a[12:15], v[76:79]
  ds_read_b64_tr_b16 a[178:179], v8 offset:38912
  v_mfma_f32_16x16x32_bf16 v[92:95], a[204:207], a[12:15], 0
  ds_read_b64_tr_b16 a[192:193], v8 offset:40960
  v_mfma_f32_16x16x32_bf16 v[92:95], a[208:211], a[28:31], v[92:95]
  ds_read_b64_tr_b16 a[194:195], v8 offset:43008
  v_mfma_f32_16x16x32_bf16 v[88:91], a[208:211], a[24:27], 0
  ds_read_b64_tr_b16 a[188:189], v8 offset:45056
  v_mfma_f32_16x16x32_bf16 v[88:91], a[204:207], a[8:11], v[88:91]
  s_waitcnt lgkmcnt(7)
  ds_read_b64_tr_b16 a[190:191], v8 offset:47104
  v_mfma_f32_16x16x32_bf16 v[104:107], a[164:167], a[8:11], 0
  ds_read_b64_tr_b16 a[200:201], v2 offset:32768
  v_mfma_f32_16x16x32_bf16 v[104:107], a[160:163], a[24:27], v[104:107]
  ds_read_b64_tr_b16 a[202:203], v2 offset:34816
  v_mfma_f32_16x16x32_bf16 v[108:111], a[160:163], a[28:31], 0
  ds_read_b64_tr_b16 a[196:197], v2 offset:36864
  v_mfma_f32_16x16x32_bf16 v[108:111], a[164:167], a[12:15], v[108:111]
  ds_read_b64_tr_b16 a[198:199], v2 offset:38912
  v_mfma_f32_16x16x32_bf16 v[124:127], a[172:175], a[12:15], 0
  ds_read_b64_tr_b16 a[208:209], v2 offset:40960
  v_mfma_f32_16x16x32_bf16 v[124:127], a[168:171], a[28:31], v[124:127]
  ds_read_b64_tr_b16 a[210:211], v2 offset:43008
  v_mfma_f32_16x16x32_bf16 v[120:123], a[168:171], a[24:27], 0
  ds_read_b64_tr_b16 a[204:205], v2 offset:45056
  v_mfma_f32_16x16x32_bf16 v[120:123], a[172:175], a[8:11], v[120:123]
  s_waitcnt lgkmcnt(7)
  ds_read_b64_tr_b16 a[206:207], v2 offset:47104
  v_mfma_f32_16x16x32_bf16 v[40:43], a[180:183], a[8:11], 0
  ds_read_b64_tr_b16 a[160:161], v3 offset:32768
  v_mfma_f32_16x16x32_bf16 v[40:43], a[176:179], a[24:27], v[40:43]
  ds_read_b64_tr_b16 a[162:163], v3 offset:34816
  v_mfma_f32_16x16x32_bf16 v[44:47], a[176:179], a[28:31], 0
  ds_read_b64_tr_b16 a[164:165], v3 offset:36864
  buffer_load_dwordx4 a[88:91], v1, s[8:11], s74 offen offset:1024 sc1
  v_mfma_f32_16x16x32_bf16 v[44:47], a[180:183], a[12:15], v[44:47]
  ds_read_b64_tr_b16 a[166:167], v3 offset:38912
  v_mfma_f32_16x16x32_bf16 v[60:63], a[192:195], a[12:15], 0
  ds_read_b64_tr_b16 a[168:169], v3 offset:40960
  v_mfma_f32_16x16x32_bf16 v[60:63], a[188:191], a[28:31], v[60:63]
  ds_read_b64_tr_b16 a[170:171], v3 offset:43008
  v_mfma_f32_16x16x32_bf16 v[56:59], a[188:191], a[24:27], 0
  ds_read_b64_tr_b16 a[172:173], v3 offset:45056
  s_add_u32 s74, s74, 65536
  v_mfma_f32_16x16x32_bf16 v[56:59], a[192:195], a[8:11], v[56:59]
  s_waitcnt lgkmcnt(7)
  ds_read_b64_tr_b16 a[174:175], v3 offset:47104
  v_mfma_f32_16x16x32_bf16 v[136:139], a[200:203], a[8:11], 0
  ds_read_b64_tr_b16 a[176:177], v4 offset:32768
  buffer_load_dwordx4 a[76:79], v1, s[8:11], s74 offen offset:0 sc1
  v_mfma_f32_16x16x32_bf16 v[136:139], a[196:199], a[24:27], v[136:139]
  ds_read_b64_tr_b16 a[178:179], v4 offset:34816
  v_mfma_f32_16x16x32_bf16 v[140:143], a[196:199], a[28:31], 0
  ds_read_b64_tr_b16 a[180:181], v4 offset:36864
  v_mfma_f32_16x16x32_bf16 v[140:143], a[200:203], a[12:15], v[140:143]
  ds_read_b64_tr_b16 a[182:183], v4 offset:38912
  v_mfma_f32_16x16x32_bf16 v[156:159], a[208:211], a[12:15], 0
  ds_read_b64_tr_b16 a[188:189], v4 offset:40960
  buffer_load_dwordx4 a[92:95], v1, s[8:11], s74 offen offset:1024 sc1
  v_mfma_f32_16x16x32_bf16 v[156:159], a[204:207], a[28:31], v[156:159]
  ds_read_b64_tr_b16 a[190:191], v4 offset:43008
  v_mfma_f32_16x16x32_bf16 v[152:155], a[204:207], a[24:27], 0
  ds_read_b64_tr_b16 a[192:193], v4 offset:45056
  v_mfma_f32_16x16x32_bf16 v[152:155], a[208:211], a[8:11], v[152:155]
  s_waitcnt lgkmcnt(7)
  ds_read_b64_tr_b16 a[194:195], v4 offset:47104
  v_mfma_f32_16x16x32_bf16 v[168:171], a[160:163], a[8:11], 0
  ds_read_b64_tr_b16 a[196:197], v5 offset:32768
  v_mfma_f32_16x16x32_bf16 v[168:171], a[164:167], a[24:27], v[168:171]
  ds_read_b64_tr_b16 a[198:199], v5 offset:34816
  buffer_load_dwordx4 a[96:99], v1, s[8:11], s75 offen offset:0 sc1
  v_mfma_f32_16x16x32_bf16 v[172:175], a[164:167], a[28:31], 0
  ds_read_b64_tr_b16 a[200:201], v5 offset:36864
  v_mfma_f32_16x16x32_bf16 v[172:175], a[160:163], a[12:15], v[172:175]
  ds_read_b64_tr_b16 a[202:203], v5 offset:38912
  v_mfma_f32_16x16x32_bf16 v[188:191], a[168:171], a[12:15], 0
  ds_read_b64_tr_b16 a[204:205], v5 offset:40960
  v_mfma_f32_16x16x32_bf16 v[188:191], a[172:175], a[28:31], v[188:191]
  ds_read_b64_tr_b16 a[206:207], v5 offset:43008
  v_mfma_f32_16x16x32_bf16 v[184:187], a[172:175], a[24:27], 0
  ds_read_b64_tr_b16 a[208:209], v5 offset:45056
  buffer_load_dwordx4 a[112:115], v1, s[8:11], s75 offen offset:1024 sc1
  v_mfma_f32_16x16x32_bf16 v[184:187], a[168:171], a[8:11], v[184:187]
  s_waitcnt lgkmcnt(7)
  ds_read_b64_tr_b16 a[210:211], v5 offset:47104
  v_mfma_f32_16x16x32_bf16 v[200:203], a[176:179], a[8:11], 0
  ds_read_b64_tr_b16 a[164:165], v6 offset:49152
  v_mfma_f32_16x16x32_bf16 v[200:203], a[180:183], a[24:27], v[200:203]
  ds_read_b64_tr_b16 a[166:167], v6 offset:51200
  v_mfma_f32_16x16x32_bf16 v[204:207], a[180:183], a[28:31], 0
  ds_read_b64_tr_b16 a[160:161], v6 offset:53248
  s_add_u32 s75, s75, 65536
  v_mfma_f32_16x16x32_bf16 v[204:207], a[176:179], a[12:15], v[204:207]
  ds_read_b64_tr_b16 a[162:163], v6 offset:55296
  buffer_load_dwordx4 a[100:103], v1, s[8:11], s75 offen offset:0 sc1
  v_mfma_f32_16x16x32_bf16 v[220:223], a[188:191], a[12:15], 0
  ds_read_b64_tr_b16 a[172:173], v6 offset:57344
  v_mfma_f32_16x16x32_bf16 v[220:223], a[192:195], a[28:31], v[220:223]
  ds_read_b64_tr_b16 a[174:175], v6 offset:59392
  v_mfma_f32_16x16x32_bf16 v[216:219], a[192:195], a[24:27], 0
  ds_read_b64_tr_b16 a[168:169], v6 offset:61440
  v_mfma_f32_16x16x32_bf16 v[216:219], a[188:191], a[8:11], v[216:219]
  s_waitcnt lgkmcnt(7)
  ds_read_b64_tr_b16 a[170:171], v6 offset:63488
  v_mfma_f32_16x16x32_bf16 v[232:235], a[196:199], a[8:11], 0
  ds_read_b64_tr_b16 a[180:181], v7 offset:49152
  buffer_load_dwordx4 a[116:119], v1, s[8:11], s75 offen offset:1024 sc1
  v_mfma_f32_16x16x32_bf16 v[232:235], a[200:203], a[24:27], v[232:235]
  ds_read_b64_tr_b16 a[182:183], v7 offset:51200
  v_mfma_f32_16x16x32_bf16 v[236:239], a[200:203], a[28:31], 0
  ds_read_b64_tr_b16 a[176:177], v7 offset:53248
  v_mfma_f32_16x16x32_bf16 v[236:239], a[196:199], a[12:15], v[236:239]
  ds_read_b64_tr_b16 a[178:179], v7 offset:55296
  s_add_u32 s75, s75, 65536
  v_mfma_f32_16x16x32_bf16 v[252:255], a[204:207], a[12:15], 0
  ds_read_b64_tr_b16 a[192:193], v7 offset:57344
  s_barrier
  v_mfma_f32_16x16x32_bf16 v[252:255], a[208:211], a[28:31], v[252:255]
  ds_read_b64_tr_b16 a[194:195], v7 offset:59392
  buffer_load_dwordx4 a[104:107], v1, s[8:11], s75 offen offset:0 sc1
  v_mfma_f32_16x16x32_bf16 v[248:251], a[208:211], a[24:27], 0
  ds_read_b64_tr_b16 a[188:189], v7 offset:61440
  v_mfma_f32_16x16x32_bf16 v[248:251], a[204:207], a[8:11], v[248:251]
  s_waitcnt vmcnt(13) lgkmcnt(7)
  ds_read_b64_tr_b16 a[190:191], v7 offset:63488
  v_mfma_f32_16x16x32_bf16 v[72:75], a[164:167], a[40:43], v[72:75]
  ds_read_b64_tr_b16 a[200:201], v8 offset:49152
  v_mfma_f32_16x16x32_bf16 v[72:75], a[160:163], a[56:59], v[72:75]
  ds_read_b64_tr_b16 a[202:203], v8 offset:51200
  v_mfma_f32_16x16x32_bf16 v[76:79], a[160:163], a[60:63], v[76:79]
  ds_read_b64_tr_b16 a[196:197], v8 offset:53248
  buffer_load_dwordx4 a[120:123], v1, s[8:11], s75 offen offset:1024 sc1
  v_mfma_f32_16x16x32_bf16 v[76:79], a[164:167], a[44:47], v[76:79]
  ds_read_b64_tr_b16 a[198:199], v8 offset:55296
  v_mfma_f32_16x16x32_bf16 v[92:95], a[172:175], a[44:47], v[92:95]
  ds_read_b64_tr_b16 a[208:209], v8 offset:57344
  v_mfma_f32_16x16x32_bf16 v[92:95], a[168:171], a[60:63], v[92:95]
  ds_read_b64_tr_b16 a[210:211], v8 offset:59392
  v_mfma_f32_16x16x32_bf16 v[88:91], a[168:171], a[56:59], v[88:91]
  ds_read_b64_tr_b16 a[204:205], v8 offset:61440
  s_mov_b32 s62, 28672
  v_mfma_f32_16x16x32_bf16 v[88:91], a[172:175], a[40:43], v[88:91]
  s_waitcnt lgkmcnt(7)
  ds_read_b64_tr_b16 a[206:207], v8 offset:63488
  buffer_load_dwordx4 a[236:239], v13, s[12:15], s62 offen
  v_mfma_f32_16x16x32_bf16 v[104:107], a[180:183], a[40:43], v[104:107]
  ds_read_b64_tr_b16 a[160:161], v2 offset:49152
  s_mov_b32 s62, 35840
  v_mfma_f32_16x16x32_bf16 v[104:107], a[176:179], a[56:59], v[104:107]
  ds_read_b64_tr_b16 a[162:163], v2 offset:51200
  buffer_load_dwordx4 a[240:243], v13, s[12:15], s62 offen
  v_mfma_f32_16x16x32_bf16 v[108:111], a[176:179], a[60:63], v[108:111]
  ds_read_b64_tr_b16 a[164:165], v2 offset:53248
  s_mov_b32 s62, 43008
  v_mfma_f32_16x16x32_bf16 v[108:111], a[180:183], a[44:47], v[108:111]
  ds_read_b64_tr_b16 a[166:167], v2 offset:55296
  buffer_load_dwordx4 a[244:247], v13, s[12:15], s62 offen
  v_mfma_f32_16x16x32_bf16 v[124:127], a[192:195], a[44:47], v[124:127]
  ds_read_b64_tr_b16 a[168:169], v2 offset:57344
  s_mov_b32 s62, 50176
  v_mfma_f32_16x16x32_bf16 v[124:127], a[188:191], a[60:63], v[124:127]
  ds_read_b64_tr_b16 a[170:171], v2 offset:59392
  buffer_load_dwordx4 a[248:251], v13, s[12:15], s62 offen
  v_mfma_f32_16x16x32_bf16 v[120:123], a[188:191], a[56:59], v[120:123]
  ds_read_b64_tr_b16 a[172:173], v2 offset:61440
  v_mfma_f32_16x16x32_bf16 v[120:123], a[192:195], a[40:43], v[120:123]
  s_waitcnt lgkmcnt(7)
  ds_read_b64_tr_b16 a[174:175], v2 offset:63488
  v_mfma_f32_16x16x32_bf16 v[40:43], a[200:203], a[40:43], v[40:43]
  ds_read_b64_tr_b16 a[176:177], v3 offset:49152
  v_mfma_f32_16x16x32_bf16 v[40:43], a[196:199], a[56:59], v[40:43]
  ds_read_b64_tr_b16 a[178:179], v3 offset:51200
  v_mfma_f32_16x16x32_bf16 v[44:47], a[196:199], a[60:63], v[44:47]
  ds_read_b64_tr_b16 a[180:181], v3 offset:53248
  v_mfma_f32_16x16x32_bf16 v[44:47], a[200:203], a[44:47], v[44:47]
  ds_read_b64_tr_b16 a[182:183], v3 offset:55296
  v_mfma_f32_16x16x32_bf16 v[60:63], a[208:211], a[44:47], v[60:63]
  ds_read_b64_tr_b16 a[188:189], v3 offset:57344
  v_mfma_f32_16x16x32_bf16 v[60:63], a[204:207], a[60:63], v[60:63]
  ds_read_b64_tr_b16 a[190:191], v3 offset:59392
  v_mfma_f32_16x16x32_bf16 v[56:59], a[204:207], a[56:59], v[56:59]
  ds_read_b64_tr_b16 a[192:193], v3 offset:61440
  v_mfma_f32_16x16x32_bf16 v[56:59], a[208:211], a[40:43], v[56:59]
  s_waitcnt lgkmcnt(7)
  ds_read_b64_tr_b16 a[194:195], v3 offset:63488
  v_mfma_f32_16x16x32_bf16 v[136:139], a[160:163], a[40:43], v[136:139]
  ds_read_b64_tr_b16 a[196:197], v4 offset:49152
  v_mfma_f32_16x16x32_bf16 v[136:139], a[164:167], a[56:59], v[136:139]
  ds_read_b64_tr_b16 a[198:199], v4 offset:51200
  v_mfma_f32_16x16x32_bf16 v[140:143], a[164:167], a[60:63], v[140:143]
  ds_read_b64_tr_b16 a[200:201], v4 offset:53248
  v_mfma_f32_16x16x32_bf16 v[140:143], a[160:163], a[44:47], v[140:143]
  ds_read_b64_tr_b16 a[202:203], v4 offset:55296
  v_mfma_f32_16x16x32_bf16 v[156:159], a[168:171], a[44:47], v[156:159]
  ds_read_b64_tr_b16 a[204:205], v4 offset:57344
  v_mfma_f32_16x16x32_bf16 v[156:159], a[172:175], a[60:63], v[156:159]
  ds_read_b64_tr_b16 a[206:207], v4 offset:59392
  v_mfma_f32_16x16x32_bf16 v[152:155], a[172:175], a[56:59], v[152:155]
  ds_read_b64_tr_b16 a[208:209], v4 offset:61440
  v_mfma_f32_16x16x32_bf16 v[152:155], a[168:171], a[40:43], v[152:155]
  s_waitcnt lgkmcnt(7)
  ds_read_b64_tr_b16 a[210:211], v4 offset:63488
  v_mfma_f32_16x16x32_bf16 v[168:171], a[176:179], a[40:43], v[168:171]
  ds_read_b64_tr_b16 a[164:165], v5 offset:49152
  ds_read_b128 v[24:27], v14 offset:0
  v_mfma_f32_16x16x32_bf16 v[168:171], a[180:183], a[56:59], v[168:171]
  ds_read_b64_tr_b16 a[166:167], v5 offset:51200
  v_mfma_f32_16x16x32_bf16 v[172:175], a[180:183], a[60:63], v[172:175]
  ds_read_b64_tr_b16 a[160:161], v5 offset:53248
  v_mfma_f32_16x16x32_bf16 v[172:175], a[176:179], a[44:47], v[172:175]
  ds_read_b64_tr_b16 a[162:163], v5 offset:55296
  v_mfma_f32_16x16x32_bf16 v[188:191], a[188:191], a[44:47], v[188:191]
  ds_read_b64_tr_b16 a[172:173], v5 offset:57344
  v_mfma_f32_16x16x32_bf16 v[188:191], a[192:195], a[60:63], v[188:191]
  ds_read_b64_tr_b16 a[174:175], v5 offset:59392
  s_waitcnt vmcnt(38)
  s_barrier
  v_mfma_f32_16x16x32_bf16 v[184:187], a[192:195], a[56:59], v[184:187]
  ds_read_b64_tr_b16 a[168:169], v5 offset:61440
  ds_read_b64_tr_b16 a[180:181], v6 offset:16384
  v_mfma_f32_16x16x32_bf16 v[184:187], a[188:191], a[40:43], v[184:187]
  s_waitcnt lgkmcnt(9)
  ds_read_b64_tr_b16 a[170:171], v5 offset:63488
  v_mfma_f32_16x16x32_bf16 v[200:203], a[196:199], a[40:43], v[200:203]
  ds_read_b64_tr_b16 a[182:183], v6 offset:18432
  s_waitcnt vmcnt(13) lgkmcnt(9)
  v_mfma_f32_16x16x32_bf16 v[200:203], a[200:203], a[56:59], v[200:203]
  s_add_u32 s75, s75, 65536
  v_cndmask_b32 v28, 0, v24, s[16:17]
  v_cndmask_b32 v29, 0, v24, s[18:19]
  v_mfma_f32_16x16x32_bf16 v[204:207], a[200:203], a[60:63], v[204:207]
  ds_read_b64_tr_b16 a[176:177], v6 offset:20480
  v_cndmask_b32 v30, 0, v24, s[20:21]
  v_mfma_f32_16x16x32_bf16 v[204:207], a[196:199], a[44:47], v[204:207]
  buffer_load_dwordx4 a[108:111], v1, s[8:11], s75 offen offset:0 sc1
  v_cndmask_b32 v31, 0, v24, s[22:23]
  v_mfma_f32_16x16x32_bf16 v[220:223], a[204:207], a[44:47], v[220:223]
  ds_read_b64_tr_b16 a[178:179], v6 offset:22528
  v_mfma_f32_16x16x32_bf16 a[184:187], v[28:31], a[220:223], 0
  v_cndmask_b32 v28, 0, v25, s[16:17]
  v_cndmask_b32 v29, 0, v25, s[18:19]
  v_mfma_f32_16x16x32_bf16 v[220:223], a[208:211], a[60:63], v[220:223]
  v_cndmask_b32 v30, 0, v25, s[20:21]
  v_cndmask_b32 v31, 0, v25, s[22:23]
  v_mfma_f32_16x16x32_bf16 v[216:219], a[208:211], a[56:59], v[216:219]
  ds_read_b64_tr_b16 a[192:193], v6 offset:24576
  v_mfma_f32_16x16x32_bf16 a[184:187], v[28:31], a[224:227], a[184:187]
  v_cndmask_b32 v28, 0, v26, s[16:17]
  v_cndmask_b32 v29, 0, v26, s[18:19]
  v_mfma_f32_16x16x32_bf16 v[216:219], a[204:207], a[40:43], v[216:219]
  s_waitcnt lgkmcnt(4)
  v_cndmask_b32 v30, 0, v26, s[20:21]
  v_cndmask_b32 v31, 0, v26, s[22:23]
  v_mfma_f32_16x16x32_bf16 v[232:235], a[164:167], a[40:43], v[232:235]
  ds_read_b64_tr_b16 a[194:195], v6 offset:26624
  v_mfma_f32_16x16x32_bf16 a[184:187], v[28:31], a[228:231], a[184:187]
  v_cndmask_b32 v28, 0, v27, s[16:17]
  v_cndmask_b32 v29, 0, v27, s[18:19]
  v_mfma_f32_16x16x32_bf16 v[232:235], a[160:163], a[56:59], v[232:235]
  buffer_load_dwordx4 a[124:127], v1, s[8:11], s75 offen offset:1024 sc1
  v_cndmask_b32 v30, 0, v27, s[20:21]
  v_cndmask_b32 v31, 0, v27, s[22:23]
  v_mfma_f32_16x16x32_bf16 v[236:239], a[160:163], a[60:63], v[236:239]
  ds_read_b64_tr_b16 a[188:189], v6 offset:28672
  v_mfma_f32_16x16x32_bf16 a[184:187], v[28:31], a[232:235], a[184:187]
  v_mfma_f32_16x16x32_bf16 v[236:239], a[164:167], a[44:47], v[236:239]
  s_mov_b32 s68, 1835008
  s_add_u32 s76, s57, 8192
  s_add_u32 m0, s45, 98304
  v_mfma_f32_16x16x32_bf16 v[252:255], a[172:175], a[44:47], v[252:255]
  ds_read_b64_tr_b16 a[190:191], v6 offset:30720
  v_mfma_f32_16x16x32_bf16 v[252:255], a[168:171], a[60:63], v[252:255]
  buffer_load_dwordx4 v11, s[28:31], s68 offen lds
  v_mfma_f32_16x16x32_bf16 v[248:251], a[168:171], a[56:59], v[248:251]
  ds_read_b64_tr_b16 a[200:201], v7 offset:16384
  v_mfma_f32_16x16x32_bf16 v[248:251], a[172:175], a[40:43], v[248:251]
  s_waitcnt vmcnt(13) lgkmcnt(5)
  v_mfma_f32_16x16x32_bf16 v[64:67], a[180:183], a[64:67], v[64:67]
  ds_read_b64_tr_b16 a[202:203], v7 offset:18432
  v_mfma_f32_16x16x32_bf16 v[64:67], a[176:179], a[80:83], v[64:67]
  s_add_u32 m0, s45, 106496
  v_mfma_f32_16x16x32_bf16 v[68:71], a[176:179], a[84:87], v[68:71]
  ds_read_b64_tr_b16 a[196:197], v7 offset:20480
  v_mfma_f32_16x16x32_bf16 v[68:71], a[180:183], a[68:71], v[68:71]
  buffer_load_dwordx4 v11, s[32:35], s68 offen lds
  v_mfma_f32_16x16x32_bf16 v[72:75], a[180:183], a[72:75], v[72:75]
  ds_read_b64_tr_b16 a[198:199], v7 offset:22528
  v_mfma_f32_16x16x32_bf16 v[72:75], a[176:179], a[88:91], v[72:75]
  s_add_u32 m0, s45, 102400
  s_add_u32 s61, s68, 229376
  v_mfma_f32_16x16x32_bf16 v[76:79], a[176:179], a[92:95], v[76:79]
  ds_read_b64_tr_b16 a[160:161], v7 offset:24576
  v_mfma_f32_16x16x32_bf16 v[76:79], a[180:183], a[76:79], v[76:79]
  s_waitcnt lgkmcnt(5)
  buffer_load_dwordx4 v11, s[28:31], s61 offen lds
  v_mfma_f32_16x16x32_bf16 v[92:95], a[192:195], a[76:79], v[92:95]
  ds_read_b64_tr_b16 a[162:163], v7 offset:26624
  v_mfma_f32_16x16x32_bf16 v[92:95], a[188:191], a[92:95], v[92:95]
  v_mfma_f32_16x16x32_bf16 v[88:91], a[188:191], a[88:91], v[88:91]
  ds_read_b64_tr_b16 a[164:165], v7 offset:28672
  v_mfma_f32_16x16x32_bf16 v[88:91], a[192:195], a[72:75], v[88:91]
  s_add_u32 m0, s45, 110592
  s_add_u32 s61, s68, 229376
  v_mfma_f32_16x16x32_bf16 v[84:87], a[192:195], a[68:71], v[84:87]
  ds_read_b64_tr_b16 a[166:167], v7 offset:30720
  v_mfma_f32_16x16x32_bf16 v[84:87], a[188:191], a[84:87], v[84:87]
  buffer_load_dwordx4 v11, s[32:35], s61 offen lds
  v_mfma_f32_16x16x32_bf16 v[80:83], a[188:191], a[80:83], v[80:83]
  ds_read_b64_tr_b16 a[168:169], v8 offset:16384
  v_mfma_f32_16x16x32_bf16 v[80:83], a[192:195], a[64:67], v[80:83]
  s_waitcnt lgkmcnt(5)
  s_add_u32 m0, s45, 32768
  v_mfma_f32_16x16x32_bf16 v[96:99], a[200:203], a[64:67], v[96:99]
  ds_read_b64_tr_b16 a[170:171], v8 offset:18432
  v_mfma_f32_16x16x32_bf16 v[96:99], a[196:199], a[80:83], v[96:99]
  buffer_load_dwordx4 v10, s[28:31], s68 offen lds
  v_mfma_f32_16x16x32_bf16 v[100:103], a[196:199], a[84:87], v[100:103]
  ds_read_b64_tr_b16 a[172:173], v8 offset:20480
  v_mfma_f32_16x16x32_bf16 v[100:103], a[200:203], a[68:71], v[100:103]
  v_mfma_f32_16x16x32_bf16 v[104:107], a[200:203], a[72:75], v[104:107]
  ds_read_b64_tr_b16 a[174:175], v8 offset:22528
  v_mfma_f32_16x16x32_bf16 v[104:107], a[196:199], a[88:91], v[104:107]
  s_add_u32 m0, s45, 40960
  v_mfma_f32_16x16x32_bf16 v[108:111], a[196:199], a[92:95], v[108:111]
  ds_read_b64_tr_b16 a[176:177], v8 offset:24576
  v_mfma_f32_16x16x32_bf16 v[108:111], a[200:203], a[76:79], v[108:111]
  s_waitcnt lgkmcnt(5)
  buffer_load_dwordx4 v10, s[32:35], s68 offen lds
  v_mfma_f32_16x16x32_bf16 v[124:127], a[160:163], a[76:79], v[124:127]
  ds_read_b64_tr_b16 a[178:179], v8 offset:26624
  v_mfma_f32_16x16x32_bf16 v[124:127], a[164:167], a[92:95], v[124:127]
  s_add_u32 m0, s45, 36864
  s_add_u32 s61, s68, 229376
  v_mfma_f32_16x16x32_bf16 v[120:123], a[164:167], a[88:91], v[120:123]
  ds_read_b64_tr_b16 a[180:181], v8 offset:28672
  v_mfma_f32_16x16x32_bf16 v[120:123], a[160:163], a[72:75], v[120:123]
  buffer_load_dwordx4 v10, s[28:31], s61 offen lds
  v_mfma_f32_16x16x32_bf16 v[116:119], a[160:163], a[68:71], v[116:119]
  ds_read_b64_tr_b16 a[182:183], v8 offset:30720
  v_mfma_f32_16x16x32_bf16 v[116:119], a[164:167], a[84:87], v[116:119]
  v_mfma_f32_16x16x32_bf16 v[112:115], a[164:167], a[80:83], v[112:115]
  ds_read_b64_tr_b16 a[164:165], v2 offset:16384
  v_mfma_f32_16x16x32_bf16 v[112:115], a[160:163], a[64:67], v[112:115]
  s_waitcnt lgkmcnt(5)
  s_add_u32 m0, s45, 45056
  s_add_u32 s61, s68, 229376
  v_mfma_f32_16x16x32_bf16 v[32:35], a[168:171], a[64:67], v[32:35]
  ds_read_b64_tr_b16 a[166:167], v2 offset:18432
  v_mfma_f32_16x16x32_bf16 v[32:35], a[172:175], a[80:83], v[32:35]
  buffer_load_dwordx4 v10, s[32:35], s61 offen lds
  v_mfma_f32_16x16x32_bf16 v[36:39], a[172:175], a[84:87], v[36:39]
  ds_read_b64_tr_b16 a[160:161], v2 offset:20480
  v_mfma_f32_16x16x32_bf16 v[36:39], a[168:171], a[68:71], v[36:39]
  v_mfma_f32_16x16x32_bf16 v[40:43], a[168:171], a[72:75], v[40:43]
  ds_read_b64_tr_b16 a[162:163], v2 offset:22528
  s_mov_b32 s62, 57344
  v_mfma_f32_16x16x32_bf16 v[40:43], a[172:175], a[88:91], v[40:43]
  buffer_load_dwordx4 a[220:223], v13, s[12:15], s62 offen
  s_mov_b32 s62, 64512
  v_mfma_f32_16x16x32_bf16 v[44:47], a[172:175], a[92:95], v[44:47]
  ds_read_b64_tr_b16 a[172:173], v2 offset:24576
  v_mfma_f32_16x16x32_bf16 v[44:47], a[168:171], a[76:79], v[44:47]
  s_waitcnt lgkmcnt(5)
  buffer_load_dwordx4 a[224:227], v13, s[12:15], s62 offen
  v_mfma_f32_16x16x32_bf16 v[60:63], a[176:179], a[76:79], v[60:63]
  ds_read_b64_tr_b16 a[174:175], v2 offset:26624
  s_mov_b32 s62, 71680
  v_mfma_f32_16x16x32_bf16 v[60:63], a[180:183], a[92:95], v[60:63]
HOP8:
  s_cbranch_execz HOP12
  buffer_load_dwordx4 a[228:231], v13, s[12:15], s62 offen
  s_mov_b32 s62, 78848
  v_mfma_f32_16x16x32_bf16 v[56:59], a[180:183], a[88:91], v[56:59]
  ds_read_b64_tr_b16 a[168:169], v2 offset:28672
  v_mfma_f32_16x16x32_bf16 v[56:59], a[176:179], a[72:75], v[56:59]
  buffer_load_dwordx4 a[232:235], v13, s[12:15], s62 offen
  ds_read_b128 v[24:27], v14 offset:16
  v_mfma_f32_16x16x32_bf16 v[52:55], a[176:179], a[68:71], v[52:55]
  ds_read_b64_tr_b16 a[170:171], v2 offset:30720
  v_mfma_f32_16x16x32_bf16 v[52:55], a[180:183], a[84:87], v[52:55]
  v_mfma_f32_16x16x32_bf16 v[48:51], a[180:183], a[80:83], v[48:51]
  ds_read_b64_tr_b16 a[180:181], v3 offset:16384
  v_mfma_f32_16x16x32_bf16 v[48:51], a[176:179], a[64:67], v[48:51]
  s_waitcnt lgkmcnt(6)
  v_mfma_f32_16x16x32_bf16 v[128:131], a[164:167], a[64:67], v[128:131]
  ds_read_b64_tr_b16 a[182:183], v3 offset:18432
  v_mfma_f32_16x16x32_bf16 v[128:131], a[160:163], a[80:83], v[128:131]
  s_waitcnt vmcnt(14) lgkmcnt(3)
  v_cndmask_b32 v28, 0, v24, s[16:17]
  v_cndmask_b32 v29, 0, v24, s[18:19]
  v_mfma_f32_16x16x32_bf16 v[132:135], a[160:163], a[84:87], v[132:135]
  ds_read_b64_tr_b16 a[176:177], v3 offset:20480
  v_cndmask_b32 v30, 0, v24, s[20:21]
  v_mfma_f32_16x16x32_bf16 v[132:135], a[164:167], a[68:71], v[132:135]
  v_cndmask_b32 v31, 0, v24, s[22:23]
  v_mfma_f32_16x16x32_bf16 v[136:139], a[164:167], a[72:75], v[136:139]
  ds_read_b64_tr_b16 a[178:179], v3 offset:22528
  v_mfma_f32_16x16x32_bf16 a[184:187], v[28:31], a[236:239], a[184:187]
  v_cndmask_b32 v28, 0, v25, s[16:17]
  v_cndmask_b32 v29, 0, v25, s[18:19]
  v_mfma_f32_16x16x32_bf16 v[136:139], a[160:163], a[88:91], v[136:139]
  v_cndmask_b32 v30, 0, v25, s[20:21]
  v_cndmask_b32 v31, 0, v25, s[22:23]
  v_mfma_f32_16x16x32_bf16 v[140:143], a[160:163], a[92:95], v[140:143]
  ds_read_b64_tr_b16 a[160:161], v3 offset:24576
  v_mfma_f32_16x16x32_bf16 a[184:187], v[28:31], a[240:243], a[184:187]
  v_cndmask_b32 v28, 0, v26, s[16:17]
  v_cndmask_b32 v29, 0, v26, s[18:19]
  v_mfma_f32_16x16x32_bf16 v[140:143], a[164:167], a[76:79], v[140:143]
  s_waitcnt lgkmcnt(5)
  v_cndmask_b32 v30, 0, v26, s[20:21]
  v_cndmask_b32 v31, 0, v26, s[22:23]
  v_mfma_f32_16x16x32_bf16 v[156:159], a[172:175], a[76:79], v[156:159]
  ds_read_b64_tr_b16 a[162:163], v3 offset:26624
  v_mfma_f32_16x16x32_bf16 a[184:187], v[28:31], a[244:247], a[184:187]
  v_cndmask_b32 v28, 0, v27, s[16:17]
  v_cndmask_b32 v29, 0, v27, s[18:19]
  v_mfma_f32_16x16x32_bf16 v[156:159], a[168:171], a[92:95], v[156:159]
  v_cndmask_b32 v30, 0, v27, s[20:21]
  v_cndmask_b32 v31, 0, v27, s[22:23]
  v_mfma_f32_16x16x32_bf16 v[152:155], a[168:171], a[88:91], v[152:155]
  ds_read_b64_tr_b16 a[164:165], v3 offset:28672
  v_mfma_f32_16x16x32_bf16 a[184:187], v[28:31], a[248:251], a[184:187]
  v_mfma_f32_16x16x32_bf16 v[152:155], a[172:175], a[72:75], v[152:155]
  v_mfma_f32_16x16x32_bf16 v[148:151], a[172:175], a[68:71], v[148:151]
  ds_read_b64_tr_b16 a[166:167], v3 offset:30720
  v_mfma_f32_16x16x32_bf16 v[148:151], a[168:171], a[84:87], v[148:151]
  v_mfma_f32_16x16x32_bf16 v[144:147], a[168:171], a[80:83], v[144:147]
  ds_read_b64_tr_b16 a[168:169], v4 offset:16384
  v_mfma_f32_16x16x32_bf16 v[144:147], a[172:175], a[64:67], v[144:147]
  s_waitcnt lgkmcnt(5)
  v_mfma_f32_16x16x32_bf16 v[160:163], a[180:183], a[64:67], v[160:163]
  ds_read_b64_tr_b16 a[170:171], v4 offset:18432
  v_mfma_f32_16x16x32_bf16 v[160:163], a[176:179], a[80:83], v[160:163]
  v_mfma_f32_16x16x32_bf16 v[164:167], a[176:179], a[84:87], v[164:167]
  ds_read_b64_tr_b16 a[172:173], v4 offset:20480
  v_mfma_f32_16x16x32_bf16 v[164:167], a[180:183], a[68:71], v[164:167]
  v_mfma_f32_16x16x32_bf16 v[168:171], a[180:183], a[72:75], v[168:171]
  ds_read_b64_tr_b16 a[174:175], v4 offset:22528
  v_mfma_f32_16x16x32_bf16 v[168:171], a[176:179], a[88:91], v[168:171]
  v_mfma_f32_16x16x32_bf16 v[172:175], a[176:179], a[92:95], v[172:175]
  ds_read_b64_tr_b16 a[176:177], v4 offset:24576
  v_mfma_f32_16x16x32_bf16 v[172:175], a[180:183], a[76:79], v[172:175]
  s_waitcnt lgkmcnt(5)
  v_mfma_f32_16x16x32_bf16 v[188:191], a[160:163], a[76:79], v[188:191]
  ds_read_b64_tr_b16 a[178:179], v4 offset:26624
  v_mfma_f32_16x16x32_bf16 v[188:191], a[164:167], a[92:95], v[188:191]
  buffer_load_dwordx4 a[128:131], v1, s[8:11], s76 offen offset:0 sc1
  v_mfma_f32_16x16x32_bf16 v[184:187], a[164:167], a[88:91], v[184:187]
  ds_read_b64_tr_b16 a[180:181], v4 offset:28672
  v_mfma_f32_16x16x32_bf16 v[184:187], a[160:163], a[72:75], v[184:187]
  v_mfma_f32_16x16x32_bf16 v[180:183], a[160:163], a[68:71], v[180:183]
  ds_read_b64_tr_b16 a[182:183], v4 offset:30720
  v_mfma_f32_16x16x32_bf16 v[180:183], a[164:167], a[84:87], v[180:183]
  s_add_u32 s62, s63, 0
  v_mfma_f32_16x16x32_bf16 v[176:179], a[164:167], a[80:83], v[176:179]
  ds_read_b64_tr_b16 a[164:165], v5 offset:16384
  v_mfma_f32_16x16x32_bf16 v[176:179], a[160:163], a[64:67], v[176:179]
  s_waitcnt lgkmcnt(5)
  buffer_load_dwordx4 a[188:191], v12, s[8:11], s62 offen offset:0 sc1
  v_mfma_f32_16x16x32_bf16 v[192:195], a[168:171], a[64:67], v[192:195]
  ds_read_b64_tr_b16 a[166:167], v5 offset:18432
  v_mfma_f32_16x16x32_bf16 v[192:195], a[172:175], a[80:83], v[192:195]
  s_add_u32 s62, s63, 0
  v_mfma_f32_16x16x32_bf16 v[196:199], a[172:175], a[84:87], v[196:199]
  ds_read_b64_tr_b16 a[160:161], v5 offset:20480
  v_mfma_f32_16x16x32_bf16 v[196:199], a[168:171], a[68:71], v[196:199]
  buffer_load_dwordx4 a[192:195], v12, s[8:11], s62 offen offset:256 sc1
  v_mfma_f32_16x16x32_bf16 v[200:203], a[168:171], a[72:75], v[200:203]
  ds_read_b64_tr_b16 a[162:163], v5 offset:22528
  v_mfma_f32_16x16x32_bf16 v[200:203], a[172:175], a[88:91], v[200:203]
  v_mfma_f32_16x16x32_bf16 v[204:207], a[172:175], a[92:95], v[204:207]
  ds_read_b64_tr_b16 a[172:173], v5 offset:24576
  v_mfma_f32_16x16x32_bf16 v[204:207], a[168:171], a[76:79], v[204:207]
  s_waitcnt lgkmcnt(5)
  s_add_u32 s62, s63, 2048
  v_mfma_f32_16x16x32_bf16 v[220:223], a[176:179], a[76:79], v[220:223]
  ds_read_b64_tr_b16 a[174:175], v5 offset:26624
  v_mfma_f32_16x16x32_bf16 v[220:223], a[180:183], a[92:95], v[220:223]
  buffer_load_dwordx4 a[196:199], v12, s[8:11], s62 offen offset:0 sc1
  v_mfma_f32_16x16x32_bf16 v[216:219], a[180:183], a[88:91], v[216:219]
  ds_read_b64_tr_b16 a[168:169], v5 offset:28672
  v_mfma_f32_16x16x32_bf16 v[216:219], a[176:179], a[72:75], v[216:219]
  s_add_u32 s62, s63, 2048
  v_mfma_f32_16x16x32_bf16 v[212:215], a[176:179], a[68:71], v[212:215]
  ds_read_b64_tr_b16 a[170:171], v5 offset:30720
  v_mfma_f32_16x16x32_bf16 v[212:215], a[180:183], a[84:87], v[212:215]
  buffer_load_dwordx4 a[200:203], v12, s[8:11], s62 offen offset:256 sc1
  s_waitcnt vmcnt(45)
  s_barrier
  v_mfma_f32_16x16x32_bf16 v[208:211], a[180:183], a[80:83], v[208:211]
  ds_read_b64_tr_b16 a[180:181], v6 offset:0
  v_mfma_f32_16x16x32_bf16 v[208:211], a[176:179], a[64:67], v[208:211]
  s_waitcnt lgkmcnt(5)
  v_mfma_f32_16x16x32_bf16 v[224:227], a[164:167], a[64:67], v[224:227]
  ds_read_b64_tr_b16 a[182:183], v6 offset:2048
  v_mfma_f32_16x16x32_bf16 v[224:227], a[160:163], a[80:83], v[224:227]
  s_add_u32 s62, s63, 4096
  v_mfma_f32_16x16x32_bf16 v[228:231], a[160:163], a[84:87], v[228:231]
  ds_read_b64_tr_b16 a[176:177], v6 offset:4096
  v_mfma_f32_16x16x32_bf16 v[228:231], a[164:167], a[68:71], v[228:231]
  buffer_load_dwordx4 a[204:207], v12, s[8:11], s62 offen offset:0 sc1
  v_mfma_f32_16x16x32_bf16 v[232:235], a[164:167], a[72:75], v[232:235]
  ds_read_b64_tr_b16 a[178:179], v6 offset:6144
  v_mfma_f32_16x16x32_bf16 v[232:235], a[160:163], a[88:91], v[232:235]
  s_add_u32 s62, s63, 4096
  v_mfma_f32_16x16x32_bf16 v[236:239], a[160:163], a[92:95], v[236:239]
  ds_read_b64_tr_b16 a[160:161], v6 offset:8192
  v_mfma_f32_16x16x32_bf16 v[236:239], a[164:167], a[76:79], v[236:239]
  s_waitcnt lgkmcnt(5)
  buffer_load_dwordx4 a[208:211], v12, s[8:11], s62 offen offset:256 sc1
  v_mfma_f32_16x16x32_bf16 v[252:255], a[172:175], a[76:79], v[252:255]
  ds_read_b64_tr_b16 a[162:163], v6 offset:10240
  v_mfma_f32_16x16x32_bf16 v[252:255], a[168:171], a[92:95], v[252:255]
  v_mfma_f32_16x16x32_bf16 v[248:251], a[168:171], a[88:91], v[248:251]
  ds_read_b64_tr_b16 a[164:165], v6 offset:12288
  v_mfma_f32_16x16x32_bf16 v[248:251], a[172:175], a[72:75], v[248:251]
  s_add_u32 s62, s63, 6144
  v_mfma_f32_16x16x32_bf16 v[244:247], a[172:175], a[68:71], v[244:247]
  ds_read_b64_tr_b16 a[166:167], v6 offset:14336
  v_mfma_f32_16x16x32_bf16 v[244:247], a[168:171], a[84:87], v[244:247]
  buffer_load_dwordx4 a[212:215], v12, s[8:11], s62 offen offset:0 sc1
  v_mfma_f32_16x16x32_bf16 v[240:243], a[168:171], a[80:83], v[240:243]
  ds_read_b64_tr_b16 a[168:169], v7 offset:0
  v_mfma_f32_16x16x32_bf16 v[240:243], a[172:175], a[64:67], v[240:243]
  s_waitcnt vmcnt(20) lgkmcnt(5)
  s_add_u32 s62, s63, 6144
  v_mfma_f32_16x16x32_bf16 v[64:67], a[180:183], a[96:99], v[64:67]
  ds_read_b64_tr_b16 a[170:171], v7 offset:2048
  v_mfma_f32_16x16x32_bf16 v[64:67], a[176:179], a[112:115], v[64:67]
  buffer_load_dwordx4 a[216:219], v12, s[8:11], s62 offen offset:256 sc1
  v_mfma_f32_16x16x32_bf16 v[68:71], a[176:179], a[116:119], v[68:71]
  ds_read_b64_tr_b16 a[172:173], v7 offset:4096
  v_mfma_f32_16x16x32_bf16 v[68:71], a[180:183], a[100:103], v[68:71]
  v_mfma_f32_16x16x32_bf16 v[72:75], a[180:183], a[104:107], v[72:75]
  ds_read_b64_tr_b16 a[174:175], v7 offset:6144
  v_mfma_f32_16x16x32_bf16 v[72:75], a[176:179], a[120:123], v[72:75]
  v_mfma_f32_16x16x32_bf16 v[76:79], a[176:179], a[124:127], v[76:79]
  ds_read_b64_tr_b16 a[176:177], v7 offset:8192
  v_mfma_f32_16x16x32_bf16 v[76:79], a[180:183], a[108:111], v[76:79]
  s_waitcnt lgkmcnt(5)
  buffer_load_dwordx4 a[144:147], v1, s[8:11], s76 offen offset:1024 sc1
  v_mfma_f32_16x16x32_bf16 v[92:95], a[160:163], a[108:111], v[92:95]
  ds_read_b64_tr_b16 a[178:179], v7 offset:10240
  v_mfma_f32_16x16x32_bf16 v[92:95], a[164:167], a[124:127], v[92:95]
  s_add_u32 s76, s76, 65536
  v_mfma_f32_16x16x32_bf16 v[88:91], a[164:167], a[120:123], v[88:91]
  ds_read_b64_tr_b16 a[180:181], v7 offset:12288
  v_mfma_f32_16x16x32_bf16 v[88:91], a[160:163], a[104:107], v[88:91]
  buffer_load_dwordx4 a[132:135], v1, s[8:11], s76 offen offset:0 sc1
  v_mfma_f32_16x16x32_bf16 v[84:87], a[160:163], a[100:103], v[84:87]
  ds_read_b64_tr_b16 a[182:183], v7 offset:14336
  v_mfma_f32_16x16x32_bf16 v[84:87], a[164:167], a[116:119], v[84:87]
  v_mfma_f32_16x16x32_bf16 v[80:83], a[164:167], a[112:115], v[80:83]
  ds_read_b64_tr_b16 a[164:165], v8 offset:0
  v_mfma_f32_16x16x32_bf16 v[80:83], a[160:163], a[96:99], v[80:83]
  s_waitcnt lgkmcnt(5)
  s_mov_b32 s62, 86016
  v_mfma_f32_16x16x32_bf16 v[96:99], a[168:171], a[96:99], v[96:99]
  ds_read_b64_tr_b16 a[166:167], v8 offset:2048
  buffer_load_dwordx4 a[236:239], v13, s[12:15], s62 offen
  v_mfma_f32_16x16x32_bf16 v[96:99], a[172:175], a[112:115], v[96:99]
  s_mov_b32 s62, 93184
  v_mfma_f32_16x16x32_bf16 v[100:103], a[172:175], a[116:119], v[100:103]
  ds_read_b64_tr_b16 a[160:161], v8 offset:4096
  buffer_load_dwordx4 a[240:243], v13, s[12:15], s62 offen
  v_mfma_f32_16x16x32_bf16 v[100:103], a[168:171], a[100:103], v[100:103]
  s_mov_b32 s62, 100352
  ds_read_b128 v[24:27], v14 offset:32
  v_mfma_f32_16x16x32_bf16 v[104:107], a[168:171], a[104:107], v[104:107]
  ds_read_b64_tr_b16 a[162:163], v8 offset:6144
  buffer_load_dwordx4 a[244:247], v13, s[12:15], s62 offen
  v_mfma_f32_16x16x32_bf16 v[104:107], a[172:175], a[120:123], v[104:107]
  s_mov_b32 s62, 107520
  v_mfma_f32_16x16x32_bf16 v[108:111], a[172:175], a[124:127], v[108:111]
  ds_read_b64_tr_b16 a[172:173], v8 offset:8192
  v_mfma_f32_16x16x32_bf16 v[108:111], a[168:171], a[108:111], v[108:111]
  s_waitcnt lgkmcnt(6)
  buffer_load_dwordx4 a[248:251], v13, s[12:15], s62 offen
  v_mfma_f32_16x16x32_bf16 v[124:127], a[176:179], a[108:111], v[124:127]
  ds_read_b64_tr_b16 a[174:175], v8 offset:10240
  v_mfma_f32_16x16x32_bf16 v[124:127], a[180:183], a[124:127], v[124:127]
  s_waitcnt vmcnt(15) lgkmcnt(3)
  v_cndmask_b32 v28, 0, v24, s[16:17]
  v_cndmask_b32 v29, 0, v24, s[18:19]
  v_mfma_f32_16x16x32_bf16 v[120:123], a[180:183], a[120:123], v[120:123]
  ds_read_b64_tr_b16 a[168:169], v8 offset:12288
  v_cndmask_b32 v30, 0, v24, s[20:21]
  v_mfma_f32_16x16x32_bf16 v[120:123], a[176:179], a[104:107], v[120:123]
  v_cndmask_b32 v31, 0, v24, s[22:23]
  v_mfma_f32_16x16x32_bf16 v[116:119], a[176:179], a[100:103], v[116:119]
  ds_read_b64_tr_b16 a[170:171], v8 offset:14336
  v_mfma_f32_16x16x32_bf16 a[184:187], v[28:31], a[220:223], a[184:187]
  v_cndmask_b32 v28, 0, v25, s[16:17]
  v_cndmask_b32 v29, 0, v25, s[18:19]
  v_mfma_f32_16x16x32_bf16 v[116:119], a[180:183], a[116:119], v[116:119]
  v_cndmask_b32 v30, 0, v25, s[20:21]
  v_cndmask_b32 v31, 0, v25, s[22:23]
  v_mfma_f32_16x16x32_bf16 v[112:115], a[180:183], a[112:115], v[112:115]
  ds_read_b64_tr_b16 a[180:181], v2 offset:0
  v_mfma_f32_16x16x32_bf16 a[184:187], v[28:31], a[224:227], a[184:187]
  v_cndmask_b32 v28, 0, v26, s[16:17]
  v_cndmask_b32 v29, 0, v26, s[18:19]
  v_mfma_f32_16x16x32_bf16 v[112:115], a[176:179], a[96:99], v[112:115]
  s_waitcnt lgkmcnt(5)
  v_cndmask_b32 v30, 0, v26, s[20:21]
  v_cndmask_b32 v31, 0, v26, s[22:23]
  v_mfma_f32_16x16x32_bf16 v[32:35], a[164:167], a[96:99], v[32:35]
  ds_read_b64_tr_b16 a[182:183], v2 offset:2048
  v_mfma_f32_16x16x32_bf16 a[184:187], v[28:31], a[228:231], a[184:187]
  v_cndmask_b32 v28, 0, v27, s[16:17]
  v_cndmask_b32 v29, 0, v27, s[18:19]
  v_mfma_f32_16x16x32_bf16 v[32:35], a[160:163], a[112:115], v[32:35]
  v_cndmask_b32 v30, 0, v27, s[20:21]
  v_cndmask_b32 v31, 0, v27, s[22:23]
  v_mfma_f32_16x16x32_bf16 v[36:39], a[160:163], a[116:119], v[36:39]
  ds_read_b64_tr_b16 a[176:177], v2 offset:4096
  v_mfma_f32_16x16x32_bf16 a[184:187], v[28:31], a[232:235], a[184:187]
  v_mfma_f32_16x16x32_bf16 v[36:39], a[164:167], a[100:103], v[36:39]
  v_mfma_f32_16x16x32_bf16 v[40:43], a[164:167], a[104:107], v[40:43]
  ds_read_b64_tr_b16 a[178:179], v2 offset:6144
  v_mfma_f32_16x16x32_bf16 v[40:43], a[160:163], a[120:123], v[40:43]
  v_mfma_f32_16x16x32_bf16 v[44:47], a[160:163], a[124:127], v[44:47]
  ds_read_b64_tr_b16 a[160:161], v2 offset:8192
  v_mfma_f32_16x16x32_bf16 v[44:47], a[164:167], a[108:111], v[44:47]
  s_waitcnt lgkmcnt(5)
  v_mfma_f32_16x16x32_bf16 v[60:63], a[172:175], a[108:111], v[60:63]
  ds_read_b64_tr_b16 a[162:163], v2 offset:10240
  v_mfma_f32_16x16x32_bf16 v[60:63], a[168:171], a[124:127], v[60:63]
  v_mfma_f32_16x16x32_bf16 v[56:59], a[168:171], a[120:123], v[56:59]
  ds_read_b64_tr_b16 a[164:165], v2 offset:12288
  v_mfma_f32_16x16x32_bf16 v[56:59], a[172:175], a[104:107], v[56:59]
  v_mfma_f32_16x16x32_bf16 v[52:55], a[172:175], a[100:103], v[52:55]
  ds_read_b64_tr_b16 a[166:167], v2 offset:14336
  v_mfma_f32_16x16x32_bf16 v[52:55], a[168:171], a[116:119], v[52:55]
  v_mfma_f32_16x16x32_bf16 v[48:51], a[168:171], a[112:115], v[48:51]
  ds_read_b64_tr_b16 a[168:169], v3 offset:0
  v_mfma_f32_16x16x32_bf16 v[48:51], a[172:175], a[96:99], v[48:51]
  s_waitcnt lgkmcnt(5)
  v_mfma_f32_16x16x32_bf16 v[128:131], a[180:183], a[96:99], v[128:131]
  ds_read_b64_tr_b16 a[170:171], v3 offset:2048
  v_mfma_f32_16x16x32_bf16 v[128:131], a[176:179], a[112:115], v[128:131]
  v_mfma_f32_16x16x32_bf16 v[132:135], a[176:179], a[116:119], v[132:135]
  ds_read_b64_tr_b16 a[172:173], v3 offset:4096
  v_mfma_f32_16x16x32_bf16 v[132:135], a[180:183], a[100:103], v[132:135]
  v_mfma_f32_16x16x32_bf16 v[136:139], a[180:183], a[104:107], v[136:139]
  ds_read_b64_tr_b16 a[174:175], v3 offset:6144
  v_mfma_f32_16x16x32_bf16 v[136:139], a[176:179], a[120:123], v[136:139]
  buffer_load_dwordx4 a[148:151], v1, s[8:11], s76 offen offset:1024 sc1
  v_mfma_f32_16x16x32_bf16 v[140:143], a[176:179], a[124:127], v[140:143]
  ds_read_b64_tr_b16 a[176:177], v3 offset:8192
  v_mfma_f32_16x16x32_bf16 v[140:143], a[180:183], a[108:111], v[140:143]
  s_waitcnt lgkmcnt(5)
  s_add_u32 s76, s76, 65536
  v_mfma_f32_16x16x32_bf16 v[156:159], a[160:163], a[108:111], v[156:159]
  ds_read_b64_tr_b16 a[178:179], v3 offset:10240
  v_mfma_f32_16x16x32_bf16 v[156:159], a[164:167], a[124:127], v[156:159]
  buffer_load_dwordx4 a[136:139], v1, s[8:11], s76 offen offset:0 sc1
  v_mfma_f32_16x16x32_bf16 v[152:155], a[164:167], a[120:123], v[152:155]
  ds_read_b64_tr_b16 a[180:181], v3 offset:12288
  v_mfma_f32_16x16x32_bf16 v[152:155], a[160:163], a[104:107], v[152:155]
  v_mfma_f32_16x16x32_bf16 v[148:151], a[160:163], a[100:103], v[148:151]
  ds_read_b64_tr_b16 a[182:183], v3 offset:14336
  v_mfma_f32_16x16x32_bf16 v[148:151], a[164:167], a[116:119], v[148:151]
  v_mfma_f32_16x16x32_bf16 v[144:147], a[164:167], a[112:115], v[144:147]
  ds_read_b64_tr_b16 a[164:165], v4 offset:0
  v_mfma_f32_16x16x32_bf16 v[144:147], a[160:163], a[96:99], v[144:147]
  s_waitcnt lgkmcnt(5)
  buffer_load_dwordx4 a[152:155], v1, s[8:11], s76 offen offset:1024 sc1
  v_mfma_f32_16x16x32_bf16 v[160:163], a[168:171], a[96:99], v[160:163]
  ds_read_b64_tr_b16 a[166:167], v4 offset:2048
  s_waitcnt vmcnt(9)
  v_mfma_f32_16x16x32_bf16 v[160:163], a[172:175], a[112:115], v[160:163]
  s_add_u32 s76, s76, 65536
  v_accvgpr_read_b32 v16, a188
  v_accvgpr_read_b32 v17, a189
  v_mfma_f32_16x16x32_bf16 v[164:167], a[172:175], a[116:119], v[164:167]
  ds_read_b64_tr_b16 a[160:161], v4 offset:4096
  v_accvgpr_read_b32 v18, a190
  v_mfma_f32_16x16x32_bf16 v[164:167], a[168:171], a[100:103], v[164:167]
  buffer_load_dwordx4 a[140:143], v1, s[8:11], s76 offen offset:0 sc1
  v_accvgpr_read_b32 v19, a191
  v_accvgpr_read_b32 v20, a192
  v_mfma_f32_16x16x32_bf16 v[168:171], a[168:171], a[104:107], v[168:171]
  ds_read_b64_tr_b16 a[162:163], v4 offset:6144
  v_accvgpr_read_b32 v21, a193
  v_mfma_f32_16x16x32_bf16 v[168:171], a[172:175], a[120:123], v[168:171]
  v_accvgpr_read_b32 v22, a194
  v_accvgpr_read_b32 v23, a195
  v_mfma_f32_16x16x32_bf16 v[172:175], a[172:175], a[124:127], v[172:175]
  ds_read_b64_tr_b16 a[172:173], v4 offset:8192
  v_accvgpr_read_b32 v24, a196
  v_mfma_f32_16x16x32_bf16 v[172:175], a[168:171], a[108:111], v[172:175]
  s_waitcnt lgkmcnt(5)
  v_accvgpr_read_b32 v25, a197
  v_accvgpr_read_b32 v26, a198
  v_mfma_f32_16x16x32_bf16 v[188:191], a[176:179], a[108:111], v[188:191]
  ds_read_b64_tr_b16 a[174:175], v4 offset:10240
  v_accvgpr_read_b32 v27, a199
  v_mfma_f32_16x16x32_bf16 v[188:191], a[180:183], a[124:127], v[188:191]
  buffer_load_dwordx4 a[156:159], v1, s[8:11], s76 offen offset:1024 sc1
  v_accvgpr_read_b32 v28, a200
  v_accvgpr_read_b32 v29, a201
  v_mfma_f32_16x16x32_bf16 v[184:187], a[180:183], a[120:123], v[184:187]
  ds_read_b64_tr_b16 a[168:169], v4 offset:12288
  v_accvgpr_read_b32 v30, a202
  v_mfma_f32_16x16x32_bf16 v[184:187], a[176:179], a[104:107], v[184:187]
  s_mov_b32 s69, 2293760
  s_add_u32 s77, s57, 10240
  s_add_u32 m0, s45, 114688
  v_accvgpr_read_b32 v31, a203
  v_add_f32 v16, v16, v24
  v_mfma_f32_16x16x32_bf16 v[180:183], a[176:179], a[100:103], v[180:183]
  ds_read_b64_tr_b16 a[170:171], v4 offset:14336
  v_add_f32 v17, v17, v25
  v_mfma_f32_16x16x32_bf16 v[180:183], a[180:183], a[116:119], v[180:183]
  buffer_load_dwordx4 v11, s[28:31], s69 offen lds
  v_add_f32 v18, v18, v26
  v_add_f32 v19, v19, v27
  v_mfma_f32_16x16x32_bf16 v[176:179], a[180:183], a[112:115], v[176:179]
  ds_read_b64_tr_b16 a[180:181], v5 offset:0
  v_add_f32 v20, v20, v28
  v_mfma_f32_16x16x32_bf16 v[176:179], a[176:179], a[96:99], v[176:179]
  s_waitcnt lgkmcnt(5)
  v_add_f32 v21, v21, v29
  v_add_f32 v22, v22, v30
  v_mfma_f32_16x16x32_bf16 v[192:195], a[164:167], a[96:99], v[192:195]
  ds_read_b64_tr_b16 a[182:183], v5 offset:2048
  v_add_f32 v23, v23, v31
  v_mfma_f32_16x16x32_bf16 v[192:195], a[160:163], a[112:115], v[192:195]
  s_add_u32 m0, s45, 122880
  v_accvgpr_read_b32 v24, a204
  v_accvgpr_read_b32 v25, a205
  v_mfma_f32_16x16x32_bf16 v[196:199], a[160:163], a[116:119], v[196:199]
  ds_read_b64_tr_b16 a[176:177], v5 offset:4096
  v_accvgpr_read_b32 v26, a206
  v_mfma_f32_16x16x32_bf16 v[196:199], a[164:167], a[100:103], v[196:199]
  buffer_load_dwordx4 v11, s[32:35], s69 offen lds
  v_accvgpr_read_b32 v27, a207
  v_accvgpr_read_b32 v28, a208
  v_mfma_f32_16x16x32_bf16 v[200:203], a[164:167], a[104:107], v[200:203]
  ds_read_b64_tr_b16 a[178:179], v5 offset:6144
  v_accvgpr_read_b32 v29, a209
  v_mfma_f32_16x16x32_bf16 v[200:203], a[160:163], a[120:123], v[200:203]
  s_add_u32 m0, s45, 118784
  s_add_u32 s61, s69, 229376
  v_accvgpr_read_b32 v30, a210
  v_mfma_f32_16x16x32_bf16 v[204:207], a[160:163], a[124:127], v[204:207]
  ds_read_b64_tr_b16 a[160:161], v5 offset:8192
  v_accvgpr_read_b32 v31, a211
  v_mfma_f32_16x16x32_bf16 v[204:207], a[164:167], a[108:111], v[204:207]
  s_waitcnt lgkmcnt(5)
  buffer_load_dwordx4 v11, s[28:31], s61 offen lds
  v_add_f32 v16, v16, v24
  v_mfma_f32_16x16x32_bf16 v[220:223], a[172:175], a[108:111], v[220:223]
  ds_read_b64_tr_b16 a[162:163], v5 offset:10240
  v_add_f32 v17, v17, v25
  v_mfma_f32_16x16x32_bf16 v[220:223], a[168:171], a[124:127], v[220:223]
  v_add_f32 v18, v18, v26
  v_add_f32 v19, v19, v27
  v_mfma_f32_16x16x32_bf16 v[216:219], a[168:171], a[120:123], v[216:219]
  ds_read_b64_tr_b16 a[164:165], v5 offset:12288
  v_add_f32 v20, v20, v28
  v_mfma_f32_16x16x32_bf16 v[216:219], a[172:175], a[104:107], v[216:219]
  s_add_u32 m0, s45, 126976
  s_add_u32 s61, s69, 229376
  v_add_f32 v21, v21, v29
  v_mfma_f32_16x16x32_bf16 v[212:215], a[172:175], a[100:103], v[212:215]
  ds_read_b64_tr_b16 a[166:167], v5 offset:14336
  buffer_load_dwordx4 v11, s[32:35], s61 offen lds
  v_mfma_f32_16x16x32_bf16 v[212:215], a[168:171], a[116:119], v[212:215]
  s_waitcnt vmcnt(28)
  s_barrier
  v_mfma_f32_16x16x32_bf16 v[208:211], a[168:171], a[112:115], v[208:211]
  ds_read_b64_tr_b16 a[168:169], v6 offset:32768
  v_add_f32 v22, v22, v30
  v_mfma_f32_16x16x32_bf16 v[208:211], a[172:175], a[96:99], v[208:211]
  s_waitcnt lgkmcnt(5)
  s_add_u32 m0, s45, 49152
  v_add_f32 v23, v23, v31
  v_mfma_f32_16x16x32_bf16 v[224:227], a[180:183], a[96:99], v[224:227]
  ds_read_b64_tr_b16 a[170:171], v6 offset:34816
  v_accvgpr_read_b32 v24, a212
  v_mfma_f32_16x16x32_bf16 v[224:227], a[176:179], a[112:115], v[224:227]
  buffer_load_dwordx4 v10, s[28:31], s69 offen lds
  v_accvgpr_read_b32 v25, a213
  v_accvgpr_read_b32 v26, a214
  v_mfma_f32_16x16x32_bf16 v[228:231], a[176:179], a[116:119], v[228:231]
  ds_read_b64_tr_b16 a[172:173], v6 offset:36864
  v_accvgpr_read_b32 v27, a215
  v_mfma_f32_16x16x32_bf16 v[228:231], a[180:183], a[100:103], v[228:231]
  v_accvgpr_read_b32 v28, a216
  v_accvgpr_read_b32 v29, a217
  v_mfma_f32_16x16x32_bf16 v[232:235], a[180:183], a[104:107], v[232:235]
  ds_read_b64_tr_b16 a[174:175], v6 offset:38912
  v_accvgpr_read_b32 v30, a218
  v_mfma_f32_16x16x32_bf16 v[232:235], a[176:179], a[120:123], v[232:235]
  s_add_u32 m0, s45, 57344
  v_accvgpr_read_b32 v31, a219
  v_add_f32 v16, v16, v24
  v_mfma_f32_16x16x32_bf16 v[236:239], a[176:179], a[124:127], v[236:239]
  ds_read_b64_tr_b16 a[176:177], v6 offset:40960
  v_add_f32 v17, v17, v25
  v_mfma_f32_16x16x32_bf16 v[236:239], a[180:183], a[108:111], v[236:239]
  s_waitcnt lgkmcnt(5)
  buffer_load_dwordx4 v10, s[32:35], s69 offen lds
  v_add_f32 v18, v18, v26
  v_mfma_f32_16x16x32_bf16 v[252:255], a[160:163], a[108:111], v[252:255]
  ds_read_b64_tr_b16 a[178:179], v6 offset:43008
  v_add_f32 v19, v19, v27
  v_mfma_f32_16x16x32_bf16 v[252:255], a[164:167], a[124:127], v[252:255]
  s_add_u32 m0, s45, 53248
  s_add_u32 s61, s69, 229376
  v_add_f32 v20, v20, v28
  v_mfma_f32_16x16x32_bf16 v[248:251], a[164:167], a[120:123], v[248:251]
  ds_read_b64_tr_b16 a[180:181], v6 offset:45056
  v_add_f32 v21, v21, v29
  v_mfma_f32_16x16x32_bf16 v[248:251], a[160:163], a[104:107], v[248:251]
  buffer_load_dwordx4 v10, s[28:31], s61 offen lds
  v_add_f32 v22, v22, v30
  v_add_f32 v23, v23, v31
  v_mfma_f32_16x16x32_bf16 v[244:247], a[160:163], a[100:103], v[244:247]
  ds_read_b64_tr_b16 a[182:183], v6 offset:47104
  v_mfma_f32_16x16x32_bf16 v[244:247], a[164:167], a[116:119], v[244:247]
  ds_read_b128 v[24:27], v14 offset:48
  v_mfma_f32_16x16x32_bf16 v[240:243], a[164:167], a[112:115], v[240:243]
  ds_read_b64_tr_b16 a[164:165], v7 offset:32768
  v_mfma_f32_16x16x32_bf16 v[240:243], a[160:163], a[96:99], v[240:243]
  s_waitcnt vmcnt(7) lgkmcnt(6)
  s_add_u32 m0, s45, 61440
  s_add_u32 s61, s69, 229376
  v_mfma_f32_16x16x32_bf16 v[64:67], a[168:171], a[128:131], v[64:67]
  ds_read_b64_tr_b16 a[166:167], v7 offset:34816
  v_mfma_f32_16x16x32_bf16 v[64:67], a[172:175], a[144:147], v[64:67]
  buffer_load_dwordx4 v10, s[32:35], s61 offen lds
  v_mfma_f32_16x16x32_bf16 v[68:71], a[172:175], a[148:151], v[68:71]
  ds_read_b64_tr_b16 a[160:161], v7 offset:36864
  v_mfma_f32_16x16x32_bf16 v[68:71], a[168:171], a[132:135], v[68:71]
  s_waitcnt vmcnt(13) lgkmcnt(3)
  v_cndmask_b32 v28, 0, v24, s[16:17]
  v_mfma_f32_16x16x32_bf16 v[72:75], a[168:171], a[136:139], v[72:75]
  ds_read_b64_tr_b16 a[162:163], v7 offset:38912
  v_cndmask_b32 v29, 0, v24, s[18:19]
  v_mfma_f32_16x16x32_bf16 v[72:75], a[172:175], a[152:155], v[72:75]
  buffer_load_dwordx4 a[0:3], v1, s[8:11], s77 offen offset:0 sc1
  v_cndmask_b32 v30, 0, v24, s[20:21]
  v_cndmask_b32 v31, 0, v24, s[22:23]
  v_mfma_f32_16x16x32_bf16 v[76:79], a[172:175], a[156:159], v[76:79]
  ds_read_b64_tr_b16 a[172:173], v7 offset:40960
  v_mfma_f32_16x16x32_bf16 a[184:187], v[28:31], a[236:239], a[184:187]
  v_cndmask_b32 v28, 0, v25, s[16:17]
  v_cndmask_b32 v29, 0, v25, s[18:19]
  v_mfma_f32_16x16x32_bf16 v[76:79], a[168:171], a[140:143], v[76:79]
  s_waitcnt lgkmcnt(6)
  v_cndmask_b32 v30, 0, v25, s[20:21]
  v_cndmask_b32 v31, 0, v25, s[22:23]
  v_mfma_f32_16x16x32_bf16 v[92:95], a[176:179], a[140:143], v[92:95]
  ds_read_b64_tr_b16 a[174:175], v7 offset:43008
  v_mfma_f32_16x16x32_bf16 a[184:187], v[28:31], a[240:243], a[184:187]
  v_cndmask_b32 v28, 0, v26, s[16:17]
  v_cndmask_b32 v29, 0, v26, s[18:19]
  v_mfma_f32_16x16x32_bf16 v[92:95], a[180:183], a[156:159], v[92:95]
  v_cndmask_b32 v30, 0, v26, s[20:21]
  v_cndmask_b32 v31, 0, v26, s[22:23]
  v_mfma_f32_16x16x32_bf16 v[88:91], a[180:183], a[152:155], v[88:91]
  ds_read_b64_tr_b16 a[168:169], v7 offset:45056
  v_mfma_f32_16x16x32_bf16 a[184:187], v[28:31], a[244:247], a[184:187]
  v_cndmask_b32 v28, 0, v27, s[16:17]
  v_cndmask_b32 v29, 0, v27, s[18:19]
  v_mfma_f32_16x16x32_bf16 v[88:91], a[176:179], a[136:139], v[88:91]
  buffer_load_dwordx4 a[16:19], v1, s[8:11], s77 offen offset:1024 sc1
  v_cndmask_b32 v30, 0, v27, s[20:21]
  v_cndmask_b32 v31, 0, v27, s[22:23]
  v_mfma_f32_16x16x32_bf16 v[84:87], a[176:179], a[132:135], v[84:87]
  ds_read_b64_tr_b16 a[170:171], v7 offset:47104
  v_mfma_f32_16x16x32_bf16 a[184:187], v[28:31], a[248:251], a[184:187]
  v_mfma_f32_16x16x32_bf16 v[84:87], a[180:183], a[148:151], v[84:87]
  s_add_u32 s77, s77, 65536
  v_mfma_f32_16x16x32_bf16 v[80:83], a[180:183], a[144:147], v[80:83]
  ds_read_b64_tr_b16 a[180:181], v8 offset:32768
  v_mfma_f32_16x16x32_bf16 v[80:83], a[176:179], a[128:131], v[80:83]
  s_waitcnt lgkmcnt(5)
  buffer_load_dwordx4 a[4:7], v1, s[8:11], s77 offen offset:0 sc1
  v_mfma_f32_16x16x32_bf16 v[96:99], a[164:167], a[128:131], v[96:99]
  ds_read_b64_tr_b16 a[182:183], v8 offset:34816
  s_bfe_u32 s53, s2, 0x20004
  v_mfma_f32_16x16x32_bf16 v[96:99], a[160:163], a[144:147], v[96:99]
  s_lshl_b32 s53, s53, 9
  v_and_b32 v14, 15, v0
  v_lshl_add_u32 v14, v14, 5, s53
  v_mfma_f32_16x16x32_bf16 v[100:103], a[160:163], a[148:151], v[100:103]
  ds_read_b64_tr_b16 a[176:177], v8 offset:36864
  v_cmp_gt_u32 vcc, 1792, v14
  v_mov_b32 v15, 134217728
  v_bfe_u32 v13, v0, 4, 1
  v_cndmask_b32 v14, v15, v14, vcc
  v_mfma_f32_16x16x32_bf16 v[100:103], a[164:167], a[132:135], v[100:103]
  v_lshl_add_u32 v14, v13, 4, v14
  v_lshrrev_b32 v13, 5, v0
  v_mfma_f32_16x16x32_bf16 v[104:107], a[164:167], a[136:139], v[104:107]
  ds_read_b64_tr_b16 a[178:179], v8 offset:38912
  v_mul_u32_u24 v13, 14336, v13
  v_mfma_f32_16x16x32_bf16 v[104:107], a[160:163], a[152:155], v[104:107]
  buffer_load_dwordx4 a[20:23], v1, s[8:11], s77 offen offset:1024 sc1
  v_add_u32 v14, v14, v13
  s_lshr_b32 s53, s2, 6
  v_mfma_f32_16x16x32_bf16 v[108:111], a[160:163], a[156:159], v[108:111]
  ds_read_b64_tr_b16 a[160:161], v8 offset:40960
  s_lshl_b32 s53, s53, 2
  v_mfma_f32_16x16x32_bf16 v[108:111], a[164:167], a[140:143], v[108:111]
  s_waitcnt lgkmcnt(5)
  s_add_u32 s62, s63, 8192
  s_add_u32 s53, s53, s44
  v_mfma_f32_16x16x32_bf16 v[124:127], a[172:175], a[140:143], v[124:127]
  ds_read_b64_tr_b16 a[162:163], v8 offset:43008
  s_lshl_b32 s53, s53, 1
HOP9:
  s_cbranch_execz HOP13
  v_mfma_f32_16x16x32_bf16 v[124:127], a[168:171], a[156:159], v[124:127]
  buffer_load_dwordx4 a[188:191], v12, s[8:11], s62 offen offset:0 sc1
  s_bfe_u32 s54, s2, 0x10003
  s_add_u32 s53, s53, s54
  v_mfma_f32_16x16x32_bf16 v[120:123], a[168:171], a[152:155], v[120:123]
  ds_read_b64_tr_b16 a[164:165], v8 offset:45056
  s_mul_i32 s53, s53, 28672
  v_mfma_f32_16x16x32_bf16 v[120:123], a[172:175], a[136:139], v[120:123]
  s_mul_i32 s54, s52, 1792
  s_add_u32 s53, s53, s54
  s_add_u32 s53, s53, 46137344
  v_mfma_f32_16x16x32_bf16 v[116:119], a[172:175], a[132:135], v[116:119]
  ds_read_b64_tr_b16 a[166:167], v8 offset:47104
  v_mfma_f32_16x16x32_bf16 v[116:119], a[168:171], a[148:151], v[116:119]
  s_add_u32 s62, s63, 8192
  buffer_store_dwordx4 a[184:187], v14, s[8:11], s53 offen sc1
  v_mfma_f32_16x16x32_bf16 v[112:115], a[168:171], a[144:147], v[112:115]
  ds_read_b64_tr_b16 a[168:169], v2 offset:32768
  s_lshl_b32 s53, s52, 7
  v_mfma_f32_16x16x32_bf16 v[112:115], a[172:175], a[128:131], v[112:115]
  s_waitcnt lgkmcnt(5)
  buffer_load_dwordx4 a[192:195], v12, s[8:11], s62 offen offset:256 sc1
  s_add_u32 s53, s53, 884736
  v_mfma_f32_16x16x32_bf16 v[32:35], a[180:183], a[128:131], v[32:35]
  ds_read_b64_tr_b16 a[170:171], v2 offset:34816
  v_and_b32 v13, 31, v0
  v_mfma_f32_16x16x32_bf16 v[32:35], a[176:179], a[144:147], v[32:35]
  s_add_u32 s62, s63, 10240
  v_min_u32 v15, 27, v13
  v_lshl_add_u32 v13, v13, 10, s53
  v_mfma_f32_16x16x32_bf16 v[36:39], a[176:179], a[148:151], v[36:39]
  ds_read_b64_tr_b16 a[172:173], v2 offset:36864
  v_lshlrev_b32 v15, 4, v15
  v_mfma_f32_16x16x32_bf16 v[36:39], a[180:183], a[132:135], v[36:39]
  buffer_load_dwordx4 a[196:199], v12, s[8:11], s62 offen offset:0 sc1
  s_lshl_b32 s53, s51, 9
  v_mov_b32 v14, s53
  v_mfma_f32_16x16x32_bf16 v[40:43], a[180:183], a[136:139], v[40:43]
  ds_read_b64_tr_b16 a[174:175], v2 offset:38912
  s_lshl_b32 s55, s51, 3
  v_mfma_f32_16x16x32_bf16 v[40:43], a[176:179], a[152:155], v[40:43]
  s_lshr_b32 s53, 0x0b070602, s55
  s_and_b32 s53, s53, 15
  s_lshl_b32 s53, s53, 7
  v_mfma_f32_16x16x32_bf16 v[44:47], a[176:179], a[156:159], v[44:47]
  ds_read_b64_tr_b16 a[176:177], v2 offset:40960
  s_sub_u32 s53, s53, 256
  v_mfma_f32_16x16x32_bf16 v[44:47], a[180:183], a[140:143], v[44:47]
  s_waitcnt lgkmcnt(5)
  s_add_u32 s62, s63, 10240
  v_mov_b32 v24, s53
  v_mfma_f32_16x16x32_bf16 v[60:63], a[160:163], a[140:143], v[60:63]
  ds_read_b64_tr_b16 a[178:179], v2 offset:43008
  v_mfma_f32_16x16x32_bf16 v[60:63], a[164:167], a[156:159], v[60:63]
  buffer_load_dwordx4 a[200:203], v12, s[8:11], s62 offen offset:256 sc1
  v_cmp_gt_u32 vcc, 256, v15
  s_nop 1
  v_cndmask_b32 v14, v24, v14, vcc
  v_mfma_f32_16x16x32_bf16 v[56:59], a[164:167], a[152:155], v[56:59]
  ds_read_b64_tr_b16 a[180:181], v2 offset:45056
  s_lshr_b32 s53, 0x15140706, s55
  v_mfma_f32_16x16x32_bf16 v[56:59], a[160:163], a[136:139], v[56:59]
  s_add_u32 s62, s63, 12288
  s_and_b32 s53, s53, 31
  s_lshl_b32 s53, s53, 6
  v_mfma_f32_16x16x32_bf16 v[52:55], a[160:163], a[132:135], v[52:55]
  ds_read_b64_tr_b16 a[182:183], v2 offset:47104
  s_sub_u32 s53, s53, 384
  v_mfma_f32_16x16x32_bf16 v[52:55], a[164:167], a[148:151], v[52:55]
  buffer_load_dwordx4 a[204:207], v12, s[8:11], s62 offen offset:0 sc1
  v_mov_b32 v24, s53
  v_mfma_f32_16x16x32_bf16 v[48:51], a[164:167], a[144:147], v[48:51]
  ds_read_b64_tr_b16 a[164:165], v3 offset:32768
  v_mfma_f32_16x16x32_bf16 v[48:51], a[160:163], a[128:131], v[48:51]
  s_waitcnt lgkmcnt(5)
  v_cmp_gt_u32 vcc, 384, v15
  s_nop 1
  v_cndmask_b32 v14, v24, v14, vcc
  v_mfma_f32_16x16x32_bf16 v[128:131], a[168:171], a[128:131], v[128:131]
  ds_read_b64_tr_b16 a[166:167], v3 offset:34816
  v_lshrrev_b32 v24, 5, v0
  v_mfma_f32_16x16x32_bf16 v[128:131], a[172:175], a[144:147], v[128:131]
  s_add_u32 s62, s63, 12288
  v_mul_u32_u24 v24, 57344, v24
  v_add3_u32 v14, v14, v15, v24
  v_mfma_f32_16x16x32_bf16 v[132:135], a[172:175], a[148:151], v[132:135]
  ds_read_b64_tr_b16 a[160:161], v3 offset:36864
  s_mul_i32 s53, s44, 14336
  v_mfma_f32_16x16x32_bf16 v[132:135], a[168:171], a[132:135], v[132:135]
  buffer_load_dwordx4 a[208:211], v12, s[8:11], s62 offen offset:256 sc1
  s_add_u32 s53, s53, s54
  s_add_u32 s53, s53, 46137344
  v_mfma_f32_16x16x32_bf16 v[136:139], a[168:171], a[136:139], v[136:139]
  ds_read_b64_tr_b16 a[162:163], v3 offset:38912
  v_add_u32 v14, s53, v14
  v_mfma_f32_16x16x32_bf16 v[136:139], a[172:175], a[152:155], v[136:139]
  s_add_u32 s62, s63, 14336
  s_lshl_b32 s53, s44, 9
  s_add_u32 s53, s53, 131072
  v_mfma_f32_16x16x32_bf16 v[140:143], a[172:175], a[156:159], v[140:143]
  ds_read_b64_tr_b16 a[172:173], v3 offset:40960
  v_add_u32 v15, s53, v15
  v_mfma_f32_16x16x32_bf16 v[140:143], a[168:171], a[140:143], v[140:143]
  s_waitcnt lgkmcnt(5)
  buffer_load_dwordx4 a[212:215], v12, s[8:11], s62 offen offset:0 sc1
  s_and_b32 s50, s2, 4
  v_mfma_f32_16x16x32_bf16 v[156:159], a[176:179], a[140:143], v[156:159]
  ds_read_b64_tr_b16 a[174:175], v3 offset:43008
  s_lshr_b32 s53, s2, 6
  v_mfma_f32_16x16x32_bf16 v[156:159], a[180:183], a[156:159], v[156:159]
  s_add_u32 s50, s50, s53
  s_bfe_u32 s51, s2, 0x30003
  s_and_b32 s52, s2, 3
  v_mfma_f32_16x16x32_bf16 v[152:155], a[180:183], a[152:155], v[152:155]
  ds_read_b64_tr_b16 a[168:169], v3 offset:45056
  s_add_u32 s91, s50, s51
  v_mfma_f32_16x16x32_bf16 v[152:155], a[176:179], a[136:139], v[152:155]
  s_add_u32 s62, s63, 14336
  s_and_b32 s91, s91, 3
  s_lshl_b32 s53, s50, 4
  v_mfma_f32_16x16x32_bf16 v[148:151], a[176:179], a[132:135], v[148:151]
  ds_read_b64_tr_b16 a[170:171], v3 offset:47104
  s_and_b32 s54, s52, 2
  v_mfma_f32_16x16x32_bf16 v[148:151], a[180:183], a[148:151], v[148:151]
  buffer_load_dwordx4 a[216:219], v12, s[8:11], s62 offen offset:256 sc1
  s_mul_i32 s89, s54, 4293918720
  s_add_u32 s89, s89, 917504
  v_mfma_f32_16x16x32_bf16 v[144:147], a[180:183], a[144:147], v[144:147]
  ds_read_b64_tr_b16 a[180:181], v4 offset:32768
  s_lshl_b32 s54, s54, 2
  v_mfma_f32_16x16x32_bf16 v[144:147], a[176:179], a[128:131], v[144:147]
  s_waitcnt lgkmcnt(5)
  s_add_u32 s77, s77, 65536
  s_add_u32 s53, s53, s54
  v_mfma_f32_16x16x32_bf16 v[160:163], a[164:167], a[128:131], v[160:163]
  ds_read_b64_tr_b16 a[182:183], v4 offset:34816
  s_lshl_b32 s54, s44, 1
  v_mfma_f32_16x16x32_bf16 v[160:163], a[160:163], a[144:147], v[160:163]
  buffer_load_dwordx4 a[8:11], v1, s[8:11], s77 offen offset:0 sc1
  s_add_u32 s53, s53, s54
  s_mul_i32 s84, s53, 131072
  v_mfma_f32_16x16x32_bf16 v[164:167], a[160:163], a[148:151], v[164:167]
  ds_read_b64_tr_b16 a[176:177], v4 offset:36864
  s_mul_i32 s54, s52, 28672
  v_mfma_f32_16x16x32_bf16 v[164:167], a[164:167], a[132:135], v[164:167]
  s_add_u32 s84, s84, s54
  s_add_u32 s84, s84, 19922944
  s_lshl_b32 s85, s53, 15
  v_mfma_f32_16x16x32_bf16 v[168:171], a[164:167], a[136:139], v[168:171]
  ds_read_b64_tr_b16 a[178:179], v4 offset:38912
  s_lshl_b32 s51, s51, 1
  v_mfma_f32_16x16x32_bf16 v[168:171], a[160:163], a[152:155], v[168:171]
  s_and_b32 s54, s52, 1
  s_add_u32 s51, s51, s54
  s_lshl_b32 s53, s51, 7
  v_mfma_f32_16x16x32_bf16 v[172:175], a[160:163], a[156:159], v[172:175]
  ds_read_b64_tr_b16 a[160:161], v4 offset:40960
  s_add_u32 s85, s85, s53
  v_mfma_f32_16x16x32_bf16 v[172:175], a[164:167], a[140:143], v[172:175]
  s_waitcnt lgkmcnt(5)
  buffer_load_dwordx4 a[24:27], v1, s[8:11], s77 offen offset:1024 sc1
  s_lshl_b32 s88, s51, 8
  v_mfma_f32_16x16x32_bf16 v[188:191], a[172:175], a[140:143], v[188:191]
  ds_read_b64_tr_b16 a[162:163], v4 offset:43008
  s_add_u32 s88, s88, 20480
  v_mfma_f32_16x16x32_bf16 v[188:191], a[168:171], a[156:159], v[188:191]
  s_add_u32 s77, s77, 65536
  s_lshl_b32 s53, s50, 12
  s_lshl_b32 s54, s52, 8
  v_mfma_f32_16x16x32_bf16 v[184:187], a[168:171], a[152:155], v[184:187]
  ds_read_b64_tr_b16 a[164:165], v4 offset:45056
  s_add_u32 s53, s53, s54
  v_mfma_f32_16x16x32_bf16 v[184:187], a[172:175], a[136:139], v[184:187]
  buffer_load_dwordx4 a[12:15], v1, s[8:11], s77 offen offset:0 sc1
  s_add_u32 s82, s53, 688128
  s_lshl_b32 s90, s44, 12
  v_mfma_f32_16x16x32_bf16 v[180:183], a[172:175], a[132:135], v[180:183]
  ds_read_b64_tr_b16 a[166:167], v4 offset:47104
  s_add_u32 s90, s90, 135168
  v_mfma_f32_16x16x32_bf16 v[180:183], a[168:171], a[148:151], v[180:183]
  s_lshl_b32 s86, s2, 16
  s_lshl_b32 s53, s44, 14
  s_add_u32 s86, s86, s53
  v_mfma_f32_16x16x32_bf16 v[176:179], a[168:171], a[144:147], v[176:179]
  ds_read_b64_tr_b16 a[168:169], v5 offset:32768
  s_add_u32 s86, s86, 67108864
  v_mfma_f32_16x16x32_bf16 v[176:179], a[172:175], a[128:131], v[176:179]
  s_waitcnt lgkmcnt(5)
  s_lshr_b32 s53, s2, 3
  s_lshl_b32 s53, s53, 2
  v_mfma_f32_16x16x32_bf16 v[192:195], a[180:183], a[128:131], v[192:195]
  ds_read_b64_tr_b16 a[170:171], v5 offset:34816
  s_add_u32 s53, s53, s44
  v_mfma_f32_16x16x32_bf16 v[192:195], a[176:179], a[144:147], v[192:195]
  buffer_load_dwordx4 a[28:31], v1, s[8:11], s77 offen offset:1024 sc1
  s_mul_i32 s92, s53, 14336
  s_mul_i32 s53, s52, 1835008
  v_mfma_f32_16x16x32_bf16 v[196:199], a[176:179], a[148:151], v[196:199]
  ds_read_b64_tr_b16 a[172:173], v5 offset:36864
  s_add_u32 s92, s92, s53
  v_mfma_f32_16x16x32_bf16 v[196:199], a[180:183], a[132:135], v[196:199]
  s_mov_b32 s70, 2752512
  s_add_u32 s78, s57, 12288
  s_add_u32 m0, s45, 81920
  s_nop 0
  v_mfma_f32_16x16x32_bf16 v[200:203], a[180:183], a[136:139], v[200:203]
  ds_read_b64_tr_b16 a[174:175], v5 offset:38912
  v_mfma_f32_16x16x32_bf16 v[200:203], a[176:179], a[152:155], v[200:203]
  buffer_load_dwordx4 v11, s[28:31], s70 offen lds
  v_mfma_f32_16x16x32_bf16 v[204:207], a[176:179], a[156:159], v[204:207]
  ds_read_b64_tr_b16 a[176:177], v5 offset:40960
  v_mfma_f32_16x16x32_bf16 v[204:207], a[180:183], a[140:143], v[204:207]
  s_waitcnt lgkmcnt(5)
  v_mfma_f32_16x16x32_bf16 v[220:223], a[160:163], a[140:143], v[220:223]
  ds_read_b64_tr_b16 a[178:179], v5 offset:43008
  v_mfma_f32_16x16x32_bf16 v[220:223], a[164:167], a[156:159], v[220:223]
  s_add_u32 m0, s45, 90112
  v_mfma_f32_16x16x32_bf16 v[216:219], a[164:167], a[152:155], v[216:219]
  ds_read_b64_tr_b16 a[180:181], v5 offset:45056
  v_mfma_f32_16x16x32_bf16 v[216:219], a[160:163], a[136:139], v[216:219]
  buffer_load_dwordx4 v11, s[32:35], s70 offen lds
  v_mfma_f32_16x16x32_bf16 v[212:215], a[160:163], a[132:135], v[212:215]
  ds_read_b64_tr_b16 a[182:183], v5 offset:47104
  v_add_u32 v9, s46, v0
  s_waitcnt vmcnt(13)
  s_barrier
  s_mov_b64 exec, 1
  buffer_store_dword v9, v0, s[8:11], s80 offen offset:0 sc1
  s_mov_b64 exec, -1
  s_sub_u32 s80, s80, 196608
  v_mfma_f32_16x16x32_bf16 v[212:215], a[164:167], a[148:151], v[212:215]
  s_waitcnt vmcnt(20)
  s_barrier
  v_mfma_f32_16x16x32_bf16 v[208:211], a[164:167], a[144:147], v[208:211]
  ds_read_b64_tr_b16 a[164:165], v6 offset:49152
  s_add_u32 m0, s45, 86016
  s_add_u32 s61, s70, 229376
  v_mfma_f32_16x16x32_bf16 v[208:211], a[160:163], a[128:131], v[208:211]
  s_waitcnt lgkmcnt(5)
  buffer_load_dwordx4 v11, s[28:31], s61 offen lds
  v_mfma_f32_16x16x32_bf16 v[224:227], a[168:171], a[128:131], v[224:227]
  ds_read_b64_tr_b16 a[166:167], v6 offset:51200
  v_mfma_f32_16x16x32_bf16 v[224:227], a[172:175], a[144:147], v[224:227]
  v_mfma_f32_16x16x32_bf16 v[228:231], a[172:175], a[148:151], v[228:231]
  ds_read_b64_tr_b16 a[160:161], v6 offset:53248
  v_mfma_f32_16x16x32_bf16 v[228:231], a[168:171], a[132:135], v[228:231]
  s_add_u32 m0, s45, 94208
  s_add_u32 s61, s70, 229376
  v_mfma_f32_16x16x32_bf16 v[232:235], a[168:171], a[136:139], v[232:235]
  ds_read_b64_tr_b16 a[162:163], v6 offset:55296
  v_mfma_f32_16x16x32_bf16 v[232:235], a[172:175], a[152:155], v[232:235]
  buffer_load_dwordx4 v11, s[32:35], s61 offen lds
  v_mfma_f32_16x16x32_bf16 v[236:239], a[172:175], a[156:159], v[236:239]
  ds_read_b64_tr_b16 a[172:173], v6 offset:57344
  v_mfma_f32_16x16x32_bf16 v[236:239], a[168:171], a[140:143], v[236:239]
  s_waitcnt lgkmcnt(5)
  s_add_u32 m0, s45, 16384
  v_mfma_f32_16x16x32_bf16 v[252:255], a[176:179], a[140:143], v[252:255]
  ds_read_b64_tr_b16 a[174:175], v6 offset:59392
  v_mfma_f32_16x16x32_bf16 v[252:255], a[180:183], a[156:159], v[252:255]
  buffer_load_dwordx4 v10, s[28:31], s70 offen lds
  v_mfma_f32_16x16x32_bf16 v[248:251], a[180:183], a[152:155], v[248:251]
  ds_read_b64_tr_b16 a[168:169], v6 offset:61440
  v_mfma_f32_16x16x32_bf16 v[248:251], a[176:179], a[136:139], v[248:251]
  v_mfma_f32_16x16x32_bf16 v[244:247], a[176:179], a[132:135], v[244:247]
  ds_read_b64_tr_b16 a[170:171], v6 offset:63488
  v_mfma_f32_16x16x32_bf16 v[244:247], a[180:183], a[148:151], v[244:247]
  s_add_u32 m0, s45, 24576
  v_mfma_f32_16x16x32_bf16 v[240:243], a[180:183], a[144:147], v[240:243]
  ds_read_b64_tr_b16 a[180:181], v7 offset:49152
  v_mfma_f32_16x16x32_bf16 v[240:243], a[176:179], a[128:131], v[240:243]
  s_waitcnt vmcnt(6) lgkmcnt(5)
  buffer_load_dwordx4 v10, s[32:35], s70 offen lds
  v_mfma_f32_16x16x32_bf16 v[64:67], a[164:167], a[0:3], v[64:67]
  ds_read_b64_tr_b16 a[182:183], v7 offset:51200
  v_mfma_f32_16x16x32_bf16 v[64:67], a[160:163], a[16:19], v[64:67]
  s_add_u32 m0, s45, 20480
  s_add_u32 s61, s70, 229376
  v_mfma_f32_16x16x32_bf16 v[68:71], a[160:163], a[20:23], v[68:71]
  ds_read_b64_tr_b16 a[176:177], v7 offset:53248
  v_mfma_f32_16x16x32_bf16 v[68:71], a[164:167], a[4:7], v[68:71]
  buffer_load_dwordx4 v10, s[28:31], s61 offen lds
  v_mfma_f32_16x16x32_bf16 v[72:75], a[164:167], a[8:11], v[72:75]
  ds_read_b64_tr_b16 a[178:179], v7 offset:55296
  v_mfma_f32_16x16x32_bf16 v[72:75], a[160:163], a[24:27], v[72:75]
  v_mfma_f32_16x16x32_bf16 v[76:79], a[160:163], a[28:31], v[76:79]
  ds_read_b64_tr_b16 a[160:161], v7 offset:57344
  v_mfma_f32_16x16x32_bf16 v[76:79], a[164:167], a[12:15], v[76:79]
  s_waitcnt lgkmcnt(5)
  s_add_u32 m0, s45, 28672
  s_add_u32 s61, s70, 229376
  v_mfma_f32_16x16x32_bf16 v[92:95], a[172:175], a[12:15], v[92:95]
  ds_read_b64_tr_b16 a[162:163], v7 offset:59392
  v_mfma_f32_16x16x32_bf16 v[92:95], a[168:171], a[28:31], v[92:95]
  buffer_load_dwordx4 v10, s[32:35], s61 offen lds
  v_mfma_f32_16x16x32_bf16 v[88:91], a[168:171], a[24:27], v[88:91]
  ds_read_b64_tr_b16 a[164:165], v7 offset:61440
  s_waitcnt vmcnt(13)
  v_mfma_f32_16x16x32_bf16 v[88:91], a[172:175], a[8:11], v[88:91]
  v_accvgpr_read_b32 v24, a188
  v_accvgpr_read_b32 v25, a189
  v_mfma_f32_16x16x32_bf16 v[84:87], a[172:175], a[4:7], v[84:87]
  ds_read_b64_tr_b16 a[166:167], v7 offset:63488
  v_accvgpr_read_b32 v26, a190
  v_mfma_f32_16x16x32_bf16 v[84:87], a[168:171], a[20:23], v[84:87]
  buffer_load_dwordx4 a[32:35], v1, s[8:11], s78 offen offset:0 sc1
  v_accvgpr_read_b32 v27, a191
  v_accvgpr_read_b32 v28, a192
  v_mfma_f32_16x16x32_bf16 v[80:83], a[168:171], a[16:19], v[80:83]
  ds_read_b64_tr_b16 a[168:169], v8 offset:49152
  v_accvgpr_read_b32 v29, a193
  v_mfma_f32_16x16x32_bf16 v[80:83], a[172:175], a[0:3], v[80:83]
  s_waitcnt lgkmcnt(5)
  v_accvgpr_read_b32 v30, a194
  v_accvgpr_read_b32 v31, a195
  v_mfma_f32_16x16x32_bf16 v[96:99], a[180:183], a[0:3], v[96:99]
  ds_read_b64_tr_b16 a[170:171], v8 offset:51200
  v_add_f32 v16, v16, v24
  v_mfma_f32_16x16x32_bf16 v[96:99], a[176:179], a[16:19], v[96:99]
  v_add_f32 v17, v17, v25
  v_add_f32 v18, v18, v26
  v_mfma_f32_16x16x32_bf16 v[100:103], a[176:179], a[20:23], v[100:103]
  ds_read_b64_tr_b16 a[172:173], v8 offset:53248
  v_add_f32 v19, v19, v27
  v_mfma_f32_16x16x32_bf16 v[100:103], a[180:183], a[4:7], v[100:103]
  buffer_load_dwordx4 a[48:51], v1, s[8:11], s78 offen offset:1024 sc1
  v_add_f32 v20, v20, v28
  v_add_f32 v21, v21, v29
  v_mfma_f32_16x16x32_bf16 v[104:107], a[180:183], a[8:11], v[104:107]
  ds_read_b64_tr_b16 a[174:175], v8 offset:55296
  v_add_f32 v22, v22, v30
  v_mfma_f32_16x16x32_bf16 v[104:107], a[176:179], a[24:27], v[104:107]
  s_add_u32 s78, s78, 65536
  v_add_f32 v23, v23, v31
  v_accvgpr_read_b32 v24, a196
  v_mfma_f32_16x16x32_bf16 v[108:111], a[176:179], a[28:31], v[108:111]
  ds_read_b64_tr_b16 a[176:177], v8 offset:57344
  v_accvgpr_read_b32 v25, a197
  v_mfma_f32_16x16x32_bf16 v[108:111], a[180:183], a[12:15], v[108:111]
  s_waitcnt lgkmcnt(5)
  buffer_load_dwordx4 a[36:39], v1, s[8:11], s78 offen offset:0 sc1
  v_accvgpr_read_b32 v26, a198
  v_mfma_f32_16x16x32_bf16 v[124:127], a[160:163], a[12:15], v[124:127]
  ds_read_b64_tr_b16 a[178:179], v8 offset:59392
  v_accvgpr_read_b32 v27, a199
  v_mfma_f32_16x16x32_bf16 v[124:127], a[164:167], a[28:31], v[124:127]
  v_accvgpr_read_b32 v28, a200
  v_accvgpr_read_b32 v29, a201
  v_mfma_f32_16x16x32_bf16 v[120:123], a[164:167], a[24:27], v[120:123]
  ds_read_b64_tr_b16 a[180:181], v8 offset:61440
  v_accvgpr_read_b32 v30, a202
  v_mfma_f32_16x16x32_bf16 v[120:123], a[160:163], a[8:11], v[120:123]
  v_accvgpr_read_b32 v31, a203
  v_add_f32 v16, v16, v24
  v_mfma_f32_16x16x32_bf16 v[116:119], a[160:163], a[4:7], v[116:119]
  ds_read_b64_tr_b16 a[182:183], v8 offset:63488
  v_add_f32 v17, v17, v25
  v_mfma_f32_16x16x32_bf16 v[116:119], a[164:167], a[20:23], v[116:119]
  buffer_load_dwordx4 a[52:55], v1, s[8:11], s78 offen offset:1024 sc1
  v_add_f32 v18, v18, v26
  v_add_f32 v19, v19, v27
  v_mfma_f32_16x16x32_bf16 v[112:115], a[164:167], a[16:19], v[112:115]
  ds_read_b64_tr_b16 a[164:165], v2 offset:49152
  v_add_f32 v20, v20, v28
  v_mfma_f32_16x16x32_bf16 v[112:115], a[160:163], a[0:3], v[112:115]
  s_waitcnt lgkmcnt(5)
  s_add_u32 s78, s78, 65536
  v_add_f32 v21, v21, v29
  v_mfma_f32_16x16x32_bf16 v[32:35], a[168:171], a[0:3], v[32:35]
  ds_read_b64_tr_b16 a[166:167], v2 offset:51200
  v_add_f32 v22, v22, v30
  v_mfma_f32_16x16x32_bf16 v[32:35], a[172:175], a[16:19], v[32:35]
  buffer_load_dwordx4 a[40:43], v1, s[8:11], s78 offen offset:0 sc1
  v_add_f32 v23, v23, v31
  v_accvgpr_read_b32 v24, a204
  v_mfma_f32_16x16x32_bf16 v[36:39], a[172:175], a[20:23], v[36:39]
  ds_read_b64_tr_b16 a[160:161], v2 offset:53248
  v_accvgpr_read_b32 v25, a205
  v_mfma_f32_16x16x32_bf16 v[36:39], a[168:171], a[4:7], v[36:39]
  v_accvgpr_read_b32 v26, a206
  v_accvgpr_read_b32 v27, a207
  v_mfma_f32_16x16x32_bf16 v[40:43], a[168:171], a[8:11], v[40:43]
  ds_read_b64_tr_b16 a[162:163], v2 offset:55296
  v_accvgpr_read_b32 v28, a208
  v_mfma_f32_16x16x32_bf16 v[40:43], a[172:175], a[24:27], v[40:43]
  v_accvgpr_read_b32 v29, a209
  v_accvgpr_read_b32 v30, a210
  v_mfma_f32_16x16x32_bf16 v[44:47], a[172:175], a[28:31], v[44:47]
  ds_read_b64_tr_b16 a[172:173], v2 offset:57344
  v_accvgpr_read_b32 v31, a211
  v_mfma_f32_16x16x32_bf16 v[44:47], a[168:171], a[12:15], v[44:47]
  s_waitcnt lgkmcnt(5)
  buffer_load_dwordx4 a[56:59], v1, s[8:11], s78 offen offset:1024 sc1
  v_add_f32 v16, v16, v24
  v_mfma_f32_16x16x32_bf16 v[60:63], a[176:179], a[12:15], v[60:63]
  ds_read_b64_tr_b16 a[174:175], v2 offset:59392
  v_add_f32 v17, v17, v25
  v_mfma_f32_16x16x32_bf16 v[60:63], a[180:183], a[28:31], v[60:63]
  s_add_u32 s78, s78, 65536
  v_add_f32 v18, v18, v26
  v_add_f32 v19, v19, v27
  v_mfma_f32_16x16x32_bf16 v[56:59], a[180:183], a[24:27], v[56:59]
  ds_read_b64_tr_b16 a[168:169], v2 offset:61440
  v_add_f32 v20, v20, v28
  v_mfma_f32_16x16x32_bf16 v[56:59], a[176:179], a[8:11], v[56:59]
  buffer_load_dwordx4 a[44:47], v1, s[8:11], s78 offen offset:0 sc1
  v_add_f32 v21, v21, v29
  v_add_f32 v22, v22, v30
  v_mfma_f32_16x16x32_bf16 v[52:55], a[176:179], a[4:7], v[52:55]
  ds_read_b64_tr_b16 a[170:171], v2 offset:63488
  v_add_f32 v23, v23, v31
  v_mfma_f32_16x16x32_bf16 v[52:55], a[180:183], a[20:23], v[52:55]
  v_accvgpr_read_b32 v24, a212
  v_accvgpr_read_b32 v25, a213
  v_mfma_f32_16x16x32_bf16 v[48:51], a[180:183], a[16:19], v[48:51]
  ds_read_b64_tr_b16 a[180:181], v3 offset:49152
  v_accvgpr_read_b32 v26, a214
  v_mfma_f32_16x16x32_bf16 v[48:51], a[176:179], a[0:3], v[48:51]
  s_waitcnt lgkmcnt(5)
  v_accvgpr_read_b32 v27, a215
  v_accvgpr_read_b32 v28, a216
  v_mfma_f32_16x16x32_bf16 v[128:131], a[164:167], a[0:3], v[128:131]
  ds_read_b64_tr_b16 a[182:183], v3 offset:51200
  v_accvgpr_read_b32 v29, a217
  v_mfma_f32_16x16x32_bf16 v[128:131], a[160:163], a[16:19], v[128:131]
  buffer_load_dwordx4 a[60:63], v1, s[8:11], s78 offen offset:1024 sc1
  v_accvgpr_read_b32 v30, a218
  v_accvgpr_read_b32 v31, a219
  v_mfma_f32_16x16x32_bf16 v[132:135], a[160:163], a[20:23], v[132:135]
  ds_read_b64_tr_b16 a[176:177], v3 offset:53248
  v_add_f32 v16, v16, v24
  v_mfma_f32_16x16x32_bf16 v[132:135], a[164:167], a[4:7], v[132:135]
  s_mov_b32 s71, 3211264
  s_add_u32 s79, s57, 14336
  s_add_u32 m0, s45, 65536
  v_add_f32 v17, v17, v25
  v_add_f32 v18, v18, v26
  v_mfma_f32_16x16x32_bf16 v[136:139], a[164:167], a[8:11], v[136:139]
  ds_read_b64_tr_b16 a[178:179], v3 offset:55296
  v_add_f32 v19, v19, v27
  v_mfma_f32_16x16x32_bf16 v[136:139], a[160:163], a[24:27], v[136:139]
  buffer_load_dwordx4 v11, s[28:31], s71 offen lds
  v_add_f32 v20, v20, v28
  v_add_f32 v21, v21, v29
  v_mfma_f32_16x16x32_bf16 v[140:143], a[160:163], a[28:31], v[140:143]
  ds_read_b64_tr_b16 a[160:161], v3 offset:57344
  v_add_f32 v22, v22, v30
  v_mfma_f32_16x16x32_bf16 v[140:143], a[164:167], a[12:15], v[140:143]
  s_waitcnt lgkmcnt(5)
  v_add_f32 v23, v23, v31
  v_mfma_f32_16x16x32_bf16 v[156:159], a[172:175], a[12:15], v[156:159]
  ds_read_b64_tr_b16 a[162:163], v3 offset:59392
  v_mfma_f32_16x16x32_bf16 v[156:159], a[168:171], a[28:31], v[156:159]
  s_add_u32 m0, s45, 73728
  v_permlane32_swap_b32 v16, v20
  v_mfma_f32_16x16x32_bf16 v[152:155], a[168:171], a[24:27], v[152:155]
  ds_read_b64_tr_b16 a[164:165], v3 offset:61440
  v_mfma_f32_16x16x32_bf16 v[152:155], a[172:175], a[8:11], v[152:155]
  buffer_load_dwordx4 v11, s[32:35], s71 offen lds
  v_permlane32_swap_b32 v17, v21
  v_mfma_f32_16x16x32_bf16 v[148:151], a[172:175], a[4:7], v[148:151]
  ds_read_b64_tr_b16 a[166:167], v3 offset:63488
  v_mfma_f32_16x16x32_bf16 v[148:151], a[168:171], a[20:23], v[148:151]
  s_add_u32 m0, s45, 69632
  s_add_u32 s61, s71, 229376
  v_mfma_f32_16x16x32_bf16 v[144:147], a[168:171], a[16:19], v[144:147]
  ds_read_b64_tr_b16 a[168:169], v4 offset:49152
  v_mfma_f32_16x16x32_bf16 v[144:147], a[172:175], a[0:3], v[144:147]
  s_waitcnt lgkmcnt(5)
  buffer_load_dwordx4 v11, s[28:31], s61 offen lds
  v_mfma_f32_16x16x32_bf16 v[160:163], a[180:183], a[0:3], v[160:163]
  ds_read_b64_tr_b16 a[170:171], v4 offset:51200
  v_permlane32_swap_b32 v18, v22
  v_mfma_f32_16x16x32_bf16 v[160:163], a[176:179], a[16:19], v[160:163]
  v_permlane32_swap_b32 v19, v23
  v_mfma_f32_16x16x32_bf16 v[164:167], a[176:179], a[20:23], v[164:167]
  ds_read_b64_tr_b16 a[172:173], v4 offset:53248
  v_add_f32 v16, v16, v20
  v_mfma_f32_16x16x32_bf16 v[164:167], a[180:183], a[4:7], v[164:167]
  s_add_u32 m0, s45, 77824
  s_add_u32 s61, s71, 229376
  v_add_f32 v17, v17, v21
  v_mfma_f32_16x16x32_bf16 v[168:171], a[180:183], a[8:11], v[168:171]
  ds_read_b64_tr_b16 a[174:175], v4 offset:55296
  v_add_f32 v18, v18, v22
  v_mfma_f32_16x16x32_bf16 v[168:171], a[176:179], a[24:27], v[168:171]
  buffer_load_dwordx4 v11, s[32:35], s61 offen lds
  v_add_f32 v19, v19, v23
  v_mfma_f32_16x16x32_bf16 v[172:175], a[176:179], a[28:31], v[172:175]
  ds_read_b64_tr_b16 a[176:177], v4 offset:57344
  v_mfma_f32_16x16x32_bf16 v[172:175], a[180:183], a[12:15], v[172:175]
  s_waitcnt lgkmcnt(5)
  s_add_u32 m0, s45, 0
  v_mfma_f32_16x16x32_bf16 v[188:191], a[160:163], a[12:15], v[188:191]
  ds_read_b64_tr_b16 a[178:179], v4 offset:59392
  v_mfma_f32_16x16x32_bf16 v[188:191], a[164:167], a[28:31], v[188:191]
  buffer_load_dwordx4 v10, s[28:31], s71 offen lds
  v_permlane16_swap_b32 v16, v18
  v_mfma_f32_16x16x32_bf16 v[184:187], a[164:167], a[24:27], v[184:187]
  ds_read_b64_tr_b16 a[180:181], v4 offset:61440
  v_mfma_f32_16x16x32_bf16 v[184:187], a[160:163], a[8:11], v[184:187]
  v_permlane16_swap_b32 v17, v19
  v_mfma_f32_16x16x32_bf16 v[180:183], a[160:163], a[4:7], v[180:183]
  ds_read_b64_tr_b16 a[182:183], v4 offset:63488
  v_add_f32 v16, v16, v18
  v_mfma_f32_16x16x32_bf16 v[180:183], a[164:167], a[20:23], v[180:183]
  s_add_u32 m0, s45, 8192
  v_add_f32 v17, v17, v19
  v_mul_f32 v16, 0x3a800000, v16
  v_mfma_f32_16x16x32_bf16 v[176:179], a[164:167], a[16:19], v[176:179]
  ds_read_b64_tr_b16 a[164:165], v5 offset:49152
  v_mul_f32 v17, 0x3a800000, v17
  v_mfma_f32_16x16x32_bf16 v[176:179], a[160:163], a[0:3], v[176:179]
  s_waitcnt lgkmcnt(5)
  buffer_load_dwordx4 v10, s[32:35], s71 offen lds
  v_fma_f32 v17, -v16, v16, v17
  v_mfma_f32_16x16x32_bf16 v[192:195], a[168:171], a[0:3], v[192:195]
  ds_read_b64_tr_b16 a[166:167], v5 offset:51200
  v_max_f32 v17, 0, v17
  v_mfma_f32_16x16x32_bf16 v[192:195], a[172:175], a[16:19], v[192:195]
  s_add_u32 m0, s45, 4096
  s_add_u32 s61, s71, 229376
  v_cvt_pk_bf16_f32 v17, v17, v17
  v_mfma_f32_16x16x32_bf16 v[196:199], a[172:175], a[20:23], v[196:199]
  ds_read_b64_tr_b16 a[160:161], v5 offset:53248
  v_lshlrev_b32 v17, 16, v17
  v_mfma_f32_16x16x32_bf16 v[196:199], a[168:171], a[4:7], v[196:199]
  buffer_load_dwordx4 v10, s[28:31], s61 offen lds
  v_add_f32 v17, 0x3727c5ac, v17
  v_cvt_pk_bf16_f32 v17, v17, v17
  v_mfma_f32_16x16x32_bf16 v[200:203], a[168:171], a[8:11], v[200:203]
  ds_read_b64_tr_b16 a[162:163], v5 offset:55296
  v_lshlrev_b32 v17, 16, v17
  v_mfma_f32_16x16x32_bf16 v[200:203], a[172:175], a[24:27], v[200:203]
  v_sqrt_f32 v17, v17
  v_mfma_f32_16x16x32_bf16 v[204:207], a[172:175], a[28:31], v[204:207]
  ds_read_b64_tr_b16 a[172:173], v5 offset:57344
  v_cvt_pk_bf16_f32 v16, v16, v16
  v_mfma_f32_16x16x32_bf16 v[204:207], a[168:171], a[12:15], v[204:207]
  s_waitcnt lgkmcnt(5)
  s_add_u32 m0, s45, 12288
  s_add_u32 s61, s71, 229376
  v_mfma_f32_16x16x32_bf16 v[220:223], a[176:179], a[12:15], v[220:223]
  ds_read_b64_tr_b16 a[174:175], v5 offset:59392
  v_lshlrev_b32 v16, 16, v16
  v_mfma_f32_16x16x32_bf16 v[220:223], a[180:183], a[28:31], v[220:223]
  buffer_load_dwordx4 v10, s[32:35], s61 offen lds
  v_cvt_pk_bf16_f32 v17, v17, v17
  v_lshlrev_b32 v17, 16, v17
  v_mfma_f32_16x16x32_bf16 v[216:219], a[180:183], a[24:27], v[216:219]
  ds_read_b64_tr_b16 a[168:169], v5 offset:61440
  v_sub_f32 v16, 0, v16
  v_mfma_f32_16x16x32_bf16 v[216:219], a[176:179], a[8:11], v[216:219]
  v_mov_b32 v18, v16
  v_mov_b32 v19, v17
  v_mfma_f32_16x16x32_bf16 v[212:215], a[176:179], a[4:7], v[212:215]
  ds_read_b64_tr_b16 a[170:171], v5 offset:63488
  v_mfma_f32_16x16x32_bf16 v[212:215], a[180:183], a[20:23], v[212:215]
  buffer_load_dwordx4 a[64:67], v1, s[8:11], s79 offen offset:0 sc1
  s_waitcnt vmcnt(17)
  s_barrier
  v_mfma_f32_16x16x32_bf16 v[208:211], a[180:183], a[16:19], v[208:211]
  ds_read_b64_tr_b16 a[180:181], v6 offset:16384
  v_mfma_f32_16x16x32_bf16 v[208:211], a[176:179], a[0:3], v[208:211]
  s_waitcnt lgkmcnt(5)
  v_permlane16_swap_b32 v16, v18
  v_mfma_f32_16x16x32_bf16 v[224:227], a[164:167], a[0:3], v[224:227]
  ds_read_b64_tr_b16 a[182:183], v6 offset:18432
  v_mfma_f32_16x16x32_bf16 v[224:227], a[160:163], a[16:19], v[224:227]
  v_permlane16_swap_b32 v17, v19
  v_mfma_f32_16x16x32_bf16 v[228:231], a[160:163], a[20:23], v[228:231]
  ds_read_b64_tr_b16 a[176:177], v6 offset:20480
  v_mov_b32 v20, v16
  v_mfma_f32_16x16x32_bf16 v[228:231], a[164:167], a[4:7], v[228:231]
  buffer_load_dwordx4 a[80:83], v1, s[8:11], s79 offen offset:1024 sc1
  v_mov_b32 v21, v17
  v_mov_b32 v22, v18
  v_mfma_f32_16x16x32_bf16 v[232:235], a[164:167], a[8:11], v[232:235]
  ds_read_b64_tr_b16 a[178:179], v6 offset:22528
  v_mov_b32 v23, v19
  v_mfma_f32_16x16x32_bf16 v[232:235], a[160:163], a[24:27], v[232:235]
  s_add_u32 s79, s79, 65536
  v_permlane32_swap_b32 v16, v20
  v_mfma_f32_16x16x32_bf16 v[236:239], a[160:163], a[28:31], v[236:239]
  ds_read_b64_tr_b16 a[160:161], v6 offset:24576
  v_mfma_f32_16x16x32_bf16 v[236:239], a[164:167], a[12:15], v[236:239]
  s_waitcnt lgkmcnt(5)
HOP10:
  s_cbranch_execz HOP14
  buffer_load_dwordx4 a[68:71], v1, s[8:11], s79 offen offset:0 sc1
  v_mfma_f32_16x16x32_bf16 v[252:255], a[172:175], a[12:15], v[252:255]
  ds_read_b64_tr_b16 a[162:163], v6 offset:26624
  v_mfma_f32_16x16x32_bf16 v[252:255], a[168:171], a[28:31], v[252:255]
  v_permlane32_swap_b32 v17, v21
  v_mfma_f32_16x16x32_bf16 v[248:251], a[168:171], a[24:27], v[248:251]
  ds_read_b64_tr_b16 a[164:165], v6 offset:28672
  v_mfma_f32_16x16x32_bf16 v[248:251], a[172:175], a[8:11], v[248:251]
  v_permlane32_swap_b32 v18, v22
  v_mfma_f32_16x16x32_bf16 v[244:247], a[172:175], a[4:7], v[244:247]
  ds_read_b64_tr_b16 a[166:167], v6 offset:30720
  v_mfma_f32_16x16x32_bf16 v[244:247], a[168:171], a[20:23], v[244:247]
  buffer_load_dwordx4 a[84:87], v1, s[8:11], s79 offen offset:1024 sc1
  v_permlane32_swap_b32 v19, v23
  v_mfma_f32_16x16x32_bf16 v[240:243], a[168:171], a[16:19], v[240:243]
  ds_read_b64_tr_b16 a[168:169], v7 offset:16384
  v_lshrrev_b32 v12, 8, v1
  v_mfma_f32_16x16x32_bf16 v[240:243], a[172:175], a[0:3], v[240:243]
  s_waitcnt vmcnt(12) lgkmcnt(5)
  s_add_u32 s79, s79, 65536
  v_lshlrev_b32 v12, 4, v12
  v_mfma_f32_16x16x32_bf16 v[64:67], a[180:183], a[32:35], v[64:67]
  ds_read_b64_tr_b16 a[170:171], v7 offset:18432
  v_add_u32 v12, 131072, v12
  v_mfma_f32_16x16x32_bf16 v[64:67], a[176:179], a[48:51], v[64:67]
  buffer_load_dwordx4 a[72:75], v1, s[8:11], s79 offen offset:0 sc1
  v_mfma_f32_16x16x32_bf16 v[68:71], a[176:179], a[52:55], v[68:71]
  ds_read_b64_tr_b16 a[172:173], v7 offset:20480
  v_mfma_f32_16x16x32_bf16 v[68:71], a[180:183], a[36:39], v[68:71]
  v_mfma_f32_16x16x32_bf16 v[72:75], a[180:183], a[40:43], v[72:75]
  ds_read_b64_tr_b16 a[174:175], v7 offset:22528
  v_mfma_f32_16x16x32_bf16 v[72:75], a[176:179], a[56:59], v[72:75]
  v_mfma_f32_16x16x32_bf16 v[76:79], a[176:179], a[60:63], v[76:79]
  ds_read_b64_tr_b16 a[176:177], v7 offset:24576
  v_mfma_f32_16x16x32_bf16 v[76:79], a[180:183], a[44:47], v[76:79]
  s_waitcnt lgkmcnt(5)
  buffer_load_dwordx4 a[88:91], v1, s[8:11], s79 offen offset:1024 sc1
  v_mfma_f32_16x16x32_bf16 v[92:95], a[160:163], a[44:47], v[92:95]
  ds_read_b64_tr_b16 a[178:179], v7 offset:26624
  v_mfma_f32_16x16x32_bf16 v[92:95], a[164:167], a[60:63], v[92:95]
  s_add_u32 s79, s79, 65536
  v_mfma_f32_16x16x32_bf16 v[88:91], a[164:167], a[56:59], v[88:91]
  ds_read_b64_tr_b16 a[180:181], v7 offset:28672
  v_mfma_f32_16x16x32_bf16 v[88:91], a[160:163], a[40:43], v[88:91]
  buffer_load_dwordx4 a[76:79], v1, s[8:11], s79 offen offset:0 sc1
  v_mfma_f32_16x16x32_bf16 v[84:87], a[160:163], a[36:39], v[84:87]
  ds_read_b64_tr_b16 a[182:183], v7 offset:30720
  v_mfma_f32_16x16x32_bf16 v[84:87], a[164:167], a[52:55], v[84:87]
  s_lshl_b32 s83, s44, 28
  buffer_load_dword v9, v13, s[8:11], s83 offen sc1
  v_mfma_f32_16x16x32_bf16 v[80:83], a[164:167], a[48:51], v[80:83]
  ds_read_b64_tr_b16 a[164:165], v8 offset:16384
  v_mfma_f32_16x16x32_bf16 v[80:83], a[160:163], a[32:35], v[80:83]
  s_waitcnt lgkmcnt(5)
  v_mfma_f32_16x16x32_bf16 v[96:99], a[168:171], a[32:35], v[96:99]
  ds_read_b64_tr_b16 a[166:167], v8 offset:18432
  v_mfma_f32_16x16x32_bf16 v[96:99], a[172:175], a[48:51], v[96:99]
  buffer_load_dwordx4 a[92:95], v1, s[8:11], s79 offen offset:1024 sc1
  v_mfma_f32_16x16x32_bf16 v[100:103], a[172:175], a[52:55], v[100:103]
  ds_read_b64_tr_b16 a[160:161], v8 offset:20480
  v_mfma_f32_16x16x32_bf16 v[100:103], a[168:171], a[36:39], v[100:103]
  s_mov_b32 s64, 3670016
  s_add_u32 s72, s57, 16384
  s_add_u32 m0, s45, 98304
  v_mfma_f32_16x16x32_bf16 v[104:107], a[168:171], a[40:43], v[104:107]
  ds_read_b64_tr_b16 a[162:163], v8 offset:22528
  v_mfma_f32_16x16x32_bf16 v[104:107], a[172:175], a[56:59], v[104:107]
  buffer_load_dwordx4 v11, s[28:31], s64 offen lds
  v_mfma_f32_16x16x32_bf16 v[108:111], a[172:175], a[60:63], v[108:111]
  ds_read_b64_tr_b16 a[172:173], v8 offset:24576
  v_mfma_f32_16x16x32_bf16 v[108:111], a[168:171], a[44:47], v[108:111]
  s_waitcnt lgkmcnt(5)
  v_mfma_f32_16x16x32_bf16 v[124:127], a[176:179], a[44:47], v[124:127]
  ds_read_b64_tr_b16 a[174:175], v8 offset:26624
  v_mfma_f32_16x16x32_bf16 v[124:127], a[180:183], a[60:63], v[124:127]
  s_add_u32 m0, s45, 106496
  v_mfma_f32_16x16x32_bf16 v[120:123], a[180:183], a[56:59], v[120:123]
  ds_read_b64_tr_b16 a[168:169], v8 offset:28672
  v_mfma_f32_16x16x32_bf16 v[120:123], a[176:179], a[40:43], v[120:123]
  buffer_load_dwordx4 v11, s[32:35], s64 offen lds
  v_mfma_f32_16x16x32_bf16 v[116:119], a[176:179], a[36:39], v[116:119]
  ds_read_b64_tr_b16 a[170:171], v8 offset:30720
  v_mfma_f32_16x16x32_bf16 v[116:119], a[180:183], a[52:55], v[116:119]
  s_add_u32 m0, s45, 102400
  s_add_u32 s61, s64, 229376
  v_mfma_f32_16x16x32_bf16 v[112:115], a[180:183], a[48:51], v[112:115]
  ds_read_b64_tr_b16 a[180:181], v2 offset:16384
  v_mfma_f32_16x16x32_bf16 v[112:115], a[176:179], a[32:35], v[112:115]
  s_waitcnt lgkmcnt(5)
  buffer_load_dwordx4 v11, s[28:31], s61 offen lds
  v_mfma_f32_16x16x32_bf16 v[32:35], a[164:167], a[32:35], v[32:35]
  ds_read_b64_tr_b16 a[182:183], v2 offset:18432
  v_mfma_f32_16x16x32_bf16 v[32:35], a[160:163], a[48:51], v[32:35]
  v_mfma_f32_16x16x32_bf16 v[36:39], a[160:163], a[52:55], v[36:39]
  ds_read_b64_tr_b16 a[176:177], v2 offset:20480
  v_mfma_f32_16x16x32_bf16 v[36:39], a[164:167], a[36:39], v[36:39]
  s_add_u32 m0, s45, 110592
  s_add_u32 s61, s64, 229376
  v_mfma_f32_16x16x32_bf16 v[40:43], a[164:167], a[40:43], v[40:43]
  ds_read_b64_tr_b16 a[178:179], v2 offset:22528
  v_mfma_f32_16x16x32_bf16 v[40:43], a[160:163], a[56:59], v[40:43]
  buffer_load_dwordx4 v11, s[32:35], s61 offen lds
  v_mfma_f32_16x16x32_bf16 v[44:47], a[160:163], a[60:63], v[44:47]
  ds_read_b64_tr_b16 a[160:161], v2 offset:24576
  v_mfma_f32_16x16x32_bf16 v[44:47], a[164:167], a[44:47], v[44:47]
  s_waitcnt lgkmcnt(5)
  s_add_u32 m0, s45, 32768
  v_mfma_f32_16x16x32_bf16 v[60:63], a[172:175], a[44:47], v[60:63]
  ds_read_b64_tr_b16 a[162:163], v2 offset:26624
  v_mfma_f32_16x16x32_bf16 v[60:63], a[168:171], a[60:63], v[60:63]
  buffer_load_dwordx4 v10, s[28:31], s64 offen lds
  v_mfma_f32_16x16x32_bf16 v[56:59], a[168:171], a[56:59], v[56:59]
  ds_read_b64_tr_b16 a[164:165], v2 offset:28672
  v_mfma_f32_16x16x32_bf16 v[56:59], a[172:175], a[40:43], v[56:59]
  v_mfma_f32_16x16x32_bf16 v[52:55], a[172:175], a[36:39], v[52:55]
  ds_read_b64_tr_b16 a[166:167], v2 offset:30720
  v_mfma_f32_16x16x32_bf16 v[52:55], a[168:171], a[52:55], v[52:55]
  s_add_u32 m0, s45, 40960
  v_mfma_f32_16x16x32_bf16 v[48:51], a[168:171], a[48:51], v[48:51]
  ds_read_b64_tr_b16 a[168:169], v3 offset:16384
  v_mfma_f32_16x16x32_bf16 v[48:51], a[172:175], a[32:35], v[48:51]
  s_waitcnt lgkmcnt(5)
  buffer_load_dwordx4 v10, s[32:35], s64 offen lds
  v_mfma_f32_16x16x32_bf16 v[128:131], a[180:183], a[32:35], v[128:131]
  ds_read_b64_tr_b16 a[170:171], v3 offset:18432
  v_mfma_f32_16x16x32_bf16 v[128:131], a[176:179], a[48:51], v[128:131]
  s_add_u32 m0, s45, 36864
  s_add_u32 s61, s64, 229376
  v_mfma_f32_16x16x32_bf16 v[132:135], a[176:179], a[52:55], v[132:135]
  ds_read_b64_tr_b16 a[172:173], v3 offset:20480
  v_mfma_f32_16x16x32_bf16 v[132:135], a[180:183], a[36:39], v[132:135]
  buffer_load_dwordx4 v10, s[28:31], s61 offen lds
  v_mfma_f32_16x16x32_bf16 v[136:139], a[180:183], a[40:43], v[136:139]
  ds_read_b64_tr_b16 a[174:175], v3 offset:22528
  v_mfma_f32_16x16x32_bf16 v[136:139], a[176:179], a[56:59], v[136:139]
  s_waitcnt vmcnt(8)
  s_cmp_lg_u32 s44, 0
  s_cbranch_scc1 PL11_adaLN_cond__sliding_local_dilated__swiglu_ffn__prompt_kernelx
  v_cmp_ne_u32 vcc, s46, v9
  s_nop 4
  s_cbranch_vccz PL11_adaLN_cond__sliding_local_dilated__swiglu_ffn__prompt_kernelx
  s_mov_b32 s83, 60000
PL11_adaLN_cond__sliding_local_dilated__swiglu_ffn__prompt_kernel:
  buffer_load_dword v9, v13, s[8:11], 0 offen sc1
  s_sub_u32 s83, s83, 1
  s_cmp_eq_u32 s83, 0
  s_waitcnt vmcnt(0)
  s_cbranch_scc1 PL11_adaLN_cond__sliding_local_dilated__swiglu_ffn__prompt_kernelx
  v_cmp_ne_u32 vcc, s46, v9
  s_nop 4
  s_cbranch_vccnz PL11_adaLN_cond__sliding_local_dilated__swiglu_ffn__prompt_kernel
PL11_adaLN_cond__sliding_local_dilated__swiglu_ffn__prompt_kernelx:
  s_barrier
  v_mfma_f32_16x16x32_bf16 v[140:143], a[176:179], a[60:63], v[140:143]
  ds_read_b64_tr_b16 a[176:177], v3 offset:24576
  v_mfma_f32_16x16x32_bf16 v[140:143], a[180:183], a[44:47], v[140:143]
  s_waitcnt lgkmcnt(5)
  s_add_u32 m0, s45, 45056
  s_add_u32 s61, s64, 229376
  v_mfma_f32_16x16x32_bf16 v[156:159], a[160:163], a[44:47], v[156:159]
  ds_read_b64_tr_b16 a[178:179], v3 offset:26624
  v_mfma_f32_16x16x32_bf16 v[156:159], a[164:167], a[60:63], v[156:159]
  buffer_load_dwordx4 v10, s[32:35], s61 offen lds
  v_mfma_f32_16x16x32_bf16 v[152:155], a[164:167], a[56:59], v[152:155]
  ds_read_b64_tr_b16 a[180:181], v3 offset:28672
  v_mfma_f32_16x16x32_bf16 v[152:155], a[160:163], a[40:43], v[152:155]
  s_mov_b32 s62, 0
  v_mfma_f32_16x16x32_bf16 v[148:151], a[160:163], a[36:39], v[148:151]
  ds_read_b64_tr_b16 a[182:183], v3 offset:30720
  v_mfma_f32_16x16x32_bf16 v[148:151], a[164:167], a[52:55], v[148:151]
  buffer_load_dwordx4 a[220:223], v14, s[8:11], s62 offen sc1
  v_mfma_f32_16x16x32_bf16 v[144:147], a[164:167], a[48:51], v[144:147]
  ds_read_b64_tr_b16 a[164:165], v4 offset:16384
  v_mfma_f32_16x16x32_bf16 v[144:147], a[160:163], a[32:35], v[144:147]
  s_waitcnt lgkmcnt(5)
  s_mov_b32 s62, 114688
  v_mfma_f32_16x16x32_bf16 v[160:163], a[168:171], a[32:35], v[160:163]
  ds_read_b64_tr_b16 a[166:167], v4 offset:18432
  buffer_load_dwordx4 a[224:227], v14, s[8:11], s62 offen sc1
  v_mfma_f32_16x16x32_bf16 v[160:163], a[172:175], a[48:51], v[160:163]
  s_mov_b32 s62, 229376
  v_mfma_f32_16x16x32_bf16 v[164:167], a[172:175], a[52:55], v[164:167]
  ds_read_b64_tr_b16 a[160:161], v4 offset:20480
  buffer_load_dwordx4 a[228:231], v14, s[8:11], s62 offen sc1
  v_mfma_f32_16x16x32_bf16 v[164:167], a[168:171], a[36:39], v[164:167]
  s_mov_b32 s62, 344064
  v_mfma_f32_16x16x32_bf16 v[168:171], a[168:171], a[40:43], v[168:171]
  ds_read_b64_tr_b16 a[162:163], v4 offset:22528
  v_mfma_f32_16x16x32_bf16 v[168:171], a[172:175], a[56:59], v[168:171]
  buffer_load_dwordx4 a[232:235], v14, s[8:11], s62 offen sc1
  s_mov_b32 s62, 458752
  v_mfma_f32_16x16x32_bf16 v[172:175], a[172:175], a[60:63], v[172:175]
  ds_read_b64_tr_b16 a[172:173], v4 offset:24576
  v_mfma_f32_16x16x32_bf16 v[172:175], a[168:171], a[44:47], v[172:175]
  s_waitcnt lgkmcnt(5)
  buffer_load_dwordx4 a[236:239], v14, s[8:11], s62 offen sc1
  v_mfma_f32_16x16x32_bf16 v[188:191], a[176:179], a[44:47], v[188:191]
  ds_read_b64_tr_b16 a[174:175], v4 offset:26624
  v_mfma_f32_16x16x32_bf16 v[188:191], a[180:183], a[60:63], v[188:191]
  s_mov_b32 s62, 573440
  v_mfma_f32_16x16x32_bf16 v[184:187], a[180:183], a[56:59], v[184:187]
  ds_read_b64_tr_b16 a[168:169], v4 offset:28672
  buffer_load_dwordx4 a[240:243], v14, s[8:11], s62 offen sc1
  v_mfma_f32_16x16x32_bf16 v[184:187], a[176:179], a[40:43], v[184:187]
  s_mov_b32 s62, 688128
  v_mfma_f32_16x16x32_bf16 v[180:183], a[176:179], a[36:39], v[180:183]
  ds_read_b64_tr_b16 a[170:171], v4 offset:30720
  buffer_load_dwordx4 a[244:247], v14, s[8:11], s62 offen sc1
  v_mfma_f32_16x16x32_bf16 v[180:183], a[180:183], a[52:55], v[180:183]
  s_mov_b32 s62, 802816
  v_mfma_f32_16x16x32_bf16 v[176:179], a[180:183], a[48:51], v[176:179]
  ds_read_b64_tr_b16 a[180:181], v5 offset:16384
  v_mfma_f32_16x16x32_bf16 v[176:179], a[176:179], a[32:35], v[176:179]
  s_waitcnt lgkmcnt(5)
  buffer_load_dwordx4 a[248:251], v14, s[8:11], s62 offen sc1
  v_mfma_f32_16x16x32_bf16 v[192:195], a[164:167], a[32:35], v[192:195]
  ds_read_b64_tr_b16 a[182:183], v5 offset:18432
  v_mfma_f32_16x16x32_bf16 v[192:195], a[160:163], a[48:51], v[192:195]
  buffer_load_dwordx4 a[96:99], v1, s[8:11], s72 offen offset:0 sc1
  v_mfma_f32_16x16x32_bf16 v[196:199], a[160:163], a[52:55], v[196:199]
  ds_read_b64_tr_b16 a[176:177], v5 offset:20480
  v_mfma_f32_16x16x32_bf16 v[196:199], a[164:167], a[36:39], v[196:199]
  v_mfma_f32_16x16x32_bf16 v[200:203], a[164:167], a[40:43], v[200:203]
  ds_read_b64_tr_b16 a[178:179], v5 offset:22528
  v_mfma_f32_16x16x32_bf16 v[200:203], a[160:163], a[56:59], v[200:203]
  v_mfma_f32_16x16x32_bf16 v[204:207], a[160:163], a[60:63], v[204:207]
  ds_read_b64_tr_b16 a[160:161], v5 offset:24576
  v_mfma_f32_16x16x32_bf16 v[204:207], a[164:167], a[44:47], v[204:207]
  s_waitcnt lgkmcnt(5)
  buffer_load_dwordx4 a[112:115], v1, s[8:11], s72 offen offset:1024 sc1
  v_mfma_f32_16x16x32_bf16 v[220:223], a[172:175], a[44:47], v[220:223]
  ds_read_b64_tr_b16 a[162:163], v5 offset:26624
  v_mfma_f32_16x16x32_bf16 v[220:223], a[168:171], a[60:63], v[220:223]
  s_add_u32 s72, s72, 65536
  v_mfma_f32_16x16x32_bf16 v[216:219], a[168:171], a[56:59], v[216:219]
  ds_read_b64_tr_b16 a[164:165], v5 offset:28672
  v_mfma_f32_16x16x32_bf16 v[216:219], a[172:175], a[40:43], v[216:219]
  buffer_load_dwordx4 a[100:103], v1, s[8:11], s72 offen offset:0 sc1
  v_mfma_f32_16x16x32_bf16 v[212:215], a[172:175], a[36:39], v[212:215]
  ds_read_b64_tr_b16 a[166:167], v5 offset:30720
  v_mfma_f32_16x16x32_bf16 v[212:215], a[168:171], a[52:55], v[212:215]
  s_waitcnt vmcnt(28)
  s_barrier
  v_mfma_f32_16x16x32_bf16 v[208:211], a[168:171], a[48:51], v[208:211]
  ds_read_b64_tr_b16 a[168:169], v6 offset:0
  v_mfma_f32_16x16x32_bf16 v[208:211], a[172:175], a[32:35], v[208:211]
  s_waitcnt lgkmcnt(5)
  v_mfma_f32_16x16x32_bf16 v[224:227], a[180:183], a[32:35], v[224:227]
  ds_read_b64_tr_b16 a[170:171], v6 offset:2048
  v_mfma_f32_16x16x32_bf16 v[224:227], a[176:179], a[48:51], v[224:227]
  buffer_load_dwordx4 a[116:119], v1, s[8:11], s72 offen offset:1024 sc1
  v_mfma_f32_16x16x32_bf16 v[228:231], a[176:179], a[52:55], v[228:231]
  ds_read_b64_tr_b16 a[172:173], v6 offset:4096
  v_mfma_f32_16x16x32_bf16 v[228:231], a[180:183], a[36:39], v[228:231]
  s_add_u32 s72, s72, 65536
  v_mfma_f32_16x16x32_bf16 v[232:235], a[180:183], a[40:43], v[232:235]
  ds_read_b64_tr_b16 a[174:175], v6 offset:6144
  v_mfma_f32_16x16x32_bf16 v[232:235], a[176:179], a[56:59], v[232:235]
  buffer_load_dwordx4 a[104:107], v1, s[8:11], s72 offen offset:0 sc1
  v_mfma_f32_16x16x32_bf16 v[236:239], a[176:179], a[60:63], v[236:239]
  ds_read_b64_tr_b16 a[176:177], v6 offset:8192
  v_mfma_f32_16x16x32_bf16 v[236:239], a[180:183], a[44:47], v[236:239]
  s_waitcnt lgkmcnt(5)
  v_mfma_f32_16x16x32_bf16 v[252:255], a[160:163], a[44:47], v[252:255]
  ds_read_b64_tr_b16 a[178:179], v6 offset:10240
  v_mfma_f32_16x16x32_bf16 v[252:255], a[164:167], a[60:63], v[252:255]
  v_mfma_f32_16x16x32_bf16 v[248:251], a[164:167], a[56:59], v[248:251]
  ds_read_b64_tr_b16 a[180:181], v6 offset:12288
  v_mfma_f32_16x16x32_bf16 v[248:251], a[160:163], a[40:43], v[248:251]
  buffer_load_dwordx4 a[120:123], v1, s[8:11], s72 offen offset:1024 sc1
  v_mfma_f32_16x16x32_bf16 v[244:247], a[160:163], a[36:39], v[244:247]
  ds_read_b64_tr_b16 a[182:183], v6 offset:14336
  v_mfma_f32_16x16x32_bf16 v[244:247], a[164:167], a[52:55], v[244:247]
  s_add_u32 s72, s72, 65536
  v_mfma_f32_16x16x32_bf16 v[240:243], a[164:167], a[48:51], v[240:243]
  ds_read_b64_tr_b16 a[164:165], v7 offset:0
  v_mfma_f32_16x16x32_bf16 v[240:243], a[160:163], a[32:35], v[240:243]
  s_waitcnt vmcnt(22) lgkmcnt(5)
  buffer_load_dwordx4 a[108:111], v1, s[8:11], s72 offen offset:0 sc1
  v_mfma_f32_16x16x32_bf16 v[64:67], a[168:171], a[64:67], v[64:67]
  ds_read_b64_tr_b16 a[166:167], v7 offset:2048
  v_mfma_f32_16x16x32_bf16 v[64:67], a[172:175], a[80:83], v[64:67]
  v_mfma_f32_16x16x32_bf16 v[68:71], a[172:175], a[84:87], v[68:71]
  ds_read_b64_tr_b16 a[160:161], v7 offset:4096
  v_mfma_f32_16x16x32_bf16 v[68:71], a[168:171], a[68:71], v[68:71]
  v_mfma_f32_16x16x32_bf16 v[72:75], a[168:171], a[72:75], v[72:75]
  ds_read_b64_tr_b16 a[162:163], v7 offset:6144
  v_mfma_f32_16x16x32_bf16 v[72:75], a[172:175], a[88:91], v[72:75]
  buffer_load_dwordx4 a[124:127], v1, s[8:11], s72 offen offset:1024 sc1
  v_mfma_f32_16x16x32_bf16 v[76:79], a[172:175], a[92:95], v[76:79]
  ds_read_b64_tr_b16 a[172:173], v7 offset:8192
  s_waitcnt vmcnt(8)
  v_mfma_f32_16x16x32_bf16 v[76:79], a[168:171], a[76:79], v[76:79]
  s_waitcnt lgkmcnt(5)
  s_mov_b32 s65, 4128768
  s_add_u32 s73, s57, 18432
  s_add_u32 m0, s45, 114688
  v_accvgpr_read_b32 v24, a220
  v_accvgpr_read_b32 v25, a221
  v_mfma_f32_16x16x32_bf16 v[92:95], a[176:179], a[76:79], v[92:95]
  ds_read_b64_tr_b16 a[174:175], v7 offset:10240
  v_accvgpr_read_b32 v26, a222
  v_mfma_f32_16x16x32_bf16 v[92:95], a[180:183], a[92:95], v[92:95]
  buffer_load_dwordx4 v11, s[28:31], s65 offen lds
  v_accvgpr_read_b32 v27, a223
  v_accvgpr_read_b32 v28, a224
  v_mfma_f32_16x16x32_bf16 v[88:91], a[180:183], a[88:91], v[88:91]
  ds_read_b64_tr_b16 a[168:169], v7 offset:12288
  v_accvgpr_read_b32 v29, a225
  v_mfma_f32_16x16x32_bf16 v[88:91], a[176:179], a[72:75], v[88:91]
  v_accvgpr_read_b32 v30, a226
  v_accvgpr_read_b32 v31, a227
  v_add_f32 v24, v24, v28
  v_mfma_f32_16x16x32_bf16 v[84:87], a[176:179], a[68:71], v[84:87]
  ds_read_b64_tr_b16 a[170:171], v7 offset:14336
  v_add_f32 v25, v25, v29
  v_mfma_f32_16x16x32_bf16 v[84:87], a[180:183], a[84:87], v[84:87]
  s_add_u32 m0, s45, 122880
  v_add_f32 v26, v26, v30
  v_add_f32 v27, v27, v31
  v_mfma_f32_16x16x32_bf16 v[80:83], a[180:183], a[80:83], v[80:83]
  ds_read_b64_tr_b16 a[180:181], v8 offset:0
  v_accvgpr_read_b32 v28, a228
  v_mfma_f32_16x16x32_bf16 v[80:83], a[176:179], a[64:67], v[80:83]
  s_waitcnt lgkmcnt(5)
  buffer_load_dwordx4 v11, s[32:35], s65 offen lds
  v_accvgpr_read_b32 v29, a229
  v_accvgpr_read_b32 v30, a230
  v_mfma_f32_16x16x32_bf16 v[96:99], a[164:167], a[64:67], v[96:99]
  ds_read_b64_tr_b16 a[182:183], v8 offset:2048
  v_accvgpr_read_b32 v31, a231
  v_mfma_f32_16x16x32_bf16 v[96:99], a[160:163], a[80:83], v[96:99]
  s_add_u32 m0, s45, 118784
  s_add_u32 s61, s65, 229376
  v_add_f32 v24, v24, v28
  v_mfma_f32_16x16x32_bf16 v[100:103], a[160:163], a[84:87], v[100:103]
  ds_read_b64_tr_b16 a[176:177], v8 offset:4096
  v_add_f32 v25, v25, v29
  v_mfma_f32_16x16x32_bf16 v[100:103], a[164:167], a[68:71], v[100:103]
  buffer_load_dwordx4 v11, s[28:31], s61 offen lds
  v_add_f32 v26, v26, v30
  v_add_f32 v27, v27, v31
  v_accvgpr_read_b32 v28, a232
  v_mfma_f32_16x16x32_bf16 v[104:107], a[164:167], a[72:75], v[104:107]
  ds_read_b64_tr_b16 a[178:179], v8 offset:6144
  v_accvgpr_read_b32 v29, a233
  v_mfma_f32_16x16x32_bf16 v[104:107], a[160:163], a[88:91], v[104:107]
  v_accvgpr_read_b32 v30, a234
  v_accvgpr_read_b32 v31, a235
  v_mfma_f32_16x16x32_bf16 v[108:111], a[160:163], a[92:95], v[108:111]
  ds_read_b64_tr_b16 a[160:161], v8 offset:8192
  v_add_f32 v24, v24, v28
  v_mfma_f32_16x16x32_bf16 v[108:111], a[164:167], a[76:79], v[108:111]
  s_waitcnt lgkmcnt(5)
  s_add_u32 m0, s45, 126976
  s_add_u32 s61, s65, 229376
  v_add_f32 v25, v25, v29
  v_mfma_f32_16x16x32_bf16 v[124:127], a[172:175], a[76:79], v[124:127]
  ds_read_b64_tr_b16 a[162:163], v8 offset:10240
  v_add_f32 v26, v26, v30
  v_mfma_f32_16x16x32_bf16 v[124:127], a[168:171], a[92:95], v[124:127]
  buffer_load_dwordx4 v11, s[32:35], s61 offen lds
  v_add_f32 v27, v27, v31
  v_accvgpr_read_b32 v28, a236
  v_mfma_f32_16x16x32_bf16 v[120:123], a[168:171], a[88:91], v[120:123]
  ds_read_b64_tr_b16 a[164:165], v8 offset:12288
  v_accvgpr_read_b32 v29, a237
  v_mfma_f32_16x16x32_bf16 v[120:123], a[172:175], a[72:75], v[120:123]
  s_add_u32 m0, s45, 49152
  v_accvgpr_read_b32 v30, a238
  v_accvgpr_read_b32 v31, a239
  v_add_f32 v24, v24, v28
  v_mfma_f32_16x16x32_bf16 v[116:119], a[172:175], a[68:71], v[116:119]
  ds_read_b64_tr_b16 a[166:167], v8 offset:14336
  v_add_f32 v25, v25, v29
  v_mfma_f32_16x16x32_bf16 v[116:119], a[168:171], a[84:87], v[116:119]
  buffer_load_dwordx4 v10, s[28:31], s65 offen lds
  v_add_f32 v26, v26, v30
  v_add_f32 v27, v27, v31
  v_mfma_f32_16x16x32_bf16 v[112:115], a[168:171], a[80:83], v[112:115]
  ds_read_b64_tr_b16 a[168:169], v2 offset:0
  v_accvgpr_read_b32 v28, a240
  v_mfma_f32_16x16x32_bf16 v[112:115], a[172:175], a[64:67], v[112:115]
  s_waitcnt lgkmcnt(5)
  v_accvgpr_read_b32 v29, a241
  v_accvgpr_read_b32 v30, a242
  v_accvgpr_read_b32 v31, a243
  v_mfma_f32_16x16x32_bf16 v[32:35], a[180:183], a[64:67], v[32:35]
  ds_read_b64_tr_b16 a[170:171], v2 offset:2048
  v_add_f32 v24, v24, v28
  v_mfma_f32_16x16x32_bf16 v[32:35], a[176:179], a[80:83], v[32:35]
  s_add_u32 m0, s45, 57344
  v_add_f32 v25, v25, v29
  v_add_f32 v26, v26, v30
  v_mfma_f32_16x16x32_bf16 v[36:39], a[176:179], a[84:87], v[36:39]
  ds_read_b64_tr_b16 a[172:173], v2 offset:4096
  v_add_f32 v27, v27, v31
  v_mfma_f32_16x16x32_bf16 v[36:39], a[180:183], a[68:71], v[36:39]
  buffer_load_dwordx4 v10, s[32:35], s65 offen lds
  v_accvgpr_read_b32 v28, a244
  v_accvgpr_read_b32 v29, a245
  v_accvgpr_read_b32 v30, a246
  v_mfma_f32_16x16x32_bf16 v[40:43], a[180:183], a[72:75], v[40:43]
  ds_read_b64_tr_b16 a[174:175], v2 offset:6144
  v_accvgpr_read_b32 v31, a247
  v_mfma_f32_16x16x32_bf16 v[40:43], a[176:179], a[88:91], v[40:43]
  s_add_u32 m0, s45, 53248
  s_add_u32 s61, s65, 229376
  v_add_f32 v24, v24, v28
  v_mfma_f32_16x16x32_bf16 v[44:47], a[176:179], a[92:95], v[44:47]
  ds_read_b64_tr_b16 a[176:177], v2 offset:8192
  v_add_f32 v25, v25, v29
  v_mfma_f32_16x16x32_bf16 v[44:47], a[180:183], a[76:79], v[44:47]
  s_waitcnt lgkmcnt(5)
  buffer_load_dwordx4 v10, s[28:31], s61 offen lds
  v_add_f32 v26, v26, v30
  v_add_f32 v27, v27, v31
  v_mfma_f32_16x16x32_bf16 v[60:63], a[160:163], a[76:79], v[60:63]
  ds_read_b64_tr_b16 a[178:179], v2 offset:10240
  v_accvgpr_read_b32 v28, a248
  v_mfma_f32_16x16x32_bf16 v[60:63], a[164:167], a[92:95], v[60:63]
  v_accvgpr_read_b32 v29, a249
  v_accvgpr_read_b32 v30, a250
  v_mfma_f32_16x16x32_bf16 v[56:59], a[164:167], a[88:91], v[56:59]
  ds_read_b64_tr_b16 a[180:181], v2 offset:12288
  v_accvgpr_read_b32 v31, a251
  v_mfma_f32_16x16x32_bf16 v[56:59], a[160:163], a[72:75], v[56:59]
  s_add_u32 m0, s45, 61440
  s_add_u32 s61, s65, 229376
  v_add_f32 v24, v24, v28
  v_add_f32 v25, v25, v29
  v_mfma_f32_16x16x32_bf16 v[52:55], a[160:163], a[68:71], v[52:55]
  ds_read_b64_tr_b16 a[182:183], v2 offset:14336
  v_add_f32 v26, v26, v30
  v_mfma_f32_16x16x32_bf16 v[52:55], a[164:167], a[84:87], v[52:55]
  buffer_load_dwordx4 v10, s[32:35], s61 offen lds
  v_add_f32 v27, v27, v31
  v_mov_b32 v28, v24
  v_mfma_f32_16x16x32_bf16 v[48:51], a[164:167], a[80:83], v[48:51]
  ds_read_b64_tr_b16 a[164:165], v3 offset:0
  v_mov_b32 v29, v25
  v_mfma_f32_16x16x32_bf16 v[48:51], a[160:163], a[64:67], v[48:51]
  s_waitcnt lgkmcnt(5)
  v_mov_b32 v30, v26
  v_mov_b32 v31, v27
  v_mfma_f32_16x16x32_bf16 v[128:131], a[168:171], a[64:67], v[128:131]
  ds_read_b64_tr_b16 a[166:167], v3 offset:2048
  v_mfma_f32_16x16x32_bf16 v[128:131], a[172:175], a[80:83], v[128:131]
  buffer_load_dwordx4 a[128:131], v1, s[8:11], s73 offen offset:0 sc1
  v_permlane32_swap_b32 v24, v28
  v_mfma_f32_16x16x32_bf16 v[132:135], a[172:175], a[84:87], v[132:135]
  ds_read_b64_tr_b16 a[160:161], v3 offset:4096
  v_mfma_f32_16x16x32_bf16 v[132:135], a[168:171], a[68:71], v[132:135]
  v_permlane32_swap_b32 v25, v29
  v_mfma_f32_16x16x32_bf16 v[136:139], a[168:171], a[72:75], v[136:139]
  ds_read_b64_tr_b16 a[162:163], v3 offset:6144
  v_mfma_f32_16x16x32_bf16 v[136:139], a[172:175], a[88:91], v[136:139]
  v_permlane32_swap_b32 v26, v30
  v_mfma_f32_16x16x32_bf16 v[140:143], a[172:175], a[92:95], v[140:143]
  ds_read_b64_tr_b16 a[172:173], v3 offset:8192
  v_mfma_f32_16x16x32_bf16 v[140:143], a[168:171], a[76:79], v[140:143]
  s_waitcnt lgkmcnt(5)
  buffer_load_dwordx4 a[144:147], v1, s[8:11], s73 offen offset:1024 sc1
  v_permlane32_swap_b32 v27, v31
  v_mfma_f32_16x16x32_bf16 v[156:159], a[176:179], a[76:79], v[156:159]
  ds_read_b64_tr_b16 a[174:175], v3 offset:10240
  v_add_f32 v24, v24, v28
  v_mfma_f32_16x16x32_bf16 v[156:159], a[180:183], a[92:95], v[156:159]
  s_add_u32 s73, s73, 65536
  v_add_f32 v25, v25, v29
  v_add_f32 v26, v26, v30
  v_mfma_f32_16x16x32_bf16 v[152:155], a[180:183], a[88:91], v[152:155]
  ds_read_b64_tr_b16 a[168:169], v3 offset:12288
  v_add_f32 v27, v27, v31
  v_mfma_f32_16x16x32_bf16 v[152:155], a[176:179], a[72:75], v[152:155]
  buffer_load_dwordx4 a[132:135], v1, s[8:11], s73 offen offset:0 sc1
  s_cmp_eq_u32 s44, 1
  s_cselect_b32 s55, 0xbfb8aa3b, 1.0
  v_mul_f32 v24, s55, v24
  v_mfma_f32_16x16x32_bf16 v[148:151], a[176:179], a[68:71], v[148:151]
  ds_read_b64_tr_b16 a[170:171], v3 offset:14336
  v_lshrrev_b32 v13, 8, v1
  v_lshlrev_b32 v13, 28, v13
  v_mfma_f32_16x16x32_bf16 v[148:151], a[180:183], a[84:87], v[148:151]
  v_lshl_add_u32 v13, v1, 3, v13
  v_xor_b32 v9, 96, v6
  v_mfma_f32_16x16x32_bf16 v[144:147], a[180:183], a[80:83], v[144:147]
  ds_read_b64_tr_b16 a[180:181], v4 offset:0
  v_mul_f32 v25, s55, v25
  v_mfma_f32_16x16x32_bf16 v[144:147], a[176:179], a[64:67], v[144:147]
  s_waitcnt lgkmcnt(5)
  v_mul_f32 v26, s55, v26
  v_mul_f32 v27, s55, v27
  v_mfma_f32_16x16x32_bf16 v[160:163], a[164:167], a[64:67], v[160:163]
  ds_read_b64_tr_b16 a[182:183], v4 offset:2048
  v_mfma_f32_16x16x32_bf16 v[160:163], a[160:163], a[80:83], v[160:163]
  buffer_load_dwordx4 a[148:151], v1, s[8:11], s73 offen offset:1024 sc1
  ds_write_b128 v15, v[24:27]
  v_mfma_f32_16x16x32_bf16 v[164:167], a[160:163], a[84:87], v[164:167]
  ds_read_b64_tr_b16 a[176:177], v4 offset:4096
  v_mfma_f32_16x16x32_bf16 v[164:167], a[164:167], a[68:71], v[164:167]
  s_add_u32 s73, s73, 65536
  v_mfma_f32_16x16x32_bf16 v[168:171], a[164:167], a[72:75], v[168:171]
  ds_read_b64_tr_b16 a[178:179], v4 offset:6144
  s_waitcnt lgkmcnt(2)
  s_barrier
  v_mfma_f32_16x16x32_bf16 v[168:171], a[160:163], a[88:91], v[168:171]
  buffer_load_dwordx4 a[136:139], v1, s[8:11], s73 offen offset:0 sc1
  ds_read_b128 v[24:27], v12 offset:384
  v_mfma_f32_16x16x32_bf16 v[172:175], a[160:163], a[92:95], v[172:175]
  ds_read_b64_tr_b16 a[160:161], v4 offset:8192
  v_mfma_f32_16x16x32_bf16 v[172:175], a[164:167], a[76:79], v[172:175]
  s_waitcnt lgkmcnt(7)
  v_mfma_f32_16x16x32_bf16 v[188:191], a[172:175], a[76:79], v[188:191]
  ds_read_b64_tr_b16 a[162:163], v4 offset:10240
  v_mfma_f32_16x16x32_bf16 v[188:191], a[168:171], a[92:95], v[188:191]
  v_mfma_f32_16x16x32_bf16 v[184:187], a[168:171], a[88:91], v[184:187]
  ds_read_b64_tr_b16 a[164:165], v4 offset:12288
  v_mfma_f32_16x16x32_bf16 v[184:187], a[172:175], a[72:75], v[184:187]
  buffer_load_dwordx4 a[152:155], v1, s[8:11], s73 offen offset:1024 sc1
  v_mfma_f32_16x16x32_bf16 v[180:183], a[172:175], a[68:71], v[180:183]
  ds_read_b64_tr_b16 a[166:167], v4 offset:14336
  v_mfma_f32_16x16x32_bf16 v[180:183], a[168:171], a[84:87], v[180:183]
  s_add_u32 s73, s73, 65536
  ds_read_b128 v[28:31], v12 offset:1408
  v_mfma_f32_16x16x32_bf16 v[176:179], a[168:171], a[80:83], v[176:179]
  ds_read_b64_tr_b16 a[168:169], v5 offset:0
  s_waitcnt lgkmcnt(6)
  v_mfma_f32_16x16x32_bf16 v[176:179], a[172:175], a[64:67], v[176:179]
  s_waitcnt lgkmcnt(7)
  buffer_load_dwordx4 a[140:143], v1, s[8:11], s73 offen offset:0 sc1
  v_fmac_f32 v32, v16, v24
  v_mfma_f32_16x16x32_bf16 v[192:195], a[180:183], a[64:67], v[192:195]
  ds_read_b64_tr_b16 a[170:171], v5 offset:2048
  v_fmac_f32 v33, v16, v25
  v_mfma_f32_16x16x32_bf16 v[192:195], a[176:179], a[80:83], v[192:195]
  v_fmac_f32 v34, v16, v26
  v_fmac_f32 v35, v16, v27
  v_mfma_f32_16x16x32_bf16 v[196:199], a[176:179], a[84:87], v[196:199]
  ds_read_b64_tr_b16 a[172:173], v5 offset:4096
  v_fmac_f32 v36, v18, v24
  v_mfma_f32_16x16x32_bf16 v[196:199], a[180:183], a[68:71], v[196:199]
  v_fmac_f32 v37, v18, v25
  v_fmac_f32 v38, v18, v26
  v_mfma_f32_16x16x32_bf16 v[200:203], a[180:183], a[72:75], v[200:203]
  ds_read_b64_tr_b16 a[174:175], v5 offset:6144
  v_fmac_f32 v39, v18, v27
  v_mfma_f32_16x16x32_bf16 v[200:203], a[176:179], a[88:91], v[200:203]
  buffer_load_dwordx4 a[156:159], v1, s[8:11], s73 offen offset:1024 sc1
  v_fmac_f32 v40, v20, v24
  v_fmac_f32 v41, v20, v25
  v_mfma_f32_16x16x32_bf16 v[204:207], a[176:179], a[92:95], v[204:207]
  ds_read_b64_tr_b16 a[176:177], v5 offset:8192
  v_fmac_f32 v42, v20, v26
  v_mfma_f32_16x16x32_bf16 v[204:207], a[180:183], a[76:79], v[204:207]
  s_waitcnt lgkmcnt(6)
  s_mov_b32 s66, 4587520
  s_add_u32 s74, s57, 20480
  s_add_u32 m0, s45, 81920
  v_fmac_f32 v43, v20, v27
  v_mfma_f32_16x16x32_bf16 v[220:223], a[160:163], a[76:79], v[220:223]
  ds_read_b64_tr_b16 a[178:179], v5 offset:10240
  v_fmac_f32 v44, v22, v24
  v_mfma_f32_16x16x32_bf16 v[220:223], a[164:167], a[92:95], v[220:223]
  buffer_load_dwordx4 v11, s[28:31], s66 offen lds
  v_fmac_f32 v45, v22, v25
  v_fmac_f32 v46, v22, v26
  v_mfma_f32_16x16x32_bf16 v[216:219], a[164:167], a[88:91], v[216:219]
  ds_read_b64_tr_b16 a[180:181], v5 offset:12288
  v_fmac_f32 v47, v22, v27
  v_mfma_f32_16x16x32_bf16 v[216:219], a[160:163], a[72:75], v[216:219]
  ds_read_b128 v[24:27], v12 offset:1920
HOP11:
  s_cbranch_execz WRET0
  s_waitcnt lgkmcnt(8)
  v_mfma_f32_16x16x32_bf16 v[212:215], a[160:163], a[68:71], v[212:215]
  ds_read_b64_tr_b16 a[182:183], v5 offset:14336
  v_fmac_f32 v48, v16, v28
  v_mfma_f32_16x16x32_bf16 v[212:215], a[164:167], a[84:87], v[212:215]
  s_waitcnt vmcnt(33)
  s_barrier
  v_mfma_f32_16x16x32_bf16 v[208:211], a[164:167], a[80:83], v[208:211]
  ds_read_b64_tr_b16 a[164:165], v6 offset:32768
  s_add_u32 m0, s45, 90112
  v_mfma_f32_16x16x32_bf16 v[208:211], a[160:163], a[64:67], v[208:211]
  s_waitcnt lgkmcnt(6)
  buffer_load_dwordx4 v11, s[32:35], s66 offen lds
  v_fmac_f32 v49, v16, v29
  v_mfma_f32_16x16x32_bf16 v[224:227], a[168:171], a[64:67], v[224:227]
  ds_read_b64_tr_b16 a[166:167], v6 offset:34816
  v_fmac_f32 v50, v16, v30
  v_mfma_f32_16x16x32_bf16 v[224:227], a[172:175], a[80:83], v[224:227]
  s_add_u32 m0, s45, 86016
  s_add_u32 s61, s66, 229376
  v_fmac_f32 v51, v16, v31
  v_mfma_f32_16x16x32_bf16 v[228:231], a[172:175], a[84:87], v[228:231]
  ds_read_b64_tr_b16 a[160:161], v6 offset:36864
  v_fmac_f32 v52, v18, v28
  v_mfma_f32_16x16x32_bf16 v[228:231], a[168:171], a[68:71], v[228:231]
  buffer_load_dwordx4 v11, s[28:31], s61 offen lds
  v_fmac_f32 v53, v18, v29
  v_fmac_f32 v54, v18, v30
  v_mfma_f32_16x16x32_bf16 v[232:235], a[168:171], a[72:75], v[232:235]
  ds_read_b64_tr_b16 a[162:163], v6 offset:38912
  v_fmac_f32 v55, v18, v31
  v_mfma_f32_16x16x32_bf16 v[232:235], a[172:175], a[88:91], v[232:235]
  v_fmac_f32 v56, v20, v28
  v_fmac_f32 v57, v20, v29
  v_mfma_f32_16x16x32_bf16 v[236:239], a[172:175], a[92:95], v[236:239]
  ds_read_b64_tr_b16 a[172:173], v6 offset:40960
  v_fmac_f32 v58, v20, v30
  v_mfma_f32_16x16x32_bf16 v[236:239], a[168:171], a[76:79], v[236:239]
  s_waitcnt lgkmcnt(5)
  s_add_u32 m0, s45, 94208
  s_add_u32 s61, s66, 229376
  v_mfma_f32_16x16x32_bf16 v[252:255], a[176:179], a[76:79], v[252:255]
  ds_read_b64_tr_b16 a[174:175], v6 offset:43008
  v_fmac_f32 v59, v20, v31
  v_mfma_f32_16x16x32_bf16 v[252:255], a[180:183], a[92:95], v[252:255]
  buffer_load_dwordx4 v11, s[32:35], s61 offen lds
  v_fmac_f32 v60, v22, v28
  v_fmac_f32 v61, v22, v29
  v_mfma_f32_16x16x32_bf16 v[248:251], a[180:183], a[88:91], v[248:251]
  ds_read_b64_tr_b16 a[168:169], v6 offset:45056
  v_fmac_f32 v62, v22, v30
  v_mfma_f32_16x16x32_bf16 v[248:251], a[176:179], a[72:75], v[248:251]
  s_mov_b32 s67, 5046272
  s_add_u32 s75, s57, 22528
  s_add_u32 m0, s45, 65536
  v_fmac_f32 v63, v22, v31
  v_mfma_f32_16x16x32_bf16 v[244:247], a[176:179], a[68:71], v[244:247]
  ds_read_b64_tr_b16 a[170:171], v6 offset:47104
  v_mfma_f32_16x16x32_bf16 v[244:247], a[180:183], a[84:87], v[244:247]
  buffer_load_dwordx4 v11, s[28:31], s67 offen lds
  ds_read_b128 v[28:31], v12 offset:0
  v_mfma_f32_16x16x32_bf16 v[240:243], a[180:183], a[80:83], v[240:243]
  ds_read_b64_tr_b16 a[180:181], v7 offset:32768
  s_waitcnt lgkmcnt(11)
  v_mfma_f32_16x16x32_bf16 v[240:243], a[176:179], a[64:67], v[240:243]
  s_waitcnt vmcnt(21) lgkmcnt(6)
  v_fmac_f32 v48, v17, v24
  v_fmac_f32 v49, v17, v25
  v_mfma_f32_16x16x32_bf16 v[64:67], a[164:167], a[96:99], v[64:67]
  ds_read_b64_tr_b16 a[182:183], v7 offset:34816
  v_fmac_f32 v50, v17, v26
  v_mfma_f32_16x16x32_bf16 v[64:67], a[160:163], a[112:115], v[64:67]
  s_add_u32 m0, s45, 73728
  v_fmac_f32 v51, v17, v27
  v_fmac_f32 v52, v19, v24
  v_mfma_f32_16x16x32_bf16 v[68:71], a[160:163], a[116:119], v[68:71]
  ds_read_b64_tr_b16 a[176:177], v7 offset:36864
  v_fmac_f32 v53, v19, v25
  v_mfma_f32_16x16x32_bf16 v[68:71], a[164:167], a[100:103], v[68:71]
  buffer_load_dwordx4 v11, s[32:35], s67 offen lds
  v_fmac_f32 v54, v19, v26
  v_fmac_f32 v55, v19, v27
  v_mfma_f32_16x16x32_bf16 v[72:75], a[164:167], a[104:107], v[72:75]
  ds_read_b64_tr_b16 a[178:179], v7 offset:38912
  v_fmac_f32 v56, v21, v24
  v_mfma_f32_16x16x32_bf16 v[72:75], a[160:163], a[120:123], v[72:75]
  s_add_u32 m0, s45, 69632
  s_add_u32 s61, s67, 229376
  v_fmac_f32 v57, v21, v25
  v_mfma_f32_16x16x32_bf16 v[76:79], a[160:163], a[124:127], v[76:79]
  ds_read_b64_tr_b16 a[160:161], v7 offset:40960
  v_fmac_f32 v58, v21, v26
  v_mfma_f32_16x16x32_bf16 v[76:79], a[164:167], a[108:111], v[76:79]
  s_waitcnt lgkmcnt(6)
  buffer_load_dwordx4 v11, s[28:31], s61 offen lds
  v_fmac_f32 v59, v21, v27
  v_mfma_f32_16x16x32_bf16 v[92:95], a[172:175], a[108:111], v[92:95]
  ds_read_b64_tr_b16 a[162:163], v7 offset:43008
  v_fmac_f32 v60, v23, v24
  v_mfma_f32_16x16x32_bf16 v[92:95], a[168:171], a[124:127], v[92:95]
  v_fmac_f32 v61, v23, v25
  v_fmac_f32 v62, v23, v26
  v_mfma_f32_16x16x32_bf16 v[88:91], a[168:171], a[120:123], v[88:91]
  ds_read_b64_tr_b16 a[164:165], v7 offset:45056
  v_fmac_f32 v63, v23, v27
  v_mfma_f32_16x16x32_bf16 v[88:91], a[172:175], a[104:107], v[88:91]
  s_add_u32 m0, s45, 77824
  s_add_u32 s61, s67, 229376
  v_mfma_f32_16x16x32_bf16 v[84:87], a[172:175], a[100:103], v[84:87]
  ds_read_b64_tr_b16 a[166:167], v7 offset:47104
  v_mfma_f32_16x16x32_bf16 v[84:87], a[168:171], a[116:119], v[84:87]
  buffer_load_dwordx4 v11, s[32:35], s61 offen lds
  ds_read_b128 v[24:27], v12 offset:256
  v_mfma_f32_16x16x32_bf16 v[80:83], a[168:171], a[112:115], v[80:83]
  ds_read_b64_tr_b16 a[168:169], v8 offset:32768
  s_waitcnt lgkmcnt(10)
  v_mfma_f32_16x16x32_bf16 v[80:83], a[172:175], a[96:99], v[80:83]
  s_waitcnt lgkmcnt(6)
  s_add_u32 m0, s45, 16384
  v_fmac_f32 v128, v16, v28
  v_mfma_f32_16x16x32_bf16 v[96:99], a[180:183], a[96:99], v[96:99]
  ds_read_b64_tr_b16 a[170:171], v8 offset:34816
  v_fmac_f32 v129, v16, v29
  v_mfma_f32_16x16x32_bf16 v[96:99], a[176:179], a[112:115], v[96:99]
  buffer_load_dwordx4 v10, s[28:31], s66 offen lds
  v_fmac_f32 v130, v16, v30
  v_fmac_f32 v131, v16, v31
  v_mfma_f32_16x16x32_bf16 v[100:103], a[176:179], a[116:119], v[100:103]
  ds_read_b64_tr_b16 a[172:173], v8 offset:36864
  v_fmac_f32 v132, v18, v28
  v_mfma_f32_16x16x32_bf16 v[100:103], a[180:183], a[100:103], v[100:103]
  v_fmac_f32 v133, v18, v29
  v_fmac_f32 v134, v18, v30
  v_mfma_f32_16x16x32_bf16 v[104:107], a[180:183], a[104:107], v[104:107]
  ds_read_b64_tr_b16 a[174:175], v8 offset:38912
  v_fmac_f32 v135, v18, v31
  v_mfma_f32_16x16x32_bf16 v[104:107], a[176:179], a[120:123], v[104:107]
  s_add_u32 m0, s45, 24576
  v_fmac_f32 v136, v20, v28
  v_fmac_f32 v137, v20, v29
  v_mfma_f32_16x16x32_bf16 v[108:111], a[176:179], a[124:127], v[108:111]
  ds_read_b64_tr_b16 a[176:177], v8 offset:40960
  v_fmac_f32 v138, v20, v30
  v_mfma_f32_16x16x32_bf16 v[108:111], a[180:183], a[108:111], v[108:111]
  s_waitcnt lgkmcnt(6)
  buffer_load_dwordx4 v10, s[32:35], s66 offen lds
  v_fmac_f32 v139, v20, v31
  v_mfma_f32_16x16x32_bf16 v[124:127], a[160:163], a[108:111], v[124:127]
  ds_read_b64_tr_b16 a[178:179], v8 offset:43008
  v_fmac_f32 v140, v22, v28
  v_mfma_f32_16x16x32_bf16 v[124:127], a[164:167], a[124:127], v[124:127]
  s_add_u32 m0, s45, 20480
  s_add_u32 s61, s66, 229376
  v_fmac_f32 v141, v22, v29
  v_mfma_f32_16x16x32_bf16 v[120:123], a[164:167], a[120:123], v[120:123]
  ds_read_b64_tr_b16 a[180:181], v8 offset:45056
  v_fmac_f32 v142, v22, v30
  v_mfma_f32_16x16x32_bf16 v[120:123], a[160:163], a[104:107], v[120:123]
  buffer_load_dwordx4 v10, s[28:31], s61 offen lds
  v_fmac_f32 v143, v22, v31
  v_mfma_f32_16x16x32_bf16 v[116:119], a[160:163], a[100:103], v[116:119]
  ds_read_b64_tr_b16 a[182:183], v8 offset:47104
  v_mfma_f32_16x16x32_bf16 v[116:119], a[164:167], a[116:119], v[116:119]
  ds_read_b128 v[28:31], v12 offset:1280
  s_waitcnt lgkmcnt(9)
  v_mfma_f32_16x16x32_bf16 v[112:115], a[164:167], a[112:115], v[112:115]
  ds_read_b64_tr_b16 a[164:165], v2 offset:32768
  v_fmac_f32 v64, v16, v24
  v_mfma_f32_16x16x32_bf16 v[112:115], a[160:163], a[96:99], v[112:115]
  s_waitcnt lgkmcnt(6)
  s_add_u32 m0, s45, 28672
  s_add_u32 s61, s66, 229376
  v_mfma_f32_16x16x32_bf16 v[32:35], a[168:171], a[96:99], v[32:35]
  ds_read_b64_tr_b16 a[166:167], v2 offset:34816
  v_fmac_f32 v65, v16, v25
  v_mfma_f32_16x16x32_bf16 v[32:35], a[172:175], a[112:115], v[32:35]
  buffer_load_dwordx4 v10, s[32:35], s61 offen lds
  v_fmac_f32 v66, v16, v26
  v_fmac_f32 v67, v16, v27
  v_mfma_f32_16x16x32_bf16 v[36:39], a[172:175], a[116:119], v[36:39]
  ds_read_b64_tr_b16 a[160:161], v2 offset:36864
  v_fmac_f32 v68, v18, v24
  v_mfma_f32_16x16x32_bf16 v[36:39], a[168:171], a[100:103], v[36:39]
  v_fmac_f32 v69, v18, v25
  v_fmac_f32 v70, v18, v26
  v_mfma_f32_16x16x32_bf16 v[40:43], a[168:171], a[104:107], v[40:43]
  ds_read_b64_tr_b16 a[162:163], v2 offset:38912
  v_fmac_f32 v71, v18, v27
  v_mfma_f32_16x16x32_bf16 v[40:43], a[172:175], a[120:123], v[40:43]
  buffer_load_dwordx4 a[0:3], v1, s[8:11], s74 offen offset:0 sc1
  v_fmac_f32 v72, v20, v24
  v_fmac_f32 v73, v20, v25
  v_mfma_f32_16x16x32_bf16 v[44:47], a[172:175], a[124:127], v[44:47]
  ds_read_b64_tr_b16 a[172:173], v2 offset:40960
  v_fmac_f32 v74, v20, v26
  v_mfma_f32_16x16x32_bf16 v[44:47], a[168:171], a[108:111], v[44:47]
  s_waitcnt lgkmcnt(6)
  v_fmac_f32 v75, v20, v27
  v_fmac_f32 v76, v22, v24
  v_mfma_f32_16x16x32_bf16 v[60:63], a[176:179], a[108:111], v[60:63]
  ds_read_b64_tr_b16 a[174:175], v2 offset:43008
  v_fmac_f32 v77, v22, v25
  v_mfma_f32_16x16x32_bf16 v[60:63], a[180:183], a[124:127], v[60:63]
  v_fmac_f32 v78, v22, v26
  v_fmac_f32 v79, v22, v27
  v_mfma_f32_16x16x32_bf16 v[56:59], a[180:183], a[120:123], v[56:59]
  ds_read_b64_tr_b16 a[168:169], v2 offset:45056
  v_mfma_f32_16x16x32_bf16 v[56:59], a[176:179], a[104:107], v[56:59]
  buffer_load_dwordx4 a[16:19], v1, s[8:11], s74 offen offset:1024 sc1
  ds_read_b128 v[24:27], v12 offset:1792
  v_mfma_f32_16x16x32_bf16 v[52:55], a[176:179], a[100:103], v[52:55]
  ds_read_b64_tr_b16 a[170:171], v2 offset:47104
  s_waitcnt lgkmcnt(9)
  v_mfma_f32_16x16x32_bf16 v[52:55], a[180:183], a[116:119], v[52:55]
  s_add_u32 s74, s74, 65536
  v_fmac_f32 v80, v16, v28
  v_fmac_f32 v81, v16, v29
  v_mfma_f32_16x16x32_bf16 v[48:51], a[180:183], a[112:115], v[48:51]
  ds_read_b64_tr_b16 a[180:181], v3 offset:32768
  v_fmac_f32 v82, v16, v30
  v_mfma_f32_16x16x32_bf16 v[48:51], a[176:179], a[96:99], v[48:51]
  s_waitcnt lgkmcnt(6)
  buffer_load_dwordx4 a[4:7], v1, s[8:11], s74 offen offset:0 sc1
  v_fmac_f32 v83, v16, v31
  v_mfma_f32_16x16x32_bf16 v[128:131], a[164:167], a[96:99], v[128:131]
  ds_read_b64_tr_b16 a[182:183], v3 offset:34816
  v_fmac_f32 v84, v18, v28
  v_mfma_f32_16x16x32_bf16 v[128:131], a[160:163], a[112:115], v[128:131]
  v_fmac_f32 v85, v18, v29
  v_fmac_f32 v86, v18, v30
  v_mfma_f32_16x16x32_bf16 v[132:135], a[160:163], a[116:119], v[132:135]
  ds_read_b64_tr_b16 a[176:177], v3 offset:36864
  v_fmac_f32 v87, v18, v31
  v_mfma_f32_16x16x32_bf16 v[132:135], a[164:167], a[100:103], v[132:135]
  v_fmac_f32 v88, v20, v28
  v_fmac_f32 v89, v20, v29
  v_mfma_f32_16x16x32_bf16 v[136:139], a[164:167], a[104:107], v[136:139]
  ds_read_b64_tr_b16 a[178:179], v3 offset:38912
  v_fmac_f32 v90, v20, v30
  v_mfma_f32_16x16x32_bf16 v[136:139], a[160:163], a[120:123], v[136:139]
  buffer_load_dwordx4 a[20:23], v1, s[8:11], s74 offen offset:1024 sc1
  v_fmac_f32 v91, v20, v31
  v_fmac_f32 v92, v22, v28
  v_mfma_f32_16x16x32_bf16 v[140:143], a[160:163], a[124:127], v[140:143]
  ds_read_b64_tr_b16 a[160:161], v3 offset:40960
  v_fmac_f32 v93, v22, v29
  v_mfma_f32_16x16x32_bf16 v[140:143], a[164:167], a[108:111], v[140:143]
  s_waitcnt lgkmcnt(5)
  s_add_u32 s74, s74, 65536
  v_fmac_f32 v94, v22, v30
  v_mfma_f32_16x16x32_bf16 v[156:159], a[172:175], a[108:111], v[156:159]
  ds_read_b64_tr_b16 a[162:163], v3 offset:43008
  v_fmac_f32 v95, v22, v31
  v_mfma_f32_16x16x32_bf16 v[156:159], a[168:171], a[124:127], v[156:159]
  buffer_load_dwordx4 a[8:11], v1, s[8:11], s74 offen offset:0 sc1
  ds_read_b128 v[28:31], v12 offset:320
  v_mfma_f32_16x16x32_bf16 v[152:155], a[168:171], a[120:123], v[152:155]
  ds_read_b64_tr_b16 a[164:165], v3 offset:45056
  s_waitcnt lgkmcnt(9)
  v_mfma_f32_16x16x32_bf16 v[152:155], a[172:175], a[104:107], v[152:155]
  v_fmac_f32 v80, v17, v24
  v_fmac_f32 v81, v17, v25
  v_mfma_f32_16x16x32_bf16 v[148:151], a[172:175], a[100:103], v[148:151]
  ds_read_b64_tr_b16 a[166:167], v3 offset:47104
  v_fmac_f32 v82, v17, v26
  v_mfma_f32_16x16x32_bf16 v[148:151], a[168:171], a[116:119], v[148:151]
  v_fmac_f32 v83, v17, v27
  v_fmac_f32 v84, v19, v24
  v_mfma_f32_16x16x32_bf16 v[144:147], a[168:171], a[112:115], v[144:147]
  ds_read_b64_tr_b16 a[168:169], v4 offset:32768
  v_fmac_f32 v85, v19, v25
  v_mfma_f32_16x16x32_bf16 v[144:147], a[172:175], a[96:99], v[144:147]
  s_waitcnt lgkmcnt(6)
  buffer_load_dwordx4 a[24:27], v1, s[8:11], s74 offen offset:1024 sc1
  v_fmac_f32 v86, v19, v26
  v_mfma_f32_16x16x32_bf16 v[160:163], a[180:183], a[96:99], v[160:163]
  ds_read_b64_tr_b16 a[170:171], v4 offset:34816
  v_fmac_f32 v87, v19, v27
  v_mfma_f32_16x16x32_bf16 v[160:163], a[176:179], a[112:115], v[160:163]
  s_add_u32 s74, s74, 65536
  v_fmac_f32 v88, v21, v24
  v_fmac_f32 v89, v21, v25
  v_mfma_f32_16x16x32_bf16 v[164:167], a[176:179], a[116:119], v[164:167]
  ds_read_b64_tr_b16 a[172:173], v4 offset:36864
  v_fmac_f32 v90, v21, v26
  v_mfma_f32_16x16x32_bf16 v[164:167], a[180:183], a[100:103], v[164:167]
  buffer_load_dwordx4 a[12:15], v1, s[8:11], s74 offen offset:0 sc1
  v_fmac_f32 v91, v21, v27
  v_fmac_f32 v92, v23, v24
  v_mfma_f32_16x16x32_bf16 v[168:171], a[180:183], a[104:107], v[168:171]
  ds_read_b64_tr_b16 a[174:175], v4 offset:38912
  v_fmac_f32 v93, v23, v25
  v_mfma_f32_16x16x32_bf16 v[168:171], a[176:179], a[120:123], v[168:171]
  v_fmac_f32 v94, v23, v26
  v_fmac_f32 v95, v23, v27
  v_mfma_f32_16x16x32_bf16 v[172:175], a[176:179], a[124:127], v[172:175]
  ds_read_b64_tr_b16 a[176:177], v4 offset:40960
  v_mfma_f32_16x16x32_bf16 v[172:175], a[180:183], a[108:111], v[172:175]
  s_waitcnt lgkmcnt(5)
  ds_read_b128 v[24:27], v12 offset:1344
  v_mfma_f32_16x16x32_bf16 v[188:191], a[160:163], a[108:111], v[188:191]
  ds_read_b64_tr_b16 a[178:179], v4 offset:43008
  s_waitcnt lgkmcnt(9)
  v_mfma_f32_16x16x32_bf16 v[188:191], a[164:167], a[124:127], v[188:191]
  buffer_load_dwordx4 a[28:31], v1, s[8:11], s74 offen offset:1024 sc1
  v_fmac_f32 v96, v16, v28
  v_fmac_f32 v97, v16, v29
  v_mfma_f32_16x16x32_bf16 v[184:187], a[164:167], a[120:123], v[184:187]
  ds_read_b64_tr_b16 a[180:181], v4 offset:45056
  v_fmac_f32 v98, v16, v30
  v_mfma_f32_16x16x32_bf16 v[184:187], a[160:163], a[104:107], v[184:187]
  v_fmac_f32 v99, v16, v31
  v_fmac_f32 v100, v18, v28
  v_mfma_f32_16x16x32_bf16 v[180:183], a[160:163], a[100:103], v[180:183]
  ds_read_b64_tr_b16 a[182:183], v4 offset:47104
  v_fmac_f32 v101, v18, v29
  v_mfma_f32_16x16x32_bf16 v[180:183], a[164:167], a[116:119], v[180:183]
  buffer_load_dwordx4 a[32:35], v1, s[8:11], s75 offen offset:0 sc1
  v_fmac_f32 v102, v18, v30
  v_fmac_f32 v103, v18, v31
  v_mfma_f32_16x16x32_bf16 v[176:179], a[164:167], a[112:115], v[176:179]
  ds_read_b64_tr_b16 a[164:165], v5 offset:32768
  v_fmac_f32 v104, v20, v28
  v_mfma_f32_16x16x32_bf16 v[176:179], a[160:163], a[96:99], v[176:179]
  s_waitcnt lgkmcnt(6)
  v_fmac_f32 v105, v20, v29
  v_fmac_f32 v106, v20, v30
  v_mfma_f32_16x16x32_bf16 v[192:195], a[168:171], a[96:99], v[192:195]
  ds_read_b64_tr_b16 a[166:167], v5 offset:34816
  v_fmac_f32 v107, v20, v31
  v_mfma_f32_16x16x32_bf16 v[192:195], a[172:175], a[112:115], v[192:195]
  v_fmac_f32 v108, v22, v28
  v_fmac_f32 v109, v22, v29
  v_mfma_f32_16x16x32_bf16 v[196:199], a[172:175], a[116:119], v[196:199]
  ds_read_b64_tr_b16 a[160:161], v5 offset:36864
  v_fmac_f32 v110, v22, v30
  v_mfma_f32_16x16x32_bf16 v[196:199], a[168:171], a[100:103], v[196:199]
  buffer_load_dwordx4 a[48:51], v1, s[8:11], s75 offen offset:1024 sc1
  v_fmac_f32 v111, v22, v31
  v_mfma_f32_16x16x32_bf16 v[200:203], a[168:171], a[104:107], v[200:203]
  ds_read_b64_tr_b16 a[162:163], v5 offset:38912
  v_mfma_f32_16x16x32_bf16 v[200:203], a[172:175], a[120:123], v[200:203]
  s_add_u32 s75, s75, 65536
  ds_read_b128 v[28:31], v12 offset:1856
  v_mfma_f32_16x16x32_bf16 v[204:207], a[172:175], a[124:127], v[204:207]
  ds_read_b64_tr_b16 a[172:173], v5 offset:40960
  s_waitcnt lgkmcnt(9)
  v_mfma_f32_16x16x32_bf16 v[204:207], a[168:171], a[108:111], v[204:207]
  s_waitcnt lgkmcnt(6)
  buffer_load_dwordx4 a[36:39], v1, s[8:11], s75 offen offset:0 sc1
  v_fmac_f32 v112, v16, v24
  v_mfma_f32_16x16x32_bf16 v[220:223], a[176:179], a[108:111], v[220:223]
  ds_read_b64_tr_b16 a[174:175], v5 offset:43008
  v_fmac_f32 v113, v16, v25
  v_mfma_f32_16x16x32_bf16 v[220:223], a[180:183], a[124:127], v[220:223]
  v_fmac_f32 v114, v16, v26
  v_fmac_f32 v115, v16, v27
  v_mfma_f32_16x16x32_bf16 v[216:219], a[180:183], a[120:123], v[216:219]
  ds_read_b64_tr_b16 a[168:169], v5 offset:45056
  v_fmac_f32 v116, v18, v24
  v_mfma_f32_16x16x32_bf16 v[216:219], a[176:179], a[104:107], v[216:219]
  v_fmac_f32 v117, v18, v25
  v_fmac_f32 v118, v18, v26
  v_mfma_f32_16x16x32_bf16 v[212:215], a[176:179], a[100:103], v[212:215]
  ds_read_b64_tr_b16 a[170:171], v5 offset:47104
  buffer_load_dwordx4 a[52:55], v1, s[8:11], s75 offen offset:1024 sc1
  v_mfma_f32_16x16x32_bf16 v[212:215], a[180:183], a[116:119], v[212:215]
  s_waitcnt vmcnt(32)
  s_barrier
  v_mfma_f32_16x16x32_bf16 v[208:211], a[180:183], a[112:115], v[208:211]
  ds_read_b64_tr_b16 a[180:181], v6 offset:49152
  v_fmac_f32 v119, v18, v27
  v_mfma_f32_16x16x32_bf16 v[208:211], a[176:179], a[96:99], v[208:211]
  s_waitcnt lgkmcnt(6)
  s_add_u32 s75, s75, 65536
  v_fmac_f32 v120, v20, v24
  v_mfma_f32_16x16x32_bf16 v[224:227], a[164:167], a[96:99], v[224:227]
  ds_read_b64_tr_b16 a[182:183], v6 offset:51200
  v_fmac_f32 v121, v20, v25
  v_mfma_f32_16x16x32_bf16 v[224:227], a[160:163], a[112:115], v[224:227]
  buffer_load_dwordx4 a[40:43], v1, s[8:11], s75 offen offset:0 sc1
  v_fmac_f32 v122, v20, v26
  v_fmac_f32 v123, v20, v27
  v_mfma_f32_16x16x32_bf16 v[228:231], a[160:163], a[116:119], v[228:231]
  ds_read_b64_tr_b16 a[176:177], v6 offset:53248
  v_fmac_f32 v124, v22, v24
  v_mfma_f32_16x16x32_bf16 v[228:231], a[164:167], a[100:103], v[228:231]
  v_fmac_f32 v125, v22, v25
  v_fmac_f32 v126, v22, v26
  v_mfma_f32_16x16x32_bf16 v[232:235], a[164:167], a[104:107], v[232:235]
  ds_read_b64_tr_b16 a[178:179], v6 offset:55296
  v_fmac_f32 v127, v22, v27
  v_mfma_f32_16x16x32_bf16 v[232:235], a[160:163], a[120:123], v[232:235]
  ds_read_b128 v[24:27], v12 offset:1024
  s_waitcnt lgkmcnt(9)
  v_mfma_f32_16x16x32_bf16 v[236:239], a[160:163], a[124:127], v[236:239]
  ds_read_b64_tr_b16 a[160:161], v6 offset:57344
  v_fmac_f32 v112, v17, v28
  v_mfma_f32_16x16x32_bf16 v[236:239], a[164:167], a[108:111], v[236:239]
  s_waitcnt lgkmcnt(6)
  buffer_load_dwordx4 a[56:59], v1, s[8:11], s75 offen offset:1024 sc1
  v_fmac_f32 v113, v17, v29
  v_mfma_f32_16x16x32_bf16 v[252:255], a[172:175], a[108:111], v[252:255]
  ds_read_b64_tr_b16 a[162:163], v6 offset:59392
  v_fmac_f32 v114, v17, v30
  v_mfma_f32_16x16x32_bf16 v[252:255], a[168:171], a[124:127], v[252:255]
  s_add_u32 s75, s75, 65536
  v_fmac_f32 v115, v17, v31
  v_fmac_f32 v116, v19, v28
  v_mfma_f32_16x16x32_bf16 v[248:251], a[168:171], a[120:123], v[248:251]
  ds_read_b64_tr_b16 a[164:165], v6 offset:61440
  v_fmac_f32 v117, v19, v29
  v_mfma_f32_16x16x32_bf16 v[248:251], a[172:175], a[104:107], v[248:251]
  buffer_load_dwordx4 a[44:47], v1, s[8:11], s75 offen offset:0 sc1
  v_fmac_f32 v118, v19, v30
  v_fmac_f32 v119, v19, v31
  v_mfma_f32_16x16x32_bf16 v[244:247], a[172:175], a[100:103], v[244:247]
  ds_read_b64_tr_b16 a[166:167], v6 offset:63488
  v_fmac_f32 v120, v21, v28
  v_mfma_f32_16x16x32_bf16 v[244:247], a[168:171], a[116:119], v[244:247]
  v_fmac_f32 v121, v21, v29
  v_fmac_f32 v122, v21, v30
  v_mfma_f32_16x16x32_bf16 v[240:243], a[168:171], a[112:115], v[240:243]
  ds_read_b64_tr_b16 a[168:169], v7 offset:49152
  v_fmac_f32 v123, v21, v31
  v_mfma_f32_16x16x32_bf16 v[240:243], a[172:175], a[96:99], v[240:243]
  s_waitcnt vmcnt(27) lgkmcnt(6)
  v_fmac_f32 v124, v23, v28
  v_fmac_f32 v125, v23, v29
  v_mfma_f32_16x16x32_bf16 v[64:67], a[180:183], a[128:131], v[64:67]
  ds_read_b64_tr_b16 a[170:171], v7 offset:51200
  v_fmac_f32 v126, v23, v30
  v_mfma_f32_16x16x32_bf16 v[64:67], a[176:179], a[144:147], v[64:67]
  buffer_load_dwordx4 a[60:63], v1, s[8:11], s75 offen offset:1024 sc1
  v_fmac_f32 v127, v23, v31
  v_mfma_f32_16x16x32_bf16 v[68:71], a[176:179], a[148:151], v[68:71]
  ds_read_b64_tr_b16 a[172:173], v7 offset:53248
  v_mfma_f32_16x16x32_bf16 v[68:71], a[180:183], a[132:135], v[68:71]
  s_mov_b32 s68, 5505024
  s_add_u32 s76, s57, 24576
  s_add_u32 m0, s45, 98304
  ds_read_b128 v[28:31], v12 offset:1536
  v_mfma_f32_16x16x32_bf16 v[72:75], a[180:183], a[136:139], v[72:75]
  ds_read_b64_tr_b16 a[174:175], v7 offset:55296
  s_waitcnt lgkmcnt(9)
  v_mfma_f32_16x16x32_bf16 v[72:75], a[176:179], a[152:155], v[72:75]
  buffer_load_dwordx4 v11, s[28:31], s68 offen lds
  v_fmac_f32 v144, v16, v24
  v_fmac_f32 v145, v16, v25
  v_mfma_f32_16x16x32_bf16 v[76:79], a[176:179], a[156:159], v[76:79]
  ds_read_b64_tr_b16 a[176:177], v7 offset:57344
  v_fmac_f32 v146, v16, v26
  v_mfma_f32_16x16x32_bf16 v[76:79], a[180:183], a[140:143], v[76:79]
  s_waitcnt lgkmcnt(6)
  v_fmac_f32 v147, v16, v27
  v_fmac_f32 v148, v18, v24
  v_mfma_f32_16x16x32_bf16 v[92:95], a[160:163], a[140:143], v[92:95]
  ds_read_b64_tr_b16 a[178:179], v7 offset:59392
  v_fmac_f32 v149, v18, v25
  v_mfma_f32_16x16x32_bf16 v[92:95], a[164:167], a[156:159], v[92:95]
  s_add_u32 m0, s45, 106496
  v_fmac_f32 v150, v18, v26
  v_fmac_f32 v151, v18, v27
  v_mfma_f32_16x16x32_bf16 v[88:91], a[164:167], a[152:155], v[88:91]
  ds_read_b64_tr_b16 a[180:181], v7 offset:61440
  v_fmac_f32 v152, v20, v24
  v_mfma_f32_16x16x32_bf16 v[88:91], a[160:163], a[136:139], v[88:91]
  buffer_load_dwordx4 v11, s[32:35], s68 offen lds
  v_fmac_f32 v153, v20, v25
  v_fmac_f32 v154, v20, v26
  v_mfma_f32_16x16x32_bf16 v[84:87], a[160:163], a[132:135], v[84:87]
  ds_read_b64_tr_b16 a[182:183], v7 offset:63488
  v_fmac_f32 v155, v20, v27
  v_mfma_f32_16x16x32_bf16 v[84:87], a[164:167], a[148:151], v[84:87]
  s_add_u32 m0, s45, 102400
  s_add_u32 s61, s68, 229376
  v_fmac_f32 v156, v22, v24
  v_mfma_f32_16x16x32_bf16 v[80:83], a[164:167], a[144:147], v[80:83]
  ds_read_b64_tr_b16 a[164:165], v8 offset:49152
  v_fmac_f32 v157, v22, v25
  v_mfma_f32_16x16x32_bf16 v[80:83], a[160:163], a[128:131], v[80:83]
  s_waitcnt lgkmcnt(5)
  buffer_load_dwordx4 v11, s[28:31], s61 offen lds
  v_fmac_f32 v158, v22, v26
  v_mfma_f32_16x16x32_bf16 v[96:99], a[168:171], a[128:131], v[96:99]
  ds_read_b64_tr_b16 a[166:167], v8 offset:51200
  v_fmac_f32 v159, v22, v27
  v_mfma_f32_16x16x32_bf16 v[96:99], a[172:175], a[144:147], v[96:99]
  ds_read_b128 v[24:27], v12 offset:64
  s_waitcnt lgkmcnt(8)
  v_mfma_f32_16x16x32_bf16 v[100:103], a[172:175], a[148:151], v[100:103]
  ds_read_b64_tr_b16 a[160:161], v8 offset:53248
  v_fmac_f32 v144, v17, v28
  v_mfma_f32_16x16x32_bf16 v[100:103], a[168:171], a[132:135], v[100:103]
  s_add_u32 m0, s45, 110592
  s_add_u32 s61, s68, 229376
  v_fmac_f32 v145, v17, v29
  v_mfma_f32_16x16x32_bf16 v[104:107], a[168:171], a[136:139], v[104:107]
  ds_read_b64_tr_b16 a[162:163], v8 offset:55296
  v_fmac_f32 v146, v17, v30
  v_mfma_f32_16x16x32_bf16 v[104:107], a[172:175], a[152:155], v[104:107]
  buffer_load_dwordx4 v11, s[32:35], s61 offen lds
  v_fmac_f32 v147, v17, v31
  v_fmac_f32 v148, v19, v28
  v_mfma_f32_16x16x32_bf16 v[108:111], a[172:175], a[156:159], v[108:111]
  ds_read_b64_tr_b16 a[172:173], v8 offset:57344
  v_fmac_f32 v149, v19, v29
  v_mfma_f32_16x16x32_bf16 v[108:111], a[168:171], a[140:143], v[108:111]
  s_waitcnt lgkmcnt(6)
  s_add_u32 s62, s92, 0
  v_fmac_f32 v150, v19, v30
  v_mfma_f32_16x16x32_bf16 v[124:127], a[176:179], a[140:143], v[124:127]
  ds_read_b64_tr_b16 a[174:175], v8 offset:59392
  v_fmac_f32 v151, v19, v31
  v_mfma_f32_16x16x32_bf16 v[124:127], a[180:183], a[156:159], v[124:127]
  buffer_load_dword a253, v13, s[36:39], s62 offen
  v_fmac_f32 v152, v21, v28
  v_fmac_f32 v153, v21, v29
  v_mfma_f32_16x16x32_bf16 v[120:123], a[180:183], a[152:155], v[120:123]
  ds_read_b64_tr_b16 a[168:169], v8 offset:61440
  v_fmac_f32 v154, v21, v30
  v_mfma_f32_16x16x32_bf16 v[120:123], a[176:179], a[136:139], v[120:123]
  v_fmac_f32 v155, v21, v31
  v_fmac_f32 v156, v23, v28
  v_mfma_f32_16x16x32_bf16 v[116:119], a[176:179], a[132:135], v[116:119]
  ds_read_b64_tr_b16 a[170:171], v8 offset:63488
  v_fmac_f32 v157, v23, v29
  v_mfma_f32_16x16x32_bf16 v[116:119], a[180:183], a[148:151], v[116:119]
  v_fmac_f32 v158, v23, v30
  v_fmac_f32 v159, v23, v31
  v_mfma_f32_16x16x32_bf16 v[112:115], a[180:183], a[144:147], v[112:115]
  ds_read_b64_tr_b16 a[180:181], v2 offset:49152
  v_mfma_f32_16x16x32_bf16 v[112:115], a[176:179], a[128:131], v[112:115]
  s_waitcnt lgkmcnt(5)
  ds_read_b128 v[28:31], v12 offset:1088
  v_mfma_f32_16x16x32_bf16 v[32:35], a[164:167], a[128:131], v[32:35]
  ds_read_b64_tr_b16 a[182:183], v2 offset:51200
  s_waitcnt lgkmcnt(9)
  v_mfma_f32_16x16x32_bf16 v[32:35], a[160:163], a[144:147], v[32:35]
  v_fmac_f32 v160, v16, v24
  v_fmac_f32 v161, v16, v25
  v_mfma_f32_16x16x32_bf16 v[36:39], a[160:163], a[148:151], v[36:39]
  ds_read_b64_tr_b16 a[176:177], v2 offset:53248
  v_fmac_f32 v162, v16, v26
  v_mfma_f32_16x16x32_bf16 v[36:39], a[164:167], a[132:135], v[36:39]
  buffer_load_dwordx4 a[64:67], v1, s[8:11], s76 offen offset:0 sc1
  v_fmac_f32 v163, v16, v27
  v_fmac_f32 v164, v18, v24
  v_mfma_f32_16x16x32_bf16 v[40:43], a[164:167], a[136:139], v[40:43]
  ds_read_b64_tr_b16 a[178:179], v2 offset:55296
  v_fmac_f32 v165, v18, v25
  v_mfma_f32_16x16x32_bf16 v[40:43], a[160:163], a[152:155], v[40:43]
  v_fmac_f32 v166, v18, v26
  v_fmac_f32 v167, v18, v27
  v_mfma_f32_16x16x32_bf16 v[44:47], a[160:163], a[156:159], v[44:47]
  ds_read_b64_tr_b16 a[160:161], v2 offset:57344
  v_fmac_f32 v168, v20, v24
  v_mfma_f32_16x16x32_bf16 v[44:47], a[164:167], a[140:143], v[44:47]
  s_waitcnt lgkmcnt(6)
  v_fmac_f32 v169, v20, v25
  v_fmac_f32 v170, v20, v26
  v_mfma_f32_16x16x32_bf16 v[60:63], a[172:175], a[140:143], v[60:63]
  ds_read_b64_tr_b16 a[162:163], v2 offset:59392
  v_fmac_f32 v171, v20, v27
  v_mfma_f32_16x16x32_bf16 v[60:63], a[168:171], a[156:159], v[60:63]
  buffer_load_dwordx4 a[80:83], v1, s[8:11], s76 offen offset:1024 sc1
  v_fmac_f32 v172, v22, v24
  v_fmac_f32 v173, v22, v25
  v_mfma_f32_16x16x32_bf16 v[56:59], a[168:171], a[152:155], v[56:59]
  ds_read_b64_tr_b16 a[164:165], v2 offset:61440
  v_fmac_f32 v174, v22, v26
  v_mfma_f32_16x16x32_bf16 v[56:59], a[172:175], a[136:139], v[56:59]
  s_add_u32 s76, s76, 65536
  v_fmac_f32 v175, v22, v27
  v_mfma_f32_16x16x32_bf16 v[52:55], a[172:175], a[132:135], v[52:55]
  ds_read_b64_tr_b16 a[166:167], v2 offset:63488
  v_mfma_f32_16x16x32_bf16 v[52:55], a[168:171], a[148:151], v[52:55]
  buffer_load_dwordx4 a[68:71], v1, s[8:11], s76 offen offset:0 sc1
  ds_read_b128 v[24:27], v12 offset:128
  v_mfma_f32_16x16x32_bf16 v[48:51], a[168:171], a[144:147], v[48:51]
  ds_read_b64_tr_b16 a[168:169], v3 offset:49152
  s_waitcnt lgkmcnt(9)
  v_mfma_f32_16x16x32_bf16 v[48:51], a[172:175], a[128:131], v[48:51]
  s_waitcnt lgkmcnt(6)
  v_fmac_f32 v176, v16, v28
  v_fmac_f32 v177, v16, v29
  v_mfma_f32_16x16x32_bf16 v[128:131], a[180:183], a[128:131], v[128:131]
  ds_read_b64_tr_b16 a[170:171], v3 offset:51200
  v_fmac_f32 v178, v16, v30
  v_mfma_f32_16x16x32_bf16 v[128:131], a[176:179], a[144:147], v[128:131]
  v_fmac_f32 v179, v16, v31
  v_fmac_f32 v180, v18, v28
  v_mfma_f32_16x16x32_bf16 v[132:135], a[176:179], a[148:151], v[132:135]
  ds_read_b64_tr_b16 a[172:173], v3 offset:53248
  v_fmac_f32 v181, v18, v29
  v_mfma_f32_16x16x32_bf16 v[132:135], a[180:183], a[132:135], v[132:135]
  buffer_load_dwordx4 a[84:87], v1, s[8:11], s76 offen offset:1024 sc1
  v_fmac_f32 v182, v18, v30
  v_fmac_f32 v183, v18, v31
  v_mfma_f32_16x16x32_bf16 v[136:139], a[180:183], a[136:139], v[136:139]
  ds_read_b64_tr_b16 a[174:175], v3 offset:55296
  v_fmac_f32 v184, v20, v28
  v_mfma_f32_16x16x32_bf16 v[136:139], a[176:179], a[152:155], v[136:139]
  s_add_u32 s76, s76, 65536
  v_fmac_f32 v185, v20, v29
  v_fmac_f32 v186, v20, v30
  v_mfma_f32_16x16x32_bf16 v[140:143], a[176:179], a[156:159], v[140:143]
  ds_read_b64_tr_b16 a[176:177], v3 offset:57344
  v_fmac_f32 v187, v20, v31
  v_mfma_f32_16x16x32_bf16 v[140:143], a[180:183], a[140:143], v[140:143]
  s_waitcnt lgkmcnt(6)
  buffer_load_dwordx4 a[72:75], v1, s[8:11], s76 offen offset:0 sc1
  v_fmac_f32 v188, v22, v28
  v_mfma_f32_16x16x32_bf16 v[156:159], a[160:163], a[140:143], v[156:159]
  ds_read_b64_tr_b16 a[178:179], v3 offset:59392
  v_fmac_f32 v189, v22, v29
  v_mfma_f32_16x16x32_bf16 v[156:159], a[164:167], a[156:159], v[156:159]
  v_fmac_f32 v190, v22, v30
  v_fmac_f32 v191, v22, v31
  v_mfma_f32_16x16x32_bf16 v[152:155], a[164:167], a[152:155], v[152:155]
  ds_read_b64_tr_b16 a[180:181], v3 offset:61440
  v_mfma_f32_16x16x32_bf16 v[152:155], a[160:163], a[136:139], v[152:155]
  ds_read_b128 v[28:31], v12 offset:192
  s_waitcnt lgkmcnt(8)
  v_mfma_f32_16x16x32_bf16 v[148:151], a[160:163], a[132:135], v[148:151]
  ds_read_b64_tr_b16 a[182:183], v3 offset:63488
  v_fmac_f32 v192, v16, v24
  v_mfma_f32_16x16x32_bf16 v[148:151], a[164:167], a[148:151], v[148:151]
  buffer_load_dwordx4 a[88:91], v1, s[8:11], s76 offen offset:1024 sc1
  v_fmac_f32 v193, v16, v25
  v_fmac_f32 v194, v16, v26
  v_mfma_f32_16x16x32_bf16 v[144:147], a[164:167], a[144:147], v[144:147]
  ds_read_b64_tr_b16 a[164:165], v4 offset:49152
  v_fmac_f32 v195, v16, v27
  v_mfma_f32_16x16x32_bf16 v[144:147], a[160:163], a[128:131], v[144:147]
  s_waitcnt lgkmcnt(6)
  s_add_u32 s76, s76, 65536
  v_fmac_f32 v196, v18, v24
  v_mfma_f32_16x16x32_bf16 v[160:163], a[168:171], a[128:131], v[160:163]
  ds_read_b64_tr_b16 a[166:167], v4 offset:51200
HOP12:
  s_cbranch_execz WRET0
  v_fmac_f32 v197, v18, v25
  v_mfma_f32_16x16x32_bf16 v[160:163], a[172:175], a[144:147], v[160:163]
  buffer_load_dwordx4 a[76:79], v1, s[8:11], s76 offen offset:0 sc1
  v_fmac_f32 v198, v18, v26
  v_fmac_f32 v199, v18, v27
  v_mfma_f32_16x16x32_bf16 v[164:167], a[172:175], a[148:151], v[164:167]
  ds_read_b64_tr_b16 a[160:161], v4 offset:53248
  v_fmac_f32 v200, v20, v24
  v_mfma_f32_16x16x32_bf16 v[164:167], a[168:171], a[132:135], v[164:167]
  v_fmac_f32 v201, v20, v25
  v_fmac_f32 v202, v20, v26
  v_mfma_f32_16x16x32_bf16 v[168:171], a[168:171], a[136:139], v[168:171]
  ds_read_b64_tr_b16 a[162:163], v4 offset:55296
  v_fmac_f32 v203, v20, v27
  v_mfma_f32_16x16x32_bf16 v[168:171], a[172:175], a[152:155], v[168:171]
  v_fmac_f32 v204, v22, v24
  v_fmac_f32 v205, v22, v25
  v_mfma_f32_16x16x32_bf16 v[172:175], a[172:175], a[156:159], v[172:175]
  ds_read_b64_tr_b16 a[172:173], v4 offset:57344
  v_fmac_f32 v206, v22, v26
  v_mfma_f32_16x16x32_bf16 v[172:175], a[168:171], a[140:143], v[172:175]
  s_waitcnt lgkmcnt(5)
  buffer_load_dwordx4 a[92:95], v1, s[8:11], s76 offen offset:1024 sc1
  v_fmac_f32 v207, v22, v27
  v_mfma_f32_16x16x32_bf16 v[188:191], a[176:179], a[140:143], v[188:191]
  ds_read_b64_tr_b16 a[174:175], v4 offset:59392
  v_mfma_f32_16x16x32_bf16 v[188:191], a[180:183], a[156:159], v[188:191]
  s_mov_b32 s69, 5963776
  s_add_u32 s77, s57, 26624
  ds_read_b128 v[24:27], v12 offset:1600
  v_mfma_f32_16x16x32_bf16 v[184:187], a[180:183], a[152:155], v[184:187]
  ds_read_b64_tr_b16 a[168:169], v4 offset:61440
  s_waitcnt lgkmcnt(9)
  v_mfma_f32_16x16x32_bf16 v[184:187], a[176:179], a[136:139], v[184:187]
  buffer_load_dwordx4 a[96:99], v1, s[8:11], s77 offen offset:0 sc1
  v_fmac_f32 v224, v16, v28
  v_fmac_f32 v225, v16, v29
  v_mfma_f32_16x16x32_bf16 v[180:183], a[176:179], a[132:135], v[180:183]
  ds_read_b64_tr_b16 a[170:171], v4 offset:63488
  v_fmac_f32 v226, v16, v30
  v_mfma_f32_16x16x32_bf16 v[180:183], a[180:183], a[148:151], v[180:183]
  v_fmac_f32 v227, v16, v31
  v_fmac_f32 v228, v18, v28
  v_mfma_f32_16x16x32_bf16 v[176:179], a[180:183], a[144:147], v[176:179]
  ds_read_b64_tr_b16 a[180:181], v5 offset:49152
  v_fmac_f32 v229, v18, v29
  v_mfma_f32_16x16x32_bf16 v[176:179], a[176:179], a[128:131], v[176:179]
  s_waitcnt lgkmcnt(6)
  v_fmac_f32 v230, v18, v30
  v_fmac_f32 v231, v18, v31
  v_mfma_f32_16x16x32_bf16 v[192:195], a[164:167], a[128:131], v[192:195]
  ds_read_b64_tr_b16 a[182:183], v5 offset:51200
  v_fmac_f32 v232, v20, v28
  v_mfma_f32_16x16x32_bf16 v[192:195], a[160:163], a[144:147], v[192:195]
  buffer_load_dwordx4 a[112:115], v1, s[8:11], s77 offen offset:1024 sc1
  v_fmac_f32 v233, v20, v29
  v_fmac_f32 v234, v20, v30
  v_mfma_f32_16x16x32_bf16 v[196:199], a[160:163], a[148:151], v[196:199]
  ds_read_b64_tr_b16 a[176:177], v5 offset:53248
  v_fmac_f32 v235, v20, v31
  v_mfma_f32_16x16x32_bf16 v[196:199], a[164:167], a[132:135], v[196:199]
  s_add_u32 s77, s77, 65536
  v_fmac_f32 v236, v22, v28
  v_fmac_f32 v237, v22, v29
  v_mfma_f32_16x16x32_bf16 v[200:203], a[164:167], a[136:139], v[200:203]
  ds_read_b64_tr_b16 a[178:179], v5 offset:55296
  v_fmac_f32 v238, v22, v30
  v_mfma_f32_16x16x32_bf16 v[200:203], a[160:163], a[152:155], v[200:203]
  buffer_load_dwordx4 a[100:103], v1, s[8:11], s77 offen offset:0 sc1
  v_fmac_f32 v239, v22, v31
  v_mfma_f32_16x16x32_bf16 v[204:207], a[160:163], a[156:159], v[204:207]
  ds_read_b64_tr_b16 a[160:161], v5 offset:57344
  v_mfma_f32_16x16x32_bf16 v[204:207], a[164:167], a[140:143], v[204:207]
  s_waitcnt lgkmcnt(5)
  ds_read_b128 v[28:31], v12 offset:1152
  v_mfma_f32_16x16x32_bf16 v[220:223], a[172:175], a[140:143], v[220:223]
  ds_read_b64_tr_b16 a[162:163], v5 offset:59392
  s_waitcnt lgkmcnt(9)
  v_mfma_f32_16x16x32_bf16 v[220:223], a[168:171], a[156:159], v[220:223]
  v_fmac_f32 v176, v17, v24
  v_fmac_f32 v177, v17, v25
  v_mfma_f32_16x16x32_bf16 v[216:219], a[168:171], a[152:155], v[216:219]
  ds_read_b64_tr_b16 a[164:165], v5 offset:61440
  v_fmac_f32 v178, v17, v26
  v_mfma_f32_16x16x32_bf16 v[216:219], a[172:175], a[136:139], v[216:219]
  buffer_load_dwordx4 a[116:119], v1, s[8:11], s77 offen offset:1024 sc1
  v_fmac_f32 v179, v17, v27
  v_fmac_f32 v180, v19, v24
  v_mfma_f32_16x16x32_bf16 v[212:215], a[172:175], a[132:135], v[212:215]
  ds_read_b64_tr_b16 a[166:167], v5 offset:63488
  v_fmac_f32 v181, v19, v25
  v_mfma_f32_16x16x32_bf16 v[212:215], a[168:171], a[148:151], v[212:215]
  s_waitcnt vmcnt(33)
  s_barrier
  v_mfma_f32_16x16x32_bf16 v[208:211], a[168:171], a[144:147], v[208:211]
  ds_read_b64_tr_b16 a[168:169], v6 offset:16384
  s_add_u32 s62, s92, 2048
  v_mfma_f32_16x16x32_bf16 v[208:211], a[172:175], a[128:131], v[208:211]
  s_waitcnt lgkmcnt(6)
  buffer_load_dword a253, v13, s[36:39], s62 offen
  v_fmac_f32 v182, v19, v26
  v_mfma_f32_16x16x32_bf16 v[224:227], a[180:183], a[128:131], v[224:227]
  ds_read_b64_tr_b16 a[170:171], v6 offset:18432
  v_fmac_f32 v183, v19, v27
  v_mfma_f32_16x16x32_bf16 v[224:227], a[176:179], a[144:147], v[224:227]
  v_fmac_f32 v184, v21, v24
  v_fmac_f32 v185, v21, v25
  v_mfma_f32_16x16x32_bf16 v[228:231], a[176:179], a[148:151], v[228:231]
  ds_read_b64_tr_b16 a[172:173], v6 offset:20480
  v_fmac_f32 v186, v21, v26
  v_mfma_f32_16x16x32_bf16 v[228:231], a[180:183], a[132:135], v[228:231]
  v_fmac_f32 v187, v21, v27
  v_fmac_f32 v188, v23, v24
  v_mfma_f32_16x16x32_bf16 v[232:235], a[180:183], a[136:139], v[232:235]
  ds_read_b64_tr_b16 a[174:175], v6 offset:22528
  v_fmac_f32 v189, v23, v25
  v_mfma_f32_16x16x32_bf16 v[232:235], a[176:179], a[152:155], v[232:235]
  v_fmac_f32 v190, v23, v26
  v_fmac_f32 v191, v23, v27
  v_mfma_f32_16x16x32_bf16 v[236:239], a[176:179], a[156:159], v[236:239]
  ds_read_b64_tr_b16 a[176:177], v6 offset:24576
  v_mfma_f32_16x16x32_bf16 v[236:239], a[180:183], a[140:143], v[236:239]
  s_waitcnt lgkmcnt(5)
  s_add_u32 m0, s45, 114688
  v_mfma_f32_16x16x32_bf16 v[252:255], a[160:163], a[140:143], v[252:255]
  ds_read_b64_tr_b16 a[178:179], v6 offset:26624
  v_mfma_f32_16x16x32_bf16 v[252:255], a[164:167], a[156:159], v[252:255]
  buffer_load_dwordx4 v11, s[28:31], s69 offen lds
  ds_read_b128 v[24:27], v12 offset:1664
  v_mfma_f32_16x16x32_bf16 v[248:251], a[164:167], a[152:155], v[248:251]
  ds_read_b64_tr_b16 a[180:181], v6 offset:28672
  s_waitcnt lgkmcnt(11)
  v_mfma_f32_16x16x32_bf16 v[248:251], a[160:163], a[136:139], v[248:251]
  v_fmac_f32 v208, v16, v28
  v_fmac_f32 v209, v16, v29
  v_mfma_f32_16x16x32_bf16 v[244:247], a[160:163], a[132:135], v[244:247]
  ds_read_b64_tr_b16 a[182:183], v6 offset:30720
  v_fmac_f32 v210, v16, v30
  v_mfma_f32_16x16x32_bf16 v[244:247], a[164:167], a[148:151], v[244:247]
  s_add_u32 m0, s45, 122880
  v_fmac_f32 v211, v16, v31
  v_fmac_f32 v212, v18, v28
  v_mfma_f32_16x16x32_bf16 v[240:243], a[164:167], a[144:147], v[240:243]
  ds_read_b64_tr_b16 a[164:165], v7 offset:16384
  v_fmac_f32 v213, v18, v29
  v_mfma_f32_16x16x32_bf16 v[240:243], a[160:163], a[128:131], v[240:243]
  s_waitcnt vmcnt(27) lgkmcnt(6)
  buffer_load_dwordx4 v11, s[32:35], s69 offen lds
  v_fmac_f32 v214, v18, v30
  v_mfma_f32_16x16x32_bf16 v[64:67], a[168:171], a[0:3], v[64:67]
  ds_read_b64_tr_b16 a[166:167], v7 offset:18432
  v_fmac_f32 v215, v18, v31
  v_mfma_f32_16x16x32_bf16 v[64:67], a[172:175], a[16:19], v[64:67]
  s_add_u32 m0, s45, 118784
  s_add_u32 s61, s69, 229376
  v_fmac_f32 v216, v20, v28
  v_mfma_f32_16x16x32_bf16 v[68:71], a[172:175], a[20:23], v[68:71]
  ds_read_b64_tr_b16 a[160:161], v7 offset:20480
  v_fmac_f32 v217, v20, v29
  v_mfma_f32_16x16x32_bf16 v[68:71], a[168:171], a[4:7], v[68:71]
  buffer_load_dwordx4 v11, s[28:31], s61 offen lds
  v_fmac_f32 v218, v20, v30
  v_fmac_f32 v219, v20, v31
  v_mfma_f32_16x16x32_bf16 v[72:75], a[168:171], a[8:11], v[72:75]
  ds_read_b64_tr_b16 a[162:163], v7 offset:22528
  v_fmac_f32 v220, v22, v28
  v_mfma_f32_16x16x32_bf16 v[72:75], a[172:175], a[24:27], v[72:75]
  v_fmac_f32 v221, v22, v29
  v_fmac_f32 v222, v22, v30
  v_mfma_f32_16x16x32_bf16 v[76:79], a[172:175], a[28:31], v[76:79]
  ds_read_b64_tr_b16 a[172:173], v7 offset:24576
  v_fmac_f32 v223, v22, v31
  v_mfma_f32_16x16x32_bf16 v[76:79], a[168:171], a[12:15], v[76:79]
  s_waitcnt lgkmcnt(5)
  s_add_u32 m0, s45, 126976
  s_add_u32 s61, s69, 229376
  v_mfma_f32_16x16x32_bf16 v[92:95], a[176:179], a[12:15], v[92:95]
  ds_read_b64_tr_b16 a[174:175], v7 offset:26624
  v_mfma_f32_16x16x32_bf16 v[92:95], a[180:183], a[28:31], v[92:95]
  buffer_load_dwordx4 v11, s[32:35], s61 offen lds
  ds_read_b128 v[28:31], v12 offset:1216
  v_mfma_f32_16x16x32_bf16 v[88:91], a[180:183], a[24:27], v[88:91]
  ds_read_b64_tr_b16 a[168:169], v7 offset:28672
  s_waitcnt lgkmcnt(10)
  v_mfma_f32_16x16x32_bf16 v[88:91], a[176:179], a[8:11], v[88:91]
  s_add_u32 s77, s77, 65536
  v_fmac_f32 v208, v17, v24
  v_fmac_f32 v209, v17, v25
  v_mfma_f32_16x16x32_bf16 v[84:87], a[176:179], a[4:7], v[84:87]
  ds_read_b64_tr_b16 a[170:171], v7 offset:30720
  v_fmac_f32 v210, v17, v26
  v_mfma_f32_16x16x32_bf16 v[84:87], a[180:183], a[20:23], v[84:87]
  buffer_load_dwordx4 a[104:107], v1, s[8:11], s77 offen offset:0 sc1
  v_fmac_f32 v211, v17, v27
  v_fmac_f32 v212, v19, v24
  v_mfma_f32_16x16x32_bf16 v[80:83], a[180:183], a[16:19], v[80:83]
  ds_read_b64_tr_b16 a[180:181], v8 offset:16384
  v_fmac_f32 v213, v19, v25
  v_mfma_f32_16x16x32_bf16 v[80:83], a[176:179], a[0:3], v[80:83]
  s_waitcnt lgkmcnt(6)
  v_fmac_f32 v214, v19, v26
  v_fmac_f32 v215, v19, v27
  v_mfma_f32_16x16x32_bf16 v[96:99], a[164:167], a[0:3], v[96:99]
  ds_read_b64_tr_b16 a[182:183], v8 offset:18432
  v_fmac_f32 v216, v21, v24
  v_mfma_f32_16x16x32_bf16 v[96:99], a[160:163], a[16:19], v[96:99]
  v_fmac_f32 v217, v21, v25
  v_fmac_f32 v218, v21, v26
  v_mfma_f32_16x16x32_bf16 v[100:103], a[160:163], a[20:23], v[100:103]
  ds_read_b64_tr_b16 a[176:177], v8 offset:20480
  v_fmac_f32 v219, v21, v27
  v_mfma_f32_16x16x32_bf16 v[100:103], a[164:167], a[4:7], v[100:103]
  buffer_load_dwordx4 a[120:123], v1, s[8:11], s77 offen offset:1024 sc1
  v_fmac_f32 v220, v23, v24
  v_fmac_f32 v221, v23, v25
  v_mfma_f32_16x16x32_bf16 v[104:107], a[164:167], a[8:11], v[104:107]
  ds_read_b64_tr_b16 a[178:179], v8 offset:22528
  v_fmac_f32 v222, v23, v26
  v_mfma_f32_16x16x32_bf16 v[104:107], a[160:163], a[24:27], v[104:107]
  s_add_u32 s77, s77, 65536
  v_fmac_f32 v223, v23, v27
  v_mfma_f32_16x16x32_bf16 v[108:111], a[160:163], a[28:31], v[108:111]
  ds_read_b64_tr_b16 a[160:161], v8 offset:24576
  v_mfma_f32_16x16x32_bf16 v[108:111], a[164:167], a[12:15], v[108:111]
  s_waitcnt lgkmcnt(5)
  buffer_load_dwordx4 a[108:111], v1, s[8:11], s77 offen offset:0 sc1
  v_mfma_f32_16x16x32_bf16 v[124:127], a[172:175], a[12:15], v[124:127]
  ds_read_b64_tr_b16 a[162:163], v8 offset:26624
  v_mfma_f32_16x16x32_bf16 v[124:127], a[168:171], a[28:31], v[124:127]
  ds_read_b128 v[24:27], v12 offset:1728
  s_waitcnt lgkmcnt(9)
  v_mfma_f32_16x16x32_bf16 v[120:123], a[168:171], a[24:27], v[120:123]
  ds_read_b64_tr_b16 a[164:165], v8 offset:28672
  v_fmac_f32 v240, v16, v28
  v_mfma_f32_16x16x32_bf16 v[120:123], a[172:175], a[8:11], v[120:123]
  v_fmac_f32 v241, v16, v29
  v_fmac_f32 v242, v16, v30
  v_mfma_f32_16x16x32_bf16 v[116:119], a[172:175], a[4:7], v[116:119]
  ds_read_b64_tr_b16 a[166:167], v8 offset:30720
  v_fmac_f32 v243, v16, v31
  v_mfma_f32_16x16x32_bf16 v[116:119], a[168:171], a[20:23], v[116:119]
  buffer_load_dwordx4 a[124:127], v1, s[8:11], s77 offen offset:1024 sc1
  v_fmac_f32 v244, v18, v28
  v_fmac_f32 v245, v18, v29
  v_mfma_f32_16x16x32_bf16 v[112:115], a[168:171], a[16:19], v[112:115]
  ds_read_b64_tr_b16 a[168:169], v6 offset:0
  v_fmac_f32 v246, v18, v30
  v_mfma_f32_16x16x32_bf16 v[112:115], a[172:175], a[0:3], v[112:115]
  s_waitcnt lgkmcnt(6)
  s_mov_b32 s70, 6422528
  s_add_u32 s78, s57, 28672
  v_fmac_f32 v247, v18, v31
  v_mfma_f32_16x16x32_bf16 v[32:35], a[180:183], a[0:3], v[32:35]
  ds_read_b64_tr_b16 a[170:171], v6 offset:2048
  v_fmac_f32 v248, v20, v28
  v_mfma_f32_16x16x32_bf16 v[32:35], a[176:179], a[16:19], v[32:35]
  buffer_load_dwordx4 a[128:131], v1, s[8:11], s78 offen offset:0 sc1
  v_fmac_f32 v249, v20, v29
  v_fmac_f32 v250, v20, v30
  v_mfma_f32_16x16x32_bf16 v[36:39], a[176:179], a[20:23], v[36:39]
  ds_read_b64_tr_b16 a[172:173], v6 offset:4096
  v_fmac_f32 v251, v20, v31
  v_mfma_f32_16x16x32_bf16 v[36:39], a[180:183], a[4:7], v[36:39]
  v_fmac_f32 v252, v22, v28
  v_fmac_f32 v253, v22, v29
  v_mfma_f32_16x16x32_bf16 v[40:43], a[180:183], a[8:11], v[40:43]
  ds_read_b64_tr_b16 a[174:175], v6 offset:6144
  v_fmac_f32 v254, v22, v30
  v_mfma_f32_16x16x32_bf16 v[40:43], a[176:179], a[24:27], v[40:43]
  v_fmac_f32 v255, v22, v31
  v_mfma_f32_16x16x32_bf16 v[44:47], a[176:179], a[28:31], v[44:47]
  ds_read_b64_tr_b16 a[176:177], v6 offset:8192
  s_waitcnt lgkmcnt(7)
  v_mfma_f32_16x16x32_bf16 v[44:47], a[180:183], a[12:15], v[44:47]
  s_waitcnt lgkmcnt(5)
  buffer_load_dwordx4 a[144:147], v1, s[8:11], s78 offen offset:1024 sc1
  v_fmac_f32 v240, v17, v24
  v_mfma_f32_16x16x32_bf16 v[60:63], a[160:163], a[12:15], v[60:63]
  ds_read_b64_tr_b16 a[178:179], v6 offset:10240
  v_fmac_f32 v241, v17, v25
  v_mfma_f32_16x16x32_bf16 v[60:63], a[164:167], a[28:31], v[60:63]
  s_add_u32 s78, s78, 65536
  v_fmac_f32 v242, v17, v26
  v_fmac_f32 v243, v17, v27
  v_mfma_f32_16x16x32_bf16 v[56:59], a[164:167], a[24:27], v[56:59]
  ds_read_b64_tr_b16 a[180:181], v6 offset:12288
  v_fmac_f32 v244, v19, v24
  v_mfma_f32_16x16x32_bf16 v[56:59], a[160:163], a[8:11], v[56:59]
  buffer_load_dwordx4 a[132:135], v1, s[8:11], s78 offen offset:0 sc1
  v_fmac_f32 v245, v19, v25
  v_fmac_f32 v246, v19, v26
  v_mfma_f32_16x16x32_bf16 v[52:55], a[160:163], a[4:7], v[52:55]
  ds_read_b64_tr_b16 a[182:183], v6 offset:14336
  v_fmac_f32 v247, v19, v27
  v_mfma_f32_16x16x32_bf16 v[52:55], a[164:167], a[20:23], v[52:55]
  v_fmac_f32 v248, v21, v24
  v_fmac_f32 v249, v21, v25
  v_mfma_f32_16x16x32_bf16 v[48:51], a[164:167], a[16:19], v[48:51]
  ds_read_b64_tr_b16 a[164:165], v7 offset:0
  v_fmac_f32 v250, v21, v26
  v_mfma_f32_16x16x32_bf16 v[48:51], a[160:163], a[0:3], v[48:51]
  s_waitcnt vmcnt(29) lgkmcnt(5)
  v_fmac_f32 v251, v21, v27
  v_fmac_f32 v252, v23, v24
  v_mfma_f32_16x16x32_bf16 v[64:67], a[168:171], a[32:35], v[64:67]
  ds_read_b64_tr_b16 a[166:167], v7 offset:2048
  v_fmac_f32 v253, v23, v25
  v_mfma_f32_16x16x32_bf16 v[64:67], a[172:175], a[48:51], v[64:67]
  buffer_load_dwordx4 a[148:151], v1, s[8:11], s78 offen offset:1024 sc1
  v_fmac_f32 v254, v23, v26
  v_fmac_f32 v255, v23, v27
  v_mfma_f32_16x16x32_bf16 v[68:71], a[172:175], a[52:55], v[68:71]
  ds_read_b64_tr_b16 a[160:161], v7 offset:4096
  v_mfma_f32_16x16x32_bf16 v[68:71], a[168:171], a[36:39], v[68:71]
  s_add_u32 s62, s92, 4096
  ds_read_b128 v[28:31], v12 offset:896
  v_mfma_f32_16x16x32_bf16 v[72:75], a[168:171], a[40:43], v[72:75]
  ds_read_b64_tr_b16 a[162:163], v7 offset:6144
  v_mfma_f32_16x16x32_bf16 v[72:75], a[172:175], a[56:59], v[72:75]
  buffer_load_dword a253, v13, s[36:39], s62 offen
  v_rcp_f32 v16, v17
  v_mfma_f32_16x16x32_bf16 v[76:79], a[172:175], a[60:63], v[76:79]
  ds_read_b64_tr_b16 a[172:173], v7 offset:8192
  v_mfma_f32_16x16x32_bf16 v[76:79], a[168:171], a[44:47], v[76:79]
  s_waitcnt lgkmcnt(6)
  v_rcp_f32 v18, v19
  v_mfma_f32_16x16x32_bf16 v[92:95], a[176:179], a[44:47], v[92:95]
  ds_read_b64_tr_b16 a[174:175], v7 offset:10240
  v_mfma_f32_16x16x32_bf16 v[92:95], a[180:183], a[60:63], v[92:95]
  v_rcp_f32 v20, v21
  v_mfma_f32_16x16x32_bf16 v[88:91], a[180:183], a[56:59], v[88:91]
  ds_read_b64_tr_b16 a[168:169], v7 offset:12288
  v_mfma_f32_16x16x32_bf16 v[88:91], a[176:179], a[40:43], v[88:91]
  v_rcp_f32 v22, v23
  v_mfma_f32_16x16x32_bf16 v[84:87], a[176:179], a[36:39], v[84:87]
  ds_read_b64_tr_b16 a[170:171], v7 offset:14336
  v_mul_f32 v17, 0xbfb8aa3b, v17
  v_mfma_f32_16x16x32_bf16 v[84:87], a[180:183], a[52:55], v[84:87]
  s_add_u32 s78, s78, 65536
  v_mul_f32 v19, 0xbfb8aa3b, v19
  v_mul_f32 v21, 0xbfb8aa3b, v21
  v_mfma_f32_16x16x32_bf16 v[80:83], a[180:183], a[48:51], v[80:83]
  ds_read_b64_tr_b16 a[180:181], v8 offset:0
  v_mul_f32 v23, 0xbfb8aa3b, v23
  v_mfma_f32_16x16x32_bf16 v[80:83], a[176:179], a[32:35], v[80:83]
  s_waitcnt lgkmcnt(5)
  buffer_load_dwordx4 a[136:139], v1, s[8:11], s78 offen offset:0 sc1
  v_mul_f32 v16, 0xbfb8aa3b, v16
  v_mfma_f32_16x16x32_bf16 v[96:99], a[164:167], a[32:35], v[96:99]
  ds_read_b64_tr_b16 a[182:183], v8 offset:2048
  v_mul_f32 v18, 0xbfb8aa3b, v18
  v_mfma_f32_16x16x32_bf16 v[96:99], a[160:163], a[48:51], v[96:99]
  v_mul_f32 v20, 0xbfb8aa3b, v20
  v_mul_f32 v22, 0xbfb8aa3b, v22
  v_mfma_f32_16x16x32_bf16 v[100:103], a[160:163], a[52:55], v[100:103]
  ds_read_b64_tr_b16 a[176:177], v8 offset:4096
  v_mfma_f32_16x16x32_bf16 v[100:103], a[164:167], a[36:39], v[100:103]
  v_mfma_f32_16x16x32_bf16 v[104:107], a[164:167], a[40:43], v[104:107]
  ds_read_b64_tr_b16 a[178:179], v8 offset:6144
  v_mfma_f32_16x16x32_bf16 v[104:107], a[160:163], a[56:59], v[104:107]
  buffer_load_dwordx4 a[152:155], v1, s[8:11], s78 offen offset:1024 sc1
  v_mfma_f32_16x16x32_bf16 v[108:111], a[160:163], a[60:63], v[108:111]
  ds_read_b64_tr_b16 a[160:161], v8 offset:8192
  v_mfma_f32_16x16x32_bf16 v[108:111], a[164:167], a[44:47], v[108:111]
  s_waitcnt lgkmcnt(5)
  s_add_u32 s78, s78, 65536
  v_mfma_f32_16x16x32_bf16 v[124:127], a[172:175], a[44:47], v[124:127]
  ds_read_b64_tr_b16 a[162:163], v8 offset:10240
  v_mfma_f32_16x16x32_bf16 v[124:127], a[168:171], a[60:63], v[124:127]
  buffer_load_dwordx4 a[140:143], v1, s[8:11], s78 offen offset:0 sc1
  v_mfma_f32_16x16x32_bf16 v[120:123], a[168:171], a[56:59], v[120:123]
  ds_read_b64_tr_b16 a[164:165], v8 offset:12288
  v_mfma_f32_16x16x32_bf16 v[120:123], a[172:175], a[40:43], v[120:123]
  v_mfma_f32_16x16x32_bf16 v[116:119], a[172:175], a[36:39], v[116:119]
  ds_read_b64_tr_b16 a[166:167], v8 offset:14336
  v_mfma_f32_16x16x32_bf16 v[116:119], a[168:171], a[52:55], v[116:119]
  v_mfma_f32_16x16x32_bf16 v[112:115], a[168:171], a[48:51], v[112:115]
  ds_read_b64_tr_b16 a[168:169], v2 offset:16384
  v_mfma_f32_16x16x32_bf16 v[112:115], a[172:175], a[32:35], v[112:115]
  s_waitcnt lgkmcnt(5)
  buffer_load_dwordx4 a[156:159], v1, s[8:11], s78 offen offset:1024 sc1
  v_mfma_f32_16x16x32_bf16 v[32:35], a[180:183], a[32:35], v[32:35]
  ds_read_b64_tr_b16 a[170:171], v2 offset:18432
  v_mfma_f32_16x16x32_bf16 v[32:35], a[176:179], a[48:51], v[32:35]
  s_mov_b32 s71, 6881280
  s_add_u32 s79, s57, 30720
  v_mfma_f32_16x16x32_bf16 v[36:39], a[176:179], a[52:55], v[36:39]
  ds_read_b64_tr_b16 a[172:173], v2 offset:20480
  v_mfma_f32_16x16x32_bf16 v[36:39], a[180:183], a[36:39], v[36:39]
  buffer_load_dwordx4 a[188:191], v1, s[8:11], s79 offen offset:0 sc1
  v_mfma_f32_16x16x32_bf16 v[40:43], a[180:183], a[40:43], v[40:43]
  ds_read_b64_tr_b16 a[174:175], v2 offset:22528
  v_mfma_f32_16x16x32_bf16 v[40:43], a[176:179], a[56:59], v[40:43]
  v_mfma_f32_16x16x32_bf16 v[44:47], a[176:179], a[60:63], v[44:47]
  ds_read_b64_tr_b16 a[176:177], v2 offset:24576
  v_mfma_f32_16x16x32_bf16 v[44:47], a[180:183], a[44:47], v[44:47]
  s_waitcnt lgkmcnt(5)
  v_mfma_f32_16x16x32_bf16 v[60:63], a[160:163], a[44:47], v[60:63]
  ds_read_b64_tr_b16 a[178:179], v2 offset:26624
  s_barrier
  v_mfma_f32_16x16x32_bf16 v[60:63], a[164:167], a[60:63], v[60:63]
  buffer_load_dwordx4 a[204:207], v1, s[8:11], s79 offen offset:1024 sc1
  v_mfma_f32_16x16x32_bf16 v[56:59], a[164:167], a[56:59], v[56:59]
  ds_read_b64_tr_b16 a[180:181], v2 offset:28672
  v_mfma_f32_16x16x32_bf16 v[56:59], a[160:163], a[40:43], v[56:59]
  s_add_u32 m0, s45, 81920
  v_mfma_f32_16x16x32_bf16 v[52:55], a[160:163], a[36:39], v[52:55]
  ds_read_b64_tr_b16 a[182:183], v2 offset:30720
  v_mfma_f32_16x16x32_bf16 v[52:55], a[164:167], a[52:55], v[52:55]
  buffer_load_dwordx4 v11, s[28:31], s70 offen lds
  v_mfma_f32_16x16x32_bf16 v[48:51], a[164:167], a[48:51], v[48:51]
  ds_read_b64_tr_b16 a[164:165], v3 offset:16384
  v_mfma_f32_16x16x32_bf16 v[48:51], a[160:163], a[32:35], v[48:51]
  s_waitcnt lgkmcnt(5)
  v_mfma_f32_16x16x32_bf16 v[128:131], a[168:171], a[0:3], v[128:131]
  ds_read_b64_tr_b16 a[166:167], v3 offset:18432
  v_mfma_f32_16x16x32_bf16 v[128:131], a[172:175], a[16:19], v[128:131]
  s_add_u32 m0, s45, 90112
  v_mfma_f32_16x16x32_bf16 v[132:135], a[172:175], a[20:23], v[132:135]
  ds_read_b64_tr_b16 a[160:161], v3 offset:20480
  v_mfma_f32_16x16x32_bf16 v[132:135], a[168:171], a[4:7], v[132:135]
  buffer_load_dwordx4 v11, s[32:35], s70 offen lds
  v_mfma_f32_16x16x32_bf16 v[136:139], a[168:171], a[8:11], v[136:139]
  ds_read_b64_tr_b16 a[162:163], v3 offset:22528
  v_mfma_f32_16x16x32_bf16 v[136:139], a[172:175], a[24:27], v[136:139]
  s_add_u32 m0, s45, 86016
  s_add_u32 s61, s70, 229376
  v_mfma_f32_16x16x32_bf16 v[140:143], a[172:175], a[28:31], v[140:143]
  ds_read_b64_tr_b16 a[172:173], v3 offset:24576
  v_mfma_f32_16x16x32_bf16 v[140:143], a[168:171], a[12:15], v[140:143]
  s_waitcnt lgkmcnt(5)
  buffer_load_dwordx4 v11, s[28:31], s61 offen lds
  v_mfma_f32_16x16x32_bf16 v[156:159], a[176:179], a[12:15], v[156:159]
  ds_read_b64_tr_b16 a[174:175], v3 offset:26624
  v_mfma_f32_16x16x32_bf16 v[156:159], a[180:183], a[28:31], v[156:159]
  v_mfma_f32_16x16x32_bf16 v[152:155], a[180:183], a[24:27], v[152:155]
  ds_read_b64_tr_b16 a[168:169], v3 offset:28672
  v_mfma_f32_16x16x32_bf16 v[152:155], a[176:179], a[8:11], v[152:155]
  s_add_u32 m0, s45, 94208
  s_add_u32 s61, s70, 229376
  v_mfma_f32_16x16x32_bf16 v[148:151], a[176:179], a[4:7], v[148:151]
  ds_read_b64_tr_b16 a[170:171], v3 offset:30720
  v_mfma_f32_16x16x32_bf16 v[148:151], a[180:183], a[20:23], v[148:151]
  buffer_load_dwordx4 v11, s[32:35], s61 offen lds
  v_mfma_f32_16x16x32_bf16 v[144:147], a[180:183], a[16:19], v[144:147]
  ds_read_b64_tr_b16 a[180:181], v4 offset:16384
  v_mfma_f32_16x16x32_bf16 v[144:147], a[176:179], a[0:3], v[144:147]
  s_waitcnt lgkmcnt(5)
  s_add_u32 m0, s45, 65536
  v_mfma_f32_16x16x32_bf16 v[160:163], a[164:167], a[0:3], v[160:163]
  ds_read_b64_tr_b16 a[182:183], v4 offset:18432
  v_mfma_f32_16x16x32_bf16 v[160:163], a[160:163], a[16:19], v[160:163]
  buffer_load_dwordx4 v11, s[28:31], s71 offen lds
  v_mfma_f32_16x16x32_bf16 v[164:167], a[160:163], a[20:23], v[164:167]
  ds_read_b64_tr_b16 a[176:177], v4 offset:20480
  v_mfma_f32_16x16x32_bf16 v[164:167], a[164:167], a[4:7], v[164:167]
  v_mfma_f32_16x16x32_bf16 v[168:171], a[164:167], a[8:11], v[168:171]
  ds_read_b64_tr_b16 a[178:179], v4 offset:22528
  v_mfma_f32_16x16x32_bf16 v[168:171], a[160:163], a[24:27], v[168:171]
  s_add_u32 m0, s45, 73728
  v_mfma_f32_16x16x32_bf16 v[172:175], a[160:163], a[28:31], v[172:175]
  ds_read_b64_tr_b16 a[160:161], v4 offset:24576
  v_mfma_f32_16x16x32_bf16 v[172:175], a[164:167], a[12:15], v[172:175]
  s_waitcnt lgkmcnt(5)
  buffer_load_dwordx4 v11, s[32:35], s71 offen lds
  v_mfma_f32_16x16x32_bf16 v[188:191], a[172:175], a[12:15], v[188:191]
  ds_read_b64_tr_b16 a[162:163], v4 offset:26624
  v_mfma_f32_16x16x32_bf16 v[188:191], a[168:171], a[28:31], v[188:191]
  s_add_u32 m0, s45, 69632
  s_add_u32 s61, s71, 229376
  v_mfma_f32_16x16x32_bf16 v[184:187], a[168:171], a[24:27], v[184:187]
  ds_read_b64_tr_b16 a[164:165], v4 offset:28672
  v_mfma_f32_16x16x32_bf16 v[184:187], a[172:175], a[8:11], v[184:187]
  buffer_load_dwordx4 v11, s[28:31], s61 offen lds
  v_mfma_f32_16x16x32_bf16 v[180:183], a[172:175], a[4:7], v[180:183]
  ds_read_b64_tr_b16 a[166:167], v4 offset:30720
  v_mfma_f32_16x16x32_bf16 v[180:183], a[168:171], a[20:23], v[180:183]
  v_mfma_f32_16x16x32_bf16 v[176:179], a[168:171], a[16:19], v[176:179]
  ds_read_b64_tr_b16 a[168:169], v5 offset:16384
  v_mfma_f32_16x16x32_bf16 v[176:179], a[172:175], a[0:3], v[176:179]
  s_waitcnt lgkmcnt(5)
  s_add_u32 m0, s45, 77824
  s_add_u32 s61, s71, 229376
  v_mfma_f32_16x16x32_bf16 v[192:195], a[180:183], a[0:3], v[192:195]
  ds_read_b64_tr_b16 a[170:171], v5 offset:18432
  v_mfma_f32_16x16x32_bf16 v[192:195], a[176:179], a[16:19], v[192:195]
  buffer_load_dwordx4 v11, s[32:35], s61 offen lds
  v_mfma_f32_16x16x32_bf16 v[196:199], a[176:179], a[20:23], v[196:199]
  ds_read_b64_tr_b16 a[172:173], v5 offset:20480
  v_mfma_f32_16x16x32_bf16 v[196:199], a[180:183], a[4:7], v[196:199]
  s_add_u32 s62, s92, 6144
  v_mfma_f32_16x16x32_bf16 v[200:203], a[180:183], a[8:11], v[200:203]
  ds_read_b64_tr_b16 a[174:175], v5 offset:22528
  v_mfma_f32_16x16x32_bf16 v[200:203], a[176:179], a[24:27], v[200:203]
  buffer_load_dword a253, v13, s[36:39], s62 offen
  v_mfma_f32_16x16x32_bf16 v[204:207], a[176:179], a[28:31], v[204:207]
  ds_read_b64_tr_b16 a[176:177], v5 offset:24576
  v_mfma_f32_16x16x32_bf16 v[204:207], a[180:183], a[12:15], v[204:207]
  s_waitcnt lgkmcnt(5)
  v_mfma_f32_16x16x32_bf16 v[220:223], a[160:163], a[12:15], v[220:223]
  ds_read_b64_tr_b16 a[178:179], v5 offset:26624
  v_mfma_f32_16x16x32_bf16 v[220:223], a[164:167], a[28:31], v[220:223]
  v_mfma_f32_16x16x32_bf16 v[216:219], a[164:167], a[24:27], v[216:219]
  ds_read_b64_tr_b16 a[180:181], v5 offset:28672
  v_mfma_f32_16x16x32_bf16 v[216:219], a[160:163], a[8:11], v[216:219]
  v_mfma_f32_16x16x32_bf16 v[212:215], a[160:163], a[4:7], v[212:215]
  ds_read_b64_tr_b16 a[182:183], v5 offset:30720
  v_mfma_f32_16x16x32_bf16 v[212:215], a[164:167], a[20:23], v[212:215]
  s_waitcnt vmcnt(24)
  s_barrier
  v_mfma_f32_16x16x32_bf16 v[208:211], a[164:167], a[16:19], v[208:211]
  ds_read_b64_tr_b16 a[164:165], v8 offset:32768
  s_add_u32 s79, s79, 65536
  v_mfma_f32_16x16x32_bf16 v[208:211], a[160:163], a[0:3], v[208:211]
  s_waitcnt lgkmcnt(5)
  buffer_load_dwordx4 a[192:195], v1, s[8:11], s79 offen offset:0 sc1
  v_mfma_f32_16x16x32_bf16 v[224:227], a[168:171], a[0:3], v[224:227]
  ds_read_b64_tr_b16 a[166:167], v8 offset:34816
  v_mfma_f32_16x16x32_bf16 v[224:227], a[172:175], a[16:19], v[224:227]
  v_mfma_f32_16x16x32_bf16 v[228:231], a[172:175], a[20:23], v[228:231]
  ds_read_b64_tr_b16 a[160:161], v8 offset:36864
  v_mfma_f32_16x16x32_bf16 v[228:231], a[168:171], a[4:7], v[228:231]
  v_mfma_f32_16x16x32_bf16 v[232:235], a[168:171], a[8:11], v[232:235]
  ds_read_b64_tr_b16 a[162:163], v8 offset:38912
  v_mfma_f32_16x16x32_bf16 v[232:235], a[172:175], a[24:27], v[232:235]
  buffer_load_dwordx4 a[208:211], v1, s[8:11], s79 offen offset:1024 sc1
  v_mfma_f32_16x16x32_bf16 v[236:239], a[172:175], a[28:31], v[236:239]
  ds_read_b64_tr_b16 a[172:173], v8 offset:40960
  v_mfma_f32_16x16x32_bf16 v[236:239], a[168:171], a[12:15], v[236:239]
  s_waitcnt lgkmcnt(5)
  s_add_u32 s79, s79, 65536
  v_mfma_f32_16x16x32_bf16 v[252:255], a[176:179], a[12:15], v[252:255]
  ds_read_b64_tr_b16 a[174:175], v8 offset:43008
  v_mfma_f32_16x16x32_bf16 v[252:255], a[180:183], a[28:31], v[252:255]
  buffer_load_dwordx4 a[196:199], v1, s[8:11], s79 offen offset:0 sc1
  v_mfma_f32_16x16x32_bf16 v[248:251], a[180:183], a[24:27], v[248:251]
  ds_read_b64_tr_b16 a[168:169], v8 offset:45056
  v_mfma_f32_16x16x32_bf16 v[248:251], a[176:179], a[8:11], v[248:251]
  v_mfma_f32_16x16x32_bf16 v[244:247], a[176:179], a[4:7], v[244:247]
  ds_read_b64_tr_b16 a[170:171], v8 offset:47104
  v_mfma_f32_16x16x32_bf16 v[244:247], a[180:183], a[20:23], v[244:247]
  v_mfma_f32_16x16x32_bf16 v[240:243], a[180:183], a[16:19], v[240:243]
  ds_read_b64_tr_b16 a[180:181], v8 offset:49152
  v_mfma_f32_16x16x32_bf16 v[240:243], a[176:179], a[0:3], v[240:243]
  s_waitcnt vmcnt(36) lgkmcnt(5)
  buffer_load_dwordx4 a[212:215], v1, s[8:11], s79 offen offset:1024 sc1
  v_mfma_f32_16x16x32_bf16 v[32:35], a[164:167], a[64:67], v[32:35]
  ds_read_b64_tr_b16 a[182:183], v8 offset:51200
  v_mfma_f32_16x16x32_bf16 v[32:35], a[160:163], a[80:83], v[32:35]
  s_add_u32 s79, s79, 65536
  v_mfma_f32_16x16x32_bf16 v[36:39], a[160:163], a[84:87], v[36:39]
  ds_read_b64_tr_b16 a[176:177], v8 offset:53248
  v_mfma_f32_16x16x32_bf16 v[36:39], a[164:167], a[68:71], v[36:39]
  buffer_load_dwordx4 a[200:203], v1, s[8:11], s79 offen offset:0 sc1
  v_mfma_f32_16x16x32_bf16 v[40:43], a[164:167], a[72:75], v[40:43]
  ds_read_b64_tr_b16 a[178:179], v8 offset:55296
  v_mfma_f32_16x16x32_bf16 v[40:43], a[160:163], a[88:91], v[40:43]
  v_mfma_f32_16x16x32_bf16 v[44:47], a[160:163], a[92:95], v[44:47]
  ds_read_b64_tr_b16 a[160:161], v8 offset:57344
  v_mfma_f32_16x16x32_bf16 v[44:47], a[164:167], a[76:79], v[44:47]
  s_waitcnt lgkmcnt(5)
  buffer_load_dwordx4 a[216:219], v1, s[8:11], s79 offen offset:1024 sc1
  v_mfma_f32_16x16x32_bf16 v[60:63], a[172:175], a[76:79], v[60:63]
  ds_read_b64_tr_b16 a[162:163], v8 offset:59392
  v_mfma_f32_16x16x32_bf16 v[60:63], a[168:171], a[92:95], v[60:63]
  s_add_u32 m0, s45, 0
  v_mfma_f32_16x16x32_bf16 v[56:59], a[168:171], a[88:91], v[56:59]
  ds_read_b64_tr_b16 a[164:165], v8 offset:61440
  v_mfma_f32_16x16x32_bf16 v[56:59], a[172:175], a[72:75], v[56:59]
  buffer_load_dwordx4 v10, s[28:31], s67 offen lds
  v_mfma_f32_16x16x32_bf16 v[52:55], a[172:175], a[68:71], v[52:55]
  ds_read_b64_tr_b16 a[166:167], v8 offset:63488
  v_mfma_f32_16x16x32_bf16 v[52:55], a[168:171], a[84:87], v[52:55]
  s_waitcnt vmcnt(8)
  s_barrier
  v_mfma_f32_16x16x32_bf16 v[48:51], a[168:171], a[80:83], v[48:51]
  ds_read_b64_tr_b16 a[168:169], v8 offset:16384
  s_add_u32 m0, s45, 8192
  v_mfma_f32_16x16x32_bf16 v[48:51], a[172:175], a[64:67], v[48:51]
  s_waitcnt vmcnt(27) lgkmcnt(5)
  buffer_load_dwordx4 v10, s[32:35], s67 offen lds
  v_mfma_f32_16x16x32_bf16 v[32:35], a[180:183], a[96:99], v[32:35]
  ds_read_b64_tr_b16 a[170:171], v8 offset:18432
  v_mfma_f32_16x16x32_bf16 v[32:35], a[176:179], a[112:115], v[32:35]
  s_add_u32 m0, s45, 4096
  s_add_u32 s61, s67, 229376
  v_mfma_f32_16x16x32_bf16 v[36:39], a[176:179], a[116:119], v[36:39]
  ds_read_b64_tr_b16 a[172:173], v8 offset:20480
HOP13:
  s_cbranch_execz WRET0
  v_mfma_f32_16x16x32_bf16 v[36:39], a[180:183], a[100:103], v[36:39]
  buffer_load_dwordx4 v10, s[28:31], s61 offen lds
  v_mfma_f32_16x16x32_bf16 v[40:43], a[180:183], a[104:107], v[40:43]
  ds_read_b64_tr_b16 a[174:175], v8 offset:22528
  v_mfma_f32_16x16x32_bf16 v[40:43], a[176:179], a[120:123], v[40:43]
  s_add_u32 m0, s45, 12288
  s_add_u32 s61, s67, 229376
  v_mfma_f32_16x16x32_bf16 v[44:47], a[176:179], a[124:127], v[44:47]
  ds_read_b64_tr_b16 a[176:177], v8 offset:24576
  v_mfma_f32_16x16x32_bf16 v[44:47], a[180:183], a[108:111], v[44:47]
  s_waitcnt lgkmcnt(5)
  buffer_load_dwordx4 v10, s[32:35], s61 offen lds
  v_mfma_f32_16x16x32_bf16 v[60:63], a[160:163], a[108:111], v[60:63]
  ds_read_b64_tr_b16 a[178:179], v8 offset:26624
  v_mfma_f32_16x16x32_bf16 v[60:63], a[164:167], a[124:127], v[60:63]
  s_add_u32 m0, s45, 32768
  v_mfma_f32_16x16x32_bf16 v[56:59], a[164:167], a[120:123], v[56:59]
  ds_read_b64_tr_b16 a[180:181], v8 offset:28672
  v_mfma_f32_16x16x32_bf16 v[56:59], a[160:163], a[104:107], v[56:59]
  buffer_load_dwordx4 v10, s[28:31], s68 offen lds
  v_mfma_f32_16x16x32_bf16 v[52:55], a[160:163], a[100:103], v[52:55]
  ds_read_b64_tr_b16 a[182:183], v8 offset:30720
  v_mfma_f32_16x16x32_bf16 v[52:55], a[164:167], a[116:119], v[52:55]
  s_add_u32 m0, s45, 40960
  v_mfma_f32_16x16x32_bf16 v[48:51], a[164:167], a[112:115], v[48:51]
  ds_read_b64_tr_b16 a[164:165], v8 offset:0
  v_mfma_f32_16x16x32_bf16 v[48:51], a[160:163], a[96:99], v[48:51]
  s_waitcnt vmcnt(22) lgkmcnt(5)
  buffer_load_dwordx4 v10, s[32:35], s68 offen lds
  v_mfma_f32_16x16x32_bf16 v[32:35], a[168:171], a[128:131], v[32:35]
  ds_read_b64_tr_b16 a[166:167], v8 offset:2048
  v_mfma_f32_16x16x32_bf16 v[32:35], a[172:175], a[144:147], v[32:35]
  s_add_u32 m0, s45, 36864
  s_add_u32 s61, s68, 229376
  v_mfma_f32_16x16x32_bf16 v[36:39], a[172:175], a[148:151], v[36:39]
  ds_read_b64_tr_b16 a[160:161], v8 offset:4096
  v_mfma_f32_16x16x32_bf16 v[36:39], a[168:171], a[132:135], v[36:39]
  buffer_load_dwordx4 v10, s[28:31], s61 offen lds
  v_mfma_f32_16x16x32_bf16 v[40:43], a[168:171], a[136:139], v[40:43]
  ds_read_b64_tr_b16 a[162:163], v8 offset:6144
  v_mfma_f32_16x16x32_bf16 v[40:43], a[172:175], a[152:155], v[40:43]
  s_add_u32 m0, s45, 45056
  s_add_u32 s61, s68, 229376
  v_mfma_f32_16x16x32_bf16 v[44:47], a[172:175], a[156:159], v[44:47]
  ds_read_b64_tr_b16 a[172:173], v8 offset:8192
  v_mfma_f32_16x16x32_bf16 v[44:47], a[168:171], a[140:143], v[44:47]
  s_waitcnt lgkmcnt(5)
  buffer_load_dwordx4 v10, s[32:35], s61 offen lds
  v_mfma_f32_16x16x32_bf16 v[60:63], a[176:179], a[140:143], v[60:63]
  ds_read_b64_tr_b16 a[174:175], v8 offset:10240
  v_mfma_f32_16x16x32_bf16 v[60:63], a[180:183], a[156:159], v[60:63]
  s_add_u32 s62, s92, 8192
  v_mfma_f32_16x16x32_bf16 v[56:59], a[180:183], a[152:155], v[56:59]
  ds_read_b64_tr_b16 a[168:169], v8 offset:12288
  v_mfma_f32_16x16x32_bf16 v[56:59], a[176:179], a[136:139], v[56:59]
  buffer_load_dword a253, v13, s[36:39], s62 offen
  v_mfma_f32_16x16x32_bf16 v[52:55], a[176:179], a[132:135], v[52:55]
  ds_read_b64_tr_b16 a[170:171], v8 offset:14336
  v_mfma_f32_16x16x32_bf16 v[52:55], a[180:183], a[148:151], v[52:55]
  v_mfma_f32_16x16x32_bf16 v[48:51], a[180:183], a[144:147], v[48:51]
  ds_read_b64_tr_b16 a[180:181], v6 offset:32768
  v_mfma_f32_16x16x32_bf16 v[48:51], a[176:179], a[128:131], v[48:51]
  s_waitcnt vmcnt(9) lgkmcnt(5)
  v_mfma_f32_16x16x32_bf16 v[32:35], a[164:167], a[188:191], v[32:35]
  ds_read_b64_tr_b16 a[182:183], v6 offset:34816
  v_mfma_f32_16x16x32_bf16 v[32:35], a[160:163], a[204:207], v[32:35]
  s_add_u32 m0, s45, 49152
  v_mfma_f32_16x16x32_bf16 v[36:39], a[160:163], a[208:211], v[36:39]
  ds_read_b64_tr_b16 a[176:177], v6 offset:36864
  v_mfma_f32_16x16x32_bf16 v[36:39], a[164:167], a[192:195], v[36:39]
  buffer_load_dwordx4 v10, s[28:31], s69 offen lds
  v_mfma_f32_16x16x32_bf16 v[40:43], a[164:167], a[196:199], v[40:43]
  ds_read_b64_tr_b16 a[178:179], v6 offset:38912
  v_mfma_f32_16x16x32_bf16 v[40:43], a[160:163], a[212:215], v[40:43]
  s_add_u32 m0, s45, 57344
  v_mfma_f32_16x16x32_bf16 v[44:47], a[160:163], a[216:219], v[44:47]
  ds_read_b64_tr_b16 a[160:161], v6 offset:40960
  v_mfma_f32_16x16x32_bf16 v[44:47], a[164:167], a[200:203], v[44:47]
  s_waitcnt lgkmcnt(5)
  buffer_load_dwordx4 v10, s[32:35], s69 offen lds
  v_mfma_f32_16x16x32_bf16 v[60:63], a[172:175], a[200:203], v[60:63]
  ds_read_b64_tr_b16 a[162:163], v6 offset:43008
  v_mfma_f32_16x16x32_bf16 v[60:63], a[168:171], a[216:219], v[60:63]
  s_add_u32 m0, s45, 53248
  s_add_u32 s61, s69, 229376
  v_mfma_f32_16x16x32_bf16 v[56:59], a[168:171], a[212:215], v[56:59]
  ds_read_b64_tr_b16 a[164:165], v6 offset:45056
  v_mfma_f32_16x16x32_bf16 v[56:59], a[172:175], a[196:199], v[56:59]
  buffer_load_dwordx4 v10, s[28:31], s61 offen lds
  v_mfma_f32_16x16x32_bf16 v[52:55], a[172:175], a[192:195], v[52:55]
  ds_read_b64_tr_b16 a[166:167], v6 offset:47104
  v_mfma_f32_16x16x32_bf16 v[52:55], a[168:171], a[208:211], v[52:55]
  s_add_u32 m0, s45, 61440
  s_add_u32 s61, s69, 229376
  v_mfma_f32_16x16x32_bf16 v[48:51], a[168:171], a[204:207], v[48:51]
  ds_read_b64_tr_b16 a[168:169], v6 offset:49152
  v_mfma_f32_16x16x32_bf16 v[48:51], a[172:175], a[188:191], v[48:51]
  s_waitcnt lgkmcnt(5)
  buffer_load_dwordx4 v10, s[32:35], s61 offen lds
  v_mfma_f32_16x16x32_bf16 v[64:67], a[180:183], a[64:67], v[64:67]
  ds_read_b64_tr_b16 a[170:171], v6 offset:51200
  v_mfma_f32_16x16x32_bf16 v[64:67], a[176:179], a[80:83], v[64:67]
  s_add_u32 m0, s45, 16384
  v_mfma_f32_16x16x32_bf16 v[68:71], a[176:179], a[84:87], v[68:71]
  ds_read_b64_tr_b16 a[172:173], v6 offset:53248
  s_waitcnt lgkmcnt(15)
  v_fma_f32 v32, v32, v16, v28
  v_mfma_f32_16x16x32_bf16 v[68:71], a[180:183], a[68:71], v[68:71]
  buffer_load_dwordx4 v10, s[28:31], s70 offen lds
  v_exp_f32 v24, v32
  v_fma_f32 v33, v33, v16, v29
  v_mfma_f32_16x16x32_bf16 v[72:75], a[180:183], a[72:75], v[72:75]
  ds_read_b64_tr_b16 a[174:175], v6 offset:55296
  v_exp_f32 v25, v33
  v_mfma_f32_16x16x32_bf16 v[72:75], a[176:179], a[88:91], v[72:75]
  s_add_u32 m0, s45, 24576
  v_fma_f32 v34, v34, v16, v30
  v_exp_f32 v26, v34
  v_mfma_f32_16x16x32_bf16 v[76:79], a[176:179], a[92:95], v[76:79]
  ds_read_b64_tr_b16 a[176:177], v6 offset:57344
  v_fma_f32 v35, v35, v16, v31
  v_mul_f32 v48, v32, v48
  v_mfma_f32_16x16x32_bf16 v[76:79], a[180:183], a[76:79], v[76:79]
  s_waitcnt lgkmcnt(5)
  buffer_load_dwordx4 v10, s[32:35], s70 offen lds
  v_exp_f32 v27, v35
  v_mfma_f32_16x16x32_bf16 v[92:95], a[160:163], a[76:79], v[92:95]
  ds_read_b64_tr_b16 a[178:179], v6 offset:59392
  v_mul_f32 v49, v33, v49
  v_mfma_f32_16x16x32_bf16 v[92:95], a[164:167], a[92:95], v[92:95]
  s_add_u32 m0, s45, 20480
  s_add_u32 s61, s70, 229376
  v_mul_f32 v50, v34, v50
  v_mul_f32 v51, v35, v51
  v_mfma_f32_16x16x32_bf16 v[88:91], a[164:167], a[88:91], v[88:91]
  ds_read_b64_tr_b16 a[180:181], v6 offset:61440
  v_fma_f32 v24, v24, v17, v17
  v_fma_f32 v25, v25, v17, v17
  v_mfma_f32_16x16x32_bf16 v[88:91], a[160:163], a[72:75], v[88:91]
  buffer_load_dwordx4 v10, s[28:31], s61 offen lds
  v_rcp_f32 v24, v24
  v_fma_f32 v26, v26, v17, v17
  v_mfma_f32_16x16x32_bf16 v[84:87], a[160:163], a[68:71], v[84:87]
  ds_read_b64_tr_b16 a[182:183], v6 offset:63488
  v_rcp_f32 v25, v25
  v_mfma_f32_16x16x32_bf16 v[84:87], a[164:167], a[84:87], v[84:87]
  s_add_u32 m0, s45, 28672
  s_add_u32 s61, s70, 229376
  v_rcp_f32 v26, v26
  v_mfma_f32_16x16x32_bf16 v[80:83], a[164:167], a[80:83], v[80:83]
  ds_read_b64_tr_b16 a[164:165], v6 offset:16384
  v_fma_f32 v27, v27, v17, v17
  v_mul_f32 v48, v48, v24
  v_mfma_f32_16x16x32_bf16 v[80:83], a[160:163], a[64:67], v[80:83]
  s_waitcnt lgkmcnt(5)
  buffer_load_dwordx4 v10, s[32:35], s61 offen lds
  v_rcp_f32 v27, v27
  v_mfma_f32_16x16x32_bf16 v[64:67], a[168:171], a[96:99], v[64:67]
  ds_read_b64_tr_b16 a[166:167], v6 offset:18432
  v_mul_f32 v49, v49, v25
  v_mfma_f32_16x16x32_bf16 v[64:67], a[172:175], a[112:115], v[64:67]
  v_mul_f32 v50, v50, v26
  v_mul_f32 v51, v51, v27
  v_cvt_pk_bf16_f32 v32, v48, v49
  v_mfma_f32_16x16x32_bf16 v[68:71], a[172:175], a[116:119], v[68:71]
  ds_read_b64_tr_b16 a[160:161], v6 offset:20480
  v_cvt_pk_bf16_f32 v33, v50, v51
  v_fma_f32 v36, v36, v18, v28
  v_mfma_f32_16x16x32_bf16 v[68:71], a[168:171], a[100:103], v[68:71]
  buffer_store_dwordx2 v[32:33], v1, s[8:11], s60 offen sc1
  v_mfma_f32_16x16x32_bf16 v[72:75], a[168:171], a[104:107], v[72:75]
  ds_read_b64_tr_b16 a[162:163], v6 offset:22528
  v_exp_f32 v24, v36
  v_mfma_f32_16x16x32_bf16 v[72:75], a[172:175], a[120:123], v[72:75]
  v_fma_f32 v37, v37, v18, v29
  v_exp_f32 v25, v37
  v_mfma_f32_16x16x32_bf16 v[76:79], a[172:175], a[124:127], v[76:79]
  ds_read_b64_tr_b16 a[172:173], v6 offset:24576
  v_fma_f32 v38, v38, v18, v30
  v_fma_f32 v39, v39, v18, v31
  v_mfma_f32_16x16x32_bf16 v[76:79], a[168:171], a[108:111], v[76:79]
  s_waitcnt lgkmcnt(5)
  v_exp_f32 v26, v38
  v_mul_f32 v52, v36, v52
  v_mfma_f32_16x16x32_bf16 v[92:95], a[176:179], a[108:111], v[92:95]
  ds_read_b64_tr_b16 a[174:175], v6 offset:26624
  v_mul_f32 v53, v37, v53
  v_mfma_f32_16x16x32_bf16 v[92:95], a[180:183], a[124:127], v[92:95]
  v_exp_f32 v27, v39
  v_mul_f32 v54, v38, v54
  v_mfma_f32_16x16x32_bf16 v[88:91], a[180:183], a[120:123], v[88:91]
  ds_read_b64_tr_b16 a[168:169], v6 offset:28672
  v_mul_f32 v55, v39, v55
  v_fma_f32 v24, v24, v19, v19
  v_mfma_f32_16x16x32_bf16 v[88:91], a[176:179], a[104:107], v[88:91]
  v_rcp_f32 v24, v24
  v_fma_f32 v25, v25, v19, v19
  v_mfma_f32_16x16x32_bf16 v[84:87], a[176:179], a[100:103], v[84:87]
  ds_read_b64_tr_b16 a[170:171], v6 offset:30720
  v_rcp_f32 v25, v25
  v_mfma_f32_16x16x32_bf16 v[84:87], a[180:183], a[116:119], v[84:87]
  v_fma_f32 v26, v26, v19, v19
  v_rcp_f32 v26, v26
  v_mfma_f32_16x16x32_bf16 v[80:83], a[180:183], a[112:115], v[80:83]
  ds_read_b64_tr_b16 a[180:181], v6 offset:0
  v_fma_f32 v27, v27, v19, v19
  v_mul_f32 v52, v52, v24
  v_mfma_f32_16x16x32_bf16 v[80:83], a[176:179], a[96:99], v[80:83]
  s_waitcnt lgkmcnt(5)
  v_rcp_f32 v27, v27
  v_mul_f32 v53, v53, v25
  v_mfma_f32_16x16x32_bf16 v[64:67], a[164:167], a[128:131], v[64:67]
  ds_read_b64_tr_b16 a[182:183], v6 offset:2048
  v_mul_f32 v54, v54, v26
  v_mfma_f32_16x16x32_bf16 v[64:67], a[160:163], a[144:147], v[64:67]
  v_mul_f32 v55, v55, v27
  v_cvt_pk_bf16_f32 v36, v52, v53
  v_cvt_pk_bf16_f32 v37, v54, v55
  v_mfma_f32_16x16x32_bf16 v[68:71], a[160:163], a[148:151], v[68:71]
  ds_read_b64_tr_b16 a[176:177], v6 offset:4096
  v_fma_f32 v40, v40, v20, v28
  v_fma_f32 v41, v41, v20, v29
  v_mfma_f32_16x16x32_bf16 v[68:71], a[164:167], a[132:135], v[68:71]
  s_add_u32 s55, s60, 262144
  buffer_store_dwordx2 v[36:37], v1, s[8:11], s55 offen sc1
  v_mfma_f32_16x16x32_bf16 v[72:75], a[164:167], a[136:139], v[72:75]
  ds_read_b64_tr_b16 a[178:179], v6 offset:6144
  s_add_u32 s62, s92, 10240
  v_fma_f32 v42, v42, v20, v30
  v_mfma_f32_16x16x32_bf16 v[72:75], a[160:163], a[152:155], v[72:75]
  buffer_load_dword a253, v13, s[36:39], s62 offen
  v_exp_f32 v24, v40
  v_fma_f32 v43, v43, v20, v31
  v_mfma_f32_16x16x32_bf16 v[76:79], a[160:163], a[156:159], v[76:79]
  ds_read_b64_tr_b16 a[160:161], v6 offset:8192
  v_exp_f32 v25, v41
  v_mfma_f32_16x16x32_bf16 v[76:79], a[164:167], a[140:143], v[76:79]
  s_waitcnt lgkmcnt(5)
  v_exp_f32 v26, v42
  v_mul_f32 v56, v40, v56
  v_mfma_f32_16x16x32_bf16 v[92:95], a[172:175], a[140:143], v[92:95]
  ds_read_b64_tr_b16 a[162:163], v6 offset:10240
  v_mul_f32 v57, v41, v57
  v_mfma_f32_16x16x32_bf16 v[92:95], a[168:171], a[156:159], v[92:95]
  v_exp_f32 v27, v43
  v_mul_f32 v58, v42, v58
  v_mfma_f32_16x16x32_bf16 v[88:91], a[168:171], a[152:155], v[88:91]
  ds_read_b64_tr_b16 a[164:165], v6 offset:12288
  v_mul_f32 v59, v43, v59
  v_fma_f32 v24, v24, v21, v21
  v_mfma_f32_16x16x32_bf16 v[88:91], a[172:175], a[136:139], v[88:91]
  v_rcp_f32 v24, v24
  v_fma_f32 v25, v25, v21, v21
  v_mfma_f32_16x16x32_bf16 v[84:87], a[172:175], a[132:135], v[84:87]
  ds_read_b64_tr_b16 a[166:167], v6 offset:14336
  v_rcp_f32 v25, v25
  v_mfma_f32_16x16x32_bf16 v[84:87], a[168:171], a[148:151], v[84:87]
  v_fma_f32 v26, v26, v21, v21
  v_rcp_f32 v26, v26
  v_mfma_f32_16x16x32_bf16 v[80:83], a[168:171], a[144:147], v[80:83]
  ds_read_b64_tr_b16 a[168:169], v7 offset:32768
  v_fma_f32 v27, v27, v21, v21
  v_mul_f32 v56, v56, v24
  v_mfma_f32_16x16x32_bf16 v[80:83], a[172:175], a[128:131], v[80:83]
  s_waitcnt lgkmcnt(5)
  v_rcp_f32 v27, v27
  v_mul_f32 v57, v57, v25
  v_mfma_f32_16x16x32_bf16 v[64:67], a[180:183], a[188:191], v[64:67]
  ds_read_b64_tr_b16 a[170:171], v7 offset:34816
  v_mul_f32 v58, v58, v26
  v_mfma_f32_16x16x32_bf16 v[64:67], a[176:179], a[204:207], v[64:67]
  v_mul_f32 v59, v59, v27
  v_cvt_pk_bf16_f32 v40, v56, v57
  v_cvt_pk_bf16_f32 v41, v58, v59
  v_mfma_f32_16x16x32_bf16 v[68:71], a[176:179], a[208:211], v[68:71]
  ds_read_b64_tr_b16 a[172:173], v7 offset:36864
  v_fma_f32 v44, v44, v22, v28
  v_fma_f32 v45, v45, v22, v29
  v_mfma_f32_16x16x32_bf16 v[68:71], a[180:183], a[192:195], v[68:71]
  s_add_u32 s55, s60, 524288
  buffer_store_dwordx2 v[40:41], v1, s[8:11], s55 offen sc1
  v_mfma_f32_16x16x32_bf16 v[72:75], a[180:183], a[196:199], v[72:75]
  ds_read_b64_tr_b16 a[174:175], v7 offset:38912
  v_exp_f32 v24, v44
  v_mfma_f32_16x16x32_bf16 v[72:75], a[176:179], a[212:215], v[72:75]
  v_exp_f32 v25, v45
  v_fma_f32 v46, v46, v22, v30
  v_mfma_f32_16x16x32_bf16 v[76:79], a[176:179], a[216:219], v[76:79]
  ds_read_b64_tr_b16 a[176:177], v7 offset:40960
  v_exp_f32 v26, v46
  v_mfma_f32_16x16x32_bf16 v[76:79], a[180:183], a[200:203], v[76:79]
  s_waitcnt lgkmcnt(5)
  v_fma_f32 v47, v47, v22, v31
  v_exp_f32 v27, v47
  v_mfma_f32_16x16x32_bf16 v[92:95], a[160:163], a[200:203], v[92:95]
  ds_read_b64_tr_b16 a[178:179], v7 offset:43008
  v_mul_f32 v60, v44, v60
  v_mfma_f32_16x16x32_bf16 v[92:95], a[164:167], a[216:219], v[92:95]
  v_mul_f32 v61, v45, v61
  v_mul_f32 v62, v46, v62
  v_mul_f32 v63, v47, v63
  v_mfma_f32_16x16x32_bf16 v[88:91], a[164:167], a[212:215], v[88:91]
  ds_read_b64_tr_b16 a[180:181], v7 offset:45056
  v_fma_f32 v24, v24, v23, v23
  v_fma_f32 v25, v25, v23, v23
  v_mfma_f32_16x16x32_bf16 v[88:91], a[160:163], a[196:199], v[88:91]
  v_rcp_f32 v24, v24
  v_fma_f32 v26, v26, v23, v23
  v_mfma_f32_16x16x32_bf16 v[84:87], a[160:163], a[192:195], v[84:87]
  ds_read_b64_tr_b16 a[182:183], v7 offset:47104
  v_rcp_f32 v25, v25
  v_mfma_f32_16x16x32_bf16 v[84:87], a[164:167], a[208:211], v[84:87]
  v_rcp_f32 v26, v26
  v_fma_f32 v27, v27, v23, v23
  v_mfma_f32_16x16x32_bf16 v[80:83], a[164:167], a[204:207], v[80:83]
  ds_read_b64_tr_b16 a[164:165], v7 offset:49152
  v_rcp_f32 v27, v27
  v_mfma_f32_16x16x32_bf16 v[80:83], a[160:163], a[188:191], v[80:83]
  s_waitcnt lgkmcnt(5)
  v_mul_f32 v60, v60, v24
  v_mul_f32 v61, v61, v25
  v_mul_f32 v62, v62, v26
  v_mfma_f32_16x16x32_bf16 v[96:99], a[168:171], a[64:67], v[96:99]
  ds_read_b64_tr_b16 a[166:167], v7 offset:51200
  v_mul_f32 v63, v63, v27
  v_mfma_f32_16x16x32_bf16 v[96:99], a[172:175], a[80:83], v[96:99]
  v_cvt_pk_bf16_f32 v44, v60, v61
  v_cvt_pk_bf16_f32 v45, v62, v63
  v_mfma_f32_16x16x32_bf16 v[100:103], a[172:175], a[84:87], v[100:103]
  ds_read_b64_tr_b16 a[160:161], v7 offset:53248
  ds_read_b128 v[60:63], v12 offset:768
  v_mfma_f32_16x16x32_bf16 v[100:103], a[168:171], a[68:71], v[100:103]
  s_add_u32 s55, s60, 786432
  buffer_store_dwordx2 v[44:45], v1, s[8:11], s55 offen sc1
  v_mfma_f32_16x16x32_bf16 v[104:107], a[168:171], a[72:75], v[104:107]
  ds_read_b64_tr_b16 a[162:163], v7 offset:55296
  v_mfma_f32_16x16x32_bf16 v[104:107], a[172:175], a[88:91], v[104:107]
  v_mfma_f32_16x16x32_bf16 v[108:111], a[172:175], a[92:95], v[108:111]
  ds_read_b64_tr_b16 a[172:173], v7 offset:57344
  v_mfma_f32_16x16x32_bf16 v[108:111], a[168:171], a[76:79], v[108:111]
  s_waitcnt lgkmcnt(6)
  v_mfma_f32_16x16x32_bf16 v[124:127], a[176:179], a[76:79], v[124:127]
  ds_read_b64_tr_b16 a[174:175], v7 offset:59392
  s_waitcnt lgkmcnt(3)
  v_fma_f32 v64, v64, v16, v60
  v_mfma_f32_16x16x32_bf16 v[124:127], a[180:183], a[92:95], v[124:127]
  v_exp_f32 v24, v64
  v_mfma_f32_16x16x32_bf16 v[120:123], a[180:183], a[88:91], v[120:123]
  ds_read_b64_tr_b16 a[168:169], v7 offset:61440
  v_fma_f32 v65, v65, v16, v61
  v_fma_f32 v66, v66, v16, v62
  v_mfma_f32_16x16x32_bf16 v[120:123], a[176:179], a[72:75], v[120:123]
  v_exp_f32 v25, v65
  v_mfma_f32_16x16x32_bf16 v[116:119], a[176:179], a[68:71], v[116:119]
  ds_read_b64_tr_b16 a[170:171], v7 offset:63488
  v_exp_f32 v26, v66
  v_mfma_f32_16x16x32_bf16 v[116:119], a[180:183], a[84:87], v[116:119]
  v_fma_f32 v67, v67, v16, v63
  v_fma_f32 v68, v68, v18, v60
  v_mfma_f32_16x16x32_bf16 v[112:115], a[180:183], a[80:83], v[112:115]
  ds_read_b64_tr_b16 a[180:181], v7 offset:16384
  v_exp_f32 v27, v67
  v_mfma_f32_16x16x32_bf16 v[112:115], a[176:179], a[64:67], v[112:115]
  s_waitcnt lgkmcnt(5)
  v_exp_f32 v28, v68
  v_fma_f32 v69, v69, v18, v61
  v_mfma_f32_16x16x32_bf16 v[96:99], a[164:167], a[96:99], v[96:99]
  ds_read_b64_tr_b16 a[182:183], v7 offset:18432
  v_fma_f32 v70, v70, v18, v62
  v_mfma_f32_16x16x32_bf16 v[96:99], a[160:163], a[112:115], v[96:99]
  v_exp_f32 v29, v69
  v_fma_f32 v71, v71, v18, v63
  v_mfma_f32_16x16x32_bf16 v[100:103], a[160:163], a[116:119], v[100:103]
  ds_read_b64_tr_b16 a[176:177], v7 offset:20480
  v_mul_f32 v80, v64, v80
  v_mfma_f32_16x16x32_bf16 v[100:103], a[164:167], a[100:103], v[100:103]
  v_mul_f32 v81, v65, v81
  v_mul_f32 v82, v66, v82
  v_mul_f32 v83, v67, v83
  v_mfma_f32_16x16x32_bf16 v[104:107], a[164:167], a[104:107], v[104:107]
  ds_read_b64_tr_b16 a[178:179], v7 offset:22528
  v_mul_f32 v84, v68, v84
  v_mfma_f32_16x16x32_bf16 v[104:107], a[160:163], a[120:123], v[104:107]
  v_lshrrev_b32 v48, 3, v0
  v_bfe_u32 v49, v48, 1, 2
  v_bfe_u32 v50, v0, 1, 2
  v_mfma_f32_16x16x32_bf16 v[108:111], a[160:163], a[124:127], v[108:111]
  ds_read_b64_tr_b16 a[160:161], v7 offset:24576
  v_xor_b32 v49, v49, v50
  v_mfma_f32_16x16x32_bf16 v[108:111], a[164:167], a[108:111], v[108:111]
  s_waitcnt lgkmcnt(5)
  v_lshlrev_b32 v49, 5, v49
  v_and_b32 v50, 1, v0
  v_lshl_add_u32 v49, v50, 4, v49
  v_mfma_f32_16x16x32_bf16 v[124:127], a[172:175], a[108:111], v[124:127]
  ds_read_b64_tr_b16 a[162:163], v7 offset:26624
  v_exp_f32 v30, v70
  v_mfma_f32_16x16x32_bf16 v[124:127], a[168:171], a[124:127], v[124:127]
  s_lshl_b32 s53, s44, 3
  v_exp_f32 v31, v71
  v_mfma_f32_16x16x32_bf16 v[120:123], a[168:171], a[120:123], v[120:123]
  ds_read_b64_tr_b16 a[164:165], v7 offset:28672
  v_add_u32 v48, s53, v48
  v_lshl_add_u32 v48, v48, 11, v49
  v_mfma_f32_16x16x32_bf16 v[120:123], a[172:175], a[104:107], v[120:123]
  s_mul_i32 s53, s52, 1835008
  s_lshl_b32 s54, s51, 7
  s_add_u32 s53, s53, s54
  v_mfma_f32_16x16x32_bf16 v[116:119], a[172:175], a[100:103], v[116:119]
  ds_read_b64_tr_b16 a[166:167], v7 offset:30720
  v_add_u32 v33, s53, v48
  v_xor_b32 v32, 128, v33
  v_mfma_f32_16x16x32_bf16 v[116:119], a[168:171], a[116:119], v[116:119]
  v_and_b32 v48, 3, v0
  v_bfe_u32 v49, v0, 2, 1
  v_mfma_f32_16x16x32_bf16 v[112:115], a[168:171], a[112:115], v[112:115]
  ds_read_b64_tr_b16 a[168:169], v7 offset:0
  v_lshl_add_u32 v48, v48, 3, v49
  v_lshlrev_b32 v37, 7, v48
  v_mfma_f32_16x16x32_bf16 v[112:115], a[172:175], a[96:99], v[112:115]
  s_waitcnt lgkmcnt(5)
  v_mul_f32 v85, v69, v85
  v_mul_f32 v86, v70, v86
  v_mul_f32 v87, v71, v87
  v_mfma_f32_16x16x32_bf16 v[96:99], a[180:183], a[128:131], v[96:99]
  ds_read_b64_tr_b16 a[170:171], v7 offset:2048
  v_fma_f32 v24, v24, v17, v17
  v_mfma_f32_16x16x32_bf16 v[96:99], a[176:179], a[144:147], v[96:99]
  v_rcp_f32 v24, v24
  v_fma_f32 v25, v25, v17, v17
  v_mfma_f32_16x16x32_bf16 v[100:103], a[176:179], a[148:151], v[100:103]
  ds_read_b64_tr_b16 a[172:173], v7 offset:4096
  v_fma_f32 v26, v26, v17, v17
  v_mfma_f32_16x16x32_bf16 v[100:103], a[180:183], a[132:135], v[100:103]
  v_rcp_f32 v25, v25
  v_fma_f32 v27, v27, v17, v17
  v_mfma_f32_16x16x32_bf16 v[104:107], a[180:183], a[136:139], v[104:107]
  ds_read_b64_tr_b16 a[174:175], v7 offset:6144
  v_fma_f32 v28, v28, v19, v19
  v_mfma_f32_16x16x32_bf16 v[104:107], a[176:179], a[152:155], v[104:107]
  v_rcp_f32 v26, v26
  v_fma_f32 v29, v29, v19, v19
  v_mfma_f32_16x16x32_bf16 v[108:111], a[176:179], a[156:159], v[108:111]
  ds_read_b64_tr_b16 a[176:177], v7 offset:8192
  v_fma_f32 v30, v30, v19, v19
  v_mfma_f32_16x16x32_bf16 v[108:111], a[180:183], a[140:143], v[108:111]
  s_waitcnt lgkmcnt(5)
  v_rcp_f32 v27, v27
  v_fma_f32 v31, v31, v19, v19
  v_mfma_f32_16x16x32_bf16 v[124:127], a[160:163], a[140:143], v[124:127]
  ds_read_b64_tr_b16 a[178:179], v7 offset:10240
  v_rcp_f32 v28, v28
  v_mfma_f32_16x16x32_bf16 v[124:127], a[164:167], a[156:159], v[124:127]
  v_rcp_f32 v29, v29
  v_mfma_f32_16x16x32_bf16 v[120:123], a[164:167], a[152:155], v[120:123]
  ds_read_b64_tr_b16 a[180:181], v7 offset:12288
  s_add_u32 s62, s92, 12288
  v_mul_f32 v80, v80, v24
  v_mfma_f32_16x16x32_bf16 v[120:123], a[160:163], a[136:139], v[120:123]
  buffer_load_dword a253, v13, s[36:39], s62 offen
  v_rcp_f32 v30, v30
  v_mfma_f32_16x16x32_bf16 v[116:119], a[160:163], a[132:135], v[116:119]
  ds_read_b64_tr_b16 a[182:183], v7 offset:14336
  v_rcp_f32 v31, v31
  v_mfma_f32_16x16x32_bf16 v[116:119], a[164:167], a[148:151], v[116:119]
  s_waitcnt vmcnt(19)
  s_barrier
  v_mfma_f32_16x16x32_bf16 v[112:115], a[164:167], a[144:147], v[112:115]
  ds_read_b64_tr_b16 a[164:165], v2 offset:0
  v_mul_f32 v81, v81, v25
  v_mul_f32 v82, v82, v26
  v_mfma_f32_16x16x32_bf16 v[112:115], a[160:163], a[128:131], v[112:115]
  s_waitcnt lgkmcnt(5)
  v_mul_f32 v83, v83, v27
  v_mul_f32 v84, v84, v28
  v_mul_f32 v85, v85, v29
  v_mfma_f32_16x16x32_bf16 v[96:99], a[168:171], a[188:191], v[96:99]
  ds_read_b64_tr_b16 a[166:167], v2 offset:2048
  v_mul_f32 v86, v86, v30
  v_mfma_f32_16x16x32_bf16 v[96:99], a[172:175], a[204:207], v[96:99]
  s_add_u32 m0, s45, 98304
  v_mul_f32 v87, v87, v31
  v_cvt_pk_bf16_f32 v64, v80, v81
  v_cvt_pk_bf16_f32 v65, v82, v83
  v_mfma_f32_16x16x32_bf16 v[100:103], a[172:175], a[208:211], v[100:103]
  ds_read_b64_tr_b16 a[160:161], v2 offset:4096
  v_cvt_pk_bf16_f32 v68, v84, v85
  v_mfma_f32_16x16x32_bf16 v[100:103], a[168:171], a[192:195], v[100:103]
  buffer_load_dwordx4 v10, s[28:31], s71 offen lds
  v_cvt_pk_bf16_f32 v69, v86, v87
  v_fma_f32 v72, v72, v20, v60
  v_fma_f32 v73, v73, v20, v61
  v_mfma_f32_16x16x32_bf16 v[104:107], a[168:171], a[196:199], v[104:107]
  ds_read_b64_tr_b16 a[162:163], v2 offset:6144
  v_fma_f32 v74, v74, v20, v62
  v_mfma_f32_16x16x32_bf16 v[104:107], a[172:175], a[212:215], v[104:107]
  s_add_u32 m0, s45, 106496
  v_exp_f32 v24, v72
  v_fma_f32 v75, v75, v20, v63
  v_mfma_f32_16x16x32_bf16 v[108:111], a[172:175], a[216:219], v[108:111]
  ds_read_b64_tr_b16 a[172:173], v2 offset:8192
  v_fma_f32 v76, v76, v22, v60
  v_mfma_f32_16x16x32_bf16 v[108:111], a[168:171], a[200:203], v[108:111]
  s_waitcnt lgkmcnt(5)
  buffer_load_dwordx4 v10, s[32:35], s71 offen lds
  v_exp_f32 v25, v73
  v_mfma_f32_16x16x32_bf16 v[124:127], a[176:179], a[200:203], v[124:127]
  ds_read_b64_tr_b16 a[174:175], v2 offset:10240
  s_waitcnt vmcnt(8)
  s_barrier
  v_mfma_f32_16x16x32_bf16 v[124:127], a[180:183], a[216:219], v[124:127]
  s_add_u32 m0, s45, 102400
  s_add_u32 s61, s71, 229376
  v_fma_f32 v77, v77, v22, v61
  v_mfma_f32_16x16x32_bf16 v[120:123], a[180:183], a[212:215], v[120:123]
  ds_read_b64_tr_b16 a[168:169], v2 offset:12288
  v_exp_f32 v26, v74
  v_mfma_f32_16x16x32_bf16 v[120:123], a[176:179], a[196:199], v[120:123]
  buffer_load_dwordx4 v10, s[28:31], s61 offen lds
  v_exp_f32 v27, v75
  v_mfma_f32_16x16x32_bf16 v[116:119], a[176:179], a[192:195], v[116:119]
  ds_read_b64_tr_b16 a[170:171], v2 offset:14336
  v_exp_f32 v28, v76
  v_mfma_f32_16x16x32_bf16 v[116:119], a[180:183], a[208:211], v[116:119]
  s_add_u32 m0, s45, 110592
  s_add_u32 s61, s71, 229376
  v_fma_f32 v78, v78, v22, v62
  v_mfma_f32_16x16x32_bf16 v[112:115], a[180:183], a[204:207], v[112:115]
  ds_read_b64_tr_b16 a[180:181], v3 offset:0
  v_exp_f32 v29, v77
  v_mfma_f32_16x16x32_bf16 v[112:115], a[176:179], a[188:191], v[112:115]
  s_waitcnt lgkmcnt(5)
  buffer_load_dwordx4 v10, s[32:35], s61 offen lds
  v_exp_f32 v30, v78
  v_mfma_f32_16x16x32_bf16 v[128:131], a[164:167], a[32:35], v[128:131]
  ds_read_b64_tr_b16 a[182:183], v3 offset:2048
  v_fma_f32 v79, v79, v22, v63
  v_mfma_f32_16x16x32_bf16 v[128:131], a[160:163], a[48:51], v[128:131]
  v_exp_f32 v31, v79
  v_mul_f32 v88, v72, v88
  v_mfma_f32_16x16x32_bf16 v[132:135], a[160:163], a[52:55], v[132:135]
  ds_read_b64_tr_b16 a[176:177], v3 offset:4096
  v_mul_f32 v89, v73, v89
  v_mfma_f32_16x16x32_bf16 v[132:135], a[164:167], a[36:39], v[132:135]
  ds_read_b128 v[60:63], v12 offset:832
  v_mul_f32 v90, v74, v90
  v_mul_f32 v91, v75, v91
  v_mfma_f32_16x16x32_bf16 v[136:139], a[164:167], a[40:43], v[136:139]
  ds_read_b64_tr_b16 a[178:179], v3 offset:6144
  v_mul_f32 v92, v76, v92
  v_mfma_f32_16x16x32_bf16 v[136:139], a[160:163], a[56:59], v[136:139]
  v_mul_f32 v93, v77, v93
  v_mul_f32 v94, v78, v94
  v_mul_f32 v95, v79, v95
  v_mfma_f32_16x16x32_bf16 v[140:143], a[160:163], a[60:63], v[140:143]
  ds_read_b64_tr_b16 a[160:161], v3 offset:8192
  v_fma_f32 v24, v24, v21, v21
  v_mfma_f32_16x16x32_bf16 v[140:143], a[164:167], a[44:47], v[140:143]
  s_waitcnt lgkmcnt(6)
  v_rcp_f32 v24, v24
  v_fma_f32 v25, v25, v21, v21
  v_mfma_f32_16x16x32_bf16 v[156:159], a[172:175], a[44:47], v[156:159]
  ds_read_b64_tr_b16 a[162:163], v3 offset:10240
  v_rcp_f32 v25, v25
  v_mfma_f32_16x16x32_bf16 v[156:159], a[168:171], a[60:63], v[156:159]
  v_fma_f32 v26, v26, v21, v21
  v_fma_f32 v27, v27, v21, v21
  v_mfma_f32_16x16x32_bf16 v[152:155], a[168:171], a[56:59], v[152:155]
  ds_read_b64_tr_b16 a[164:165], v3 offset:12288
  v_rcp_f32 v26, v26
  v_mfma_f32_16x16x32_bf16 v[152:155], a[172:175], a[40:43], v[152:155]
  v_rcp_f32 v27, v27
  v_mfma_f32_16x16x32_bf16 v[148:151], a[172:175], a[36:39], v[148:151]
  ds_read_b64_tr_b16 a[166:167], v3 offset:14336
  v_fma_f32 v28, v28, v23, v23
  v_fma_f32 v29, v29, v23, v23
  v_mfma_f32_16x16x32_bf16 v[148:151], a[168:171], a[52:55], v[148:151]
  v_rcp_f32 v28, v28
  v_mfma_f32_16x16x32_bf16 v[144:147], a[168:171], a[48:51], v[144:147]
  ds_read_b64_tr_b16 a[168:169], v4 offset:0
  v_rcp_f32 v29, v29
  v_mfma_f32_16x16x32_bf16 v[144:147], a[172:175], a[32:35], v[144:147]
  s_waitcnt lgkmcnt(5)
  v_fma_f32 v30, v30, v23, v23
  v_rcp_f32 v30, v30
  v_mfma_f32_16x16x32_bf16 v[160:163], a[180:183], a[32:35], v[160:163]
  ds_read_b64_tr_b16 a[170:171], v4 offset:2048
  v_fma_f32 v31, v31, v23, v23
  v_mfma_f32_16x16x32_bf16 v[160:163], a[176:179], a[48:51], v[160:163]
  v_rcp_f32 v31, v31
  v_mul_f32 v88, v88, v24
  v_mfma_f32_16x16x32_bf16 v[164:167], a[176:179], a[52:55], v[164:167]
HOP14:
  s_cbranch_execz WRET0
  ds_read_b64_tr_b16 a[172:173], v4 offset:4096
  v_mul_f32 v89, v89, v25
  v_mfma_f32_16x16x32_bf16 v[164:167], a[180:183], a[36:39], v[164:167]
  v_mul_f32 v90, v90, v26
  v_mul_f32 v91, v91, v27
  v_mul_f32 v92, v92, v28
  v_mfma_f32_16x16x32_bf16 v[168:171], a[180:183], a[40:43], v[168:171]
  ds_read_b64_tr_b16 a[174:175], v4 offset:6144
  v_mul_f32 v93, v93, v29
  v_mfma_f32_16x16x32_bf16 v[168:171], a[176:179], a[56:59], v[168:171]
  v_mul_f32 v94, v94, v30
  v_mul_f32 v95, v95, v31
  v_cvt_pk_bf16_f32 v72, v88, v89
  v_mfma_f32_16x16x32_bf16 v[172:175], a[176:179], a[60:63], v[172:175]
  ds_read_b64_tr_b16 a[176:177], v4 offset:8192
  v_cvt_pk_bf16_f32 v73, v90, v91
  v_mfma_f32_16x16x32_bf16 v[172:175], a[180:183], a[44:47], v[172:175]
  s_waitcnt lgkmcnt(5)
  v_cvt_pk_bf16_f32 v76, v92, v93
  v_cvt_pk_bf16_f32 v77, v94, v95
  v_mfma_f32_16x16x32_bf16 v[188:191], a[160:163], a[44:47], v[188:191]
  ds_read_b64_tr_b16 a[178:179], v4 offset:10240
  s_cmp_eq_u32 s91, 0
  s_cselect_b32 s72, 8, 1
  s_lshl_b32 s64, s72, 17
  s_lshl_b32 s72, s72, 11
  s_add_u32 s72, s72, s84
  s_add_u32 m0, s45, 114688
  s_waitcnt lgkmcnt(11)
  v_mfma_f32_16x16x32_bf16 v[188:191], a[164:167], a[60:63], v[188:191]
  buffer_load_dwordx4 v32, s[36:39], s64 offen lds
  v_fma_f32 v96, v96, v16, v60
  v_exp_f32 v24, v96
  v_mfma_f32_16x16x32_bf16 v[184:187], a[164:167], a[56:59], v[184:187]
  ds_read_b64_tr_b16 a[180:181], v4 offset:12288
  v_fma_f32 v97, v97, v16, v61
  v_fma_f32 v98, v98, v16, v62
  v_mfma_f32_16x16x32_bf16 v[184:187], a[160:163], a[40:43], v[184:187]
  s_add_u32 m0, s45, 118784
  s_add_u32 s61, s64, 65536
  v_exp_f32 v25, v97
  v_mfma_f32_16x16x32_bf16 v[180:183], a[160:163], a[36:39], v[180:183]
  ds_read_b64_tr_b16 a[182:183], v4 offset:14336
  v_exp_f32 v26, v98
  v_mfma_f32_16x16x32_bf16 v[180:183], a[164:167], a[52:55], v[180:183]
  buffer_load_dwordx4 v32, s[36:39], s61 offen lds
  v_fma_f32 v99, v99, v16, v63
  v_exp_f32 v27, v99
  v_mfma_f32_16x16x32_bf16 v[176:179], a[164:167], a[48:51], v[176:179]
  ds_read_b64_tr_b16 a[164:165], v5 offset:0
  v_fma_f32 v100, v100, v18, v60
  v_fma_f32 v101, v101, v18, v61
  v_mfma_f32_16x16x32_bf16 v[176:179], a[160:163], a[32:35], v[176:179]
  s_waitcnt lgkmcnt(5)
  s_add_u32 m0, s45, 122880
  v_exp_f32 v28, v100
  v_mfma_f32_16x16x32_bf16 v[192:195], a[168:171], a[32:35], v[192:195]
  ds_read_b64_tr_b16 a[166:167], v5 offset:2048
  v_fma_f32 v102, v102, v18, v62
  v_mfma_f32_16x16x32_bf16 v[192:195], a[172:175], a[48:51], v[192:195]
  buffer_load_dwordx4 v33, s[36:39], s64 offen lds
  v_exp_f32 v29, v101
  v_fma_f32 v103, v103, v18, v63
  v_mfma_f32_16x16x32_bf16 v[196:199], a[172:175], a[52:55], v[196:199]
  ds_read_b64_tr_b16 a[160:161], v5 offset:4096
  v_exp_f32 v30, v102
  v_mfma_f32_16x16x32_bf16 v[196:199], a[168:171], a[36:39], v[196:199]
  s_add_u32 m0, s45, 126976
  s_add_u32 s61, s64, 65536
  v_exp_f32 v31, v103
  v_mfma_f32_16x16x32_bf16 v[200:203], a[168:171], a[40:43], v[200:203]
  ds_read_b64_tr_b16 a[162:163], v5 offset:6144
  v_mul_f32 v112, v96, v112
  v_mul_f32 v113, v97, v113
  v_mfma_f32_16x16x32_bf16 v[200:203], a[172:175], a[56:59], v[200:203]
  buffer_load_dwordx4 v33, s[36:39], s61 offen lds
  v_mul_f32 v114, v98, v114
  v_mul_f32 v115, v99, v115
  v_mul_f32 v116, v100, v116
  v_mfma_f32_16x16x32_bf16 v[204:207], a[172:175], a[60:63], v[204:207]
  ds_read_b64_tr_b16 a[172:173], v5 offset:8192
  v_mul_f32 v117, v101, v117
  v_mul_f32 v118, v102, v118
  v_mfma_f32_16x16x32_bf16 v[204:207], a[168:171], a[44:47], v[204:207]
  s_waitcnt lgkmcnt(5)
  s_cmp_eq_u32 s91, 1
  s_cselect_b32 s73, 10, 3
  s_lshl_b32 s65, s73, 17
  s_lshl_b32 s73, s73, 11
  s_add_u32 s73, s73, s84
  s_add_u32 m0, s45, 81920
  v_mul_f32 v119, v103, v119
  v_fma_f32 v24, v24, v17, v17
  v_mfma_f32_16x16x32_bf16 v[220:223], a[176:179], a[44:47], v[220:223]
  ds_read_b64_tr_b16 a[174:175], v5 offset:10240
  v_rcp_f32 v24, v24
  v_mfma_f32_16x16x32_bf16 v[220:223], a[180:183], a[60:63], v[220:223]
  buffer_load_dwordx4 v32, s[36:39], s65 offen lds
  v_fma_f32 v25, v25, v17, v17
  v_rcp_f32 v25, v25
  v_mfma_f32_16x16x32_bf16 v[216:219], a[180:183], a[56:59], v[216:219]
  ds_read_b64_tr_b16 a[168:169], v5 offset:12288
  v_fma_f32 v26, v26, v17, v17
  v_fma_f32 v27, v27, v17, v17
  v_mfma_f32_16x16x32_bf16 v[216:219], a[176:179], a[40:43], v[216:219]
  s_add_u32 m0, s45, 86016
  s_add_u32 s61, s65, 65536
  v_rcp_f32 v26, v26
  v_mfma_f32_16x16x32_bf16 v[212:215], a[176:179], a[36:39], v[212:215]
  ds_read_b64_tr_b16 a[170:171], v5 offset:14336
  v_rcp_f32 v27, v27
  v_mfma_f32_16x16x32_bf16 v[212:215], a[180:183], a[52:55], v[212:215]
  buffer_load_dwordx4 v32, s[36:39], s61 offen lds
  v_fma_f32 v28, v28, v19, v19
  v_rcp_f32 v28, v28
  v_mfma_f32_16x16x32_bf16 v[208:211], a[180:183], a[48:51], v[208:211]
  ds_read_b64_tr_b16 a[180:181], v2 offset:32768
  v_fma_f32 v29, v29, v19, v19
  v_fma_f32 v30, v30, v19, v19
  v_mfma_f32_16x16x32_bf16 v[208:211], a[176:179], a[32:35], v[208:211]
  s_waitcnt lgkmcnt(5)
  s_add_u32 m0, s45, 90112
  v_rcp_f32 v29, v29
  v_mfma_f32_16x16x32_bf16 v[224:227], a[164:167], a[32:35], v[224:227]
  ds_read_b64_tr_b16 a[182:183], v2 offset:34816
  v_fma_f32 v31, v31, v19, v19
  v_mfma_f32_16x16x32_bf16 v[224:227], a[160:163], a[48:51], v[224:227]
  buffer_load_dwordx4 v33, s[36:39], s65 offen lds
  v_rcp_f32 v30, v30
  v_mul_f32 v112, v112, v24
  v_mfma_f32_16x16x32_bf16 v[228:231], a[160:163], a[52:55], v[228:231]
  ds_read_b64_tr_b16 a[176:177], v2 offset:36864
  v_rcp_f32 v31, v31
  v_mfma_f32_16x16x32_bf16 v[228:231], a[164:167], a[36:39], v[228:231]
  s_add_u32 m0, s45, 94208
  s_add_u32 s61, s65, 65536
  v_mul_f32 v113, v113, v25
  v_mul_f32 v114, v114, v26
  v_mfma_f32_16x16x32_bf16 v[232:235], a[164:167], a[40:43], v[232:235]
  ds_read_b64_tr_b16 a[178:179], v2 offset:38912
  v_mul_f32 v115, v115, v27
  v_mul_f32 v116, v116, v28
  v_mfma_f32_16x16x32_bf16 v[232:235], a[160:163], a[56:59], v[232:235]
  buffer_load_dwordx4 v33, s[36:39], s61 offen lds
  v_mul_f32 v117, v117, v29
  v_mul_f32 v118, v118, v30
  v_mul_f32 v119, v119, v31
  v_mfma_f32_16x16x32_bf16 v[236:239], a[160:163], a[60:63], v[236:239]
  ds_read_b64_tr_b16 a[160:161], v2 offset:40960
  v_cvt_pk_bf16_f32 v66, v112, v113
  v_cvt_pk_bf16_f32 v67, v114, v115
  v_mfma_f32_16x16x32_bf16 v[236:239], a[164:167], a[44:47], v[236:239]
  s_waitcnt lgkmcnt(5)
  s_cmp_eq_u32 s91, 2
  s_cselect_b32 s74, 12, 5
  s_lshl_b32 s66, s74, 17
  s_lshl_b32 s74, s74, 11
  s_add_u32 s74, s74, s84
  s_add_u32 m0, s45, 65536
  v_cvt_pk_bf16_f32 v70, v116, v117
  v_cvt_pk_bf16_f32 v71, v118, v119
  v_mfma_f32_16x16x32_bf16 v[252:255], a[172:175], a[44:47], v[252:255]
  ds_read_b64_tr_b16 a[162:163], v2 offset:43008
  v_fma_f32 v104, v104, v20, v60
  v_fma_f32 v105, v105, v20, v61
  v_mfma_f32_16x16x32_bf16 v[252:255], a[168:171], a[60:63], v[252:255]
  buffer_load_dwordx4 v32, s[36:39], s66 offen lds
  buffer_store_dwordx4 v[64:67], v1, s[8:11], s59 offen offset:0 sc1
  v_mfma_f32_16x16x32_bf16 v[248:251], a[168:171], a[56:59], v[248:251]
  ds_read_b64_tr_b16 a[164:165], v2 offset:45056
  v_exp_f32 v24, v104
  v_mfma_f32_16x16x32_bf16 v[248:251], a[172:175], a[40:43], v[248:251]
  s_add_u32 m0, s45, 69632
  s_add_u32 s61, s66, 65536
  v_exp_f32 v25, v105
  v_mfma_f32_16x16x32_bf16 v[244:247], a[172:175], a[36:39], v[244:247]
  ds_read_b64_tr_b16 a[166:167], v2 offset:47104
  s_add_u32 s55, s59, 262144
  buffer_store_dwordx4 v[68:71], v1, s[8:11], s55 offen offset:0 sc1
  v_mfma_f32_16x16x32_bf16 v[244:247], a[168:171], a[52:55], v[244:247]
  buffer_load_dwordx4 v32, s[36:39], s61 offen lds
  v_fma_f32 v106, v106, v20, v62
  v_exp_f32 v26, v106
  v_mfma_f32_16x16x32_bf16 v[240:243], a[168:171], a[48:51], v[240:243]
  ds_read_b64_tr_b16 a[168:169], v2 offset:49152
  v_fma_f32 v107, v107, v20, v63
  v_fma_f32 v108, v108, v22, v60
  v_mfma_f32_16x16x32_bf16 v[240:243], a[172:175], a[32:35], v[240:243]
  s_waitcnt lgkmcnt(5)
  s_add_u32 m0, s45, 73728
  v_exp_f32 v27, v107
  v_mfma_f32_16x16x32_bf16 v[128:131], a[180:183], a[64:67], v[128:131]
  ds_read_b64_tr_b16 a[170:171], v2 offset:51200
  v_fma_f32 v109, v109, v22, v61
  v_mfma_f32_16x16x32_bf16 v[128:131], a[176:179], a[80:83], v[128:131]
  buffer_load_dwordx4 v33, s[36:39], s66 offen lds
  v_exp_f32 v28, v108
  v_fma_f32 v110, v110, v22, v62
  v_mfma_f32_16x16x32_bf16 v[132:135], a[176:179], a[84:87], v[132:135]
  ds_read_b64_tr_b16 a[172:173], v2 offset:53248
  v_exp_f32 v29, v109
  v_mfma_f32_16x16x32_bf16 v[132:135], a[180:183], a[68:71], v[132:135]
  s_add_u32 m0, s45, 77824
  s_add_u32 s61, s66, 65536
  v_exp_f32 v30, v110
  v_mfma_f32_16x16x32_bf16 v[136:139], a[180:183], a[72:75], v[136:139]
  ds_read_b64_tr_b16 a[174:175], v2 offset:55296
  v_fma_f32 v111, v111, v22, v63
  v_mul_f32 v120, v104, v120
  v_mfma_f32_16x16x32_bf16 v[136:139], a[176:179], a[88:91], v[136:139]
  buffer_load_dwordx4 v33, s[36:39], s61 offen lds
  v_exp_f32 v31, v111
  v_mul_f32 v121, v105, v121
  v_mfma_f32_16x16x32_bf16 v[140:143], a[176:179], a[92:95], v[140:143]
  ds_read_b64_tr_b16 a[176:177], v2 offset:57344
  ds_read_b128 v[60:63], v12 offset:512
  v_mfma_f32_16x16x32_bf16 v[140:143], a[180:183], a[76:79], v[140:143]
  s_waitcnt lgkmcnt(6)
  v_mul_f32 v122, v106, v122
  v_mul_f32 v123, v107, v123
  v_mul_f32 v124, v108, v124
  v_mfma_f32_16x16x32_bf16 v[156:159], a[160:163], a[76:79], v[156:159]
  ds_read_b64_tr_b16 a[178:179], v2 offset:59392
  v_mul_f32 v125, v109, v125
  v_mul_f32 v126, v110, v126
  v_mfma_f32_16x16x32_bf16 v[156:159], a[164:167], a[92:95], v[156:159]
  v_mul_f32 v127, v111, v127
  v_fma_f32 v24, v24, v21, v21
  v_fma_f32 v25, v25, v21, v21
  v_mfma_f32_16x16x32_bf16 v[152:155], a[164:167], a[88:91], v[152:155]
  ds_read_b64_tr_b16 a[180:181], v2 offset:61440
  v_rcp_f32 v24, v24
  v_mfma_f32_16x16x32_bf16 v[152:155], a[160:163], a[72:75], v[152:155]
  v_rcp_f32 v25, v25
  v_fma_f32 v26, v26, v21, v21
  v_mfma_f32_16x16x32_bf16 v[148:151], a[160:163], a[68:71], v[148:151]
  ds_read_b64_tr_b16 a[182:183], v2 offset:63488
  v_rcp_f32 v26, v26
  v_mfma_f32_16x16x32_bf16 v[148:151], a[164:167], a[84:87], v[148:151]
  v_fma_f32 v27, v27, v21, v21
  v_rcp_f32 v27, v27
  v_mfma_f32_16x16x32_bf16 v[144:147], a[164:167], a[80:83], v[144:147]
  ds_read_b64_tr_b16 a[164:165], v2 offset:16384
  v_fma_f32 v28, v28, v23, v23
  v_fma_f32 v29, v29, v23, v23
  v_mfma_f32_16x16x32_bf16 v[144:147], a[160:163], a[64:67], v[144:147]
  s_waitcnt lgkmcnt(6)
  v_rcp_f32 v28, v28
  v_fma_f32 v30, v30, v23, v23
  v_mfma_f32_16x16x32_bf16 v[128:131], a[168:171], a[96:99], v[128:131]
  ds_read_b64_tr_b16 a[166:167], v2 offset:18432
  v_fma_f32 v31, v31, v23, v23
  v_mfma_f32_16x16x32_bf16 v[128:131], a[172:175], a[112:115], v[128:131]
  v_rcp_f32 v29, v29
  v_mul_f32 v120, v120, v24
  v_mfma_f32_16x16x32_bf16 v[132:135], a[172:175], a[116:119], v[132:135]
  ds_read_b64_tr_b16 a[160:161], v2 offset:20480
  v_rcp_f32 v30, v30
  v_mfma_f32_16x16x32_bf16 v[132:135], a[168:171], a[100:103], v[132:135]
  v_rcp_f32 v31, v31
  v_mul_f32 v121, v121, v25
  v_mfma_f32_16x16x32_bf16 v[136:139], a[168:171], a[104:107], v[136:139]
  ds_read_b64_tr_b16 a[162:163], v2 offset:22528
  v_mul_f32 v122, v122, v26
  v_mul_f32 v123, v123, v27
  v_mfma_f32_16x16x32_bf16 v[136:139], a[172:175], a[120:123], v[136:139]
  v_mul_f32 v124, v124, v28
  v_mul_f32 v125, v125, v29
  v_mul_f32 v126, v126, v30
  v_mfma_f32_16x16x32_bf16 v[140:143], a[172:175], a[124:127], v[140:143]
  ds_read_b64_tr_b16 a[172:173], v2 offset:24576
  v_mul_f32 v127, v127, v31
  v_cvt_pk_bf16_f32 v74, v120, v121
  v_mfma_f32_16x16x32_bf16 v[140:143], a[168:171], a[108:111], v[140:143]
  s_waitcnt lgkmcnt(5)
  v_cvt_pk_bf16_f32 v75, v122, v123
  v_cvt_pk_bf16_f32 v78, v124, v125
  v_cvt_pk_bf16_f32 v79, v126, v127
  v_mfma_f32_16x16x32_bf16 v[156:159], a[176:179], a[108:111], v[156:159]
  ds_read_b64_tr_b16 a[174:175], v2 offset:26624
  v_mfma_f32_16x16x32_bf16 v[156:159], a[180:183], a[124:127], v[156:159]
  s_add_u32 s55, s59, 524288
  buffer_store_dwordx4 v[72:75], v1, s[8:11], s55 offen offset:0 sc1
  v_mfma_f32_16x16x32_bf16 v[152:155], a[180:183], a[120:123], v[152:155]
  ds_read_b64_tr_b16 a[168:169], v2 offset:28672
  v_mfma_f32_16x16x32_bf16 v[152:155], a[176:179], a[104:107], v[152:155]
  s_add_u32 s55, s59, 786432
  buffer_store_dwordx4 v[76:79], v1, s[8:11], s55 offen offset:0 sc1
  v_mfma_f32_16x16x32_bf16 v[148:151], a[176:179], a[100:103], v[148:151]
  ds_read_b64_tr_b16 a[170:171], v2 offset:30720
  v_mfma_f32_16x16x32_bf16 v[148:151], a[180:183], a[116:119], v[148:151]
  s_waitcnt vmcnt(16)
  s_barrier
  v_mfma_f32_16x16x32_bf16 v[144:147], a[180:183], a[112:115], v[144:147]
  ds_read_b64_tr_b16 a[180:181], v6 offset:32768
  s_cmp_eq_u32 s91, 0
  s_cselect_b32 s75, 1, 8
  s_lshl_b32 s67, s75, 17
  s_lshl_b32 s75, s75, 11
  s_add_u32 s75, s75, s84
  s_add_u32 m0, s45, 0
  v_mfma_f32_16x16x32_bf16 v[144:147], a[176:179], a[96:99], v[144:147]
  s_waitcnt lgkmcnt(5)
  buffer_load_dwordx4 v32, s[36:39], s67 offen lds
  v_mfma_f32_16x16x32_bf16 v[128:131], a[164:167], a[128:131], v[128:131]
  ds_read_b64_tr_b16 a[182:183], v6 offset:34816
  v_mfma_f32_16x16x32_bf16 v[128:131], a[160:163], a[144:147], v[128:131]
  s_add_u32 m0, s45, 4096
  s_add_u32 s61, s67, 65536
  v_mfma_f32_16x16x32_bf16 v[132:135], a[160:163], a[148:151], v[132:135]
  ds_read_b64_tr_b16 a[176:177], v6 offset:36864
  v_mfma_f32_16x16x32_bf16 v[132:135], a[164:167], a[132:135], v[132:135]
  buffer_load_dwordx4 v32, s[36:39], s61 offen lds
  v_mfma_f32_16x16x32_bf16 v[136:139], a[164:167], a[136:139], v[136:139]
  ds_read_b64_tr_b16 a[178:179], v6 offset:38912
  v_mfma_f32_16x16x32_bf16 v[136:139], a[160:163], a[152:155], v[136:139]
  s_add_u32 m0, s45, 8192
  v_mfma_f32_16x16x32_bf16 v[140:143], a[160:163], a[156:159], v[140:143]
  ds_read_b64_tr_b16 a[160:161], v6 offset:40960
  v_mfma_f32_16x16x32_bf16 v[140:143], a[164:167], a[140:143], v[140:143]
  s_waitcnt lgkmcnt(5)
  buffer_load_dwordx4 v33, s[36:39], s67 offen lds
  v_mfma_f32_16x16x32_bf16 v[156:159], a[172:175], a[140:143], v[156:159]
  ds_read_b64_tr_b16 a[162:163], v6 offset:43008
  v_mfma_f32_16x16x32_bf16 v[156:159], a[168:171], a[156:159], v[156:159]
  s_add_u32 m0, s45, 12288
  s_add_u32 s61, s67, 65536
  v_mfma_f32_16x16x32_bf16 v[152:155], a[168:171], a[152:155], v[152:155]
  ds_read_b64_tr_b16 a[164:165], v6 offset:45056
  v_mfma_f32_16x16x32_bf16 v[152:155], a[172:175], a[136:139], v[152:155]
  buffer_load_dwordx4 v33, s[36:39], s61 offen lds
  v_mfma_f32_16x16x32_bf16 v[148:151], a[172:175], a[132:135], v[148:151]
  ds_read_b64_tr_b16 a[166:167], v6 offset:47104
  v_mfma_f32_16x16x32_bf16 v[148:151], a[168:171], a[148:151], v[148:151]
  v_mfma_f32_16x16x32_bf16 v[144:147], a[168:171], a[144:147], v[144:147]
  ds_read_b64_tr_b16 a[168:169], v3 offset:32768
  v_mfma_f32_16x16x32_bf16 v[144:147], a[172:175], a[128:131], v[144:147]
  s_waitcnt lgkmcnt(5)
  v_mfma_f32_16x16x32_bf16 v[128:131], a[180:183], a[188:191], v[128:131]
  ds_read_b64_tr_b16 a[170:171], v3 offset:34816
  v_mfma_f32_16x16x32_bf16 v[128:131], a[176:179], a[204:207], v[128:131]
  v_mfma_f32_16x16x32_bf16 v[132:135], a[176:179], a[208:211], v[132:135]
  ds_read_b64_tr_b16 a[172:173], v3 offset:36864
  v_mfma_f32_16x16x32_bf16 v[132:135], a[180:183], a[192:195], v[132:135]
  v_mfma_f32_16x16x32_bf16 v[136:139], a[180:183], a[196:199], v[136:139]
  ds_read_b64_tr_b16 a[174:175], v3 offset:38912
  v_mfma_f32_16x16x32_bf16 v[136:139], a[176:179], a[212:215], v[136:139]
  v_mfma_f32_16x16x32_bf16 v[140:143], a[176:179], a[216:219], v[140:143]
  ds_read_b64_tr_b16 a[176:177], v3 offset:40960
  v_mfma_f32_16x16x32_bf16 v[140:143], a[180:183], a[200:203], v[140:143]
  s_waitcnt lgkmcnt(5)
  v_mfma_f32_16x16x32_bf16 v[156:159], a[160:163], a[200:203], v[156:159]
  ds_read_b64_tr_b16 a[178:179], v3 offset:43008
  v_mfma_f32_16x16x32_bf16 v[156:159], a[164:167], a[216:219], v[156:159]
  v_mfma_f32_16x16x32_bf16 v[152:155], a[164:167], a[212:215], v[152:155]
  ds_read_b64_tr_b16 a[180:181], v3 offset:45056
  v_mfma_f32_16x16x32_bf16 v[152:155], a[160:163], a[196:199], v[152:155]
  v_mfma_f32_16x16x32_bf16 v[148:151], a[160:163], a[192:195], v[148:151]
  ds_read_b64_tr_b16 a[182:183], v3 offset:47104
  v_mfma_f32_16x16x32_bf16 v[148:151], a[164:167], a[208:211], v[148:151]
  v_mfma_f32_16x16x32_bf16 v[144:147], a[164:167], a[204:207], v[144:147]
  ds_read_b64_tr_b16 a[164:165], v3 offset:49152
  v_mfma_f32_16x16x32_bf16 v[144:147], a[160:163], a[188:191], v[144:147]
  s_waitcnt lgkmcnt(5)
  v_mfma_f32_16x16x32_bf16 v[160:163], a[168:171], a[64:67], v[160:163]
  ds_read_b64_tr_b16 a[166:167], v3 offset:51200
  v_mfma_f32_16x16x32_bf16 v[160:163], a[172:175], a[80:83], v[160:163]
  v_mfma_f32_16x16x32_bf16 v[164:167], a[172:175], a[84:87], v[164:167]
  ds_read_b64_tr_b16 a[160:161], v3 offset:53248
  s_waitcnt lgkmcnt(15)
  v_mfma_f32_16x16x32_bf16 v[164:167], a[168:171], a[68:71], v[164:167]
  v_fma_f32 v128, v128, v16, v60
  v_fma_f32 v129, v129, v16, v61
  v_mfma_f32_16x16x32_bf16 v[168:171], a[168:171], a[72:75], v[168:171]
  ds_read_b64_tr_b16 a[162:163], v3 offset:55296
  v_fma_f32 v130, v130, v16, v62
  v_mfma_f32_16x16x32_bf16 v[168:171], a[172:175], a[88:91], v[168:171]
  v_exp_f32 v24, v128
  v_mfma_f32_16x16x32_bf16 v[172:175], a[172:175], a[92:95], v[172:175]
  ds_read_b64_tr_b16 a[172:173], v3 offset:57344
  v_fma_f32 v131, v131, v16, v63
  v_mfma_f32_16x16x32_bf16 v[172:175], a[168:171], a[76:79], v[172:175]
  s_waitcnt lgkmcnt(5)
  v_exp_f32 v25, v129
  v_mfma_f32_16x16x32_bf16 v[188:191], a[176:179], a[76:79], v[188:191]
  ds_read_b64_tr_b16 a[174:175], v3 offset:59392
  v_fma_f32 v132, v132, v18, v60
  v_mfma_f32_16x16x32_bf16 v[188:191], a[180:183], a[92:95], v[188:191]
  v_exp_f32 v26, v130
  v_mfma_f32_16x16x32_bf16 v[184:187], a[180:183], a[88:91], v[184:187]
  ds_read_b64_tr_b16 a[168:169], v3 offset:61440
  v_fma_f32 v133, v133, v18, v61
  v_mfma_f32_16x16x32_bf16 v[184:187], a[176:179], a[72:75], v[184:187]
  v_exp_f32 v27, v131
  v_mfma_f32_16x16x32_bf16 v[180:183], a[176:179], a[68:71], v[180:183]
  ds_read_b64_tr_b16 a[170:171], v3 offset:63488
  v_fma_f32 v134, v134, v18, v62
  v_mfma_f32_16x16x32_bf16 v[180:183], a[180:183], a[84:87], v[180:183]
  v_exp_f32 v28, v132
  v_mfma_f32_16x16x32_bf16 v[176:179], a[180:183], a[80:83], v[176:179]
  ds_read_b64_tr_b16 a[180:181], v3 offset:16384
  v_fma_f32 v135, v135, v18, v63
  v_mfma_f32_16x16x32_bf16 v[176:179], a[176:179], a[64:67], v[176:179]
  s_waitcnt lgkmcnt(5)
  v_exp_f32 v29, v133
  v_mul_f32 v144, v128, v144
  v_mfma_f32_16x16x32_bf16 v[160:163], a[164:167], a[96:99], v[160:163]
  ds_read_b64_tr_b16 a[182:183], v3 offset:18432
  v_mul_f32 v145, v129, v145
  v_mfma_f32_16x16x32_bf16 v[160:163], a[160:163], a[112:115], v[160:163]
  v_exp_f32 v30, v134
  v_mfma_f32_16x16x32_bf16 v[164:167], a[160:163], a[116:119], v[164:167]
  ds_read_b64_tr_b16 a[176:177], v3 offset:20480
  v_mul_f32 v146, v130, v146
  v_mfma_f32_16x16x32_bf16 v[164:167], a[164:167], a[100:103], v[164:167]
  v_exp_f32 v31, v135
  v_mfma_f32_16x16x32_bf16 v[168:171], a[164:167], a[104:107], v[168:171]
  ds_read_b64_tr_b16 a[178:179], v3 offset:22528
  v_add_u32 v38, s46, v0
  s_waitcnt vmcnt(4)
  s_barrier
  s_mov_b64 exec, 1
  buffer_store_dword v38, v0, s[8:11], s80 offen offset:0 sc1
  s_mov_b64 exec, -1
  v_mfma_f32_16x16x32_bf16 v[168:171], a[160:163], a[120:123], v[168:171]
  v_mul_f32 v147, v131, v147
  v_mul_f32 v148, v132, v148
  v_mfma_f32_16x16x32_bf16 v[172:175], a[160:163], a[124:127], v[172:175]
  ds_read_b64_tr_b16 a[160:161], v3 offset:24576
  v_mul_f32 v149, v133, v149
  v_mfma_f32_16x16x32_bf16 v[172:175], a[164:167], a[108:111], v[172:175]
  s_waitcnt lgkmcnt(5)
  v_mul_f32 v150, v134, v150
  v_mul_f32 v151, v135, v151
  v_mfma_f32_16x16x32_bf16 v[188:191], a[172:175], a[108:111], v[188:191]
  ds_read_b64_tr_b16 a[162:163], v3 offset:26624
  v_fma_f32 v24, v24, v17, v17
  v_mfma_f32_16x16x32_bf16 v[188:191], a[168:171], a[124:127], v[188:191]
  v_rcp_f32 v24, v24
  v_mfma_f32_16x16x32_bf16 v[184:187], a[168:171], a[120:123], v[184:187]
  ds_read_b64_tr_b16 a[164:165], v3 offset:28672
  v_fma_f32 v25, v25, v17, v17
  v_mfma_f32_16x16x32_bf16 v[184:187], a[172:175], a[104:107], v[184:187]
  v_rcp_f32 v25, v25
  v_mfma_f32_16x16x32_bf16 v[180:183], a[172:175], a[100:103], v[180:183]
  ds_read_b64_tr_b16 a[166:167], v3 offset:30720
  v_fma_f32 v26, v26, v17, v17
  v_mfma_f32_16x16x32_bf16 v[180:183], a[168:171], a[116:119], v[180:183]
  v_rcp_f32 v26, v26
  v_mfma_f32_16x16x32_bf16 v[176:179], a[168:171], a[112:115], v[176:179]
  ds_read_b64_tr_b16 a[168:169], v7 offset:32768
  v_fma_f32 v27, v27, v17, v17
  v_mfma_f32_16x16x32_bf16 v[176:179], a[172:175], a[96:99], v[176:179]
  s_waitcnt lgkmcnt(5)
  v_rcp_f32 v27, v27
  v_fma_f32 v28, v28, v19, v19
  v_mfma_f32_16x16x32_bf16 v[160:163], a[180:183], a[128:131], v[160:163]
  ds_read_b64_tr_b16 a[170:171], v7 offset:34816
  v_fma_f32 v29, v29, v19, v19
  v_mfma_f32_16x16x32_bf16 v[160:163], a[176:179], a[144:147], v[160:163]
  v_rcp_f32 v28, v28
  v_mfma_f32_16x16x32_bf16 v[164:167], a[176:179], a[148:151], v[164:167]
  ds_read_b64_tr_b16 a[172:173], v7 offset:36864
  v_fma_f32 v30, v30, v19, v19
  v_mfma_f32_16x16x32_bf16 v[164:167], a[180:183], a[132:135], v[164:167]
  v_rcp_f32 v29, v29
  v_mfma_f32_16x16x32_bf16 v[168:171], a[180:183], a[136:139], v[168:171]
  ds_read_b64_tr_b16 a[174:175], v7 offset:38912
  v_fma_f32 v31, v31, v19, v19
  v_mfma_f32_16x16x32_bf16 v[168:171], a[176:179], a[152:155], v[168:171]
  v_rcp_f32 v30, v30
  v_mfma_f32_16x16x32_bf16 v[172:175], a[176:179], a[156:159], v[172:175]
  ds_read_b64_tr_b16 a[176:177], v7 offset:40960
  v_mul_f32 v144, v144, v24
  v_mfma_f32_16x16x32_bf16 v[172:175], a[180:183], a[140:143], v[172:175]
  s_waitcnt lgkmcnt(5)
  v_rcp_f32 v31, v31
  v_mfma_f32_16x16x32_bf16 v[188:191], a[160:163], a[140:143], v[188:191]
  ds_read_b64_tr_b16 a[178:179], v7 offset:43008
  v_mul_f32 v145, v145, v25
  v_mfma_f32_16x16x32_bf16 v[188:191], a[164:167], a[156:159], v[188:191]
  v_mul_f32 v146, v146, v26
  v_mul_f32 v147, v147, v27
  v_mfma_f32_16x16x32_bf16 v[184:187], a[164:167], a[152:155], v[184:187]
  ds_read_b64_tr_b16 a[180:181], v7 offset:45056
  v_mul_f32 v148, v148, v28
  v_mfma_f32_16x16x32_bf16 v[184:187], a[160:163], a[136:139], v[184:187]
  v_mul_f32 v149, v149, v29
  v_mul_f32 v150, v150, v30
  v_mfma_f32_16x16x32_bf16 v[180:183], a[160:163], a[132:135], v[180:183]
  ds_read_b64_tr_b16 a[182:183], v7 offset:47104
  v_mul_f32 v151, v151, v31
  v_mfma_f32_16x16x32_bf16 v[180:183], a[164:167], a[148:151], v[180:183]
  v_cvt_pk_bf16_f32 v128, v144, v145
  v_cvt_pk_bf16_f32 v129, v146, v147
  v_mfma_f32_16x16x32_bf16 v[176:179], a[164:167], a[144:147], v[176:179]
  ds_read_b64_tr_b16 a[164:165], v4 offset:32768
  v_cvt_pk_bf16_f32 v132, v148, v149
  v_mfma_f32_16x16x32_bf16 v[176:179], a[160:163], a[128:131], v[176:179]
  s_waitcnt lgkmcnt(5)
  v_cvt_pk_bf16_f32 v133, v150, v151
  v_fma_f32 v136, v136, v20, v60
  v_fma_f32 v137, v137, v20, v61
  v_mfma_f32_16x16x32_bf16 v[160:163], a[168:171], a[188:191], v[160:163]
  ds_read_b64_tr_b16 a[166:167], v4 offset:34816
  v_fma_f32 v138, v138, v20, v62
  v_mfma_f32_16x16x32_bf16 v[160:163], a[172:175], a[204:207], v[160:163]
  v_exp_f32 v24, v136
  v_mfma_f32_16x16x32_bf16 v[164:167], a[172:175], a[208:211], v[164:167]
  ds_read_b64_tr_b16 a[160:161], v4 offset:36864
  v_fma_f32 v139, v139, v20, v63
  v_mfma_f32_16x16x32_bf16 v[164:167], a[168:171], a[192:195], v[164:167]
  v_exp_f32 v25, v137
  v_mfma_f32_16x16x32_bf16 v[168:171], a[168:171], a[196:199], v[168:171]
  ds_read_b64_tr_b16 a[162:163], v4 offset:38912
  v_fma_f32 v140, v140, v22, v60
  v_mfma_f32_16x16x32_bf16 v[168:171], a[172:175], a[212:215], v[168:171]
  v_exp_f32 v26, v138
  v_mfma_f32_16x16x32_bf16 v[172:175], a[172:175], a[216:219], v[172:175]
  ds_read_b64_tr_b16 a[172:173], v4 offset:40960
  v_fma_f32 v141, v141, v22, v61
  v_mfma_f32_16x16x32_bf16 v[172:175], a[168:171], a[200:203], v[172:175]
  s_waitcnt lgkmcnt(5)
  v_exp_f32 v27, v139
  v_mfma_f32_16x16x32_bf16 v[188:191], a[176:179], a[200:203], v[188:191]
  ds_read_b64_tr_b16 a[174:175], v4 offset:43008
  v_fma_f32 v142, v142, v22, v62
  v_mfma_f32_16x16x32_bf16 v[188:191], a[180:183], a[216:219], v[188:191]
  v_exp_f32 v28, v140
  v_mfma_f32_16x16x32_bf16 v[184:187], a[180:183], a[212:215], v[184:187]
  ds_read_b64_tr_b16 a[168:169], v4 offset:45056
  v_fma_f32 v143, v143, v22, v63
  v_mfma_f32_16x16x32_bf16 v[184:187], a[176:179], a[196:199], v[184:187]
  v_exp_f32 v29, v141
  v_mfma_f32_16x16x32_bf16 v[180:183], a[176:179], a[192:195], v[180:183]
  ds_read_b64_tr_b16 a[170:171], v4 offset:47104
  v_mul_f32 v152, v136, v152
  v_mfma_f32_16x16x32_bf16 v[180:183], a[180:183], a[208:211], v[180:183]
  v_exp_f32 v30, v142
  v_mfma_f32_16x16x32_bf16 v[176:179], a[180:183], a[204:207], v[176:179]
  ds_read_b64_tr_b16 a[180:181], v4 offset:49152
  v_mul_f32 v153, v137, v153
  v_mfma_f32_16x16x32_bf16 v[176:179], a[176:179], a[188:191], v[176:179]
  s_waitcnt lgkmcnt(5)
  v_exp_f32 v31, v143
  v_mul_f32 v154, v138, v154
  v_mfma_f32_16x16x32_bf16 v[192:195], a[164:167], a[64:67], v[192:195]
  ds_read_b64_tr_b16 a[182:183], v4 offset:51200
  ds_read_b128 v[60:63], v12 offset:576
  v_mfma_f32_16x16x32_bf16 v[192:195], a[160:163], a[80:83], v[192:195]
  v_mul_f32 v155, v139, v155
  v_mul_f32 v156, v140, v156
  v_mfma_f32_16x16x32_bf16 v[196:199], a[160:163], a[84:87], v[196:199]
  ds_read_b64_tr_b16 a[176:177], v4 offset:53248
  v_mul_f32 v157, v141, v157
  v_mfma_f32_16x16x32_bf16 v[196:199], a[164:167], a[68:71], v[196:199]
  v_mul_f32 v158, v142, v158
  v_mul_f32 v159, v143, v159
  v_mfma_f32_16x16x32_bf16 v[200:203], a[164:167], a[72:75], v[200:203]
  ds_read_b64_tr_b16 a[178:179], v4 offset:55296
  v_fma_f32 v24, v24, v21, v21
  v_mfma_f32_16x16x32_bf16 v[200:203], a[160:163], a[88:91], v[200:203]
  v_rcp_f32 v24, v24
  v_mfma_f32_16x16x32_bf16 v[204:207], a[160:163], a[92:95], v[204:207]
  ds_read_b64_tr_b16 a[160:161], v4 offset:57344
  v_fma_f32 v25, v25, v21, v21
  v_mfma_f32_16x16x32_bf16 v[204:207], a[164:167], a[76:79], v[204:207]
  s_waitcnt lgkmcnt(6)
  v_rcp_f32 v25, v25
  v_mfma_f32_16x16x32_bf16 v[220:223], a[172:175], a[76:79], v[220:223]
  ds_read_b64_tr_b16 a[162:163], v4 offset:59392
  v_fma_f32 v26, v26, v21, v21
  v_mfma_f32_16x16x32_bf16 v[220:223], a[168:171], a[92:95], v[220:223]
  v_rcp_f32 v26, v26
  v_mfma_f32_16x16x32_bf16 v[216:219], a[168:171], a[88:91], v[216:219]
  ds_read_b64_tr_b16 a[164:165], v4 offset:61440
  v_fma_f32 v27, v27, v21, v21
  v_mfma_f32_16x16x32_bf16 v[216:219], a[172:175], a[72:75], v[216:219]
  v_rcp_f32 v27, v27
  v_mfma_f32_16x16x32_bf16 v[212:215], a[172:175], a[68:71], v[212:215]
  ds_read_b64_tr_b16 a[166:167], v4 offset:63488
  v_fma_f32 v28, v28, v23, v23
  v_mfma_f32_16x16x32_bf16 v[212:215], a[168:171], a[84:87], v[212:215]
  v_rcp_f32 v28, v28
  v_mfma_f32_16x16x32_bf16 v[208:211], a[168:171], a[80:83], v[208:211]
  ds_read_b64_tr_b16 a[168:169], v4 offset:16384
  v_fma_f32 v29, v29, v23, v23
  v_mfma_f32_16x16x32_bf16 v[208:211], a[172:175], a[64:67], v[208:211]
  s_waitcnt lgkmcnt(5)
  v_rcp_f32 v29, v29
  v_fma_f32 v30, v30, v23, v23
  v_mfma_f32_16x16x32_bf16 v[192:195], a[180:183], a[96:99], v[192:195]
  ds_read_b64_tr_b16 a[170:171], v4 offset:18432
  v_fma_f32 v31, v31, v23, v23
  v_mfma_f32_16x16x32_bf16 v[192:195], a[176:179], a[112:115], v[192:195]
  v_rcp_f32 v30, v30
  v_mfma_f32_16x16x32_bf16 v[196:199], a[176:179], a[116:119], v[196:199]
  ds_read_b64_tr_b16 a[172:173], v4 offset:20480
  v_mul_f32 v152, v152, v24
  v_mfma_f32_16x16x32_bf16 v[196:199], a[180:183], a[100:103], v[196:199]
  v_rcp_f32 v31, v31
  v_mfma_f32_16x16x32_bf16 v[200:203], a[180:183], a[104:107], v[200:203]
  ds_read_b64_tr_b16 a[174:175], v4 offset:22528
HOP15:
  s_cbranch_execz HOP19
  v_mul_f32 v153, v153, v25
  v_mfma_f32_16x16x32_bf16 v[200:203], a[176:179], a[120:123], v[200:203]
  v_mul_f32 v154, v154, v26
  v_mul_f32 v155, v155, v27
  v_mfma_f32_16x16x32_bf16 v[204:207], a[176:179], a[124:127], v[204:207]
  ds_read_b64_tr_b16 a[176:177], v4 offset:24576
  v_mul_f32 v156, v156, v28
  v_mfma_f32_16x16x32_bf16 v[204:207], a[180:183], a[108:111], v[204:207]
  s_waitcnt lgkmcnt(5)
  v_mul_f32 v157, v157, v29
  v_mul_f32 v158, v158, v30
  v_mfma_f32_16x16x32_bf16 v[220:223], a[160:163], a[108:111], v[220:223]
  ds_read_b64_tr_b16 a[178:179], v4 offset:26624
  v_mul_f32 v159, v159, v31
  v_mfma_f32_16x16x32_bf16 v[220:223], a[164:167], a[124:127], v[220:223]
  v_cvt_pk_bf16_f32 v136, v152, v153
  v_cvt_pk_bf16_f32 v137, v154, v155
  v_mfma_f32_16x16x32_bf16 v[216:219], a[164:167], a[120:123], v[216:219]
  ds_read_b64_tr_b16 a[180:181], v4 offset:28672
  v_cvt_pk_bf16_f32 v140, v156, v157
  v_mfma_f32_16x16x32_bf16 v[216:219], a[160:163], a[104:107], v[216:219]
  v_cvt_pk_bf16_f32 v141, v158, v159
  v_mfma_f32_16x16x32_bf16 v[212:215], a[160:163], a[100:103], v[212:215]
  ds_read_b64_tr_b16 a[182:183], v4 offset:30720
  s_lshl_b32 s83, s44, 28
  s_add_u32 s83, s83, s82
  buffer_load_dword v36, v37, s[8:11], s83 offen sc1
  v_mfma_f32_16x16x32_bf16 v[212:215], a[164:167], a[116:119], v[212:215]
  s_waitcnt lgkmcnt(14)
  v_fma_f32 v160, v160, v16, v60
  v_fma_f32 v161, v161, v16, v61
  v_mfma_f32_16x16x32_bf16 v[208:211], a[164:167], a[112:115], v[208:211]
  ds_read_b64_tr_b16 a[164:165], v8 offset:32768
  v_fma_f32 v162, v162, v16, v62
  v_mfma_f32_16x16x32_bf16 v[208:211], a[160:163], a[96:99], v[208:211]
  s_waitcnt lgkmcnt(5)
  v_exp_f32 v24, v160
  v_fma_f32 v163, v163, v16, v63
  v_mfma_f32_16x16x32_bf16 v[192:195], a[168:171], a[128:131], v[192:195]
  ds_read_b64_tr_b16 a[166:167], v8 offset:34816
  v_fma_f32 v164, v164, v18, v60
  v_mfma_f32_16x16x32_bf16 v[192:195], a[172:175], a[144:147], v[192:195]
  v_exp_f32 v25, v161
  v_mfma_f32_16x16x32_bf16 v[196:199], a[172:175], a[148:151], v[196:199]
  ds_read_b64_tr_b16 a[160:161], v8 offset:36864
  v_fma_f32 v165, v165, v18, v61
  v_mfma_f32_16x16x32_bf16 v[196:199], a[168:171], a[132:135], v[196:199]
  v_exp_f32 v26, v162
  v_fma_f32 v166, v166, v18, v62
  v_mfma_f32_16x16x32_bf16 v[200:203], a[168:171], a[136:139], v[200:203]
  ds_read_b64_tr_b16 a[162:163], v8 offset:38912
  v_fma_f32 v167, v167, v18, v63
  v_mfma_f32_16x16x32_bf16 v[200:203], a[172:175], a[152:155], v[200:203]
  v_exp_f32 v27, v163
  v_mfma_f32_16x16x32_bf16 v[204:207], a[172:175], a[156:159], v[204:207]
  ds_read_b64_tr_b16 a[172:173], v8 offset:40960
  v_mul_f32 v176, v160, v176
  v_mfma_f32_16x16x32_bf16 v[204:207], a[168:171], a[140:143], v[204:207]
  s_waitcnt lgkmcnt(5)
  v_exp_f32 v28, v164
  v_mul_f32 v177, v161, v177
  v_mfma_f32_16x16x32_bf16 v[220:223], a[176:179], a[140:143], v[220:223]
  ds_read_b64_tr_b16 a[174:175], v8 offset:43008
  v_mul_f32 v178, v162, v178
  v_mfma_f32_16x16x32_bf16 v[220:223], a[180:183], a[156:159], v[220:223]
  v_exp_f32 v29, v165
  v_mfma_f32_16x16x32_bf16 v[216:219], a[180:183], a[152:155], v[216:219]
  ds_read_b64_tr_b16 a[168:169], v8 offset:45056
  v_mul_f32 v179, v163, v179
  v_mfma_f32_16x16x32_bf16 v[216:219], a[176:179], a[136:139], v[216:219]
  v_exp_f32 v30, v166
  v_mul_f32 v180, v164, v180
  v_mfma_f32_16x16x32_bf16 v[212:215], a[176:179], a[132:135], v[212:215]
  ds_read_b64_tr_b16 a[170:171], v8 offset:47104
  v_mul_f32 v181, v165, v181
  v_mfma_f32_16x16x32_bf16 v[212:215], a[180:183], a[148:151], v[212:215]
  v_exp_f32 v31, v167
  v_mfma_f32_16x16x32_bf16 v[208:211], a[180:183], a[144:147], v[208:211]
  ds_read_b64_tr_b16 a[180:181], v5 offset:32768
  v_mul_f32 v182, v166, v182
  v_mfma_f32_16x16x32_bf16 v[208:211], a[176:179], a[128:131], v[208:211]
  s_waitcnt lgkmcnt(5)
  v_mul_f32 v183, v167, v183
  v_fma_f32 v24, v24, v17, v17
  v_fma_f32 v25, v25, v17, v17
  v_mfma_f32_16x16x32_bf16 v[192:195], a[164:167], a[188:191], v[192:195]
  ds_read_b64_tr_b16 a[182:183], v5 offset:34816
  v_fma_f32 v26, v26, v17, v17
  v_mfma_f32_16x16x32_bf16 v[192:195], a[160:163], a[204:207], v[192:195]
  v_rcp_f32 v24, v24
  v_mfma_f32_16x16x32_bf16 v[196:199], a[160:163], a[208:211], v[196:199]
  ds_read_b64_tr_b16 a[176:177], v5 offset:36864
  v_fma_f32 v27, v27, v17, v17
  v_mfma_f32_16x16x32_bf16 v[196:199], a[164:167], a[192:195], v[196:199]
  v_rcp_f32 v25, v25
  v_fma_f32 v28, v28, v19, v19
  v_mfma_f32_16x16x32_bf16 v[200:203], a[164:167], a[196:199], v[200:203]
  ds_read_b64_tr_b16 a[178:179], v5 offset:38912
  v_fma_f32 v29, v29, v19, v19
  v_mfma_f32_16x16x32_bf16 v[200:203], a[160:163], a[212:215], v[200:203]
  v_rcp_f32 v26, v26
  v_mfma_f32_16x16x32_bf16 v[204:207], a[160:163], a[216:219], v[204:207]
  ds_read_b64_tr_b16 a[160:161], v5 offset:40960
  v_fma_f32 v30, v30, v19, v19
  v_mfma_f32_16x16x32_bf16 v[204:207], a[164:167], a[200:203], v[204:207]
  s_waitcnt lgkmcnt(5)
  v_rcp_f32 v27, v27
  v_fma_f32 v31, v31, v19, v19
  v_mfma_f32_16x16x32_bf16 v[220:223], a[172:175], a[200:203], v[220:223]
  ds_read_b64_tr_b16 a[162:163], v5 offset:43008
  v_mul_f32 v176, v176, v24
  v_mfma_f32_16x16x32_bf16 v[220:223], a[168:171], a[216:219], v[220:223]
  v_rcp_f32 v28, v28
  v_mfma_f32_16x16x32_bf16 v[216:219], a[168:171], a[212:215], v[216:219]
  ds_read_b64_tr_b16 a[164:165], v5 offset:45056
  v_mul_f32 v177, v177, v25
  v_mfma_f32_16x16x32_bf16 v[216:219], a[172:175], a[196:199], v[216:219]
  v_rcp_f32 v29, v29
  v_mul_f32 v178, v178, v26
  v_mfma_f32_16x16x32_bf16 v[212:215], a[172:175], a[192:195], v[212:215]
  ds_read_b64_tr_b16 a[166:167], v5 offset:47104
  v_mul_f32 v179, v179, v27
  v_mfma_f32_16x16x32_bf16 v[212:215], a[168:171], a[208:211], v[212:215]
  v_rcp_f32 v30, v30
  v_mfma_f32_16x16x32_bf16 v[208:211], a[168:171], a[204:207], v[208:211]
  ds_read_b64_tr_b16 a[168:169], v5 offset:49152
  v_mul_f32 v180, v180, v28
  v_mfma_f32_16x16x32_bf16 v[208:211], a[172:175], a[188:191], v[208:211]
  s_waitcnt lgkmcnt(5)
  v_rcp_f32 v31, v31
  v_mul_f32 v181, v181, v29
  v_mfma_f32_16x16x32_bf16 v[224:227], a[180:183], a[64:67], v[224:227]
  ds_read_b64_tr_b16 a[170:171], v5 offset:51200
  v_mul_f32 v182, v182, v30
  v_mfma_f32_16x16x32_bf16 v[224:227], a[176:179], a[80:83], v[224:227]
  v_mul_f32 v183, v183, v31
  v_cvt_pk_bf16_f32 v130, v176, v177
  v_mfma_f32_16x16x32_bf16 v[228:231], a[176:179], a[84:87], v[228:231]
  ds_read_b64_tr_b16 a[172:173], v5 offset:53248
  v_cvt_pk_bf16_f32 v131, v178, v179
  v_mfma_f32_16x16x32_bf16 v[228:231], a[180:183], a[68:71], v[228:231]
  buffer_store_dwordx4 v[128:131], v1, s[8:11], s58 offen offset:0 sc1
  v_mfma_f32_16x16x32_bf16 v[232:235], a[180:183], a[72:75], v[232:235]
  ds_read_b64_tr_b16 a[174:175], v5 offset:55296
  s_waitcnt vmcnt(1)
  s_cmp_lg_u32 s44, 0
  s_cbranch_scc1 PL12_adaLN_cond__sliding_local_dilated__swiglu_ffn__prompt_kernelx
  v_cmp_ne_u32 vcc, s46, v36
  s_nop 4
  s_cbranch_vccz PL12_adaLN_cond__sliding_local_dilated__swiglu_ffn__prompt_kernelx
  s_mov_b32 s83, 60000
PL12_adaLN_cond__sliding_local_dilated__swiglu_ffn__prompt_kernel:
  buffer_load_dword v36, v37, s[8:11], s82 offen sc1
  s_sub_u32 s83, s83, 1
  s_cmp_eq_u32 s83, 0
  s_waitcnt vmcnt(0)
  s_cbranch_scc1 PL12_adaLN_cond__sliding_local_dilated__swiglu_ffn__prompt_kernelx
  v_cmp_ne_u32 vcc, s46, v36
  s_nop 4
  s_cbranch_vccnz PL12_adaLN_cond__sliding_local_dilated__swiglu_ffn__prompt_kernel
PL12_adaLN_cond__sliding_local_dilated__swiglu_ffn__prompt_kernelx:
  s_barrier
  v_mfma_f32_16x16x32_bf16 v[232:235], a[176:179], a[88:91], v[232:235]
  v_cvt_pk_bf16_f32 v134, v180, v181
  v_cvt_pk_bf16_f32 v135, v182, v183
  v_mfma_f32_16x16x32_bf16 v[236:239], a[176:179], a[92:95], v[236:239]
  ds_read_b64_tr_b16 a[176:177], v5 offset:57344
  v_fma_f32 v168, v168, v20, v60
  v_mfma_f32_16x16x32_bf16 v[236:239], a[180:183], a[76:79], v[236:239]
  s_waitcnt lgkmcnt(5)
  buffer_load_dwordx4 a[220:223], v1, s[8:11], s72 offen offset:0 sc1
  v_exp_f32 v24, v168
  v_mfma_f32_16x16x32_bf16 v[252:255], a[160:163], a[76:79], v[252:255]
  ds_read_b64_tr_b16 a[178:179], v5 offset:59392
  s_add_u32 s55, s58, 262144
  buffer_store_dwordx4 v[132:135], v1, s[8:11], s55 offen offset:0 sc1
  v_mfma_f32_16x16x32_bf16 v[252:255], a[164:167], a[92:95], v[252:255]
  v_fma_f32 v169, v169, v20, v61
  v_fma_f32 v170, v170, v20, v62
  v_mfma_f32_16x16x32_bf16 v[248:251], a[164:167], a[88:91], v[248:251]
  ds_read_b64_tr_b16 a[180:181], v5 offset:61440
  v_fma_f32 v171, v171, v20, v63
  v_mfma_f32_16x16x32_bf16 v[248:251], a[160:163], a[72:75], v[248:251]
  buffer_load_dwordx4 a[236:239], v1, s[8:11], s72 offen offset:1024 sc1
  v_exp_f32 v25, v169
  v_fma_f32 v172, v172, v22, v60
  v_mfma_f32_16x16x32_bf16 v[244:247], a[160:163], a[68:71], v[244:247]
  ds_read_b64_tr_b16 a[182:183], v5 offset:63488
  v_fma_f32 v173, v173, v22, v61
  v_mfma_f32_16x16x32_bf16 v[244:247], a[164:167], a[84:87], v[244:247]
  s_add_u32 s72, s72, 131072
  v_exp_f32 v26, v170
  v_mfma_f32_16x16x32_bf16 v[240:243], a[164:167], a[80:83], v[240:243]
  ds_read_b64_tr_b16 a[164:165], v5 offset:16384
  v_fma_f32 v174, v174, v22, v62
  v_mfma_f32_16x16x32_bf16 v[240:243], a[160:163], a[64:67], v[240:243]
  s_waitcnt lgkmcnt(5)
  buffer_load_dwordx4 a[224:227], v1, s[8:11], s72 offen offset:0 sc1
  v_exp_f32 v27, v171
  v_mfma_f32_16x16x32_bf16 v[224:227], a[168:171], a[96:99], v[224:227]
  ds_read_b64_tr_b16 a[166:167], v5 offset:18432
  v_fma_f32 v175, v175, v22, v63
  v_mfma_f32_16x16x32_bf16 v[224:227], a[172:175], a[112:115], v[224:227]
  v_exp_f32 v28, v172
  v_mfma_f32_16x16x32_bf16 v[228:231], a[172:175], a[116:119], v[228:231]
  ds_read_b64_tr_b16 a[160:161], v5 offset:20480
  v_mul_f32 v184, v168, v184
  v_mfma_f32_16x16x32_bf16 v[228:231], a[168:171], a[100:103], v[228:231]
  buffer_load_dwordx4 a[240:243], v1, s[8:11], s72 offen offset:1024 sc1
  v_exp_f32 v29, v173
  v_mul_f32 v185, v169, v185
  v_mfma_f32_16x16x32_bf16 v[232:235], a[168:171], a[104:107], v[232:235]
  ds_read_b64_tr_b16 a[162:163], v5 offset:22528
  v_mul_f32 v186, v170, v186
  v_mfma_f32_16x16x32_bf16 v[232:235], a[172:175], a[120:123], v[232:235]
  s_add_u32 s72, s72, s89
  v_exp_f32 v30, v174
  v_mfma_f32_16x16x32_bf16 v[236:239], a[172:175], a[124:127], v[236:239]
  ds_read_b64_tr_b16 a[172:173], v5 offset:24576
  ds_read_b128 v[60:63], v12 offset:640
  v_mfma_f32_16x16x32_bf16 v[236:239], a[168:171], a[108:111], v[236:239]
  s_waitcnt lgkmcnt(6)
  buffer_load_dwordx4 a[228:231], v1, s[8:11], s72 offen offset:0 sc1
  v_exp_f32 v31, v175
  v_mfma_f32_16x16x32_bf16 v[252:255], a[176:179], a[108:111], v[252:255]
  ds_read_b64_tr_b16 a[174:175], v5 offset:26624
  v_mul_f32 v187, v171, v187
  v_mfma_f32_16x16x32_bf16 v[252:255], a[180:183], a[124:127], v[252:255]
  v_mul_f32 v188, v172, v188
  v_mul_f32 v189, v173, v189
  v_mfma_f32_16x16x32_bf16 v[248:251], a[180:183], a[120:123], v[248:251]
  ds_read_b64_tr_b16 a[168:169], v5 offset:28672
  v_mul_f32 v190, v174, v190
  v_mfma_f32_16x16x32_bf16 v[248:251], a[176:179], a[104:107], v[248:251]
  buffer_load_dwordx4 a[244:247], v1, s[8:11], s72 offen offset:1024 sc1
  v_mul_f32 v191, v175, v191
  v_fma_f32 v24, v24, v21, v21
  v_fma_f32 v25, v25, v21, v21
  v_mfma_f32_16x16x32_bf16 v[244:247], a[176:179], a[100:103], v[244:247]
  ds_read_b64_tr_b16 a[170:171], v5 offset:30720
  v_fma_f32 v26, v26, v21, v21
  v_mfma_f32_16x16x32_bf16 v[244:247], a[180:183], a[116:119], v[244:247]
  s_add_u32 s72, s72, 131072
  v_rcp_f32 v24, v24
  v_mfma_f32_16x16x32_bf16 v[240:243], a[180:183], a[112:115], v[240:243]
  ds_read_b64_tr_b16 a[180:181], v9 offset:32768
  v_fma_f32 v27, v27, v21, v21
  v_mfma_f32_16x16x32_bf16 v[240:243], a[176:179], a[96:99], v[240:243]
  s_waitcnt lgkmcnt(6)
  buffer_load_dwordx4 a[232:235], v1, s[8:11], s72 offen offset:0 sc1
  v_rcp_f32 v25, v25
  v_mfma_f32_16x16x32_bf16 v[224:227], a[164:167], a[128:131], v[224:227]
  ds_read_b64_tr_b16 a[182:183], v9 offset:34816
  v_fma_f32 v28, v28, v23, v23
  v_mfma_f32_16x16x32_bf16 v[224:227], a[160:163], a[144:147], v[224:227]
  v_rcp_f32 v26, v26
  v_mfma_f32_16x16x32_bf16 v[228:231], a[160:163], a[148:151], v[228:231]
  ds_read_b64_tr_b16 a[176:177], v9 offset:36864
  v_fma_f32 v29, v29, v23, v23
  v_mfma_f32_16x16x32_bf16 v[228:231], a[164:167], a[132:135], v[228:231]
  buffer_load_dwordx4 a[248:251], v1, s[8:11], s72 offen offset:1024 sc1
  v_rcp_f32 v27, v27
  v_fma_f32 v30, v30, v23, v23
  v_mfma_f32_16x16x32_bf16 v[232:235], a[164:167], a[136:139], v[232:235]
  ds_read_b64_tr_b16 a[178:179], v9 offset:38912
  v_fma_f32 v31, v31, v23, v23
  v_mfma_f32_16x16x32_bf16 v[232:235], a[160:163], a[152:155], v[232:235]
  v_rcp_f32 v28, v28
  v_mfma_f32_16x16x32_bf16 v[236:239], a[160:163], a[156:159], v[236:239]
  ds_read_b64_tr_b16 a[160:161], v9 offset:40960
  v_mul_f32 v184, v184, v24
  v_mfma_f32_16x16x32_bf16 v[236:239], a[164:167], a[140:143], v[236:239]
  s_waitcnt lgkmcnt(5)
  buffer_load_dwordx4 a[0:3], v1, s[8:11], s73 offen offset:0 sc1
  v_rcp_f32 v29, v29
  v_mfma_f32_16x16x32_bf16 v[252:255], a[172:175], a[140:143], v[252:255]
  ds_read_b64_tr_b16 a[162:163], v9 offset:43008
  v_mul_f32 v185, v185, v25
  v_mfma_f32_16x16x32_bf16 v[252:255], a[168:171], a[156:159], v[252:255]
  v_rcp_f32 v30, v30
  v_mfma_f32_16x16x32_bf16 v[248:251], a[168:171], a[152:155], v[248:251]
  ds_read_b64_tr_b16 a[164:165], v9 offset:45056
  v_mul_f32 v186, v186, v26
  v_mfma_f32_16x16x32_bf16 v[248:251], a[172:175], a[136:139], v[248:251]
  buffer_load_dwordx4 a[16:19], v1, s[8:11], s73 offen offset:1024 sc1
  v_rcp_f32 v31, v31
  v_mul_f32 v187, v187, v27
  v_mfma_f32_16x16x32_bf16 v[244:247], a[172:175], a[132:135], v[244:247]
  ds_read_b64_tr_b16 a[166:167], v9 offset:47104
  v_mul_f32 v188, v188, v28
  v_mfma_f32_16x16x32_bf16 v[244:247], a[168:171], a[148:151], v[244:247]
  s_waitcnt vmcnt(32)
  s_barrier
  v_mfma_f32_16x16x32_bf16 v[240:243], a[168:171], a[144:147], v[240:243]
  ds_read_b64_tr_b16 a[168:169], v6 offset:49152
  s_add_u32 s73, s73, 131072
  v_mfma_f32_16x16x32_bf16 v[240:243], a[172:175], a[128:131], v[240:243]
  s_waitcnt lgkmcnt(5)
  buffer_load_dwordx4 a[4:7], v1, s[8:11], s73 offen offset:0 sc1
  v_mul_f32 v189, v189, v29
  v_mul_f32 v190, v190, v30
  v_mfma_f32_16x16x32_bf16 v[224:227], a[180:183], a[188:191], v[224:227]
  ds_read_b64_tr_b16 a[170:171], v6 offset:51200
  v_mul_f32 v191, v191, v31
  v_mfma_f32_16x16x32_bf16 v[224:227], a[176:179], a[204:207], v[224:227]
  v_cvt_pk_bf16_f32 v138, v184, v185
  v_cvt_pk_bf16_f32 v139, v186, v187
  v_mfma_f32_16x16x32_bf16 v[228:231], a[176:179], a[208:211], v[228:231]
  ds_read_b64_tr_b16 a[172:173], v6 offset:53248
  v_cvt_pk_bf16_f32 v142, v188, v189
  v_mfma_f32_16x16x32_bf16 v[228:231], a[180:183], a[192:195], v[228:231]
  buffer_load_dwordx4 a[20:23], v1, s[8:11], s73 offen offset:1024 sc1
  s_add_u32 s55, s58, 524288
  buffer_store_dwordx4 v[136:139], v1, s[8:11], s55 offen offset:0 sc1
  v_mfma_f32_16x16x32_bf16 v[232:235], a[180:183], a[196:199], v[232:235]
  ds_read_b64_tr_b16 a[174:175], v6 offset:55296
  v_cvt_pk_bf16_f32 v143, v190, v191
  v_mfma_f32_16x16x32_bf16 v[232:235], a[176:179], a[212:215], v[232:235]
  s_add_u32 s73, s73, s89
  s_add_u32 s55, s58, 786432
  buffer_store_dwordx4 v[140:143], v1, s[8:11], s55 offen offset:0 sc1
  v_mfma_f32_16x16x32_bf16 v[236:239], a[176:179], a[216:219], v[236:239]
  ds_read_b64_tr_b16 a[176:177], v7 offset:49152
  s_waitcnt lgkmcnt(15)
  v_mfma_f32_16x16x32_bf16 v[236:239], a[180:183], a[200:203], v[236:239]
  s_waitcnt lgkmcnt(5)
  buffer_load_dwordx4 a[8:11], v1, s[8:11], s73 offen offset:0 sc1
  v_fma_f32 v192, v192, v16, v60
  v_fma_f32 v193, v193, v16, v61
  v_mfma_f32_16x16x32_bf16 v[252:255], a[160:163], a[200:203], v[252:255]
  ds_read_b64_tr_b16 a[178:179], v7 offset:51200
  v_fma_f32 v194, v194, v16, v62
  v_mfma_f32_16x16x32_bf16 v[252:255], a[164:167], a[216:219], v[252:255]
  s_waitcnt vmcnt(31)
  s_barrier
  v_mfma_f32_16x16x32_bf16 v[248:251], a[164:167], a[212:215], v[248:251]
  ds_read_b64_tr_b16 a[180:181], v7 offset:53248
  v_exp_f32 v24, v192
  v_mfma_f32_16x16x32_bf16 v[248:251], a[160:163], a[196:199], v[248:251]
  buffer_load_dwordx4 a[24:27], v1, s[8:11], s73 offen offset:1024 sc1
  v_exp_f32 v25, v193
  v_mfma_f32_16x16x32_bf16 v[244:247], a[160:163], a[192:195], v[244:247]
  ds_read_b64_tr_b16 a[182:183], v7 offset:55296
  v_fma_f32 v195, v195, v16, v63
  v_mfma_f32_16x16x32_bf16 v[244:247], a[164:167], a[208:211], v[244:247]
  s_add_u32 s73, s73, 131072
  v_exp_f32 v26, v194
  v_fma_f32 v196, v196, v18, v60
  v_mfma_f32_16x16x32_bf16 v[240:243], a[164:167], a[204:207], v[240:243]
  ds_read_b64_tr_b16 a[164:165], v8 offset:49152
  v_fma_f32 v197, v197, v18, v61
  v_mfma_f32_16x16x32_bf16 v[240:243], a[160:163], a[188:191], v[240:243]
  s_waitcnt vmcnt(8) lgkmcnt(5)
  buffer_load_dwordx4 a[12:15], v1, s[8:11], s73 offen offset:0 sc1
  v_exp_f32 v27, v195
  v_mfma_f32_16x16x32_bf16 v[64:67], a[168:171], a[220:223], 0
  ds_read_b64_tr_b16 a[166:167], v8 offset:51200
  v_fma_f32 v198, v198, v18, v62
  v_mfma_f32_16x16x32_bf16 v[64:67], a[172:175], a[236:239], v[64:67]
  v_exp_f32 v28, v196
  v_mfma_f32_16x16x32_bf16 v[68:71], a[172:175], a[240:243], 0
  ds_read_b64_tr_b16 a[160:161], v8 offset:53248
  v_exp_f32 v29, v197
  v_mfma_f32_16x16x32_bf16 v[68:71], a[168:171], a[224:227], v[68:71]
  buffer_load_dwordx4 a[28:31], v1, s[8:11], s73 offen offset:1024 sc1
  v_exp_f32 v30, v198
  v_mfma_f32_16x16x32_bf16 v[72:75], a[168:171], a[228:231], 0
  ds_read_b64_tr_b16 a[162:163], v8 offset:55296
  v_fma_f32 v199, v199, v18, v63
  v_mfma_f32_16x16x32_bf16 v[72:75], a[172:175], a[244:247], v[72:75]
  v_exp_f32 v31, v199
  v_mul_f32 v208, v192, v208
  v_mfma_f32_16x16x32_bf16 v[76:79], a[172:175], a[248:251], 0
  ds_read_b64_tr_b16 a[172:173], v9 offset:49152
  v_mul_f32 v209, v193, v209
  v_mfma_f32_16x16x32_bf16 v[76:79], a[168:171], a[232:235], v[76:79]
  s_waitcnt lgkmcnt(5)
  buffer_load_dwordx4 a[32:35], v1, s[8:11], s74 offen offset:0 sc1
  v_mul_f32 v210, v194, v210
  v_mul_f32 v211, v195, v211
  v_mfma_f32_16x16x32_bf16 v[92:95], a[176:179], a[232:235], 0
  ds_read_b64_tr_b16 a[174:175], v9 offset:51200
  v_mul_f32 v212, v196, v212
  v_mfma_f32_16x16x32_bf16 v[92:95], a[180:183], a[248:251], v[92:95]
  v_mul_f32 v213, v197, v213
  v_mul_f32 v214, v198, v214
  v_mfma_f32_16x16x32_bf16 v[88:91], a[180:183], a[244:247], 0
  ds_read_b64_tr_b16 a[168:169], v9 offset:53248
  v_mul_f32 v215, v199, v215
  v_fma_f32 v24, v24, v17, v17
  v_mfma_f32_16x16x32_bf16 v[88:91], a[176:179], a[228:231], v[88:91]
  buffer_load_dwordx4 a[48:51], v1, s[8:11], s74 offen offset:1024 sc1
  v_rcp_f32 v24, v24
  v_mfma_f32_16x16x32_bf16 v[84:87], a[176:179], a[224:227], 0
  ds_read_b64_tr_b16 a[170:171], v9 offset:55296
  v_fma_f32 v25, v25, v17, v17
  v_mfma_f32_16x16x32_bf16 v[84:87], a[180:183], a[240:243], v[84:87]
  v_rcp_f32 v25, v25
  v_fma_f32 v26, v26, v17, v17
  v_mfma_f32_16x16x32_bf16 v[80:83], a[180:183], a[236:239], 0
  ds_read_b64_tr_b16 a[180:181], v6 offset:57344
  v_fma_f32 v27, v27, v17, v17
  v_mfma_f32_16x16x32_bf16 v[80:83], a[176:179], a[220:223], v[80:83]
  s_waitcnt lgkmcnt(5)
  s_add_u32 s74, s74, 131072
  v_rcp_f32 v26, v26
  v_mfma_f32_16x16x32_bf16 v[96:99], a[164:167], a[220:223], 0
  ds_read_b64_tr_b16 a[182:183], v6 offset:59392
  v_fma_f32 v28, v28, v19, v19
  v_mfma_f32_16x16x32_bf16 v[96:99], a[160:163], a[236:239], v[96:99]
  buffer_load_dwordx4 a[36:39], v1, s[8:11], s74 offen offset:0 sc1
  v_rcp_f32 v27, v27
  v_mfma_f32_16x16x32_bf16 v[100:103], a[160:163], a[240:243], 0
  ds_read_b64_tr_b16 a[176:177], v6 offset:61440
  v_rcp_f32 v28, v28
  v_mfma_f32_16x16x32_bf16 v[100:103], a[164:167], a[224:227], v[100:103]
  v_fma_f32 v29, v29, v19, v19
  v_fma_f32 v30, v30, v19, v19
  v_mfma_f32_16x16x32_bf16 v[104:107], a[164:167], a[228:231], 0
  ds_read_b64_tr_b16 a[178:179], v6 offset:63488
  v_fma_f32 v31, v31, v19, v19
  v_mfma_f32_16x16x32_bf16 v[104:107], a[160:163], a[244:247], v[104:107]
  buffer_load_dwordx4 a[52:55], v1, s[8:11], s74 offen offset:1024 sc1
  v_rcp_f32 v29, v29
  v_mul_f32 v208, v208, v24
  v_mfma_f32_16x16x32_bf16 v[108:111], a[160:163], a[248:251], 0
  ds_read_b64_tr_b16 a[160:161], v7 offset:57344
  v_mul_f32 v209, v209, v25
  v_mfma_f32_16x16x32_bf16 v[108:111], a[164:167], a[232:235], v[108:111]
  s_waitcnt lgkmcnt(5)
  s_add_u32 s74, s74, s89
  v_rcp_f32 v30, v30
  v_mfma_f32_16x16x32_bf16 v[124:127], a[172:175], a[232:235], 0
  ds_read_b64_tr_b16 a[162:163], v7 offset:59392
  v_mul_f32 v210, v210, v26
  v_mfma_f32_16x16x32_bf16 v[124:127], a[168:171], a[248:251], v[124:127]
  buffer_load_dwordx4 a[40:43], v1, s[8:11], s74 offen offset:0 sc1
  v_rcp_f32 v31, v31
  v_mfma_f32_16x16x32_bf16 v[120:123], a[168:171], a[244:247], 0
  ds_read_b64_tr_b16 a[164:165], v7 offset:61440
  v_mul_f32 v211, v211, v27
  v_mul_f32 v212, v212, v28
  v_mfma_f32_16x16x32_bf16 v[120:123], a[172:175], a[228:231], v[120:123]
  v_mul_f32 v213, v213, v29
  v_mul_f32 v214, v214, v30
  v_mfma_f32_16x16x32_bf16 v[116:119], a[172:175], a[224:227], 0
  ds_read_b64_tr_b16 a[166:167], v7 offset:63488
  v_mul_f32 v215, v215, v31
  v_mfma_f32_16x16x32_bf16 v[116:119], a[168:171], a[240:243], v[116:119]
  buffer_load_dwordx4 a[56:59], v1, s[8:11], s74 offen offset:1024 sc1
  v_cvt_pk_bf16_f32 v192, v208, v209
  v_cvt_pk_bf16_f32 v193, v210, v211
  v_cvt_pk_bf16_f32 v196, v212, v213
  v_mfma_f32_16x16x32_bf16 v[112:115], a[168:171], a[236:239], 0
  ds_read_b64_tr_b16 a[168:169], v8 offset:57344
  v_cvt_pk_bf16_f32 v197, v214, v215
  v_mfma_f32_16x16x32_bf16 v[112:115], a[172:175], a[220:223], v[112:115]
  s_waitcnt lgkmcnt(5)
  v_fma_f32 v200, v200, v20, v60
  v_exp_f32 v24, v200
  v_mfma_f32_16x16x32_bf16 v[128:131], a[180:183], a[220:223], 0
  ds_read_b64_tr_b16 a[170:171], v8 offset:59392
  v_fma_f32 v201, v201, v20, v61
  v_mfma_f32_16x16x32_bf16 v[128:131], a[176:179], a[236:239], v[128:131]
  s_add_u32 s74, s74, 131072
  v_exp_f32 v25, v201
  v_mfma_f32_16x16x32_bf16 v[132:135], a[176:179], a[240:243], 0
  ds_read_b64_tr_b16 a[172:173], v8 offset:61440
  v_fma_f32 v202, v202, v20, v62
  v_fma_f32 v203, v203, v20, v63
  v_mfma_f32_16x16x32_bf16 v[132:135], a[180:183], a[224:227], v[132:135]
  buffer_load_dwordx4 a[44:47], v1, s[8:11], s74 offen offset:0 sc1
  v_exp_f32 v26, v202
  v_mfma_f32_16x16x32_bf16 v[136:139], a[180:183], a[228:231], 0
  ds_read_b64_tr_b16 a[174:175], v8 offset:63488
  v_fma_f32 v204, v204, v22, v60
  v_mfma_f32_16x16x32_bf16 v[136:139], a[176:179], a[244:247], v[136:139]
  v_exp_f32 v27, v203
  v_fma_f32 v205, v205, v22, v61
  v_mfma_f32_16x16x32_bf16 v[140:143], a[176:179], a[248:251], 0
  ds_read_b64_tr_b16 a[176:177], v9 offset:57344
  v_fma_f32 v206, v206, v22, v62
  v_mfma_f32_16x16x32_bf16 v[140:143], a[180:183], a[232:235], v[140:143]
  s_waitcnt lgkmcnt(5)
  buffer_load_dwordx4 a[60:63], v1, s[8:11], s74 offen offset:1024 sc1
  v_exp_f32 v28, v204
  v_mfma_f32_16x16x32_bf16 v[156:159], a[160:163], a[232:235], 0
  ds_read_b64_tr_b16 a[178:179], v9 offset:59392
  v_fma_f32 v207, v207, v22, v63
  v_mfma_f32_16x16x32_bf16 v[156:159], a[164:167], a[248:251], v[156:159]
  v_exp_f32 v29, v205
  v_mfma_f32_16x16x32_bf16 v[152:155], a[164:167], a[244:247], 0
  ds_read_b64_tr_b16 a[180:181], v9 offset:61440
  v_exp_f32 v30, v206
  v_mfma_f32_16x16x32_bf16 v[152:155], a[160:163], a[228:231], v[152:155]
  buffer_load_dwordx4 a[64:67], v1, s[8:11], s75 offen offset:0 sc1
  v_exp_f32 v31, v207
  v_mfma_f32_16x16x32_bf16 v[148:151], a[160:163], a[224:227], 0
  ds_read_b64_tr_b16 a[182:183], v9 offset:63488
  v_mul_f32 v216, v200, v216
  v_mfma_f32_16x16x32_bf16 v[148:151], a[164:167], a[240:243], v[148:151]
  ds_read_b128 v[60:63], v12 offset:704
  v_mul_f32 v217, v201, v217
  v_mul_f32 v218, v202, v218
  v_mfma_f32_16x16x32_bf16 v[144:147], a[164:167], a[236:239], 0
  ds_read_b64_tr_b16 a[164:165], v6 offset:16384
  v_mul_f32 v219, v203, v219
  v_mfma_f32_16x16x32_bf16 v[144:147], a[160:163], a[220:223], v[144:147]
  s_waitcnt lgkmcnt(6)
  buffer_load_dwordx4 a[80:83], v1, s[8:11], s75 offen offset:1024 sc1
  v_mul_f32 v220, v204, v220
  v_mul_f32 v221, v205, v221
  v_mfma_f32_16x16x32_bf16 v[160:163], a[168:171], a[220:223], 0
  ds_read_b64_tr_b16 a[166:167], v6 offset:18432
  v_mul_f32 v222, v206, v222
  v_mfma_f32_16x16x32_bf16 v[160:163], a[172:175], a[236:239], v[160:163]
  v_mul_f32 v223, v207, v223
  v_fma_f32 v24, v24, v21, v21
  v_mfma_f32_16x16x32_bf16 v[164:167], a[172:175], a[240:243], 0
  ds_read_b64_tr_b16 a[160:161], v6 offset:20480
  v_rcp_f32 v24, v24
  v_mfma_f32_16x16x32_bf16 v[164:167], a[168:171], a[224:227], v[164:167]
  s_add_u32 s75, s75, 131072
  v_fma_f32 v25, v25, v21, v21
  v_fma_f32 v26, v26, v21, v21
  v_mfma_f32_16x16x32_bf16 v[168:171], a[168:171], a[228:231], 0
  ds_read_b64_tr_b16 a[162:163], v6 offset:22528
  v_fma_f32 v27, v27, v21, v21
  v_mfma_f32_16x16x32_bf16 v[168:171], a[172:175], a[244:247], v[168:171]
  buffer_load_dwordx4 a[68:71], v1, s[8:11], s75 offen offset:0 sc1
  v_rcp_f32 v25, v25
  v_fma_f32 v28, v28, v23, v23
  v_mfma_f32_16x16x32_bf16 v[172:175], a[172:175], a[248:251], 0
  ds_read_b64_tr_b16 a[172:173], v7 offset:16384
  v_fma_f32 v29, v29, v23, v23
  v_mfma_f32_16x16x32_bf16 v[172:175], a[168:171], a[232:235], v[172:175]
  s_waitcnt lgkmcnt(6)
  v_rcp_f32 v26, v26
  v_fma_f32 v30, v30, v23, v23
  v_mfma_f32_16x16x32_bf16 v[188:191], a[176:179], a[232:235], 0
  ds_read_b64_tr_b16 a[174:175], v7 offset:18432
  v_fma_f32 v31, v31, v23, v23
  v_mfma_f32_16x16x32_bf16 v[188:191], a[180:183], a[248:251], v[188:191]
  buffer_load_dwordx4 a[84:87], v1, s[8:11], s75 offen offset:1024 sc1
  v_rcp_f32 v27, v27
  v_mfma_f32_16x16x32_bf16 v[184:187], a[180:183], a[244:247], 0
  ds_read_b64_tr_b16 a[168:169], v7 offset:20480
  v_rcp_f32 v28, v28
  v_mfma_f32_16x16x32_bf16 v[184:187], a[176:179], a[228:231], v[184:187]
  s_add_u32 s75, s75, s89
  v_rcp_f32 v29, v29
  v_mfma_f32_16x16x32_bf16 v[180:183], a[176:179], a[224:227], 0
  ds_read_b64_tr_b16 a[170:171], v7 offset:22528
  v_mul_f32 v216, v216, v24
  v_mfma_f32_16x16x32_bf16 v[180:183], a[180:183], a[240:243], v[180:183]
  buffer_load_dwordx4 a[72:75], v1, s[8:11], s75 offen offset:0 sc1
  v_rcp_f32 v30, v30
  v_mul_f32 v217, v217, v25
  v_mfma_f32_16x16x32_bf16 v[176:179], a[180:183], a[236:239], 0
  ds_read_b64_tr_b16 a[180:181], v8 offset:16384
  v_mul_f32 v218, v218, v26
  v_mfma_f32_16x16x32_bf16 v[176:179], a[176:179], a[220:223], v[176:179]
  s_waitcnt vmcnt(13) lgkmcnt(5)
  v_rcp_f32 v31, v31
  v_mul_f32 v219, v219, v27
  v_mfma_f32_16x16x32_bf16 v[64:67], a[164:167], a[0:3], v[64:67]
  ds_read_b64_tr_b16 a[182:183], v8 offset:18432
  v_mul_f32 v220, v220, v28
  v_mfma_f32_16x16x32_bf16 v[64:67], a[160:163], a[16:19], v[64:67]
  buffer_load_dwordx4 a[88:91], v1, s[8:11], s75 offen offset:1024 sc1
  v_mul_f32 v221, v221, v29
  v_mul_f32 v222, v222, v30
  v_mfma_f32_16x16x32_bf16 v[68:71], a[160:163], a[20:23], v[68:71]
  ds_read_b64_tr_b16 a[176:177], v8 offset:20480
  v_mul_f32 v223, v223, v31
  v_cvt_pk_bf16_f32 v200, v216, v217
  v_mfma_f32_16x16x32_bf16 v[68:71], a[164:167], a[4:7], v[68:71]
  v_cvt_pk_bf16_f32 v201, v218, v219
  v_cvt_pk_bf16_f32 v204, v220, v221
  v_mfma_f32_16x16x32_bf16 v[72:75], a[164:167], a[8:11], v[72:75]
  ds_read_b64_tr_b16 a[178:179], v8 offset:22528
  v_cvt_pk_bf16_f32 v205, v222, v223
  v_mfma_f32_16x16x32_bf16 v[72:75], a[160:163], a[24:27], v[72:75]
  s_add_u32 s75, s75, 131072
  v_mfma_f32_16x16x32_bf16 v[76:79], a[160:163], a[28:31], v[76:79]
  ds_read_b64_tr_b16 a[160:161], v9 offset:16384
  s_waitcnt lgkmcnt(13)
  v_fma_f32 v224, v224, v16, v60
  v_mfma_f32_16x16x32_bf16 v[76:79], a[164:167], a[12:15], v[76:79]
  s_waitcnt lgkmcnt(5)
  buffer_load_dwordx4 a[76:79], v1, s[8:11], s75 offen offset:0 sc1
  v_exp_f32 v24, v224
  v_mfma_f32_16x16x32_bf16 v[92:95], a[172:175], a[12:15], v[92:95]
  ds_read_b64_tr_b16 a[162:163], v9 offset:18432
  v_fma_f32 v225, v225, v16, v61
  v_fma_f32 v226, v226, v16, v62
  v_mfma_f32_16x16x32_bf16 v[92:95], a[168:171], a[28:31], v[92:95]
  v_exp_f32 v25, v225
  v_fma_f32 v227, v227, v16, v63
  v_mfma_f32_16x16x32_bf16 v[88:91], a[168:171], a[24:27], v[88:91]
  ds_read_b64_tr_b16 a[164:165], v9 offset:20480
  v_fma_f32 v228, v228, v18, v60
  v_mfma_f32_16x16x32_bf16 v[88:91], a[172:175], a[8:11], v[88:91]
  buffer_load_dwordx4 a[92:95], v1, s[8:11], s75 offen offset:1024 sc1
  v_exp_f32 v26, v226
  v_fma_f32 v229, v229, v18, v61
  v_mfma_f32_16x16x32_bf16 v[84:87], a[172:175], a[4:7], v[84:87]
HOP16:
  s_cbranch_execz WRET1
  ds_read_b64_tr_b16 a[166:167], v9 offset:22528
  v_exp_f32 v27, v227
  v_mfma_f32_16x16x32_bf16 v[84:87], a[168:171], a[20:23], v[84:87]
  s_cmp_eq_u32 s91, 1
  s_cselect_b32 s76, 3, 10
  s_lshl_b32 s68, s76, 17
  s_lshl_b32 s76, s76, 11
  s_add_u32 s76, s76, s84
  s_add_u32 m0, s45, 32768
  v_exp_f32 v28, v228
  v_fma_f32 v230, v230, v18, v62
  v_mfma_f32_16x16x32_bf16 v[80:83], a[168:171], a[16:19], v[80:83]
  ds_read_b64_tr_b16 a[168:169], v6 offset:24576
  v_exp_f32 v29, v229
  v_mfma_f32_16x16x32_bf16 v[80:83], a[172:175], a[0:3], v[80:83]
  s_waitcnt lgkmcnt(5)
  buffer_load_dwordx4 v32, s[36:39], s68 offen lds
  v_exp_f32 v30, v230
  v_mfma_f32_16x16x32_bf16 v[96:99], a[180:183], a[0:3], v[96:99]
  ds_read_b64_tr_b16 a[170:171], v6 offset:26624
  v_fma_f32 v231, v231, v18, v63
  v_mfma_f32_16x16x32_bf16 v[96:99], a[176:179], a[16:19], v[96:99]
  s_add_u32 m0, s45, 36864
  s_add_u32 s61, s68, 65536
  v_exp_f32 v31, v231
  v_mfma_f32_16x16x32_bf16 v[100:103], a[176:179], a[20:23], v[100:103]
  ds_read_b64_tr_b16 a[172:173], v6 offset:28672
  v_mul_f32 v240, v224, v240
  v_mul_f32 v241, v225, v241
  v_mfma_f32_16x16x32_bf16 v[100:103], a[180:183], a[4:7], v[100:103]
  buffer_load_dwordx4 v32, s[36:39], s61 offen lds
  v_mul_f32 v242, v226, v242
  v_mul_f32 v243, v227, v243
  v_mul_f32 v244, v228, v244
  v_mfma_f32_16x16x32_bf16 v[104:107], a[180:183], a[8:11], v[104:107]
  ds_read_b64_tr_b16 a[174:175], v6 offset:30720
  v_mul_f32 v245, v229, v245
  v_mul_f32 v246, v230, v246
  v_mfma_f32_16x16x32_bf16 v[104:107], a[176:179], a[24:27], v[104:107]
  v_mul_f32 v247, v231, v247
  v_fma_f32 v24, v24, v17, v17
  v_mfma_f32_16x16x32_bf16 v[108:111], a[176:179], a[28:31], v[108:111]
  ds_read_b64_tr_b16 a[176:177], v7 offset:24576
  v_rcp_f32 v24, v24
  v_mfma_f32_16x16x32_bf16 v[108:111], a[180:183], a[12:15], v[108:111]
  s_waitcnt lgkmcnt(5)
  s_add_u32 m0, s45, 40960
  v_fma_f32 v25, v25, v17, v17
  v_fma_f32 v26, v26, v17, v17
  v_mfma_f32_16x16x32_bf16 v[124:127], a[160:163], a[12:15], v[124:127]
  ds_read_b64_tr_b16 a[178:179], v7 offset:26624
  v_rcp_f32 v25, v25
  v_mfma_f32_16x16x32_bf16 v[124:127], a[164:167], a[28:31], v[124:127]
  buffer_load_dwordx4 v33, s[36:39], s68 offen lds
  v_rcp_f32 v26, v26
  v_fma_f32 v27, v27, v17, v17
  v_mfma_f32_16x16x32_bf16 v[120:123], a[164:167], a[24:27], v[120:123]
  ds_read_b64_tr_b16 a[180:181], v7 offset:28672
  v_fma_f32 v28, v28, v19, v19
  v_mfma_f32_16x16x32_bf16 v[120:123], a[160:163], a[8:11], v[120:123]
  s_add_u32 m0, s45, 45056
  s_add_u32 s61, s68, 65536
  v_rcp_f32 v27, v27
  v_mfma_f32_16x16x32_bf16 v[116:119], a[160:163], a[4:7], v[116:119]
  ds_read_b64_tr_b16 a[182:183], v7 offset:30720
  v_rcp_f32 v28, v28
  v_mfma_f32_16x16x32_bf16 v[116:119], a[164:167], a[20:23], v[116:119]
  buffer_load_dwordx4 v33, s[36:39], s61 offen lds
  v_fma_f32 v29, v29, v19, v19
  v_rcp_f32 v29, v29
  v_mfma_f32_16x16x32_bf16 v[112:115], a[164:167], a[16:19], v[112:115]
  ds_read_b64_tr_b16 a[164:165], v8 offset:24576
  v_fma_f32 v30, v30, v19, v19
  v_fma_f32 v31, v31, v19, v19
  v_mfma_f32_16x16x32_bf16 v[112:115], a[160:163], a[0:3], v[112:115]
  s_waitcnt lgkmcnt(5)
  s_cmp_eq_u32 s91, 2
  s_cselect_b32 s77, 5, 12
  s_lshl_b32 s69, s77, 17
  s_lshl_b32 s77, s77, 11
  s_add_u32 s77, s77, s84
  s_add_u32 m0, s45, 49152
  v_rcp_f32 v30, v30
  v_mfma_f32_16x16x32_bf16 v[128:131], a[168:171], a[0:3], v[128:131]
  ds_read_b64_tr_b16 a[166:167], v8 offset:26624
  v_mul_f32 v240, v240, v24
  v_mfma_f32_16x16x32_bf16 v[128:131], a[172:175], a[16:19], v[128:131]
  buffer_load_dwordx4 v32, s[36:39], s69 offen lds
  v_rcp_f32 v31, v31
  v_mul_f32 v241, v241, v25
  v_mfma_f32_16x16x32_bf16 v[132:135], a[172:175], a[20:23], v[132:135]
  ds_read_b64_tr_b16 a[160:161], v8 offset:28672
  v_mul_f32 v242, v242, v26
  v_mul_f32 v243, v243, v27
  v_mfma_f32_16x16x32_bf16 v[132:135], a[168:171], a[4:7], v[132:135]
  s_add_u32 m0, s45, 53248
  s_add_u32 s61, s69, 65536
  v_mul_f32 v244, v244, v28
  v_mul_f32 v245, v245, v29
  v_mfma_f32_16x16x32_bf16 v[136:139], a[168:171], a[8:11], v[136:139]
  ds_read_b64_tr_b16 a[162:163], v8 offset:30720
  v_mul_f32 v246, v246, v30
  v_mul_f32 v247, v247, v31
  v_mfma_f32_16x16x32_bf16 v[136:139], a[172:175], a[24:27], v[136:139]
  buffer_load_dwordx4 v32, s[36:39], s61 offen lds
  v_cvt_pk_bf16_f32 v194, v240, v241
  v_cvt_pk_bf16_f32 v195, v242, v243
  v_mfma_f32_16x16x32_bf16 v[140:143], a[172:175], a[28:31], v[140:143]
  ds_read_b64_tr_b16 a[172:173], v9 offset:24576
  v_cvt_pk_bf16_f32 v198, v244, v245
  v_cvt_pk_bf16_f32 v199, v246, v247
  v_mfma_f32_16x16x32_bf16 v[140:143], a[168:171], a[12:15], v[140:143]
  s_waitcnt lgkmcnt(5)
  buffer_store_dwordx4 v[192:195], v1, s[8:11], s58 offen offset:1024 sc1
  v_mfma_f32_16x16x32_bf16 v[156:159], a[176:179], a[12:15], v[156:159]
  ds_read_b64_tr_b16 a[174:175], v9 offset:26624
  v_fma_f32 v232, v232, v20, v60
  v_fma_f32 v233, v233, v20, v61
  v_mfma_f32_16x16x32_bf16 v[156:159], a[180:183], a[28:31], v[156:159]
  s_add_u32 m0, s45, 57344
  s_add_u32 s55, s58, 262144
  buffer_store_dwordx4 v[196:199], v1, s[8:11], s55 offen offset:1024 sc1
  v_mfma_f32_16x16x32_bf16 v[152:155], a[180:183], a[24:27], v[152:155]
  ds_read_b64_tr_b16 a[168:169], v9 offset:28672
  v_fma_f32 v234, v234, v20, v62
  v_mfma_f32_16x16x32_bf16 v[152:155], a[176:179], a[8:11], v[152:155]
  buffer_load_dwordx4 v33, s[36:39], s69 offen lds
  v_exp_f32 v24, v232
  v_fma_f32 v235, v235, v20, v63
  v_mfma_f32_16x16x32_bf16 v[148:151], a[176:179], a[4:7], v[148:151]
  ds_read_b64_tr_b16 a[170:171], v9 offset:30720
  v_exp_f32 v25, v233
  v_mfma_f32_16x16x32_bf16 v[148:151], a[180:183], a[20:23], v[148:151]
  v_fma_f32 v236, v236, v22, v60
  s_waitcnt vmcnt(47)
  s_barrier
  v_mfma_f32_16x16x32_bf16 v[144:147], a[180:183], a[16:19], v[144:147]
  ds_read_b64_tr_b16 a[180:181], v6 offset:0
  s_add_u32 m0, s45, 61440
  s_add_u32 s61, s69, 65536
  v_mfma_f32_16x16x32_bf16 v[144:147], a[176:179], a[0:3], v[144:147]
  s_waitcnt lgkmcnt(5)
  buffer_load_dwordx4 v33, s[36:39], s61 offen lds
  v_exp_f32 v26, v234
  v_mfma_f32_16x16x32_bf16 v[160:163], a[164:167], a[0:3], v[160:163]
  ds_read_b64_tr_b16 a[182:183], v6 offset:2048
  v_fma_f32 v237, v237, v22, v61
  v_mfma_f32_16x16x32_bf16 v[160:163], a[160:163], a[16:19], v[160:163]
  v_exp_f32 v27, v235
  v_fma_f32 v238, v238, v22, v62
  v_mfma_f32_16x16x32_bf16 v[164:167], a[160:163], a[20:23], v[164:167]
  ds_read_b64_tr_b16 a[176:177], v6 offset:4096
  v_exp_f32 v28, v236
  v_mfma_f32_16x16x32_bf16 v[164:167], a[164:167], a[4:7], v[164:167]
  buffer_load_dwordx4 a[96:99], v1, s[8:11], s76 offen offset:0 sc1
  v_exp_f32 v29, v237
  v_fma_f32 v239, v239, v22, v63
  v_mfma_f32_16x16x32_bf16 v[168:171], a[164:167], a[8:11], v[168:171]
  ds_read_b64_tr_b16 a[178:179], v6 offset:6144
  v_exp_f32 v30, v238
  v_mfma_f32_16x16x32_bf16 v[168:171], a[160:163], a[24:27], v[168:171]
  v_exp_f32 v31, v239
  v_mfma_f32_16x16x32_bf16 v[172:175], a[160:163], a[28:31], v[172:175]
  ds_read_b64_tr_b16 a[160:161], v7 offset:0
  v_mul_f32 v248, v232, v248
  v_mul_f32 v249, v233, v249
  v_mfma_f32_16x16x32_bf16 v[172:175], a[164:167], a[12:15], v[172:175]
  s_waitcnt lgkmcnt(5)
  buffer_load_dwordx4 a[112:115], v1, s[8:11], s76 offen offset:1024 sc1
  v_mul_f32 v250, v234, v250
  v_mul_f32 v251, v235, v251
  v_mfma_f32_16x16x32_bf16 v[188:191], a[172:175], a[12:15], v[188:191]
  ds_read_b64_tr_b16 a[162:163], v7 offset:2048
  v_mul_f32 v252, v236, v252
  v_mul_f32 v253, v237, v253
  v_mfma_f32_16x16x32_bf16 v[188:191], a[168:171], a[28:31], v[188:191]
  v_mul_f32 v254, v238, v254
  v_mul_f32 v255, v239, v255
  v_fma_f32 v24, v24, v21, v21
  v_mfma_f32_16x16x32_bf16 v[184:187], a[168:171], a[24:27], v[184:187]
  ds_read_b64_tr_b16 a[164:165], v7 offset:4096
  v_fma_f32 v25, v25, v21, v21
  v_mfma_f32_16x16x32_bf16 v[184:187], a[172:175], a[8:11], v[184:187]
  s_add_u32 s76, s76, 131072
  v_rcp_f32 v24, v24
  v_fma_f32 v26, v26, v21, v21
  v_mfma_f32_16x16x32_bf16 v[180:183], a[172:175], a[4:7], v[180:183]
  ds_read_b64_tr_b16 a[166:167], v7 offset:6144
  v_rcp_f32 v25, v25
  v_mfma_f32_16x16x32_bf16 v[180:183], a[168:171], a[20:23], v[180:183]
  buffer_load_dwordx4 a[100:103], v1, s[8:11], s76 offen offset:0 sc1
  v_rcp_f32 v26, v26
  v_fma_f32 v27, v27, v21, v21
  v_mfma_f32_16x16x32_bf16 v[176:179], a[168:171], a[16:19], v[176:179]
  ds_read_b64_tr_b16 a[168:169], v8 offset:0
  v_rcp_f32 v27, v27
  v_mfma_f32_16x16x32_bf16 v[176:179], a[172:175], a[0:3], v[176:179]
  s_waitcnt vmcnt(21) lgkmcnt(5)
  v_fma_f32 v28, v28, v23, v23
  v_rcp_f32 v28, v28
  v_mfma_f32_16x16x32_bf16 v[64:67], a[180:183], a[32:35], v[64:67]
  ds_read_b64_tr_b16 a[170:171], v8 offset:2048
  v_fma_f32 v29, v29, v23, v23
  v_mfma_f32_16x16x32_bf16 v[64:67], a[176:179], a[48:51], v[64:67]
  buffer_load_dwordx4 a[116:119], v1, s[8:11], s76 offen offset:1024 sc1
  v_rcp_f32 v29, v29
  v_fma_f32 v30, v30, v23, v23
  v_mfma_f32_16x16x32_bf16 v[68:71], a[176:179], a[52:55], v[68:71]
  ds_read_b64_tr_b16 a[172:173], v8 offset:4096
  v_rcp_f32 v30, v30
  v_mfma_f32_16x16x32_bf16 v[68:71], a[180:183], a[36:39], v[68:71]
  s_add_u32 s76, s76, s89
  v_fma_f32 v31, v31, v23, v23
  v_rcp_f32 v31, v31
  v_mfma_f32_16x16x32_bf16 v[72:75], a[180:183], a[40:43], v[72:75]
  ds_read_b64_tr_b16 a[174:175], v8 offset:6144
  v_mul_f32 v248, v248, v24
  v_mul_f32 v249, v249, v25
  v_mfma_f32_16x16x32_bf16 v[72:75], a[176:179], a[56:59], v[72:75]
  buffer_load_dwordx4 a[104:107], v1, s[8:11], s76 offen offset:0 sc1
  v_mul_f32 v250, v250, v26
  v_mul_f32 v251, v251, v27
  v_mfma_f32_16x16x32_bf16 v[76:79], a[176:179], a[60:63], v[76:79]
  ds_read_b64_tr_b16 a[176:177], v9 offset:0
  v_mul_f32 v252, v252, v28
  v_mul_f32 v253, v253, v29
  v_mfma_f32_16x16x32_bf16 v[76:79], a[180:183], a[44:47], v[76:79]
  s_waitcnt lgkmcnt(5)
  v_mul_f32 v254, v254, v30
  v_mul_f32 v255, v255, v31
  v_cvt_pk_bf16_f32 v202, v248, v249
  v_mfma_f32_16x16x32_bf16 v[92:95], a[160:163], a[44:47], v[92:95]
  ds_read_b64_tr_b16 a[178:179], v9 offset:2048
  v_cvt_pk_bf16_f32 v203, v250, v251
  v_cvt_pk_bf16_f32 v206, v252, v253
  v_mfma_f32_16x16x32_bf16 v[92:95], a[164:167], a[60:63], v[92:95]
  buffer_load_dwordx4 a[120:123], v1, s[8:11], s76 offen offset:1024 sc1
  s_add_u32 s55, s58, 524288
  buffer_store_dwordx4 v[200:203], v1, s[8:11], s55 offen offset:1024 sc1
  v_mfma_f32_16x16x32_bf16 v[88:91], a[164:167], a[56:59], v[88:91]
  ds_read_b64_tr_b16 a[180:181], v9 offset:4096
  v_cvt_pk_bf16_f32 v207, v254, v255
  v_mfma_f32_16x16x32_bf16 v[88:91], a[160:163], a[40:43], v[88:91]
  s_add_u32 s55, s58, 786432
  buffer_store_dwordx4 v[204:207], v1, s[8:11], s55 offen offset:1024 sc1
  v_mfma_f32_16x16x32_bf16 v[84:87], a[160:163], a[36:39], v[84:87]
  ds_read_b64_tr_b16 a[182:183], v9 offset:6144
  s_sub_u32 s80, s80, 491520
  v_mfma_f32_16x16x32_bf16 v[84:87], a[164:167], a[52:55], v[84:87]
  s_add_u32 s76, s76, 131072
  v_mfma_f32_16x16x32_bf16 v[80:83], a[164:167], a[48:51], v[80:83]
  ds_read_b64_tr_b16 a[164:165], v6 offset:8192
  v_mfma_f32_16x16x32_bf16 v[80:83], a[160:163], a[32:35], v[80:83]
  s_waitcnt lgkmcnt(5)
  buffer_load_dwordx4 a[108:111], v1, s[8:11], s76 offen offset:0 sc1
  v_mfma_f32_16x16x32_bf16 v[96:99], a[168:171], a[32:35], v[96:99]
  ds_read_b64_tr_b16 a[166:167], v6 offset:10240
  v_mfma_f32_16x16x32_bf16 v[96:99], a[172:175], a[48:51], v[96:99]
  v_mfma_f32_16x16x32_bf16 v[100:103], a[172:175], a[52:55], v[100:103]
  ds_read_b64_tr_b16 a[160:161], v6 offset:12288
  v_mfma_f32_16x16x32_bf16 v[100:103], a[168:171], a[36:39], v[100:103]
  buffer_load_dwordx4 a[124:127], v1, s[8:11], s76 offen offset:1024 sc1
  v_mfma_f32_16x16x32_bf16 v[104:107], a[168:171], a[40:43], v[104:107]
  ds_read_b64_tr_b16 a[162:163], v6 offset:14336
  v_mfma_f32_16x16x32_bf16 v[104:107], a[172:175], a[56:59], v[104:107]
  v_mfma_f32_16x16x32_bf16 v[108:111], a[172:175], a[60:63], v[108:111]
  ds_read_b64_tr_b16 a[172:173], v7 offset:8192
  v_mfma_f32_16x16x32_bf16 v[108:111], a[168:171], a[44:47], v[108:111]
  s_waitcnt lgkmcnt(5)
  buffer_load_dwordx4 a[128:131], v1, s[8:11], s77 offen offset:0 sc1
  v_mfma_f32_16x16x32_bf16 v[124:127], a[176:179], a[44:47], v[124:127]
  ds_read_b64_tr_b16 a[174:175], v7 offset:10240
  v_mfma_f32_16x16x32_bf16 v[124:127], a[180:183], a[60:63], v[124:127]
  v_mfma_f32_16x16x32_bf16 v[120:123], a[180:183], a[56:59], v[120:123]
  ds_read_b64_tr_b16 a[168:169], v7 offset:12288
  v_mfma_f32_16x16x32_bf16 v[120:123], a[176:179], a[40:43], v[120:123]
  buffer_load_dwordx4 a[144:147], v1, s[8:11], s77 offen offset:1024 sc1
  v_mfma_f32_16x16x32_bf16 v[116:119], a[176:179], a[36:39], v[116:119]
  ds_read_b64_tr_b16 a[170:171], v7 offset:14336
  v_mfma_f32_16x16x32_bf16 v[116:119], a[180:183], a[52:55], v[116:119]
  v_mfma_f32_16x16x32_bf16 v[112:115], a[180:183], a[48:51], v[112:115]
  ds_read_b64_tr_b16 a[180:181], v8 offset:8192
  v_mfma_f32_16x16x32_bf16 v[112:115], a[176:179], a[32:35], v[112:115]
  s_waitcnt lgkmcnt(5)
  s_add_u32 s77, s77, 131072
  v_mfma_f32_16x16x32_bf16 v[128:131], a[164:167], a[32:35], v[128:131]
  ds_read_b64_tr_b16 a[182:183], v8 offset:10240
  v_mfma_f32_16x16x32_bf16 v[128:131], a[160:163], a[48:51], v[128:131]
  buffer_load_dwordx4 a[132:135], v1, s[8:11], s77 offen offset:0 sc1
  v_mfma_f32_16x16x32_bf16 v[132:135], a[160:163], a[52:55], v[132:135]
  ds_read_b64_tr_b16 a[176:177], v8 offset:12288
  v_mfma_f32_16x16x32_bf16 v[132:135], a[164:167], a[36:39], v[132:135]
  v_mfma_f32_16x16x32_bf16 v[136:139], a[164:167], a[40:43], v[136:139]
  ds_read_b64_tr_b16 a[178:179], v8 offset:14336
  v_mfma_f32_16x16x32_bf16 v[136:139], a[160:163], a[56:59], v[136:139]
  buffer_load_dwordx4 a[148:151], v1, s[8:11], s77 offen offset:1024 sc1
  v_mfma_f32_16x16x32_bf16 v[140:143], a[160:163], a[60:63], v[140:143]
  ds_read_b64_tr_b16 a[160:161], v9 offset:8192
  v_mfma_f32_16x16x32_bf16 v[140:143], a[164:167], a[44:47], v[140:143]
  s_waitcnt lgkmcnt(5)
  s_add_u32 s77, s77, s89
  v_mfma_f32_16x16x32_bf16 v[156:159], a[172:175], a[44:47], v[156:159]
  ds_read_b64_tr_b16 a[162:163], v9 offset:10240
  v_mfma_f32_16x16x32_bf16 v[156:159], a[168:171], a[60:63], v[156:159]
  buffer_load_dwordx4 a[136:139], v1, s[8:11], s77 offen offset:0 sc1
  v_mfma_f32_16x16x32_bf16 v[152:155], a[168:171], a[56:59], v[152:155]
  ds_read_b64_tr_b16 a[164:165], v9 offset:12288
  v_mfma_f32_16x16x32_bf16 v[152:155], a[172:175], a[40:43], v[152:155]
  v_mfma_f32_16x16x32_bf16 v[148:151], a[172:175], a[36:39], v[148:151]
  ds_read_b64_tr_b16 a[166:167], v9 offset:14336
  v_mfma_f32_16x16x32_bf16 v[148:151], a[168:171], a[52:55], v[148:151]
  buffer_load_dwordx4 a[152:155], v1, s[8:11], s77 offen offset:1024 sc1
  v_mfma_f32_16x16x32_bf16 v[144:147], a[168:171], a[48:51], v[144:147]
  ds_read_b64_tr_b16 a[168:169], v2 offset:0
  v_mfma_f32_16x16x32_bf16 v[144:147], a[172:175], a[32:35], v[144:147]
  s_waitcnt lgkmcnt(5)
  v_mfma_f32_16x16x32_bf16 v[160:163], a[180:183], a[32:35], v[160:163]
  ds_read_b64_tr_b16 a[170:171], v2 offset:2048
  v_mfma_f32_16x16x32_bf16 v[160:163], a[176:179], a[48:51], v[160:163]
  s_add_u32 s77, s77, 131072
  v_mfma_f32_16x16x32_bf16 v[164:167], a[176:179], a[52:55], v[164:167]
  ds_read_b64_tr_b16 a[172:173], v2 offset:4096
  v_mfma_f32_16x16x32_bf16 v[164:167], a[180:183], a[36:39], v[164:167]
  buffer_load_dwordx4 a[140:143], v1, s[8:11], s77 offen offset:0 sc1
  v_mfma_f32_16x16x32_bf16 v[168:171], a[180:183], a[40:43], v[168:171]
  ds_read_b64_tr_b16 a[174:175], v2 offset:6144
  v_mfma_f32_16x16x32_bf16 v[168:171], a[176:179], a[56:59], v[168:171]
  v_mfma_f32_16x16x32_bf16 v[172:175], a[176:179], a[60:63], v[172:175]
  ds_read_b64_tr_b16 a[176:177], v3 offset:0
  v_mfma_f32_16x16x32_bf16 v[172:175], a[180:183], a[44:47], v[172:175]
  s_waitcnt lgkmcnt(5)
  buffer_load_dwordx4 a[156:159], v1, s[8:11], s77 offen offset:1024 sc1
  v_mfma_f32_16x16x32_bf16 v[188:191], a[160:163], a[44:47], v[188:191]
  ds_read_b64_tr_b16 a[178:179], v3 offset:2048
  v_mfma_f32_16x16x32_bf16 v[188:191], a[164:167], a[60:63], v[188:191]
  s_cmp_eq_u32 s91, 0
  s_cselect_b32 s78, 7, 0
  s_lshl_b32 s70, s78, 17
  s_lshl_b32 s78, s78, 11
  s_add_u32 s78, s78, s84
  s_add_u32 m0, s45, 16384
  v_mfma_f32_16x16x32_bf16 v[184:187], a[164:167], a[56:59], v[184:187]
  ds_read_b64_tr_b16 a[180:181], v3 offset:4096
  v_mfma_f32_16x16x32_bf16 v[184:187], a[160:163], a[40:43], v[184:187]
  buffer_load_dwordx4 v32, s[36:39], s70 offen lds
  v_mfma_f32_16x16x32_bf16 v[180:183], a[160:163], a[36:39], v[180:183]
  ds_read_b64_tr_b16 a[182:183], v3 offset:6144
  v_mfma_f32_16x16x32_bf16 v[180:183], a[164:167], a[52:55], v[180:183]
  s_add_u32 m0, s45, 20480
  s_add_u32 s61, s70, 65536
  v_mfma_f32_16x16x32_bf16 v[176:179], a[164:167], a[48:51], v[176:179]
  ds_read_b64_tr_b16 a[164:165], v4 offset:0
  v_mfma_f32_16x16x32_bf16 v[176:179], a[160:163], a[32:35], v[176:179]
  s_waitcnt vmcnt(29) lgkmcnt(5)
  buffer_load_dwordx4 v32, s[36:39], s61 offen lds
  v_mfma_f32_16x16x32_bf16 v[64:67], a[168:171], a[64:67], v[64:67]
  ds_read_b64_tr_b16 a[166:167], v4 offset:2048
  v_mfma_f32_16x16x32_bf16 v[64:67], a[172:175], a[80:83], v[64:67]
  v_mfma_f32_16x16x32_bf16 v[68:71], a[172:175], a[84:87], v[68:71]
  ds_read_b64_tr_b16 a[160:161], v4 offset:4096
  v_mfma_f32_16x16x32_bf16 v[68:71], a[168:171], a[68:71], v[68:71]
  s_add_u32 m0, s45, 24576
  v_mfma_f32_16x16x32_bf16 v[72:75], a[168:171], a[72:75], v[72:75]
  ds_read_b64_tr_b16 a[162:163], v4 offset:6144
  v_mfma_f32_16x16x32_bf16 v[72:75], a[172:175], a[88:91], v[72:75]
  buffer_load_dwordx4 v33, s[36:39], s70 offen lds
  v_mfma_f32_16x16x32_bf16 v[76:79], a[172:175], a[92:95], v[76:79]
  ds_read_b64_tr_b16 a[172:173], v5 offset:0
  v_mfma_f32_16x16x32_bf16 v[76:79], a[168:171], a[76:79], v[76:79]
  s_waitcnt lgkmcnt(5)
  s_add_u32 m0, s45, 28672
  s_add_u32 s61, s70, 65536
  v_mfma_f32_16x16x32_bf16 v[92:95], a[176:179], a[76:79], v[92:95]
  ds_read_b64_tr_b16 a[174:175], v5 offset:2048
  v_mfma_f32_16x16x32_bf16 v[92:95], a[180:183], a[92:95], v[92:95]
  buffer_load_dwordx4 v33, s[36:39], s61 offen lds
  v_add_u32 v38, s46, v0
  s_waitcnt vmcnt(14)
  s_barrier
  s_mov_b64 exec, 1
  buffer_store_dword v38, v0, s[8:11], s80 offen offset:0 sc1
  s_mov_b64 exec, -1
  v_mfma_f32_16x16x32_bf16 v[88:91], a[180:183], a[88:91], v[88:91]
  ds_read_b64_tr_b16 a[168:169], v5 offset:4096
  s_lshl_b32 s53, s44, 8
  v_mfma_f32_16x16x32_bf16 v[88:91], a[176:179], a[72:75], v[88:91]
  s_cmp_eq_u32 s91, 1
  s_cselect_b32 s79, 9, 2
  s_lshl_b32 s71, s79, 17
  s_lshl_b32 s79, s79, 11
  s_add_u32 s79, s79, s84
  s_add_u32 m0, s45, 98304
  s_add_u32 s53, s53, 133120
  v_lshrrev_b32 v49, 4, v0
  v_mfma_f32_16x16x32_bf16 v[84:87], a[176:179], a[68:71], v[84:87]
  ds_read_b64_tr_b16 a[170:171], v5 offset:6144
  v_lshl_add_u32 v46, v49, 4, s53
  v_mfma_f32_16x16x32_bf16 v[84:87], a[180:183], a[84:87], v[84:87]
  buffer_load_dwordx4 v32, s[36:39], s71 offen lds
  v_lshlrev_b32 v47, 2, v0
  v_add_u32 v45, s53, v47
  v_mfma_f32_16x16x32_bf16 v[80:83], a[180:183], a[80:83], v[80:83]
  ds_read_b64_tr_b16 a[180:181], v2 offset:8192
  v_lshrrev_b32 v48, 3, v0
  v_mfma_f32_16x16x32_bf16 v[80:83], a[176:179], a[64:67], v[80:83]
  s_waitcnt lgkmcnt(5)
  s_add_u32 m0, s45, 102400
  s_add_u32 s61, s71, 65536
  v_mfma_f32_16x16x32_bf16 v[96:99], a[164:167], a[64:67], v[96:99]
  ds_read_b64_tr_b16 a[182:183], v2 offset:10240
  v_and_b32 v50, 7, v0
  v_mfma_f32_16x16x32_bf16 v[96:99], a[160:163], a[80:83], v[96:99]
  buffer_load_dwordx4 v32, s[36:39], s61 offen lds
  v_xor_b32 v51, v50, v48
  v_lshlrev_b32 v51, 4, v51
  v_mfma_f32_16x16x32_bf16 v[100:103], a[160:163], a[84:87], v[100:103]
  ds_read_b64_tr_b16 a[176:177], v2 offset:12288
  v_lshl_add_u32 v40, v48, 11, v51
  v_mfma_f32_16x16x32_bf16 v[100:103], a[164:167], a[68:71], v[100:103]
  v_bfe_u32 v48, v0, 4, 1
  v_lshrrev_b32 v51, 5, v0
  v_mfma_f32_16x16x32_bf16 v[104:107], a[164:167], a[72:75], v[104:107]
  ds_read_b64_tr_b16 a[178:179], v2 offset:14336
  v_lshl_add_u32 v48, v48, 1, v51
  v_mfma_f32_16x16x32_bf16 v[104:107], a[160:163], a[88:91], v[104:107]
  s_cmp_eq_u32 s91, 2
  s_cselect_b32 s72, 11, 4
  s_lshl_b32 s64, s72, 17
  s_lshl_b32 s72, s72, 11
  s_add_u32 s72, s72, s84
  s_add_u32 m0, s45, 114688
  v_xor_b32 v48, v48, v50
  v_lshlrev_b32 v48, 4, v48
  v_mfma_f32_16x16x32_bf16 v[108:111], a[160:163], a[92:95], v[108:111]
  ds_read_b64_tr_b16 a[160:161], v3 offset:8192
  v_and_b32 v50, 15, v0
  v_mfma_f32_16x16x32_bf16 v[108:111], a[164:167], a[76:79], v[108:111]
  s_waitcnt lgkmcnt(5)
  buffer_load_dwordx4 v32, s[36:39], s64 offen lds
  v_lshl_add_u32 v48, v50, 7, v48
  v_mfma_f32_16x16x32_bf16 v[124:127], a[172:175], a[76:79], v[124:127]
  ds_read_b64_tr_b16 a[162:163], v3 offset:10240
  v_add_u32 v42, s90, v48
  v_mfma_f32_16x16x32_bf16 v[124:127], a[168:171], a[92:95], v[124:127]
  s_add_u32 m0, s45, 118784
  s_add_u32 s61, s64, 65536
  v_xor_b32 v43, 64, v42
  v_mfma_f32_16x16x32_bf16 v[120:123], a[168:171], a[88:91], v[120:123]
  ds_read_b64_tr_b16 a[164:165], v3 offset:12288
  v_add_u32 v44, s90, v1
  v_mfma_f32_16x16x32_bf16 v[120:123], a[172:175], a[72:75], v[120:123]
  buffer_load_dwordx4 v32, s[36:39], s61 offen lds
  v_bfe_u32 v48, v0, 2, 2
  v_lshrrev_b32 v49, 4, v0
  v_mfma_f32_16x16x32_bf16 v[116:119], a[172:175], a[68:71], v[116:119]
  ds_read_b64_tr_b16 a[166:167], v3 offset:14336
  v_and_b32 v50, 1, v0
  v_mfma_f32_16x16x32_bf16 v[116:119], a[168:171], a[84:87], v[116:119]
  s_cmp_eq_u32 s91, 3
  s_cselect_b32 s73, 13, 6
  s_lshl_b32 s65, s73, 17
  s_lshl_b32 s73, s73, 11
  s_add_u32 s73, s73, s84
  s_add_u32 m0, s45, 81920
  v_lshlrev_b32 v50, 4, v50
  v_mov_b32 v51, 0xffff
  v_mfma_f32_16x16x32_bf16 v[112:115], a[168:171], a[80:83], v[112:115]
  ds_read_b64_tr_b16 a[168:169], v4 offset:8192
  v_lshlrev_b32 v50, v50, v51
  v_mfma_f32_16x16x32_bf16 v[112:115], a[172:175], a[64:67], v[112:115]
  s_waitcnt lgkmcnt(5)
  buffer_load_dwordx4 v32, s[36:39], s65 offen lds
  v_cmp_eq_u32 vcc, v48, v49
  v_mov_b32 v60, 0
  v_mov_b32 v61, 0
  v_cndmask_b32 v48, 0, v50, vcc
  v_mfma_f32_16x16x32_bf16 v[128:131], a[180:183], a[64:67], v[128:131]
  ds_read_b64_tr_b16 a[170:171], v4 offset:10240
  v_and_b32 v49, 2, v0
  v_mfma_f32_16x16x32_bf16 v[128:131], a[176:179], a[80:83], v[128:131]
  s_add_u32 m0, s45, 86016
  s_add_u32 s61, s65, 65536
  v_cmp_eq_u32 vcc, 0, v49
  v_mov_b32 v54, 0
  v_mov_b32 v55, 0
  v_cndmask_b32 v50, 0, v48, vcc
  v_mfma_f32_16x16x32_bf16 v[132:135], a[176:179], a[84:87], v[132:135]
  ds_read_b64_tr_b16 a[172:173], v4 offset:12288
  v_sub_u32 v51, v48, v50
  v_mfma_f32_16x16x32_bf16 v[132:135], a[180:183], a[68:71], v[132:135]
  buffer_load_dwordx4 v32, s[36:39], s61 offen lds
  v_mfma_f32_16x16x32_bf16 v[136:139], a[180:183], a[72:75], v[136:139]
  ds_read_b64_tr_b16 a[174:175], v4 offset:14336
  v_mfma_f32_16x16x32_bf16 v[136:139], a[176:179], a[88:91], v[136:139]
  v_mfma_f32_16x16x32_bf16 v[140:143], a[176:179], a[92:95], v[140:143]
  ds_read_b64_tr_b16 a[176:177], v5 offset:8192
  v_mfma_f32_16x16x32_bf16 v[140:143], a[180:183], a[76:79], v[140:143]
  s_waitcnt lgkmcnt(5)
  s_add_u32 m0, s45, 106496
  v_mfma_f32_16x16x32_bf16 v[156:159], a[160:163], a[76:79], v[156:159]
  ds_read_b64_tr_b16 a[178:179], v5 offset:10240
  v_mfma_f32_16x16x32_bf16 v[156:159], a[164:167], a[92:95], v[156:159]
  buffer_load_dwordx4 v33, s[36:39], s71 offen lds
  v_mfma_f32_16x16x32_bf16 v[152:155], a[164:167], a[88:91], v[152:155]
  ds_read_b64_tr_b16 a[180:181], v5 offset:12288
  v_mfma_f32_16x16x32_bf16 v[152:155], a[160:163], a[72:75], v[152:155]
  s_add_u32 m0, s45, 110592
  s_add_u32 s61, s71, 65536
  v_mfma_f32_16x16x32_bf16 v[148:151], a[160:163], a[68:71], v[148:151]
  ds_read_b64_tr_b16 a[182:183], v5 offset:14336
  buffer_load_dwordx4 v33, s[36:39], s61 offen lds
  v_mfma_f32_16x16x32_bf16 v[148:151], a[164:167], a[84:87], v[148:151]
  s_waitcnt vmcnt(31)
  s_barrier
  v_mfma_f32_16x16x32_bf16 v[144:147], a[164:167], a[80:83], v[144:147]
  ds_read_b64_tr_b16 a[164:165], v2 offset:32768
  v_mfma_f32_16x16x32_bf16 v[144:147], a[160:163], a[64:67], v[144:147]
  s_waitcnt lgkmcnt(5)
  s_cmp_eq_u32 s91, 0
  s_cselect_b32 s74, 0, 7
  s_lshl_b32 s66, s74, 17
  s_lshl_b32 s74, s74, 11
  s_add_u32 s74, s74, s84
  s_add_u32 m0, s45, 65536
  v_mfma_f32_16x16x32_bf16 v[160:163], a[168:171], a[64:67], v[160:163]
  ds_read_b64_tr_b16 a[166:167], v2 offset:34816
  v_mfma_f32_16x16x32_bf16 v[160:163], a[172:175], a[80:83], v[160:163]
  buffer_load_dwordx4 v32, s[36:39], s66 offen lds
  v_mfma_f32_16x16x32_bf16 v[164:167], a[172:175], a[84:87], v[164:167]
  ds_read_b64_tr_b16 a[160:161], v2 offset:36864
  v_mfma_f32_16x16x32_bf16 v[164:167], a[168:171], a[68:71], v[164:167]
  s_add_u32 m0, s45, 69632
  s_add_u32 s61, s66, 65536
  v_mfma_f32_16x16x32_bf16 v[168:171], a[168:171], a[72:75], v[168:171]
  ds_read_b64_tr_b16 a[162:163], v2 offset:38912
  v_mfma_f32_16x16x32_bf16 v[168:171], a[172:175], a[88:91], v[168:171]
  buffer_load_dwordx4 v32, s[36:39], s61 offen lds
  v_mfma_f32_16x16x32_bf16 v[172:175], a[172:175], a[92:95], v[172:175]
  ds_read_b64_tr_b16 a[172:173], v3 offset:32768
  v_mfma_f32_16x16x32_bf16 v[172:175], a[168:171], a[76:79], v[172:175]
  s_waitcnt lgkmcnt(5)
  v_mfma_f32_16x16x32_bf16 v[188:191], a[176:179], a[76:79], v[188:191]
  ds_read_b64_tr_b16 a[174:175], v3 offset:34816
  v_mfma_f32_16x16x32_bf16 v[188:191], a[180:183], a[92:95], v[188:191]
  s_add_u32 s62, s88, 0
  v_mfma_f32_16x16x32_bf16 v[184:187], a[180:183], a[88:91], v[184:187]
  ds_read_b64_tr_b16 a[168:169], v3 offset:36864
  v_mfma_f32_16x16x32_bf16 v[184:187], a[176:179], a[72:75], v[184:187]
  buffer_load_dword v240, v47, s[8:11], s62 offen sc1
  v_mfma_f32_16x16x32_bf16 v[180:183], a[176:179], a[68:71], v[180:183]
  ds_read_b64_tr_b16 a[170:171], v3 offset:38912
  v_mfma_f32_16x16x32_bf16 v[180:183], a[180:183], a[84:87], v[180:183]
  s_add_u32 s62, s88, 24576
  v_mfma_f32_16x16x32_bf16 v[176:179], a[180:183], a[80:83], v[176:179]
  ds_read_b64_tr_b16 a[180:181], v4 offset:32768
  v_mfma_f32_16x16x32_bf16 v[176:179], a[176:179], a[64:67], v[176:179]
  s_waitcnt vmcnt(24) lgkmcnt(5)
  buffer_load_dword v241, v47, s[8:11], s62 offen sc1
  v_mfma_f32_16x16x32_bf16 v[64:67], a[164:167], a[96:99], v[64:67]
  ds_read_b64_tr_b16 a[182:183], v4 offset:34816
  v_mfma_f32_16x16x32_bf16 v[64:67], a[160:163], a[112:115], v[64:67]
  s_add_u32 s62, s88, 49152
  v_mfma_f32_16x16x32_bf16 v[68:71], a[160:163], a[116:119], v[68:71]
  ds_read_b64_tr_b16 a[176:177], v4 offset:36864
  v_mfma_f32_16x16x32_bf16 v[68:71], a[164:167], a[100:103], v[68:71]
  buffer_load_dword v242, v47, s[8:11], s62 offen sc1
  v_mfma_f32_16x16x32_bf16 v[72:75], a[164:167], a[104:107], v[72:75]
  ds_read_b64_tr_b16 a[178:179], v4 offset:38912
  v_mfma_f32_16x16x32_bf16 v[72:75], a[160:163], a[120:123], v[72:75]
  s_add_u32 s62, s88, 73728
  v_mfma_f32_16x16x32_bf16 v[76:79], a[160:163], a[124:127], v[76:79]
  ds_read_b64_tr_b16 a[160:161], v5 offset:32768
  v_mfma_f32_16x16x32_bf16 v[76:79], a[164:167], a[108:111], v[76:79]
  s_waitcnt lgkmcnt(5)
  buffer_load_dword v243, v47, s[8:11], s62 offen sc1
  v_mfma_f32_16x16x32_bf16 v[92:95], a[172:175], a[108:111], v[92:95]
  ds_read_b64_tr_b16 a[162:163], v5 offset:34816
  v_mfma_f32_16x16x32_bf16 v[92:95], a[168:171], a[124:127], v[92:95]
  v_mfma_f32_16x16x32_bf16 v[88:91], a[168:171], a[120:123], v[88:91]
  ds_read_b64_tr_b16 a[164:165], v5 offset:36864
  v_mfma_f32_16x16x32_bf16 v[88:91], a[172:175], a[104:107], v[88:91]
  s_cmp_eq_u32 s91, 1
  s_cselect_b32 s75, 2, 9
  s_lshl_b32 s67, s75, 17
  s_lshl_b32 s75, s75, 11
  s_add_u32 s75, s75, s84
  s_add_u32 m0, s45, 0
  v_mfma_f32_16x16x32_bf16 v[84:87], a[172:175], a[100:103], v[84:87]
  ds_read_b64_tr_b16 a[166:167], v5 offset:38912
  v_mfma_f32_16x16x32_bf16 v[84:87], a[168:171], a[116:119], v[84:87]
  buffer_load_dwordx4 v32, s[36:39], s67 offen lds
  v_mfma_f32_16x16x32_bf16 v[80:83], a[168:171], a[112:115], v[80:83]
  ds_read_b64_tr_b16 a[168:169], v2 offset:40960
  v_mfma_f32_16x16x32_bf16 v[80:83], a[172:175], a[96:99], v[80:83]
  s_waitcnt lgkmcnt(5)
  s_add_u32 m0, s45, 4096
HOP17:
  s_cbranch_execz WRET1
  s_add_u32 s61, s67, 65536
  v_mfma_f32_16x16x32_bf16 v[96:99], a[180:183], a[96:99], v[96:99]
  ds_read_b64_tr_b16 a[170:171], v2 offset:43008
  v_mfma_f32_16x16x32_bf16 v[96:99], a[176:179], a[112:115], v[96:99]
  s_sub_u32 s82, s82, 491520
  buffer_load_dwordx4 v32, s[36:39], s61 offen lds
  v_mfma_f32_16x16x32_bf16 v[100:103], a[176:179], a[116:119], v[100:103]
  ds_read_b64_tr_b16 a[172:173], v2 offset:45056
  s_lshl_b32 s83, s44, 28
  s_add_u32 s83, s83, s82
  buffer_load_dword v36, v37, s[8:11], s83 offen sc1
  v_mfma_f32_16x16x32_bf16 v[100:103], a[180:183], a[100:103], v[100:103]
  s_add_u32 m0, s45, 122880
  v_mfma_f32_16x16x32_bf16 v[104:107], a[180:183], a[104:107], v[104:107]
  ds_read_b64_tr_b16 a[174:175], v2 offset:47104
  v_mfma_f32_16x16x32_bf16 v[104:107], a[176:179], a[120:123], v[104:107]
  buffer_load_dwordx4 v33, s[36:39], s64 offen lds
  v_mfma_f32_16x16x32_bf16 v[108:111], a[176:179], a[124:127], v[108:111]
  ds_read_b64_tr_b16 a[176:177], v3 offset:40960
  v_mfma_f32_16x16x32_bf16 v[108:111], a[180:183], a[108:111], v[108:111]
  s_waitcnt lgkmcnt(5)
  s_add_u32 m0, s45, 126976
  s_add_u32 s61, s64, 65536
  v_mfma_f32_16x16x32_bf16 v[124:127], a[160:163], a[108:111], v[124:127]
  ds_read_b64_tr_b16 a[178:179], v3 offset:43008
  v_mfma_f32_16x16x32_bf16 v[124:127], a[164:167], a[124:127], v[124:127]
  buffer_load_dwordx4 v33, s[36:39], s61 offen lds
  v_mfma_f32_16x16x32_bf16 v[120:123], a[164:167], a[120:123], v[120:123]
  ds_read_b64_tr_b16 a[180:181], v3 offset:45056
  v_mfma_f32_16x16x32_bf16 v[120:123], a[160:163], a[104:107], v[120:123]
  v_mfma_f32_16x16x32_bf16 v[116:119], a[160:163], a[100:103], v[116:119]
  ds_read_b64_tr_b16 a[182:183], v3 offset:47104
  v_mfma_f32_16x16x32_bf16 v[116:119], a[164:167], a[116:119], v[116:119]
  s_add_u32 m0, s45, 90112
  v_mfma_f32_16x16x32_bf16 v[112:115], a[164:167], a[112:115], v[112:115]
  ds_read_b64_tr_b16 a[164:165], v4 offset:40960
  v_mfma_f32_16x16x32_bf16 v[112:115], a[160:163], a[96:99], v[112:115]
  s_waitcnt lgkmcnt(5)
  buffer_load_dwordx4 v33, s[36:39], s65 offen lds
  v_mfma_f32_16x16x32_bf16 v[128:131], a[168:171], a[96:99], v[128:131]
  ds_read_b64_tr_b16 a[166:167], v4 offset:43008
  v_mfma_f32_16x16x32_bf16 v[128:131], a[172:175], a[112:115], v[128:131]
  s_add_u32 m0, s45, 94208
  s_add_u32 s61, s65, 65536
  v_mfma_f32_16x16x32_bf16 v[132:135], a[172:175], a[116:119], v[132:135]
  ds_read_b64_tr_b16 a[160:161], v4 offset:45056
  v_mfma_f32_16x16x32_bf16 v[132:135], a[168:171], a[100:103], v[132:135]
  buffer_load_dwordx4 v33, s[36:39], s61 offen lds
  v_mfma_f32_16x16x32_bf16 v[136:139], a[168:171], a[104:107], v[136:139]
  ds_read_b64_tr_b16 a[162:163], v4 offset:47104
  v_mfma_f32_16x16x32_bf16 v[136:139], a[172:175], a[120:123], v[136:139]
  s_add_u32 m0, s45, 73728
  v_mfma_f32_16x16x32_bf16 v[140:143], a[172:175], a[124:127], v[140:143]
  ds_read_b64_tr_b16 a[172:173], v5 offset:40960
  v_mfma_f32_16x16x32_bf16 v[140:143], a[168:171], a[108:111], v[140:143]
  s_waitcnt lgkmcnt(5)
  buffer_load_dwordx4 v33, s[36:39], s66 offen lds
  v_mfma_f32_16x16x32_bf16 v[156:159], a[176:179], a[108:111], v[156:159]
  ds_read_b64_tr_b16 a[174:175], v5 offset:43008
  v_mfma_f32_16x16x32_bf16 v[156:159], a[180:183], a[124:127], v[156:159]
  s_add_u32 m0, s45, 77824
  s_add_u32 s61, s66, 65536
  v_mfma_f32_16x16x32_bf16 v[152:155], a[180:183], a[120:123], v[152:155]
  ds_read_b64_tr_b16 a[168:169], v5 offset:45056
  v_mfma_f32_16x16x32_bf16 v[152:155], a[176:179], a[104:107], v[152:155]
  buffer_load_dwordx4 v33, s[36:39], s61 offen lds
  v_mfma_f32_16x16x32_bf16 v[148:151], a[176:179], a[100:103], v[148:151]
  ds_read_b64_tr_b16 a[170:171], v5 offset:47104
  v_mfma_f32_16x16x32_bf16 v[148:151], a[180:183], a[116:119], v[148:151]
  v_mfma_f32_16x16x32_bf16 v[144:147], a[180:183], a[112:115], v[144:147]
  ds_read_b64_tr_b16 a[180:181], v2 offset:49152
  v_mfma_f32_16x16x32_bf16 v[144:147], a[176:179], a[96:99], v[144:147]
  s_waitcnt lgkmcnt(5)
  v_mfma_f32_16x16x32_bf16 v[160:163], a[164:167], a[96:99], v[160:163]
  ds_read_b64_tr_b16 a[182:183], v2 offset:51200
  v_mfma_f32_16x16x32_bf16 v[160:163], a[160:163], a[112:115], v[160:163]
  v_mfma_f32_16x16x32_bf16 v[164:167], a[160:163], a[116:119], v[164:167]
  ds_read_b64_tr_b16 a[176:177], v2 offset:53248
  v_mfma_f32_16x16x32_bf16 v[164:167], a[164:167], a[100:103], v[164:167]
  v_mfma_f32_16x16x32_bf16 v[168:171], a[164:167], a[104:107], v[168:171]
  ds_read_b64_tr_b16 a[178:179], v2 offset:55296
  v_mfma_f32_16x16x32_bf16 v[168:171], a[160:163], a[120:123], v[168:171]
  v_mfma_f32_16x16x32_bf16 v[172:175], a[160:163], a[124:127], v[172:175]
  ds_read_b64_tr_b16 a[160:161], v3 offset:49152
  v_mfma_f32_16x16x32_bf16 v[172:175], a[164:167], a[108:111], v[172:175]
  s_waitcnt lgkmcnt(5)
  v_mfma_f32_16x16x32_bf16 v[188:191], a[172:175], a[108:111], v[188:191]
  ds_read_b64_tr_b16 a[162:163], v3 offset:51200
  v_mfma_f32_16x16x32_bf16 v[188:191], a[168:171], a[124:127], v[188:191]
  v_mfma_f32_16x16x32_bf16 v[184:187], a[168:171], a[120:123], v[184:187]
  ds_read_b64_tr_b16 a[164:165], v3 offset:53248
  s_waitcnt vmcnt(6)
  s_cmp_lg_u32 s44, 0
  s_cbranch_scc1 PL13_adaLN_cond__sliding_local_dilated__swiglu_ffn__prompt_kernelx
  v_cmp_ne_u32 vcc, s46, v36
  s_nop 4
  s_cbranch_vccz PL13_adaLN_cond__sliding_local_dilated__swiglu_ffn__prompt_kernelx
  s_mov_b32 s83, 60000
PL13_adaLN_cond__sliding_local_dilated__swiglu_ffn__prompt_kernel:
  buffer_load_dword v36, v37, s[8:11], s82 offen sc1
  s_sub_u32 s83, s83, 1
  s_cmp_eq_u32 s83, 0
  s_waitcnt vmcnt(0)
  s_cbranch_scc1 PL13_adaLN_cond__sliding_local_dilated__swiglu_ffn__prompt_kernelx
  v_cmp_ne_u32 vcc, s46, v36
  s_nop 4
  s_cbranch_vccnz PL13_adaLN_cond__sliding_local_dilated__swiglu_ffn__prompt_kernel
PL13_adaLN_cond__sliding_local_dilated__swiglu_ffn__prompt_kernelx:
  s_barrier
  v_mfma_f32_16x16x32_bf16 v[184:187], a[172:175], a[104:107], v[184:187]
  v_mfma_f32_16x16x32_bf16 v[180:183], a[172:175], a[100:103], v[180:183]
  ds_read_b64_tr_b16 a[166:167], v3 offset:55296
  v_mfma_f32_16x16x32_bf16 v[180:183], a[168:171], a[116:119], v[180:183]
  buffer_load_dwordx4 a[188:191], v1, s[8:11], s78 offen offset:0 sc1
  v_mfma_f32_16x16x32_bf16 v[176:179], a[168:171], a[112:115], v[176:179]
  ds_read_b64_tr_b16 a[168:169], v4 offset:49152
  v_mfma_f32_16x16x32_bf16 v[176:179], a[172:175], a[96:99], v[176:179]
  s_waitcnt vmcnt(29) lgkmcnt(5)
  v_mfma_f32_16x16x32_bf16 v[64:67], a[180:183], a[128:131], v[64:67]
  ds_read_b64_tr_b16 a[170:171], v4 offset:51200
  v_mfma_f32_16x16x32_bf16 v[64:67], a[176:179], a[144:147], v[64:67]
  buffer_load_dwordx4 a[204:207], v1, s[8:11], s78 offen offset:1024 sc1
  v_mfma_f32_16x16x32_bf16 v[68:71], a[176:179], a[148:151], v[68:71]
  ds_read_b64_tr_b16 a[172:173], v4 offset:53248
  v_mfma_f32_16x16x32_bf16 v[68:71], a[180:183], a[132:135], v[68:71]
  s_add_u32 s78, s78, 131072
  v_mfma_f32_16x16x32_bf16 v[72:75], a[180:183], a[136:139], v[72:75]
  ds_read_b64_tr_b16 a[174:175], v4 offset:55296
  v_mfma_f32_16x16x32_bf16 v[72:75], a[176:179], a[152:155], v[72:75]
  buffer_load_dwordx4 a[192:195], v1, s[8:11], s78 offen offset:0 sc1
  v_mfma_f32_16x16x32_bf16 v[76:79], a[176:179], a[156:159], v[76:79]
  ds_read_b64_tr_b16 a[176:177], v5 offset:49152
  v_mfma_f32_16x16x32_bf16 v[76:79], a[180:183], a[140:143], v[76:79]
  s_waitcnt lgkmcnt(5)
  v_mfma_f32_16x16x32_bf16 v[92:95], a[160:163], a[140:143], v[92:95]
  ds_read_b64_tr_b16 a[178:179], v5 offset:51200
  v_mfma_f32_16x16x32_bf16 v[92:95], a[164:167], a[156:159], v[92:95]
  v_mfma_f32_16x16x32_bf16 v[88:91], a[164:167], a[152:155], v[88:91]
  ds_read_b64_tr_b16 a[180:181], v5 offset:53248
  v_mfma_f32_16x16x32_bf16 v[88:91], a[160:163], a[136:139], v[88:91]
  buffer_load_dwordx4 a[208:211], v1, s[8:11], s78 offen offset:1024 sc1
  v_mfma_f32_16x16x32_bf16 v[84:87], a[160:163], a[132:135], v[84:87]
  ds_read_b64_tr_b16 a[182:183], v5 offset:55296
  v_mfma_f32_16x16x32_bf16 v[84:87], a[164:167], a[148:151], v[84:87]
  s_add_u32 s78, s78, s89
  v_mfma_f32_16x16x32_bf16 v[80:83], a[164:167], a[144:147], v[80:83]
  ds_read_b64_tr_b16 a[164:165], v2 offset:57344
  v_mfma_f32_16x16x32_bf16 v[80:83], a[160:163], a[128:131], v[80:83]
  s_waitcnt lgkmcnt(5)
  buffer_load_dwordx4 a[196:199], v1, s[8:11], s78 offen offset:0 sc1
  v_mfma_f32_16x16x32_bf16 v[96:99], a[168:171], a[128:131], v[96:99]
  ds_read_b64_tr_b16 a[166:167], v2 offset:59392
  v_mfma_f32_16x16x32_bf16 v[96:99], a[172:175], a[144:147], v[96:99]
  v_mfma_f32_16x16x32_bf16 v[100:103], a[172:175], a[148:151], v[100:103]
  ds_read_b64_tr_b16 a[160:161], v2 offset:61440
  v_mfma_f32_16x16x32_bf16 v[100:103], a[168:171], a[132:135], v[100:103]
  buffer_load_dwordx4 a[212:215], v1, s[8:11], s78 offen offset:1024 sc1
  v_mfma_f32_16x16x32_bf16 v[104:107], a[168:171], a[136:139], v[104:107]
  ds_read_b64_tr_b16 a[162:163], v2 offset:63488
  v_mfma_f32_16x16x32_bf16 v[104:107], a[172:175], a[152:155], v[104:107]
  s_add_u32 s78, s78, 131072
  v_mfma_f32_16x16x32_bf16 v[108:111], a[172:175], a[156:159], v[108:111]
  ds_read_b64_tr_b16 a[172:173], v3 offset:57344
  v_mfma_f32_16x16x32_bf16 v[108:111], a[168:171], a[140:143], v[108:111]
  s_waitcnt lgkmcnt(5)
  buffer_load_dwordx4 a[200:203], v1, s[8:11], s78 offen offset:0 sc1
  v_mfma_f32_16x16x32_bf16 v[124:127], a[176:179], a[140:143], v[124:127]
  ds_read_b64_tr_b16 a[174:175], v3 offset:59392
  v_mfma_f32_16x16x32_bf16 v[124:127], a[180:183], a[156:159], v[124:127]
  v_mfma_f32_16x16x32_bf16 v[120:123], a[180:183], a[152:155], v[120:123]
  ds_read_b64_tr_b16 a[168:169], v3 offset:61440
  v_mfma_f32_16x16x32_bf16 v[120:123], a[176:179], a[136:139], v[120:123]
  v_mfma_f32_16x16x32_bf16 v[116:119], a[176:179], a[132:135], v[116:119]
  ds_read_b64_tr_b16 a[170:171], v3 offset:63488
  v_mfma_f32_16x16x32_bf16 v[116:119], a[180:183], a[148:151], v[116:119]
  buffer_load_dwordx4 a[216:219], v1, s[8:11], s78 offen offset:1024 sc1
  v_mfma_f32_16x16x32_bf16 v[112:115], a[180:183], a[144:147], v[112:115]
  ds_read_b64_tr_b16 a[180:181], v4 offset:57344
  v_mfma_f32_16x16x32_bf16 v[112:115], a[176:179], a[128:131], v[112:115]
  s_waitcnt lgkmcnt(5)
  v_mfma_f32_16x16x32_bf16 v[128:131], a[164:167], a[128:131], v[128:131]
  ds_read_b64_tr_b16 a[182:183], v4 offset:59392
  v_mfma_f32_16x16x32_bf16 v[128:131], a[160:163], a[144:147], v[128:131]
  buffer_load_dwordx4 a[220:223], v1, s[8:11], s79 offen offset:0 sc1
  v_mfma_f32_16x16x32_bf16 v[132:135], a[160:163], a[148:151], v[132:135]
  ds_read_b64_tr_b16 a[176:177], v4 offset:61440
  v_mfma_f32_16x16x32_bf16 v[132:135], a[164:167], a[132:135], v[132:135]
  v_mfma_f32_16x16x32_bf16 v[136:139], a[164:167], a[136:139], v[136:139]
  ds_read_b64_tr_b16 a[178:179], v4 offset:63488
  v_mfma_f32_16x16x32_bf16 v[136:139], a[160:163], a[152:155], v[136:139]
  buffer_load_dwordx4 a[236:239], v1, s[8:11], s79 offen offset:1024 sc1
  v_mfma_f32_16x16x32_bf16 v[140:143], a[160:163], a[156:159], v[140:143]
  ds_read_b64_tr_b16 a[160:161], v5 offset:57344
  v_mfma_f32_16x16x32_bf16 v[140:143], a[164:167], a[140:143], v[140:143]
  s_waitcnt lgkmcnt(5)
  s_add_u32 s79, s79, 131072
  v_mfma_f32_16x16x32_bf16 v[156:159], a[172:175], a[140:143], v[156:159]
  ds_read_b64_tr_b16 a[162:163], v5 offset:59392
  v_mfma_f32_16x16x32_bf16 v[156:159], a[168:171], a[156:159], v[156:159]
  buffer_load_dwordx4 a[224:227], v1, s[8:11], s79 offen offset:0 sc1
  ds_read_b128 v[192:195], v44 offset:0
  v_mfma_f32_16x16x32_bf16 v[152:155], a[168:171], a[152:155], v[152:155]
  ds_read_b64_tr_b16 a[164:165], v5 offset:61440
  v_mfma_f32_16x16x32_bf16 v[152:155], a[172:175], a[136:139], v[152:155]
  ds_read_b128 v[196:199], v44 offset:1024
  v_mfma_f32_16x16x32_bf16 v[148:151], a[172:175], a[132:135], v[148:151]
  ds_read_b64_tr_b16 a[166:167], v5 offset:63488
  v_mfma_f32_16x16x32_bf16 v[148:151], a[168:171], a[148:151], v[148:151]
  s_waitcnt vmcnt(35)
  s_barrier
  v_mfma_f32_16x16x32_bf16 v[144:147], a[168:171], a[144:147], v[144:147]
  ds_read_b64_tr_b16 a[168:169], v2 offset:16384
  v_mfma_f32_16x16x32_bf16 v[144:147], a[172:175], a[128:131], v[144:147]
  s_waitcnt lgkmcnt(7)
  buffer_load_dwordx4 a[240:243], v1, s[8:11], s79 offen offset:1024 sc1
  v_mfma_f32_16x16x32_bf16 v[160:163], a[180:183], a[128:131], v[160:163]
  ds_read_b64_tr_b16 a[170:171], v2 offset:18432
  ds_read_b128 v[200:203], v44 offset:2048
  v_mfma_f32_16x16x32_bf16 v[160:163], a[176:179], a[144:147], v[160:163]
  s_add_u32 s79, s79, s89
  ds_read_b128 v[204:207], v44 offset:3072
  v_mfma_f32_16x16x32_bf16 v[164:167], a[176:179], a[148:151], v[164:167]
  ds_read_b64_tr_b16 a[172:173], v2 offset:20480
  s_waitcnt vmcnt(21)
  v_mfma_f32_16x16x32_bf16 v[164:167], a[180:183], a[132:135], v[164:167]
  buffer_load_dwordx4 a[228:231], v1, s[8:11], s79 offen offset:0 sc1
  v_add_f32 v240, v240, v241
  v_add_f32 v242, v242, v243
  v_mfma_f32_16x16x32_bf16 v[168:171], a[180:183], a[136:139], v[168:171]
  ds_read_b64_tr_b16 a[174:175], v2 offset:22528
  v_add_f32 v240, v240, v242
  v_mfma_f32_16x16x32_bf16 v[168:171], a[176:179], a[152:155], v[168:171]
  v_cvt_pk_bf16_f32 v240, v240, v240
  v_lshlrev_b32 v240, 16, v240
  v_mfma_f32_16x16x32_bf16 v[172:175], a[176:179], a[156:159], v[172:175]
  ds_read_b64_tr_b16 a[176:177], v3 offset:16384
  v_mfma_f32_16x16x32_bf16 v[172:175], a[180:183], a[140:143], v[172:175]
  s_waitcnt lgkmcnt(7)
  buffer_load_dwordx4 a[244:247], v1, s[8:11], s79 offen offset:1024 sc1
  v_mfma_f32_16x16x32_bf16 v[188:191], a[160:163], a[140:143], v[188:191]
  ds_read_b64_tr_b16 a[178:179], v3 offset:18432
  v_mfma_f32_16x16x32_bf16 v[188:191], a[164:167], a[156:159], v[188:191]
  s_add_u32 s79, s79, 131072
  ds_write_b32 v45, v240
  v_mfma_f32_16x16x32_bf16 v[184:187], a[164:167], a[152:155], v[184:187]
  ds_read_b64_tr_b16 a[180:181], v3 offset:20480
  v_mfma_f32_16x16x32_bf16 v[184:187], a[160:163], a[136:139], v[184:187]
  buffer_load_dwordx4 a[232:235], v1, s[8:11], s79 offen offset:0 sc1
  ds_read_b128 v[240:243], v46 offset:0
  v_mfma_f32_16x16x32_bf16 v[180:183], a[160:163], a[132:135], v[180:183]
  ds_read_b64_tr_b16 a[182:183], v3 offset:22528
  v_mfma_f32_16x16x32_bf16 v[180:183], a[164:167], a[148:151], v[180:183]
  ds_read_b128 v[244:247], v46 offset:64
  v_mfma_f32_16x16x32_bf16 v[176:179], a[164:167], a[144:147], v[176:179]
  ds_read_b64_tr_b16 a[164:165], v4 offset:16384
  v_mfma_f32_16x16x32_bf16 v[176:179], a[160:163], a[128:131], v[176:179]
  s_waitcnt vmcnt(7) lgkmcnt(8)
  ds_read_b128 v[248:251], v46 offset:128
  v_mfma_f32_16x16x32_bf16 v[64:67], a[168:171], a[188:191], v[64:67]
  ds_read_b64_tr_b16 a[166:167], v4 offset:18432
  v_mfma_f32_16x16x32_bf16 v[64:67], a[172:175], a[204:207], v[64:67]
  buffer_load_dwordx4 a[248:251], v1, s[8:11], s79 offen offset:1024 sc1
  ds_read_b128 v[252:255], v46 offset:192
  v_mfma_f32_16x16x32_bf16 v[68:71], a[172:175], a[208:211], v[68:71]
  ds_read_b64_tr_b16 a[160:161], v4 offset:20480
  s_waitcnt lgkmcnt(14)
  v_mfma_f32_16x16x32_bf16 v[68:71], a[168:171], a[192:195], v[68:71]
  v_lshlrev_b32 v208, 16, v192
  v_and_b32 v209, 0xffff0000, v192
  v_mfma_f32_16x16x32_bf16 v[72:75], a[168:171], a[196:199], v[72:75]
  ds_read_b64_tr_b16 a[162:163], v4 offset:22528
  v_lshlrev_b32 v210, 16, v193
  v_mfma_f32_16x16x32_bf16 v[72:75], a[172:175], a[212:215], v[72:75]
  buffer_load_dwordx4 a[0:3], v1, s[8:11], s72 offen offset:0 sc1
  v_and_b32 v211, 0xffff0000, v193
  v_lshlrev_b32 v212, 16, v194
  v_mfma_f32_16x16x32_bf16 v[76:79], a[172:175], a[216:219], v[76:79]
  ds_read_b64_tr_b16 a[172:173], v5 offset:16384
  v_and_b32 v213, 0xffff0000, v194
  v_mfma_f32_16x16x32_bf16 v[76:79], a[168:171], a[200:203], v[76:79]
  s_waitcnt lgkmcnt(8)
  v_lshlrev_b32 v214, 16, v195
  v_and_b32 v215, 0xffff0000, v195
  v_mfma_f32_16x16x32_bf16 v[92:95], a[176:179], a[200:203], v[92:95]
  ds_read_b64_tr_b16 a[174:175], v5 offset:18432
  v_lshlrev_b32 v216, 16, v196
  v_mfma_f32_16x16x32_bf16 v[92:95], a[180:183], a[216:219], v[92:95]
  buffer_load_dwordx4 a[16:19], v1, s[8:11], s72 offen offset:1024 sc1
  v_and_b32 v217, 0xffff0000, v196
  v_lshlrev_b32 v218, 16, v197
  v_mfma_f32_16x16x32_bf16 v[88:91], a[180:183], a[212:215], v[88:91]
  ds_read_b64_tr_b16 a[168:169], v5 offset:20480
  v_and_b32 v219, 0xffff0000, v197
  v_mfma_f32_16x16x32_bf16 v[88:91], a[176:179], a[196:199], v[88:91]
  s_add_u32 s72, s72, 131072
  v_lshlrev_b32 v220, 16, v198
  v_and_b32 v221, 0xffff0000, v198
  v_mfma_f32_16x16x32_bf16 v[84:87], a[176:179], a[192:195], v[84:87]
  ds_read_b64_tr_b16 a[170:171], v5 offset:22528
  v_lshlrev_b32 v222, 16, v199
  v_mfma_f32_16x16x32_bf16 v[84:87], a[180:183], a[208:211], v[84:87]
  buffer_load_dwordx4 a[4:7], v1, s[8:11], s72 offen offset:0 sc1
  v_and_b32 v223, 0xffff0000, v199
  v_lshlrev_b32 v224, 16, v200
  v_mfma_f32_16x16x32_bf16 v[80:83], a[180:183], a[204:207], v[80:83]
  ds_read_b64_tr_b16 a[180:181], v2 offset:24576
  v_and_b32 v225, 0xffff0000, v200
  v_mfma_f32_16x16x32_bf16 v[80:83], a[176:179], a[188:191], v[80:83]
  s_waitcnt lgkmcnt(5)
  v_lshlrev_b32 v226, 16, v201
  v_and_b32 v227, 0xffff0000, v201
  v_mfma_f32_16x16x32_bf16 v[96:99], a[164:167], a[188:191], v[96:99]
  ds_read_b64_tr_b16 a[182:183], v2 offset:26624
  v_lshlrev_b32 v228, 16, v202
  v_mfma_f32_16x16x32_bf16 v[96:99], a[160:163], a[204:207], v[96:99]
  v_and_b32 v229, 0xffff0000, v202
  v_lshlrev_b32 v230, 16, v203
  v_mfma_f32_16x16x32_bf16 v[100:103], a[160:163], a[208:211], v[100:103]
  ds_read_b64_tr_b16 a[176:177], v2 offset:28672
  v_and_b32 v231, 0xffff0000, v203
  v_mfma_f32_16x16x32_bf16 v[100:103], a[164:167], a[192:195], v[100:103]
  buffer_load_dwordx4 a[20:23], v1, s[8:11], s72 offen offset:1024 sc1
  v_lshlrev_b32 v232, 16, v204
  v_and_b32 v233, 0xffff0000, v204
  v_mfma_f32_16x16x32_bf16 v[104:107], a[164:167], a[196:199], v[104:107]
  ds_read_b64_tr_b16 a[178:179], v2 offset:30720
  v_lshlrev_b32 v234, 16, v205
  v_mfma_f32_16x16x32_bf16 v[104:107], a[160:163], a[212:215], v[104:107]
  s_add_u32 s72, s72, s89
  v_and_b32 v235, 0xffff0000, v205
  v_lshlrev_b32 v236, 16, v206
  v_mfma_f32_16x16x32_bf16 v[108:111], a[160:163], a[216:219], v[108:111]
  ds_read_b64_tr_b16 a[160:161], v3 offset:24576
  v_and_b32 v237, 0xffff0000, v206
  v_mfma_f32_16x16x32_bf16 v[108:111], a[164:167], a[200:203], v[108:111]
  s_waitcnt lgkmcnt(5)
  buffer_load_dwordx4 a[8:11], v1, s[8:11], s72 offen offset:0 sc1
  v_lshlrev_b32 v238, 16, v207
  v_mfma_f32_16x16x32_bf16 v[124:127], a[172:175], a[200:203], v[124:127]
  ds_read_b64_tr_b16 a[162:163], v3 offset:26624
  v_and_b32 v239, 0xffff0000, v207
  v_mfma_f32_16x16x32_bf16 v[124:127], a[168:171], a[216:219], v[124:127]
  v_mov_b32 v37, 0
  s_waitcnt lgkmcnt(12)
  v_mfma_f32_16x16x32_bf16 v[120:123], a[168:171], a[212:215], v[120:123]
  ds_read_b64_tr_b16 a[164:165], v3 offset:28672
  v_cvt_pk_bf16_f32 v52, v240, v241
  v_mfma_f32_16x16x32_bf16 v[120:123], a[172:175], a[196:199], v[120:123]
  buffer_load_dwordx4 a[24:27], v1, s[8:11], s72 offen offset:1024 sc1
  v_and_b32 v52, v52, v50
  v_cvt_pk_bf16_f32 v53, v242, v243
  v_mfma_f32_16x16x32_bf16 v[116:119], a[172:175], a[192:195], v[116:119]
  ds_read_b64_tr_b16 a[166:167], v3 offset:30720
  v_and_b32 v53, v53, v51
  v_mfma_f32_16x16x32_bf16 v[116:119], a[168:171], a[208:211], v[116:119]
  s_add_u32 s72, s72, 131072
  v_cvt_pk_bf16_f32 v56, v244, v245
  v_and_b32 v56, v56, v50
  v_mfma_f32_16x16x32_bf16 v[112:115], a[168:171], a[204:207], v[112:115]
  ds_read_b64_tr_b16 a[168:169], v4 offset:24576
  v_cvt_pk_bf16_f32 v57, v246, v247
  v_mfma_f32_16x16x32_bf16 v[112:115], a[172:175], a[188:191], v[112:115]
  s_waitcnt lgkmcnt(5)
  buffer_load_dwordx4 a[12:15], v1, s[8:11], s72 offen offset:0 sc1
  v_and_b32 v57, v57, v51
  v_mfma_f32_16x16x32_bf16 v[128:131], a[180:183], a[188:191], v[128:131]
  ds_read_b64_tr_b16 a[170:171], v4 offset:26624
  v_cvt_pk_bf16_f32 v58, v248, v249
  v_mfma_f32_16x16x32_bf16 v[128:131], a[176:179], a[204:207], v[128:131]
  v_and_b32 v58, v58, v50
  v_cvt_pk_bf16_f32 v59, v250, v251
  v_mfma_f32_16x16x32_bf16 v[132:135], a[176:179], a[208:211], v[132:135]
  ds_read_b64_tr_b16 a[172:173], v4 offset:28672
  v_and_b32 v59, v59, v51
  v_mfma_f32_16x16x32_bf16 v[132:135], a[180:183], a[192:195], v[132:135]
  v_cvt_pk_bf16_f32 v62, v252, v253
  v_and_b32 v62, v62, v50
  v_mfma_f32_16x16x32_bf16 v[136:139], a[180:183], a[196:199], v[136:139]
  ds_read_b64_tr_b16 a[174:175], v4 offset:30720
  v_cvt_pk_bf16_f32 v63, v254, v255
  v_mfma_f32_16x16x32_bf16 v[136:139], a[176:179], a[212:215], v[136:139]
  buffer_load_dwordx4 a[28:31], v1, s[8:11], s72 offen offset:1024 sc1
  v_and_b32 v63, v63, v51
  v_mfma_f32_16x16x32_bf16 v[140:143], a[176:179], a[216:219], v[140:143]
  ds_read_b64_tr_b16 a[176:177], v5 offset:24576
  v_mfma_f32_16x16x32_bf16 v[140:143], a[180:183], a[200:203], v[140:143]
  s_waitcnt lgkmcnt(5)
  s_cmp_eq_u32 s91, 2
  s_cselect_b32 s76, 4, 11
  s_lshl_b32 s68, s76, 17
  s_lshl_b32 s76, s76, 11
  s_add_u32 s76, s76, s84
  s_add_u32 m0, s45, 32768
  v_mfma_f32_16x16x32_bf16 v[156:159], a[160:163], a[200:203], v[156:159]
  ds_read_b64_tr_b16 a[178:179], v5 offset:26624
  v_mfma_f32_16x16x32_bf16 v[156:159], a[164:167], a[216:219], v[156:159]
  buffer_load_dwordx4 v32, s[36:39], s68 offen lds
  v_mfma_f32_16x16x32_bf16 v[152:155], a[164:167], a[212:215], v[152:155]
  ds_read_b64_tr_b16 a[180:181], v5 offset:28672
  v_mfma_f32_16x16x32_bf16 v[152:155], a[160:163], a[196:199], v[152:155]
  s_add_u32 m0, s45, 36864
  s_add_u32 s61, s68, 65536
  v_mfma_f32_16x16x32_bf16 v[148:151], a[160:163], a[192:195], v[148:151]
  ds_read_b64_tr_b16 a[182:183], v5 offset:30720
  v_mfma_f32_16x16x32_bf16 v[148:151], a[164:167], a[208:211], v[148:151]
  buffer_load_dwordx4 v32, s[36:39], s61 offen lds
  s_waitcnt vmcnt(45)
  s_barrier
  v_mfma_f32_16x16x32_bf16 v[144:147], a[164:167], a[204:207], v[144:147]
  ds_read_b64_tr_b16 a[164:165], v6 offset:32768
  v_mfma_f32_16x16x32_bf16 v[144:147], a[160:163], a[188:191], v[144:147]
  s_waitcnt lgkmcnt(5)
  s_cmp_eq_u32 s91, 3
  s_cselect_b32 s77, 6, 13
  s_lshl_b32 s69, s77, 17
  s_lshl_b32 s77, s77, 11
  s_add_u32 s77, s77, s84
  s_add_u32 m0, s45, 49152
  v_mfma_f32_16x16x32_bf16 v[160:163], a[168:171], a[188:191], v[160:163]
  ds_read_b64_tr_b16 a[166:167], v6 offset:34816
  v_mfma_f32_16x16x32_bf16 v[160:163], a[172:175], a[204:207], v[160:163]
  buffer_load_dwordx4 v32, s[36:39], s69 offen lds
  v_mfma_f32_16x16x32_bf16 v[164:167], a[172:175], a[208:211], v[164:167]
  ds_read_b64_tr_b16 a[160:161], v6 offset:36864
  v_mfma_f32_16x16x32_bf16 v[164:167], a[168:171], a[192:195], v[164:167]
  v_mfma_f32_16x16x32_bf16 v[168:171], a[168:171], a[196:199], v[168:171]
  ds_read_b64_tr_b16 a[162:163], v6 offset:38912
  v_mfma_f32_16x16x32_bf16 v[168:171], a[172:175], a[212:215], v[168:171]
  s_add_u32 m0, s45, 53248
  s_add_u32 s61, s69, 65536
  v_mfma_f32_16x16x32_bf16 v[172:175], a[172:175], a[216:219], v[172:175]
  ds_read_b64_tr_b16 a[172:173], v7 offset:32768
  v_mfma_f32_16x16x32_bf16 v[172:175], a[168:171], a[200:203], v[172:175]
  s_waitcnt lgkmcnt(5)
  buffer_load_dwordx4 v32, s[36:39], s61 offen lds
  v_mfma_f32_16x16x32_bf16 v[188:191], a[176:179], a[200:203], v[188:191]
  ds_read_b64_tr_b16 a[174:175], v7 offset:34816
  v_mfma_f32_16x16x32_bf16 v[188:191], a[180:183], a[216:219], v[188:191]
  v_mfma_f32_16x16x32_bf16 v[184:187], a[180:183], a[212:215], v[184:187]
  ds_read_b64_tr_b16 a[168:169], v7 offset:36864
  v_mfma_f32_16x16x32_bf16 v[184:187], a[176:179], a[196:199], v[184:187]
  buffer_load_dwordx4 a[32:35], v1, s[8:11], s73 offen offset:0 sc1
  v_mfma_f32_16x16x32_bf16 v[180:183], a[176:179], a[192:195], v[180:183]
  ds_read_b64_tr_b16 a[170:171], v7 offset:38912
  v_mfma_f32_16x16x32_bf16 v[180:183], a[180:183], a[208:211], v[180:183]
  v_mfma_f32_16x16x32_bf16 v[176:179], a[180:183], a[204:207], v[176:179]
  ds_read_b64_tr_b16 a[180:181], v8 offset:32768
  v_mfma_f32_16x16x32_bf16 v[176:179], a[176:179], a[188:191], v[176:179]
  s_waitcnt vmcnt(13) lgkmcnt(5)
  buffer_load_dwordx4 a[48:51], v1, s[8:11], s73 offen offset:1024 sc1
  v_mfma_f32_16x16x32_bf16 v[64:67], a[164:167], a[220:223], v[64:67]
  ds_read_b64_tr_b16 a[182:183], v8 offset:34816
  v_mfma_f32_16x16x32_bf16 v[64:67], a[160:163], a[236:239], v[64:67]
  s_add_u32 s73, s73, 131072
  v_mfma_f32_16x16x32_bf16 v[68:71], a[160:163], a[240:243], v[68:71]
  ds_read_b64_tr_b16 a[176:177], v8 offset:36864
  v_mfma_f32_16x16x32_bf16 v[68:71], a[164:167], a[224:227], v[68:71]
  buffer_load_dwordx4 a[36:39], v1, s[8:11], s73 offen offset:0 sc1
  v_mfma_f32_16x16x32_bf16 v[72:75], a[164:167], a[228:231], v[72:75]
  ds_read_b64_tr_b16 a[178:179], v8 offset:38912
  v_mfma_f32_16x16x32_bf16 v[72:75], a[160:163], a[244:247], v[72:75]
  v_mfma_f32_16x16x32_bf16 v[76:79], a[160:163], a[248:251], v[76:79]
  ds_read_b64_tr_b16 a[160:161], v9 offset:32768
  v_mfma_f32_16x16x32_bf16 v[76:79], a[164:167], a[232:235], v[76:79]
  s_waitcnt lgkmcnt(5)
  v_mfma_f32_16x16x32_bf16 v[92:95], a[172:175], a[232:235], v[92:95]
  ds_read_b64_tr_b16 a[162:163], v9 offset:34816
  v_mfma_f32_16x16x32_bf16 v[92:95], a[168:171], a[248:251], v[92:95]
  buffer_load_dwordx4 a[52:55], v1, s[8:11], s73 offen offset:1024 sc1
  v_mfma_f32_16x16x32_bf16 v[88:91], a[168:171], a[244:247], v[88:91]
  ds_read_b64_tr_b16 a[164:165], v9 offset:36864
  v_mfma_f32_16x16x32_bf16 v[88:91], a[172:175], a[228:231], v[88:91]
  s_add_u32 s73, s73, s89
  v_mfma_f32_16x16x32_bf16 v[84:87], a[172:175], a[224:227], v[84:87]
  ds_read_b64_tr_b16 a[166:167], v9 offset:38912
  v_mfma_f32_16x16x32_bf16 v[84:87], a[168:171], a[240:243], v[84:87]
  buffer_load_dwordx4 a[40:43], v1, s[8:11], s73 offen offset:0 sc1
  v_mfma_f32_16x16x32_bf16 v[80:83], a[168:171], a[236:239], v[80:83]
  ds_read_b64_tr_b16 a[168:169], v6 offset:49152
  v_mfma_f32_16x16x32_bf16 v[80:83], a[172:175], a[220:223], v[80:83]
  s_waitcnt lgkmcnt(5)
  v_mfma_f32_16x16x32_bf16 v[96:99], a[180:183], a[220:223], v[96:99]
  ds_read_b64_tr_b16 a[170:171], v6 offset:51200
  v_mfma_f32_16x16x32_bf16 v[96:99], a[176:179], a[236:239], v[96:99]
  buffer_load_dwordx4 a[56:59], v1, s[8:11], s73 offen offset:1024 sc1
  v_mfma_f32_16x16x32_bf16 v[100:103], a[176:179], a[240:243], v[100:103]
  ds_read_b64_tr_b16 a[172:173], v6 offset:53248
  v_mfma_f32_16x16x32_bf16 v[100:103], a[180:183], a[224:227], v[100:103]
  s_add_u32 s73, s73, 131072
  v_mfma_f32_16x16x32_bf16 v[104:107], a[180:183], a[228:231], v[104:107]
  ds_read_b64_tr_b16 a[174:175], v6 offset:55296
  v_mfma_f32_16x16x32_bf16 v[104:107], a[176:179], a[244:247], v[104:107]
  buffer_load_dwordx4 a[44:47], v1, s[8:11], s73 offen offset:0 sc1
  v_mfma_f32_16x16x32_bf16 v[108:111], a[176:179], a[248:251], v[108:111]
  ds_read_b64_tr_b16 a[176:177], v7 offset:49152
  v_mfma_f32_16x16x32_bf16 v[108:111], a[180:183], a[232:235], v[108:111]
  s_waitcnt lgkmcnt(5)
  v_mfma_f32_16x16x32_bf16 v[124:127], a[160:163], a[232:235], v[124:127]
  ds_read_b64_tr_b16 a[178:179], v7 offset:51200
  v_mfma_f32_16x16x32_bf16 v[124:127], a[164:167], a[248:251], v[124:127]
  v_mfma_f32_16x16x32_bf16 v[120:123], a[164:167], a[244:247], v[120:123]
  ds_read_b64_tr_b16 a[180:181], v7 offset:53248
  v_mfma_f32_16x16x32_bf16 v[120:123], a[160:163], a[228:231], v[120:123]
  buffer_load_dwordx4 a[60:63], v1, s[8:11], s73 offen offset:1024 sc1
  v_mfma_f32_16x16x32_bf16 v[116:119], a[160:163], a[224:227], v[116:119]
  ds_read_b64_tr_b16 a[182:183], v7 offset:55296
  v_mfma_f32_16x16x32_bf16 v[116:119], a[164:167], a[240:243], v[116:119]
  v_mfma_f32_16x16x32_bf16 v[112:115], a[164:167], a[236:239], v[112:115]
  ds_read_b64_tr_b16 a[164:165], v8 offset:49152
  v_mfma_f32_16x16x32_bf16 v[112:115], a[160:163], a[220:223], v[112:115]
  s_waitcnt vmcnt(12) lgkmcnt(5)
  buffer_load_dwordx4 a[64:67], v1, s[8:11], s74 offen offset:0 sc1
  v_mfma_f32_16x16x32_bf16 v[64:67], a[168:171], a[0:3], v[64:67]
  ds_read_b64_tr_b16 a[166:167], v8 offset:51200
  v_mfma_f32_16x16x32_bf16 v[64:67], a[172:175], a[16:19], v[64:67]
  v_mfma_f32_16x16x32_bf16 v[68:71], a[172:175], a[20:23], v[68:71]
  ds_read_b64_tr_b16 a[160:161], v8 offset:53248
  v_mfma_f32_16x16x32_bf16 v[68:71], a[168:171], a[4:7], v[68:71]
  buffer_load_dwordx4 a[80:83], v1, s[8:11], s74 offen offset:1024 sc1
  v_mfma_f32_16x16x32_bf16 v[72:75], a[168:171], a[8:11], v[72:75]
  ds_read_b64_tr_b16 a[162:163], v8 offset:55296
  v_mfma_f32_16x16x32_bf16 v[72:75], a[172:175], a[24:27], v[72:75]
  s_add_u32 s74, s74, 131072
  v_mfma_f32_16x16x32_bf16 v[76:79], a[172:175], a[28:31], v[76:79]
  ds_read_b64_tr_b16 a[172:173], v9 offset:49152
  v_mfma_f32_16x16x32_bf16 v[76:79], a[168:171], a[12:15], v[76:79]
  s_waitcnt lgkmcnt(5)
  buffer_load_dwordx4 a[68:71], v1, s[8:11], s74 offen offset:0 sc1
  v_mfma_f32_16x16x32_bf16 v[92:95], a[176:179], a[12:15], v[92:95]
  ds_read_b64_tr_b16 a[174:175], v9 offset:51200
  v_mfma_f32_16x16x32_bf16 v[92:95], a[180:183], a[28:31], v[92:95]
  v_mfma_f32_16x16x32_bf16 v[88:91], a[180:183], a[24:27], v[88:91]
  ds_read_b64_tr_b16 a[168:169], v9 offset:53248
  v_mfma_f32_16x16x32_bf16 v[88:91], a[176:179], a[8:11], v[88:91]
  v_mfma_f32_16x16x32_bf16 v[84:87], a[176:179], a[4:7], v[84:87]
  ds_read_b64_tr_b16 a[170:171], v9 offset:55296
  buffer_load_dwordx4 a[84:87], v1, s[8:11], s74 offen offset:1024 sc1
  v_mfma_f32_16x16x32_bf16 v[84:87], a[180:183], a[20:23], v[84:87]
  s_waitcnt vmcnt(12)
  s_barrier
  v_mfma_f32_16x16x32_bf16 v[80:83], a[180:183], a[16:19], v[80:83]
  ds_read_b64_tr_b16 a[180:181], v6 offset:16384
  v_mfma_f32_16x16x32_bf16 v[80:83], a[176:179], a[0:3], v[80:83]
  s_waitcnt lgkmcnt(5)
  s_add_u32 s74, s74, s89
  v_mfma_f32_16x16x32_bf16 v[96:99], a[164:167], a[0:3], v[96:99]
  ds_read_b64_tr_b16 a[182:183], v6 offset:18432
  v_mfma_f32_16x16x32_bf16 v[96:99], a[160:163], a[16:19], v[96:99]
  buffer_load_dwordx4 a[72:75], v1, s[8:11], s74 offen offset:0 sc1
  v_mfma_f32_16x16x32_bf16 v[100:103], a[160:163], a[20:23], v[100:103]
  ds_read_b64_tr_b16 a[176:177], v6 offset:20480
  v_mfma_f32_16x16x32_bf16 v[100:103], a[164:167], a[4:7], v[100:103]
  v_mfma_f32_16x16x32_bf16 v[104:107], a[164:167], a[8:11], v[104:107]
  ds_read_b64_tr_b16 a[178:179], v6 offset:22528
  v_mfma_f32_16x16x32_bf16 v[104:107], a[160:163], a[24:27], v[104:107]
  buffer_load_dwordx4 a[88:91], v1, s[8:11], s74 offen offset:1024 sc1
  v_mfma_f32_16x16x32_bf16 v[108:111], a[160:163], a[28:31], v[108:111]
  ds_read_b64_tr_b16 a[160:161], v7 offset:16384
  v_mfma_f32_16x16x32_bf16 v[108:111], a[164:167], a[12:15], v[108:111]
  s_waitcnt lgkmcnt(5)
  s_add_u32 s74, s74, 131072
  v_mfma_f32_16x16x32_bf16 v[124:127], a[172:175], a[12:15], v[124:127]
HOP18:
  s_cbranch_execz WRET1
  ds_read_b64_tr_b16 a[162:163], v7 offset:18432
  v_mfma_f32_16x16x32_bf16 v[124:127], a[168:171], a[28:31], v[124:127]
  buffer_load_dwordx4 a[76:79], v1, s[8:11], s74 offen offset:0 sc1
  v_mfma_f32_16x16x32_bf16 v[120:123], a[168:171], a[24:27], v[120:123]
  ds_read_b64_tr_b16 a[164:165], v7 offset:20480
  v_mfma_f32_16x16x32_bf16 v[120:123], a[172:175], a[8:11], v[120:123]
  v_mfma_f32_16x16x32_bf16 v[116:119], a[172:175], a[4:7], v[116:119]
  ds_read_b64_tr_b16 a[166:167], v7 offset:22528
  v_mfma_f32_16x16x32_bf16 v[116:119], a[168:171], a[20:23], v[116:119]
  v_mfma_f32_16x16x32_bf16 v[112:115], a[168:171], a[16:19], v[112:115]
  ds_read_b64_tr_b16 a[168:169], v8 offset:16384
  v_mfma_f32_16x16x32_bf16 v[112:115], a[172:175], a[0:3], v[112:115]
  s_waitcnt vmcnt(7) lgkmcnt(5)
  buffer_load_dwordx4 a[92:95], v1, s[8:11], s74 offen offset:1024 sc1
  v_mfma_f32_16x16x32_bf16 v[64:67], a[180:183], a[32:35], v[64:67]
  ds_read_b64_tr_b16 a[170:171], v8 offset:18432
  v_mfma_f32_16x16x32_bf16 v[64:67], a[176:179], a[48:51], v[64:67]
  v_mfma_f32_16x16x32_bf16 v[68:71], a[176:179], a[52:55], v[68:71]
  ds_read_b64_tr_b16 a[172:173], v8 offset:20480
  v_mfma_f32_16x16x32_bf16 v[68:71], a[180:183], a[36:39], v[68:71]
  buffer_load_dwordx4 a[96:99], v1, s[8:11], s75 offen offset:0 sc1
  v_mfma_f32_16x16x32_bf16 v[72:75], a[180:183], a[40:43], v[72:75]
  ds_read_b64_tr_b16 a[174:175], v8 offset:22528
  v_mfma_f32_16x16x32_bf16 v[72:75], a[176:179], a[56:59], v[72:75]
  v_mfma_f32_16x16x32_bf16 v[76:79], a[176:179], a[60:63], v[76:79]
  ds_read_b64_tr_b16 a[176:177], v9 offset:16384
  v_mfma_f32_16x16x32_bf16 v[76:79], a[180:183], a[44:47], v[76:79]
  s_waitcnt lgkmcnt(5)
  buffer_load_dwordx4 a[112:115], v1, s[8:11], s75 offen offset:1024 sc1
  v_mfma_f32_16x16x32_bf16 v[92:95], a[160:163], a[44:47], v[92:95]
  ds_read_b64_tr_b16 a[178:179], v9 offset:18432
  v_mfma_f32_16x16x32_bf16 v[92:95], a[164:167], a[60:63], v[92:95]
  s_add_u32 s75, s75, 131072
  v_mfma_f32_16x16x32_bf16 v[88:91], a[164:167], a[56:59], v[88:91]
  ds_read_b64_tr_b16 a[180:181], v9 offset:20480
  v_mfma_f32_16x16x32_bf16 v[88:91], a[160:163], a[40:43], v[88:91]
  buffer_load_dwordx4 a[100:103], v1, s[8:11], s75 offen offset:0 sc1
  v_mfma_f32_16x16x32_bf16 v[84:87], a[160:163], a[36:39], v[84:87]
  ds_read_b64_tr_b16 a[182:183], v9 offset:22528
  v_mfma_f32_16x16x32_bf16 v[84:87], a[164:167], a[52:55], v[84:87]
  v_mfma_f32_16x16x32_bf16 v[80:83], a[164:167], a[48:51], v[80:83]
  ds_read_b64_tr_b16 a[164:165], v6 offset:0
  v_mfma_f32_16x16x32_bf16 v[80:83], a[160:163], a[32:35], v[80:83]
  s_waitcnt lgkmcnt(5)
  v_mfma_f32_16x16x32_bf16 v[96:99], a[168:171], a[32:35], v[96:99]
  ds_read_b64_tr_b16 a[166:167], v6 offset:2048
  v_mfma_f32_16x16x32_bf16 v[96:99], a[172:175], a[48:51], v[96:99]
  buffer_load_dwordx4 a[116:119], v1, s[8:11], s75 offen offset:1024 sc1
  v_mfma_f32_16x16x32_bf16 v[100:103], a[172:175], a[52:55], v[100:103]
  ds_read_b64_tr_b16 a[160:161], v6 offset:4096
  v_mfma_f32_16x16x32_bf16 v[100:103], a[168:171], a[36:39], v[100:103]
  s_add_u32 s75, s75, s89
  v_mfma_f32_16x16x32_bf16 v[104:107], a[168:171], a[40:43], v[104:107]
  ds_read_b64_tr_b16 a[162:163], v6 offset:6144
  v_mfma_f32_16x16x32_bf16 v[104:107], a[172:175], a[56:59], v[104:107]
  buffer_load_dwordx4 a[104:107], v1, s[8:11], s75 offen offset:0 sc1
  v_mfma_f32_16x16x32_bf16 v[108:111], a[172:175], a[60:63], v[108:111]
  ds_read_b64_tr_b16 a[172:173], v7 offset:0
  v_mfma_f32_16x16x32_bf16 v[108:111], a[168:171], a[44:47], v[108:111]
  s_waitcnt lgkmcnt(5)
  v_mfma_f32_16x16x32_bf16 v[124:127], a[176:179], a[44:47], v[124:127]
  ds_read_b64_tr_b16 a[174:175], v7 offset:2048
  v_mfma_f32_16x16x32_bf16 v[124:127], a[180:183], a[60:63], v[124:127]
  buffer_load_dwordx4 a[120:123], v1, s[8:11], s75 offen offset:1024 sc1
  v_mfma_f32_16x16x32_bf16 v[120:123], a[180:183], a[56:59], v[120:123]
  ds_read_b64_tr_b16 a[168:169], v7 offset:4096
  v_mfma_f32_16x16x32_bf16 v[120:123], a[176:179], a[40:43], v[120:123]
  s_add_u32 s75, s75, 131072
  v_mfma_f32_16x16x32_bf16 v[116:119], a[176:179], a[36:39], v[116:119]
  ds_read_b64_tr_b16 a[170:171], v7 offset:6144
  v_mfma_f32_16x16x32_bf16 v[116:119], a[180:183], a[52:55], v[116:119]
  buffer_load_dwordx4 a[108:111], v1, s[8:11], s75 offen offset:0 sc1
  v_mfma_f32_16x16x32_bf16 v[112:115], a[180:183], a[48:51], v[112:115]
  ds_read_b64_tr_b16 a[180:181], v8 offset:0
  v_mfma_f32_16x16x32_bf16 v[112:115], a[176:179], a[32:35], v[112:115]
  s_waitcnt vmcnt(7) lgkmcnt(5)
  v_mfma_f32_16x16x32_bf16 v[64:67], a[164:167], a[64:67], v[64:67]
  ds_read_b64_tr_b16 a[182:183], v8 offset:2048
  v_mfma_f32_16x16x32_bf16 v[64:67], a[160:163], a[80:83], v[64:67]
  v_mfma_f32_16x16x32_bf16 v[68:71], a[160:163], a[84:87], v[68:71]
  ds_read_b64_tr_b16 a[176:177], v8 offset:4096
  v_mfma_f32_16x16x32_bf16 v[68:71], a[164:167], a[68:71], v[68:71]
  buffer_load_dwordx4 a[124:127], v1, s[8:11], s75 offen offset:1024 sc1
  v_mfma_f32_16x16x32_bf16 v[72:75], a[164:167], a[72:75], v[72:75]
  ds_read_b64_tr_b16 a[178:179], v8 offset:6144
  v_mfma_f32_16x16x32_bf16 v[72:75], a[160:163], a[88:91], v[72:75]
  v_mfma_f32_16x16x32_bf16 v[76:79], a[160:163], a[92:95], v[76:79]
  ds_read_b64_tr_b16 a[160:161], v9 offset:0
  v_mfma_f32_16x16x32_bf16 v[76:79], a[164:167], a[76:79], v[76:79]
  s_waitcnt lgkmcnt(5)
  buffer_load_dwordx4 a[128:131], v1, s[8:11], s76 offen offset:0 sc1
  v_mfma_f32_16x16x32_bf16 v[92:95], a[172:175], a[76:79], v[92:95]
  ds_read_b64_tr_b16 a[162:163], v9 offset:2048
  v_mfma_f32_16x16x32_bf16 v[92:95], a[168:171], a[92:95], v[92:95]
  v_mfma_f32_16x16x32_bf16 v[88:91], a[168:171], a[88:91], v[88:91]
  ds_read_b64_tr_b16 a[164:165], v9 offset:4096
  v_mfma_f32_16x16x32_bf16 v[88:91], a[172:175], a[72:75], v[88:91]
  buffer_load_dwordx4 a[144:147], v1, s[8:11], s76 offen offset:1024 sc1
  v_mfma_f32_16x16x32_bf16 v[84:87], a[172:175], a[68:71], v[84:87]
  ds_read_b64_tr_b16 a[166:167], v9 offset:6144
  v_mfma_f32_16x16x32_bf16 v[84:87], a[168:171], a[84:87], v[84:87]
  s_add_u32 s76, s76, 131072
  v_mfma_f32_16x16x32_bf16 v[80:83], a[168:171], a[80:83], v[80:83]
  ds_read_b64_tr_b16 a[168:169], v2 offset:0
  v_mfma_f32_16x16x32_bf16 v[80:83], a[172:175], a[64:67], v[80:83]
  s_waitcnt lgkmcnt(5)
  buffer_load_dwordx4 a[132:135], v1, s[8:11], s76 offen offset:0 sc1
  v_mfma_f32_16x16x32_bf16 v[96:99], a[180:183], a[64:67], v[96:99]
  ds_read_b64_tr_b16 a[170:171], v2 offset:2048
  v_mfma_f32_16x16x32_bf16 v[96:99], a[176:179], a[80:83], v[96:99]
  v_mfma_f32_16x16x32_bf16 v[100:103], a[176:179], a[84:87], v[100:103]
  ds_read_b64_tr_b16 a[172:173], v2 offset:4096
  v_mfma_f32_16x16x32_bf16 v[100:103], a[180:183], a[68:71], v[100:103]
  v_mfma_f32_16x16x32_bf16 v[104:107], a[180:183], a[72:75], v[104:107]
  ds_read_b64_tr_b16 a[174:175], v2 offset:6144
  v_mfma_f32_16x16x32_bf16 v[104:107], a[176:179], a[88:91], v[104:107]
  buffer_load_dwordx4 a[148:151], v1, s[8:11], s76 offen offset:1024 sc1
  v_mfma_f32_16x16x32_bf16 v[108:111], a[176:179], a[92:95], v[108:111]
  ds_read_b64_tr_b16 a[176:177], v3 offset:0
  v_mfma_f32_16x16x32_bf16 v[108:111], a[180:183], a[76:79], v[108:111]
  s_waitcnt lgkmcnt(5)
  s_add_u32 s76, s76, s89
  v_mfma_f32_16x16x32_bf16 v[124:127], a[160:163], a[76:79], v[124:127]
  ds_read_b64_tr_b16 a[178:179], v3 offset:2048
  v_mfma_f32_16x16x32_bf16 v[124:127], a[164:167], a[92:95], v[124:127]
  buffer_load_dwordx4 a[136:139], v1, s[8:11], s76 offen offset:0 sc1
  v_mfma_f32_16x16x32_bf16 v[120:123], a[164:167], a[88:91], v[120:123]
  ds_read_b64_tr_b16 a[180:181], v3 offset:4096
  v_mfma_f32_16x16x32_bf16 v[120:123], a[160:163], a[72:75], v[120:123]
  v_mfma_f32_16x16x32_bf16 v[116:119], a[160:163], a[68:71], v[116:119]
  ds_read_b64_tr_b16 a[182:183], v3 offset:6144
  v_mfma_f32_16x16x32_bf16 v[116:119], a[164:167], a[84:87], v[116:119]
  buffer_load_dwordx4 a[152:155], v1, s[8:11], s76 offen offset:1024 sc1
  v_mfma_f32_16x16x32_bf16 v[112:115], a[164:167], a[80:83], v[112:115]
  ds_read_b64_tr_b16 a[164:165], v4 offset:0
  v_mfma_f32_16x16x32_bf16 v[112:115], a[160:163], a[64:67], v[112:115]
  s_waitcnt vmcnt(6) lgkmcnt(5)
  s_add_u32 s76, s76, 131072
  v_mfma_f32_16x16x32_bf16 v[64:67], a[168:171], a[96:99], v[64:67]
  ds_read_b64_tr_b16 a[166:167], v4 offset:2048
  v_mfma_f32_16x16x32_bf16 v[64:67], a[172:175], a[112:115], v[64:67]
  buffer_load_dwordx4 a[140:143], v1, s[8:11], s76 offen offset:0 sc1
  v_mfma_f32_16x16x32_bf16 v[68:71], a[172:175], a[116:119], v[68:71]
  ds_read_b64_tr_b16 a[160:161], v4 offset:4096
  v_mfma_f32_16x16x32_bf16 v[68:71], a[168:171], a[100:103], v[68:71]
  v_mfma_f32_16x16x32_bf16 v[72:75], a[168:171], a[104:107], v[72:75]
  ds_read_b64_tr_b16 a[162:163], v4 offset:6144
  v_mfma_f32_16x16x32_bf16 v[72:75], a[172:175], a[120:123], v[72:75]
  v_mfma_f32_16x16x32_bf16 v[76:79], a[172:175], a[124:127], v[76:79]
  ds_read_b64_tr_b16 a[172:173], v5 offset:0
  v_mfma_f32_16x16x32_bf16 v[76:79], a[168:171], a[108:111], v[76:79]
  s_waitcnt lgkmcnt(5)
  buffer_load_dwordx4 a[156:159], v1, s[8:11], s76 offen offset:1024 sc1
  v_mfma_f32_16x16x32_bf16 v[92:95], a[176:179], a[108:111], v[92:95]
  ds_read_b64_tr_b16 a[174:175], v5 offset:2048
  v_mfma_f32_16x16x32_bf16 v[92:95], a[180:183], a[124:127], v[92:95]
  v_mfma_f32_16x16x32_bf16 v[88:91], a[180:183], a[120:123], v[88:91]
  ds_read_b64_tr_b16 a[168:169], v5 offset:4096
  v_mfma_f32_16x16x32_bf16 v[88:91], a[176:179], a[104:107], v[88:91]
  buffer_load_dwordx4 a[188:191], v1, s[8:11], s77 offen offset:0 sc1
  v_mfma_f32_16x16x32_bf16 v[84:87], a[176:179], a[100:103], v[84:87]
  ds_read_b64_tr_b16 a[170:171], v5 offset:6144
  v_mfma_f32_16x16x32_bf16 v[84:87], a[180:183], a[116:119], v[84:87]
  v_mfma_f32_16x16x32_bf16 v[80:83], a[180:183], a[112:115], v[80:83]
  ds_read_b64_tr_b16 a[180:181], v2 offset:32768
  v_mfma_f32_16x16x32_bf16 v[80:83], a[176:179], a[96:99], v[80:83]
  s_waitcnt lgkmcnt(5)
  buffer_load_dwordx4 a[204:207], v1, s[8:11], s77 offen offset:1024 sc1
  v_mfma_f32_16x16x32_bf16 v[96:99], a[164:167], a[96:99], v[96:99]
  ds_read_b64_tr_b16 a[182:183], v2 offset:34816
  v_mfma_f32_16x16x32_bf16 v[96:99], a[160:163], a[112:115], v[96:99]
  s_add_u32 s77, s77, 131072
  v_mfma_f32_16x16x32_bf16 v[100:103], a[160:163], a[116:119], v[100:103]
  ds_read_b64_tr_b16 a[176:177], v2 offset:36864
  v_mfma_f32_16x16x32_bf16 v[100:103], a[164:167], a[100:103], v[100:103]
  buffer_load_dwordx4 a[192:195], v1, s[8:11], s77 offen offset:0 sc1
  v_mfma_f32_16x16x32_bf16 v[104:107], a[164:167], a[104:107], v[104:107]
  ds_read_b64_tr_b16 a[178:179], v2 offset:38912
  v_mfma_f32_16x16x32_bf16 v[104:107], a[160:163], a[120:123], v[104:107]
  v_mfma_f32_16x16x32_bf16 v[108:111], a[160:163], a[124:127], v[108:111]
  ds_read_b64_tr_b16 a[160:161], v3 offset:32768
  v_mfma_f32_16x16x32_bf16 v[108:111], a[164:167], a[108:111], v[108:111]
  s_waitcnt lgkmcnt(5)
  v_mfma_f32_16x16x32_bf16 v[124:127], a[172:175], a[108:111], v[124:127]
  ds_read_b64_tr_b16 a[162:163], v3 offset:34816
  v_mfma_f32_16x16x32_bf16 v[124:127], a[168:171], a[124:127], v[124:127]
  buffer_load_dwordx4 a[208:211], v1, s[8:11], s77 offen offset:1024 sc1
  v_mfma_f32_16x16x32_bf16 v[120:123], a[168:171], a[120:123], v[120:123]
  ds_read_b64_tr_b16 a[164:165], v3 offset:36864
  v_mfma_f32_16x16x32_bf16 v[120:123], a[172:175], a[104:107], v[120:123]
  s_add_u32 s77, s77, s89
  v_mfma_f32_16x16x32_bf16 v[116:119], a[172:175], a[100:103], v[116:119]
  ds_read_b64_tr_b16 a[166:167], v3 offset:38912
  v_mfma_f32_16x16x32_bf16 v[116:119], a[168:171], a[116:119], v[116:119]
  buffer_load_dwordx4 a[196:199], v1, s[8:11], s77 offen offset:0 sc1
  v_mfma_f32_16x16x32_bf16 v[112:115], a[168:171], a[112:115], v[112:115]
  ds_read_b64_tr_b16 a[168:169], v4 offset:32768
  v_mfma_f32_16x16x32_bf16 v[112:115], a[172:175], a[96:99], v[112:115]
  s_waitcnt vmcnt(5) lgkmcnt(5)
  v_mfma_f32_16x16x32_bf16 v[64:67], a[180:183], a[128:131], v[64:67]
  ds_read_b64_tr_b16 a[170:171], v4 offset:34816
  v_mfma_f32_16x16x32_bf16 v[64:67], a[176:179], a[144:147], v[64:67]
  buffer_load_dwordx4 a[212:215], v1, s[8:11], s77 offen offset:1024 sc1
  v_mfma_f32_16x16x32_bf16 v[68:71], a[176:179], a[148:151], v[68:71]
  ds_read_b64_tr_b16 a[172:173], v4 offset:36864
  v_mfma_f32_16x16x32_bf16 v[68:71], a[180:183], a[132:135], v[68:71]
  s_add_u32 s77, s77, 131072
  v_mfma_f32_16x16x32_bf16 v[72:75], a[180:183], a[136:139], v[72:75]
  ds_read_b64_tr_b16 a[174:175], v4 offset:38912
  v_mfma_f32_16x16x32_bf16 v[72:75], a[176:179], a[152:155], v[72:75]
  buffer_load_dwordx4 a[200:203], v1, s[8:11], s77 offen offset:0 sc1
  v_mfma_f32_16x16x32_bf16 v[76:79], a[176:179], a[156:159], v[76:79]
  ds_read_b64_tr_b16 a[176:177], v5 offset:32768
  v_mfma_f32_16x16x32_bf16 v[76:79], a[180:183], a[140:143], v[76:79]
  s_waitcnt lgkmcnt(5)
  v_mfma_f32_16x16x32_bf16 v[92:95], a[160:163], a[140:143], v[92:95]
  ds_read_b64_tr_b16 a[178:179], v5 offset:34816
  v_mfma_f32_16x16x32_bf16 v[92:95], a[164:167], a[156:159], v[92:95]
  v_mfma_f32_16x16x32_bf16 v[88:91], a[164:167], a[152:155], v[88:91]
  ds_read_b64_tr_b16 a[180:181], v5 offset:36864
  v_mfma_f32_16x16x32_bf16 v[88:91], a[160:163], a[136:139], v[88:91]
  buffer_load_dwordx4 a[216:219], v1, s[8:11], s77 offen offset:1024 sc1
  v_mfma_f32_16x16x32_bf16 v[84:87], a[160:163], a[132:135], v[84:87]
  ds_read_b64_tr_b16 a[182:183], v5 offset:38912
  v_mfma_f32_16x16x32_bf16 v[84:87], a[164:167], a[148:151], v[84:87]
  s_add_u32 m0, s45, 8192
  v_mfma_f32_16x16x32_bf16 v[80:83], a[164:167], a[144:147], v[80:83]
  ds_read_b64_tr_b16 a[164:165], v2 offset:49152
  v_mfma_f32_16x16x32_bf16 v[80:83], a[160:163], a[128:131], v[80:83]
  s_waitcnt lgkmcnt(5)
  buffer_load_dwordx4 v33, s[36:39], s67 offen lds
  v_mfma_f32_16x16x32_bf16 v[96:99], a[168:171], a[128:131], v[96:99]
  ds_read_b64_tr_b16 a[166:167], v2 offset:51200
  v_mfma_f32_16x16x32_bf16 v[96:99], a[172:175], a[144:147], v[96:99]
  s_add_u32 m0, s45, 12288
  s_add_u32 s61, s67, 65536
  v_mfma_f32_16x16x32_bf16 v[100:103], a[172:175], a[148:151], v[100:103]
  ds_read_b64_tr_b16 a[160:161], v2 offset:53248
  v_mfma_f32_16x16x32_bf16 v[100:103], a[168:171], a[132:135], v[100:103]
  buffer_load_dwordx4 v33, s[36:39], s61 offen lds
  v_mfma_f32_16x16x32_bf16 v[104:107], a[168:171], a[136:139], v[104:107]
  ds_read_b64_tr_b16 a[162:163], v2 offset:55296
  v_mfma_f32_16x16x32_bf16 v[104:107], a[172:175], a[152:155], v[104:107]
  s_add_u32 m0, s45, 40960
  v_mfma_f32_16x16x32_bf16 v[108:111], a[172:175], a[156:159], v[108:111]
  ds_read_b64_tr_b16 a[172:173], v3 offset:49152
  v_mfma_f32_16x16x32_bf16 v[108:111], a[168:171], a[140:143], v[108:111]
  s_waitcnt lgkmcnt(5)
  buffer_load_dwordx4 v33, s[36:39], s68 offen lds
  v_mfma_f32_16x16x32_bf16 v[124:127], a[176:179], a[140:143], v[124:127]
  ds_read_b64_tr_b16 a[174:175], v3 offset:51200
  v_mfma_f32_16x16x32_bf16 v[124:127], a[180:183], a[156:159], v[124:127]
  v_mfma_f32_16x16x32_bf16 v[120:123], a[180:183], a[152:155], v[120:123]
  ds_read_b64_tr_b16 a[168:169], v3 offset:53248
  v_mfma_f32_16x16x32_bf16 v[120:123], a[176:179], a[136:139], v[120:123]
  s_add_u32 m0, s45, 45056
  s_add_u32 s61, s68, 65536
  v_mfma_f32_16x16x32_bf16 v[116:119], a[176:179], a[132:135], v[116:119]
  ds_read_b64_tr_b16 a[170:171], v3 offset:55296
  v_mfma_f32_16x16x32_bf16 v[116:119], a[180:183], a[148:151], v[116:119]
  buffer_load_dwordx4 v33, s[36:39], s61 offen lds
  v_mfma_f32_16x16x32_bf16 v[112:115], a[180:183], a[144:147], v[112:115]
  ds_read_b64_tr_b16 a[180:181], v4 offset:49152
  v_mfma_f32_16x16x32_bf16 v[112:115], a[176:179], a[128:131], v[112:115]
  s_waitcnt vmcnt(4) lgkmcnt(5)
  s_add_u32 m0, s45, 57344
  v_mfma_f32_16x16x32_bf16 v[64:67], a[164:167], a[188:191], v[64:67]
  ds_read_b64_tr_b16 a[182:183], v4 offset:51200
  v_mfma_f32_16x16x32_bf16 v[64:67], a[160:163], a[204:207], v[64:67]
  buffer_load_dwordx4 v33, s[36:39], s69 offen lds
  v_mfma_f32_16x16x32_bf16 v[68:71], a[160:163], a[208:211], v[68:71]
  ds_read_b64_tr_b16 a[176:177], v4 offset:53248
  v_mfma_f32_16x16x32_bf16 v[68:71], a[164:167], a[192:195], v[68:71]
  s_add_u32 m0, s45, 61440
  s_add_u32 s61, s69, 65536
  v_mfma_f32_16x16x32_bf16 v[72:75], a[164:167], a[196:199], v[72:75]
  ds_read_b64_tr_b16 a[178:179], v4 offset:55296
  v_mfma_f32_16x16x32_bf16 v[72:75], a[160:163], a[212:215], v[72:75]
  buffer_load_dwordx4 v33, s[36:39], s61 offen lds
  v_mfma_f32_16x16x32_bf16 v[76:79], a[160:163], a[216:219], v[76:79]
  ds_read_b64_tr_b16 a[160:161], v5 offset:49152
  v_mfma_f32_16x16x32_bf16 v[76:79], a[164:167], a[200:203], v[76:79]
  s_waitcnt lgkmcnt(5)
  v_mfma_f32_16x16x32_bf16 v[92:95], a[172:175], a[200:203], v[92:95]
  ds_read_b64_tr_b16 a[162:163], v5 offset:51200
  v_mfma_f32_16x16x32_bf16 v[92:95], a[168:171], a[216:219], v[92:95]
  v_mfma_f32_16x16x32_bf16 v[88:91], a[168:171], a[212:215], v[88:91]
  ds_read_b64_tr_b16 a[164:165], v5 offset:53248
  v_cvt_pk_bf16_f32 v72, v72, v73
  v_mfma_f32_16x16x32_bf16 v[88:91], a[172:175], a[196:199], v[88:91]
  v_cvt_pk_bf16_f32 v73, v74, v75
  v_cvt_pk_bf16_f32 v76, v76, v77
  v_mfma_f32_16x16x32_bf16 v[84:87], a[172:175], a[192:195], v[84:87]
  ds_read_b64_tr_b16 a[166:167], v5 offset:55296
  v_cvt_pk_bf16_f32 v77, v78, v79
  v_mfma_f32_16x16x32_bf16 v[84:87], a[168:171], a[208:211], v[84:87]
  v_cvt_pk_bf16_f32 v64, v64, v65
  v_cvt_pk_bf16_f32 v65, v66, v67
  v_mfma_f32_16x16x32_bf16 v[80:83], a[168:171], a[204:207], v[80:83]
  v_cvt_pk_bf16_f32 v68, v68, v69
  v_cvt_pk_bf16_f32 v69, v70, v71
  v_mfma_f32_16x16x32_bf16 v[80:83], a[172:175], a[188:191], v[80:83]
  s_waitcnt lgkmcnt(4)
  s_waitcnt vmcnt(0)
  s_barrier
  v_mfma_f32_16x16x32_bf16 v[96:99], a[180:183], a[188:191], v[96:99]
  ds_read_b64_tr_b16 v[16:17], v6 offset:40960
  v_mfma_f32_16x16x32_bf16 v[96:99], a[176:179], a[204:207], v[96:99]
  ds_read_b64_tr_b16 v[18:19], v6 offset:43008
  v_mfma_f32_16x16x32_bf16 v[100:103], a[176:179], a[208:211], v[100:103]
  ds_read_b64_tr_b16 v[20:21], v6 offset:45056
  v_cvt_pk_bf16_f32 v74, v88, v89
  v_mfma_f32_16x16x32_bf16 v[100:103], a[180:183], a[192:195], v[100:103]
  ds_read_b64_tr_b16 v[22:23], v6 offset:47104
  v_cvt_pk_bf16_f32 v75, v90, v91
  v_mfma_f32_16x16x32_bf16 v[104:107], a[180:183], a[196:199], v[104:107]
  ds_read_b64_tr_b16 v[24:25], v7 offset:40960
  v_mfma_f32_16x16x32_bf16 v[104:107], a[176:179], a[212:215], v[104:107]
  ds_read_b64_tr_b16 v[26:27], v7 offset:43008
  v_mfma_f32_16x16x32_bf16 v[108:111], a[176:179], a[216:219], v[108:111]
  ds_read_b64_tr_b16 v[28:29], v7 offset:45056
  s_add_u32 s87, s86, 0
  buffer_store_dwordx4 v[72:75], v1, s[8:11], s87 offen offset:0 sc1
  v_mfma_f32_16x16x32_bf16 v[108:111], a[180:183], a[200:203], v[108:111]
  s_waitcnt lgkmcnt(7)
  ds_read_b64_tr_b16 v[30:31], v7 offset:47104
  v_mfma_f32_16x16x32_bf16 v[124:127], a[160:163], a[200:203], v[124:127]
  ds_read_b64_tr_b16 a[168:169], v8 offset:40960
  v_cvt_pk_bf16_f32 v78, v92, v93
  v_mfma_f32_16x16x32_bf16 v[124:127], a[164:167], a[216:219], v[124:127]
  ds_read_b64_tr_b16 a[170:171], v8 offset:43008
  v_cvt_pk_bf16_f32 v79, v94, v95
  v_mfma_f32_16x16x32_bf16 v[120:123], a[164:167], a[212:215], v[120:123]
  ds_read_b64_tr_b16 a[172:173], v8 offset:45056
  v_mfma_f32_16x16x32_bf16 v[120:123], a[160:163], a[196:199], v[120:123]
  ds_read_b64_tr_b16 a[174:175], v8 offset:47104
  v_mfma_f32_16x16x32_bf16 v[116:119], a[160:163], a[192:195], v[116:119]
  ds_read_b64_tr_b16 a[176:177], v9 offset:40960
  s_add_u32 s87, s86, 0
  buffer_store_dwordx4 v[76:79], v1, s[8:11], s87 offen offset:2048 sc1
  v_mfma_f32_16x16x32_bf16 v[116:119], a[164:167], a[208:211], v[116:119]
  ds_read_b64_tr_b16 a[178:179], v9 offset:43008
  v_mfma_f32_16x16x32_bf16 v[112:115], a[164:167], a[204:207], v[112:115]
  ds_read_b64_tr_b16 a[180:181], v9 offset:45056
  v_cvt_pk_bf16_f32 v66, v80, v81
  v_mfma_f32_16x16x32_bf16 v[112:115], a[160:163], a[188:191], v[112:115]
  s_waitcnt lgkmcnt(7)
  ds_read_b64_tr_b16 a[182:183], v9 offset:47104
  v_mfma_f32_16x16x32_bf16 v[136:139], v[16:19], a[228:231], v[136:139]
  ds_read_b64_tr_b16 a[164:165], v6 offset:57344
  v_cvt_pk_bf16_f32 v67, v82, v83
  v_mfma_f32_16x16x32_bf16 v[136:139], v[20:23], a[244:247], v[136:139]
  ds_read_b64_tr_b16 a[166:167], v6 offset:59392
  v_mfma_f32_16x16x32_bf16 v[140:143], v[20:23], a[248:251], v[140:143]
  ds_read_b64_tr_b16 a[160:161], v6 offset:61440
  v_mfma_f32_16x16x32_bf16 v[140:143], v[16:19], a[232:235], v[140:143]
  ds_read_b64_tr_b16 a[162:163], v6 offset:63488
  s_add_u32 s87, s86, 4096
  buffer_store_dwordx4 v[64:67], v1, s[8:11], s87 offen offset:0 sc1
  v_mfma_f32_16x16x32_bf16 v[156:159], v[24:27], a[232:235], v[156:159]
  ds_read_b64_tr_b16 v[20:21], v7 offset:57344
  v_mfma_f32_16x16x32_bf16 v[156:159], v[28:31], a[248:251], v[156:159]
  ds_read_b64_tr_b16 v[22:23], v7 offset:59392
  v_cvt_pk_bf16_f32 v70, v84, v85
  v_mfma_f32_16x16x32_bf16 v[152:155], v[28:31], a[244:247], v[152:155]
  ds_read_b64_tr_b16 v[16:17], v7 offset:61440
  v_cvt_pk_bf16_f32 v71, v86, v87
  v_mfma_f32_16x16x32_bf16 v[152:155], v[24:27], a[228:231], v[152:155]
  s_waitcnt lgkmcnt(7)
  ds_read_b64_tr_b16 v[18:19], v7 offset:63488
  v_mfma_f32_16x16x32_bf16 v[168:171], a[168:171], a[228:231], v[168:171]
  ds_read_b64_tr_b16 v[28:29], v8 offset:57344
  v_mfma_f32_16x16x32_bf16 v[168:171], a[172:175], a[244:247], v[168:171]
  ds_read_b64_tr_b16 v[30:31], v8 offset:59392
  s_add_u32 s87, s86, 4096
  buffer_store_dwordx4 v[68:71], v1, s[8:11], s87 offen offset:2048 sc1
  v_mfma_f32_16x16x32_bf16 v[172:175], a[172:175], a[248:251], v[172:175]
  ds_read_b64_tr_b16 v[24:25], v8 offset:61440
  v_mfma_f32_16x16x32_bf16 v[172:175], a[168:171], a[232:235], v[172:175]
  ds_read_b64_tr_b16 v[26:27], v8 offset:63488
  v_cvt_pk_bf16_f32 v104, v104, v105
  v_mfma_f32_16x16x32_bf16 v[188:191], a[176:179], a[232:235], v[188:191]
  ds_read_b64_tr_b16 a[172:173], v9 offset:57344
  v_cvt_pk_bf16_f32 v105, v106, v107
  v_mfma_f32_16x16x32_bf16 v[188:191], a[180:183], a[248:251], v[188:191]
  ds_read_b64_tr_b16 a[174:175], v9 offset:59392
  v_cvt_pk_bf16_f32 v108, v108, v109
  v_mfma_f32_16x16x32_bf16 v[184:187], a[180:183], a[244:247], v[184:187]
  ds_read_b64_tr_b16 a[168:169], v9 offset:61440
  v_cvt_pk_bf16_f32 v109, v110, v111
  v_mfma_f32_16x16x32_bf16 v[184:187], a[176:179], a[228:231], v[184:187]
  s_waitcnt lgkmcnt(7)
  ds_read_b64_tr_b16 a[170:171], v9 offset:63488
  v_mfma_f32_16x16x32_bf16 v[136:139], a[164:167], a[8:11], v[136:139]
  ds_read_b64_tr_b16 a[180:181], v6 offset:24576
  v_cvt_pk_bf16_f32 v96, v96, v97
  v_mfma_f32_16x16x32_bf16 v[136:139], a[160:163], a[24:27], v[136:139]
  ds_read_b64_tr_b16 a[182:183], v6 offset:26624
  v_cvt_pk_bf16_f32 v97, v98, v99
  v_mfma_f32_16x16x32_bf16 v[140:143], a[160:163], a[28:31], v[140:143]
  ds_read_b64_tr_b16 a[176:177], v6 offset:28672
  v_cvt_pk_bf16_f32 v100, v100, v101
  v_mfma_f32_16x16x32_bf16 v[140:143], a[164:167], a[12:15], v[140:143]
  ds_read_b64_tr_b16 a[178:179], v6 offset:30720
  v_cvt_pk_bf16_f32 v101, v102, v103
  v_mfma_f32_16x16x32_bf16 v[156:159], v[20:23], a[12:15], v[156:159]
  ds_read_b64_tr_b16 a[160:161], v7 offset:24576
  v_cvt_pk_bf16_f32 v106, v120, v121
  v_mfma_f32_16x16x32_bf16 v[156:159], v[16:19], a[28:31], v[156:159]
  ds_read_b64_tr_b16 a[162:163], v7 offset:26624
  v_cvt_pk_bf16_f32 v107, v122, v123
  v_mfma_f32_16x16x32_bf16 v[152:155], v[16:19], a[24:27], v[152:155]
  ds_read_b64_tr_b16 a[164:165], v7 offset:28672
  v_mfma_f32_16x16x32_bf16 v[152:155], v[20:23], a[8:11], v[152:155]
  s_waitcnt lgkmcnt(7)
  ds_read_b64_tr_b16 a[166:167], v7 offset:30720
  v_mfma_f32_16x16x32_bf16 v[168:171], v[28:31], a[8:11], v[168:171]
  ds_read_b64_tr_b16 v[16:17], v8 offset:24576
  s_add_u32 s87, s86, 0
  buffer_store_dwordx4 v[104:107], v1, s[8:11], s87 offen offset:1024 sc1
  v_mfma_f32_16x16x32_bf16 v[168:171], v[24:27], a[24:27], v[168:171]
  ds_read_b64_tr_b16 v[18:19], v8 offset:26624
  v_mfma_f32_16x16x32_bf16 v[172:175], v[24:27], a[28:31], v[172:175]
  ds_read_b64_tr_b16 v[20:21], v8 offset:28672
  v_cvt_pk_bf16_f32 v110, v124, v125
  v_mfma_f32_16x16x32_bf16 v[172:175], v[28:31], a[12:15], v[172:175]
  ds_read_b64_tr_b16 v[22:23], v8 offset:30720
  v_cvt_pk_bf16_f32 v111, v126, v127
  v_mfma_f32_16x16x32_bf16 v[188:191], a[172:175], a[12:15], v[188:191]
  ds_read_b64_tr_b16 v[24:25], v9 offset:24576
  v_mfma_f32_16x16x32_bf16 v[188:191], a[168:171], a[28:31], v[188:191]
  ds_read_b64_tr_b16 v[26:27], v9 offset:26624
  v_mfma_f32_16x16x32_bf16 v[184:187], a[168:171], a[24:27], v[184:187]
  ds_read_b64_tr_b16 v[28:29], v9 offset:28672
  s_add_u32 s87, s86, 0
  buffer_store_dwordx4 v[108:111], v1, s[8:11], s87 offen offset:3072 sc1
  v_mfma_f32_16x16x32_bf16 v[184:187], a[172:175], a[8:11], v[184:187]
  s_waitcnt lgkmcnt(7)
  ds_read_b64_tr_b16 v[30:31], v9 offset:30720
  v_mfma_f32_16x16x32_bf16 v[136:139], a[180:183], a[40:43], v[136:139]
  ds_read_b64_tr_b16 a[168:169], v6 offset:8192
  v_cvt_pk_bf16_f32 v98, v112, v113
  v_mfma_f32_16x16x32_bf16 v[136:139], a[176:179], a[56:59], v[136:139]
  ds_read_b64_tr_b16 a[170:171], v6 offset:10240
  v_cvt_pk_bf16_f32 v99, v114, v115
  v_mfma_f32_16x16x32_bf16 v[140:143], a[176:179], a[60:63], v[140:143]
  ds_read_b64_tr_b16 a[172:173], v6 offset:12288
  v_mfma_f32_16x16x32_bf16 v[140:143], a[180:183], a[44:47], v[140:143]
  ds_read_b64_tr_b16 a[174:175], v6 offset:14336
  v_mfma_f32_16x16x32_bf16 v[156:159], a[160:163], a[44:47], v[156:159]
  ds_read_b64_tr_b16 a[176:177], v7 offset:8192
  s_add_u32 s87, s86, 4096
  buffer_store_dwordx4 v[96:99], v1, s[8:11], s87 offen offset:1024 sc1
  v_mfma_f32_16x16x32_bf16 v[156:159], a[164:167], a[60:63], v[156:159]
  ds_read_b64_tr_b16 a[178:179], v7 offset:10240
  v_mfma_f32_16x16x32_bf16 v[152:155], a[164:167], a[56:59], v[152:155]
  ds_read_b64_tr_b16 a[180:181], v7 offset:12288
  v_cvt_pk_bf16_f32 v102, v116, v117
  v_mfma_f32_16x16x32_bf16 v[152:155], a[160:163], a[40:43], v[152:155]
  s_waitcnt lgkmcnt(7)
  ds_read_b64_tr_b16 a[182:183], v7 offset:14336
  v_mfma_f32_16x16x32_bf16 v[168:171], v[16:19], a[40:43], v[168:171]
  ds_read_b64_tr_b16 a[164:165], v8 offset:8192
  v_cvt_pk_bf16_f32 v103, v118, v119
  v_mfma_f32_16x16x32_bf16 v[168:171], v[20:23], a[56:59], v[168:171]
  ds_read_b64_tr_b16 a[166:167], v8 offset:10240
  v_mfma_f32_16x16x32_bf16 v[172:175], v[20:23], a[60:63], v[172:175]
  ds_read_b64_tr_b16 a[160:161], v8 offset:12288
  v_mfma_f32_16x16x32_bf16 v[172:175], v[16:19], a[44:47], v[172:175]
  ds_read_b64_tr_b16 a[162:163], v8 offset:14336
  s_add_u32 s87, s86, 4096
  buffer_store_dwordx4 v[100:103], v1, s[8:11], s87 offen offset:3072 sc1
  v_mfma_f32_16x16x32_bf16 v[188:191], v[24:27], a[44:47], v[188:191]
  ds_read_b64_tr_b16 v[20:21], v9 offset:8192
  v_mfma_f32_16x16x32_bf16 v[188:191], v[28:31], a[60:63], v[188:191]
  ds_read_b64_tr_b16 v[22:23], v9 offset:10240
  v_mfma_f32_16x16x32_bf16 v[184:187], v[28:31], a[56:59], v[184:187]
  ds_read_b64_tr_b16 v[16:17], v9 offset:12288
  v_mfma_f32_16x16x32_bf16 v[184:187], v[24:27], a[40:43], v[184:187]
  s_waitcnt lgkmcnt(7)
  ds_read_b64_tr_b16 v[18:19], v9 offset:14336
  v_mfma_f32_16x16x32_bf16 v[136:139], a[168:171], a[72:75], v[136:139]
  ds_read_b64_tr_b16 v[28:29], v2 offset:8192
  v_mfma_f32_16x16x32_bf16 v[136:139], a[172:175], a[88:91], v[136:139]
  ds_read_b64_tr_b16 v[30:31], v2 offset:10240
  v_mfma_f32_16x16x32_bf16 v[140:143], a[172:175], a[92:95], v[140:143]
  ds_read_b64_tr_b16 v[24:25], v2 offset:12288
  v_mfma_f32_16x16x32_bf16 v[140:143], a[168:171], a[76:79], v[140:143]
  ds_read_b64_tr_b16 v[26:27], v2 offset:14336
  v_mfma_f32_16x16x32_bf16 v[156:159], a[176:179], a[76:79], v[156:159]
  ds_read_b64_tr_b16 a[172:173], v3 offset:8192
  v_mfma_f32_16x16x32_bf16 v[156:159], a[180:183], a[92:95], v[156:159]
  ds_read_b64_tr_b16 a[174:175], v3 offset:10240
  v_mfma_f32_16x16x32_bf16 v[152:155], a[180:183], a[88:91], v[152:155]
  ds_read_b64_tr_b16 a[168:169], v3 offset:12288
  v_mfma_f32_16x16x32_bf16 v[152:155], a[176:179], a[72:75], v[152:155]
  s_waitcnt lgkmcnt(7)
  ds_read_b64_tr_b16 a[170:171], v3 offset:14336
  v_mfma_f32_16x16x32_bf16 v[168:171], a[164:167], a[72:75], v[168:171]
  ds_read_b64_tr_b16 a[180:181], v4 offset:8192
  v_mfma_f32_16x16x32_bf16 v[168:171], a[160:163], a[88:91], v[168:171]
  ds_read_b64_tr_b16 a[182:183], v4 offset:10240
  v_mfma_f32_16x16x32_bf16 v[172:175], a[160:163], a[92:95], v[172:175]
  ds_read_b64_tr_b16 a[176:177], v4 offset:12288
  v_mfma_f32_16x16x32_bf16 v[172:175], a[164:167], a[76:79], v[172:175]
  ds_read_b64_tr_b16 a[178:179], v4 offset:14336
  v_mfma_f32_16x16x32_bf16 v[188:191], v[20:23], a[76:79], v[188:191]
  ds_read_b64_tr_b16 a[160:161], v5 offset:8192
  v_mfma_f32_16x16x32_bf16 v[188:191], v[16:19], a[92:95], v[188:191]
  ds_read_b64_tr_b16 a[162:163], v5 offset:10240
  v_mfma_f32_16x16x32_bf16 v[184:187], v[16:19], a[88:91], v[184:187]
  ds_read_b64_tr_b16 a[164:165], v5 offset:12288
  v_mfma_f32_16x16x32_bf16 v[184:187], v[20:23], a[72:75], v[184:187]
  s_waitcnt lgkmcnt(7)
  ds_read_b64_tr_b16 a[166:167], v5 offset:14336
  v_mfma_f32_16x16x32_bf16 v[136:139], v[28:31], a[104:107], v[136:139]
  ds_read_b64_tr_b16 v[16:17], v2 offset:40960
  v_mfma_f32_16x16x32_bf16 v[136:139], v[24:27], a[120:123], v[136:139]
  ds_read_b64_tr_b16 v[18:19], v2 offset:43008
  v_mfma_f32_16x16x32_bf16 v[140:143], v[24:27], a[124:127], v[140:143]
  ds_read_b64_tr_b16 v[20:21], v2 offset:45056
  v_mfma_f32_16x16x32_bf16 v[140:143], v[28:31], a[108:111], v[140:143]
  ds_read_b64_tr_b16 v[22:23], v2 offset:47104
  v_mfma_f32_16x16x32_bf16 v[156:159], a[172:175], a[108:111], v[156:159]
  ds_read_b64_tr_b16 v[24:25], v3 offset:40960
  v_mfma_f32_16x16x32_bf16 v[156:159], a[168:171], a[124:127], v[156:159]
  ds_read_b64_tr_b16 v[26:27], v3 offset:43008
  v_mfma_f32_16x16x32_bf16 v[152:155], a[168:171], a[120:123], v[152:155]
  ds_read_b64_tr_b16 v[28:29], v3 offset:45056
  v_mfma_f32_16x16x32_bf16 v[152:155], a[172:175], a[104:107], v[152:155]
  s_waitcnt lgkmcnt(7)
HOP19:
  s_cbranch_execz WRET1
  ds_read_b64_tr_b16 v[30:31], v3 offset:47104
  v_mfma_f32_16x16x32_bf16 v[168:171], a[180:183], a[104:107], v[168:171]
  ds_read_b64_tr_b16 a[168:169], v4 offset:40960
  v_mfma_f32_16x16x32_bf16 v[168:171], a[176:179], a[120:123], v[168:171]
  ds_read_b64_tr_b16 a[170:171], v4 offset:43008
  v_mfma_f32_16x16x32_bf16 v[172:175], a[176:179], a[124:127], v[172:175]
  ds_read_b64_tr_b16 a[172:173], v4 offset:45056
  v_mfma_f32_16x16x32_bf16 v[172:175], a[180:183], a[108:111], v[172:175]
  ds_read_b64_tr_b16 a[174:175], v4 offset:47104
  v_mfma_f32_16x16x32_bf16 v[188:191], a[160:163], a[108:111], v[188:191]
  ds_read_b64_tr_b16 a[176:177], v5 offset:40960
  v_mfma_f32_16x16x32_bf16 v[188:191], a[164:167], a[124:127], v[188:191]
  ds_read_b64_tr_b16 a[178:179], v5 offset:43008
  v_mfma_f32_16x16x32_bf16 v[184:187], a[164:167], a[120:123], v[184:187]
  ds_read_b64_tr_b16 a[180:181], v5 offset:45056
  v_mfma_f32_16x16x32_bf16 v[184:187], a[160:163], a[104:107], v[184:187]
  s_waitcnt lgkmcnt(7)
  ds_read_b64_tr_b16 a[182:183], v5 offset:47104
  v_mfma_f32_16x16x32_bf16 v[136:139], v[16:19], a[136:139], v[136:139]
  ds_read_b64_tr_b16 a[164:165], v2 offset:57344
  v_mfma_f32_16x16x32_bf16 v[136:139], v[20:23], a[152:155], v[136:139]
  ds_read_b64_tr_b16 a[166:167], v2 offset:59392
  v_mfma_f32_16x16x32_bf16 v[140:143], v[20:23], a[156:159], v[140:143]
  ds_read_b64_tr_b16 a[160:161], v2 offset:61440
  v_mfma_f32_16x16x32_bf16 v[140:143], v[16:19], a[140:143], v[140:143]
  ds_read_b64_tr_b16 a[162:163], v2 offset:63488
  v_mfma_f32_16x16x32_bf16 v[156:159], v[24:27], a[140:143], v[156:159]
  ds_read_b64_tr_b16 v[20:21], v3 offset:57344
  v_add_u32 v38, s46, v0
  s_waitcnt vmcnt(0)
  s_mov_b64 exec, 1
  buffer_store_dword v38, v0, s[8:11], s81 offen offset:0 sc1
  s_mov_b64 exec, -1
  v_mfma_f32_16x16x32_bf16 v[156:159], v[28:31], a[156:159], v[156:159]
  ds_read_b64_tr_b16 v[22:23], v3 offset:59392
  v_mfma_f32_16x16x32_bf16 v[152:155], v[28:31], a[152:155], v[152:155]
  ds_read_b64_tr_b16 v[16:17], v3 offset:61440
  v_mfma_f32_16x16x32_bf16 v[152:155], v[24:27], a[136:139], v[152:155]
  s_waitcnt lgkmcnt(7)
  ds_read_b64_tr_b16 v[18:19], v3 offset:63488
  v_mfma_f32_16x16x32_bf16 v[168:171], a[168:171], a[136:139], v[168:171]
  ds_read_b64_tr_b16 v[28:29], v4 offset:57344
  v_mfma_f32_16x16x32_bf16 v[168:171], a[172:175], a[152:155], v[168:171]
  ds_read_b64_tr_b16 v[30:31], v4 offset:59392
  v_mfma_f32_16x16x32_bf16 v[172:175], a[172:175], a[156:159], v[172:175]
  ds_read_b64_tr_b16 v[24:25], v4 offset:61440
  v_mfma_f32_16x16x32_bf16 v[172:175], a[168:171], a[140:143], v[172:175]
  ds_read_b64_tr_b16 v[26:27], v4 offset:63488
  v_mfma_f32_16x16x32_bf16 v[188:191], a[176:179], a[140:143], v[188:191]
  ds_read_b64_tr_b16 a[172:173], v5 offset:57344
  v_mfma_f32_16x16x32_bf16 v[188:191], a[180:183], a[156:159], v[188:191]
  ds_read_b64_tr_b16 a[174:175], v5 offset:59392
  v_mfma_f32_16x16x32_bf16 v[184:187], a[180:183], a[152:155], v[184:187]
  ds_read_b64_tr_b16 a[168:169], v5 offset:61440
  v_mfma_f32_16x16x32_bf16 v[184:187], a[176:179], a[136:139], v[184:187]
  s_waitcnt lgkmcnt(7)
  ds_read_b64_tr_b16 a[170:171], v5 offset:63488
  v_mfma_f32_16x16x32_bf16 v[136:139], a[164:167], a[196:199], v[136:139]
  ds_read_b64_tr_b16 a[180:181], v6 offset:40960
  v_mfma_f32_16x16x32_bf16 v[136:139], a[160:163], a[212:215], v[136:139]
  ds_read_b64_tr_b16 a[182:183], v6 offset:43008
  v_mfma_f32_16x16x32_bf16 v[140:143], a[160:163], a[216:219], v[140:143]
  ds_read_b64_tr_b16 a[176:177], v6 offset:45056
  v_mfma_f32_16x16x32_bf16 v[140:143], a[164:167], a[200:203], v[140:143]
  ds_read_b64_tr_b16 a[178:179], v6 offset:47104
  v_mfma_f32_16x16x32_bf16 v[156:159], v[20:23], a[200:203], v[156:159]
  ds_read_b64_tr_b16 a[160:161], v7 offset:40960
  v_mfma_f32_16x16x32_bf16 v[156:159], v[16:19], a[216:219], v[156:159]
  ds_read_b64_tr_b16 a[162:163], v7 offset:43008
  v_mfma_f32_16x16x32_bf16 v[152:155], v[16:19], a[212:215], v[152:155]
  ds_read_b64_tr_b16 a[164:165], v7 offset:45056
  v_cvt_pk_bf16_f32 v136, v136, v137
  v_cvt_pk_bf16_f32 v137, v138, v139
  v_cvt_pk_bf16_f32 v140, v140, v141
  v_cvt_pk_bf16_f32 v141, v142, v143
  v_mfma_f32_16x16x32_bf16 v[152:155], v[20:23], a[196:199], v[152:155]
  s_waitcnt lgkmcnt(7)
  ds_read_b64_tr_b16 a[166:167], v7 offset:47104
  v_mfma_f32_16x16x32_bf16 v[168:171], v[28:31], a[196:199], v[168:171]
  ds_read_b64_tr_b16 v[16:17], v8 offset:40960
  v_mfma_f32_16x16x32_bf16 v[168:171], v[24:27], a[212:215], v[168:171]
  ds_read_b64_tr_b16 v[18:19], v8 offset:43008
  v_mfma_f32_16x16x32_bf16 v[172:175], v[24:27], a[216:219], v[172:175]
  ds_read_b64_tr_b16 v[20:21], v8 offset:45056
  v_cvt_pk_bf16_f32 v138, v152, v153
  v_cvt_pk_bf16_f32 v139, v154, v155
  v_mfma_f32_16x16x32_bf16 v[172:175], v[28:31], a[200:203], v[172:175]
  ds_read_b64_tr_b16 v[22:23], v8 offset:47104
  v_mfma_f32_16x16x32_bf16 v[188:191], a[172:175], a[200:203], v[188:191]
  ds_read_b64_tr_b16 v[24:25], v9 offset:40960
  v_mfma_f32_16x16x32_bf16 v[188:191], a[168:171], a[216:219], v[188:191]
  ds_read_b64_tr_b16 v[26:27], v9 offset:43008
  s_add_u32 s87, s86, 8192
  buffer_store_dwordx4 v[136:139], v1, s[8:11], s87 offen offset:0 sc1
  v_mfma_f32_16x16x32_bf16 v[184:187], a[168:171], a[212:215], v[184:187]
  ds_read_b64_tr_b16 v[28:29], v9 offset:45056
  v_cvt_pk_bf16_f32 v142, v156, v157
  v_cvt_pk_bf16_f32 v143, v158, v159
  v_mfma_f32_16x16x32_bf16 v[184:187], a[172:175], a[196:199], v[184:187]
  s_waitcnt lgkmcnt(7)
  ds_read_b64_tr_b16 v[30:31], v9 offset:47104
  v_mfma_f32_16x16x32_bf16 v[128:131], a[180:183], a[220:223], v[128:131]
  ds_read_b64_tr_b16 a[168:169], v6 offset:57344
  v_mfma_f32_16x16x32_bf16 v[128:131], a[176:179], a[236:239], v[128:131]
  ds_read_b64_tr_b16 a[170:171], v6 offset:59392
  s_add_u32 s87, s86, 8192
  buffer_store_dwordx4 v[140:143], v1, s[8:11], s87 offen offset:2048 sc1
  v_mfma_f32_16x16x32_bf16 v[132:135], a[176:179], a[240:243], v[132:135]
  ds_read_b64_tr_b16 a[172:173], v6 offset:61440
  v_cvt_pk_bf16_f32 v168, v168, v169
  v_cvt_pk_bf16_f32 v169, v170, v171
  v_cvt_pk_bf16_f32 v172, v172, v173
  v_cvt_pk_bf16_f32 v173, v174, v175
  v_mfma_f32_16x16x32_bf16 v[132:135], a[180:183], a[224:227], v[132:135]
  ds_read_b64_tr_b16 a[174:175], v6 offset:63488
  v_cvt_pk_bf16_f32 v170, v184, v185
  v_cvt_pk_bf16_f32 v171, v186, v187
  v_mfma_f32_16x16x32_bf16 v[148:151], a[160:163], a[224:227], v[148:151]
  ds_read_b64_tr_b16 a[176:177], v7 offset:57344
  v_mfma_f32_16x16x32_bf16 v[148:151], a[164:167], a[240:243], v[148:151]
  ds_read_b64_tr_b16 a[178:179], v7 offset:59392
  v_mfma_f32_16x16x32_bf16 v[144:147], a[164:167], a[236:239], v[144:147]
  ds_read_b64_tr_b16 a[180:181], v7 offset:61440
  s_add_u32 s87, s86, 8192
  buffer_store_dwordx4 v[168:171], v1, s[8:11], s87 offen offset:1024 sc1
  v_mfma_f32_16x16x32_bf16 v[144:147], a[160:163], a[220:223], v[144:147]
  s_waitcnt lgkmcnt(7)
  ds_read_b64_tr_b16 a[182:183], v7 offset:63488
  v_cvt_pk_bf16_f32 v174, v188, v189
  v_cvt_pk_bf16_f32 v175, v190, v191
  v_mfma_f32_16x16x32_bf16 v[160:163], v[16:19], a[220:223], v[160:163]
  ds_read_b64_tr_b16 a[164:165], v8 offset:57344
  v_mfma_f32_16x16x32_bf16 v[160:163], v[20:23], a[236:239], v[160:163]
  ds_read_b64_tr_b16 a[166:167], v8 offset:59392
  v_mfma_f32_16x16x32_bf16 v[164:167], v[20:23], a[240:243], v[164:167]
  ds_read_b64_tr_b16 a[160:161], v8 offset:61440
  s_add_u32 s87, s86, 8192
  buffer_store_dwordx4 v[172:175], v1, s[8:11], s87 offen offset:3072 sc1
  v_mfma_f32_16x16x32_bf16 v[164:167], v[16:19], a[224:227], v[164:167]
  ds_read_b64_tr_b16 a[162:163], v8 offset:63488
  v_mfma_f32_16x16x32_bf16 v[180:183], v[24:27], a[224:227], v[180:183]
  ds_read_b64_tr_b16 v[20:21], v9 offset:57344
  v_mfma_f32_16x16x32_bf16 v[180:183], v[28:31], a[240:243], v[180:183]
  ds_read_b64_tr_b16 v[22:23], v9 offset:59392
  v_mfma_f32_16x16x32_bf16 v[176:179], v[28:31], a[236:239], v[176:179]
  ds_read_b64_tr_b16 v[16:17], v9 offset:61440
  v_mfma_f32_16x16x32_bf16 v[176:179], v[24:27], a[220:223], v[176:179]
  s_waitcnt lgkmcnt(7)
  ds_read_b64_tr_b16 v[18:19], v9 offset:63488
  v_mfma_f32_16x16x32_bf16 v[128:131], a[168:171], a[0:3], v[128:131]
  ds_read_b64_tr_b16 v[28:29], v6 offset:24576
  v_mfma_f32_16x16x32_bf16 v[128:131], a[172:175], a[16:19], v[128:131]
  ds_read_b64_tr_b16 v[30:31], v6 offset:26624
  v_mfma_f32_16x16x32_bf16 v[132:135], a[172:175], a[20:23], v[132:135]
  ds_read_b64_tr_b16 v[24:25], v6 offset:28672
  v_mfma_f32_16x16x32_bf16 v[132:135], a[168:171], a[4:7], v[132:135]
  ds_read_b64_tr_b16 v[26:27], v6 offset:30720
  v_mfma_f32_16x16x32_bf16 v[148:151], a[176:179], a[4:7], v[148:151]
  ds_read_b64_tr_b16 a[172:173], v7 offset:24576
  v_mfma_f32_16x16x32_bf16 v[148:151], a[180:183], a[20:23], v[148:151]
  ds_read_b64_tr_b16 a[174:175], v7 offset:26624
  v_mfma_f32_16x16x32_bf16 v[144:147], a[180:183], a[16:19], v[144:147]
  ds_read_b64_tr_b16 a[168:169], v7 offset:28672
  v_mfma_f32_16x16x32_bf16 v[144:147], a[176:179], a[0:3], v[144:147]
  s_waitcnt lgkmcnt(7)
  ds_read_b64_tr_b16 a[170:171], v7 offset:30720
  v_mfma_f32_16x16x32_bf16 v[160:163], a[164:167], a[0:3], v[160:163]
  ds_read_b64_tr_b16 a[180:181], v8 offset:24576
  v_mfma_f32_16x16x32_bf16 v[160:163], a[160:163], a[16:19], v[160:163]
  ds_read_b64_tr_b16 a[182:183], v8 offset:26624
  v_mfma_f32_16x16x32_bf16 v[164:167], a[160:163], a[20:23], v[164:167]
  ds_read_b64_tr_b16 a[176:177], v8 offset:28672
  v_mfma_f32_16x16x32_bf16 v[164:167], a[164:167], a[4:7], v[164:167]
  ds_read_b64_tr_b16 a[178:179], v8 offset:30720
  v_mfma_f32_16x16x32_bf16 v[180:183], v[20:23], a[4:7], v[180:183]
  ds_read_b64_tr_b16 a[160:161], v9 offset:24576
  v_mfma_f32_16x16x32_bf16 v[180:183], v[16:19], a[20:23], v[180:183]
  ds_read_b64_tr_b16 a[162:163], v9 offset:26624
  v_mfma_f32_16x16x32_bf16 v[176:179], v[16:19], a[16:19], v[176:179]
  ds_read_b64_tr_b16 a[164:165], v9 offset:28672
  v_mfma_f32_16x16x32_bf16 v[176:179], v[20:23], a[0:3], v[176:179]
  s_waitcnt lgkmcnt(7)
  ds_read_b64_tr_b16 a[166:167], v9 offset:30720
  v_mfma_f32_16x16x32_bf16 v[128:131], v[28:31], a[32:35], v[128:131]
  ds_read_b64_tr_b16 v[16:17], v6 offset:8192
  v_mfma_f32_16x16x32_bf16 v[128:131], v[24:27], a[48:51], v[128:131]
  ds_read_b64_tr_b16 v[18:19], v6 offset:10240
  v_mfma_f32_16x16x32_bf16 v[132:135], v[24:27], a[52:55], v[132:135]
  ds_read_b64_tr_b16 v[20:21], v6 offset:12288
  v_mfma_f32_16x16x32_bf16 v[132:135], v[28:31], a[36:39], v[132:135]
  ds_read_b64_tr_b16 v[22:23], v6 offset:14336
  v_mfma_f32_16x16x32_bf16 v[148:151], a[172:175], a[36:39], v[148:151]
  ds_read_b64_tr_b16 v[24:25], v7 offset:8192
  v_mfma_f32_16x16x32_bf16 v[148:151], a[168:171], a[52:55], v[148:151]
  ds_read_b64_tr_b16 v[26:27], v7 offset:10240
  s_xor_b32 s84, s81, 1536
  s_add_u32 s84, s84, 0
  buffer_load_dword v34, v37, s[8:11], s84 offen sc1
  v_mfma_f32_16x16x32_bf16 v[144:147], a[168:171], a[48:51], v[144:147]
  ds_read_b64_tr_b16 v[28:29], v7 offset:12288
  s_xor_b32 s91, s81, 512
  s_add_u32 s91, s91, 0
  buffer_load_dword v39, v37, s[8:11], s91 offen sc1
  v_mfma_f32_16x16x32_bf16 v[144:147], a[172:175], a[32:35], v[144:147]
  s_waitcnt lgkmcnt(7)
  ds_read_b64_tr_b16 v[30:31], v7 offset:14336
  v_mfma_f32_16x16x32_bf16 v[160:163], a[180:183], a[32:35], v[160:163]
  ds_read_b64_tr_b16 a[168:169], v8 offset:8192
  v_mfma_f32_16x16x32_bf16 v[160:163], a[176:179], a[48:51], v[160:163]
  ds_read_b64_tr_b16 a[170:171], v8 offset:10240
  v_mfma_f32_16x16x32_bf16 v[164:167], a[176:179], a[52:55], v[164:167]
  ds_read_b64_tr_b16 a[172:173], v8 offset:12288
  v_mfma_f32_16x16x32_bf16 v[164:167], a[180:183], a[36:39], v[164:167]
  ds_read_b64_tr_b16 a[174:175], v8 offset:14336
  v_mfma_f32_16x16x32_bf16 v[180:183], a[160:163], a[36:39], v[180:183]
  ds_read_b64_tr_b16 a[176:177], v9 offset:8192
  v_mfma_f32_16x16x32_bf16 v[180:183], a[164:167], a[52:55], v[180:183]
  ds_read_b64_tr_b16 a[178:179], v9 offset:10240
  v_mfma_f32_16x16x32_bf16 v[176:179], a[164:167], a[48:51], v[176:179]
  ds_read_b64_tr_b16 a[180:181], v9 offset:12288
  v_mfma_f32_16x16x32_bf16 v[176:179], a[160:163], a[32:35], v[176:179]
  s_waitcnt lgkmcnt(7)
  ds_read_b64_tr_b16 a[182:183], v9 offset:14336
  v_add_u32 v38, s46, v0
  s_waitcnt vmcnt(2)
  s_mov_b64 exec, 1
  buffer_store_dword v38, v0, s[8:11], s81 offen offset:16 sc1
  s_mov_b64 exec, -1
  v_mfma_f32_16x16x32_bf16 v[128:131], v[16:19], a[64:67], v[128:131]
  ds_read_b64_tr_b16 a[164:165], v2 offset:8192
  v_mfma_f32_16x16x32_bf16 v[128:131], v[20:23], a[80:83], v[128:131]
  ds_read_b64_tr_b16 a[166:167], v2 offset:10240
  v_mfma_f32_16x16x32_bf16 v[132:135], v[20:23], a[84:87], v[132:135]
  ds_read_b64_tr_b16 a[160:161], v2 offset:12288
  v_mfma_f32_16x16x32_bf16 v[132:135], v[16:19], a[68:71], v[132:135]
  ds_read_b64_tr_b16 a[162:163], v2 offset:14336
  s_xor_b32 s82, s81, 1024
  s_add_u32 s82, s82, 16
  buffer_load_dword v36, v37, s[8:11], s82 offen sc1
  v_mfma_f32_16x16x32_bf16 v[148:151], v[24:27], a[68:71], v[148:151]
  ds_read_b64_tr_b16 v[20:21], v3 offset:8192
  v_mfma_f32_16x16x32_bf16 v[148:151], v[28:31], a[84:87], v[148:151]
  ds_read_b64_tr_b16 v[22:23], v3 offset:10240
  v_mfma_f32_16x16x32_bf16 v[144:147], v[28:31], a[80:83], v[144:147]
  ds_read_b64_tr_b16 v[16:17], v3 offset:12288
  v_mfma_f32_16x16x32_bf16 v[144:147], v[24:27], a[64:67], v[144:147]
  s_waitcnt lgkmcnt(7)
  ds_read_b64_tr_b16 v[18:19], v3 offset:14336
  v_mfma_f32_16x16x32_bf16 v[160:163], a[168:171], a[64:67], v[160:163]
  ds_read_b64_tr_b16 v[28:29], v4 offset:8192
  v_mfma_f32_16x16x32_bf16 v[160:163], a[172:175], a[80:83], v[160:163]
  ds_read_b64_tr_b16 v[30:31], v4 offset:10240
  v_mfma_f32_16x16x32_bf16 v[164:167], a[172:175], a[84:87], v[164:167]
  ds_read_b64_tr_b16 v[24:25], v4 offset:12288
  v_mfma_f32_16x16x32_bf16 v[164:167], a[168:171], a[68:71], v[164:167]
  ds_read_b64_tr_b16 v[26:27], v4 offset:14336
  v_mfma_f32_16x16x32_bf16 v[180:183], a[176:179], a[68:71], v[180:183]
  ds_read_b64_tr_b16 a[172:173], v5 offset:8192
  v_mfma_f32_16x16x32_bf16 v[180:183], a[180:183], a[84:87], v[180:183]
  ds_read_b64_tr_b16 a[174:175], v5 offset:10240
  v_mfma_f32_16x16x32_bf16 v[176:179], a[180:183], a[80:83], v[176:179]
  ds_read_b64_tr_b16 a[168:169], v5 offset:12288
  v_mfma_f32_16x16x32_bf16 v[176:179], a[176:179], a[64:67], v[176:179]
  s_waitcnt lgkmcnt(7)
  ds_read_b64_tr_b16 a[170:171], v5 offset:14336
  v_mfma_f32_16x16x32_bf16 v[128:131], a[164:167], a[96:99], v[128:131]
  ds_read_b64_tr_b16 a[180:181], v2 offset:40960
  v_mfma_f32_16x16x32_bf16 v[128:131], a[160:163], a[112:115], v[128:131]
  ds_read_b64_tr_b16 a[182:183], v2 offset:43008
  s_waitcnt vmcnt(3)
  v_cmp_ne_u32 vcc, s46, v34
  s_nop 4
  s_cbranch_vccz PL14_adaLN_cond__sliding_local_dilated__swiglu_ffn__prompt_kernelx
  s_mov_b32 s83, 60000
PL14_adaLN_cond__sliding_local_dilated__swiglu_ffn__prompt_kernel:
  buffer_load_dword v34, v37, s[8:11], s84 offen sc1
  s_sub_u32 s83, s83, 1
  s_cmp_eq_u32 s83, 0
  s_waitcnt vmcnt(0)
  s_cbranch_scc1 PL14_adaLN_cond__sliding_local_dilated__swiglu_ffn__prompt_kernelx
  v_cmp_ne_u32 vcc, s46, v34
  s_nop 4
  s_cbranch_vccnz PL14_adaLN_cond__sliding_local_dilated__swiglu_ffn__prompt_kernel
PL14_adaLN_cond__sliding_local_dilated__swiglu_ffn__prompt_kernelx:
  v_mfma_f32_16x16x32_bf16 v[132:135], a[160:163], a[116:119], v[132:135]
  ds_read_b64_tr_b16 a[176:177], v2 offset:45056
  s_xor_b32 s55, s86, 196608
  s_add_u32 s55, s55, 0
  buffer_load_dwordx4 v[88:91], v1, s[8:11], s55 offen offset:0 sc1
  v_mfma_f32_16x16x32_bf16 v[132:135], a[164:167], a[100:103], v[132:135]
  ds_read_b64_tr_b16 a[178:179], v2 offset:47104
  s_xor_b32 s55, s86, 196608
  s_add_u32 s55, s55, 0
  buffer_load_dwordx4 v[120:123], v1, s[8:11], s55 offen offset:1024 sc1
  v_mfma_f32_16x16x32_bf16 v[148:151], v[20:23], a[100:103], v[148:151]
  ds_read_b64_tr_b16 a[160:161], v3 offset:40960
  s_xor_b32 s55, s86, 196608
  s_add_u32 s55, s55, 0
  buffer_load_dwordx4 v[92:95], v1, s[8:11], s55 offen offset:2048 sc1
  v_mfma_f32_16x16x32_bf16 v[148:151], v[16:19], a[116:119], v[148:151]
  ds_read_b64_tr_b16 a[162:163], v3 offset:43008
  s_xor_b32 s55, s86, 196608
  s_add_u32 s55, s55, 0
  buffer_load_dwordx4 v[124:127], v1, s[8:11], s55 offen offset:3072 sc1
  v_mfma_f32_16x16x32_bf16 v[144:147], v[16:19], a[112:115], v[144:147]
  ds_read_b64_tr_b16 a[164:165], v3 offset:45056
  s_waitcnt vmcnt(6)
  v_cmp_ne_u32 vcc, s46, v39
  s_nop 4
  s_cbranch_vccz PL15_adaLN_cond__sliding_local_dilated__swiglu_ffn__prompt_kernelx
  s_mov_b32 s83, 60000
PL15_adaLN_cond__sliding_local_dilated__swiglu_ffn__prompt_kernel:
  buffer_load_dword v39, v37, s[8:11], s91 offen sc1
  s_sub_u32 s83, s83, 1
  s_cmp_eq_u32 s83, 0
  s_waitcnt vmcnt(0)
  s_cbranch_scc1 PL15_adaLN_cond__sliding_local_dilated__swiglu_ffn__prompt_kernelx
  v_cmp_ne_u32 vcc, s46, v39
  s_nop 4
  s_cbranch_vccnz PL15_adaLN_cond__sliding_local_dilated__swiglu_ffn__prompt_kernel
PL15_adaLN_cond__sliding_local_dilated__swiglu_ffn__prompt_kernelx:
  v_mfma_f32_16x16x32_bf16 v[144:147], v[20:23], a[96:99], v[144:147]
  s_waitcnt lgkmcnt(7)
  ds_read_b64_tr_b16 a[166:167], v3 offset:47104
  s_xor_b32 s55, s86, 65536
  s_add_u32 s55, s55, 4096
  buffer_load_dwordx4 v[80:83], v1, s[8:11], s55 offen offset:0 sc1
  v_mfma_f32_16x16x32_bf16 v[160:163], v[28:31], a[96:99], v[160:163]
  ds_read_b64_tr_b16 v[16:17], v4 offset:40960
  s_xor_b32 s55, s86, 65536
  s_add_u32 s55, s55, 4096
  buffer_load_dwordx4 v[112:115], v1, s[8:11], s55 offen offset:1024 sc1
  v_mfma_f32_16x16x32_bf16 v[160:163], v[24:27], a[112:115], v[160:163]
  ds_read_b64_tr_b16 v[18:19], v4 offset:43008
  s_xor_b32 s55, s86, 65536
  s_add_u32 s55, s55, 4096
  buffer_load_dwordx4 v[84:87], v1, s[8:11], s55 offen offset:2048 sc1
  v_mfma_f32_16x16x32_bf16 v[164:167], v[24:27], a[116:119], v[164:167]
  ds_read_b64_tr_b16 v[20:21], v4 offset:45056
  s_xor_b32 s55, s86, 65536
  s_add_u32 s55, s55, 4096
  buffer_load_dwordx4 v[116:119], v1, s[8:11], s55 offen offset:3072 sc1
  v_mfma_f32_16x16x32_bf16 v[164:167], v[28:31], a[100:103], v[164:167]
  ds_read_b64_tr_b16 v[22:23], v4 offset:47104
  v_mfma_f32_16x16x32_bf16 v[180:183], a[172:175], a[100:103], v[180:183]
  ds_read_b64_tr_b16 v[24:25], v5 offset:40960
  v_mfma_f32_16x16x32_bf16 v[180:183], a[168:171], a[116:119], v[180:183]
  ds_read_b64_tr_b16 v[26:27], v5 offset:43008
  s_waitcnt vmcnt(8)
  v_cmp_ne_u32 vcc, s46, v36
  s_mov_b32 s87, 0
  s_nop 3
  s_cbranch_vccnz XL16_adaLN_cond__sliding_local_dilated__swiglu_ffn__prompt_kernel
  s_xor_b32 s55, s86, 131072
  s_add_u32 s55, s55, 8192
  buffer_load_dwordx4 v[152:155], v1, s[8:11], s55 offen offset:0 sc1
  buffer_load_dwordx4 v[184:187], v1, s[8:11], s55 offen offset:1024 sc1
  buffer_load_dwordx4 v[156:159], v1, s[8:11], s55 offen offset:2048 sc1
  buffer_load_dwordx4 v[188:191], v1, s[8:11], s55 offen offset:3072 sc1
  s_mov_b32 s87, 1
XL16_adaLN_cond__sliding_local_dilated__swiglu_ffn__prompt_kernel:
  v_mfma_f32_16x16x32_bf16 v[176:179], a[168:171], a[112:115], v[176:179]
  ds_read_b64_tr_b16 v[28:29], v5 offset:45056
  v_mfma_f32_16x16x32_bf16 v[176:179], a[172:175], a[96:99], v[176:179]
  s_waitcnt lgkmcnt(7)
  ds_read_b64_tr_b16 v[30:31], v5 offset:47104
  v_mfma_f32_16x16x32_bf16 v[128:131], a[180:183], a[128:131], v[128:131]
  ds_read_b64_tr_b16 a[168:169], v2 offset:57344
  v_mfma_f32_16x16x32_bf16 v[128:131], a[176:179], a[144:147], v[128:131]
  ds_read_b64_tr_b16 a[170:171], v2 offset:59392
  v_mfma_f32_16x16x32_bf16 v[132:135], a[176:179], a[148:151], v[132:135]
  ds_read_b64_tr_b16 a[172:173], v2 offset:61440
  v_mfma_f32_16x16x32_bf16 v[132:135], a[180:183], a[132:135], v[132:135]
  ds_read_b64_tr_b16 a[174:175], v2 offset:63488
  v_mfma_f32_16x16x32_bf16 v[148:151], a[160:163], a[132:135], v[148:151]
  ds_read_b64_tr_b16 a[176:177], v3 offset:57344
  v_mfma_f32_16x16x32_bf16 v[148:151], a[164:167], a[148:151], v[148:151]
  ds_read_b64_tr_b16 a[178:179], v3 offset:59392
  v_mfma_f32_16x16x32_bf16 v[144:147], a[164:167], a[144:147], v[144:147]
  ds_read_b64_tr_b16 a[180:181], v3 offset:61440
  v_mfma_f32_16x16x32_bf16 v[144:147], a[160:163], a[128:131], v[144:147]
  s_waitcnt lgkmcnt(7)
  ds_read_b64_tr_b16 a[182:183], v3 offset:63488
  v_mfma_f32_16x16x32_bf16 v[160:163], v[16:19], a[128:131], v[160:163]
  ds_read_b64_tr_b16 a[164:165], v4 offset:57344
  v_mfma_f32_16x16x32_bf16 v[160:163], v[20:23], a[144:147], v[160:163]
  ds_read_b64_tr_b16 a[166:167], v4 offset:59392
  v_mfma_f32_16x16x32_bf16 v[164:167], v[20:23], a[148:151], v[164:167]
  ds_read_b64_tr_b16 a[160:161], v4 offset:61440
  v_mfma_f32_16x16x32_bf16 v[164:167], v[16:19], a[132:135], v[164:167]
  ds_read_b64_tr_b16 a[162:163], v4 offset:63488
  v_mfma_f32_16x16x32_bf16 v[180:183], v[24:27], a[132:135], v[180:183]
  ds_read_b64_tr_b16 v[20:21], v5 offset:57344
  v_mfma_f32_16x16x32_bf16 v[180:183], v[28:31], a[148:151], v[180:183]
  ds_read_b64_tr_b16 v[22:23], v5 offset:59392
  v_mfma_f32_16x16x32_bf16 v[176:179], v[28:31], a[144:147], v[176:179]
  ds_read_b64_tr_b16 v[16:17], v5 offset:61440
  v_mfma_f32_16x16x32_bf16 v[176:179], v[24:27], a[128:131], v[176:179]
  s_waitcnt lgkmcnt(7)
  ds_read_b64_tr_b16 v[18:19], v5 offset:63488
  v_mfma_f32_16x16x32_bf16 v[128:131], a[168:171], a[188:191], v[128:131]
  v_mfma_f32_16x16x32_bf16 v[128:131], a[172:175], a[204:207], v[128:131]
  v_mfma_f32_16x16x32_bf16 v[132:135], a[172:175], a[208:211], v[132:135]
  v_mfma_f32_16x16x32_bf16 v[132:135], a[168:171], a[192:195], v[132:135]
  v_mfma_f32_16x16x32_bf16 v[148:151], a[176:179], a[192:195], v[148:151]
  v_mfma_f32_16x16x32_bf16 v[148:151], a[180:183], a[208:211], v[148:151]
  v_mfma_f32_16x16x32_bf16 v[144:147], a[180:183], a[204:207], v[144:147]
  v_mfma_f32_16x16x32_bf16 v[144:147], a[176:179], a[188:191], v[144:147]
  s_waitcnt lgkmcnt(0)
  v_mfma_f32_16x16x32_bf16 v[160:163], a[164:167], a[188:191], v[160:163]
  v_mfma_f32_16x16x32_bf16 v[160:163], a[160:163], a[204:207], v[160:163]
  v_mfma_f32_16x16x32_bf16 v[164:167], a[160:163], a[208:211], v[164:167]
  v_mfma_f32_16x16x32_bf16 v[164:167], a[164:167], a[192:195], v[164:167]
  v_mfma_f32_16x16x32_bf16 v[180:183], v[20:23], a[192:195], v[180:183]
  v_mfma_f32_16x16x32_bf16 v[180:183], v[16:19], a[208:211], v[180:183]
  v_mfma_f32_16x16x32_bf16 v[176:179], v[16:19], a[204:207], v[176:179]
  v_mfma_f32_16x16x32_bf16 v[176:179], v[20:23], a[188:191], v[176:179]
  s_waitcnt vmcnt(0)
  v_mfma_f32_16x16x32_bf16 v[208:211], v[52:55], v[88:91], v[208:211]
  v_mfma_f32_16x16x32_bf16 v[212:215], v[54:57], v[88:91], v[212:215]
  v_mfma_f32_16x16x32_bf16 v[216:219], v[58:61], v[120:123], v[216:219]
  v_mfma_f32_16x16x32_bf16 v[220:223], v[60:63], v[120:123], v[220:223]
  v_mfma_f32_16x16x32_bf16 v[224:227], v[52:55], v[92:95], v[224:227]
  v_mfma_f32_16x16x32_bf16 v[228:231], v[54:57], v[92:95], v[228:231]
  v_mfma_f32_16x16x32_bf16 v[232:235], v[58:61], v[124:127], v[232:235]
  v_mfma_f32_16x16x32_bf16 v[236:239], v[60:63], v[124:127], v[236:239]
  v_mfma_f32_16x16x32_bf16 v[208:211], v[52:55], v[80:83], v[208:211]
  v_mfma_f32_16x16x32_bf16 v[212:215], v[54:57], v[80:83], v[212:215]
  v_mfma_f32_16x16x32_bf16 v[216:219], v[58:61], v[112:115], v[216:219]
  v_mfma_f32_16x16x32_bf16 v[220:223], v[60:63], v[112:115], v[220:223]
  v_mfma_f32_16x16x32_bf16 v[224:227], v[52:55], v[84:87], v[224:227]
  v_mfma_f32_16x16x32_bf16 v[228:231], v[54:57], v[84:87], v[228:231]
  v_mfma_f32_16x16x32_bf16 v[232:235], v[58:61], v[116:119], v[232:235]
  v_mfma_f32_16x16x32_bf16 v[236:239], v[60:63], v[116:119], v[236:239]
  s_nop 0
  v_fmac_f32 v208, v240, v128
  v_fmac_f32 v209, v241, v129
  v_fmac_f32 v210, v242, v130
  v_fmac_f32 v211, v243, v131
  v_fmac_f32 v212, v244, v144
  v_fmac_f32 v213, v245, v145
  v_fmac_f32 v214, v246, v146
  v_fmac_f32 v215, v247, v147
  v_fmac_f32 v224, v240, v132
  v_fmac_f32 v225, v241, v133
  v_fmac_f32 v226, v242, v134
  v_fmac_f32 v227, v243, v135
  v_fmac_f32 v228, v244, v148
  v_fmac_f32 v229, v245, v149
  v_fmac_f32 v230, v246, v150
  v_fmac_f32 v231, v247, v151
  v_fmac_f32 v216, v248, v160
  v_fmac_f32 v217, v249, v161
  v_fmac_f32 v218, v250, v162
  v_fmac_f32 v219, v251, v163
  v_fmac_f32 v220, v252, v176
  v_fmac_f32 v221, v253, v177
  v_fmac_f32 v222, v254, v178
  v_fmac_f32 v223, v255, v179
  v_fmac_f32 v232, v248, v164
  v_fmac_f32 v233, v249, v165
  v_fmac_f32 v234, v250, v166
  v_fmac_f32 v235, v251, v167
  v_fmac_f32 v236, v252, v180
  v_fmac_f32 v237, v253, v181
  v_fmac_f32 v238, v254, v182
  v_fmac_f32 v239, v255, v183
  s_cmp_eq_u32 s87, 1
  s_cbranch_scc1 XA17_adaLN_cond__sliding_local_dilated__swiglu_ffn__prompt_kernelx
  s_mov_b32 s83, 60000
XA17_adaLN_cond__sliding_local_dilated__swiglu_ffn__prompt_kernel:
  buffer_load_dword v36, v37, s[8:11], s82 offen sc1
  s_sub_u32 s83, s83, 1
  s_cmp_eq_u32 s83, 0
  s_waitcnt vmcnt(0)
  s_cbranch_scc1 XA17_adaLN_cond__sliding_local_dilated__swiglu_ffn__prompt_kernely
  v_cmp_ne_u32 vcc, s46, v36
  s_nop 4
  s_cbranch_vccnz XA17_adaLN_cond__sliding_local_dilated__swiglu_ffn__prompt_kernel
XA17_adaLN_cond__sliding_local_dilated__swiglu_ffn__prompt_kernely:
  s_xor_b32 s55, s86, 131072
  s_add_u32 s55, s55, 8192
  buffer_load_dwordx4 v[152:155], v1, s[8:11], s55 offen offset:0 sc1
  buffer_load_dwordx4 v[184:187], v1, s[8:11], s55 offen offset:1024 sc1
  buffer_load_dwordx4 v[156:159], v1, s[8:11], s55 offen offset:2048 sc1
  buffer_load_dwordx4 v[188:191], v1, s[8:11], s55 offen offset:3072 sc1
XA17_adaLN_cond__sliding_local_dilated__swiglu_ffn__prompt_kernelx:
  s_waitcnt vmcnt(3)
  v_mfma_f32_16x16x32_bf16 v[208:211], v[52:55], v[152:155], v[208:211]
  v_mfma_f32_16x16x32_bf16 v[212:215], v[54:57], v[152:155], v[212:215]
  s_waitcnt vmcnt(2)
  v_mfma_f32_16x16x32_bf16 v[216:219], v[58:61], v[184:187], v[216:219]
  v_mfma_f32_16x16x32_bf16 v[220:223], v[60:63], v[184:187], v[220:223]
  s_waitcnt vmcnt(1)
  v_mfma_f32_16x16x32_bf16 v[224:227], v[52:55], v[156:159], v[224:227]
  v_mfma_f32_16x16x32_bf16 v[228:231], v[54:57], v[156:159], v[228:231]
  s_waitcnt vmcnt(0)
  v_mfma_f32_16x16x32_bf16 v[232:235], v[58:61], v[188:191], v[232:235]
  v_mfma_f32_16x16x32_bf16 v[236:239], v[60:63], v[188:191], v[236:239]
  v_cvt_pk_bf16_f32 v192, v208, v209
  v_cvt_pk_bf16_f32 v193, v210, v211
  v_cvt_pk_bf16_f32 v194, v212, v213
  v_cvt_pk_bf16_f32 v195, v214, v215
  s_nop 0
  v_permlane16_swap_b32 v192, v194
  v_permlane16_swap_b32 v193, v195
  ds_write_b128 v42, v[192:195] offset:0
  v_cvt_pk_bf16_f32 v196, v216, v217
  v_cvt_pk_bf16_f32 v197, v218, v219
  v_cvt_pk_bf16_f32 v198, v220, v221
  v_cvt_pk_bf16_f32 v199, v222, v223
  s_nop 0
  v_permlane16_swap_b32 v196, v198
  v_permlane16_swap_b32 v197, v199
  ds_write_b128 v43, v[196:199] offset:0
  ds_read_b128 v[208:211], v44 offset:0
  ds_read_b128 v[212:215], v44 offset:1024
  v_cvt_pk_bf16_f32 v200, v224, v225
  v_cvt_pk_bf16_f32 v201, v226, v227
  v_cvt_pk_bf16_f32 v202, v228, v229
  v_cvt_pk_bf16_f32 v203, v230, v231
  s_nop 0
  v_permlane16_swap_b32 v200, v202
  v_permlane16_swap_b32 v201, v203
  ds_write_b128 v42, v[200:203] offset:2048
  v_cvt_pk_bf16_f32 v204, v232, v233
  v_cvt_pk_bf16_f32 v205, v234, v235
  v_cvt_pk_bf16_f32 v206, v236, v237
  v_cvt_pk_bf16_f32 v207, v238, v239
  s_nop 0
  v_permlane16_swap_b32 v204, v206
  v_permlane16_swap_b32 v205, v207
  ds_write_b128 v43, v[204:207] offset:2048
  ds_read_b128 v[224:227], v44 offset:2048
  ds_read_b128 v[228:231], v44 offset:3072
  s_waitcnt lgkmcnt(5)
  buffer_store_dwordx4 v[208:211], v40, s[40:43], s85 offen sc1
  s_add_u32 s85, s85, 16384
  s_waitcnt lgkmcnt(4)
  buffer_store_dwordx4 v[212:215], v40, s[40:43], s85 offen sc1
  s_add_u32 s85, s85, 16384
  s_waitcnt lgkmcnt(1)
  buffer_store_dwordx4 v[224:227], v40, s[40:43], s85 offen sc1
  s_add_u32 s85, s85, 16384
  s_waitcnt lgkmcnt(0)
  buffer_store_dwordx4 v[228:231], v40, s[40:43], s85 offen sc1
E_adaLN_cond__sliding_local_dilated__swiglu_ffn__prompt_kernel:
X_adaLN_cond__sliding_local_dilated__swiglu_ffn__prompt_kernel:
  s_endpgm
code_end:
.fill 2048, 4, 0xBF800000
.section .rodata,"a"
.p2align 6
.amdhsa_kernel adaLN_cond__sliding_local_dilated__swiglu_ffn__prompt_kernel
  .amdhsa_next_free_vgpr 512
  .amdhsa_next_free_sgpr 102
  .amdhsa_accum_offset 256
  .amdhsa_group_segment_fixed_size 0
  .amdhsa_kernarg_size 96
  .amdhsa_user_sgpr_count 2
  .amdhsa_user_sgpr_kernarg_segment_ptr 1
  .amdhsa_system_sgpr_workgroup_id_x 1
  .amdhsa_float_denorm_mode_32 3
.end_amdhsa_kernel
```

```asm
; @launch grid=(256,1,1) block=(256,1,1) lds=163840
.amdgcn_target "amdgcn-amd-amdhsa--gfx950"
.text
.globl adaLN_cond__sliding_local_dilated__swiglu_ffn__prompt_kernel
.type adaLN_cond__sliding_local_dilated__swiglu_ffn__prompt_kernel,@function
.p2align 8
adaLN_cond__sliding_local_dilated__swiglu_ffn__prompt_kernel:
  s_cmp_ge_u32 s2, 256
  s_cbranch_scc1 X_adaLN_cond__sliding_local_dilated__swiglu_ffn__prompt_kernel
  s_load_dwordx2 s[4:5], s[0:1], 0
  s_load_dwordx2 s[8:9], s[0:1], 88
  s_load_dwordx2 s[12:13], s[0:1], 8
  s_load_dwordx2 s[16:17], s[0:1], 16
  s_load_dwordx2 s[20:21], s[0:1], 64
  s_load_dwordx2 s[24:25], s[0:1], 56
  s_load_dwordx2 s[28:29], s[0:1], 32
  s_load_dwordx2 s[32:33], s[0:1], 40
  s_load_dwordx2 s[36:37], s[0:1], 48
  s_load_dwordx2 s[40:41], s[0:1], 72
  v_lshrrev_b32 v21, 6, v0
  v_and_b32 v0, 63, v0
  v_readfirstlane_b32 s44, v21
  v_lshrrev_b32 v22, 3, v0
  v_bfe_u32 v11, v22, 1, 2
  v_bfe_u32 v23, v0, 1, 2
  v_xor_b32 v11, v11, v23
  v_lshlrev_b32 v11, 5, v11
  v_and_b32 v23, 1, v0
  v_lshl_add_u32 v11, v23, 4, v11
  s_lshl_b32 s45, s44, 10
  s_lshl_b32 s52, s44, 3
  v_add_u32 v10, s52, v22
  s_and_b32 s52, s2, 7
  s_lshl_b32 s52, s52, 7
  v_add_u32 v35, s52, v10
  v_mul_u32_u24 v35, 12288, v35
  s_lshr_b32 s53, s2, 3
  s_lshl_b32 s53, s53, 7
  v_add3_u32 v35, v35, v11, s53
  s_and_b32 s53, s44, 1
  s_lshl_b32 s53, s53, 6
  s_add_u32 s52, s52, s53
  v_add_lshl_u32 v16, s52, v0, 1
  s_and_b32 s52, s2, 7
  s_lshr_b32 s53, s2, 3
  s_and_b32 s51, s52, 3
  s_lshl_b32 s51, s51, 2
  s_and_b32 s50, s53, 3
  s_add_u32 s51, s51, s50
  s_lshr_b32 s50, s52, 2
  s_lshl_b32 s50, s50, 3
  s_lshr_b32 s53, s53, 2
  s_add_u32 s50, s50, s53
  s_lshl_b32 s54, s50, 4
  s_add_u32 s54, s54, s51
  v_and_b32 v21, 7, v0
  v_lshlrev_b32 v28, 11, v21
  v_lshl_add_u32 v28, v22, 4, v28
  v_mov_b32 v29, 851968
  s_lshr_b32 s38, s54, 1
  s_lshl_b32 s38, s38, 15
  s_and_b32 s53, s54, 1
  s_lshl_b32 s53, s53, 2
  s_add_u32 s53, s53, s44
  s_lshl_b32 s52, s53, 8
  s_add_u32 s30, s38, s52
  s_mov_b32 s6, 4194304
  s_mov_b32 s7, 0x20000
  s_mov_b32 s10, 134217728
  s_mov_b32 s11, 0x20000
  s_mov_b32 s14, 6291456
  s_mov_b32 s15, 0x20000
  s_mov_b32 s18, 2097152
  s_mov_b32 s19, 0x20000
  s_mov_b32 s22, 12582912
  s_mov_b32 s23, 0x20000
  s_mov_b32 s26, 2048
  s_mov_b32 s27, 0x20000
  s_waitcnt lgkmcnt(0)
  buffer_load_ushort v15, v16, s[24:27], 0 offen
  s_add_u32 m0, s45, 131072
  s_mov_b32 s68, 0
  buffer_load_dwordx4 v35, s[20:23], s68 offen nt lds
  s_add_u32 m0, s45, 135168
  s_add_u32 s68, s68, 393216
  buffer_load_dwordx4 v35, s[20:23], s68 offen nt lds
  s_add_u32 m0, s45, 139264
  s_add_u32 s68, s68, 393216
  buffer_load_dwordx4 v35, s[20:23], s68 offen nt lds
  s_add_u32 m0, s45, 143360
  s_add_u32 s68, s68, 393216
  buffer_load_dwordx4 v35, s[20:23], s68 offen nt lds
  buffer_load_dword v36, v29, s[8:11], 0 offen sc1
  s_and_b32 s52, s2, 3
  s_lshl_b32 s52, s52, 2
  s_add_u32 s52, s52, s44
  s_lshl_b32 s52, s52, 7
  v_lshlrev_b32 v23, 1, v0
  buffer_load_ushort v23, v23, s[24:27], s52 offen
  s_add_u32 s52, s30, 0
  buffer_load_dwordx4 v[44:47], v28, s[4:7], s52 offen offset:0 nt
  buffer_load_dwordx4 v[48:51], v28, s[4:7], s52 offen offset:128 nt
  s_add_u32 s52, s30, 16384
  buffer_load_dwordx4 v[52:55], v28, s[4:7], s52 offen offset:0 nt
  buffer_load_dwordx4 v[56:59], v28, s[4:7], s52 offen offset:128 nt
  s_branch BODY0
.p2align 12
BODY0:
  v_lshlrev_b32 v1, 4, v0
  v_add_u32 v2, 65536, v1
  v_add_u32 v13, 131072, v1
  s_and_b32 s66, s51, 3
  v_mul_u32_u24 v9, 6144, v10
  s_lshl_b32 s52, s51, 7
  v_add3_u32 v9, v9, v11, s52
  s_lshl_b32 s52, s53, 12
  s_add_u32 s38, s38, s52
  s_add_u32 s39, s38, 41943040
  s_add_u32 s38, s38, 1048576
  s_lshl_b32 s34, s53, 9
  s_add_u32 s34, s34, 131072
  s_lshl_b32 s35, s53, 11
  s_add_u32 s35, s35, 819200
  s_lshr_b32 s83, s2, 3
  s_lshl_b32 s83, s83, 2
  s_add_u32 s83, s83, s44
  s_lshl_b32 s83, s83, 10
  s_getpc_b64 s[80:81]
CT1_adaLN_cond__sliding_local_dilated__swiglu_ffn__prompt_kernel:
  s_min_u32 s82, s83, code_end-CT1_adaLN_cond__sliding_local_dilated__swiglu_ffn__prompt_kernel
  s_add_u32 s80, s80, s82
  s_addc_u32 s81, s81, 0
  v_and_b32 v24, 0x70, v1
  v_lshlrev_b32 v24, 3, v24
  global_load_dword a253, v24, s[80:81]
  s_xor_b32 s30, s30, 1024
  s_add_u32 s52, s30, 0
  buffer_load_dwordx4 v[92:95], v28, s[4:7], s52 offen offset:0 nt
  buffer_load_dwordx4 v[96:99], v28, s[4:7], s52 offen offset:128 nt
  s_add_u32 s52, s30, 16384
  buffer_load_dwordx4 v[100:103], v28, s[4:7], s52 offen offset:0 nt
  buffer_load_dwordx4 v[104:107], v28, s[4:7], s52 offen offset:128 nt
  s_lshr_b32 s52, s2, 3
  s_mul_i32 s52, s52, 98304
  s_lshl_b32 s53, s44, 11
  s_add_u32 s52, s52, s53
  s_and_b32 s53, s2, 3
  s_lshl_b32 s53, s53, 9
  s_add_u32 s52, s52, s53
  s_add_u32 s52, s52, 0
  s_cmp_lt_u32 s44, 3
  s_cselect_b32 s52, s52, 1073741824
  v_lshrrev_b32 v43, 2, v0
  v_mul_u32_u24 v43, 5632, v43
  v_lshl_add_u32 v43, v0, 7, v43
  buffer_load_dword a252, v43, s[12:15], s52 offen
  v_lshrrev_b32 v41, 2, v0
  v_bfe_u32 v40, v41, 1, 2
  v_lshlrev_b32 v40, 5, v40
  v_lshl_add_u32 v40, v41, 7, v40
  v_and_b32 v41, 3, v0
  v_lshl_add_u32 v40, v41, 3, v40
  s_lshl_b32 s52, s44, 5
  v_xor_b32 v3, s52, v40
  s_and_b32 s52, s52, 64
  s_and_b32 s53, s44, 1
  s_lshl_b32 s53, s53, 14
  s_add_u32 s52, s52, s53
  v_xor_b32 v4, s52, v40
  v_xor_b32 v5, 32, v4
  v_add_u32 v6, 65536, v3
  v_add_u32 v7, 65536, v4
  v_add_u32 v8, 65536, v5
  v_add_u32 v35, 131072, v3
  v_lshrrev_b32 v30, 5, v0
  v_lshlrev_b32 v30, 6, v30
  v_bfe_u32 v40, v0, 2, 2
  v_lshl_add_u32 v30, v40, 4, v30
  v_bfe_u32 v40, v0, 4, 1
  v_lshl_add_u32 v30, v40, 3, v30
  v_lshl_add_u32 v30, v41, 1, v30
  s_lshl_b32 s52, s44, 7
  s_add_u32 s52, s52, 160768
  v_add_u32 v30, s52, v30
  v_lshrrev_b32 v32, 4, v0
  v_lshlrev_b32 v32, 4, v32
  v_add_u32 v31, 160768, v32
  v_and_b32 v40, 15, v0
  v_lshl_add_u32 v32, v40, 27, v32
  s_and_b32 s52, s2, 7
  s_lshl_b32 s52, s52, 13
  s_lshr_b32 s53, s2, 3
  s_lshl_b32 s53, s53, 8
  s_add_u32 s52, s52, s53
  s_lshl_b32 s53, s44, 6
  s_add_u32 s52, s52, s53
  s_add_u32 s42, s52, 131072
  s_lshl_b32 s53, s44, 28
  s_lshl_b32 s31, s2, 7
  s_add_u32 s31, s31, s53
  s_add_u32 s31, s31, 819200
  s_lshl_b32 s74, s54, 7
  s_add_u32 s74, s74, s53
  s_add_u32 s75, s74, 786432
  s_add_u32 s74, s74, 655360
  s_waitcnt vmcnt(16)
  v_lshlrev_b32 v15, 16, v15
  v_mul_f32 v16, 0xbfb8aa3b, v15
  v_exp_f32 v16, v16
  s_nop 0
  v_add_f32 v16, 1.0, v16
  v_rcp_f32 v16, v16
  s_nop 0
  v_mul_f32 v15, v15, v16
  v_cvt_pk_bf16_f32 v15, v15, v15
  ds_write_b16 v30, v15
  s_waitcnt vmcnt(12) lgkmcnt(0)
  s_barrier
  ds_read_b64_tr_b16 v[60:61], v35 offset:0
  ds_read_b64_tr_b16 v[62:63], v35 offset:2048
  ds_read_b128 v[76:79], v31 offset:0
  ds_read_b64_tr_b16 v[64:65], v35 offset:4096
  ds_read_b64_tr_b16 v[66:67], v35 offset:6144
  ds_read_b128 v[80:83], v31 offset:64
  ds_read_b64_tr_b16 v[68:69], v35 offset:8192
  ds_read_b64_tr_b16 v[70:71], v35 offset:10240
  ds_read_b128 v[84:87], v31 offset:128
  ds_read_b64_tr_b16 v[72:73], v35 offset:12288
  ds_read_b64_tr_b16 v[74:75], v35 offset:14336
  ds_read_b128 v[88:91], v31 offset:192
  s_waitcnt vmcnt(11)
  v_readfirstlane_b32 s46, v36
  s_nop 0
  s_add_u32 s46, s46, 8
  s_mul_i32 s52, s46, 0x13c6ef37
  v_mov_b32 v36, 0xff
  s_bfe_u32 s55, s52, 0x80000
  s_bfe_u32 s56, s52, 0x80008
  s_bfe_u32 s69, s52, 0x80010
  s_bfe_u32 s54, s52, 0x80018
  s_waitcnt lgkmcnt(9)
  v_mfma_f32_16x16x32_bf16 v[40:43], v[60:63], v[76:79], 0
  s_waitcnt lgkmcnt(6)
  v_mfma_f32_16x16x32_bf16 v[40:43], v[64:67], v[80:83], v[40:43]
  s_waitcnt lgkmcnt(3)
  v_mfma_f32_16x16x32_bf16 v[40:43], v[68:71], v[84:87], v[40:43]
  s_waitcnt lgkmcnt(0)
  v_mfma_f32_16x16x32_bf16 v[40:43], v[72:75], v[88:91], v[40:43]
  s_nop 7
  v_bfi_b32 v40, v36, s55, v40
  v_bfi_b32 v41, v36, s56, v41
  v_bfi_b32 v42, v36, s69, v42
  v_bfi_b32 v43, v36, s54, v43
  buffer_store_dwordx4 v[40:43], v32, s[8:11], s42 offen sc1
  s_lshr_b32 s52, s2, 3
  s_mul_i32 s52, s52, 98304
  s_lshl_b32 s53, s44, 11
  s_add_u32 s52, s52, s53
  s_and_b32 s53, s2, 3
  s_lshl_b32 s53, s53, 9
  s_add_u32 s52, s52, s53
  s_add_u32 s52, s52, 3145728
  s_cmp_lt_u32 s44, 3
  s_cselect_b32 s52, s52, 1073741824
  v_lshrrev_b32 v43, 2, v0
  v_mul_u32_u24 v43, 5632, v43
  v_lshl_add_u32 v43, v0, 7, v43
  buffer_load_dword a252, v43, s[12:15], s52 offen
  s_lshl_b32 s52, s50, 18
  s_add_u32 s52, s52, 1015808
  s_max_u32 s72, s52, 1048576
  s_lshr_b32 s53, s44, 1
  s_lshl_b32 s70, s53, 15
  s_add_u32 s52, s52, s70
  v_add_u32 v12, s52, v1
  s_lshl_b32 s53, s53, 11
  s_add_u32 s72, s72, s53
  s_lshl_b32 s70, s44, 12
  s_and_b32 s52, s70, 4096
  s_add_u32 s71, s52, s53
  s_and_b32 s52, s44, 1
  s_add_u32 s52, s52, s66
  s_add_u32 s58, s52, 0
  s_and_b32 s58, s58, 7
  s_lshl_b32 s58, s58, 12
  s_add_u32 s59, s52, 2
  s_and_b32 s59, s59, 7
  s_lshl_b32 s59, s59, 12
  s_add_u32 s60, s52, 4
  s_and_b32 s60, s60, 7
  s_lshl_b32 s60, s60, 12
  s_add_u32 s61, s52, 6
  s_and_b32 s61, s61, 7
  s_lshl_b32 s61, s61, 12
  s_lshl_b32 s52, s50, 4
  s_sub_u32 s52, s52, 2
  v_min_u32 v14, 17, v0
  v_add_u32 v14, s52, v14
  v_max_i32 v14, 0, v14
  v_lshlrev_b32 v14, 7, v14
  v_add_u32 v14, 786432, v14
  s_and_b32 s52, s2, 3
  s_lshl_b32 s52, s52, 8
  v_add_u32 v40, s52, v10
  v_mul_u32_u24 v40, 12288, v40
  s_lshr_b32 s53, s2, 2
  s_add_u32 s53, s53, 32
  s_lshl_b32 s53, s53, 7
  v_lshl_add_u32 v10, v10, 11, v11
  v_add3_u32 v11, v40, v11, s53
  s_and_b32 s52, s44, 1
  s_lshl_b32 s53, s50, 3
  s_add_u32 s53, s53, s52
  s_lshl_b32 s73, s53, 15
  s_lshl_b32 s53, s51, 1
  s_lshr_b32 s57, s44, 1
  s_add_u32 s53, s53, s57
  s_lshl_b32 s53, s53, 10
  s_add_u32 s73, s73, s53
  s_add_u32 s73, s73, 7340032
  s_mul_i32 s57, s57, 3072
  s_add_u32 s57, s57, 131072
  v_add_u32 v19, s57, v1
  s_lshl_b32 s53, s52, 3
  v_add_u32 v18, s53, v19
  s_lshl_b32 s53, s52, 10
  v_add_u32 v17, s53, v19
  v_lshrrev_b32 v40, 2, v0
  v_and_b32 v20, 3, v0
  v_lshl_add_u32 v40, v20, 4, v40
  v_lshl_add_u32 v20, v40, 4, s57
  s_mov_b32 s80, 0xfff0ffff
  s_mov_b32 s81, 0xf000ff00
  s_mov_b32 s82, 0xffe0fffe
  s_mov_b32 s83, 0xe000fe00
  s_mov_b32 s84, 0xffc0fffc
  s_mov_b32 s85, 0xc000fc00
  s_mov_b32 s86, 0xff80fff8
  s_mov_b32 s87, 0x8000f800
  s_mov_b32 s88, 0xaaaaaaaa
  s_mov_b32 s89, 0xaaaaaaaa
  s_mov_b32 s90, 0x000f0000
  s_mov_b32 s91, 0x0fff00ff
  s_mov_b32 s92, 0x003f0003
  s_mov_b32 s93, 0x3fff03ff
  v_mov_b32 v41, 0xffff
  v_mov_b32 v24, 0xffff0000
  v_cndmask_b32 v41, v41, v24, s[88:89]
  v_cndmask_b32 v24, 0, v41, s[90:91]
  v_cndmask_b32 v25, 0, v41, s[92:93]
  v_xor_b32 v26, v24, v41
  v_xor_b32 v27, v25, v41
  s_or_b32 s52, s52, s50
  s_cmp_eq_u32 s52, 0
  s_cselect_b64 s[90:91], s[90:91], 0
  s_cselect_b64 s[92:93], s[92:93], 0
  s_bfe_u32 s53, s2, 0x30003
  s_lshl_b32 s43, s53, 1
  s_and_b32 s52, s2, 1
  s_add_u32 s43, s43, s52
  s_and_b32 s79, s2, 4
  s_lshr_b32 s52, s2, 6
  s_add_u32 s79, s79, s52
  s_lshl_b32 s79, s79, 1
  s_add_u32 s67, s79, s53
  s_bfe_u32 s52, s2, 0x10001
  s_add_u32 s79, s79, s52
  s_and_b32 s52, s44, 1
  s_add_u32 s52, s52, s67
  s_add_u32 s62, s52, 0
  s_and_b32 s62, s62, 7
  s_lshl_b32 s62, s62, 12
  s_add_u32 s63, s52, 2
  s_and_b32 s63, s63, 7
  s_lshl_b32 s63, s63, 12
  s_add_u32 s64, s52, 4
  s_and_b32 s64, s64, 7
  s_lshl_b32 s64, s64, 12
  s_add_u32 s65, s52, 6
  s_and_b32 s65, s65, 7
  s_lshl_b32 s65, s65, 12
  s_lshl_b32 s52, s43, 7
  v_add_u32 v10, s52, v10
  s_lshl_b32 s52, s79, 18
  s_lshr_b32 s53, s44, 1
  s_lshl_b32 s53, s53, 15
  s_add_u32 s53, s52, s53
  s_add_u32 s78, s53, 7340032
  s_and_b32 s53, s44, 1
  s_lshl_b32 s53, s53, 15
  s_add_u32 s52, s52, s53
  s_lshl_b32 s53, s43, 1
  s_lshr_b32 s57, s44, 1
  s_add_u32 s53, s53, s57
  s_lshl_b32 s76, s53, 7
  s_lshl_b32 s53, s53, 10
  s_add_u32 s47, s52, s53
  s_lshr_b32 s53, s53, 1
  s_lshl_b32 s52, s79, 1
  s_and_b32 s57, s44, 1
  s_add_u32 s52, s52, s57
  s_lshl_b32 s52, s52, 14
  s_add_u32 s52, s52, s53
  s_add_u32 s48, s52, 6291456
  s_lshl_b32 s52, s79, 11
  s_lshl_b32 s53, s43, 7
  s_add_u32 s53, s53, s52
  s_lshl_b32 s57, s44, 28
  s_add_u32 s53, s53, s57
  s_add_u32 s49, s53, 753664
  s_add_u32 s77, s52, 655360
  s_lshl_b32 s53, s44, 4
  v_lshlrev_b32 v31, 6, v21
  v_add_u32 v31, 159744, v31
  v_add_u32 v30, s53, v31
  v_mov_b32 v34, 0x3f803f80
  v_mov_b32 v36, 0
  v_mov_b32 v37, 0
  v_mov_b32 v38, 0
  v_mov_b32 v39, 0
  s_waitcnt vmcnt(8)
  v_dot2c_f32_bf16 v36, v44, v34
  v_dot2c_f32_bf16 v37, v44, v44
  v_dot2c_f32_bf16 v38, v52, v34
  v_dot2c_f32_bf16 v39, v52, v52
  v_dot2c_f32_bf16 v36, v45, v34
  v_dot2c_f32_bf16 v37, v45, v45
  v_dot2c_f32_bf16 v38, v53, v34
  v_dot2c_f32_bf16 v39, v53, v53
  v_dot2c_f32_bf16 v36, v46, v34
  v_dot2c_f32_bf16 v37, v46, v46
  v_dot2c_f32_bf16 v38, v54, v34
  v_dot2c_f32_bf16 v39, v54, v54
  v_dot2c_f32_bf16 v36, v47, v34
  v_dot2c_f32_bf16 v37, v47, v47
  v_dot2c_f32_bf16 v38, v55, v34
  v_dot2c_f32_bf16 v39, v55, v55
  v_dot2c_f32_bf16 v36, v48, v34
  v_dot2c_f32_bf16 v37, v48, v48
  v_dot2c_f32_bf16 v38, v56, v34
  v_dot2c_f32_bf16 v39, v56, v56
  v_dot2c_f32_bf16 v36, v49, v34
  v_dot2c_f32_bf16 v37, v49, v49
  v_dot2c_f32_bf16 v38, v57, v34
  v_dot2c_f32_bf16 v39, v57, v57
  v_dot2c_f32_bf16 v36, v50, v34
  v_dot2c_f32_bf16 v37, v50, v50
  v_dot2c_f32_bf16 v38, v58, v34
  v_dot2c_f32_bf16 v39, v58, v58
  v_dot2c_f32_bf16 v36, v51, v34
  v_dot2c_f32_bf16 v37, v51, v51
  v_dot2c_f32_bf16 v38, v59, v34
  v_dot2c_f32_bf16 v39, v59, v59
  s_waitcnt vmcnt(3)
  v_dot2c_f32_bf16 v36, v92, v34
  v_dot2c_f32_bf16 v37, v92, v92
  v_dot2c_f32_bf16 v38, v100, v34
  v_dot2c_f32_bf16 v39, v100, v100
  v_dot2c_f32_bf16 v36, v93, v34
  v_dot2c_f32_bf16 v37, v93, v93
  v_dot2c_f32_bf16 v38, v101, v34
  v_dot2c_f32_bf16 v39, v101, v101
  v_dot2c_f32_bf16 v36, v94, v34
  v_dot2c_f32_bf16 v37, v94, v94
  v_dot2c_f32_bf16 v38, v102, v34
  v_dot2c_f32_bf16 v39, v102, v102
  v_dot2c_f32_bf16 v36, v95, v34
  v_dot2c_f32_bf16 v37, v95, v95
  v_dot2c_f32_bf16 v38, v103, v34
  v_dot2c_f32_bf16 v39, v103, v103
  v_dot2c_f32_bf16 v36, v96, v34
  v_dot2c_f32_bf16 v37, v96, v96
  v_dot2c_f32_bf16 v38, v104, v34
  v_dot2c_f32_bf16 v39, v104, v104
  v_dot2c_f32_bf16 v36, v97, v34
  v_dot2c_f32_bf16 v37, v97, v97
  v_dot2c_f32_bf16 v38, v105, v34
  v_dot2c_f32_bf16 v39, v105, v105
  v_dot2c_f32_bf16 v36, v98, v34
  v_dot2c_f32_bf16 v37, v98, v98
  v_dot2c_f32_bf16 v38, v106, v34
  v_dot2c_f32_bf16 v39, v106, v106
  v_dot2c_f32_bf16 v36, v99, v34
  v_dot2c_f32_bf16 v37, v99, v99
  v_dot2c_f32_bf16 v38, v107, v34
  v_dot2c_f32_bf16 v39, v107, v107
  s_nop 2
  v_add_f32_dpp v36, v36, v36 row_ror:8 row_mask:0xf bank_mask:0xf
  v_add_f32_dpp v37, v37, v37 row_ror:8 row_mask:0xf bank_mask:0xf
  v_add_f32_dpp v38, v38, v38 row_ror:8 row_mask:0xf bank_mask:0xf
  v_add_f32_dpp v39, v39, v39 row_ror:8 row_mask:0xf bank_mask:0xf
  v_mov_b32 v40, v36
  v_mov_b32 v41, v37
  v_mov_b32 v42, v38
  v_mov_b32 v43, v39
  v_permlane16_swap_b32 v36, v40
  v_permlane16_swap_b32 v37, v41
  v_permlane16_swap_b32 v38, v42
  v_permlane16_swap_b32 v39, v43
  v_add_f32 v36, v36, v40
  v_add_f32 v37, v37, v41
  v_add_f32 v38, v38, v42
  v_add_f32 v39, v39, v43
  v_mov_b32 v40, v36
  v_mov_b32 v41, v37
  v_mov_b32 v42, v38
  v_mov_b32 v43, v39
  v_permlane32_swap_b32 v36, v40
  v_permlane32_swap_b32 v37, v41
  v_permlane32_swap_b32 v38, v42
  v_permlane32_swap_b32 v39, v43
  v_add_f32 v36, v36, v40
  v_add_f32 v37, v37, v41
  v_add_f32 v38, v38, v42
  v_add_f32 v39, v39, v43
  ds_write_b128 v30, v[36:39]
  v_lshlrev_b32 v60, 16, v44
  v_and_b32 v61, 0xffff0000, v44
  v_lshlrev_b32 v62, 16, v45
  v_and_b32 v63, 0xffff0000, v45
  v_lshlrev_b32 v64, 16, v46
  v_and_b32 v65, 0xffff0000, v46
  v_lshlrev_b32 v66, 16, v47
  v_and_b32 v67, 0xffff0000, v47
  v_lshlrev_b32 v68, 16, v48
  v_and_b32 v69, 0xffff0000, v48
  v_lshlrev_b32 v70, 16, v49
  v_and_b32 v71, 0xffff0000, v49
  v_lshlrev_b32 v72, 16, v50
  v_and_b32 v73, 0xffff0000, v50
  v_lshlrev_b32 v74, 16, v51
  v_and_b32 v75, 0xffff0000, v51
  v_lshlrev_b32 v76, 16, v52
  v_and_b32 v77, 0xffff0000, v52
  v_lshlrev_b32 v78, 16, v53
  v_and_b32 v79, 0xffff0000, v53
  v_lshlrev_b32 v80, 16, v54
  v_and_b32 v81, 0xffff0000, v54
  v_lshlrev_b32 v82, 16, v55
  v_and_b32 v83, 0xffff0000, v55
  v_lshlrev_b32 v84, 16, v56
  v_and_b32 v85, 0xffff0000, v56
  v_lshlrev_b32 v86, 16, v57
  v_and_b32 v87, 0xffff0000, v57
  v_lshlrev_b32 v88, 16, v58
  v_and_b32 v89, 0xffff0000, v58
  v_lshlrev_b32 v90, 16, v59
  v_and_b32 v91, 0xffff0000, v59
  s_waitcnt lgkmcnt(0)
  s_barrier
  ds_read_b128 v[92:95], v31 offset:0
  ds_read_b128 v[96:99], v31 offset:16
  ds_read_b128 v[100:103], v31 offset:32
  ds_read_b128 v[104:107], v31 offset:48
  v_permlane16_swap_b32 v44, v46
  v_permlane16_swap_b32 v45, v47
  v_permlane16_swap_b32 v48, v50
  v_permlane16_swap_b32 v49, v51
  v_permlane16_swap_b32 v52, v54
  v_permlane16_swap_b32 v53, v55
  v_permlane16_swap_b32 v56, v58
  v_permlane16_swap_b32 v57, v59
  v_bfe_u32 v36, v0, 3, 1
  v_lshlrev_b32 v28, 9, v36
  v_bfe_u32 v36, v0, 4, 1
  v_lshl_add_u32 v28, v36, 8, v28
  v_lshrrev_b32 v34, 5, v0
  v_lshl_add_u32 v28, v34, 10, v28
  v_lshl_add_u32 v28, v21, 4, v28
  v_and_b32 v29, 31, v0
  v_lshlrev_b32 v29, 4, v29
  v_lshl_add_u32 v29, v34, 12, v29
  v_cvt_f32_u32 v34, v34
  s_add_u32 s53, s45, 151552
  v_add_u32 v32, s53, v1
  v_lshl_add_u32 v33, v22, 5, s53
  v_lshlrev_b32 v36, 14, v36
  v_and_b32 v35, 15, v0
  v_lshl_add_u32 v35, v35, 7, v36
  s_waitcnt lgkmcnt(0)
  v_add_f32 v92, v92, v100
  v_add_f32 v93, v93, v101
  v_add_f32 v94, v94, v102
  v_add_f32 v95, v95, v103
  v_add_f32 v96, v96, v104
  v_add_f32 v97, v97, v105
  v_add_f32 v98, v98, v106
  v_add_f32 v99, v99, v107
  v_add_f32 v92, v92, v96
  v_add_f32 v93, v93, v97
  v_add_f32 v94, v94, v98
  v_add_f32 v95, v95, v99
  v_mul_f32 v92, 0x3a800000, v92
  v_mul_f32 v94, 0x3a800000, v94
  v_mul_f32 v93, 0x3a800000, v93
  v_mul_f32 v95, 0x3a800000, v95
  v_fma_f32 v93, -v92, v92, v93
  v_fma_f32 v95, -v94, v94, v95
  v_max_f32 v93, 0, v93
  v_max_f32 v95, 0, v95
  v_cvt_pk_bf16_f32 v93, v93, v93
  v_cvt_pk_bf16_f32 v95, v95, v95
  v_lshlrev_b32 v93, 16, v93
  v_lshlrev_b32 v95, 16, v95
  v_add_f32 v93, 0x3727c5ac, v93
  v_add_f32 v95, 0x3727c5ac, v95
  v_cvt_pk_bf16_f32 v93, v93, v93
  v_cvt_pk_bf16_f32 v95, v95, v95
  v_lshlrev_b32 v93, 16, v93
  v_lshlrev_b32 v95, 16, v95
  v_sqrt_f32 v93, v93
  v_sqrt_f32 v95, v95
  v_cvt_pk_bf16_f32 v92, v92, v92
  v_cvt_pk_bf16_f32 v94, v94, v94
  v_lshlrev_b32 v92, 16, v92
  v_lshlrev_b32 v94, 16, v94
  v_cvt_pk_bf16_f32 v93, v93, v93
  v_cvt_pk_bf16_f32 v95, v95, v95
  v_lshlrev_b32 v93, 16, v93
  v_lshlrev_b32 v95, 16, v95
  v_rcp_f32 v93, v93
  v_rcp_f32 v95, v95
  v_mul_f32 v92, v92, v93
  v_mul_f32 v94, v94, v95
  v_fma_f32 v60, v60, v93, -v92
  v_fma_f32 v61, v61, v93, -v92
  v_fma_f32 v62, v62, v93, -v92
  v_fma_f32 v63, v63, v93, -v92
  v_fma_f32 v64, v64, v93, -v92
  v_fma_f32 v65, v65, v93, -v92
  v_fma_f32 v66, v66, v93, -v92
  v_fma_f32 v67, v67, v93, -v92
  v_fma_f32 v68, v68, v93, -v92
  v_fma_f32 v69, v69, v93, -v92
  v_fma_f32 v70, v70, v93, -v92
  v_fma_f32 v71, v71, v93, -v92
  v_fma_f32 v72, v72, v93, -v92
  v_fma_f32 v73, v73, v93, -v92
  v_fma_f32 v74, v74, v93, -v92
  v_fma_f32 v75, v75, v93, -v92
  v_fma_f32 v76, v76, v95, -v94
  v_fma_f32 v77, v77, v95, -v94
  v_fma_f32 v78, v78, v95, -v94
  v_fma_f32 v79, v79, v95, -v94
  v_fma_f32 v80, v80, v95, -v94
  v_fma_f32 v81, v81, v95, -v94
  v_fma_f32 v82, v82, v95, -v94
  v_fma_f32 v83, v83, v95, -v94
  v_fma_f32 v84, v84, v95, -v94
  v_fma_f32 v85, v85, v95, -v94
  v_fma_f32 v86, v86, v95, -v94
  v_fma_f32 v87, v87, v95, -v94
  v_fma_f32 v88, v88, v95, -v94
  v_fma_f32 v89, v89, v95, -v94
  v_fma_f32 v90, v90, v95, -v94
  v_fma_f32 v91, v91, v95, -v94
  s_waitcnt vmcnt(12)
  v_lshlrev_b32 v15, 16, v23
  v_mul_f32 v16, 0xbfb8aa3b, v15
  v_exp_f32 v16, v16
  v_lshrrev_b32 v21, 5, v0
  v_add_f32 v16, 1.0, v16
  v_rcp_f32 v16, v16
  v_lshlrev_b32 v21, 6, v21
  v_mul_f32 v15, v15, v16
  v_cvt_pk_bf16_f32 v16, v15, v15
  v_bfe_u32 v15, v0, 2, 2
  v_lshl_add_u32 v21, v15, 4, v21
  v_bfe_u32 v15, v0, 4, 1
  v_lshl_add_u32 v21, v15, 3, v21
  v_and_b32 v15, 3, v0
  v_lshl_add_u32 v21, v15, 1, v21
  s_lshl_b32 s53, s44, 7
  s_add_u32 s53, s53, 160768
  v_add_u32 v21, s53, v21
  s_mov_b64 exec, 0
  s_cmp_eq_u32 s44, 0
  s_cbranch_scc1 HOP0
  s_cmp_eq_u32 s44, 1
  s_cbranch_scc1 HOP1
  s_cmp_eq_u32 s44, 2
  s_cbranch_scc1 HOP2
  s_cmp_eq_u32 s44, 3
  s_cbranch_scc1 HOP3
WRET0:
  s_mov_b64 exec, -1
  s_add_u32 m0, s45, 0
  s_add_u32 s68, s66, 0
  s_and_b32 s68, s68, 7
  s_mul_i32 s68, s68, 786432
  buffer_load_dwordx4 v9, s[12:15], s68 offen lds
  s_add_u32 m0, s45, 4096
  s_add_u32 s68, s68, 196608
  buffer_load_dwordx4 v9, s[12:15], s68 offen lds
  s_add_u32 m0, s45, 8192
  s_add_u32 s68, s68, 196608
  buffer_load_dwordx4 v9, s[12:15], s68 offen lds
  s_add_u32 m0, s45, 12288
  s_add_u32 s68, s68, 196608
  buffer_load_dwordx4 v9, s[12:15], s68 offen lds
  s_add_u32 m0, s45, 16384
  s_add_u32 s68, s66, 1
  s_and_b32 s68, s68, 7
  s_mul_i32 s68, s68, 786432
  buffer_load_dwordx4 v9, s[12:15], s68 offen lds
  s_add_u32 m0, s45, 20480
  s_add_u32 s68, s68, 196608
  buffer_load_dwordx4 v9, s[12:15], s68 offen lds
  s_add_u32 m0, s45, 24576
  s_add_u32 s68, s68, 196608
  buffer_load_dwordx4 v9, s[12:15], s68 offen lds
  s_add_u32 m0, s45, 28672
  s_add_u32 s68, s68, 196608
  buffer_load_dwordx4 v9, s[12:15], s68 offen lds
  s_add_u32 s52, s34, 0
  buffer_load_dwordx4 v[92:95], v29, s[8:11], s52 offen sc1
  s_add_u32 s52, s34, 8192
  buffer_load_dwordx4 v[96:99], v29, s[8:11], s52 offen sc1
  s_add_u32 s52, s34, 16384
  buffer_load_dwordx4 v[100:103], v29, s[8:11], s52 offen sc1
  s_add_u32 s52, s34, 24576
  buffer_load_dwordx4 v[104:107], v29, s[8:11], s52 offen sc1
  s_add_u32 s52, s34, 32768
  buffer_load_dwordx4 v[108:111], v29, s[8:11], s52 offen sc1
  s_add_u32 s52, s34, 40960
  buffer_load_dwordx4 v[112:115], v29, s[8:11], s52 offen sc1
  s_add_u32 s52, s34, 49152
  buffer_load_dwordx4 v[116:119], v29, s[8:11], s52 offen sc1
  s_add_u32 s52, s34, 57344
  buffer_load_dwordx4 v[120:123], v29, s[8:11], s52 offen sc1
  s_add_u32 m0, s45, 32768
  s_add_u32 s68, s66, 0
  s_and_b32 s68, s68, 7
  s_mul_i32 s68, s68, 786432
  s_add_u32 s68, s68, 2048
  buffer_load_dwordx4 v9, s[12:15], s68 offen lds
  s_add_u32 m0, s45, 36864
  s_add_u32 s68, s68, 196608
  buffer_load_dwordx4 v9, s[12:15], s68 offen lds
  s_add_u32 m0, s45, 40960
  s_add_u32 s68, s68, 196608
  buffer_load_dwordx4 v9, s[12:15], s68 offen lds
  s_add_u32 m0, s45, 45056
  s_add_u32 s68, s68, 196608
  buffer_load_dwordx4 v9, s[12:15], s68 offen lds
  s_add_u32 m0, s45, 49152
  s_add_u32 s68, s66, 0
  s_and_b32 s68, s68, 7
  s_mul_i32 s68, s68, 786432
  s_add_u32 s68, s68, 4096
  buffer_load_dwordx4 v9, s[12:15], s68 offen lds
  s_add_u32 m0, s45, 53248
  s_add_u32 s68, s68, 196608
  buffer_load_dwordx4 v9, s[12:15], s68 offen lds
  s_add_u32 m0, s45, 57344
  s_add_u32 s68, s68, 196608
  buffer_load_dwordx4 v9, s[12:15], s68 offen lds
  s_add_u32 m0, s45, 61440
  s_add_u32 s68, s68, 196608
  buffer_load_dwordx4 v9, s[12:15], s68 offen lds
  s_mov_b32 s57, 20000
  s_branch MT2_adaLN_cond__sliding_local_dilated__swiglu_ffn__prompt_kernelt
MT2_adaLN_cond__sliding_local_dilated__swiglu_ffn__prompt_kernel:
  s_add_u32 s52, s34, 0
  buffer_load_dwordx4 v[92:95], v29, s[8:11], s52 offen sc1
  s_add_u32 s52, s34, 8192
  buffer_load_dwordx4 v[96:99], v29, s[8:11], s52 offen sc1
  s_add_u32 s52, s34, 16384
  buffer_load_dwordx4 v[100:103], v29, s[8:11], s52 offen sc1
  s_add_u32 s52, s34, 24576
  buffer_load_dwordx4 v[104:107], v29, s[8:11], s52 offen sc1
  s_add_u32 s52, s34, 32768
  buffer_load_dwordx4 v[108:111], v29, s[8:11], s52 offen sc1
  s_add_u32 s52, s34, 40960
  buffer_load_dwordx4 v[112:115], v29, s[8:11], s52 offen sc1
  s_add_u32 s52, s34, 49152
  buffer_load_dwordx4 v[116:119], v29, s[8:11], s52 offen sc1
  s_add_u32 s52, s34, 57344
  buffer_load_dwordx4 v[120:123], v29, s[8:11], s52 offen sc1
  s_waitcnt vmcnt(0)
MT2_adaLN_cond__sliding_local_dilated__swiglu_ffn__prompt_kernelt:
  s_waitcnt vmcnt(15)
  v_xor_b32 v92, s55, v92
  v_xor_b32 v93, s56, v93
  v_xor_b32 v94, s69, v94
  v_xor_b32 v95, s54, v95
  v_or3_b32 v36, v92, v93, 0
  v_or3_b32 v36, v94, v95, v36
  s_waitcnt vmcnt(14)
  v_xor_b32 v96, s55, v96
  v_xor_b32 v97, s56, v97
  v_xor_b32 v98, s69, v98
  v_xor_b32 v99, s54, v99
  v_or3_b32 v36, v96, v97, v36
  v_or3_b32 v36, v98, v99, v36
  s_waitcnt vmcnt(13)
  v_xor_b32 v100, s55, v100
  v_xor_b32 v101, s56, v101
  v_xor_b32 v102, s69, v102
  v_xor_b32 v103, s54, v103
  v_or3_b32 v36, v100, v101, v36
  v_or3_b32 v36, v102, v103, v36
  s_waitcnt vmcnt(12)
  v_xor_b32 v104, s55, v104
  v_xor_b32 v105, s56, v105
  v_xor_b32 v106, s69, v106
  v_xor_b32 v107, s54, v107
  v_or3_b32 v36, v104, v105, v36
  v_or3_b32 v36, v106, v107, v36
  s_waitcnt vmcnt(11)
  v_xor_b32 v108, s55, v108
  v_xor_b32 v109, s56, v109
  v_xor_b32 v110, s69, v110
  v_xor_b32 v111, s54, v111
  v_or3_b32 v36, v108, v109, v36
  v_or3_b32 v36, v110, v111, v36
  s_waitcnt vmcnt(10)
  v_xor_b32 v112, s55, v112
  v_xor_b32 v113, s56, v113
  v_xor_b32 v114, s69, v114
  v_xor_b32 v115, s54, v115
  v_or3_b32 v36, v112, v113, v36
  v_or3_b32 v36, v114, v115, v36
  s_waitcnt vmcnt(9)
  v_xor_b32 v116, s55, v116
  v_xor_b32 v117, s56, v117
  v_xor_b32 v118, s69, v118
  v_xor_b32 v119, s54, v119
  v_or3_b32 v36, v116, v117, v36
  v_or3_b32 v36, v118, v119, v36
  s_waitcnt vmcnt(8)
  v_xor_b32 v120, s55, v120
  v_xor_b32 v121, s56, v121
  v_xor_b32 v122, s69, v122
  v_xor_b32 v123, s54, v123
  v_or3_b32 v36, v120, v121, v36
  v_or3_b32 v36, v122, v123, v36
HOP0:
  s_cbranch_execz HOP4
  v_and_b32 v36, 0xff, v36
  v_cmp_ne_u32 vcc, 0, v36
  s_sub_u32 s57, s57, 1
  s_cmp_eq_u32 s57, 0
  s_cbranch_scc1 MT2_adaLN_cond__sliding_local_dilated__swiglu_ffn__prompt_kernelx
  s_nop 1
  s_cbranch_vccnz MT2_adaLN_cond__sliding_local_dilated__swiglu_ffn__prompt_kernel
MT2_adaLN_cond__sliding_local_dilated__swiglu_ffn__prompt_kernelx:
  s_waitcnt vmcnt(14)
  v_pk_add_f32 v[92:93], v[92:93], v[96:97]
  v_pk_add_f32 v[94:95], v[94:95], v[98:99]
  s_waitcnt vmcnt(13)
  v_pk_add_f32 v[92:93], v[92:93], v[100:101]
  v_pk_add_f32 v[94:95], v[94:95], v[102:103]
  s_waitcnt vmcnt(12)
  v_pk_add_f32 v[92:93], v[92:93], v[104:105]
  v_pk_add_f32 v[94:95], v[94:95], v[106:107]
  s_waitcnt vmcnt(11)
  v_pk_add_f32 v[92:93], v[92:93], v[108:109]
  v_pk_add_f32 v[94:95], v[94:95], v[110:111]
  s_waitcnt vmcnt(10)
  v_pk_add_f32 v[92:93], v[92:93], v[112:113]
  v_pk_add_f32 v[94:95], v[94:95], v[114:115]
  s_waitcnt vmcnt(9)
  v_pk_add_f32 v[92:93], v[92:93], v[116:117]
  v_pk_add_f32 v[94:95], v[94:95], v[118:119]
  s_waitcnt vmcnt(8)
  v_pk_add_f32 v[92:93], v[92:93], v[120:121]
  v_pk_add_f32 v[94:95], v[94:95], v[122:123]
  v_cvt_pk_bf16_f32 v96, v92, v93
  v_cvt_pk_bf16_f32 v97, v94, v95
  v_lshlrev_b32 v92, 16, v96
  v_and_b32 v93, 0xffff0000, v96
  v_lshlrev_b32 v94, 16, v97
  v_and_b32 v95, 0xffff0000, v97
  v_add_f32 v92, v34, v92
  v_add_f32 v93, v34, v93
  v_add_f32 v94, v34, v94
  v_add_f32 v95, v34, v95
  v_cvt_pk_bf16_f32 v96, v92, v93
  v_cvt_pk_bf16_f32 v97, v94, v95
  v_lshlrev_b32 v92, 16, v96
  v_and_b32 v93, 0xffff0000, v96
  v_lshlrev_b32 v94, 16, v97
  v_and_b32 v95, 0xffff0000, v97
  ds_write_b128 v32, v[92:95]
  ds_read_b128 v[92:95], v33 offset:512
  ds_read_b128 v[108:111], v33 offset:0
  ds_read_b128 v[96:99], v33 offset:528
  ds_read_b128 v[112:115], v33 offset:16
  ds_read_b128 v[100:103], v33 offset:768
  ds_read_b128 v[116:119], v33 offset:256
  ds_read_b128 v[104:107], v33 offset:784
  ds_read_b128 v[120:123], v33 offset:272
  s_waitcnt lgkmcnt(4)
  v_pk_fma_f32 v[60:61], v[60:61], v[92:93], v[108:109]
  v_pk_fma_f32 v[62:63], v[62:63], v[94:95], v[110:111]
  v_pk_fma_f32 v[64:65], v[64:65], v[96:97], v[112:113]
  v_pk_fma_f32 v[66:67], v[66:67], v[98:99], v[114:115]
  v_pk_fma_f32 v[76:77], v[76:77], v[92:93], v[108:109]
  v_pk_fma_f32 v[78:79], v[78:79], v[94:95], v[110:111]
  v_pk_fma_f32 v[80:81], v[80:81], v[96:97], v[112:113]
  v_pk_fma_f32 v[82:83], v[82:83], v[98:99], v[114:115]
  v_cvt_pk_bf16_f32 v60, v60, v61
  v_cvt_pk_bf16_f32 v61, v62, v63
  v_cvt_pk_bf16_f32 v62, v64, v65
  v_cvt_pk_bf16_f32 v63, v66, v67
  v_cvt_pk_bf16_f32 v76, v76, v77
  v_cvt_pk_bf16_f32 v77, v78, v79
  v_cvt_pk_bf16_f32 v78, v80, v81
  v_cvt_pk_bf16_f32 v79, v82, v83
  v_permlane16_swap_b32 v60, v62
  v_permlane16_swap_b32 v61, v63
  buffer_store_dwordx4 v[60:63], v28, s[8:11], s38 offen offset:0 sc1
  v_permlane16_swap_b32 v76, v78
  v_permlane16_swap_b32 v77, v79
  buffer_store_dwordx4 v[76:79], v28, s[8:11], s38 offen offset:128 sc1
  s_waitcnt lgkmcnt(0)
  v_pk_fma_f32 v[68:69], v[68:69], v[100:101], v[116:117]
  v_pk_fma_f32 v[70:71], v[70:71], v[102:103], v[118:119]
  v_pk_fma_f32 v[72:73], v[72:73], v[104:105], v[120:121]
  v_pk_fma_f32 v[74:75], v[74:75], v[106:107], v[122:123]
  v_pk_fma_f32 v[84:85], v[84:85], v[100:101], v[116:117]
  v_pk_fma_f32 v[86:87], v[86:87], v[102:103], v[118:119]
  v_pk_fma_f32 v[88:89], v[88:89], v[104:105], v[120:121]
  v_pk_fma_f32 v[90:91], v[90:91], v[106:107], v[122:123]
  v_cvt_pk_bf16_f32 v68, v68, v69
  v_cvt_pk_bf16_f32 v69, v70, v71
  v_cvt_pk_bf16_f32 v70, v72, v73
  v_cvt_pk_bf16_f32 v71, v74, v75
  v_cvt_pk_bf16_f32 v84, v84, v85
  v_cvt_pk_bf16_f32 v85, v86, v87
  v_cvt_pk_bf16_f32 v86, v88, v89
  v_cvt_pk_bf16_f32 v87, v90, v91
  v_permlane16_swap_b32 v68, v70
  v_permlane16_swap_b32 v69, v71
  buffer_store_dwordx4 v[68:71], v28, s[8:11], s38 offen offset:2048 sc1
  v_permlane16_swap_b32 v84, v86
  v_permlane16_swap_b32 v85, v87
  buffer_store_dwordx4 v[84:87], v28, s[8:11], s38 offen offset:2176 sc1
  buffer_store_dwordx4 v[44:47], v28, s[8:11], s39 offen offset:0 sc1
  buffer_store_dwordx4 v[48:51], v28, s[8:11], s39 offen offset:2048 sc1
  buffer_store_dwordx4 v[52:55], v28, s[8:11], s39 offen offset:128 sc1
  buffer_store_dwordx4 v[56:59], v28, s[8:11], s39 offen offset:2176 sc1
  s_add_u32 m0, s45, 65536
  s_add_u32 s68, s66, 1
  s_and_b32 s68, s68, 7
  s_mul_i32 s68, s68, 786432
  s_add_u32 s68, s68, 2048
  buffer_load_dwordx4 v9, s[12:15], s68 offen lds
  s_add_u32 m0, s45, 69632
  s_add_u32 s68, s68, 196608
  buffer_load_dwordx4 v9, s[12:15], s68 offen lds
  s_add_u32 m0, s45, 73728
  s_add_u32 s68, s68, 196608
  buffer_load_dwordx4 v9, s[12:15], s68 offen lds
  s_add_u32 m0, s45, 77824
  s_add_u32 s68, s68, 196608
  buffer_load_dwordx4 v9, s[12:15], s68 offen lds
  s_add_u32 m0, s45, 81920
  s_add_u32 s68, s66, 1
  s_and_b32 s68, s68, 7
  s_mul_i32 s68, s68, 786432
  s_add_u32 s68, s68, 4096
  buffer_load_dwordx4 v9, s[12:15], s68 offen lds
  s_add_u32 m0, s45, 86016
  s_add_u32 s68, s68, 196608
  buffer_load_dwordx4 v9, s[12:15], s68 offen lds
  s_add_u32 m0, s45, 90112
  s_add_u32 s68, s68, 196608
  buffer_load_dwordx4 v9, s[12:15], s68 offen lds
  s_add_u32 m0, s45, 94208
  s_add_u32 s68, s68, 196608
  buffer_load_dwordx4 v9, s[12:15], s68 offen lds
  v_add_u32 v15, s46, v0
  s_waitcnt vmcnt(12)
  s_barrier
  s_mov_b64 exec, 1
  buffer_store_dword v15, v0, s[8:11], s75 offen offset:0 sc1
  s_mov_b64 exec, -1
  s_waitcnt vmcnt(33) lgkmcnt(0)
  s_barrier
  s_add_u32 m0, s45, 98304
  s_add_u32 s68, s66, 2
  s_and_b32 s68, s68, 7
  s_mul_i32 s68, s68, 786432
  buffer_load_dwordx4 v9, s[12:15], s68 offen lds
  ds_read_b64_tr_b16 a[0:1], v3 offset:0
  ds_read_b64_tr_b16 a[2:3], v3 offset:2048
  s_add_u32 m0, s45, 102400
  s_add_u32 s68, s68, 196608
  buffer_load_dwordx4 v9, s[12:15], s68 offen lds
  ds_read_b64_tr_b16 a[12:13], v3 offset:4096
  ds_read_b64_tr_b16 a[14:15], v3 offset:6144
  s_add_u32 m0, s45, 106496
  s_add_u32 s68, s68, 196608
  buffer_load_dwordx4 v9, s[12:15], s68 offen lds
  ds_read_b64_tr_b16 a[24:25], v3 offset:8192
  ds_read_b64_tr_b16 a[26:27], v3 offset:10240
  s_add_u32 m0, s45, 110592
  s_add_u32 s68, s68, 196608
  buffer_load_dwordx4 v9, s[12:15], s68 offen lds
  ds_read_b64_tr_b16 a[36:37], v3 offset:12288
  ds_read_b64_tr_b16 a[38:39], v3 offset:14336
  s_add_u32 m0, s45, 114688
  s_add_u32 s68, s66, 3
  s_and_b32 s68, s68, 7
  s_mul_i32 s68, s68, 786432
  buffer_load_dwordx4 v9, s[12:15], s68 offen lds
  ds_read_b64_tr_b16 a[48:49], v3 offset:16384
  ds_read_b64_tr_b16 a[50:51], v3 offset:18432
  s_add_u32 m0, s45, 118784
  s_add_u32 s68, s68, 196608
  buffer_load_dwordx4 v9, s[12:15], s68 offen lds
  ds_read_b64_tr_b16 a[60:61], v3 offset:20480
  ds_read_b64_tr_b16 a[62:63], v3 offset:22528
  s_add_u32 m0, s45, 122880
  s_add_u32 s68, s68, 196608
  buffer_load_dwordx4 v9, s[12:15], s68 offen lds
  ds_read_b64_tr_b16 a[72:73], v3 offset:24576
  ds_read_b64_tr_b16 a[74:75], v3 offset:26624
  s_add_u32 m0, s45, 126976
  s_add_u32 s68, s68, 196608
  buffer_load_dwordx4 v9, s[12:15], s68 offen lds
  ds_read_b64_tr_b16 a[84:85], v3 offset:28672
  ds_read_b64_tr_b16 a[86:87], v3 offset:30720
  s_waitcnt vmcnt(25) lgkmcnt(0)
  s_barrier
  s_add_u32 m0, s45, 0
  s_add_u32 s68, s66, 2
  s_and_b32 s68, s68, 7
  s_mul_i32 s68, s68, 786432
  s_add_u32 s68, s68, 2048
  buffer_load_dwordx4 v9, s[12:15], s68 offen lds
  ds_read_b64_tr_b16 a[4:5], v4 offset:32768
  ds_read_b64_tr_b16 a[6:7], v4 offset:34816
  s_add_u32 m0, s45, 4096
  s_add_u32 s68, s68, 196608
  buffer_load_dwordx4 v9, s[12:15], s68 offen lds
  ds_read_b64_tr_b16 a[8:9], v5 offset:32768
  ds_read_b64_tr_b16 a[10:11], v5 offset:34816
  s_add_u32 m0, s45, 8192
  s_add_u32 s68, s68, 196608
  buffer_load_dwordx4 v9, s[12:15], s68 offen lds
  ds_read_b64_tr_b16 a[16:17], v4 offset:36864
  ds_read_b64_tr_b16 a[18:19], v4 offset:38912
  s_add_u32 m0, s45, 12288
  s_add_u32 s68, s68, 196608
  buffer_load_dwordx4 v9, s[12:15], s68 offen lds
  ds_read_b64_tr_b16 a[20:21], v5 offset:36864
  ds_read_b64_tr_b16 a[22:23], v5 offset:38912
  s_add_u32 m0, s45, 16384
  s_add_u32 s68, s66, 2
  s_and_b32 s68, s68, 7
  s_mul_i32 s68, s68, 786432
  s_add_u32 s68, s68, 4096
  buffer_load_dwordx4 v9, s[12:15], s68 offen lds
  ds_read_b64_tr_b16 a[28:29], v4 offset:40960
  ds_read_b64_tr_b16 a[30:31], v4 offset:43008
  s_add_u32 m0, s45, 20480
  s_add_u32 s68, s68, 196608
  buffer_load_dwordx4 v9, s[12:15], s68 offen lds
  ds_read_b64_tr_b16 a[32:33], v5 offset:40960
  ds_read_b64_tr_b16 a[34:35], v5 offset:43008
  s_add_u32 m0, s45, 24576
  s_add_u32 s68, s68, 196608
  buffer_load_dwordx4 v9, s[12:15], s68 offen lds
  ds_read_b64_tr_b16 a[40:41], v4 offset:45056
  ds_read_b64_tr_b16 a[42:43], v4 offset:47104
  s_add_u32 m0, s45, 28672
  s_add_u32 s68, s68, 196608
  buffer_load_dwordx4 v9, s[12:15], s68 offen lds
  ds_read_b64_tr_b16 a[44:45], v5 offset:45056
  ds_read_b64_tr_b16 a[46:47], v5 offset:47104
  s_waitcnt vmcnt(17) lgkmcnt(0)
  s_barrier
  s_add_u32 m0, s45, 32768
  s_add_u32 s68, s66, 3
  s_and_b32 s68, s68, 7
  s_mul_i32 s68, s68, 786432
  s_add_u32 s68, s68, 2048
  buffer_load_dwordx4 v9, s[12:15], s68 offen lds
  ds_read_b64_tr_b16 a[52:53], v7 offset:0
  ds_read_b64_tr_b16 a[54:55], v7 offset:2048
  s_add_u32 m0, s45, 36864
  s_add_u32 s68, s68, 196608
  buffer_load_dwordx4 v9, s[12:15], s68 offen lds
  ds_read_b64_tr_b16 a[56:57], v8 offset:0
  ds_read_b64_tr_b16 a[58:59], v8 offset:2048
  s_add_u32 m0, s45, 40960
  s_add_u32 s68, s68, 196608
  buffer_load_dwordx4 v9, s[12:15], s68 offen lds
  ds_read_b64_tr_b16 a[64:65], v7 offset:4096
  ds_read_b64_tr_b16 a[66:67], v7 offset:6144
  s_add_u32 m0, s45, 45056
  s_add_u32 s68, s68, 196608
  buffer_load_dwordx4 v9, s[12:15], s68 offen lds
  ds_read_b64_tr_b16 a[68:69], v8 offset:4096
  ds_read_b64_tr_b16 a[70:71], v8 offset:6144
  s_add_u32 m0, s45, 49152
  s_add_u32 s68, s66, 3
  s_and_b32 s68, s68, 7
  s_mul_i32 s68, s68, 786432
  s_add_u32 s68, s68, 4096
  buffer_load_dwordx4 v9, s[12:15], s68 offen lds
  ds_read_b64_tr_b16 a[76:77], v7 offset:8192
  ds_read_b64_tr_b16 a[78:79], v7 offset:10240
  s_add_u32 m0, s45, 53248
  s_add_u32 s68, s68, 196608
  buffer_load_dwordx4 v9, s[12:15], s68 offen lds
  ds_read_b64_tr_b16 a[80:81], v8 offset:8192
  ds_read_b64_tr_b16 a[82:83], v8 offset:10240
  s_add_u32 m0, s45, 57344
  s_add_u32 s68, s68, 196608
  buffer_load_dwordx4 v9, s[12:15], s68 offen lds
  ds_read_b64_tr_b16 a[88:89], v7 offset:12288
  ds_read_b64_tr_b16 a[90:91], v7 offset:14336
  s_add_u32 m0, s45, 61440
  s_add_u32 s68, s68, 196608
  buffer_load_dwordx4 v9, s[12:15], s68 offen lds
  ds_read_b64_tr_b16 a[92:93], v8 offset:12288
  ds_read_b64_tr_b16 a[94:95], v8 offset:14336
  s_lshl_b32 s57, s44, 28
  buffer_load_dword v36, v14, s[8:11], s57 offen sc1
  s_waitcnt vmcnt(17) lgkmcnt(0)
  s_barrier
  s_add_u32 m0, s45, 65536
  s_add_u32 s68, s66, 4
  s_and_b32 s68, s68, 7
  s_mul_i32 s68, s68, 786432
  buffer_load_dwordx4 v9, s[12:15], s68 offen lds
  ds_read_b64_tr_b16 a[96:97], v6 offset:32768
  ds_read_b64_tr_b16 a[98:99], v6 offset:34816
  s_add_u32 m0, s45, 69632
  s_add_u32 s68, s68, 196608
  buffer_load_dwordx4 v9, s[12:15], s68 offen lds
  ds_read_b64_tr_b16 a[108:109], v6 offset:36864
  ds_read_b64_tr_b16 a[110:111], v6 offset:38912
  s_add_u32 m0, s45, 73728
  s_add_u32 s68, s68, 196608
  buffer_load_dwordx4 v9, s[12:15], s68 offen lds
  ds_read_b64_tr_b16 a[120:121], v6 offset:40960
  ds_read_b64_tr_b16 a[122:123], v6 offset:43008
  s_add_u32 m0, s45, 77824
  s_add_u32 s68, s68, 196608
  buffer_load_dwordx4 v9, s[12:15], s68 offen lds
  ds_read_b64_tr_b16 a[132:133], v6 offset:45056
  ds_read_b64_tr_b16 a[134:135], v6 offset:47104
  s_add_u32 m0, s45, 81920
  s_add_u32 s68, s66, 5
  s_and_b32 s68, s68, 7
  s_mul_i32 s68, s68, 786432
  buffer_load_dwordx4 v9, s[12:15], s68 offen lds
  ds_read_b64_tr_b16 a[144:145], v6 offset:49152
  ds_read_b64_tr_b16 a[146:147], v6 offset:51200
  s_add_u32 m0, s45, 86016
  s_add_u32 s68, s68, 196608
  buffer_load_dwordx4 v9, s[12:15], s68 offen lds
  ds_read_b64_tr_b16 a[156:157], v6 offset:53248
  ds_read_b64_tr_b16 a[158:159], v6 offset:55296
  s_add_u32 m0, s45, 90112
  s_add_u32 s68, s68, 196608
  buffer_load_dwordx4 v9, s[12:15], s68 offen lds
  ds_read_b64_tr_b16 a[168:169], v6 offset:57344
  ds_read_b64_tr_b16 a[170:171], v6 offset:59392
  s_add_u32 m0, s45, 94208
  s_add_u32 s68, s68, 196608
  buffer_load_dwordx4 v9, s[12:15], s68 offen lds
  ds_read_b64_tr_b16 a[180:181], v6 offset:61440
  ds_read_b64_tr_b16 a[182:183], v6 offset:63488
  s_waitcnt vmcnt(17) lgkmcnt(0)
  s_barrier
  ds_read_b64_tr_b16 a[100:101], v4 offset:0
  ds_read_b64_tr_b16 a[102:103], v4 offset:2048
  ds_read_b64_tr_b16 a[104:105], v5 offset:0
  ds_read_b64_tr_b16 a[106:107], v5 offset:2048
  ds_read_b64_tr_b16 a[112:113], v4 offset:4096
  ds_read_b64_tr_b16 a[114:115], v4 offset:6144
  ds_read_b64_tr_b16 a[116:117], v5 offset:4096
  ds_read_b64_tr_b16 a[118:119], v5 offset:6144
  ds_read_b64_tr_b16 a[124:125], v4 offset:8192
  ds_read_b64_tr_b16 a[126:127], v4 offset:10240
  ds_read_b64_tr_b16 a[128:129], v5 offset:8192
  ds_read_b64_tr_b16 a[130:131], v5 offset:10240
  ds_read_b64_tr_b16 a[136:137], v4 offset:12288
  ds_read_b64_tr_b16 a[138:139], v4 offset:14336
  ds_read_b64_tr_b16 a[140:141], v5 offset:12288
  ds_read_b64_tr_b16 a[142:143], v5 offset:14336
  s_waitcnt vmcnt(8)
  s_cmp_lg_u32 s44, 0
  s_cbranch_scc1 PL3_adaLN_cond__sliding_local_dilated__swiglu_ffn__prompt_kernelx
  v_cmp_ne_u32 vcc, s46, v36
  s_nop 4
  s_cbranch_vccz PL3_adaLN_cond__sliding_local_dilated__swiglu_ffn__prompt_kernelx
  s_mov_b32 s57, 60000
PL3_adaLN_cond__sliding_local_dilated__swiglu_ffn__prompt_kernel:
  buffer_load_dword v36, v14, s[8:11], 0 offen sc1
  s_sub_u32 s57, s57, 1
  s_cmp_eq_u32 s57, 0
  s_waitcnt vmcnt(0)
  s_cbranch_scc1 PL3_adaLN_cond__sliding_local_dilated__swiglu_ffn__prompt_kernelx
  v_cmp_ne_u32 vcc, s46, v36
  s_nop 4
  s_cbranch_vccnz PL3_adaLN_cond__sliding_local_dilated__swiglu_ffn__prompt_kernel
PL3_adaLN_cond__sliding_local_dilated__swiglu_ffn__prompt_kernelx:
  s_barrier
  s_add_u32 m0, s70, 98304
  s_add_u32 s69, s58, 32768
  buffer_load_dwordx4 v12, s[8:11], s69 offen offset:0 sc1 lds
  buffer_load_dwordx4 v12, s[8:11], s69 offen offset:1024 sc1 lds
  buffer_load_dwordx4 v12, s[8:11], s69 offen offset:2048 sc1 lds
  buffer_load_dwordx4 v12, s[8:11], s69 offen offset:3072 sc1 lds
  s_add_u32 m0, s71, 131072
  s_add_u32 s69, s58, s72
  buffer_load_dwordx4 v1, s[8:11], s69 offen offset:0 sc1 lds
  buffer_load_dwordx4 v1, s[8:11], s69 offen offset:1024 sc1 lds
  s_add_u32 m0, s70, 114688
  s_add_u32 s69, s59, 32768
  buffer_load_dwordx4 v12, s[8:11], s69 offen offset:0 sc1 lds
  buffer_load_dwordx4 v12, s[8:11], s69 offen offset:1024 sc1 lds
  buffer_load_dwordx4 v12, s[8:11], s69 offen offset:2048 sc1 lds
  buffer_load_dwordx4 v12, s[8:11], s69 offen offset:3072 sc1 lds
  s_add_u32 m0, s71, 139264
  s_add_u32 s69, s59, s72
  buffer_load_dwordx4 v1, s[8:11], s69 offen offset:0 sc1 lds
  buffer_load_dwordx4 v1, s[8:11], s69 offen offset:1024 sc1 lds
  s_waitcnt vmcnt(21) lgkmcnt(0)
  s_barrier
  s_add_u32 m0, s45, 0
  s_add_u32 s68, s66, 4
  s_and_b32 s68, s68, 7
  s_mul_i32 s68, s68, 786432
  s_add_u32 s68, s68, 2048
  buffer_load_dwordx4 v9, s[12:15], s68 offen lds
  ds_read_b64_tr_b16 a[148:149], v4 offset:32768
  ds_read_b64_tr_b16 a[150:151], v4 offset:34816
  s_add_u32 m0, s45, 4096
  s_add_u32 s68, s68, 196608
  buffer_load_dwordx4 v9, s[12:15], s68 offen lds
  ds_read_b64_tr_b16 a[152:153], v5 offset:32768
  ds_read_b64_tr_b16 a[154:155], v5 offset:34816
  s_add_u32 m0, s45, 8192
  s_add_u32 s68, s68, 196608
  buffer_load_dwordx4 v9, s[12:15], s68 offen lds
  ds_read_b64_tr_b16 a[160:161], v4 offset:36864
  ds_read_b64_tr_b16 a[162:163], v4 offset:38912
  s_add_u32 m0, s45, 12288
  s_add_u32 s68, s68, 196608
  buffer_load_dwordx4 v9, s[12:15], s68 offen lds
  ds_read_b64_tr_b16 a[164:165], v5 offset:36864
  ds_read_b64_tr_b16 a[166:167], v5 offset:38912
  s_add_u32 m0, s45, 16384
  s_add_u32 s68, s66, 4
  s_and_b32 s68, s68, 7
  s_mul_i32 s68, s68, 786432
  s_add_u32 s68, s68, 4096
  buffer_load_dwordx4 v9, s[12:15], s68 offen lds
  ds_read_b64_tr_b16 a[172:173], v4 offset:40960
  ds_read_b64_tr_b16 a[174:175], v4 offset:43008
  s_add_u32 m0, s45, 20480
  s_add_u32 s68, s68, 196608
  buffer_load_dwordx4 v9, s[12:15], s68 offen lds
  ds_read_b64_tr_b16 a[176:177], v5 offset:40960
  ds_read_b64_tr_b16 a[178:179], v5 offset:43008
  s_add_u32 m0, s45, 24576
  s_add_u32 s68, s68, 196608
  buffer_load_dwordx4 v9, s[12:15], s68 offen lds
  ds_read_b64_tr_b16 a[184:185], v4 offset:45056
  ds_read_b64_tr_b16 a[186:187], v4 offset:47104
  s_add_u32 m0, s45, 28672
  s_add_u32 s68, s68, 196608
  buffer_load_dwordx4 v9, s[12:15], s68 offen lds
  ds_read_b64_tr_b16 a[188:189], v5 offset:45056
  ds_read_b64_tr_b16 a[190:191], v5 offset:47104
  s_waitcnt vmcnt(14) lgkmcnt(0)
  s_barrier
  ds_read_b128 v[76:79], v2 offset:32768
  ds_read_b128 v[80:83], v2 offset:33792
  ds_read_b128 v[84:87], v2 offset:40960
  ds_read_b128 v[88:91], v2 offset:41984
  ds_read_b128 v[92:95], v13 offset:0
  ds_read_b128 v[96:99], v13 offset:1024
  ds_read_b128 v[100:103], v2 offset:34816
  ds_read_b128 v[104:107], v2 offset:35840
  s_waitcnt lgkmcnt(2)
  v_mfma_f32_16x16x32_bf16 v[28:31], a[0:3], v[76:79], 0
  ds_read_b64_tr_b16 a[192:193], v6 offset:0
  s_add_u32 m0, s45, 32768
  s_add_u32 s68, s66, 5
  s_and_b32 s68, s68, 7
  s_mul_i32 s68, s68, 786432
  s_add_u32 s68, s68, 2048
  v_mfma_f32_16x16x32_bf16 v[28:31], a[12:15], v[80:83], v[28:31]
  ds_read_b128 v[108:111], v2 offset:43008
  buffer_load_dwordx4 v9, s[12:15], s68 offen lds
  v_mfma_f32_16x16x32_bf16 v[32:35], a[12:15], v[88:91], 0
  ds_read_b64_tr_b16 a[194:195], v6 offset:2048
  v_mfma_f32_16x16x32_bf16 v[32:35], a[0:3], v[84:87], v[32:35]
  ds_read_b64_tr_b16 a[204:205], v6 offset:4096
  v_mfma_f32_16x16x32_bf16 v[40:43], a[4:7], v[84:87], 0
  ds_read_b128 v[112:115], v2 offset:44032
  s_add_u32 m0, s45, 36864
  s_add_u32 s68, s68, 196608
  v_mfma_f32_16x16x32_bf16 v[40:43], a[16:19], v[88:91], v[40:43]
  ds_read_b64_tr_b16 a[206:207], v6 offset:6144
  buffer_load_dwordx4 v9, s[12:15], s68 offen lds
  v_mfma_f32_16x16x32_bf16 v[36:39], a[16:19], v[80:83], 0
  ds_read_b128 v[116:119], v13 offset:2048
  v_mfma_f32_16x16x32_bf16 v[36:39], a[4:7], v[76:79], v[36:39]
  ds_read_b64_tr_b16 a[216:217], v6 offset:8192
  v_mfma_f32_16x16x32_bf16 v[44:47], a[8:11], v[76:79], 0
  ds_read_b64_tr_b16 a[218:219], v6 offset:10240
  s_add_u32 m0, s45, 40960
  s_add_u32 s68, s68, 196608
  v_mfma_f32_16x16x32_bf16 v[44:47], a[20:23], v[80:83], v[44:47]
  ds_read_b128 v[120:123], v13 offset:3072
  buffer_load_dwordx4 v9, s[12:15], s68 offen lds
  v_mfma_f32_16x16x32_bf16 v[48:51], a[20:23], v[88:91], 0
  ds_read_b64_tr_b16 a[228:229], v6 offset:12288
  v_mfma_f32_16x16x32_bf16 v[48:51], a[8:11], v[84:87], v[48:51]
  ds_read_b64_tr_b16 a[230:231], v6 offset:14336
  v_mfma_f32_16x16x32_bf16 v[68:71], a[8:11], v[92:95], 0
  ds_read_b128 v[76:79], v2 offset:36864
  s_add_u32 m0, s45, 45056
  s_add_u32 s68, s68, 196608
  v_mfma_f32_16x16x32_bf16 v[68:71], a[20:23], v[96:99], v[68:71]
  ds_read_b64_tr_b16 a[240:241], v6 offset:16384
  buffer_load_dwordx4 v9, s[12:15], s68 offen lds
  v_mfma_f32_16x16x32_bf16 v[60:63], a[16:19], v[96:99], 0
  ds_read_b128 v[80:83], v2 offset:37888
  v_mfma_f32_16x16x32_bf16 v[60:63], a[4:7], v[92:95], v[60:63]
  s_waitcnt lgkmcnt(5)
  ds_read_b64_tr_b16 a[242:243], v6 offset:18432
  v_mfma_f32_16x16x32_bf16 v[28:31], a[24:27], v[100:103], v[28:31]
  ds_read_b64_tr_b16 v[124:125], v6 offset:20480
  s_add_u32 m0, s45, 49152
  s_add_u32 s68, s66, 5
  s_and_b32 s68, s68, 7
  s_mul_i32 s68, s68, 786432
  s_add_u32 s68, s68, 4096
  v_mfma_f32_16x16x32_bf16 v[28:31], a[36:39], v[104:107], v[28:31]
  ds_read_b128 v[88:91], v2 offset:45056
  buffer_load_dwordx4 v9, s[12:15], s68 offen lds
  v_mfma_f32_16x16x32_bf16 v[32:35], a[36:39], v[112:115], v[32:35]
  ds_read_b64_tr_b16 v[126:127], v6 offset:22528
  v_mfma_f32_16x16x32_bf16 v[32:35], a[24:27], v[108:111], v[32:35]
  ds_read_b64_tr_b16 v[136:137], v6 offset:24576
  v_mfma_f32_16x16x32_bf16 v[40:43], a[28:31], v[108:111], v[40:43]
  ds_read_b128 v[84:87], v2 offset:46080
  s_add_u32 m0, s45, 53248
  s_add_u32 s68, s68, 196608
  v_mfma_f32_16x16x32_bf16 v[40:43], a[40:43], v[112:115], v[40:43]
  ds_read_b64_tr_b16 v[138:139], v6 offset:26624
  buffer_load_dwordx4 v9, s[12:15], s68 offen lds
  v_mfma_f32_16x16x32_bf16 v[36:39], a[40:43], v[104:107], v[36:39]
  ds_read_b128 v[96:99], v13 offset:4096
  v_mfma_f32_16x16x32_bf16 v[36:39], a[28:31], v[100:103], v[36:39]
  ds_read_b64_tr_b16 v[148:149], v6 offset:28672
  v_mfma_f32_16x16x32_bf16 v[44:47], a[32:35], v[100:103], v[44:47]
  ds_read_b64_tr_b16 v[150:151], v6 offset:30720
  v_mfma_f32_16x16x32_bf16 v[44:47], a[44:47], v[104:107], v[44:47]
  ds_read_b128 v[92:95], v13 offset:5120
  s_add_u32 m0, s45, 57344
  s_add_u32 s68, s68, 196608
  v_mfma_f32_16x16x32_bf16 v[48:51], a[44:47], v[112:115], v[48:51]
  buffer_load_dwordx4 v9, s[12:15], s68 offen lds
  v_mfma_f32_16x16x32_bf16 v[48:51], a[32:35], v[108:111], v[48:51]
  s_add_u32 m0, s45, 61440
  s_add_u32 s68, s68, 196608
  v_mfma_f32_16x16x32_bf16 v[68:71], a[32:35], v[116:119], v[68:71]
  ds_read_b128 v[100:103], v2 offset:38912
  v_mfma_f32_16x16x32_bf16 v[68:71], a[44:47], v[120:123], v[68:71]
  buffer_load_dwordx4 v9, s[12:15], s68 offen lds
  v_mfma_f32_16x16x32_bf16 v[60:63], a[40:43], v[120:123], v[60:63]
  ds_read_b128 v[104:107], v2 offset:39936
  v_mfma_f32_16x16x32_bf16 v[60:63], a[28:31], v[116:119], v[60:63]
  s_waitcnt lgkmcnt(2)
  v_mfma_f32_16x16x32_bf16 v[28:31], a[48:51], v[76:79], v[28:31]
  s_add_u32 m0, s71, 147456
  s_add_u32 s69, s60, s72
  v_mfma_f32_16x16x32_bf16 v[28:31], a[60:63], v[80:83], v[28:31]
  ds_read_b128 v[112:115], v2 offset:47104
  v_mfma_f32_16x16x32_bf16 v[32:35], a[60:63], v[84:87], v[32:35]
  buffer_load_dwordx4 v1, s[8:11], s69 offen offset:0 sc1 lds
  v_mfma_f32_16x16x32_bf16 v[32:35], a[48:51], v[88:91], v[32:35]
  v_mfma_f32_16x16x32_bf16 v[40:43], a[52:55], v[88:91], v[40:43]
  ds_read_b128 v[108:111], v2 offset:48128
  v_mfma_f32_16x16x32_bf16 v[40:43], a[64:67], v[84:87], v[40:43]
  buffer_load_dwordx4 v1, s[8:11], s69 offen offset:1024 sc1 lds
  v_mfma_f32_16x16x32_bf16 v[36:39], a[64:67], v[80:83], v[36:39]
  ds_read_b128 v[120:123], v13 offset:6144
  v_mfma_f32_16x16x32_bf16 v[36:39], a[52:55], v[76:79], v[36:39]
  v_mfma_f32_16x16x32_bf16 v[44:47], a[56:59], v[76:79], v[44:47]
  s_add_u32 m0, s71, 155648
  s_add_u32 s69, s61, s72
  v_mfma_f32_16x16x32_bf16 v[44:47], a[68:71], v[80:83], v[44:47]
  ds_read_b128 v[116:119], v13 offset:7168
  v_mfma_f32_16x16x32_bf16 v[48:51], a[68:71], v[84:87], v[48:51]
  buffer_load_dwordx4 v1, s[8:11], s69 offen offset:0 sc1 lds
  v_mfma_f32_16x16x32_bf16 v[48:51], a[56:59], v[88:91], v[48:51]
  s_waitcnt vmcnt(11) lgkmcnt(7)
  s_barrier
  v_mfma_f32_16x16x32_bf16 v[68:71], a[56:59], v[96:99], v[68:71]
  ds_read_b128 v[76:79], v2 offset:49152
  v_mfma_f32_16x16x32_bf16 v[68:71], a[68:71], v[92:95], v[68:71]
  ds_read_b64_tr_b16 a[196:197], v4 offset:0
HOP1:
  s_cbranch_execz HOP5
  buffer_load_dwordx4 v1, s[8:11], s69 offen offset:1024 sc1 lds
  v_mfma_f32_16x16x32_bf16 v[60:63], a[64:67], v[92:95], v[60:63]
  ds_read_b128 v[80:83], v2 offset:50176
  v_mfma_f32_16x16x32_bf16 v[60:63], a[52:55], v[96:99], v[60:63]
  s_waitcnt lgkmcnt(3)
  ds_read_b64_tr_b16 a[198:199], v4 offset:2048
  v_mfma_f32_16x16x32_bf16 v[28:31], a[72:75], v[100:103], v[28:31]
  ds_read_b64_tr_b16 a[200:201], v5 offset:0
  s_add_u32 m0, s70, 65536
  s_add_u32 s69, s60, 32768
  v_mfma_f32_16x16x32_bf16 v[28:31], a[84:87], v[104:107], v[28:31]
  ds_read_b128 v[84:87], v2 offset:57344
  buffer_load_dwordx4 v12, s[8:11], s69 offen offset:0 sc1 lds
  v_mfma_f32_16x16x32_bf16 v[32:35], a[84:87], v[108:111], v[32:35]
  ds_read_b64_tr_b16 a[202:203], v5 offset:2048
  v_mfma_f32_16x16x32_bf16 v[32:35], a[72:75], v[112:115], v[32:35]
  ds_read_b64_tr_b16 a[208:209], v4 offset:4096
  v_mfma_f32_16x16x32_bf16 v[40:43], a[76:79], v[112:115], v[40:43]
  ds_read_b128 v[88:91], v2 offset:58368
  v_mfma_f32_16x16x32_bf16 v[40:43], a[88:91], v[108:111], v[40:43]
  ds_read_b64_tr_b16 a[210:211], v4 offset:6144
  buffer_load_dwordx4 v12, s[8:11], s69 offen offset:1024 sc1 lds
  v_mfma_f32_16x16x32_bf16 v[36:39], a[88:91], v[104:107], v[36:39]
  ds_read_b128 v[92:95], v13 offset:8192
  v_mfma_f32_16x16x32_bf16 v[36:39], a[76:79], v[100:103], v[36:39]
  ds_read_b64_tr_b16 a[212:213], v5 offset:4096
  v_mfma_f32_16x16x32_bf16 v[44:47], a[80:83], v[100:103], v[44:47]
  ds_read_b64_tr_b16 a[214:215], v5 offset:6144
  v_mfma_f32_16x16x32_bf16 v[44:47], a[92:95], v[104:107], v[44:47]
  ds_read_b128 v[96:99], v13 offset:9216
  buffer_load_dwordx4 v12, s[8:11], s69 offen offset:2048 sc1 lds
  v_mfma_f32_16x16x32_bf16 v[48:51], a[92:95], v[108:111], v[48:51]
  ds_read_b64_tr_b16 a[220:221], v4 offset:8192
  v_mfma_f32_16x16x32_bf16 v[48:51], a[80:83], v[112:115], v[48:51]
  ds_read_b64_tr_b16 a[222:223], v4 offset:10240
  v_mfma_f32_16x16x32_bf16 v[68:71], a[80:83], v[120:123], v[68:71]
  ds_read_b128 v[100:103], v2 offset:51200
  v_mfma_f32_16x16x32_bf16 v[68:71], a[92:95], v[116:119], v[68:71]
  ds_read_b64_tr_b16 a[224:225], v5 offset:8192
  buffer_load_dwordx4 v12, s[8:11], s69 offen offset:3072 sc1 lds
  v_mfma_f32_16x16x32_bf16 v[60:63], a[88:91], v[116:119], v[60:63]
  ds_read_b128 v[104:107], v2 offset:52224
  v_mfma_f32_16x16x32_bf16 v[60:63], a[76:79], v[120:123], v[60:63]
  s_waitcnt lgkmcnt(5)
  ds_read_b64_tr_b16 a[226:227], v5 offset:10240
  v_mfma_f32_16x16x32_bf16 v[28:31], a[96:99], v[76:79], v[28:31]
  ds_read_b64_tr_b16 a[232:233], v4 offset:12288
  s_add_u32 m0, s45, 81920
  s_add_u32 s68, s66, 6
  s_and_b32 s68, s68, 7
  s_mul_i32 s68, s68, 786432
  v_mfma_f32_16x16x32_bf16 v[28:31], a[108:111], v[80:83], v[28:31]
  ds_read_b128 v[108:111], v2 offset:59392
  buffer_load_dwordx4 v9, s[12:15], s68 offen lds
  v_mfma_f32_16x16x32_bf16 v[32:35], a[108:111], v[88:91], v[32:35]
  ds_read_b64_tr_b16 a[234:235], v4 offset:14336
  v_mfma_f32_16x16x32_bf16 v[32:35], a[96:99], v[84:87], v[32:35]
  ds_read_b64_tr_b16 a[236:237], v5 offset:12288
  v_mfma_f32_16x16x32_bf16 v[40:43], a[100:103], v[84:87], v[40:43]
  ds_read_b128 v[112:115], v2 offset:60416
  s_add_u32 m0, s45, 86016
  s_add_u32 s68, s68, 196608
  v_mfma_f32_16x16x32_bf16 v[40:43], a[112:115], v[88:91], v[40:43]
  ds_read_b64_tr_b16 a[238:239], v5 offset:14336
  buffer_load_dwordx4 v9, s[12:15], s68 offen lds
  v_mfma_f32_16x16x32_bf16 v[36:39], a[112:115], v[80:83], v[36:39]
  ds_read_b128 v[116:119], v13 offset:10240
  v_mfma_f32_16x16x32_bf16 v[36:39], a[100:103], v[76:79], v[36:39]
  v_mfma_f32_16x16x32_bf16 v[44:47], a[104:107], v[76:79], v[44:47]
  s_add_u32 m0, s45, 90112
  s_add_u32 s68, s68, 196608
  v_mfma_f32_16x16x32_bf16 v[44:47], a[116:119], v[80:83], v[44:47]
  ds_read_b128 v[120:123], v13 offset:11264
  v_mfma_f32_16x16x32_bf16 v[48:51], a[116:119], v[88:91], v[48:51]
  buffer_load_dwordx4 v9, s[12:15], s68 offen lds
  v_mfma_f32_16x16x32_bf16 v[48:51], a[104:107], v[84:87], v[48:51]
  s_waitcnt vmcnt(11) lgkmcnt(2)
  s_barrier
  v_mfma_f32_16x16x32_bf16 v[68:71], a[104:107], v[92:95], v[68:71]
  ds_read_b128 v[76:79], v2 offset:53248
  s_add_u32 m0, s45, 94208
  s_add_u32 s68, s68, 196608
  v_mfma_f32_16x16x32_bf16 v[68:71], a[116:119], v[96:99], v[68:71]
  ds_read_b64_tr_b16 a[244:245], v4 offset:32768
  buffer_load_dwordx4 v9, s[12:15], s68 offen lds
  v_mfma_f32_16x16x32_bf16 v[60:63], a[112:115], v[96:99], v[60:63]
  ds_read_b128 v[80:83], v2 offset:54272
  v_mfma_f32_16x16x32_bf16 v[60:63], a[100:103], v[92:95], v[60:63]
  s_waitcnt lgkmcnt(3)
  ds_read_b64_tr_b16 a[246:247], v4 offset:34816
  v_mfma_f32_16x16x32_bf16 v[28:31], a[120:123], v[100:103], v[28:31]
  ds_read_b64_tr_b16 a[248:249], v5 offset:32768
  s_add_u32 m0, s45, 98304
  s_add_u32 s68, s66, 7
  s_and_b32 s68, s68, 7
  s_mul_i32 s68, s68, 786432
  v_mfma_f32_16x16x32_bf16 v[28:31], a[132:135], v[104:107], v[28:31]
  ds_read_b128 v[88:91], v2 offset:61440
  buffer_load_dwordx4 v9, s[12:15], s68 offen lds
  v_mfma_f32_16x16x32_bf16 v[32:35], a[132:135], v[112:115], v[32:35]
  ds_read_b64_tr_b16 a[250:251], v5 offset:34816
  v_mfma_f32_16x16x32_bf16 v[32:35], a[120:123], v[108:111], v[32:35]
  ds_read_b64_tr_b16 v[128:129], v4 offset:36864
  v_mfma_f32_16x16x32_bf16 v[40:43], a[124:127], v[108:111], v[40:43]
  ds_read_b128 v[84:87], v2 offset:62464
  s_add_u32 m0, s45, 102400
  s_add_u32 s68, s68, 196608
  v_mfma_f32_16x16x32_bf16 v[40:43], a[136:139], v[112:115], v[40:43]
  ds_read_b64_tr_b16 v[130:131], v4 offset:38912
  buffer_load_dwordx4 v9, s[12:15], s68 offen lds
  v_mfma_f32_16x16x32_bf16 v[36:39], a[136:139], v[104:107], v[36:39]
  ds_read_b128 v[96:99], v13 offset:12288
  v_mfma_f32_16x16x32_bf16 v[36:39], a[124:127], v[100:103], v[36:39]
  ds_read_b64_tr_b16 v[132:133], v5 offset:36864
  v_mfma_f32_16x16x32_bf16 v[44:47], a[128:131], v[100:103], v[44:47]
  ds_read_b64_tr_b16 v[134:135], v5 offset:38912
  s_add_u32 m0, s45, 106496
  s_add_u32 s68, s68, 196608
  v_mfma_f32_16x16x32_bf16 v[44:47], a[140:143], v[104:107], v[44:47]
  ds_read_b128 v[92:95], v13 offset:13312
  buffer_load_dwordx4 v9, s[12:15], s68 offen lds
  v_mfma_f32_16x16x32_bf16 v[48:51], a[140:143], v[112:115], v[48:51]
  ds_read_b64_tr_b16 v[140:141], v4 offset:40960
  v_mfma_f32_16x16x32_bf16 v[48:51], a[128:131], v[108:111], v[48:51]
  ds_read_b64_tr_b16 v[142:143], v4 offset:43008
  v_mfma_f32_16x16x32_bf16 v[68:71], a[128:131], v[116:119], v[68:71]
  ds_read_b128 v[100:103], v2 offset:55296
  s_add_u32 m0, s45, 110592
  s_add_u32 s68, s68, 196608
  v_mfma_f32_16x16x32_bf16 v[68:71], a[140:143], v[120:123], v[68:71]
  ds_read_b64_tr_b16 v[144:145], v5 offset:40960
  buffer_load_dwordx4 v9, s[12:15], s68 offen lds
  v_mfma_f32_16x16x32_bf16 v[60:63], a[136:139], v[120:123], v[60:63]
  ds_read_b128 v[104:107], v2 offset:56320
  v_mfma_f32_16x16x32_bf16 v[60:63], a[124:127], v[116:119], v[60:63]
  s_waitcnt lgkmcnt(5)
  ds_read_b64_tr_b16 v[146:147], v5 offset:43008
  v_mfma_f32_16x16x32_bf16 v[28:31], a[144:147], v[76:79], v[28:31]
  ds_read_b64_tr_b16 v[152:153], v4 offset:45056
  s_add_u32 m0, s45, 0
  s_add_u32 s68, s66, 6
  s_and_b32 s68, s68, 7
  s_mul_i32 s68, s68, 786432
  s_add_u32 s68, s68, 2048
  v_mfma_f32_16x16x32_bf16 v[28:31], a[156:159], v[80:83], v[28:31]
  ds_read_b128 v[112:115], v2 offset:63488
  buffer_load_dwordx4 v9, s[12:15], s68 offen lds
  v_mfma_f32_16x16x32_bf16 v[32:35], a[156:159], v[84:87], v[32:35]
  ds_read_b64_tr_b16 v[154:155], v4 offset:47104
  v_mfma_f32_16x16x32_bf16 v[32:35], a[144:147], v[88:91], v[32:35]
  ds_read_b64_tr_b16 v[156:157], v5 offset:45056
  v_mfma_f32_16x16x32_bf16 v[40:43], a[148:151], v[88:91], v[40:43]
  ds_read_b128 v[108:111], v2 offset:64512
  s_add_u32 m0, s45, 4096
  s_add_u32 s68, s68, 196608
  v_mfma_f32_16x16x32_bf16 v[40:43], a[160:163], v[84:87], v[40:43]
  ds_read_b64_tr_b16 v[158:159], v5 offset:47104
  buffer_load_dwordx4 v9, s[12:15], s68 offen lds
  v_mfma_f32_16x16x32_bf16 v[36:39], a[160:163], v[80:83], v[36:39]
  ds_read_b128 v[120:123], v13 offset:14336
  v_mfma_f32_16x16x32_bf16 v[36:39], a[148:151], v[76:79], v[36:39]
  v_mfma_f32_16x16x32_bf16 v[44:47], a[152:155], v[76:79], v[44:47]
  s_add_u32 m0, s45, 8192
  s_add_u32 s68, s68, 196608
  v_mfma_f32_16x16x32_bf16 v[44:47], a[164:167], v[80:83], v[44:47]
  ds_read_b128 v[116:119], v13 offset:15360
  v_mfma_f32_16x16x32_bf16 v[48:51], a[164:167], v[84:87], v[48:51]
  buffer_load_dwordx4 v9, s[12:15], s68 offen lds
  v_mfma_f32_16x16x32_bf16 v[48:51], a[152:155], v[88:91], v[48:51]
  s_waitcnt vmcnt(3) lgkmcnt(2)
  s_barrier
  v_mfma_f32_16x16x32_bf16 v[68:71], a[152:155], v[96:99], v[68:71]
  ds_read_b128 v[76:79], v2 offset:0
  s_add_u32 m0, s45, 12288
  s_add_u32 s68, s68, 196608
  v_mfma_f32_16x16x32_bf16 v[68:71], a[164:167], v[92:95], v[68:71]
  ds_read_b64_tr_b16 v[160:161], v6 offset:16384
  buffer_load_dwordx4 v9, s[12:15], s68 offen lds
  v_mfma_f32_16x16x32_bf16 v[60:63], a[160:163], v[92:95], v[60:63]
  ds_read_b128 v[80:83], v2 offset:1024
  v_mfma_f32_16x16x32_bf16 v[60:63], a[148:151], v[96:99], v[60:63]
  s_waitcnt lgkmcnt(3)
  ds_read_b64_tr_b16 v[162:163], v6 offset:18432
  v_mfma_f32_16x16x32_bf16 v[28:31], a[168:171], v[100:103], v[28:31]
  ds_read_b64_tr_b16 v[172:173], v6 offset:20480
  s_add_u32 m0, s45, 16384
  s_add_u32 s68, s66, 6
  s_and_b32 s68, s68, 7
  s_mul_i32 s68, s68, 786432
  s_add_u32 s68, s68, 4096
  v_mfma_f32_16x16x32_bf16 v[28:31], a[180:183], v[104:107], v[28:31]
  ds_read_b128 v[84:87], v2 offset:8192
  buffer_load_dwordx4 v9, s[12:15], s68 offen lds
  v_mfma_f32_16x16x32_bf16 v[32:35], a[180:183], v[108:111], v[32:35]
  ds_read_b64_tr_b16 v[174:175], v6 offset:22528
  v_mfma_f32_16x16x32_bf16 v[32:35], a[168:171], v[112:115], v[32:35]
  ds_read_b64_tr_b16 v[184:185], v6 offset:24576
  v_mfma_f32_16x16x32_bf16 v[40:43], a[172:175], v[112:115], v[40:43]
  ds_read_b128 v[88:91], v2 offset:9216
  s_add_u32 m0, s45, 20480
  s_add_u32 s68, s68, 196608
  v_mfma_f32_16x16x32_bf16 v[40:43], a[184:187], v[108:111], v[40:43]
  ds_read_b64_tr_b16 v[186:187], v6 offset:26624
  buffer_load_dwordx4 v9, s[12:15], s68 offen lds
  v_mfma_f32_16x16x32_bf16 v[36:39], a[184:187], v[104:107], v[36:39]
  ds_read_b128 v[92:95], v13 offset:16384
  v_mfma_f32_16x16x32_bf16 v[36:39], a[172:175], v[100:103], v[36:39]
  ds_read_b64_tr_b16 v[196:197], v6 offset:28672
  v_mfma_f32_16x16x32_bf16 v[44:47], a[176:179], v[100:103], v[44:47]
  ds_read_b64_tr_b16 v[198:199], v6 offset:30720
  s_add_u32 m0, s45, 24576
  s_add_u32 s68, s68, 196608
  v_mfma_f32_16x16x32_bf16 v[44:47], a[188:191], v[104:107], v[44:47]
  ds_read_b128 v[96:99], v13 offset:17408
  buffer_load_dwordx4 v9, s[12:15], s68 offen lds
  v_mfma_f32_16x16x32_bf16 v[48:51], a[188:191], v[108:111], v[48:51]
  ds_read_b64_tr_b16 v[208:209], v6 offset:32768
  v_mfma_f32_16x16x32_bf16 v[48:51], a[176:179], v[112:115], v[48:51]
  ds_read_b64_tr_b16 v[210:211], v6 offset:34816
  v_mfma_f32_16x16x32_bf16 v[68:71], a[176:179], v[120:123], v[68:71]
  ds_read_b128 v[100:103], v2 offset:2048
  s_add_u32 m0, s45, 28672
  s_add_u32 s68, s68, 196608
  v_mfma_f32_16x16x32_bf16 v[68:71], a[188:191], v[116:119], v[68:71]
  ds_read_b64_tr_b16 v[220:221], v6 offset:36864
  buffer_load_dwordx4 v9, s[12:15], s68 offen lds
  v_mfma_f32_16x16x32_bf16 v[60:63], a[184:187], v[116:119], v[60:63]
  ds_read_b128 v[104:107], v2 offset:3072
  v_mfma_f32_16x16x32_bf16 v[60:63], a[172:175], v[120:123], v[60:63]
  s_waitcnt lgkmcnt(5)
  ds_read_b64_tr_b16 v[222:223], v6 offset:38912
  v_mfma_f32_16x16x32_bf16 v[28:31], a[192:195], v[76:79], v[28:31]
  ds_read_b64_tr_b16 v[232:233], v6 offset:40960
  s_add_u32 m0, s70, 32768
  s_add_u32 s69, s61, 32768
  v_mfma_f32_16x16x32_bf16 v[28:31], a[204:207], v[80:83], v[28:31]
  ds_read_b128 v[108:111], v2 offset:10240
  buffer_load_dwordx4 v12, s[8:11], s69 offen offset:0 sc1 lds
  v_mfma_f32_16x16x32_bf16 v[32:35], a[204:207], v[88:91], v[32:35]
  ds_read_b64_tr_b16 v[234:235], v6 offset:43008
  v_mfma_f32_16x16x32_bf16 v[32:35], a[192:195], v[84:87], v[32:35]
  ds_read_b64_tr_b16 v[244:245], v6 offset:45056
  v_mfma_f32_16x16x32_bf16 v[40:43], a[196:199], v[84:87], v[40:43]
  ds_read_b128 v[112:115], v2 offset:11264
  v_mfma_f32_16x16x32_bf16 v[40:43], a[208:211], v[88:91], v[40:43]
  ds_read_b64_tr_b16 v[246:247], v6 offset:47104
  buffer_load_dwordx4 v12, s[8:11], s69 offen offset:1024 sc1 lds
  v_mfma_f32_16x16x32_bf16 v[36:39], a[208:211], v[80:83], v[36:39]
  ds_read_b128 v[116:119], v13 offset:18432
  v_mfma_f32_16x16x32_bf16 v[36:39], a[196:199], v[76:79], v[36:39]
  v_mfma_f32_16x16x32_bf16 v[44:47], a[200:203], v[76:79], v[44:47]
  v_mfma_f32_16x16x32_bf16 v[44:47], a[212:215], v[80:83], v[44:47]
  ds_read_b128 v[120:123], v13 offset:19456
  v_mfma_f32_16x16x32_bf16 v[48:51], a[212:215], v[88:91], v[48:51]
  buffer_load_dwordx4 v12, s[8:11], s69 offen offset:2048 sc1 lds
  v_mfma_f32_16x16x32_bf16 v[48:51], a[200:203], v[84:87], v[48:51]
  s_waitcnt vmcnt(3) lgkmcnt(2)
  s_barrier
  v_mfma_f32_16x16x32_bf16 v[68:71], a[200:203], v[92:95], v[68:71]
  ds_read_b128 v[76:79], v2 offset:4096
  v_mfma_f32_16x16x32_bf16 v[68:71], a[212:215], v[96:99], v[68:71]
  ds_read_b64_tr_b16 v[164:165], v4 offset:0
  buffer_load_dwordx4 v12, s[8:11], s69 offen offset:3072 sc1 lds
  v_mfma_f32_16x16x32_bf16 v[60:63], a[208:211], v[96:99], v[60:63]
  ds_read_b128 v[80:83], v2 offset:5120
  v_mfma_f32_16x16x32_bf16 v[60:63], a[196:199], v[92:95], v[60:63]
  s_waitcnt lgkmcnt(3)
  ds_read_b64_tr_b16 v[166:167], v4 offset:2048
  v_mfma_f32_16x16x32_bf16 v[28:31], a[216:219], v[100:103], v[28:31]
  ds_read_b64_tr_b16 v[168:169], v5 offset:0
  s_add_u32 m0, s45, 81920
  s_add_u32 s68, s66, 7
  s_and_b32 s68, s68, 7
  s_mul_i32 s68, s68, 786432
  s_add_u32 s68, s68, 2048
  v_mfma_f32_16x16x32_bf16 v[28:31], a[228:231], v[104:107], v[28:31]
  ds_read_b128 v[88:91], v2 offset:12288
  buffer_load_dwordx4 v9, s[12:15], s68 offen lds
  v_mfma_f32_16x16x32_bf16 v[32:35], a[228:231], v[112:115], v[32:35]
  ds_read_b64_tr_b16 v[170:171], v5 offset:2048
  v_mfma_f32_16x16x32_bf16 v[32:35], a[216:219], v[108:111], v[32:35]
  ds_read_b64_tr_b16 v[176:177], v4 offset:4096
  v_mfma_f32_16x16x32_bf16 v[40:43], a[220:223], v[108:111], v[40:43]
  ds_read_b128 v[84:87], v2 offset:13312
  s_add_u32 m0, s45, 86016
  s_add_u32 s68, s68, 196608
  v_mfma_f32_16x16x32_bf16 v[40:43], a[232:235], v[112:115], v[40:43]
  ds_read_b64_tr_b16 v[178:179], v4 offset:6144
  buffer_load_dwordx4 v9, s[12:15], s68 offen lds
  v_mfma_f32_16x16x32_bf16 v[36:39], a[232:235], v[104:107], v[36:39]
  ds_read_b128 v[96:99], v13 offset:20480
  v_mfma_f32_16x16x32_bf16 v[36:39], a[220:223], v[100:103], v[36:39]
  ds_read_b64_tr_b16 v[180:181], v5 offset:4096
  v_mfma_f32_16x16x32_bf16 v[44:47], a[224:227], v[100:103], v[44:47]
  ds_read_b64_tr_b16 v[182:183], v5 offset:6144
  s_add_u32 m0, s45, 90112
  s_add_u32 s68, s68, 196608
  v_mfma_f32_16x16x32_bf16 v[44:47], a[236:239], v[104:107], v[44:47]
  ds_read_b128 v[92:95], v13 offset:21504
  buffer_load_dwordx4 v9, s[12:15], s68 offen lds
  v_mfma_f32_16x16x32_bf16 v[48:51], a[236:239], v[112:115], v[48:51]
  ds_read_b64_tr_b16 v[188:189], v4 offset:8192
  v_mfma_f32_16x16x32_bf16 v[48:51], a[224:227], v[108:111], v[48:51]
  ds_read_b64_tr_b16 v[190:191], v4 offset:10240
  v_mfma_f32_16x16x32_bf16 v[68:71], a[224:227], v[116:119], v[68:71]
  ds_read_b128 v[100:103], v2 offset:6144
  s_add_u32 m0, s45, 94208
  s_add_u32 s68, s68, 196608
  v_mfma_f32_16x16x32_bf16 v[68:71], a[236:239], v[120:123], v[68:71]
  ds_read_b64_tr_b16 v[192:193], v5 offset:8192
  buffer_load_dwordx4 v9, s[12:15], s68 offen lds
  v_mfma_f32_16x16x32_bf16 v[60:63], a[232:235], v[120:123], v[60:63]
  ds_read_b128 v[104:107], v2 offset:7168
  v_mfma_f32_16x16x32_bf16 v[60:63], a[220:223], v[116:119], v[60:63]
  s_waitcnt lgkmcnt(5)
  ds_read_b64_tr_b16 v[194:195], v5 offset:10240
  v_mfma_f32_16x16x32_bf16 v[28:31], a[240:243], v[76:79], v[28:31]
  ds_read_b64_tr_b16 v[200:201], v4 offset:12288
  s_add_u32 m0, s45, 98304
  s_add_u32 s68, s66, 7
  s_and_b32 s68, s68, 7
  s_mul_i32 s68, s68, 786432
  s_add_u32 s68, s68, 4096
  v_mfma_f32_16x16x32_bf16 v[28:31], v[124:127], v[80:83], v[28:31]
  ds_read_b128 v[112:115], v2 offset:14336
  buffer_load_dwordx4 v9, s[12:15], s68 offen lds
  v_mfma_f32_16x16x32_bf16 v[32:35], v[124:127], v[84:87], v[32:35]
  ds_read_b64_tr_b16 v[202:203], v4 offset:14336
  v_mfma_f32_16x16x32_bf16 v[32:35], a[240:243], v[88:91], v[32:35]
  ds_read_b64_tr_b16 v[204:205], v5 offset:12288
  v_mfma_f32_16x16x32_bf16 v[40:43], a[244:247], v[88:91], v[40:43]
  ds_read_b128 v[108:111], v2 offset:15360
  s_add_u32 m0, s45, 102400
  s_add_u32 s68, s68, 196608
  v_mfma_f32_16x16x32_bf16 v[40:43], v[128:131], v[84:87], v[40:43]
  ds_read_b64_tr_b16 v[206:207], v5 offset:14336
  buffer_load_dwordx4 v9, s[12:15], s68 offen lds
  v_mfma_f32_16x16x32_bf16 v[36:39], v[128:131], v[80:83], v[36:39]
  ds_read_b128 v[120:123], v13 offset:22528
  v_mfma_f32_16x16x32_bf16 v[36:39], a[244:247], v[76:79], v[36:39]
  v_mfma_f32_16x16x32_bf16 v[44:47], a[248:251], v[76:79], v[44:47]
  s_add_u32 m0, s45, 106496
  s_add_u32 s68, s68, 196608
  v_mfma_f32_16x16x32_bf16 v[44:47], v[132:135], v[80:83], v[44:47]
  ds_read_b128 v[116:119], v13 offset:23552
  v_mfma_f32_16x16x32_bf16 v[48:51], v[132:135], v[84:87], v[48:51]
  buffer_load_dwordx4 v9, s[12:15], s68 offen lds
  v_mfma_f32_16x16x32_bf16 v[48:51], a[248:251], v[88:91], v[48:51]
  s_waitcnt vmcnt(7) lgkmcnt(2)
  s_barrier
  v_mfma_f32_16x16x32_bf16 v[68:71], a[248:251], v[96:99], v[68:71]
  ds_read_b128 v[76:79], v1 offset:32768
  s_add_u32 m0, s45, 110592
  s_add_u32 s68, s68, 196608
  v_mfma_f32_16x16x32_bf16 v[68:71], v[132:135], v[92:95], v[68:71]
  buffer_load_dwordx4 v9, s[12:15], s68 offen lds
  v_mfma_f32_16x16x32_bf16 v[60:63], v[128:131], v[92:95], v[60:63]
  ds_read_b128 v[80:83], v1 offset:33792
  v_mfma_f32_16x16x32_bf16 v[60:63], a[244:247], v[96:99], v[60:63]
  s_waitcnt lgkmcnt(2)
  v_mfma_f32_16x16x32_bf16 v[28:31], v[136:139], v[100:103], v[28:31]
  s_add_u32 m0, s70, 49152
  s_add_u32 s69, s58, 98304
  v_mfma_f32_16x16x32_bf16 v[28:31], v[148:151], v[104:107], v[28:31]
  ds_read_b128 v[84:87], v1 offset:40960
  v_mfma_f32_16x16x32_bf16 v[32:35], v[148:151], v[108:111], v[32:35]
  buffer_load_dwordx4 v12, s[8:11], s69 offen offset:0 sc1 lds
  v_mfma_f32_16x16x32_bf16 v[32:35], v[136:139], v[112:115], v[32:35]
  v_mfma_f32_16x16x32_bf16 v[40:43], v[140:143], v[112:115], v[40:43]
  ds_read_b128 v[88:91], v1 offset:41984
  v_mfma_f32_16x16x32_bf16 v[40:43], v[152:155], v[108:111], v[40:43]
  buffer_load_dwordx4 v12, s[8:11], s69 offen offset:1024 sc1 lds
  v_mfma_f32_16x16x32_bf16 v[36:39], v[152:155], v[104:107], v[36:39]
  ds_read_b128 v[92:95], v13 offset:24576
  v_mfma_f32_16x16x32_bf16 v[36:39], v[140:143], v[100:103], v[36:39]
  v_mfma_f32_16x16x32_bf16 v[44:47], v[144:147], v[100:103], v[44:47]
  v_mfma_f32_16x16x32_bf16 v[44:47], v[156:159], v[104:107], v[44:47]
  ds_read_b128 v[96:99], v13 offset:25600
  v_mfma_f32_16x16x32_bf16 v[48:51], v[156:159], v[108:111], v[48:51]
  buffer_load_dwordx4 v12, s[8:11], s69 offen offset:2048 sc1 lds
  v_mfma_f32_16x16x32_bf16 v[48:51], v[144:147], v[112:115], v[48:51]
  s_waitcnt vmcnt(3)
  s_barrier
  v_mfma_f32_16x16x32_bf16 v[68:71], v[144:147], v[120:123], v[68:71]
  ds_read_b128 v[100:103], v1 offset:34816
  v_mfma_f32_16x16x32_bf16 v[68:71], v[156:159], v[116:119], v[68:71]
  ds_read_b64_tr_b16 v[212:213], v7 offset:16384
  buffer_load_dwordx4 v12, s[8:11], s69 offen offset:3072 sc1 lds
  v_mfma_f32_16x16x32_bf16 v[60:63], v[152:155], v[116:119], v[60:63]
  ds_read_b128 v[104:107], v1 offset:35840
  v_mfma_f32_16x16x32_bf16 v[60:63], v[140:143], v[120:123], v[60:63]
  s_waitcnt lgkmcnt(3)
  ds_read_b64_tr_b16 v[214:215], v7 offset:18432
  v_mfma_f32_16x16x32_bf16 v[28:31], v[160:163], v[76:79], v[28:31]
  ds_read_b64_tr_b16 v[216:217], v8 offset:16384
  s_add_u32 m0, s70, 114688
  s_add_u32 s69, s59, 98304
  v_mfma_f32_16x16x32_bf16 v[28:31], v[172:175], v[80:83], v[28:31]
  ds_read_b128 v[108:111], v1 offset:43008
  buffer_load_dwordx4 v12, s[8:11], s69 offen offset:0 sc1 lds
  v_mfma_f32_16x16x32_bf16 v[32:35], v[172:175], v[88:91], v[32:35]
  ds_read_b64_tr_b16 v[218:219], v8 offset:18432
  v_mfma_f32_16x16x32_bf16 v[32:35], v[160:163], v[84:87], v[32:35]
  ds_read_b64_tr_b16 v[224:225], v7 offset:20480
  v_mfma_f32_16x16x32_bf16 v[40:43], v[164:167], v[84:87], v[40:43]
  ds_read_b128 v[112:115], v1 offset:44032
  v_mfma_f32_16x16x32_bf16 v[40:43], v[176:179], v[88:91], v[40:43]
  ds_read_b64_tr_b16 v[226:227], v7 offset:22528
  buffer_load_dwordx4 v12, s[8:11], s69 offen offset:1024 sc1 lds
  v_mfma_f32_16x16x32_bf16 v[36:39], v[176:179], v[80:83], v[36:39]
  ds_read_b128 v[116:119], v13 offset:26624
  v_mfma_f32_16x16x32_bf16 v[36:39], v[164:167], v[76:79], v[36:39]
  ds_read_b64_tr_b16 v[228:229], v8 offset:20480
  v_mfma_f32_16x16x32_bf16 v[44:47], v[168:171], v[76:79], v[44:47]
  ds_read_b64_tr_b16 v[230:231], v8 offset:22528
  v_mfma_f32_16x16x32_bf16 v[44:47], v[180:183], v[80:83], v[44:47]
  ds_read_b128 v[120:123], v13 offset:27648
  buffer_load_dwordx4 v12, s[8:11], s69 offen offset:2048 sc1 lds
  v_mfma_f32_16x16x32_bf16 v[48:51], v[180:183], v[88:91], v[48:51]
  ds_read_b64_tr_b16 v[236:237], v7 offset:24576
  v_mfma_f32_16x16x32_bf16 v[48:51], v[168:171], v[84:87], v[48:51]
  ds_read_b64_tr_b16 v[238:239], v7 offset:26624
  v_mfma_f32_16x16x32_bf16 v[68:71], v[168:171], v[92:95], v[68:71]
  ds_read_b128 v[76:79], v1 offset:36864
  v_mfma_f32_16x16x32_bf16 v[68:71], v[180:183], v[96:99], v[68:71]
  ds_read_b64_tr_b16 v[240:241], v8 offset:24576
  buffer_load_dwordx4 v12, s[8:11], s69 offen offset:3072 sc1 lds
  v_mfma_f32_16x16x32_bf16 v[60:63], v[176:179], v[96:99], v[60:63]
  ds_read_b128 v[80:83], v1 offset:37888
  v_mfma_f32_16x16x32_bf16 v[60:63], v[164:167], v[92:95], v[60:63]
  s_waitcnt lgkmcnt(5)
  ds_read_b64_tr_b16 v[242:243], v8 offset:26624
  v_mfma_f32_16x16x32_bf16 v[28:31], v[184:187], v[100:103], v[28:31]
  ds_read_b64_tr_b16 v[248:249], v7 offset:28672
  s_add_u32 m0, s70, 0
  s_add_u32 s69, s60, 98304
  v_mfma_f32_16x16x32_bf16 v[28:31], v[196:199], v[104:107], v[28:31]
  ds_read_b128 v[88:91], v1 offset:45056
  buffer_load_dwordx4 v12, s[8:11], s69 offen offset:0 sc1 lds
  v_mfma_f32_16x16x32_bf16 v[32:35], v[196:199], v[112:115], v[32:35]
  ds_read_b64_tr_b16 v[250:251], v7 offset:30720
  v_mfma_f32_16x16x32_bf16 v[32:35], v[184:187], v[108:111], v[32:35]
  ds_read_b64_tr_b16 v[252:253], v8 offset:28672
  v_mfma_f32_16x16x32_bf16 v[40:43], v[188:191], v[108:111], v[40:43]
  ds_read_b128 v[84:87], v1 offset:46080
  v_mfma_f32_16x16x32_bf16 v[40:43], v[200:203], v[112:115], v[40:43]
  ds_read_b64_tr_b16 v[254:255], v8 offset:30720
  buffer_load_dwordx4 v12, s[8:11], s69 offen offset:1024 sc1 lds
  v_mfma_f32_16x16x32_bf16 v[36:39], v[200:203], v[104:107], v[36:39]
  ds_read_b128 v[96:99], v13 offset:28672
  v_mfma_f32_16x16x32_bf16 v[36:39], v[188:191], v[100:103], v[36:39]
  v_mfma_f32_16x16x32_bf16 v[44:47], v[192:195], v[100:103], v[44:47]
  v_mfma_f32_16x16x32_bf16 v[44:47], v[204:207], v[104:107], v[44:47]
  ds_read_b128 v[92:95], v13 offset:29696
  v_mfma_f32_16x16x32_bf16 v[48:51], v[204:207], v[112:115], v[48:51]
  buffer_load_dwordx4 v12, s[8:11], s69 offen offset:2048 sc1 lds
  v_mfma_f32_16x16x32_bf16 v[48:51], v[192:195], v[108:111], v[48:51]
  v_mfma_f32_16x16x32_bf16 v[68:71], v[192:195], v[116:119], v[68:71]
  ds_read_b128 v[100:103], v1 offset:38912
  v_mfma_f32_16x16x32_bf16 v[68:71], v[204:207], v[120:123], v[68:71]
  buffer_load_dwordx4 v12, s[8:11], s69 offen offset:3072 sc1 lds
  v_mfma_f32_16x16x32_bf16 v[60:63], v[200:203], v[120:123], v[60:63]
  ds_read_b128 v[104:107], v1 offset:39936
  s_mov_b32 s30, 7340032
  v_mfma_f32_16x16x32_bf16 v[60:63], v[188:191], v[116:119], v[60:63]
  s_waitcnt lgkmcnt(2)
  s_mov_b32 s31, 131072
  s_mov_b32 s34, 7340032
  v_mfma_f32_16x16x32_bf16 v[28:31], v[208:211], v[76:79], v[28:31]
  s_add_u32 m0, s45, 16384
  s_mov_b32 s68, 0
  v_mfma_f32_16x16x32_bf16 v[28:31], v[220:223], v[80:83], v[28:31]
  ds_read_b128 v[112:115], v1 offset:47104
  s_mov_b32 s35, 131072
  v_mfma_f32_16x16x32_bf16 v[32:35], v[220:223], v[84:87], v[32:35]
  buffer_load_dwordx4 v11, s[20:23], s68 offen nt lds
  s_mov_b32 s38, 7340032
  s_mov_b32 s39, 131072
  v_mfma_f32_16x16x32_bf16 v[32:35], v[208:211], v[88:91], v[32:35]
  s_add_u32 m0, s45, 20480
  s_add_u32 s68, s68, 393216
  s_mov_b32 s42, 4194304
  v_mfma_f32_16x16x32_bf16 v[40:43], v[212:215], v[88:91], v[40:43]
  ds_read_b128 v[108:111], v1 offset:48128
  s_mov_b32 s43, 131072
  v_mfma_f32_16x16x32_bf16 v[40:43], v[224:227], v[84:87], v[40:43]
  buffer_load_dwordx4 v11, s[20:23], s68 offen nt lds
  v_add_u32 v9, s78, v1
  v_and_b32 v4, 0xffffbfff, v4
  v_mfma_f32_16x16x32_bf16 v[36:39], v[224:227], v[80:83], v[36:39]
  ds_read_b128 v[120:123], v13 offset:30720
  v_and_b32 v5, 0xffffbfff, v5
  v_mfma_f32_16x16x32_bf16 v[36:39], v[212:215], v[76:79], v[36:39]
  v_and_b32 v7, 0xffffbfff, v7
  v_and_b32 v8, 0xffffbfff, v8
  v_mfma_f32_16x16x32_bf16 v[44:47], v[216:219], v[76:79], v[44:47]
  s_add_u32 m0, s45, 24576
  s_add_u32 s68, s68, 393216
  s_lshl_b32 s52, s44, 13
  v_mfma_f32_16x16x32_bf16 v[44:47], v[228:231], v[80:83], v[44:47]
  ds_read_b128 v[116:119], v13 offset:31744
  s_and_b32 s52, s52, 8192
  v_mfma_f32_16x16x32_bf16 v[48:51], v[228:231], v[84:87], v[48:51]
  buffer_load_dwordx4 v11, s[20:23], s68 offen nt lds
  v_add_u32 v22, s52, v1
  v_add_u32 v23, s52, v2
  v_mfma_f32_16x16x32_bf16 v[48:51], v[216:219], v[88:91], v[48:51]
  s_waitcnt vmcnt(11) lgkmcnt(8)
  s_barrier
  v_mfma_f32_16x16x32_bf16 v[68:71], v[216:219], v[96:99], v[68:71]
  ds_read_b128 v[76:79], v1 offset:49152
  s_add_u32 m0, s45, 28672
  s_add_u32 s68, s68, 393216
  v_mfma_f32_16x16x32_bf16 v[68:71], v[228:231], v[92:95], v[68:71]
  buffer_load_dwordx4 v11, s[20:23], s68 offen nt lds
  v_and_b32 v14, 15, v0
  v_lshlrev_b32 v14, 7, v14
  v_mfma_f32_16x16x32_bf16 v[60:63], v[224:227], v[92:95], v[60:63]
  v_mfma_f32_16x16x32_bf16 v[60:63], v[212:215], v[96:99], v[60:63]
  s_waitcnt lgkmcnt(1)
  ds_read_b128 v[80:83], v1 offset:50176
  v_mfma_f32_16x16x32_bf16 v[28:31], v[232:235], v[100:103], v[28:31]
  v_mfma_f32_16x16x32_bf16 v[28:31], v[244:247], v[104:107], v[28:31]
  v_mfma_f32_16x16x32_bf16 v[32:35], v[244:247], v[108:111], v[32:35]
  ds_read_b128 v[84:87], v1 offset:57344
  v_mfma_f32_16x16x32_bf16 v[32:35], v[232:235], v[112:115], v[32:35]
  v_mfma_f32_16x16x32_bf16 v[40:43], v[236:239], v[112:115], v[40:43]
  v_mfma_f32_16x16x32_bf16 v[40:43], v[248:251], v[108:111], v[40:43]
  ds_read_b128 v[88:91], v1 offset:58368
  v_mfma_f32_16x16x32_bf16 v[36:39], v[248:251], v[104:107], v[36:39]
  v_mfma_f32_16x16x32_bf16 v[36:39], v[236:239], v[100:103], v[36:39]
  v_mfma_f32_16x16x32_bf16 v[44:47], v[240:243], v[100:103], v[44:47]
  ds_read_b128 v[92:95], v1 offset:51200
  v_mfma_f32_16x16x32_bf16 v[44:47], v[252:255], v[104:107], v[44:47]
  v_mfma_f32_16x16x32_bf16 v[48:51], v[252:255], v[108:111], v[48:51]
HOP2:
  s_cbranch_execz HOP6
  v_mfma_f32_16x16x32_bf16 v[48:51], v[240:243], v[112:115], v[48:51]
  ds_read_b128 v[96:99], v1 offset:52224
  v_mfma_f32_16x16x32_bf16 v[68:71], v[240:243], v[120:123], v[68:71]
  v_mfma_f32_16x16x32_bf16 v[68:71], v[252:255], v[116:119], v[68:71]
  v_mfma_f32_16x16x32_bf16 v[60:63], v[248:251], v[116:119], v[60:63]
  ds_read_b128 v[100:103], v1 offset:59392
  v_mfma_f32_16x16x32_bf16 v[60:63], v[236:239], v[120:123], v[60:63]
  s_waitcnt lgkmcnt(3)
  v_mfma_f32_16x16x32_bf16 v[52:55], a[0:3], v[76:79], 0
  v_mfma_f32_16x16x32_bf16 v[52:55], a[12:15], v[80:83], v[52:55]
  ds_read_b128 v[104:107], v1 offset:60416
  v_mfma_f32_16x16x32_bf16 v[56:59], a[12:15], v[88:91], 0
  s_nop 2
  v_cvt_pk_bf16_f32 v60, v60, v61
  v_cvt_pk_bf16_f32 v61, v62, v63
  v_cvt_pk_bf16_f32 v62, v68, v69
  v_cvt_pk_bf16_f32 v63, v70, v71
  ds_write_b128 v17, v[60:63] offset:1024
  v_mfma_f32_16x16x32_bf16 v[56:59], a[0:3], v[84:87], v[56:59]
  v_cvt_pk_bf16_f32 v28, v28, v29
  v_cvt_pk_bf16_f32 v29, v30, v31
  v_mfma_f32_16x16x32_bf16 v[64:67], a[4:7], v[84:87], 0
  ds_read_b128 v[108:111], v1 offset:53248
  v_mfma_f32_16x16x32_bf16 v[64:67], a[16:19], v[88:91], v[64:67]
  ds_write_b64 v18, v[28:29] offset:6144
  v_mfma_f32_16x16x32_bf16 v[60:63], a[16:19], v[80:83], 0
  v_cvt_pk_bf16_f32 v36, v36, v37
  v_cvt_pk_bf16_f32 v37, v38, v39
  v_mfma_f32_16x16x32_bf16 v[60:63], a[4:7], v[76:79], v[60:63]
  ds_read_b128 v[112:115], v1 offset:54272
  v_cvt_pk_bf16_f32 v38, v44, v45
  v_mfma_f32_16x16x32_bf16 v[68:71], a[8:11], v[76:79], 0
  v_cvt_pk_bf16_f32 v39, v46, v47
  v_mfma_f32_16x16x32_bf16 v[68:71], a[20:23], v[80:83], v[68:71]
  ds_write_b128 v17, v[36:39] offset:7168
  v_mfma_f32_16x16x32_bf16 v[72:75], a[20:23], v[88:91], 0
  ds_read_b128 v[76:79], v1 offset:61440
  v_cvt_pk_bf16_f32 v32, v32, v33
  v_mfma_f32_16x16x32_bf16 v[72:75], a[8:11], v[84:87], v[72:75]
  s_waitcnt lgkmcnt(6)
  v_cvt_pk_bf16_f32 v33, v34, v35
  v_mfma_f32_16x16x32_bf16 v[52:55], a[24:27], v[92:95], v[52:55]
  s_add_u32 m0, s70, 65536
  s_add_u32 s69, s61, 98304
  v_mfma_f32_16x16x32_bf16 v[52:55], a[36:39], v[96:99], v[52:55]
  ds_read_b128 v[80:83], v1 offset:62464
  v_mfma_f32_16x16x32_bf16 v[56:59], a[36:39], v[104:107], v[56:59]
  buffer_load_dwordx4 v12, s[8:11], s69 offen offset:0 sc1 lds
  ds_write_b64 v18, v[32:33] offset:12288
  v_mfma_f32_16x16x32_bf16 v[56:59], a[24:27], v[100:103], v[56:59]
  v_cvt_pk_bf16_f32 v40, v40, v41
  v_cvt_pk_bf16_f32 v41, v42, v43
  v_mfma_f32_16x16x32_bf16 v[64:67], a[28:31], v[100:103], v[64:67]
  ds_read_b128 v[88:91], v1 offset:55296
  v_cvt_pk_bf16_f32 v42, v48, v49
  v_mfma_f32_16x16x32_bf16 v[64:67], a[40:43], v[104:107], v[64:67]
  v_cvt_pk_bf16_f32 v43, v50, v51
  v_mfma_f32_16x16x32_bf16 v[60:63], a[40:43], v[96:99], v[60:63]
  buffer_load_dwordx4 v12, s[8:11], s69 offen offset:1024 sc1 lds
  ds_write_b128 v17, v[40:43] offset:13312
  v_mfma_f32_16x16x32_bf16 v[60:63], a[28:31], v[92:95], v[60:63]
  ds_read_b128 v[84:87], v1 offset:56320
  v_mfma_f32_16x16x32_bf16 v[68:71], a[32:35], v[92:95], v[68:71]
  s_bitcmp1_b32 s44, 0
  s_mov_b32 s52, 6144
  s_cselect_b32 s52, 12288, s52
  s_mov_b32 s53, 0
  s_cselect_b32 s53, 6144, s53
  v_mfma_f32_16x16x32_bf16 v[68:71], a[44:47], v[96:99], v[68:71]
  v_add_u32 v116, s52, v19
  v_add_u32 v117, s53, v19
  v_mfma_f32_16x16x32_bf16 v[72:75], a[44:47], v[104:107], v[72:75]
  ds_read_b128 v[92:95], v1 offset:63488
  v_add_u32 v118, s52, v20
  v_mfma_f32_16x16x32_bf16 v[72:75], a[32:35], v[100:103], v[72:75]
  s_waitcnt lgkmcnt(5)
  buffer_load_dwordx4 v12, s[8:11], s69 offen offset:2048 sc1 lds
  v_add_u32 v119, s53, v20
  v_mfma_f32_16x16x32_bf16 v[52:55], a[48:51], v[108:111], v[52:55]
  s_waitcnt vmcnt(11) lgkmcnt(2)
  s_barrier
  v_mfma_f32_16x16x32_bf16 v[52:55], a[60:63], v[112:115], v[52:55]
  ds_read_b128 v[96:99], v1 offset:64512
  ds_write_b16 v21, v16
  v_mfma_f32_16x16x32_bf16 v[56:59], a[60:63], v[80:83], v[56:59]
  ds_read_b128 v[28:31], v116
  v_mfma_f32_16x16x32_bf16 v[56:59], a[48:51], v[76:79], v[56:59]
  ds_read_b128 v[32:35], v117 offset:1024
  v_mfma_f32_16x16x32_bf16 v[64:67], a[52:55], v[76:79], v[64:67]
  ds_read_b128 v[104:107], v2 offset:49152
  v_mfma_f32_16x16x32_bf16 v[64:67], a[64:67], v[80:83], v[64:67]
  buffer_load_dwordx4 v12, s[8:11], s69 offen offset:3072 sc1 lds
  ds_read_b128 v[36:39], v116 offset:1024
  v_mfma_f32_16x16x32_bf16 v[60:63], a[64:67], v[112:115], v[60:63]
  ds_read_b64_tr_b16 v[40:41], v119 offset:2048
  v_mfma_f32_16x16x32_bf16 v[60:63], a[52:55], v[108:111], v[60:63]
  ds_read_b128 v[100:103], v2 offset:50176
  v_mfma_f32_16x16x32_bf16 v[68:71], a[56:59], v[108:111], v[68:71]
  s_add_u32 m0, s70, 98304
  s_add_u32 s69, s58, 163840
  v_mfma_f32_16x16x32_bf16 v[68:71], a[68:71], v[112:115], v[68:71]
  buffer_load_dwordx4 v12, s[8:11], s69 offen offset:0 sc1 lds
  ds_read_b64_tr_b16 v[42:43], v118 offset:2048
  v_mfma_f32_16x16x32_bf16 v[72:75], a[68:71], v[80:83], v[72:75]
  ds_read_b128 v[108:111], v2 offset:57344
  v_mfma_f32_16x16x32_bf16 v[72:75], a[56:59], v[76:79], v[72:75]
  s_waitcnt lgkmcnt(9)
  ds_read_b64_tr_b16 v[44:45], v119 offset:2056
  v_mfma_f32_16x16x32_bf16 v[52:55], a[72:75], v[88:91], v[52:55]
  ds_read_b64_tr_b16 v[46:47], v118 offset:2056
  v_mfma_f32_16x16x32_bf16 v[52:55], a[84:87], v[84:87], v[52:55]
  ds_read_b128 v[112:115], v2 offset:58368
  v_mfma_f32_16x16x32_bf16 v[56:59], a[84:87], v[96:99], v[56:59]
  buffer_load_dwordx4 v12, s[8:11], s69 offen offset:1024 sc1 lds
  v_mfma_f32_16x16x32_bf16 v[56:59], a[72:75], v[92:95], v[56:59]
  v_mfma_f32_16x16x32_bf16 v[64:67], a[76:79], v[92:95], v[64:67]
  ds_read_b128 v[80:83], v2 offset:51200
  v_mfma_f32_16x16x32_bf16 v[64:67], a[88:91], v[96:99], v[64:67]
  s_waitcnt lgkmcnt(2)
  v_mfma_f32_16x16x32_bf16 v[116:119], v[32:35], v[28:31], 0
  v_mfma_f32_16x16x32_bf16 v[120:123], v[36:39], v[28:31], 0
  v_mfma_f32_16x16x32_bf16 v[60:63], a[88:91], v[84:87], v[60:63]
  v_mfma_f32_16x16x32_bf16 v[60:63], a[76:79], v[88:91], v[60:63]
  ds_read_b128 v[76:79], v2 offset:52224
  v_mfma_f32_16x16x32_bf16 v[68:71], a[80:83], v[88:91], v[68:71]
  buffer_load_dwordx4 v12, s[8:11], s69 offen offset:2048 sc1 lds
  v_mfma_f32_16x16x32_bf16 v[68:71], a[92:95], v[84:87], v[68:71]
  s_nop 1
  v_cndmask_b32 v48, v116, v120, s[80:81]
  v_cndmask_b32 v49, v117, v121, s[82:83]
  v_mfma_f32_16x16x32_bf16 v[72:75], a[92:95], v[96:99], v[72:75]
  ds_read_b128 v[88:91], v2 offset:59392
  v_cndmask_b32 v50, v118, v122, s[84:85]
  v_mfma_f32_16x16x32_bf16 v[72:75], a[80:83], v[92:95], v[72:75]
  s_waitcnt lgkmcnt(3)
  v_cndmask_b32 v51, v119, v123, s[86:87]
  v_cndmask_b32 v48, v48, v49, s[88:89]
  v_mfma_f32_16x16x32_bf16 v[52:55], a[96:99], v[104:107], v[52:55]
  buffer_load_dwordx4 v12, s[8:11], s69 offen offset:3072 sc1 lds
  v_cndmask_b32 v49, v50, v51, s[88:89]
  v_mul_f32 v48, 0x3e8293ee, v48
  v_mfma_f32_16x16x32_bf16 v[52:55], a[108:111], v[100:103], v[52:55]
  ds_read_b128 v[84:87], v2 offset:60416
  v_mul_f32 v49, 0x3e8293ee, v49
  v_mfma_f32_16x16x32_bf16 v[56:59], a[108:111], v[112:115], v[56:59]
  v_mov_b32 v50, 0xce6e6b28
  v_cndmask_b32 v48, v48, v50, s[90:91]
  v_mfma_f32_16x16x32_bf16 v[56:59], a[96:99], v[108:111], v[56:59]
  s_add_u32 m0, s45, 81920
  s_mov_b32 s68, 1572864
  v_mfma_f32_16x16x32_bf16 v[64:67], a[100:103], v[108:111], v[64:67]
  ds_read_b128 v[96:99], v2 offset:53248
  v_cndmask_b32 v49, v49, v50, s[92:93]
  v_mfma_f32_16x16x32_bf16 v[64:67], a[112:115], v[112:115], v[64:67]
  buffer_load_dwordx4 v11, s[20:23], s68 offen nt lds
  v_max_f32 v50, v48, v49
  v_mov_b32 v51, v50
  v_mfma_f32_16x16x32_bf16 v[60:63], a[112:115], v[100:103], v[60:63]
  s_nop 0
  v_permlane16_swap_b32 v50, v51
  v_mfma_f32_16x16x32_bf16 v[60:63], a[100:103], v[104:107], v[60:63]
  ds_read_b128 v[92:95], v2 offset:54272
  v_max_f32 v50, v50, v51
  v_mfma_f32_16x16x32_bf16 v[68:71], a[104:107], v[104:107], v[68:71]
  v_mov_b32 v51, v50
  v_mfma_f32_16x16x32_bf16 v[68:71], a[116:119], v[100:103], v[68:71]
  s_add_u32 m0, s45, 86016
  s_add_u32 s68, s68, 393216
  v_mfma_f32_16x16x32_bf16 v[72:75], a[116:119], v[112:115], v[72:75]
  ds_read_b128 v[104:107], v2 offset:61440
  v_mfma_f32_16x16x32_bf16 v[72:75], a[104:107], v[108:111], v[72:75]
  s_waitcnt lgkmcnt(3)
  buffer_load_dwordx4 v11, s[20:23], s68 offen nt lds
  v_mfma_f32_16x16x32_bf16 v[52:55], a[120:123], v[80:83], v[52:55]
  v_permlane32_swap_b32 v50, v51
  v_mfma_f32_16x16x32_bf16 v[52:55], a[132:135], v[76:79], v[52:55]
  ds_read_b128 v[100:103], v2 offset:62464
  v_max_f32 v50, v50, v51
  v_mfma_f32_16x16x32_bf16 v[56:59], a[132:135], v[84:87], v[56:59]
  s_add_u32 m0, s45, 90112
  s_add_u32 s68, s68, 393216
  v_sub_f32 v48, v48, v50
  v_mfma_f32_16x16x32_bf16 v[56:59], a[120:123], v[88:91], v[56:59]
  buffer_load_dwordx4 v11, s[20:23], s68 offen nt lds
  v_sub_f32 v49, v49, v50
  v_mfma_f32_16x16x32_bf16 v[64:67], a[124:127], v[88:91], v[64:67]
  ds_read_b128 v[112:115], v2 offset:55296
  v_mfma_f32_16x16x32_bf16 v[64:67], a[136:139], v[84:87], v[64:67]
  v_exp_f32 v48, v48
  v_mfma_f32_16x16x32_bf16 v[60:63], a[136:139], v[76:79], v[60:63]
  s_add_u32 m0, s45, 94208
  s_add_u32 s68, s68, 393216
  v_mfma_f32_16x16x32_bf16 v[60:63], a[124:127], v[80:83], v[60:63]
  ds_read_b128 v[108:111], v2 offset:56320
  v_mfma_f32_16x16x32_bf16 v[68:71], a[128:131], v[80:83], v[68:71]
  buffer_load_dwordx4 v11, s[20:23], s68 offen nt lds
  v_exp_f32 v49, v49
  v_mfma_f32_16x16x32_bf16 v[68:71], a[140:143], v[76:79], v[68:71]
  v_add_f32 v50, v48, v49
  v_mov_b32 v51, v50
  v_mfma_f32_16x16x32_bf16 v[72:75], a[140:143], v[84:87], v[72:75]
  ds_read_b128 v[80:83], v2 offset:63488
  v_mfma_f32_16x16x32_bf16 v[72:75], a[128:131], v[88:91], v[72:75]
  s_waitcnt lgkmcnt(3)
  v_permlane16_swap_b32 v50, v51
  v_mfma_f32_16x16x32_bf16 v[52:55], a[144:147], v[96:99], v[52:55]
  v_add_f32 v50, v50, v51
  v_mov_b32 v51, v50
  v_mfma_f32_16x16x32_bf16 v[52:55], a[156:159], v[92:95], v[52:55]
  ds_read_b128 v[76:79], v2 offset:64512
  v_mfma_f32_16x16x32_bf16 v[56:59], a[156:159], v[100:103], v[56:59]
  v_permlane32_swap_b32 v50, v51
  v_mfma_f32_16x16x32_bf16 v[56:59], a[144:147], v[104:107], v[56:59]
  s_waitcnt vmcnt(8) lgkmcnt(15)
  s_barrier
  v_mfma_f32_16x16x32_bf16 v[64:67], a[148:151], v[104:107], v[64:67]
  ds_read_b128 v[84:87], v1 offset:0
  v_add_f32 v50, v50, v51
  v_mfma_f32_16x16x32_bf16 v[64:67], a[160:163], v[100:103], v[64:67]
  v_rcp_f32 v50, v50
  v_mfma_f32_16x16x32_bf16 v[60:63], a[160:163], v[92:95], v[60:63]
  v_mul_f32 v48, v48, v50
  v_mul_f32 v49, v49, v50
  v_mfma_f32_16x16x32_bf16 v[60:63], a[148:151], v[96:99], v[60:63]
  ds_read_b128 v[88:91], v1 offset:1024
  v_cvt_pk_bf16_f32 v48, v48, v48
  v_mfma_f32_16x16x32_bf16 v[68:71], a[152:155], v[96:99], v[68:71]
  v_cvt_pk_bf16_f32 v49, v49, v49
  v_and_b32 v28, v24, v48
  v_mfma_f32_16x16x32_bf16 v[68:71], a[164:167], v[92:95], v[68:71]
  v_and_b32 v29, v25, v49
  v_and_b32 v30, v26, v48
  v_mfma_f32_16x16x32_bf16 v[72:75], a[164:167], v[100:103], v[72:75]
  ds_read_b128 v[96:99], v1 offset:8192
  v_and_b32 v31, v27, v49
  v_mfma_f32_16x16x32_bf16 v[72:75], a[152:155], v[104:107], v[72:75]
  s_waitcnt lgkmcnt(3)
  v_mfma_f32_16x16x32_bf16 v[32:35], v[40:43], v[28:31], 0
  v_mfma_f32_16x16x32_bf16 v[36:39], v[44:47], v[28:31], 0
  v_mfma_f32_16x16x32_bf16 v[52:55], a[168:171], v[112:115], v[52:55]
  v_mfma_f32_16x16x32_bf16 v[52:55], a[180:183], v[108:111], v[52:55]
  ds_read_b128 v[92:95], v1 offset:9216
  v_mfma_f32_16x16x32_bf16 v[56:59], a[180:183], v[76:79], v[56:59]
  v_mfma_f32_16x16x32_bf16 v[56:59], a[168:171], v[80:83], v[56:59]
  s_nop 1
  v_cvt_pk_bf16_f32 v116, v32, v33
  v_cvt_pk_bf16_f32 v117, v34, v35
  v_mfma_f32_16x16x32_bf16 v[64:67], a[172:175], v[80:83], v[64:67]
  ds_read_b128 v[100:103], v1 offset:2048
  v_cvt_pk_bf16_f32 v118, v36, v37
  v_mfma_f32_16x16x32_bf16 v[64:67], a[184:187], v[76:79], v[64:67]
  v_cvt_pk_bf16_f32 v119, v38, v39
  v_mfma_f32_16x16x32_bf16 v[60:63], a[184:187], v[108:111], v[60:63]
  buffer_store_dwordx4 v[116:119], v1, s[8:11], s73 offen sc1
  v_mfma_f32_16x16x32_bf16 v[60:63], a[172:175], v[112:115], v[60:63]
  ds_read_b128 v[104:107], v1 offset:3072
  s_add_u32 s73, s73, 65536
  v_mfma_f32_16x16x32_bf16 v[68:71], a[176:179], v[112:115], v[68:71]
  v_mfma_f32_16x16x32_bf16 v[68:71], a[188:191], v[108:111], v[68:71]
  v_mfma_f32_16x16x32_bf16 v[72:75], a[188:191], v[76:79], v[72:75]
  ds_read_b128 v[112:115], v1 offset:10240
  v_mfma_f32_16x16x32_bf16 v[72:75], a[176:179], v[80:83], v[72:75]
  s_waitcnt lgkmcnt(3)
  v_mfma_f32_16x16x32_bf16 v[52:55], a[192:195], v[84:87], v[52:55]
  v_mfma_f32_16x16x32_bf16 v[52:55], a[204:207], v[88:91], v[52:55]
  ds_read_b128 v[108:111], v1 offset:11264
  v_mfma_f32_16x16x32_bf16 v[56:59], a[204:207], v[92:95], v[56:59]
  v_mfma_f32_16x16x32_bf16 v[56:59], a[192:195], v[96:99], v[56:59]
  v_mfma_f32_16x16x32_bf16 v[64:67], a[196:199], v[96:99], v[64:67]
  ds_read_b128 v[76:79], v1 offset:4096
  v_lshrrev_b32 v40, 4, v0
  v_lshlrev_b32 v40, 4, v40
  v_mfma_f32_16x16x32_bf16 v[64:67], a[208:211], v[92:95], v[64:67]
  v_add_u32 v41, 160768, v40
  v_mfma_f32_16x16x32_bf16 v[60:63], a[208:211], v[88:91], v[60:63]
  ds_read_b64_tr_b16 v[116:117], v3 offset:16384
  v_mfma_f32_16x16x32_bf16 v[60:63], a[196:199], v[84:87], v[60:63]
  ds_read_b128 v[80:83], v1 offset:5120
  ds_read_b64_tr_b16 v[118:119], v3 offset:18432
  v_mfma_f32_16x16x32_bf16 v[68:71], a[200:203], v[84:87], v[68:71]
  ds_read_b128 v[28:31], v41 offset:0
  v_mfma_f32_16x16x32_bf16 v[68:71], a[212:215], v[88:91], v[68:71]
  v_mfma_f32_16x16x32_bf16 v[72:75], a[212:215], v[92:95], v[72:75]
  ds_read_b128 v[84:87], v1 offset:12288
  v_mfma_f32_16x16x32_bf16 v[72:75], a[200:203], v[96:99], v[72:75]
  s_waitcnt lgkmcnt(6)
  s_add_u32 m0, s70, 32768
  s_add_u32 s69, s59, 163840
  v_mfma_f32_16x16x32_bf16 v[52:55], a[216:219], v[100:103], v[52:55]
  buffer_load_dwordx4 v12, s[8:11], s69 offen offset:0 sc1 lds
  v_mfma_f32_16x16x32_bf16 v[52:55], a[228:231], v[104:107], v[52:55]
  ds_read_b128 v[88:91], v1 offset:13312
  v_mfma_f32_16x16x32_bf16 v[56:59], a[228:231], v[108:111], v[56:59]
  v_mfma_f32_16x16x32_bf16 v[56:59], a[216:219], v[112:115], v[56:59]
  v_mfma_f32_16x16x32_bf16 v[64:67], a[220:223], v[112:115], v[64:67]
  ds_read_b128 v[92:95], v1 offset:6144
  ds_read_b64_tr_b16 v[120:121], v3 offset:20480
  v_mfma_f32_16x16x32_bf16 v[64:67], a[232:235], v[108:111], v[64:67]
  ds_read_b64_tr_b16 v[122:123], v3 offset:22528
  s_waitcnt lgkmcnt(5)
  v_mfma_f32_16x16x32_bf16 v[36:39], v[116:119], v[28:31], 0
  v_mfma_f32_16x16x32_bf16 v[60:63], a[232:235], v[104:107], v[60:63]
  buffer_load_dwordx4 v12, s[8:11], s69 offen offset:1024 sc1 lds
  ds_read_b128 v[32:35], v41 offset:64
  v_mfma_f32_16x16x32_bf16 v[60:63], a[220:223], v[100:103], v[60:63]
  ds_read_b128 v[96:99], v1 offset:7168
  v_mfma_f32_16x16x32_bf16 v[68:71], a[224:227], v[100:103], v[68:71]
  v_mfma_f32_16x16x32_bf16 v[68:71], a[236:239], v[104:107], v[68:71]
  v_mfma_f32_16x16x32_bf16 v[72:75], a[236:239], v[108:111], v[72:75]
  ds_read_b128 v[100:103], v1 offset:14336
  v_mfma_f32_16x16x32_bf16 v[72:75], a[224:227], v[112:115], v[72:75]
  s_waitcnt lgkmcnt(6)
  buffer_load_dwordx4 v12, s[8:11], s69 offen offset:2048 sc1 lds
  v_mfma_f32_16x16x32_bf16 v[52:55], a[240:243], v[76:79], v[52:55]
  v_mfma_f32_16x16x32_bf16 v[52:55], v[124:127], v[80:83], v[52:55]
  ds_read_b128 v[104:107], v1 offset:15360
  v_mfma_f32_16x16x32_bf16 v[56:59], v[124:127], v[88:91], v[56:59]
  ds_read_b64_tr_b16 v[116:117], v3 offset:24576
  v_and_b32 v42, 15, v0
  v_mfma_f32_16x16x32_bf16 v[56:59], a[240:243], v[84:87], v[56:59]
  ds_read_b64_tr_b16 v[118:119], v3 offset:26624
  buffer_load_dwordx4 v12, s[8:11], s69 offen offset:3072 sc1 lds
  s_waitcnt lgkmcnt(5)
  v_mfma_f32_16x16x32_bf16 v[36:39], v[120:123], v[32:35], v[36:39]
  v_lshl_add_u32 v40, v42, 27, v40
  s_lshr_b32 s52, s2, 2
  v_mfma_f32_16x16x32_bf16 v[64:67], a[244:247], v[84:87], v[64:67]
  ds_read_b128 v[108:111], v2 offset:0
  ds_read_b128 v[28:31], v41 offset:128
  v_mfma_f32_16x16x32_bf16 v[64:67], v[128:131], v[88:91], v[64:67]
  s_lshl_b32 s54, s52, 7
  s_lshl_b32 s52, s52, 8
  s_and_b32 s53, s2, 3
  v_mfma_f32_16x16x32_bf16 v[60:63], v[128:131], v[80:83], v[60:63]
  s_add_u32 m0, s70, 49152
  s_add_u32 s69, s60, 163840
  s_mul_i32 s79, s53, 24576
  v_mfma_f32_16x16x32_bf16 v[60:63], a[244:247], v[76:79], v[60:63]
  ds_read_b128 v[112:115], v2 offset:1024
  s_add_u32 s52, s52, s79
  v_mfma_f32_16x16x32_bf16 v[68:71], a[248:251], v[76:79], v[68:71]
  buffer_load_dwordx4 v12, s[8:11], s69 offen offset:0 sc1 lds
  s_lshl_b32 s79, s44, 6
  s_add_u32 s52, s52, s79
  v_mfma_f32_16x16x32_bf16 v[68:71], v[132:135], v[80:83], v[68:71]
  s_add_u32 s52, s52, 8192
  s_lshl_b32 s53, s53, 2
  s_add_u32 s54, s54, s53
  v_mfma_f32_16x16x32_bf16 v[72:75], v[132:135], v[88:91], v[72:75]
  ds_read_b128 v[76:79], v2 offset:8192
  s_add_u32 s54, s54, 720896
  v_mfma_f32_16x16x32_bf16 v[72:75], a[248:251], v[84:87], v[72:75]
  s_waitcnt lgkmcnt(6)
  s_cmp_eq_u32 s44, 0
  s_cselect_b32 s79, s54, 1073741824
  v_mfma_f32_16x16x32_bf16 v[52:55], v[136:139], v[92:95], v[52:55]
  ds_read_b64_tr_b16 v[120:121], v3 offset:28672
  v_mfma_f32_16x16x32_bf16 v[52:55], v[148:151], v[96:99], v[52:55]
  ds_read_b128 v[80:83], v2 offset:9216
  ds_read_b64_tr_b16 v[122:123], v3 offset:30720
  s_waitcnt lgkmcnt(5)
  v_mfma_f32_16x16x32_bf16 v[36:39], v[116:119], v[28:31], v[36:39]
  v_mfma_f32_16x16x32_bf16 v[56:59], v[148:151], v[104:107], v[56:59]
  buffer_load_dwordx4 v12, s[8:11], s69 offen offset:1024 sc1 lds
  ds_read_b128 v[32:35], v41 offset:192
  v_mfma_f32_16x16x32_bf16 v[56:59], v[136:139], v[100:103], v[56:59]
  v_mfma_f32_16x16x32_bf16 v[64:67], v[140:143], v[100:103], v[64:67]
  ds_read_b128 v[88:91], v2 offset:2048
  v_mfma_f32_16x16x32_bf16 v[64:67], v[152:155], v[104:107], v[64:67]
  v_mfma_f32_16x16x32_bf16 v[60:63], v[152:155], v[96:99], v[60:63]
  buffer_load_dwordx4 v12, s[8:11], s69 offen offset:2048 sc1 lds
  v_mfma_f32_16x16x32_bf16 v[60:63], v[140:143], v[92:95], v[60:63]
  ds_read_b128 v[84:87], v2 offset:3072
  v_mfma_f32_16x16x32_bf16 v[68:71], v[144:147], v[92:95], v[68:71]
  v_mfma_f32_16x16x32_bf16 v[68:71], v[156:159], v[96:99], v[68:71]
  s_waitcnt vmcnt(8)
  s_barrier
  v_mfma_f32_16x16x32_bf16 v[72:75], v[156:159], v[104:107], v[72:75]
  ds_read_b128 v[92:95], v2 offset:10240
  ds_read_b64_tr_b16 v[116:117], v6 offset:16384
  v_mfma_f32_16x16x32_bf16 v[72:75], v[144:147], v[100:103], v[72:75]
  s_waitcnt lgkmcnt(6)
  ds_read_b64_tr_b16 v[118:119], v6 offset:18432
  s_waitcnt lgkmcnt(5)
  v_mfma_f32_16x16x32_bf16 v[36:39], v[120:123], v[32:35], v[36:39]
  v_mfma_f32_16x16x32_bf16 v[52:55], v[160:163], v[108:111], v[52:55]
  buffer_load_dwordx4 v12, s[8:11], s69 offen offset:3072 sc1 lds
  ds_read_b128 v[28:31], v41 offset:256
  v_mfma_f32_16x16x32_bf16 v[52:55], v[172:175], v[112:115], v[52:55]
  ds_read_b128 v[96:99], v2 offset:11264
  v_mfma_f32_16x16x32_bf16 v[56:59], v[172:175], v[80:83], v[56:59]
  v_mfma_f32_16x16x32_bf16 v[56:59], v[160:163], v[76:79], v[56:59]
  s_add_u32 m0, s70, 114688
  s_add_u32 s69, s61, 163840
  v_mfma_f32_16x16x32_bf16 v[64:67], v[164:167], v[76:79], v[64:67]
  ds_read_b128 v[104:107], v2 offset:4096
  v_mfma_f32_16x16x32_bf16 v[64:67], v[176:179], v[80:83], v[64:67]
  buffer_load_dwordx4 v12, s[8:11], s69 offen offset:0 sc1 lds
  v_mfma_f32_16x16x32_bf16 v[60:63], v[176:179], v[112:115], v[60:63]
  v_mfma_f32_16x16x32_bf16 v[60:63], v[164:167], v[108:111], v[60:63]
  ds_read_b128 v[100:103], v2 offset:5120
  v_mfma_f32_16x16x32_bf16 v[68:71], v[168:171], v[108:111], v[68:71]
  ds_read_b64_tr_b16 v[120:121], v6 offset:20480
  v_mfma_f32_16x16x32_bf16 v[68:71], v[180:183], v[112:115], v[68:71]
  ds_read_b64_tr_b16 v[122:123], v6 offset:22528
  buffer_load_dwordx4 v12, s[8:11], s69 offen offset:1024 sc1 lds
  s_waitcnt lgkmcnt(5)
  v_mfma_f32_16x16x32_bf16 v[36:39], v[116:119], v[28:31], v[36:39]
  v_mfma_f32_16x16x32_bf16 v[72:75], v[180:183], v[80:83], v[72:75]
  ds_read_b128 v[108:111], v2 offset:12288
  ds_read_b128 v[32:35], v41 offset:320
  v_mfma_f32_16x16x32_bf16 v[72:75], v[168:171], v[76:79], v[72:75]
  s_waitcnt lgkmcnt(6)
  v_mfma_f32_16x16x32_bf16 v[52:55], v[184:187], v[88:91], v[52:55]
  v_mfma_f32_16x16x32_bf16 v[52:55], v[196:199], v[84:87], v[52:55]
  ds_read_b128 v[112:115], v2 offset:13312
  v_mfma_f32_16x16x32_bf16 v[56:59], v[196:199], v[96:99], v[56:59]
  buffer_load_dwordx4 v12, s[8:11], s69 offen offset:2048 sc1 lds
  v_mfma_f32_16x16x32_bf16 v[56:59], v[184:187], v[92:95], v[56:59]
  v_mfma_f32_16x16x32_bf16 v[64:67], v[188:191], v[92:95], v[64:67]
  ds_read_b128 v[80:83], v2 offset:6144
  v_mfma_f32_16x16x32_bf16 v[64:67], v[200:203], v[96:99], v[64:67]
  v_mfma_f32_16x16x32_bf16 v[60:63], v[200:203], v[84:87], v[60:63]
  ds_read_b64_tr_b16 v[116:117], v6 offset:24576
  v_mfma_f32_16x16x32_bf16 v[60:63], v[188:191], v[88:91], v[60:63]
  ds_read_b128 v[76:79], v2 offset:7168
  ds_read_b64_tr_b16 v[118:119], v6 offset:26624
  s_waitcnt lgkmcnt(5)
  v_mfma_f32_16x16x32_bf16 v[36:39], v[120:123], v[32:35], v[36:39]
  v_mfma_f32_16x16x32_bf16 v[68:71], v[192:195], v[88:91], v[68:71]
  buffer_load_dwordx4 v12, s[8:11], s69 offen offset:3072 sc1 lds
  ds_read_b128 v[28:31], v41 offset:384
  v_mfma_f32_16x16x32_bf16 v[68:71], v[204:207], v[84:87], v[68:71]
  v_mfma_f32_16x16x32_bf16 v[72:75], v[204:207], v[96:99], v[72:75]
  ds_read_b128 v[88:91], v2 offset:14336
  v_mfma_f32_16x16x32_bf16 v[72:75], v[192:195], v[92:95], v[72:75]
  s_waitcnt lgkmcnt(6)
  s_add_u32 m0, s70, 0
  s_add_u32 s69, s58, 229376
  v_mfma_f32_16x16x32_bf16 v[52:55], v[208:211], v[104:107], v[52:55]
  buffer_load_dwordx4 v12, s[8:11], s69 offen offset:0 sc1 lds
  v_mfma_f32_16x16x32_bf16 v[52:55], v[220:223], v[100:103], v[52:55]
  ds_read_b128 v[84:87], v2 offset:15360
  v_mfma_f32_16x16x32_bf16 v[56:59], v[220:223], v[112:115], v[56:59]
  v_mfma_f32_16x16x32_bf16 v[56:59], v[208:211], v[108:111], v[56:59]
  v_mfma_f32_16x16x32_bf16 v[64:67], v[212:215], v[108:111], v[64:67]
  ds_read_b128 v[96:99], v2 offset:32768
  ds_read_b64_tr_b16 v[120:121], v6 offset:28672
  v_mfma_f32_16x16x32_bf16 v[64:67], v[224:227], v[112:115], v[64:67]
  ds_read_b64_tr_b16 v[122:123], v6 offset:30720
  s_waitcnt lgkmcnt(5)
  v_mfma_f32_16x16x32_bf16 v[36:39], v[116:119], v[28:31], v[36:39]
  v_mfma_f32_16x16x32_bf16 v[60:63], v[224:227], v[100:103], v[60:63]
  buffer_load_dwordx4 v12, s[8:11], s69 offen offset:1024 sc1 lds
  ds_read_b128 v[32:35], v41 offset:448
  v_mfma_f32_16x16x32_bf16 v[60:63], v[212:215], v[104:107], v[60:63]
  ds_read_b128 v[92:95], v2 offset:33792
  v_mfma_f32_16x16x32_bf16 v[68:71], v[216:219], v[104:107], v[68:71]
  v_mfma_f32_16x16x32_bf16 v[68:71], v[228:231], v[100:103], v[68:71]
  v_mfma_f32_16x16x32_bf16 v[72:75], v[228:231], v[112:115], v[72:75]
  ds_read_b128 v[104:107], v2 offset:40960
  v_mfma_f32_16x16x32_bf16 v[72:75], v[216:219], v[108:111], v[72:75]
  s_waitcnt lgkmcnt(6)
  buffer_load_dwordx4 v12, s[8:11], s69 offen offset:2048 sc1 lds
  v_mfma_f32_16x16x32_bf16 v[52:55], v[232:235], v[80:83], v[52:55]
  v_mfma_f32_16x16x32_bf16 v[52:55], v[244:247], v[76:79], v[52:55]
  ds_read_b128 v[100:103], v2 offset:41984
  v_mfma_f32_16x16x32_bf16 v[56:59], v[244:247], v[84:87], v[56:59]
  v_mfma_f32_16x16x32_bf16 v[56:59], v[232:235], v[88:91], v[56:59]
  buffer_load_dwordx4 v12, s[8:11], s69 offen offset:3072 sc1 lds
  s_waitcnt lgkmcnt(3)
  v_mfma_f32_16x16x32_bf16 v[36:39], v[120:123], v[32:35], v[36:39]
  v_mfma_f32_16x16x32_bf16 v[64:67], v[236:239], v[88:91], v[64:67]
  ds_read_b128 v[112:115], v2 offset:34816
  v_mfma_f32_16x16x32_bf16 v[64:67], v[248:251], v[84:87], v[64:67]
  v_mfma_f32_16x16x32_bf16 v[60:63], v[248:251], v[76:79], v[60:63]
  v_mfma_f32_16x16x32_bf16 v[60:63], v[236:239], v[80:83], v[60:63]
  ds_read_b128 v[108:111], v2 offset:35840
  v_mfma_f32_16x16x32_bf16 v[68:71], v[240:243], v[80:83], v[68:71]
  s_nop 0
  buffer_store_dwordx4 v[36:39], v40, s[8:11], s52 offen sc1
  v_mfma_f32_16x16x32_bf16 v[68:71], v[252:255], v[76:79], v[68:71]
  v_mfma_f32_16x16x32_bf16 v[72:75], v[252:255], v[84:87], v[72:75]
  ds_read_b128 v[80:83], v2 offset:43008
  v_mfma_f32_16x16x32_bf16 v[72:75], v[240:243], v[88:91], v[72:75]
  s_waitcnt lgkmcnt(3)
  v_mfma_f32_16x16x32_bf16 v[28:31], a[0:3], v[96:99], 0
  v_mfma_f32_16x16x32_bf16 v[28:31], a[12:15], v[92:95], v[28:31]
  ds_read_b128 v[76:79], v2 offset:44032
  v_mfma_f32_16x16x32_bf16 v[32:35], a[12:15], v[100:103], 0
  v_mfma_f32_16x16x32_bf16 v[32:35], a[0:3], v[104:107], v[32:35]
  v_cvt_pk_bf16_f32 v52, v52, v53
  v_cvt_pk_bf16_f32 v53, v54, v55
  v_mfma_f32_16x16x32_bf16 v[40:43], a[4:7], v[104:107], 0
  ds_read_b128 v[84:87], v2 offset:36864
  v_mfma_f32_16x16x32_bf16 v[40:43], a[16:19], v[100:103], v[40:43]
  ds_write_b64 v18, v[52:53] offset:0
  v_mfma_f32_16x16x32_bf16 v[36:39], a[16:19], v[92:95], 0
  v_cvt_pk_bf16_f32 v60, v60, v61
  v_cvt_pk_bf16_f32 v61, v62, v63
  v_mfma_f32_16x16x32_bf16 v[36:39], a[4:7], v[96:99], v[36:39]
  ds_read_b128 v[88:91], v2 offset:37888
  v_cvt_pk_bf16_f32 v62, v68, v69
  v_cvt_pk_bf16_f32 v63, v70, v71
  v_mfma_f32_16x16x32_bf16 v[44:47], a[8:11], v[96:99], 0
  ds_write_b128 v17, v[60:63] offset:1024
  v_mfma_f32_16x16x32_bf16 v[44:47], a[20:23], v[92:95], v[44:47]
  v_cvt_pk_bf16_f32 v56, v56, v57
  v_cvt_pk_bf16_f32 v57, v58, v59
  v_mfma_f32_16x16x32_bf16 v[48:51], a[20:23], v[100:103], 0
  ds_read_b128 v[96:99], v2 offset:45056
  v_mfma_f32_16x16x32_bf16 v[48:51], a[8:11], v[104:107], v[48:51]
  s_waitcnt lgkmcnt(5)
  ds_write_b64 v18, v[56:57] offset:6144
  v_mfma_f32_16x16x32_bf16 v[28:31], a[24:27], v[112:115], v[28:31]
  v_cvt_pk_bf16_f32 v64, v64, v65
  v_cvt_pk_bf16_f32 v65, v66, v67
  v_mfma_f32_16x16x32_bf16 v[28:31], a[36:39], v[108:111], v[28:31]
  ds_read_b128 v[92:95], v2 offset:46080
  v_cvt_pk_bf16_f32 v66, v72, v73
  v_mfma_f32_16x16x32_bf16 v[32:35], a[36:39], v[76:79], v[32:35]
  v_cvt_pk_bf16_f32 v67, v74, v75
  v_mfma_f32_16x16x32_bf16 v[32:35], a[24:27], v[80:83], v[32:35]
  ds_write_b128 v17, v[64:67] offset:7168
  v_mfma_f32_16x16x32_bf16 v[40:43], a[28:31], v[80:83], v[40:43]
  ds_read_b128 v[100:103], v2 offset:38912
  v_mfma_f32_16x16x32_bf16 v[40:43], a[40:43], v[76:79], v[40:43]
  s_bitcmp1_b32 s44, 0
  s_mov_b32 s52, 0
  s_cselect_b32 s52, 6144, s52
  s_mov_b32 s53, 12288
  s_cselect_b32 s53, 0, s53
  v_mfma_f32_16x16x32_bf16 v[36:39], a[40:43], v[108:111], v[36:39]
  v_add_u32 v116, s52, v19
  v_add_u32 v117, s53, v19
  v_mfma_f32_16x16x32_bf16 v[36:39], a[28:31], v[112:115], v[36:39]
  ds_read_b128 v[104:107], v2 offset:39936
  v_add_u32 v118, s52, v20
  v_mfma_f32_16x16x32_bf16 v[44:47], a[32:35], v[112:115], v[44:47]
  v_add_u32 v119, s53, v20
  v_mfma_f32_16x16x32_bf16 v[44:47], a[44:47], v[108:111], v[44:47]
  s_waitcnt vmcnt(13) lgkmcnt(2)
  s_barrier
  v_mfma_f32_16x16x32_bf16 v[48:51], a[44:47], v[76:79], v[48:51]
  ds_read_b128 v[112:115], v2 offset:47104
  v_mfma_f32_16x16x32_bf16 v[48:51], a[32:35], v[80:83], v[48:51]
  s_waitcnt lgkmcnt(4)
  s_add_u32 m0, s45, 16384
  s_add_u32 s68, s67, 0
  s_and_b32 s68, s68, 7
  s_mul_i32 s68, s68, 262144
  v_mfma_f32_16x16x32_bf16 v[28:31], a[48:51], v[84:87], v[28:31]
  buffer_load_dwordx4 v10, s[16:19], s68 offen lds
  ds_read_b128 v[52:55], v116
  v_mfma_f32_16x16x32_bf16 v[28:31], a[60:63], v[88:91], v[28:31]
  ds_read_b128 v[108:111], v2 offset:48128
  v_mfma_f32_16x16x32_bf16 v[32:35], a[60:63], v[92:95], v[32:35]
  ds_read_b128 v[56:59], v117 offset:1024
  v_mfma_f32_16x16x32_bf16 v[32:35], a[48:51], v[96:99], v[32:35]
HOP3:
  s_cbranch_execz HOP7
  s_add_u32 m0, s45, 20480
  s_add_u32 s68, s68, 65536
  v_mfma_f32_16x16x32_bf16 v[40:43], a[52:55], v[96:99], v[40:43]
  ds_read_b128 v[76:79], v1 offset:32768
  v_mfma_f32_16x16x32_bf16 v[40:43], a[64:67], v[92:95], v[40:43]
  buffer_load_dwordx4 v10, s[16:19], s68 offen lds
  ds_read_b128 v[60:63], v116 offset:1024
  v_mfma_f32_16x16x32_bf16 v[36:39], a[64:67], v[88:91], v[36:39]
  ds_read_b64_tr_b16 v[64:65], v119 offset:2048
  v_mfma_f32_16x16x32_bf16 v[36:39], a[52:55], v[84:87], v[36:39]
  ds_read_b128 v[80:83], v1 offset:33792
  v_mfma_f32_16x16x32_bf16 v[44:47], a[56:59], v[84:87], v[44:47]
  s_add_u32 m0, s45, 24576
  s_add_u32 s68, s68, 65536
  v_mfma_f32_16x16x32_bf16 v[44:47], a[68:71], v[88:91], v[44:47]
  buffer_load_dwordx4 v10, s[16:19], s68 offen lds
  ds_read_b64_tr_b16 v[66:67], v118 offset:2048
  v_mfma_f32_16x16x32_bf16 v[48:51], a[68:71], v[92:95], v[48:51]
  ds_read_b128 v[84:87], v1 offset:40960
  v_mfma_f32_16x16x32_bf16 v[48:51], a[56:59], v[96:99], v[48:51]
  s_waitcnt lgkmcnt(7)
  ds_read_b64_tr_b16 v[68:69], v119 offset:2056
  v_mfma_f32_16x16x32_bf16 v[28:31], a[72:75], v[100:103], v[28:31]
  s_add_u32 m0, s45, 28672
  s_add_u32 s68, s68, 65536
  v_mfma_f32_16x16x32_bf16 v[28:31], a[84:87], v[104:107], v[28:31]
  ds_read_b128 v[88:91], v1 offset:41984
  v_mfma_f32_16x16x32_bf16 v[32:35], a[84:87], v[108:111], v[32:35]
  buffer_load_dwordx4 v10, s[16:19], s68 offen lds
  ds_read_b64_tr_b16 v[70:71], v118 offset:2056
  v_mfma_f32_16x16x32_bf16 v[32:35], a[72:75], v[112:115], v[32:35]
  v_mfma_f32_16x16x32_bf16 v[40:43], a[76:79], v[112:115], v[40:43]
  ds_read_b128 v[92:95], v1 offset:34816
  v_mfma_f32_16x16x32_bf16 v[40:43], a[88:91], v[108:111], v[40:43]
  v_mfma_f32_16x16x32_bf16 v[36:39], a[88:91], v[104:107], v[36:39]
  s_add_u32 m0, s70, 65536
  s_add_u32 s69, s59, 229376
  v_mfma_f32_16x16x32_bf16 v[36:39], a[76:79], v[100:103], v[36:39]
  ds_read_b128 v[96:99], v1 offset:35840
  s_waitcnt lgkmcnt(2)
  v_mfma_f32_16x16x32_bf16 v[116:119], v[56:59], v[52:55], 0
  v_mfma_f32_16x16x32_bf16 v[120:123], v[60:63], v[52:55], 0
  v_mfma_f32_16x16x32_bf16 v[44:47], a[80:83], v[100:103], v[44:47]
  buffer_load_dwordx4 v12, s[8:11], s69 offen offset:0 sc1 lds
  v_mfma_f32_16x16x32_bf16 v[44:47], a[92:95], v[104:107], v[44:47]
  v_mfma_f32_16x16x32_bf16 v[48:51], a[92:95], v[108:111], v[48:51]
  ds_read_b128 v[100:103], v1 offset:43008
  v_mfma_f32_16x16x32_bf16 v[48:51], a[80:83], v[112:115], v[48:51]
  s_waitcnt lgkmcnt(4)
  s_nop 0
  v_cndmask_b32 v72, v116, v120, s[80:81]
  v_cndmask_b32 v73, v117, v121, s[82:83]
  v_mfma_f32_16x16x32_bf16 v[28:31], a[96:99], v[76:79], v[28:31]
  buffer_load_dwordx4 v12, s[8:11], s69 offen offset:1024 sc1 lds
  v_cndmask_b32 v74, v118, v122, s[84:85]
  v_cndmask_b32 v75, v119, v123, s[86:87]
  v_mfma_f32_16x16x32_bf16 v[28:31], a[108:111], v[80:83], v[28:31]
  ds_read_b128 v[104:107], v1 offset:44032
  v_cndmask_b32 v72, v72, v73, s[88:89]
  v_mfma_f32_16x16x32_bf16 v[32:35], a[108:111], v[88:91], v[32:35]
  v_cndmask_b32 v73, v74, v75, s[88:89]
  v_mul_f32 v72, 0x3e8293ee, v72
  v_mfma_f32_16x16x32_bf16 v[32:35], a[96:99], v[84:87], v[32:35]
  v_mul_f32 v73, 0x3e8293ee, v73
  v_max_f32 v74, v72, v73
  v_mfma_f32_16x16x32_bf16 v[40:43], a[100:103], v[84:87], v[40:43]
  ds_read_b128 v[108:111], v1 offset:36864
  v_mov_b32 v75, v74
  v_mfma_f32_16x16x32_bf16 v[40:43], a[112:115], v[88:91], v[40:43]
  buffer_load_dwordx4 v12, s[8:11], s69 offen offset:2048 sc1 lds
  v_permlane16_swap_b32 v74, v75
  v_mfma_f32_16x16x32_bf16 v[36:39], a[112:115], v[80:83], v[36:39]
  v_max_f32 v74, v74, v75
  v_mov_b32 v75, v74
  v_mfma_f32_16x16x32_bf16 v[36:39], a[100:103], v[76:79], v[36:39]
  ds_read_b128 v[112:115], v1 offset:37888
  v_mfma_f32_16x16x32_bf16 v[44:47], a[104:107], v[76:79], v[44:47]
  v_permlane32_swap_b32 v74, v75
  v_mfma_f32_16x16x32_bf16 v[44:47], a[116:119], v[80:83], v[44:47]
  v_max_f32 v74, v74, v75
  v_sub_f32 v72, v72, v74
  v_mfma_f32_16x16x32_bf16 v[48:51], a[116:119], v[88:91], v[48:51]
  ds_read_b128 v[76:79], v1 offset:45056
  v_sub_f32 v73, v73, v74
  v_mfma_f32_16x16x32_bf16 v[48:51], a[104:107], v[84:87], v[48:51]
  s_waitcnt lgkmcnt(3)
  buffer_load_dwordx4 v12, s[8:11], s69 offen offset:3072 sc1 lds
  v_mfma_f32_16x16x32_bf16 v[28:31], a[120:123], v[92:95], v[28:31]
  v_exp_f32 v72, v72
  v_mfma_f32_16x16x32_bf16 v[28:31], a[132:135], v[96:99], v[28:31]
  ds_read_b128 v[80:83], v1 offset:46080
  v_mfma_f32_16x16x32_bf16 v[32:35], a[132:135], v[104:107], v[32:35]
  s_add_u32 m0, s45, 81920
  s_add_u32 s68, s67, 1
  s_and_b32 s68, s68, 7
  s_mul_i32 s68, s68, 262144
  v_mfma_f32_16x16x32_bf16 v[32:35], a[120:123], v[100:103], v[32:35]
  buffer_load_dwordx4 v10, s[16:19], s68 offen lds
  v_exp_f32 v73, v73
  v_mfma_f32_16x16x32_bf16 v[40:43], a[124:127], v[100:103], v[40:43]
  ds_read_b128 v[88:91], v1 offset:38912
  v_add_f32 v74, v72, v73
  v_mfma_f32_16x16x32_bf16 v[40:43], a[136:139], v[104:107], v[40:43]
  v_mov_b32 v75, v74
  v_mfma_f32_16x16x32_bf16 v[36:39], a[136:139], v[96:99], v[36:39]
  s_add_u32 m0, s45, 86016
  s_add_u32 s68, s68, 65536
  v_mfma_f32_16x16x32_bf16 v[36:39], a[124:127], v[92:95], v[36:39]
  ds_read_b128 v[84:87], v1 offset:39936
  v_mfma_f32_16x16x32_bf16 v[44:47], a[128:131], v[92:95], v[44:47]
  buffer_load_dwordx4 v10, s[16:19], s68 offen lds
  v_permlane16_swap_b32 v74, v75
  v_mfma_f32_16x16x32_bf16 v[44:47], a[140:143], v[96:99], v[44:47]
  v_add_f32 v74, v74, v75
  v_mov_b32 v75, v74
  v_mfma_f32_16x16x32_bf16 v[48:51], a[140:143], v[104:107], v[48:51]
  ds_read_b128 v[92:95], v1 offset:47104
  v_mfma_f32_16x16x32_bf16 v[48:51], a[128:131], v[100:103], v[48:51]
  s_waitcnt lgkmcnt(3)
  v_permlane32_swap_b32 v74, v75
  v_mfma_f32_16x16x32_bf16 v[28:31], a[144:147], v[108:111], v[28:31]
  s_add_u32 m0, s45, 90112
  s_add_u32 s68, s68, 65536
  v_add_f32 v74, v74, v75
  v_mfma_f32_16x16x32_bf16 v[28:31], a[156:159], v[112:115], v[28:31]
  ds_read_b128 v[96:99], v1 offset:48128
  v_mfma_f32_16x16x32_bf16 v[32:35], a[156:159], v[80:83], v[32:35]
  buffer_load_dwordx4 v10, s[16:19], s68 offen lds
  v_rcp_f32 v74, v74
  v_mfma_f32_16x16x32_bf16 v[32:35], a[144:147], v[76:79], v[32:35]
  s_waitcnt vmcnt(11)
  s_barrier
  v_mfma_f32_16x16x32_bf16 v[40:43], a[148:151], v[76:79], v[40:43]
  ds_read_b128 v[104:107], v1 offset:49152
  v_mul_f32 v72, v72, v74
  v_add_u32 v15, s46, v0
  s_mov_b64 exec, 1
  buffer_store_dword v15, v0, s[8:11], s79 offen offset:0 sc1
  s_mov_b64 exec, -1
  v_mfma_f32_16x16x32_bf16 v[40:43], a[160:163], v[80:83], v[40:43]
  s_add_u32 m0, s45, 94208
  s_add_u32 s68, s68, 65536
  v_mul_f32 v73, v73, v74
  v_mfma_f32_16x16x32_bf16 v[36:39], a[160:163], v[112:115], v[36:39]
  buffer_load_dwordx4 v10, s[16:19], s68 offen lds
  v_cvt_pk_bf16_f32 v72, v72, v72
  v_cvt_pk_bf16_f32 v73, v73, v73
  v_mfma_f32_16x16x32_bf16 v[36:39], a[148:151], v[108:111], v[36:39]
  ds_read_b128 v[100:103], v1 offset:50176
  v_and_b32 v52, v24, v72
  v_mfma_f32_16x16x32_bf16 v[44:47], a[152:155], v[108:111], v[44:47]
  v_and_b32 v53, v25, v73
  v_and_b32 v54, v26, v72
  v_mfma_f32_16x16x32_bf16 v[44:47], a[164:167], v[112:115], v[44:47]
  v_and_b32 v55, v27, v73
  v_mfma_f32_16x16x32_bf16 v[48:51], a[164:167], v[80:83], v[48:51]
  ds_read_b128 v[108:111], v1 offset:57344
  v_mfma_f32_16x16x32_bf16 v[56:59], v[64:67], v[52:55], 0
  v_mfma_f32_16x16x32_bf16 v[60:63], v[68:71], v[52:55], 0
  v_mfma_f32_16x16x32_bf16 v[48:51], a[152:155], v[76:79], v[48:51]
  s_waitcnt lgkmcnt(3)
  s_add_u32 m0, s70, 98304
  s_add_u32 s69, s60, 229376
  v_mfma_f32_16x16x32_bf16 v[28:31], a[168:171], v[88:91], v[28:31]
  buffer_load_dwordx4 v12, s[8:11], s69 offen offset:0 sc1 lds
  v_mfma_f32_16x16x32_bf16 v[28:31], a[180:183], v[84:87], v[28:31]
  ds_read_b128 v[112:115], v1 offset:58368
  v_mfma_f32_16x16x32_bf16 v[32:35], a[180:183], v[96:99], v[32:35]
  v_cvt_pk_bf16_f32 v116, v56, v57
  v_cvt_pk_bf16_f32 v117, v58, v59
  v_mfma_f32_16x16x32_bf16 v[32:35], a[168:171], v[92:95], v[32:35]
  v_cvt_pk_bf16_f32 v118, v60, v61
  v_cvt_pk_bf16_f32 v119, v62, v63
  v_mfma_f32_16x16x32_bf16 v[40:43], a[172:175], v[92:95], v[40:43]
  ds_read_b128 v[80:83], v1 offset:51200
  v_mfma_f32_16x16x32_bf16 v[40:43], a[184:187], v[96:99], v[40:43]
  buffer_load_dwordx4 v12, s[8:11], s69 offen offset:1024 sc1 lds
  buffer_store_dwordx4 v[116:119], v1, s[8:11], s73 offen sc1
  v_mfma_f32_16x16x32_bf16 v[36:39], a[184:187], v[84:87], v[36:39]
  s_add_u32 s73, s73, 65536
  v_mfma_f32_16x16x32_bf16 v[36:39], a[172:175], v[88:91], v[36:39]
  ds_read_b128 v[76:79], v1 offset:52224
  v_mfma_f32_16x16x32_bf16 v[44:47], a[176:179], v[88:91], v[44:47]
  v_mfma_f32_16x16x32_bf16 v[44:47], a[188:191], v[84:87], v[44:47]
  buffer_load_dwordx4 v12, s[8:11], s69 offen offset:2048 sc1 lds
  v_mfma_f32_16x16x32_bf16 v[48:51], a[188:191], v[96:99], v[48:51]
  ds_read_b128 v[88:91], v1 offset:59392
  v_mfma_f32_16x16x32_bf16 v[48:51], a[176:179], v[92:95], v[48:51]
  s_waitcnt lgkmcnt(3)
  v_mfma_f32_16x16x32_bf16 v[28:31], a[192:195], v[104:107], v[28:31]
  v_mfma_f32_16x16x32_bf16 v[28:31], a[204:207], v[100:103], v[28:31]
  ds_read_b128 v[84:87], v1 offset:60416
  v_mfma_f32_16x16x32_bf16 v[32:35], a[204:207], v[112:115], v[32:35]
  buffer_load_dwordx4 v12, s[8:11], s69 offen offset:3072 sc1 lds
  v_mfma_f32_16x16x32_bf16 v[32:35], a[192:195], v[108:111], v[32:35]
  v_mfma_f32_16x16x32_bf16 v[40:43], a[196:199], v[108:111], v[40:43]
  ds_read_b128 v[96:99], v1 offset:53248
  v_mfma_f32_16x16x32_bf16 v[40:43], a[208:211], v[112:115], v[40:43]
  v_mfma_f32_16x16x32_bf16 v[36:39], a[208:211], v[100:103], v[36:39]
  v_lshrrev_b32 v116, 3, v0
  v_bfe_u32 v117, v116, 1, 2
  v_mfma_f32_16x16x32_bf16 v[36:39], a[196:199], v[104:107], v[36:39]
  ds_read_b128 v[92:95], v1 offset:54272
  v_bfe_u32 v118, v0, 1, 2
  v_mfma_f32_16x16x32_bf16 v[44:47], a[200:203], v[104:107], v[44:47]
  v_xor_b32 v117, v117, v118
  s_lshl_b32 s52, s44, 3
  v_mfma_f32_16x16x32_bf16 v[44:47], a[212:215], v[100:103], v[44:47]
  v_add_u32 v116, s52, v116
  v_mul_u32_u24 v116, 7168, v116
  v_mfma_f32_16x16x32_bf16 v[48:51], a[212:215], v[112:115], v[48:51]
  ds_read_b128 v[104:107], v1 offset:61440
  v_and_b32 v118, 1, v0
  v_mfma_f32_16x16x32_bf16 v[48:51], a[200:203], v[108:111], v[48:51]
  s_waitcnt lgkmcnt(3)
  v_lshl_add_u32 v116, v118, 4, v116
  s_and_b32 s52, s2, 7
  v_mfma_f32_16x16x32_bf16 v[28:31], a[216:219], v[80:83], v[28:31]
  s_mul_i32 s52, s52, 896
  v_add_u32 v116, s52, v116
  v_lshlrev_b32 v118, 5, v117
  v_mfma_f32_16x16x32_bf16 v[28:31], a[228:231], v[76:79], v[28:31]
  ds_read_b128 v[100:103], v1 offset:62464
  s_and_b32 s53, s2, 24
  v_mfma_f32_16x16x32_bf16 v[32:35], a[228:231], v[84:87], v[32:35]
  s_lshl_b32 s52, s53, 5
  v_add3_u32 v16, v116, v118, s52
  s_lshr_b32 s52, 0x0b070602, s53
  v_mfma_f32_16x16x32_bf16 v[32:35], a[216:219], v[88:91], v[32:35]
  s_and_b32 s52, s52, 15
  s_lshl_b32 s52, s52, 6
  v_add_u32 v118, s52, v118
  v_mfma_f32_16x16x32_bf16 v[40:43], a[220:223], v[88:91], v[40:43]
  ds_read_b128 v[112:115], v1 offset:55296
  s_lshr_b32 s52, 0x15140706, s53
  v_mfma_f32_16x16x32_bf16 v[40:43], a[232:235], v[84:87], v[40:43]
  s_and_b32 s52, s52, 31
  s_lshl_b32 s52, s52, 5
  v_mov_b32 v119, s52
  v_mfma_f32_16x16x32_bf16 v[36:39], a[232:235], v[76:79], v[36:39]
  v_cmp_gt_u32 vcc, 2, v117
  s_nop 1
  v_cndmask_b32 v118, v119, v118, vcc
  v_mfma_f32_16x16x32_bf16 v[36:39], a[220:223], v[80:83], v[36:39]
  ds_read_b128 v[108:111], v1 offset:56320
  v_add_u32 v11, v116, v118
  v_mfma_f32_16x16x32_bf16 v[44:47], a[224:227], v[80:83], v[44:47]
  v_add_u32 v117, 1, v117
  v_lshrrev_b32 v117, 2, v117
  v_mfma_f32_16x16x32_bf16 v[44:47], a[236:239], v[76:79], v[44:47]
  v_lshl_add_u32 v11, v117, 30, v11
  v_mfma_f32_16x16x32_bf16 v[48:51], a[236:239], v[84:87], v[48:51]
  ds_read_b128 v[80:83], v1 offset:63488
  v_mfma_f32_16x16x32_bf16 v[48:51], a[224:227], v[88:91], v[48:51]
  s_waitcnt lgkmcnt(3)
  v_mfma_f32_16x16x32_bf16 v[28:31], a[240:243], v[96:99], v[28:31]
  v_mfma_f32_16x16x32_bf16 v[28:31], v[124:127], v[92:95], v[28:31]
  ds_read_b128 v[76:79], v1 offset:64512
  v_mfma_f32_16x16x32_bf16 v[32:35], v[124:127], v[100:103], v[32:35]
  v_mfma_f32_16x16x32_bf16 v[32:35], a[240:243], v[104:107], v[32:35]
  s_waitcnt vmcnt(23)
  s_barrier
  v_mfma_f32_16x16x32_bf16 v[40:43], a[244:247], v[104:107], v[40:43]
  ds_read_b128 v[84:87], v2 offset:49152
  s_add_u32 m0, s45, 32768
  s_add_u32 s68, s67, 2
  s_and_b32 s68, s68, 7
  s_mul_i32 s68, s68, 262144
  v_mfma_f32_16x16x32_bf16 v[40:43], v[128:131], v[100:103], v[40:43]
  buffer_load_dwordx4 v10, s[16:19], s68 offen lds
  v_mfma_f32_16x16x32_bf16 v[36:39], v[128:131], v[92:95], v[36:39]
  v_mfma_f32_16x16x32_bf16 v[36:39], a[244:247], v[96:99], v[36:39]
  ds_read_b128 v[88:91], v2 offset:50176
  v_mfma_f32_16x16x32_bf16 v[44:47], a[248:251], v[96:99], v[44:47]
  v_mfma_f32_16x16x32_bf16 v[44:47], v[132:135], v[92:95], v[44:47]
  s_add_u32 m0, s45, 36864
  s_add_u32 s68, s68, 65536
  v_mfma_f32_16x16x32_bf16 v[48:51], v[132:135], v[100:103], v[48:51]
  ds_read_b128 v[96:99], v2 offset:57344
  v_mfma_f32_16x16x32_bf16 v[48:51], a[248:251], v[104:107], v[48:51]
  s_waitcnt lgkmcnt(3)
  buffer_load_dwordx4 v10, s[16:19], s68 offen lds
  v_mfma_f32_16x16x32_bf16 v[28:31], v[136:139], v[112:115], v[28:31]
  v_mfma_f32_16x16x32_bf16 v[28:31], v[148:151], v[108:111], v[28:31]
  ds_read_b128 v[92:95], v2 offset:58368
  v_mfma_f32_16x16x32_bf16 v[32:35], v[148:151], v[76:79], v[32:35]
  s_add_u32 m0, s45, 40960
  s_add_u32 s68, s68, 65536
  v_mfma_f32_16x16x32_bf16 v[32:35], v[136:139], v[80:83], v[32:35]
  buffer_load_dwordx4 v10, s[16:19], s68 offen lds
  v_mfma_f32_16x16x32_bf16 v[40:43], v[140:143], v[80:83], v[40:43]
  ds_read_b128 v[100:103], v2 offset:51200
  v_mfma_f32_16x16x32_bf16 v[40:43], v[152:155], v[76:79], v[40:43]
  s_add_u32 m0, s45, 45056
  s_add_u32 s68, s68, 65536
  v_mfma_f32_16x16x32_bf16 v[36:39], v[152:155], v[108:111], v[36:39]
  buffer_load_dwordx4 v10, s[16:19], s68 offen lds
  v_mfma_f32_16x16x32_bf16 v[36:39], v[140:143], v[112:115], v[36:39]
  ds_read_b128 v[104:107], v2 offset:52224
  v_mfma_f32_16x16x32_bf16 v[44:47], v[144:147], v[112:115], v[44:47]
  v_mfma_f32_16x16x32_bf16 v[44:47], v[156:159], v[108:111], v[44:47]
  v_mfma_f32_16x16x32_bf16 v[48:51], v[156:159], v[76:79], v[48:51]
  ds_read_b128 v[112:115], v2 offset:59392
  s_cmp_gt_u32 s44, 1
  s_cbranch_scc1 TH4_adaLN_cond__sliding_local_dilated__swiglu_ffn__prompt_kernel
  s_cmp_eq_u32 s44, 0
  s_cselect_b64 s[4:5], s[28:29], s[32:33]
  s_lshr_b32 s57, s2, 3
  s_mul_i32 s57, s57, 57344
  s_and_b32 vcc_lo, s2, 7
  s_mul_i32 vcc_lo, vcc_lo, 896
  s_add_u32 s57, s57, vcc_lo
  v_lshrrev_b32 v15, 3, v0
  v_mul_u32_u24 v15, 6144, v15
  v_lshl_add_u32 v15, v0, 7, v15
  s_mov_b32 exec_lo, 0x7f7f7f7f
  s_mov_b32 exec_hi, 0x7f7f7f7f
  buffer_load_dword a253, v15, s[4:7], s57 offen
  s_mov_b64 exec, -1
TH4_adaLN_cond__sliding_local_dilated__swiglu_ffn__prompt_kernel:
  v_mfma_f32_16x16x32_bf16 v[48:51], v[144:147], v[80:83], v[48:51]
  s_waitcnt lgkmcnt(3)
  v_mfma_f32_16x16x32_bf16 v[28:31], v[160:163], v[84:87], v[28:31]
  v_mfma_f32_16x16x32_bf16 v[28:31], v[172:175], v[88:91], v[28:31]
  ds_read_b128 v[108:111], v2 offset:60416
  v_mfma_f32_16x16x32_bf16 v[32:35], v[172:175], v[92:95], v[32:35]
  v_mfma_f32_16x16x32_bf16 v[32:35], v[160:163], v[96:99], v[32:35]
  v_mfma_f32_16x16x32_bf16 v[40:43], v[164:167], v[96:99], v[40:43]
  ds_read_b128 v[76:79], v2 offset:53248
  v_mfma_f32_16x16x32_bf16 v[40:43], v[176:179], v[92:95], v[40:43]
  v_mfma_f32_16x16x32_bf16 v[36:39], v[176:179], v[88:91], v[36:39]
  v_mfma_f32_16x16x32_bf16 v[36:39], v[164:167], v[84:87], v[36:39]
  ds_read_b128 v[80:83], v2 offset:54272
  v_mfma_f32_16x16x32_bf16 v[44:47], v[168:171], v[84:87], v[44:47]
  v_mfma_f32_16x16x32_bf16 v[44:47], v[180:183], v[88:91], v[44:47]
  v_mfma_f32_16x16x32_bf16 v[48:51], v[180:183], v[92:95], v[48:51]
  ds_read_b128 v[84:87], v2 offset:61440
  v_mfma_f32_16x16x32_bf16 v[48:51], v[168:171], v[96:99], v[48:51]
  s_waitcnt lgkmcnt(3)
  v_mfma_f32_16x16x32_bf16 v[28:31], v[184:187], v[100:103], v[28:31]
  v_mfma_f32_16x16x32_bf16 v[28:31], v[196:199], v[104:107], v[28:31]
  ds_read_b128 v[88:91], v2 offset:62464
  v_mfma_f32_16x16x32_bf16 v[32:35], v[196:199], v[108:111], v[32:35]
  v_mfma_f32_16x16x32_bf16 v[32:35], v[184:187], v[112:115], v[32:35]
  v_mfma_f32_16x16x32_bf16 v[40:43], v[188:191], v[112:115], v[40:43]
  ds_read_b128 v[92:95], v2 offset:55296
  v_mfma_f32_16x16x32_bf16 v[40:43], v[200:203], v[108:111], v[40:43]
  v_mfma_f32_16x16x32_bf16 v[36:39], v[200:203], v[104:107], v[36:39]
  v_mfma_f32_16x16x32_bf16 v[36:39], v[188:191], v[100:103], v[36:39]
  ds_read_b128 v[96:99], v2 offset:56320
  v_mfma_f32_16x16x32_bf16 v[44:47], v[192:195], v[100:103], v[44:47]
  v_mfma_f32_16x16x32_bf16 v[44:47], v[204:207], v[104:107], v[44:47]
  v_mfma_f32_16x16x32_bf16 v[48:51], v[204:207], v[108:111], v[48:51]
  ds_read_b128 v[100:103], v2 offset:63488
  v_mfma_f32_16x16x32_bf16 v[48:51], v[192:195], v[112:115], v[48:51]
  s_waitcnt lgkmcnt(3)
  v_mfma_f32_16x16x32_bf16 v[28:31], v[208:211], v[76:79], v[28:31]
  v_mfma_f32_16x16x32_bf16 v[28:31], v[220:223], v[80:83], v[28:31]
  ds_read_b128 v[104:107], v2 offset:64512
  v_mfma_f32_16x16x32_bf16 v[32:35], v[220:223], v[88:91], v[32:35]
  v_mfma_f32_16x16x32_bf16 v[32:35], v[208:211], v[84:87], v[32:35]
  s_waitcnt vmcnt(6)
  s_barrier
  v_add_u32 v15, s46, v0
  v_add_u32 v15, 1, v15
  s_mov_b64 exec, 1
  buffer_store_dword v15, v0, s[8:11], s74 offen offset:0 sc1
  s_mov_b64 exec, -1
  v_mfma_f32_16x16x32_bf16 v[40:43], v[212:215], v[84:87], v[40:43]
  ds_read_b128 v[108:111], v1 offset:0
  s_add_u32 m0, s45, 49152
  s_add_u32 s68, s67, 3
  s_and_b32 s68, s68, 7
  s_mul_i32 s68, s68, 262144
  v_mfma_f32_16x16x32_bf16 v[40:43], v[224:227], v[88:91], v[40:43]
  buffer_load_dwordx4 v10, s[16:19], s68 offen lds
  v_mfma_f32_16x16x32_bf16 v[36:39], v[224:227], v[80:83], v[36:39]
  s_add_u32 m0, s45, 53248
  s_add_u32 s68, s68, 65536
  v_mfma_f32_16x16x32_bf16 v[36:39], v[212:215], v[76:79], v[36:39]
  ds_read_b128 v[112:115], v1 offset:1024
  v_mfma_f32_16x16x32_bf16 v[44:47], v[216:219], v[76:79], v[44:47]
  buffer_load_dwordx4 v10, s[16:19], s68 offen lds
  v_mfma_f32_16x16x32_bf16 v[44:47], v[228:231], v[80:83], v[44:47]
  v_mfma_f32_16x16x32_bf16 v[48:51], v[228:231], v[88:91], v[48:51]
  ds_read_b128 v[76:79], v1 offset:8192
  v_mfma_f32_16x16x32_bf16 v[48:51], v[216:219], v[84:87], v[48:51]
  s_waitcnt lgkmcnt(3)
  s_add_u32 m0, s45, 57344
  s_add_u32 s68, s68, 65536
  v_mfma_f32_16x16x32_bf16 v[28:31], v[232:235], v[92:95], v[28:31]
  buffer_load_dwordx4 v10, s[16:19], s68 offen lds
  s_add_u32 m0, s45, 61440
  s_add_u32 s68, s68, 65536
  v_mfma_f32_16x16x32_bf16 v[28:31], v[244:247], v[96:99], v[28:31]
  ds_read_b128 v[80:83], v1 offset:9216
  v_mfma_f32_16x16x32_bf16 v[32:35], v[244:247], v[104:107], v[32:35]
  buffer_load_dwordx4 v10, s[16:19], s68 offen lds
  v_mfma_f32_16x16x32_bf16 v[32:35], v[232:235], v[100:103], v[32:35]
  v_mfma_f32_16x16x32_bf16 v[40:43], v[236:239], v[100:103], v[40:43]
  ds_read_b128 v[88:91], v1 offset:2048
  v_mfma_f32_16x16x32_bf16 v[40:43], v[248:251], v[104:107], v[40:43]
  v_mfma_f32_16x16x32_bf16 v[36:39], v[248:251], v[96:99], v[36:39]
  v_mfma_f32_16x16x32_bf16 v[36:39], v[236:239], v[92:95], v[36:39]
  ds_read_b128 v[84:87], v1 offset:3072
  v_mfma_f32_16x16x32_bf16 v[44:47], v[240:243], v[92:95], v[44:47]
  v_mfma_f32_16x16x32_bf16 v[44:47], v[252:255], v[96:99], v[44:47]
  v_mfma_f32_16x16x32_bf16 v[48:51], v[252:255], v[104:107], v[48:51]
  ds_read_b128 v[92:95], v1 offset:10240
  v_mfma_f32_16x16x32_bf16 v[48:51], v[240:243], v[100:103], v[48:51]
  s_waitcnt lgkmcnt(3)
  v_mfma_f32_16x16x32_bf16 v[52:55], a[0:3], v[108:111], 0
  v_mfma_f32_16x16x32_bf16 v[52:55], a[12:15], v[112:115], v[52:55]
  ds_read_b128 v[96:99], v1 offset:11264
  v_mfma_f32_16x16x32_bf16 v[56:59], a[12:15], v[80:83], 0
  v_mfma_f32_16x16x32_bf16 v[56:59], a[0:3], v[76:79], v[56:59]
  v_cvt_pk_bf16_f32 v28, v28, v29
  v_cvt_pk_bf16_f32 v29, v30, v31
  v_mfma_f32_16x16x32_bf16 v[64:67], a[4:7], v[76:79], 0
  ds_read_b128 v[104:107], v1 offset:4096
  v_mfma_f32_16x16x32_bf16 v[64:67], a[16:19], v[80:83], v[64:67]
  ds_write_b64 v18, v[28:29] offset:12288
  v_mfma_f32_16x16x32_bf16 v[60:63], a[16:19], v[112:115], 0
  v_cvt_pk_bf16_f32 v36, v36, v37
  v_cvt_pk_bf16_f32 v37, v38, v39
  v_mfma_f32_16x16x32_bf16 v[60:63], a[4:7], v[108:111], v[60:63]
  ds_read_b128 v[100:103], v1 offset:5120
  v_cvt_pk_bf16_f32 v38, v44, v45
  v_cvt_pk_bf16_f32 v39, v46, v47
  v_mfma_f32_16x16x32_bf16 v[68:71], a[8:11], v[108:111], 0
  ds_write_b128 v17, v[36:39] offset:13312
  v_mfma_f32_16x16x32_bf16 v[68:71], a[20:23], v[112:115], v[68:71]
  v_cvt_pk_bf16_f32 v32, v32, v33
  v_cvt_pk_bf16_f32 v33, v34, v35
  v_mfma_f32_16x16x32_bf16 v[72:75], a[20:23], v[80:83], 0
  ds_read_b128 v[108:111], v1 offset:12288
  v_mfma_f32_16x16x32_bf16 v[72:75], a[8:11], v[76:79], v[72:75]
  s_waitcnt lgkmcnt(5)
  ds_write_b64 v18, v[32:33] offset:0
  v_mfma_f32_16x16x32_bf16 v[52:55], a[24:27], v[88:91], v[52:55]
  v_cvt_pk_bf16_f32 v40, v40, v41
  v_cvt_pk_bf16_f32 v41, v42, v43
  v_mfma_f32_16x16x32_bf16 v[52:55], a[36:39], v[84:87], v[52:55]
  ds_read_b128 v[112:115], v1 offset:13312
  v_cvt_pk_bf16_f32 v42, v48, v49
  v_mfma_f32_16x16x32_bf16 v[56:59], a[36:39], v[96:99], v[56:59]
  v_cvt_pk_bf16_f32 v43, v50, v51
  v_mfma_f32_16x16x32_bf16 v[56:59], a[24:27], v[92:95], v[56:59]
  ds_write_b128 v17, v[40:43] offset:1024
  v_mfma_f32_16x16x32_bf16 v[64:67], a[28:31], v[92:95], v[64:67]
  ds_read_b128 v[80:83], v1 offset:6144
  v_mfma_f32_16x16x32_bf16 v[64:67], a[40:43], v[96:99], v[64:67]
  s_bitcmp1_b32 s44, 0
  s_mov_b32 s52, 12288
  s_cselect_b32 s52, 0, s52
  s_mov_b32 s53, 6144
  s_cselect_b32 s53, 12288, s53
  v_mfma_f32_16x16x32_bf16 v[60:63], a[40:43], v[84:87], v[60:63]
  v_add_u32 v116, s52, v19
  v_add_u32 v117, s53, v19
  v_mfma_f32_16x16x32_bf16 v[60:63], a[28:31], v[88:91], v[60:63]
  ds_read_b128 v[76:79], v1 offset:7168
  v_add_u32 v118, s52, v20
  v_mfma_f32_16x16x32_bf16 v[68:71], a[32:35], v[88:91], v[68:71]
  v_add_u32 v119, s53, v20
  v_mfma_f32_16x16x32_bf16 v[68:71], a[44:47], v[84:87], v[68:71]
  s_waitcnt vmcnt(19) lgkmcnt(2)
  s_barrier
  v_mfma_f32_16x16x32_bf16 v[72:75], a[44:47], v[96:99], v[72:75]
  ds_read_b128 v[88:91], v1 offset:14336
  s_add_u32 m0, s45, 114688
  s_add_u32 s68, s67, 4
  s_and_b32 s68, s68, 7
  s_mul_i32 s68, s68, 262144
  v_mfma_f32_16x16x32_bf16 v[72:75], a[32:35], v[92:95], v[72:75]
  s_waitcnt lgkmcnt(4)
  buffer_load_dwordx4 v10, s[16:19], s68 offen lds
  ds_read_b128 v[28:31], v116
  v_mfma_f32_16x16x32_bf16 v[52:55], a[48:51], v[104:107], v[52:55]
  ds_read_b64_tr_b16 a[0:1], v4 offset:16384
  ds_read_b128 v[32:35], v117 offset:1024
  v_mfma_f32_16x16x32_bf16 v[52:55], a[60:63], v[100:103], v[52:55]
  ds_read_b128 v[84:87], v1 offset:15360
  s_add_u32 m0, s45, 118784
  s_add_u32 s68, s68, 65536
  v_mfma_f32_16x16x32_bf16 v[56:59], a[60:63], v[112:115], v[56:59]
  ds_read_b64_tr_b16 a[2:3], v4 offset:18432
  buffer_load_dwordx4 v10, s[16:19], s68 offen lds
  v_mfma_f32_16x16x32_bf16 v[56:59], a[48:51], v[108:111], v[56:59]
  ds_read_b64_tr_b16 a[4:5], v5 offset:16384
  ds_read_b128 v[36:39], v116 offset:1024
  v_mfma_f32_16x16x32_bf16 v[64:67], a[52:55], v[108:111], v[64:67]
  ds_read_b128 v[96:99], v2 offset:0
  s_add_u32 m0, s45, 122880
  s_add_u32 s68, s68, 65536
  v_mfma_f32_16x16x32_bf16 v[64:67], a[64:67], v[112:115], v[64:67]
  ds_read_b64_tr_b16 a[6:7], v5 offset:18432
  buffer_load_dwordx4 v10, s[16:19], s68 offen lds
  v_mfma_f32_16x16x32_bf16 v[60:63], a[64:67], v[100:103], v[60:63]
  ds_read_b64_tr_b16 a[8:9], v4 offset:20480
  ds_read_b64_tr_b16 v[40:41], v119 offset:2048
  v_mfma_f32_16x16x32_bf16 v[60:63], a[52:55], v[104:107], v[60:63]
  ds_read_b128 v[92:95], v2 offset:1024
  s_add_u32 m0, s45, 126976
  s_add_u32 s68, s68, 65536
  v_mfma_f32_16x16x32_bf16 v[68:71], a[56:59], v[104:107], v[68:71]
  ds_read_b64_tr_b16 a[10:11], v4 offset:22528
  buffer_load_dwordx4 v10, s[16:19], s68 offen lds
  v_mfma_f32_16x16x32_bf16 v[68:71], a[68:71], v[100:103], v[68:71]
  ds_read_b64_tr_b16 a[12:13], v5 offset:20480
  ds_read_b64_tr_b16 v[42:43], v118 offset:2048
  v_mfma_f32_16x16x32_bf16 v[72:75], a[68:71], v[112:115], v[72:75]
  ds_read_b128 v[104:107], v2 offset:8192
  ds_read_b64_tr_b16 v[44:45], v119 offset:2056
  v_mfma_f32_16x16x32_bf16 v[72:75], a[56:59], v[108:111], v[72:75]
  s_waitcnt lgkmcnt(13)
  ds_read_b64_tr_b16 a[14:15], v5 offset:22528
  v_mfma_f32_16x16x32_bf16 v[52:55], a[72:75], v[80:83], v[52:55]
  ds_read_b64_tr_b16 a[16:17], v4 offset:24576
  ds_read_b64_tr_b16 v[46:47], v118 offset:2056
  v_mfma_f32_16x16x32_bf16 v[52:55], a[84:87], v[76:79], v[52:55]
  ds_read_b128 v[100:103], v2 offset:9216
  v_mfma_f32_16x16x32_bf16 v[56:59], a[84:87], v[84:87], v[56:59]
  ds_read_b64_tr_b16 a[18:19], v4 offset:26624
  v_mfma_f32_16x16x32_bf16 v[56:59], a[72:75], v[88:91], v[56:59]
  ds_read_b64_tr_b16 a[20:21], v5 offset:24576
  v_mfma_f32_16x16x32_bf16 v[64:67], a[76:79], v[88:91], v[64:67]
  ds_read_b128 v[112:115], v2 offset:2048
  v_mfma_f32_16x16x32_bf16 v[64:67], a[88:91], v[84:87], v[64:67]
  ds_read_b64_tr_b16 a[22:23], v5 offset:26624
  s_waitcnt lgkmcnt(5)
  v_mfma_f32_16x16x32_bf16 v[116:119], v[32:35], v[28:31], 0
  v_mfma_f32_16x16x32_bf16 v[120:123], v[36:39], v[28:31], 0
  v_mfma_f32_16x16x32_bf16 v[60:63], a[88:91], v[76:79], v[60:63]
  ds_read_b64_tr_b16 a[24:25], v4 offset:28672
  v_mfma_f32_16x16x32_bf16 v[60:63], a[76:79], v[80:83], v[60:63]
  ds_read_b128 v[108:111], v2 offset:3072
  v_mfma_f32_16x16x32_bf16 v[68:71], a[80:83], v[80:83], v[68:71]
  ds_read_b64_tr_b16 a[26:27], v4 offset:30720
  v_mfma_f32_16x16x32_bf16 v[68:71], a[92:95], v[76:79], v[68:71]
  ds_read_b64_tr_b16 a[28:29], v5 offset:28672
  v_cndmask_b32 v48, v116, v120, s[80:81]
  v_cndmask_b32 v49, v117, v121, s[82:83]
  v_mfma_f32_16x16x32_bf16 v[72:75], a[92:95], v[84:87], v[72:75]
  ds_read_b128 v[80:83], v2 offset:10240
  v_cndmask_b32 v50, v118, v122, s[84:85]
  v_cndmask_b32 v51, v119, v123, s[86:87]
  v_mfma_f32_16x16x32_bf16 v[72:75], a[80:83], v[88:91], v[72:75]
  s_waitcnt lgkmcnt(9)
  ds_read_b64_tr_b16 a[30:31], v5 offset:30720
  v_cndmask_b32 v48, v48, v49, s[88:89]
  v_mfma_f32_16x16x32_bf16 v[52:55], a[96:99], v[96:99], v[52:55]
  s_lshl_b32 s57, s44, 28
  s_add_u32 s57, s57, s77
  buffer_load_dword v13, v14, s[8:11], s57 offen sc1
  v_cndmask_b32 v49, v50, v51, s[88:89]
  v_mfma_f32_16x16x32_bf16 v[52:55], a[108:111], v[92:95], v[52:55]
  ds_read_b128 v[76:79], v2 offset:11264
  v_mul_f32 v48, 0x3e8293ee, v48
  v_mul_f32 v49, 0x3e8293ee, v49
  v_mfma_f32_16x16x32_bf16 v[56:59], a[108:111], v[100:103], v[56:59]
  v_max_f32 v50, v48, v49
  v_mov_b32 v51, v50
  v_mfma_f32_16x16x32_bf16 v[56:59], a[96:99], v[104:107], v[56:59]
  s_nop 0
  v_permlane16_swap_b32 v50, v51
  v_max_f32 v50, v50, v51
  v_mfma_f32_16x16x32_bf16 v[64:67], a[100:103], v[104:107], v[64:67]
  ds_read_b128 v[84:87], v2 offset:4096
HOP4:
  s_cbranch_execz HOP8
  s_waitcnt vmcnt(14)
  s_barrier
  v_mfma_f32_16x16x32_bf16 v[64:67], a[112:115], v[100:103], v[64:67]
  ds_read_b64_tr_b16 a[32:33], v7 offset:16384
  s_add_u32 m0, s70, 0
  s_add_u32 s69, s61, 229376
  v_mfma_f32_16x16x32_bf16 v[60:63], a[112:115], v[92:95], v[60:63]
  ds_read_b64_tr_b16 a[34:35], v7 offset:18432
  buffer_load_dwordx4 v12, s[8:11], s69 offen offset:0 sc1 lds
  v_mov_b32 v51, v50
  v_mfma_f32_16x16x32_bf16 v[60:63], a[100:103], v[96:99], v[60:63]
  ds_read_b128 v[88:91], v2 offset:5120
  v_permlane32_swap_b32 v50, v51
  v_mfma_f32_16x16x32_bf16 v[68:71], a[104:107], v[96:99], v[68:71]
  ds_read_b64_tr_b16 a[36:37], v8 offset:16384
  v_max_f32 v50, v50, v51
  v_sub_f32 v48, v48, v50
  v_mfma_f32_16x16x32_bf16 v[68:71], a[116:119], v[92:95], v[68:71]
  ds_read_b64_tr_b16 a[38:39], v8 offset:18432
  buffer_load_dwordx4 v12, s[8:11], s69 offen offset:1024 sc1 lds
  v_sub_f32 v49, v49, v50
  v_mfma_f32_16x16x32_bf16 v[72:75], a[116:119], v[100:103], v[72:75]
  ds_read_b128 v[96:99], v2 offset:12288
  v_exp_f32 v48, v48
  v_mfma_f32_16x16x32_bf16 v[72:75], a[104:107], v[104:107], v[72:75]
  s_waitcnt lgkmcnt(7)
  ds_read_b64_tr_b16 a[40:41], v7 offset:20480
  v_mfma_f32_16x16x32_bf16 v[52:55], a[120:123], v[112:115], v[52:55]
  ds_read_b64_tr_b16 a[42:43], v7 offset:22528
  buffer_load_dwordx4 v12, s[8:11], s69 offen offset:2048 sc1 lds
  v_mfma_f32_16x16x32_bf16 v[52:55], a[132:135], v[108:111], v[52:55]
  ds_read_b128 v[92:95], v2 offset:13312
  v_exp_f32 v49, v49
  v_mfma_f32_16x16x32_bf16 v[56:59], a[132:135], v[76:79], v[56:59]
  ds_read_b64_tr_b16 a[44:45], v8 offset:20480
  v_add_f32 v50, v48, v49
  v_mov_b32 v51, v50
  v_mfma_f32_16x16x32_bf16 v[56:59], a[120:123], v[80:83], v[56:59]
  ds_read_b64_tr_b16 a[46:47], v8 offset:22528
  buffer_load_dwordx4 v12, s[8:11], s69 offen offset:3072 sc1 lds
  v_mfma_f32_16x16x32_bf16 v[64:67], a[124:127], v[80:83], v[64:67]
  ds_read_b128 v[100:103], v2 offset:6144
  v_permlane16_swap_b32 v50, v51
  v_mfma_f32_16x16x32_bf16 v[64:67], a[136:139], v[76:79], v[64:67]
  ds_read_b64_tr_b16 a[48:49], v7 offset:24576
  v_add_f32 v50, v50, v51
  v_mov_b32 v51, v50
  v_mfma_f32_16x16x32_bf16 v[60:63], a[136:139], v[108:111], v[60:63]
  ds_read_b64_tr_b16 a[50:51], v7 offset:26624
  v_permlane32_swap_b32 v50, v51
  v_mfma_f32_16x16x32_bf16 v[60:63], a[124:127], v[112:115], v[60:63]
  ds_read_b128 v[104:107], v2 offset:7168
  v_add_f32 v50, v50, v51
  v_mfma_f32_16x16x32_bf16 v[68:71], a[128:131], v[112:115], v[68:71]
  ds_read_b64_tr_b16 a[52:53], v8 offset:24576
  v_rcp_f32 v50, v50
  v_mfma_f32_16x16x32_bf16 v[68:71], a[140:143], v[108:111], v[68:71]
  ds_read_b64_tr_b16 a[54:55], v8 offset:26624
  v_mul_f32 v48, v48, v50
  v_mul_f32 v49, v49, v50
  v_mfma_f32_16x16x32_bf16 v[72:75], a[140:143], v[76:79], v[72:75]
  ds_read_b128 v[112:115], v2 offset:14336
  v_cvt_pk_bf16_f32 v48, v48, v48
  v_cvt_pk_bf16_f32 v49, v49, v49
  v_mfma_f32_16x16x32_bf16 v[72:75], a[128:131], v[80:83], v[72:75]
  s_waitcnt lgkmcnt(9)
  ds_read_b64_tr_b16 a[56:57], v7 offset:28672
  v_and_b32 v28, v24, v48
  v_mfma_f32_16x16x32_bf16 v[52:55], a[144:147], v[84:87], v[52:55]
  ds_read_b64_tr_b16 a[58:59], v7 offset:30720
  v_and_b32 v29, v25, v49
  v_and_b32 v30, v26, v48
  v_mfma_f32_16x16x32_bf16 v[52:55], a[156:159], v[88:91], v[52:55]
  ds_read_b128 v[108:111], v2 offset:15360
  v_and_b32 v31, v27, v49
  v_mfma_f32_16x16x32_bf16 v[56:59], a[156:159], v[92:95], v[56:59]
  ds_read_b64_tr_b16 a[60:61], v8 offset:28672
  v_mfma_f32_16x16x32_bf16 v[32:35], v[40:43], v[28:31], 0
  v_mfma_f32_16x16x32_bf16 v[36:39], v[44:47], v[28:31], 0
  v_mfma_f32_16x16x32_bf16 v[56:59], a[144:147], v[96:99], v[56:59]
  ds_read_b64_tr_b16 a[62:63], v8 offset:30720
  v_mfma_f32_16x16x32_bf16 v[64:67], a[148:151], v[96:99], v[64:67]
  ds_read_b128 v[76:79], v2 offset:32768
  v_mfma_f32_16x16x32_bf16 v[64:67], a[160:163], v[92:95], v[64:67]
  v_mfma_f32_16x16x32_bf16 v[60:63], a[160:163], v[88:91], v[60:63]
  s_nop 0
  v_cvt_pk_bf16_f32 v116, v32, v33
  v_cvt_pk_bf16_f32 v117, v34, v35
  v_cvt_pk_bf16_f32 v118, v36, v37
  v_mfma_f32_16x16x32_bf16 v[60:63], a[148:151], v[84:87], v[60:63]
  ds_read_b128 v[80:83], v2 offset:33792
  v_cvt_pk_bf16_f32 v119, v38, v39
  v_mfma_f32_16x16x32_bf16 v[68:71], a[152:155], v[84:87], v[68:71]
  buffer_store_dwordx4 v[116:119], v1, s[8:11], s73 offen sc1
  v_mfma_f32_16x16x32_bf16 v[68:71], a[164:167], v[88:91], v[68:71]
  s_add_u32 s73, s73, 65536
  v_mfma_f32_16x16x32_bf16 v[72:75], a[164:167], v[92:95], v[72:75]
  ds_read_b128 v[84:87], v2 offset:40960
  v_mfma_f32_16x16x32_bf16 v[72:75], a[152:155], v[96:99], v[72:75]
  s_waitcnt lgkmcnt(5)
  s_waitcnt vmcnt(5)
  s_cmp_lg_u32 s44, 0
  s_cbranch_scc1 PL5_adaLN_cond__sliding_local_dilated__swiglu_ffn__prompt_kernelx
  v_subrev_u32 v13, s46, v13
  v_subrev_u32 v13, 1, v13
  v_cmp_lt_u32 vcc, 3, v13
  s_nop 4
  s_cbranch_vccz PL5_adaLN_cond__sliding_local_dilated__swiglu_ffn__prompt_kernelx
  s_mov_b32 s57, 60000
PL5_adaLN_cond__sliding_local_dilated__swiglu_ffn__prompt_kernel:
  buffer_load_dword v13, v14, s[8:11], s77 offen sc1
  s_sub_u32 s57, s57, 1
  s_cmp_eq_u32 s57, 0
  s_waitcnt vmcnt(0)
  s_cbranch_scc1 PL5_adaLN_cond__sliding_local_dilated__swiglu_ffn__prompt_kernelx
  v_subrev_u32 v13, s46, v13
  v_subrev_u32 v13, 1, v13
  v_cmp_lt_u32 vcc, 3, v13
  s_nop 4
  s_cbranch_vccnz PL5_adaLN_cond__sliding_local_dilated__swiglu_ffn__prompt_kernel
PL5_adaLN_cond__sliding_local_dilated__swiglu_ffn__prompt_kernelx:
  s_waitcnt vmcnt(10) lgkmcnt(3)
  s_barrier
  v_mfma_f32_16x16x32_bf16 v[52:55], a[168:171], v[100:103], v[52:55]
  ds_read_b64_tr_b16 a[64:65], v4 offset:32768
  s_add_u32 m0, s45, 16384
  s_add_u32 s68, s67, 5
  s_and_b32 s68, s68, 7
  s_mul_i32 s68, s68, 262144
  v_mfma_f32_16x16x32_bf16 v[52:55], a[180:183], v[104:107], v[52:55]
  ds_read_b128 v[88:91], v2 offset:41984
  ds_read_b64_tr_b16 a[66:67], v4 offset:34816
  v_mfma_f32_16x16x32_bf16 v[56:59], a[180:183], v[108:111], v[56:59]
  ds_read_b64_tr_b16 a[68:69], v5 offset:32768
  buffer_load_dwordx4 v10, s[16:19], s68 offen lds
  v_mfma_f32_16x16x32_bf16 v[56:59], a[168:171], v[112:115], v[56:59]
  ds_read_b64_tr_b16 a[70:71], v5 offset:34816
  ds_read_b64_tr_b16 a[72:73], v4 offset:36864
  v_mfma_f32_16x16x32_bf16 v[64:67], a[172:175], v[112:115], v[64:67]
  ds_read_b128 v[92:95], v2 offset:34816
  ds_read_b64_tr_b16 a[74:75], v4 offset:38912
  s_add_u32 m0, s45, 20480
  s_add_u32 s68, s68, 65536
  v_mfma_f32_16x16x32_bf16 v[64:67], a[184:187], v[108:111], v[64:67]
  ds_read_b64_tr_b16 a[76:77], v5 offset:36864
  buffer_load_dwordx4 v10, s[16:19], s68 offen lds
  v_mfma_f32_16x16x32_bf16 v[60:63], a[184:187], v[104:107], v[60:63]
  ds_read_b64_tr_b16 a[78:79], v5 offset:38912
  ds_read_b64_tr_b16 a[80:81], v4 offset:40960
  v_mfma_f32_16x16x32_bf16 v[60:63], a[172:175], v[100:103], v[60:63]
  ds_read_b128 v[96:99], v2 offset:35840
  ds_read_b64_tr_b16 a[82:83], v4 offset:43008
  s_add_u32 m0, s45, 24576
  s_add_u32 s68, s68, 65536
  v_mfma_f32_16x16x32_bf16 v[68:71], a[176:179], v[100:103], v[68:71]
  ds_read_b64_tr_b16 a[84:85], v5 offset:40960
  buffer_load_dwordx4 v10, s[16:19], s68 offen lds
  v_mfma_f32_16x16x32_bf16 v[68:71], a[188:191], v[104:107], v[68:71]
  ds_read_b64_tr_b16 a[86:87], v5 offset:43008
  ds_read_b64_tr_b16 a[88:89], v4 offset:45056
  v_mfma_f32_16x16x32_bf16 v[72:75], a[188:191], v[108:111], v[72:75]
  ds_read_b128 v[100:103], v2 offset:43008
  ds_read_b64_tr_b16 a[90:91], v4 offset:47104
  s_add_u32 m0, s45, 28672
  s_add_u32 s68, s68, 65536
  v_mfma_f32_16x16x32_bf16 v[72:75], a[176:179], v[112:115], v[72:75]
  s_waitcnt lgkmcnt(15)
  ds_read_b64_tr_b16 a[92:93], v5 offset:45056
  buffer_load_dwordx4 v10, s[16:19], s68 offen lds
  v_mfma_f32_16x16x32_bf16 v[52:55], a[192:195], v[76:79], v[52:55]
  ds_read_b64_tr_b16 a[94:95], v5 offset:47104
  ds_read_b64_tr_b16 a[96:97], v4 offset:49152
  v_mfma_f32_16x16x32_bf16 v[52:55], a[204:207], v[80:83], v[52:55]
  ds_read_b128 v[104:107], v2 offset:44032
  ds_read_b64_tr_b16 a[98:99], v4 offset:51200
  s_add_u32 m0, s45, 81920
  s_add_u32 s68, s67, 6
  s_and_b32 s68, s68, 7
  s_mul_i32 s68, s68, 262144
  v_mfma_f32_16x16x32_bf16 v[56:59], a[204:207], v[88:91], v[56:59]
  ds_read_b64_tr_b16 a[100:101], v5 offset:49152
  buffer_load_dwordx4 v10, s[16:19], s68 offen lds
  v_mfma_f32_16x16x32_bf16 v[56:59], a[192:195], v[84:87], v[56:59]
  ds_read_b64_tr_b16 a[102:103], v5 offset:51200
  ds_read_b64_tr_b16 a[104:105], v4 offset:53248
  v_mfma_f32_16x16x32_bf16 v[64:67], a[196:199], v[84:87], v[64:67]
  ds_read_b128 v[108:111], v2 offset:36864
  ds_read_b64_tr_b16 a[106:107], v4 offset:55296
  s_add_u32 m0, s45, 86016
  s_add_u32 s68, s68, 65536
  v_mfma_f32_16x16x32_bf16 v[64:67], a[208:211], v[88:91], v[64:67]
  ds_read_b64_tr_b16 a[108:109], v5 offset:53248
  buffer_load_dwordx4 v10, s[16:19], s68 offen lds
  v_mfma_f32_16x16x32_bf16 v[60:63], a[208:211], v[80:83], v[60:63]
  ds_read_b64_tr_b16 a[110:111], v5 offset:55296
  ds_read_b64_tr_b16 a[112:113], v4 offset:57344
  v_mfma_f32_16x16x32_bf16 v[60:63], a[196:199], v[76:79], v[60:63]
  ds_read_b128 v[112:115], v2 offset:37888
  ds_read_b64_tr_b16 a[114:115], v4 offset:59392
  s_add_u32 m0, s45, 90112
  s_add_u32 s68, s68, 65536
  v_mfma_f32_16x16x32_bf16 v[68:71], a[200:203], v[76:79], v[68:71]
  ds_read_b64_tr_b16 a[116:117], v5 offset:57344
  buffer_load_dwordx4 v10, s[16:19], s68 offen lds
  v_mfma_f32_16x16x32_bf16 v[68:71], a[212:215], v[80:83], v[68:71]
  ds_read_b64_tr_b16 a[118:119], v5 offset:59392
  ds_read_b64_tr_b16 a[120:121], v4 offset:61440
  v_mfma_f32_16x16x32_bf16 v[72:75], a[212:215], v[88:91], v[72:75]
  ds_read_b128 v[76:79], v2 offset:45056
  ds_read_b64_tr_b16 a[122:123], v4 offset:63488
  s_add_u32 m0, s45, 94208
  s_add_u32 s68, s68, 65536
  v_mfma_f32_16x16x32_bf16 v[72:75], a[200:203], v[84:87], v[72:75]
  s_waitcnt lgkmcnt(15)
  ds_read_b64_tr_b16 a[124:125], v5 offset:61440
  buffer_load_dwordx4 v10, s[16:19], s68 offen lds
  v_mfma_f32_16x16x32_bf16 v[52:55], a[216:219], v[92:95], v[52:55]
  ds_read_b64_tr_b16 a[126:127], v5 offset:63488
  v_mfma_f32_16x16x32_bf16 v[52:55], a[228:231], v[96:99], v[52:55]
  ds_read_b128 v[80:83], v2 offset:46080
  v_mfma_f32_16x16x32_bf16 v[56:59], a[228:231], v[104:107], v[56:59]
  v_mfma_f32_16x16x32_bf16 v[56:59], a[216:219], v[100:103], v[56:59]
  v_mfma_f32_16x16x32_bf16 v[64:67], a[220:223], v[100:103], v[64:67]
  ds_read_b128 v[88:91], v2 offset:38912
  v_mfma_f32_16x16x32_bf16 v[64:67], a[232:235], v[104:107], v[64:67]
  v_lshlrev_b32 v21, 7, v0
  v_add_u32 v21, 720896, v21
  v_mfma_f32_16x16x32_bf16 v[60:63], a[232:235], v[96:99], v[60:63]
  s_waitcnt vmcnt(4) lgkmcnt(2)
  s_barrier
  v_add_u32 v15, s46, v0
  v_add_u32 v15, 2, v15
  s_mov_b64 exec, 1
  buffer_store_dword v15, v0, s[8:11], s74 offen offset:0 sc1
  s_mov_b64 exec, -1
  v_mfma_f32_16x16x32_bf16 v[60:63], a[220:223], v[92:95], v[60:63]
  ds_read_b128 v[84:87], v2 offset:39936
  ds_read_b64_tr_b16 a[128:129], v7 offset:49152
  s_add_u32 m0, s45, 65536
  s_add_u32 s68, s67, 7
  s_and_b32 s68, s68, 7
  s_mul_i32 s68, s68, 262144
  v_mfma_f32_16x16x32_bf16 v[68:71], a[224:227], v[92:95], v[68:71]
  ds_read_b64_tr_b16 a[130:131], v7 offset:51200
  buffer_load_dwordx4 v10, s[16:19], s68 offen lds
  v_mfma_f32_16x16x32_bf16 v[68:71], a[236:239], v[96:99], v[68:71]
  ds_read_b64_tr_b16 a[132:133], v8 offset:49152
  v_mfma_f32_16x16x32_bf16 v[72:75], a[236:239], v[104:107], v[72:75]
  ds_read_b128 v[92:95], v2 offset:47104
  ds_read_b64_tr_b16 a[134:135], v8 offset:51200
  ds_read_b64_tr_b16 a[136:137], v7 offset:53248
  v_mfma_f32_16x16x32_bf16 v[72:75], a[224:227], v[100:103], v[72:75]
  s_waitcnt lgkmcnt(8)
  ds_read_b64_tr_b16 a[138:139], v7 offset:55296
  s_add_u32 m0, s45, 69632
  s_add_u32 s68, s68, 65536
  v_mfma_f32_16x16x32_bf16 v[52:55], a[240:243], v[108:111], v[52:55]
  ds_read_b64_tr_b16 a[140:141], v8 offset:53248
  buffer_load_dwordx4 v10, s[16:19], s68 offen lds
  s_add_u32 m0, s45, 73728
  s_add_u32 s68, s68, 65536
  v_mfma_f32_16x16x32_bf16 v[52:55], v[124:127], v[112:115], v[52:55]
  ds_read_b128 v[96:99], v2 offset:48128
  ds_read_b64_tr_b16 a[142:143], v8 offset:55296
  ds_read_b64_tr_b16 a[144:145], v7 offset:57344
  v_mfma_f32_16x16x32_bf16 v[56:59], v[124:127], v[80:83], v[56:59]
  ds_read_b64_tr_b16 a[146:147], v7 offset:59392
  buffer_load_dwordx4 v10, s[16:19], s68 offen lds
  v_mfma_f32_16x16x32_bf16 v[56:59], a[240:243], v[76:79], v[56:59]
  ds_read_b64_tr_b16 a[148:149], v8 offset:57344
  s_add_u32 m0, s45, 77824
  s_add_u32 s68, s68, 65536
  v_mfma_f32_16x16x32_bf16 v[64:67], a[244:247], v[76:79], v[64:67]
  ds_read_b128 v[104:107], v1 offset:0
  ds_read_b64_tr_b16 a[150:151], v8 offset:59392
  ds_read_b64_tr_b16 a[152:153], v7 offset:61440
  v_mfma_f32_16x16x32_bf16 v[64:67], v[128:131], v[80:83], v[64:67]
  ds_read_b64_tr_b16 a[154:155], v7 offset:63488
  buffer_load_dwordx4 v10, s[16:19], s68 offen lds
  v_mfma_f32_16x16x32_bf16 v[60:63], v[128:131], v[112:115], v[60:63]
  ds_read_b64_tr_b16 a[156:157], v8 offset:61440
  s_add_u32 m0, s70, 32768
  s_add_u32 s69, s62, 0
  v_mfma_f32_16x16x32_bf16 v[60:63], a[244:247], v[108:111], v[60:63]
  ds_read_b128 v[100:103], v1 offset:1024
  ds_read_b64_tr_b16 a[158:159], v8 offset:63488
  ds_read_b64_tr_b16 a[160:161], v4 offset:16384
  v_mfma_f32_16x16x32_bf16 v[68:71], a[248:251], v[108:111], v[68:71]
  ds_read_b64_tr_b16 a[162:163], v4 offset:18432
  buffer_load_dwordx4 v9, s[8:11], s69 offen offset:0 sc1 lds
  v_mfma_f32_16x16x32_bf16 v[68:71], v[132:135], v[112:115], v[68:71]
  ds_read_b64_tr_b16 a[164:165], v5 offset:16384
  v_mfma_f32_16x16x32_bf16 v[72:75], v[132:135], v[80:83], v[72:75]
  ds_read_b128 v[108:111], v1 offset:8192
  ds_read_b64_tr_b16 a[166:167], v5 offset:18432
  ds_read_b64_tr_b16 a[168:169], v4 offset:20480
  s_lshl_b32 s57, s44, 28
  buffer_load_dwordx4 v[116:119], v21, s[8:11], s57 offen sc1
  v_mfma_f32_16x16x32_bf16 v[72:75], a[248:251], v[76:79], v[72:75]
  s_waitcnt lgkmcnt(15)
  ds_read_b64_tr_b16 a[170:171], v4 offset:22528
  v_mfma_f32_16x16x32_bf16 v[52:55], v[136:139], v[88:91], v[52:55]
  ds_read_b64_tr_b16 a[172:173], v5 offset:20480
  buffer_load_dwordx4 v9, s[8:11], s69 offen offset:1024 sc1 lds
  v_mfma_f32_16x16x32_bf16 v[52:55], v[148:151], v[84:87], v[52:55]
  ds_read_b128 v[112:115], v1 offset:9216
  ds_read_b64_tr_b16 a[174:175], v5 offset:22528
  ds_read_b64_tr_b16 a[176:177], v4 offset:24576
  v_mfma_f32_16x16x32_bf16 v[56:59], v[148:151], v[96:99], v[56:59]
  ds_read_b64_tr_b16 a[178:179], v4 offset:26624
  buffer_load_dwordx4 v9, s[8:11], s69 offen offset:2048 sc1 lds
  v_mfma_f32_16x16x32_bf16 v[56:59], v[136:139], v[92:95], v[56:59]
  ds_read_b64_tr_b16 a[180:181], v5 offset:24576
  v_mfma_f32_16x16x32_bf16 v[64:67], v[140:143], v[92:95], v[64:67]
  ds_read_b128 v[80:83], v1 offset:2048
  ds_read_b64_tr_b16 a[182:183], v5 offset:26624
  ds_read_b64_tr_b16 a[184:185], v4 offset:28672
  v_mfma_f32_16x16x32_bf16 v[64:67], v[152:155], v[96:99], v[64:67]
  ds_read_b64_tr_b16 a[186:187], v4 offset:30720
  buffer_load_dwordx4 v9, s[8:11], s69 offen offset:3072 sc1 lds
  v_mfma_f32_16x16x32_bf16 v[60:63], v[152:155], v[84:87], v[60:63]
  ds_read_b64_tr_b16 a[188:189], v5 offset:28672
  s_add_u32 m0, s70, 49152
  s_add_u32 s69, s63, 0
  v_mfma_f32_16x16x32_bf16 v[60:63], v[140:143], v[88:91], v[60:63]
  ds_read_b128 v[76:79], v1 offset:3072
  ds_read_b64_tr_b16 a[190:191], v5 offset:30720
  v_mfma_f32_16x16x32_bf16 v[68:71], v[144:147], v[88:91], v[68:71]
  buffer_load_dwordx4 v9, s[8:11], s69 offen offset:0 sc1 lds
  v_mfma_f32_16x16x32_bf16 v[68:71], v[156:159], v[84:87], v[68:71]
  v_mfma_f32_16x16x32_bf16 v[72:75], v[156:159], v[96:99], v[72:75]
  ds_read_b128 v[88:91], v1 offset:10240
  v_mfma_f32_16x16x32_bf16 v[72:75], v[144:147], v[92:95], v[72:75]
  s_waitcnt lgkmcnt(12)
  buffer_load_dwordx4 v9, s[8:11], s69 offen offset:1024 sc1 lds
  v_mfma_f32_16x16x32_bf16 v[52:55], v[160:163], v[104:107], v[52:55]
  s_waitcnt vmcnt(7) lgkmcnt(15)
  s_barrier
  v_mfma_f32_16x16x32_bf16 v[52:55], v[172:175], v[100:103], v[52:55]
  ds_read_b128 v[84:87], v1 offset:11264
  ds_read_b64_tr_b16 a[192:193], v7 offset:16384
  v_mfma_f32_16x16x32_bf16 v[56:59], v[172:175], v[112:115], v[56:59]
  ds_read_b64_tr_b16 a[194:195], v7 offset:18432
  buffer_load_dwordx4 v9, s[8:11], s69 offen offset:2048 sc1 lds
  v_mfma_f32_16x16x32_bf16 v[56:59], v[160:163], v[108:111], v[56:59]
  ds_read_b64_tr_b16 a[196:197], v8 offset:16384
  v_mfma_f32_16x16x32_bf16 v[64:67], v[164:167], v[108:111], v[64:67]
  ds_read_b128 v[96:99], v1 offset:4096
  ds_read_b64_tr_b16 a[198:199], v8 offset:18432
  ds_read_b64_tr_b16 a[200:201], v7 offset:20480
  v_mfma_f32_16x16x32_bf16 v[64:67], v[176:179], v[112:115], v[64:67]
  ds_read_b64_tr_b16 a[202:203], v7 offset:22528
  buffer_load_dwordx4 v9, s[8:11], s69 offen offset:3072 sc1 lds
  v_mfma_f32_16x16x32_bf16 v[60:63], v[176:179], v[100:103], v[60:63]
  ds_read_b64_tr_b16 a[204:205], v8 offset:20480
  s_add_u32 m0, s70, 98304
  s_add_u32 s69, s64, 0
  v_mfma_f32_16x16x32_bf16 v[60:63], v[164:167], v[104:107], v[60:63]
  ds_read_b128 v[92:95], v1 offset:5120
  ds_read_b64_tr_b16 a[206:207], v8 offset:22528
  ds_read_b64_tr_b16 a[208:209], v7 offset:24576
  v_mfma_f32_16x16x32_bf16 v[68:71], v[168:171], v[104:107], v[68:71]
  ds_read_b64_tr_b16 a[210:211], v7 offset:26624
  buffer_load_dwordx4 v9, s[8:11], s69 offen offset:0 sc1 lds
  v_mfma_f32_16x16x32_bf16 v[68:71], v[180:183], v[100:103], v[68:71]
  ds_read_b64_tr_b16 a[212:213], v8 offset:24576
  v_mfma_f32_16x16x32_bf16 v[72:75], v[180:183], v[112:115], v[72:75]
  ds_read_b128 v[104:107], v1 offset:12288
  ds_read_b64_tr_b16 a[214:215], v8 offset:26624
  ds_read_b64_tr_b16 a[216:217], v7 offset:28672
  v_mfma_f32_16x16x32_bf16 v[72:75], v[168:171], v[108:111], v[72:75]
  s_waitcnt lgkmcnt(15)
  ds_read_b64_tr_b16 a[218:219], v7 offset:30720
  v_mfma_f32_16x16x32_bf16 v[52:55], v[184:187], v[80:83], v[52:55]
  ds_read_b64_tr_b16 a[220:221], v8 offset:28672
  buffer_load_dwordx4 v9, s[8:11], s69 offen offset:1024 sc1 lds
  v_mfma_f32_16x16x32_bf16 v[52:55], v[196:199], v[76:79], v[52:55]
  ds_read_b128 v[100:103], v1 offset:13312
  ds_read_b64_tr_b16 a[222:223], v8 offset:30720
  ds_read_b64_tr_b16 a[224:225], v7 offset:0
  v_mfma_f32_16x16x32_bf16 v[56:59], v[196:199], v[84:87], v[56:59]
  ds_read_b64_tr_b16 a[226:227], v7 offset:2048
  buffer_load_dwordx4 v9, s[8:11], s69 offen offset:2048 sc1 lds
  v_mfma_f32_16x16x32_bf16 v[56:59], v[184:187], v[88:91], v[56:59]
  ds_read_b64_tr_b16 a[228:229], v8 offset:0
  v_mfma_f32_16x16x32_bf16 v[64:67], v[188:191], v[88:91], v[64:67]
  ds_read_b128 v[112:115], v1 offset:6144
  ds_read_b64_tr_b16 a[230:231], v8 offset:2048
  ds_read_b64_tr_b16 a[232:233], v7 offset:4096
  v_mfma_f32_16x16x32_bf16 v[64:67], v[200:203], v[84:87], v[64:67]
  ds_read_b64_tr_b16 a[234:235], v7 offset:6144
  buffer_load_dwordx4 v9, s[8:11], s69 offen offset:3072 sc1 lds
  v_mfma_f32_16x16x32_bf16 v[60:63], v[200:203], v[76:79], v[60:63]
  ds_read_b64_tr_b16 a[236:237], v8 offset:4096
  s_add_u32 m0, s70, 114688
  s_add_u32 s69, s65, 0
  v_mfma_f32_16x16x32_bf16 v[60:63], v[188:191], v[80:83], v[60:63]
  ds_read_b128 v[108:111], v1 offset:7168
  ds_read_b64_tr_b16 a[238:239], v8 offset:6144
  ds_read_b64_tr_b16 a[240:241], v7 offset:8192
  v_mfma_f32_16x16x32_bf16 v[68:71], v[192:195], v[80:83], v[68:71]
  ds_read_b64_tr_b16 a[242:243], v7 offset:10240
  buffer_load_dwordx4 v9, s[8:11], s69 offen offset:0 sc1 lds
  v_mfma_f32_16x16x32_bf16 v[68:71], v[204:207], v[76:79], v[68:71]
  ds_read_b64_tr_b16 a[244:245], v8 offset:8192
  v_mfma_f32_16x16x32_bf16 v[72:75], v[204:207], v[84:87], v[72:75]
  ds_read_b128 v[80:83], v1 offset:14336
  ds_read_b64_tr_b16 a[246:247], v8 offset:10240
  ds_read_b64_tr_b16 a[248:249], v7 offset:12288
  v_mfma_f32_16x16x32_bf16 v[72:75], v[192:195], v[88:91], v[72:75]
  s_waitcnt lgkmcnt(15)
  ds_read_b64_tr_b16 a[250:251], v7 offset:14336
  v_mfma_f32_16x16x32_bf16 v[52:55], v[208:211], v[96:99], v[52:55]
  ds_read_b64_tr_b16 v[124:125], v8 offset:12288
  buffer_load_dwordx4 v9, s[8:11], s69 offen offset:1024 sc1 lds
  v_mfma_f32_16x16x32_bf16 v[52:55], v[220:223], v[92:95], v[52:55]
  ds_read_b128 v[76:79], v1 offset:15360
  ds_read_b64_tr_b16 v[126:127], v8 offset:14336
  v_mfma_f32_16x16x32_bf16 v[56:59], v[220:223], v[100:103], v[56:59]
  buffer_load_dwordx4 v9, s[8:11], s69 offen offset:2048 sc1 lds
  v_mfma_f32_16x16x32_bf16 v[56:59], v[208:211], v[104:107], v[56:59]
  v_mfma_f32_16x16x32_bf16 v[64:67], v[212:215], v[104:107], v[64:67]
  v_mfma_f32_16x16x32_bf16 v[64:67], v[224:227], v[100:103], v[64:67]
  buffer_load_dwordx4 v9, s[8:11], s69 offen offset:3072 sc1 lds
  v_mfma_f32_16x16x32_bf16 v[60:63], v[224:227], v[92:95], v[60:63]
  v_mfma_f32_16x16x32_bf16 v[60:63], v[212:215], v[96:99], v[60:63]
  s_waitcnt vmcnt(15)
  s_cmp_lg_u32 s44, 0
  s_cbranch_scc1 PL6_adaLN_cond__sliding_local_dilated__swiglu_ffn__prompt_kernelx
  v_bitop3_b32 v116, v116, v117, s46 bitop3:0x7e
  v_bitop3_b32 v118, v118, v119, s46 bitop3:0x7e
  v_or_b32 v116, v116, v118
  v_cmp_ne_u32 vcc, 0, v116
  s_nop 4
  s_cbranch_vccz PL6_adaLN_cond__sliding_local_dilated__swiglu_ffn__prompt_kernelx
  s_mov_b32 s57, 60000
PL6_adaLN_cond__sliding_local_dilated__swiglu_ffn__prompt_kernel:
  buffer_load_dwordx4 v[116:119], v21, s[8:11], 0 offen sc1
  s_sub_u32 s57, s57, 1
  s_cmp_eq_u32 s57, 0
  s_waitcnt vmcnt(0)
  s_cbranch_scc1 PL6_adaLN_cond__sliding_local_dilated__swiglu_ffn__prompt_kernelx
  v_bitop3_b32 v116, v116, v117, s46 bitop3:0x7e
  v_bitop3_b32 v118, v118, v119, s46 bitop3:0x7e
  v_or_b32 v116, v116, v118
  v_cmp_ne_u32 vcc, 0, v116
  s_nop 4
  s_cbranch_vccnz PL6_adaLN_cond__sliding_local_dilated__swiglu_ffn__prompt_kernel
PL6_adaLN_cond__sliding_local_dilated__swiglu_ffn__prompt_kernelx:
  s_waitcnt vmcnt(8) lgkmcnt(0)
  s_barrier
  v_mfma_f32_16x16x32_bf16 v[68:71], v[216:219], v[96:99], v[68:71]
  ds_read_b128 v[84:87], v22 offset:32768
  s_add_u32 m0, s70, 16384
  s_add_u32 s69, s62, 65536
  v_mfma_f32_16x16x32_bf16 v[68:71], v[228:231], v[92:95], v[68:71]
  v_and_b32 v21, 31, v0
  v_lshlrev_b32 v21, 2, v21
  v_lshrrev_b32 v181, 5, v0
  v_lshl_add_u32 v21, v181, 13, v21
  v_mfma_f32_16x16x32_bf16 v[72:75], v[228:231], v[100:103], v[72:75]
  ds_read_b128 v[88:91], v22 offset:33792
  buffer_load_dwordx4 v9, s[8:11], s69 offen offset:0 sc1 lds
  v_mfma_f32_16x16x32_bf16 v[72:75], v[216:219], v[104:107], v[72:75]
  s_waitcnt lgkmcnt(3)
  v_mfma_f32_16x16x32_bf16 v[52:55], v[232:235], v[112:115], v[52:55]
  ds_read_b128 v[96:99], v22 offset:34816
  v_mfma_f32_16x16x32_bf16 v[52:55], v[244:247], v[108:111], v[52:55]
  buffer_load_dwordx4 v9, s[8:11], s69 offen offset:1024 sc1 lds
  v_mfma_f32_16x16x32_bf16 v[56:59], v[244:247], v[76:79], v[56:59]
  ds_read_b128 v[92:95], v22 offset:35840
  v_mfma_f32_16x16x32_bf16 v[56:59], v[232:235], v[80:83], v[56:59]
  buffer_load_dwordx4 v9, s[8:11], s69 offen offset:2048 sc1 lds
  v_mfma_f32_16x16x32_bf16 v[64:67], v[236:239], v[80:83], v[64:67]
  ds_read_b128 v[100:103], v22 offset:36864
  v_mfma_f32_16x16x32_bf16 v[64:67], v[248:251], v[76:79], v[64:67]
  v_mfma_f32_16x16x32_bf16 v[60:63], v[248:251], v[108:111], v[60:63]
  ds_read_b128 v[104:107], v22 offset:37888
  v_mfma_f32_16x16x32_bf16 v[60:63], v[236:239], v[112:115], v[60:63]
  buffer_load_dwordx4 v9, s[8:11], s69 offen offset:3072 sc1 lds
  s_add_u32 s56, s76, 8192
  v_mfma_f32_16x16x32_bf16 v[68:71], v[240:243], v[112:115], v[68:71]
  ds_read_b128 v[112:115], v22 offset:38912
  v_mfma_f32_16x16x32_bf16 v[68:71], v[252:255], v[108:111], v[68:71]
  buffer_load_dword v160, v21, s[8:11], s56 offen sc1
  s_add_u32 s56, s76, 32768
  v_mfma_f32_16x16x32_bf16 v[72:75], v[252:255], v[76:79], v[72:75]
  ds_read_b128 v[108:111], v22 offset:39936
  v_mfma_f32_16x16x32_bf16 v[72:75], v[240:243], v[80:83], v[72:75]
  s_waitcnt lgkmcnt(4)
  buffer_load_dword v161, v21, s[8:11], s56 offen sc1
  s_add_u32 s56, s76, 57344
  v_mfma_f32_16x16x32_bf16 v[128:131], a[0:3], v[84:87], 0
  ds_read_b128 v[76:79], v22 offset:49152
  buffer_load_dword v162, v21, s[8:11], s56 offen sc1
  v_mfma_f32_16x16x32_bf16 v[128:131], a[8:11], v[88:91], v[128:131]
  s_add_u32 s56, s76, 81920
  v_mfma_f32_16x16x32_bf16 v[132:135], a[12:15], v[88:91], 0
  ds_read_b128 v[80:83], v22 offset:50176
  s_lshr_b32 s79, s2, 6
  s_lshl_b32 s79, s79, 2
  s_add_u32 s79, s79, s44
  s_lshl_b32 s79, s79, 8
  buffer_load_dword v163, v21, s[8:11], s56 offen sc1
  s_add_u32 s56, s47, 41943040
  v_mfma_f32_16x16x32_bf16 v[132:135], a[4:7], v[84:87], v[132:135]
  buffer_load_dwordx4 v[144:147], v1, s[8:11], s56 offen sc1
  s_add_u32 s56, s47, 42008576
  v_cvt_pk_bf16_f32 v52, v52, v53
  v_cvt_pk_bf16_f32 v53, v54, v55
  ds_write_b64 v18, v[52:53] offset:6144
  v_cvt_pk_bf16_f32 v60, v60, v61
  v_cvt_pk_bf16_f32 v61, v62, v63
  v_mfma_f32_16x16x32_bf16 v[128:131], a[16:19], v[96:99], v[128:131]
  ds_read_b128 v[88:91], v22 offset:51200
  v_cvt_pk_bf16_f32 v62, v68, v69
  v_cvt_pk_bf16_f32 v63, v70, v71
  ds_write_b128 v17, v[60:63] offset:7168
  v_mfma_f32_16x16x32_bf16 v[128:131], a[24:27], v[92:95], v[128:131]
  buffer_load_dwordx4 v[148:151], v1, s[8:11], s56 offen sc1
  s_add_u32 s56, s47, 42074112
  v_cvt_pk_bf16_f32 v56, v56, v57
  v_cvt_pk_bf16_f32 v57, v58, v59
  ds_write_b64 v18, v[56:57] offset:12288
  v_cvt_pk_bf16_f32 v64, v64, v65
  v_cvt_pk_bf16_f32 v65, v66, v67
  v_mfma_f32_16x16x32_bf16 v[132:135], a[28:31], v[92:95], v[132:135]
  ds_read_b128 v[84:87], v22 offset:52224
  v_cvt_pk_bf16_f32 v66, v72, v73
  v_cvt_pk_bf16_f32 v67, v74, v75
  ds_write_b128 v17, v[64:67] offset:13312
  v_mfma_f32_16x16x32_bf16 v[132:135], a[20:23], v[96:99], v[132:135]
  s_waitcnt lgkmcnt(8)
  buffer_load_dwordx4 v[152:155], v1, s[8:11], s56 offen sc1
  s_add_u32 s56, s47, 42139648
  s_bitcmp1_b32 s44, 0
  s_mov_b32 s52, 6144
  s_cselect_b32 s52, 12288, s52
  s_mov_b32 s53, 0
  s_cselect_b32 s53, 6144, s53
  v_add_u32 v116, s52, v19
  v_add_u32 v117, s53, v19
  v_mfma_f32_16x16x32_bf16 v[128:131], a[32:35], v[100:103], v[128:131]
  ds_read_b128 v[92:95], v22 offset:53248
  v_add_u32 v118, s52, v20
  v_add_u32 v119, s53, v20
  s_waitcnt vmcnt(11) lgkmcnt(1)
  s_barrier
  v_mfma_f32_16x16x32_bf16 v[128:131], a[40:43], v[104:107], v[128:131]
  buffer_load_dwordx4 v[156:159], v1, s[8:11], s56 offen sc1
  s_add_u32 m0, s70, 81920
  s_add_u32 s69, s63, 65536
  ds_read_b128 v[52:55], v116
  ds_read_b128 v[56:59], v117 offset:1024
  v_mfma_f32_16x16x32_bf16 v[132:135], a[44:47], v[104:107], v[132:135]
  ds_read_b128 v[96:99], v22 offset:54272
  ds_read_b128 v[60:63], v116 offset:1024
  ds_read_b64_tr_b16 v[64:65], v119 offset:2048
  ds_read_b64_tr_b16 v[66:67], v118 offset:2048
  v_mfma_f32_16x16x32_bf16 v[132:135], a[36:39], v[100:103], v[132:135]
  buffer_load_dwordx4 v9, s[8:11], s69 offen offset:0 sc1 lds
  ds_read_b64_tr_b16 v[68:69], v119 offset:2056
  ds_read_b64_tr_b16 v[70:71], v118 offset:2056
  v_mfma_f32_16x16x32_bf16 v[128:131], a[48:51], v[112:115], v[128:131]
  ds_read_b128 v[104:107], v22 offset:55296
  s_lshl_b32 s57, s44, 28
  s_add_u32 s57, s57, s77
  buffer_load_dword v13, v14, s[8:11], s57 offen sc1
  v_mfma_f32_16x16x32_bf16 v[128:131], a[56:59], v[108:111], v[128:131]
  v_mfma_f32_16x16x32_bf16 v[132:135], a[60:63], v[108:111], v[132:135]
  ds_read_b128 v[100:103], v22 offset:56320
HOP5:
  s_cbranch_execz HOP9
  v_mfma_f32_16x16x32_bf16 v[132:135], a[52:55], v[112:115], v[132:135]
  s_waitcnt lgkmcnt(12)
  buffer_load_dwordx4 v9, s[8:11], s69 offen offset:1024 sc1 lds
  v_mfma_f32_16x16x32_bf16 v[128:131], a[64:67], v[76:79], v[128:131]
  ds_read_b128 v[108:111], v23 offset:32768
  s_waitcnt lgkmcnt(3)
  v_mfma_f32_16x16x32_bf16 v[116:119], v[56:59], v[52:55], 0
  v_mfma_f32_16x16x32_bf16 v[120:123], v[60:63], v[52:55], 0
  v_mfma_f32_16x16x32_bf16 v[128:131], a[72:75], v[80:83], v[128:131]
  buffer_load_dwordx4 v9, s[8:11], s69 offen offset:2048 sc1 lds
  v_mfma_f32_16x16x32_bf16 v[132:135], a[76:79], v[80:83], v[132:135]
  ds_read_b128 v[112:115], v23 offset:33792
  v_mfma_f32_16x16x32_bf16 v[132:135], a[68:71], v[76:79], v[132:135]
  v_mfma_f32_16x16x32_bf16 v[128:131], a[80:83], v[88:91], v[128:131]
  ds_read_b128 v[80:83], v23 offset:34816
  s_nop 0
  v_cndmask_b32 v72, v116, v120, s[80:81]
  v_cndmask_b32 v73, v117, v121, s[82:83]
  v_cndmask_b32 v74, v118, v122, s[84:85]
  v_cndmask_b32 v75, v119, v123, s[86:87]
  v_cndmask_b32 v72, v72, v73, s[88:89]
  v_cndmask_b32 v73, v74, v75, s[88:89]
  v_mfma_f32_16x16x32_bf16 v[128:131], a[88:91], v[84:87], v[128:131]
  buffer_load_dwordx4 v9, s[8:11], s69 offen offset:3072 sc1 lds
  s_add_u32 m0, s70, 65536
  s_add_u32 s69, s64, 65536
  v_mul_f32 v72, 0x3e8293ee, v72
  v_mul_f32 v73, 0x3e8293ee, v73
  v_max_f32 v74, v72, v73
  v_mov_b32 v75, v74
  v_mfma_f32_16x16x32_bf16 v[132:135], a[92:95], v[84:87], v[132:135]
  ds_read_b128 v[76:79], v23 offset:35840
  v_permlane16_swap_b32 v74, v75
  v_max_f32 v74, v74, v75
  v_mov_b32 v75, v74
  v_mfma_f32_16x16x32_bf16 v[132:135], a[84:87], v[88:91], v[132:135]
  s_waitcnt lgkmcnt(4)
  buffer_load_dwordx4 v9, s[8:11], s69 offen offset:0 sc1 lds
  v_permlane32_swap_b32 v74, v75
  v_max_f32 v74, v74, v75
  v_sub_f32 v72, v72, v74
  v_sub_f32 v73, v73, v74
  v_mfma_f32_16x16x32_bf16 v[128:131], a[96:99], v[92:95], v[128:131]
  ds_read_b128 v[84:87], v23 offset:36864
  v_exp_f32 v72, v72
  v_exp_f32 v73, v73
  v_mfma_f32_16x16x32_bf16 v[128:131], a[104:107], v[96:99], v[128:131]
  v_add_f32 v74, v72, v73
  v_mov_b32 v75, v74
  v_mfma_f32_16x16x32_bf16 v[132:135], a[108:111], v[96:99], v[132:135]
  ds_read_b128 v[88:91], v23 offset:37888
  v_permlane16_swap_b32 v74, v75
  v_add_f32 v74, v74, v75
  v_mov_b32 v75, v74
  v_mfma_f32_16x16x32_bf16 v[132:135], a[100:103], v[92:95], v[132:135]
  buffer_load_dwordx4 v9, s[8:11], s69 offen offset:1024 sc1 lds
  v_permlane32_swap_b32 v74, v75
  v_add_f32 v74, v74, v75
  v_rcp_f32 v74, v74
  v_mfma_f32_16x16x32_bf16 v[128:131], a[112:115], v[104:107], v[128:131]
  ds_read_b128 v[96:99], v23 offset:38912
  v_mul_f32 v72, v72, v74
  v_mul_f32 v73, v73, v74
  v_cvt_pk_bf16_f32 v72, v72, v72
  v_cvt_pk_bf16_f32 v73, v73, v73
  v_and_b32 v52, v24, v72
  v_and_b32 v53, v25, v73
  v_mfma_f32_16x16x32_bf16 v[128:131], a[120:123], v[100:103], v[128:131]
  buffer_load_dwordx4 v9, s[8:11], s69 offen offset:2048 sc1 lds
  v_and_b32 v54, v26, v72
  v_and_b32 v55, v27, v73
  v_mfma_f32_16x16x32_bf16 v[132:135], a[124:127], v[100:103], v[132:135]
  ds_read_b128 v[92:95], v23 offset:39936
  v_mfma_f32_16x16x32_bf16 v[56:59], v[64:67], v[52:55], 0
  v_mfma_f32_16x16x32_bf16 v[60:63], v[68:71], v[52:55], 0
  v_mfma_f32_16x16x32_bf16 v[132:135], a[116:119], v[104:107], v[132:135]
  s_waitcnt lgkmcnt(4)
  v_mfma_f32_16x16x32_bf16 v[128:131], a[128:131], v[108:111], v[128:131]
  ds_read_b128 v[100:103], v23 offset:49152
  v_mfma_f32_16x16x32_bf16 v[128:131], a[136:139], v[112:115], v[128:131]
  buffer_load_dwordx4 v9, s[8:11], s69 offen offset:3072 sc1 lds
  s_add_u32 m0, s70, 0
  s_add_u32 s69, s65, 65536
  v_mfma_f32_16x16x32_bf16 v[132:135], a[140:143], v[112:115], v[132:135]
  ds_read_b128 v[104:107], v23 offset:50176
  v_cvt_pk_bf16_f32 v116, v56, v57
  v_cvt_pk_bf16_f32 v117, v58, v59
  v_cvt_pk_bf16_f32 v118, v60, v61
  v_cvt_pk_bf16_f32 v119, v62, v63
  v_mfma_f32_16x16x32_bf16 v[132:135], a[132:135], v[108:111], v[132:135]
  buffer_load_dwordx4 v9, s[8:11], s69 offen offset:0 sc1 lds
  buffer_store_dwordx4 v[116:119], v1, s[8:11], s73 offen sc1
  s_add_u32 s73, s73, 65536
  v_mfma_f32_16x16x32_bf16 v[128:131], a[144:147], v[80:83], v[128:131]
  ds_read_b128 v[112:115], v23 offset:51200
  v_mfma_f32_16x16x32_bf16 v[128:131], a[152:155], v[76:79], v[128:131]
  v_mfma_f32_16x16x32_bf16 v[132:135], a[156:159], v[76:79], v[132:135]
  ds_read_b128 v[108:111], v23 offset:52224
  v_mfma_f32_16x16x32_bf16 v[132:135], a[148:151], v[80:83], v[132:135]
  s_waitcnt lgkmcnt(4)
  buffer_load_dwordx4 v9, s[8:11], s69 offen offset:1024 sc1 lds
  v_mfma_f32_16x16x32_bf16 v[128:131], a[160:163], v[84:87], v[128:131]
  ds_read_b128 v[76:79], v23 offset:53248
  s_waitcnt vmcnt(16)
  v_add_f32 v160, v160, v161
  v_mfma_f32_16x16x32_bf16 v[128:131], a[168:171], v[88:91], v[128:131]
  buffer_load_dwordx4 v9, s[8:11], s69 offen offset:2048 sc1 lds
  v_add_f32 v162, v162, v163
  v_add_f32 v160, v160, v162
  v_cvt_pk_bf16_f32 v160, v160, v160
  v_mfma_f32_16x16x32_bf16 v[132:135], a[172:175], v[88:91], v[132:135]
  ds_read_b128 v[80:83], v23 offset:54272
  v_lshlrev_b32 v160, 16, v160
  v_cvt_f32_u32 v181, v181
  v_mfma_f32_16x16x32_bf16 v[132:135], a[164:167], v[84:87], v[132:135]
  v_add_f32 v160, v160, v181
  v_cvt_pk_bf16_f32 v160, v160, v160
  v_lshlrev_b32 v160, 16, v160
  v_mfma_f32_16x16x32_bf16 v[128:131], a[176:179], v[96:99], v[128:131]
  ds_read_b128 v[88:91], v23 offset:55296
  s_lshl_b32 s54, s44, 8
  s_add_u32 s54, s54, 161792
  v_mfma_f32_16x16x32_bf16 v[128:131], a[184:187], v[92:95], v[128:131]
  buffer_load_dwordx4 v9, s[8:11], s69 offen offset:3072 sc1 lds
  v_lshl_add_u32 v180, v0, 2, s54
  v_lshrrev_b32 v161, 4, v0
  v_lshl_add_u32 v181, v161, 4, s54
  v_mfma_f32_16x16x32_bf16 v[132:135], a[188:191], v[92:95], v[132:135]
  ds_read_b128 v[84:87], v23 offset:56320
  ds_write_b32 v180, v160
  v_mfma_f32_16x16x32_bf16 v[132:135], a[180:183], v[96:99], v[132:135]
  s_waitcnt lgkmcnt(5)
  s_waitcnt vmcnt(12)
  s_cmp_lg_u32 s44, 0
  s_cbranch_scc1 PL7_adaLN_cond__sliding_local_dilated__swiglu_ffn__prompt_kernelx
  v_subrev_u32 v13, s46, v13
  v_subrev_u32 v13, 2, v13
  v_cmp_lt_u32 vcc, 3, v13
  s_nop 4
  s_cbranch_vccz PL7_adaLN_cond__sliding_local_dilated__swiglu_ffn__prompt_kernelx
  s_mov_b32 s57, 60000
PL7_adaLN_cond__sliding_local_dilated__swiglu_ffn__prompt_kernel:
  buffer_load_dword v13, v14, s[8:11], s77 offen sc1
  s_sub_u32 s57, s57, 1
  s_cmp_eq_u32 s57, 0
  s_waitcnt vmcnt(0)
  s_cbranch_scc1 PL7_adaLN_cond__sliding_local_dilated__swiglu_ffn__prompt_kernelx
  v_subrev_u32 v13, s46, v13
  v_subrev_u32 v13, 2, v13
  v_cmp_lt_u32 vcc, 3, v13
  s_nop 4
  s_cbranch_vccnz PL7_adaLN_cond__sliding_local_dilated__swiglu_ffn__prompt_kernel
PL7_adaLN_cond__sliding_local_dilated__swiglu_ffn__prompt_kernelx:
  s_waitcnt vmcnt(9)
  s_barrier
  v_mfma_f32_16x16x32_bf16 v[128:131], a[192:195], v[100:103], v[128:131]
  ds_read_b128 v[92:95], v22 offset:16384
  s_add_u32 m0, s70, 32768
  s_add_u32 s69, s62, 131072
  v_mfma_f32_16x16x32_bf16 v[128:131], a[200:203], v[104:107], v[128:131]
  buffer_load_dwordx4 v9, s[8:11], s69 offen offset:0 sc1 lds
  v_bfe_u32 v180, v0, 2, 2
  v_xor_b32 v180, v180, v161
  v_lshlrev_b32 v180, 27, v180
  v_mfma_f32_16x16x32_bf16 v[132:135], a[204:207], v[104:107], v[132:135]
  ds_read_b128 v[96:99], v22 offset:17408
  v_and_b32 v162, 15, v0
  v_lshl_add_u32 v180, v162, 4, v180
  v_mfma_f32_16x16x32_bf16 v[132:135], a[196:199], v[100:103], v[132:135]
  s_and_b32 s54, s44, 1
  s_lshl_b32 s54, s54, 11
  v_add_u32 v182, s54, v1
  s_and_b32 s54, s44, 2
  v_mfma_f32_16x16x32_bf16 v[128:131], a[208:211], v[112:115], v[128:131]
  ds_read_b128 v[104:107], v22 offset:18432
  s_lshl_b32 s54, s54, 9
  s_add_u32 s54, s54, 135168
  v_mfma_f32_16x16x32_bf16 v[128:131], a[216:219], v[108:111], v[128:131]
  buffer_load_dwordx4 v9, s[8:11], s69 offen offset:1024 sc1 lds
  v_add_u32 v182, s54, v182
  ds_read_b128 v[160:163], v181 offset:0
  v_mfma_f32_16x16x32_bf16 v[132:135], a[220:223], v[108:111], v[132:135]
  ds_read_b128 v[100:103], v22 offset:19456
  ds_read_b128 v[164:167], v181 offset:64
  v_mfma_f32_16x16x32_bf16 v[132:135], a[212:215], v[112:115], v[132:135]
  s_waitcnt lgkmcnt(7)
  buffer_load_dwordx4 v9, s[8:11], s69 offen offset:2048 sc1 lds
  ds_read_b128 v[168:171], v181 offset:128
  v_mfma_f32_16x16x32_bf16 v[128:131], a[224:227], v[76:79], v[128:131]
  ds_read_b128 v[108:111], v22 offset:20480
  ds_read_b128 v[172:175], v181 offset:192
  v_mfma_f32_16x16x32_bf16 v[128:131], a[232:235], v[80:83], v[128:131]
  v_mov_b32 v176, 0x3f803f80
  v_mov_b32 v177, 0x3f803f80
  v_mov_b32 v178, 0x3f803f80
  v_mfma_f32_16x16x32_bf16 v[132:135], a[236:239], v[80:83], v[132:135]
  ds_read_b128 v[112:115], v22 offset:21504
  v_mov_b32 v179, 0x3f803f80
  s_mov_b32 s90, 0xcccccccc
  v_mfma_f32_16x16x32_bf16 v[132:135], a[228:231], v[76:79], v[132:135]
  buffer_load_dwordx4 v9, s[8:11], s69 offen offset:3072 sc1 lds
  s_add_u32 m0, s70, 49152
  s_add_u32 s69, s63, 131072
  s_mov_b32 s91, 0xcccccccc
  v_mfma_f32_16x16x32_bf16 v[128:131], a[240:243], v[88:91], v[128:131]
  ds_read_b128 v[80:83], v22 offset:22528
  v_lshrrev_b32 v220, 5, v0
  v_xor_b32 v220, 1, v220
  v_lshlrev_b32 v220, 12, v220
  v_mfma_f32_16x16x32_bf16 v[128:131], a[248:251], v[84:87], v[128:131]
  buffer_load_dwordx4 v9, s[8:11], s69 offen offset:0 sc1 lds
  s_waitcnt vmcnt(22) lgkmcnt(2)
  v_lshlrev_b32 v184, 16, v144
  v_and_b32 v185, 0xffff0000, v144
  v_mfma_f32_16x16x32_bf16 v[132:135], v[124:127], v[84:87], v[132:135]
  ds_read_b128 v[76:79], v22 offset:23552
  v_and_b32 v221, 31, v0
  v_lshl_add_u32 v220, v221, 3, v220
  v_mfma_f32_16x16x32_bf16 v[132:135], a[244:247], v[88:91], v[132:135]
  s_waitcnt lgkmcnt(7)
  v_add_u32 v15, s46, v0
  v_add_u32 v15, 3, v15
  s_waitcnt vmcnt(8)
  s_barrier
  s_mov_b64 exec, 1
  buffer_store_dword v15, v0, s[8:11], s74 offen offset:0 sc1
  s_mov_b64 exec, -1
  v_mfma_f32_16x16x32_bf16 v[136:139], a[0:3], v[92:95], 0
  ds_read_b128 v[84:87], v23 offset:16384
  v_lshlrev_b32 v186, 16, v145
  v_and_b32 v187, 0xffff0000, v145
  v_mfma_f32_16x16x32_bf16 v[136:139], a[8:11], v[96:99], v[136:139]
  buffer_load_dwordx4 v9, s[8:11], s69 offen offset:1024 sc1 lds
  v_lshlrev_b32 v188, 16, v146
  v_and_b32 v189, 0xffff0000, v146
  v_lshlrev_b32 v190, 16, v147
  v_mfma_f32_16x16x32_bf16 v[140:143], a[12:15], v[96:99], 0
  ds_read_b128 v[88:91], v23 offset:17408
  v_and_b32 v191, 0xffff0000, v147
  v_fmac_f32 v184, v160, v128
  v_mfma_f32_16x16x32_bf16 v[140:143], a[4:7], v[92:95], v[140:143]
  buffer_load_dwordx4 v9, s[8:11], s69 offen offset:2048 sc1 lds
  v_fmac_f32 v185, v161, v129
  v_fmac_f32 v186, v162, v130
  v_fmac_f32 v187, v163, v131
  v_mfma_f32_16x16x32_bf16 v[136:139], a[16:19], v[104:107], v[136:139]
  ds_read_b128 v[96:99], v23 offset:18432
  v_fmac_f32 v188, v164, v132
  v_fmac_f32 v189, v165, v133
  v_mfma_f32_16x16x32_bf16 v[136:139], a[24:27], v[100:103], v[136:139]
  v_fmac_f32 v190, v166, v134
  v_fmac_f32 v191, v167, v135
  v_mul_f32 v128, v184, v168
  v_mfma_f32_16x16x32_bf16 v[140:143], a[28:31], v[100:103], v[140:143]
  ds_read_b128 v[92:95], v23 offset:19456
  v_mul_f32 v129, v185, v169
  v_mul_f32 v130, v186, v170
  v_mfma_f32_16x16x32_bf16 v[140:143], a[20:23], v[104:107], v[140:143]
  s_waitcnt lgkmcnt(4)
  buffer_load_dwordx4 v9, s[8:11], s69 offen offset:3072 sc1 lds
  v_mul_f32 v131, v187, v171
  v_mul_f32 v132, v188, v172
  v_mfma_f32_16x16x32_bf16 v[136:139], a[32:35], v[108:111], v[136:139]
  ds_read_b128 v[100:103], v23 offset:20480
  s_add_u32 m0, s70, 98304
  s_add_u32 s69, s64, 131072
  v_mfma_f32_16x16x32_bf16 v[136:139], a[40:43], v[112:115], v[136:139]
  buffer_load_dwordx4 v9, s[8:11], s69 offen offset:0 sc1 lds
  v_mul_f32 v133, v189, v173
  v_mul_f32 v134, v190, v174
  v_mul_f32 v135, v191, v175
  v_mfma_f32_16x16x32_bf16 v[140:143], a[44:47], v[112:115], v[140:143]
  ds_read_b128 v[104:107], v23 offset:21504
  v_cvt_pk_bf16_f32 v196, v128, v129
  v_cvt_pk_bf16_f32 v197, v130, v131
  v_mfma_f32_16x16x32_bf16 v[140:143], a[36:39], v[108:111], v[140:143]
  v_cvt_pk_bf16_f32 v198, v132, v133
  v_cvt_pk_bf16_f32 v199, v134, v135
  v_mfma_f32_16x16x32_bf16 v[136:139], a[48:51], v[80:83], v[136:139]
  ds_read_b128 v[112:115], v23 offset:22528
  v_mfma_f32_16x16x32_bf16 v[136:139], a[56:59], v[76:79], v[136:139]
  buffer_load_dwordx4 v9, s[8:11], s69 offen offset:1024 sc1 lds
  s_add_u32 s54, s47, 36700160
  buffer_store_dwordx4 v[196:199], v1, s[8:11], s54 offen sc1
  v_mfma_f32_16x16x32_bf16 v[140:143], a[60:63], v[76:79], v[140:143]
  ds_read_b128 v[108:111], v23 offset:23552
  v_cvt_pk_bf16_f32 v144, v184, v185
  v_cvt_pk_bf16_f32 v145, v186, v187
  v_mfma_f32_16x16x32_bf16 v[140:143], a[52:55], v[80:83], v[140:143]
  s_waitcnt lgkmcnt(4)
  v_cvt_pk_bf16_f32 v146, v188, v189
  s_waitcnt vmcnt(12)
  s_barrier
  v_mfma_f32_16x16x32_bf16 v[136:139], a[64:67], v[84:87], v[136:139]
  ds_read_b128 v[76:79], v23 offset:0
  buffer_load_dwordx4 v9, s[8:11], s69 offen offset:2048 sc1 lds
  v_cvt_pk_bf16_f32 v147, v190, v191
  v_mfma_f32_16x16x32_bf16 v[136:139], a[72:75], v[88:91], v[136:139]
  s_nop 0
  v_mfma_f32_16x16x32_bf16 v[224:227], v[176:179], v[144:147], 0
  v_mfma_f32_16x16x32_bf16 v[192:195], v[144:147], v[144:147], 0
  v_mfma_f32_16x16x32_bf16 v[140:143], a[76:79], v[88:91], v[140:143]
  ds_read_b128 v[80:83], v23 offset:1024
  v_mfma_f32_16x16x32_bf16 v[140:143], a[68:71], v[84:87], v[140:143]
  buffer_load_dwordx4 v9, s[8:11], s69 offen offset:3072 sc1 lds
  s_add_u32 m0, s70, 114688
  s_add_u32 s69, s65, 131072
  v_mfma_f32_16x16x32_bf16 v[136:139], a[80:83], v[96:99], v[136:139]
  ds_read_b128 v[88:91], v23 offset:2048
  v_cndmask_b32 v192, v192, v193, s[88:89]
  v_cndmask_b32 v194, v194, v195, s[88:89]
  v_mfma_f32_16x16x32_bf16 v[136:139], a[88:91], v[92:95], v[136:139]
  buffer_load_dwordx4 v9, s[8:11], s69 offen offset:0 sc1 lds
  v_cndmask_b32 v225, v192, v194, s[90:91]
  v_mfma_f32_16x16x32_bf16 v[140:143], a[92:95], v[92:95], v[140:143]
  ds_read_b128 v[84:87], v23 offset:3072
  v_mfma_f32_16x16x32_bf16 v[140:143], a[84:87], v[96:99], v[140:143]
  s_waitcnt lgkmcnt(4)
  v_mfma_f32_16x16x32_bf16 v[136:139], a[96:99], v[100:103], v[136:139]
  ds_read_b128 v[92:95], v23 offset:4096
  v_mfma_f32_16x16x32_bf16 v[136:139], a[104:107], v[104:107], v[136:139]
  buffer_load_dwordx4 v9, s[8:11], s69 offen offset:1024 sc1 lds
  v_mfma_f32_16x16x32_bf16 v[140:143], a[108:111], v[104:107], v[140:143]
  ds_read_b128 v[96:99], v23 offset:5120
  v_mfma_f32_16x16x32_bf16 v[140:143], a[100:103], v[100:103], v[140:143]
  buffer_load_dwordx4 v9, s[8:11], s69 offen offset:2048 sc1 lds
  v_mfma_f32_16x16x32_bf16 v[136:139], a[112:115], v[112:115], v[136:139]
  ds_read_b128 v[104:107], v23 offset:6144
  v_mfma_f32_16x16x32_bf16 v[136:139], a[120:123], v[108:111], v[136:139]
  v_mfma_f32_16x16x32_bf16 v[140:143], a[124:127], v[108:111], v[140:143]
  ds_read_b128 v[100:103], v23 offset:7168
  v_mfma_f32_16x16x32_bf16 v[140:143], a[116:119], v[112:115], v[140:143]
  s_waitcnt lgkmcnt(4)
  buffer_load_dwordx4 v9, s[8:11], s69 offen offset:3072 sc1 lds
  v_mfma_f32_16x16x32_bf16 v[136:139], a[128:131], v[76:79], v[136:139]
  ds_read_b128 v[108:111], v22 offset:0
  v_mfma_f32_16x16x32_bf16 v[136:139], a[136:139], v[80:83], v[136:139]
  v_mfma_f32_16x16x32_bf16 v[140:143], a[140:143], v[80:83], v[140:143]
  ds_read_b128 v[112:115], v22 offset:1024
  v_mfma_f32_16x16x32_bf16 v[140:143], a[132:135], v[76:79], v[140:143]
  v_mfma_f32_16x16x32_bf16 v[136:139], a[144:147], v[88:91], v[136:139]
  ds_read_b128 v[80:83], v22 offset:2048
  v_mfma_f32_16x16x32_bf16 v[136:139], a[152:155], v[84:87], v[136:139]
  v_mfma_f32_16x16x32_bf16 v[140:143], a[156:159], v[84:87], v[140:143]
  ds_read_b128 v[76:79], v22 offset:3072
  v_mfma_f32_16x16x32_bf16 v[140:143], a[148:151], v[88:91], v[140:143]
  s_waitcnt lgkmcnt(4)
  v_mfma_f32_16x16x32_bf16 v[136:139], a[160:163], v[92:95], v[136:139]
  ds_read_b128 v[84:87], v22 offset:4096
  v_mfma_f32_16x16x32_bf16 v[136:139], a[168:171], v[96:99], v[136:139]
  s_or_b32 s57, s2, s44
  s_mov_b32 s57, 851968
  s_cselect_b32 s57, 1073741824, s57
  v_add_u32 v15, s46, v0
  s_mov_b64 exec, 1
  buffer_store_dword v15, v0, s[8:11], s57 offen offset:0 sc1
  s_mov_b64 exec, -1
  v_mfma_f32_16x16x32_bf16 v[140:143], a[172:175], v[96:99], v[140:143]
  ds_read_b128 v[88:91], v22 offset:5120
  v_mfma_f32_16x16x32_bf16 v[140:143], a[164:167], v[92:95], v[140:143]
  v_mfma_f32_16x16x32_bf16 v[136:139], a[176:179], v[104:107], v[136:139]
  ds_read_b128 v[96:99], v22 offset:6144
  s_lshl_b32 s57, s44, 28
  s_add_u32 s57, s57, s77
  buffer_load_dword v13, v14, s[8:11], s57 offen sc1
  v_mfma_f32_16x16x32_bf16 v[136:139], a[184:187], v[100:103], v[136:139]
  v_mfma_f32_16x16x32_bf16 v[140:143], a[188:191], v[100:103], v[140:143]
  ds_read_b128 v[92:95], v22 offset:7168
  v_mfma_f32_16x16x32_bf16 v[140:143], a[180:183], v[104:107], v[140:143]
  s_waitcnt lgkmcnt(4)
  s_waitcnt vmcnt(11)
  s_barrier
  v_mfma_f32_16x16x32_bf16 v[136:139], a[192:195], v[108:111], v[136:139]
  ds_read_b128 v[100:103], v22 offset:32768
  v_mfma_f32_16x16x32_bf16 v[136:139], a[200:203], v[112:115], v[136:139]
  v_mfma_f32_16x16x32_bf16 v[140:143], a[204:207], v[112:115], v[140:143]
  ds_read_b128 v[104:107], v22 offset:33792
  v_mfma_f32_16x16x32_bf16 v[140:143], a[196:199], v[108:111], v[140:143]
  v_mfma_f32_16x16x32_bf16 v[136:139], a[208:211], v[80:83], v[136:139]
  ds_read_b128 v[112:115], v22 offset:34816
  s_waitcnt vmcnt(36) lgkmcnt(15)
  v_lshlrev_b32 v184, 16, v148
  v_and_b32 v185, 0xffff0000, v148
  v_lshlrev_b32 v186, 16, v149
  v_mfma_f32_16x16x32_bf16 v[136:139], a[216:219], v[76:79], v[136:139]
  v_and_b32 v187, 0xffff0000, v149
  v_lshlrev_b32 v188, 16, v150
  v_and_b32 v189, 0xffff0000, v150
  v_lshlrev_b32 v190, 16, v151
  v_and_b32 v191, 0xffff0000, v151
  v_mfma_f32_16x16x32_bf16 v[140:143], a[220:223], v[76:79], v[140:143]
  ds_read_b128 v[108:111], v22 offset:35840
  v_mfma_f32_16x16x32_bf16 v[140:143], a[212:215], v[80:83], v[140:143]
  s_waitcnt lgkmcnt(4)
  v_mfma_f32_16x16x32_bf16 v[136:139], a[224:227], v[84:87], v[136:139]
  ds_read_b128 v[76:79], v22 offset:36864
  v_mfma_f32_16x16x32_bf16 v[136:139], a[232:235], v[88:91], v[136:139]
  v_mfma_f32_16x16x32_bf16 v[140:143], a[236:239], v[88:91], v[140:143]
  ds_read_b128 v[80:83], v22 offset:37888
  v_mfma_f32_16x16x32_bf16 v[140:143], a[228:231], v[84:87], v[140:143]
  v_mfma_f32_16x16x32_bf16 v[136:139], a[240:243], v[96:99], v[136:139]
  ds_read_b128 v[88:91], v22 offset:38912
  v_mfma_f32_16x16x32_bf16 v[136:139], a[248:251], v[92:95], v[136:139]
  v_mfma_f32_16x16x32_bf16 v[140:143], v[124:127], v[92:95], v[140:143]
  ds_read_b128 v[84:87], v22 offset:39936
  v_mfma_f32_16x16x32_bf16 v[140:143], a[244:247], v[96:99], v[140:143]
  s_waitcnt lgkmcnt(4)
  v_mfma_f32_16x16x32_bf16 v[128:131], a[0:3], v[100:103], 0
  ds_read_b128 v[92:95], v22 offset:49152
  v_mfma_f32_16x16x32_bf16 v[128:131], a[8:11], v[104:107], v[128:131]
  v_mfma_f32_16x16x32_bf16 v[132:135], a[12:15], v[104:107], 0
  ds_read_b128 v[96:99], v22 offset:50176
  v_fmac_f32 v184, v160, v136
  v_fmac_f32 v185, v161, v137
  v_fmac_f32 v186, v162, v138
  v_fmac_f32 v187, v163, v139
  v_mfma_f32_16x16x32_bf16 v[132:135], a[4:7], v[100:103], v[132:135]
  v_fmac_f32 v188, v164, v140
  v_fmac_f32 v189, v165, v141
  v_fmac_f32 v190, v166, v142
  v_fmac_f32 v191, v167, v143
  v_mul_f32 v136, v184, v168
  v_mfma_f32_16x16x32_bf16 v[128:131], a[16:19], v[112:115], v[128:131]
  ds_read_b128 v[104:107], v22 offset:51200
  v_mul_f32 v137, v185, v169
  v_mul_f32 v138, v186, v170
  v_mul_f32 v139, v187, v171
  v_mul_f32 v140, v188, v172
  v_mfma_f32_16x16x32_bf16 v[128:131], a[24:27], v[108:111], v[128:131]
  v_mul_f32 v141, v189, v173
  v_mul_f32 v142, v190, v174
  v_mul_f32 v143, v191, v175
  v_cvt_pk_bf16_f32 v200, v136, v137
  v_cvt_pk_bf16_f32 v201, v138, v139
  v_mfma_f32_16x16x32_bf16 v[132:135], a[28:31], v[108:111], v[132:135]
  ds_read_b128 v[100:103], v22 offset:52224
  v_cvt_pk_bf16_f32 v202, v140, v141
  v_cvt_pk_bf16_f32 v203, v142, v143
  v_mfma_f32_16x16x32_bf16 v[132:135], a[20:23], v[112:115], v[132:135]
  s_waitcnt lgkmcnt(4)
  s_add_u32 s54, s47, 36765696
  buffer_store_dwordx4 v[200:203], v1, s[8:11], s54 offen sc1
  v_mfma_f32_16x16x32_bf16 v[128:131], a[32:35], v[76:79], v[128:131]
  ds_read_b128 v[108:111], v22 offset:53248
  v_cvt_pk_bf16_f32 v148, v184, v185
  v_cvt_pk_bf16_f32 v149, v186, v187
  v_cvt_pk_bf16_f32 v150, v188, v189
  v_cvt_pk_bf16_f32 v151, v190, v191
  v_mfma_f32_16x16x32_bf16 v[128:131], a[40:43], v[80:83], v[128:131]
  s_nop 0
  v_mfma_f32_16x16x32_bf16 v[226:229], v[176:179], v[148:151], 0
  v_mfma_f32_16x16x32_bf16 v[192:195], v[148:151], v[148:151], 0
  v_mfma_f32_16x16x32_bf16 v[132:135], a[44:47], v[80:83], v[132:135]
  ds_read_b128 v[112:115], v22 offset:54272
  v_mfma_f32_16x16x32_bf16 v[132:135], a[36:39], v[76:79], v[132:135]
  v_mfma_f32_16x16x32_bf16 v[128:131], a[48:51], v[88:91], v[128:131]
  ds_read_b128 v[80:83], v22 offset:55296
  s_nop 2
  v_cndmask_b32 v192, v192, v193, s[88:89]
  v_cndmask_b32 v194, v194, v195, s[88:89]
  v_cndmask_b32 v227, v192, v194, s[90:91]
  v_mfma_f32_16x16x32_bf16 v[128:131], a[56:59], v[84:87], v[128:131]
  buffer_store_dwordx4 v[224:227], v180, s[8:11], s48 offen offset:0 sc1
  v_mfma_f32_16x16x32_bf16 v[132:135], a[60:63], v[84:87], v[132:135]
  ds_read_b128 v[76:79], v22 offset:56320
  v_mfma_f32_16x16x32_bf16 v[132:135], a[52:55], v[88:91], v[132:135]
  s_waitcnt lgkmcnt(4)
  s_waitcnt vmcnt(2)
  s_cmp_lg_u32 s44, 0
  s_cbranch_scc1 PL8_adaLN_cond__sliding_local_dilated__swiglu_ffn__prompt_kernelx
  v_subrev_u32 v13, s46, v13
  v_subrev_u32 v13, 3, v13
  v_cmp_lt_u32 vcc, 3, v13
  s_nop 4
  s_cbranch_vccz PL8_adaLN_cond__sliding_local_dilated__swiglu_ffn__prompt_kernelx
  s_mov_b32 s57, 60000
PL8_adaLN_cond__sliding_local_dilated__swiglu_ffn__prompt_kernel:
  buffer_load_dword v13, v14, s[8:11], s77 offen sc1
  s_sub_u32 s57, s57, 1
  s_cmp_eq_u32 s57, 0
  s_waitcnt vmcnt(0)
  s_cbranch_scc1 PL8_adaLN_cond__sliding_local_dilated__swiglu_ffn__prompt_kernelx
  v_subrev_u32 v13, s46, v13
  v_subrev_u32 v13, 3, v13
  v_cmp_lt_u32 vcc, 3, v13
  s_nop 4
  s_cbranch_vccnz PL8_adaLN_cond__sliding_local_dilated__swiglu_ffn__prompt_kernel
PL8_adaLN_cond__sliding_local_dilated__swiglu_ffn__prompt_kernelx:
  s_waitcnt vmcnt(4)
  s_barrier
  v_mfma_f32_16x16x32_bf16 v[128:131], a[64:67], v[92:95], v[128:131]
  ds_read_b128 v[84:87], v23 offset:32768
  s_add_u32 m0, s70, 16384
  s_add_u32 s69, s62, 196608
  v_mfma_f32_16x16x32_bf16 v[128:131], a[72:75], v[96:99], v[128:131]
  buffer_load_dwordx4 v9, s[8:11], s69 offen offset:0 sc1 lds
  v_mfma_f32_16x16x32_bf16 v[132:135], a[76:79], v[96:99], v[132:135]
  ds_read_b128 v[88:91], v23 offset:33792
  v_mfma_f32_16x16x32_bf16 v[132:135], a[68:71], v[92:95], v[132:135]
  buffer_load_dwordx4 v9, s[8:11], s69 offen offset:1024 sc1 lds
  v_mfma_f32_16x16x32_bf16 v[128:131], a[80:83], v[104:107], v[128:131]
  ds_read_b128 v[96:99], v23 offset:34816
  buffer_load_dwordx4 v9, s[8:11], s69 offen offset:2048 sc1 lds
  v_mfma_f32_16x16x32_bf16 v[128:131], a[88:91], v[100:103], v[128:131]
  v_mfma_f32_16x16x32_bf16 v[132:135], a[92:95], v[100:103], v[132:135]
  ds_read_b128 v[92:95], v23 offset:35840
  buffer_load_dwordx4 v9, s[8:11], s69 offen offset:3072 sc1 lds
  s_add_u32 m0, s70, 81920
  s_add_u32 s69, s63, 196608
  v_mfma_f32_16x16x32_bf16 v[132:135], a[84:87], v[104:107], v[132:135]
  s_waitcnt lgkmcnt(4)
  buffer_load_dwordx4 v9, s[8:11], s69 offen offset:0 sc1 lds
  v_mfma_f32_16x16x32_bf16 v[128:131], a[96:99], v[108:111], v[128:131]
  ds_read_b128 v[100:103], v23 offset:36864
  v_mfma_f32_16x16x32_bf16 v[128:131], a[104:107], v[112:115], v[128:131]
  buffer_load_dwordx4 v9, s[8:11], s69 offen offset:1024 sc1 lds
  v_mfma_f32_16x16x32_bf16 v[132:135], a[108:111], v[112:115], v[132:135]
  ds_read_b128 v[104:107], v23 offset:37888
  buffer_load_dwordx4 v9, s[8:11], s69 offen offset:2048 sc1 lds
  v_mfma_f32_16x16x32_bf16 v[132:135], a[100:103], v[108:111], v[132:135]
  v_mfma_f32_16x16x32_bf16 v[128:131], a[112:115], v[80:83], v[128:131]
  ds_read_b128 v[112:115], v23 offset:38912
  buffer_load_dwordx4 v9, s[8:11], s69 offen offset:3072 sc1 lds
  s_add_u32 m0, s70, 65536
  s_add_u32 s69, s64, 196608
  v_mfma_f32_16x16x32_bf16 v[128:131], a[120:123], v[76:79], v[128:131]
  buffer_load_dwordx4 v9, s[8:11], s69 offen offset:0 sc1 lds
  v_mfma_f32_16x16x32_bf16 v[132:135], a[124:127], v[76:79], v[132:135]
  ds_read_b128 v[108:111], v23 offset:39936
  v_mfma_f32_16x16x32_bf16 v[132:135], a[116:119], v[80:83], v[132:135]
  s_waitcnt lgkmcnt(4)
  buffer_load_dwordx4 v9, s[8:11], s69 offen offset:1024 sc1 lds
  v_mfma_f32_16x16x32_bf16 v[128:131], a[128:131], v[84:87], v[128:131]
  ds_read_b128 v[76:79], v23 offset:49152
  buffer_load_dwordx4 v9, s[8:11], s69 offen offset:2048 sc1 lds
  v_mfma_f32_16x16x32_bf16 v[128:131], a[136:139], v[88:91], v[128:131]
  v_mfma_f32_16x16x32_bf16 v[132:135], a[140:143], v[88:91], v[132:135]
  ds_read_b128 v[80:83], v23 offset:50176
  buffer_load_dwordx4 v9, s[8:11], s69 offen offset:3072 sc1 lds
  s_add_u32 m0, s70, 0
  s_add_u32 s69, s65, 196608
  v_mfma_f32_16x16x32_bf16 v[132:135], a[132:135], v[84:87], v[132:135]
  buffer_load_dwordx4 v9, s[8:11], s69 offen offset:0 sc1 lds
  v_mfma_f32_16x16x32_bf16 v[128:131], a[144:147], v[96:99], v[128:131]
  ds_read_b128 v[88:91], v23 offset:51200
  v_mfma_f32_16x16x32_bf16 v[128:131], a[152:155], v[92:95], v[128:131]
  buffer_load_dwordx4 v9, s[8:11], s69 offen offset:1024 sc1 lds
  v_mfma_f32_16x16x32_bf16 v[132:135], a[156:159], v[92:95], v[132:135]
  ds_read_b128 v[84:87], v23 offset:52224
  buffer_load_dwordx4 v9, s[8:11], s69 offen offset:2048 sc1 lds
  v_mfma_f32_16x16x32_bf16 v[132:135], a[148:151], v[96:99], v[132:135]
  s_waitcnt lgkmcnt(4)
  v_mfma_f32_16x16x32_bf16 v[128:131], a[160:163], v[100:103], v[128:131]
  ds_read_b128 v[92:95], v23 offset:53248
  v_mfma_f32_16x16x32_bf16 v[128:131], a[168:171], v[104:107], v[128:131]
  buffer_load_dwordx4 v9, s[8:11], s69 offen offset:3072 sc1 lds
  v_mfma_f32_16x16x32_bf16 v[132:135], a[172:175], v[104:107], v[132:135]
  ds_read_b128 v[96:99], v23 offset:54272
  v_mfma_f32_16x16x32_bf16 v[132:135], a[164:167], v[100:103], v[132:135]
  v_mfma_f32_16x16x32_bf16 v[128:131], a[176:179], v[112:115], v[128:131]
  ds_read_b128 v[104:107], v23 offset:55296
  v_mfma_f32_16x16x32_bf16 v[128:131], a[184:187], v[108:111], v[128:131]
  s_mov_b32 s55, 0
  s_add_u32 m0, s45, 32768
  s_sub_u32 s73, s49, 524288
  v_mfma_f32_16x16x32_bf16 v[132:135], a[188:191], v[108:111], v[132:135]
  ds_read_b128 v[100:103], v23 offset:56320
  buffer_load_dwordx4 v16, s[28:31], s55 offen lds
  v_mfma_f32_16x16x32_bf16 v[132:135], a[180:183], v[112:115], v[132:135]
  s_waitcnt lgkmcnt(4)
  s_waitcnt vmcnt(9)
  s_barrier
  v_add_u32 v15, s46, v0
  s_mov_b64 exec, 1
  buffer_store_dword v15, v0, s[8:11], s73 offen offset:0 sc1
  s_mov_b64 exec, -1
  v_mfma_f32_16x16x32_bf16 v[128:131], a[192:195], v[76:79], v[128:131]
  ds_read_b128 v[108:111], v22 offset:16384
  v_mfma_f32_16x16x32_bf16 v[128:131], a[200:203], v[80:83], v[128:131]
  v_mfma_f32_16x16x32_bf16 v[132:135], a[204:207], v[80:83], v[132:135]
  ds_read_b128 v[112:115], v22 offset:17408
  v_mfma_f32_16x16x32_bf16 v[132:135], a[196:199], v[76:79], v[132:135]
  s_mov_b32 s55, 0
  s_add_u32 m0, s45, 40960
  v_mfma_f32_16x16x32_bf16 v[128:131], a[208:211], v[88:91], v[128:131]
  ds_read_b128 v[80:83], v22 offset:18432
  s_waitcnt vmcnt(55) lgkmcnt(15)
  v_lshlrev_b32 v184, 16, v152
  v_mfma_f32_16x16x32_bf16 v[128:131], a[216:219], v[84:87], v[128:131]
  buffer_load_dwordx4 v16, s[32:35], s55 offen lds
  v_and_b32 v185, 0xffff0000, v152
  v_lshlrev_b32 v186, 16, v153
  v_and_b32 v187, 0xffff0000, v153
  v_mfma_f32_16x16x32_bf16 v[132:135], a[220:223], v[84:87], v[132:135]
  ds_read_b128 v[76:79], v22 offset:19456
  v_lshlrev_b32 v188, 16, v154
  v_and_b32 v189, 0xffff0000, v154
  v_mfma_f32_16x16x32_bf16 v[132:135], a[212:215], v[88:91], v[132:135]
  s_waitcnt lgkmcnt(4)
  v_lshlrev_b32 v190, 16, v155
  v_and_b32 v191, 0xffff0000, v155
  v_mfma_f32_16x16x32_bf16 v[128:131], a[224:227], v[92:95], v[128:131]
  ds_read_b128 v[84:87], v22 offset:20480
  v_mfma_f32_16x16x32_bf16 v[128:131], a[232:235], v[96:99], v[128:131]
  s_mov_b32 s55, 229376
  s_add_u32 m0, s45, 36864
  v_mfma_f32_16x16x32_bf16 v[132:135], a[236:239], v[96:99], v[132:135]
  ds_read_b128 v[88:91], v22 offset:21504
  v_mfma_f32_16x16x32_bf16 v[132:135], a[228:231], v[92:95], v[132:135]
HOP6:
  s_cbranch_execz HOP10
  buffer_load_dwordx4 v16, s[28:31], s55 offen lds
  v_mfma_f32_16x16x32_bf16 v[128:131], a[240:243], v[104:107], v[128:131]
  ds_read_b128 v[96:99], v22 offset:22528
  v_mfma_f32_16x16x32_bf16 v[128:131], a[248:251], v[100:103], v[128:131]
  v_mfma_f32_16x16x32_bf16 v[132:135], v[124:127], v[100:103], v[132:135]
  ds_read_b128 v[92:95], v22 offset:23552
  v_mfma_f32_16x16x32_bf16 v[132:135], a[244:247], v[104:107], v[132:135]
  s_waitcnt lgkmcnt(4)
  s_mov_b32 s55, 229376
  s_add_u32 m0, s45, 45056
  v_mfma_f32_16x16x32_bf16 v[136:139], a[0:3], v[108:111], 0
  ds_read_b128 v[100:103], v23 offset:16384
  v_mfma_f32_16x16x32_bf16 v[136:139], a[8:11], v[112:115], v[136:139]
  buffer_load_dwordx4 v16, s[32:35], s55 offen lds
  v_mfma_f32_16x16x32_bf16 v[140:143], a[12:15], v[112:115], 0
  ds_read_b128 v[104:107], v23 offset:17408
  v_fmac_f32 v184, v160, v128
  v_fmac_f32 v185, v161, v129
  v_mfma_f32_16x16x32_bf16 v[140:143], a[4:7], v[108:111], v[140:143]
  v_fmac_f32 v186, v162, v130
  v_fmac_f32 v187, v163, v131
  v_fmac_f32 v188, v164, v132
  v_mfma_f32_16x16x32_bf16 v[136:139], a[16:19], v[80:83], v[136:139]
  ds_read_b128 v[112:115], v23 offset:18432
  v_fmac_f32 v189, v165, v133
  v_fmac_f32 v190, v166, v134
  v_mfma_f32_16x16x32_bf16 v[136:139], a[24:27], v[76:79], v[136:139]
  s_add_u32 s56, s79, 12288
  v_fmac_f32 v191, v167, v135
  v_mul_f32 v128, v184, v168
  v_mul_f32 v129, v185, v169
  v_mfma_f32_16x16x32_bf16 v[140:143], a[28:31], v[76:79], v[140:143]
  ds_read_b128 v[108:111], v23 offset:19456
  v_mul_f32 v130, v186, v170
  v_mul_f32 v131, v187, v171
  v_mfma_f32_16x16x32_bf16 v[140:143], a[20:23], v[80:83], v[140:143]
  s_waitcnt lgkmcnt(4)
  buffer_load_dwordx2 v[212:213], v220, s[8:11], s56 offen sc1
  v_mul_f32 v132, v188, v172
  v_mul_f32 v133, v189, v173
  v_mfma_f32_16x16x32_bf16 v[136:139], a[32:35], v[84:87], v[136:139]
  ds_read_b128 v[76:79], v23 offset:20480
  s_add_u32 s56, s79, 36864
  v_mul_f32 v134, v190, v174
  v_mfma_f32_16x16x32_bf16 v[136:139], a[40:43], v[88:91], v[136:139]
  buffer_load_dwordx2 v[214:215], v220, s[8:11], s56 offen sc1
  v_mul_f32 v135, v191, v175
  v_cvt_pk_bf16_f32 v204, v128, v129
  v_cvt_pk_bf16_f32 v205, v130, v131
  v_mfma_f32_16x16x32_bf16 v[140:143], a[44:47], v[88:91], v[140:143]
  ds_read_b128 v[80:83], v23 offset:21504
  v_cvt_pk_bf16_f32 v206, v132, v133
  v_cvt_pk_bf16_f32 v207, v134, v135
  v_mfma_f32_16x16x32_bf16 v[140:143], a[36:39], v[84:87], v[140:143]
  s_add_u32 s56, s79, 61440
  s_add_u32 s54, s47, 36831232
  buffer_store_dwordx4 v[204:207], v1, s[8:11], s54 offen sc1
  v_mfma_f32_16x16x32_bf16 v[136:139], a[48:51], v[96:99], v[136:139]
  ds_read_b128 v[88:91], v23 offset:22528
  v_cvt_pk_bf16_f32 v152, v184, v185
  v_cvt_pk_bf16_f32 v153, v186, v187
  v_mfma_f32_16x16x32_bf16 v[136:139], a[56:59], v[92:95], v[136:139]
  buffer_load_dwordx2 v[216:217], v220, s[8:11], s56 offen sc1
  v_cvt_pk_bf16_f32 v154, v188, v189
  v_cvt_pk_bf16_f32 v155, v190, v191
  v_mfma_f32_16x16x32_bf16 v[140:143], a[60:63], v[92:95], v[140:143]
  ds_read_b128 v[84:87], v23 offset:23552
  s_add_u32 s56, s79, 86016
  v_mfma_f32_16x16x32_bf16 v[228:231], v[176:179], v[152:155], 0
  v_mfma_f32_16x16x32_bf16 v[192:195], v[152:155], v[152:155], 0
  v_mfma_f32_16x16x32_bf16 v[140:143], a[52:55], v[96:99], v[140:143]
  s_waitcnt lgkmcnt(4)
  s_waitcnt vmcnt(9)
  s_barrier
  v_mfma_f32_16x16x32_bf16 v[136:139], a[64:67], v[100:103], v[136:139]
  ds_read_b128 v[92:95], v23 offset:0
  buffer_load_dwordx2 v[218:219], v220, s[8:11], s56 offen sc1
  v_mfma_f32_16x16x32_bf16 v[136:139], a[72:75], v[104:107], v[136:139]
  s_mov_b32 s55, 0
  s_add_u32 m0, s45, 98304
  v_cndmask_b32 v192, v192, v193, s[88:89]
  v_cndmask_b32 v194, v194, v195, s[88:89]
  v_mfma_f32_16x16x32_bf16 v[140:143], a[76:79], v[104:107], v[140:143]
  ds_read_b128 v[96:99], v23 offset:1024
  v_cndmask_b32 v229, v192, v194, s[90:91]
  v_mfma_f32_16x16x32_bf16 v[140:143], a[68:71], v[100:103], v[140:143]
  buffer_load_dwordx4 v11, s[28:31], s55 offen lds
  v_mfma_f32_16x16x32_bf16 v[136:139], a[80:83], v[112:115], v[136:139]
  ds_read_b128 v[104:107], v23 offset:2048
  v_mfma_f32_16x16x32_bf16 v[136:139], a[88:91], v[108:111], v[136:139]
  v_mfma_f32_16x16x32_bf16 v[140:143], a[92:95], v[108:111], v[140:143]
  ds_read_b128 v[100:103], v23 offset:3072
  v_mfma_f32_16x16x32_bf16 v[140:143], a[84:87], v[112:115], v[140:143]
  s_waitcnt lgkmcnt(4)
  s_mov_b32 s55, 0
  s_add_u32 m0, s45, 106496
  v_mfma_f32_16x16x32_bf16 v[136:139], a[96:99], v[76:79], v[136:139]
  ds_read_b128 v[108:111], v23 offset:4096
  v_mfma_f32_16x16x32_bf16 v[136:139], a[104:107], v[80:83], v[136:139]
  buffer_load_dwordx4 v11, s[32:35], s55 offen lds
  v_mfma_f32_16x16x32_bf16 v[140:143], a[108:111], v[80:83], v[140:143]
  ds_read_b128 v[112:115], v23 offset:5120
  v_mfma_f32_16x16x32_bf16 v[140:143], a[100:103], v[76:79], v[140:143]
  v_mfma_f32_16x16x32_bf16 v[136:139], a[112:115], v[88:91], v[136:139]
  ds_read_b128 v[80:83], v23 offset:6144
  v_mfma_f32_16x16x32_bf16 v[136:139], a[120:123], v[84:87], v[136:139]
  s_mov_b32 s55, 229376
  s_add_u32 m0, s45, 102400
  v_mfma_f32_16x16x32_bf16 v[140:143], a[124:127], v[84:87], v[140:143]
  ds_read_b128 v[76:79], v23 offset:7168
  v_mfma_f32_16x16x32_bf16 v[140:143], a[116:119], v[88:91], v[140:143]
  s_waitcnt lgkmcnt(4)
  buffer_load_dwordx4 v11, s[28:31], s55 offen lds
  v_mfma_f32_16x16x32_bf16 v[136:139], a[128:131], v[92:95], v[136:139]
  ds_read_b128 v[84:87], v22 offset:0
  v_mfma_f32_16x16x32_bf16 v[136:139], a[136:139], v[96:99], v[136:139]
  v_mfma_f32_16x16x32_bf16 v[140:143], a[140:143], v[96:99], v[140:143]
  ds_read_b128 v[88:91], v22 offset:1024
  v_mfma_f32_16x16x32_bf16 v[140:143], a[132:135], v[92:95], v[140:143]
  s_mov_b32 s55, 229376
  s_add_u32 m0, s45, 110592
  v_mfma_f32_16x16x32_bf16 v[136:139], a[144:147], v[104:107], v[136:139]
  ds_read_b128 v[96:99], v22 offset:2048
  v_mfma_f32_16x16x32_bf16 v[136:139], a[152:155], v[100:103], v[136:139]
  buffer_load_dwordx4 v11, s[32:35], s55 offen lds
  v_mfma_f32_16x16x32_bf16 v[140:143], a[156:159], v[100:103], v[140:143]
  ds_read_b128 v[92:95], v22 offset:3072
  v_mfma_f32_16x16x32_bf16 v[140:143], a[148:151], v[104:107], v[140:143]
  s_waitcnt lgkmcnt(4)
  v_mfma_f32_16x16x32_bf16 v[136:139], a[160:163], v[108:111], v[136:139]
  ds_read_b128 v[100:103], v22 offset:4096
  v_mfma_f32_16x16x32_bf16 v[136:139], a[168:171], v[112:115], v[136:139]
  s_mov_b32 s55, 458752
  s_add_u32 m0, s45, 114688
  v_mfma_f32_16x16x32_bf16 v[140:143], a[172:175], v[112:115], v[140:143]
  ds_read_b128 v[104:107], v22 offset:5120
  v_mfma_f32_16x16x32_bf16 v[140:143], a[164:167], v[108:111], v[140:143]
  buffer_load_dwordx4 v11, s[28:31], s55 offen lds
  v_mfma_f32_16x16x32_bf16 v[136:139], a[176:179], v[80:83], v[136:139]
  ds_read_b128 v[112:115], v22 offset:6144
  s_waitcnt vmcnt(63) lgkmcnt(15)
  v_mfma_f32_16x16x32_bf16 v[136:139], a[184:187], v[76:79], v[136:139]
  v_lshlrev_b32 v184, 16, v156
  v_and_b32 v185, 0xffff0000, v156
  v_mfma_f32_16x16x32_bf16 v[140:143], a[188:191], v[76:79], v[140:143]
  ds_read_b128 v[108:111], v22 offset:7168
  v_lshlrev_b32 v186, 16, v157
  v_mfma_f32_16x16x32_bf16 v[140:143], a[180:183], v[80:83], v[140:143]
  s_waitcnt lgkmcnt(4)
  s_mov_b32 s55, 458752
  s_add_u32 m0, s45, 122880
  v_mfma_f32_16x16x32_bf16 v[136:139], a[192:195], v[84:87], v[136:139]
  buffer_load_dwordx4 v11, s[32:35], s55 offen lds
  v_and_b32 v187, 0xffff0000, v157
  v_lshlrev_b32 v188, 16, v158
  v_mfma_f32_16x16x32_bf16 v[136:139], a[200:203], v[88:91], v[136:139]
  v_and_b32 v189, 0xffff0000, v158
  v_lshlrev_b32 v190, 16, v159
  v_mfma_f32_16x16x32_bf16 v[140:143], a[204:207], v[88:91], v[140:143]
  v_and_b32 v191, 0xffff0000, v159
  v_mfma_f32_16x16x32_bf16 v[140:143], a[196:199], v[84:87], v[140:143]
  v_mfma_f32_16x16x32_bf16 v[136:139], a[208:211], v[96:99], v[136:139]
  v_mfma_f32_16x16x32_bf16 v[136:139], a[216:219], v[92:95], v[136:139]
  s_mov_b32 s55, 688128
  s_add_u32 m0, s45, 118784
  v_mfma_f32_16x16x32_bf16 v[140:143], a[220:223], v[92:95], v[140:143]
  buffer_load_dwordx4 v11, s[28:31], s55 offen lds
  v_mfma_f32_16x16x32_bf16 v[140:143], a[212:215], v[96:99], v[140:143]
  s_waitcnt lgkmcnt(0)
  v_mfma_f32_16x16x32_bf16 v[136:139], a[224:227], v[100:103], v[136:139]
  v_mfma_f32_16x16x32_bf16 v[136:139], a[232:235], v[104:107], v[136:139]
  v_mfma_f32_16x16x32_bf16 v[140:143], a[236:239], v[104:107], v[140:143]
  v_mfma_f32_16x16x32_bf16 v[140:143], a[228:231], v[100:103], v[140:143]
  s_mov_b32 s55, 688128
  s_add_u32 m0, s45, 126976
  v_mfma_f32_16x16x32_bf16 v[136:139], a[240:243], v[112:115], v[136:139]
  buffer_load_dwordx4 v11, s[32:35], s55 offen lds
  v_mfma_f32_16x16x32_bf16 v[136:139], a[248:251], v[108:111], v[136:139]
  v_mfma_f32_16x16x32_bf16 v[140:143], v[124:127], v[108:111], v[140:143]
  v_mfma_f32_16x16x32_bf16 v[140:143], a[244:247], v[112:115], v[140:143]
  s_nop 5
  v_fmac_f32 v184, v160, v136
  v_fmac_f32 v185, v161, v137
  v_fmac_f32 v186, v162, v138
  v_fmac_f32 v187, v163, v139
  v_fmac_f32 v188, v164, v140
  v_fmac_f32 v189, v165, v141
  v_fmac_f32 v190, v166, v142
  v_fmac_f32 v191, v167, v143
  v_mul_f32 v136, v184, v168
  v_mul_f32 v137, v185, v169
  v_mul_f32 v138, v186, v170
  v_mul_f32 v139, v187, v171
  v_mul_f32 v140, v188, v172
  v_mul_f32 v141, v189, v173
  v_mul_f32 v142, v190, v174
  v_mul_f32 v143, v191, v175
  v_cvt_pk_bf16_f32 v208, v136, v137
  v_cvt_pk_bf16_f32 v209, v138, v139
  v_cvt_pk_bf16_f32 v210, v140, v141
  v_cvt_pk_bf16_f32 v211, v142, v143
  s_add_u32 s54, s47, 36896768
  buffer_store_dwordx4 v[208:211], v1, s[8:11], s54 offen sc1
  v_cvt_pk_bf16_f32 v156, v184, v185
  v_cvt_pk_bf16_f32 v157, v186, v187
  v_cvt_pk_bf16_f32 v158, v188, v189
  v_cvt_pk_bf16_f32 v159, v190, v191
  s_nop 1
  v_mfma_f32_16x16x32_bf16 v[230:233], v[176:179], v[156:159], 0
  v_mfma_f32_16x16x32_bf16 v[192:195], v[156:159], v[156:159], 0
  s_nop 7
  v_cndmask_b32 v192, v192, v193, s[88:89]
  v_cndmask_b32 v194, v194, v195, s[88:89]
  v_cndmask_b32 v231, v192, v194, s[90:91]
  buffer_store_dwordx4 v[228:231], v180, s[8:11], s48 offen offset:256 sc1
  s_waitcnt lgkmcnt(0)
  s_and_b32 s52, s2, 7
  s_bfe_u32 s51, s2, 0x20003
  s_lshr_b32 s50, s2, 5
  s_add_u32 s56, s51, s50
  s_and_b32 s56, s56, 3
  s_lshl_b32 s53, s50, 1
  s_lshr_b32 s54, s44, 1
  s_add_u32 s53, s53, s54
  s_lshl_b32 s63, s53, 3
  s_and_b32 s55, s44, 1
  s_add_u32 s63, s63, s55
  s_lshl_b32 s57, s63, 15
  s_add_u32 s57, s57, 36700160
  s_lshl_b32 s53, s50, 12
  s_add_u32 s82, s53, 753664
  v_and_b32 v15, 31, v0
  v_lshlrev_b32 v15, 7, v15
  v_lshrrev_b32 v33, 2, v0
  v_bfe_u32 v32, v33, 1, 2
  v_lshlrev_b32 v32, 5, v32
  v_lshl_add_u32 v32, v33, 7, v32
  v_and_b32 v33, 3, v0
  v_lshl_add_u32 v2, v33, 3, v32
  v_xor_b32 v3, 32, v2
  v_xor_b32 v4, 64, v2
  v_xor_b32 v5, 96, v2
  v_add_u32 v6, 65536, v2
  v_add_u32 v7, 65536, v3
  v_add_u32 v8, 65536, v4
  s_lshl_b32 s80, s2, 7
  s_lshl_b32 s53, s44, 28
  s_add_u32 s80, s80, s53
  s_add_u32 s80, s80, 884736
  s_lshl_b32 s53, s2, 2
  s_add_u32 s53, s53, s44
  s_lshl_b32 s53, s53, 7
  s_add_u32 s81, s53, 917504
  s_sub_u32 s60, s82, 524288
  s_lshl_b32 s83, s44, 28
  s_add_u32 s83, s83, s60
  buffer_load_dword v13, v15, s[8:11], s83 offen sc1
  s_waitcnt vmcnt(11)
  v_add_f32 v212, v212, v214
  v_add_f32 v216, v216, v218
  v_add_f32 v212, v212, v216
  v_add_f32 v213, v213, v215
  v_add_f32 v217, v217, v219
  v_add_f32 v213, v213, v217
  v_lshrrev_b32 v32, 5, v0
  v_xor_b32 v33, 1, v32
  v_cvt_f32_u32 v33, v33
  v_cvt_pk_bf16_f32 v214, v212, v213
  v_lshlrev_b32 v212, 16, v214
  v_and_b32 v213, 0xffff0000, v214
  v_add_f32 v212, v212, v33
  v_add_f32 v213, v213, v33
  v_cvt_pk_bf16_f32 v214, v212, v213
  v_lshlrev_b32 v212, 16, v214
  v_and_b32 v213, 0xffff0000, v214
  v_lshrrev_b32 v215, 16, v214
  v_and_b32 v214, 0xffff, v214
  s_add_u32 s53, s45, 151552
  v_lshlrev_b32 v32, 8, v32
  v_lshl_add_u32 v32, v0, 3, v32
  v_add_u32 v32, s53, v32
  ds_write_b64 v32, v[214:215]
  ds_write_b64 v32, v[212:213] offset:256
  s_bitcmp1_b32 s2, 3
  s_cselect_b64 s[12:13], s[32:33], s[28:29]
  s_mov_b32 s14, 7340032
  s_mov_b32 s16, 0x03030303
  s_mov_b32 s17, 0x03030303
  s_mov_b32 s18, 0x0c0c0c0c
  s_mov_b32 s19, 0x0c0c0c0c
  s_mov_b32 s20, 0x30303030
  s_mov_b32 s21, 0x30303030
  s_mov_b32 s22, 0xc0c0c0c0
  s_mov_b32 s23, 0xc0c0c0c0
  s_waitcnt vmcnt(7)
  v_add_u32 v9, s46, v0
  s_waitcnt vmcnt(1)
  s_barrier
  s_mov_b64 exec, 1
  buffer_store_dword v9, v0, s[8:11], s49 offen offset:0 sc1
  s_mov_b64 exec, -1
  s_mov_b32 s55, 458752
  s_add_u32 m0, s45, 49152
  s_nop 0
  buffer_load_dwordx4 v16, s[28:31], s55 offen lds
  s_mov_b32 s55, 458752
  s_add_u32 m0, s45, 57344
  s_nop 0
  buffer_load_dwordx4 v16, s[32:35], s55 offen lds
  s_mov_b32 s55, 688128
  s_add_u32 m0, s45, 53248
  s_nop 0
  buffer_load_dwordx4 v16, s[28:31], s55 offen lds
  s_mov_b32 s55, 688128
  s_add_u32 m0, s45, 61440
  s_nop 0
  buffer_load_dwordx4 v16, s[32:35], s55 offen lds
  ds_write_b128 v182, v[144:147] offset:0
  ds_write_b128 v182, v[148:151] offset:4096
  ds_write_b128 v182, v[152:155] offset:8192
  ds_write_b128 v182, v[156:159] offset:12288
  v_mov_b32 v10, v16
  s_waitcnt vmcnt(5)
  s_cmp_lg_u32 s44, 0
  s_cbranch_scc1 PL9_adaLN_cond__sliding_local_dilated__swiglu_ffn__prompt_kernelx
  v_cmp_ne_u32 vcc, s46, v13
  s_nop 4
  s_cbranch_vccz PL9_adaLN_cond__sliding_local_dilated__swiglu_ffn__prompt_kernelx
  s_mov_b32 s83, 60000
PL9_adaLN_cond__sliding_local_dilated__swiglu_ffn__prompt_kernel:
  buffer_load_dword v13, v15, s[8:11], s60 offen sc1
  s_sub_u32 s83, s83, 1
  s_cmp_eq_u32 s83, 0
  s_waitcnt vmcnt(0)
  s_cbranch_scc1 PL9_adaLN_cond__sliding_local_dilated__swiglu_ffn__prompt_kernelx
  v_cmp_ne_u32 vcc, s46, v13
  s_nop 4
  s_cbranch_vccnz PL9_adaLN_cond__sliding_local_dilated__swiglu_ffn__prompt_kernel
PL9_adaLN_cond__sliding_local_dilated__swiglu_ffn__prompt_kernelx:
  s_barrier
  s_mov_b32 s64, 0
  s_add_u32 s72, s57, 0
  buffer_load_dwordx4 a[0:3], v1, s[8:11], s72 offen offset:0 sc1
  buffer_load_dwordx4 a[16:19], v1, s[8:11], s72 offen offset:1024 sc1
  s_add_u32 s72, s72, 65536
  buffer_load_dwordx4 a[4:7], v1, s[8:11], s72 offen offset:0 sc1
  buffer_load_dwordx4 a[20:23], v1, s[8:11], s72 offen offset:1024 sc1
  s_mov_b32 s65, 458752
  s_add_u32 s73, s57, 2048
  buffer_load_dwordx4 a[32:35], v1, s[8:11], s73 offen offset:0 sc1
  buffer_load_dwordx4 a[48:51], v1, s[8:11], s73 offen offset:1024 sc1
  s_add_u32 s73, s73, 65536
  buffer_load_dwordx4 a[36:39], v1, s[8:11], s73 offen offset:0 sc1
  buffer_load_dwordx4 a[52:55], v1, s[8:11], s73 offen offset:1024 sc1
  s_mov_b64 exec, 0
  s_cmp_eq_u32 s44, 0
  s_cbranch_scc1 HOP15
  s_cmp_eq_u32 s44, 1
  s_cbranch_scc1 HOP16
  s_cmp_eq_u32 s44, 2
  s_cbranch_scc1 HOP17
  s_cmp_eq_u32 s44, 3
  s_cbranch_scc1 HOP18
WRET1:
  s_mov_b64 exec, -1
  v_bfe_u32 v32, v0, 3, 1
  v_lshlrev_b32 v32, 9, v32
  v_and_b32 v33, 1, v0
  v_lshl_add_u32 v32, v33, 8, v32
  v_lshrrev_b32 v33, 4, v0
  v_lshl_add_u32 v32, v33, 6, v32
  v_add_u32 v14, s53, v32
  s_bfe_u32 s53, s2, 0x20004
  s_lshl_b32 s53, s53, 8
  v_and_b32 v32, 15, v0
  v_lshl_add_u32 v32, v32, 4, s53
  v_cmp_gt_u32 vcc, 896, v32
  v_mov_b32 v34, 1073741824
  v_mul_u32_u24 v33, 114688, v33
  v_cndmask_b32 v32, v34, v32, vcc
  s_lshr_b32 s53, s2, 6
  s_lshl_b32 s53, s53, 2
  s_add_u32 s53, s53, s44
  s_mul_i32 s53, s53, 458752
  s_mul_i32 s54, s52, 896
  s_add_u32 s53, s53, s54
  v_add3_u32 v13, v32, v33, s53
  ds_read_b64_tr_b16 a[160:161], v6 offset:32768
  ds_read_b64_tr_b16 a[162:163], v6 offset:34816
  ds_read_b64_tr_b16 a[164:165], v6 offset:36864
  ds_read_b64_tr_b16 a[166:167], v6 offset:38912
  ds_read_b64_tr_b16 a[168:169], v6 offset:40960
  ds_read_b64_tr_b16 a[170:171], v6 offset:43008
  ds_read_b64_tr_b16 a[172:173], v6 offset:45056
  ds_read_b64_tr_b16 a[174:175], v6 offset:47104
  ds_read_b64_tr_b16 a[176:177], v7 offset:32768
  ds_read_b64_tr_b16 a[178:179], v7 offset:34816
  ds_read_b64_tr_b16 a[180:181], v7 offset:36864
  ds_read_b64_tr_b16 a[182:183], v7 offset:38912
  ds_read_b64_tr_b16 a[188:189], v7 offset:40960
  ds_read_b64_tr_b16 a[190:191], v7 offset:43008
  ds_read_b64_tr_b16 a[192:193], v7 offset:45056
  ds_read_b64_tr_b16 a[194:195], v7 offset:47104
  s_waitcnt vmcnt(4) lgkmcnt(8)
  v_mfma_f32_16x16x32_bf16 v[64:67], a[160:163], a[0:3], 0
  ds_read_b64_tr_b16 a[196:197], v8 offset:32768
  s_mov_b32 s66, 917504
  s_add_u32 s74, s57, 4096
  s_add_u32 m0, s45, 81920
  v_mfma_f32_16x16x32_bf16 v[64:67], a[164:167], a[16:19], v[64:67]
  ds_read_b64_tr_b16 a[198:199], v8 offset:34816
  buffer_load_dwordx4 v11, s[28:31], s66 offen lds
  v_mfma_f32_16x16x32_bf16 v[68:71], a[164:167], a[20:23], 0
  ds_read_b64_tr_b16 a[200:201], v8 offset:36864
  v_mfma_f32_16x16x32_bf16 v[68:71], a[160:163], a[4:7], v[68:71]
  ds_read_b64_tr_b16 a[202:203], v8 offset:38912
  v_mfma_f32_16x16x32_bf16 v[84:87], a[168:171], a[4:7], 0
  ds_read_b64_tr_b16 a[204:205], v8 offset:40960
  s_add_u32 m0, s45, 90112
  v_mfma_f32_16x16x32_bf16 v[84:87], a[172:175], a[20:23], v[84:87]
  ds_read_b64_tr_b16 a[206:207], v8 offset:43008
  buffer_load_dwordx4 v11, s[32:35], s66 offen lds
  v_mfma_f32_16x16x32_bf16 v[80:83], a[172:175], a[16:19], 0
  ds_read_b64_tr_b16 a[208:209], v8 offset:45056
  v_mfma_f32_16x16x32_bf16 v[80:83], a[168:171], a[0:3], v[80:83]
  s_waitcnt lgkmcnt(7)
  ds_read_b64_tr_b16 a[210:211], v8 offset:47104
  v_mfma_f32_16x16x32_bf16 v[96:99], a[176:179], a[0:3], 0
  ds_read_b64_tr_b16 a[164:165], v2 offset:32768
  s_add_u32 m0, s45, 86016
  s_add_u32 s61, s66, 229376
  v_mfma_f32_16x16x32_bf16 v[96:99], a[180:183], a[16:19], v[96:99]
  ds_read_b64_tr_b16 a[166:167], v2 offset:34816
  buffer_load_dwordx4 v11, s[28:31], s61 offen lds
  v_mfma_f32_16x16x32_bf16 v[100:103], a[180:183], a[20:23], 0
  ds_read_b64_tr_b16 a[160:161], v2 offset:36864
  v_mfma_f32_16x16x32_bf16 v[100:103], a[176:179], a[4:7], v[100:103]
  ds_read_b64_tr_b16 a[162:163], v2 offset:38912
  v_mfma_f32_16x16x32_bf16 v[116:119], a[188:191], a[4:7], 0
  ds_read_b64_tr_b16 a[172:173], v2 offset:40960
  s_add_u32 m0, s45, 94208
  s_add_u32 s61, s66, 229376
  v_mfma_f32_16x16x32_bf16 v[116:119], a[192:195], a[20:23], v[116:119]
  ds_read_b64_tr_b16 a[174:175], v2 offset:43008
  buffer_load_dwordx4 v11, s[32:35], s61 offen lds
  v_mfma_f32_16x16x32_bf16 v[112:115], a[192:195], a[16:19], 0
  ds_read_b64_tr_b16 a[168:169], v2 offset:45056
  v_mfma_f32_16x16x32_bf16 v[112:115], a[188:191], a[0:3], v[112:115]
  s_waitcnt lgkmcnt(7)
  ds_read_b64_tr_b16 a[170:171], v2 offset:47104
  v_mfma_f32_16x16x32_bf16 v[32:35], a[196:199], a[0:3], 0
  ds_read_b64_tr_b16 a[180:181], v3 offset:32768
  s_add_u32 m0, s45, 16384
  v_mfma_f32_16x16x32_bf16 v[32:35], a[200:203], a[16:19], v[32:35]
  ds_read_b64_tr_b16 a[182:183], v3 offset:34816
  buffer_load_dwordx4 v10, s[28:31], s66 offen lds
  v_mfma_f32_16x16x32_bf16 v[36:39], a[200:203], a[20:23], 0
  ds_read_b64_tr_b16 a[176:177], v3 offset:36864
  v_mfma_f32_16x16x32_bf16 v[36:39], a[196:199], a[4:7], v[36:39]
  ds_read_b64_tr_b16 a[178:179], v3 offset:38912
  v_mfma_f32_16x16x32_bf16 v[52:55], a[204:207], a[4:7], 0
  ds_read_b64_tr_b16 a[192:193], v3 offset:40960
  s_add_u32 m0, s45, 24576
  v_mfma_f32_16x16x32_bf16 v[52:55], a[208:211], a[20:23], v[52:55]
  ds_read_b64_tr_b16 a[194:195], v3 offset:43008
  buffer_load_dwordx4 v10, s[32:35], s66 offen lds
  v_mfma_f32_16x16x32_bf16 v[48:51], a[208:211], a[16:19], 0
  ds_read_b64_tr_b16 a[188:189], v3 offset:45056
  s_lshl_b32 s58, s51, 12
  v_mfma_f32_16x16x32_bf16 v[48:51], a[204:207], a[0:3], v[48:51]
  s_waitcnt lgkmcnt(7)
  ds_read_b64_tr_b16 a[190:191], v3 offset:47104
  v_mfma_f32_16x16x32_bf16 v[128:131], a[164:167], a[0:3], 0
  ds_read_b64_tr_b16 a[200:201], v4 offset:32768
  s_add_u32 m0, s45, 20480
  s_add_u32 s61, s66, 229376
  v_mfma_f32_16x16x32_bf16 v[128:131], a[160:163], a[16:19], v[128:131]
  ds_read_b64_tr_b16 a[202:203], v4 offset:34816
  s_lshl_b32 s83, s44, 28
  s_add_u32 s83, s83, s82
  buffer_load_dword v9, v15, s[8:11], s83 offen sc1
  v_mfma_f32_16x16x32_bf16 v[132:135], a[160:163], a[20:23], 0
  ds_read_b64_tr_b16 a[196:197], v4 offset:36864
  buffer_load_dwordx4 v10, s[28:31], s61 offen lds
  v_mfma_f32_16x16x32_bf16 v[132:135], a[164:167], a[4:7], v[132:135]
  ds_read_b64_tr_b16 a[198:199], v4 offset:38912
  s_lshl_b32 s54, s51, 3
  v_mfma_f32_16x16x32_bf16 v[148:151], a[172:175], a[4:7], 0
  ds_read_b64_tr_b16 a[208:209], v4 offset:40960
  s_add_u32 m0, s45, 28672
  s_add_u32 s61, s66, 229376
  v_mfma_f32_16x16x32_bf16 v[148:151], a[168:171], a[20:23], v[148:151]
  ds_read_b64_tr_b16 a[210:211], v4 offset:43008
  buffer_load_dwordx4 v10, s[32:35], s61 offen lds
  v_mfma_f32_16x16x32_bf16 v[144:147], a[168:171], a[16:19], 0
  ds_read_b64_tr_b16 a[204:205], v4 offset:45056
  s_lshr_b32 s53, 0x0b070602, s54
  v_mfma_f32_16x16x32_bf16 v[144:147], a[172:175], a[0:3], v[144:147]
  s_waitcnt lgkmcnt(7)
  ds_read_b64_tr_b16 a[206:207], v4 offset:47104
  v_mfma_f32_16x16x32_bf16 v[160:163], a[180:183], a[0:3], 0
  ds_read_b64_tr_b16 a[160:161], v5 offset:32768
  v_mfma_f32_16x16x32_bf16 v[160:163], a[176:179], a[16:19], v[160:163]
  ds_read_b64_tr_b16 a[162:163], v5 offset:34816
  buffer_load_dwordx4 a[64:67], v1, s[8:11], s74 offen offset:0 sc1
  v_mfma_f32_16x16x32_bf16 v[164:167], a[176:179], a[20:23], 0
  ds_read_b64_tr_b16 a[164:165], v5 offset:36864
  s_and_b32 s53, s53, 15
  v_mfma_f32_16x16x32_bf16 v[164:167], a[180:183], a[4:7], v[164:167]
  ds_read_b64_tr_b16 a[166:167], v5 offset:38912
  s_lshl_b32 s59, s53, 10
  v_mfma_f32_16x16x32_bf16 v[180:183], a[192:195], a[4:7], 0
  ds_read_b64_tr_b16 a[168:169], v5 offset:40960
  s_lshr_b32 s53, s51, 1
  v_mfma_f32_16x16x32_bf16 v[180:183], a[188:191], a[20:23], v[180:183]
  ds_read_b64_tr_b16 a[170:171], v5 offset:43008
  buffer_load_dwordx4 a[80:83], v1, s[8:11], s74 offen offset:1024 sc1
  v_mfma_f32_16x16x32_bf16 v[176:179], a[188:191], a[16:19], 0
  ds_read_b64_tr_b16 a[172:173], v5 offset:45056
  s_mul_i32 s53, s53, 7168
  v_mfma_f32_16x16x32_bf16 v[176:179], a[192:195], a[0:3], v[176:179]
  s_waitcnt lgkmcnt(7)
  ds_read_b64_tr_b16 a[174:175], v5 offset:47104
  s_waitcnt vmcnt(19)
  s_barrier
  v_mfma_f32_16x16x32_bf16 v[192:195], a[200:203], a[0:3], 0
  ds_read_b64_tr_b16 a[176:177], v6 offset:49152
  s_add_u32 s74, s74, 65536
  v_mfma_f32_16x16x32_bf16 v[192:195], a[196:199], a[16:19], v[192:195]
  ds_read_b64_tr_b16 a[178:179], v6 offset:51200
  buffer_load_dwordx4 a[68:71], v1, s[8:11], s74 offen offset:0 sc1
  v_mfma_f32_16x16x32_bf16 v[196:199], a[196:199], a[20:23], 0
  ds_read_b64_tr_b16 a[180:181], v6 offset:53248
  s_and_b32 s54, s54, 8
  v_mfma_f32_16x16x32_bf16 v[196:199], a[200:203], a[4:7], v[196:199]
  ds_read_b64_tr_b16 a[182:183], v6 offset:55296
  s_add_u32 s53, s53, s54
  v_mfma_f32_16x16x32_bf16 v[212:215], a[208:211], a[4:7], 0
  ds_read_b64_tr_b16 a[188:189], v6 offset:57344
  s_add_u32 s60, s53, 3072
  v_mfma_f32_16x16x32_bf16 v[212:215], a[204:207], a[20:23], v[212:215]
  ds_read_b64_tr_b16 a[190:191], v6 offset:59392
  buffer_load_dwordx4 a[84:87], v1, s[8:11], s74 offen offset:1024 sc1
  v_mfma_f32_16x16x32_bf16 v[208:211], a[204:207], a[16:19], 0
  ds_read_b64_tr_b16 a[192:193], v6 offset:61440
  s_mul_i32 s53, s52, 14336
  v_mfma_f32_16x16x32_bf16 v[208:211], a[208:211], a[0:3], v[208:211]
  s_waitcnt lgkmcnt(7)
  ds_read_b64_tr_b16 a[194:195], v6 offset:63488
  v_mfma_f32_16x16x32_bf16 v[224:227], a[160:163], a[0:3], 0
  ds_read_b64_tr_b16 a[196:197], v7 offset:49152
  s_mov_b32 s67, 1376256
  s_add_u32 s75, s57, 6144
  s_add_u32 m0, s45, 65536
  v_mfma_f32_16x16x32_bf16 v[224:227], a[164:167], a[16:19], v[224:227]
  ds_read_b64_tr_b16 a[198:199], v7 offset:51200
  buffer_load_dwordx4 v11, s[28:31], s67 offen lds
  v_mfma_f32_16x16x32_bf16 v[228:231], a[164:167], a[20:23], 0
  ds_read_b64_tr_b16 a[200:201], v7 offset:53248
  s_mul_i32 s54, s63, 131072
  v_mfma_f32_16x16x32_bf16 v[228:231], a[160:163], a[4:7], v[228:231]
  ds_read_b64_tr_b16 a[202:203], v7 offset:55296
  s_add_u32 s53, s53, s54
  v_mfma_f32_16x16x32_bf16 v[244:247], a[168:171], a[4:7], 0
  ds_read_b64_tr_b16 a[204:205], v7 offset:57344
  s_add_u32 m0, s45, 73728
  v_mfma_f32_16x16x32_bf16 v[244:247], a[172:175], a[20:23], v[244:247]
  ds_read_b64_tr_b16 a[206:207], v7 offset:59392
  buffer_load_dwordx4 v11, s[32:35], s67 offen lds
  v_mfma_f32_16x16x32_bf16 v[240:243], a[172:175], a[16:19], 0
  ds_read_b64_tr_b16 a[208:209], v7 offset:61440
  s_add_u32 s53, s53, 19922944
  v_mfma_f32_16x16x32_bf16 v[240:243], a[168:171], a[0:3], v[240:243]
  s_waitcnt vmcnt(15) lgkmcnt(7)
  ds_read_b64_tr_b16 a[210:211], v7 offset:63488
  v_mfma_f32_16x16x32_bf16 v[64:67], a[176:179], a[32:35], v[64:67]
  ds_read_b64_tr_b16 a[164:165], v8 offset:49152
  s_add_u32 m0, s45, 69632
  s_add_u32 s61, s67, 229376
  v_mfma_f32_16x16x32_bf16 v[64:67], a[180:183], a[48:51], v[64:67]
  ds_read_b64_tr_b16 a[166:167], v8 offset:51200
  buffer_load_dwordx4 v11, s[28:31], s61 offen lds
  v_mfma_f32_16x16x32_bf16 v[68:71], a[180:183], a[52:55], v[68:71]
  ds_read_b64_tr_b16 a[160:161], v8 offset:53248
  s_add_u32 s58, s58, s53
  v_mfma_f32_16x16x32_bf16 v[68:71], a[176:179], a[36:39], v[68:71]
  ds_read_b64_tr_b16 a[162:163], v8 offset:55296
  s_add_u32 s59, s59, s53
  v_mfma_f32_16x16x32_bf16 v[84:87], a[188:191], a[36:39], v[84:87]
  ds_read_b64_tr_b16 a[172:173], v8 offset:57344
  s_add_u32 m0, s45, 77824
  s_add_u32 s61, s67, 229376
  v_mfma_f32_16x16x32_bf16 v[84:87], a[192:195], a[52:55], v[84:87]
  ds_read_b64_tr_b16 a[174:175], v8 offset:59392
  buffer_load_dwordx4 v11, s[32:35], s61 offen lds
  v_mfma_f32_16x16x32_bf16 v[80:83], a[192:195], a[48:51], v[80:83]
  ds_read_b64_tr_b16 a[168:169], v8 offset:61440
  s_add_u32 s60, s60, s53
  v_mfma_f32_16x16x32_bf16 v[80:83], a[188:191], a[32:35], v[80:83]
  s_waitcnt lgkmcnt(7)
HOP7:
  s_cbranch_execz HOP11
  ds_read_b64_tr_b16 a[170:171], v8 offset:63488
  v_mfma_f32_16x16x32_bf16 v[96:99], a[196:199], a[32:35], v[96:99]
  ds_read_b64_tr_b16 a[180:181], v2 offset:49152
  s_add_u32 m0, s45, 0
  v_mfma_f32_16x16x32_bf16 v[96:99], a[200:203], a[48:51], v[96:99]
  ds_read_b64_tr_b16 a[182:183], v2 offset:51200
  s_waitcnt vmcnt(10)
  s_cmp_lg_u32 s44, 0
  s_cbranch_scc1 PL10_adaLN_cond__sliding_local_dilated__swiglu_ffn__prompt_kernelx
  v_cmp_ne_u32 vcc, s46, v9
  s_nop 4
  s_cbranch_vccz PL10_adaLN_cond__sliding_local_dilated__swiglu_ffn__prompt_kernelx
  s_mov_b32 s83, 60000
PL10_adaLN_cond__sliding_local_dilated__swiglu_ffn__prompt_kernel:
  buffer_load_dword v9, v15, s[8:11], s82 offen sc1
  s_sub_u32 s83, s83, 1
  s_cmp_eq_u32 s83, 0
  s_waitcnt vmcnt(0)
  s_cbranch_scc1 PL10_adaLN_cond__sliding_local_dilated__swiglu_ffn__prompt_kernelx
  v_cmp_ne_u32 vcc, s46, v9
  s_nop 4
  s_cbranch_vccnz PL10_adaLN_cond__sliding_local_dilated__swiglu_ffn__prompt_kernel
PL10_adaLN_cond__sliding_local_dilated__swiglu_ffn__prompt_kernelx:
  s_barrier
  v_mfma_f32_16x16x32_bf16 v[100:103], a[200:203], a[52:55], v[100:103]
  ds_read_b64_tr_b16 a[176:177], v2 offset:53248
  buffer_load_dwordx4 v10, s[28:31], s67 offen lds
  v_mfma_f32_16x16x32_bf16 v[100:103], a[196:199], a[36:39], v[100:103]
  ds_read_b64_tr_b16 a[178:179], v2 offset:55296
  s_lshl_b32 s63, s50, 2
  v_mfma_f32_16x16x32_bf16 v[116:119], a[204:207], a[36:39], v[116:119]
  ds_read_b64_tr_b16 a[192:193], v2 offset:57344
  s_add_u32 m0, s45, 8192
  v_mfma_f32_16x16x32_bf16 v[116:119], a[208:211], a[52:55], v[116:119]
  ds_read_b64_tr_b16 a[194:195], v2 offset:59392
  buffer_load_dwordx4 v10, s[32:35], s67 offen lds
  v_mfma_f32_16x16x32_bf16 v[112:115], a[208:211], a[48:51], v[112:115]
  ds_read_b64_tr_b16 a[188:189], v2 offset:61440
  s_add_u32 s63, s63, s44
  v_mfma_f32_16x16x32_bf16 v[112:115], a[204:207], a[32:35], v[112:115]
  s_waitcnt lgkmcnt(7)
  ds_read_b64_tr_b16 a[190:191], v2 offset:63488
  v_mfma_f32_16x16x32_bf16 v[32:35], a[164:167], a[32:35], v[32:35]
  ds_read_b64_tr_b16 a[200:201], v3 offset:49152
  s_add_u32 m0, s45, 4096
  s_add_u32 s61, s67, 229376
  v_mfma_f32_16x16x32_bf16 v[32:35], a[160:163], a[48:51], v[32:35]
  ds_read_b64_tr_b16 a[202:203], v3 offset:51200
  buffer_load_dwordx4 v10, s[28:31], s61 offen lds
  v_mfma_f32_16x16x32_bf16 v[36:39], a[160:163], a[52:55], v[36:39]
  ds_read_b64_tr_b16 a[196:197], v3 offset:53248
  s_lshl_b32 s63, s63, 14
  v_mfma_f32_16x16x32_bf16 v[36:39], a[164:167], a[36:39], v[36:39]
  ds_read_b64_tr_b16 a[198:199], v3 offset:55296
  s_add_u32 s63, s63, 6291456
  v_mfma_f32_16x16x32_bf16 v[52:55], a[172:175], a[36:39], v[52:55]
  ds_read_b64_tr_b16 a[208:209], v3 offset:57344
  s_add_u32 m0, s45, 12288
  s_add_u32 s61, s67, 229376
  v_mfma_f32_16x16x32_bf16 v[52:55], a[168:171], a[52:55], v[52:55]
  ds_read_b64_tr_b16 a[210:211], v3 offset:59392
  buffer_load_dwordx4 v10, s[32:35], s61 offen lds
  v_mfma_f32_16x16x32_bf16 v[48:51], a[168:171], a[48:51], v[48:51]
  ds_read_b64_tr_b16 a[204:205], v3 offset:61440
  v_and_b32 v12, 0x300, v1
  v_mfma_f32_16x16x32_bf16 v[48:51], a[172:175], a[32:35], v[48:51]
  s_waitcnt lgkmcnt(7)
  ds_read_b64_tr_b16 a[206:207], v3 offset:63488
  v_mfma_f32_16x16x32_bf16 v[128:131], a[180:183], a[32:35], v[128:131]
  ds_read_b64_tr_b16 a[160:161], v4 offset:49152
  s_add_u32 s72, s72, 65536
  v_mfma_f32_16x16x32_bf16 v[128:131], a[176:179], a[48:51], v[128:131]
  ds_read_b64_tr_b16 a[162:163], v4 offset:51200
  buffer_load_dwordx4 a[8:11], v1, s[8:11], s72 offen offset:0 sc1
  v_mfma_f32_16x16x32_bf16 v[132:135], a[176:179], a[52:55], v[132:135]
  ds_read_b64_tr_b16 a[164:165], v4 offset:53248
  v_add_u32 v12, v12, v1
  v_mfma_f32_16x16x32_bf16 v[132:135], a[180:183], a[36:39], v[132:135]
  ds_read_b64_tr_b16 a[166:167], v4 offset:55296
  buffer_load_dwordx4 a[24:27], v1, s[8:11], s72 offen offset:1024 sc1
  v_mfma_f32_16x16x32_bf16 v[148:151], a[192:195], a[36:39], v[148:151]
  ds_read_b64_tr_b16 a[168:169], v4 offset:57344
  s_add_u32 s72, s72, 65536
  v_mfma_f32_16x16x32_bf16 v[148:151], a[188:191], a[52:55], v[148:151]
  ds_read_b64_tr_b16 a[170:171], v4 offset:59392
  buffer_load_dwordx4 a[12:15], v1, s[8:11], s72 offen offset:0 sc1
  v_mfma_f32_16x16x32_bf16 v[144:147], a[188:191], a[48:51], v[144:147]
  ds_read_b64_tr_b16 a[172:173], v4 offset:61440
  v_mfma_f32_16x16x32_bf16 v[144:147], a[192:195], a[32:35], v[144:147]
  s_waitcnt lgkmcnt(7)
  ds_read_b64_tr_b16 a[174:175], v4 offset:63488
  buffer_load_dwordx4 a[28:31], v1, s[8:11], s72 offen offset:1024 sc1
  v_mfma_f32_16x16x32_bf16 v[160:163], a[200:203], a[32:35], v[160:163]
  ds_read_b64_tr_b16 a[176:177], v5 offset:49152
  s_add_u32 s73, s73, 65536
  v_mfma_f32_16x16x32_bf16 v[160:163], a[196:199], a[48:51], v[160:163]
  ds_read_b64_tr_b16 a[178:179], v5 offset:51200
  buffer_load_dwordx4 a[40:43], v1, s[8:11], s73 offen offset:0 sc1
  v_mfma_f32_16x16x32_bf16 v[164:167], a[196:199], a[52:55], v[164:167]
  ds_read_b64_tr_b16 a[180:181], v5 offset:53248
  v_mfma_f32_16x16x32_bf16 v[164:167], a[200:203], a[36:39], v[164:167]
  ds_read_b64_tr_b16 a[182:183], v5 offset:55296
  buffer_load_dwordx4 a[56:59], v1, s[8:11], s73 offen offset:1024 sc1
  v_mfma_f32_16x16x32_bf16 v[180:183], a[208:211], a[36:39], v[180:183]
  ds_read_b64_tr_b16 a[188:189], v5 offset:57344
  s_add_u32 s73, s73, 65536
  v_mfma_f32_16x16x32_bf16 v[180:183], a[204:207], a[52:55], v[180:183]
  ds_read_b64_tr_b16 a[190:191], v5 offset:59392
  buffer_load_dwordx4 a[44:47], v1, s[8:11], s73 offen offset:0 sc1
  v_mfma_f32_16x16x32_bf16 v[176:179], a[204:207], a[48:51], v[176:179]
  ds_read_b64_tr_b16 a[192:193], v5 offset:61440
  v_mfma_f32_16x16x32_bf16 v[176:179], a[208:211], a[32:35], v[176:179]
  s_waitcnt lgkmcnt(7)
  ds_read_b64_tr_b16 a[194:195], v5 offset:63488
  buffer_load_dwordx4 a[60:63], v1, s[8:11], s73 offen offset:1024 sc1
  v_mfma_f32_16x16x32_bf16 v[192:195], a[160:163], a[32:35], v[192:195]
  ds_read_b64_tr_b16 a[196:197], v6 offset:32768
  s_add_u32 s74, s74, 65536
  v_mfma_f32_16x16x32_bf16 v[192:195], a[164:167], a[48:51], v[192:195]
  ds_read_b64_tr_b16 a[198:199], v6 offset:34816
  buffer_load_dwordx4 a[72:75], v1, s[8:11], s74 offen offset:0 sc1
  v_mfma_f32_16x16x32_bf16 v[196:199], a[164:167], a[52:55], v[196:199]
  ds_read_b64_tr_b16 a[200:201], v6 offset:36864
  v_mfma_f32_16x16x32_bf16 v[196:199], a[160:163], a[36:39], v[196:199]
  ds_read_b64_tr_b16 a[202:203], v6 offset:38912
  v_mfma_f32_16x16x32_bf16 v[212:215], a[168:171], a[36:39], v[212:215]
  ds_read_b64_tr_b16 a[204:205], v6 offset:40960
  s_mov_b32 s62, 0
  v_mfma_f32_16x16x32_bf16 v[212:215], a[172:175], a[52:55], v[212:215]
  ds_read_b64_tr_b16 a[206:207], v6 offset:43008
  buffer_load_dwordx4 a[220:223], v13, s[12:15], s62 offen
  v_mfma_f32_16x16x32_bf16 v[208:211], a[172:175], a[48:51], v[208:211]
  ds_read_b64_tr_b16 a[208:209], v6 offset:45056
  s_mov_b32 s62, 7168
  v_mfma_f32_16x16x32_bf16 v[208:211], a[168:171], a[32:35], v[208:211]
  s_waitcnt lgkmcnt(7)
  ds_read_b64_tr_b16 a[210:211], v6 offset:47104
  buffer_load_dwordx4 a[224:227], v13, s[12:15], s62 offen
  v_mfma_f32_16x16x32_bf16 v[224:227], a[176:179], a[32:35], v[224:227]
  ds_read_b64_tr_b16 a[164:165], v7 offset:32768
  s_mov_b32 s62, 14336
  v_mfma_f32_16x16x32_bf16 v[224:227], a[180:183], a[48:51], v[224:227]
  ds_read_b64_tr_b16 a[166:167], v7 offset:34816
  buffer_load_dwordx4 a[228:231], v13, s[12:15], s62 offen
  s_mov_b32 s62, 21504
  v_mfma_f32_16x16x32_bf16 v[228:231], a[180:183], a[52:55], v[228:231]
  ds_read_b64_tr_b16 a[160:161], v7 offset:36864
  buffer_load_dwordx4 a[232:235], v13, s[12:15], s62 offen
  v_mfma_f32_16x16x32_bf16 v[228:231], a[176:179], a[36:39], v[228:231]
  ds_read_b64_tr_b16 a[162:163], v7 offset:38912
  v_mfma_f32_16x16x32_bf16 v[244:247], a[188:191], a[36:39], v[244:247]
  ds_read_b64_tr_b16 a[172:173], v7 offset:40960
  v_mfma_f32_16x16x32_bf16 v[244:247], a[192:195], a[52:55], v[244:247]
  ds_read_b64_tr_b16 a[174:175], v7 offset:43008
  v_mfma_f32_16x16x32_bf16 v[240:243], a[192:195], a[48:51], v[240:243]
  ds_read_b64_tr_b16 a[168:169], v7 offset:45056
  v_mfma_f32_16x16x32_bf16 v[240:243], a[188:191], a[32:35], v[240:243]
  s_waitcnt vmcnt(9) lgkmcnt(7)
  ds_read_b64_tr_b16 a[170:171], v7 offset:47104
  v_mfma_f32_16x16x32_bf16 v[72:75], a[196:199], a[8:11], 0
  ds_read_b64_tr_b16 a[180:181], v8 offset:32768
  v_mfma_f32_16x16x32_bf16 v[72:75], a[200:203], a[24:27], v[72:75]
  ds_read_b64_tr_b16 a[182:183], v8 offset:34816
  v_mfma_f32_16x16x32_bf16 v[76:79], a[200:203], a[28:31], 0
  ds_read_b64_tr_b16 a[176:177], v8 offset:36864
  v_mfma_f32_16x16x32_bf16 v[76:79], a[196:199], a[12:15], v[76:79]
  ds_read_b64_tr_b16 a[178:179], v8 offset:38912
  v_mfma_f32_16x16x32_bf16 v[92:95], a[204:207], a[12:15], 0
  ds_read_b64_tr_b16 a[192:193], v8 offset:40960
  v_mfma_f32_16x16x32_bf16 v[92:95], a[208:211], a[28:31], v[92:95]
  ds_read_b64_tr_b16 a[194:195], v8 offset:43008
  v_mfma_f32_16x16x32_bf16 v[88:91], a[208:211], a[24:27], 0
  ds_read_b64_tr_b16 a[188:189], v8 offset:45056
  v_mfma_f32_16x16x32_bf16 v[88:91], a[204:207], a[8:11], v[88:91]
  s_waitcnt lgkmcnt(7)
  ds_read_b64_tr_b16 a[190:191], v8 offset:47104
  v_mfma_f32_16x16x32_bf16 v[104:107], a[164:167], a[8:11], 0
  ds_read_b64_tr_b16 a[200:201], v2 offset:32768
  v_mfma_f32_16x16x32_bf16 v[104:107], a[160:163], a[24:27], v[104:107]
  ds_read_b64_tr_b16 a[202:203], v2 offset:34816
  v_mfma_f32_16x16x32_bf16 v[108:111], a[160:163], a[28:31], 0
  ds_read_b64_tr_b16 a[196:197], v2 offset:36864
  v_mfma_f32_16x16x32_bf16 v[108:111], a[164:167], a[12:15], v[108:111]
  ds_read_b64_tr_b16 a[198:199], v2 offset:38912
  v_mfma_f32_16x16x32_bf16 v[124:127], a[172:175], a[12:15], 0
  ds_read_b64_tr_b16 a[208:209], v2 offset:40960
  v_mfma_f32_16x16x32_bf16 v[124:127], a[168:171], a[28:31], v[124:127]
  ds_read_b64_tr_b16 a[210:211], v2 offset:43008
  v_mfma_f32_16x16x32_bf16 v[120:123], a[168:171], a[24:27], 0
  ds_read_b64_tr_b16 a[204:205], v2 offset:45056
  v_mfma_f32_16x16x32_bf16 v[120:123], a[172:175], a[8:11], v[120:123]
  s_waitcnt lgkmcnt(7)
  ds_read_b64_tr_b16 a[206:207], v2 offset:47104
  v_mfma_f32_16x16x32_bf16 v[40:43], a[180:183], a[8:11], 0
  ds_read_b64_tr_b16 a[160:161], v3 offset:32768
  v_mfma_f32_16x16x32_bf16 v[40:43], a[176:179], a[24:27], v[40:43]
  ds_read_b64_tr_b16 a[162:163], v3 offset:34816
  v_mfma_f32_16x16x32_bf16 v[44:47], a[176:179], a[28:31], 0
  ds_read_b64_tr_b16 a[164:165], v3 offset:36864
  buffer_load_dwordx4 a[88:91], v1, s[8:11], s74 offen offset:1024 sc1
  v_mfma_f32_16x16x32_bf16 v[44:47], a[180:183], a[12:15], v[44:47]
  ds_read_b64_tr_b16 a[166:167], v3 offset:38912
  v_mfma_f32_16x16x32_bf16 v[60:63], a[192:195], a[12:15], 0
  ds_read_b64_tr_b16 a[168:169], v3 offset:40960
  v_mfma_f32_16x16x32_bf16 v[60:63], a[188:191], a[28:31], v[60:63]
  ds_read_b64_tr_b16 a[170:171], v3 offset:43008
  v_mfma_f32_16x16x32_bf16 v[56:59], a[188:191], a[24:27], 0
  ds_read_b64_tr_b16 a[172:173], v3 offset:45056
  s_add_u32 s74, s74, 65536
  v_mfma_f32_16x16x32_bf16 v[56:59], a[192:195], a[8:11], v[56:59]
  s_waitcnt lgkmcnt(7)
  ds_read_b64_tr_b16 a[174:175], v3 offset:47104
  v_mfma_f32_16x16x32_bf16 v[136:139], a[200:203], a[8:11], 0
  ds_read_b64_tr_b16 a[176:177], v4 offset:32768
  buffer_load_dwordx4 a[76:79], v1, s[8:11], s74 offen offset:0 sc1
  v_mfma_f32_16x16x32_bf16 v[136:139], a[196:199], a[24:27], v[136:139]
  ds_read_b64_tr_b16 a[178:179], v4 offset:34816
  v_mfma_f32_16x16x32_bf16 v[140:143], a[196:199], a[28:31], 0
  ds_read_b64_tr_b16 a[180:181], v4 offset:36864
  v_mfma_f32_16x16x32_bf16 v[140:143], a[200:203], a[12:15], v[140:143]
  ds_read_b64_tr_b16 a[182:183], v4 offset:38912
  v_mfma_f32_16x16x32_bf16 v[156:159], a[208:211], a[12:15], 0
  ds_read_b64_tr_b16 a[188:189], v4 offset:40960
  buffer_load_dwordx4 a[92:95], v1, s[8:11], s74 offen offset:1024 sc1
  v_mfma_f32_16x16x32_bf16 v[156:159], a[204:207], a[28:31], v[156:159]
  ds_read_b64_tr_b16 a[190:191], v4 offset:43008
  v_mfma_f32_16x16x32_bf16 v[152:155], a[204:207], a[24:27], 0
  ds_read_b64_tr_b16 a[192:193], v4 offset:45056
  v_mfma_f32_16x16x32_bf16 v[152:155], a[208:211], a[8:11], v[152:155]
  s_waitcnt lgkmcnt(7)
  ds_read_b64_tr_b16 a[194:195], v4 offset:47104
  v_mfma_f32_16x16x32_bf16 v[168:171], a[160:163], a[8:11], 0
  ds_read_b64_tr_b16 a[196:197], v5 offset:32768
  v_mfma_f32_16x16x32_bf16 v[168:171], a[164:167], a[24:27], v[168:171]
  ds_read_b64_tr_b16 a[198:199], v5 offset:34816
  buffer_load_dwordx4 a[96:99], v1, s[8:11], s75 offen offset:0 sc1
  v_mfma_f32_16x16x32_bf16 v[172:175], a[164:167], a[28:31], 0
  ds_read_b64_tr_b16 a[200:201], v5 offset:36864
  v_mfma_f32_16x16x32_bf16 v[172:175], a[160:163], a[12:15], v[172:175]
  ds_read_b64_tr_b16 a[202:203], v5 offset:38912
  v_mfma_f32_16x16x32_bf16 v[188:191], a[168:171], a[12:15], 0
  ds_read_b64_tr_b16 a[204:205], v5 offset:40960
  v_mfma_f32_16x16x32_bf16 v[188:191], a[172:175], a[28:31], v[188:191]
  ds_read_b64_tr_b16 a[206:207], v5 offset:43008
  v_mfma_f32_16x16x32_bf16 v[184:187], a[172:175], a[24:27], 0
  ds_read_b64_tr_b16 a[208:209], v5 offset:45056
  buffer_load_dwordx4 a[112:115], v1, s[8:11], s75 offen offset:1024 sc1
  v_mfma_f32_16x16x32_bf16 v[184:187], a[168:171], a[8:11], v[184:187]
  s_waitcnt lgkmcnt(7)
  ds_read_b64_tr_b16 a[210:211], v5 offset:47104
  v_mfma_f32_16x16x32_bf16 v[200:203], a[176:179], a[8:11], 0
  ds_read_b64_tr_b16 a[164:165], v6 offset:49152
  v_mfma_f32_16x16x32_bf16 v[200:203], a[180:183], a[24:27], v[200:203]
  ds_read_b64_tr_b16 a[166:167], v6 offset:51200
  v_mfma_f32_16x16x32_bf16 v[204:207], a[180:183], a[28:31], 0
  ds_read_b64_tr_b16 a[160:161], v6 offset:53248
  s_add_u32 s75, s75, 65536
  v_mfma_f32_16x16x32_bf16 v[204:207], a[176:179], a[12:15], v[204:207]
  ds_read_b64_tr_b16 a[162:163], v6 offset:55296
  buffer_load_dwordx4 a[100:103], v1, s[8:11], s75 offen offset:0 sc1
  v_mfma_f32_16x16x32_bf16 v[220:223], a[188:191], a[12:15], 0
  ds_read_b64_tr_b16 a[172:173], v6 offset:57344
  v_mfma_f32_16x16x32_bf16 v[220:223], a[192:195], a[28:31], v[220:223]
  ds_read_b64_tr_b16 a[174:175], v6 offset:59392
  v_mfma_f32_16x16x32_bf16 v[216:219], a[192:195], a[24:27], 0
  ds_read_b64_tr_b16 a[168:169], v6 offset:61440
  v_mfma_f32_16x16x32_bf16 v[216:219], a[188:191], a[8:11], v[216:219]
  s_waitcnt lgkmcnt(7)
  ds_read_b64_tr_b16 a[170:171], v6 offset:63488
  v_mfma_f32_16x16x32_bf16 v[232:235], a[196:199], a[8:11], 0
  ds_read_b64_tr_b16 a[180:181], v7 offset:49152
  buffer_load_dwordx4 a[116:119], v1, s[8:11], s75 offen offset:1024 sc1
  v_mfma_f32_16x16x32_bf16 v[232:235], a[200:203], a[24:27], v[232:235]
  ds_read_b64_tr_b16 a[182:183], v7 offset:51200
  v_mfma_f32_16x16x32_bf16 v[236:239], a[200:203], a[28:31], 0
  ds_read_b64_tr_b16 a[176:177], v7 offset:53248
  v_mfma_f32_16x16x32_bf16 v[236:239], a[196:199], a[12:15], v[236:239]
  ds_read_b64_tr_b16 a[178:179], v7 offset:55296
  s_add_u32 s75, s75, 65536
  v_mfma_f32_16x16x32_bf16 v[252:255], a[204:207], a[12:15], 0
  ds_read_b64_tr_b16 a[192:193], v7 offset:57344
  s_barrier
  v_mfma_f32_16x16x32_bf16 v[252:255], a[208:211], a[28:31], v[252:255]
  ds_read_b64_tr_b16 a[194:195], v7 offset:59392
  buffer_load_dwordx4 a[104:107], v1, s[8:11], s75 offen offset:0 sc1
  v_mfma_f32_16x16x32_bf16 v[248:251], a[208:211], a[24:27], 0
  ds_read_b64_tr_b16 a[188:189], v7 offset:61440
  v_mfma_f32_16x16x32_bf16 v[248:251], a[204:207], a[8:11], v[248:251]
  s_waitcnt vmcnt(13) lgkmcnt(7)
  ds_read_b64_tr_b16 a[190:191], v7 offset:63488
  v_mfma_f32_16x16x32_bf16 v[72:75], a[164:167], a[40:43], v[72:75]
  ds_read_b64_tr_b16 a[200:201], v8 offset:49152
  v_mfma_f32_16x16x32_bf16 v[72:75], a[160:163], a[56:59], v[72:75]
  ds_read_b64_tr_b16 a[202:203], v8 offset:51200
  v_mfma_f32_16x16x32_bf16 v[76:79], a[160:163], a[60:63], v[76:79]
  ds_read_b64_tr_b16 a[196:197], v8 offset:53248
  buffer_load_dwordx4 a[120:123], v1, s[8:11], s75 offen offset:1024 sc1
  v_mfma_f32_16x16x32_bf16 v[76:79], a[164:167], a[44:47], v[76:79]
  ds_read_b64_tr_b16 a[198:199], v8 offset:55296
  v_mfma_f32_16x16x32_bf16 v[92:95], a[172:175], a[44:47], v[92:95]
  ds_read_b64_tr_b16 a[208:209], v8 offset:57344
  v_mfma_f32_16x16x32_bf16 v[92:95], a[168:171], a[60:63], v[92:95]
  ds_read_b64_tr_b16 a[210:211], v8 offset:59392
  v_mfma_f32_16x16x32_bf16 v[88:91], a[168:171], a[56:59], v[88:91]
  ds_read_b64_tr_b16 a[204:205], v8 offset:61440
  s_mov_b32 s62, 28672
  v_mfma_f32_16x16x32_bf16 v[88:91], a[172:175], a[40:43], v[88:91]
  s_waitcnt lgkmcnt(7)
  ds_read_b64_tr_b16 a[206:207], v8 offset:63488
  buffer_load_dwordx4 a[236:239], v13, s[12:15], s62 offen
  v_mfma_f32_16x16x32_bf16 v[104:107], a[180:183], a[40:43], v[104:107]
  ds_read_b64_tr_b16 a[160:161], v2 offset:49152
  s_mov_b32 s62, 35840
  v_mfma_f32_16x16x32_bf16 v[104:107], a[176:179], a[56:59], v[104:107]
  ds_read_b64_tr_b16 a[162:163], v2 offset:51200
  buffer_load_dwordx4 a[240:243], v13, s[12:15], s62 offen
  v_mfma_f32_16x16x32_bf16 v[108:111], a[176:179], a[60:63], v[108:111]
  ds_read_b64_tr_b16 a[164:165], v2 offset:53248
  s_mov_b32 s62, 43008
  v_mfma_f32_16x16x32_bf16 v[108:111], a[180:183], a[44:47], v[108:111]
  ds_read_b64_tr_b16 a[166:167], v2 offset:55296
  buffer_load_dwordx4 a[244:247], v13, s[12:15], s62 offen
  v_mfma_f32_16x16x32_bf16 v[124:127], a[192:195], a[44:47], v[124:127]
  ds_read_b64_tr_b16 a[168:169], v2 offset:57344
  s_mov_b32 s62, 50176
  v_mfma_f32_16x16x32_bf16 v[124:127], a[188:191], a[60:63], v[124:127]
  ds_read_b64_tr_b16 a[170:171], v2 offset:59392
  buffer_load_dwordx4 a[248:251], v13, s[12:15], s62 offen
  v_mfma_f32_16x16x32_bf16 v[120:123], a[188:191], a[56:59], v[120:123]
  ds_read_b64_tr_b16 a[172:173], v2 offset:61440
  v_mfma_f32_16x16x32_bf16 v[120:123], a[192:195], a[40:43], v[120:123]
  s_waitcnt lgkmcnt(7)
  ds_read_b64_tr_b16 a[174:175], v2 offset:63488
  v_mfma_f32_16x16x32_bf16 v[40:43], a[200:203], a[40:43], v[40:43]
  ds_read_b64_tr_b16 a[176:177], v3 offset:49152
  v_mfma_f32_16x16x32_bf16 v[40:43], a[196:199], a[56:59], v[40:43]
  ds_read_b64_tr_b16 a[178:179], v3 offset:51200
  v_mfma_f32_16x16x32_bf16 v[44:47], a[196:199], a[60:63], v[44:47]
  ds_read_b64_tr_b16 a[180:181], v3 offset:53248
  v_mfma_f32_16x16x32_bf16 v[44:47], a[200:203], a[44:47], v[44:47]
  ds_read_b64_tr_b16 a[182:183], v3 offset:55296
  v_mfma_f32_16x16x32_bf16 v[60:63], a[208:211], a[44:47], v[60:63]
  ds_read_b64_tr_b16 a[188:189], v3 offset:57344
  v_mfma_f32_16x16x32_bf16 v[60:63], a[204:207], a[60:63], v[60:63]
  ds_read_b64_tr_b16 a[190:191], v3 offset:59392
  v_mfma_f32_16x16x32_bf16 v[56:59], a[204:207], a[56:59], v[56:59]
  ds_read_b64_tr_b16 a[192:193], v3 offset:61440
  v_mfma_f32_16x16x32_bf16 v[56:59], a[208:211], a[40:43], v[56:59]
  s_waitcnt lgkmcnt(7)
  ds_read_b64_tr_b16 a[194:195], v3 offset:63488
  v_mfma_f32_16x16x32_bf16 v[136:139], a[160:163], a[40:43], v[136:139]
  ds_read_b64_tr_b16 a[196:197], v4 offset:49152
  v_mfma_f32_16x16x32_bf16 v[136:139], a[164:167], a[56:59], v[136:139]
  ds_read_b64_tr_b16 a[198:199], v4 offset:51200
  v_mfma_f32_16x16x32_bf16 v[140:143], a[164:167], a[60:63], v[140:143]
  ds_read_b64_tr_b16 a[200:201], v4 offset:53248
  v_mfma_f32_16x16x32_bf16 v[140:143], a[160:163], a[44:47], v[140:143]
  ds_read_b64_tr_b16 a[202:203], v4 offset:55296
  v_mfma_f32_16x16x32_bf16 v[156:159], a[168:171], a[44:47], v[156:159]
  ds_read_b64_tr_b16 a[204:205], v4 offset:57344
  v_mfma_f32_16x16x32_bf16 v[156:159], a[172:175], a[60:63], v[156:159]
  ds_read_b64_tr_b16 a[206:207], v4 offset:59392
  v_mfma_f32_16x16x32_bf16 v[152:155], a[172:175], a[56:59], v[152:155]
  ds_read_b64_tr_b16 a[208:209], v4 offset:61440
  v_mfma_f32_16x16x32_bf16 v[152:155], a[168:171], a[40:43], v[152:155]
  s_waitcnt lgkmcnt(7)
  ds_read_b64_tr_b16 a[210:211], v4 offset:63488
  v_mfma_f32_16x16x32_bf16 v[168:171], a[176:179], a[40:43], v[168:171]
  ds_read_b64_tr_b16 a[164:165], v5 offset:49152
  ds_read_b128 v[24:27], v14 offset:0
  v_mfma_f32_16x16x32_bf16 v[168:171], a[180:183], a[56:59], v[168:171]
  ds_read_b64_tr_b16 a[166:167], v5 offset:51200
  v_mfma_f32_16x16x32_bf16 v[172:175], a[180:183], a[60:63], v[172:175]
  ds_read_b64_tr_b16 a[160:161], v5 offset:53248
  v_mfma_f32_16x16x32_bf16 v[172:175], a[176:179], a[44:47], v[172:175]
  ds_read_b64_tr_b16 a[162:163], v5 offset:55296
  v_mfma_f32_16x16x32_bf16 v[188:191], a[188:191], a[44:47], v[188:191]
  ds_read_b64_tr_b16 a[172:173], v5 offset:57344
  v_mfma_f32_16x16x32_bf16 v[188:191], a[192:195], a[60:63], v[188:191]
  ds_read_b64_tr_b16 a[174:175], v5 offset:59392
  s_waitcnt vmcnt(38)
  s_barrier
  v_mfma_f32_16x16x32_bf16 v[184:187], a[192:195], a[56:59], v[184:187]
  ds_read_b64_tr_b16 a[168:169], v5 offset:61440
  ds_read_b64_tr_b16 a[180:181], v6 offset:16384
  v_mfma_f32_16x16x32_bf16 v[184:187], a[188:191], a[40:43], v[184:187]
  s_waitcnt lgkmcnt(9)
  ds_read_b64_tr_b16 a[170:171], v5 offset:63488
  v_mfma_f32_16x16x32_bf16 v[200:203], a[196:199], a[40:43], v[200:203]
  ds_read_b64_tr_b16 a[182:183], v6 offset:18432
  s_waitcnt vmcnt(13) lgkmcnt(9)
  v_mfma_f32_16x16x32_bf16 v[200:203], a[200:203], a[56:59], v[200:203]
  s_add_u32 s75, s75, 65536
  v_cndmask_b32 v28, 0, v24, s[16:17]
  v_cndmask_b32 v29, 0, v24, s[18:19]
  v_mfma_f32_16x16x32_bf16 v[204:207], a[200:203], a[60:63], v[204:207]
  ds_read_b64_tr_b16 a[176:177], v6 offset:20480
  v_cndmask_b32 v30, 0, v24, s[20:21]
  v_mfma_f32_16x16x32_bf16 v[204:207], a[196:199], a[44:47], v[204:207]
  buffer_load_dwordx4 a[108:111], v1, s[8:11], s75 offen offset:0 sc1
  v_cndmask_b32 v31, 0, v24, s[22:23]
  v_mfma_f32_16x16x32_bf16 v[220:223], a[204:207], a[44:47], v[220:223]
  ds_read_b64_tr_b16 a[178:179], v6 offset:22528
  v_mfma_f32_16x16x32_bf16 a[184:187], v[28:31], a[220:223], 0
  v_cndmask_b32 v28, 0, v25, s[16:17]
  v_cndmask_b32 v29, 0, v25, s[18:19]
  v_mfma_f32_16x16x32_bf16 v[220:223], a[208:211], a[60:63], v[220:223]
  v_cndmask_b32 v30, 0, v25, s[20:21]
  v_cndmask_b32 v31, 0, v25, s[22:23]
  v_mfma_f32_16x16x32_bf16 v[216:219], a[208:211], a[56:59], v[216:219]
  ds_read_b64_tr_b16 a[192:193], v6 offset:24576
  v_mfma_f32_16x16x32_bf16 a[184:187], v[28:31], a[224:227], a[184:187]
  v_cndmask_b32 v28, 0, v26, s[16:17]
  v_cndmask_b32 v29, 0, v26, s[18:19]
  v_mfma_f32_16x16x32_bf16 v[216:219], a[204:207], a[40:43], v[216:219]
  s_waitcnt lgkmcnt(4)
  v_cndmask_b32 v30, 0, v26, s[20:21]
  v_cndmask_b32 v31, 0, v26, s[22:23]
  v_mfma_f32_16x16x32_bf16 v[232:235], a[164:167], a[40:43], v[232:235]
  ds_read_b64_tr_b16 a[194:195], v6 offset:26624
  v_mfma_f32_16x16x32_bf16 a[184:187], v[28:31], a[228:231], a[184:187]
  v_cndmask_b32 v28, 0, v27, s[16:17]
  v_cndmask_b32 v29, 0, v27, s[18:19]
  v_mfma_f32_16x16x32_bf16 v[232:235], a[160:163], a[56:59], v[232:235]
  buffer_load_dwordx4 a[124:127], v1, s[8:11], s75 offen offset:1024 sc1
  v_cndmask_b32 v30, 0, v27, s[20:21]
  v_cndmask_b32 v31, 0, v27, s[22:23]
  v_mfma_f32_16x16x32_bf16 v[236:239], a[160:163], a[60:63], v[236:239]
  ds_read_b64_tr_b16 a[188:189], v6 offset:28672
  v_mfma_f32_16x16x32_bf16 a[184:187], v[28:31], a[232:235], a[184:187]
  v_mfma_f32_16x16x32_bf16 v[236:239], a[164:167], a[44:47], v[236:239]
  s_mov_b32 s68, 1835008
  s_add_u32 s76, s57, 8192
  s_add_u32 m0, s45, 98304
  v_mfma_f32_16x16x32_bf16 v[252:255], a[172:175], a[44:47], v[252:255]
  ds_read_b64_tr_b16 a[190:191], v6 offset:30720
  v_mfma_f32_16x16x32_bf16 v[252:255], a[168:171], a[60:63], v[252:255]
  buffer_load_dwordx4 v11, s[28:31], s68 offen lds
  v_mfma_f32_16x16x32_bf16 v[248:251], a[168:171], a[56:59], v[248:251]
  ds_read_b64_tr_b16 a[200:201], v7 offset:16384
  v_mfma_f32_16x16x32_bf16 v[248:251], a[172:175], a[40:43], v[248:251]
  s_waitcnt vmcnt(13) lgkmcnt(5)
  v_mfma_f32_16x16x32_bf16 v[64:67], a[180:183], a[64:67], v[64:67]
  ds_read_b64_tr_b16 a[202:203], v7 offset:18432
  v_mfma_f32_16x16x32_bf16 v[64:67], a[176:179], a[80:83], v[64:67]
  s_add_u32 m0, s45, 106496
  v_mfma_f32_16x16x32_bf16 v[68:71], a[176:179], a[84:87], v[68:71]
  ds_read_b64_tr_b16 a[196:197], v7 offset:20480
  v_mfma_f32_16x16x32_bf16 v[68:71], a[180:183], a[68:71], v[68:71]
  buffer_load_dwordx4 v11, s[32:35], s68 offen lds
  v_mfma_f32_16x16x32_bf16 v[72:75], a[180:183], a[72:75], v[72:75]
  ds_read_b64_tr_b16 a[198:199], v7 offset:22528
  v_mfma_f32_16x16x32_bf16 v[72:75], a[176:179], a[88:91], v[72:75]
  s_add_u32 m0, s45, 102400
  s_add_u32 s61, s68, 229376
  v_mfma_f32_16x16x32_bf16 v[76:79], a[176:179], a[92:95], v[76:79]
  ds_read_b64_tr_b16 a[160:161], v7 offset:24576
  v_mfma_f32_16x16x32_bf16 v[76:79], a[180:183], a[76:79], v[76:79]
  s_waitcnt lgkmcnt(5)
  buffer_load_dwordx4 v11, s[28:31], s61 offen lds
  v_mfma_f32_16x16x32_bf16 v[92:95], a[192:195], a[76:79], v[92:95]
  ds_read_b64_tr_b16 a[162:163], v7 offset:26624
  v_mfma_f32_16x16x32_bf16 v[92:95], a[188:191], a[92:95], v[92:95]
  v_mfma_f32_16x16x32_bf16 v[88:91], a[188:191], a[88:91], v[88:91]
  ds_read_b64_tr_b16 a[164:165], v7 offset:28672
  v_mfma_f32_16x16x32_bf16 v[88:91], a[192:195], a[72:75], v[88:91]
  s_add_u32 m0, s45, 110592
  s_add_u32 s61, s68, 229376
  v_mfma_f32_16x16x32_bf16 v[84:87], a[192:195], a[68:71], v[84:87]
  ds_read_b64_tr_b16 a[166:167], v7 offset:30720
  v_mfma_f32_16x16x32_bf16 v[84:87], a[188:191], a[84:87], v[84:87]
  buffer_load_dwordx4 v11, s[32:35], s61 offen lds
  v_mfma_f32_16x16x32_bf16 v[80:83], a[188:191], a[80:83], v[80:83]
  ds_read_b64_tr_b16 a[168:169], v8 offset:16384
  v_mfma_f32_16x16x32_bf16 v[80:83], a[192:195], a[64:67], v[80:83]
  s_waitcnt lgkmcnt(5)
  s_add_u32 m0, s45, 32768
  v_mfma_f32_16x16x32_bf16 v[96:99], a[200:203], a[64:67], v[96:99]
  ds_read_b64_tr_b16 a[170:171], v8 offset:18432
  v_mfma_f32_16x16x32_bf16 v[96:99], a[196:199], a[80:83], v[96:99]
  buffer_load_dwordx4 v10, s[28:31], s68 offen lds
  v_mfma_f32_16x16x32_bf16 v[100:103], a[196:199], a[84:87], v[100:103]
  ds_read_b64_tr_b16 a[172:173], v8 offset:20480
  v_mfma_f32_16x16x32_bf16 v[100:103], a[200:203], a[68:71], v[100:103]
  v_mfma_f32_16x16x32_bf16 v[104:107], a[200:203], a[72:75], v[104:107]
  ds_read_b64_tr_b16 a[174:175], v8 offset:22528
  v_mfma_f32_16x16x32_bf16 v[104:107], a[196:199], a[88:91], v[104:107]
  s_add_u32 m0, s45, 40960
  v_mfma_f32_16x16x32_bf16 v[108:111], a[196:199], a[92:95], v[108:111]
  ds_read_b64_tr_b16 a[176:177], v8 offset:24576
  v_mfma_f32_16x16x32_bf16 v[108:111], a[200:203], a[76:79], v[108:111]
  s_waitcnt lgkmcnt(5)
  buffer_load_dwordx4 v10, s[32:35], s68 offen lds
  v_mfma_f32_16x16x32_bf16 v[124:127], a[160:163], a[76:79], v[124:127]
  ds_read_b64_tr_b16 a[178:179], v8 offset:26624
  v_mfma_f32_16x16x32_bf16 v[124:127], a[164:167], a[92:95], v[124:127]
  s_add_u32 m0, s45, 36864
  s_add_u32 s61, s68, 229376
  v_mfma_f32_16x16x32_bf16 v[120:123], a[164:167], a[88:91], v[120:123]
  ds_read_b64_tr_b16 a[180:181], v8 offset:28672
  v_mfma_f32_16x16x32_bf16 v[120:123], a[160:163], a[72:75], v[120:123]
  buffer_load_dwordx4 v10, s[28:31], s61 offen lds
  v_mfma_f32_16x16x32_bf16 v[116:119], a[160:163], a[68:71], v[116:119]
  ds_read_b64_tr_b16 a[182:183], v8 offset:30720
  v_mfma_f32_16x16x32_bf16 v[116:119], a[164:167], a[84:87], v[116:119]
  v_mfma_f32_16x16x32_bf16 v[112:115], a[164:167], a[80:83], v[112:115]
  ds_read_b64_tr_b16 a[164:165], v2 offset:16384
  v_mfma_f32_16x16x32_bf16 v[112:115], a[160:163], a[64:67], v[112:115]
  s_waitcnt lgkmcnt(5)
  s_add_u32 m0, s45, 45056
  s_add_u32 s61, s68, 229376
  v_mfma_f32_16x16x32_bf16 v[32:35], a[168:171], a[64:67], v[32:35]
  ds_read_b64_tr_b16 a[166:167], v2 offset:18432
  v_mfma_f32_16x16x32_bf16 v[32:35], a[172:175], a[80:83], v[32:35]
  buffer_load_dwordx4 v10, s[32:35], s61 offen lds
  v_mfma_f32_16x16x32_bf16 v[36:39], a[172:175], a[84:87], v[36:39]
  ds_read_b64_tr_b16 a[160:161], v2 offset:20480
  v_mfma_f32_16x16x32_bf16 v[36:39], a[168:171], a[68:71], v[36:39]
  v_mfma_f32_16x16x32_bf16 v[40:43], a[168:171], a[72:75], v[40:43]
  ds_read_b64_tr_b16 a[162:163], v2 offset:22528
  s_mov_b32 s62, 57344
  v_mfma_f32_16x16x32_bf16 v[40:43], a[172:175], a[88:91], v[40:43]
  buffer_load_dwordx4 a[220:223], v13, s[12:15], s62 offen
  s_mov_b32 s62, 64512
  v_mfma_f32_16x16x32_bf16 v[44:47], a[172:175], a[92:95], v[44:47]
  ds_read_b64_tr_b16 a[172:173], v2 offset:24576
  v_mfma_f32_16x16x32_bf16 v[44:47], a[168:171], a[76:79], v[44:47]
  s_waitcnt lgkmcnt(5)
  buffer_load_dwordx4 a[224:227], v13, s[12:15], s62 offen
  v_mfma_f32_16x16x32_bf16 v[60:63], a[176:179], a[76:79], v[60:63]
  ds_read_b64_tr_b16 a[174:175], v2 offset:26624
  s_mov_b32 s62, 71680
  v_mfma_f32_16x16x32_bf16 v[60:63], a[180:183], a[92:95], v[60:63]
  buffer_load_dwordx4 a[228:231], v13, s[12:15], s62 offen
  s_mov_b32 s62, 78848
  v_mfma_f32_16x16x32_bf16 v[56:59], a[180:183], a[88:91], v[56:59]
  ds_read_b64_tr_b16 a[168:169], v2 offset:28672
  v_mfma_f32_16x16x32_bf16 v[56:59], a[176:179], a[72:75], v[56:59]
HOP8:
  s_cbranch_execz HOP12
  buffer_load_dwordx4 a[232:235], v13, s[12:15], s62 offen
  ds_read_b128 v[24:27], v14 offset:16
  v_mfma_f32_16x16x32_bf16 v[52:55], a[176:179], a[68:71], v[52:55]
  ds_read_b64_tr_b16 a[170:171], v2 offset:30720
  v_mfma_f32_16x16x32_bf16 v[52:55], a[180:183], a[84:87], v[52:55]
  v_mfma_f32_16x16x32_bf16 v[48:51], a[180:183], a[80:83], v[48:51]
  ds_read_b64_tr_b16 a[180:181], v3 offset:16384
  v_mfma_f32_16x16x32_bf16 v[48:51], a[176:179], a[64:67], v[48:51]
  s_waitcnt lgkmcnt(6)
  v_mfma_f32_16x16x32_bf16 v[128:131], a[164:167], a[64:67], v[128:131]
  ds_read_b64_tr_b16 a[182:183], v3 offset:18432
  v_mfma_f32_16x16x32_bf16 v[128:131], a[160:163], a[80:83], v[128:131]
  s_waitcnt vmcnt(14) lgkmcnt(3)
  v_cndmask_b32 v28, 0, v24, s[16:17]
  v_cndmask_b32 v29, 0, v24, s[18:19]
  v_mfma_f32_16x16x32_bf16 v[132:135], a[160:163], a[84:87], v[132:135]
  ds_read_b64_tr_b16 a[176:177], v3 offset:20480
  v_cndmask_b32 v30, 0, v24, s[20:21]
  v_mfma_f32_16x16x32_bf16 v[132:135], a[164:167], a[68:71], v[132:135]
  v_cndmask_b32 v31, 0, v24, s[22:23]
  v_mfma_f32_16x16x32_bf16 v[136:139], a[164:167], a[72:75], v[136:139]
  ds_read_b64_tr_b16 a[178:179], v3 offset:22528
  v_mfma_f32_16x16x32_bf16 a[184:187], v[28:31], a[236:239], a[184:187]
  v_cndmask_b32 v28, 0, v25, s[16:17]
  v_cndmask_b32 v29, 0, v25, s[18:19]
  v_mfma_f32_16x16x32_bf16 v[136:139], a[160:163], a[88:91], v[136:139]
  v_cndmask_b32 v30, 0, v25, s[20:21]
  v_cndmask_b32 v31, 0, v25, s[22:23]
  v_mfma_f32_16x16x32_bf16 v[140:143], a[160:163], a[92:95], v[140:143]
  ds_read_b64_tr_b16 a[160:161], v3 offset:24576
  v_mfma_f32_16x16x32_bf16 a[184:187], v[28:31], a[240:243], a[184:187]
  v_cndmask_b32 v28, 0, v26, s[16:17]
  v_cndmask_b32 v29, 0, v26, s[18:19]
  v_mfma_f32_16x16x32_bf16 v[140:143], a[164:167], a[76:79], v[140:143]
  s_waitcnt lgkmcnt(5)
  v_cndmask_b32 v30, 0, v26, s[20:21]
  v_cndmask_b32 v31, 0, v26, s[22:23]
  v_mfma_f32_16x16x32_bf16 v[156:159], a[172:175], a[76:79], v[156:159]
  ds_read_b64_tr_b16 a[162:163], v3 offset:26624
  v_mfma_f32_16x16x32_bf16 a[184:187], v[28:31], a[244:247], a[184:187]
  v_cndmask_b32 v28, 0, v27, s[16:17]
  v_cndmask_b32 v29, 0, v27, s[18:19]
  v_mfma_f32_16x16x32_bf16 v[156:159], a[168:171], a[92:95], v[156:159]
  v_cndmask_b32 v30, 0, v27, s[20:21]
  v_cndmask_b32 v31, 0, v27, s[22:23]
  v_mfma_f32_16x16x32_bf16 v[152:155], a[168:171], a[88:91], v[152:155]
  ds_read_b64_tr_b16 a[164:165], v3 offset:28672
  v_mfma_f32_16x16x32_bf16 a[184:187], v[28:31], a[248:251], a[184:187]
  v_mfma_f32_16x16x32_bf16 v[152:155], a[172:175], a[72:75], v[152:155]
  v_mfma_f32_16x16x32_bf16 v[148:151], a[172:175], a[68:71], v[148:151]
  ds_read_b64_tr_b16 a[166:167], v3 offset:30720
  v_mfma_f32_16x16x32_bf16 v[148:151], a[168:171], a[84:87], v[148:151]
  v_mfma_f32_16x16x32_bf16 v[144:147], a[168:171], a[80:83], v[144:147]
  ds_read_b64_tr_b16 a[168:169], v4 offset:16384
  v_mfma_f32_16x16x32_bf16 v[144:147], a[172:175], a[64:67], v[144:147]
  s_waitcnt lgkmcnt(5)
  v_mfma_f32_16x16x32_bf16 v[160:163], a[180:183], a[64:67], v[160:163]
  ds_read_b64_tr_b16 a[170:171], v4 offset:18432
  v_mfma_f32_16x16x32_bf16 v[160:163], a[176:179], a[80:83], v[160:163]
  v_mfma_f32_16x16x32_bf16 v[164:167], a[176:179], a[84:87], v[164:167]
  ds_read_b64_tr_b16 a[172:173], v4 offset:20480
  v_mfma_f32_16x16x32_bf16 v[164:167], a[180:183], a[68:71], v[164:167]
  v_mfma_f32_16x16x32_bf16 v[168:171], a[180:183], a[72:75], v[168:171]
  ds_read_b64_tr_b16 a[174:175], v4 offset:22528
  v_mfma_f32_16x16x32_bf16 v[168:171], a[176:179], a[88:91], v[168:171]
  v_mfma_f32_16x16x32_bf16 v[172:175], a[176:179], a[92:95], v[172:175]
  ds_read_b64_tr_b16 a[176:177], v4 offset:24576
  v_mfma_f32_16x16x32_bf16 v[172:175], a[180:183], a[76:79], v[172:175]
  s_waitcnt lgkmcnt(5)
  v_mfma_f32_16x16x32_bf16 v[188:191], a[160:163], a[76:79], v[188:191]
  ds_read_b64_tr_b16 a[178:179], v4 offset:26624
  v_mfma_f32_16x16x32_bf16 v[188:191], a[164:167], a[92:95], v[188:191]
  buffer_load_dwordx4 a[128:131], v1, s[8:11], s76 offen offset:0 sc1
  v_mfma_f32_16x16x32_bf16 v[184:187], a[164:167], a[88:91], v[184:187]
  ds_read_b64_tr_b16 a[180:181], v4 offset:28672
  v_mfma_f32_16x16x32_bf16 v[184:187], a[160:163], a[72:75], v[184:187]
  v_mfma_f32_16x16x32_bf16 v[180:183], a[160:163], a[68:71], v[180:183]
  ds_read_b64_tr_b16 a[182:183], v4 offset:30720
  v_mfma_f32_16x16x32_bf16 v[180:183], a[164:167], a[84:87], v[180:183]
  s_add_u32 s62, s63, 0
  v_mfma_f32_16x16x32_bf16 v[176:179], a[164:167], a[80:83], v[176:179]
  ds_read_b64_tr_b16 a[164:165], v5 offset:16384
  v_mfma_f32_16x16x32_bf16 v[176:179], a[160:163], a[64:67], v[176:179]
  s_waitcnt lgkmcnt(5)
  buffer_load_dwordx4 a[188:191], v12, s[8:11], s62 offen offset:0 sc1
  v_mfma_f32_16x16x32_bf16 v[192:195], a[168:171], a[64:67], v[192:195]
  ds_read_b64_tr_b16 a[166:167], v5 offset:18432
  v_mfma_f32_16x16x32_bf16 v[192:195], a[172:175], a[80:83], v[192:195]
  s_add_u32 s62, s63, 0
  v_mfma_f32_16x16x32_bf16 v[196:199], a[172:175], a[84:87], v[196:199]
  ds_read_b64_tr_b16 a[160:161], v5 offset:20480
  v_mfma_f32_16x16x32_bf16 v[196:199], a[168:171], a[68:71], v[196:199]
  buffer_load_dwordx4 a[192:195], v12, s[8:11], s62 offen offset:256 sc1
  v_mfma_f32_16x16x32_bf16 v[200:203], a[168:171], a[72:75], v[200:203]
  ds_read_b64_tr_b16 a[162:163], v5 offset:22528
  v_mfma_f32_16x16x32_bf16 v[200:203], a[172:175], a[88:91], v[200:203]
  v_mfma_f32_16x16x32_bf16 v[204:207], a[172:175], a[92:95], v[204:207]
  ds_read_b64_tr_b16 a[172:173], v5 offset:24576
  v_mfma_f32_16x16x32_bf16 v[204:207], a[168:171], a[76:79], v[204:207]
  s_waitcnt lgkmcnt(5)
  s_add_u32 s62, s63, 2048
  v_mfma_f32_16x16x32_bf16 v[220:223], a[176:179], a[76:79], v[220:223]
  ds_read_b64_tr_b16 a[174:175], v5 offset:26624
  v_mfma_f32_16x16x32_bf16 v[220:223], a[180:183], a[92:95], v[220:223]
  buffer_load_dwordx4 a[196:199], v12, s[8:11], s62 offen offset:0 sc1
  v_mfma_f32_16x16x32_bf16 v[216:219], a[180:183], a[88:91], v[216:219]
  ds_read_b64_tr_b16 a[168:169], v5 offset:28672
  v_mfma_f32_16x16x32_bf16 v[216:219], a[176:179], a[72:75], v[216:219]
  s_add_u32 s62, s63, 2048
  v_mfma_f32_16x16x32_bf16 v[212:215], a[176:179], a[68:71], v[212:215]
  ds_read_b64_tr_b16 a[170:171], v5 offset:30720
  v_mfma_f32_16x16x32_bf16 v[212:215], a[180:183], a[84:87], v[212:215]
  buffer_load_dwordx4 a[200:203], v12, s[8:11], s62 offen offset:256 sc1
  s_waitcnt vmcnt(45)
  s_barrier
  v_mfma_f32_16x16x32_bf16 v[208:211], a[180:183], a[80:83], v[208:211]
  ds_read_b64_tr_b16 a[180:181], v6 offset:0
  v_mfma_f32_16x16x32_bf16 v[208:211], a[176:179], a[64:67], v[208:211]
  s_waitcnt lgkmcnt(5)
  v_mfma_f32_16x16x32_bf16 v[224:227], a[164:167], a[64:67], v[224:227]
  ds_read_b64_tr_b16 a[182:183], v6 offset:2048
  v_mfma_f32_16x16x32_bf16 v[224:227], a[160:163], a[80:83], v[224:227]
  s_add_u32 s62, s63, 4096
  v_mfma_f32_16x16x32_bf16 v[228:231], a[160:163], a[84:87], v[228:231]
  ds_read_b64_tr_b16 a[176:177], v6 offset:4096
  v_mfma_f32_16x16x32_bf16 v[228:231], a[164:167], a[68:71], v[228:231]
  buffer_load_dwordx4 a[204:207], v12, s[8:11], s62 offen offset:0 sc1
  v_mfma_f32_16x16x32_bf16 v[232:235], a[164:167], a[72:75], v[232:235]
  ds_read_b64_tr_b16 a[178:179], v6 offset:6144
  v_mfma_f32_16x16x32_bf16 v[232:235], a[160:163], a[88:91], v[232:235]
  s_add_u32 s62, s63, 4096
  v_mfma_f32_16x16x32_bf16 v[236:239], a[160:163], a[92:95], v[236:239]
  ds_read_b64_tr_b16 a[160:161], v6 offset:8192
  v_mfma_f32_16x16x32_bf16 v[236:239], a[164:167], a[76:79], v[236:239]
  s_waitcnt lgkmcnt(5)
  buffer_load_dwordx4 a[208:211], v12, s[8:11], s62 offen offset:256 sc1
  v_mfma_f32_16x16x32_bf16 v[252:255], a[172:175], a[76:79], v[252:255]
  ds_read_b64_tr_b16 a[162:163], v6 offset:10240
  v_mfma_f32_16x16x32_bf16 v[252:255], a[168:171], a[92:95], v[252:255]
  v_mfma_f32_16x16x32_bf16 v[248:251], a[168:171], a[88:91], v[248:251]
  ds_read_b64_tr_b16 a[164:165], v6 offset:12288
  v_mfma_f32_16x16x32_bf16 v[248:251], a[172:175], a[72:75], v[248:251]
  s_add_u32 s62, s63, 6144
  v_mfma_f32_16x16x32_bf16 v[244:247], a[172:175], a[68:71], v[244:247]
  ds_read_b64_tr_b16 a[166:167], v6 offset:14336
  v_mfma_f32_16x16x32_bf16 v[244:247], a[168:171], a[84:87], v[244:247]
  buffer_load_dwordx4 a[212:215], v12, s[8:11], s62 offen offset:0 sc1
  v_mfma_f32_16x16x32_bf16 v[240:243], a[168:171], a[80:83], v[240:243]
  ds_read_b64_tr_b16 a[168:169], v7 offset:0
  v_mfma_f32_16x16x32_bf16 v[240:243], a[172:175], a[64:67], v[240:243]
  s_waitcnt vmcnt(20) lgkmcnt(5)
  s_add_u32 s62, s63, 6144
  v_mfma_f32_16x16x32_bf16 v[64:67], a[180:183], a[96:99], v[64:67]
  ds_read_b64_tr_b16 a[170:171], v7 offset:2048
  v_mfma_f32_16x16x32_bf16 v[64:67], a[176:179], a[112:115], v[64:67]
  buffer_load_dwordx4 a[216:219], v12, s[8:11], s62 offen offset:256 sc1
  v_mfma_f32_16x16x32_bf16 v[68:71], a[176:179], a[116:119], v[68:71]
  ds_read_b64_tr_b16 a[172:173], v7 offset:4096
  v_mfma_f32_16x16x32_bf16 v[68:71], a[180:183], a[100:103], v[68:71]
  v_mfma_f32_16x16x32_bf16 v[72:75], a[180:183], a[104:107], v[72:75]
  ds_read_b64_tr_b16 a[174:175], v7 offset:6144
  v_mfma_f32_16x16x32_bf16 v[72:75], a[176:179], a[120:123], v[72:75]
  v_mfma_f32_16x16x32_bf16 v[76:79], a[176:179], a[124:127], v[76:79]
  ds_read_b64_tr_b16 a[176:177], v7 offset:8192
  v_mfma_f32_16x16x32_bf16 v[76:79], a[180:183], a[108:111], v[76:79]
  s_waitcnt lgkmcnt(5)
  buffer_load_dwordx4 a[144:147], v1, s[8:11], s76 offen offset:1024 sc1
  v_mfma_f32_16x16x32_bf16 v[92:95], a[160:163], a[108:111], v[92:95]
  ds_read_b64_tr_b16 a[178:179], v7 offset:10240
  v_mfma_f32_16x16x32_bf16 v[92:95], a[164:167], a[124:127], v[92:95]
  s_add_u32 s76, s76, 65536
  v_mfma_f32_16x16x32_bf16 v[88:91], a[164:167], a[120:123], v[88:91]
  ds_read_b64_tr_b16 a[180:181], v7 offset:12288
  v_mfma_f32_16x16x32_bf16 v[88:91], a[160:163], a[104:107], v[88:91]
  buffer_load_dwordx4 a[132:135], v1, s[8:11], s76 offen offset:0 sc1
  v_mfma_f32_16x16x32_bf16 v[84:87], a[160:163], a[100:103], v[84:87]
  ds_read_b64_tr_b16 a[182:183], v7 offset:14336
  v_mfma_f32_16x16x32_bf16 v[84:87], a[164:167], a[116:119], v[84:87]
  v_mfma_f32_16x16x32_bf16 v[80:83], a[164:167], a[112:115], v[80:83]
  ds_read_b64_tr_b16 a[164:165], v8 offset:0
  v_mfma_f32_16x16x32_bf16 v[80:83], a[160:163], a[96:99], v[80:83]
  s_waitcnt lgkmcnt(5)
  s_mov_b32 s62, 86016
  v_mfma_f32_16x16x32_bf16 v[96:99], a[168:171], a[96:99], v[96:99]
  ds_read_b64_tr_b16 a[166:167], v8 offset:2048
  buffer_load_dwordx4 a[236:239], v13, s[12:15], s62 offen
  v_mfma_f32_16x16x32_bf16 v[96:99], a[172:175], a[112:115], v[96:99]
  s_mov_b32 s62, 93184
  v_mfma_f32_16x16x32_bf16 v[100:103], a[172:175], a[116:119], v[100:103]
  ds_read_b64_tr_b16 a[160:161], v8 offset:4096
  buffer_load_dwordx4 a[240:243], v13, s[12:15], s62 offen
  v_mfma_f32_16x16x32_bf16 v[100:103], a[168:171], a[100:103], v[100:103]
  s_mov_b32 s62, 100352
  ds_read_b128 v[24:27], v14 offset:32
  v_mfma_f32_16x16x32_bf16 v[104:107], a[168:171], a[104:107], v[104:107]
  ds_read_b64_tr_b16 a[162:163], v8 offset:6144
  buffer_load_dwordx4 a[244:247], v13, s[12:15], s62 offen
  v_mfma_f32_16x16x32_bf16 v[104:107], a[172:175], a[120:123], v[104:107]
  s_mov_b32 s62, 107520
  v_mfma_f32_16x16x32_bf16 v[108:111], a[172:175], a[124:127], v[108:111]
  ds_read_b64_tr_b16 a[172:173], v8 offset:8192
  v_mfma_f32_16x16x32_bf16 v[108:111], a[168:171], a[108:111], v[108:111]
  s_waitcnt lgkmcnt(6)
  buffer_load_dwordx4 a[248:251], v13, s[12:15], s62 offen
  v_mfma_f32_16x16x32_bf16 v[124:127], a[176:179], a[108:111], v[124:127]
  ds_read_b64_tr_b16 a[174:175], v8 offset:10240
  v_mfma_f32_16x16x32_bf16 v[124:127], a[180:183], a[124:127], v[124:127]
  s_waitcnt vmcnt(15) lgkmcnt(3)
  v_cndmask_b32 v28, 0, v24, s[16:17]
  v_cndmask_b32 v29, 0, v24, s[18:19]
  v_mfma_f32_16x16x32_bf16 v[120:123], a[180:183], a[120:123], v[120:123]
  ds_read_b64_tr_b16 a[168:169], v8 offset:12288
  v_cndmask_b32 v30, 0, v24, s[20:21]
  v_mfma_f32_16x16x32_bf16 v[120:123], a[176:179], a[104:107], v[120:123]
  v_cndmask_b32 v31, 0, v24, s[22:23]
  v_mfma_f32_16x16x32_bf16 v[116:119], a[176:179], a[100:103], v[116:119]
  ds_read_b64_tr_b16 a[170:171], v8 offset:14336
  v_mfma_f32_16x16x32_bf16 a[184:187], v[28:31], a[220:223], a[184:187]
  v_cndmask_b32 v28, 0, v25, s[16:17]
  v_cndmask_b32 v29, 0, v25, s[18:19]
  v_mfma_f32_16x16x32_bf16 v[116:119], a[180:183], a[116:119], v[116:119]
  v_cndmask_b32 v30, 0, v25, s[20:21]
  v_cndmask_b32 v31, 0, v25, s[22:23]
  v_mfma_f32_16x16x32_bf16 v[112:115], a[180:183], a[112:115], v[112:115]
  ds_read_b64_tr_b16 a[180:181], v2 offset:0
  v_mfma_f32_16x16x32_bf16 a[184:187], v[28:31], a[224:227], a[184:187]
  v_cndmask_b32 v28, 0, v26, s[16:17]
  v_cndmask_b32 v29, 0, v26, s[18:19]
  v_mfma_f32_16x16x32_bf16 v[112:115], a[176:179], a[96:99], v[112:115]
  s_waitcnt lgkmcnt(5)
  v_cndmask_b32 v30, 0, v26, s[20:21]
  v_cndmask_b32 v31, 0, v26, s[22:23]
  v_mfma_f32_16x16x32_bf16 v[32:35], a[164:167], a[96:99], v[32:35]
  ds_read_b64_tr_b16 a[182:183], v2 offset:2048
  v_mfma_f32_16x16x32_bf16 a[184:187], v[28:31], a[228:231], a[184:187]
  v_cndmask_b32 v28, 0, v27, s[16:17]
  v_cndmask_b32 v29, 0, v27, s[18:19]
  v_mfma_f32_16x16x32_bf16 v[32:35], a[160:163], a[112:115], v[32:35]
  v_cndmask_b32 v30, 0, v27, s[20:21]
  v_cndmask_b32 v31, 0, v27, s[22:23]
  v_mfma_f32_16x16x32_bf16 v[36:39], a[160:163], a[116:119], v[36:39]
  ds_read_b64_tr_b16 a[176:177], v2 offset:4096
  v_mfma_f32_16x16x32_bf16 a[184:187], v[28:31], a[232:235], a[184:187]
  v_mfma_f32_16x16x32_bf16 v[36:39], a[164:167], a[100:103], v[36:39]
  v_mfma_f32_16x16x32_bf16 v[40:43], a[164:167], a[104:107], v[40:43]
  ds_read_b64_tr_b16 a[178:179], v2 offset:6144
  v_mfma_f32_16x16x32_bf16 v[40:43], a[160:163], a[120:123], v[40:43]
  v_mfma_f32_16x16x32_bf16 v[44:47], a[160:163], a[124:127], v[44:47]
  ds_read_b64_tr_b16 a[160:161], v2 offset:8192
  v_mfma_f32_16x16x32_bf16 v[44:47], a[164:167], a[108:111], v[44:47]
  s_waitcnt lgkmcnt(5)
  v_mfma_f32_16x16x32_bf16 v[60:63], a[172:175], a[108:111], v[60:63]
  ds_read_b64_tr_b16 a[162:163], v2 offset:10240
  v_mfma_f32_16x16x32_bf16 v[60:63], a[168:171], a[124:127], v[60:63]
  v_mfma_f32_16x16x32_bf16 v[56:59], a[168:171], a[120:123], v[56:59]
  ds_read_b64_tr_b16 a[164:165], v2 offset:12288
  v_mfma_f32_16x16x32_bf16 v[56:59], a[172:175], a[104:107], v[56:59]
  v_mfma_f32_16x16x32_bf16 v[52:55], a[172:175], a[100:103], v[52:55]
  ds_read_b64_tr_b16 a[166:167], v2 offset:14336
  v_mfma_f32_16x16x32_bf16 v[52:55], a[168:171], a[116:119], v[52:55]
  v_mfma_f32_16x16x32_bf16 v[48:51], a[168:171], a[112:115], v[48:51]
  ds_read_b64_tr_b16 a[168:169], v3 offset:0
  v_mfma_f32_16x16x32_bf16 v[48:51], a[172:175], a[96:99], v[48:51]
  s_waitcnt lgkmcnt(5)
  v_mfma_f32_16x16x32_bf16 v[128:131], a[180:183], a[96:99], v[128:131]
  ds_read_b64_tr_b16 a[170:171], v3 offset:2048
  v_mfma_f32_16x16x32_bf16 v[128:131], a[176:179], a[112:115], v[128:131]
  v_mfma_f32_16x16x32_bf16 v[132:135], a[176:179], a[116:119], v[132:135]
  ds_read_b64_tr_b16 a[172:173], v3 offset:4096
  v_mfma_f32_16x16x32_bf16 v[132:135], a[180:183], a[100:103], v[132:135]
  v_mfma_f32_16x16x32_bf16 v[136:139], a[180:183], a[104:107], v[136:139]
  ds_read_b64_tr_b16 a[174:175], v3 offset:6144
  v_mfma_f32_16x16x32_bf16 v[136:139], a[176:179], a[120:123], v[136:139]
  buffer_load_dwordx4 a[148:151], v1, s[8:11], s76 offen offset:1024 sc1
  v_mfma_f32_16x16x32_bf16 v[140:143], a[176:179], a[124:127], v[140:143]
  ds_read_b64_tr_b16 a[176:177], v3 offset:8192
  v_mfma_f32_16x16x32_bf16 v[140:143], a[180:183], a[108:111], v[140:143]
  s_waitcnt lgkmcnt(5)
  s_add_u32 s76, s76, 65536
  v_mfma_f32_16x16x32_bf16 v[156:159], a[160:163], a[108:111], v[156:159]
  ds_read_b64_tr_b16 a[178:179], v3 offset:10240
  v_mfma_f32_16x16x32_bf16 v[156:159], a[164:167], a[124:127], v[156:159]
  buffer_load_dwordx4 a[136:139], v1, s[8:11], s76 offen offset:0 sc1
  v_mfma_f32_16x16x32_bf16 v[152:155], a[164:167], a[120:123], v[152:155]
  ds_read_b64_tr_b16 a[180:181], v3 offset:12288
  v_mfma_f32_16x16x32_bf16 v[152:155], a[160:163], a[104:107], v[152:155]
  v_mfma_f32_16x16x32_bf16 v[148:151], a[160:163], a[100:103], v[148:151]
  ds_read_b64_tr_b16 a[182:183], v3 offset:14336
  v_mfma_f32_16x16x32_bf16 v[148:151], a[164:167], a[116:119], v[148:151]
  v_mfma_f32_16x16x32_bf16 v[144:147], a[164:167], a[112:115], v[144:147]
  ds_read_b64_tr_b16 a[164:165], v4 offset:0
  v_mfma_f32_16x16x32_bf16 v[144:147], a[160:163], a[96:99], v[144:147]
  s_waitcnt lgkmcnt(5)
  buffer_load_dwordx4 a[152:155], v1, s[8:11], s76 offen offset:1024 sc1
  v_mfma_f32_16x16x32_bf16 v[160:163], a[168:171], a[96:99], v[160:163]
  ds_read_b64_tr_b16 a[166:167], v4 offset:2048
  s_waitcnt vmcnt(9)
  v_mfma_f32_16x16x32_bf16 v[160:163], a[172:175], a[112:115], v[160:163]
  s_add_u32 s76, s76, 65536
  v_accvgpr_read_b32 v16, a188
  v_accvgpr_read_b32 v17, a189
  v_mfma_f32_16x16x32_bf16 v[164:167], a[172:175], a[116:119], v[164:167]
  ds_read_b64_tr_b16 a[160:161], v4 offset:4096
  v_accvgpr_read_b32 v18, a190
  v_mfma_f32_16x16x32_bf16 v[164:167], a[168:171], a[100:103], v[164:167]
  buffer_load_dwordx4 a[140:143], v1, s[8:11], s76 offen offset:0 sc1
  v_accvgpr_read_b32 v19, a191
  v_accvgpr_read_b32 v20, a192
  v_mfma_f32_16x16x32_bf16 v[168:171], a[168:171], a[104:107], v[168:171]
  ds_read_b64_tr_b16 a[162:163], v4 offset:6144
  v_accvgpr_read_b32 v21, a193
  v_mfma_f32_16x16x32_bf16 v[168:171], a[172:175], a[120:123], v[168:171]
  v_accvgpr_read_b32 v22, a194
  v_accvgpr_read_b32 v23, a195
  v_mfma_f32_16x16x32_bf16 v[172:175], a[172:175], a[124:127], v[172:175]
  ds_read_b64_tr_b16 a[172:173], v4 offset:8192
  v_accvgpr_read_b32 v24, a196
  v_mfma_f32_16x16x32_bf16 v[172:175], a[168:171], a[108:111], v[172:175]
  s_waitcnt lgkmcnt(5)
  v_accvgpr_read_b32 v25, a197
  v_accvgpr_read_b32 v26, a198
  v_mfma_f32_16x16x32_bf16 v[188:191], a[176:179], a[108:111], v[188:191]
  ds_read_b64_tr_b16 a[174:175], v4 offset:10240
  v_accvgpr_read_b32 v27, a199
  v_mfma_f32_16x16x32_bf16 v[188:191], a[180:183], a[124:127], v[188:191]
  buffer_load_dwordx4 a[156:159], v1, s[8:11], s76 offen offset:1024 sc1
  v_accvgpr_read_b32 v28, a200
  v_accvgpr_read_b32 v29, a201
  v_mfma_f32_16x16x32_bf16 v[184:187], a[180:183], a[120:123], v[184:187]
  ds_read_b64_tr_b16 a[168:169], v4 offset:12288
  v_accvgpr_read_b32 v30, a202
  v_mfma_f32_16x16x32_bf16 v[184:187], a[176:179], a[104:107], v[184:187]
  s_mov_b32 s69, 2293760
  s_add_u32 s77, s57, 10240
  s_add_u32 m0, s45, 114688
  v_accvgpr_read_b32 v31, a203
  v_add_f32 v16, v16, v24
  v_mfma_f32_16x16x32_bf16 v[180:183], a[176:179], a[100:103], v[180:183]
  ds_read_b64_tr_b16 a[170:171], v4 offset:14336
  v_add_f32 v17, v17, v25
  v_mfma_f32_16x16x32_bf16 v[180:183], a[180:183], a[116:119], v[180:183]
  buffer_load_dwordx4 v11, s[28:31], s69 offen lds
  v_add_f32 v18, v18, v26
  v_add_f32 v19, v19, v27
  v_mfma_f32_16x16x32_bf16 v[176:179], a[180:183], a[112:115], v[176:179]
  ds_read_b64_tr_b16 a[180:181], v5 offset:0
  v_add_f32 v20, v20, v28
  v_mfma_f32_16x16x32_bf16 v[176:179], a[176:179], a[96:99], v[176:179]
  s_waitcnt lgkmcnt(5)
  v_add_f32 v21, v21, v29
  v_add_f32 v22, v22, v30
  v_mfma_f32_16x16x32_bf16 v[192:195], a[164:167], a[96:99], v[192:195]
  ds_read_b64_tr_b16 a[182:183], v5 offset:2048
  v_add_f32 v23, v23, v31
  v_mfma_f32_16x16x32_bf16 v[192:195], a[160:163], a[112:115], v[192:195]
  s_add_u32 m0, s45, 122880
  v_accvgpr_read_b32 v24, a204
  v_accvgpr_read_b32 v25, a205
  v_mfma_f32_16x16x32_bf16 v[196:199], a[160:163], a[116:119], v[196:199]
  ds_read_b64_tr_b16 a[176:177], v5 offset:4096
  v_accvgpr_read_b32 v26, a206
  v_mfma_f32_16x16x32_bf16 v[196:199], a[164:167], a[100:103], v[196:199]
  buffer_load_dwordx4 v11, s[32:35], s69 offen lds
  v_accvgpr_read_b32 v27, a207
  v_accvgpr_read_b32 v28, a208
  v_mfma_f32_16x16x32_bf16 v[200:203], a[164:167], a[104:107], v[200:203]
  ds_read_b64_tr_b16 a[178:179], v5 offset:6144
  v_accvgpr_read_b32 v29, a209
  v_mfma_f32_16x16x32_bf16 v[200:203], a[160:163], a[120:123], v[200:203]
  s_add_u32 m0, s45, 118784
  s_add_u32 s61, s69, 229376
  v_accvgpr_read_b32 v30, a210
  v_mfma_f32_16x16x32_bf16 v[204:207], a[160:163], a[124:127], v[204:207]
  ds_read_b64_tr_b16 a[160:161], v5 offset:8192
  v_accvgpr_read_b32 v31, a211
  v_mfma_f32_16x16x32_bf16 v[204:207], a[164:167], a[108:111], v[204:207]
  s_waitcnt lgkmcnt(5)
  buffer_load_dwordx4 v11, s[28:31], s61 offen lds
  v_add_f32 v16, v16, v24
  v_mfma_f32_16x16x32_bf16 v[220:223], a[172:175], a[108:111], v[220:223]
  ds_read_b64_tr_b16 a[162:163], v5 offset:10240
  v_add_f32 v17, v17, v25
  v_mfma_f32_16x16x32_bf16 v[220:223], a[168:171], a[124:127], v[220:223]
  v_add_f32 v18, v18, v26
  v_add_f32 v19, v19, v27
  v_mfma_f32_16x16x32_bf16 v[216:219], a[168:171], a[120:123], v[216:219]
  ds_read_b64_tr_b16 a[164:165], v5 offset:12288
  v_add_f32 v20, v20, v28
  v_mfma_f32_16x16x32_bf16 v[216:219], a[172:175], a[104:107], v[216:219]
  s_add_u32 m0, s45, 126976
  s_add_u32 s61, s69, 229376
  v_add_f32 v21, v21, v29
  v_mfma_f32_16x16x32_bf16 v[212:215], a[172:175], a[100:103], v[212:215]
  ds_read_b64_tr_b16 a[166:167], v5 offset:14336
  buffer_load_dwordx4 v11, s[32:35], s61 offen lds
  v_mfma_f32_16x16x32_bf16 v[212:215], a[168:171], a[116:119], v[212:215]
  s_waitcnt vmcnt(28)
  s_barrier
  v_mfma_f32_16x16x32_bf16 v[208:211], a[168:171], a[112:115], v[208:211]
  ds_read_b64_tr_b16 a[168:169], v6 offset:32768
  v_add_f32 v22, v22, v30
  v_mfma_f32_16x16x32_bf16 v[208:211], a[172:175], a[96:99], v[208:211]
  s_waitcnt lgkmcnt(5)
  s_add_u32 m0, s45, 49152
  v_add_f32 v23, v23, v31
  v_mfma_f32_16x16x32_bf16 v[224:227], a[180:183], a[96:99], v[224:227]
  ds_read_b64_tr_b16 a[170:171], v6 offset:34816
  v_accvgpr_read_b32 v24, a212
  v_mfma_f32_16x16x32_bf16 v[224:227], a[176:179], a[112:115], v[224:227]
  buffer_load_dwordx4 v10, s[28:31], s69 offen lds
  v_accvgpr_read_b32 v25, a213
  v_accvgpr_read_b32 v26, a214
  v_mfma_f32_16x16x32_bf16 v[228:231], a[176:179], a[116:119], v[228:231]
  ds_read_b64_tr_b16 a[172:173], v6 offset:36864
  v_accvgpr_read_b32 v27, a215
  v_mfma_f32_16x16x32_bf16 v[228:231], a[180:183], a[100:103], v[228:231]
  v_accvgpr_read_b32 v28, a216
  v_accvgpr_read_b32 v29, a217
  v_mfma_f32_16x16x32_bf16 v[232:235], a[180:183], a[104:107], v[232:235]
  ds_read_b64_tr_b16 a[174:175], v6 offset:38912
  v_accvgpr_read_b32 v30, a218
  v_mfma_f32_16x16x32_bf16 v[232:235], a[176:179], a[120:123], v[232:235]
  s_add_u32 m0, s45, 57344
  v_accvgpr_read_b32 v31, a219
  v_add_f32 v16, v16, v24
  v_mfma_f32_16x16x32_bf16 v[236:239], a[176:179], a[124:127], v[236:239]
  ds_read_b64_tr_b16 a[176:177], v6 offset:40960
  v_add_f32 v17, v17, v25
  v_mfma_f32_16x16x32_bf16 v[236:239], a[180:183], a[108:111], v[236:239]
  s_waitcnt lgkmcnt(5)
  buffer_load_dwordx4 v10, s[32:35], s69 offen lds
  v_add_f32 v18, v18, v26
  v_mfma_f32_16x16x32_bf16 v[252:255], a[160:163], a[108:111], v[252:255]
  ds_read_b64_tr_b16 a[178:179], v6 offset:43008
  v_add_f32 v19, v19, v27
  v_mfma_f32_16x16x32_bf16 v[252:255], a[164:167], a[124:127], v[252:255]
  s_add_u32 m0, s45, 53248
  s_add_u32 s61, s69, 229376
  v_add_f32 v20, v20, v28
  v_mfma_f32_16x16x32_bf16 v[248:251], a[164:167], a[120:123], v[248:251]
  ds_read_b64_tr_b16 a[180:181], v6 offset:45056
  v_add_f32 v21, v21, v29
  v_mfma_f32_16x16x32_bf16 v[248:251], a[160:163], a[104:107], v[248:251]
  buffer_load_dwordx4 v10, s[28:31], s61 offen lds
  v_add_f32 v22, v22, v30
  v_add_f32 v23, v23, v31
  v_mfma_f32_16x16x32_bf16 v[244:247], a[160:163], a[100:103], v[244:247]
  ds_read_b64_tr_b16 a[182:183], v6 offset:47104
  v_mfma_f32_16x16x32_bf16 v[244:247], a[164:167], a[116:119], v[244:247]
  ds_read_b128 v[24:27], v14 offset:48
  v_mfma_f32_16x16x32_bf16 v[240:243], a[164:167], a[112:115], v[240:243]
  ds_read_b64_tr_b16 a[164:165], v7 offset:32768
  v_mfma_f32_16x16x32_bf16 v[240:243], a[160:163], a[96:99], v[240:243]
  s_waitcnt vmcnt(7) lgkmcnt(6)
  s_add_u32 m0, s45, 61440
  s_add_u32 s61, s69, 229376
  v_mfma_f32_16x16x32_bf16 v[64:67], a[168:171], a[128:131], v[64:67]
  ds_read_b64_tr_b16 a[166:167], v7 offset:34816
  v_mfma_f32_16x16x32_bf16 v[64:67], a[172:175], a[144:147], v[64:67]
  buffer_load_dwordx4 v10, s[32:35], s61 offen lds
  v_mfma_f32_16x16x32_bf16 v[68:71], a[172:175], a[148:151], v[68:71]
  ds_read_b64_tr_b16 a[160:161], v7 offset:36864
  v_mfma_f32_16x16x32_bf16 v[68:71], a[168:171], a[132:135], v[68:71]
  s_waitcnt vmcnt(13) lgkmcnt(3)
  v_cndmask_b32 v28, 0, v24, s[16:17]
  v_mfma_f32_16x16x32_bf16 v[72:75], a[168:171], a[136:139], v[72:75]
  ds_read_b64_tr_b16 a[162:163], v7 offset:38912
  v_cndmask_b32 v29, 0, v24, s[18:19]
  v_mfma_f32_16x16x32_bf16 v[72:75], a[172:175], a[152:155], v[72:75]
  buffer_load_dwordx4 a[0:3], v1, s[8:11], s77 offen offset:0 sc1
  v_cndmask_b32 v30, 0, v24, s[20:21]
  v_cndmask_b32 v31, 0, v24, s[22:23]
  v_mfma_f32_16x16x32_bf16 v[76:79], a[172:175], a[156:159], v[76:79]
  ds_read_b64_tr_b16 a[172:173], v7 offset:40960
  v_mfma_f32_16x16x32_bf16 a[184:187], v[28:31], a[236:239], a[184:187]
  v_cndmask_b32 v28, 0, v25, s[16:17]
  v_cndmask_b32 v29, 0, v25, s[18:19]
  v_mfma_f32_16x16x32_bf16 v[76:79], a[168:171], a[140:143], v[76:79]
  s_waitcnt lgkmcnt(6)
  v_cndmask_b32 v30, 0, v25, s[20:21]
  v_cndmask_b32 v31, 0, v25, s[22:23]
  v_mfma_f32_16x16x32_bf16 v[92:95], a[176:179], a[140:143], v[92:95]
  ds_read_b64_tr_b16 a[174:175], v7 offset:43008
  v_mfma_f32_16x16x32_bf16 a[184:187], v[28:31], a[240:243], a[184:187]
  v_cndmask_b32 v28, 0, v26, s[16:17]
  v_cndmask_b32 v29, 0, v26, s[18:19]
  v_mfma_f32_16x16x32_bf16 v[92:95], a[180:183], a[156:159], v[92:95]
  v_cndmask_b32 v30, 0, v26, s[20:21]
  v_cndmask_b32 v31, 0, v26, s[22:23]
  v_mfma_f32_16x16x32_bf16 v[88:91], a[180:183], a[152:155], v[88:91]
  ds_read_b64_tr_b16 a[168:169], v7 offset:45056
  v_mfma_f32_16x16x32_bf16 a[184:187], v[28:31], a[244:247], a[184:187]
  v_cndmask_b32 v28, 0, v27, s[16:17]
  v_cndmask_b32 v29, 0, v27, s[18:19]
  v_mfma_f32_16x16x32_bf16 v[88:91], a[176:179], a[136:139], v[88:91]
  buffer_load_dwordx4 a[16:19], v1, s[8:11], s77 offen offset:1024 sc1
  v_cndmask_b32 v30, 0, v27, s[20:21]
  v_cndmask_b32 v31, 0, v27, s[22:23]
  v_mfma_f32_16x16x32_bf16 v[84:87], a[176:179], a[132:135], v[84:87]
  ds_read_b64_tr_b16 a[170:171], v7 offset:47104
  v_mfma_f32_16x16x32_bf16 a[184:187], v[28:31], a[248:251], a[184:187]
  v_mfma_f32_16x16x32_bf16 v[84:87], a[180:183], a[148:151], v[84:87]
  s_add_u32 s77, s77, 65536
  v_mfma_f32_16x16x32_bf16 v[80:83], a[180:183], a[144:147], v[80:83]
  ds_read_b64_tr_b16 a[180:181], v8 offset:32768
  v_mfma_f32_16x16x32_bf16 v[80:83], a[176:179], a[128:131], v[80:83]
  s_waitcnt lgkmcnt(5)
  buffer_load_dwordx4 a[4:7], v1, s[8:11], s77 offen offset:0 sc1
  v_mfma_f32_16x16x32_bf16 v[96:99], a[164:167], a[128:131], v[96:99]
  ds_read_b64_tr_b16 a[182:183], v8 offset:34816
  s_bfe_u32 s53, s2, 0x20004
  v_mfma_f32_16x16x32_bf16 v[96:99], a[160:163], a[144:147], v[96:99]
  s_lshl_b32 s53, s53, 9
  v_and_b32 v14, 15, v0
  v_lshl_add_u32 v14, v14, 5, s53
  v_mfma_f32_16x16x32_bf16 v[100:103], a[160:163], a[148:151], v[100:103]
  ds_read_b64_tr_b16 a[176:177], v8 offset:36864
  v_cmp_gt_u32 vcc, 1792, v14
  v_mov_b32 v15, 134217728
  v_bfe_u32 v13, v0, 4, 1
  v_cndmask_b32 v14, v15, v14, vcc
  v_mfma_f32_16x16x32_bf16 v[100:103], a[164:167], a[132:135], v[100:103]
  v_lshl_add_u32 v14, v13, 4, v14
  v_lshrrev_b32 v13, 5, v0
  v_mfma_f32_16x16x32_bf16 v[104:107], a[164:167], a[136:139], v[104:107]
  ds_read_b64_tr_b16 a[178:179], v8 offset:38912
  v_mul_u32_u24 v13, 14336, v13
  v_mfma_f32_16x16x32_bf16 v[104:107], a[160:163], a[152:155], v[104:107]
  buffer_load_dwordx4 a[20:23], v1, s[8:11], s77 offen offset:1024 sc1
  v_add_u32 v14, v14, v13
  s_lshr_b32 s53, s2, 6
  v_mfma_f32_16x16x32_bf16 v[108:111], a[160:163], a[156:159], v[108:111]
  ds_read_b64_tr_b16 a[160:161], v8 offset:40960
  s_lshl_b32 s53, s53, 2
  v_mfma_f32_16x16x32_bf16 v[108:111], a[164:167], a[140:143], v[108:111]
  s_waitcnt lgkmcnt(5)
  s_add_u32 s62, s63, 8192
  s_add_u32 s53, s53, s44
  v_mfma_f32_16x16x32_bf16 v[124:127], a[172:175], a[140:143], v[124:127]
  ds_read_b64_tr_b16 a[162:163], v8 offset:43008
  s_lshl_b32 s53, s53, 1
  v_mfma_f32_16x16x32_bf16 v[124:127], a[168:171], a[156:159], v[124:127]
  buffer_load_dwordx4 a[188:191], v12, s[8:11], s62 offen offset:0 sc1
  s_bfe_u32 s54, s2, 0x10003
  s_add_u32 s53, s53, s54
  v_mfma_f32_16x16x32_bf16 v[120:123], a[168:171], a[152:155], v[120:123]
  ds_read_b64_tr_b16 a[164:165], v8 offset:45056
HOP9:
  s_cbranch_execz HOP13
  s_mul_i32 s53, s53, 28672
  v_mfma_f32_16x16x32_bf16 v[120:123], a[172:175], a[136:139], v[120:123]
  s_mul_i32 s54, s52, 1792
  s_add_u32 s53, s53, s54
  s_add_u32 s53, s53, 46137344
  v_mfma_f32_16x16x32_bf16 v[116:119], a[172:175], a[132:135], v[116:119]
  ds_read_b64_tr_b16 a[166:167], v8 offset:47104
  v_mfma_f32_16x16x32_bf16 v[116:119], a[168:171], a[148:151], v[116:119]
  s_add_u32 s62, s63, 8192
  buffer_store_dwordx4 a[184:187], v14, s[8:11], s53 offen sc1
  v_mfma_f32_16x16x32_bf16 v[112:115], a[168:171], a[144:147], v[112:115]
  ds_read_b64_tr_b16 a[168:169], v2 offset:32768
  s_lshl_b32 s53, s52, 7
  v_mfma_f32_16x16x32_bf16 v[112:115], a[172:175], a[128:131], v[112:115]
  s_waitcnt lgkmcnt(5)
  buffer_load_dwordx4 a[192:195], v12, s[8:11], s62 offen offset:256 sc1
  s_add_u32 s53, s53, 884736
  v_mfma_f32_16x16x32_bf16 v[32:35], a[180:183], a[128:131], v[32:35]
  ds_read_b64_tr_b16 a[170:171], v2 offset:34816
  v_and_b32 v13, 31, v0
  v_mfma_f32_16x16x32_bf16 v[32:35], a[176:179], a[144:147], v[32:35]
  s_add_u32 s62, s63, 10240
  v_min_u32 v15, 27, v13
  v_lshl_add_u32 v13, v13, 10, s53
  v_mfma_f32_16x16x32_bf16 v[36:39], a[176:179], a[148:151], v[36:39]
  ds_read_b64_tr_b16 a[172:173], v2 offset:36864
  v_lshlrev_b32 v15, 4, v15
  v_mfma_f32_16x16x32_bf16 v[36:39], a[180:183], a[132:135], v[36:39]
  buffer_load_dwordx4 a[196:199], v12, s[8:11], s62 offen offset:0 sc1
  s_lshl_b32 s53, s51, 9
  v_mov_b32 v14, s53
  v_mfma_f32_16x16x32_bf16 v[40:43], a[180:183], a[136:139], v[40:43]
  ds_read_b64_tr_b16 a[174:175], v2 offset:38912
  s_lshl_b32 s55, s51, 3
  v_mfma_f32_16x16x32_bf16 v[40:43], a[176:179], a[152:155], v[40:43]
  s_lshr_b32 s53, 0x0b070602, s55
  s_and_b32 s53, s53, 15
  s_lshl_b32 s53, s53, 7
  v_mfma_f32_16x16x32_bf16 v[44:47], a[176:179], a[156:159], v[44:47]
  ds_read_b64_tr_b16 a[176:177], v2 offset:40960
  s_sub_u32 s53, s53, 256
  v_mfma_f32_16x16x32_bf16 v[44:47], a[180:183], a[140:143], v[44:47]
  s_waitcnt lgkmcnt(5)
  s_add_u32 s62, s63, 10240
  v_mov_b32 v24, s53
  v_mfma_f32_16x16x32_bf16 v[60:63], a[160:163], a[140:143], v[60:63]
  ds_read_b64_tr_b16 a[178:179], v2 offset:43008
  v_mfma_f32_16x16x32_bf16 v[60:63], a[164:167], a[156:159], v[60:63]
  buffer_load_dwordx4 a[200:203], v12, s[8:11], s62 offen offset:256 sc1
  v_cmp_gt_u32 vcc, 256, v15
  s_nop 1
  v_cndmask_b32 v14, v24, v14, vcc
  v_mfma_f32_16x16x32_bf16 v[56:59], a[164:167], a[152:155], v[56:59]
  ds_read_b64_tr_b16 a[180:181], v2 offset:45056
  s_lshr_b32 s53, 0x15140706, s55
  v_mfma_f32_16x16x32_bf16 v[56:59], a[160:163], a[136:139], v[56:59]
  s_add_u32 s62, s63, 12288
  s_and_b32 s53, s53, 31
  s_lshl_b32 s53, s53, 6
  v_mfma_f32_16x16x32_bf16 v[52:55], a[160:163], a[132:135], v[52:55]
  ds_read_b64_tr_b16 a[182:183], v2 offset:47104
  s_sub_u32 s53, s53, 384
  v_mfma_f32_16x16x32_bf16 v[52:55], a[164:167], a[148:151], v[52:55]
  buffer_load_dwordx4 a[204:207], v12, s[8:11], s62 offen offset:0 sc1
  v_mov_b32 v24, s53
  v_mfma_f32_16x16x32_bf16 v[48:51], a[164:167], a[144:147], v[48:51]
  ds_read_b64_tr_b16 a[164:165], v3 offset:32768
  v_mfma_f32_16x16x32_bf16 v[48:51], a[160:163], a[128:131], v[48:51]
  s_waitcnt lgkmcnt(5)
  v_cmp_gt_u32 vcc, 384, v15
  s_nop 1
  v_cndmask_b32 v14, v24, v14, vcc
  v_mfma_f32_16x16x32_bf16 v[128:131], a[168:171], a[128:131], v[128:131]
  ds_read_b64_tr_b16 a[166:167], v3 offset:34816
  v_lshrrev_b32 v24, 5, v0
  v_mfma_f32_16x16x32_bf16 v[128:131], a[172:175], a[144:147], v[128:131]
  s_add_u32 s62, s63, 12288
  v_mul_u32_u24 v24, 57344, v24
  v_add3_u32 v14, v14, v15, v24
  v_mfma_f32_16x16x32_bf16 v[132:135], a[172:175], a[148:151], v[132:135]
  ds_read_b64_tr_b16 a[160:161], v3 offset:36864
  s_mul_i32 s53, s44, 14336
  v_mfma_f32_16x16x32_bf16 v[132:135], a[168:171], a[132:135], v[132:135]
  buffer_load_dwordx4 a[208:211], v12, s[8:11], s62 offen offset:256 sc1
  s_add_u32 s53, s53, s54
  s_add_u32 s53, s53, 46137344
  v_mfma_f32_16x16x32_bf16 v[136:139], a[168:171], a[136:139], v[136:139]
  ds_read_b64_tr_b16 a[162:163], v3 offset:38912
  v_add_u32 v14, s53, v14
  v_mfma_f32_16x16x32_bf16 v[136:139], a[172:175], a[152:155], v[136:139]
  s_add_u32 s62, s63, 14336
  s_lshl_b32 s53, s44, 9
  s_add_u32 s53, s53, 131072
  v_mfma_f32_16x16x32_bf16 v[140:143], a[172:175], a[156:159], v[140:143]
  ds_read_b64_tr_b16 a[172:173], v3 offset:40960
  v_add_u32 v15, s53, v15
  v_mfma_f32_16x16x32_bf16 v[140:143], a[168:171], a[140:143], v[140:143]
  s_waitcnt lgkmcnt(5)
  buffer_load_dwordx4 a[212:215], v12, s[8:11], s62 offen offset:0 sc1
  s_and_b32 s50, s2, 4
  v_mfma_f32_16x16x32_bf16 v[156:159], a[176:179], a[140:143], v[156:159]
  ds_read_b64_tr_b16 a[174:175], v3 offset:43008
  s_lshr_b32 s53, s2, 6
  v_mfma_f32_16x16x32_bf16 v[156:159], a[180:183], a[156:159], v[156:159]
  s_add_u32 s50, s50, s53
  s_bfe_u32 s51, s2, 0x30003
  s_and_b32 s52, s2, 3
  v_mfma_f32_16x16x32_bf16 v[152:155], a[180:183], a[152:155], v[152:155]
  ds_read_b64_tr_b16 a[168:169], v3 offset:45056
  s_add_u32 s91, s50, s51
  v_mfma_f32_16x16x32_bf16 v[152:155], a[176:179], a[136:139], v[152:155]
  s_add_u32 s62, s63, 14336
  s_and_b32 s91, s91, 3
  s_lshl_b32 s53, s50, 4
  v_mfma_f32_16x16x32_bf16 v[148:151], a[176:179], a[132:135], v[148:151]
  ds_read_b64_tr_b16 a[170:171], v3 offset:47104
  s_and_b32 s54, s52, 2
  v_mfma_f32_16x16x32_bf16 v[148:151], a[180:183], a[148:151], v[148:151]
  buffer_load_dwordx4 a[216:219], v12, s[8:11], s62 offen offset:256 sc1
  s_mul_i32 s89, s54, 4293918720
  s_add_u32 s89, s89, 917504
  v_mfma_f32_16x16x32_bf16 v[144:147], a[180:183], a[144:147], v[144:147]
  ds_read_b64_tr_b16 a[180:181], v4 offset:32768
  s_lshl_b32 s54, s54, 2
  v_mfma_f32_16x16x32_bf16 v[144:147], a[176:179], a[128:131], v[144:147]
  s_waitcnt lgkmcnt(5)
  s_add_u32 s77, s77, 65536
  s_add_u32 s53, s53, s54
  v_mfma_f32_16x16x32_bf16 v[160:163], a[164:167], a[128:131], v[160:163]
  ds_read_b64_tr_b16 a[182:183], v4 offset:34816
  s_lshl_b32 s54, s44, 1
  v_mfma_f32_16x16x32_bf16 v[160:163], a[160:163], a[144:147], v[160:163]
  buffer_load_dwordx4 a[8:11], v1, s[8:11], s77 offen offset:0 sc1
  s_add_u32 s53, s53, s54
  s_mul_i32 s84, s53, 131072
  v_mfma_f32_16x16x32_bf16 v[164:167], a[160:163], a[148:151], v[164:167]
  ds_read_b64_tr_b16 a[176:177], v4 offset:36864
  s_mul_i32 s54, s52, 28672
  v_mfma_f32_16x16x32_bf16 v[164:167], a[164:167], a[132:135], v[164:167]
  s_add_u32 s84, s84, s54
  s_add_u32 s84, s84, 19922944
  s_lshl_b32 s85, s53, 15
  v_mfma_f32_16x16x32_bf16 v[168:171], a[164:167], a[136:139], v[168:171]
  ds_read_b64_tr_b16 a[178:179], v4 offset:38912
  s_lshl_b32 s51, s51, 1
  v_mfma_f32_16x16x32_bf16 v[168:171], a[160:163], a[152:155], v[168:171]
  s_and_b32 s54, s52, 1
  s_add_u32 s51, s51, s54
  s_lshl_b32 s53, s51, 7
  v_mfma_f32_16x16x32_bf16 v[172:175], a[160:163], a[156:159], v[172:175]
  ds_read_b64_tr_b16 a[160:161], v4 offset:40960
  s_add_u32 s85, s85, s53
  v_mfma_f32_16x16x32_bf16 v[172:175], a[164:167], a[140:143], v[172:175]
  s_waitcnt lgkmcnt(5)
  buffer_load_dwordx4 a[24:27], v1, s[8:11], s77 offen offset:1024 sc1
  s_lshl_b32 s88, s51, 8
  v_mfma_f32_16x16x32_bf16 v[188:191], a[172:175], a[140:143], v[188:191]
  ds_read_b64_tr_b16 a[162:163], v4 offset:43008
  s_add_u32 s88, s88, 20480
  v_mfma_f32_16x16x32_bf16 v[188:191], a[168:171], a[156:159], v[188:191]
  s_add_u32 s77, s77, 65536
  s_lshl_b32 s53, s50, 12
  s_lshl_b32 s54, s52, 8
  v_mfma_f32_16x16x32_bf16 v[184:187], a[168:171], a[152:155], v[184:187]
  ds_read_b64_tr_b16 a[164:165], v4 offset:45056
  s_add_u32 s53, s53, s54
  v_mfma_f32_16x16x32_bf16 v[184:187], a[172:175], a[136:139], v[184:187]
  buffer_load_dwordx4 a[12:15], v1, s[8:11], s77 offen offset:0 sc1
  s_add_u32 s82, s53, 688128
  s_lshl_b32 s90, s44, 12
  v_mfma_f32_16x16x32_bf16 v[180:183], a[172:175], a[132:135], v[180:183]
  ds_read_b64_tr_b16 a[166:167], v4 offset:47104
  s_add_u32 s90, s90, 135168
  v_mfma_f32_16x16x32_bf16 v[180:183], a[168:171], a[148:151], v[180:183]
  s_lshl_b32 s86, s2, 16
  s_lshl_b32 s53, s44, 14
  s_add_u32 s86, s86, s53
  v_mfma_f32_16x16x32_bf16 v[176:179], a[168:171], a[144:147], v[176:179]
  ds_read_b64_tr_b16 a[168:169], v5 offset:32768
  s_add_u32 s86, s86, 67108864
  v_mfma_f32_16x16x32_bf16 v[176:179], a[172:175], a[128:131], v[176:179]
  s_waitcnt lgkmcnt(5)
  s_lshr_b32 s53, s2, 3
  s_lshl_b32 s53, s53, 2
  v_mfma_f32_16x16x32_bf16 v[192:195], a[180:183], a[128:131], v[192:195]
  ds_read_b64_tr_b16 a[170:171], v5 offset:34816
  s_add_u32 s53, s53, s44
  v_mfma_f32_16x16x32_bf16 v[192:195], a[176:179], a[144:147], v[192:195]
  buffer_load_dwordx4 a[28:31], v1, s[8:11], s77 offen offset:1024 sc1
  s_mul_i32 s92, s53, 14336
  s_mul_i32 s53, s52, 1835008
  v_mfma_f32_16x16x32_bf16 v[196:199], a[176:179], a[148:151], v[196:199]
  ds_read_b64_tr_b16 a[172:173], v5 offset:36864
  s_add_u32 s92, s92, s53
  v_mfma_f32_16x16x32_bf16 v[196:199], a[180:183], a[132:135], v[196:199]
  s_mov_b32 s70, 2752512
  s_add_u32 s78, s57, 12288
  s_add_u32 m0, s45, 81920
  s_nop 0
  v_mfma_f32_16x16x32_bf16 v[200:203], a[180:183], a[136:139], v[200:203]
  ds_read_b64_tr_b16 a[174:175], v5 offset:38912
  v_mfma_f32_16x16x32_bf16 v[200:203], a[176:179], a[152:155], v[200:203]
  buffer_load_dwordx4 v11, s[28:31], s70 offen lds
  v_mfma_f32_16x16x32_bf16 v[204:207], a[176:179], a[156:159], v[204:207]
  ds_read_b64_tr_b16 a[176:177], v5 offset:40960
  v_mfma_f32_16x16x32_bf16 v[204:207], a[180:183], a[140:143], v[204:207]
  s_waitcnt lgkmcnt(5)
  v_mfma_f32_16x16x32_bf16 v[220:223], a[160:163], a[140:143], v[220:223]
  ds_read_b64_tr_b16 a[178:179], v5 offset:43008
  v_mfma_f32_16x16x32_bf16 v[220:223], a[164:167], a[156:159], v[220:223]
  s_add_u32 m0, s45, 90112
  v_mfma_f32_16x16x32_bf16 v[216:219], a[164:167], a[152:155], v[216:219]
  ds_read_b64_tr_b16 a[180:181], v5 offset:45056
  v_mfma_f32_16x16x32_bf16 v[216:219], a[160:163], a[136:139], v[216:219]
  buffer_load_dwordx4 v11, s[32:35], s70 offen lds
  v_mfma_f32_16x16x32_bf16 v[212:215], a[160:163], a[132:135], v[212:215]
  ds_read_b64_tr_b16 a[182:183], v5 offset:47104
  v_add_u32 v9, s46, v0
  s_waitcnt vmcnt(13)
  s_barrier
  s_mov_b64 exec, 1
  buffer_store_dword v9, v0, s[8:11], s80 offen offset:0 sc1
  s_mov_b64 exec, -1
  s_sub_u32 s80, s80, 196608
  v_mfma_f32_16x16x32_bf16 v[212:215], a[164:167], a[148:151], v[212:215]
  s_waitcnt vmcnt(20)
  s_barrier
  v_mfma_f32_16x16x32_bf16 v[208:211], a[164:167], a[144:147], v[208:211]
  ds_read_b64_tr_b16 a[164:165], v6 offset:49152
  s_add_u32 m0, s45, 86016
  s_add_u32 s61, s70, 229376
  v_mfma_f32_16x16x32_bf16 v[208:211], a[160:163], a[128:131], v[208:211]
  s_waitcnt lgkmcnt(5)
  buffer_load_dwordx4 v11, s[28:31], s61 offen lds
  v_mfma_f32_16x16x32_bf16 v[224:227], a[168:171], a[128:131], v[224:227]
  ds_read_b64_tr_b16 a[166:167], v6 offset:51200
  v_mfma_f32_16x16x32_bf16 v[224:227], a[172:175], a[144:147], v[224:227]
  v_mfma_f32_16x16x32_bf16 v[228:231], a[172:175], a[148:151], v[228:231]
  ds_read_b64_tr_b16 a[160:161], v6 offset:53248
  v_mfma_f32_16x16x32_bf16 v[228:231], a[168:171], a[132:135], v[228:231]
  s_add_u32 m0, s45, 94208
  s_add_u32 s61, s70, 229376
  v_mfma_f32_16x16x32_bf16 v[232:235], a[168:171], a[136:139], v[232:235]
  ds_read_b64_tr_b16 a[162:163], v6 offset:55296
  v_mfma_f32_16x16x32_bf16 v[232:235], a[172:175], a[152:155], v[232:235]
  buffer_load_dwordx4 v11, s[32:35], s61 offen lds
  v_mfma_f32_16x16x32_bf16 v[236:239], a[172:175], a[156:159], v[236:239]
  ds_read_b64_tr_b16 a[172:173], v6 offset:57344
  v_mfma_f32_16x16x32_bf16 v[236:239], a[168:171], a[140:143], v[236:239]
  s_waitcnt lgkmcnt(5)
  s_add_u32 m0, s45, 16384
  v_mfma_f32_16x16x32_bf16 v[252:255], a[176:179], a[140:143], v[252:255]
  ds_read_b64_tr_b16 a[174:175], v6 offset:59392
  v_mfma_f32_16x16x32_bf16 v[252:255], a[180:183], a[156:159], v[252:255]
  buffer_load_dwordx4 v10, s[28:31], s70 offen lds
  v_mfma_f32_16x16x32_bf16 v[248:251], a[180:183], a[152:155], v[248:251]
  ds_read_b64_tr_b16 a[168:169], v6 offset:61440
  v_mfma_f32_16x16x32_bf16 v[248:251], a[176:179], a[136:139], v[248:251]
  v_mfma_f32_16x16x32_bf16 v[244:247], a[176:179], a[132:135], v[244:247]
  ds_read_b64_tr_b16 a[170:171], v6 offset:63488
  v_mfma_f32_16x16x32_bf16 v[244:247], a[180:183], a[148:151], v[244:247]
  s_add_u32 m0, s45, 24576
  v_mfma_f32_16x16x32_bf16 v[240:243], a[180:183], a[144:147], v[240:243]
  ds_read_b64_tr_b16 a[180:181], v7 offset:49152
  v_mfma_f32_16x16x32_bf16 v[240:243], a[176:179], a[128:131], v[240:243]
  s_waitcnt vmcnt(6) lgkmcnt(5)
  buffer_load_dwordx4 v10, s[32:35], s70 offen lds
  v_mfma_f32_16x16x32_bf16 v[64:67], a[164:167], a[0:3], v[64:67]
  ds_read_b64_tr_b16 a[182:183], v7 offset:51200
  v_mfma_f32_16x16x32_bf16 v[64:67], a[160:163], a[16:19], v[64:67]
  s_add_u32 m0, s45, 20480
  s_add_u32 s61, s70, 229376
  v_mfma_f32_16x16x32_bf16 v[68:71], a[160:163], a[20:23], v[68:71]
  ds_read_b64_tr_b16 a[176:177], v7 offset:53248
  v_mfma_f32_16x16x32_bf16 v[68:71], a[164:167], a[4:7], v[68:71]
  buffer_load_dwordx4 v10, s[28:31], s61 offen lds
  v_mfma_f32_16x16x32_bf16 v[72:75], a[164:167], a[8:11], v[72:75]
  ds_read_b64_tr_b16 a[178:179], v7 offset:55296
  v_mfma_f32_16x16x32_bf16 v[72:75], a[160:163], a[24:27], v[72:75]
  v_mfma_f32_16x16x32_bf16 v[76:79], a[160:163], a[28:31], v[76:79]
  ds_read_b64_tr_b16 a[160:161], v7 offset:57344
  v_mfma_f32_16x16x32_bf16 v[76:79], a[164:167], a[12:15], v[76:79]
  s_waitcnt lgkmcnt(5)
  s_add_u32 m0, s45, 28672
  s_add_u32 s61, s70, 229376
  v_mfma_f32_16x16x32_bf16 v[92:95], a[172:175], a[12:15], v[92:95]
  ds_read_b64_tr_b16 a[162:163], v7 offset:59392
  v_mfma_f32_16x16x32_bf16 v[92:95], a[168:171], a[28:31], v[92:95]
  buffer_load_dwordx4 v10, s[32:35], s61 offen lds
  v_mfma_f32_16x16x32_bf16 v[88:91], a[168:171], a[24:27], v[88:91]
  ds_read_b64_tr_b16 a[164:165], v7 offset:61440
  s_waitcnt vmcnt(13)
  v_mfma_f32_16x16x32_bf16 v[88:91], a[172:175], a[8:11], v[88:91]
  v_accvgpr_read_b32 v24, a188
  v_accvgpr_read_b32 v25, a189
  v_mfma_f32_16x16x32_bf16 v[84:87], a[172:175], a[4:7], v[84:87]
  ds_read_b64_tr_b16 a[166:167], v7 offset:63488
  v_accvgpr_read_b32 v26, a190
  v_mfma_f32_16x16x32_bf16 v[84:87], a[168:171], a[20:23], v[84:87]
  buffer_load_dwordx4 a[32:35], v1, s[8:11], s78 offen offset:0 sc1
  v_accvgpr_read_b32 v27, a191
  v_accvgpr_read_b32 v28, a192
  v_mfma_f32_16x16x32_bf16 v[80:83], a[168:171], a[16:19], v[80:83]
  ds_read_b64_tr_b16 a[168:169], v8 offset:49152
  v_accvgpr_read_b32 v29, a193
  v_mfma_f32_16x16x32_bf16 v[80:83], a[172:175], a[0:3], v[80:83]
  s_waitcnt lgkmcnt(5)
  v_accvgpr_read_b32 v30, a194
  v_accvgpr_read_b32 v31, a195
  v_mfma_f32_16x16x32_bf16 v[96:99], a[180:183], a[0:3], v[96:99]
  ds_read_b64_tr_b16 a[170:171], v8 offset:51200
  v_add_f32 v16, v16, v24
  v_mfma_f32_16x16x32_bf16 v[96:99], a[176:179], a[16:19], v[96:99]
  v_add_f32 v17, v17, v25
  v_add_f32 v18, v18, v26
  v_mfma_f32_16x16x32_bf16 v[100:103], a[176:179], a[20:23], v[100:103]
  ds_read_b64_tr_b16 a[172:173], v8 offset:53248
  v_add_f32 v19, v19, v27
  v_mfma_f32_16x16x32_bf16 v[100:103], a[180:183], a[4:7], v[100:103]
  buffer_load_dwordx4 a[48:51], v1, s[8:11], s78 offen offset:1024 sc1
  v_add_f32 v20, v20, v28
  v_add_f32 v21, v21, v29
  v_mfma_f32_16x16x32_bf16 v[104:107], a[180:183], a[8:11], v[104:107]
  ds_read_b64_tr_b16 a[174:175], v8 offset:55296
  v_add_f32 v22, v22, v30
  v_mfma_f32_16x16x32_bf16 v[104:107], a[176:179], a[24:27], v[104:107]
  s_add_u32 s78, s78, 65536
  v_add_f32 v23, v23, v31
  v_accvgpr_read_b32 v24, a196
  v_mfma_f32_16x16x32_bf16 v[108:111], a[176:179], a[28:31], v[108:111]
  ds_read_b64_tr_b16 a[176:177], v8 offset:57344
  v_accvgpr_read_b32 v25, a197
  v_mfma_f32_16x16x32_bf16 v[108:111], a[180:183], a[12:15], v[108:111]
  s_waitcnt lgkmcnt(5)
  buffer_load_dwordx4 a[36:39], v1, s[8:11], s78 offen offset:0 sc1
  v_accvgpr_read_b32 v26, a198
  v_mfma_f32_16x16x32_bf16 v[124:127], a[160:163], a[12:15], v[124:127]
  ds_read_b64_tr_b16 a[178:179], v8 offset:59392
  v_accvgpr_read_b32 v27, a199
  v_mfma_f32_16x16x32_bf16 v[124:127], a[164:167], a[28:31], v[124:127]
  v_accvgpr_read_b32 v28, a200
  v_accvgpr_read_b32 v29, a201
  v_mfma_f32_16x16x32_bf16 v[120:123], a[164:167], a[24:27], v[120:123]
  ds_read_b64_tr_b16 a[180:181], v8 offset:61440
  v_accvgpr_read_b32 v30, a202
  v_mfma_f32_16x16x32_bf16 v[120:123], a[160:163], a[8:11], v[120:123]
  v_accvgpr_read_b32 v31, a203
  v_add_f32 v16, v16, v24
  v_mfma_f32_16x16x32_bf16 v[116:119], a[160:163], a[4:7], v[116:119]
  ds_read_b64_tr_b16 a[182:183], v8 offset:63488
  v_add_f32 v17, v17, v25
  v_mfma_f32_16x16x32_bf16 v[116:119], a[164:167], a[20:23], v[116:119]
  buffer_load_dwordx4 a[52:55], v1, s[8:11], s78 offen offset:1024 sc1
  v_add_f32 v18, v18, v26
  v_add_f32 v19, v19, v27
  v_mfma_f32_16x16x32_bf16 v[112:115], a[164:167], a[16:19], v[112:115]
  ds_read_b64_tr_b16 a[164:165], v2 offset:49152
  v_add_f32 v20, v20, v28
  v_mfma_f32_16x16x32_bf16 v[112:115], a[160:163], a[0:3], v[112:115]
  s_waitcnt lgkmcnt(5)
  s_add_u32 s78, s78, 65536
  v_add_f32 v21, v21, v29
  v_mfma_f32_16x16x32_bf16 v[32:35], a[168:171], a[0:3], v[32:35]
  ds_read_b64_tr_b16 a[166:167], v2 offset:51200
  v_add_f32 v22, v22, v30
  v_mfma_f32_16x16x32_bf16 v[32:35], a[172:175], a[16:19], v[32:35]
  buffer_load_dwordx4 a[40:43], v1, s[8:11], s78 offen offset:0 sc1
  v_add_f32 v23, v23, v31
  v_accvgpr_read_b32 v24, a204
  v_mfma_f32_16x16x32_bf16 v[36:39], a[172:175], a[20:23], v[36:39]
  ds_read_b64_tr_b16 a[160:161], v2 offset:53248
  v_accvgpr_read_b32 v25, a205
  v_mfma_f32_16x16x32_bf16 v[36:39], a[168:171], a[4:7], v[36:39]
  v_accvgpr_read_b32 v26, a206
  v_accvgpr_read_b32 v27, a207
  v_mfma_f32_16x16x32_bf16 v[40:43], a[168:171], a[8:11], v[40:43]
  ds_read_b64_tr_b16 a[162:163], v2 offset:55296
  v_accvgpr_read_b32 v28, a208
  v_mfma_f32_16x16x32_bf16 v[40:43], a[172:175], a[24:27], v[40:43]
  v_accvgpr_read_b32 v29, a209
  v_accvgpr_read_b32 v30, a210
  v_mfma_f32_16x16x32_bf16 v[44:47], a[172:175], a[28:31], v[44:47]
  ds_read_b64_tr_b16 a[172:173], v2 offset:57344
  v_accvgpr_read_b32 v31, a211
  v_mfma_f32_16x16x32_bf16 v[44:47], a[168:171], a[12:15], v[44:47]
  s_waitcnt lgkmcnt(5)
  buffer_load_dwordx4 a[56:59], v1, s[8:11], s78 offen offset:1024 sc1
  v_add_f32 v16, v16, v24
  v_mfma_f32_16x16x32_bf16 v[60:63], a[176:179], a[12:15], v[60:63]
  ds_read_b64_tr_b16 a[174:175], v2 offset:59392
  v_add_f32 v17, v17, v25
  v_mfma_f32_16x16x32_bf16 v[60:63], a[180:183], a[28:31], v[60:63]
  s_add_u32 s78, s78, 65536
  v_add_f32 v18, v18, v26
  v_add_f32 v19, v19, v27
  v_mfma_f32_16x16x32_bf16 v[56:59], a[180:183], a[24:27], v[56:59]
  ds_read_b64_tr_b16 a[168:169], v2 offset:61440
  v_add_f32 v20, v20, v28
  v_mfma_f32_16x16x32_bf16 v[56:59], a[176:179], a[8:11], v[56:59]
  buffer_load_dwordx4 a[44:47], v1, s[8:11], s78 offen offset:0 sc1
  v_add_f32 v21, v21, v29
  v_add_f32 v22, v22, v30
  v_mfma_f32_16x16x32_bf16 v[52:55], a[176:179], a[4:7], v[52:55]
  ds_read_b64_tr_b16 a[170:171], v2 offset:63488
  v_add_f32 v23, v23, v31
  v_mfma_f32_16x16x32_bf16 v[52:55], a[180:183], a[20:23], v[52:55]
  v_accvgpr_read_b32 v24, a212
  v_accvgpr_read_b32 v25, a213
  v_mfma_f32_16x16x32_bf16 v[48:51], a[180:183], a[16:19], v[48:51]
  ds_read_b64_tr_b16 a[180:181], v3 offset:49152
  v_accvgpr_read_b32 v26, a214
  v_mfma_f32_16x16x32_bf16 v[48:51], a[176:179], a[0:3], v[48:51]
  s_waitcnt lgkmcnt(5)
  v_accvgpr_read_b32 v27, a215
  v_accvgpr_read_b32 v28, a216
  v_mfma_f32_16x16x32_bf16 v[128:131], a[164:167], a[0:3], v[128:131]
  ds_read_b64_tr_b16 a[182:183], v3 offset:51200
  v_accvgpr_read_b32 v29, a217
  v_mfma_f32_16x16x32_bf16 v[128:131], a[160:163], a[16:19], v[128:131]
  buffer_load_dwordx4 a[60:63], v1, s[8:11], s78 offen offset:1024 sc1
  v_accvgpr_read_b32 v30, a218
  v_accvgpr_read_b32 v31, a219
  v_mfma_f32_16x16x32_bf16 v[132:135], a[160:163], a[20:23], v[132:135]
  ds_read_b64_tr_b16 a[176:177], v3 offset:53248
  v_add_f32 v16, v16, v24
  v_mfma_f32_16x16x32_bf16 v[132:135], a[164:167], a[4:7], v[132:135]
  s_mov_b32 s71, 3211264
  s_add_u32 s79, s57, 14336
  s_add_u32 m0, s45, 65536
  v_add_f32 v17, v17, v25
  v_add_f32 v18, v18, v26
  v_mfma_f32_16x16x32_bf16 v[136:139], a[164:167], a[8:11], v[136:139]
  ds_read_b64_tr_b16 a[178:179], v3 offset:55296
  v_add_f32 v19, v19, v27
  v_mfma_f32_16x16x32_bf16 v[136:139], a[160:163], a[24:27], v[136:139]
  buffer_load_dwordx4 v11, s[28:31], s71 offen lds
  v_add_f32 v20, v20, v28
  v_add_f32 v21, v21, v29
  v_mfma_f32_16x16x32_bf16 v[140:143], a[160:163], a[28:31], v[140:143]
  ds_read_b64_tr_b16 a[160:161], v3 offset:57344
  v_add_f32 v22, v22, v30
  v_mfma_f32_16x16x32_bf16 v[140:143], a[164:167], a[12:15], v[140:143]
  s_waitcnt lgkmcnt(5)
  v_add_f32 v23, v23, v31
  v_mfma_f32_16x16x32_bf16 v[156:159], a[172:175], a[12:15], v[156:159]
  ds_read_b64_tr_b16 a[162:163], v3 offset:59392
  v_mfma_f32_16x16x32_bf16 v[156:159], a[168:171], a[28:31], v[156:159]
  s_add_u32 m0, s45, 73728
  v_permlane32_swap_b32 v16, v20
  v_mfma_f32_16x16x32_bf16 v[152:155], a[168:171], a[24:27], v[152:155]
  ds_read_b64_tr_b16 a[164:165], v3 offset:61440
  v_mfma_f32_16x16x32_bf16 v[152:155], a[172:175], a[8:11], v[152:155]
  buffer_load_dwordx4 v11, s[32:35], s71 offen lds
  v_permlane32_swap_b32 v17, v21
  v_mfma_f32_16x16x32_bf16 v[148:151], a[172:175], a[4:7], v[148:151]
  ds_read_b64_tr_b16 a[166:167], v3 offset:63488
  v_mfma_f32_16x16x32_bf16 v[148:151], a[168:171], a[20:23], v[148:151]
  s_add_u32 m0, s45, 69632
  s_add_u32 s61, s71, 229376
  v_mfma_f32_16x16x32_bf16 v[144:147], a[168:171], a[16:19], v[144:147]
  ds_read_b64_tr_b16 a[168:169], v4 offset:49152
  v_mfma_f32_16x16x32_bf16 v[144:147], a[172:175], a[0:3], v[144:147]
  s_waitcnt lgkmcnt(5)
  buffer_load_dwordx4 v11, s[28:31], s61 offen lds
  v_mfma_f32_16x16x32_bf16 v[160:163], a[180:183], a[0:3], v[160:163]
  ds_read_b64_tr_b16 a[170:171], v4 offset:51200
  v_permlane32_swap_b32 v18, v22
  v_mfma_f32_16x16x32_bf16 v[160:163], a[176:179], a[16:19], v[160:163]
  v_permlane32_swap_b32 v19, v23
  v_mfma_f32_16x16x32_bf16 v[164:167], a[176:179], a[20:23], v[164:167]
  ds_read_b64_tr_b16 a[172:173], v4 offset:53248
  v_add_f32 v16, v16, v20
  v_mfma_f32_16x16x32_bf16 v[164:167], a[180:183], a[4:7], v[164:167]
  s_add_u32 m0, s45, 77824
  s_add_u32 s61, s71, 229376
  v_add_f32 v17, v17, v21
  v_mfma_f32_16x16x32_bf16 v[168:171], a[180:183], a[8:11], v[168:171]
  ds_read_b64_tr_b16 a[174:175], v4 offset:55296
  v_add_f32 v18, v18, v22
  v_mfma_f32_16x16x32_bf16 v[168:171], a[176:179], a[24:27], v[168:171]
  buffer_load_dwordx4 v11, s[32:35], s61 offen lds
  v_add_f32 v19, v19, v23
  v_mfma_f32_16x16x32_bf16 v[172:175], a[176:179], a[28:31], v[172:175]
  ds_read_b64_tr_b16 a[176:177], v4 offset:57344
  v_mfma_f32_16x16x32_bf16 v[172:175], a[180:183], a[12:15], v[172:175]
  s_waitcnt lgkmcnt(5)
  s_add_u32 m0, s45, 0
  v_mfma_f32_16x16x32_bf16 v[188:191], a[160:163], a[12:15], v[188:191]
  ds_read_b64_tr_b16 a[178:179], v4 offset:59392
  v_mfma_f32_16x16x32_bf16 v[188:191], a[164:167], a[28:31], v[188:191]
  buffer_load_dwordx4 v10, s[28:31], s71 offen lds
  v_permlane16_swap_b32 v16, v18
  v_mfma_f32_16x16x32_bf16 v[184:187], a[164:167], a[24:27], v[184:187]
  ds_read_b64_tr_b16 a[180:181], v4 offset:61440
  v_mfma_f32_16x16x32_bf16 v[184:187], a[160:163], a[8:11], v[184:187]
  v_permlane16_swap_b32 v17, v19
  v_mfma_f32_16x16x32_bf16 v[180:183], a[160:163], a[4:7], v[180:183]
  ds_read_b64_tr_b16 a[182:183], v4 offset:63488
  v_add_f32 v16, v16, v18
  v_mfma_f32_16x16x32_bf16 v[180:183], a[164:167], a[20:23], v[180:183]
  s_add_u32 m0, s45, 8192
  v_add_f32 v17, v17, v19
  v_mul_f32 v16, 0x3a800000, v16
  v_mfma_f32_16x16x32_bf16 v[176:179], a[164:167], a[16:19], v[176:179]
  ds_read_b64_tr_b16 a[164:165], v5 offset:49152
  v_mul_f32 v17, 0x3a800000, v17
  v_mfma_f32_16x16x32_bf16 v[176:179], a[160:163], a[0:3], v[176:179]
  s_waitcnt lgkmcnt(5)
  buffer_load_dwordx4 v10, s[32:35], s71 offen lds
  v_fma_f32 v17, -v16, v16, v17
  v_mfma_f32_16x16x32_bf16 v[192:195], a[168:171], a[0:3], v[192:195]
  ds_read_b64_tr_b16 a[166:167], v5 offset:51200
  v_max_f32 v17, 0, v17
  v_mfma_f32_16x16x32_bf16 v[192:195], a[172:175], a[16:19], v[192:195]
  s_add_u32 m0, s45, 4096
  s_add_u32 s61, s71, 229376
  v_cvt_pk_bf16_f32 v17, v17, v17
  v_mfma_f32_16x16x32_bf16 v[196:199], a[172:175], a[20:23], v[196:199]
  ds_read_b64_tr_b16 a[160:161], v5 offset:53248
  v_lshlrev_b32 v17, 16, v17
  v_mfma_f32_16x16x32_bf16 v[196:199], a[168:171], a[4:7], v[196:199]
  buffer_load_dwordx4 v10, s[28:31], s61 offen lds
  v_add_f32 v17, 0x3727c5ac, v17
  v_cvt_pk_bf16_f32 v17, v17, v17
  v_mfma_f32_16x16x32_bf16 v[200:203], a[168:171], a[8:11], v[200:203]
  ds_read_b64_tr_b16 a[162:163], v5 offset:55296
  v_lshlrev_b32 v17, 16, v17
  v_mfma_f32_16x16x32_bf16 v[200:203], a[172:175], a[24:27], v[200:203]
  v_sqrt_f32 v17, v17
  v_mfma_f32_16x16x32_bf16 v[204:207], a[172:175], a[28:31], v[204:207]
  ds_read_b64_tr_b16 a[172:173], v5 offset:57344
  v_cvt_pk_bf16_f32 v16, v16, v16
  v_mfma_f32_16x16x32_bf16 v[204:207], a[168:171], a[12:15], v[204:207]
  s_waitcnt lgkmcnt(5)
  s_add_u32 m0, s45, 12288
  s_add_u32 s61, s71, 229376
  v_mfma_f32_16x16x32_bf16 v[220:223], a[176:179], a[12:15], v[220:223]
  ds_read_b64_tr_b16 a[174:175], v5 offset:59392
  v_lshlrev_b32 v16, 16, v16
  v_mfma_f32_16x16x32_bf16 v[220:223], a[180:183], a[28:31], v[220:223]
  buffer_load_dwordx4 v10, s[32:35], s61 offen lds
  v_cvt_pk_bf16_f32 v17, v17, v17
  v_lshlrev_b32 v17, 16, v17
  v_mfma_f32_16x16x32_bf16 v[216:219], a[180:183], a[24:27], v[216:219]
  ds_read_b64_tr_b16 a[168:169], v5 offset:61440
  v_sub_f32 v16, 0, v16
  v_mfma_f32_16x16x32_bf16 v[216:219], a[176:179], a[8:11], v[216:219]
  v_mov_b32 v18, v16
  v_mov_b32 v19, v17
  v_mfma_f32_16x16x32_bf16 v[212:215], a[176:179], a[4:7], v[212:215]
  ds_read_b64_tr_b16 a[170:171], v5 offset:63488
  v_mfma_f32_16x16x32_bf16 v[212:215], a[180:183], a[20:23], v[212:215]
  buffer_load_dwordx4 a[64:67], v1, s[8:11], s79 offen offset:0 sc1
  s_waitcnt vmcnt(17)
  s_barrier
  v_mfma_f32_16x16x32_bf16 v[208:211], a[180:183], a[16:19], v[208:211]
  ds_read_b64_tr_b16 a[180:181], v6 offset:16384
  v_mfma_f32_16x16x32_bf16 v[208:211], a[176:179], a[0:3], v[208:211]
  s_waitcnt lgkmcnt(5)
  v_permlane16_swap_b32 v16, v18
  v_mfma_f32_16x16x32_bf16 v[224:227], a[164:167], a[0:3], v[224:227]
  ds_read_b64_tr_b16 a[182:183], v6 offset:18432
  v_mfma_f32_16x16x32_bf16 v[224:227], a[160:163], a[16:19], v[224:227]
  v_permlane16_swap_b32 v17, v19
  v_mfma_f32_16x16x32_bf16 v[228:231], a[160:163], a[20:23], v[228:231]
  ds_read_b64_tr_b16 a[176:177], v6 offset:20480
  v_mov_b32 v20, v16
  v_mfma_f32_16x16x32_bf16 v[228:231], a[164:167], a[4:7], v[228:231]
  buffer_load_dwordx4 a[80:83], v1, s[8:11], s79 offen offset:1024 sc1
  v_mov_b32 v21, v17
  v_mov_b32 v22, v18
  v_mfma_f32_16x16x32_bf16 v[232:235], a[164:167], a[8:11], v[232:235]
  ds_read_b64_tr_b16 a[178:179], v6 offset:22528
  v_mov_b32 v23, v19
  v_mfma_f32_16x16x32_bf16 v[232:235], a[160:163], a[24:27], v[232:235]
  s_add_u32 s79, s79, 65536
  v_permlane32_swap_b32 v16, v20
  v_mfma_f32_16x16x32_bf16 v[236:239], a[160:163], a[28:31], v[236:239]
  ds_read_b64_tr_b16 a[160:161], v6 offset:24576
  v_mfma_f32_16x16x32_bf16 v[236:239], a[164:167], a[12:15], v[236:239]
  s_waitcnt lgkmcnt(5)
  buffer_load_dwordx4 a[68:71], v1, s[8:11], s79 offen offset:0 sc1
  v_mfma_f32_16x16x32_bf16 v[252:255], a[172:175], a[12:15], v[252:255]
  ds_read_b64_tr_b16 a[162:163], v6 offset:26624
  v_mfma_f32_16x16x32_bf16 v[252:255], a[168:171], a[28:31], v[252:255]
  v_permlane32_swap_b32 v17, v21
  v_mfma_f32_16x16x32_bf16 v[248:251], a[168:171], a[24:27], v[248:251]
HOP10:
  s_cbranch_execz HOP14
  ds_read_b64_tr_b16 a[164:165], v6 offset:28672
  v_mfma_f32_16x16x32_bf16 v[248:251], a[172:175], a[8:11], v[248:251]
  v_permlane32_swap_b32 v18, v22
  v_mfma_f32_16x16x32_bf16 v[244:247], a[172:175], a[4:7], v[244:247]
  ds_read_b64_tr_b16 a[166:167], v6 offset:30720
  v_mfma_f32_16x16x32_bf16 v[244:247], a[168:171], a[20:23], v[244:247]
  buffer_load_dwordx4 a[84:87], v1, s[8:11], s79 offen offset:1024 sc1
  v_permlane32_swap_b32 v19, v23
  v_mfma_f32_16x16x32_bf16 v[240:243], a[168:171], a[16:19], v[240:243]
  ds_read_b64_tr_b16 a[168:169], v7 offset:16384
  v_lshrrev_b32 v12, 8, v1
  v_mfma_f32_16x16x32_bf16 v[240:243], a[172:175], a[0:3], v[240:243]
  s_waitcnt vmcnt(12) lgkmcnt(5)
  s_add_u32 s79, s79, 65536
  v_lshlrev_b32 v12, 4, v12
  v_mfma_f32_16x16x32_bf16 v[64:67], a[180:183], a[32:35], v[64:67]
  ds_read_b64_tr_b16 a[170:171], v7 offset:18432
  v_add_u32 v12, 131072, v12
  v_mfma_f32_16x16x32_bf16 v[64:67], a[176:179], a[48:51], v[64:67]
  buffer_load_dwordx4 a[72:75], v1, s[8:11], s79 offen offset:0 sc1
  v_mfma_f32_16x16x32_bf16 v[68:71], a[176:179], a[52:55], v[68:71]
  ds_read_b64_tr_b16 a[172:173], v7 offset:20480
  v_mfma_f32_16x16x32_bf16 v[68:71], a[180:183], a[36:39], v[68:71]
  v_mfma_f32_16x16x32_bf16 v[72:75], a[180:183], a[40:43], v[72:75]
  ds_read_b64_tr_b16 a[174:175], v7 offset:22528
  v_mfma_f32_16x16x32_bf16 v[72:75], a[176:179], a[56:59], v[72:75]
  v_mfma_f32_16x16x32_bf16 v[76:79], a[176:179], a[60:63], v[76:79]
  ds_read_b64_tr_b16 a[176:177], v7 offset:24576
  v_mfma_f32_16x16x32_bf16 v[76:79], a[180:183], a[44:47], v[76:79]
  s_waitcnt lgkmcnt(5)
  buffer_load_dwordx4 a[88:91], v1, s[8:11], s79 offen offset:1024 sc1
  v_mfma_f32_16x16x32_bf16 v[92:95], a[160:163], a[44:47], v[92:95]
  ds_read_b64_tr_b16 a[178:179], v7 offset:26624
  v_mfma_f32_16x16x32_bf16 v[92:95], a[164:167], a[60:63], v[92:95]
  s_add_u32 s79, s79, 65536
  v_mfma_f32_16x16x32_bf16 v[88:91], a[164:167], a[56:59], v[88:91]
  ds_read_b64_tr_b16 a[180:181], v7 offset:28672
  v_mfma_f32_16x16x32_bf16 v[88:91], a[160:163], a[40:43], v[88:91]
  buffer_load_dwordx4 a[76:79], v1, s[8:11], s79 offen offset:0 sc1
  v_mfma_f32_16x16x32_bf16 v[84:87], a[160:163], a[36:39], v[84:87]
  ds_read_b64_tr_b16 a[182:183], v7 offset:30720
  v_mfma_f32_16x16x32_bf16 v[84:87], a[164:167], a[52:55], v[84:87]
  s_lshl_b32 s83, s44, 28
  buffer_load_dword v9, v13, s[8:11], s83 offen sc1
  v_mfma_f32_16x16x32_bf16 v[80:83], a[164:167], a[48:51], v[80:83]
  ds_read_b64_tr_b16 a[164:165], v8 offset:16384
  v_mfma_f32_16x16x32_bf16 v[80:83], a[160:163], a[32:35], v[80:83]
  s_waitcnt lgkmcnt(5)
  v_mfma_f32_16x16x32_bf16 v[96:99], a[168:171], a[32:35], v[96:99]
  ds_read_b64_tr_b16 a[166:167], v8 offset:18432
  v_mfma_f32_16x16x32_bf16 v[96:99], a[172:175], a[48:51], v[96:99]
  buffer_load_dwordx4 a[92:95], v1, s[8:11], s79 offen offset:1024 sc1
  v_mfma_f32_16x16x32_bf16 v[100:103], a[172:175], a[52:55], v[100:103]
  ds_read_b64_tr_b16 a[160:161], v8 offset:20480
  v_mfma_f32_16x16x32_bf16 v[100:103], a[168:171], a[36:39], v[100:103]
  s_mov_b32 s64, 3670016
  s_add_u32 s72, s57, 16384
  s_add_u32 m0, s45, 98304
  v_mfma_f32_16x16x32_bf16 v[104:107], a[168:171], a[40:43], v[104:107]
  ds_read_b64_tr_b16 a[162:163], v8 offset:22528
  v_mfma_f32_16x16x32_bf16 v[104:107], a[172:175], a[56:59], v[104:107]
  buffer_load_dwordx4 v11, s[28:31], s64 offen lds
  v_mfma_f32_16x16x32_bf16 v[108:111], a[172:175], a[60:63], v[108:111]
  ds_read_b64_tr_b16 a[172:173], v8 offset:24576
  v_mfma_f32_16x16x32_bf16 v[108:111], a[168:171], a[44:47], v[108:111]
  s_waitcnt lgkmcnt(5)
  v_mfma_f32_16x16x32_bf16 v[124:127], a[176:179], a[44:47], v[124:127]
  ds_read_b64_tr_b16 a[174:175], v8 offset:26624
  v_mfma_f32_16x16x32_bf16 v[124:127], a[180:183], a[60:63], v[124:127]
  s_add_u32 m0, s45, 106496
  v_mfma_f32_16x16x32_bf16 v[120:123], a[180:183], a[56:59], v[120:123]
  ds_read_b64_tr_b16 a[168:169], v8 offset:28672
  v_mfma_f32_16x16x32_bf16 v[120:123], a[176:179], a[40:43], v[120:123]
  buffer_load_dwordx4 v11, s[32:35], s64 offen lds
  v_mfma_f32_16x16x32_bf16 v[116:119], a[176:179], a[36:39], v[116:119]
  ds_read_b64_tr_b16 a[170:171], v8 offset:30720
  v_mfma_f32_16x16x32_bf16 v[116:119], a[180:183], a[52:55], v[116:119]
  s_add_u32 m0, s45, 102400
  s_add_u32 s61, s64, 229376
  v_mfma_f32_16x16x32_bf16 v[112:115], a[180:183], a[48:51], v[112:115]
  ds_read_b64_tr_b16 a[180:181], v2 offset:16384
  v_mfma_f32_16x16x32_bf16 v[112:115], a[176:179], a[32:35], v[112:115]
  s_waitcnt lgkmcnt(5)
  buffer_load_dwordx4 v11, s[28:31], s61 offen lds
  v_mfma_f32_16x16x32_bf16 v[32:35], a[164:167], a[32:35], v[32:35]
  ds_read_b64_tr_b16 a[182:183], v2 offset:18432
  v_mfma_f32_16x16x32_bf16 v[32:35], a[160:163], a[48:51], v[32:35]
  v_mfma_f32_16x16x32_bf16 v[36:39], a[160:163], a[52:55], v[36:39]
  ds_read_b64_tr_b16 a[176:177], v2 offset:20480
  v_mfma_f32_16x16x32_bf16 v[36:39], a[164:167], a[36:39], v[36:39]
  s_add_u32 m0, s45, 110592
  s_add_u32 s61, s64, 229376
  v_mfma_f32_16x16x32_bf16 v[40:43], a[164:167], a[40:43], v[40:43]
  ds_read_b64_tr_b16 a[178:179], v2 offset:22528
  v_mfma_f32_16x16x32_bf16 v[40:43], a[160:163], a[56:59], v[40:43]
  buffer_load_dwordx4 v11, s[32:35], s61 offen lds
  v_mfma_f32_16x16x32_bf16 v[44:47], a[160:163], a[60:63], v[44:47]
  ds_read_b64_tr_b16 a[160:161], v2 offset:24576
  v_mfma_f32_16x16x32_bf16 v[44:47], a[164:167], a[44:47], v[44:47]
  s_waitcnt lgkmcnt(5)
  s_add_u32 m0, s45, 32768
  v_mfma_f32_16x16x32_bf16 v[60:63], a[172:175], a[44:47], v[60:63]
  ds_read_b64_tr_b16 a[162:163], v2 offset:26624
  v_mfma_f32_16x16x32_bf16 v[60:63], a[168:171], a[60:63], v[60:63]
  buffer_load_dwordx4 v10, s[28:31], s64 offen lds
  v_mfma_f32_16x16x32_bf16 v[56:59], a[168:171], a[56:59], v[56:59]
  ds_read_b64_tr_b16 a[164:165], v2 offset:28672
  v_mfma_f32_16x16x32_bf16 v[56:59], a[172:175], a[40:43], v[56:59]
  v_mfma_f32_16x16x32_bf16 v[52:55], a[172:175], a[36:39], v[52:55]
  ds_read_b64_tr_b16 a[166:167], v2 offset:30720
  v_mfma_f32_16x16x32_bf16 v[52:55], a[168:171], a[52:55], v[52:55]
  s_add_u32 m0, s45, 40960
  v_mfma_f32_16x16x32_bf16 v[48:51], a[168:171], a[48:51], v[48:51]
  ds_read_b64_tr_b16 a[168:169], v3 offset:16384
  v_mfma_f32_16x16x32_bf16 v[48:51], a[172:175], a[32:35], v[48:51]
  s_waitcnt lgkmcnt(5)
  buffer_load_dwordx4 v10, s[32:35], s64 offen lds
  v_mfma_f32_16x16x32_bf16 v[128:131], a[180:183], a[32:35], v[128:131]
  ds_read_b64_tr_b16 a[170:171], v3 offset:18432
  v_mfma_f32_16x16x32_bf16 v[128:131], a[176:179], a[48:51], v[128:131]
  s_add_u32 m0, s45, 36864
  s_add_u32 s61, s64, 229376
  v_mfma_f32_16x16x32_bf16 v[132:135], a[176:179], a[52:55], v[132:135]
  ds_read_b64_tr_b16 a[172:173], v3 offset:20480
  v_mfma_f32_16x16x32_bf16 v[132:135], a[180:183], a[36:39], v[132:135]
  buffer_load_dwordx4 v10, s[28:31], s61 offen lds
  v_mfma_f32_16x16x32_bf16 v[136:139], a[180:183], a[40:43], v[136:139]
  ds_read_b64_tr_b16 a[174:175], v3 offset:22528
  v_mfma_f32_16x16x32_bf16 v[136:139], a[176:179], a[56:59], v[136:139]
  s_waitcnt vmcnt(8)
  s_cmp_lg_u32 s44, 0
  s_cbranch_scc1 PL11_adaLN_cond__sliding_local_dilated__swiglu_ffn__prompt_kernelx
  v_cmp_ne_u32 vcc, s46, v9
  s_nop 4
  s_cbranch_vccz PL11_adaLN_cond__sliding_local_dilated__swiglu_ffn__prompt_kernelx
  s_mov_b32 s83, 60000
PL11_adaLN_cond__sliding_local_dilated__swiglu_ffn__prompt_kernel:
  buffer_load_dword v9, v13, s[8:11], 0 offen sc1
  s_sub_u32 s83, s83, 1
  s_cmp_eq_u32 s83, 0
  s_waitcnt vmcnt(0)
  s_cbranch_scc1 PL11_adaLN_cond__sliding_local_dilated__swiglu_ffn__prompt_kernelx
  v_cmp_ne_u32 vcc, s46, v9
  s_nop 4
  s_cbranch_vccnz PL11_adaLN_cond__sliding_local_dilated__swiglu_ffn__prompt_kernel
PL11_adaLN_cond__sliding_local_dilated__swiglu_ffn__prompt_kernelx:
  s_barrier
  v_mfma_f32_16x16x32_bf16 v[140:143], a[176:179], a[60:63], v[140:143]
  ds_read_b64_tr_b16 a[176:177], v3 offset:24576
  v_mfma_f32_16x16x32_bf16 v[140:143], a[180:183], a[44:47], v[140:143]
  s_waitcnt lgkmcnt(5)
  s_add_u32 m0, s45, 45056
  s_add_u32 s61, s64, 229376
  v_mfma_f32_16x16x32_bf16 v[156:159], a[160:163], a[44:47], v[156:159]
  ds_read_b64_tr_b16 a[178:179], v3 offset:26624
  v_mfma_f32_16x16x32_bf16 v[156:159], a[164:167], a[60:63], v[156:159]
  buffer_load_dwordx4 v10, s[32:35], s61 offen lds
  v_mfma_f32_16x16x32_bf16 v[152:155], a[164:167], a[56:59], v[152:155]
  ds_read_b64_tr_b16 a[180:181], v3 offset:28672
  v_mfma_f32_16x16x32_bf16 v[152:155], a[160:163], a[40:43], v[152:155]
  s_mov_b32 s62, 0
  v_mfma_f32_16x16x32_bf16 v[148:151], a[160:163], a[36:39], v[148:151]
  ds_read_b64_tr_b16 a[182:183], v3 offset:30720
  v_mfma_f32_16x16x32_bf16 v[148:151], a[164:167], a[52:55], v[148:151]
  buffer_load_dwordx4 a[220:223], v14, s[8:11], s62 offen sc1
  v_mfma_f32_16x16x32_bf16 v[144:147], a[164:167], a[48:51], v[144:147]
  ds_read_b64_tr_b16 a[164:165], v4 offset:16384
  v_mfma_f32_16x16x32_bf16 v[144:147], a[160:163], a[32:35], v[144:147]
  s_waitcnt lgkmcnt(5)
  s_mov_b32 s62, 114688
  v_mfma_f32_16x16x32_bf16 v[160:163], a[168:171], a[32:35], v[160:163]
  ds_read_b64_tr_b16 a[166:167], v4 offset:18432
  buffer_load_dwordx4 a[224:227], v14, s[8:11], s62 offen sc1
  v_mfma_f32_16x16x32_bf16 v[160:163], a[172:175], a[48:51], v[160:163]
  s_mov_b32 s62, 229376
  v_mfma_f32_16x16x32_bf16 v[164:167], a[172:175], a[52:55], v[164:167]
  ds_read_b64_tr_b16 a[160:161], v4 offset:20480
  buffer_load_dwordx4 a[228:231], v14, s[8:11], s62 offen sc1
  v_mfma_f32_16x16x32_bf16 v[164:167], a[168:171], a[36:39], v[164:167]
  s_mov_b32 s62, 344064
  v_mfma_f32_16x16x32_bf16 v[168:171], a[168:171], a[40:43], v[168:171]
  ds_read_b64_tr_b16 a[162:163], v4 offset:22528
  v_mfma_f32_16x16x32_bf16 v[168:171], a[172:175], a[56:59], v[168:171]
  buffer_load_dwordx4 a[232:235], v14, s[8:11], s62 offen sc1
  s_mov_b32 s62, 458752
  v_mfma_f32_16x16x32_bf16 v[172:175], a[172:175], a[60:63], v[172:175]
  ds_read_b64_tr_b16 a[172:173], v4 offset:24576
  v_mfma_f32_16x16x32_bf16 v[172:175], a[168:171], a[44:47], v[172:175]
  s_waitcnt lgkmcnt(5)
  buffer_load_dwordx4 a[236:239], v14, s[8:11], s62 offen sc1
  v_mfma_f32_16x16x32_bf16 v[188:191], a[176:179], a[44:47], v[188:191]
  ds_read_b64_tr_b16 a[174:175], v4 offset:26624
  v_mfma_f32_16x16x32_bf16 v[188:191], a[180:183], a[60:63], v[188:191]
  s_mov_b32 s62, 573440
  v_mfma_f32_16x16x32_bf16 v[184:187], a[180:183], a[56:59], v[184:187]
  ds_read_b64_tr_b16 a[168:169], v4 offset:28672
  buffer_load_dwordx4 a[240:243], v14, s[8:11], s62 offen sc1
  v_mfma_f32_16x16x32_bf16 v[184:187], a[176:179], a[40:43], v[184:187]
  s_mov_b32 s62, 688128
  v_mfma_f32_16x16x32_bf16 v[180:183], a[176:179], a[36:39], v[180:183]
  ds_read_b64_tr_b16 a[170:171], v4 offset:30720
  buffer_load_dwordx4 a[244:247], v14, s[8:11], s62 offen sc1
  v_mfma_f32_16x16x32_bf16 v[180:183], a[180:183], a[52:55], v[180:183]
  s_mov_b32 s62, 802816
  v_mfma_f32_16x16x32_bf16 v[176:179], a[180:183], a[48:51], v[176:179]
  ds_read_b64_tr_b16 a[180:181], v5 offset:16384
  v_mfma_f32_16x16x32_bf16 v[176:179], a[176:179], a[32:35], v[176:179]
  s_waitcnt lgkmcnt(5)
  buffer_load_dwordx4 a[248:251], v14, s[8:11], s62 offen sc1
  v_mfma_f32_16x16x32_bf16 v[192:195], a[164:167], a[32:35], v[192:195]
  ds_read_b64_tr_b16 a[182:183], v5 offset:18432
  v_mfma_f32_16x16x32_bf16 v[192:195], a[160:163], a[48:51], v[192:195]
  buffer_load_dwordx4 a[96:99], v1, s[8:11], s72 offen offset:0 sc1
  v_mfma_f32_16x16x32_bf16 v[196:199], a[160:163], a[52:55], v[196:199]
  ds_read_b64_tr_b16 a[176:177], v5 offset:20480
  v_mfma_f32_16x16x32_bf16 v[196:199], a[164:167], a[36:39], v[196:199]
  v_mfma_f32_16x16x32_bf16 v[200:203], a[164:167], a[40:43], v[200:203]
  ds_read_b64_tr_b16 a[178:179], v5 offset:22528
  v_mfma_f32_16x16x32_bf16 v[200:203], a[160:163], a[56:59], v[200:203]
  v_mfma_f32_16x16x32_bf16 v[204:207], a[160:163], a[60:63], v[204:207]
  ds_read_b64_tr_b16 a[160:161], v5 offset:24576
  v_mfma_f32_16x16x32_bf16 v[204:207], a[164:167], a[44:47], v[204:207]
  s_waitcnt lgkmcnt(5)
  buffer_load_dwordx4 a[112:115], v1, s[8:11], s72 offen offset:1024 sc1
  v_mfma_f32_16x16x32_bf16 v[220:223], a[172:175], a[44:47], v[220:223]
  ds_read_b64_tr_b16 a[162:163], v5 offset:26624
  v_mfma_f32_16x16x32_bf16 v[220:223], a[168:171], a[60:63], v[220:223]
  s_add_u32 s72, s72, 65536
  v_mfma_f32_16x16x32_bf16 v[216:219], a[168:171], a[56:59], v[216:219]
  ds_read_b64_tr_b16 a[164:165], v5 offset:28672
  v_mfma_f32_16x16x32_bf16 v[216:219], a[172:175], a[40:43], v[216:219]
  buffer_load_dwordx4 a[100:103], v1, s[8:11], s72 offen offset:0 sc1
  v_mfma_f32_16x16x32_bf16 v[212:215], a[172:175], a[36:39], v[212:215]
  ds_read_b64_tr_b16 a[166:167], v5 offset:30720
  v_mfma_f32_16x16x32_bf16 v[212:215], a[168:171], a[52:55], v[212:215]
  s_waitcnt vmcnt(28)
  s_barrier
  v_mfma_f32_16x16x32_bf16 v[208:211], a[168:171], a[48:51], v[208:211]
  ds_read_b64_tr_b16 a[168:169], v6 offset:0
  v_mfma_f32_16x16x32_bf16 v[208:211], a[172:175], a[32:35], v[208:211]
  s_waitcnt lgkmcnt(5)
  v_mfma_f32_16x16x32_bf16 v[224:227], a[180:183], a[32:35], v[224:227]
  ds_read_b64_tr_b16 a[170:171], v6 offset:2048
  v_mfma_f32_16x16x32_bf16 v[224:227], a[176:179], a[48:51], v[224:227]
  buffer_load_dwordx4 a[116:119], v1, s[8:11], s72 offen offset:1024 sc1
  v_mfma_f32_16x16x32_bf16 v[228:231], a[176:179], a[52:55], v[228:231]
  ds_read_b64_tr_b16 a[172:173], v6 offset:4096
  v_mfma_f32_16x16x32_bf16 v[228:231], a[180:183], a[36:39], v[228:231]
  s_add_u32 s72, s72, 65536
  v_mfma_f32_16x16x32_bf16 v[232:235], a[180:183], a[40:43], v[232:235]
  ds_read_b64_tr_b16 a[174:175], v6 offset:6144
  v_mfma_f32_16x16x32_bf16 v[232:235], a[176:179], a[56:59], v[232:235]
  buffer_load_dwordx4 a[104:107], v1, s[8:11], s72 offen offset:0 sc1
  v_mfma_f32_16x16x32_bf16 v[236:239], a[176:179], a[60:63], v[236:239]
  ds_read_b64_tr_b16 a[176:177], v6 offset:8192
  v_mfma_f32_16x16x32_bf16 v[236:239], a[180:183], a[44:47], v[236:239]
  s_waitcnt lgkmcnt(5)
  v_mfma_f32_16x16x32_bf16 v[252:255], a[160:163], a[44:47], v[252:255]
  ds_read_b64_tr_b16 a[178:179], v6 offset:10240
  v_mfma_f32_16x16x32_bf16 v[252:255], a[164:167], a[60:63], v[252:255]
  v_mfma_f32_16x16x32_bf16 v[248:251], a[164:167], a[56:59], v[248:251]
  ds_read_b64_tr_b16 a[180:181], v6 offset:12288
  v_mfma_f32_16x16x32_bf16 v[248:251], a[160:163], a[40:43], v[248:251]
  buffer_load_dwordx4 a[120:123], v1, s[8:11], s72 offen offset:1024 sc1
  v_mfma_f32_16x16x32_bf16 v[244:247], a[160:163], a[36:39], v[244:247]
  ds_read_b64_tr_b16 a[182:183], v6 offset:14336
  v_mfma_f32_16x16x32_bf16 v[244:247], a[164:167], a[52:55], v[244:247]
  s_add_u32 s72, s72, 65536
  v_mfma_f32_16x16x32_bf16 v[240:243], a[164:167], a[48:51], v[240:243]
  ds_read_b64_tr_b16 a[164:165], v7 offset:0
  v_mfma_f32_16x16x32_bf16 v[240:243], a[160:163], a[32:35], v[240:243]
  s_waitcnt vmcnt(22) lgkmcnt(5)
  buffer_load_dwordx4 a[108:111], v1, s[8:11], s72 offen offset:0 sc1
  v_mfma_f32_16x16x32_bf16 v[64:67], a[168:171], a[64:67], v[64:67]
  ds_read_b64_tr_b16 a[166:167], v7 offset:2048
  v_mfma_f32_16x16x32_bf16 v[64:67], a[172:175], a[80:83], v[64:67]
  v_mfma_f32_16x16x32_bf16 v[68:71], a[172:175], a[84:87], v[68:71]
  ds_read_b64_tr_b16 a[160:161], v7 offset:4096
  v_mfma_f32_16x16x32_bf16 v[68:71], a[168:171], a[68:71], v[68:71]
  v_mfma_f32_16x16x32_bf16 v[72:75], a[168:171], a[72:75], v[72:75]
  ds_read_b64_tr_b16 a[162:163], v7 offset:6144
  v_mfma_f32_16x16x32_bf16 v[72:75], a[172:175], a[88:91], v[72:75]
  buffer_load_dwordx4 a[124:127], v1, s[8:11], s72 offen offset:1024 sc1
  v_mfma_f32_16x16x32_bf16 v[76:79], a[172:175], a[92:95], v[76:79]
  ds_read_b64_tr_b16 a[172:173], v7 offset:8192
  s_waitcnt vmcnt(8)
  v_mfma_f32_16x16x32_bf16 v[76:79], a[168:171], a[76:79], v[76:79]
  s_waitcnt lgkmcnt(5)
  s_mov_b32 s65, 4128768
  s_add_u32 s73, s57, 18432
  s_add_u32 m0, s45, 114688
  v_accvgpr_read_b32 v24, a220
  v_accvgpr_read_b32 v25, a221
  v_mfma_f32_16x16x32_bf16 v[92:95], a[176:179], a[76:79], v[92:95]
  ds_read_b64_tr_b16 a[174:175], v7 offset:10240
  v_accvgpr_read_b32 v26, a222
  v_mfma_f32_16x16x32_bf16 v[92:95], a[180:183], a[92:95], v[92:95]
  buffer_load_dwordx4 v11, s[28:31], s65 offen lds
  v_accvgpr_read_b32 v27, a223
  v_accvgpr_read_b32 v28, a224
  v_mfma_f32_16x16x32_bf16 v[88:91], a[180:183], a[88:91], v[88:91]
  ds_read_b64_tr_b16 a[168:169], v7 offset:12288
  v_accvgpr_read_b32 v29, a225
  v_mfma_f32_16x16x32_bf16 v[88:91], a[176:179], a[72:75], v[88:91]
  v_accvgpr_read_b32 v30, a226
  v_accvgpr_read_b32 v31, a227
  v_add_f32 v24, v24, v28
  v_mfma_f32_16x16x32_bf16 v[84:87], a[176:179], a[68:71], v[84:87]
  ds_read_b64_tr_b16 a[170:171], v7 offset:14336
  v_add_f32 v25, v25, v29
  v_mfma_f32_16x16x32_bf16 v[84:87], a[180:183], a[84:87], v[84:87]
  s_add_u32 m0, s45, 122880
  v_add_f32 v26, v26, v30
  v_add_f32 v27, v27, v31
  v_mfma_f32_16x16x32_bf16 v[80:83], a[180:183], a[80:83], v[80:83]
  ds_read_b64_tr_b16 a[180:181], v8 offset:0
  v_accvgpr_read_b32 v28, a228
  v_mfma_f32_16x16x32_bf16 v[80:83], a[176:179], a[64:67], v[80:83]
  s_waitcnt lgkmcnt(5)
  buffer_load_dwordx4 v11, s[32:35], s65 offen lds
  v_accvgpr_read_b32 v29, a229
  v_accvgpr_read_b32 v30, a230
  v_mfma_f32_16x16x32_bf16 v[96:99], a[164:167], a[64:67], v[96:99]
  ds_read_b64_tr_b16 a[182:183], v8 offset:2048
  v_accvgpr_read_b32 v31, a231
  v_mfma_f32_16x16x32_bf16 v[96:99], a[160:163], a[80:83], v[96:99]
  s_add_u32 m0, s45, 118784
  s_add_u32 s61, s65, 229376
  v_add_f32 v24, v24, v28
  v_mfma_f32_16x16x32_bf16 v[100:103], a[160:163], a[84:87], v[100:103]
  ds_read_b64_tr_b16 a[176:177], v8 offset:4096
  v_add_f32 v25, v25, v29
  v_mfma_f32_16x16x32_bf16 v[100:103], a[164:167], a[68:71], v[100:103]
  buffer_load_dwordx4 v11, s[28:31], s61 offen lds
  v_add_f32 v26, v26, v30
  v_add_f32 v27, v27, v31
  v_accvgpr_read_b32 v28, a232
  v_mfma_f32_16x16x32_bf16 v[104:107], a[164:167], a[72:75], v[104:107]
  ds_read_b64_tr_b16 a[178:179], v8 offset:6144
  v_accvgpr_read_b32 v29, a233
  v_mfma_f32_16x16x32_bf16 v[104:107], a[160:163], a[88:91], v[104:107]
  v_accvgpr_read_b32 v30, a234
  v_accvgpr_read_b32 v31, a235
  v_mfma_f32_16x16x32_bf16 v[108:111], a[160:163], a[92:95], v[108:111]
  ds_read_b64_tr_b16 a[160:161], v8 offset:8192
  v_add_f32 v24, v24, v28
  v_mfma_f32_16x16x32_bf16 v[108:111], a[164:167], a[76:79], v[108:111]
  s_waitcnt lgkmcnt(5)
  s_add_u32 m0, s45, 126976
  s_add_u32 s61, s65, 229376
  v_add_f32 v25, v25, v29
  v_mfma_f32_16x16x32_bf16 v[124:127], a[172:175], a[76:79], v[124:127]
  ds_read_b64_tr_b16 a[162:163], v8 offset:10240
  v_add_f32 v26, v26, v30
  v_mfma_f32_16x16x32_bf16 v[124:127], a[168:171], a[92:95], v[124:127]
  buffer_load_dwordx4 v11, s[32:35], s61 offen lds
  v_add_f32 v27, v27, v31
  v_accvgpr_read_b32 v28, a236
  v_mfma_f32_16x16x32_bf16 v[120:123], a[168:171], a[88:91], v[120:123]
  ds_read_b64_tr_b16 a[164:165], v8 offset:12288
  v_accvgpr_read_b32 v29, a237
  v_mfma_f32_16x16x32_bf16 v[120:123], a[172:175], a[72:75], v[120:123]
  s_add_u32 m0, s45, 49152
  v_accvgpr_read_b32 v30, a238
  v_accvgpr_read_b32 v31, a239
  v_add_f32 v24, v24, v28
  v_mfma_f32_16x16x32_bf16 v[116:119], a[172:175], a[68:71], v[116:119]
  ds_read_b64_tr_b16 a[166:167], v8 offset:14336
  v_add_f32 v25, v25, v29
  v_mfma_f32_16x16x32_bf16 v[116:119], a[168:171], a[84:87], v[116:119]
  buffer_load_dwordx4 v10, s[28:31], s65 offen lds
  v_add_f32 v26, v26, v30
  v_add_f32 v27, v27, v31
  v_mfma_f32_16x16x32_bf16 v[112:115], a[168:171], a[80:83], v[112:115]
  ds_read_b64_tr_b16 a[168:169], v2 offset:0
  v_accvgpr_read_b32 v28, a240
  v_mfma_f32_16x16x32_bf16 v[112:115], a[172:175], a[64:67], v[112:115]
  s_waitcnt lgkmcnt(5)
  v_accvgpr_read_b32 v29, a241
  v_accvgpr_read_b32 v30, a242
  v_accvgpr_read_b32 v31, a243
  v_mfma_f32_16x16x32_bf16 v[32:35], a[180:183], a[64:67], v[32:35]
  ds_read_b64_tr_b16 a[170:171], v2 offset:2048
  v_add_f32 v24, v24, v28
  v_mfma_f32_16x16x32_bf16 v[32:35], a[176:179], a[80:83], v[32:35]
  s_add_u32 m0, s45, 57344
  v_add_f32 v25, v25, v29
  v_add_f32 v26, v26, v30
  v_mfma_f32_16x16x32_bf16 v[36:39], a[176:179], a[84:87], v[36:39]
  ds_read_b64_tr_b16 a[172:173], v2 offset:4096
  v_add_f32 v27, v27, v31
  v_mfma_f32_16x16x32_bf16 v[36:39], a[180:183], a[68:71], v[36:39]
  buffer_load_dwordx4 v10, s[32:35], s65 offen lds
  v_accvgpr_read_b32 v28, a244
  v_accvgpr_read_b32 v29, a245
  v_accvgpr_read_b32 v30, a246
  v_mfma_f32_16x16x32_bf16 v[40:43], a[180:183], a[72:75], v[40:43]
  ds_read_b64_tr_b16 a[174:175], v2 offset:6144
  v_accvgpr_read_b32 v31, a247
  v_mfma_f32_16x16x32_bf16 v[40:43], a[176:179], a[88:91], v[40:43]
  s_add_u32 m0, s45, 53248
  s_add_u32 s61, s65, 229376
  v_add_f32 v24, v24, v28
  v_mfma_f32_16x16x32_bf16 v[44:47], a[176:179], a[92:95], v[44:47]
  ds_read_b64_tr_b16 a[176:177], v2 offset:8192
  v_add_f32 v25, v25, v29
  v_mfma_f32_16x16x32_bf16 v[44:47], a[180:183], a[76:79], v[44:47]
  s_waitcnt lgkmcnt(5)
  buffer_load_dwordx4 v10, s[28:31], s61 offen lds
  v_add_f32 v26, v26, v30
  v_add_f32 v27, v27, v31
  v_mfma_f32_16x16x32_bf16 v[60:63], a[160:163], a[76:79], v[60:63]
  ds_read_b64_tr_b16 a[178:179], v2 offset:10240
  v_accvgpr_read_b32 v28, a248
  v_mfma_f32_16x16x32_bf16 v[60:63], a[164:167], a[92:95], v[60:63]
  v_accvgpr_read_b32 v29, a249
  v_accvgpr_read_b32 v30, a250
  v_mfma_f32_16x16x32_bf16 v[56:59], a[164:167], a[88:91], v[56:59]
  ds_read_b64_tr_b16 a[180:181], v2 offset:12288
  v_accvgpr_read_b32 v31, a251
  v_mfma_f32_16x16x32_bf16 v[56:59], a[160:163], a[72:75], v[56:59]
  s_add_u32 m0, s45, 61440
  s_add_u32 s61, s65, 229376
  v_add_f32 v24, v24, v28
  v_add_f32 v25, v25, v29
  v_mfma_f32_16x16x32_bf16 v[52:55], a[160:163], a[68:71], v[52:55]
  ds_read_b64_tr_b16 a[182:183], v2 offset:14336
  v_add_f32 v26, v26, v30
  v_mfma_f32_16x16x32_bf16 v[52:55], a[164:167], a[84:87], v[52:55]
  buffer_load_dwordx4 v10, s[32:35], s61 offen lds
  v_add_f32 v27, v27, v31
  v_mov_b32 v28, v24
  v_mfma_f32_16x16x32_bf16 v[48:51], a[164:167], a[80:83], v[48:51]
  ds_read_b64_tr_b16 a[164:165], v3 offset:0
  v_mov_b32 v29, v25
  v_mfma_f32_16x16x32_bf16 v[48:51], a[160:163], a[64:67], v[48:51]
  s_waitcnt lgkmcnt(5)
  v_mov_b32 v30, v26
  v_mov_b32 v31, v27
  v_mfma_f32_16x16x32_bf16 v[128:131], a[168:171], a[64:67], v[128:131]
  ds_read_b64_tr_b16 a[166:167], v3 offset:2048
  v_mfma_f32_16x16x32_bf16 v[128:131], a[172:175], a[80:83], v[128:131]
  buffer_load_dwordx4 a[128:131], v1, s[8:11], s73 offen offset:0 sc1
  v_permlane32_swap_b32 v24, v28
  v_mfma_f32_16x16x32_bf16 v[132:135], a[172:175], a[84:87], v[132:135]
  ds_read_b64_tr_b16 a[160:161], v3 offset:4096
  v_mfma_f32_16x16x32_bf16 v[132:135], a[168:171], a[68:71], v[132:135]
  v_permlane32_swap_b32 v25, v29
  v_mfma_f32_16x16x32_bf16 v[136:139], a[168:171], a[72:75], v[136:139]
  ds_read_b64_tr_b16 a[162:163], v3 offset:6144
  v_mfma_f32_16x16x32_bf16 v[136:139], a[172:175], a[88:91], v[136:139]
  v_permlane32_swap_b32 v26, v30
  v_mfma_f32_16x16x32_bf16 v[140:143], a[172:175], a[92:95], v[140:143]
  ds_read_b64_tr_b16 a[172:173], v3 offset:8192
  v_mfma_f32_16x16x32_bf16 v[140:143], a[168:171], a[76:79], v[140:143]
  s_waitcnt lgkmcnt(5)
  buffer_load_dwordx4 a[144:147], v1, s[8:11], s73 offen offset:1024 sc1
  v_permlane32_swap_b32 v27, v31
  v_mfma_f32_16x16x32_bf16 v[156:159], a[176:179], a[76:79], v[156:159]
  ds_read_b64_tr_b16 a[174:175], v3 offset:10240
  v_add_f32 v24, v24, v28
  v_mfma_f32_16x16x32_bf16 v[156:159], a[180:183], a[92:95], v[156:159]
  s_add_u32 s73, s73, 65536
  v_add_f32 v25, v25, v29
  v_add_f32 v26, v26, v30
  v_mfma_f32_16x16x32_bf16 v[152:155], a[180:183], a[88:91], v[152:155]
  ds_read_b64_tr_b16 a[168:169], v3 offset:12288
  v_add_f32 v27, v27, v31
  v_mfma_f32_16x16x32_bf16 v[152:155], a[176:179], a[72:75], v[152:155]
  buffer_load_dwordx4 a[132:135], v1, s[8:11], s73 offen offset:0 sc1
  s_cmp_eq_u32 s44, 1
  s_cselect_b32 s55, 0xbfb8aa3b, 1.0
  v_mul_f32 v24, s55, v24
  v_mfma_f32_16x16x32_bf16 v[148:151], a[176:179], a[68:71], v[148:151]
  ds_read_b64_tr_b16 a[170:171], v3 offset:14336
  v_lshrrev_b32 v13, 8, v1
  v_lshlrev_b32 v13, 28, v13
  v_mfma_f32_16x16x32_bf16 v[148:151], a[180:183], a[84:87], v[148:151]
  v_lshl_add_u32 v13, v1, 3, v13
  v_xor_b32 v9, 96, v6
  v_mfma_f32_16x16x32_bf16 v[144:147], a[180:183], a[80:83], v[144:147]
  ds_read_b64_tr_b16 a[180:181], v4 offset:0
  v_mul_f32 v25, s55, v25
  v_mfma_f32_16x16x32_bf16 v[144:147], a[176:179], a[64:67], v[144:147]
  s_waitcnt lgkmcnt(5)
  v_mul_f32 v26, s55, v26
  v_mul_f32 v27, s55, v27
  v_mfma_f32_16x16x32_bf16 v[160:163], a[164:167], a[64:67], v[160:163]
  ds_read_b64_tr_b16 a[182:183], v4 offset:2048
  v_mfma_f32_16x16x32_bf16 v[160:163], a[160:163], a[80:83], v[160:163]
  buffer_load_dwordx4 a[148:151], v1, s[8:11], s73 offen offset:1024 sc1
  ds_write_b128 v15, v[24:27]
  v_mfma_f32_16x16x32_bf16 v[164:167], a[160:163], a[84:87], v[164:167]
  ds_read_b64_tr_b16 a[176:177], v4 offset:4096
  v_mfma_f32_16x16x32_bf16 v[164:167], a[164:167], a[68:71], v[164:167]
  s_add_u32 s73, s73, 65536
  v_mfma_f32_16x16x32_bf16 v[168:171], a[164:167], a[72:75], v[168:171]
  ds_read_b64_tr_b16 a[178:179], v4 offset:6144
  s_waitcnt lgkmcnt(2)
  s_barrier
  v_mfma_f32_16x16x32_bf16 v[168:171], a[160:163], a[88:91], v[168:171]
  buffer_load_dwordx4 a[136:139], v1, s[8:11], s73 offen offset:0 sc1
  ds_read_b128 v[24:27], v12 offset:384
  v_mfma_f32_16x16x32_bf16 v[172:175], a[160:163], a[92:95], v[172:175]
  ds_read_b64_tr_b16 a[160:161], v4 offset:8192
  v_mfma_f32_16x16x32_bf16 v[172:175], a[164:167], a[76:79], v[172:175]
  s_waitcnt lgkmcnt(7)
  v_mfma_f32_16x16x32_bf16 v[188:191], a[172:175], a[76:79], v[188:191]
  ds_read_b64_tr_b16 a[162:163], v4 offset:10240
  v_mfma_f32_16x16x32_bf16 v[188:191], a[168:171], a[92:95], v[188:191]
  v_mfma_f32_16x16x32_bf16 v[184:187], a[168:171], a[88:91], v[184:187]
  ds_read_b64_tr_b16 a[164:165], v4 offset:12288
  v_mfma_f32_16x16x32_bf16 v[184:187], a[172:175], a[72:75], v[184:187]
  buffer_load_dwordx4 a[152:155], v1, s[8:11], s73 offen offset:1024 sc1
  v_mfma_f32_16x16x32_bf16 v[180:183], a[172:175], a[68:71], v[180:183]
  ds_read_b64_tr_b16 a[166:167], v4 offset:14336
  v_mfma_f32_16x16x32_bf16 v[180:183], a[168:171], a[84:87], v[180:183]
  s_add_u32 s73, s73, 65536
  ds_read_b128 v[28:31], v12 offset:1408
  v_mfma_f32_16x16x32_bf16 v[176:179], a[168:171], a[80:83], v[176:179]
  ds_read_b64_tr_b16 a[168:169], v5 offset:0
  s_waitcnt lgkmcnt(6)
  v_mfma_f32_16x16x32_bf16 v[176:179], a[172:175], a[64:67], v[176:179]
  s_waitcnt lgkmcnt(7)
  buffer_load_dwordx4 a[140:143], v1, s[8:11], s73 offen offset:0 sc1
  v_fmac_f32 v32, v16, v24
  v_mfma_f32_16x16x32_bf16 v[192:195], a[180:183], a[64:67], v[192:195]
  ds_read_b64_tr_b16 a[170:171], v5 offset:2048
  v_fmac_f32 v33, v16, v25
  v_mfma_f32_16x16x32_bf16 v[192:195], a[176:179], a[80:83], v[192:195]
  v_fmac_f32 v34, v16, v26
  v_fmac_f32 v35, v16, v27
  v_mfma_f32_16x16x32_bf16 v[196:199], a[176:179], a[84:87], v[196:199]
  ds_read_b64_tr_b16 a[172:173], v5 offset:4096
  v_fmac_f32 v36, v18, v24
  v_mfma_f32_16x16x32_bf16 v[196:199], a[180:183], a[68:71], v[196:199]
  v_fmac_f32 v37, v18, v25
  v_fmac_f32 v38, v18, v26
  v_mfma_f32_16x16x32_bf16 v[200:203], a[180:183], a[72:75], v[200:203]
  ds_read_b64_tr_b16 a[174:175], v5 offset:6144
  v_fmac_f32 v39, v18, v27
  v_mfma_f32_16x16x32_bf16 v[200:203], a[176:179], a[88:91], v[200:203]
  buffer_load_dwordx4 a[156:159], v1, s[8:11], s73 offen offset:1024 sc1
  v_fmac_f32 v40, v20, v24
  v_fmac_f32 v41, v20, v25
  v_mfma_f32_16x16x32_bf16 v[204:207], a[176:179], a[92:95], v[204:207]
  ds_read_b64_tr_b16 a[176:177], v5 offset:8192
  v_fmac_f32 v42, v20, v26
  v_mfma_f32_16x16x32_bf16 v[204:207], a[180:183], a[76:79], v[204:207]
  s_waitcnt lgkmcnt(6)
  s_mov_b32 s66, 4587520
  s_add_u32 s74, s57, 20480
  s_add_u32 m0, s45, 81920
  v_fmac_f32 v43, v20, v27
  v_mfma_f32_16x16x32_bf16 v[220:223], a[160:163], a[76:79], v[220:223]
  ds_read_b64_tr_b16 a[178:179], v5 offset:10240
  v_fmac_f32 v44, v22, v24
  v_mfma_f32_16x16x32_bf16 v[220:223], a[164:167], a[92:95], v[220:223]
  buffer_load_dwordx4 v11, s[28:31], s66 offen lds
  v_fmac_f32 v45, v22, v25
  v_fmac_f32 v46, v22, v26
  v_mfma_f32_16x16x32_bf16 v[216:219], a[164:167], a[88:91], v[216:219]
  ds_read_b64_tr_b16 a[180:181], v5 offset:12288
  v_fmac_f32 v47, v22, v27
  v_mfma_f32_16x16x32_bf16 v[216:219], a[160:163], a[72:75], v[216:219]
  ds_read_b128 v[24:27], v12 offset:1920
  s_waitcnt lgkmcnt(8)
  v_mfma_f32_16x16x32_bf16 v[212:215], a[160:163], a[68:71], v[212:215]
  ds_read_b64_tr_b16 a[182:183], v5 offset:14336
  v_fmac_f32 v48, v16, v28
  v_mfma_f32_16x16x32_bf16 v[212:215], a[164:167], a[84:87], v[212:215]
  s_waitcnt vmcnt(33)
HOP11:
  s_cbranch_execz WRET0
  s_barrier
  v_mfma_f32_16x16x32_bf16 v[208:211], a[164:167], a[80:83], v[208:211]
  ds_read_b64_tr_b16 a[164:165], v6 offset:32768
  s_add_u32 m0, s45, 90112
  v_mfma_f32_16x16x32_bf16 v[208:211], a[160:163], a[64:67], v[208:211]
  s_waitcnt lgkmcnt(6)
  buffer_load_dwordx4 v11, s[32:35], s66 offen lds
  v_fmac_f32 v49, v16, v29
  v_mfma_f32_16x16x32_bf16 v[224:227], a[168:171], a[64:67], v[224:227]
  ds_read_b64_tr_b16 a[166:167], v6 offset:34816
  v_fmac_f32 v50, v16, v30
  v_mfma_f32_16x16x32_bf16 v[224:227], a[172:175], a[80:83], v[224:227]
  s_add_u32 m0, s45, 86016
  s_add_u32 s61, s66, 229376
  v_fmac_f32 v51, v16, v31
  v_mfma_f32_16x16x32_bf16 v[228:231], a[172:175], a[84:87], v[228:231]
  ds_read_b64_tr_b16 a[160:161], v6 offset:36864
  v_fmac_f32 v52, v18, v28
  v_mfma_f32_16x16x32_bf16 v[228:231], a[168:171], a[68:71], v[228:231]
  buffer_load_dwordx4 v11, s[28:31], s61 offen lds
  v_fmac_f32 v53, v18, v29
  v_fmac_f32 v54, v18, v30
  v_mfma_f32_16x16x32_bf16 v[232:235], a[168:171], a[72:75], v[232:235]
  ds_read_b64_tr_b16 a[162:163], v6 offset:38912
  v_fmac_f32 v55, v18, v31
  v_mfma_f32_16x16x32_bf16 v[232:235], a[172:175], a[88:91], v[232:235]
  v_fmac_f32 v56, v20, v28
  v_fmac_f32 v57, v20, v29
  v_mfma_f32_16x16x32_bf16 v[236:239], a[172:175], a[92:95], v[236:239]
  ds_read_b64_tr_b16 a[172:173], v6 offset:40960
  v_fmac_f32 v58, v20, v30
  v_mfma_f32_16x16x32_bf16 v[236:239], a[168:171], a[76:79], v[236:239]
  s_waitcnt lgkmcnt(5)
  s_add_u32 m0, s45, 94208
  s_add_u32 s61, s66, 229376
  v_mfma_f32_16x16x32_bf16 v[252:255], a[176:179], a[76:79], v[252:255]
  ds_read_b64_tr_b16 a[174:175], v6 offset:43008
  v_fmac_f32 v59, v20, v31
  v_mfma_f32_16x16x32_bf16 v[252:255], a[180:183], a[92:95], v[252:255]
  buffer_load_dwordx4 v11, s[32:35], s61 offen lds
  v_fmac_f32 v60, v22, v28
  v_fmac_f32 v61, v22, v29
  v_mfma_f32_16x16x32_bf16 v[248:251], a[180:183], a[88:91], v[248:251]
  ds_read_b64_tr_b16 a[168:169], v6 offset:45056
  v_fmac_f32 v62, v22, v30
  v_mfma_f32_16x16x32_bf16 v[248:251], a[176:179], a[72:75], v[248:251]
  s_mov_b32 s67, 5046272
  s_add_u32 s75, s57, 22528
  s_add_u32 m0, s45, 65536
  v_fmac_f32 v63, v22, v31
  v_mfma_f32_16x16x32_bf16 v[244:247], a[176:179], a[68:71], v[244:247]
  ds_read_b64_tr_b16 a[170:171], v6 offset:47104
  v_mfma_f32_16x16x32_bf16 v[244:247], a[180:183], a[84:87], v[244:247]
  buffer_load_dwordx4 v11, s[28:31], s67 offen lds
  ds_read_b128 v[28:31], v12 offset:0
  v_mfma_f32_16x16x32_bf16 v[240:243], a[180:183], a[80:83], v[240:243]
  ds_read_b64_tr_b16 a[180:181], v7 offset:32768
  s_waitcnt lgkmcnt(11)
  v_mfma_f32_16x16x32_bf16 v[240:243], a[176:179], a[64:67], v[240:243]
  s_waitcnt vmcnt(21) lgkmcnt(6)
  v_fmac_f32 v48, v17, v24
  v_fmac_f32 v49, v17, v25
  v_mfma_f32_16x16x32_bf16 v[64:67], a[164:167], a[96:99], v[64:67]
  ds_read_b64_tr_b16 a[182:183], v7 offset:34816
  v_fmac_f32 v50, v17, v26
  v_mfma_f32_16x16x32_bf16 v[64:67], a[160:163], a[112:115], v[64:67]
  s_add_u32 m0, s45, 73728
  v_fmac_f32 v51, v17, v27
  v_fmac_f32 v52, v19, v24
  v_mfma_f32_16x16x32_bf16 v[68:71], a[160:163], a[116:119], v[68:71]
  ds_read_b64_tr_b16 a[176:177], v7 offset:36864
  v_fmac_f32 v53, v19, v25
  v_mfma_f32_16x16x32_bf16 v[68:71], a[164:167], a[100:103], v[68:71]
  buffer_load_dwordx4 v11, s[32:35], s67 offen lds
  v_fmac_f32 v54, v19, v26
  v_fmac_f32 v55, v19, v27
  v_mfma_f32_16x16x32_bf16 v[72:75], a[164:167], a[104:107], v[72:75]
  ds_read_b64_tr_b16 a[178:179], v7 offset:38912
  v_fmac_f32 v56, v21, v24
  v_mfma_f32_16x16x32_bf16 v[72:75], a[160:163], a[120:123], v[72:75]
  s_add_u32 m0, s45, 69632
  s_add_u32 s61, s67, 229376
  v_fmac_f32 v57, v21, v25
  v_mfma_f32_16x16x32_bf16 v[76:79], a[160:163], a[124:127], v[76:79]
  ds_read_b64_tr_b16 a[160:161], v7 offset:40960
  v_fmac_f32 v58, v21, v26
  v_mfma_f32_16x16x32_bf16 v[76:79], a[164:167], a[108:111], v[76:79]
  s_waitcnt lgkmcnt(6)
  buffer_load_dwordx4 v11, s[28:31], s61 offen lds
  v_fmac_f32 v59, v21, v27
  v_mfma_f32_16x16x32_bf16 v[92:95], a[172:175], a[108:111], v[92:95]
  ds_read_b64_tr_b16 a[162:163], v7 offset:43008
  v_fmac_f32 v60, v23, v24
  v_mfma_f32_16x16x32_bf16 v[92:95], a[168:171], a[124:127], v[92:95]
  v_fmac_f32 v61, v23, v25
  v_fmac_f32 v62, v23, v26
  v_mfma_f32_16x16x32_bf16 v[88:91], a[168:171], a[120:123], v[88:91]
  ds_read_b64_tr_b16 a[164:165], v7 offset:45056
  v_fmac_f32 v63, v23, v27
  v_mfma_f32_16x16x32_bf16 v[88:91], a[172:175], a[104:107], v[88:91]
  s_add_u32 m0, s45, 77824
  s_add_u32 s61, s67, 229376
  v_mfma_f32_16x16x32_bf16 v[84:87], a[172:175], a[100:103], v[84:87]
  ds_read_b64_tr_b16 a[166:167], v7 offset:47104
  v_mfma_f32_16x16x32_bf16 v[84:87], a[168:171], a[116:119], v[84:87]
  buffer_load_dwordx4 v11, s[32:35], s61 offen lds
  ds_read_b128 v[24:27], v12 offset:256
  v_mfma_f32_16x16x32_bf16 v[80:83], a[168:171], a[112:115], v[80:83]
  ds_read_b64_tr_b16 a[168:169], v8 offset:32768
  s_waitcnt lgkmcnt(10)
  v_mfma_f32_16x16x32_bf16 v[80:83], a[172:175], a[96:99], v[80:83]
  s_waitcnt lgkmcnt(6)
  s_add_u32 m0, s45, 16384
  v_fmac_f32 v128, v16, v28
  v_mfma_f32_16x16x32_bf16 v[96:99], a[180:183], a[96:99], v[96:99]
  ds_read_b64_tr_b16 a[170:171], v8 offset:34816
  v_fmac_f32 v129, v16, v29
  v_mfma_f32_16x16x32_bf16 v[96:99], a[176:179], a[112:115], v[96:99]
  buffer_load_dwordx4 v10, s[28:31], s66 offen lds
  v_fmac_f32 v130, v16, v30
  v_fmac_f32 v131, v16, v31
  v_mfma_f32_16x16x32_bf16 v[100:103], a[176:179], a[116:119], v[100:103]
  ds_read_b64_tr_b16 a[172:173], v8 offset:36864
  v_fmac_f32 v132, v18, v28
  v_mfma_f32_16x16x32_bf16 v[100:103], a[180:183], a[100:103], v[100:103]
  v_fmac_f32 v133, v18, v29
  v_fmac_f32 v134, v18, v30
  v_mfma_f32_16x16x32_bf16 v[104:107], a[180:183], a[104:107], v[104:107]
  ds_read_b64_tr_b16 a[174:175], v8 offset:38912
  v_fmac_f32 v135, v18, v31
  v_mfma_f32_16x16x32_bf16 v[104:107], a[176:179], a[120:123], v[104:107]
  s_add_u32 m0, s45, 24576
  v_fmac_f32 v136, v20, v28
  v_fmac_f32 v137, v20, v29
  v_mfma_f32_16x16x32_bf16 v[108:111], a[176:179], a[124:127], v[108:111]
  ds_read_b64_tr_b16 a[176:177], v8 offset:40960
  v_fmac_f32 v138, v20, v30
  v_mfma_f32_16x16x32_bf16 v[108:111], a[180:183], a[108:111], v[108:111]
  s_waitcnt lgkmcnt(6)
  buffer_load_dwordx4 v10, s[32:35], s66 offen lds
  v_fmac_f32 v139, v20, v31
  v_mfma_f32_16x16x32_bf16 v[124:127], a[160:163], a[108:111], v[124:127]
  ds_read_b64_tr_b16 a[178:179], v8 offset:43008
  v_fmac_f32 v140, v22, v28
  v_mfma_f32_16x16x32_bf16 v[124:127], a[164:167], a[124:127], v[124:127]
  s_add_u32 m0, s45, 20480
  s_add_u32 s61, s66, 229376
  v_fmac_f32 v141, v22, v29
  v_mfma_f32_16x16x32_bf16 v[120:123], a[164:167], a[120:123], v[120:123]
  ds_read_b64_tr_b16 a[180:181], v8 offset:45056
  v_fmac_f32 v142, v22, v30
  v_mfma_f32_16x16x32_bf16 v[120:123], a[160:163], a[104:107], v[120:123]
  buffer_load_dwordx4 v10, s[28:31], s61 offen lds
  v_fmac_f32 v143, v22, v31
  v_mfma_f32_16x16x32_bf16 v[116:119], a[160:163], a[100:103], v[116:119]
  ds_read_b64_tr_b16 a[182:183], v8 offset:47104
  v_mfma_f32_16x16x32_bf16 v[116:119], a[164:167], a[116:119], v[116:119]
  ds_read_b128 v[28:31], v12 offset:1280
  s_waitcnt lgkmcnt(9)
  v_mfma_f32_16x16x32_bf16 v[112:115], a[164:167], a[112:115], v[112:115]
  ds_read_b64_tr_b16 a[164:165], v2 offset:32768
  v_fmac_f32 v64, v16, v24
  v_mfma_f32_16x16x32_bf16 v[112:115], a[160:163], a[96:99], v[112:115]
  s_waitcnt lgkmcnt(6)
  s_add_u32 m0, s45, 28672
  s_add_u32 s61, s66, 229376
  v_mfma_f32_16x16x32_bf16 v[32:35], a[168:171], a[96:99], v[32:35]
  ds_read_b64_tr_b16 a[166:167], v2 offset:34816
  v_fmac_f32 v65, v16, v25
  v_mfma_f32_16x16x32_bf16 v[32:35], a[172:175], a[112:115], v[32:35]
  buffer_load_dwordx4 v10, s[32:35], s61 offen lds
  v_fmac_f32 v66, v16, v26
  v_fmac_f32 v67, v16, v27
  v_mfma_f32_16x16x32_bf16 v[36:39], a[172:175], a[116:119], v[36:39]
  ds_read_b64_tr_b16 a[160:161], v2 offset:36864
  v_fmac_f32 v68, v18, v24
  v_mfma_f32_16x16x32_bf16 v[36:39], a[168:171], a[100:103], v[36:39]
  v_fmac_f32 v69, v18, v25
  v_fmac_f32 v70, v18, v26
  v_mfma_f32_16x16x32_bf16 v[40:43], a[168:171], a[104:107], v[40:43]
  ds_read_b64_tr_b16 a[162:163], v2 offset:38912
  v_fmac_f32 v71, v18, v27
  v_mfma_f32_16x16x32_bf16 v[40:43], a[172:175], a[120:123], v[40:43]
  buffer_load_dwordx4 a[0:3], v1, s[8:11], s74 offen offset:0 sc1
  v_fmac_f32 v72, v20, v24
  v_fmac_f32 v73, v20, v25
  v_mfma_f32_16x16x32_bf16 v[44:47], a[172:175], a[124:127], v[44:47]
  ds_read_b64_tr_b16 a[172:173], v2 offset:40960
  v_fmac_f32 v74, v20, v26
  v_mfma_f32_16x16x32_bf16 v[44:47], a[168:171], a[108:111], v[44:47]
  s_waitcnt lgkmcnt(6)
  v_fmac_f32 v75, v20, v27
  v_fmac_f32 v76, v22, v24
  v_mfma_f32_16x16x32_bf16 v[60:63], a[176:179], a[108:111], v[60:63]
  ds_read_b64_tr_b16 a[174:175], v2 offset:43008
  v_fmac_f32 v77, v22, v25
  v_mfma_f32_16x16x32_bf16 v[60:63], a[180:183], a[124:127], v[60:63]
  v_fmac_f32 v78, v22, v26
  v_fmac_f32 v79, v22, v27
  v_mfma_f32_16x16x32_bf16 v[56:59], a[180:183], a[120:123], v[56:59]
  ds_read_b64_tr_b16 a[168:169], v2 offset:45056
  v_mfma_f32_16x16x32_bf16 v[56:59], a[176:179], a[104:107], v[56:59]
  buffer_load_dwordx4 a[16:19], v1, s[8:11], s74 offen offset:1024 sc1
  ds_read_b128 v[24:27], v12 offset:1792
  v_mfma_f32_16x16x32_bf16 v[52:55], a[176:179], a[100:103], v[52:55]
  ds_read_b64_tr_b16 a[170:171], v2 offset:47104
  s_waitcnt lgkmcnt(9)
  v_mfma_f32_16x16x32_bf16 v[52:55], a[180:183], a[116:119], v[52:55]
  s_add_u32 s74, s74, 65536
  v_fmac_f32 v80, v16, v28
  v_fmac_f32 v81, v16, v29
  v_mfma_f32_16x16x32_bf16 v[48:51], a[180:183], a[112:115], v[48:51]
  ds_read_b64_tr_b16 a[180:181], v3 offset:32768
  v_fmac_f32 v82, v16, v30
  v_mfma_f32_16x16x32_bf16 v[48:51], a[176:179], a[96:99], v[48:51]
  s_waitcnt lgkmcnt(6)
  buffer_load_dwordx4 a[4:7], v1, s[8:11], s74 offen offset:0 sc1
  v_fmac_f32 v83, v16, v31
  v_mfma_f32_16x16x32_bf16 v[128:131], a[164:167], a[96:99], v[128:131]
  ds_read_b64_tr_b16 a[182:183], v3 offset:34816
  v_fmac_f32 v84, v18, v28
  v_mfma_f32_16x16x32_bf16 v[128:131], a[160:163], a[112:115], v[128:131]
  v_fmac_f32 v85, v18, v29
  v_fmac_f32 v86, v18, v30
  v_mfma_f32_16x16x32_bf16 v[132:135], a[160:163], a[116:119], v[132:135]
  ds_read_b64_tr_b16 a[176:177], v3 offset:36864
  v_fmac_f32 v87, v18, v31
  v_mfma_f32_16x16x32_bf16 v[132:135], a[164:167], a[100:103], v[132:135]
  v_fmac_f32 v88, v20, v28
  v_fmac_f32 v89, v20, v29
  v_mfma_f32_16x16x32_bf16 v[136:139], a[164:167], a[104:107], v[136:139]
  ds_read_b64_tr_b16 a[178:179], v3 offset:38912
  v_fmac_f32 v90, v20, v30
  v_mfma_f32_16x16x32_bf16 v[136:139], a[160:163], a[120:123], v[136:139]
  buffer_load_dwordx4 a[20:23], v1, s[8:11], s74 offen offset:1024 sc1
  v_fmac_f32 v91, v20, v31
  v_fmac_f32 v92, v22, v28
  v_mfma_f32_16x16x32_bf16 v[140:143], a[160:163], a[124:127], v[140:143]
  ds_read_b64_tr_b16 a[160:161], v3 offset:40960
  v_fmac_f32 v93, v22, v29
  v_mfma_f32_16x16x32_bf16 v[140:143], a[164:167], a[108:111], v[140:143]
  s_waitcnt lgkmcnt(5)
  s_add_u32 s74, s74, 65536
  v_fmac_f32 v94, v22, v30
  v_mfma_f32_16x16x32_bf16 v[156:159], a[172:175], a[108:111], v[156:159]
  ds_read_b64_tr_b16 a[162:163], v3 offset:43008
  v_fmac_f32 v95, v22, v31
  v_mfma_f32_16x16x32_bf16 v[156:159], a[168:171], a[124:127], v[156:159]
  buffer_load_dwordx4 a[8:11], v1, s[8:11], s74 offen offset:0 sc1
  ds_read_b128 v[28:31], v12 offset:320
  v_mfma_f32_16x16x32_bf16 v[152:155], a[168:171], a[120:123], v[152:155]
  ds_read_b64_tr_b16 a[164:165], v3 offset:45056
  s_waitcnt lgkmcnt(9)
  v_mfma_f32_16x16x32_bf16 v[152:155], a[172:175], a[104:107], v[152:155]
  v_fmac_f32 v80, v17, v24
  v_fmac_f32 v81, v17, v25
  v_mfma_f32_16x16x32_bf16 v[148:151], a[172:175], a[100:103], v[148:151]
  ds_read_b64_tr_b16 a[166:167], v3 offset:47104
  v_fmac_f32 v82, v17, v26
  v_mfma_f32_16x16x32_bf16 v[148:151], a[168:171], a[116:119], v[148:151]
  v_fmac_f32 v83, v17, v27
  v_fmac_f32 v84, v19, v24
  v_mfma_f32_16x16x32_bf16 v[144:147], a[168:171], a[112:115], v[144:147]
  ds_read_b64_tr_b16 a[168:169], v4 offset:32768
  v_fmac_f32 v85, v19, v25
  v_mfma_f32_16x16x32_bf16 v[144:147], a[172:175], a[96:99], v[144:147]
  s_waitcnt lgkmcnt(6)
  buffer_load_dwordx4 a[24:27], v1, s[8:11], s74 offen offset:1024 sc1
  v_fmac_f32 v86, v19, v26
  v_mfma_f32_16x16x32_bf16 v[160:163], a[180:183], a[96:99], v[160:163]
  ds_read_b64_tr_b16 a[170:171], v4 offset:34816
  v_fmac_f32 v87, v19, v27
  v_mfma_f32_16x16x32_bf16 v[160:163], a[176:179], a[112:115], v[160:163]
  s_add_u32 s74, s74, 65536
  v_fmac_f32 v88, v21, v24
  v_fmac_f32 v89, v21, v25
  v_mfma_f32_16x16x32_bf16 v[164:167], a[176:179], a[116:119], v[164:167]
  ds_read_b64_tr_b16 a[172:173], v4 offset:36864
  v_fmac_f32 v90, v21, v26
  v_mfma_f32_16x16x32_bf16 v[164:167], a[180:183], a[100:103], v[164:167]
  buffer_load_dwordx4 a[12:15], v1, s[8:11], s74 offen offset:0 sc1
  v_fmac_f32 v91, v21, v27
  v_fmac_f32 v92, v23, v24
  v_mfma_f32_16x16x32_bf16 v[168:171], a[180:183], a[104:107], v[168:171]
  ds_read_b64_tr_b16 a[174:175], v4 offset:38912
  v_fmac_f32 v93, v23, v25
  v_mfma_f32_16x16x32_bf16 v[168:171], a[176:179], a[120:123], v[168:171]
  v_fmac_f32 v94, v23, v26
  v_fmac_f32 v95, v23, v27
  v_mfma_f32_16x16x32_bf16 v[172:175], a[176:179], a[124:127], v[172:175]
  ds_read_b64_tr_b16 a[176:177], v4 offset:40960
  v_mfma_f32_16x16x32_bf16 v[172:175], a[180:183], a[108:111], v[172:175]
  s_waitcnt lgkmcnt(5)
  ds_read_b128 v[24:27], v12 offset:1344
  v_mfma_f32_16x16x32_bf16 v[188:191], a[160:163], a[108:111], v[188:191]
  ds_read_b64_tr_b16 a[178:179], v4 offset:43008
  s_waitcnt lgkmcnt(9)
  v_mfma_f32_16x16x32_bf16 v[188:191], a[164:167], a[124:127], v[188:191]
  buffer_load_dwordx4 a[28:31], v1, s[8:11], s74 offen offset:1024 sc1
  v_fmac_f32 v96, v16, v28
  v_fmac_f32 v97, v16, v29
  v_mfma_f32_16x16x32_bf16 v[184:187], a[164:167], a[120:123], v[184:187]
  ds_read_b64_tr_b16 a[180:181], v4 offset:45056
  v_fmac_f32 v98, v16, v30
  v_mfma_f32_16x16x32_bf16 v[184:187], a[160:163], a[104:107], v[184:187]
  v_fmac_f32 v99, v16, v31
  v_fmac_f32 v100, v18, v28
  v_mfma_f32_16x16x32_bf16 v[180:183], a[160:163], a[100:103], v[180:183]
  ds_read_b64_tr_b16 a[182:183], v4 offset:47104
  v_fmac_f32 v101, v18, v29
  v_mfma_f32_16x16x32_bf16 v[180:183], a[164:167], a[116:119], v[180:183]
  buffer_load_dwordx4 a[32:35], v1, s[8:11], s75 offen offset:0 sc1
  v_fmac_f32 v102, v18, v30
  v_fmac_f32 v103, v18, v31
  v_mfma_f32_16x16x32_bf16 v[176:179], a[164:167], a[112:115], v[176:179]
  ds_read_b64_tr_b16 a[164:165], v5 offset:32768
  v_fmac_f32 v104, v20, v28
  v_mfma_f32_16x16x32_bf16 v[176:179], a[160:163], a[96:99], v[176:179]
  s_waitcnt lgkmcnt(6)
  v_fmac_f32 v105, v20, v29
  v_fmac_f32 v106, v20, v30
  v_mfma_f32_16x16x32_bf16 v[192:195], a[168:171], a[96:99], v[192:195]
  ds_read_b64_tr_b16 a[166:167], v5 offset:34816
  v_fmac_f32 v107, v20, v31
  v_mfma_f32_16x16x32_bf16 v[192:195], a[172:175], a[112:115], v[192:195]
  v_fmac_f32 v108, v22, v28
  v_fmac_f32 v109, v22, v29
  v_mfma_f32_16x16x32_bf16 v[196:199], a[172:175], a[116:119], v[196:199]
  ds_read_b64_tr_b16 a[160:161], v5 offset:36864
  v_fmac_f32 v110, v22, v30
  v_mfma_f32_16x16x32_bf16 v[196:199], a[168:171], a[100:103], v[196:199]
  buffer_load_dwordx4 a[48:51], v1, s[8:11], s75 offen offset:1024 sc1
  v_fmac_f32 v111, v22, v31
  v_mfma_f32_16x16x32_bf16 v[200:203], a[168:171], a[104:107], v[200:203]
  ds_read_b64_tr_b16 a[162:163], v5 offset:38912
  v_mfma_f32_16x16x32_bf16 v[200:203], a[172:175], a[120:123], v[200:203]
  s_add_u32 s75, s75, 65536
  ds_read_b128 v[28:31], v12 offset:1856
  v_mfma_f32_16x16x32_bf16 v[204:207], a[172:175], a[124:127], v[204:207]
  ds_read_b64_tr_b16 a[172:173], v5 offset:40960
  s_waitcnt lgkmcnt(9)
  v_mfma_f32_16x16x32_bf16 v[204:207], a[168:171], a[108:111], v[204:207]
  s_waitcnt lgkmcnt(6)
  buffer_load_dwordx4 a[36:39], v1, s[8:11], s75 offen offset:0 sc1
  v_fmac_f32 v112, v16, v24
  v_mfma_f32_16x16x32_bf16 v[220:223], a[176:179], a[108:111], v[220:223]
  ds_read_b64_tr_b16 a[174:175], v5 offset:43008
  v_fmac_f32 v113, v16, v25
  v_mfma_f32_16x16x32_bf16 v[220:223], a[180:183], a[124:127], v[220:223]
  v_fmac_f32 v114, v16, v26
  v_fmac_f32 v115, v16, v27
  v_mfma_f32_16x16x32_bf16 v[216:219], a[180:183], a[120:123], v[216:219]
  ds_read_b64_tr_b16 a[168:169], v5 offset:45056
  v_fmac_f32 v116, v18, v24
  v_mfma_f32_16x16x32_bf16 v[216:219], a[176:179], a[104:107], v[216:219]
  v_fmac_f32 v117, v18, v25
  v_fmac_f32 v118, v18, v26
  v_mfma_f32_16x16x32_bf16 v[212:215], a[176:179], a[100:103], v[212:215]
  ds_read_b64_tr_b16 a[170:171], v5 offset:47104
  buffer_load_dwordx4 a[52:55], v1, s[8:11], s75 offen offset:1024 sc1
  v_mfma_f32_16x16x32_bf16 v[212:215], a[180:183], a[116:119], v[212:215]
  s_waitcnt vmcnt(32)
  s_barrier
  v_mfma_f32_16x16x32_bf16 v[208:211], a[180:183], a[112:115], v[208:211]
  ds_read_b64_tr_b16 a[180:181], v6 offset:49152
  v_fmac_f32 v119, v18, v27
  v_mfma_f32_16x16x32_bf16 v[208:211], a[176:179], a[96:99], v[208:211]
  s_waitcnt lgkmcnt(6)
  s_add_u32 s75, s75, 65536
  v_fmac_f32 v120, v20, v24
  v_mfma_f32_16x16x32_bf16 v[224:227], a[164:167], a[96:99], v[224:227]
  ds_read_b64_tr_b16 a[182:183], v6 offset:51200
  v_fmac_f32 v121, v20, v25
  v_mfma_f32_16x16x32_bf16 v[224:227], a[160:163], a[112:115], v[224:227]
  buffer_load_dwordx4 a[40:43], v1, s[8:11], s75 offen offset:0 sc1
  v_fmac_f32 v122, v20, v26
  v_fmac_f32 v123, v20, v27
  v_mfma_f32_16x16x32_bf16 v[228:231], a[160:163], a[116:119], v[228:231]
  ds_read_b64_tr_b16 a[176:177], v6 offset:53248
  v_fmac_f32 v124, v22, v24
  v_mfma_f32_16x16x32_bf16 v[228:231], a[164:167], a[100:103], v[228:231]
  v_fmac_f32 v125, v22, v25
  v_fmac_f32 v126, v22, v26
  v_mfma_f32_16x16x32_bf16 v[232:235], a[164:167], a[104:107], v[232:235]
  ds_read_b64_tr_b16 a[178:179], v6 offset:55296
  v_fmac_f32 v127, v22, v27
  v_mfma_f32_16x16x32_bf16 v[232:235], a[160:163], a[120:123], v[232:235]
  ds_read_b128 v[24:27], v12 offset:1024
  s_waitcnt lgkmcnt(9)
  v_mfma_f32_16x16x32_bf16 v[236:239], a[160:163], a[124:127], v[236:239]
  ds_read_b64_tr_b16 a[160:161], v6 offset:57344
  v_fmac_f32 v112, v17, v28
  v_mfma_f32_16x16x32_bf16 v[236:239], a[164:167], a[108:111], v[236:239]
  s_waitcnt lgkmcnt(6)
  buffer_load_dwordx4 a[56:59], v1, s[8:11], s75 offen offset:1024 sc1
  v_fmac_f32 v113, v17, v29
  v_mfma_f32_16x16x32_bf16 v[252:255], a[172:175], a[108:111], v[252:255]
  ds_read_b64_tr_b16 a[162:163], v6 offset:59392
  v_fmac_f32 v114, v17, v30
  v_mfma_f32_16x16x32_bf16 v[252:255], a[168:171], a[124:127], v[252:255]
  s_add_u32 s75, s75, 65536
  v_fmac_f32 v115, v17, v31
  v_fmac_f32 v116, v19, v28
  v_mfma_f32_16x16x32_bf16 v[248:251], a[168:171], a[120:123], v[248:251]
  ds_read_b64_tr_b16 a[164:165], v6 offset:61440
  v_fmac_f32 v117, v19, v29
  v_mfma_f32_16x16x32_bf16 v[248:251], a[172:175], a[104:107], v[248:251]
  buffer_load_dwordx4 a[44:47], v1, s[8:11], s75 offen offset:0 sc1
  v_fmac_f32 v118, v19, v30
  v_fmac_f32 v119, v19, v31
  v_mfma_f32_16x16x32_bf16 v[244:247], a[172:175], a[100:103], v[244:247]
  ds_read_b64_tr_b16 a[166:167], v6 offset:63488
  v_fmac_f32 v120, v21, v28
  v_mfma_f32_16x16x32_bf16 v[244:247], a[168:171], a[116:119], v[244:247]
  v_fmac_f32 v121, v21, v29
  v_fmac_f32 v122, v21, v30
  v_mfma_f32_16x16x32_bf16 v[240:243], a[168:171], a[112:115], v[240:243]
  ds_read_b64_tr_b16 a[168:169], v7 offset:49152
  v_fmac_f32 v123, v21, v31
  v_mfma_f32_16x16x32_bf16 v[240:243], a[172:175], a[96:99], v[240:243]
  s_waitcnt vmcnt(27) lgkmcnt(6)
  v_fmac_f32 v124, v23, v28
  v_fmac_f32 v125, v23, v29
  v_mfma_f32_16x16x32_bf16 v[64:67], a[180:183], a[128:131], v[64:67]
  ds_read_b64_tr_b16 a[170:171], v7 offset:51200
  v_fmac_f32 v126, v23, v30
  v_mfma_f32_16x16x32_bf16 v[64:67], a[176:179], a[144:147], v[64:67]
  buffer_load_dwordx4 a[60:63], v1, s[8:11], s75 offen offset:1024 sc1
  v_fmac_f32 v127, v23, v31
  v_mfma_f32_16x16x32_bf16 v[68:71], a[176:179], a[148:151], v[68:71]
  ds_read_b64_tr_b16 a[172:173], v7 offset:53248
  v_mfma_f32_16x16x32_bf16 v[68:71], a[180:183], a[132:135], v[68:71]
  s_mov_b32 s68, 5505024
  s_add_u32 s76, s57, 24576
  s_add_u32 m0, s45, 98304
  ds_read_b128 v[28:31], v12 offset:1536
  v_mfma_f32_16x16x32_bf16 v[72:75], a[180:183], a[136:139], v[72:75]
  ds_read_b64_tr_b16 a[174:175], v7 offset:55296
  s_waitcnt lgkmcnt(9)
  v_mfma_f32_16x16x32_bf16 v[72:75], a[176:179], a[152:155], v[72:75]
  buffer_load_dwordx4 v11, s[28:31], s68 offen lds
  v_fmac_f32 v144, v16, v24
  v_fmac_f32 v145, v16, v25
  v_mfma_f32_16x16x32_bf16 v[76:79], a[176:179], a[156:159], v[76:79]
  ds_read_b64_tr_b16 a[176:177], v7 offset:57344
  v_fmac_f32 v146, v16, v26
  v_mfma_f32_16x16x32_bf16 v[76:79], a[180:183], a[140:143], v[76:79]
  s_waitcnt lgkmcnt(6)
  v_fmac_f32 v147, v16, v27
  v_fmac_f32 v148, v18, v24
  v_mfma_f32_16x16x32_bf16 v[92:95], a[160:163], a[140:143], v[92:95]
  ds_read_b64_tr_b16 a[178:179], v7 offset:59392
  v_fmac_f32 v149, v18, v25
  v_mfma_f32_16x16x32_bf16 v[92:95], a[164:167], a[156:159], v[92:95]
  s_add_u32 m0, s45, 106496
  v_fmac_f32 v150, v18, v26
  v_fmac_f32 v151, v18, v27
  v_mfma_f32_16x16x32_bf16 v[88:91], a[164:167], a[152:155], v[88:91]
  ds_read_b64_tr_b16 a[180:181], v7 offset:61440
  v_fmac_f32 v152, v20, v24
  v_mfma_f32_16x16x32_bf16 v[88:91], a[160:163], a[136:139], v[88:91]
  buffer_load_dwordx4 v11, s[32:35], s68 offen lds
  v_fmac_f32 v153, v20, v25
  v_fmac_f32 v154, v20, v26
  v_mfma_f32_16x16x32_bf16 v[84:87], a[160:163], a[132:135], v[84:87]
  ds_read_b64_tr_b16 a[182:183], v7 offset:63488
  v_fmac_f32 v155, v20, v27
  v_mfma_f32_16x16x32_bf16 v[84:87], a[164:167], a[148:151], v[84:87]
  s_add_u32 m0, s45, 102400
  s_add_u32 s61, s68, 229376
  v_fmac_f32 v156, v22, v24
  v_mfma_f32_16x16x32_bf16 v[80:83], a[164:167], a[144:147], v[80:83]
  ds_read_b64_tr_b16 a[164:165], v8 offset:49152
  v_fmac_f32 v157, v22, v25
  v_mfma_f32_16x16x32_bf16 v[80:83], a[160:163], a[128:131], v[80:83]
  s_waitcnt lgkmcnt(5)
  buffer_load_dwordx4 v11, s[28:31], s61 offen lds
  v_fmac_f32 v158, v22, v26
  v_mfma_f32_16x16x32_bf16 v[96:99], a[168:171], a[128:131], v[96:99]
  ds_read_b64_tr_b16 a[166:167], v8 offset:51200
  v_fmac_f32 v159, v22, v27
  v_mfma_f32_16x16x32_bf16 v[96:99], a[172:175], a[144:147], v[96:99]
  ds_read_b128 v[24:27], v12 offset:64
  s_waitcnt lgkmcnt(8)
  v_mfma_f32_16x16x32_bf16 v[100:103], a[172:175], a[148:151], v[100:103]
  ds_read_b64_tr_b16 a[160:161], v8 offset:53248
  v_fmac_f32 v144, v17, v28
  v_mfma_f32_16x16x32_bf16 v[100:103], a[168:171], a[132:135], v[100:103]
  s_add_u32 m0, s45, 110592
  s_add_u32 s61, s68, 229376
  v_fmac_f32 v145, v17, v29
  v_mfma_f32_16x16x32_bf16 v[104:107], a[168:171], a[136:139], v[104:107]
  ds_read_b64_tr_b16 a[162:163], v8 offset:55296
  v_fmac_f32 v146, v17, v30
  v_mfma_f32_16x16x32_bf16 v[104:107], a[172:175], a[152:155], v[104:107]
  buffer_load_dwordx4 v11, s[32:35], s61 offen lds
  v_fmac_f32 v147, v17, v31
  v_fmac_f32 v148, v19, v28
  v_mfma_f32_16x16x32_bf16 v[108:111], a[172:175], a[156:159], v[108:111]
  ds_read_b64_tr_b16 a[172:173], v8 offset:57344
  v_fmac_f32 v149, v19, v29
  v_mfma_f32_16x16x32_bf16 v[108:111], a[168:171], a[140:143], v[108:111]
  s_waitcnt lgkmcnt(6)
  s_add_u32 s62, s92, 0
  v_fmac_f32 v150, v19, v30
  v_mfma_f32_16x16x32_bf16 v[124:127], a[176:179], a[140:143], v[124:127]
  ds_read_b64_tr_b16 a[174:175], v8 offset:59392
  v_fmac_f32 v151, v19, v31
  v_mfma_f32_16x16x32_bf16 v[124:127], a[180:183], a[156:159], v[124:127]
  buffer_load_dword a253, v13, s[36:39], s62 offen
  v_fmac_f32 v152, v21, v28
  v_fmac_f32 v153, v21, v29
  v_mfma_f32_16x16x32_bf16 v[120:123], a[180:183], a[152:155], v[120:123]
  ds_read_b64_tr_b16 a[168:169], v8 offset:61440
  v_fmac_f32 v154, v21, v30
  v_mfma_f32_16x16x32_bf16 v[120:123], a[176:179], a[136:139], v[120:123]
  v_fmac_f32 v155, v21, v31
  v_fmac_f32 v156, v23, v28
  v_mfma_f32_16x16x32_bf16 v[116:119], a[176:179], a[132:135], v[116:119]
  ds_read_b64_tr_b16 a[170:171], v8 offset:63488
  v_fmac_f32 v157, v23, v29
  v_mfma_f32_16x16x32_bf16 v[116:119], a[180:183], a[148:151], v[116:119]
  v_fmac_f32 v158, v23, v30
  v_fmac_f32 v159, v23, v31
  v_mfma_f32_16x16x32_bf16 v[112:115], a[180:183], a[144:147], v[112:115]
  ds_read_b64_tr_b16 a[180:181], v2 offset:49152
  v_mfma_f32_16x16x32_bf16 v[112:115], a[176:179], a[128:131], v[112:115]
  s_waitcnt lgkmcnt(5)
  ds_read_b128 v[28:31], v12 offset:1088
  v_mfma_f32_16x16x32_bf16 v[32:35], a[164:167], a[128:131], v[32:35]
  ds_read_b64_tr_b16 a[182:183], v2 offset:51200
  s_waitcnt lgkmcnt(9)
  v_mfma_f32_16x16x32_bf16 v[32:35], a[160:163], a[144:147], v[32:35]
  v_fmac_f32 v160, v16, v24
  v_fmac_f32 v161, v16, v25
  v_mfma_f32_16x16x32_bf16 v[36:39], a[160:163], a[148:151], v[36:39]
  ds_read_b64_tr_b16 a[176:177], v2 offset:53248
  v_fmac_f32 v162, v16, v26
  v_mfma_f32_16x16x32_bf16 v[36:39], a[164:167], a[132:135], v[36:39]
  buffer_load_dwordx4 a[64:67], v1, s[8:11], s76 offen offset:0 sc1
  v_fmac_f32 v163, v16, v27
  v_fmac_f32 v164, v18, v24
  v_mfma_f32_16x16x32_bf16 v[40:43], a[164:167], a[136:139], v[40:43]
  ds_read_b64_tr_b16 a[178:179], v2 offset:55296
  v_fmac_f32 v165, v18, v25
  v_mfma_f32_16x16x32_bf16 v[40:43], a[160:163], a[152:155], v[40:43]
  v_fmac_f32 v166, v18, v26
  v_fmac_f32 v167, v18, v27
  v_mfma_f32_16x16x32_bf16 v[44:47], a[160:163], a[156:159], v[44:47]
  ds_read_b64_tr_b16 a[160:161], v2 offset:57344
  v_fmac_f32 v168, v20, v24
  v_mfma_f32_16x16x32_bf16 v[44:47], a[164:167], a[140:143], v[44:47]
  s_waitcnt lgkmcnt(6)
  v_fmac_f32 v169, v20, v25
  v_fmac_f32 v170, v20, v26
  v_mfma_f32_16x16x32_bf16 v[60:63], a[172:175], a[140:143], v[60:63]
  ds_read_b64_tr_b16 a[162:163], v2 offset:59392
  v_fmac_f32 v171, v20, v27
  v_mfma_f32_16x16x32_bf16 v[60:63], a[168:171], a[156:159], v[60:63]
  buffer_load_dwordx4 a[80:83], v1, s[8:11], s76 offen offset:1024 sc1
  v_fmac_f32 v172, v22, v24
  v_fmac_f32 v173, v22, v25
  v_mfma_f32_16x16x32_bf16 v[56:59], a[168:171], a[152:155], v[56:59]
  ds_read_b64_tr_b16 a[164:165], v2 offset:61440
  v_fmac_f32 v174, v22, v26
  v_mfma_f32_16x16x32_bf16 v[56:59], a[172:175], a[136:139], v[56:59]
  s_add_u32 s76, s76, 65536
  v_fmac_f32 v175, v22, v27
  v_mfma_f32_16x16x32_bf16 v[52:55], a[172:175], a[132:135], v[52:55]
  ds_read_b64_tr_b16 a[166:167], v2 offset:63488
  v_mfma_f32_16x16x32_bf16 v[52:55], a[168:171], a[148:151], v[52:55]
  buffer_load_dwordx4 a[68:71], v1, s[8:11], s76 offen offset:0 sc1
  ds_read_b128 v[24:27], v12 offset:128
  v_mfma_f32_16x16x32_bf16 v[48:51], a[168:171], a[144:147], v[48:51]
  ds_read_b64_tr_b16 a[168:169], v3 offset:49152
  s_waitcnt lgkmcnt(9)
  v_mfma_f32_16x16x32_bf16 v[48:51], a[172:175], a[128:131], v[48:51]
  s_waitcnt lgkmcnt(6)
  v_fmac_f32 v176, v16, v28
  v_fmac_f32 v177, v16, v29
  v_mfma_f32_16x16x32_bf16 v[128:131], a[180:183], a[128:131], v[128:131]
  ds_read_b64_tr_b16 a[170:171], v3 offset:51200
  v_fmac_f32 v178, v16, v30
  v_mfma_f32_16x16x32_bf16 v[128:131], a[176:179], a[144:147], v[128:131]
  v_fmac_f32 v179, v16, v31
  v_fmac_f32 v180, v18, v28
  v_mfma_f32_16x16x32_bf16 v[132:135], a[176:179], a[148:151], v[132:135]
  ds_read_b64_tr_b16 a[172:173], v3 offset:53248
  v_fmac_f32 v181, v18, v29
  v_mfma_f32_16x16x32_bf16 v[132:135], a[180:183], a[132:135], v[132:135]
  buffer_load_dwordx4 a[84:87], v1, s[8:11], s76 offen offset:1024 sc1
  v_fmac_f32 v182, v18, v30
  v_fmac_f32 v183, v18, v31
  v_mfma_f32_16x16x32_bf16 v[136:139], a[180:183], a[136:139], v[136:139]
  ds_read_b64_tr_b16 a[174:175], v3 offset:55296
  v_fmac_f32 v184, v20, v28
  v_mfma_f32_16x16x32_bf16 v[136:139], a[176:179], a[152:155], v[136:139]
  s_add_u32 s76, s76, 65536
  v_fmac_f32 v185, v20, v29
  v_fmac_f32 v186, v20, v30
  v_mfma_f32_16x16x32_bf16 v[140:143], a[176:179], a[156:159], v[140:143]
  ds_read_b64_tr_b16 a[176:177], v3 offset:57344
  v_fmac_f32 v187, v20, v31
  v_mfma_f32_16x16x32_bf16 v[140:143], a[180:183], a[140:143], v[140:143]
  s_waitcnt lgkmcnt(6)
  buffer_load_dwordx4 a[72:75], v1, s[8:11], s76 offen offset:0 sc1
  v_fmac_f32 v188, v22, v28
  v_mfma_f32_16x16x32_bf16 v[156:159], a[160:163], a[140:143], v[156:159]
  ds_read_b64_tr_b16 a[178:179], v3 offset:59392
  v_fmac_f32 v189, v22, v29
  v_mfma_f32_16x16x32_bf16 v[156:159], a[164:167], a[156:159], v[156:159]
  v_fmac_f32 v190, v22, v30
  v_fmac_f32 v191, v22, v31
  v_mfma_f32_16x16x32_bf16 v[152:155], a[164:167], a[152:155], v[152:155]
  ds_read_b64_tr_b16 a[180:181], v3 offset:61440
  v_mfma_f32_16x16x32_bf16 v[152:155], a[160:163], a[136:139], v[152:155]
  ds_read_b128 v[28:31], v12 offset:192
  s_waitcnt lgkmcnt(8)
  v_mfma_f32_16x16x32_bf16 v[148:151], a[160:163], a[132:135], v[148:151]
  ds_read_b64_tr_b16 a[182:183], v3 offset:63488
  v_fmac_f32 v192, v16, v24
  v_mfma_f32_16x16x32_bf16 v[148:151], a[164:167], a[148:151], v[148:151]
  buffer_load_dwordx4 a[88:91], v1, s[8:11], s76 offen offset:1024 sc1
  v_fmac_f32 v193, v16, v25
  v_fmac_f32 v194, v16, v26
  v_mfma_f32_16x16x32_bf16 v[144:147], a[164:167], a[144:147], v[144:147]
  ds_read_b64_tr_b16 a[164:165], v4 offset:49152
  v_fmac_f32 v195, v16, v27
  v_mfma_f32_16x16x32_bf16 v[144:147], a[160:163], a[128:131], v[144:147]
  s_waitcnt lgkmcnt(6)
  s_add_u32 s76, s76, 65536
  v_fmac_f32 v196, v18, v24
  v_mfma_f32_16x16x32_bf16 v[160:163], a[168:171], a[128:131], v[160:163]
  ds_read_b64_tr_b16 a[166:167], v4 offset:51200
  v_fmac_f32 v197, v18, v25
  v_mfma_f32_16x16x32_bf16 v[160:163], a[172:175], a[144:147], v[160:163]
  buffer_load_dwordx4 a[76:79], v1, s[8:11], s76 offen offset:0 sc1
  v_fmac_f32 v198, v18, v26
  v_fmac_f32 v199, v18, v27
  v_mfma_f32_16x16x32_bf16 v[164:167], a[172:175], a[148:151], v[164:167]
HOP12:
  s_cbranch_execz WRET0
  ds_read_b64_tr_b16 a[160:161], v4 offset:53248
  v_fmac_f32 v200, v20, v24
  v_mfma_f32_16x16x32_bf16 v[164:167], a[168:171], a[132:135], v[164:167]
  v_fmac_f32 v201, v20, v25
  v_fmac_f32 v202, v20, v26
  v_mfma_f32_16x16x32_bf16 v[168:171], a[168:171], a[136:139], v[168:171]
  ds_read_b64_tr_b16 a[162:163], v4 offset:55296
  v_fmac_f32 v203, v20, v27
  v_mfma_f32_16x16x32_bf16 v[168:171], a[172:175], a[152:155], v[168:171]
  v_fmac_f32 v204, v22, v24
  v_fmac_f32 v205, v22, v25
  v_mfma_f32_16x16x32_bf16 v[172:175], a[172:175], a[156:159], v[172:175]
  ds_read_b64_tr_b16 a[172:173], v4 offset:57344
  v_fmac_f32 v206, v22, v26
  v_mfma_f32_16x16x32_bf16 v[172:175], a[168:171], a[140:143], v[172:175]
  s_waitcnt lgkmcnt(5)
  buffer_load_dwordx4 a[92:95], v1, s[8:11], s76 offen offset:1024 sc1
  v_fmac_f32 v207, v22, v27
  v_mfma_f32_16x16x32_bf16 v[188:191], a[176:179], a[140:143], v[188:191]
  ds_read_b64_tr_b16 a[174:175], v4 offset:59392
  v_mfma_f32_16x16x32_bf16 v[188:191], a[180:183], a[156:159], v[188:191]
  s_mov_b32 s69, 5963776
  s_add_u32 s77, s57, 26624
  ds_read_b128 v[24:27], v12 offset:1600
  v_mfma_f32_16x16x32_bf16 v[184:187], a[180:183], a[152:155], v[184:187]
  ds_read_b64_tr_b16 a[168:169], v4 offset:61440
  s_waitcnt lgkmcnt(9)
  v_mfma_f32_16x16x32_bf16 v[184:187], a[176:179], a[136:139], v[184:187]
  buffer_load_dwordx4 a[96:99], v1, s[8:11], s77 offen offset:0 sc1
  v_fmac_f32 v224, v16, v28
  v_fmac_f32 v225, v16, v29
  v_mfma_f32_16x16x32_bf16 v[180:183], a[176:179], a[132:135], v[180:183]
  ds_read_b64_tr_b16 a[170:171], v4 offset:63488
  v_fmac_f32 v226, v16, v30
  v_mfma_f32_16x16x32_bf16 v[180:183], a[180:183], a[148:151], v[180:183]
  v_fmac_f32 v227, v16, v31
  v_fmac_f32 v228, v18, v28
  v_mfma_f32_16x16x32_bf16 v[176:179], a[180:183], a[144:147], v[176:179]
  ds_read_b64_tr_b16 a[180:181], v5 offset:49152
  v_fmac_f32 v229, v18, v29
  v_mfma_f32_16x16x32_bf16 v[176:179], a[176:179], a[128:131], v[176:179]
  s_waitcnt lgkmcnt(6)
  v_fmac_f32 v230, v18, v30
  v_fmac_f32 v231, v18, v31
  v_mfma_f32_16x16x32_bf16 v[192:195], a[164:167], a[128:131], v[192:195]
  ds_read_b64_tr_b16 a[182:183], v5 offset:51200
  v_fmac_f32 v232, v20, v28
  v_mfma_f32_16x16x32_bf16 v[192:195], a[160:163], a[144:147], v[192:195]
  buffer_load_dwordx4 a[112:115], v1, s[8:11], s77 offen offset:1024 sc1
  v_fmac_f32 v233, v20, v29
  v_fmac_f32 v234, v20, v30
  v_mfma_f32_16x16x32_bf16 v[196:199], a[160:163], a[148:151], v[196:199]
  ds_read_b64_tr_b16 a[176:177], v5 offset:53248
  v_fmac_f32 v235, v20, v31
  v_mfma_f32_16x16x32_bf16 v[196:199], a[164:167], a[132:135], v[196:199]
  s_add_u32 s77, s77, 65536
  v_fmac_f32 v236, v22, v28
  v_fmac_f32 v237, v22, v29
  v_mfma_f32_16x16x32_bf16 v[200:203], a[164:167], a[136:139], v[200:203]
  ds_read_b64_tr_b16 a[178:179], v5 offset:55296
  v_fmac_f32 v238, v22, v30
  v_mfma_f32_16x16x32_bf16 v[200:203], a[160:163], a[152:155], v[200:203]
  buffer_load_dwordx4 a[100:103], v1, s[8:11], s77 offen offset:0 sc1
  v_fmac_f32 v239, v22, v31
  v_mfma_f32_16x16x32_bf16 v[204:207], a[160:163], a[156:159], v[204:207]
  ds_read_b64_tr_b16 a[160:161], v5 offset:57344
  v_mfma_f32_16x16x32_bf16 v[204:207], a[164:167], a[140:143], v[204:207]
  s_waitcnt lgkmcnt(5)
  ds_read_b128 v[28:31], v12 offset:1152
  v_mfma_f32_16x16x32_bf16 v[220:223], a[172:175], a[140:143], v[220:223]
  ds_read_b64_tr_b16 a[162:163], v5 offset:59392
  s_waitcnt lgkmcnt(9)
  v_mfma_f32_16x16x32_bf16 v[220:223], a[168:171], a[156:159], v[220:223]
  v_fmac_f32 v176, v17, v24
  v_fmac_f32 v177, v17, v25
  v_mfma_f32_16x16x32_bf16 v[216:219], a[168:171], a[152:155], v[216:219]
  ds_read_b64_tr_b16 a[164:165], v5 offset:61440
  v_fmac_f32 v178, v17, v26
  v_mfma_f32_16x16x32_bf16 v[216:219], a[172:175], a[136:139], v[216:219]
  buffer_load_dwordx4 a[116:119], v1, s[8:11], s77 offen offset:1024 sc1
  v_fmac_f32 v179, v17, v27
  v_fmac_f32 v180, v19, v24
  v_mfma_f32_16x16x32_bf16 v[212:215], a[172:175], a[132:135], v[212:215]
  ds_read_b64_tr_b16 a[166:167], v5 offset:63488
  v_fmac_f32 v181, v19, v25
  v_mfma_f32_16x16x32_bf16 v[212:215], a[168:171], a[148:151], v[212:215]
  s_waitcnt vmcnt(33)
  s_barrier
  v_mfma_f32_16x16x32_bf16 v[208:211], a[168:171], a[144:147], v[208:211]
  ds_read_b64_tr_b16 a[168:169], v6 offset:16384
  s_add_u32 s62, s92, 2048
  v_mfma_f32_16x16x32_bf16 v[208:211], a[172:175], a[128:131], v[208:211]
  s_waitcnt lgkmcnt(6)
  buffer_load_dword a253, v13, s[36:39], s62 offen
  v_fmac_f32 v182, v19, v26
  v_mfma_f32_16x16x32_bf16 v[224:227], a[180:183], a[128:131], v[224:227]
  ds_read_b64_tr_b16 a[170:171], v6 offset:18432
  v_fmac_f32 v183, v19, v27
  v_mfma_f32_16x16x32_bf16 v[224:227], a[176:179], a[144:147], v[224:227]
  v_fmac_f32 v184, v21, v24
  v_fmac_f32 v185, v21, v25
  v_mfma_f32_16x16x32_bf16 v[228:231], a[176:179], a[148:151], v[228:231]
  ds_read_b64_tr_b16 a[172:173], v6 offset:20480
  v_fmac_f32 v186, v21, v26
  v_mfma_f32_16x16x32_bf16 v[228:231], a[180:183], a[132:135], v[228:231]
  v_fmac_f32 v187, v21, v27
  v_fmac_f32 v188, v23, v24
  v_mfma_f32_16x16x32_bf16 v[232:235], a[180:183], a[136:139], v[232:235]
  ds_read_b64_tr_b16 a[174:175], v6 offset:22528
  v_fmac_f32 v189, v23, v25
  v_mfma_f32_16x16x32_bf16 v[232:235], a[176:179], a[152:155], v[232:235]
  v_fmac_f32 v190, v23, v26
  v_fmac_f32 v191, v23, v27
  v_mfma_f32_16x16x32_bf16 v[236:239], a[176:179], a[156:159], v[236:239]
  ds_read_b64_tr_b16 a[176:177], v6 offset:24576
  v_mfma_f32_16x16x32_bf16 v[236:239], a[180:183], a[140:143], v[236:239]
  s_waitcnt lgkmcnt(5)
  s_add_u32 m0, s45, 114688
  v_mfma_f32_16x16x32_bf16 v[252:255], a[160:163], a[140:143], v[252:255]
  ds_read_b64_tr_b16 a[178:179], v6 offset:26624
  v_mfma_f32_16x16x32_bf16 v[252:255], a[164:167], a[156:159], v[252:255]
  buffer_load_dwordx4 v11, s[28:31], s69 offen lds
  ds_read_b128 v[24:27], v12 offset:1664
  v_mfma_f32_16x16x32_bf16 v[248:251], a[164:167], a[152:155], v[248:251]
  ds_read_b64_tr_b16 a[180:181], v6 offset:28672
  s_waitcnt lgkmcnt(11)
  v_mfma_f32_16x16x32_bf16 v[248:251], a[160:163], a[136:139], v[248:251]
  v_fmac_f32 v208, v16, v28
  v_fmac_f32 v209, v16, v29
  v_mfma_f32_16x16x32_bf16 v[244:247], a[160:163], a[132:135], v[244:247]
  ds_read_b64_tr_b16 a[182:183], v6 offset:30720
  v_fmac_f32 v210, v16, v30
  v_mfma_f32_16x16x32_bf16 v[244:247], a[164:167], a[148:151], v[244:247]
  s_add_u32 m0, s45, 122880
  v_fmac_f32 v211, v16, v31
  v_fmac_f32 v212, v18, v28
  v_mfma_f32_16x16x32_bf16 v[240:243], a[164:167], a[144:147], v[240:243]
  ds_read_b64_tr_b16 a[164:165], v7 offset:16384
  v_fmac_f32 v213, v18, v29
  v_mfma_f32_16x16x32_bf16 v[240:243], a[160:163], a[128:131], v[240:243]
  s_waitcnt vmcnt(27) lgkmcnt(6)
  buffer_load_dwordx4 v11, s[32:35], s69 offen lds
  v_fmac_f32 v214, v18, v30
  v_mfma_f32_16x16x32_bf16 v[64:67], a[168:171], a[0:3], v[64:67]
  ds_read_b64_tr_b16 a[166:167], v7 offset:18432
  v_fmac_f32 v215, v18, v31
  v_mfma_f32_16x16x32_bf16 v[64:67], a[172:175], a[16:19], v[64:67]
  s_add_u32 m0, s45, 118784
  s_add_u32 s61, s69, 229376
  v_fmac_f32 v216, v20, v28
  v_mfma_f32_16x16x32_bf16 v[68:71], a[172:175], a[20:23], v[68:71]
  ds_read_b64_tr_b16 a[160:161], v7 offset:20480
  v_fmac_f32 v217, v20, v29
  v_mfma_f32_16x16x32_bf16 v[68:71], a[168:171], a[4:7], v[68:71]
  buffer_load_dwordx4 v11, s[28:31], s61 offen lds
  v_fmac_f32 v218, v20, v30
  v_fmac_f32 v219, v20, v31
  v_mfma_f32_16x16x32_bf16 v[72:75], a[168:171], a[8:11], v[72:75]
  ds_read_b64_tr_b16 a[162:163], v7 offset:22528
  v_fmac_f32 v220, v22, v28
  v_mfma_f32_16x16x32_bf16 v[72:75], a[172:175], a[24:27], v[72:75]
  v_fmac_f32 v221, v22, v29
  v_fmac_f32 v222, v22, v30
  v_mfma_f32_16x16x32_bf16 v[76:79], a[172:175], a[28:31], v[76:79]
  ds_read_b64_tr_b16 a[172:173], v7 offset:24576
  v_fmac_f32 v223, v22, v31
  v_mfma_f32_16x16x32_bf16 v[76:79], a[168:171], a[12:15], v[76:79]
  s_waitcnt lgkmcnt(5)
  s_add_u32 m0, s45, 126976
  s_add_u32 s61, s69, 229376
  v_mfma_f32_16x16x32_bf16 v[92:95], a[176:179], a[12:15], v[92:95]
  ds_read_b64_tr_b16 a[174:175], v7 offset:26624
  v_mfma_f32_16x16x32_bf16 v[92:95], a[180:183], a[28:31], v[92:95]
  buffer_load_dwordx4 v11, s[32:35], s61 offen lds
  ds_read_b128 v[28:31], v12 offset:1216
  v_mfma_f32_16x16x32_bf16 v[88:91], a[180:183], a[24:27], v[88:91]
  ds_read_b64_tr_b16 a[168:169], v7 offset:28672
  s_waitcnt lgkmcnt(10)
  v_mfma_f32_16x16x32_bf16 v[88:91], a[176:179], a[8:11], v[88:91]
  s_add_u32 s77, s77, 65536
  v_fmac_f32 v208, v17, v24
  v_fmac_f32 v209, v17, v25
  v_mfma_f32_16x16x32_bf16 v[84:87], a[176:179], a[4:7], v[84:87]
  ds_read_b64_tr_b16 a[170:171], v7 offset:30720
  v_fmac_f32 v210, v17, v26
  v_mfma_f32_16x16x32_bf16 v[84:87], a[180:183], a[20:23], v[84:87]
  buffer_load_dwordx4 a[104:107], v1, s[8:11], s77 offen offset:0 sc1
  v_fmac_f32 v211, v17, v27
  v_fmac_f32 v212, v19, v24
  v_mfma_f32_16x16x32_bf16 v[80:83], a[180:183], a[16:19], v[80:83]
  ds_read_b64_tr_b16 a[180:181], v8 offset:16384
  v_fmac_f32 v213, v19, v25
  v_mfma_f32_16x16x32_bf16 v[80:83], a[176:179], a[0:3], v[80:83]
  s_waitcnt lgkmcnt(6)
  v_fmac_f32 v214, v19, v26
  v_fmac_f32 v215, v19, v27
  v_mfma_f32_16x16x32_bf16 v[96:99], a[164:167], a[0:3], v[96:99]
  ds_read_b64_tr_b16 a[182:183], v8 offset:18432
  v_fmac_f32 v216, v21, v24
  v_mfma_f32_16x16x32_bf16 v[96:99], a[160:163], a[16:19], v[96:99]
  v_fmac_f32 v217, v21, v25
  v_fmac_f32 v218, v21, v26
  v_mfma_f32_16x16x32_bf16 v[100:103], a[160:163], a[20:23], v[100:103]
  ds_read_b64_tr_b16 a[176:177], v8 offset:20480
  v_fmac_f32 v219, v21, v27
  v_mfma_f32_16x16x32_bf16 v[100:103], a[164:167], a[4:7], v[100:103]
  buffer_load_dwordx4 a[120:123], v1, s[8:11], s77 offen offset:1024 sc1
  v_fmac_f32 v220, v23, v24
  v_fmac_f32 v221, v23, v25
  v_mfma_f32_16x16x32_bf16 v[104:107], a[164:167], a[8:11], v[104:107]
  ds_read_b64_tr_b16 a[178:179], v8 offset:22528
  v_fmac_f32 v222, v23, v26
  v_mfma_f32_16x16x32_bf16 v[104:107], a[160:163], a[24:27], v[104:107]
  s_add_u32 s77, s77, 65536
  v_fmac_f32 v223, v23, v27
  v_mfma_f32_16x16x32_bf16 v[108:111], a[160:163], a[28:31], v[108:111]
  ds_read_b64_tr_b16 a[160:161], v8 offset:24576
  v_mfma_f32_16x16x32_bf16 v[108:111], a[164:167], a[12:15], v[108:111]
  s_waitcnt lgkmcnt(5)
  buffer_load_dwordx4 a[108:111], v1, s[8:11], s77 offen offset:0 sc1
  v_mfma_f32_16x16x32_bf16 v[124:127], a[172:175], a[12:15], v[124:127]
  ds_read_b64_tr_b16 a[162:163], v8 offset:26624
  v_mfma_f32_16x16x32_bf16 v[124:127], a[168:171], a[28:31], v[124:127]
  ds_read_b128 v[24:27], v12 offset:1728
  s_waitcnt lgkmcnt(9)
  v_mfma_f32_16x16x32_bf16 v[120:123], a[168:171], a[24:27], v[120:123]
  ds_read_b64_tr_b16 a[164:165], v8 offset:28672
  v_fmac_f32 v240, v16, v28
  v_mfma_f32_16x16x32_bf16 v[120:123], a[172:175], a[8:11], v[120:123]
  v_fmac_f32 v241, v16, v29
  v_fmac_f32 v242, v16, v30
  v_mfma_f32_16x16x32_bf16 v[116:119], a[172:175], a[4:7], v[116:119]
  ds_read_b64_tr_b16 a[166:167], v8 offset:30720
  v_fmac_f32 v243, v16, v31
  v_mfma_f32_16x16x32_bf16 v[116:119], a[168:171], a[20:23], v[116:119]
  buffer_load_dwordx4 a[124:127], v1, s[8:11], s77 offen offset:1024 sc1
  v_fmac_f32 v244, v18, v28
  v_fmac_f32 v245, v18, v29
  v_mfma_f32_16x16x32_bf16 v[112:115], a[168:171], a[16:19], v[112:115]
  ds_read_b64_tr_b16 a[168:169], v6 offset:0
  v_fmac_f32 v246, v18, v30
  v_mfma_f32_16x16x32_bf16 v[112:115], a[172:175], a[0:3], v[112:115]
  s_waitcnt lgkmcnt(6)
  s_mov_b32 s70, 6422528
  s_add_u32 s78, s57, 28672
  v_fmac_f32 v247, v18, v31
  v_mfma_f32_16x16x32_bf16 v[32:35], a[180:183], a[0:3], v[32:35]
  ds_read_b64_tr_b16 a[170:171], v6 offset:2048
  v_fmac_f32 v248, v20, v28
  v_mfma_f32_16x16x32_bf16 v[32:35], a[176:179], a[16:19], v[32:35]
  buffer_load_dwordx4 a[128:131], v1, s[8:11], s78 offen offset:0 sc1
  v_fmac_f32 v249, v20, v29
  v_fmac_f32 v250, v20, v30
  v_mfma_f32_16x16x32_bf16 v[36:39], a[176:179], a[20:23], v[36:39]
  ds_read_b64_tr_b16 a[172:173], v6 offset:4096
  v_fmac_f32 v251, v20, v31
  v_mfma_f32_16x16x32_bf16 v[36:39], a[180:183], a[4:7], v[36:39]
  v_fmac_f32 v252, v22, v28
  v_fmac_f32 v253, v22, v29
  v_mfma_f32_16x16x32_bf16 v[40:43], a[180:183], a[8:11], v[40:43]
  ds_read_b64_tr_b16 a[174:175], v6 offset:6144
  v_fmac_f32 v254, v22, v30
  v_mfma_f32_16x16x32_bf16 v[40:43], a[176:179], a[24:27], v[40:43]
  v_fmac_f32 v255, v22, v31
  v_mfma_f32_16x16x32_bf16 v[44:47], a[176:179], a[28:31], v[44:47]
  ds_read_b64_tr_b16 a[176:177], v6 offset:8192
  s_waitcnt lgkmcnt(7)
  v_mfma_f32_16x16x32_bf16 v[44:47], a[180:183], a[12:15], v[44:47]
  s_waitcnt lgkmcnt(5)
  buffer_load_dwordx4 a[144:147], v1, s[8:11], s78 offen offset:1024 sc1
  v_fmac_f32 v240, v17, v24
  v_mfma_f32_16x16x32_bf16 v[60:63], a[160:163], a[12:15], v[60:63]
  ds_read_b64_tr_b16 a[178:179], v6 offset:10240
  v_fmac_f32 v241, v17, v25
  v_mfma_f32_16x16x32_bf16 v[60:63], a[164:167], a[28:31], v[60:63]
  s_add_u32 s78, s78, 65536
  v_fmac_f32 v242, v17, v26
  v_fmac_f32 v243, v17, v27
  v_mfma_f32_16x16x32_bf16 v[56:59], a[164:167], a[24:27], v[56:59]
  ds_read_b64_tr_b16 a[180:181], v6 offset:12288
  v_fmac_f32 v244, v19, v24
  v_mfma_f32_16x16x32_bf16 v[56:59], a[160:163], a[8:11], v[56:59]
  buffer_load_dwordx4 a[132:135], v1, s[8:11], s78 offen offset:0 sc1
  v_fmac_f32 v245, v19, v25
  v_fmac_f32 v246, v19, v26
  v_mfma_f32_16x16x32_bf16 v[52:55], a[160:163], a[4:7], v[52:55]
  ds_read_b64_tr_b16 a[182:183], v6 offset:14336
  v_fmac_f32 v247, v19, v27
  v_mfma_f32_16x16x32_bf16 v[52:55], a[164:167], a[20:23], v[52:55]
  v_fmac_f32 v248, v21, v24
  v_fmac_f32 v249, v21, v25
  v_mfma_f32_16x16x32_bf16 v[48:51], a[164:167], a[16:19], v[48:51]
  ds_read_b64_tr_b16 a[164:165], v7 offset:0
  v_fmac_f32 v250, v21, v26
  v_mfma_f32_16x16x32_bf16 v[48:51], a[160:163], a[0:3], v[48:51]
  s_waitcnt vmcnt(29) lgkmcnt(5)
  v_fmac_f32 v251, v21, v27
  v_fmac_f32 v252, v23, v24
  v_mfma_f32_16x16x32_bf16 v[64:67], a[168:171], a[32:35], v[64:67]
  ds_read_b64_tr_b16 a[166:167], v7 offset:2048
  v_fmac_f32 v253, v23, v25
  v_mfma_f32_16x16x32_bf16 v[64:67], a[172:175], a[48:51], v[64:67]
  buffer_load_dwordx4 a[148:151], v1, s[8:11], s78 offen offset:1024 sc1
  v_fmac_f32 v254, v23, v26
  v_fmac_f32 v255, v23, v27
  v_mfma_f32_16x16x32_bf16 v[68:71], a[172:175], a[52:55], v[68:71]
  ds_read_b64_tr_b16 a[160:161], v7 offset:4096
  v_mfma_f32_16x16x32_bf16 v[68:71], a[168:171], a[36:39], v[68:71]
  s_add_u32 s62, s92, 4096
  ds_read_b128 v[28:31], v12 offset:896
  v_mfma_f32_16x16x32_bf16 v[72:75], a[168:171], a[40:43], v[72:75]
  ds_read_b64_tr_b16 a[162:163], v7 offset:6144
  v_mfma_f32_16x16x32_bf16 v[72:75], a[172:175], a[56:59], v[72:75]
  buffer_load_dword a253, v13, s[36:39], s62 offen
  v_rcp_f32 v16, v17
  v_mfma_f32_16x16x32_bf16 v[76:79], a[172:175], a[60:63], v[76:79]
  ds_read_b64_tr_b16 a[172:173], v7 offset:8192
  v_mfma_f32_16x16x32_bf16 v[76:79], a[168:171], a[44:47], v[76:79]
  s_waitcnt lgkmcnt(6)
  v_rcp_f32 v18, v19
  v_mfma_f32_16x16x32_bf16 v[92:95], a[176:179], a[44:47], v[92:95]
  ds_read_b64_tr_b16 a[174:175], v7 offset:10240
  v_mfma_f32_16x16x32_bf16 v[92:95], a[180:183], a[60:63], v[92:95]
  v_rcp_f32 v20, v21
  v_mfma_f32_16x16x32_bf16 v[88:91], a[180:183], a[56:59], v[88:91]
  ds_read_b64_tr_b16 a[168:169], v7 offset:12288
  v_mfma_f32_16x16x32_bf16 v[88:91], a[176:179], a[40:43], v[88:91]
  v_rcp_f32 v22, v23
  v_mfma_f32_16x16x32_bf16 v[84:87], a[176:179], a[36:39], v[84:87]
  ds_read_b64_tr_b16 a[170:171], v7 offset:14336
  v_mul_f32 v17, 0xbfb8aa3b, v17
  v_mfma_f32_16x16x32_bf16 v[84:87], a[180:183], a[52:55], v[84:87]
  s_add_u32 s78, s78, 65536
  v_mul_f32 v19, 0xbfb8aa3b, v19
  v_mul_f32 v21, 0xbfb8aa3b, v21
  v_mfma_f32_16x16x32_bf16 v[80:83], a[180:183], a[48:51], v[80:83]
  ds_read_b64_tr_b16 a[180:181], v8 offset:0
  v_mul_f32 v23, 0xbfb8aa3b, v23
  v_mfma_f32_16x16x32_bf16 v[80:83], a[176:179], a[32:35], v[80:83]
  s_waitcnt lgkmcnt(5)
  buffer_load_dwordx4 a[136:139], v1, s[8:11], s78 offen offset:0 sc1
  v_mul_f32 v16, 0xbfb8aa3b, v16
  v_mfma_f32_16x16x32_bf16 v[96:99], a[164:167], a[32:35], v[96:99]
  ds_read_b64_tr_b16 a[182:183], v8 offset:2048
  v_mul_f32 v18, 0xbfb8aa3b, v18
  v_mfma_f32_16x16x32_bf16 v[96:99], a[160:163], a[48:51], v[96:99]
  v_mul_f32 v20, 0xbfb8aa3b, v20
  v_mul_f32 v22, 0xbfb8aa3b, v22
  v_mfma_f32_16x16x32_bf16 v[100:103], a[160:163], a[52:55], v[100:103]
  ds_read_b64_tr_b16 a[176:177], v8 offset:4096
  v_mfma_f32_16x16x32_bf16 v[100:103], a[164:167], a[36:39], v[100:103]
  v_mfma_f32_16x16x32_bf16 v[104:107], a[164:167], a[40:43], v[104:107]
  ds_read_b64_tr_b16 a[178:179], v8 offset:6144
  v_mfma_f32_16x16x32_bf16 v[104:107], a[160:163], a[56:59], v[104:107]
  buffer_load_dwordx4 a[152:155], v1, s[8:11], s78 offen offset:1024 sc1
  v_mfma_f32_16x16x32_bf16 v[108:111], a[160:163], a[60:63], v[108:111]
  ds_read_b64_tr_b16 a[160:161], v8 offset:8192
  v_mfma_f32_16x16x32_bf16 v[108:111], a[164:167], a[44:47], v[108:111]
  s_waitcnt lgkmcnt(5)
  s_add_u32 s78, s78, 65536
  v_mfma_f32_16x16x32_bf16 v[124:127], a[172:175], a[44:47], v[124:127]
  ds_read_b64_tr_b16 a[162:163], v8 offset:10240
  v_mfma_f32_16x16x32_bf16 v[124:127], a[168:171], a[60:63], v[124:127]
  buffer_load_dwordx4 a[140:143], v1, s[8:11], s78 offen offset:0 sc1
  v_mfma_f32_16x16x32_bf16 v[120:123], a[168:171], a[56:59], v[120:123]
  ds_read_b64_tr_b16 a[164:165], v8 offset:12288
  v_mfma_f32_16x16x32_bf16 v[120:123], a[172:175], a[40:43], v[120:123]
  v_mfma_f32_16x16x32_bf16 v[116:119], a[172:175], a[36:39], v[116:119]
  ds_read_b64_tr_b16 a[166:167], v8 offset:14336
  v_mfma_f32_16x16x32_bf16 v[116:119], a[168:171], a[52:55], v[116:119]
  v_mfma_f32_16x16x32_bf16 v[112:115], a[168:171], a[48:51], v[112:115]
  ds_read_b64_tr_b16 a[168:169], v2 offset:16384
  v_mfma_f32_16x16x32_bf16 v[112:115], a[172:175], a[32:35], v[112:115]
  s_waitcnt lgkmcnt(5)
  buffer_load_dwordx4 a[156:159], v1, s[8:11], s78 offen offset:1024 sc1
  v_mfma_f32_16x16x32_bf16 v[32:35], a[180:183], a[32:35], v[32:35]
  ds_read_b64_tr_b16 a[170:171], v2 offset:18432
  v_mfma_f32_16x16x32_bf16 v[32:35], a[176:179], a[48:51], v[32:35]
  s_mov_b32 s71, 6881280
  s_add_u32 s79, s57, 30720
  v_mfma_f32_16x16x32_bf16 v[36:39], a[176:179], a[52:55], v[36:39]
  ds_read_b64_tr_b16 a[172:173], v2 offset:20480
  v_mfma_f32_16x16x32_bf16 v[36:39], a[180:183], a[36:39], v[36:39]
  buffer_load_dwordx4 a[188:191], v1, s[8:11], s79 offen offset:0 sc1
  v_mfma_f32_16x16x32_bf16 v[40:43], a[180:183], a[40:43], v[40:43]
  ds_read_b64_tr_b16 a[174:175], v2 offset:22528
  v_mfma_f32_16x16x32_bf16 v[40:43], a[176:179], a[56:59], v[40:43]
  v_mfma_f32_16x16x32_bf16 v[44:47], a[176:179], a[60:63], v[44:47]
  ds_read_b64_tr_b16 a[176:177], v2 offset:24576
  v_mfma_f32_16x16x32_bf16 v[44:47], a[180:183], a[44:47], v[44:47]
  s_waitcnt lgkmcnt(5)
  v_mfma_f32_16x16x32_bf16 v[60:63], a[160:163], a[44:47], v[60:63]
  ds_read_b64_tr_b16 a[178:179], v2 offset:26624
  s_barrier
  v_mfma_f32_16x16x32_bf16 v[60:63], a[164:167], a[60:63], v[60:63]
  buffer_load_dwordx4 a[204:207], v1, s[8:11], s79 offen offset:1024 sc1
  v_mfma_f32_16x16x32_bf16 v[56:59], a[164:167], a[56:59], v[56:59]
  ds_read_b64_tr_b16 a[180:181], v2 offset:28672
  v_mfma_f32_16x16x32_bf16 v[56:59], a[160:163], a[40:43], v[56:59]
  s_add_u32 m0, s45, 81920
  v_mfma_f32_16x16x32_bf16 v[52:55], a[160:163], a[36:39], v[52:55]
  ds_read_b64_tr_b16 a[182:183], v2 offset:30720
  v_mfma_f32_16x16x32_bf16 v[52:55], a[164:167], a[52:55], v[52:55]
  buffer_load_dwordx4 v11, s[28:31], s70 offen lds
  v_mfma_f32_16x16x32_bf16 v[48:51], a[164:167], a[48:51], v[48:51]
  ds_read_b64_tr_b16 a[164:165], v3 offset:16384
  v_mfma_f32_16x16x32_bf16 v[48:51], a[160:163], a[32:35], v[48:51]
  s_waitcnt lgkmcnt(5)
  v_mfma_f32_16x16x32_bf16 v[128:131], a[168:171], a[0:3], v[128:131]
  ds_read_b64_tr_b16 a[166:167], v3 offset:18432
  v_mfma_f32_16x16x32_bf16 v[128:131], a[172:175], a[16:19], v[128:131]
  s_add_u32 m0, s45, 90112
  v_mfma_f32_16x16x32_bf16 v[132:135], a[172:175], a[20:23], v[132:135]
  ds_read_b64_tr_b16 a[160:161], v3 offset:20480
  v_mfma_f32_16x16x32_bf16 v[132:135], a[168:171], a[4:7], v[132:135]
  buffer_load_dwordx4 v11, s[32:35], s70 offen lds
  v_mfma_f32_16x16x32_bf16 v[136:139], a[168:171], a[8:11], v[136:139]
  ds_read_b64_tr_b16 a[162:163], v3 offset:22528
  v_mfma_f32_16x16x32_bf16 v[136:139], a[172:175], a[24:27], v[136:139]
  s_add_u32 m0, s45, 86016
  s_add_u32 s61, s70, 229376
  v_mfma_f32_16x16x32_bf16 v[140:143], a[172:175], a[28:31], v[140:143]
  ds_read_b64_tr_b16 a[172:173], v3 offset:24576
  v_mfma_f32_16x16x32_bf16 v[140:143], a[168:171], a[12:15], v[140:143]
  s_waitcnt lgkmcnt(5)
  buffer_load_dwordx4 v11, s[28:31], s61 offen lds
  v_mfma_f32_16x16x32_bf16 v[156:159], a[176:179], a[12:15], v[156:159]
  ds_read_b64_tr_b16 a[174:175], v3 offset:26624
  v_mfma_f32_16x16x32_bf16 v[156:159], a[180:183], a[28:31], v[156:159]
  v_mfma_f32_16x16x32_bf16 v[152:155], a[180:183], a[24:27], v[152:155]
  ds_read_b64_tr_b16 a[168:169], v3 offset:28672
  v_mfma_f32_16x16x32_bf16 v[152:155], a[176:179], a[8:11], v[152:155]
  s_add_u32 m0, s45, 94208
  s_add_u32 s61, s70, 229376
  v_mfma_f32_16x16x32_bf16 v[148:151], a[176:179], a[4:7], v[148:151]
  ds_read_b64_tr_b16 a[170:171], v3 offset:30720
  v_mfma_f32_16x16x32_bf16 v[148:151], a[180:183], a[20:23], v[148:151]
  buffer_load_dwordx4 v11, s[32:35], s61 offen lds
  v_mfma_f32_16x16x32_bf16 v[144:147], a[180:183], a[16:19], v[144:147]
  ds_read_b64_tr_b16 a[180:181], v4 offset:16384
  v_mfma_f32_16x16x32_bf16 v[144:147], a[176:179], a[0:3], v[144:147]
  s_waitcnt lgkmcnt(5)
  s_add_u32 m0, s45, 65536
  v_mfma_f32_16x16x32_bf16 v[160:163], a[164:167], a[0:3], v[160:163]
  ds_read_b64_tr_b16 a[182:183], v4 offset:18432
  v_mfma_f32_16x16x32_bf16 v[160:163], a[160:163], a[16:19], v[160:163]
  buffer_load_dwordx4 v11, s[28:31], s71 offen lds
  v_mfma_f32_16x16x32_bf16 v[164:167], a[160:163], a[20:23], v[164:167]
  ds_read_b64_tr_b16 a[176:177], v4 offset:20480
  v_mfma_f32_16x16x32_bf16 v[164:167], a[164:167], a[4:7], v[164:167]
  v_mfma_f32_16x16x32_bf16 v[168:171], a[164:167], a[8:11], v[168:171]
  ds_read_b64_tr_b16 a[178:179], v4 offset:22528
  v_mfma_f32_16x16x32_bf16 v[168:171], a[160:163], a[24:27], v[168:171]
  s_add_u32 m0, s45, 73728
  v_mfma_f32_16x16x32_bf16 v[172:175], a[160:163], a[28:31], v[172:175]
  ds_read_b64_tr_b16 a[160:161], v4 offset:24576
  v_mfma_f32_16x16x32_bf16 v[172:175], a[164:167], a[12:15], v[172:175]
  s_waitcnt lgkmcnt(5)
  buffer_load_dwordx4 v11, s[32:35], s71 offen lds
  v_mfma_f32_16x16x32_bf16 v[188:191], a[172:175], a[12:15], v[188:191]
  ds_read_b64_tr_b16 a[162:163], v4 offset:26624
  v_mfma_f32_16x16x32_bf16 v[188:191], a[168:171], a[28:31], v[188:191]
  s_add_u32 m0, s45, 69632
  s_add_u32 s61, s71, 229376
  v_mfma_f32_16x16x32_bf16 v[184:187], a[168:171], a[24:27], v[184:187]
  ds_read_b64_tr_b16 a[164:165], v4 offset:28672
  v_mfma_f32_16x16x32_bf16 v[184:187], a[172:175], a[8:11], v[184:187]
  buffer_load_dwordx4 v11, s[28:31], s61 offen lds
  v_mfma_f32_16x16x32_bf16 v[180:183], a[172:175], a[4:7], v[180:183]
  ds_read_b64_tr_b16 a[166:167], v4 offset:30720
  v_mfma_f32_16x16x32_bf16 v[180:183], a[168:171], a[20:23], v[180:183]
  v_mfma_f32_16x16x32_bf16 v[176:179], a[168:171], a[16:19], v[176:179]
  ds_read_b64_tr_b16 a[168:169], v5 offset:16384
  v_mfma_f32_16x16x32_bf16 v[176:179], a[172:175], a[0:3], v[176:179]
  s_waitcnt lgkmcnt(5)
  s_add_u32 m0, s45, 77824
  s_add_u32 s61, s71, 229376
  v_mfma_f32_16x16x32_bf16 v[192:195], a[180:183], a[0:3], v[192:195]
  ds_read_b64_tr_b16 a[170:171], v5 offset:18432
  v_mfma_f32_16x16x32_bf16 v[192:195], a[176:179], a[16:19], v[192:195]
  buffer_load_dwordx4 v11, s[32:35], s61 offen lds
  v_mfma_f32_16x16x32_bf16 v[196:199], a[176:179], a[20:23], v[196:199]
  ds_read_b64_tr_b16 a[172:173], v5 offset:20480
  v_mfma_f32_16x16x32_bf16 v[196:199], a[180:183], a[4:7], v[196:199]
  s_add_u32 s62, s92, 6144
  v_mfma_f32_16x16x32_bf16 v[200:203], a[180:183], a[8:11], v[200:203]
  ds_read_b64_tr_b16 a[174:175], v5 offset:22528
  v_mfma_f32_16x16x32_bf16 v[200:203], a[176:179], a[24:27], v[200:203]
  buffer_load_dword a253, v13, s[36:39], s62 offen
  v_mfma_f32_16x16x32_bf16 v[204:207], a[176:179], a[28:31], v[204:207]
  ds_read_b64_tr_b16 a[176:177], v5 offset:24576
  v_mfma_f32_16x16x32_bf16 v[204:207], a[180:183], a[12:15], v[204:207]
  s_waitcnt lgkmcnt(5)
  v_mfma_f32_16x16x32_bf16 v[220:223], a[160:163], a[12:15], v[220:223]
  ds_read_b64_tr_b16 a[178:179], v5 offset:26624
  v_mfma_f32_16x16x32_bf16 v[220:223], a[164:167], a[28:31], v[220:223]
  v_mfma_f32_16x16x32_bf16 v[216:219], a[164:167], a[24:27], v[216:219]
  ds_read_b64_tr_b16 a[180:181], v5 offset:28672
  v_mfma_f32_16x16x32_bf16 v[216:219], a[160:163], a[8:11], v[216:219]
  v_mfma_f32_16x16x32_bf16 v[212:215], a[160:163], a[4:7], v[212:215]
  ds_read_b64_tr_b16 a[182:183], v5 offset:30720
  v_mfma_f32_16x16x32_bf16 v[212:215], a[164:167], a[20:23], v[212:215]
  s_waitcnt vmcnt(24)
  s_barrier
  v_mfma_f32_16x16x32_bf16 v[208:211], a[164:167], a[16:19], v[208:211]
  ds_read_b64_tr_b16 a[164:165], v8 offset:32768
  s_add_u32 s79, s79, 65536
  v_mfma_f32_16x16x32_bf16 v[208:211], a[160:163], a[0:3], v[208:211]
  s_waitcnt lgkmcnt(5)
  buffer_load_dwordx4 a[192:195], v1, s[8:11], s79 offen offset:0 sc1
  v_mfma_f32_16x16x32_bf16 v[224:227], a[168:171], a[0:3], v[224:227]
  ds_read_b64_tr_b16 a[166:167], v8 offset:34816
  v_mfma_f32_16x16x32_bf16 v[224:227], a[172:175], a[16:19], v[224:227]
  v_mfma_f32_16x16x32_bf16 v[228:231], a[172:175], a[20:23], v[228:231]
  ds_read_b64_tr_b16 a[160:161], v8 offset:36864
  v_mfma_f32_16x16x32_bf16 v[228:231], a[168:171], a[4:7], v[228:231]
  v_mfma_f32_16x16x32_bf16 v[232:235], a[168:171], a[8:11], v[232:235]
  ds_read_b64_tr_b16 a[162:163], v8 offset:38912
  v_mfma_f32_16x16x32_bf16 v[232:235], a[172:175], a[24:27], v[232:235]
  buffer_load_dwordx4 a[208:211], v1, s[8:11], s79 offen offset:1024 sc1
  v_mfma_f32_16x16x32_bf16 v[236:239], a[172:175], a[28:31], v[236:239]
  ds_read_b64_tr_b16 a[172:173], v8 offset:40960
  v_mfma_f32_16x16x32_bf16 v[236:239], a[168:171], a[12:15], v[236:239]
  s_waitcnt lgkmcnt(5)
  s_add_u32 s79, s79, 65536
  v_mfma_f32_16x16x32_bf16 v[252:255], a[176:179], a[12:15], v[252:255]
  ds_read_b64_tr_b16 a[174:175], v8 offset:43008
  v_mfma_f32_16x16x32_bf16 v[252:255], a[180:183], a[28:31], v[252:255]
  buffer_load_dwordx4 a[196:199], v1, s[8:11], s79 offen offset:0 sc1
  v_mfma_f32_16x16x32_bf16 v[248:251], a[180:183], a[24:27], v[248:251]
  ds_read_b64_tr_b16 a[168:169], v8 offset:45056
  v_mfma_f32_16x16x32_bf16 v[248:251], a[176:179], a[8:11], v[248:251]
  v_mfma_f32_16x16x32_bf16 v[244:247], a[176:179], a[4:7], v[244:247]
  ds_read_b64_tr_b16 a[170:171], v8 offset:47104
  v_mfma_f32_16x16x32_bf16 v[244:247], a[180:183], a[20:23], v[244:247]
  v_mfma_f32_16x16x32_bf16 v[240:243], a[180:183], a[16:19], v[240:243]
  ds_read_b64_tr_b16 a[180:181], v8 offset:49152
  v_mfma_f32_16x16x32_bf16 v[240:243], a[176:179], a[0:3], v[240:243]
  s_waitcnt vmcnt(36) lgkmcnt(5)
  buffer_load_dwordx4 a[212:215], v1, s[8:11], s79 offen offset:1024 sc1
  v_mfma_f32_16x16x32_bf16 v[32:35], a[164:167], a[64:67], v[32:35]
  ds_read_b64_tr_b16 a[182:183], v8 offset:51200
  v_mfma_f32_16x16x32_bf16 v[32:35], a[160:163], a[80:83], v[32:35]
  s_add_u32 s79, s79, 65536
  v_mfma_f32_16x16x32_bf16 v[36:39], a[160:163], a[84:87], v[36:39]
  ds_read_b64_tr_b16 a[176:177], v8 offset:53248
  v_mfma_f32_16x16x32_bf16 v[36:39], a[164:167], a[68:71], v[36:39]
  buffer_load_dwordx4 a[200:203], v1, s[8:11], s79 offen offset:0 sc1
  v_mfma_f32_16x16x32_bf16 v[40:43], a[164:167], a[72:75], v[40:43]
  ds_read_b64_tr_b16 a[178:179], v8 offset:55296
  v_mfma_f32_16x16x32_bf16 v[40:43], a[160:163], a[88:91], v[40:43]
  v_mfma_f32_16x16x32_bf16 v[44:47], a[160:163], a[92:95], v[44:47]
  ds_read_b64_tr_b16 a[160:161], v8 offset:57344
  v_mfma_f32_16x16x32_bf16 v[44:47], a[164:167], a[76:79], v[44:47]
  s_waitcnt lgkmcnt(5)
  buffer_load_dwordx4 a[216:219], v1, s[8:11], s79 offen offset:1024 sc1
  v_mfma_f32_16x16x32_bf16 v[60:63], a[172:175], a[76:79], v[60:63]
  ds_read_b64_tr_b16 a[162:163], v8 offset:59392
  v_mfma_f32_16x16x32_bf16 v[60:63], a[168:171], a[92:95], v[60:63]
  s_add_u32 m0, s45, 0
  v_mfma_f32_16x16x32_bf16 v[56:59], a[168:171], a[88:91], v[56:59]
  ds_read_b64_tr_b16 a[164:165], v8 offset:61440
  v_mfma_f32_16x16x32_bf16 v[56:59], a[172:175], a[72:75], v[56:59]
  buffer_load_dwordx4 v10, s[28:31], s67 offen lds
  v_mfma_f32_16x16x32_bf16 v[52:55], a[172:175], a[68:71], v[52:55]
  ds_read_b64_tr_b16 a[166:167], v8 offset:63488
  v_mfma_f32_16x16x32_bf16 v[52:55], a[168:171], a[84:87], v[52:55]
  s_waitcnt vmcnt(8)
  s_barrier
  v_mfma_f32_16x16x32_bf16 v[48:51], a[168:171], a[80:83], v[48:51]
  ds_read_b64_tr_b16 a[168:169], v8 offset:16384
  s_add_u32 m0, s45, 8192
  v_mfma_f32_16x16x32_bf16 v[48:51], a[172:175], a[64:67], v[48:51]
  s_waitcnt vmcnt(27) lgkmcnt(5)
  buffer_load_dwordx4 v10, s[32:35], s67 offen lds
  v_mfma_f32_16x16x32_bf16 v[32:35], a[180:183], a[96:99], v[32:35]
  ds_read_b64_tr_b16 a[170:171], v8 offset:18432
  v_mfma_f32_16x16x32_bf16 v[32:35], a[176:179], a[112:115], v[32:35]
  s_add_u32 m0, s45, 4096
  s_add_u32 s61, s67, 229376
  v_mfma_f32_16x16x32_bf16 v[36:39], a[176:179], a[116:119], v[36:39]
  ds_read_b64_tr_b16 a[172:173], v8 offset:20480
  v_mfma_f32_16x16x32_bf16 v[36:39], a[180:183], a[100:103], v[36:39]
  buffer_load_dwordx4 v10, s[28:31], s61 offen lds
  v_mfma_f32_16x16x32_bf16 v[40:43], a[180:183], a[104:107], v[40:43]
  ds_read_b64_tr_b16 a[174:175], v8 offset:22528
  v_mfma_f32_16x16x32_bf16 v[40:43], a[176:179], a[120:123], v[40:43]
HOP13:
  s_cbranch_execz WRET0
  s_add_u32 m0, s45, 12288
  s_add_u32 s61, s67, 229376
  v_mfma_f32_16x16x32_bf16 v[44:47], a[176:179], a[124:127], v[44:47]
  ds_read_b64_tr_b16 a[176:177], v8 offset:24576
  v_mfma_f32_16x16x32_bf16 v[44:47], a[180:183], a[108:111], v[44:47]
  s_waitcnt lgkmcnt(5)
  buffer_load_dwordx4 v10, s[32:35], s61 offen lds
  v_mfma_f32_16x16x32_bf16 v[60:63], a[160:163], a[108:111], v[60:63]
  ds_read_b64_tr_b16 a[178:179], v8 offset:26624
  v_mfma_f32_16x16x32_bf16 v[60:63], a[164:167], a[124:127], v[60:63]
  s_add_u32 m0, s45, 32768
  v_mfma_f32_16x16x32_bf16 v[56:59], a[164:167], a[120:123], v[56:59]
  ds_read_b64_tr_b16 a[180:181], v8 offset:28672
  v_mfma_f32_16x16x32_bf16 v[56:59], a[160:163], a[104:107], v[56:59]
  buffer_load_dwordx4 v10, s[28:31], s68 offen lds
  v_mfma_f32_16x16x32_bf16 v[52:55], a[160:163], a[100:103], v[52:55]
  ds_read_b64_tr_b16 a[182:183], v8 offset:30720
  v_mfma_f32_16x16x32_bf16 v[52:55], a[164:167], a[116:119], v[52:55]
  s_add_u32 m0, s45, 40960
  v_mfma_f32_16x16x32_bf16 v[48:51], a[164:167], a[112:115], v[48:51]
  ds_read_b64_tr_b16 a[164:165], v8 offset:0
  v_mfma_f32_16x16x32_bf16 v[48:51], a[160:163], a[96:99], v[48:51]
  s_waitcnt vmcnt(22) lgkmcnt(5)
  buffer_load_dwordx4 v10, s[32:35], s68 offen lds
  v_mfma_f32_16x16x32_bf16 v[32:35], a[168:171], a[128:131], v[32:35]
  ds_read_b64_tr_b16 a[166:167], v8 offset:2048
  v_mfma_f32_16x16x32_bf16 v[32:35], a[172:175], a[144:147], v[32:35]
  s_add_u32 m0, s45, 36864
  s_add_u32 s61, s68, 229376
  v_mfma_f32_16x16x32_bf16 v[36:39], a[172:175], a[148:151], v[36:39]
  ds_read_b64_tr_b16 a[160:161], v8 offset:4096
  v_mfma_f32_16x16x32_bf16 v[36:39], a[168:171], a[132:135], v[36:39]
  buffer_load_dwordx4 v10, s[28:31], s61 offen lds
  v_mfma_f32_16x16x32_bf16 v[40:43], a[168:171], a[136:139], v[40:43]
  ds_read_b64_tr_b16 a[162:163], v8 offset:6144
  v_mfma_f32_16x16x32_bf16 v[40:43], a[172:175], a[152:155], v[40:43]
  s_add_u32 m0, s45, 45056
  s_add_u32 s61, s68, 229376
  v_mfma_f32_16x16x32_bf16 v[44:47], a[172:175], a[156:159], v[44:47]
  ds_read_b64_tr_b16 a[172:173], v8 offset:8192
  v_mfma_f32_16x16x32_bf16 v[44:47], a[168:171], a[140:143], v[44:47]
  s_waitcnt lgkmcnt(5)
  buffer_load_dwordx4 v10, s[32:35], s61 offen lds
  v_mfma_f32_16x16x32_bf16 v[60:63], a[176:179], a[140:143], v[60:63]
  ds_read_b64_tr_b16 a[174:175], v8 offset:10240
  v_mfma_f32_16x16x32_bf16 v[60:63], a[180:183], a[156:159], v[60:63]
  s_add_u32 s62, s92, 8192
  v_mfma_f32_16x16x32_bf16 v[56:59], a[180:183], a[152:155], v[56:59]
  ds_read_b64_tr_b16 a[168:169], v8 offset:12288
  v_mfma_f32_16x16x32_bf16 v[56:59], a[176:179], a[136:139], v[56:59]
  buffer_load_dword a253, v13, s[36:39], s62 offen
  v_mfma_f32_16x16x32_bf16 v[52:55], a[176:179], a[132:135], v[52:55]
  ds_read_b64_tr_b16 a[170:171], v8 offset:14336
  v_mfma_f32_16x16x32_bf16 v[52:55], a[180:183], a[148:151], v[52:55]
  v_mfma_f32_16x16x32_bf16 v[48:51], a[180:183], a[144:147], v[48:51]
  ds_read_b64_tr_b16 a[180:181], v6 offset:32768
  v_mfma_f32_16x16x32_bf16 v[48:51], a[176:179], a[128:131], v[48:51]
  s_waitcnt vmcnt(9) lgkmcnt(5)
  v_mfma_f32_16x16x32_bf16 v[32:35], a[164:167], a[188:191], v[32:35]
  ds_read_b64_tr_b16 a[182:183], v6 offset:34816
  v_mfma_f32_16x16x32_bf16 v[32:35], a[160:163], a[204:207], v[32:35]
  s_add_u32 m0, s45, 49152
  v_mfma_f32_16x16x32_bf16 v[36:39], a[160:163], a[208:211], v[36:39]
  ds_read_b64_tr_b16 a[176:177], v6 offset:36864
  v_mfma_f32_16x16x32_bf16 v[36:39], a[164:167], a[192:195], v[36:39]
  buffer_load_dwordx4 v10, s[28:31], s69 offen lds
  v_mfma_f32_16x16x32_bf16 v[40:43], a[164:167], a[196:199], v[40:43]
  ds_read_b64_tr_b16 a[178:179], v6 offset:38912
  v_mfma_f32_16x16x32_bf16 v[40:43], a[160:163], a[212:215], v[40:43]
  s_add_u32 m0, s45, 57344
  v_mfma_f32_16x16x32_bf16 v[44:47], a[160:163], a[216:219], v[44:47]
  ds_read_b64_tr_b16 a[160:161], v6 offset:40960
  v_mfma_f32_16x16x32_bf16 v[44:47], a[164:167], a[200:203], v[44:47]
  s_waitcnt lgkmcnt(5)
  buffer_load_dwordx4 v10, s[32:35], s69 offen lds
  v_mfma_f32_16x16x32_bf16 v[60:63], a[172:175], a[200:203], v[60:63]
  ds_read_b64_tr_b16 a[162:163], v6 offset:43008
  v_mfma_f32_16x16x32_bf16 v[60:63], a[168:171], a[216:219], v[60:63]
  s_add_u32 m0, s45, 53248
  s_add_u32 s61, s69, 229376
  v_mfma_f32_16x16x32_bf16 v[56:59], a[168:171], a[212:215], v[56:59]
  ds_read_b64_tr_b16 a[164:165], v6 offset:45056
  v_mfma_f32_16x16x32_bf16 v[56:59], a[172:175], a[196:199], v[56:59]
  buffer_load_dwordx4 v10, s[28:31], s61 offen lds
  v_mfma_f32_16x16x32_bf16 v[52:55], a[172:175], a[192:195], v[52:55]
  ds_read_b64_tr_b16 a[166:167], v6 offset:47104
  v_mfma_f32_16x16x32_bf16 v[52:55], a[168:171], a[208:211], v[52:55]
  s_add_u32 m0, s45, 61440
  s_add_u32 s61, s69, 229376
  v_mfma_f32_16x16x32_bf16 v[48:51], a[168:171], a[204:207], v[48:51]
  ds_read_b64_tr_b16 a[168:169], v6 offset:49152
  v_mfma_f32_16x16x32_bf16 v[48:51], a[172:175], a[188:191], v[48:51]
  s_waitcnt lgkmcnt(5)
  buffer_load_dwordx4 v10, s[32:35], s61 offen lds
  v_mfma_f32_16x16x32_bf16 v[64:67], a[180:183], a[64:67], v[64:67]
  ds_read_b64_tr_b16 a[170:171], v6 offset:51200
  v_mfma_f32_16x16x32_bf16 v[64:67], a[176:179], a[80:83], v[64:67]
  s_add_u32 m0, s45, 16384
  v_mfma_f32_16x16x32_bf16 v[68:71], a[176:179], a[84:87], v[68:71]
  ds_read_b64_tr_b16 a[172:173], v6 offset:53248
  s_waitcnt lgkmcnt(15)
  v_fma_f32 v32, v32, v16, v28
  v_mfma_f32_16x16x32_bf16 v[68:71], a[180:183], a[68:71], v[68:71]
  buffer_load_dwordx4 v10, s[28:31], s70 offen lds
  v_exp_f32 v24, v32
  v_fma_f32 v33, v33, v16, v29
  v_mfma_f32_16x16x32_bf16 v[72:75], a[180:183], a[72:75], v[72:75]
  ds_read_b64_tr_b16 a[174:175], v6 offset:55296
  v_exp_f32 v25, v33
  v_mfma_f32_16x16x32_bf16 v[72:75], a[176:179], a[88:91], v[72:75]
  s_add_u32 m0, s45, 24576
  v_fma_f32 v34, v34, v16, v30
  v_exp_f32 v26, v34
  v_mfma_f32_16x16x32_bf16 v[76:79], a[176:179], a[92:95], v[76:79]
  ds_read_b64_tr_b16 a[176:177], v6 offset:57344
  v_fma_f32 v35, v35, v16, v31
  v_mul_f32 v48, v32, v48
  v_mfma_f32_16x16x32_bf16 v[76:79], a[180:183], a[76:79], v[76:79]
  s_waitcnt lgkmcnt(5)
  buffer_load_dwordx4 v10, s[32:35], s70 offen lds
  v_exp_f32 v27, v35
  v_mfma_f32_16x16x32_bf16 v[92:95], a[160:163], a[76:79], v[92:95]
  ds_read_b64_tr_b16 a[178:179], v6 offset:59392
  v_mul_f32 v49, v33, v49
  v_mfma_f32_16x16x32_bf16 v[92:95], a[164:167], a[92:95], v[92:95]
  s_add_u32 m0, s45, 20480
  s_add_u32 s61, s70, 229376
  v_mul_f32 v50, v34, v50
  v_mul_f32 v51, v35, v51
  v_mfma_f32_16x16x32_bf16 v[88:91], a[164:167], a[88:91], v[88:91]
  ds_read_b64_tr_b16 a[180:181], v6 offset:61440
  v_fma_f32 v24, v24, v17, v17
  v_fma_f32 v25, v25, v17, v17
  v_mfma_f32_16x16x32_bf16 v[88:91], a[160:163], a[72:75], v[88:91]
  buffer_load_dwordx4 v10, s[28:31], s61 offen lds
  v_rcp_f32 v24, v24
  v_fma_f32 v26, v26, v17, v17
  v_mfma_f32_16x16x32_bf16 v[84:87], a[160:163], a[68:71], v[84:87]
  ds_read_b64_tr_b16 a[182:183], v6 offset:63488
  v_rcp_f32 v25, v25
  v_mfma_f32_16x16x32_bf16 v[84:87], a[164:167], a[84:87], v[84:87]
  s_add_u32 m0, s45, 28672
  s_add_u32 s61, s70, 229376
  v_rcp_f32 v26, v26
  v_mfma_f32_16x16x32_bf16 v[80:83], a[164:167], a[80:83], v[80:83]
  ds_read_b64_tr_b16 a[164:165], v6 offset:16384
  v_fma_f32 v27, v27, v17, v17
  v_mul_f32 v48, v48, v24
  v_mfma_f32_16x16x32_bf16 v[80:83], a[160:163], a[64:67], v[80:83]
  s_waitcnt lgkmcnt(5)
  buffer_load_dwordx4 v10, s[32:35], s61 offen lds
  v_rcp_f32 v27, v27
  v_mfma_f32_16x16x32_bf16 v[64:67], a[168:171], a[96:99], v[64:67]
  ds_read_b64_tr_b16 a[166:167], v6 offset:18432
  v_mul_f32 v49, v49, v25
  v_mfma_f32_16x16x32_bf16 v[64:67], a[172:175], a[112:115], v[64:67]
  v_mul_f32 v50, v50, v26
  v_mul_f32 v51, v51, v27
  v_cvt_pk_bf16_f32 v32, v48, v49
  v_mfma_f32_16x16x32_bf16 v[68:71], a[172:175], a[116:119], v[68:71]
  ds_read_b64_tr_b16 a[160:161], v6 offset:20480
  v_cvt_pk_bf16_f32 v33, v50, v51
  v_fma_f32 v36, v36, v18, v28
  v_mfma_f32_16x16x32_bf16 v[68:71], a[168:171], a[100:103], v[68:71]
  buffer_store_dwordx2 v[32:33], v1, s[8:11], s60 offen sc1
  v_mfma_f32_16x16x32_bf16 v[72:75], a[168:171], a[104:107], v[72:75]
  ds_read_b64_tr_b16 a[162:163], v6 offset:22528
  v_exp_f32 v24, v36
  v_mfma_f32_16x16x32_bf16 v[72:75], a[172:175], a[120:123], v[72:75]
  v_fma_f32 v37, v37, v18, v29
  v_exp_f32 v25, v37
  v_mfma_f32_16x16x32_bf16 v[76:79], a[172:175], a[124:127], v[76:79]
  ds_read_b64_tr_b16 a[172:173], v6 offset:24576
  v_fma_f32 v38, v38, v18, v30
  v_fma_f32 v39, v39, v18, v31
  v_mfma_f32_16x16x32_bf16 v[76:79], a[168:171], a[108:111], v[76:79]
  s_waitcnt lgkmcnt(5)
  v_exp_f32 v26, v38
  v_mul_f32 v52, v36, v52
  v_mfma_f32_16x16x32_bf16 v[92:95], a[176:179], a[108:111], v[92:95]
  ds_read_b64_tr_b16 a[174:175], v6 offset:26624
  v_mul_f32 v53, v37, v53
  v_mfma_f32_16x16x32_bf16 v[92:95], a[180:183], a[124:127], v[92:95]
  v_exp_f32 v27, v39
  v_mul_f32 v54, v38, v54
  v_mfma_f32_16x16x32_bf16 v[88:91], a[180:183], a[120:123], v[88:91]
  ds_read_b64_tr_b16 a[168:169], v6 offset:28672
  v_mul_f32 v55, v39, v55
  v_fma_f32 v24, v24, v19, v19
  v_mfma_f32_16x16x32_bf16 v[88:91], a[176:179], a[104:107], v[88:91]
  v_rcp_f32 v24, v24
  v_fma_f32 v25, v25, v19, v19
  v_mfma_f32_16x16x32_bf16 v[84:87], a[176:179], a[100:103], v[84:87]
  ds_read_b64_tr_b16 a[170:171], v6 offset:30720
  v_rcp_f32 v25, v25
  v_mfma_f32_16x16x32_bf16 v[84:87], a[180:183], a[116:119], v[84:87]
  v_fma_f32 v26, v26, v19, v19
  v_rcp_f32 v26, v26
  v_mfma_f32_16x16x32_bf16 v[80:83], a[180:183], a[112:115], v[80:83]
  ds_read_b64_tr_b16 a[180:181], v6 offset:0
  v_fma_f32 v27, v27, v19, v19
  v_mul_f32 v52, v52, v24
  v_mfma_f32_16x16x32_bf16 v[80:83], a[176:179], a[96:99], v[80:83]
  s_waitcnt lgkmcnt(5)
  v_rcp_f32 v27, v27
  v_mul_f32 v53, v53, v25
  v_mfma_f32_16x16x32_bf16 v[64:67], a[164:167], a[128:131], v[64:67]
  ds_read_b64_tr_b16 a[182:183], v6 offset:2048
  v_mul_f32 v54, v54, v26
  v_mfma_f32_16x16x32_bf16 v[64:67], a[160:163], a[144:147], v[64:67]
  v_mul_f32 v55, v55, v27
  v_cvt_pk_bf16_f32 v36, v52, v53
  v_cvt_pk_bf16_f32 v37, v54, v55
  v_mfma_f32_16x16x32_bf16 v[68:71], a[160:163], a[148:151], v[68:71]
  ds_read_b64_tr_b16 a[176:177], v6 offset:4096
  v_fma_f32 v40, v40, v20, v28
  v_fma_f32 v41, v41, v20, v29
  v_mfma_f32_16x16x32_bf16 v[68:71], a[164:167], a[132:135], v[68:71]
  s_add_u32 s55, s60, 262144
  buffer_store_dwordx2 v[36:37], v1, s[8:11], s55 offen sc1
  v_mfma_f32_16x16x32_bf16 v[72:75], a[164:167], a[136:139], v[72:75]
  ds_read_b64_tr_b16 a[178:179], v6 offset:6144
  s_add_u32 s62, s92, 10240
  v_fma_f32 v42, v42, v20, v30
  v_mfma_f32_16x16x32_bf16 v[72:75], a[160:163], a[152:155], v[72:75]
  buffer_load_dword a253, v13, s[36:39], s62 offen
  v_exp_f32 v24, v40
  v_fma_f32 v43, v43, v20, v31
  v_mfma_f32_16x16x32_bf16 v[76:79], a[160:163], a[156:159], v[76:79]
  ds_read_b64_tr_b16 a[160:161], v6 offset:8192
  v_exp_f32 v25, v41
  v_mfma_f32_16x16x32_bf16 v[76:79], a[164:167], a[140:143], v[76:79]
  s_waitcnt lgkmcnt(5)
  v_exp_f32 v26, v42
  v_mul_f32 v56, v40, v56
  v_mfma_f32_16x16x32_bf16 v[92:95], a[172:175], a[140:143], v[92:95]
  ds_read_b64_tr_b16 a[162:163], v6 offset:10240
  v_mul_f32 v57, v41, v57
  v_mfma_f32_16x16x32_bf16 v[92:95], a[168:171], a[156:159], v[92:95]
  v_exp_f32 v27, v43
  v_mul_f32 v58, v42, v58
  v_mfma_f32_16x16x32_bf16 v[88:91], a[168:171], a[152:155], v[88:91]
  ds_read_b64_tr_b16 a[164:165], v6 offset:12288
  v_mul_f32 v59, v43, v59
  v_fma_f32 v24, v24, v21, v21
  v_mfma_f32_16x16x32_bf16 v[88:91], a[172:175], a[136:139], v[88:91]
  v_rcp_f32 v24, v24
  v_fma_f32 v25, v25, v21, v21
  v_mfma_f32_16x16x32_bf16 v[84:87], a[172:175], a[132:135], v[84:87]
  ds_read_b64_tr_b16 a[166:167], v6 offset:14336
  v_rcp_f32 v25, v25
  v_mfma_f32_16x16x32_bf16 v[84:87], a[168:171], a[148:151], v[84:87]
  v_fma_f32 v26, v26, v21, v21
  v_rcp_f32 v26, v26
  v_mfma_f32_16x16x32_bf16 v[80:83], a[168:171], a[144:147], v[80:83]
  ds_read_b64_tr_b16 a[168:169], v7 offset:32768
  v_fma_f32 v27, v27, v21, v21
  v_mul_f32 v56, v56, v24
  v_mfma_f32_16x16x32_bf16 v[80:83], a[172:175], a[128:131], v[80:83]
  s_waitcnt lgkmcnt(5)
  v_rcp_f32 v27, v27
  v_mul_f32 v57, v57, v25
  v_mfma_f32_16x16x32_bf16 v[64:67], a[180:183], a[188:191], v[64:67]
  ds_read_b64_tr_b16 a[170:171], v7 offset:34816
  v_mul_f32 v58, v58, v26
  v_mfma_f32_16x16x32_bf16 v[64:67], a[176:179], a[204:207], v[64:67]
  v_mul_f32 v59, v59, v27
  v_cvt_pk_bf16_f32 v40, v56, v57
  v_cvt_pk_bf16_f32 v41, v58, v59
  v_mfma_f32_16x16x32_bf16 v[68:71], a[176:179], a[208:211], v[68:71]
  ds_read_b64_tr_b16 a[172:173], v7 offset:36864
  v_fma_f32 v44, v44, v22, v28
  v_fma_f32 v45, v45, v22, v29
  v_mfma_f32_16x16x32_bf16 v[68:71], a[180:183], a[192:195], v[68:71]
  s_add_u32 s55, s60, 524288
  buffer_store_dwordx2 v[40:41], v1, s[8:11], s55 offen sc1
  v_mfma_f32_16x16x32_bf16 v[72:75], a[180:183], a[196:199], v[72:75]
  ds_read_b64_tr_b16 a[174:175], v7 offset:38912
  v_exp_f32 v24, v44
  v_mfma_f32_16x16x32_bf16 v[72:75], a[176:179], a[212:215], v[72:75]
  v_exp_f32 v25, v45
  v_fma_f32 v46, v46, v22, v30
  v_mfma_f32_16x16x32_bf16 v[76:79], a[176:179], a[216:219], v[76:79]
  ds_read_b64_tr_b16 a[176:177], v7 offset:40960
  v_exp_f32 v26, v46
  v_mfma_f32_16x16x32_bf16 v[76:79], a[180:183], a[200:203], v[76:79]
  s_waitcnt lgkmcnt(5)
  v_fma_f32 v47, v47, v22, v31
  v_exp_f32 v27, v47
  v_mfma_f32_16x16x32_bf16 v[92:95], a[160:163], a[200:203], v[92:95]
  ds_read_b64_tr_b16 a[178:179], v7 offset:43008
  v_mul_f32 v60, v44, v60
  v_mfma_f32_16x16x32_bf16 v[92:95], a[164:167], a[216:219], v[92:95]
  v_mul_f32 v61, v45, v61
  v_mul_f32 v62, v46, v62
  v_mul_f32 v63, v47, v63
  v_mfma_f32_16x16x32_bf16 v[88:91], a[164:167], a[212:215], v[88:91]
  ds_read_b64_tr_b16 a[180:181], v7 offset:45056
  v_fma_f32 v24, v24, v23, v23
  v_fma_f32 v25, v25, v23, v23
  v_mfma_f32_16x16x32_bf16 v[88:91], a[160:163], a[196:199], v[88:91]
  v_rcp_f32 v24, v24
  v_fma_f32 v26, v26, v23, v23
  v_mfma_f32_16x16x32_bf16 v[84:87], a[160:163], a[192:195], v[84:87]
  ds_read_b64_tr_b16 a[182:183], v7 offset:47104
  v_rcp_f32 v25, v25
  v_mfma_f32_16x16x32_bf16 v[84:87], a[164:167], a[208:211], v[84:87]
  v_rcp_f32 v26, v26
  v_fma_f32 v27, v27, v23, v23
  v_mfma_f32_16x16x32_bf16 v[80:83], a[164:167], a[204:207], v[80:83]
  ds_read_b64_tr_b16 a[164:165], v7 offset:49152
  v_rcp_f32 v27, v27
  v_mfma_f32_16x16x32_bf16 v[80:83], a[160:163], a[188:191], v[80:83]
  s_waitcnt lgkmcnt(5)
  v_mul_f32 v60, v60, v24
  v_mul_f32 v61, v61, v25
  v_mul_f32 v62, v62, v26
  v_mfma_f32_16x16x32_bf16 v[96:99], a[168:171], a[64:67], v[96:99]
  ds_read_b64_tr_b16 a[166:167], v7 offset:51200
  v_mul_f32 v63, v63, v27
  v_mfma_f32_16x16x32_bf16 v[96:99], a[172:175], a[80:83], v[96:99]
  v_cvt_pk_bf16_f32 v44, v60, v61
  v_cvt_pk_bf16_f32 v45, v62, v63
  v_mfma_f32_16x16x32_bf16 v[100:103], a[172:175], a[84:87], v[100:103]
  ds_read_b64_tr_b16 a[160:161], v7 offset:53248
  ds_read_b128 v[60:63], v12 offset:768
  v_mfma_f32_16x16x32_bf16 v[100:103], a[168:171], a[68:71], v[100:103]
  s_add_u32 s55, s60, 786432
  buffer_store_dwordx2 v[44:45], v1, s[8:11], s55 offen sc1
  v_mfma_f32_16x16x32_bf16 v[104:107], a[168:171], a[72:75], v[104:107]
  ds_read_b64_tr_b16 a[162:163], v7 offset:55296
  v_mfma_f32_16x16x32_bf16 v[104:107], a[172:175], a[88:91], v[104:107]
  v_mfma_f32_16x16x32_bf16 v[108:111], a[172:175], a[92:95], v[108:111]
  ds_read_b64_tr_b16 a[172:173], v7 offset:57344
  v_mfma_f32_16x16x32_bf16 v[108:111], a[168:171], a[76:79], v[108:111]
  s_waitcnt lgkmcnt(6)
  v_mfma_f32_16x16x32_bf16 v[124:127], a[176:179], a[76:79], v[124:127]
  ds_read_b64_tr_b16 a[174:175], v7 offset:59392
  s_waitcnt lgkmcnt(3)
  v_fma_f32 v64, v64, v16, v60
  v_mfma_f32_16x16x32_bf16 v[124:127], a[180:183], a[92:95], v[124:127]
  v_exp_f32 v24, v64
  v_mfma_f32_16x16x32_bf16 v[120:123], a[180:183], a[88:91], v[120:123]
  ds_read_b64_tr_b16 a[168:169], v7 offset:61440
  v_fma_f32 v65, v65, v16, v61
  v_fma_f32 v66, v66, v16, v62
  v_mfma_f32_16x16x32_bf16 v[120:123], a[176:179], a[72:75], v[120:123]
  v_exp_f32 v25, v65
  v_mfma_f32_16x16x32_bf16 v[116:119], a[176:179], a[68:71], v[116:119]
  ds_read_b64_tr_b16 a[170:171], v7 offset:63488
  v_exp_f32 v26, v66
  v_mfma_f32_16x16x32_bf16 v[116:119], a[180:183], a[84:87], v[116:119]
  v_fma_f32 v67, v67, v16, v63
  v_fma_f32 v68, v68, v18, v60
  v_mfma_f32_16x16x32_bf16 v[112:115], a[180:183], a[80:83], v[112:115]
  ds_read_b64_tr_b16 a[180:181], v7 offset:16384
  v_exp_f32 v27, v67
  v_mfma_f32_16x16x32_bf16 v[112:115], a[176:179], a[64:67], v[112:115]
  s_waitcnt lgkmcnt(5)
  v_exp_f32 v28, v68
  v_fma_f32 v69, v69, v18, v61
  v_mfma_f32_16x16x32_bf16 v[96:99], a[164:167], a[96:99], v[96:99]
  ds_read_b64_tr_b16 a[182:183], v7 offset:18432
  v_fma_f32 v70, v70, v18, v62
  v_mfma_f32_16x16x32_bf16 v[96:99], a[160:163], a[112:115], v[96:99]
  v_exp_f32 v29, v69
  v_fma_f32 v71, v71, v18, v63
  v_mfma_f32_16x16x32_bf16 v[100:103], a[160:163], a[116:119], v[100:103]
  ds_read_b64_tr_b16 a[176:177], v7 offset:20480
  v_mul_f32 v80, v64, v80
  v_mfma_f32_16x16x32_bf16 v[100:103], a[164:167], a[100:103], v[100:103]
  v_mul_f32 v81, v65, v81
  v_mul_f32 v82, v66, v82
  v_mul_f32 v83, v67, v83
  v_mfma_f32_16x16x32_bf16 v[104:107], a[164:167], a[104:107], v[104:107]
  ds_read_b64_tr_b16 a[178:179], v7 offset:22528
  v_mul_f32 v84, v68, v84
  v_mfma_f32_16x16x32_bf16 v[104:107], a[160:163], a[120:123], v[104:107]
  v_lshrrev_b32 v48, 3, v0
  v_bfe_u32 v49, v48, 1, 2
  v_bfe_u32 v50, v0, 1, 2
  v_mfma_f32_16x16x32_bf16 v[108:111], a[160:163], a[124:127], v[108:111]
  ds_read_b64_tr_b16 a[160:161], v7 offset:24576
  v_xor_b32 v49, v49, v50
  v_mfma_f32_16x16x32_bf16 v[108:111], a[164:167], a[108:111], v[108:111]
  s_waitcnt lgkmcnt(5)
  v_lshlrev_b32 v49, 5, v49
  v_and_b32 v50, 1, v0
  v_lshl_add_u32 v49, v50, 4, v49
  v_mfma_f32_16x16x32_bf16 v[124:127], a[172:175], a[108:111], v[124:127]
  ds_read_b64_tr_b16 a[162:163], v7 offset:26624
  v_exp_f32 v30, v70
  v_mfma_f32_16x16x32_bf16 v[124:127], a[168:171], a[124:127], v[124:127]
  s_lshl_b32 s53, s44, 3
  v_exp_f32 v31, v71
  v_mfma_f32_16x16x32_bf16 v[120:123], a[168:171], a[120:123], v[120:123]
  ds_read_b64_tr_b16 a[164:165], v7 offset:28672
  v_add_u32 v48, s53, v48
  v_lshl_add_u32 v48, v48, 11, v49
  v_mfma_f32_16x16x32_bf16 v[120:123], a[172:175], a[104:107], v[120:123]
  s_mul_i32 s53, s52, 1835008
  s_lshl_b32 s54, s51, 7
  s_add_u32 s53, s53, s54
  v_mfma_f32_16x16x32_bf16 v[116:119], a[172:175], a[100:103], v[116:119]
  ds_read_b64_tr_b16 a[166:167], v7 offset:30720
  v_add_u32 v33, s53, v48
  v_xor_b32 v32, 128, v33
  v_mfma_f32_16x16x32_bf16 v[116:119], a[168:171], a[116:119], v[116:119]
  v_and_b32 v48, 3, v0
  v_bfe_u32 v49, v0, 2, 1
  v_mfma_f32_16x16x32_bf16 v[112:115], a[168:171], a[112:115], v[112:115]
  ds_read_b64_tr_b16 a[168:169], v7 offset:0
  v_lshl_add_u32 v48, v48, 3, v49
  v_lshlrev_b32 v37, 7, v48
  v_mfma_f32_16x16x32_bf16 v[112:115], a[172:175], a[96:99], v[112:115]
  s_waitcnt lgkmcnt(5)
  v_mul_f32 v85, v69, v85
  v_mul_f32 v86, v70, v86
  v_mul_f32 v87, v71, v87
  v_mfma_f32_16x16x32_bf16 v[96:99], a[180:183], a[128:131], v[96:99]
  ds_read_b64_tr_b16 a[170:171], v7 offset:2048
  v_fma_f32 v24, v24, v17, v17
  v_mfma_f32_16x16x32_bf16 v[96:99], a[176:179], a[144:147], v[96:99]
  v_rcp_f32 v24, v24
  v_fma_f32 v25, v25, v17, v17
  v_mfma_f32_16x16x32_bf16 v[100:103], a[176:179], a[148:151], v[100:103]
  ds_read_b64_tr_b16 a[172:173], v7 offset:4096
  v_fma_f32 v26, v26, v17, v17
  v_mfma_f32_16x16x32_bf16 v[100:103], a[180:183], a[132:135], v[100:103]
  v_rcp_f32 v25, v25
  v_fma_f32 v27, v27, v17, v17
  v_mfma_f32_16x16x32_bf16 v[104:107], a[180:183], a[136:139], v[104:107]
  ds_read_b64_tr_b16 a[174:175], v7 offset:6144
  v_fma_f32 v28, v28, v19, v19
  v_mfma_f32_16x16x32_bf16 v[104:107], a[176:179], a[152:155], v[104:107]
  v_rcp_f32 v26, v26
  v_fma_f32 v29, v29, v19, v19
  v_mfma_f32_16x16x32_bf16 v[108:111], a[176:179], a[156:159], v[108:111]
  ds_read_b64_tr_b16 a[176:177], v7 offset:8192
  v_fma_f32 v30, v30, v19, v19
  v_mfma_f32_16x16x32_bf16 v[108:111], a[180:183], a[140:143], v[108:111]
  s_waitcnt lgkmcnt(5)
  v_rcp_f32 v27, v27
  v_fma_f32 v31, v31, v19, v19
  v_mfma_f32_16x16x32_bf16 v[124:127], a[160:163], a[140:143], v[124:127]
  ds_read_b64_tr_b16 a[178:179], v7 offset:10240
  v_rcp_f32 v28, v28
  v_mfma_f32_16x16x32_bf16 v[124:127], a[164:167], a[156:159], v[124:127]
  v_rcp_f32 v29, v29
  v_mfma_f32_16x16x32_bf16 v[120:123], a[164:167], a[152:155], v[120:123]
  ds_read_b64_tr_b16 a[180:181], v7 offset:12288
  s_add_u32 s62, s92, 12288
  v_mul_f32 v80, v80, v24
  v_mfma_f32_16x16x32_bf16 v[120:123], a[160:163], a[136:139], v[120:123]
  buffer_load_dword a253, v13, s[36:39], s62 offen
  v_rcp_f32 v30, v30
  v_mfma_f32_16x16x32_bf16 v[116:119], a[160:163], a[132:135], v[116:119]
  ds_read_b64_tr_b16 a[182:183], v7 offset:14336
  v_rcp_f32 v31, v31
  v_mfma_f32_16x16x32_bf16 v[116:119], a[164:167], a[148:151], v[116:119]
  s_waitcnt vmcnt(19)
  s_barrier
  v_mfma_f32_16x16x32_bf16 v[112:115], a[164:167], a[144:147], v[112:115]
  ds_read_b64_tr_b16 a[164:165], v2 offset:0
  v_mul_f32 v81, v81, v25
  v_mul_f32 v82, v82, v26
  v_mfma_f32_16x16x32_bf16 v[112:115], a[160:163], a[128:131], v[112:115]
  s_waitcnt lgkmcnt(5)
  v_mul_f32 v83, v83, v27
  v_mul_f32 v84, v84, v28
  v_mul_f32 v85, v85, v29
  v_mfma_f32_16x16x32_bf16 v[96:99], a[168:171], a[188:191], v[96:99]
  ds_read_b64_tr_b16 a[166:167], v2 offset:2048
  v_mul_f32 v86, v86, v30
  v_mfma_f32_16x16x32_bf16 v[96:99], a[172:175], a[204:207], v[96:99]
  s_add_u32 m0, s45, 98304
  v_mul_f32 v87, v87, v31
  v_cvt_pk_bf16_f32 v64, v80, v81
  v_cvt_pk_bf16_f32 v65, v82, v83
  v_mfma_f32_16x16x32_bf16 v[100:103], a[172:175], a[208:211], v[100:103]
  ds_read_b64_tr_b16 a[160:161], v2 offset:4096
  v_cvt_pk_bf16_f32 v68, v84, v85
  v_mfma_f32_16x16x32_bf16 v[100:103], a[168:171], a[192:195], v[100:103]
  buffer_load_dwordx4 v10, s[28:31], s71 offen lds
  v_cvt_pk_bf16_f32 v69, v86, v87
  v_fma_f32 v72, v72, v20, v60
  v_fma_f32 v73, v73, v20, v61
  v_mfma_f32_16x16x32_bf16 v[104:107], a[168:171], a[196:199], v[104:107]
  ds_read_b64_tr_b16 a[162:163], v2 offset:6144
  v_fma_f32 v74, v74, v20, v62
  v_mfma_f32_16x16x32_bf16 v[104:107], a[172:175], a[212:215], v[104:107]
  s_add_u32 m0, s45, 106496
  v_exp_f32 v24, v72
  v_fma_f32 v75, v75, v20, v63
  v_mfma_f32_16x16x32_bf16 v[108:111], a[172:175], a[216:219], v[108:111]
  ds_read_b64_tr_b16 a[172:173], v2 offset:8192
  v_fma_f32 v76, v76, v22, v60
  v_mfma_f32_16x16x32_bf16 v[108:111], a[168:171], a[200:203], v[108:111]
  s_waitcnt lgkmcnt(5)
  buffer_load_dwordx4 v10, s[32:35], s71 offen lds
  v_exp_f32 v25, v73
  v_mfma_f32_16x16x32_bf16 v[124:127], a[176:179], a[200:203], v[124:127]
  ds_read_b64_tr_b16 a[174:175], v2 offset:10240
  s_waitcnt vmcnt(8)
  s_barrier
  v_mfma_f32_16x16x32_bf16 v[124:127], a[180:183], a[216:219], v[124:127]
  s_add_u32 m0, s45, 102400
  s_add_u32 s61, s71, 229376
  v_fma_f32 v77, v77, v22, v61
  v_mfma_f32_16x16x32_bf16 v[120:123], a[180:183], a[212:215], v[120:123]
  ds_read_b64_tr_b16 a[168:169], v2 offset:12288
  v_exp_f32 v26, v74
  v_mfma_f32_16x16x32_bf16 v[120:123], a[176:179], a[196:199], v[120:123]
  buffer_load_dwordx4 v10, s[28:31], s61 offen lds
  v_exp_f32 v27, v75
  v_mfma_f32_16x16x32_bf16 v[116:119], a[176:179], a[192:195], v[116:119]
  ds_read_b64_tr_b16 a[170:171], v2 offset:14336
  v_exp_f32 v28, v76
  v_mfma_f32_16x16x32_bf16 v[116:119], a[180:183], a[208:211], v[116:119]
  s_add_u32 m0, s45, 110592
  s_add_u32 s61, s71, 229376
  v_fma_f32 v78, v78, v22, v62
  v_mfma_f32_16x16x32_bf16 v[112:115], a[180:183], a[204:207], v[112:115]
  ds_read_b64_tr_b16 a[180:181], v3 offset:0
  v_exp_f32 v29, v77
  v_mfma_f32_16x16x32_bf16 v[112:115], a[176:179], a[188:191], v[112:115]
  s_waitcnt lgkmcnt(5)
  buffer_load_dwordx4 v10, s[32:35], s61 offen lds
  v_exp_f32 v30, v78
  v_mfma_f32_16x16x32_bf16 v[128:131], a[164:167], a[32:35], v[128:131]
  ds_read_b64_tr_b16 a[182:183], v3 offset:2048
  v_fma_f32 v79, v79, v22, v63
  v_mfma_f32_16x16x32_bf16 v[128:131], a[160:163], a[48:51], v[128:131]
  v_exp_f32 v31, v79
  v_mul_f32 v88, v72, v88
  v_mfma_f32_16x16x32_bf16 v[132:135], a[160:163], a[52:55], v[132:135]
  ds_read_b64_tr_b16 a[176:177], v3 offset:4096
  v_mul_f32 v89, v73, v89
  v_mfma_f32_16x16x32_bf16 v[132:135], a[164:167], a[36:39], v[132:135]
  ds_read_b128 v[60:63], v12 offset:832
  v_mul_f32 v90, v74, v90
  v_mul_f32 v91, v75, v91
  v_mfma_f32_16x16x32_bf16 v[136:139], a[164:167], a[40:43], v[136:139]
  ds_read_b64_tr_b16 a[178:179], v3 offset:6144
  v_mul_f32 v92, v76, v92
  v_mfma_f32_16x16x32_bf16 v[136:139], a[160:163], a[56:59], v[136:139]
  v_mul_f32 v93, v77, v93
  v_mul_f32 v94, v78, v94
  v_mul_f32 v95, v79, v95
  v_mfma_f32_16x16x32_bf16 v[140:143], a[160:163], a[60:63], v[140:143]
  ds_read_b64_tr_b16 a[160:161], v3 offset:8192
  v_fma_f32 v24, v24, v21, v21
  v_mfma_f32_16x16x32_bf16 v[140:143], a[164:167], a[44:47], v[140:143]
  s_waitcnt lgkmcnt(6)
  v_rcp_f32 v24, v24
  v_fma_f32 v25, v25, v21, v21
  v_mfma_f32_16x16x32_bf16 v[156:159], a[172:175], a[44:47], v[156:159]
  ds_read_b64_tr_b16 a[162:163], v3 offset:10240
  v_rcp_f32 v25, v25
  v_mfma_f32_16x16x32_bf16 v[156:159], a[168:171], a[60:63], v[156:159]
  v_fma_f32 v26, v26, v21, v21
  v_fma_f32 v27, v27, v21, v21
  v_mfma_f32_16x16x32_bf16 v[152:155], a[168:171], a[56:59], v[152:155]
  ds_read_b64_tr_b16 a[164:165], v3 offset:12288
  v_rcp_f32 v26, v26
  v_mfma_f32_16x16x32_bf16 v[152:155], a[172:175], a[40:43], v[152:155]
  v_rcp_f32 v27, v27
  v_mfma_f32_16x16x32_bf16 v[148:151], a[172:175], a[36:39], v[148:151]
  ds_read_b64_tr_b16 a[166:167], v3 offset:14336
  v_fma_f32 v28, v28, v23, v23
  v_fma_f32 v29, v29, v23, v23
  v_mfma_f32_16x16x32_bf16 v[148:151], a[168:171], a[52:55], v[148:151]
  v_rcp_f32 v28, v28
  v_mfma_f32_16x16x32_bf16 v[144:147], a[168:171], a[48:51], v[144:147]
  ds_read_b64_tr_b16 a[168:169], v4 offset:0
  v_rcp_f32 v29, v29
  v_mfma_f32_16x16x32_bf16 v[144:147], a[172:175], a[32:35], v[144:147]
  s_waitcnt lgkmcnt(5)
  v_fma_f32 v30, v30, v23, v23
  v_rcp_f32 v30, v30
  v_mfma_f32_16x16x32_bf16 v[160:163], a[180:183], a[32:35], v[160:163]
  ds_read_b64_tr_b16 a[170:171], v4 offset:2048
  v_fma_f32 v31, v31, v23, v23
  v_mfma_f32_16x16x32_bf16 v[160:163], a[176:179], a[48:51], v[160:163]
  v_rcp_f32 v31, v31
  v_mul_f32 v88, v88, v24
  v_mfma_f32_16x16x32_bf16 v[164:167], a[176:179], a[52:55], v[164:167]
  ds_read_b64_tr_b16 a[172:173], v4 offset:4096
  v_mul_f32 v89, v89, v25
  v_mfma_f32_16x16x32_bf16 v[164:167], a[180:183], a[36:39], v[164:167]
  v_mul_f32 v90, v90, v26
  v_mul_f32 v91, v91, v27
  v_mul_f32 v92, v92, v28
  v_mfma_f32_16x16x32_bf16 v[168:171], a[180:183], a[40:43], v[168:171]
HOP14:
  s_cbranch_execz WRET0
  ds_read_b64_tr_b16 a[174:175], v4 offset:6144
  v_mul_f32 v93, v93, v29
  v_mfma_f32_16x16x32_bf16 v[168:171], a[176:179], a[56:59], v[168:171]
  v_mul_f32 v94, v94, v30
  v_mul_f32 v95, v95, v31
  v_cvt_pk_bf16_f32 v72, v88, v89
  v_mfma_f32_16x16x32_bf16 v[172:175], a[176:179], a[60:63], v[172:175]
  ds_read_b64_tr_b16 a[176:177], v4 offset:8192
  v_cvt_pk_bf16_f32 v73, v90, v91
  v_mfma_f32_16x16x32_bf16 v[172:175], a[180:183], a[44:47], v[172:175]
  s_waitcnt lgkmcnt(5)
  v_cvt_pk_bf16_f32 v76, v92, v93
  v_cvt_pk_bf16_f32 v77, v94, v95
  v_mfma_f32_16x16x32_bf16 v[188:191], a[160:163], a[44:47], v[188:191]
  ds_read_b64_tr_b16 a[178:179], v4 offset:10240
  s_cmp_eq_u32 s91, 0
  s_cselect_b32 s72, 8, 1
  s_lshl_b32 s64, s72, 17
  s_lshl_b32 s72, s72, 11
  s_add_u32 s72, s72, s84
  s_add_u32 m0, s45, 114688
  s_waitcnt lgkmcnt(11)
  v_mfma_f32_16x16x32_bf16 v[188:191], a[164:167], a[60:63], v[188:191]
  buffer_load_dwordx4 v32, s[36:39], s64 offen lds
  v_fma_f32 v96, v96, v16, v60
  v_exp_f32 v24, v96
  v_mfma_f32_16x16x32_bf16 v[184:187], a[164:167], a[56:59], v[184:187]
  ds_read_b64_tr_b16 a[180:181], v4 offset:12288
  v_fma_f32 v97, v97, v16, v61
  v_fma_f32 v98, v98, v16, v62
  v_mfma_f32_16x16x32_bf16 v[184:187], a[160:163], a[40:43], v[184:187]
  s_add_u32 m0, s45, 118784
  s_add_u32 s61, s64, 65536
  v_exp_f32 v25, v97
  v_mfma_f32_16x16x32_bf16 v[180:183], a[160:163], a[36:39], v[180:183]
  ds_read_b64_tr_b16 a[182:183], v4 offset:14336
  v_exp_f32 v26, v98
  v_mfma_f32_16x16x32_bf16 v[180:183], a[164:167], a[52:55], v[180:183]
  buffer_load_dwordx4 v32, s[36:39], s61 offen lds
  v_fma_f32 v99, v99, v16, v63
  v_exp_f32 v27, v99
  v_mfma_f32_16x16x32_bf16 v[176:179], a[164:167], a[48:51], v[176:179]
  ds_read_b64_tr_b16 a[164:165], v5 offset:0
  v_fma_f32 v100, v100, v18, v60
  v_fma_f32 v101, v101, v18, v61
  v_mfma_f32_16x16x32_bf16 v[176:179], a[160:163], a[32:35], v[176:179]
  s_waitcnt lgkmcnt(5)
  s_add_u32 m0, s45, 122880
  v_exp_f32 v28, v100
  v_mfma_f32_16x16x32_bf16 v[192:195], a[168:171], a[32:35], v[192:195]
  ds_read_b64_tr_b16 a[166:167], v5 offset:2048
  v_fma_f32 v102, v102, v18, v62
  v_mfma_f32_16x16x32_bf16 v[192:195], a[172:175], a[48:51], v[192:195]
  buffer_load_dwordx4 v33, s[36:39], s64 offen lds
  v_exp_f32 v29, v101
  v_fma_f32 v103, v103, v18, v63
  v_mfma_f32_16x16x32_bf16 v[196:199], a[172:175], a[52:55], v[196:199]
  ds_read_b64_tr_b16 a[160:161], v5 offset:4096
  v_exp_f32 v30, v102
  v_mfma_f32_16x16x32_bf16 v[196:199], a[168:171], a[36:39], v[196:199]
  s_add_u32 m0, s45, 126976
  s_add_u32 s61, s64, 65536
  v_exp_f32 v31, v103
  v_mfma_f32_16x16x32_bf16 v[200:203], a[168:171], a[40:43], v[200:203]
  ds_read_b64_tr_b16 a[162:163], v5 offset:6144
  v_mul_f32 v112, v96, v112
  v_mul_f32 v113, v97, v113
  v_mfma_f32_16x16x32_bf16 v[200:203], a[172:175], a[56:59], v[200:203]
  buffer_load_dwordx4 v33, s[36:39], s61 offen lds
  v_mul_f32 v114, v98, v114
  v_mul_f32 v115, v99, v115
  v_mul_f32 v116, v100, v116
  v_mfma_f32_16x16x32_bf16 v[204:207], a[172:175], a[60:63], v[204:207]
  ds_read_b64_tr_b16 a[172:173], v5 offset:8192
  v_mul_f32 v117, v101, v117
  v_mul_f32 v118, v102, v118
  v_mfma_f32_16x16x32_bf16 v[204:207], a[168:171], a[44:47], v[204:207]
  s_waitcnt lgkmcnt(5)
  s_cmp_eq_u32 s91, 1
  s_cselect_b32 s73, 10, 3
  s_lshl_b32 s65, s73, 17
  s_lshl_b32 s73, s73, 11
  s_add_u32 s73, s73, s84
  s_add_u32 m0, s45, 81920
  v_mul_f32 v119, v103, v119
  v_fma_f32 v24, v24, v17, v17
  v_mfma_f32_16x16x32_bf16 v[220:223], a[176:179], a[44:47], v[220:223]
  ds_read_b64_tr_b16 a[174:175], v5 offset:10240
  v_rcp_f32 v24, v24
  v_mfma_f32_16x16x32_bf16 v[220:223], a[180:183], a[60:63], v[220:223]
  buffer_load_dwordx4 v32, s[36:39], s65 offen lds
  v_fma_f32 v25, v25, v17, v17
  v_rcp_f32 v25, v25
  v_mfma_f32_16x16x32_bf16 v[216:219], a[180:183], a[56:59], v[216:219]
  ds_read_b64_tr_b16 a[168:169], v5 offset:12288
  v_fma_f32 v26, v26, v17, v17
  v_fma_f32 v27, v27, v17, v17
  v_mfma_f32_16x16x32_bf16 v[216:219], a[176:179], a[40:43], v[216:219]
  s_add_u32 m0, s45, 86016
  s_add_u32 s61, s65, 65536
  v_rcp_f32 v26, v26
  v_mfma_f32_16x16x32_bf16 v[212:215], a[176:179], a[36:39], v[212:215]
  ds_read_b64_tr_b16 a[170:171], v5 offset:14336
  v_rcp_f32 v27, v27
  v_mfma_f32_16x16x32_bf16 v[212:215], a[180:183], a[52:55], v[212:215]
  buffer_load_dwordx4 v32, s[36:39], s61 offen lds
  v_fma_f32 v28, v28, v19, v19
  v_rcp_f32 v28, v28
  v_mfma_f32_16x16x32_bf16 v[208:211], a[180:183], a[48:51], v[208:211]
  ds_read_b64_tr_b16 a[180:181], v2 offset:32768
  v_fma_f32 v29, v29, v19, v19
  v_fma_f32 v30, v30, v19, v19
  v_mfma_f32_16x16x32_bf16 v[208:211], a[176:179], a[32:35], v[208:211]
  s_waitcnt lgkmcnt(5)
  s_add_u32 m0, s45, 90112
  v_rcp_f32 v29, v29
  v_mfma_f32_16x16x32_bf16 v[224:227], a[164:167], a[32:35], v[224:227]
  ds_read_b64_tr_b16 a[182:183], v2 offset:34816
  v_fma_f32 v31, v31, v19, v19
  v_mfma_f32_16x16x32_bf16 v[224:227], a[160:163], a[48:51], v[224:227]
  buffer_load_dwordx4 v33, s[36:39], s65 offen lds
  v_rcp_f32 v30, v30
  v_mul_f32 v112, v112, v24
  v_mfma_f32_16x16x32_bf16 v[228:231], a[160:163], a[52:55], v[228:231]
  ds_read_b64_tr_b16 a[176:177], v2 offset:36864
  v_rcp_f32 v31, v31
  v_mfma_f32_16x16x32_bf16 v[228:231], a[164:167], a[36:39], v[228:231]
  s_add_u32 m0, s45, 94208
  s_add_u32 s61, s65, 65536
  v_mul_f32 v113, v113, v25
  v_mul_f32 v114, v114, v26
  v_mfma_f32_16x16x32_bf16 v[232:235], a[164:167], a[40:43], v[232:235]
  ds_read_b64_tr_b16 a[178:179], v2 offset:38912
  v_mul_f32 v115, v115, v27
  v_mul_f32 v116, v116, v28
  v_mfma_f32_16x16x32_bf16 v[232:235], a[160:163], a[56:59], v[232:235]
  buffer_load_dwordx4 v33, s[36:39], s61 offen lds
  v_mul_f32 v117, v117, v29
  v_mul_f32 v118, v118, v30
  v_mul_f32 v119, v119, v31
  v_mfma_f32_16x16x32_bf16 v[236:239], a[160:163], a[60:63], v[236:239]
  ds_read_b64_tr_b16 a[160:161], v2 offset:40960
  v_cvt_pk_bf16_f32 v66, v112, v113
  v_cvt_pk_bf16_f32 v67, v114, v115
  v_mfma_f32_16x16x32_bf16 v[236:239], a[164:167], a[44:47], v[236:239]
  s_waitcnt lgkmcnt(5)
  s_cmp_eq_u32 s91, 2
  s_cselect_b32 s74, 12, 5
  s_lshl_b32 s66, s74, 17
  s_lshl_b32 s74, s74, 11
  s_add_u32 s74, s74, s84
  s_add_u32 m0, s45, 65536
  v_cvt_pk_bf16_f32 v70, v116, v117
  v_cvt_pk_bf16_f32 v71, v118, v119
  v_mfma_f32_16x16x32_bf16 v[252:255], a[172:175], a[44:47], v[252:255]
  ds_read_b64_tr_b16 a[162:163], v2 offset:43008
  v_fma_f32 v104, v104, v20, v60
  v_fma_f32 v105, v105, v20, v61
  v_mfma_f32_16x16x32_bf16 v[252:255], a[168:171], a[60:63], v[252:255]
  buffer_load_dwordx4 v32, s[36:39], s66 offen lds
  buffer_store_dwordx4 v[64:67], v1, s[8:11], s59 offen offset:0 sc1
  v_mfma_f32_16x16x32_bf16 v[248:251], a[168:171], a[56:59], v[248:251]
  ds_read_b64_tr_b16 a[164:165], v2 offset:45056
  v_exp_f32 v24, v104
  v_mfma_f32_16x16x32_bf16 v[248:251], a[172:175], a[40:43], v[248:251]
  s_add_u32 m0, s45, 69632
  s_add_u32 s61, s66, 65536
  v_exp_f32 v25, v105
  v_mfma_f32_16x16x32_bf16 v[244:247], a[172:175], a[36:39], v[244:247]
  ds_read_b64_tr_b16 a[166:167], v2 offset:47104
  s_add_u32 s55, s59, 262144
  buffer_store_dwordx4 v[68:71], v1, s[8:11], s55 offen offset:0 sc1
  v_mfma_f32_16x16x32_bf16 v[244:247], a[168:171], a[52:55], v[244:247]
  buffer_load_dwordx4 v32, s[36:39], s61 offen lds
  v_fma_f32 v106, v106, v20, v62
  v_exp_f32 v26, v106
  v_mfma_f32_16x16x32_bf16 v[240:243], a[168:171], a[48:51], v[240:243]
  ds_read_b64_tr_b16 a[168:169], v2 offset:49152
  v_fma_f32 v107, v107, v20, v63
  v_fma_f32 v108, v108, v22, v60
  v_mfma_f32_16x16x32_bf16 v[240:243], a[172:175], a[32:35], v[240:243]
  s_waitcnt lgkmcnt(5)
  s_add_u32 m0, s45, 73728
  v_exp_f32 v27, v107
  v_mfma_f32_16x16x32_bf16 v[128:131], a[180:183], a[64:67], v[128:131]
  ds_read_b64_tr_b16 a[170:171], v2 offset:51200
  v_fma_f32 v109, v109, v22, v61
  v_mfma_f32_16x16x32_bf16 v[128:131], a[176:179], a[80:83], v[128:131]
  buffer_load_dwordx4 v33, s[36:39], s66 offen lds
  v_exp_f32 v28, v108
  v_fma_f32 v110, v110, v22, v62
  v_mfma_f32_16x16x32_bf16 v[132:135], a[176:179], a[84:87], v[132:135]
  ds_read_b64_tr_b16 a[172:173], v2 offset:53248
  v_exp_f32 v29, v109
  v_mfma_f32_16x16x32_bf16 v[132:135], a[180:183], a[68:71], v[132:135]
  s_add_u32 m0, s45, 77824
  s_add_u32 s61, s66, 65536
  v_exp_f32 v30, v110
  v_mfma_f32_16x16x32_bf16 v[136:139], a[180:183], a[72:75], v[136:139]
  ds_read_b64_tr_b16 a[174:175], v2 offset:55296
  v_fma_f32 v111, v111, v22, v63
  v_mul_f32 v120, v104, v120
  v_mfma_f32_16x16x32_bf16 v[136:139], a[176:179], a[88:91], v[136:139]
  buffer_load_dwordx4 v33, s[36:39], s61 offen lds
  v_exp_f32 v31, v111
  v_mul_f32 v121, v105, v121
  v_mfma_f32_16x16x32_bf16 v[140:143], a[176:179], a[92:95], v[140:143]
  ds_read_b64_tr_b16 a[176:177], v2 offset:57344
  ds_read_b128 v[60:63], v12 offset:512
  v_mfma_f32_16x16x32_bf16 v[140:143], a[180:183], a[76:79], v[140:143]
  s_waitcnt lgkmcnt(6)
  v_mul_f32 v122, v106, v122
  v_mul_f32 v123, v107, v123
  v_mul_f32 v124, v108, v124
  v_mfma_f32_16x16x32_bf16 v[156:159], a[160:163], a[76:79], v[156:159]
  ds_read_b64_tr_b16 a[178:179], v2 offset:59392
  v_mul_f32 v125, v109, v125
  v_mul_f32 v126, v110, v126
  v_mfma_f32_16x16x32_bf16 v[156:159], a[164:167], a[92:95], v[156:159]
  v_mul_f32 v127, v111, v127
  v_fma_f32 v24, v24, v21, v21
  v_fma_f32 v25, v25, v21, v21
  v_mfma_f32_16x16x32_bf16 v[152:155], a[164:167], a[88:91], v[152:155]
  ds_read_b64_tr_b16 a[180:181], v2 offset:61440
  v_rcp_f32 v24, v24
  v_mfma_f32_16x16x32_bf16 v[152:155], a[160:163], a[72:75], v[152:155]
  v_rcp_f32 v25, v25
  v_fma_f32 v26, v26, v21, v21
  v_mfma_f32_16x16x32_bf16 v[148:151], a[160:163], a[68:71], v[148:151]
  ds_read_b64_tr_b16 a[182:183], v2 offset:63488
  v_rcp_f32 v26, v26
  v_mfma_f32_16x16x32_bf16 v[148:151], a[164:167], a[84:87], v[148:151]
  v_fma_f32 v27, v27, v21, v21
  v_rcp_f32 v27, v27
  v_mfma_f32_16x16x32_bf16 v[144:147], a[164:167], a[80:83], v[144:147]
  ds_read_b64_tr_b16 a[164:165], v2 offset:16384
  v_fma_f32 v28, v28, v23, v23
  v_fma_f32 v29, v29, v23, v23
  v_mfma_f32_16x16x32_bf16 v[144:147], a[160:163], a[64:67], v[144:147]
  s_waitcnt lgkmcnt(6)
  v_rcp_f32 v28, v28
  v_fma_f32 v30, v30, v23, v23
  v_mfma_f32_16x16x32_bf16 v[128:131], a[168:171], a[96:99], v[128:131]
  ds_read_b64_tr_b16 a[166:167], v2 offset:18432
  v_fma_f32 v31, v31, v23, v23
  v_mfma_f32_16x16x32_bf16 v[128:131], a[172:175], a[112:115], v[128:131]
  v_rcp_f32 v29, v29
  v_mul_f32 v120, v120, v24
  v_mfma_f32_16x16x32_bf16 v[132:135], a[172:175], a[116:119], v[132:135]
  ds_read_b64_tr_b16 a[160:161], v2 offset:20480
  v_rcp_f32 v30, v30
  v_mfma_f32_16x16x32_bf16 v[132:135], a[168:171], a[100:103], v[132:135]
  v_rcp_f32 v31, v31
  v_mul_f32 v121, v121, v25
  v_mfma_f32_16x16x32_bf16 v[136:139], a[168:171], a[104:107], v[136:139]
  ds_read_b64_tr_b16 a[162:163], v2 offset:22528
  v_mul_f32 v122, v122, v26
  v_mul_f32 v123, v123, v27
  v_mfma_f32_16x16x32_bf16 v[136:139], a[172:175], a[120:123], v[136:139]
  v_mul_f32 v124, v124, v28
  v_mul_f32 v125, v125, v29
  v_mul_f32 v126, v126, v30
  v_mfma_f32_16x16x32_bf16 v[140:143], a[172:175], a[124:127], v[140:143]
  ds_read_b64_tr_b16 a[172:173], v2 offset:24576
  v_mul_f32 v127, v127, v31
  v_cvt_pk_bf16_f32 v74, v120, v121
  v_mfma_f32_16x16x32_bf16 v[140:143], a[168:171], a[108:111], v[140:143]
  s_waitcnt lgkmcnt(5)
  v_cvt_pk_bf16_f32 v75, v122, v123
  v_cvt_pk_bf16_f32 v78, v124, v125
  v_cvt_pk_bf16_f32 v79, v126, v127
  v_mfma_f32_16x16x32_bf16 v[156:159], a[176:179], a[108:111], v[156:159]
  ds_read_b64_tr_b16 a[174:175], v2 offset:26624
  v_mfma_f32_16x16x32_bf16 v[156:159], a[180:183], a[124:127], v[156:159]
  s_add_u32 s55, s59, 524288
  buffer_store_dwordx4 v[72:75], v1, s[8:11], s55 offen offset:0 sc1
  v_mfma_f32_16x16x32_bf16 v[152:155], a[180:183], a[120:123], v[152:155]
  ds_read_b64_tr_b16 a[168:169], v2 offset:28672
  v_mfma_f32_16x16x32_bf16 v[152:155], a[176:179], a[104:107], v[152:155]
  s_add_u32 s55, s59, 786432
  buffer_store_dwordx4 v[76:79], v1, s[8:11], s55 offen offset:0 sc1
  v_mfma_f32_16x16x32_bf16 v[148:151], a[176:179], a[100:103], v[148:151]
  ds_read_b64_tr_b16 a[170:171], v2 offset:30720
  v_mfma_f32_16x16x32_bf16 v[148:151], a[180:183], a[116:119], v[148:151]
  s_waitcnt vmcnt(16)
  s_barrier
  v_mfma_f32_16x16x32_bf16 v[144:147], a[180:183], a[112:115], v[144:147]
  ds_read_b64_tr_b16 a[180:181], v6 offset:32768
  s_cmp_eq_u32 s91, 0
  s_cselect_b32 s75, 1, 8
  s_lshl_b32 s67, s75, 17
  s_lshl_b32 s75, s75, 11
  s_add_u32 s75, s75, s84
  s_add_u32 m0, s45, 0
  v_mfma_f32_16x16x32_bf16 v[144:147], a[176:179], a[96:99], v[144:147]
  s_waitcnt lgkmcnt(5)
  buffer_load_dwordx4 v32, s[36:39], s67 offen lds
  v_mfma_f32_16x16x32_bf16 v[128:131], a[164:167], a[128:131], v[128:131]
  ds_read_b64_tr_b16 a[182:183], v6 offset:34816
  v_mfma_f32_16x16x32_bf16 v[128:131], a[160:163], a[144:147], v[128:131]
  s_add_u32 m0, s45, 4096
  s_add_u32 s61, s67, 65536
  v_mfma_f32_16x16x32_bf16 v[132:135], a[160:163], a[148:151], v[132:135]
  ds_read_b64_tr_b16 a[176:177], v6 offset:36864
  v_mfma_f32_16x16x32_bf16 v[132:135], a[164:167], a[132:135], v[132:135]
  buffer_load_dwordx4 v32, s[36:39], s61 offen lds
  v_mfma_f32_16x16x32_bf16 v[136:139], a[164:167], a[136:139], v[136:139]
  ds_read_b64_tr_b16 a[178:179], v6 offset:38912
  v_mfma_f32_16x16x32_bf16 v[136:139], a[160:163], a[152:155], v[136:139]
  s_add_u32 m0, s45, 8192
  v_mfma_f32_16x16x32_bf16 v[140:143], a[160:163], a[156:159], v[140:143]
  ds_read_b64_tr_b16 a[160:161], v6 offset:40960
  v_mfma_f32_16x16x32_bf16 v[140:143], a[164:167], a[140:143], v[140:143]
  s_waitcnt lgkmcnt(5)
  buffer_load_dwordx4 v33, s[36:39], s67 offen lds
  v_mfma_f32_16x16x32_bf16 v[156:159], a[172:175], a[140:143], v[156:159]
  ds_read_b64_tr_b16 a[162:163], v6 offset:43008
  v_mfma_f32_16x16x32_bf16 v[156:159], a[168:171], a[156:159], v[156:159]
  s_add_u32 m0, s45, 12288
  s_add_u32 s61, s67, 65536
  v_mfma_f32_16x16x32_bf16 v[152:155], a[168:171], a[152:155], v[152:155]
  ds_read_b64_tr_b16 a[164:165], v6 offset:45056
  v_mfma_f32_16x16x32_bf16 v[152:155], a[172:175], a[136:139], v[152:155]
  buffer_load_dwordx4 v33, s[36:39], s61 offen lds
  v_mfma_f32_16x16x32_bf16 v[148:151], a[172:175], a[132:135], v[148:151]
  ds_read_b64_tr_b16 a[166:167], v6 offset:47104
  v_mfma_f32_16x16x32_bf16 v[148:151], a[168:171], a[148:151], v[148:151]
  v_mfma_f32_16x16x32_bf16 v[144:147], a[168:171], a[144:147], v[144:147]
  ds_read_b64_tr_b16 a[168:169], v3 offset:32768
  v_mfma_f32_16x16x32_bf16 v[144:147], a[172:175], a[128:131], v[144:147]
  s_waitcnt lgkmcnt(5)
  v_mfma_f32_16x16x32_bf16 v[128:131], a[180:183], a[188:191], v[128:131]
  ds_read_b64_tr_b16 a[170:171], v3 offset:34816
  v_mfma_f32_16x16x32_bf16 v[128:131], a[176:179], a[204:207], v[128:131]
  v_mfma_f32_16x16x32_bf16 v[132:135], a[176:179], a[208:211], v[132:135]
  ds_read_b64_tr_b16 a[172:173], v3 offset:36864
  v_mfma_f32_16x16x32_bf16 v[132:135], a[180:183], a[192:195], v[132:135]
  v_mfma_f32_16x16x32_bf16 v[136:139], a[180:183], a[196:199], v[136:139]
  ds_read_b64_tr_b16 a[174:175], v3 offset:38912
  v_mfma_f32_16x16x32_bf16 v[136:139], a[176:179], a[212:215], v[136:139]
  v_mfma_f32_16x16x32_bf16 v[140:143], a[176:179], a[216:219], v[140:143]
  ds_read_b64_tr_b16 a[176:177], v3 offset:40960
  v_mfma_f32_16x16x32_bf16 v[140:143], a[180:183], a[200:203], v[140:143]
  s_waitcnt lgkmcnt(5)
  v_mfma_f32_16x16x32_bf16 v[156:159], a[160:163], a[200:203], v[156:159]
  ds_read_b64_tr_b16 a[178:179], v3 offset:43008
  v_mfma_f32_16x16x32_bf16 v[156:159], a[164:167], a[216:219], v[156:159]
  v_mfma_f32_16x16x32_bf16 v[152:155], a[164:167], a[212:215], v[152:155]
  ds_read_b64_tr_b16 a[180:181], v3 offset:45056
  v_mfma_f32_16x16x32_bf16 v[152:155], a[160:163], a[196:199], v[152:155]
  v_mfma_f32_16x16x32_bf16 v[148:151], a[160:163], a[192:195], v[148:151]
  ds_read_b64_tr_b16 a[182:183], v3 offset:47104
  v_mfma_f32_16x16x32_bf16 v[148:151], a[164:167], a[208:211], v[148:151]
  v_mfma_f32_16x16x32_bf16 v[144:147], a[164:167], a[204:207], v[144:147]
  ds_read_b64_tr_b16 a[164:165], v3 offset:49152
  v_mfma_f32_16x16x32_bf16 v[144:147], a[160:163], a[188:191], v[144:147]
  s_waitcnt lgkmcnt(5)
  v_mfma_f32_16x16x32_bf16 v[160:163], a[168:171], a[64:67], v[160:163]
  ds_read_b64_tr_b16 a[166:167], v3 offset:51200
  v_mfma_f32_16x16x32_bf16 v[160:163], a[172:175], a[80:83], v[160:163]
  v_mfma_f32_16x16x32_bf16 v[164:167], a[172:175], a[84:87], v[164:167]
  ds_read_b64_tr_b16 a[160:161], v3 offset:53248
  s_waitcnt lgkmcnt(15)
  v_mfma_f32_16x16x32_bf16 v[164:167], a[168:171], a[68:71], v[164:167]
  v_fma_f32 v128, v128, v16, v60
  v_fma_f32 v129, v129, v16, v61
  v_mfma_f32_16x16x32_bf16 v[168:171], a[168:171], a[72:75], v[168:171]
  ds_read_b64_tr_b16 a[162:163], v3 offset:55296
  v_fma_f32 v130, v130, v16, v62
  v_mfma_f32_16x16x32_bf16 v[168:171], a[172:175], a[88:91], v[168:171]
  v_exp_f32 v24, v128
  v_mfma_f32_16x16x32_bf16 v[172:175], a[172:175], a[92:95], v[172:175]
  ds_read_b64_tr_b16 a[172:173], v3 offset:57344
  v_fma_f32 v131, v131, v16, v63
  v_mfma_f32_16x16x32_bf16 v[172:175], a[168:171], a[76:79], v[172:175]
  s_waitcnt lgkmcnt(5)
  v_exp_f32 v25, v129
  v_mfma_f32_16x16x32_bf16 v[188:191], a[176:179], a[76:79], v[188:191]
  ds_read_b64_tr_b16 a[174:175], v3 offset:59392
  v_fma_f32 v132, v132, v18, v60
  v_mfma_f32_16x16x32_bf16 v[188:191], a[180:183], a[92:95], v[188:191]
  v_exp_f32 v26, v130
  v_mfma_f32_16x16x32_bf16 v[184:187], a[180:183], a[88:91], v[184:187]
  ds_read_b64_tr_b16 a[168:169], v3 offset:61440
  v_fma_f32 v133, v133, v18, v61
  v_mfma_f32_16x16x32_bf16 v[184:187], a[176:179], a[72:75], v[184:187]
  v_exp_f32 v27, v131
  v_mfma_f32_16x16x32_bf16 v[180:183], a[176:179], a[68:71], v[180:183]
  ds_read_b64_tr_b16 a[170:171], v3 offset:63488
  v_fma_f32 v134, v134, v18, v62
  v_mfma_f32_16x16x32_bf16 v[180:183], a[180:183], a[84:87], v[180:183]
  v_exp_f32 v28, v132
  v_mfma_f32_16x16x32_bf16 v[176:179], a[180:183], a[80:83], v[176:179]
  ds_read_b64_tr_b16 a[180:181], v3 offset:16384
  v_fma_f32 v135, v135, v18, v63
  v_mfma_f32_16x16x32_bf16 v[176:179], a[176:179], a[64:67], v[176:179]
  s_waitcnt lgkmcnt(5)
  v_exp_f32 v29, v133
  v_mul_f32 v144, v128, v144
  v_mfma_f32_16x16x32_bf16 v[160:163], a[164:167], a[96:99], v[160:163]
  ds_read_b64_tr_b16 a[182:183], v3 offset:18432
  v_mul_f32 v145, v129, v145
  v_mfma_f32_16x16x32_bf16 v[160:163], a[160:163], a[112:115], v[160:163]
  v_exp_f32 v30, v134
  v_mfma_f32_16x16x32_bf16 v[164:167], a[160:163], a[116:119], v[164:167]
  ds_read_b64_tr_b16 a[176:177], v3 offset:20480
  v_mul_f32 v146, v130, v146
  v_mfma_f32_16x16x32_bf16 v[164:167], a[164:167], a[100:103], v[164:167]
  v_exp_f32 v31, v135
  v_mfma_f32_16x16x32_bf16 v[168:171], a[164:167], a[104:107], v[168:171]
  ds_read_b64_tr_b16 a[178:179], v3 offset:22528
  v_add_u32 v38, s46, v0
  s_waitcnt vmcnt(4)
  s_barrier
  s_mov_b64 exec, 1
  buffer_store_dword v38, v0, s[8:11], s80 offen offset:0 sc1
  s_mov_b64 exec, -1
  v_mfma_f32_16x16x32_bf16 v[168:171], a[160:163], a[120:123], v[168:171]
  v_mul_f32 v147, v131, v147
  v_mul_f32 v148, v132, v148
  v_mfma_f32_16x16x32_bf16 v[172:175], a[160:163], a[124:127], v[172:175]
  ds_read_b64_tr_b16 a[160:161], v3 offset:24576
  v_mul_f32 v149, v133, v149
  v_mfma_f32_16x16x32_bf16 v[172:175], a[164:167], a[108:111], v[172:175]
  s_waitcnt lgkmcnt(5)
  v_mul_f32 v150, v134, v150
  v_mul_f32 v151, v135, v151
  v_mfma_f32_16x16x32_bf16 v[188:191], a[172:175], a[108:111], v[188:191]
  ds_read_b64_tr_b16 a[162:163], v3 offset:26624
  v_fma_f32 v24, v24, v17, v17
  v_mfma_f32_16x16x32_bf16 v[188:191], a[168:171], a[124:127], v[188:191]
  v_rcp_f32 v24, v24
  v_mfma_f32_16x16x32_bf16 v[184:187], a[168:171], a[120:123], v[184:187]
  ds_read_b64_tr_b16 a[164:165], v3 offset:28672
  v_fma_f32 v25, v25, v17, v17
  v_mfma_f32_16x16x32_bf16 v[184:187], a[172:175], a[104:107], v[184:187]
  v_rcp_f32 v25, v25
  v_mfma_f32_16x16x32_bf16 v[180:183], a[172:175], a[100:103], v[180:183]
  ds_read_b64_tr_b16 a[166:167], v3 offset:30720
  v_fma_f32 v26, v26, v17, v17
  v_mfma_f32_16x16x32_bf16 v[180:183], a[168:171], a[116:119], v[180:183]
  v_rcp_f32 v26, v26
  v_mfma_f32_16x16x32_bf16 v[176:179], a[168:171], a[112:115], v[176:179]
  ds_read_b64_tr_b16 a[168:169], v7 offset:32768
  v_fma_f32 v27, v27, v17, v17
  v_mfma_f32_16x16x32_bf16 v[176:179], a[172:175], a[96:99], v[176:179]
  s_waitcnt lgkmcnt(5)
  v_rcp_f32 v27, v27
  v_fma_f32 v28, v28, v19, v19
  v_mfma_f32_16x16x32_bf16 v[160:163], a[180:183], a[128:131], v[160:163]
  ds_read_b64_tr_b16 a[170:171], v7 offset:34816
  v_fma_f32 v29, v29, v19, v19
  v_mfma_f32_16x16x32_bf16 v[160:163], a[176:179], a[144:147], v[160:163]
  v_rcp_f32 v28, v28
  v_mfma_f32_16x16x32_bf16 v[164:167], a[176:179], a[148:151], v[164:167]
  ds_read_b64_tr_b16 a[172:173], v7 offset:36864
  v_fma_f32 v30, v30, v19, v19
  v_mfma_f32_16x16x32_bf16 v[164:167], a[180:183], a[132:135], v[164:167]
  v_rcp_f32 v29, v29
  v_mfma_f32_16x16x32_bf16 v[168:171], a[180:183], a[136:139], v[168:171]
  ds_read_b64_tr_b16 a[174:175], v7 offset:38912
  v_fma_f32 v31, v31, v19, v19
  v_mfma_f32_16x16x32_bf16 v[168:171], a[176:179], a[152:155], v[168:171]
  v_rcp_f32 v30, v30
  v_mfma_f32_16x16x32_bf16 v[172:175], a[176:179], a[156:159], v[172:175]
  ds_read_b64_tr_b16 a[176:177], v7 offset:40960
  v_mul_f32 v144, v144, v24
  v_mfma_f32_16x16x32_bf16 v[172:175], a[180:183], a[140:143], v[172:175]
  s_waitcnt lgkmcnt(5)
  v_rcp_f32 v31, v31
  v_mfma_f32_16x16x32_bf16 v[188:191], a[160:163], a[140:143], v[188:191]
  ds_read_b64_tr_b16 a[178:179], v7 offset:43008
  v_mul_f32 v145, v145, v25
  v_mfma_f32_16x16x32_bf16 v[188:191], a[164:167], a[156:159], v[188:191]
  v_mul_f32 v146, v146, v26
  v_mul_f32 v147, v147, v27
  v_mfma_f32_16x16x32_bf16 v[184:187], a[164:167], a[152:155], v[184:187]
  ds_read_b64_tr_b16 a[180:181], v7 offset:45056
  v_mul_f32 v148, v148, v28
  v_mfma_f32_16x16x32_bf16 v[184:187], a[160:163], a[136:139], v[184:187]
  v_mul_f32 v149, v149, v29
  v_mul_f32 v150, v150, v30
  v_mfma_f32_16x16x32_bf16 v[180:183], a[160:163], a[132:135], v[180:183]
  ds_read_b64_tr_b16 a[182:183], v7 offset:47104
  v_mul_f32 v151, v151, v31
  v_mfma_f32_16x16x32_bf16 v[180:183], a[164:167], a[148:151], v[180:183]
  v_cvt_pk_bf16_f32 v128, v144, v145
  v_cvt_pk_bf16_f32 v129, v146, v147
  v_mfma_f32_16x16x32_bf16 v[176:179], a[164:167], a[144:147], v[176:179]
  ds_read_b64_tr_b16 a[164:165], v4 offset:32768
  v_cvt_pk_bf16_f32 v132, v148, v149
  v_mfma_f32_16x16x32_bf16 v[176:179], a[160:163], a[128:131], v[176:179]
  s_waitcnt lgkmcnt(5)
  v_cvt_pk_bf16_f32 v133, v150, v151
  v_fma_f32 v136, v136, v20, v60
  v_fma_f32 v137, v137, v20, v61
  v_mfma_f32_16x16x32_bf16 v[160:163], a[168:171], a[188:191], v[160:163]
  ds_read_b64_tr_b16 a[166:167], v4 offset:34816
  v_fma_f32 v138, v138, v20, v62
  v_mfma_f32_16x16x32_bf16 v[160:163], a[172:175], a[204:207], v[160:163]
  v_exp_f32 v24, v136
  v_mfma_f32_16x16x32_bf16 v[164:167], a[172:175], a[208:211], v[164:167]
  ds_read_b64_tr_b16 a[160:161], v4 offset:36864
  v_fma_f32 v139, v139, v20, v63
  v_mfma_f32_16x16x32_bf16 v[164:167], a[168:171], a[192:195], v[164:167]
  v_exp_f32 v25, v137
  v_mfma_f32_16x16x32_bf16 v[168:171], a[168:171], a[196:199], v[168:171]
  ds_read_b64_tr_b16 a[162:163], v4 offset:38912
  v_fma_f32 v140, v140, v22, v60
  v_mfma_f32_16x16x32_bf16 v[168:171], a[172:175], a[212:215], v[168:171]
  v_exp_f32 v26, v138
  v_mfma_f32_16x16x32_bf16 v[172:175], a[172:175], a[216:219], v[172:175]
  ds_read_b64_tr_b16 a[172:173], v4 offset:40960
  v_fma_f32 v141, v141, v22, v61
  v_mfma_f32_16x16x32_bf16 v[172:175], a[168:171], a[200:203], v[172:175]
  s_waitcnt lgkmcnt(5)
  v_exp_f32 v27, v139
  v_mfma_f32_16x16x32_bf16 v[188:191], a[176:179], a[200:203], v[188:191]
  ds_read_b64_tr_b16 a[174:175], v4 offset:43008
  v_fma_f32 v142, v142, v22, v62
  v_mfma_f32_16x16x32_bf16 v[188:191], a[180:183], a[216:219], v[188:191]
  v_exp_f32 v28, v140
  v_mfma_f32_16x16x32_bf16 v[184:187], a[180:183], a[212:215], v[184:187]
  ds_read_b64_tr_b16 a[168:169], v4 offset:45056
  v_fma_f32 v143, v143, v22, v63
  v_mfma_f32_16x16x32_bf16 v[184:187], a[176:179], a[196:199], v[184:187]
  v_exp_f32 v29, v141
  v_mfma_f32_16x16x32_bf16 v[180:183], a[176:179], a[192:195], v[180:183]
  ds_read_b64_tr_b16 a[170:171], v4 offset:47104
  v_mul_f32 v152, v136, v152
  v_mfma_f32_16x16x32_bf16 v[180:183], a[180:183], a[208:211], v[180:183]
  v_exp_f32 v30, v142
  v_mfma_f32_16x16x32_bf16 v[176:179], a[180:183], a[204:207], v[176:179]
  ds_read_b64_tr_b16 a[180:181], v4 offset:49152
  v_mul_f32 v153, v137, v153
  v_mfma_f32_16x16x32_bf16 v[176:179], a[176:179], a[188:191], v[176:179]
  s_waitcnt lgkmcnt(5)
  v_exp_f32 v31, v143
  v_mul_f32 v154, v138, v154
  v_mfma_f32_16x16x32_bf16 v[192:195], a[164:167], a[64:67], v[192:195]
  ds_read_b64_tr_b16 a[182:183], v4 offset:51200
  ds_read_b128 v[60:63], v12 offset:576
  v_mfma_f32_16x16x32_bf16 v[192:195], a[160:163], a[80:83], v[192:195]
  v_mul_f32 v155, v139, v155
  v_mul_f32 v156, v140, v156
  v_mfma_f32_16x16x32_bf16 v[196:199], a[160:163], a[84:87], v[196:199]
  ds_read_b64_tr_b16 a[176:177], v4 offset:53248
  v_mul_f32 v157, v141, v157
  v_mfma_f32_16x16x32_bf16 v[196:199], a[164:167], a[68:71], v[196:199]
  v_mul_f32 v158, v142, v158
  v_mul_f32 v159, v143, v159
  v_mfma_f32_16x16x32_bf16 v[200:203], a[164:167], a[72:75], v[200:203]
  ds_read_b64_tr_b16 a[178:179], v4 offset:55296
  v_fma_f32 v24, v24, v21, v21
  v_mfma_f32_16x16x32_bf16 v[200:203], a[160:163], a[88:91], v[200:203]
  v_rcp_f32 v24, v24
  v_mfma_f32_16x16x32_bf16 v[204:207], a[160:163], a[92:95], v[204:207]
  ds_read_b64_tr_b16 a[160:161], v4 offset:57344
  v_fma_f32 v25, v25, v21, v21
  v_mfma_f32_16x16x32_bf16 v[204:207], a[164:167], a[76:79], v[204:207]
  s_waitcnt lgkmcnt(6)
  v_rcp_f32 v25, v25
  v_mfma_f32_16x16x32_bf16 v[220:223], a[172:175], a[76:79], v[220:223]
  ds_read_b64_tr_b16 a[162:163], v4 offset:59392
  v_fma_f32 v26, v26, v21, v21
  v_mfma_f32_16x16x32_bf16 v[220:223], a[168:171], a[92:95], v[220:223]
  v_rcp_f32 v26, v26
  v_mfma_f32_16x16x32_bf16 v[216:219], a[168:171], a[88:91], v[216:219]
  ds_read_b64_tr_b16 a[164:165], v4 offset:61440
  v_fma_f32 v27, v27, v21, v21
  v_mfma_f32_16x16x32_bf16 v[216:219], a[172:175], a[72:75], v[216:219]
  v_rcp_f32 v27, v27
  v_mfma_f32_16x16x32_bf16 v[212:215], a[172:175], a[68:71], v[212:215]
  ds_read_b64_tr_b16 a[166:167], v4 offset:63488
  v_fma_f32 v28, v28, v23, v23
  v_mfma_f32_16x16x32_bf16 v[212:215], a[168:171], a[84:87], v[212:215]
  v_rcp_f32 v28, v28
  v_mfma_f32_16x16x32_bf16 v[208:211], a[168:171], a[80:83], v[208:211]
  ds_read_b64_tr_b16 a[168:169], v4 offset:16384
  v_fma_f32 v29, v29, v23, v23
  v_mfma_f32_16x16x32_bf16 v[208:211], a[172:175], a[64:67], v[208:211]
  s_waitcnt lgkmcnt(5)
  v_rcp_f32 v29, v29
  v_fma_f32 v30, v30, v23, v23
  v_mfma_f32_16x16x32_bf16 v[192:195], a[180:183], a[96:99], v[192:195]
  ds_read_b64_tr_b16 a[170:171], v4 offset:18432
  v_fma_f32 v31, v31, v23, v23
  v_mfma_f32_16x16x32_bf16 v[192:195], a[176:179], a[112:115], v[192:195]
  v_rcp_f32 v30, v30
  v_mfma_f32_16x16x32_bf16 v[196:199], a[176:179], a[116:119], v[196:199]
  ds_read_b64_tr_b16 a[172:173], v4 offset:20480
  v_mul_f32 v152, v152, v24
  v_mfma_f32_16x16x32_bf16 v[196:199], a[180:183], a[100:103], v[196:199]
  v_rcp_f32 v31, v31
  v_mfma_f32_16x16x32_bf16 v[200:203], a[180:183], a[104:107], v[200:203]
  ds_read_b64_tr_b16 a[174:175], v4 offset:22528
  v_mul_f32 v153, v153, v25
  v_mfma_f32_16x16x32_bf16 v[200:203], a[176:179], a[120:123], v[200:203]
  v_mul_f32 v154, v154, v26
  v_mul_f32 v155, v155, v27
  v_mfma_f32_16x16x32_bf16 v[204:207], a[176:179], a[124:127], v[204:207]
  ds_read_b64_tr_b16 a[176:177], v4 offset:24576
HOP15:
  s_cbranch_execz HOP19
  v_mul_f32 v156, v156, v28
  v_mfma_f32_16x16x32_bf16 v[204:207], a[180:183], a[108:111], v[204:207]
  s_waitcnt lgkmcnt(5)
  v_mul_f32 v157, v157, v29
  v_mul_f32 v158, v158, v30
  v_mfma_f32_16x16x32_bf16 v[220:223], a[160:163], a[108:111], v[220:223]
  ds_read_b64_tr_b16 a[178:179], v4 offset:26624
  v_mul_f32 v159, v159, v31
  v_mfma_f32_16x16x32_bf16 v[220:223], a[164:167], a[124:127], v[220:223]
  v_cvt_pk_bf16_f32 v136, v152, v153
  v_cvt_pk_bf16_f32 v137, v154, v155
  v_mfma_f32_16x16x32_bf16 v[216:219], a[164:167], a[120:123], v[216:219]
  ds_read_b64_tr_b16 a[180:181], v4 offset:28672
  v_cvt_pk_bf16_f32 v140, v156, v157
  v_mfma_f32_16x16x32_bf16 v[216:219], a[160:163], a[104:107], v[216:219]
  v_cvt_pk_bf16_f32 v141, v158, v159
  v_mfma_f32_16x16x32_bf16 v[212:215], a[160:163], a[100:103], v[212:215]
  ds_read_b64_tr_b16 a[182:183], v4 offset:30720
  s_lshl_b32 s83, s44, 28
  s_add_u32 s83, s83, s82
  buffer_load_dword v36, v37, s[8:11], s83 offen sc1
  v_mfma_f32_16x16x32_bf16 v[212:215], a[164:167], a[116:119], v[212:215]
  s_waitcnt lgkmcnt(14)
  v_fma_f32 v160, v160, v16, v60
  v_fma_f32 v161, v161, v16, v61
  v_mfma_f32_16x16x32_bf16 v[208:211], a[164:167], a[112:115], v[208:211]
  ds_read_b64_tr_b16 a[164:165], v8 offset:32768
  v_fma_f32 v162, v162, v16, v62
  v_mfma_f32_16x16x32_bf16 v[208:211], a[160:163], a[96:99], v[208:211]
  s_waitcnt lgkmcnt(5)
  v_exp_f32 v24, v160
  v_fma_f32 v163, v163, v16, v63
  v_mfma_f32_16x16x32_bf16 v[192:195], a[168:171], a[128:131], v[192:195]
  ds_read_b64_tr_b16 a[166:167], v8 offset:34816
  v_fma_f32 v164, v164, v18, v60
  v_mfma_f32_16x16x32_bf16 v[192:195], a[172:175], a[144:147], v[192:195]
  v_exp_f32 v25, v161
  v_mfma_f32_16x16x32_bf16 v[196:199], a[172:175], a[148:151], v[196:199]
  ds_read_b64_tr_b16 a[160:161], v8 offset:36864
  v_fma_f32 v165, v165, v18, v61
  v_mfma_f32_16x16x32_bf16 v[196:199], a[168:171], a[132:135], v[196:199]
  v_exp_f32 v26, v162
  v_fma_f32 v166, v166, v18, v62
  v_mfma_f32_16x16x32_bf16 v[200:203], a[168:171], a[136:139], v[200:203]
  ds_read_b64_tr_b16 a[162:163], v8 offset:38912
  v_fma_f32 v167, v167, v18, v63
  v_mfma_f32_16x16x32_bf16 v[200:203], a[172:175], a[152:155], v[200:203]
  v_exp_f32 v27, v163
  v_mfma_f32_16x16x32_bf16 v[204:207], a[172:175], a[156:159], v[204:207]
  ds_read_b64_tr_b16 a[172:173], v8 offset:40960
  v_mul_f32 v176, v160, v176
  v_mfma_f32_16x16x32_bf16 v[204:207], a[168:171], a[140:143], v[204:207]
  s_waitcnt lgkmcnt(5)
  v_exp_f32 v28, v164
  v_mul_f32 v177, v161, v177
  v_mfma_f32_16x16x32_bf16 v[220:223], a[176:179], a[140:143], v[220:223]
  ds_read_b64_tr_b16 a[174:175], v8 offset:43008
  v_mul_f32 v178, v162, v178
  v_mfma_f32_16x16x32_bf16 v[220:223], a[180:183], a[156:159], v[220:223]
  v_exp_f32 v29, v165
  v_mfma_f32_16x16x32_bf16 v[216:219], a[180:183], a[152:155], v[216:219]
  ds_read_b64_tr_b16 a[168:169], v8 offset:45056
  v_mul_f32 v179, v163, v179
  v_mfma_f32_16x16x32_bf16 v[216:219], a[176:179], a[136:139], v[216:219]
  v_exp_f32 v30, v166
  v_mul_f32 v180, v164, v180
  v_mfma_f32_16x16x32_bf16 v[212:215], a[176:179], a[132:135], v[212:215]
  ds_read_b64_tr_b16 a[170:171], v8 offset:47104
  v_mul_f32 v181, v165, v181
  v_mfma_f32_16x16x32_bf16 v[212:215], a[180:183], a[148:151], v[212:215]
  v_exp_f32 v31, v167
  v_mfma_f32_16x16x32_bf16 v[208:211], a[180:183], a[144:147], v[208:211]
  ds_read_b64_tr_b16 a[180:181], v5 offset:32768
  v_mul_f32 v182, v166, v182
  v_mfma_f32_16x16x32_bf16 v[208:211], a[176:179], a[128:131], v[208:211]
  s_waitcnt lgkmcnt(5)
  v_mul_f32 v183, v167, v183
  v_fma_f32 v24, v24, v17, v17
  v_fma_f32 v25, v25, v17, v17
  v_mfma_f32_16x16x32_bf16 v[192:195], a[164:167], a[188:191], v[192:195]
  ds_read_b64_tr_b16 a[182:183], v5 offset:34816
  v_fma_f32 v26, v26, v17, v17
  v_mfma_f32_16x16x32_bf16 v[192:195], a[160:163], a[204:207], v[192:195]
  v_rcp_f32 v24, v24
  v_mfma_f32_16x16x32_bf16 v[196:199], a[160:163], a[208:211], v[196:199]
  ds_read_b64_tr_b16 a[176:177], v5 offset:36864
  v_fma_f32 v27, v27, v17, v17
  v_mfma_f32_16x16x32_bf16 v[196:199], a[164:167], a[192:195], v[196:199]
  v_rcp_f32 v25, v25
  v_fma_f32 v28, v28, v19, v19
  v_mfma_f32_16x16x32_bf16 v[200:203], a[164:167], a[196:199], v[200:203]
  ds_read_b64_tr_b16 a[178:179], v5 offset:38912
  v_fma_f32 v29, v29, v19, v19
  v_mfma_f32_16x16x32_bf16 v[200:203], a[160:163], a[212:215], v[200:203]
  v_rcp_f32 v26, v26
  v_mfma_f32_16x16x32_bf16 v[204:207], a[160:163], a[216:219], v[204:207]
  ds_read_b64_tr_b16 a[160:161], v5 offset:40960
  v_fma_f32 v30, v30, v19, v19
  v_mfma_f32_16x16x32_bf16 v[204:207], a[164:167], a[200:203], v[204:207]
  s_waitcnt lgkmcnt(5)
  v_rcp_f32 v27, v27
  v_fma_f32 v31, v31, v19, v19
  v_mfma_f32_16x16x32_bf16 v[220:223], a[172:175], a[200:203], v[220:223]
  ds_read_b64_tr_b16 a[162:163], v5 offset:43008
  v_mul_f32 v176, v176, v24
  v_mfma_f32_16x16x32_bf16 v[220:223], a[168:171], a[216:219], v[220:223]
  v_rcp_f32 v28, v28
  v_mfma_f32_16x16x32_bf16 v[216:219], a[168:171], a[212:215], v[216:219]
  ds_read_b64_tr_b16 a[164:165], v5 offset:45056
  v_mul_f32 v177, v177, v25
  v_mfma_f32_16x16x32_bf16 v[216:219], a[172:175], a[196:199], v[216:219]
  v_rcp_f32 v29, v29
  v_mul_f32 v178, v178, v26
  v_mfma_f32_16x16x32_bf16 v[212:215], a[172:175], a[192:195], v[212:215]
  ds_read_b64_tr_b16 a[166:167], v5 offset:47104
  v_mul_f32 v179, v179, v27
  v_mfma_f32_16x16x32_bf16 v[212:215], a[168:171], a[208:211], v[212:215]
  v_rcp_f32 v30, v30
  v_mfma_f32_16x16x32_bf16 v[208:211], a[168:171], a[204:207], v[208:211]
  ds_read_b64_tr_b16 a[168:169], v5 offset:49152
  v_mul_f32 v180, v180, v28
  v_mfma_f32_16x16x32_bf16 v[208:211], a[172:175], a[188:191], v[208:211]
  s_waitcnt lgkmcnt(5)
  v_rcp_f32 v31, v31
  v_mul_f32 v181, v181, v29
  v_mfma_f32_16x16x32_bf16 v[224:227], a[180:183], a[64:67], v[224:227]
  ds_read_b64_tr_b16 a[170:171], v5 offset:51200
  v_mul_f32 v182, v182, v30
  v_mfma_f32_16x16x32_bf16 v[224:227], a[176:179], a[80:83], v[224:227]
  v_mul_f32 v183, v183, v31
  v_cvt_pk_bf16_f32 v130, v176, v177
  v_mfma_f32_16x16x32_bf16 v[228:231], a[176:179], a[84:87], v[228:231]
  ds_read_b64_tr_b16 a[172:173], v5 offset:53248
  v_cvt_pk_bf16_f32 v131, v178, v179
  v_mfma_f32_16x16x32_bf16 v[228:231], a[180:183], a[68:71], v[228:231]
  buffer_store_dwordx4 v[128:131], v1, s[8:11], s58 offen offset:0 sc1
  v_mfma_f32_16x16x32_bf16 v[232:235], a[180:183], a[72:75], v[232:235]
  ds_read_b64_tr_b16 a[174:175], v5 offset:55296
  s_waitcnt vmcnt(1)
  s_cmp_lg_u32 s44, 0
  s_cbranch_scc1 PL12_adaLN_cond__sliding_local_dilated__swiglu_ffn__prompt_kernelx
  v_cmp_ne_u32 vcc, s46, v36
  s_nop 4
  s_cbranch_vccz PL12_adaLN_cond__sliding_local_dilated__swiglu_ffn__prompt_kernelx
  s_mov_b32 s83, 60000
PL12_adaLN_cond__sliding_local_dilated__swiglu_ffn__prompt_kernel:
  buffer_load_dword v36, v37, s[8:11], s82 offen sc1
  s_sub_u32 s83, s83, 1
  s_cmp_eq_u32 s83, 0
  s_waitcnt vmcnt(0)
  s_cbranch_scc1 PL12_adaLN_cond__sliding_local_dilated__swiglu_ffn__prompt_kernelx
  v_cmp_ne_u32 vcc, s46, v36
  s_nop 4
  s_cbranch_vccnz PL12_adaLN_cond__sliding_local_dilated__swiglu_ffn__prompt_kernel
PL12_adaLN_cond__sliding_local_dilated__swiglu_ffn__prompt_kernelx:
  s_barrier
  v_mfma_f32_16x16x32_bf16 v[232:235], a[176:179], a[88:91], v[232:235]
  v_cvt_pk_bf16_f32 v134, v180, v181
  v_cvt_pk_bf16_f32 v135, v182, v183
  v_mfma_f32_16x16x32_bf16 v[236:239], a[176:179], a[92:95], v[236:239]
  ds_read_b64_tr_b16 a[176:177], v5 offset:57344
  v_fma_f32 v168, v168, v20, v60
  v_mfma_f32_16x16x32_bf16 v[236:239], a[180:183], a[76:79], v[236:239]
  s_waitcnt lgkmcnt(5)
  buffer_load_dwordx4 a[220:223], v1, s[8:11], s72 offen offset:0 sc1
  v_exp_f32 v24, v168
  v_mfma_f32_16x16x32_bf16 v[252:255], a[160:163], a[76:79], v[252:255]
  ds_read_b64_tr_b16 a[178:179], v5 offset:59392
  s_add_u32 s55, s58, 262144
  buffer_store_dwordx4 v[132:135], v1, s[8:11], s55 offen offset:0 sc1
  v_mfma_f32_16x16x32_bf16 v[252:255], a[164:167], a[92:95], v[252:255]
  v_fma_f32 v169, v169, v20, v61
  v_fma_f32 v170, v170, v20, v62
  v_mfma_f32_16x16x32_bf16 v[248:251], a[164:167], a[88:91], v[248:251]
  ds_read_b64_tr_b16 a[180:181], v5 offset:61440
  v_fma_f32 v171, v171, v20, v63
  v_mfma_f32_16x16x32_bf16 v[248:251], a[160:163], a[72:75], v[248:251]
  buffer_load_dwordx4 a[236:239], v1, s[8:11], s72 offen offset:1024 sc1
  v_exp_f32 v25, v169
  v_fma_f32 v172, v172, v22, v60
  v_mfma_f32_16x16x32_bf16 v[244:247], a[160:163], a[68:71], v[244:247]
  ds_read_b64_tr_b16 a[182:183], v5 offset:63488
  v_fma_f32 v173, v173, v22, v61
  v_mfma_f32_16x16x32_bf16 v[244:247], a[164:167], a[84:87], v[244:247]
  s_add_u32 s72, s72, 131072
  v_exp_f32 v26, v170
  v_mfma_f32_16x16x32_bf16 v[240:243], a[164:167], a[80:83], v[240:243]
  ds_read_b64_tr_b16 a[164:165], v5 offset:16384
  v_fma_f32 v174, v174, v22, v62
  v_mfma_f32_16x16x32_bf16 v[240:243], a[160:163], a[64:67], v[240:243]
  s_waitcnt lgkmcnt(5)
  buffer_load_dwordx4 a[224:227], v1, s[8:11], s72 offen offset:0 sc1
  v_exp_f32 v27, v171
  v_mfma_f32_16x16x32_bf16 v[224:227], a[168:171], a[96:99], v[224:227]
  ds_read_b64_tr_b16 a[166:167], v5 offset:18432
  v_fma_f32 v175, v175, v22, v63
  v_mfma_f32_16x16x32_bf16 v[224:227], a[172:175], a[112:115], v[224:227]
  v_exp_f32 v28, v172
  v_mfma_f32_16x16x32_bf16 v[228:231], a[172:175], a[116:119], v[228:231]
  ds_read_b64_tr_b16 a[160:161], v5 offset:20480
  v_mul_f32 v184, v168, v184
  v_mfma_f32_16x16x32_bf16 v[228:231], a[168:171], a[100:103], v[228:231]
  buffer_load_dwordx4 a[240:243], v1, s[8:11], s72 offen offset:1024 sc1
  v_exp_f32 v29, v173
  v_mul_f32 v185, v169, v185
  v_mfma_f32_16x16x32_bf16 v[232:235], a[168:171], a[104:107], v[232:235]
  ds_read_b64_tr_b16 a[162:163], v5 offset:22528
  v_mul_f32 v186, v170, v186
  v_mfma_f32_16x16x32_bf16 v[232:235], a[172:175], a[120:123], v[232:235]
  s_add_u32 s72, s72, s89
  v_exp_f32 v30, v174
  v_mfma_f32_16x16x32_bf16 v[236:239], a[172:175], a[124:127], v[236:239]
  ds_read_b64_tr_b16 a[172:173], v5 offset:24576
  ds_read_b128 v[60:63], v12 offset:640
  v_mfma_f32_16x16x32_bf16 v[236:239], a[168:171], a[108:111], v[236:239]
  s_waitcnt lgkmcnt(6)
  buffer_load_dwordx4 a[228:231], v1, s[8:11], s72 offen offset:0 sc1
  v_exp_f32 v31, v175
  v_mfma_f32_16x16x32_bf16 v[252:255], a[176:179], a[108:111], v[252:255]
  ds_read_b64_tr_b16 a[174:175], v5 offset:26624
  v_mul_f32 v187, v171, v187
  v_mfma_f32_16x16x32_bf16 v[252:255], a[180:183], a[124:127], v[252:255]
  v_mul_f32 v188, v172, v188
  v_mul_f32 v189, v173, v189
  v_mfma_f32_16x16x32_bf16 v[248:251], a[180:183], a[120:123], v[248:251]
  ds_read_b64_tr_b16 a[168:169], v5 offset:28672
  v_mul_f32 v190, v174, v190
  v_mfma_f32_16x16x32_bf16 v[248:251], a[176:179], a[104:107], v[248:251]
  buffer_load_dwordx4 a[244:247], v1, s[8:11], s72 offen offset:1024 sc1
  v_mul_f32 v191, v175, v191
  v_fma_f32 v24, v24, v21, v21
  v_fma_f32 v25, v25, v21, v21
  v_mfma_f32_16x16x32_bf16 v[244:247], a[176:179], a[100:103], v[244:247]
  ds_read_b64_tr_b16 a[170:171], v5 offset:30720
  v_fma_f32 v26, v26, v21, v21
  v_mfma_f32_16x16x32_bf16 v[244:247], a[180:183], a[116:119], v[244:247]
  s_add_u32 s72, s72, 131072
  v_rcp_f32 v24, v24
  v_mfma_f32_16x16x32_bf16 v[240:243], a[180:183], a[112:115], v[240:243]
  ds_read_b64_tr_b16 a[180:181], v9 offset:32768
  v_fma_f32 v27, v27, v21, v21
  v_mfma_f32_16x16x32_bf16 v[240:243], a[176:179], a[96:99], v[240:243]
  s_waitcnt lgkmcnt(6)
  buffer_load_dwordx4 a[232:235], v1, s[8:11], s72 offen offset:0 sc1
  v_rcp_f32 v25, v25
  v_mfma_f32_16x16x32_bf16 v[224:227], a[164:167], a[128:131], v[224:227]
  ds_read_b64_tr_b16 a[182:183], v9 offset:34816
  v_fma_f32 v28, v28, v23, v23
  v_mfma_f32_16x16x32_bf16 v[224:227], a[160:163], a[144:147], v[224:227]
  v_rcp_f32 v26, v26
  v_mfma_f32_16x16x32_bf16 v[228:231], a[160:163], a[148:151], v[228:231]
  ds_read_b64_tr_b16 a[176:177], v9 offset:36864
  v_fma_f32 v29, v29, v23, v23
  v_mfma_f32_16x16x32_bf16 v[228:231], a[164:167], a[132:135], v[228:231]
  buffer_load_dwordx4 a[248:251], v1, s[8:11], s72 offen offset:1024 sc1
  v_rcp_f32 v27, v27
  v_fma_f32 v30, v30, v23, v23
  v_mfma_f32_16x16x32_bf16 v[232:235], a[164:167], a[136:139], v[232:235]
  ds_read_b64_tr_b16 a[178:179], v9 offset:38912
  v_fma_f32 v31, v31, v23, v23
  v_mfma_f32_16x16x32_bf16 v[232:235], a[160:163], a[152:155], v[232:235]
  v_rcp_f32 v28, v28
  v_mfma_f32_16x16x32_bf16 v[236:239], a[160:163], a[156:159], v[236:239]
  ds_read_b64_tr_b16 a[160:161], v9 offset:40960
  v_mul_f32 v184, v184, v24
  v_mfma_f32_16x16x32_bf16 v[236:239], a[164:167], a[140:143], v[236:239]
  s_waitcnt lgkmcnt(5)
  buffer_load_dwordx4 a[0:3], v1, s[8:11], s73 offen offset:0 sc1
  v_rcp_f32 v29, v29
  v_mfma_f32_16x16x32_bf16 v[252:255], a[172:175], a[140:143], v[252:255]
  ds_read_b64_tr_b16 a[162:163], v9 offset:43008
  v_mul_f32 v185, v185, v25
  v_mfma_f32_16x16x32_bf16 v[252:255], a[168:171], a[156:159], v[252:255]
  v_rcp_f32 v30, v30
  v_mfma_f32_16x16x32_bf16 v[248:251], a[168:171], a[152:155], v[248:251]
  ds_read_b64_tr_b16 a[164:165], v9 offset:45056
  v_mul_f32 v186, v186, v26
  v_mfma_f32_16x16x32_bf16 v[248:251], a[172:175], a[136:139], v[248:251]
  buffer_load_dwordx4 a[16:19], v1, s[8:11], s73 offen offset:1024 sc1
  v_rcp_f32 v31, v31
  v_mul_f32 v187, v187, v27
  v_mfma_f32_16x16x32_bf16 v[244:247], a[172:175], a[132:135], v[244:247]
  ds_read_b64_tr_b16 a[166:167], v9 offset:47104
  v_mul_f32 v188, v188, v28
  v_mfma_f32_16x16x32_bf16 v[244:247], a[168:171], a[148:151], v[244:247]
  s_waitcnt vmcnt(32)
  s_barrier
  v_mfma_f32_16x16x32_bf16 v[240:243], a[168:171], a[144:147], v[240:243]
  ds_read_b64_tr_b16 a[168:169], v6 offset:49152
  s_add_u32 s73, s73, 131072
  v_mfma_f32_16x16x32_bf16 v[240:243], a[172:175], a[128:131], v[240:243]
  s_waitcnt lgkmcnt(5)
  buffer_load_dwordx4 a[4:7], v1, s[8:11], s73 offen offset:0 sc1
  v_mul_f32 v189, v189, v29
  v_mul_f32 v190, v190, v30
  v_mfma_f32_16x16x32_bf16 v[224:227], a[180:183], a[188:191], v[224:227]
  ds_read_b64_tr_b16 a[170:171], v6 offset:51200
  v_mul_f32 v191, v191, v31
  v_mfma_f32_16x16x32_bf16 v[224:227], a[176:179], a[204:207], v[224:227]
  v_cvt_pk_bf16_f32 v138, v184, v185
  v_cvt_pk_bf16_f32 v139, v186, v187
  v_mfma_f32_16x16x32_bf16 v[228:231], a[176:179], a[208:211], v[228:231]
  ds_read_b64_tr_b16 a[172:173], v6 offset:53248
  v_cvt_pk_bf16_f32 v142, v188, v189
  v_mfma_f32_16x16x32_bf16 v[228:231], a[180:183], a[192:195], v[228:231]
  buffer_load_dwordx4 a[20:23], v1, s[8:11], s73 offen offset:1024 sc1
  s_add_u32 s55, s58, 524288
  buffer_store_dwordx4 v[136:139], v1, s[8:11], s55 offen offset:0 sc1
  v_mfma_f32_16x16x32_bf16 v[232:235], a[180:183], a[196:199], v[232:235]
  ds_read_b64_tr_b16 a[174:175], v6 offset:55296
  v_cvt_pk_bf16_f32 v143, v190, v191
  v_mfma_f32_16x16x32_bf16 v[232:235], a[176:179], a[212:215], v[232:235]
  s_add_u32 s73, s73, s89
  s_add_u32 s55, s58, 786432
  buffer_store_dwordx4 v[140:143], v1, s[8:11], s55 offen offset:0 sc1
  v_mfma_f32_16x16x32_bf16 v[236:239], a[176:179], a[216:219], v[236:239]
  ds_read_b64_tr_b16 a[176:177], v7 offset:49152
  s_waitcnt lgkmcnt(15)
  v_mfma_f32_16x16x32_bf16 v[236:239], a[180:183], a[200:203], v[236:239]
  s_waitcnt lgkmcnt(5)
  buffer_load_dwordx4 a[8:11], v1, s[8:11], s73 offen offset:0 sc1
  v_fma_f32 v192, v192, v16, v60
  v_fma_f32 v193, v193, v16, v61
  v_mfma_f32_16x16x32_bf16 v[252:255], a[160:163], a[200:203], v[252:255]
  ds_read_b64_tr_b16 a[178:179], v7 offset:51200
  v_fma_f32 v194, v194, v16, v62
  v_mfma_f32_16x16x32_bf16 v[252:255], a[164:167], a[216:219], v[252:255]
  s_waitcnt vmcnt(31)
  s_barrier
  v_mfma_f32_16x16x32_bf16 v[248:251], a[164:167], a[212:215], v[248:251]
  ds_read_b64_tr_b16 a[180:181], v7 offset:53248
  v_exp_f32 v24, v192
  v_mfma_f32_16x16x32_bf16 v[248:251], a[160:163], a[196:199], v[248:251]
  buffer_load_dwordx4 a[24:27], v1, s[8:11], s73 offen offset:1024 sc1
  v_exp_f32 v25, v193
  v_mfma_f32_16x16x32_bf16 v[244:247], a[160:163], a[192:195], v[244:247]
  ds_read_b64_tr_b16 a[182:183], v7 offset:55296
  v_fma_f32 v195, v195, v16, v63
  v_mfma_f32_16x16x32_bf16 v[244:247], a[164:167], a[208:211], v[244:247]
  s_add_u32 s73, s73, 131072
  v_exp_f32 v26, v194
  v_fma_f32 v196, v196, v18, v60
  v_mfma_f32_16x16x32_bf16 v[240:243], a[164:167], a[204:207], v[240:243]
  ds_read_b64_tr_b16 a[164:165], v8 offset:49152
  v_fma_f32 v197, v197, v18, v61
  v_mfma_f32_16x16x32_bf16 v[240:243], a[160:163], a[188:191], v[240:243]
  s_waitcnt vmcnt(8) lgkmcnt(5)
  buffer_load_dwordx4 a[12:15], v1, s[8:11], s73 offen offset:0 sc1
  v_exp_f32 v27, v195
  v_mfma_f32_16x16x32_bf16 v[64:67], a[168:171], a[220:223], 0
  ds_read_b64_tr_b16 a[166:167], v8 offset:51200
  v_fma_f32 v198, v198, v18, v62
  v_mfma_f32_16x16x32_bf16 v[64:67], a[172:175], a[236:239], v[64:67]
  v_exp_f32 v28, v196
  v_mfma_f32_16x16x32_bf16 v[68:71], a[172:175], a[240:243], 0
  ds_read_b64_tr_b16 a[160:161], v8 offset:53248
  v_exp_f32 v29, v197
  v_mfma_f32_16x16x32_bf16 v[68:71], a[168:171], a[224:227], v[68:71]
  buffer_load_dwordx4 a[28:31], v1, s[8:11], s73 offen offset:1024 sc1
  v_exp_f32 v30, v198
  v_mfma_f32_16x16x32_bf16 v[72:75], a[168:171], a[228:231], 0
  ds_read_b64_tr_b16 a[162:163], v8 offset:55296
  v_fma_f32 v199, v199, v18, v63
  v_mfma_f32_16x16x32_bf16 v[72:75], a[172:175], a[244:247], v[72:75]
  v_exp_f32 v31, v199
  v_mul_f32 v208, v192, v208
  v_mfma_f32_16x16x32_bf16 v[76:79], a[172:175], a[248:251], 0
  ds_read_b64_tr_b16 a[172:173], v9 offset:49152
  v_mul_f32 v209, v193, v209
  v_mfma_f32_16x16x32_bf16 v[76:79], a[168:171], a[232:235], v[76:79]
  s_waitcnt lgkmcnt(5)
  buffer_load_dwordx4 a[32:35], v1, s[8:11], s74 offen offset:0 sc1
  v_mul_f32 v210, v194, v210
  v_mul_f32 v211, v195, v211
  v_mfma_f32_16x16x32_bf16 v[92:95], a[176:179], a[232:235], 0
  ds_read_b64_tr_b16 a[174:175], v9 offset:51200
  v_mul_f32 v212, v196, v212
  v_mfma_f32_16x16x32_bf16 v[92:95], a[180:183], a[248:251], v[92:95]
  v_mul_f32 v213, v197, v213
  v_mul_f32 v214, v198, v214
  v_mfma_f32_16x16x32_bf16 v[88:91], a[180:183], a[244:247], 0
  ds_read_b64_tr_b16 a[168:169], v9 offset:53248
  v_mul_f32 v215, v199, v215
  v_fma_f32 v24, v24, v17, v17
  v_mfma_f32_16x16x32_bf16 v[88:91], a[176:179], a[228:231], v[88:91]
  buffer_load_dwordx4 a[48:51], v1, s[8:11], s74 offen offset:1024 sc1
  v_rcp_f32 v24, v24
  v_mfma_f32_16x16x32_bf16 v[84:87], a[176:179], a[224:227], 0
  ds_read_b64_tr_b16 a[170:171], v9 offset:55296
  v_fma_f32 v25, v25, v17, v17
  v_mfma_f32_16x16x32_bf16 v[84:87], a[180:183], a[240:243], v[84:87]
  v_rcp_f32 v25, v25
  v_fma_f32 v26, v26, v17, v17
  v_mfma_f32_16x16x32_bf16 v[80:83], a[180:183], a[236:239], 0
  ds_read_b64_tr_b16 a[180:181], v6 offset:57344
  v_fma_f32 v27, v27, v17, v17
  v_mfma_f32_16x16x32_bf16 v[80:83], a[176:179], a[220:223], v[80:83]
  s_waitcnt lgkmcnt(5)
  s_add_u32 s74, s74, 131072
  v_rcp_f32 v26, v26
  v_mfma_f32_16x16x32_bf16 v[96:99], a[164:167], a[220:223], 0
  ds_read_b64_tr_b16 a[182:183], v6 offset:59392
  v_fma_f32 v28, v28, v19, v19
  v_mfma_f32_16x16x32_bf16 v[96:99], a[160:163], a[236:239], v[96:99]
  buffer_load_dwordx4 a[36:39], v1, s[8:11], s74 offen offset:0 sc1
  v_rcp_f32 v27, v27
  v_mfma_f32_16x16x32_bf16 v[100:103], a[160:163], a[240:243], 0
  ds_read_b64_tr_b16 a[176:177], v6 offset:61440
  v_rcp_f32 v28, v28
  v_mfma_f32_16x16x32_bf16 v[100:103], a[164:167], a[224:227], v[100:103]
  v_fma_f32 v29, v29, v19, v19
  v_fma_f32 v30, v30, v19, v19
  v_mfma_f32_16x16x32_bf16 v[104:107], a[164:167], a[228:231], 0
  ds_read_b64_tr_b16 a[178:179], v6 offset:63488
  v_fma_f32 v31, v31, v19, v19
  v_mfma_f32_16x16x32_bf16 v[104:107], a[160:163], a[244:247], v[104:107]
  buffer_load_dwordx4 a[52:55], v1, s[8:11], s74 offen offset:1024 sc1
  v_rcp_f32 v29, v29
  v_mul_f32 v208, v208, v24
  v_mfma_f32_16x16x32_bf16 v[108:111], a[160:163], a[248:251], 0
  ds_read_b64_tr_b16 a[160:161], v7 offset:57344
  v_mul_f32 v209, v209, v25
  v_mfma_f32_16x16x32_bf16 v[108:111], a[164:167], a[232:235], v[108:111]
  s_waitcnt lgkmcnt(5)
  s_add_u32 s74, s74, s89
  v_rcp_f32 v30, v30
  v_mfma_f32_16x16x32_bf16 v[124:127], a[172:175], a[232:235], 0
  ds_read_b64_tr_b16 a[162:163], v7 offset:59392
  v_mul_f32 v210, v210, v26
  v_mfma_f32_16x16x32_bf16 v[124:127], a[168:171], a[248:251], v[124:127]
  buffer_load_dwordx4 a[40:43], v1, s[8:11], s74 offen offset:0 sc1
  v_rcp_f32 v31, v31
  v_mfma_f32_16x16x32_bf16 v[120:123], a[168:171], a[244:247], 0
  ds_read_b64_tr_b16 a[164:165], v7 offset:61440
  v_mul_f32 v211, v211, v27
  v_mul_f32 v212, v212, v28
  v_mfma_f32_16x16x32_bf16 v[120:123], a[172:175], a[228:231], v[120:123]
  v_mul_f32 v213, v213, v29
  v_mul_f32 v214, v214, v30
  v_mfma_f32_16x16x32_bf16 v[116:119], a[172:175], a[224:227], 0
  ds_read_b64_tr_b16 a[166:167], v7 offset:63488
  v_mul_f32 v215, v215, v31
  v_mfma_f32_16x16x32_bf16 v[116:119], a[168:171], a[240:243], v[116:119]
  buffer_load_dwordx4 a[56:59], v1, s[8:11], s74 offen offset:1024 sc1
  v_cvt_pk_bf16_f32 v192, v208, v209
  v_cvt_pk_bf16_f32 v193, v210, v211
  v_cvt_pk_bf16_f32 v196, v212, v213
  v_mfma_f32_16x16x32_bf16 v[112:115], a[168:171], a[236:239], 0
  ds_read_b64_tr_b16 a[168:169], v8 offset:57344
  v_cvt_pk_bf16_f32 v197, v214, v215
  v_mfma_f32_16x16x32_bf16 v[112:115], a[172:175], a[220:223], v[112:115]
  s_waitcnt lgkmcnt(5)
  v_fma_f32 v200, v200, v20, v60
  v_exp_f32 v24, v200
  v_mfma_f32_16x16x32_bf16 v[128:131], a[180:183], a[220:223], 0
  ds_read_b64_tr_b16 a[170:171], v8 offset:59392
  v_fma_f32 v201, v201, v20, v61
  v_mfma_f32_16x16x32_bf16 v[128:131], a[176:179], a[236:239], v[128:131]
  s_add_u32 s74, s74, 131072
  v_exp_f32 v25, v201
  v_mfma_f32_16x16x32_bf16 v[132:135], a[176:179], a[240:243], 0
  ds_read_b64_tr_b16 a[172:173], v8 offset:61440
  v_fma_f32 v202, v202, v20, v62
  v_fma_f32 v203, v203, v20, v63
  v_mfma_f32_16x16x32_bf16 v[132:135], a[180:183], a[224:227], v[132:135]
  buffer_load_dwordx4 a[44:47], v1, s[8:11], s74 offen offset:0 sc1
  v_exp_f32 v26, v202
  v_mfma_f32_16x16x32_bf16 v[136:139], a[180:183], a[228:231], 0
  ds_read_b64_tr_b16 a[174:175], v8 offset:63488
  v_fma_f32 v204, v204, v22, v60
  v_mfma_f32_16x16x32_bf16 v[136:139], a[176:179], a[244:247], v[136:139]
  v_exp_f32 v27, v203
  v_fma_f32 v205, v205, v22, v61
  v_mfma_f32_16x16x32_bf16 v[140:143], a[176:179], a[248:251], 0
  ds_read_b64_tr_b16 a[176:177], v9 offset:57344
  v_fma_f32 v206, v206, v22, v62
  v_mfma_f32_16x16x32_bf16 v[140:143], a[180:183], a[232:235], v[140:143]
  s_waitcnt lgkmcnt(5)
  buffer_load_dwordx4 a[60:63], v1, s[8:11], s74 offen offset:1024 sc1
  v_exp_f32 v28, v204
  v_mfma_f32_16x16x32_bf16 v[156:159], a[160:163], a[232:235], 0
  ds_read_b64_tr_b16 a[178:179], v9 offset:59392
  v_fma_f32 v207, v207, v22, v63
  v_mfma_f32_16x16x32_bf16 v[156:159], a[164:167], a[248:251], v[156:159]
  v_exp_f32 v29, v205
  v_mfma_f32_16x16x32_bf16 v[152:155], a[164:167], a[244:247], 0
  ds_read_b64_tr_b16 a[180:181], v9 offset:61440
  v_exp_f32 v30, v206
  v_mfma_f32_16x16x32_bf16 v[152:155], a[160:163], a[228:231], v[152:155]
  buffer_load_dwordx4 a[64:67], v1, s[8:11], s75 offen offset:0 sc1
  v_exp_f32 v31, v207
  v_mfma_f32_16x16x32_bf16 v[148:151], a[160:163], a[224:227], 0
  ds_read_b64_tr_b16 a[182:183], v9 offset:63488
  v_mul_f32 v216, v200, v216
  v_mfma_f32_16x16x32_bf16 v[148:151], a[164:167], a[240:243], v[148:151]
  ds_read_b128 v[60:63], v12 offset:704
  v_mul_f32 v217, v201, v217
  v_mul_f32 v218, v202, v218
  v_mfma_f32_16x16x32_bf16 v[144:147], a[164:167], a[236:239], 0
  ds_read_b64_tr_b16 a[164:165], v6 offset:16384
  v_mul_f32 v219, v203, v219
  v_mfma_f32_16x16x32_bf16 v[144:147], a[160:163], a[220:223], v[144:147]
  s_waitcnt lgkmcnt(6)
  buffer_load_dwordx4 a[80:83], v1, s[8:11], s75 offen offset:1024 sc1
  v_mul_f32 v220, v204, v220
  v_mul_f32 v221, v205, v221
  v_mfma_f32_16x16x32_bf16 v[160:163], a[168:171], a[220:223], 0
  ds_read_b64_tr_b16 a[166:167], v6 offset:18432
  v_mul_f32 v222, v206, v222
  v_mfma_f32_16x16x32_bf16 v[160:163], a[172:175], a[236:239], v[160:163]
  v_mul_f32 v223, v207, v223
  v_fma_f32 v24, v24, v21, v21
  v_mfma_f32_16x16x32_bf16 v[164:167], a[172:175], a[240:243], 0
  ds_read_b64_tr_b16 a[160:161], v6 offset:20480
  v_rcp_f32 v24, v24
  v_mfma_f32_16x16x32_bf16 v[164:167], a[168:171], a[224:227], v[164:167]
  s_add_u32 s75, s75, 131072
  v_fma_f32 v25, v25, v21, v21
  v_fma_f32 v26, v26, v21, v21
  v_mfma_f32_16x16x32_bf16 v[168:171], a[168:171], a[228:231], 0
  ds_read_b64_tr_b16 a[162:163], v6 offset:22528
  v_fma_f32 v27, v27, v21, v21
  v_mfma_f32_16x16x32_bf16 v[168:171], a[172:175], a[244:247], v[168:171]
  buffer_load_dwordx4 a[68:71], v1, s[8:11], s75 offen offset:0 sc1
  v_rcp_f32 v25, v25
  v_fma_f32 v28, v28, v23, v23
  v_mfma_f32_16x16x32_bf16 v[172:175], a[172:175], a[248:251], 0
  ds_read_b64_tr_b16 a[172:173], v7 offset:16384
  v_fma_f32 v29, v29, v23, v23
  v_mfma_f32_16x16x32_bf16 v[172:175], a[168:171], a[232:235], v[172:175]
  s_waitcnt lgkmcnt(6)
  v_rcp_f32 v26, v26
  v_fma_f32 v30, v30, v23, v23
  v_mfma_f32_16x16x32_bf16 v[188:191], a[176:179], a[232:235], 0
  ds_read_b64_tr_b16 a[174:175], v7 offset:18432
  v_fma_f32 v31, v31, v23, v23
  v_mfma_f32_16x16x32_bf16 v[188:191], a[180:183], a[248:251], v[188:191]
  buffer_load_dwordx4 a[84:87], v1, s[8:11], s75 offen offset:1024 sc1
  v_rcp_f32 v27, v27
  v_mfma_f32_16x16x32_bf16 v[184:187], a[180:183], a[244:247], 0
  ds_read_b64_tr_b16 a[168:169], v7 offset:20480
  v_rcp_f32 v28, v28
  v_mfma_f32_16x16x32_bf16 v[184:187], a[176:179], a[228:231], v[184:187]
  s_add_u32 s75, s75, s89
  v_rcp_f32 v29, v29
  v_mfma_f32_16x16x32_bf16 v[180:183], a[176:179], a[224:227], 0
  ds_read_b64_tr_b16 a[170:171], v7 offset:22528
  v_mul_f32 v216, v216, v24
  v_mfma_f32_16x16x32_bf16 v[180:183], a[180:183], a[240:243], v[180:183]
  buffer_load_dwordx4 a[72:75], v1, s[8:11], s75 offen offset:0 sc1
  v_rcp_f32 v30, v30
  v_mul_f32 v217, v217, v25
  v_mfma_f32_16x16x32_bf16 v[176:179], a[180:183], a[236:239], 0
  ds_read_b64_tr_b16 a[180:181], v8 offset:16384
  v_mul_f32 v218, v218, v26
  v_mfma_f32_16x16x32_bf16 v[176:179], a[176:179], a[220:223], v[176:179]
  s_waitcnt vmcnt(13) lgkmcnt(5)
  v_rcp_f32 v31, v31
  v_mul_f32 v219, v219, v27
  v_mfma_f32_16x16x32_bf16 v[64:67], a[164:167], a[0:3], v[64:67]
  ds_read_b64_tr_b16 a[182:183], v8 offset:18432
  v_mul_f32 v220, v220, v28
  v_mfma_f32_16x16x32_bf16 v[64:67], a[160:163], a[16:19], v[64:67]
  buffer_load_dwordx4 a[88:91], v1, s[8:11], s75 offen offset:1024 sc1
  v_mul_f32 v221, v221, v29
  v_mul_f32 v222, v222, v30
  v_mfma_f32_16x16x32_bf16 v[68:71], a[160:163], a[20:23], v[68:71]
  ds_read_b64_tr_b16 a[176:177], v8 offset:20480
  v_mul_f32 v223, v223, v31
  v_cvt_pk_bf16_f32 v200, v216, v217
  v_mfma_f32_16x16x32_bf16 v[68:71], a[164:167], a[4:7], v[68:71]
  v_cvt_pk_bf16_f32 v201, v218, v219
  v_cvt_pk_bf16_f32 v204, v220, v221
  v_mfma_f32_16x16x32_bf16 v[72:75], a[164:167], a[8:11], v[72:75]
  ds_read_b64_tr_b16 a[178:179], v8 offset:22528
  v_cvt_pk_bf16_f32 v205, v222, v223
  v_mfma_f32_16x16x32_bf16 v[72:75], a[160:163], a[24:27], v[72:75]
  s_add_u32 s75, s75, 131072
  v_mfma_f32_16x16x32_bf16 v[76:79], a[160:163], a[28:31], v[76:79]
  ds_read_b64_tr_b16 a[160:161], v9 offset:16384
  s_waitcnt lgkmcnt(13)
  v_fma_f32 v224, v224, v16, v60
  v_mfma_f32_16x16x32_bf16 v[76:79], a[164:167], a[12:15], v[76:79]
  s_waitcnt lgkmcnt(5)
  buffer_load_dwordx4 a[76:79], v1, s[8:11], s75 offen offset:0 sc1
  v_exp_f32 v24, v224
  v_mfma_f32_16x16x32_bf16 v[92:95], a[172:175], a[12:15], v[92:95]
  ds_read_b64_tr_b16 a[162:163], v9 offset:18432
  v_fma_f32 v225, v225, v16, v61
  v_fma_f32 v226, v226, v16, v62
  v_mfma_f32_16x16x32_bf16 v[92:95], a[168:171], a[28:31], v[92:95]
  v_exp_f32 v25, v225
  v_fma_f32 v227, v227, v16, v63
  v_mfma_f32_16x16x32_bf16 v[88:91], a[168:171], a[24:27], v[88:91]
  ds_read_b64_tr_b16 a[164:165], v9 offset:20480
  v_fma_f32 v228, v228, v18, v60
  v_mfma_f32_16x16x32_bf16 v[88:91], a[172:175], a[8:11], v[88:91]
  buffer_load_dwordx4 a[92:95], v1, s[8:11], s75 offen offset:1024 sc1
  v_exp_f32 v26, v226
  v_fma_f32 v229, v229, v18, v61
  v_mfma_f32_16x16x32_bf16 v[84:87], a[172:175], a[4:7], v[84:87]
  ds_read_b64_tr_b16 a[166:167], v9 offset:22528
  v_exp_f32 v27, v227
  v_mfma_f32_16x16x32_bf16 v[84:87], a[168:171], a[20:23], v[84:87]
  s_cmp_eq_u32 s91, 1
  s_cselect_b32 s76, 3, 10
  s_lshl_b32 s68, s76, 17
  s_lshl_b32 s76, s76, 11
  s_add_u32 s76, s76, s84
HOP16:
  s_cbranch_execz WRET1
  s_add_u32 m0, s45, 32768
  v_exp_f32 v28, v228
  v_fma_f32 v230, v230, v18, v62
  v_mfma_f32_16x16x32_bf16 v[80:83], a[168:171], a[16:19], v[80:83]
  ds_read_b64_tr_b16 a[168:169], v6 offset:24576
  v_exp_f32 v29, v229
  v_mfma_f32_16x16x32_bf16 v[80:83], a[172:175], a[0:3], v[80:83]
  s_waitcnt lgkmcnt(5)
  buffer_load_dwordx4 v32, s[36:39], s68 offen lds
  v_exp_f32 v30, v230
  v_mfma_f32_16x16x32_bf16 v[96:99], a[180:183], a[0:3], v[96:99]
  ds_read_b64_tr_b16 a[170:171], v6 offset:26624
  v_fma_f32 v231, v231, v18, v63
  v_mfma_f32_16x16x32_bf16 v[96:99], a[176:179], a[16:19], v[96:99]
  s_add_u32 m0, s45, 36864
  s_add_u32 s61, s68, 65536
  v_exp_f32 v31, v231
  v_mfma_f32_16x16x32_bf16 v[100:103], a[176:179], a[20:23], v[100:103]
  ds_read_b64_tr_b16 a[172:173], v6 offset:28672
  v_mul_f32 v240, v224, v240
  v_mul_f32 v241, v225, v241
  v_mfma_f32_16x16x32_bf16 v[100:103], a[180:183], a[4:7], v[100:103]
  buffer_load_dwordx4 v32, s[36:39], s61 offen lds
  v_mul_f32 v242, v226, v242
  v_mul_f32 v243, v227, v243
  v_mul_f32 v244, v228, v244
  v_mfma_f32_16x16x32_bf16 v[104:107], a[180:183], a[8:11], v[104:107]
  ds_read_b64_tr_b16 a[174:175], v6 offset:30720
  v_mul_f32 v245, v229, v245
  v_mul_f32 v246, v230, v246
  v_mfma_f32_16x16x32_bf16 v[104:107], a[176:179], a[24:27], v[104:107]
  v_mul_f32 v247, v231, v247
  v_fma_f32 v24, v24, v17, v17
  v_mfma_f32_16x16x32_bf16 v[108:111], a[176:179], a[28:31], v[108:111]
  ds_read_b64_tr_b16 a[176:177], v7 offset:24576
  v_rcp_f32 v24, v24
  v_mfma_f32_16x16x32_bf16 v[108:111], a[180:183], a[12:15], v[108:111]
  s_waitcnt lgkmcnt(5)
  s_add_u32 m0, s45, 40960
  v_fma_f32 v25, v25, v17, v17
  v_fma_f32 v26, v26, v17, v17
  v_mfma_f32_16x16x32_bf16 v[124:127], a[160:163], a[12:15], v[124:127]
  ds_read_b64_tr_b16 a[178:179], v7 offset:26624
  v_rcp_f32 v25, v25
  v_mfma_f32_16x16x32_bf16 v[124:127], a[164:167], a[28:31], v[124:127]
  buffer_load_dwordx4 v33, s[36:39], s68 offen lds
  v_rcp_f32 v26, v26
  v_fma_f32 v27, v27, v17, v17
  v_mfma_f32_16x16x32_bf16 v[120:123], a[164:167], a[24:27], v[120:123]
  ds_read_b64_tr_b16 a[180:181], v7 offset:28672
  v_fma_f32 v28, v28, v19, v19
  v_mfma_f32_16x16x32_bf16 v[120:123], a[160:163], a[8:11], v[120:123]
  s_add_u32 m0, s45, 45056
  s_add_u32 s61, s68, 65536
  v_rcp_f32 v27, v27
  v_mfma_f32_16x16x32_bf16 v[116:119], a[160:163], a[4:7], v[116:119]
  ds_read_b64_tr_b16 a[182:183], v7 offset:30720
  v_rcp_f32 v28, v28
  v_mfma_f32_16x16x32_bf16 v[116:119], a[164:167], a[20:23], v[116:119]
  buffer_load_dwordx4 v33, s[36:39], s61 offen lds
  v_fma_f32 v29, v29, v19, v19
  v_rcp_f32 v29, v29
  v_mfma_f32_16x16x32_bf16 v[112:115], a[164:167], a[16:19], v[112:115]
  ds_read_b64_tr_b16 a[164:165], v8 offset:24576
  v_fma_f32 v30, v30, v19, v19
  v_fma_f32 v31, v31, v19, v19
  v_mfma_f32_16x16x32_bf16 v[112:115], a[160:163], a[0:3], v[112:115]
  s_waitcnt lgkmcnt(5)
  s_cmp_eq_u32 s91, 2
  s_cselect_b32 s77, 5, 12
  s_lshl_b32 s69, s77, 17
  s_lshl_b32 s77, s77, 11
  s_add_u32 s77, s77, s84
  s_add_u32 m0, s45, 49152
  v_rcp_f32 v30, v30
  v_mfma_f32_16x16x32_bf16 v[128:131], a[168:171], a[0:3], v[128:131]
  ds_read_b64_tr_b16 a[166:167], v8 offset:26624
  v_mul_f32 v240, v240, v24
  v_mfma_f32_16x16x32_bf16 v[128:131], a[172:175], a[16:19], v[128:131]
  buffer_load_dwordx4 v32, s[36:39], s69 offen lds
  v_rcp_f32 v31, v31
  v_mul_f32 v241, v241, v25
  v_mfma_f32_16x16x32_bf16 v[132:135], a[172:175], a[20:23], v[132:135]
  ds_read_b64_tr_b16 a[160:161], v8 offset:28672
  v_mul_f32 v242, v242, v26
  v_mul_f32 v243, v243, v27
  v_mfma_f32_16x16x32_bf16 v[132:135], a[168:171], a[4:7], v[132:135]
  s_add_u32 m0, s45, 53248
  s_add_u32 s61, s69, 65536
  v_mul_f32 v244, v244, v28
  v_mul_f32 v245, v245, v29
  v_mfma_f32_16x16x32_bf16 v[136:139], a[168:171], a[8:11], v[136:139]
  ds_read_b64_tr_b16 a[162:163], v8 offset:30720
  v_mul_f32 v246, v246, v30
  v_mul_f32 v247, v247, v31
  v_mfma_f32_16x16x32_bf16 v[136:139], a[172:175], a[24:27], v[136:139]
  buffer_load_dwordx4 v32, s[36:39], s61 offen lds
  v_cvt_pk_bf16_f32 v194, v240, v241
  v_cvt_pk_bf16_f32 v195, v242, v243
  v_mfma_f32_16x16x32_bf16 v[140:143], a[172:175], a[28:31], v[140:143]
  ds_read_b64_tr_b16 a[172:173], v9 offset:24576
  v_cvt_pk_bf16_f32 v198, v244, v245
  v_cvt_pk_bf16_f32 v199, v246, v247
  v_mfma_f32_16x16x32_bf16 v[140:143], a[168:171], a[12:15], v[140:143]
  s_waitcnt lgkmcnt(5)
  buffer_store_dwordx4 v[192:195], v1, s[8:11], s58 offen offset:1024 sc1
  v_mfma_f32_16x16x32_bf16 v[156:159], a[176:179], a[12:15], v[156:159]
  ds_read_b64_tr_b16 a[174:175], v9 offset:26624
  v_fma_f32 v232, v232, v20, v60
  v_fma_f32 v233, v233, v20, v61
  v_mfma_f32_16x16x32_bf16 v[156:159], a[180:183], a[28:31], v[156:159]
  s_add_u32 m0, s45, 57344
  s_add_u32 s55, s58, 262144
  buffer_store_dwordx4 v[196:199], v1, s[8:11], s55 offen offset:1024 sc1
  v_mfma_f32_16x16x32_bf16 v[152:155], a[180:183], a[24:27], v[152:155]
  ds_read_b64_tr_b16 a[168:169], v9 offset:28672
  v_fma_f32 v234, v234, v20, v62
  v_mfma_f32_16x16x32_bf16 v[152:155], a[176:179], a[8:11], v[152:155]
  buffer_load_dwordx4 v33, s[36:39], s69 offen lds
  v_exp_f32 v24, v232
  v_fma_f32 v235, v235, v20, v63
  v_mfma_f32_16x16x32_bf16 v[148:151], a[176:179], a[4:7], v[148:151]
  ds_read_b64_tr_b16 a[170:171], v9 offset:30720
  v_exp_f32 v25, v233
  v_mfma_f32_16x16x32_bf16 v[148:151], a[180:183], a[20:23], v[148:151]
  v_fma_f32 v236, v236, v22, v60
  s_waitcnt vmcnt(47)
  s_barrier
  v_mfma_f32_16x16x32_bf16 v[144:147], a[180:183], a[16:19], v[144:147]
  ds_read_b64_tr_b16 a[180:181], v6 offset:0
  s_add_u32 m0, s45, 61440
  s_add_u32 s61, s69, 65536
  v_mfma_f32_16x16x32_bf16 v[144:147], a[176:179], a[0:3], v[144:147]
  s_waitcnt lgkmcnt(5)
  buffer_load_dwordx4 v33, s[36:39], s61 offen lds
  v_exp_f32 v26, v234
  v_mfma_f32_16x16x32_bf16 v[160:163], a[164:167], a[0:3], v[160:163]
  ds_read_b64_tr_b16 a[182:183], v6 offset:2048
  v_fma_f32 v237, v237, v22, v61
  v_mfma_f32_16x16x32_bf16 v[160:163], a[160:163], a[16:19], v[160:163]
  v_exp_f32 v27, v235
  v_fma_f32 v238, v238, v22, v62
  v_mfma_f32_16x16x32_bf16 v[164:167], a[160:163], a[20:23], v[164:167]
  ds_read_b64_tr_b16 a[176:177], v6 offset:4096
  v_exp_f32 v28, v236
  v_mfma_f32_16x16x32_bf16 v[164:167], a[164:167], a[4:7], v[164:167]
  buffer_load_dwordx4 a[96:99], v1, s[8:11], s76 offen offset:0 sc1
  v_exp_f32 v29, v237
  v_fma_f32 v239, v239, v22, v63
  v_mfma_f32_16x16x32_bf16 v[168:171], a[164:167], a[8:11], v[168:171]
  ds_read_b64_tr_b16 a[178:179], v6 offset:6144
  v_exp_f32 v30, v238
  v_mfma_f32_16x16x32_bf16 v[168:171], a[160:163], a[24:27], v[168:171]
  v_exp_f32 v31, v239
  v_mfma_f32_16x16x32_bf16 v[172:175], a[160:163], a[28:31], v[172:175]
  ds_read_b64_tr_b16 a[160:161], v7 offset:0
  v_mul_f32 v248, v232, v248
  v_mul_f32 v249, v233, v249
  v_mfma_f32_16x16x32_bf16 v[172:175], a[164:167], a[12:15], v[172:175]
  s_waitcnt lgkmcnt(5)
  buffer_load_dwordx4 a[112:115], v1, s[8:11], s76 offen offset:1024 sc1
  v_mul_f32 v250, v234, v250
  v_mul_f32 v251, v235, v251
  v_mfma_f32_16x16x32_bf16 v[188:191], a[172:175], a[12:15], v[188:191]
  ds_read_b64_tr_b16 a[162:163], v7 offset:2048
  v_mul_f32 v252, v236, v252
  v_mul_f32 v253, v237, v253
  v_mfma_f32_16x16x32_bf16 v[188:191], a[168:171], a[28:31], v[188:191]
  v_mul_f32 v254, v238, v254
  v_mul_f32 v255, v239, v255
  v_fma_f32 v24, v24, v21, v21
  v_mfma_f32_16x16x32_bf16 v[184:187], a[168:171], a[24:27], v[184:187]
  ds_read_b64_tr_b16 a[164:165], v7 offset:4096
  v_fma_f32 v25, v25, v21, v21
  v_mfma_f32_16x16x32_bf16 v[184:187], a[172:175], a[8:11], v[184:187]
  s_add_u32 s76, s76, 131072
  v_rcp_f32 v24, v24
  v_fma_f32 v26, v26, v21, v21
  v_mfma_f32_16x16x32_bf16 v[180:183], a[172:175], a[4:7], v[180:183]
  ds_read_b64_tr_b16 a[166:167], v7 offset:6144
  v_rcp_f32 v25, v25
  v_mfma_f32_16x16x32_bf16 v[180:183], a[168:171], a[20:23], v[180:183]
  buffer_load_dwordx4 a[100:103], v1, s[8:11], s76 offen offset:0 sc1
  v_rcp_f32 v26, v26
  v_fma_f32 v27, v27, v21, v21
  v_mfma_f32_16x16x32_bf16 v[176:179], a[168:171], a[16:19], v[176:179]
  ds_read_b64_tr_b16 a[168:169], v8 offset:0
  v_rcp_f32 v27, v27
  v_mfma_f32_16x16x32_bf16 v[176:179], a[172:175], a[0:3], v[176:179]
  s_waitcnt vmcnt(21) lgkmcnt(5)
  v_fma_f32 v28, v28, v23, v23
  v_rcp_f32 v28, v28
  v_mfma_f32_16x16x32_bf16 v[64:67], a[180:183], a[32:35], v[64:67]
  ds_read_b64_tr_b16 a[170:171], v8 offset:2048
  v_fma_f32 v29, v29, v23, v23
  v_mfma_f32_16x16x32_bf16 v[64:67], a[176:179], a[48:51], v[64:67]
  buffer_load_dwordx4 a[116:119], v1, s[8:11], s76 offen offset:1024 sc1
  v_rcp_f32 v29, v29
  v_fma_f32 v30, v30, v23, v23
  v_mfma_f32_16x16x32_bf16 v[68:71], a[176:179], a[52:55], v[68:71]
  ds_read_b64_tr_b16 a[172:173], v8 offset:4096
  v_rcp_f32 v30, v30
  v_mfma_f32_16x16x32_bf16 v[68:71], a[180:183], a[36:39], v[68:71]
  s_add_u32 s76, s76, s89
  v_fma_f32 v31, v31, v23, v23
  v_rcp_f32 v31, v31
  v_mfma_f32_16x16x32_bf16 v[72:75], a[180:183], a[40:43], v[72:75]
  ds_read_b64_tr_b16 a[174:175], v8 offset:6144
  v_mul_f32 v248, v248, v24
  v_mul_f32 v249, v249, v25
  v_mfma_f32_16x16x32_bf16 v[72:75], a[176:179], a[56:59], v[72:75]
  buffer_load_dwordx4 a[104:107], v1, s[8:11], s76 offen offset:0 sc1
  v_mul_f32 v250, v250, v26
  v_mul_f32 v251, v251, v27
  v_mfma_f32_16x16x32_bf16 v[76:79], a[176:179], a[60:63], v[76:79]
  ds_read_b64_tr_b16 a[176:177], v9 offset:0
  v_mul_f32 v252, v252, v28
  v_mul_f32 v253, v253, v29
  v_mfma_f32_16x16x32_bf16 v[76:79], a[180:183], a[44:47], v[76:79]
  s_waitcnt lgkmcnt(5)
  v_mul_f32 v254, v254, v30
  v_mul_f32 v255, v255, v31
  v_cvt_pk_bf16_f32 v202, v248, v249
  v_mfma_f32_16x16x32_bf16 v[92:95], a[160:163], a[44:47], v[92:95]
  ds_read_b64_tr_b16 a[178:179], v9 offset:2048
  v_cvt_pk_bf16_f32 v203, v250, v251
  v_cvt_pk_bf16_f32 v206, v252, v253
  v_mfma_f32_16x16x32_bf16 v[92:95], a[164:167], a[60:63], v[92:95]
  buffer_load_dwordx4 a[120:123], v1, s[8:11], s76 offen offset:1024 sc1
  s_add_u32 s55, s58, 524288
  buffer_store_dwordx4 v[200:203], v1, s[8:11], s55 offen offset:1024 sc1
  v_mfma_f32_16x16x32_bf16 v[88:91], a[164:167], a[56:59], v[88:91]
  ds_read_b64_tr_b16 a[180:181], v9 offset:4096
  v_cvt_pk_bf16_f32 v207, v254, v255
  v_mfma_f32_16x16x32_bf16 v[88:91], a[160:163], a[40:43], v[88:91]
  s_add_u32 s55, s58, 786432
  buffer_store_dwordx4 v[204:207], v1, s[8:11], s55 offen offset:1024 sc1
  v_mfma_f32_16x16x32_bf16 v[84:87], a[160:163], a[36:39], v[84:87]
  ds_read_b64_tr_b16 a[182:183], v9 offset:6144
  s_sub_u32 s80, s80, 491520
  v_mfma_f32_16x16x32_bf16 v[84:87], a[164:167], a[52:55], v[84:87]
  s_add_u32 s76, s76, 131072
  v_mfma_f32_16x16x32_bf16 v[80:83], a[164:167], a[48:51], v[80:83]
  ds_read_b64_tr_b16 a[164:165], v6 offset:8192
  v_mfma_f32_16x16x32_bf16 v[80:83], a[160:163], a[32:35], v[80:83]
  s_waitcnt lgkmcnt(5)
  buffer_load_dwordx4 a[108:111], v1, s[8:11], s76 offen offset:0 sc1
  v_mfma_f32_16x16x32_bf16 v[96:99], a[168:171], a[32:35], v[96:99]
  ds_read_b64_tr_b16 a[166:167], v6 offset:10240
  v_mfma_f32_16x16x32_bf16 v[96:99], a[172:175], a[48:51], v[96:99]
  v_mfma_f32_16x16x32_bf16 v[100:103], a[172:175], a[52:55], v[100:103]
  ds_read_b64_tr_b16 a[160:161], v6 offset:12288
  v_mfma_f32_16x16x32_bf16 v[100:103], a[168:171], a[36:39], v[100:103]
  buffer_load_dwordx4 a[124:127], v1, s[8:11], s76 offen offset:1024 sc1
  v_mfma_f32_16x16x32_bf16 v[104:107], a[168:171], a[40:43], v[104:107]
  ds_read_b64_tr_b16 a[162:163], v6 offset:14336
  v_mfma_f32_16x16x32_bf16 v[104:107], a[172:175], a[56:59], v[104:107]
  v_mfma_f32_16x16x32_bf16 v[108:111], a[172:175], a[60:63], v[108:111]
  ds_read_b64_tr_b16 a[172:173], v7 offset:8192
  v_mfma_f32_16x16x32_bf16 v[108:111], a[168:171], a[44:47], v[108:111]
  s_waitcnt lgkmcnt(5)
  buffer_load_dwordx4 a[128:131], v1, s[8:11], s77 offen offset:0 sc1
  v_mfma_f32_16x16x32_bf16 v[124:127], a[176:179], a[44:47], v[124:127]
  ds_read_b64_tr_b16 a[174:175], v7 offset:10240
  v_mfma_f32_16x16x32_bf16 v[124:127], a[180:183], a[60:63], v[124:127]
  v_mfma_f32_16x16x32_bf16 v[120:123], a[180:183], a[56:59], v[120:123]
  ds_read_b64_tr_b16 a[168:169], v7 offset:12288
  v_mfma_f32_16x16x32_bf16 v[120:123], a[176:179], a[40:43], v[120:123]
  buffer_load_dwordx4 a[144:147], v1, s[8:11], s77 offen offset:1024 sc1
  v_mfma_f32_16x16x32_bf16 v[116:119], a[176:179], a[36:39], v[116:119]
  ds_read_b64_tr_b16 a[170:171], v7 offset:14336
  v_mfma_f32_16x16x32_bf16 v[116:119], a[180:183], a[52:55], v[116:119]
  v_mfma_f32_16x16x32_bf16 v[112:115], a[180:183], a[48:51], v[112:115]
  ds_read_b64_tr_b16 a[180:181], v8 offset:8192
  v_mfma_f32_16x16x32_bf16 v[112:115], a[176:179], a[32:35], v[112:115]
  s_waitcnt lgkmcnt(5)
  s_add_u32 s77, s77, 131072
  v_mfma_f32_16x16x32_bf16 v[128:131], a[164:167], a[32:35], v[128:131]
  ds_read_b64_tr_b16 a[182:183], v8 offset:10240
  v_mfma_f32_16x16x32_bf16 v[128:131], a[160:163], a[48:51], v[128:131]
  buffer_load_dwordx4 a[132:135], v1, s[8:11], s77 offen offset:0 sc1
  v_mfma_f32_16x16x32_bf16 v[132:135], a[160:163], a[52:55], v[132:135]
  ds_read_b64_tr_b16 a[176:177], v8 offset:12288
  v_mfma_f32_16x16x32_bf16 v[132:135], a[164:167], a[36:39], v[132:135]
  v_mfma_f32_16x16x32_bf16 v[136:139], a[164:167], a[40:43], v[136:139]
  ds_read_b64_tr_b16 a[178:179], v8 offset:14336
  v_mfma_f32_16x16x32_bf16 v[136:139], a[160:163], a[56:59], v[136:139]
  buffer_load_dwordx4 a[148:151], v1, s[8:11], s77 offen offset:1024 sc1
  v_mfma_f32_16x16x32_bf16 v[140:143], a[160:163], a[60:63], v[140:143]
  ds_read_b64_tr_b16 a[160:161], v9 offset:8192
  v_mfma_f32_16x16x32_bf16 v[140:143], a[164:167], a[44:47], v[140:143]
  s_waitcnt lgkmcnt(5)
  s_add_u32 s77, s77, s89
  v_mfma_f32_16x16x32_bf16 v[156:159], a[172:175], a[44:47], v[156:159]
  ds_read_b64_tr_b16 a[162:163], v9 offset:10240
  v_mfma_f32_16x16x32_bf16 v[156:159], a[168:171], a[60:63], v[156:159]
  buffer_load_dwordx4 a[136:139], v1, s[8:11], s77 offen offset:0 sc1
  v_mfma_f32_16x16x32_bf16 v[152:155], a[168:171], a[56:59], v[152:155]
  ds_read_b64_tr_b16 a[164:165], v9 offset:12288
  v_mfma_f32_16x16x32_bf16 v[152:155], a[172:175], a[40:43], v[152:155]
  v_mfma_f32_16x16x32_bf16 v[148:151], a[172:175], a[36:39], v[148:151]
  ds_read_b64_tr_b16 a[166:167], v9 offset:14336
  v_mfma_f32_16x16x32_bf16 v[148:151], a[168:171], a[52:55], v[148:151]
  buffer_load_dwordx4 a[152:155], v1, s[8:11], s77 offen offset:1024 sc1
  v_mfma_f32_16x16x32_bf16 v[144:147], a[168:171], a[48:51], v[144:147]
  ds_read_b64_tr_b16 a[168:169], v2 offset:0
  v_mfma_f32_16x16x32_bf16 v[144:147], a[172:175], a[32:35], v[144:147]
  s_waitcnt lgkmcnt(5)
  v_mfma_f32_16x16x32_bf16 v[160:163], a[180:183], a[32:35], v[160:163]
  ds_read_b64_tr_b16 a[170:171], v2 offset:2048
  v_mfma_f32_16x16x32_bf16 v[160:163], a[176:179], a[48:51], v[160:163]
  s_add_u32 s77, s77, 131072
  v_mfma_f32_16x16x32_bf16 v[164:167], a[176:179], a[52:55], v[164:167]
  ds_read_b64_tr_b16 a[172:173], v2 offset:4096
  v_mfma_f32_16x16x32_bf16 v[164:167], a[180:183], a[36:39], v[164:167]
  buffer_load_dwordx4 a[140:143], v1, s[8:11], s77 offen offset:0 sc1
  v_mfma_f32_16x16x32_bf16 v[168:171], a[180:183], a[40:43], v[168:171]
  ds_read_b64_tr_b16 a[174:175], v2 offset:6144
  v_mfma_f32_16x16x32_bf16 v[168:171], a[176:179], a[56:59], v[168:171]
  v_mfma_f32_16x16x32_bf16 v[172:175], a[176:179], a[60:63], v[172:175]
  ds_read_b64_tr_b16 a[176:177], v3 offset:0
  v_mfma_f32_16x16x32_bf16 v[172:175], a[180:183], a[44:47], v[172:175]
  s_waitcnt lgkmcnt(5)
  buffer_load_dwordx4 a[156:159], v1, s[8:11], s77 offen offset:1024 sc1
  v_mfma_f32_16x16x32_bf16 v[188:191], a[160:163], a[44:47], v[188:191]
  ds_read_b64_tr_b16 a[178:179], v3 offset:2048
  v_mfma_f32_16x16x32_bf16 v[188:191], a[164:167], a[60:63], v[188:191]
  s_cmp_eq_u32 s91, 0
  s_cselect_b32 s78, 7, 0
  s_lshl_b32 s70, s78, 17
  s_lshl_b32 s78, s78, 11
  s_add_u32 s78, s78, s84
  s_add_u32 m0, s45, 16384
  v_mfma_f32_16x16x32_bf16 v[184:187], a[164:167], a[56:59], v[184:187]
  ds_read_b64_tr_b16 a[180:181], v3 offset:4096
  v_mfma_f32_16x16x32_bf16 v[184:187], a[160:163], a[40:43], v[184:187]
  buffer_load_dwordx4 v32, s[36:39], s70 offen lds
  v_mfma_f32_16x16x32_bf16 v[180:183], a[160:163], a[36:39], v[180:183]
  ds_read_b64_tr_b16 a[182:183], v3 offset:6144
  v_mfma_f32_16x16x32_bf16 v[180:183], a[164:167], a[52:55], v[180:183]
  s_add_u32 m0, s45, 20480
  s_add_u32 s61, s70, 65536
  v_mfma_f32_16x16x32_bf16 v[176:179], a[164:167], a[48:51], v[176:179]
  ds_read_b64_tr_b16 a[164:165], v4 offset:0
  v_mfma_f32_16x16x32_bf16 v[176:179], a[160:163], a[32:35], v[176:179]
  s_waitcnt vmcnt(29) lgkmcnt(5)
  buffer_load_dwordx4 v32, s[36:39], s61 offen lds
  v_mfma_f32_16x16x32_bf16 v[64:67], a[168:171], a[64:67], v[64:67]
  ds_read_b64_tr_b16 a[166:167], v4 offset:2048
  v_mfma_f32_16x16x32_bf16 v[64:67], a[172:175], a[80:83], v[64:67]
  v_mfma_f32_16x16x32_bf16 v[68:71], a[172:175], a[84:87], v[68:71]
  ds_read_b64_tr_b16 a[160:161], v4 offset:4096
  v_mfma_f32_16x16x32_bf16 v[68:71], a[168:171], a[68:71], v[68:71]
  s_add_u32 m0, s45, 24576
  v_mfma_f32_16x16x32_bf16 v[72:75], a[168:171], a[72:75], v[72:75]
  ds_read_b64_tr_b16 a[162:163], v4 offset:6144
  v_mfma_f32_16x16x32_bf16 v[72:75], a[172:175], a[88:91], v[72:75]
  buffer_load_dwordx4 v33, s[36:39], s70 offen lds
  v_mfma_f32_16x16x32_bf16 v[76:79], a[172:175], a[92:95], v[76:79]
  ds_read_b64_tr_b16 a[172:173], v5 offset:0
  v_mfma_f32_16x16x32_bf16 v[76:79], a[168:171], a[76:79], v[76:79]
  s_waitcnt lgkmcnt(5)
  s_add_u32 m0, s45, 28672
  s_add_u32 s61, s70, 65536
  v_mfma_f32_16x16x32_bf16 v[92:95], a[176:179], a[76:79], v[92:95]
  ds_read_b64_tr_b16 a[174:175], v5 offset:2048
  v_mfma_f32_16x16x32_bf16 v[92:95], a[180:183], a[92:95], v[92:95]
  buffer_load_dwordx4 v33, s[36:39], s61 offen lds
  v_add_u32 v38, s46, v0
  s_waitcnt vmcnt(14)
  s_barrier
  s_mov_b64 exec, 1
  buffer_store_dword v38, v0, s[8:11], s80 offen offset:0 sc1
  s_mov_b64 exec, -1
  v_mfma_f32_16x16x32_bf16 v[88:91], a[180:183], a[88:91], v[88:91]
  ds_read_b64_tr_b16 a[168:169], v5 offset:4096
  s_lshl_b32 s53, s44, 8
  v_mfma_f32_16x16x32_bf16 v[88:91], a[176:179], a[72:75], v[88:91]
  s_cmp_eq_u32 s91, 1
  s_cselect_b32 s79, 9, 2
  s_lshl_b32 s71, s79, 17
  s_lshl_b32 s79, s79, 11
  s_add_u32 s79, s79, s84
  s_add_u32 m0, s45, 98304
  s_add_u32 s53, s53, 133120
  v_lshrrev_b32 v49, 4, v0
  v_mfma_f32_16x16x32_bf16 v[84:87], a[176:179], a[68:71], v[84:87]
  ds_read_b64_tr_b16 a[170:171], v5 offset:6144
  v_lshl_add_u32 v46, v49, 4, s53
  v_mfma_f32_16x16x32_bf16 v[84:87], a[180:183], a[84:87], v[84:87]
  buffer_load_dwordx4 v32, s[36:39], s71 offen lds
  v_lshlrev_b32 v47, 2, v0
  v_add_u32 v45, s53, v47
  v_mfma_f32_16x16x32_bf16 v[80:83], a[180:183], a[80:83], v[80:83]
  ds_read_b64_tr_b16 a[180:181], v2 offset:8192
  v_lshrrev_b32 v48, 3, v0
  v_mfma_f32_16x16x32_bf16 v[80:83], a[176:179], a[64:67], v[80:83]
  s_waitcnt lgkmcnt(5)
  s_add_u32 m0, s45, 102400
  s_add_u32 s61, s71, 65536
  v_mfma_f32_16x16x32_bf16 v[96:99], a[164:167], a[64:67], v[96:99]
  ds_read_b64_tr_b16 a[182:183], v2 offset:10240
  v_and_b32 v50, 7, v0
  v_mfma_f32_16x16x32_bf16 v[96:99], a[160:163], a[80:83], v[96:99]
  buffer_load_dwordx4 v32, s[36:39], s61 offen lds
  v_xor_b32 v51, v50, v48
  v_lshlrev_b32 v51, 4, v51
  v_mfma_f32_16x16x32_bf16 v[100:103], a[160:163], a[84:87], v[100:103]
  ds_read_b64_tr_b16 a[176:177], v2 offset:12288
  v_lshl_add_u32 v40, v48, 11, v51
  v_mfma_f32_16x16x32_bf16 v[100:103], a[164:167], a[68:71], v[100:103]
  v_bfe_u32 v48, v0, 4, 1
  v_lshrrev_b32 v51, 5, v0
  v_mfma_f32_16x16x32_bf16 v[104:107], a[164:167], a[72:75], v[104:107]
  ds_read_b64_tr_b16 a[178:179], v2 offset:14336
  v_lshl_add_u32 v48, v48, 1, v51
  v_mfma_f32_16x16x32_bf16 v[104:107], a[160:163], a[88:91], v[104:107]
  s_cmp_eq_u32 s91, 2
  s_cselect_b32 s72, 11, 4
  s_lshl_b32 s64, s72, 17
  s_lshl_b32 s72, s72, 11
  s_add_u32 s72, s72, s84
  s_add_u32 m0, s45, 114688
  v_xor_b32 v48, v48, v50
  v_lshlrev_b32 v48, 4, v48
  v_mfma_f32_16x16x32_bf16 v[108:111], a[160:163], a[92:95], v[108:111]
  ds_read_b64_tr_b16 a[160:161], v3 offset:8192
  v_and_b32 v50, 15, v0
  v_mfma_f32_16x16x32_bf16 v[108:111], a[164:167], a[76:79], v[108:111]
  s_waitcnt lgkmcnt(5)
  buffer_load_dwordx4 v32, s[36:39], s64 offen lds
  v_lshl_add_u32 v48, v50, 7, v48
  v_mfma_f32_16x16x32_bf16 v[124:127], a[172:175], a[76:79], v[124:127]
  ds_read_b64_tr_b16 a[162:163], v3 offset:10240
  v_add_u32 v42, s90, v48
  v_mfma_f32_16x16x32_bf16 v[124:127], a[168:171], a[92:95], v[124:127]
  s_add_u32 m0, s45, 118784
  s_add_u32 s61, s64, 65536
  v_xor_b32 v43, 64, v42
  v_mfma_f32_16x16x32_bf16 v[120:123], a[168:171], a[88:91], v[120:123]
  ds_read_b64_tr_b16 a[164:165], v3 offset:12288
  v_add_u32 v44, s90, v1
  v_mfma_f32_16x16x32_bf16 v[120:123], a[172:175], a[72:75], v[120:123]
  buffer_load_dwordx4 v32, s[36:39], s61 offen lds
  v_bfe_u32 v48, v0, 2, 2
  v_lshrrev_b32 v49, 4, v0
  v_mfma_f32_16x16x32_bf16 v[116:119], a[172:175], a[68:71], v[116:119]
  ds_read_b64_tr_b16 a[166:167], v3 offset:14336
  v_and_b32 v50, 1, v0
  v_mfma_f32_16x16x32_bf16 v[116:119], a[168:171], a[84:87], v[116:119]
  s_cmp_eq_u32 s91, 3
  s_cselect_b32 s73, 13, 6
  s_lshl_b32 s65, s73, 17
  s_lshl_b32 s73, s73, 11
  s_add_u32 s73, s73, s84
  s_add_u32 m0, s45, 81920
  v_lshlrev_b32 v50, 4, v50
  v_mov_b32 v51, 0xffff
  v_mfma_f32_16x16x32_bf16 v[112:115], a[168:171], a[80:83], v[112:115]
  ds_read_b64_tr_b16 a[168:169], v4 offset:8192
  v_lshlrev_b32 v50, v50, v51
  v_mfma_f32_16x16x32_bf16 v[112:115], a[172:175], a[64:67], v[112:115]
  s_waitcnt lgkmcnt(5)
  buffer_load_dwordx4 v32, s[36:39], s65 offen lds
  v_cmp_eq_u32 vcc, v48, v49
  v_mov_b32 v60, 0
  v_mov_b32 v61, 0
  v_cndmask_b32 v48, 0, v50, vcc
  v_mfma_f32_16x16x32_bf16 v[128:131], a[180:183], a[64:67], v[128:131]
  ds_read_b64_tr_b16 a[170:171], v4 offset:10240
  v_and_b32 v49, 2, v0
  v_mfma_f32_16x16x32_bf16 v[128:131], a[176:179], a[80:83], v[128:131]
  s_add_u32 m0, s45, 86016
  s_add_u32 s61, s65, 65536
  v_cmp_eq_u32 vcc, 0, v49
  v_mov_b32 v54, 0
  v_mov_b32 v55, 0
  v_cndmask_b32 v50, 0, v48, vcc
  v_mfma_f32_16x16x32_bf16 v[132:135], a[176:179], a[84:87], v[132:135]
  ds_read_b64_tr_b16 a[172:173], v4 offset:12288
  v_sub_u32 v51, v48, v50
  v_mfma_f32_16x16x32_bf16 v[132:135], a[180:183], a[68:71], v[132:135]
  buffer_load_dwordx4 v32, s[36:39], s61 offen lds
  v_mfma_f32_16x16x32_bf16 v[136:139], a[180:183], a[72:75], v[136:139]
  ds_read_b64_tr_b16 a[174:175], v4 offset:14336
  v_mfma_f32_16x16x32_bf16 v[136:139], a[176:179], a[88:91], v[136:139]
  v_mfma_f32_16x16x32_bf16 v[140:143], a[176:179], a[92:95], v[140:143]
  ds_read_b64_tr_b16 a[176:177], v5 offset:8192
  v_mfma_f32_16x16x32_bf16 v[140:143], a[180:183], a[76:79], v[140:143]
  s_waitcnt lgkmcnt(5)
  s_add_u32 m0, s45, 106496
  v_mfma_f32_16x16x32_bf16 v[156:159], a[160:163], a[76:79], v[156:159]
  ds_read_b64_tr_b16 a[178:179], v5 offset:10240
  v_mfma_f32_16x16x32_bf16 v[156:159], a[164:167], a[92:95], v[156:159]
  buffer_load_dwordx4 v33, s[36:39], s71 offen lds
  v_mfma_f32_16x16x32_bf16 v[152:155], a[164:167], a[88:91], v[152:155]
  ds_read_b64_tr_b16 a[180:181], v5 offset:12288
  v_mfma_f32_16x16x32_bf16 v[152:155], a[160:163], a[72:75], v[152:155]
  s_add_u32 m0, s45, 110592
  s_add_u32 s61, s71, 65536
  v_mfma_f32_16x16x32_bf16 v[148:151], a[160:163], a[68:71], v[148:151]
  ds_read_b64_tr_b16 a[182:183], v5 offset:14336
  buffer_load_dwordx4 v33, s[36:39], s61 offen lds
  v_mfma_f32_16x16x32_bf16 v[148:151], a[164:167], a[84:87], v[148:151]
  s_waitcnt vmcnt(31)
  s_barrier
  v_mfma_f32_16x16x32_bf16 v[144:147], a[164:167], a[80:83], v[144:147]
  ds_read_b64_tr_b16 a[164:165], v2 offset:32768
  v_mfma_f32_16x16x32_bf16 v[144:147], a[160:163], a[64:67], v[144:147]
  s_waitcnt lgkmcnt(5)
  s_cmp_eq_u32 s91, 0
  s_cselect_b32 s74, 0, 7
  s_lshl_b32 s66, s74, 17
  s_lshl_b32 s74, s74, 11
  s_add_u32 s74, s74, s84
  s_add_u32 m0, s45, 65536
  v_mfma_f32_16x16x32_bf16 v[160:163], a[168:171], a[64:67], v[160:163]
  ds_read_b64_tr_b16 a[166:167], v2 offset:34816
  v_mfma_f32_16x16x32_bf16 v[160:163], a[172:175], a[80:83], v[160:163]
  buffer_load_dwordx4 v32, s[36:39], s66 offen lds
  v_mfma_f32_16x16x32_bf16 v[164:167], a[172:175], a[84:87], v[164:167]
  ds_read_b64_tr_b16 a[160:161], v2 offset:36864
  v_mfma_f32_16x16x32_bf16 v[164:167], a[168:171], a[68:71], v[164:167]
  s_add_u32 m0, s45, 69632
  s_add_u32 s61, s66, 65536
  v_mfma_f32_16x16x32_bf16 v[168:171], a[168:171], a[72:75], v[168:171]
  ds_read_b64_tr_b16 a[162:163], v2 offset:38912
  v_mfma_f32_16x16x32_bf16 v[168:171], a[172:175], a[88:91], v[168:171]
  buffer_load_dwordx4 v32, s[36:39], s61 offen lds
  v_mfma_f32_16x16x32_bf16 v[172:175], a[172:175], a[92:95], v[172:175]
  ds_read_b64_tr_b16 a[172:173], v3 offset:32768
  v_mfma_f32_16x16x32_bf16 v[172:175], a[168:171], a[76:79], v[172:175]
  s_waitcnt lgkmcnt(5)
  v_mfma_f32_16x16x32_bf16 v[188:191], a[176:179], a[76:79], v[188:191]
  ds_read_b64_tr_b16 a[174:175], v3 offset:34816
  v_mfma_f32_16x16x32_bf16 v[188:191], a[180:183], a[92:95], v[188:191]
  s_add_u32 s62, s88, 0
  v_mfma_f32_16x16x32_bf16 v[184:187], a[180:183], a[88:91], v[184:187]
  ds_read_b64_tr_b16 a[168:169], v3 offset:36864
  v_mfma_f32_16x16x32_bf16 v[184:187], a[176:179], a[72:75], v[184:187]
  buffer_load_dword v240, v47, s[8:11], s62 offen sc1
  v_mfma_f32_16x16x32_bf16 v[180:183], a[176:179], a[68:71], v[180:183]
  ds_read_b64_tr_b16 a[170:171], v3 offset:38912
  v_mfma_f32_16x16x32_bf16 v[180:183], a[180:183], a[84:87], v[180:183]
  s_add_u32 s62, s88, 24576
  v_mfma_f32_16x16x32_bf16 v[176:179], a[180:183], a[80:83], v[176:179]
  ds_read_b64_tr_b16 a[180:181], v4 offset:32768
  v_mfma_f32_16x16x32_bf16 v[176:179], a[176:179], a[64:67], v[176:179]
  s_waitcnt vmcnt(24) lgkmcnt(5)
  buffer_load_dword v241, v47, s[8:11], s62 offen sc1
  v_mfma_f32_16x16x32_bf16 v[64:67], a[164:167], a[96:99], v[64:67]
  ds_read_b64_tr_b16 a[182:183], v4 offset:34816
  v_mfma_f32_16x16x32_bf16 v[64:67], a[160:163], a[112:115], v[64:67]
  s_add_u32 s62, s88, 49152
  v_mfma_f32_16x16x32_bf16 v[68:71], a[160:163], a[116:119], v[68:71]
  ds_read_b64_tr_b16 a[176:177], v4 offset:36864
  v_mfma_f32_16x16x32_bf16 v[68:71], a[164:167], a[100:103], v[68:71]
  buffer_load_dword v242, v47, s[8:11], s62 offen sc1
  v_mfma_f32_16x16x32_bf16 v[72:75], a[164:167], a[104:107], v[72:75]
  ds_read_b64_tr_b16 a[178:179], v4 offset:38912
  v_mfma_f32_16x16x32_bf16 v[72:75], a[160:163], a[120:123], v[72:75]
  s_add_u32 s62, s88, 73728
  v_mfma_f32_16x16x32_bf16 v[76:79], a[160:163], a[124:127], v[76:79]
  ds_read_b64_tr_b16 a[160:161], v5 offset:32768
  v_mfma_f32_16x16x32_bf16 v[76:79], a[164:167], a[108:111], v[76:79]
  s_waitcnt lgkmcnt(5)
  buffer_load_dword v243, v47, s[8:11], s62 offen sc1
  v_mfma_f32_16x16x32_bf16 v[92:95], a[172:175], a[108:111], v[92:95]
  ds_read_b64_tr_b16 a[162:163], v5 offset:34816
  v_mfma_f32_16x16x32_bf16 v[92:95], a[168:171], a[124:127], v[92:95]
  v_mfma_f32_16x16x32_bf16 v[88:91], a[168:171], a[120:123], v[88:91]
  ds_read_b64_tr_b16 a[164:165], v5 offset:36864
  v_mfma_f32_16x16x32_bf16 v[88:91], a[172:175], a[104:107], v[88:91]
  s_cmp_eq_u32 s91, 1
  s_cselect_b32 s75, 2, 9
  s_lshl_b32 s67, s75, 17
  s_lshl_b32 s75, s75, 11
  s_add_u32 s75, s75, s84
  s_add_u32 m0, s45, 0
  v_mfma_f32_16x16x32_bf16 v[84:87], a[172:175], a[100:103], v[84:87]
  ds_read_b64_tr_b16 a[166:167], v5 offset:38912
  v_mfma_f32_16x16x32_bf16 v[84:87], a[168:171], a[116:119], v[84:87]
  buffer_load_dwordx4 v32, s[36:39], s67 offen lds
  v_mfma_f32_16x16x32_bf16 v[80:83], a[168:171], a[112:115], v[80:83]
  ds_read_b64_tr_b16 a[168:169], v2 offset:40960
  v_mfma_f32_16x16x32_bf16 v[80:83], a[172:175], a[96:99], v[80:83]
  s_waitcnt lgkmcnt(5)
  s_add_u32 m0, s45, 4096
  s_add_u32 s61, s67, 65536
  v_mfma_f32_16x16x32_bf16 v[96:99], a[180:183], a[96:99], v[96:99]
  ds_read_b64_tr_b16 a[170:171], v2 offset:43008
  v_mfma_f32_16x16x32_bf16 v[96:99], a[176:179], a[112:115], v[96:99]
  s_sub_u32 s82, s82, 491520
HOP17:
  s_cbranch_execz WRET1
  buffer_load_dwordx4 v32, s[36:39], s61 offen lds
  v_mfma_f32_16x16x32_bf16 v[100:103], a[176:179], a[116:119], v[100:103]
  ds_read_b64_tr_b16 a[172:173], v2 offset:45056
  s_lshl_b32 s83, s44, 28
  s_add_u32 s83, s83, s82
  buffer_load_dword v36, v37, s[8:11], s83 offen sc1
  v_mfma_f32_16x16x32_bf16 v[100:103], a[180:183], a[100:103], v[100:103]
  s_add_u32 m0, s45, 122880
  v_mfma_f32_16x16x32_bf16 v[104:107], a[180:183], a[104:107], v[104:107]
  ds_read_b64_tr_b16 a[174:175], v2 offset:47104
  v_mfma_f32_16x16x32_bf16 v[104:107], a[176:179], a[120:123], v[104:107]
  buffer_load_dwordx4 v33, s[36:39], s64 offen lds
  v_mfma_f32_16x16x32_bf16 v[108:111], a[176:179], a[124:127], v[108:111]
  ds_read_b64_tr_b16 a[176:177], v3 offset:40960
  v_mfma_f32_16x16x32_bf16 v[108:111], a[180:183], a[108:111], v[108:111]
  s_waitcnt lgkmcnt(5)
  s_add_u32 m0, s45, 126976
  s_add_u32 s61, s64, 65536
  v_mfma_f32_16x16x32_bf16 v[124:127], a[160:163], a[108:111], v[124:127]
  ds_read_b64_tr_b16 a[178:179], v3 offset:43008
  v_mfma_f32_16x16x32_bf16 v[124:127], a[164:167], a[124:127], v[124:127]
  buffer_load_dwordx4 v33, s[36:39], s61 offen lds
  v_mfma_f32_16x16x32_bf16 v[120:123], a[164:167], a[120:123], v[120:123]
  ds_read_b64_tr_b16 a[180:181], v3 offset:45056
  v_mfma_f32_16x16x32_bf16 v[120:123], a[160:163], a[104:107], v[120:123]
  v_mfma_f32_16x16x32_bf16 v[116:119], a[160:163], a[100:103], v[116:119]
  ds_read_b64_tr_b16 a[182:183], v3 offset:47104
  v_mfma_f32_16x16x32_bf16 v[116:119], a[164:167], a[116:119], v[116:119]
  s_add_u32 m0, s45, 90112
  v_mfma_f32_16x16x32_bf16 v[112:115], a[164:167], a[112:115], v[112:115]
  ds_read_b64_tr_b16 a[164:165], v4 offset:40960
  v_mfma_f32_16x16x32_bf16 v[112:115], a[160:163], a[96:99], v[112:115]
  s_waitcnt lgkmcnt(5)
  buffer_load_dwordx4 v33, s[36:39], s65 offen lds
  v_mfma_f32_16x16x32_bf16 v[128:131], a[168:171], a[96:99], v[128:131]
  ds_read_b64_tr_b16 a[166:167], v4 offset:43008
  v_mfma_f32_16x16x32_bf16 v[128:131], a[172:175], a[112:115], v[128:131]
  s_add_u32 m0, s45, 94208
  s_add_u32 s61, s65, 65536
  v_mfma_f32_16x16x32_bf16 v[132:135], a[172:175], a[116:119], v[132:135]
  ds_read_b64_tr_b16 a[160:161], v4 offset:45056
  v_mfma_f32_16x16x32_bf16 v[132:135], a[168:171], a[100:103], v[132:135]
  buffer_load_dwordx4 v33, s[36:39], s61 offen lds
  v_mfma_f32_16x16x32_bf16 v[136:139], a[168:171], a[104:107], v[136:139]
  ds_read_b64_tr_b16 a[162:163], v4 offset:47104
  v_mfma_f32_16x16x32_bf16 v[136:139], a[172:175], a[120:123], v[136:139]
  s_add_u32 m0, s45, 73728
  v_mfma_f32_16x16x32_bf16 v[140:143], a[172:175], a[124:127], v[140:143]
  ds_read_b64_tr_b16 a[172:173], v5 offset:40960
  v_mfma_f32_16x16x32_bf16 v[140:143], a[168:171], a[108:111], v[140:143]
  s_waitcnt lgkmcnt(5)
  buffer_load_dwordx4 v33, s[36:39], s66 offen lds
  v_mfma_f32_16x16x32_bf16 v[156:159], a[176:179], a[108:111], v[156:159]
  ds_read_b64_tr_b16 a[174:175], v5 offset:43008
  v_mfma_f32_16x16x32_bf16 v[156:159], a[180:183], a[124:127], v[156:159]
  s_add_u32 m0, s45, 77824
  s_add_u32 s61, s66, 65536
  v_mfma_f32_16x16x32_bf16 v[152:155], a[180:183], a[120:123], v[152:155]
  ds_read_b64_tr_b16 a[168:169], v5 offset:45056
  v_mfma_f32_16x16x32_bf16 v[152:155], a[176:179], a[104:107], v[152:155]
  buffer_load_dwordx4 v33, s[36:39], s61 offen lds
  v_mfma_f32_16x16x32_bf16 v[148:151], a[176:179], a[100:103], v[148:151]
  ds_read_b64_tr_b16 a[170:171], v5 offset:47104
  v_mfma_f32_16x16x32_bf16 v[148:151], a[180:183], a[116:119], v[148:151]
  v_mfma_f32_16x16x32_bf16 v[144:147], a[180:183], a[112:115], v[144:147]
  ds_read_b64_tr_b16 a[180:181], v2 offset:49152
  v_mfma_f32_16x16x32_bf16 v[144:147], a[176:179], a[96:99], v[144:147]
  s_waitcnt lgkmcnt(5)
  v_mfma_f32_16x16x32_bf16 v[160:163], a[164:167], a[96:99], v[160:163]
  ds_read_b64_tr_b16 a[182:183], v2 offset:51200
  v_mfma_f32_16x16x32_bf16 v[160:163], a[160:163], a[112:115], v[160:163]
  v_mfma_f32_16x16x32_bf16 v[164:167], a[160:163], a[116:119], v[164:167]
  ds_read_b64_tr_b16 a[176:177], v2 offset:53248
  v_mfma_f32_16x16x32_bf16 v[164:167], a[164:167], a[100:103], v[164:167]
  v_mfma_f32_16x16x32_bf16 v[168:171], a[164:167], a[104:107], v[168:171]
  ds_read_b64_tr_b16 a[178:179], v2 offset:55296
  v_mfma_f32_16x16x32_bf16 v[168:171], a[160:163], a[120:123], v[168:171]
  v_mfma_f32_16x16x32_bf16 v[172:175], a[160:163], a[124:127], v[172:175]
  ds_read_b64_tr_b16 a[160:161], v3 offset:49152
  v_mfma_f32_16x16x32_bf16 v[172:175], a[164:167], a[108:111], v[172:175]
  s_waitcnt lgkmcnt(5)
  v_mfma_f32_16x16x32_bf16 v[188:191], a[172:175], a[108:111], v[188:191]
  ds_read_b64_tr_b16 a[162:163], v3 offset:51200
  v_mfma_f32_16x16x32_bf16 v[188:191], a[168:171], a[124:127], v[188:191]
  v_mfma_f32_16x16x32_bf16 v[184:187], a[168:171], a[120:123], v[184:187]
  ds_read_b64_tr_b16 a[164:165], v3 offset:53248
  s_waitcnt vmcnt(6)
  s_cmp_lg_u32 s44, 0
  s_cbranch_scc1 PL13_adaLN_cond__sliding_local_dilated__swiglu_ffn__prompt_kernelx
  v_cmp_ne_u32 vcc, s46, v36
  s_nop 4
  s_cbranch_vccz PL13_adaLN_cond__sliding_local_dilated__swiglu_ffn__prompt_kernelx
  s_mov_b32 s83, 60000
PL13_adaLN_cond__sliding_local_dilated__swiglu_ffn__prompt_kernel:
  buffer_load_dword v36, v37, s[8:11], s82 offen sc1
  s_sub_u32 s83, s83, 1
  s_cmp_eq_u32 s83, 0
  s_waitcnt vmcnt(0)
  s_cbranch_scc1 PL13_adaLN_cond__sliding_local_dilated__swiglu_ffn__prompt_kernelx
  v_cmp_ne_u32 vcc, s46, v36
  s_nop 4
  s_cbranch_vccnz PL13_adaLN_cond__sliding_local_dilated__swiglu_ffn__prompt_kernel
PL13_adaLN_cond__sliding_local_dilated__swiglu_ffn__prompt_kernelx:
  s_barrier
  v_mfma_f32_16x16x32_bf16 v[184:187], a[172:175], a[104:107], v[184:187]
  v_mfma_f32_16x16x32_bf16 v[180:183], a[172:175], a[100:103], v[180:183]
  ds_read_b64_tr_b16 a[166:167], v3 offset:55296
  v_mfma_f32_16x16x32_bf16 v[180:183], a[168:171], a[116:119], v[180:183]
  buffer_load_dwordx4 a[188:191], v1, s[8:11], s78 offen offset:0 sc1
  v_mfma_f32_16x16x32_bf16 v[176:179], a[168:171], a[112:115], v[176:179]
  ds_read_b64_tr_b16 a[168:169], v4 offset:49152
  v_mfma_f32_16x16x32_bf16 v[176:179], a[172:175], a[96:99], v[176:179]
  s_waitcnt vmcnt(29) lgkmcnt(5)
  v_mfma_f32_16x16x32_bf16 v[64:67], a[180:183], a[128:131], v[64:67]
  ds_read_b64_tr_b16 a[170:171], v4 offset:51200
  v_mfma_f32_16x16x32_bf16 v[64:67], a[176:179], a[144:147], v[64:67]
  buffer_load_dwordx4 a[204:207], v1, s[8:11], s78 offen offset:1024 sc1
  v_mfma_f32_16x16x32_bf16 v[68:71], a[176:179], a[148:151], v[68:71]
  ds_read_b64_tr_b16 a[172:173], v4 offset:53248
  v_mfma_f32_16x16x32_bf16 v[68:71], a[180:183], a[132:135], v[68:71]
  s_add_u32 s78, s78, 131072
  v_mfma_f32_16x16x32_bf16 v[72:75], a[180:183], a[136:139], v[72:75]
  ds_read_b64_tr_b16 a[174:175], v4 offset:55296
  v_mfma_f32_16x16x32_bf16 v[72:75], a[176:179], a[152:155], v[72:75]
  buffer_load_dwordx4 a[192:195], v1, s[8:11], s78 offen offset:0 sc1
  v_mfma_f32_16x16x32_bf16 v[76:79], a[176:179], a[156:159], v[76:79]
  ds_read_b64_tr_b16 a[176:177], v5 offset:49152
  v_mfma_f32_16x16x32_bf16 v[76:79], a[180:183], a[140:143], v[76:79]
  s_waitcnt lgkmcnt(5)
  v_mfma_f32_16x16x32_bf16 v[92:95], a[160:163], a[140:143], v[92:95]
  ds_read_b64_tr_b16 a[178:179], v5 offset:51200
  v_mfma_f32_16x16x32_bf16 v[92:95], a[164:167], a[156:159], v[92:95]
  v_mfma_f32_16x16x32_bf16 v[88:91], a[164:167], a[152:155], v[88:91]
  ds_read_b64_tr_b16 a[180:181], v5 offset:53248
  v_mfma_f32_16x16x32_bf16 v[88:91], a[160:163], a[136:139], v[88:91]
  buffer_load_dwordx4 a[208:211], v1, s[8:11], s78 offen offset:1024 sc1
  v_mfma_f32_16x16x32_bf16 v[84:87], a[160:163], a[132:135], v[84:87]
  ds_read_b64_tr_b16 a[182:183], v5 offset:55296
  v_mfma_f32_16x16x32_bf16 v[84:87], a[164:167], a[148:151], v[84:87]
  s_add_u32 s78, s78, s89
  v_mfma_f32_16x16x32_bf16 v[80:83], a[164:167], a[144:147], v[80:83]
  ds_read_b64_tr_b16 a[164:165], v2 offset:57344
  v_mfma_f32_16x16x32_bf16 v[80:83], a[160:163], a[128:131], v[80:83]
  s_waitcnt lgkmcnt(5)
  buffer_load_dwordx4 a[196:199], v1, s[8:11], s78 offen offset:0 sc1
  v_mfma_f32_16x16x32_bf16 v[96:99], a[168:171], a[128:131], v[96:99]
  ds_read_b64_tr_b16 a[166:167], v2 offset:59392
  v_mfma_f32_16x16x32_bf16 v[96:99], a[172:175], a[144:147], v[96:99]
  v_mfma_f32_16x16x32_bf16 v[100:103], a[172:175], a[148:151], v[100:103]
  ds_read_b64_tr_b16 a[160:161], v2 offset:61440
  v_mfma_f32_16x16x32_bf16 v[100:103], a[168:171], a[132:135], v[100:103]
  buffer_load_dwordx4 a[212:215], v1, s[8:11], s78 offen offset:1024 sc1
  v_mfma_f32_16x16x32_bf16 v[104:107], a[168:171], a[136:139], v[104:107]
  ds_read_b64_tr_b16 a[162:163], v2 offset:63488
  v_mfma_f32_16x16x32_bf16 v[104:107], a[172:175], a[152:155], v[104:107]
  s_add_u32 s78, s78, 131072
  v_mfma_f32_16x16x32_bf16 v[108:111], a[172:175], a[156:159], v[108:111]
  ds_read_b64_tr_b16 a[172:173], v3 offset:57344
  v_mfma_f32_16x16x32_bf16 v[108:111], a[168:171], a[140:143], v[108:111]
  s_waitcnt lgkmcnt(5)
  buffer_load_dwordx4 a[200:203], v1, s[8:11], s78 offen offset:0 sc1
  v_mfma_f32_16x16x32_bf16 v[124:127], a[176:179], a[140:143], v[124:127]
  ds_read_b64_tr_b16 a[174:175], v3 offset:59392
  v_mfma_f32_16x16x32_bf16 v[124:127], a[180:183], a[156:159], v[124:127]
  v_mfma_f32_16x16x32_bf16 v[120:123], a[180:183], a[152:155], v[120:123]
  ds_read_b64_tr_b16 a[168:169], v3 offset:61440
  v_mfma_f32_16x16x32_bf16 v[120:123], a[176:179], a[136:139], v[120:123]
  v_mfma_f32_16x16x32_bf16 v[116:119], a[176:179], a[132:135], v[116:119]
  ds_read_b64_tr_b16 a[170:171], v3 offset:63488
  v_mfma_f32_16x16x32_bf16 v[116:119], a[180:183], a[148:151], v[116:119]
  buffer_load_dwordx4 a[216:219], v1, s[8:11], s78 offen offset:1024 sc1
  v_mfma_f32_16x16x32_bf16 v[112:115], a[180:183], a[144:147], v[112:115]
  ds_read_b64_tr_b16 a[180:181], v4 offset:57344
  v_mfma_f32_16x16x32_bf16 v[112:115], a[176:179], a[128:131], v[112:115]
  s_waitcnt lgkmcnt(5)
  v_mfma_f32_16x16x32_bf16 v[128:131], a[164:167], a[128:131], v[128:131]
  ds_read_b64_tr_b16 a[182:183], v4 offset:59392
  v_mfma_f32_16x16x32_bf16 v[128:131], a[160:163], a[144:147], v[128:131]
  buffer_load_dwordx4 a[220:223], v1, s[8:11], s79 offen offset:0 sc1
  v_mfma_f32_16x16x32_bf16 v[132:135], a[160:163], a[148:151], v[132:135]
  ds_read_b64_tr_b16 a[176:177], v4 offset:61440
  v_mfma_f32_16x16x32_bf16 v[132:135], a[164:167], a[132:135], v[132:135]
  v_mfma_f32_16x16x32_bf16 v[136:139], a[164:167], a[136:139], v[136:139]
  ds_read_b64_tr_b16 a[178:179], v4 offset:63488
  v_mfma_f32_16x16x32_bf16 v[136:139], a[160:163], a[152:155], v[136:139]
  buffer_load_dwordx4 a[236:239], v1, s[8:11], s79 offen offset:1024 sc1
  v_mfma_f32_16x16x32_bf16 v[140:143], a[160:163], a[156:159], v[140:143]
  ds_read_b64_tr_b16 a[160:161], v5 offset:57344
  v_mfma_f32_16x16x32_bf16 v[140:143], a[164:167], a[140:143], v[140:143]
  s_waitcnt lgkmcnt(5)
  s_add_u32 s79, s79, 131072
  v_mfma_f32_16x16x32_bf16 v[156:159], a[172:175], a[140:143], v[156:159]
  ds_read_b64_tr_b16 a[162:163], v5 offset:59392
  v_mfma_f32_16x16x32_bf16 v[156:159], a[168:171], a[156:159], v[156:159]
  buffer_load_dwordx4 a[224:227], v1, s[8:11], s79 offen offset:0 sc1
  ds_read_b128 v[192:195], v44 offset:0
  v_mfma_f32_16x16x32_bf16 v[152:155], a[168:171], a[152:155], v[152:155]
  ds_read_b64_tr_b16 a[164:165], v5 offset:61440
  v_mfma_f32_16x16x32_bf16 v[152:155], a[172:175], a[136:139], v[152:155]
  ds_read_b128 v[196:199], v44 offset:1024
  v_mfma_f32_16x16x32_bf16 v[148:151], a[172:175], a[132:135], v[148:151]
  ds_read_b64_tr_b16 a[166:167], v5 offset:63488
  v_mfma_f32_16x16x32_bf16 v[148:151], a[168:171], a[148:151], v[148:151]
  s_waitcnt vmcnt(35)
  s_barrier
  v_mfma_f32_16x16x32_bf16 v[144:147], a[168:171], a[144:147], v[144:147]
  ds_read_b64_tr_b16 a[168:169], v2 offset:16384
  v_mfma_f32_16x16x32_bf16 v[144:147], a[172:175], a[128:131], v[144:147]
  s_waitcnt lgkmcnt(7)
  buffer_load_dwordx4 a[240:243], v1, s[8:11], s79 offen offset:1024 sc1
  v_mfma_f32_16x16x32_bf16 v[160:163], a[180:183], a[128:131], v[160:163]
  ds_read_b64_tr_b16 a[170:171], v2 offset:18432
  ds_read_b128 v[200:203], v44 offset:2048
  v_mfma_f32_16x16x32_bf16 v[160:163], a[176:179], a[144:147], v[160:163]
  s_add_u32 s79, s79, s89
  ds_read_b128 v[204:207], v44 offset:3072
  v_mfma_f32_16x16x32_bf16 v[164:167], a[176:179], a[148:151], v[164:167]
  ds_read_b64_tr_b16 a[172:173], v2 offset:20480
  s_waitcnt vmcnt(21)
  v_mfma_f32_16x16x32_bf16 v[164:167], a[180:183], a[132:135], v[164:167]
  buffer_load_dwordx4 a[228:231], v1, s[8:11], s79 offen offset:0 sc1
  v_add_f32 v240, v240, v241
  v_add_f32 v242, v242, v243
  v_mfma_f32_16x16x32_bf16 v[168:171], a[180:183], a[136:139], v[168:171]
  ds_read_b64_tr_b16 a[174:175], v2 offset:22528
  v_add_f32 v240, v240, v242
  v_mfma_f32_16x16x32_bf16 v[168:171], a[176:179], a[152:155], v[168:171]
  v_cvt_pk_bf16_f32 v240, v240, v240
  v_lshlrev_b32 v240, 16, v240
  v_mfma_f32_16x16x32_bf16 v[172:175], a[176:179], a[156:159], v[172:175]
  ds_read_b64_tr_b16 a[176:177], v3 offset:16384
  v_mfma_f32_16x16x32_bf16 v[172:175], a[180:183], a[140:143], v[172:175]
  s_waitcnt lgkmcnt(7)
  buffer_load_dwordx4 a[244:247], v1, s[8:11], s79 offen offset:1024 sc1
  v_mfma_f32_16x16x32_bf16 v[188:191], a[160:163], a[140:143], v[188:191]
  ds_read_b64_tr_b16 a[178:179], v3 offset:18432
  v_mfma_f32_16x16x32_bf16 v[188:191], a[164:167], a[156:159], v[188:191]
  s_add_u32 s79, s79, 131072
  ds_write_b32 v45, v240
  v_mfma_f32_16x16x32_bf16 v[184:187], a[164:167], a[152:155], v[184:187]
  ds_read_b64_tr_b16 a[180:181], v3 offset:20480
  v_mfma_f32_16x16x32_bf16 v[184:187], a[160:163], a[136:139], v[184:187]
  buffer_load_dwordx4 a[232:235], v1, s[8:11], s79 offen offset:0 sc1
  ds_read_b128 v[240:243], v46 offset:0
  v_mfma_f32_16x16x32_bf16 v[180:183], a[160:163], a[132:135], v[180:183]
  ds_read_b64_tr_b16 a[182:183], v3 offset:22528
  v_mfma_f32_16x16x32_bf16 v[180:183], a[164:167], a[148:151], v[180:183]
  ds_read_b128 v[244:247], v46 offset:64
  v_mfma_f32_16x16x32_bf16 v[176:179], a[164:167], a[144:147], v[176:179]
  ds_read_b64_tr_b16 a[164:165], v4 offset:16384
  v_mfma_f32_16x16x32_bf16 v[176:179], a[160:163], a[128:131], v[176:179]
  s_waitcnt vmcnt(7) lgkmcnt(8)
  ds_read_b128 v[248:251], v46 offset:128
  v_mfma_f32_16x16x32_bf16 v[64:67], a[168:171], a[188:191], v[64:67]
  ds_read_b64_tr_b16 a[166:167], v4 offset:18432
  v_mfma_f32_16x16x32_bf16 v[64:67], a[172:175], a[204:207], v[64:67]
  buffer_load_dwordx4 a[248:251], v1, s[8:11], s79 offen offset:1024 sc1
  ds_read_b128 v[252:255], v46 offset:192
  v_mfma_f32_16x16x32_bf16 v[68:71], a[172:175], a[208:211], v[68:71]
  ds_read_b64_tr_b16 a[160:161], v4 offset:20480
  s_waitcnt lgkmcnt(14)
  v_mfma_f32_16x16x32_bf16 v[68:71], a[168:171], a[192:195], v[68:71]
  v_lshlrev_b32 v208, 16, v192
  v_and_b32 v209, 0xffff0000, v192
  v_mfma_f32_16x16x32_bf16 v[72:75], a[168:171], a[196:199], v[72:75]
  ds_read_b64_tr_b16 a[162:163], v4 offset:22528
  v_lshlrev_b32 v210, 16, v193
  v_mfma_f32_16x16x32_bf16 v[72:75], a[172:175], a[212:215], v[72:75]
  buffer_load_dwordx4 a[0:3], v1, s[8:11], s72 offen offset:0 sc1
  v_and_b32 v211, 0xffff0000, v193
  v_lshlrev_b32 v212, 16, v194
  v_mfma_f32_16x16x32_bf16 v[76:79], a[172:175], a[216:219], v[76:79]
  ds_read_b64_tr_b16 a[172:173], v5 offset:16384
  v_and_b32 v213, 0xffff0000, v194
  v_mfma_f32_16x16x32_bf16 v[76:79], a[168:171], a[200:203], v[76:79]
  s_waitcnt lgkmcnt(8)
  v_lshlrev_b32 v214, 16, v195
  v_and_b32 v215, 0xffff0000, v195
  v_mfma_f32_16x16x32_bf16 v[92:95], a[176:179], a[200:203], v[92:95]
  ds_read_b64_tr_b16 a[174:175], v5 offset:18432
  v_lshlrev_b32 v216, 16, v196
  v_mfma_f32_16x16x32_bf16 v[92:95], a[180:183], a[216:219], v[92:95]
  buffer_load_dwordx4 a[16:19], v1, s[8:11], s72 offen offset:1024 sc1
  v_and_b32 v217, 0xffff0000, v196
  v_lshlrev_b32 v218, 16, v197
  v_mfma_f32_16x16x32_bf16 v[88:91], a[180:183], a[212:215], v[88:91]
  ds_read_b64_tr_b16 a[168:169], v5 offset:20480
  v_and_b32 v219, 0xffff0000, v197
  v_mfma_f32_16x16x32_bf16 v[88:91], a[176:179], a[196:199], v[88:91]
  s_add_u32 s72, s72, 131072
  v_lshlrev_b32 v220, 16, v198
  v_and_b32 v221, 0xffff0000, v198
  v_mfma_f32_16x16x32_bf16 v[84:87], a[176:179], a[192:195], v[84:87]
  ds_read_b64_tr_b16 a[170:171], v5 offset:22528
  v_lshlrev_b32 v222, 16, v199
  v_mfma_f32_16x16x32_bf16 v[84:87], a[180:183], a[208:211], v[84:87]
  buffer_load_dwordx4 a[4:7], v1, s[8:11], s72 offen offset:0 sc1
  v_and_b32 v223, 0xffff0000, v199
  v_lshlrev_b32 v224, 16, v200
  v_mfma_f32_16x16x32_bf16 v[80:83], a[180:183], a[204:207], v[80:83]
  ds_read_b64_tr_b16 a[180:181], v2 offset:24576
  v_and_b32 v225, 0xffff0000, v200
  v_mfma_f32_16x16x32_bf16 v[80:83], a[176:179], a[188:191], v[80:83]
  s_waitcnt lgkmcnt(5)
  v_lshlrev_b32 v226, 16, v201
  v_and_b32 v227, 0xffff0000, v201
  v_mfma_f32_16x16x32_bf16 v[96:99], a[164:167], a[188:191], v[96:99]
  ds_read_b64_tr_b16 a[182:183], v2 offset:26624
  v_lshlrev_b32 v228, 16, v202
  v_mfma_f32_16x16x32_bf16 v[96:99], a[160:163], a[204:207], v[96:99]
  v_and_b32 v229, 0xffff0000, v202
  v_lshlrev_b32 v230, 16, v203
  v_mfma_f32_16x16x32_bf16 v[100:103], a[160:163], a[208:211], v[100:103]
  ds_read_b64_tr_b16 a[176:177], v2 offset:28672
  v_and_b32 v231, 0xffff0000, v203
  v_mfma_f32_16x16x32_bf16 v[100:103], a[164:167], a[192:195], v[100:103]
  buffer_load_dwordx4 a[20:23], v1, s[8:11], s72 offen offset:1024 sc1
  v_lshlrev_b32 v232, 16, v204
  v_and_b32 v233, 0xffff0000, v204
  v_mfma_f32_16x16x32_bf16 v[104:107], a[164:167], a[196:199], v[104:107]
  ds_read_b64_tr_b16 a[178:179], v2 offset:30720
  v_lshlrev_b32 v234, 16, v205
  v_mfma_f32_16x16x32_bf16 v[104:107], a[160:163], a[212:215], v[104:107]
  s_add_u32 s72, s72, s89
  v_and_b32 v235, 0xffff0000, v205
  v_lshlrev_b32 v236, 16, v206
  v_mfma_f32_16x16x32_bf16 v[108:111], a[160:163], a[216:219], v[108:111]
  ds_read_b64_tr_b16 a[160:161], v3 offset:24576
  v_and_b32 v237, 0xffff0000, v206
  v_mfma_f32_16x16x32_bf16 v[108:111], a[164:167], a[200:203], v[108:111]
  s_waitcnt lgkmcnt(5)
  buffer_load_dwordx4 a[8:11], v1, s[8:11], s72 offen offset:0 sc1
  v_lshlrev_b32 v238, 16, v207
  v_mfma_f32_16x16x32_bf16 v[124:127], a[172:175], a[200:203], v[124:127]
  ds_read_b64_tr_b16 a[162:163], v3 offset:26624
  v_and_b32 v239, 0xffff0000, v207
  v_mfma_f32_16x16x32_bf16 v[124:127], a[168:171], a[216:219], v[124:127]
  v_mov_b32 v37, 0
  s_waitcnt lgkmcnt(12)
  v_mfma_f32_16x16x32_bf16 v[120:123], a[168:171], a[212:215], v[120:123]
  ds_read_b64_tr_b16 a[164:165], v3 offset:28672
  v_cvt_pk_bf16_f32 v52, v240, v241
  v_mfma_f32_16x16x32_bf16 v[120:123], a[172:175], a[196:199], v[120:123]
  buffer_load_dwordx4 a[24:27], v1, s[8:11], s72 offen offset:1024 sc1
  v_and_b32 v52, v52, v50
  v_cvt_pk_bf16_f32 v53, v242, v243
  v_mfma_f32_16x16x32_bf16 v[116:119], a[172:175], a[192:195], v[116:119]
  ds_read_b64_tr_b16 a[166:167], v3 offset:30720
  v_and_b32 v53, v53, v51
  v_mfma_f32_16x16x32_bf16 v[116:119], a[168:171], a[208:211], v[116:119]
  s_add_u32 s72, s72, 131072
  v_cvt_pk_bf16_f32 v56, v244, v245
  v_and_b32 v56, v56, v50
  v_mfma_f32_16x16x32_bf16 v[112:115], a[168:171], a[204:207], v[112:115]
  ds_read_b64_tr_b16 a[168:169], v4 offset:24576
  v_cvt_pk_bf16_f32 v57, v246, v247
  v_mfma_f32_16x16x32_bf16 v[112:115], a[172:175], a[188:191], v[112:115]
  s_waitcnt lgkmcnt(5)
  buffer_load_dwordx4 a[12:15], v1, s[8:11], s72 offen offset:0 sc1
  v_and_b32 v57, v57, v51
  v_mfma_f32_16x16x32_bf16 v[128:131], a[180:183], a[188:191], v[128:131]
  ds_read_b64_tr_b16 a[170:171], v4 offset:26624
  v_cvt_pk_bf16_f32 v58, v248, v249
  v_mfma_f32_16x16x32_bf16 v[128:131], a[176:179], a[204:207], v[128:131]
  v_and_b32 v58, v58, v50
  v_cvt_pk_bf16_f32 v59, v250, v251
  v_mfma_f32_16x16x32_bf16 v[132:135], a[176:179], a[208:211], v[132:135]
  ds_read_b64_tr_b16 a[172:173], v4 offset:28672
  v_and_b32 v59, v59, v51
  v_mfma_f32_16x16x32_bf16 v[132:135], a[180:183], a[192:195], v[132:135]
  v_cvt_pk_bf16_f32 v62, v252, v253
  v_and_b32 v62, v62, v50
  v_mfma_f32_16x16x32_bf16 v[136:139], a[180:183], a[196:199], v[136:139]
  ds_read_b64_tr_b16 a[174:175], v4 offset:30720
  v_cvt_pk_bf16_f32 v63, v254, v255
  v_mfma_f32_16x16x32_bf16 v[136:139], a[176:179], a[212:215], v[136:139]
  buffer_load_dwordx4 a[28:31], v1, s[8:11], s72 offen offset:1024 sc1
  v_and_b32 v63, v63, v51
  v_mfma_f32_16x16x32_bf16 v[140:143], a[176:179], a[216:219], v[140:143]
  ds_read_b64_tr_b16 a[176:177], v5 offset:24576
  v_mfma_f32_16x16x32_bf16 v[140:143], a[180:183], a[200:203], v[140:143]
  s_waitcnt lgkmcnt(5)
  s_cmp_eq_u32 s91, 2
  s_cselect_b32 s76, 4, 11
  s_lshl_b32 s68, s76, 17
  s_lshl_b32 s76, s76, 11
  s_add_u32 s76, s76, s84
  s_add_u32 m0, s45, 32768
  v_mfma_f32_16x16x32_bf16 v[156:159], a[160:163], a[200:203], v[156:159]
  ds_read_b64_tr_b16 a[178:179], v5 offset:26624
  v_mfma_f32_16x16x32_bf16 v[156:159], a[164:167], a[216:219], v[156:159]
  buffer_load_dwordx4 v32, s[36:39], s68 offen lds
  v_mfma_f32_16x16x32_bf16 v[152:155], a[164:167], a[212:215], v[152:155]
  ds_read_b64_tr_b16 a[180:181], v5 offset:28672
  v_mfma_f32_16x16x32_bf16 v[152:155], a[160:163], a[196:199], v[152:155]
  s_add_u32 m0, s45, 36864
  s_add_u32 s61, s68, 65536
  v_mfma_f32_16x16x32_bf16 v[148:151], a[160:163], a[192:195], v[148:151]
  ds_read_b64_tr_b16 a[182:183], v5 offset:30720
  v_mfma_f32_16x16x32_bf16 v[148:151], a[164:167], a[208:211], v[148:151]
  buffer_load_dwordx4 v32, s[36:39], s61 offen lds
  s_waitcnt vmcnt(45)
  s_barrier
  v_mfma_f32_16x16x32_bf16 v[144:147], a[164:167], a[204:207], v[144:147]
  ds_read_b64_tr_b16 a[164:165], v6 offset:32768
  v_mfma_f32_16x16x32_bf16 v[144:147], a[160:163], a[188:191], v[144:147]
  s_waitcnt lgkmcnt(5)
  s_cmp_eq_u32 s91, 3
  s_cselect_b32 s77, 6, 13
  s_lshl_b32 s69, s77, 17
  s_lshl_b32 s77, s77, 11
  s_add_u32 s77, s77, s84
  s_add_u32 m0, s45, 49152
  v_mfma_f32_16x16x32_bf16 v[160:163], a[168:171], a[188:191], v[160:163]
  ds_read_b64_tr_b16 a[166:167], v6 offset:34816
  v_mfma_f32_16x16x32_bf16 v[160:163], a[172:175], a[204:207], v[160:163]
  buffer_load_dwordx4 v32, s[36:39], s69 offen lds
  v_mfma_f32_16x16x32_bf16 v[164:167], a[172:175], a[208:211], v[164:167]
  ds_read_b64_tr_b16 a[160:161], v6 offset:36864
  v_mfma_f32_16x16x32_bf16 v[164:167], a[168:171], a[192:195], v[164:167]
  v_mfma_f32_16x16x32_bf16 v[168:171], a[168:171], a[196:199], v[168:171]
  ds_read_b64_tr_b16 a[162:163], v6 offset:38912
  v_mfma_f32_16x16x32_bf16 v[168:171], a[172:175], a[212:215], v[168:171]
  s_add_u32 m0, s45, 53248
  s_add_u32 s61, s69, 65536
  v_mfma_f32_16x16x32_bf16 v[172:175], a[172:175], a[216:219], v[172:175]
  ds_read_b64_tr_b16 a[172:173], v7 offset:32768
  v_mfma_f32_16x16x32_bf16 v[172:175], a[168:171], a[200:203], v[172:175]
  s_waitcnt lgkmcnt(5)
  buffer_load_dwordx4 v32, s[36:39], s61 offen lds
  v_mfma_f32_16x16x32_bf16 v[188:191], a[176:179], a[200:203], v[188:191]
  ds_read_b64_tr_b16 a[174:175], v7 offset:34816
  v_mfma_f32_16x16x32_bf16 v[188:191], a[180:183], a[216:219], v[188:191]
  v_mfma_f32_16x16x32_bf16 v[184:187], a[180:183], a[212:215], v[184:187]
  ds_read_b64_tr_b16 a[168:169], v7 offset:36864
  v_mfma_f32_16x16x32_bf16 v[184:187], a[176:179], a[196:199], v[184:187]
  buffer_load_dwordx4 a[32:35], v1, s[8:11], s73 offen offset:0 sc1
  v_mfma_f32_16x16x32_bf16 v[180:183], a[176:179], a[192:195], v[180:183]
  ds_read_b64_tr_b16 a[170:171], v7 offset:38912
  v_mfma_f32_16x16x32_bf16 v[180:183], a[180:183], a[208:211], v[180:183]
  v_mfma_f32_16x16x32_bf16 v[176:179], a[180:183], a[204:207], v[176:179]
  ds_read_b64_tr_b16 a[180:181], v8 offset:32768
  v_mfma_f32_16x16x32_bf16 v[176:179], a[176:179], a[188:191], v[176:179]
  s_waitcnt vmcnt(13) lgkmcnt(5)
  buffer_load_dwordx4 a[48:51], v1, s[8:11], s73 offen offset:1024 sc1
  v_mfma_f32_16x16x32_bf16 v[64:67], a[164:167], a[220:223], v[64:67]
  ds_read_b64_tr_b16 a[182:183], v8 offset:34816
  v_mfma_f32_16x16x32_bf16 v[64:67], a[160:163], a[236:239], v[64:67]
  s_add_u32 s73, s73, 131072
  v_mfma_f32_16x16x32_bf16 v[68:71], a[160:163], a[240:243], v[68:71]
  ds_read_b64_tr_b16 a[176:177], v8 offset:36864
  v_mfma_f32_16x16x32_bf16 v[68:71], a[164:167], a[224:227], v[68:71]
  buffer_load_dwordx4 a[36:39], v1, s[8:11], s73 offen offset:0 sc1
  v_mfma_f32_16x16x32_bf16 v[72:75], a[164:167], a[228:231], v[72:75]
  ds_read_b64_tr_b16 a[178:179], v8 offset:38912
  v_mfma_f32_16x16x32_bf16 v[72:75], a[160:163], a[244:247], v[72:75]
  v_mfma_f32_16x16x32_bf16 v[76:79], a[160:163], a[248:251], v[76:79]
  ds_read_b64_tr_b16 a[160:161], v9 offset:32768
  v_mfma_f32_16x16x32_bf16 v[76:79], a[164:167], a[232:235], v[76:79]
  s_waitcnt lgkmcnt(5)
  v_mfma_f32_16x16x32_bf16 v[92:95], a[172:175], a[232:235], v[92:95]
  ds_read_b64_tr_b16 a[162:163], v9 offset:34816
  v_mfma_f32_16x16x32_bf16 v[92:95], a[168:171], a[248:251], v[92:95]
  buffer_load_dwordx4 a[52:55], v1, s[8:11], s73 offen offset:1024 sc1
  v_mfma_f32_16x16x32_bf16 v[88:91], a[168:171], a[244:247], v[88:91]
  ds_read_b64_tr_b16 a[164:165], v9 offset:36864
  v_mfma_f32_16x16x32_bf16 v[88:91], a[172:175], a[228:231], v[88:91]
  s_add_u32 s73, s73, s89
  v_mfma_f32_16x16x32_bf16 v[84:87], a[172:175], a[224:227], v[84:87]
  ds_read_b64_tr_b16 a[166:167], v9 offset:38912
  v_mfma_f32_16x16x32_bf16 v[84:87], a[168:171], a[240:243], v[84:87]
  buffer_load_dwordx4 a[40:43], v1, s[8:11], s73 offen offset:0 sc1
  v_mfma_f32_16x16x32_bf16 v[80:83], a[168:171], a[236:239], v[80:83]
  ds_read_b64_tr_b16 a[168:169], v6 offset:49152
  v_mfma_f32_16x16x32_bf16 v[80:83], a[172:175], a[220:223], v[80:83]
  s_waitcnt lgkmcnt(5)
  v_mfma_f32_16x16x32_bf16 v[96:99], a[180:183], a[220:223], v[96:99]
  ds_read_b64_tr_b16 a[170:171], v6 offset:51200
  v_mfma_f32_16x16x32_bf16 v[96:99], a[176:179], a[236:239], v[96:99]
  buffer_load_dwordx4 a[56:59], v1, s[8:11], s73 offen offset:1024 sc1
  v_mfma_f32_16x16x32_bf16 v[100:103], a[176:179], a[240:243], v[100:103]
  ds_read_b64_tr_b16 a[172:173], v6 offset:53248
  v_mfma_f32_16x16x32_bf16 v[100:103], a[180:183], a[224:227], v[100:103]
  s_add_u32 s73, s73, 131072
  v_mfma_f32_16x16x32_bf16 v[104:107], a[180:183], a[228:231], v[104:107]
  ds_read_b64_tr_b16 a[174:175], v6 offset:55296
  v_mfma_f32_16x16x32_bf16 v[104:107], a[176:179], a[244:247], v[104:107]
  buffer_load_dwordx4 a[44:47], v1, s[8:11], s73 offen offset:0 sc1
  v_mfma_f32_16x16x32_bf16 v[108:111], a[176:179], a[248:251], v[108:111]
  ds_read_b64_tr_b16 a[176:177], v7 offset:49152
  v_mfma_f32_16x16x32_bf16 v[108:111], a[180:183], a[232:235], v[108:111]
  s_waitcnt lgkmcnt(5)
  v_mfma_f32_16x16x32_bf16 v[124:127], a[160:163], a[232:235], v[124:127]
  ds_read_b64_tr_b16 a[178:179], v7 offset:51200
  v_mfma_f32_16x16x32_bf16 v[124:127], a[164:167], a[248:251], v[124:127]
  v_mfma_f32_16x16x32_bf16 v[120:123], a[164:167], a[244:247], v[120:123]
  ds_read_b64_tr_b16 a[180:181], v7 offset:53248
  v_mfma_f32_16x16x32_bf16 v[120:123], a[160:163], a[228:231], v[120:123]
  buffer_load_dwordx4 a[60:63], v1, s[8:11], s73 offen offset:1024 sc1
  v_mfma_f32_16x16x32_bf16 v[116:119], a[160:163], a[224:227], v[116:119]
  ds_read_b64_tr_b16 a[182:183], v7 offset:55296
  v_mfma_f32_16x16x32_bf16 v[116:119], a[164:167], a[240:243], v[116:119]
  v_mfma_f32_16x16x32_bf16 v[112:115], a[164:167], a[236:239], v[112:115]
  ds_read_b64_tr_b16 a[164:165], v8 offset:49152
  v_mfma_f32_16x16x32_bf16 v[112:115], a[160:163], a[220:223], v[112:115]
  s_waitcnt vmcnt(12) lgkmcnt(5)
  buffer_load_dwordx4 a[64:67], v1, s[8:11], s74 offen offset:0 sc1
  v_mfma_f32_16x16x32_bf16 v[64:67], a[168:171], a[0:3], v[64:67]
  ds_read_b64_tr_b16 a[166:167], v8 offset:51200
  v_mfma_f32_16x16x32_bf16 v[64:67], a[172:175], a[16:19], v[64:67]
  v_mfma_f32_16x16x32_bf16 v[68:71], a[172:175], a[20:23], v[68:71]
  ds_read_b64_tr_b16 a[160:161], v8 offset:53248
  v_mfma_f32_16x16x32_bf16 v[68:71], a[168:171], a[4:7], v[68:71]
  buffer_load_dwordx4 a[80:83], v1, s[8:11], s74 offen offset:1024 sc1
  v_mfma_f32_16x16x32_bf16 v[72:75], a[168:171], a[8:11], v[72:75]
  ds_read_b64_tr_b16 a[162:163], v8 offset:55296
  v_mfma_f32_16x16x32_bf16 v[72:75], a[172:175], a[24:27], v[72:75]
  s_add_u32 s74, s74, 131072
  v_mfma_f32_16x16x32_bf16 v[76:79], a[172:175], a[28:31], v[76:79]
  ds_read_b64_tr_b16 a[172:173], v9 offset:49152
  v_mfma_f32_16x16x32_bf16 v[76:79], a[168:171], a[12:15], v[76:79]
  s_waitcnt lgkmcnt(5)
  buffer_load_dwordx4 a[68:71], v1, s[8:11], s74 offen offset:0 sc1
  v_mfma_f32_16x16x32_bf16 v[92:95], a[176:179], a[12:15], v[92:95]
  ds_read_b64_tr_b16 a[174:175], v9 offset:51200
  v_mfma_f32_16x16x32_bf16 v[92:95], a[180:183], a[28:31], v[92:95]
  v_mfma_f32_16x16x32_bf16 v[88:91], a[180:183], a[24:27], v[88:91]
  ds_read_b64_tr_b16 a[168:169], v9 offset:53248
  v_mfma_f32_16x16x32_bf16 v[88:91], a[176:179], a[8:11], v[88:91]
  v_mfma_f32_16x16x32_bf16 v[84:87], a[176:179], a[4:7], v[84:87]
  ds_read_b64_tr_b16 a[170:171], v9 offset:55296
  buffer_load_dwordx4 a[84:87], v1, s[8:11], s74 offen offset:1024 sc1
  v_mfma_f32_16x16x32_bf16 v[84:87], a[180:183], a[20:23], v[84:87]
  s_waitcnt vmcnt(12)
  s_barrier
  v_mfma_f32_16x16x32_bf16 v[80:83], a[180:183], a[16:19], v[80:83]
  ds_read_b64_tr_b16 a[180:181], v6 offset:16384
  v_mfma_f32_16x16x32_bf16 v[80:83], a[176:179], a[0:3], v[80:83]
  s_waitcnt lgkmcnt(5)
  s_add_u32 s74, s74, s89
  v_mfma_f32_16x16x32_bf16 v[96:99], a[164:167], a[0:3], v[96:99]
  ds_read_b64_tr_b16 a[182:183], v6 offset:18432
  v_mfma_f32_16x16x32_bf16 v[96:99], a[160:163], a[16:19], v[96:99]
  buffer_load_dwordx4 a[72:75], v1, s[8:11], s74 offen offset:0 sc1
  v_mfma_f32_16x16x32_bf16 v[100:103], a[160:163], a[20:23], v[100:103]
  ds_read_b64_tr_b16 a[176:177], v6 offset:20480
  v_mfma_f32_16x16x32_bf16 v[100:103], a[164:167], a[4:7], v[100:103]
  v_mfma_f32_16x16x32_bf16 v[104:107], a[164:167], a[8:11], v[104:107]
  ds_read_b64_tr_b16 a[178:179], v6 offset:22528
  v_mfma_f32_16x16x32_bf16 v[104:107], a[160:163], a[24:27], v[104:107]
  buffer_load_dwordx4 a[88:91], v1, s[8:11], s74 offen offset:1024 sc1
  v_mfma_f32_16x16x32_bf16 v[108:111], a[160:163], a[28:31], v[108:111]
  ds_read_b64_tr_b16 a[160:161], v7 offset:16384
  v_mfma_f32_16x16x32_bf16 v[108:111], a[164:167], a[12:15], v[108:111]
  s_waitcnt lgkmcnt(5)
  s_add_u32 s74, s74, 131072
  v_mfma_f32_16x16x32_bf16 v[124:127], a[172:175], a[12:15], v[124:127]
  ds_read_b64_tr_b16 a[162:163], v7 offset:18432
  v_mfma_f32_16x16x32_bf16 v[124:127], a[168:171], a[28:31], v[124:127]
  buffer_load_dwordx4 a[76:79], v1, s[8:11], s74 offen offset:0 sc1
  v_mfma_f32_16x16x32_bf16 v[120:123], a[168:171], a[24:27], v[120:123]
  ds_read_b64_tr_b16 a[164:165], v7 offset:20480
HOP18:
  s_cbranch_execz WRET1
  v_mfma_f32_16x16x32_bf16 v[120:123], a[172:175], a[8:11], v[120:123]
  v_mfma_f32_16x16x32_bf16 v[116:119], a[172:175], a[4:7], v[116:119]
  ds_read_b64_tr_b16 a[166:167], v7 offset:22528
  v_mfma_f32_16x16x32_bf16 v[116:119], a[168:171], a[20:23], v[116:119]
  v_mfma_f32_16x16x32_bf16 v[112:115], a[168:171], a[16:19], v[112:115]
  ds_read_b64_tr_b16 a[168:169], v8 offset:16384
  v_mfma_f32_16x16x32_bf16 v[112:115], a[172:175], a[0:3], v[112:115]
  s_waitcnt vmcnt(7) lgkmcnt(5)
  buffer_load_dwordx4 a[92:95], v1, s[8:11], s74 offen offset:1024 sc1
  v_mfma_f32_16x16x32_bf16 v[64:67], a[180:183], a[32:35], v[64:67]
  ds_read_b64_tr_b16 a[170:171], v8 offset:18432
  v_mfma_f32_16x16x32_bf16 v[64:67], a[176:179], a[48:51], v[64:67]
  v_mfma_f32_16x16x32_bf16 v[68:71], a[176:179], a[52:55], v[68:71]
  ds_read_b64_tr_b16 a[172:173], v8 offset:20480
  v_mfma_f32_16x16x32_bf16 v[68:71], a[180:183], a[36:39], v[68:71]
  buffer_load_dwordx4 a[96:99], v1, s[8:11], s75 offen offset:0 sc1
  v_mfma_f32_16x16x32_bf16 v[72:75], a[180:183], a[40:43], v[72:75]
  ds_read_b64_tr_b16 a[174:175], v8 offset:22528
  v_mfma_f32_16x16x32_bf16 v[72:75], a[176:179], a[56:59], v[72:75]
  v_mfma_f32_16x16x32_bf16 v[76:79], a[176:179], a[60:63], v[76:79]
  ds_read_b64_tr_b16 a[176:177], v9 offset:16384
  v_mfma_f32_16x16x32_bf16 v[76:79], a[180:183], a[44:47], v[76:79]
  s_waitcnt lgkmcnt(5)
  buffer_load_dwordx4 a[112:115], v1, s[8:11], s75 offen offset:1024 sc1
  v_mfma_f32_16x16x32_bf16 v[92:95], a[160:163], a[44:47], v[92:95]
  ds_read_b64_tr_b16 a[178:179], v9 offset:18432
  v_mfma_f32_16x16x32_bf16 v[92:95], a[164:167], a[60:63], v[92:95]
  s_add_u32 s75, s75, 131072
  v_mfma_f32_16x16x32_bf16 v[88:91], a[164:167], a[56:59], v[88:91]
  ds_read_b64_tr_b16 a[180:181], v9 offset:20480
  v_mfma_f32_16x16x32_bf16 v[88:91], a[160:163], a[40:43], v[88:91]
  buffer_load_dwordx4 a[100:103], v1, s[8:11], s75 offen offset:0 sc1
  v_mfma_f32_16x16x32_bf16 v[84:87], a[160:163], a[36:39], v[84:87]
  ds_read_b64_tr_b16 a[182:183], v9 offset:22528
  v_mfma_f32_16x16x32_bf16 v[84:87], a[164:167], a[52:55], v[84:87]
  v_mfma_f32_16x16x32_bf16 v[80:83], a[164:167], a[48:51], v[80:83]
  ds_read_b64_tr_b16 a[164:165], v6 offset:0
  v_mfma_f32_16x16x32_bf16 v[80:83], a[160:163], a[32:35], v[80:83]
  s_waitcnt lgkmcnt(5)
  v_mfma_f32_16x16x32_bf16 v[96:99], a[168:171], a[32:35], v[96:99]
  ds_read_b64_tr_b16 a[166:167], v6 offset:2048
  v_mfma_f32_16x16x32_bf16 v[96:99], a[172:175], a[48:51], v[96:99]
  buffer_load_dwordx4 a[116:119], v1, s[8:11], s75 offen offset:1024 sc1
  v_mfma_f32_16x16x32_bf16 v[100:103], a[172:175], a[52:55], v[100:103]
  ds_read_b64_tr_b16 a[160:161], v6 offset:4096
  v_mfma_f32_16x16x32_bf16 v[100:103], a[168:171], a[36:39], v[100:103]
  s_add_u32 s75, s75, s89
  v_mfma_f32_16x16x32_bf16 v[104:107], a[168:171], a[40:43], v[104:107]
  ds_read_b64_tr_b16 a[162:163], v6 offset:6144
  v_mfma_f32_16x16x32_bf16 v[104:107], a[172:175], a[56:59], v[104:107]
  buffer_load_dwordx4 a[104:107], v1, s[8:11], s75 offen offset:0 sc1
  v_mfma_f32_16x16x32_bf16 v[108:111], a[172:175], a[60:63], v[108:111]
  ds_read_b64_tr_b16 a[172:173], v7 offset:0
  v_mfma_f32_16x16x32_bf16 v[108:111], a[168:171], a[44:47], v[108:111]
  s_waitcnt lgkmcnt(5)
  v_mfma_f32_16x16x32_bf16 v[124:127], a[176:179], a[44:47], v[124:127]
  ds_read_b64_tr_b16 a[174:175], v7 offset:2048
  v_mfma_f32_16x16x32_bf16 v[124:127], a[180:183], a[60:63], v[124:127]
  buffer_load_dwordx4 a[120:123], v1, s[8:11], s75 offen offset:1024 sc1
  v_mfma_f32_16x16x32_bf16 v[120:123], a[180:183], a[56:59], v[120:123]
  ds_read_b64_tr_b16 a[168:169], v7 offset:4096
  v_mfma_f32_16x16x32_bf16 v[120:123], a[176:179], a[40:43], v[120:123]
  s_add_u32 s75, s75, 131072
  v_mfma_f32_16x16x32_bf16 v[116:119], a[176:179], a[36:39], v[116:119]
  ds_read_b64_tr_b16 a[170:171], v7 offset:6144
  v_mfma_f32_16x16x32_bf16 v[116:119], a[180:183], a[52:55], v[116:119]
  buffer_load_dwordx4 a[108:111], v1, s[8:11], s75 offen offset:0 sc1
  v_mfma_f32_16x16x32_bf16 v[112:115], a[180:183], a[48:51], v[112:115]
  ds_read_b64_tr_b16 a[180:181], v8 offset:0
  v_mfma_f32_16x16x32_bf16 v[112:115], a[176:179], a[32:35], v[112:115]
  s_waitcnt vmcnt(7) lgkmcnt(5)
  v_mfma_f32_16x16x32_bf16 v[64:67], a[164:167], a[64:67], v[64:67]
  ds_read_b64_tr_b16 a[182:183], v8 offset:2048
  v_mfma_f32_16x16x32_bf16 v[64:67], a[160:163], a[80:83], v[64:67]
  v_mfma_f32_16x16x32_bf16 v[68:71], a[160:163], a[84:87], v[68:71]
  ds_read_b64_tr_b16 a[176:177], v8 offset:4096
  v_mfma_f32_16x16x32_bf16 v[68:71], a[164:167], a[68:71], v[68:71]
  buffer_load_dwordx4 a[124:127], v1, s[8:11], s75 offen offset:1024 sc1
  v_mfma_f32_16x16x32_bf16 v[72:75], a[164:167], a[72:75], v[72:75]
  ds_read_b64_tr_b16 a[178:179], v8 offset:6144
  v_mfma_f32_16x16x32_bf16 v[72:75], a[160:163], a[88:91], v[72:75]
  v_mfma_f32_16x16x32_bf16 v[76:79], a[160:163], a[92:95], v[76:79]
  ds_read_b64_tr_b16 a[160:161], v9 offset:0
  v_mfma_f32_16x16x32_bf16 v[76:79], a[164:167], a[76:79], v[76:79]
  s_waitcnt lgkmcnt(5)
  buffer_load_dwordx4 a[128:131], v1, s[8:11], s76 offen offset:0 sc1
  v_mfma_f32_16x16x32_bf16 v[92:95], a[172:175], a[76:79], v[92:95]
  ds_read_b64_tr_b16 a[162:163], v9 offset:2048
  v_mfma_f32_16x16x32_bf16 v[92:95], a[168:171], a[92:95], v[92:95]
  v_mfma_f32_16x16x32_bf16 v[88:91], a[168:171], a[88:91], v[88:91]
  ds_read_b64_tr_b16 a[164:165], v9 offset:4096
  v_mfma_f32_16x16x32_bf16 v[88:91], a[172:175], a[72:75], v[88:91]
  buffer_load_dwordx4 a[144:147], v1, s[8:11], s76 offen offset:1024 sc1
  v_mfma_f32_16x16x32_bf16 v[84:87], a[172:175], a[68:71], v[84:87]
  ds_read_b64_tr_b16 a[166:167], v9 offset:6144
  v_mfma_f32_16x16x32_bf16 v[84:87], a[168:171], a[84:87], v[84:87]
  s_add_u32 s76, s76, 131072
  v_mfma_f32_16x16x32_bf16 v[80:83], a[168:171], a[80:83], v[80:83]
  ds_read_b64_tr_b16 a[168:169], v2 offset:0
  v_mfma_f32_16x16x32_bf16 v[80:83], a[172:175], a[64:67], v[80:83]
  s_waitcnt lgkmcnt(5)
  buffer_load_dwordx4 a[132:135], v1, s[8:11], s76 offen offset:0 sc1
  v_mfma_f32_16x16x32_bf16 v[96:99], a[180:183], a[64:67], v[96:99]
  ds_read_b64_tr_b16 a[170:171], v2 offset:2048
  v_mfma_f32_16x16x32_bf16 v[96:99], a[176:179], a[80:83], v[96:99]
  v_mfma_f32_16x16x32_bf16 v[100:103], a[176:179], a[84:87], v[100:103]
  ds_read_b64_tr_b16 a[172:173], v2 offset:4096
  v_mfma_f32_16x16x32_bf16 v[100:103], a[180:183], a[68:71], v[100:103]
  v_mfma_f32_16x16x32_bf16 v[104:107], a[180:183], a[72:75], v[104:107]
  ds_read_b64_tr_b16 a[174:175], v2 offset:6144
  v_mfma_f32_16x16x32_bf16 v[104:107], a[176:179], a[88:91], v[104:107]
  buffer_load_dwordx4 a[148:151], v1, s[8:11], s76 offen offset:1024 sc1
  v_mfma_f32_16x16x32_bf16 v[108:111], a[176:179], a[92:95], v[108:111]
  ds_read_b64_tr_b16 a[176:177], v3 offset:0
  v_mfma_f32_16x16x32_bf16 v[108:111], a[180:183], a[76:79], v[108:111]
  s_waitcnt lgkmcnt(5)
  s_add_u32 s76, s76, s89
  v_mfma_f32_16x16x32_bf16 v[124:127], a[160:163], a[76:79], v[124:127]
  ds_read_b64_tr_b16 a[178:179], v3 offset:2048
  v_mfma_f32_16x16x32_bf16 v[124:127], a[164:167], a[92:95], v[124:127]
  buffer_load_dwordx4 a[136:139], v1, s[8:11], s76 offen offset:0 sc1
  v_mfma_f32_16x16x32_bf16 v[120:123], a[164:167], a[88:91], v[120:123]
  ds_read_b64_tr_b16 a[180:181], v3 offset:4096
  v_mfma_f32_16x16x32_bf16 v[120:123], a[160:163], a[72:75], v[120:123]
  v_mfma_f32_16x16x32_bf16 v[116:119], a[160:163], a[68:71], v[116:119]
  ds_read_b64_tr_b16 a[182:183], v3 offset:6144
  v_mfma_f32_16x16x32_bf16 v[116:119], a[164:167], a[84:87], v[116:119]
  buffer_load_dwordx4 a[152:155], v1, s[8:11], s76 offen offset:1024 sc1
  v_mfma_f32_16x16x32_bf16 v[112:115], a[164:167], a[80:83], v[112:115]
  ds_read_b64_tr_b16 a[164:165], v4 offset:0
  v_mfma_f32_16x16x32_bf16 v[112:115], a[160:163], a[64:67], v[112:115]
  s_waitcnt vmcnt(6) lgkmcnt(5)
  s_add_u32 s76, s76, 131072
  v_mfma_f32_16x16x32_bf16 v[64:67], a[168:171], a[96:99], v[64:67]
  ds_read_b64_tr_b16 a[166:167], v4 offset:2048
  v_mfma_f32_16x16x32_bf16 v[64:67], a[172:175], a[112:115], v[64:67]
  buffer_load_dwordx4 a[140:143], v1, s[8:11], s76 offen offset:0 sc1
  v_mfma_f32_16x16x32_bf16 v[68:71], a[172:175], a[116:119], v[68:71]
  ds_read_b64_tr_b16 a[160:161], v4 offset:4096
  v_mfma_f32_16x16x32_bf16 v[68:71], a[168:171], a[100:103], v[68:71]
  v_mfma_f32_16x16x32_bf16 v[72:75], a[168:171], a[104:107], v[72:75]
  ds_read_b64_tr_b16 a[162:163], v4 offset:6144
  v_mfma_f32_16x16x32_bf16 v[72:75], a[172:175], a[120:123], v[72:75]
  v_mfma_f32_16x16x32_bf16 v[76:79], a[172:175], a[124:127], v[76:79]
  ds_read_b64_tr_b16 a[172:173], v5 offset:0
  v_mfma_f32_16x16x32_bf16 v[76:79], a[168:171], a[108:111], v[76:79]
  s_waitcnt lgkmcnt(5)
  buffer_load_dwordx4 a[156:159], v1, s[8:11], s76 offen offset:1024 sc1
  v_mfma_f32_16x16x32_bf16 v[92:95], a[176:179], a[108:111], v[92:95]
  ds_read_b64_tr_b16 a[174:175], v5 offset:2048
  v_mfma_f32_16x16x32_bf16 v[92:95], a[180:183], a[124:127], v[92:95]
  v_mfma_f32_16x16x32_bf16 v[88:91], a[180:183], a[120:123], v[88:91]
  ds_read_b64_tr_b16 a[168:169], v5 offset:4096
  v_mfma_f32_16x16x32_bf16 v[88:91], a[176:179], a[104:107], v[88:91]
  buffer_load_dwordx4 a[188:191], v1, s[8:11], s77 offen offset:0 sc1
  v_mfma_f32_16x16x32_bf16 v[84:87], a[176:179], a[100:103], v[84:87]
  ds_read_b64_tr_b16 a[170:171], v5 offset:6144
  v_mfma_f32_16x16x32_bf16 v[84:87], a[180:183], a[116:119], v[84:87]
  v_mfma_f32_16x16x32_bf16 v[80:83], a[180:183], a[112:115], v[80:83]
  ds_read_b64_tr_b16 a[180:181], v2 offset:32768
  v_mfma_f32_16x16x32_bf16 v[80:83], a[176:179], a[96:99], v[80:83]
  s_waitcnt lgkmcnt(5)
  buffer_load_dwordx4 a[204:207], v1, s[8:11], s77 offen offset:1024 sc1
  v_mfma_f32_16x16x32_bf16 v[96:99], a[164:167], a[96:99], v[96:99]
  ds_read_b64_tr_b16 a[182:183], v2 offset:34816
  v_mfma_f32_16x16x32_bf16 v[96:99], a[160:163], a[112:115], v[96:99]
  s_add_u32 s77, s77, 131072
  v_mfma_f32_16x16x32_bf16 v[100:103], a[160:163], a[116:119], v[100:103]
  ds_read_b64_tr_b16 a[176:177], v2 offset:36864
  v_mfma_f32_16x16x32_bf16 v[100:103], a[164:167], a[100:103], v[100:103]
  buffer_load_dwordx4 a[192:195], v1, s[8:11], s77 offen offset:0 sc1
  v_mfma_f32_16x16x32_bf16 v[104:107], a[164:167], a[104:107], v[104:107]
  ds_read_b64_tr_b16 a[178:179], v2 offset:38912
  v_mfma_f32_16x16x32_bf16 v[104:107], a[160:163], a[120:123], v[104:107]
  v_mfma_f32_16x16x32_bf16 v[108:111], a[160:163], a[124:127], v[108:111]
  ds_read_b64_tr_b16 a[160:161], v3 offset:32768
  v_mfma_f32_16x16x32_bf16 v[108:111], a[164:167], a[108:111], v[108:111]
  s_waitcnt lgkmcnt(5)
  v_mfma_f32_16x16x32_bf16 v[124:127], a[172:175], a[108:111], v[124:127]
  ds_read_b64_tr_b16 a[162:163], v3 offset:34816
  v_mfma_f32_16x16x32_bf16 v[124:127], a[168:171], a[124:127], v[124:127]
  buffer_load_dwordx4 a[208:211], v1, s[8:11], s77 offen offset:1024 sc1
  v_mfma_f32_16x16x32_bf16 v[120:123], a[168:171], a[120:123], v[120:123]
  ds_read_b64_tr_b16 a[164:165], v3 offset:36864
  v_mfma_f32_16x16x32_bf16 v[120:123], a[172:175], a[104:107], v[120:123]
  s_add_u32 s77, s77, s89
  v_mfma_f32_16x16x32_bf16 v[116:119], a[172:175], a[100:103], v[116:119]
  ds_read_b64_tr_b16 a[166:167], v3 offset:38912
  v_mfma_f32_16x16x32_bf16 v[116:119], a[168:171], a[116:119], v[116:119]
  buffer_load_dwordx4 a[196:199], v1, s[8:11], s77 offen offset:0 sc1
  v_mfma_f32_16x16x32_bf16 v[112:115], a[168:171], a[112:115], v[112:115]
  ds_read_b64_tr_b16 a[168:169], v4 offset:32768
  v_mfma_f32_16x16x32_bf16 v[112:115], a[172:175], a[96:99], v[112:115]
  s_waitcnt vmcnt(5) lgkmcnt(5)
  v_mfma_f32_16x16x32_bf16 v[64:67], a[180:183], a[128:131], v[64:67]
  ds_read_b64_tr_b16 a[170:171], v4 offset:34816
  v_mfma_f32_16x16x32_bf16 v[64:67], a[176:179], a[144:147], v[64:67]
  buffer_load_dwordx4 a[212:215], v1, s[8:11], s77 offen offset:1024 sc1
  v_mfma_f32_16x16x32_bf16 v[68:71], a[176:179], a[148:151], v[68:71]
  ds_read_b64_tr_b16 a[172:173], v4 offset:36864
  v_mfma_f32_16x16x32_bf16 v[68:71], a[180:183], a[132:135], v[68:71]
  s_add_u32 s77, s77, 131072
  v_mfma_f32_16x16x32_bf16 v[72:75], a[180:183], a[136:139], v[72:75]
  ds_read_b64_tr_b16 a[174:175], v4 offset:38912
  v_mfma_f32_16x16x32_bf16 v[72:75], a[176:179], a[152:155], v[72:75]
  buffer_load_dwordx4 a[200:203], v1, s[8:11], s77 offen offset:0 sc1
  v_mfma_f32_16x16x32_bf16 v[76:79], a[176:179], a[156:159], v[76:79]
  ds_read_b64_tr_b16 a[176:177], v5 offset:32768
  v_mfma_f32_16x16x32_bf16 v[76:79], a[180:183], a[140:143], v[76:79]
  s_waitcnt lgkmcnt(5)
  v_mfma_f32_16x16x32_bf16 v[92:95], a[160:163], a[140:143], v[92:95]
  ds_read_b64_tr_b16 a[178:179], v5 offset:34816
  v_mfma_f32_16x16x32_bf16 v[92:95], a[164:167], a[156:159], v[92:95]
  v_mfma_f32_16x16x32_bf16 v[88:91], a[164:167], a[152:155], v[88:91]
  ds_read_b64_tr_b16 a[180:181], v5 offset:36864
  v_mfma_f32_16x16x32_bf16 v[88:91], a[160:163], a[136:139], v[88:91]
  buffer_load_dwordx4 a[216:219], v1, s[8:11], s77 offen offset:1024 sc1
  v_mfma_f32_16x16x32_bf16 v[84:87], a[160:163], a[132:135], v[84:87]
  ds_read_b64_tr_b16 a[182:183], v5 offset:38912
  v_mfma_f32_16x16x32_bf16 v[84:87], a[164:167], a[148:151], v[84:87]
  s_add_u32 m0, s45, 8192
  v_mfma_f32_16x16x32_bf16 v[80:83], a[164:167], a[144:147], v[80:83]
  ds_read_b64_tr_b16 a[164:165], v2 offset:49152
  v_mfma_f32_16x16x32_bf16 v[80:83], a[160:163], a[128:131], v[80:83]
  s_waitcnt lgkmcnt(5)
  buffer_load_dwordx4 v33, s[36:39], s67 offen lds
  v_mfma_f32_16x16x32_bf16 v[96:99], a[168:171], a[128:131], v[96:99]
  ds_read_b64_tr_b16 a[166:167], v2 offset:51200
  v_mfma_f32_16x16x32_bf16 v[96:99], a[172:175], a[144:147], v[96:99]
  s_add_u32 m0, s45, 12288
  s_add_u32 s61, s67, 65536
  v_mfma_f32_16x16x32_bf16 v[100:103], a[172:175], a[148:151], v[100:103]
  ds_read_b64_tr_b16 a[160:161], v2 offset:53248
  v_mfma_f32_16x16x32_bf16 v[100:103], a[168:171], a[132:135], v[100:103]
  buffer_load_dwordx4 v33, s[36:39], s61 offen lds
  v_mfma_f32_16x16x32_bf16 v[104:107], a[168:171], a[136:139], v[104:107]
  ds_read_b64_tr_b16 a[162:163], v2 offset:55296
  v_mfma_f32_16x16x32_bf16 v[104:107], a[172:175], a[152:155], v[104:107]
  s_add_u32 m0, s45, 40960
  v_mfma_f32_16x16x32_bf16 v[108:111], a[172:175], a[156:159], v[108:111]
  ds_read_b64_tr_b16 a[172:173], v3 offset:49152
  v_mfma_f32_16x16x32_bf16 v[108:111], a[168:171], a[140:143], v[108:111]
  s_waitcnt lgkmcnt(5)
  buffer_load_dwordx4 v33, s[36:39], s68 offen lds
  v_mfma_f32_16x16x32_bf16 v[124:127], a[176:179], a[140:143], v[124:127]
  ds_read_b64_tr_b16 a[174:175], v3 offset:51200
  v_mfma_f32_16x16x32_bf16 v[124:127], a[180:183], a[156:159], v[124:127]
  v_mfma_f32_16x16x32_bf16 v[120:123], a[180:183], a[152:155], v[120:123]
  ds_read_b64_tr_b16 a[168:169], v3 offset:53248
  v_mfma_f32_16x16x32_bf16 v[120:123], a[176:179], a[136:139], v[120:123]
  s_add_u32 m0, s45, 45056
  s_add_u32 s61, s68, 65536
  v_mfma_f32_16x16x32_bf16 v[116:119], a[176:179], a[132:135], v[116:119]
  ds_read_b64_tr_b16 a[170:171], v3 offset:55296
  v_mfma_f32_16x16x32_bf16 v[116:119], a[180:183], a[148:151], v[116:119]
  buffer_load_dwordx4 v33, s[36:39], s61 offen lds
  v_mfma_f32_16x16x32_bf16 v[112:115], a[180:183], a[144:147], v[112:115]
  ds_read_b64_tr_b16 a[180:181], v4 offset:49152
  v_mfma_f32_16x16x32_bf16 v[112:115], a[176:179], a[128:131], v[112:115]
  s_waitcnt vmcnt(4) lgkmcnt(5)
  s_add_u32 m0, s45, 57344
  v_mfma_f32_16x16x32_bf16 v[64:67], a[164:167], a[188:191], v[64:67]
  ds_read_b64_tr_b16 a[182:183], v4 offset:51200
  v_mfma_f32_16x16x32_bf16 v[64:67], a[160:163], a[204:207], v[64:67]
  buffer_load_dwordx4 v33, s[36:39], s69 offen lds
  v_mfma_f32_16x16x32_bf16 v[68:71], a[160:163], a[208:211], v[68:71]
  ds_read_b64_tr_b16 a[176:177], v4 offset:53248
  v_mfma_f32_16x16x32_bf16 v[68:71], a[164:167], a[192:195], v[68:71]
  s_add_u32 m0, s45, 61440
  s_add_u32 s61, s69, 65536
  v_mfma_f32_16x16x32_bf16 v[72:75], a[164:167], a[196:199], v[72:75]
  ds_read_b64_tr_b16 a[178:179], v4 offset:55296
  v_mfma_f32_16x16x32_bf16 v[72:75], a[160:163], a[212:215], v[72:75]
  buffer_load_dwordx4 v33, s[36:39], s61 offen lds
  v_mfma_f32_16x16x32_bf16 v[76:79], a[160:163], a[216:219], v[76:79]
  ds_read_b64_tr_b16 a[160:161], v5 offset:49152
  v_mfma_f32_16x16x32_bf16 v[76:79], a[164:167], a[200:203], v[76:79]
  s_waitcnt lgkmcnt(5)
  v_mfma_f32_16x16x32_bf16 v[92:95], a[172:175], a[200:203], v[92:95]
  ds_read_b64_tr_b16 a[162:163], v5 offset:51200
  v_mfma_f32_16x16x32_bf16 v[92:95], a[168:171], a[216:219], v[92:95]
  v_mfma_f32_16x16x32_bf16 v[88:91], a[168:171], a[212:215], v[88:91]
  ds_read_b64_tr_b16 a[164:165], v5 offset:53248
  v_cvt_pk_bf16_f32 v72, v72, v73
  v_mfma_f32_16x16x32_bf16 v[88:91], a[172:175], a[196:199], v[88:91]
  v_cvt_pk_bf16_f32 v73, v74, v75
  v_cvt_pk_bf16_f32 v76, v76, v77
  v_mfma_f32_16x16x32_bf16 v[84:87], a[172:175], a[192:195], v[84:87]
  ds_read_b64_tr_b16 a[166:167], v5 offset:55296
  v_cvt_pk_bf16_f32 v77, v78, v79
  v_mfma_f32_16x16x32_bf16 v[84:87], a[168:171], a[208:211], v[84:87]
  v_cvt_pk_bf16_f32 v64, v64, v65
  v_cvt_pk_bf16_f32 v65, v66, v67
  v_mfma_f32_16x16x32_bf16 v[80:83], a[168:171], a[204:207], v[80:83]
  v_cvt_pk_bf16_f32 v68, v68, v69
  v_cvt_pk_bf16_f32 v69, v70, v71
  v_mfma_f32_16x16x32_bf16 v[80:83], a[172:175], a[188:191], v[80:83]
  s_waitcnt lgkmcnt(4)
  s_waitcnt vmcnt(0)
  s_barrier
  v_mfma_f32_16x16x32_bf16 v[96:99], a[180:183], a[188:191], v[96:99]
  ds_read_b64_tr_b16 v[16:17], v6 offset:40960
  v_mfma_f32_16x16x32_bf16 v[96:99], a[176:179], a[204:207], v[96:99]
  ds_read_b64_tr_b16 v[18:19], v6 offset:43008
  v_mfma_f32_16x16x32_bf16 v[100:103], a[176:179], a[208:211], v[100:103]
  ds_read_b64_tr_b16 v[20:21], v6 offset:45056
  v_cvt_pk_bf16_f32 v74, v88, v89
  v_mfma_f32_16x16x32_bf16 v[100:103], a[180:183], a[192:195], v[100:103]
  ds_read_b64_tr_b16 v[22:23], v6 offset:47104
  v_cvt_pk_bf16_f32 v75, v90, v91
  v_mfma_f32_16x16x32_bf16 v[104:107], a[180:183], a[196:199], v[104:107]
  ds_read_b64_tr_b16 v[24:25], v7 offset:40960
  v_mfma_f32_16x16x32_bf16 v[104:107], a[176:179], a[212:215], v[104:107]
  ds_read_b64_tr_b16 v[26:27], v7 offset:43008
  v_mfma_f32_16x16x32_bf16 v[108:111], a[176:179], a[216:219], v[108:111]
  ds_read_b64_tr_b16 v[28:29], v7 offset:45056
  s_add_u32 s87, s86, 0
  buffer_store_dwordx4 v[72:75], v1, s[8:11], s87 offen offset:0 sc1
  v_mfma_f32_16x16x32_bf16 v[108:111], a[180:183], a[200:203], v[108:111]
  s_waitcnt lgkmcnt(7)
  ds_read_b64_tr_b16 v[30:31], v7 offset:47104
  v_mfma_f32_16x16x32_bf16 v[124:127], a[160:163], a[200:203], v[124:127]
  ds_read_b64_tr_b16 a[168:169], v8 offset:40960
  v_cvt_pk_bf16_f32 v78, v92, v93
  v_mfma_f32_16x16x32_bf16 v[124:127], a[164:167], a[216:219], v[124:127]
  ds_read_b64_tr_b16 a[170:171], v8 offset:43008
  v_cvt_pk_bf16_f32 v79, v94, v95
  v_mfma_f32_16x16x32_bf16 v[120:123], a[164:167], a[212:215], v[120:123]
  ds_read_b64_tr_b16 a[172:173], v8 offset:45056
  v_mfma_f32_16x16x32_bf16 v[120:123], a[160:163], a[196:199], v[120:123]
  ds_read_b64_tr_b16 a[174:175], v8 offset:47104
  v_mfma_f32_16x16x32_bf16 v[116:119], a[160:163], a[192:195], v[116:119]
  ds_read_b64_tr_b16 a[176:177], v9 offset:40960
  s_add_u32 s87, s86, 0
  buffer_store_dwordx4 v[76:79], v1, s[8:11], s87 offen offset:2048 sc1
  v_mfma_f32_16x16x32_bf16 v[116:119], a[164:167], a[208:211], v[116:119]
  ds_read_b64_tr_b16 a[178:179], v9 offset:43008
  v_mfma_f32_16x16x32_bf16 v[112:115], a[164:167], a[204:207], v[112:115]
  ds_read_b64_tr_b16 a[180:181], v9 offset:45056
  v_cvt_pk_bf16_f32 v66, v80, v81
  v_mfma_f32_16x16x32_bf16 v[112:115], a[160:163], a[188:191], v[112:115]
  s_waitcnt lgkmcnt(7)
  ds_read_b64_tr_b16 a[182:183], v9 offset:47104
  v_mfma_f32_16x16x32_bf16 v[136:139], v[16:19], a[228:231], v[136:139]
  ds_read_b64_tr_b16 a[164:165], v6 offset:57344
  v_cvt_pk_bf16_f32 v67, v82, v83
  v_mfma_f32_16x16x32_bf16 v[136:139], v[20:23], a[244:247], v[136:139]
  ds_read_b64_tr_b16 a[166:167], v6 offset:59392
  v_mfma_f32_16x16x32_bf16 v[140:143], v[20:23], a[248:251], v[140:143]
  ds_read_b64_tr_b16 a[160:161], v6 offset:61440
  v_mfma_f32_16x16x32_bf16 v[140:143], v[16:19], a[232:235], v[140:143]
  ds_read_b64_tr_b16 a[162:163], v6 offset:63488
  s_add_u32 s87, s86, 4096
  buffer_store_dwordx4 v[64:67], v1, s[8:11], s87 offen offset:0 sc1
  v_mfma_f32_16x16x32_bf16 v[156:159], v[24:27], a[232:235], v[156:159]
  ds_read_b64_tr_b16 v[20:21], v7 offset:57344
  v_mfma_f32_16x16x32_bf16 v[156:159], v[28:31], a[248:251], v[156:159]
  ds_read_b64_tr_b16 v[22:23], v7 offset:59392
  v_cvt_pk_bf16_f32 v70, v84, v85
  v_mfma_f32_16x16x32_bf16 v[152:155], v[28:31], a[244:247], v[152:155]
  ds_read_b64_tr_b16 v[16:17], v7 offset:61440
  v_cvt_pk_bf16_f32 v71, v86, v87
  v_mfma_f32_16x16x32_bf16 v[152:155], v[24:27], a[228:231], v[152:155]
  s_waitcnt lgkmcnt(7)
  ds_read_b64_tr_b16 v[18:19], v7 offset:63488
  v_mfma_f32_16x16x32_bf16 v[168:171], a[168:171], a[228:231], v[168:171]
  ds_read_b64_tr_b16 v[28:29], v8 offset:57344
  v_mfma_f32_16x16x32_bf16 v[168:171], a[172:175], a[244:247], v[168:171]
  ds_read_b64_tr_b16 v[30:31], v8 offset:59392
  s_add_u32 s87, s86, 4096
  buffer_store_dwordx4 v[68:71], v1, s[8:11], s87 offen offset:2048 sc1
  v_mfma_f32_16x16x32_bf16 v[172:175], a[172:175], a[248:251], v[172:175]
  ds_read_b64_tr_b16 v[24:25], v8 offset:61440
  v_mfma_f32_16x16x32_bf16 v[172:175], a[168:171], a[232:235], v[172:175]
  ds_read_b64_tr_b16 v[26:27], v8 offset:63488
  v_cvt_pk_bf16_f32 v104, v104, v105
  v_mfma_f32_16x16x32_bf16 v[188:191], a[176:179], a[232:235], v[188:191]
  ds_read_b64_tr_b16 a[172:173], v9 offset:57344
  v_cvt_pk_bf16_f32 v105, v106, v107
  v_mfma_f32_16x16x32_bf16 v[188:191], a[180:183], a[248:251], v[188:191]
  ds_read_b64_tr_b16 a[174:175], v9 offset:59392
  v_cvt_pk_bf16_f32 v108, v108, v109
  v_mfma_f32_16x16x32_bf16 v[184:187], a[180:183], a[244:247], v[184:187]
  ds_read_b64_tr_b16 a[168:169], v9 offset:61440
  v_cvt_pk_bf16_f32 v109, v110, v111
  v_mfma_f32_16x16x32_bf16 v[184:187], a[176:179], a[228:231], v[184:187]
  s_waitcnt lgkmcnt(7)
  ds_read_b64_tr_b16 a[170:171], v9 offset:63488
  v_mfma_f32_16x16x32_bf16 v[136:139], a[164:167], a[8:11], v[136:139]
  ds_read_b64_tr_b16 a[180:181], v6 offset:24576
  v_cvt_pk_bf16_f32 v96, v96, v97
  v_mfma_f32_16x16x32_bf16 v[136:139], a[160:163], a[24:27], v[136:139]
  ds_read_b64_tr_b16 a[182:183], v6 offset:26624
  v_cvt_pk_bf16_f32 v97, v98, v99
  v_mfma_f32_16x16x32_bf16 v[140:143], a[160:163], a[28:31], v[140:143]
  ds_read_b64_tr_b16 a[176:177], v6 offset:28672
  v_cvt_pk_bf16_f32 v100, v100, v101
  v_mfma_f32_16x16x32_bf16 v[140:143], a[164:167], a[12:15], v[140:143]
  ds_read_b64_tr_b16 a[178:179], v6 offset:30720
  v_cvt_pk_bf16_f32 v101, v102, v103
  v_mfma_f32_16x16x32_bf16 v[156:159], v[20:23], a[12:15], v[156:159]
  ds_read_b64_tr_b16 a[160:161], v7 offset:24576
  v_cvt_pk_bf16_f32 v106, v120, v121
  v_mfma_f32_16x16x32_bf16 v[156:159], v[16:19], a[28:31], v[156:159]
  ds_read_b64_tr_b16 a[162:163], v7 offset:26624
  v_cvt_pk_bf16_f32 v107, v122, v123
  v_mfma_f32_16x16x32_bf16 v[152:155], v[16:19], a[24:27], v[152:155]
  ds_read_b64_tr_b16 a[164:165], v7 offset:28672
  v_mfma_f32_16x16x32_bf16 v[152:155], v[20:23], a[8:11], v[152:155]
  s_waitcnt lgkmcnt(7)
  ds_read_b64_tr_b16 a[166:167], v7 offset:30720
  v_mfma_f32_16x16x32_bf16 v[168:171], v[28:31], a[8:11], v[168:171]
  ds_read_b64_tr_b16 v[16:17], v8 offset:24576
  s_add_u32 s87, s86, 0
  buffer_store_dwordx4 v[104:107], v1, s[8:11], s87 offen offset:1024 sc1
  v_mfma_f32_16x16x32_bf16 v[168:171], v[24:27], a[24:27], v[168:171]
  ds_read_b64_tr_b16 v[18:19], v8 offset:26624
  v_mfma_f32_16x16x32_bf16 v[172:175], v[24:27], a[28:31], v[172:175]
  ds_read_b64_tr_b16 v[20:21], v8 offset:28672
  v_cvt_pk_bf16_f32 v110, v124, v125
  v_mfma_f32_16x16x32_bf16 v[172:175], v[28:31], a[12:15], v[172:175]
  ds_read_b64_tr_b16 v[22:23], v8 offset:30720
  v_cvt_pk_bf16_f32 v111, v126, v127
  v_mfma_f32_16x16x32_bf16 v[188:191], a[172:175], a[12:15], v[188:191]
  ds_read_b64_tr_b16 v[24:25], v9 offset:24576
  v_mfma_f32_16x16x32_bf16 v[188:191], a[168:171], a[28:31], v[188:191]
  ds_read_b64_tr_b16 v[26:27], v9 offset:26624
  v_mfma_f32_16x16x32_bf16 v[184:187], a[168:171], a[24:27], v[184:187]
  ds_read_b64_tr_b16 v[28:29], v9 offset:28672
  s_add_u32 s87, s86, 0
  buffer_store_dwordx4 v[108:111], v1, s[8:11], s87 offen offset:3072 sc1
  v_mfma_f32_16x16x32_bf16 v[184:187], a[172:175], a[8:11], v[184:187]
  s_waitcnt lgkmcnt(7)
  ds_read_b64_tr_b16 v[30:31], v9 offset:30720
  v_mfma_f32_16x16x32_bf16 v[136:139], a[180:183], a[40:43], v[136:139]
  ds_read_b64_tr_b16 a[168:169], v6 offset:8192
  v_cvt_pk_bf16_f32 v98, v112, v113
  v_mfma_f32_16x16x32_bf16 v[136:139], a[176:179], a[56:59], v[136:139]
  ds_read_b64_tr_b16 a[170:171], v6 offset:10240
  v_cvt_pk_bf16_f32 v99, v114, v115
  v_mfma_f32_16x16x32_bf16 v[140:143], a[176:179], a[60:63], v[140:143]
  ds_read_b64_tr_b16 a[172:173], v6 offset:12288
  v_mfma_f32_16x16x32_bf16 v[140:143], a[180:183], a[44:47], v[140:143]
  ds_read_b64_tr_b16 a[174:175], v6 offset:14336
  v_mfma_f32_16x16x32_bf16 v[156:159], a[160:163], a[44:47], v[156:159]
  ds_read_b64_tr_b16 a[176:177], v7 offset:8192
  s_add_u32 s87, s86, 4096
  buffer_store_dwordx4 v[96:99], v1, s[8:11], s87 offen offset:1024 sc1
  v_mfma_f32_16x16x32_bf16 v[156:159], a[164:167], a[60:63], v[156:159]
  ds_read_b64_tr_b16 a[178:179], v7 offset:10240
  v_mfma_f32_16x16x32_bf16 v[152:155], a[164:167], a[56:59], v[152:155]
  ds_read_b64_tr_b16 a[180:181], v7 offset:12288
  v_cvt_pk_bf16_f32 v102, v116, v117
  v_mfma_f32_16x16x32_bf16 v[152:155], a[160:163], a[40:43], v[152:155]
  s_waitcnt lgkmcnt(7)
  ds_read_b64_tr_b16 a[182:183], v7 offset:14336
  v_mfma_f32_16x16x32_bf16 v[168:171], v[16:19], a[40:43], v[168:171]
  ds_read_b64_tr_b16 a[164:165], v8 offset:8192
  v_cvt_pk_bf16_f32 v103, v118, v119
  v_mfma_f32_16x16x32_bf16 v[168:171], v[20:23], a[56:59], v[168:171]
  ds_read_b64_tr_b16 a[166:167], v8 offset:10240
  v_mfma_f32_16x16x32_bf16 v[172:175], v[20:23], a[60:63], v[172:175]
  ds_read_b64_tr_b16 a[160:161], v8 offset:12288
  v_mfma_f32_16x16x32_bf16 v[172:175], v[16:19], a[44:47], v[172:175]
  ds_read_b64_tr_b16 a[162:163], v8 offset:14336
  s_add_u32 s87, s86, 4096
  buffer_store_dwordx4 v[100:103], v1, s[8:11], s87 offen offset:3072 sc1
  v_mfma_f32_16x16x32_bf16 v[188:191], v[24:27], a[44:47], v[188:191]
  ds_read_b64_tr_b16 v[20:21], v9 offset:8192
  v_mfma_f32_16x16x32_bf16 v[188:191], v[28:31], a[60:63], v[188:191]
  ds_read_b64_tr_b16 v[22:23], v9 offset:10240
  v_mfma_f32_16x16x32_bf16 v[184:187], v[28:31], a[56:59], v[184:187]
  ds_read_b64_tr_b16 v[16:17], v9 offset:12288
  v_mfma_f32_16x16x32_bf16 v[184:187], v[24:27], a[40:43], v[184:187]
  s_waitcnt lgkmcnt(7)
  ds_read_b64_tr_b16 v[18:19], v9 offset:14336
  v_mfma_f32_16x16x32_bf16 v[136:139], a[168:171], a[72:75], v[136:139]
  ds_read_b64_tr_b16 v[28:29], v2 offset:8192
  v_mfma_f32_16x16x32_bf16 v[136:139], a[172:175], a[88:91], v[136:139]
  ds_read_b64_tr_b16 v[30:31], v2 offset:10240
  v_mfma_f32_16x16x32_bf16 v[140:143], a[172:175], a[92:95], v[140:143]
  ds_read_b64_tr_b16 v[24:25], v2 offset:12288
  v_mfma_f32_16x16x32_bf16 v[140:143], a[168:171], a[76:79], v[140:143]
  ds_read_b64_tr_b16 v[26:27], v2 offset:14336
  v_mfma_f32_16x16x32_bf16 v[156:159], a[176:179], a[76:79], v[156:159]
  ds_read_b64_tr_b16 a[172:173], v3 offset:8192
  v_mfma_f32_16x16x32_bf16 v[156:159], a[180:183], a[92:95], v[156:159]
  ds_read_b64_tr_b16 a[174:175], v3 offset:10240
  v_mfma_f32_16x16x32_bf16 v[152:155], a[180:183], a[88:91], v[152:155]
  ds_read_b64_tr_b16 a[168:169], v3 offset:12288
  v_mfma_f32_16x16x32_bf16 v[152:155], a[176:179], a[72:75], v[152:155]
  s_waitcnt lgkmcnt(7)
  ds_read_b64_tr_b16 a[170:171], v3 offset:14336
  v_mfma_f32_16x16x32_bf16 v[168:171], a[164:167], a[72:75], v[168:171]
  ds_read_b64_tr_b16 a[180:181], v4 offset:8192
  v_mfma_f32_16x16x32_bf16 v[168:171], a[160:163], a[88:91], v[168:171]
  ds_read_b64_tr_b16 a[182:183], v4 offset:10240
  v_mfma_f32_16x16x32_bf16 v[172:175], a[160:163], a[92:95], v[172:175]
  ds_read_b64_tr_b16 a[176:177], v4 offset:12288
  v_mfma_f32_16x16x32_bf16 v[172:175], a[164:167], a[76:79], v[172:175]
  ds_read_b64_tr_b16 a[178:179], v4 offset:14336
  v_mfma_f32_16x16x32_bf16 v[188:191], v[20:23], a[76:79], v[188:191]
  ds_read_b64_tr_b16 a[160:161], v5 offset:8192
  v_mfma_f32_16x16x32_bf16 v[188:191], v[16:19], a[92:95], v[188:191]
  ds_read_b64_tr_b16 a[162:163], v5 offset:10240
  v_mfma_f32_16x16x32_bf16 v[184:187], v[16:19], a[88:91], v[184:187]
  ds_read_b64_tr_b16 a[164:165], v5 offset:12288
  v_mfma_f32_16x16x32_bf16 v[184:187], v[20:23], a[72:75], v[184:187]
  s_waitcnt lgkmcnt(7)
  ds_read_b64_tr_b16 a[166:167], v5 offset:14336
  v_mfma_f32_16x16x32_bf16 v[136:139], v[28:31], a[104:107], v[136:139]
  ds_read_b64_tr_b16 v[16:17], v2 offset:40960
  v_mfma_f32_16x16x32_bf16 v[136:139], v[24:27], a[120:123], v[136:139]
  ds_read_b64_tr_b16 v[18:19], v2 offset:43008
  v_mfma_f32_16x16x32_bf16 v[140:143], v[24:27], a[124:127], v[140:143]
  ds_read_b64_tr_b16 v[20:21], v2 offset:45056
  v_mfma_f32_16x16x32_bf16 v[140:143], v[28:31], a[108:111], v[140:143]
  ds_read_b64_tr_b16 v[22:23], v2 offset:47104
  v_mfma_f32_16x16x32_bf16 v[156:159], a[172:175], a[108:111], v[156:159]
  ds_read_b64_tr_b16 v[24:25], v3 offset:40960
  v_mfma_f32_16x16x32_bf16 v[156:159], a[168:171], a[124:127], v[156:159]
  ds_read_b64_tr_b16 v[26:27], v3 offset:43008
  v_mfma_f32_16x16x32_bf16 v[152:155], a[168:171], a[120:123], v[152:155]
  ds_read_b64_tr_b16 v[28:29], v3 offset:45056
  v_mfma_f32_16x16x32_bf16 v[152:155], a[172:175], a[104:107], v[152:155]
  s_waitcnt lgkmcnt(7)
  ds_read_b64_tr_b16 v[30:31], v3 offset:47104
  v_mfma_f32_16x16x32_bf16 v[168:171], a[180:183], a[104:107], v[168:171]
  ds_read_b64_tr_b16 a[168:169], v4 offset:40960
  v_mfma_f32_16x16x32_bf16 v[168:171], a[176:179], a[120:123], v[168:171]
  ds_read_b64_tr_b16 a[170:171], v4 offset:43008
HOP19:
  s_cbranch_execz WRET1
  v_mfma_f32_16x16x32_bf16 v[172:175], a[176:179], a[124:127], v[172:175]
  ds_read_b64_tr_b16 a[172:173], v4 offset:45056
  v_mfma_f32_16x16x32_bf16 v[172:175], a[180:183], a[108:111], v[172:175]
  ds_read_b64_tr_b16 a[174:175], v4 offset:47104
  v_mfma_f32_16x16x32_bf16 v[188:191], a[160:163], a[108:111], v[188:191]
  ds_read_b64_tr_b16 a[176:177], v5 offset:40960
  v_mfma_f32_16x16x32_bf16 v[188:191], a[164:167], a[124:127], v[188:191]
  ds_read_b64_tr_b16 a[178:179], v5 offset:43008
  v_mfma_f32_16x16x32_bf16 v[184:187], a[164:167], a[120:123], v[184:187]
  ds_read_b64_tr_b16 a[180:181], v5 offset:45056
  v_mfma_f32_16x16x32_bf16 v[184:187], a[160:163], a[104:107], v[184:187]
  s_waitcnt lgkmcnt(7)
  ds_read_b64_tr_b16 a[182:183], v5 offset:47104
  v_mfma_f32_16x16x32_bf16 v[136:139], v[16:19], a[136:139], v[136:139]
  ds_read_b64_tr_b16 a[164:165], v2 offset:57344
  v_mfma_f32_16x16x32_bf16 v[136:139], v[20:23], a[152:155], v[136:139]
  ds_read_b64_tr_b16 a[166:167], v2 offset:59392
  v_mfma_f32_16x16x32_bf16 v[140:143], v[20:23], a[156:159], v[140:143]
  ds_read_b64_tr_b16 a[160:161], v2 offset:61440
  v_mfma_f32_16x16x32_bf16 v[140:143], v[16:19], a[140:143], v[140:143]
  ds_read_b64_tr_b16 a[162:163], v2 offset:63488
  v_mfma_f32_16x16x32_bf16 v[156:159], v[24:27], a[140:143], v[156:159]
  ds_read_b64_tr_b16 v[20:21], v3 offset:57344
  v_add_u32 v38, s46, v0
  s_waitcnt vmcnt(0)
  s_mov_b64 exec, 1
  buffer_store_dword v38, v0, s[8:11], s81 offen offset:0 sc1
  s_mov_b64 exec, -1
  v_mfma_f32_16x16x32_bf16 v[156:159], v[28:31], a[156:159], v[156:159]
  ds_read_b64_tr_b16 v[22:23], v3 offset:59392
  v_mfma_f32_16x16x32_bf16 v[152:155], v[28:31], a[152:155], v[152:155]
  ds_read_b64_tr_b16 v[16:17], v3 offset:61440
  v_mfma_f32_16x16x32_bf16 v[152:155], v[24:27], a[136:139], v[152:155]
  s_waitcnt lgkmcnt(7)
  ds_read_b64_tr_b16 v[18:19], v3 offset:63488
  v_mfma_f32_16x16x32_bf16 v[168:171], a[168:171], a[136:139], v[168:171]
  ds_read_b64_tr_b16 v[28:29], v4 offset:57344
  v_mfma_f32_16x16x32_bf16 v[168:171], a[172:175], a[152:155], v[168:171]
  ds_read_b64_tr_b16 v[30:31], v4 offset:59392
  v_mfma_f32_16x16x32_bf16 v[172:175], a[172:175], a[156:159], v[172:175]
  ds_read_b64_tr_b16 v[24:25], v4 offset:61440
  v_mfma_f32_16x16x32_bf16 v[172:175], a[168:171], a[140:143], v[172:175]
  ds_read_b64_tr_b16 v[26:27], v4 offset:63488
  v_mfma_f32_16x16x32_bf16 v[188:191], a[176:179], a[140:143], v[188:191]
  ds_read_b64_tr_b16 a[172:173], v5 offset:57344
  v_mfma_f32_16x16x32_bf16 v[188:191], a[180:183], a[156:159], v[188:191]
  ds_read_b64_tr_b16 a[174:175], v5 offset:59392
  v_mfma_f32_16x16x32_bf16 v[184:187], a[180:183], a[152:155], v[184:187]
  ds_read_b64_tr_b16 a[168:169], v5 offset:61440
  v_mfma_f32_16x16x32_bf16 v[184:187], a[176:179], a[136:139], v[184:187]
  s_waitcnt lgkmcnt(7)
  ds_read_b64_tr_b16 a[170:171], v5 offset:63488
  v_mfma_f32_16x16x32_bf16 v[136:139], a[164:167], a[196:199], v[136:139]
  ds_read_b64_tr_b16 a[180:181], v6 offset:40960
  v_mfma_f32_16x16x32_bf16 v[136:139], a[160:163], a[212:215], v[136:139]
  ds_read_b64_tr_b16 a[182:183], v6 offset:43008
  v_mfma_f32_16x16x32_bf16 v[140:143], a[160:163], a[216:219], v[140:143]
  ds_read_b64_tr_b16 a[176:177], v6 offset:45056
  v_mfma_f32_16x16x32_bf16 v[140:143], a[164:167], a[200:203], v[140:143]
  ds_read_b64_tr_b16 a[178:179], v6 offset:47104
  v_mfma_f32_16x16x32_bf16 v[156:159], v[20:23], a[200:203], v[156:159]
  ds_read_b64_tr_b16 a[160:161], v7 offset:40960
  v_mfma_f32_16x16x32_bf16 v[156:159], v[16:19], a[216:219], v[156:159]
  ds_read_b64_tr_b16 a[162:163], v7 offset:43008
  v_mfma_f32_16x16x32_bf16 v[152:155], v[16:19], a[212:215], v[152:155]
  ds_read_b64_tr_b16 a[164:165], v7 offset:45056
  v_cvt_pk_bf16_f32 v136, v136, v137
  v_cvt_pk_bf16_f32 v137, v138, v139
  v_cvt_pk_bf16_f32 v140, v140, v141
  v_cvt_pk_bf16_f32 v141, v142, v143
  v_mfma_f32_16x16x32_bf16 v[152:155], v[20:23], a[196:199], v[152:155]
  s_waitcnt lgkmcnt(7)
  ds_read_b64_tr_b16 a[166:167], v7 offset:47104
  v_mfma_f32_16x16x32_bf16 v[168:171], v[28:31], a[196:199], v[168:171]
  ds_read_b64_tr_b16 v[16:17], v8 offset:40960
  v_mfma_f32_16x16x32_bf16 v[168:171], v[24:27], a[212:215], v[168:171]
  ds_read_b64_tr_b16 v[18:19], v8 offset:43008
  v_mfma_f32_16x16x32_bf16 v[172:175], v[24:27], a[216:219], v[172:175]
  ds_read_b64_tr_b16 v[20:21], v8 offset:45056
  v_cvt_pk_bf16_f32 v138, v152, v153
  v_cvt_pk_bf16_f32 v139, v154, v155
  v_mfma_f32_16x16x32_bf16 v[172:175], v[28:31], a[200:203], v[172:175]
  ds_read_b64_tr_b16 v[22:23], v8 offset:47104
  v_mfma_f32_16x16x32_bf16 v[188:191], a[172:175], a[200:203], v[188:191]
  ds_read_b64_tr_b16 v[24:25], v9 offset:40960
  v_mfma_f32_16x16x32_bf16 v[188:191], a[168:171], a[216:219], v[188:191]
  ds_read_b64_tr_b16 v[26:27], v9 offset:43008
  s_add_u32 s87, s86, 8192
  buffer_store_dwordx4 v[136:139], v1, s[8:11], s87 offen offset:0 sc1
  v_mfma_f32_16x16x32_bf16 v[184:187], a[168:171], a[212:215], v[184:187]
  ds_read_b64_tr_b16 v[28:29], v9 offset:45056
  v_cvt_pk_bf16_f32 v142, v156, v157
  v_cvt_pk_bf16_f32 v143, v158, v159
  v_mfma_f32_16x16x32_bf16 v[184:187], a[172:175], a[196:199], v[184:187]
  s_waitcnt lgkmcnt(7)
  ds_read_b64_tr_b16 v[30:31], v9 offset:47104
  v_mfma_f32_16x16x32_bf16 v[128:131], a[180:183], a[220:223], v[128:131]
  ds_read_b64_tr_b16 a[168:169], v6 offset:57344
  v_mfma_f32_16x16x32_bf16 v[128:131], a[176:179], a[236:239], v[128:131]
  ds_read_b64_tr_b16 a[170:171], v6 offset:59392
  s_add_u32 s87, s86, 8192
  buffer_store_dwordx4 v[140:143], v1, s[8:11], s87 offen offset:2048 sc1
  v_mfma_f32_16x16x32_bf16 v[132:135], a[176:179], a[240:243], v[132:135]
  ds_read_b64_tr_b16 a[172:173], v6 offset:61440
  v_cvt_pk_bf16_f32 v168, v168, v169
  v_cvt_pk_bf16_f32 v169, v170, v171
  v_cvt_pk_bf16_f32 v172, v172, v173
  v_cvt_pk_bf16_f32 v173, v174, v175
  v_mfma_f32_16x16x32_bf16 v[132:135], a[180:183], a[224:227], v[132:135]
  ds_read_b64_tr_b16 a[174:175], v6 offset:63488
  v_cvt_pk_bf16_f32 v170, v184, v185
  v_cvt_pk_bf16_f32 v171, v186, v187
  v_mfma_f32_16x16x32_bf16 v[148:151], a[160:163], a[224:227], v[148:151]
  ds_read_b64_tr_b16 a[176:177], v7 offset:57344
  v_mfma_f32_16x16x32_bf16 v[148:151], a[164:167], a[240:243], v[148:151]
  ds_read_b64_tr_b16 a[178:179], v7 offset:59392
  v_mfma_f32_16x16x32_bf16 v[144:147], a[164:167], a[236:239], v[144:147]
  ds_read_b64_tr_b16 a[180:181], v7 offset:61440
  s_add_u32 s87, s86, 8192
  buffer_store_dwordx4 v[168:171], v1, s[8:11], s87 offen offset:1024 sc1
  v_mfma_f32_16x16x32_bf16 v[144:147], a[160:163], a[220:223], v[144:147]
  s_waitcnt lgkmcnt(7)
  ds_read_b64_tr_b16 a[182:183], v7 offset:63488
  v_cvt_pk_bf16_f32 v174, v188, v189
  v_cvt_pk_bf16_f32 v175, v190, v191
  v_mfma_f32_16x16x32_bf16 v[160:163], v[16:19], a[220:223], v[160:163]
  ds_read_b64_tr_b16 a[164:165], v8 offset:57344
  v_mfma_f32_16x16x32_bf16 v[160:163], v[20:23], a[236:239], v[160:163]
  ds_read_b64_tr_b16 a[166:167], v8 offset:59392
  v_mfma_f32_16x16x32_bf16 v[164:167], v[20:23], a[240:243], v[164:167]
  ds_read_b64_tr_b16 a[160:161], v8 offset:61440
  s_add_u32 s87, s86, 8192
  buffer_store_dwordx4 v[172:175], v1, s[8:11], s87 offen offset:3072 sc1
  v_mfma_f32_16x16x32_bf16 v[164:167], v[16:19], a[224:227], v[164:167]
  ds_read_b64_tr_b16 a[162:163], v8 offset:63488
  v_mfma_f32_16x16x32_bf16 v[180:183], v[24:27], a[224:227], v[180:183]
  ds_read_b64_tr_b16 v[20:21], v9 offset:57344
  v_mfma_f32_16x16x32_bf16 v[180:183], v[28:31], a[240:243], v[180:183]
  ds_read_b64_tr_b16 v[22:23], v9 offset:59392
  v_mfma_f32_16x16x32_bf16 v[176:179], v[28:31], a[236:239], v[176:179]
  ds_read_b64_tr_b16 v[16:17], v9 offset:61440
  v_mfma_f32_16x16x32_bf16 v[176:179], v[24:27], a[220:223], v[176:179]
  s_waitcnt lgkmcnt(7)
  ds_read_b64_tr_b16 v[18:19], v9 offset:63488
  v_mfma_f32_16x16x32_bf16 v[128:131], a[168:171], a[0:3], v[128:131]
  ds_read_b64_tr_b16 v[28:29], v6 offset:24576
  v_mfma_f32_16x16x32_bf16 v[128:131], a[172:175], a[16:19], v[128:131]
  ds_read_b64_tr_b16 v[30:31], v6 offset:26624
  v_mfma_f32_16x16x32_bf16 v[132:135], a[172:175], a[20:23], v[132:135]
  ds_read_b64_tr_b16 v[24:25], v6 offset:28672
  v_mfma_f32_16x16x32_bf16 v[132:135], a[168:171], a[4:7], v[132:135]
  ds_read_b64_tr_b16 v[26:27], v6 offset:30720
  v_mfma_f32_16x16x32_bf16 v[148:151], a[176:179], a[4:7], v[148:151]
  ds_read_b64_tr_b16 a[172:173], v7 offset:24576
  v_mfma_f32_16x16x32_bf16 v[148:151], a[180:183], a[20:23], v[148:151]
  ds_read_b64_tr_b16 a[174:175], v7 offset:26624
  v_mfma_f32_16x16x32_bf16 v[144:147], a[180:183], a[16:19], v[144:147]
  ds_read_b64_tr_b16 a[168:169], v7 offset:28672
  v_mfma_f32_16x16x32_bf16 v[144:147], a[176:179], a[0:3], v[144:147]
  s_waitcnt lgkmcnt(7)
  ds_read_b64_tr_b16 a[170:171], v7 offset:30720
  v_mfma_f32_16x16x32_bf16 v[160:163], a[164:167], a[0:3], v[160:163]
  ds_read_b64_tr_b16 a[180:181], v8 offset:24576
  v_mfma_f32_16x16x32_bf16 v[160:163], a[160:163], a[16:19], v[160:163]
  ds_read_b64_tr_b16 a[182:183], v8 offset:26624
  v_mfma_f32_16x16x32_bf16 v[164:167], a[160:163], a[20:23], v[164:167]
  ds_read_b64_tr_b16 a[176:177], v8 offset:28672
  v_mfma_f32_16x16x32_bf16 v[164:167], a[164:167], a[4:7], v[164:167]
  ds_read_b64_tr_b16 a[178:179], v8 offset:30720
  v_mfma_f32_16x16x32_bf16 v[180:183], v[20:23], a[4:7], v[180:183]
  ds_read_b64_tr_b16 a[160:161], v9 offset:24576
  v_mfma_f32_16x16x32_bf16 v[180:183], v[16:19], a[20:23], v[180:183]
  ds_read_b64_tr_b16 a[162:163], v9 offset:26624
  v_mfma_f32_16x16x32_bf16 v[176:179], v[16:19], a[16:19], v[176:179]
  ds_read_b64_tr_b16 a[164:165], v9 offset:28672
  v_mfma_f32_16x16x32_bf16 v[176:179], v[20:23], a[0:3], v[176:179]
  s_waitcnt lgkmcnt(7)
  ds_read_b64_tr_b16 a[166:167], v9 offset:30720
  v_mfma_f32_16x16x32_bf16 v[128:131], v[28:31], a[32:35], v[128:131]
  ds_read_b64_tr_b16 v[16:17], v6 offset:8192
  v_mfma_f32_16x16x32_bf16 v[128:131], v[24:27], a[48:51], v[128:131]
  ds_read_b64_tr_b16 v[18:19], v6 offset:10240
  v_mfma_f32_16x16x32_bf16 v[132:135], v[24:27], a[52:55], v[132:135]
  ds_read_b64_tr_b16 v[20:21], v6 offset:12288
  v_mfma_f32_16x16x32_bf16 v[132:135], v[28:31], a[36:39], v[132:135]
  ds_read_b64_tr_b16 v[22:23], v6 offset:14336
  v_mfma_f32_16x16x32_bf16 v[148:151], a[172:175], a[36:39], v[148:151]
  ds_read_b64_tr_b16 v[24:25], v7 offset:8192
  v_mfma_f32_16x16x32_bf16 v[148:151], a[168:171], a[52:55], v[148:151]
  ds_read_b64_tr_b16 v[26:27], v7 offset:10240
  s_xor_b32 s84, s81, 1536
  s_add_u32 s84, s84, 0
  buffer_load_dword v34, v37, s[8:11], s84 offen sc1
  v_mfma_f32_16x16x32_bf16 v[144:147], a[168:171], a[48:51], v[144:147]
  ds_read_b64_tr_b16 v[28:29], v7 offset:12288
  s_xor_b32 s91, s81, 512
  s_add_u32 s91, s91, 0
  buffer_load_dword v39, v37, s[8:11], s91 offen sc1
  v_mfma_f32_16x16x32_bf16 v[144:147], a[172:175], a[32:35], v[144:147]
  s_waitcnt lgkmcnt(7)
  ds_read_b64_tr_b16 v[30:31], v7 offset:14336
  v_mfma_f32_16x16x32_bf16 v[160:163], a[180:183], a[32:35], v[160:163]
  ds_read_b64_tr_b16 a[168:169], v8 offset:8192
  v_mfma_f32_16x16x32_bf16 v[160:163], a[176:179], a[48:51], v[160:163]
  ds_read_b64_tr_b16 a[170:171], v8 offset:10240
  v_mfma_f32_16x16x32_bf16 v[164:167], a[176:179], a[52:55], v[164:167]
  ds_read_b64_tr_b16 a[172:173], v8 offset:12288
  v_mfma_f32_16x16x32_bf16 v[164:167], a[180:183], a[36:39], v[164:167]
  ds_read_b64_tr_b16 a[174:175], v8 offset:14336
  v_mfma_f32_16x16x32_bf16 v[180:183], a[160:163], a[36:39], v[180:183]
  ds_read_b64_tr_b16 a[176:177], v9 offset:8192
  v_mfma_f32_16x16x32_bf16 v[180:183], a[164:167], a[52:55], v[180:183]
  ds_read_b64_tr_b16 a[178:179], v9 offset:10240
  v_mfma_f32_16x16x32_bf16 v[176:179], a[164:167], a[48:51], v[176:179]
  ds_read_b64_tr_b16 a[180:181], v9 offset:12288
  v_mfma_f32_16x16x32_bf16 v[176:179], a[160:163], a[32:35], v[176:179]
  s_waitcnt lgkmcnt(7)
  ds_read_b64_tr_b16 a[182:183], v9 offset:14336
  v_add_u32 v38, s46, v0
  s_waitcnt vmcnt(2)
  s_mov_b64 exec, 1
  buffer_store_dword v38, v0, s[8:11], s81 offen offset:16 sc1
  s_mov_b64 exec, -1
  v_mfma_f32_16x16x32_bf16 v[128:131], v[16:19], a[64:67], v[128:131]
  ds_read_b64_tr_b16 a[164:165], v2 offset:8192
  v_mfma_f32_16x16x32_bf16 v[128:131], v[20:23], a[80:83], v[128:131]
  ds_read_b64_tr_b16 a[166:167], v2 offset:10240
  v_mfma_f32_16x16x32_bf16 v[132:135], v[20:23], a[84:87], v[132:135]
  ds_read_b64_tr_b16 a[160:161], v2 offset:12288
  v_mfma_f32_16x16x32_bf16 v[132:135], v[16:19], a[68:71], v[132:135]
  ds_read_b64_tr_b16 a[162:163], v2 offset:14336
  s_xor_b32 s82, s81, 1024
  s_add_u32 s82, s82, 16
  buffer_load_dword v36, v37, s[8:11], s82 offen sc1
  v_mfma_f32_16x16x32_bf16 v[148:151], v[24:27], a[68:71], v[148:151]
  ds_read_b64_tr_b16 v[20:21], v3 offset:8192
  v_mfma_f32_16x16x32_bf16 v[148:151], v[28:31], a[84:87], v[148:151]
  ds_read_b64_tr_b16 v[22:23], v3 offset:10240
  v_mfma_f32_16x16x32_bf16 v[144:147], v[28:31], a[80:83], v[144:147]
  ds_read_b64_tr_b16 v[16:17], v3 offset:12288
  v_mfma_f32_16x16x32_bf16 v[144:147], v[24:27], a[64:67], v[144:147]
  s_waitcnt lgkmcnt(7)
  ds_read_b64_tr_b16 v[18:19], v3 offset:14336
  v_mfma_f32_16x16x32_bf16 v[160:163], a[168:171], a[64:67], v[160:163]
  ds_read_b64_tr_b16 v[28:29], v4 offset:8192
  v_mfma_f32_16x16x32_bf16 v[160:163], a[172:175], a[80:83], v[160:163]
  ds_read_b64_tr_b16 v[30:31], v4 offset:10240
  v_mfma_f32_16x16x32_bf16 v[164:167], a[172:175], a[84:87], v[164:167]
  ds_read_b64_tr_b16 v[24:25], v4 offset:12288
  v_mfma_f32_16x16x32_bf16 v[164:167], a[168:171], a[68:71], v[164:167]
  ds_read_b64_tr_b16 v[26:27], v4 offset:14336
  v_mfma_f32_16x16x32_bf16 v[180:183], a[176:179], a[68:71], v[180:183]
  ds_read_b64_tr_b16 a[172:173], v5 offset:8192
  v_mfma_f32_16x16x32_bf16 v[180:183], a[180:183], a[84:87], v[180:183]
  ds_read_b64_tr_b16 a[174:175], v5 offset:10240
  v_mfma_f32_16x16x32_bf16 v[176:179], a[180:183], a[80:83], v[176:179]
  ds_read_b64_tr_b16 a[168:169], v5 offset:12288
  v_mfma_f32_16x16x32_bf16 v[176:179], a[176:179], a[64:67], v[176:179]
  s_waitcnt lgkmcnt(7)
  ds_read_b64_tr_b16 a[170:171], v5 offset:14336
  v_mfma_f32_16x16x32_bf16 v[128:131], a[164:167], a[96:99], v[128:131]
  ds_read_b64_tr_b16 a[180:181], v2 offset:40960
  v_mfma_f32_16x16x32_bf16 v[128:131], a[160:163], a[112:115], v[128:131]
  ds_read_b64_tr_b16 a[182:183], v2 offset:43008
  s_waitcnt vmcnt(3)
  v_cmp_ne_u32 vcc, s46, v34
  s_nop 4
  s_cbranch_vccz PL14_adaLN_cond__sliding_local_dilated__swiglu_ffn__prompt_kernelx
  s_mov_b32 s83, 60000
PL14_adaLN_cond__sliding_local_dilated__swiglu_ffn__prompt_kernel:
  buffer_load_dword v34, v37, s[8:11], s84 offen sc1
  s_sub_u32 s83, s83, 1
  s_cmp_eq_u32 s83, 0
  s_waitcnt vmcnt(0)
  s_cbranch_scc1 PL14_adaLN_cond__sliding_local_dilated__swiglu_ffn__prompt_kernelx
  v_cmp_ne_u32 vcc, s46, v34
  s_nop 4
  s_cbranch_vccnz PL14_adaLN_cond__sliding_local_dilated__swiglu_ffn__prompt_kernel
PL14_adaLN_cond__sliding_local_dilated__swiglu_ffn__prompt_kernelx:
  v_mfma_f32_16x16x32_bf16 v[132:135], a[160:163], a[116:119], v[132:135]
  ds_read_b64_tr_b16 a[176:177], v2 offset:45056
  s_xor_b32 s55, s86, 196608
  s_add_u32 s55, s55, 0
  buffer_load_dwordx4 v[88:91], v1, s[8:11], s55 offen offset:0 sc1
  v_mfma_f32_16x16x32_bf16 v[132:135], a[164:167], a[100:103], v[132:135]
  ds_read_b64_tr_b16 a[178:179], v2 offset:47104
  s_xor_b32 s55, s86, 196608
  s_add_u32 s55, s55, 0
  buffer_load_dwordx4 v[120:123], v1, s[8:11], s55 offen offset:1024 sc1
  v_mfma_f32_16x16x32_bf16 v[148:151], v[20:23], a[100:103], v[148:151]
  ds_read_b64_tr_b16 a[160:161], v3 offset:40960
  s_xor_b32 s55, s86, 196608
  s_add_u32 s55, s55, 0
  buffer_load_dwordx4 v[92:95], v1, s[8:11], s55 offen offset:2048 sc1
  v_mfma_f32_16x16x32_bf16 v[148:151], v[16:19], a[116:119], v[148:151]
  ds_read_b64_tr_b16 a[162:163], v3 offset:43008
  s_xor_b32 s55, s86, 196608
  s_add_u32 s55, s55, 0
  buffer_load_dwordx4 v[124:127], v1, s[8:11], s55 offen offset:3072 sc1
  v_mfma_f32_16x16x32_bf16 v[144:147], v[16:19], a[112:115], v[144:147]
  ds_read_b64_tr_b16 a[164:165], v3 offset:45056
  s_waitcnt vmcnt(6)
  v_cmp_ne_u32 vcc, s46, v39
  s_nop 4
  s_cbranch_vccz PL15_adaLN_cond__sliding_local_dilated__swiglu_ffn__prompt_kernelx
  s_mov_b32 s83, 60000
PL15_adaLN_cond__sliding_local_dilated__swiglu_ffn__prompt_kernel:
  buffer_load_dword v39, v37, s[8:11], s91 offen sc1
  s_sub_u32 s83, s83, 1
  s_cmp_eq_u32 s83, 0
  s_waitcnt vmcnt(0)
  s_cbranch_scc1 PL15_adaLN_cond__sliding_local_dilated__swiglu_ffn__prompt_kernelx
  v_cmp_ne_u32 vcc, s46, v39
  s_nop 4
  s_cbranch_vccnz PL15_adaLN_cond__sliding_local_dilated__swiglu_ffn__prompt_kernel
PL15_adaLN_cond__sliding_local_dilated__swiglu_ffn__prompt_kernelx:
  v_mfma_f32_16x16x32_bf16 v[144:147], v[20:23], a[96:99], v[144:147]
  s_waitcnt lgkmcnt(7)
  ds_read_b64_tr_b16 a[166:167], v3 offset:47104
  s_xor_b32 s55, s86, 65536
  s_add_u32 s55, s55, 4096
  buffer_load_dwordx4 v[80:83], v1, s[8:11], s55 offen offset:0 sc1
  v_mfma_f32_16x16x32_bf16 v[160:163], v[28:31], a[96:99], v[160:163]
  ds_read_b64_tr_b16 v[16:17], v4 offset:40960
  s_xor_b32 s55, s86, 65536
  s_add_u32 s55, s55, 4096
  buffer_load_dwordx4 v[112:115], v1, s[8:11], s55 offen offset:1024 sc1
  v_mfma_f32_16x16x32_bf16 v[160:163], v[24:27], a[112:115], v[160:163]
  ds_read_b64_tr_b16 v[18:19], v4 offset:43008
  s_xor_b32 s55, s86, 65536
  s_add_u32 s55, s55, 4096
  buffer_load_dwordx4 v[84:87], v1, s[8:11], s55 offen offset:2048 sc1
  v_mfma_f32_16x16x32_bf16 v[164:167], v[24:27], a[116:119], v[164:167]
  ds_read_b64_tr_b16 v[20:21], v4 offset:45056
  s_xor_b32 s55, s86, 65536
  s_add_u32 s55, s55, 4096
  buffer_load_dwordx4 v[116:119], v1, s[8:11], s55 offen offset:3072 sc1
  v_mfma_f32_16x16x32_bf16 v[164:167], v[28:31], a[100:103], v[164:167]
  ds_read_b64_tr_b16 v[22:23], v4 offset:47104
  v_mfma_f32_16x16x32_bf16 v[180:183], a[172:175], a[100:103], v[180:183]
  ds_read_b64_tr_b16 v[24:25], v5 offset:40960
  v_mfma_f32_16x16x32_bf16 v[180:183], a[168:171], a[116:119], v[180:183]
  ds_read_b64_tr_b16 v[26:27], v5 offset:43008
  s_waitcnt vmcnt(8)
  v_cmp_ne_u32 vcc, s46, v36
  s_mov_b32 s87, 0
  s_nop 3
  s_cbranch_vccnz XL16_adaLN_cond__sliding_local_dilated__swiglu_ffn__prompt_kernel
  s_xor_b32 s55, s86, 131072
  s_add_u32 s55, s55, 8192
  buffer_load_dwordx4 v[152:155], v1, s[8:11], s55 offen offset:0 sc1
  buffer_load_dwordx4 v[184:187], v1, s[8:11], s55 offen offset:1024 sc1
  buffer_load_dwordx4 v[156:159], v1, s[8:11], s55 offen offset:2048 sc1
  buffer_load_dwordx4 v[188:191], v1, s[8:11], s55 offen offset:3072 sc1
  s_mov_b32 s87, 1
XL16_adaLN_cond__sliding_local_dilated__swiglu_ffn__prompt_kernel:
  v_mfma_f32_16x16x32_bf16 v[176:179], a[168:171], a[112:115], v[176:179]
  ds_read_b64_tr_b16 v[28:29], v5 offset:45056
  v_mfma_f32_16x16x32_bf16 v[176:179], a[172:175], a[96:99], v[176:179]
  s_waitcnt lgkmcnt(7)
  ds_read_b64_tr_b16 v[30:31], v5 offset:47104
  v_mfma_f32_16x16x32_bf16 v[128:131], a[180:183], a[128:131], v[128:131]
  ds_read_b64_tr_b16 a[168:169], v2 offset:57344
  v_mfma_f32_16x16x32_bf16 v[128:131], a[176:179], a[144:147], v[128:131]
  ds_read_b64_tr_b16 a[170:171], v2 offset:59392
  v_mfma_f32_16x16x32_bf16 v[132:135], a[176:179], a[148:151], v[132:135]
  ds_read_b64_tr_b16 a[172:173], v2 offset:61440
  v_mfma_f32_16x16x32_bf16 v[132:135], a[180:183], a[132:135], v[132:135]
  ds_read_b64_tr_b16 a[174:175], v2 offset:63488
  v_mfma_f32_16x16x32_bf16 v[148:151], a[160:163], a[132:135], v[148:151]
  ds_read_b64_tr_b16 a[176:177], v3 offset:57344
  v_mfma_f32_16x16x32_bf16 v[148:151], a[164:167], a[148:151], v[148:151]
  ds_read_b64_tr_b16 a[178:179], v3 offset:59392
  v_mfma_f32_16x16x32_bf16 v[144:147], a[164:167], a[144:147], v[144:147]
  ds_read_b64_tr_b16 a[180:181], v3 offset:61440
  v_mfma_f32_16x16x32_bf16 v[144:147], a[160:163], a[128:131], v[144:147]
  s_waitcnt lgkmcnt(7)
  ds_read_b64_tr_b16 a[182:183], v3 offset:63488
  v_mfma_f32_16x16x32_bf16 v[160:163], v[16:19], a[128:131], v[160:163]
  ds_read_b64_tr_b16 a[164:165], v4 offset:57344
  v_mfma_f32_16x16x32_bf16 v[160:163], v[20:23], a[144:147], v[160:163]
  ds_read_b64_tr_b16 a[166:167], v4 offset:59392
  v_mfma_f32_16x16x32_bf16 v[164:167], v[20:23], a[148:151], v[164:167]
  ds_read_b64_tr_b16 a[160:161], v4 offset:61440
  v_mfma_f32_16x16x32_bf16 v[164:167], v[16:19], a[132:135], v[164:167]
  ds_read_b64_tr_b16 a[162:163], v4 offset:63488
  v_mfma_f32_16x16x32_bf16 v[180:183], v[24:27], a[132:135], v[180:183]
  ds_read_b64_tr_b16 v[20:21], v5 offset:57344
  v_mfma_f32_16x16x32_bf16 v[180:183], v[28:31], a[148:151], v[180:183]
  ds_read_b64_tr_b16 v[22:23], v5 offset:59392
  v_mfma_f32_16x16x32_bf16 v[176:179], v[28:31], a[144:147], v[176:179]
  ds_read_b64_tr_b16 v[16:17], v5 offset:61440
  v_mfma_f32_16x16x32_bf16 v[176:179], v[24:27], a[128:131], v[176:179]
  s_waitcnt lgkmcnt(7)
  ds_read_b64_tr_b16 v[18:19], v5 offset:63488
  v_mfma_f32_16x16x32_bf16 v[128:131], a[168:171], a[188:191], v[128:131]
  v_mfma_f32_16x16x32_bf16 v[128:131], a[172:175], a[204:207], v[128:131]
  v_mfma_f32_16x16x32_bf16 v[132:135], a[172:175], a[208:211], v[132:135]
  v_mfma_f32_16x16x32_bf16 v[132:135], a[168:171], a[192:195], v[132:135]
  v_mfma_f32_16x16x32_bf16 v[148:151], a[176:179], a[192:195], v[148:151]
  v_mfma_f32_16x16x32_bf16 v[148:151], a[180:183], a[208:211], v[148:151]
  v_mfma_f32_16x16x32_bf16 v[144:147], a[180:183], a[204:207], v[144:147]
  v_mfma_f32_16x16x32_bf16 v[144:147], a[176:179], a[188:191], v[144:147]
  s_waitcnt lgkmcnt(0)
  v_mfma_f32_16x16x32_bf16 v[160:163], a[164:167], a[188:191], v[160:163]
  v_mfma_f32_16x16x32_bf16 v[160:163], a[160:163], a[204:207], v[160:163]
  v_mfma_f32_16x16x32_bf16 v[164:167], a[160:163], a[208:211], v[164:167]
  v_mfma_f32_16x16x32_bf16 v[164:167], a[164:167], a[192:195], v[164:167]
  v_mfma_f32_16x16x32_bf16 v[180:183], v[20:23], a[192:195], v[180:183]
  v_mfma_f32_16x16x32_bf16 v[180:183], v[16:19], a[208:211], v[180:183]
  v_mfma_f32_16x16x32_bf16 v[176:179], v[16:19], a[204:207], v[176:179]
  v_mfma_f32_16x16x32_bf16 v[176:179], v[20:23], a[188:191], v[176:179]
  s_waitcnt vmcnt(0)
  v_mfma_f32_16x16x32_bf16 v[208:211], v[52:55], v[88:91], v[208:211]
  v_mfma_f32_16x16x32_bf16 v[212:215], v[54:57], v[88:91], v[212:215]
  v_mfma_f32_16x16x32_bf16 v[216:219], v[58:61], v[120:123], v[216:219]
  v_mfma_f32_16x16x32_bf16 v[220:223], v[60:63], v[120:123], v[220:223]
  v_mfma_f32_16x16x32_bf16 v[224:227], v[52:55], v[92:95], v[224:227]
  v_mfma_f32_16x16x32_bf16 v[228:231], v[54:57], v[92:95], v[228:231]
  v_mfma_f32_16x16x32_bf16 v[232:235], v[58:61], v[124:127], v[232:235]
  v_mfma_f32_16x16x32_bf16 v[236:239], v[60:63], v[124:127], v[236:239]
  v_mfma_f32_16x16x32_bf16 v[208:211], v[52:55], v[80:83], v[208:211]
  v_mfma_f32_16x16x32_bf16 v[212:215], v[54:57], v[80:83], v[212:215]
  v_mfma_f32_16x16x32_bf16 v[216:219], v[58:61], v[112:115], v[216:219]
  v_mfma_f32_16x16x32_bf16 v[220:223], v[60:63], v[112:115], v[220:223]
  v_mfma_f32_16x16x32_bf16 v[224:227], v[52:55], v[84:87], v[224:227]
  v_mfma_f32_16x16x32_bf16 v[228:231], v[54:57], v[84:87], v[228:231]
  v_mfma_f32_16x16x32_bf16 v[232:235], v[58:61], v[116:119], v[232:235]
  v_mfma_f32_16x16x32_bf16 v[236:239], v[60:63], v[116:119], v[236:239]
  s_nop 0
  v_fmac_f32 v208, v240, v128
  v_fmac_f32 v209, v241, v129
  v_fmac_f32 v210, v242, v130
  v_fmac_f32 v211, v243, v131
  v_fmac_f32 v212, v244, v144
  v_fmac_f32 v213, v245, v145
  v_fmac_f32 v214, v246, v146
  v_fmac_f32 v215, v247, v147
  v_fmac_f32 v224, v240, v132
  v_fmac_f32 v225, v241, v133
  v_fmac_f32 v226, v242, v134
  v_fmac_f32 v227, v243, v135
  v_fmac_f32 v228, v244, v148
  v_fmac_f32 v229, v245, v149
  v_fmac_f32 v230, v246, v150
  v_fmac_f32 v231, v247, v151
  v_fmac_f32 v216, v248, v160
  v_fmac_f32 v217, v249, v161
  v_fmac_f32 v218, v250, v162
  v_fmac_f32 v219, v251, v163
  v_fmac_f32 v220, v252, v176
  v_fmac_f32 v221, v253, v177
  v_fmac_f32 v222, v254, v178
  v_fmac_f32 v223, v255, v179
  v_fmac_f32 v232, v248, v164
  v_fmac_f32 v233, v249, v165
  v_fmac_f32 v234, v250, v166
  v_fmac_f32 v235, v251, v167
  v_fmac_f32 v236, v252, v180
  v_fmac_f32 v237, v253, v181
  v_fmac_f32 v238, v254, v182
  v_fmac_f32 v239, v255, v183
  s_cmp_eq_u32 s87, 1
  s_cbranch_scc1 XA17_adaLN_cond__sliding_local_dilated__swiglu_ffn__prompt_kernelx
  s_mov_b32 s83, 60000
XA17_adaLN_cond__sliding_local_dilated__swiglu_ffn__prompt_kernel:
  buffer_load_dword v36, v37, s[8:11], s82 offen sc1
  s_sub_u32 s83, s83, 1
  s_cmp_eq_u32 s83, 0
  s_waitcnt vmcnt(0)
  s_cbranch_scc1 XA17_adaLN_cond__sliding_local_dilated__swiglu_ffn__prompt_kernely
  v_cmp_ne_u32 vcc, s46, v36
  s_nop 4
  s_cbranch_vccnz XA17_adaLN_cond__sliding_local_dilated__swiglu_ffn__prompt_kernel
XA17_adaLN_cond__sliding_local_dilated__swiglu_ffn__prompt_kernely:
  s_xor_b32 s55, s86, 131072
  s_add_u32 s55, s55, 8192
  buffer_load_dwordx4 v[152:155], v1, s[8:11], s55 offen offset:0 sc1
  buffer_load_dwordx4 v[184:187], v1, s[8:11], s55 offen offset:1024 sc1
  buffer_load_dwordx4 v[156:159], v1, s[8:11], s55 offen offset:2048 sc1
  buffer_load_dwordx4 v[188:191], v1, s[8:11], s55 offen offset:3072 sc1
XA17_adaLN_cond__sliding_local_dilated__swiglu_ffn__prompt_kernelx:
  s_waitcnt vmcnt(3)
  v_mfma_f32_16x16x32_bf16 v[208:211], v[52:55], v[152:155], v[208:211]
  v_mfma_f32_16x16x32_bf16 v[212:215], v[54:57], v[152:155], v[212:215]
  s_waitcnt vmcnt(2)
  v_mfma_f32_16x16x32_bf16 v[216:219], v[58:61], v[184:187], v[216:219]
  v_mfma_f32_16x16x32_bf16 v[220:223], v[60:63], v[184:187], v[220:223]
  s_waitcnt vmcnt(1)
  v_mfma_f32_16x16x32_bf16 v[224:227], v[52:55], v[156:159], v[224:227]
  v_mfma_f32_16x16x32_bf16 v[228:231], v[54:57], v[156:159], v[228:231]
  s_waitcnt vmcnt(0)
  v_mfma_f32_16x16x32_bf16 v[232:235], v[58:61], v[188:191], v[232:235]
  v_mfma_f32_16x16x32_bf16 v[236:239], v[60:63], v[188:191], v[236:239]
  v_cvt_pk_bf16_f32 v192, v208, v209
  v_cvt_pk_bf16_f32 v193, v210, v211
  v_cvt_pk_bf16_f32 v194, v212, v213
  v_cvt_pk_bf16_f32 v195, v214, v215
  s_nop 0
  v_permlane16_swap_b32 v192, v194
  v_permlane16_swap_b32 v193, v195
  ds_write_b128 v42, v[192:195] offset:0
  v_cvt_pk_bf16_f32 v196, v216, v217
  v_cvt_pk_bf16_f32 v197, v218, v219
  v_cvt_pk_bf16_f32 v198, v220, v221
  v_cvt_pk_bf16_f32 v199, v222, v223
  s_nop 0
  v_permlane16_swap_b32 v196, v198
  v_permlane16_swap_b32 v197, v199
  ds_write_b128 v43, v[196:199] offset:0
  ds_read_b128 v[208:211], v44 offset:0
  ds_read_b128 v[212:215], v44 offset:1024
  v_cvt_pk_bf16_f32 v200, v224, v225
  v_cvt_pk_bf16_f32 v201, v226, v227
  v_cvt_pk_bf16_f32 v202, v228, v229
  v_cvt_pk_bf16_f32 v203, v230, v231
  s_nop 0
  v_permlane16_swap_b32 v200, v202
  v_permlane16_swap_b32 v201, v203
  ds_write_b128 v42, v[200:203] offset:2048
  v_cvt_pk_bf16_f32 v204, v232, v233
  v_cvt_pk_bf16_f32 v205, v234, v235
  v_cvt_pk_bf16_f32 v206, v236, v237
  v_cvt_pk_bf16_f32 v207, v238, v239
  s_nop 0
  v_permlane16_swap_b32 v204, v206
  v_permlane16_swap_b32 v205, v207
  ds_write_b128 v43, v[204:207] offset:2048
  ds_read_b128 v[224:227], v44 offset:2048
  ds_read_b128 v[228:231], v44 offset:3072
  s_waitcnt lgkmcnt(5)
  buffer_store_dwordx4 v[208:211], v40, s[40:43], s85 offen sc1
  s_add_u32 s85, s85, 16384
  s_waitcnt lgkmcnt(4)
  buffer_store_dwordx4 v[212:215], v40, s[40:43], s85 offen sc1
  s_add_u32 s85, s85, 16384
  s_waitcnt lgkmcnt(1)
  buffer_store_dwordx4 v[224:227], v40, s[40:43], s85 offen sc1
  s_add_u32 s85, s85, 16384
  s_waitcnt lgkmcnt(0)
  buffer_store_dwordx4 v[228:231], v40, s[40:43], s85 offen sc1
E_adaLN_cond__sliding_local_dilated__swiglu_ffn__prompt_kernel:
X_adaLN_cond__sliding_local_dilated__swiglu_ffn__prompt_kernel:
  s_endpgm
code_end:
.fill 2048, 4, 0xBF800000
.section .rodata,"a"
.p2align 6
.amdhsa_kernel adaLN_cond__sliding_local_dilated__swiglu_ffn__prompt_kernel
  .amdhsa_next_free_vgpr 512
  .amdhsa_next_free_sgpr 102
  .amdhsa_accum_offset 256
  .amdhsa_group_segment_fixed_size 0
  .amdhsa_kernarg_size 96
  .amdhsa_user_sgpr_count 2
  .amdhsa_user_sgpr_kernarg_segment_ptr 1
  .amdhsa_system_sgpr_workgroup_id_x 1
  .amdhsa_float_denorm_mode_32 3
.end_amdhsa_kernel
```

```asm
; @launch grid=(256,1,1) block=(256,1,1) lds=163840
.amdgcn_target "amdgcn-amd-amdhsa--gfx950"
.text
.globl adaLN_cond__sliding_local_dilated__swiglu_ffn__prompt_kernel
.type adaLN_cond__sliding_local_dilated__swiglu_ffn__prompt_kernel,@function
.p2align 8
adaLN_cond__sliding_local_dilated__swiglu_ffn__prompt_kernel:
  s_cmp_ge_u32 s2, 256
  s_cbranch_scc1 X_adaLN_cond__sliding_local_dilated__swiglu_ffn__prompt_kernel
  s_load_dwordx2 s[4:5], s[0:1], 0
  s_load_dwordx2 s[8:9], s[0:1], 88
  s_load_dwordx2 s[12:13], s[0:1], 8
  s_load_dwordx2 s[16:17], s[0:1], 16
  s_load_dwordx2 s[20:21], s[0:1], 64
  s_load_dwordx2 s[24:25], s[0:1], 56
  s_load_dwordx2 s[28:29], s[0:1], 32
  s_load_dwordx2 s[32:33], s[0:1], 40
  s_load_dwordx2 s[36:37], s[0:1], 48
  s_load_dwordx2 s[40:41], s[0:1], 72
  v_lshrrev_b32 v21, 6, v0
  v_and_b32 v0, 63, v0
  v_readfirstlane_b32 s44, v21
  v_lshrrev_b32 v22, 3, v0
  v_lshlrev_b32 v1, 4, v0
  s_lshr_b32 s83, s2, 3
  s_lshl_b32 s83, s83, 2
  s_add_u32 s83, s83, s44
  s_lshl_b32 s83, s83, 10
  s_getpc_b64 s[80:81]
CT1_adaLN_cond__sliding_local_dilated__swiglu_ffn__prompt_kernel:
  s_min_u32 s82, s83, code_end-CB0
  s_add_u32 s82, s82, CB0-CT1_adaLN_cond__sliding_local_dilated__swiglu_ffn__prompt_kernel
  s_add_u32 s80, s80, s82
  s_addc_u32 s81, s81, 0
  v_and_b32 v24, 0x70, v1
  v_lshlrev_b32 v24, 3, v24
  global_load_dword a253, v24, s[80:81]
  v_bfe_u32 v11, v22, 1, 2
  v_bfe_u32 v23, v0, 1, 2
  v_xor_b32 v11, v11, v23
  v_lshlrev_b32 v11, 5, v11
  v_and_b32 v23, 1, v0
  v_lshl_add_u32 v11, v23, 4, v11
  s_lshl_b32 s45, s44, 10
  s_lshl_b32 s52, s44, 3
  v_add_u32 v10, s52, v22
  s_and_b32 s52, s2, 7
  s_lshl_b32 s52, s52, 7
  v_add_u32 v35, s52, v10
  v_mul_u32_u24 v35, 12288, v35
  s_lshr_b32 s53, s2, 3
  s_lshl_b32 s53, s53, 7
  v_add3_u32 v35, v35, v11, s53
  s_and_b32 s53, s44, 1
  s_lshl_b32 s53, s53, 6
  s_add_u32 s52, s52, s53
  v_add_lshl_u32 v16, s52, v0, 1
  s_and_b32 s52, s2, 7
  s_lshr_b32 s53, s2, 3
  s_and_b32 s51, s52, 3
  s_lshl_b32 s51, s51, 2
  s_and_b32 s50, s53, 3
  s_add_u32 s51, s51, s50
  s_lshr_b32 s50, s52, 2
  s_lshl_b32 s50, s50, 3
  s_lshr_b32 s53, s53, 2
  s_add_u32 s50, s50, s53
  s_lshl_b32 s54, s50, 4
  s_add_u32 s54, s54, s51
  v_and_b32 v21, 7, v0
  v_lshlrev_b32 v28, 11, v21
  v_lshl_add_u32 v28, v22, 4, v28
  v_mov_b32 v29, 851968
  s_lshr_b32 s38, s54, 1
  s_lshl_b32 s38, s38, 15
  s_and_b32 s53, s54, 1
  s_lshl_b32 s53, s53, 2
  s_add_u32 s53, s53, s44
  s_lshl_b32 s52, s53, 8
  s_add_u32 s30, s38, s52
  s_mov_b32 s6, 4194304
  s_mov_b32 s7, 0x20000
  s_mov_b32 s10, 134217728
  s_mov_b32 s11, 0x20000
  s_mov_b32 s14, 6291456
  s_mov_b32 s15, 0x20000
  s_mov_b32 s18, 2097152
  s_mov_b32 s19, 0x20000
  s_mov_b32 s22, 12582912
  s_mov_b32 s23, 0x20000
  s_mov_b32 s26, 2048
  s_mov_b32 s27, 0x20000
  s_waitcnt lgkmcnt(0)
  buffer_load_ushort v15, v16, s[24:27], 0 offen
  s_add_u32 m0, s45, 131072
  s_mov_b32 s68, 0
  buffer_load_dwordx4 v35, s[20:23], s68 offen nt lds
  s_add_u32 m0, s45, 135168
  s_add_u32 s68, s68, 393216
  buffer_load_dwordx4 v35, s[20:23], s68 offen nt lds
  s_add_u32 m0, s45, 139264
  s_add_u32 s68, s68, 393216
  buffer_load_dwordx4 v35, s[20:23], s68 offen nt lds
  s_add_u32 m0, s45, 143360
  s_add_u32 s68, s68, 393216
  buffer_load_dwordx4 v35, s[20:23], s68 offen nt lds
  buffer_load_dword v36, v29, s[8:11], 0 offen sc1
  s_and_b32 s52, s2, 3
  s_lshl_b32 s52, s52, 2
  s_add_u32 s52, s52, s44
  s_lshl_b32 s52, s52, 7
  v_lshlrev_b32 v23, 1, v0
  buffer_load_ushort v23, v23, s[24:27], s52 offen
  s_add_u32 s52, s30, 0
  buffer_load_dwordx4 v[44:47], v28, s[4:7], s52 offen offset:0 nt
  buffer_load_dwordx4 v[48:51], v28, s[4:7], s52 offen offset:128 nt
  s_add_u32 s52, s30, 16384
  buffer_load_dwordx4 v[52:55], v28, s[4:7], s52 offen offset:0 nt
  buffer_load_dwordx4 v[56:59], v28, s[4:7], s52 offen offset:128 nt
  s_branch BODY0
.p2align 12
BODY0:
CB0:
  v_lshlrev_b32 v1, 4, v0
  v_add_u32 v2, 65536, v1
  v_add_u32 v13, 131072, v1
  s_and_b32 s66, s51, 3
  v_mul_u32_u24 v9, 6144, v10
  s_lshl_b32 s52, s51, 7
  v_add3_u32 v9, v9, v11, s52
  s_lshl_b32 s52, s53, 12
  s_add_u32 s38, s38, s52
  s_add_u32 s39, s38, 41943040
  s_add_u32 s38, s38, 1048576
  s_lshl_b32 s34, s53, 9
  s_add_u32 s34, s34, 131072
  s_lshl_b32 s35, s53, 11
  s_add_u32 s35, s35, 819200
  s_xor_b32 s30, s30, 1024
  s_add_u32 s52, s30, 0
  buffer_load_dwordx4 v[92:95], v28, s[4:7], s52 offen offset:0 nt
  buffer_load_dwordx4 v[96:99], v28, s[4:7], s52 offen offset:128 nt
  s_add_u32 s52, s30, 16384
  buffer_load_dwordx4 v[100:103], v28, s[4:7], s52 offen offset:0 nt
  buffer_load_dwordx4 v[104:107], v28, s[4:7], s52 offen offset:128 nt
  s_lshr_b32 s52, s2, 3
  s_mul_i32 s52, s52, 98304
  s_lshl_b32 s53, s44, 11
  s_add_u32 s52, s52, s53
  s_and_b32 s53, s2, 3
  s_lshl_b32 s53, s53, 9
  s_add_u32 s52, s52, s53
  s_add_u32 s52, s52, 0
  s_cmp_lt_u32 s44, 3
  s_cselect_b32 s52, s52, 1073741824
  v_lshrrev_b32 v43, 2, v0
  v_mul_u32_u24 v43, 5632, v43
  v_lshl_add_u32 v43, v0, 7, v43
  buffer_load_dword a252, v43, s[12:15], s52 offen
  v_lshrrev_b32 v41, 2, v0
  v_bfe_u32 v40, v41, 1, 2
  v_lshlrev_b32 v40, 5, v40
  v_lshl_add_u32 v40, v41, 7, v40
  v_and_b32 v41, 3, v0
  v_lshl_add_u32 v40, v41, 3, v40
  s_lshl_b32 s52, s44, 5
  v_xor_b32 v3, s52, v40
  s_and_b32 s52, s52, 64
  s_and_b32 s53, s44, 1
  s_lshl_b32 s53, s53, 14
  s_add_u32 s52, s52, s53
  v_xor_b32 v4, s52, v40
  v_xor_b32 v5, 32, v4
  v_add_u32 v6, 65536, v3
  v_add_u32 v7, 65536, v4
  v_add_u32 v8, 65536, v5
  v_add_u32 v35, 131072, v3
  v_lshrrev_b32 v30, 5, v0
  v_lshlrev_b32 v30, 6, v30
  v_bfe_u32 v40, v0, 2, 2
  v_lshl_add_u32 v30, v40, 4, v30
  v_bfe_u32 v40, v0, 4, 1
  v_lshl_add_u32 v30, v40, 3, v30
  v_lshl_add_u32 v30, v41, 1, v30
  s_lshl_b32 s52, s44, 7
  s_add_u32 s52, s52, 160768
  v_add_u32 v30, s52, v30
  v_lshrrev_b32 v32, 4, v0
  v_lshlrev_b32 v32, 4, v32
  v_add_u32 v31, 160768, v32
  v_and_b32 v40, 15, v0
  v_lshl_add_u32 v32, v40, 27, v32
  s_and_b32 s52, s2, 7
  s_lshl_b32 s52, s52, 13
  s_lshr_b32 s53, s2, 3
  s_lshl_b32 s53, s53, 8
  s_add_u32 s52, s52, s53
  s_lshl_b32 s53, s44, 6
  s_add_u32 s52, s52, s53
  s_add_u32 s42, s52, 131072
  s_lshl_b32 s53, s44, 28
  s_lshl_b32 s31, s2, 7
  s_add_u32 s31, s31, s53
  s_add_u32 s31, s31, 819200
  s_lshl_b32 s74, s54, 7
  s_add_u32 s74, s74, s53
  s_add_u32 s75, s74, 786432
  s_add_u32 s74, s74, 655360
  s_lshl_b32 s52, s50, 18
  s_add_u32 s52, s52, 1015808
  s_max_u32 s72, s52, 1048576
  s_lshr_b32 s53, s44, 1
  s_lshl_b32 s70, s53, 15
  s_add_u32 s52, s52, s70
  v_add_u32 v12, s52, v1
  s_lshl_b32 s53, s53, 11
  s_add_u32 s72, s72, s53
  s_lshl_b32 s70, s44, 12
  s_and_b32 s52, s70, 4096
  s_add_u32 s71, s52, s53
  s_and_b32 s52, s44, 1
  s_add_u32 s52, s52, s66
  s_add_u32 s58, s52, 0
  s_and_b32 s58, s58, 7
  s_lshl_b32 s58, s58, 12
  s_add_u32 s59, s52, 2
  s_and_b32 s59, s59, 7
  s_lshl_b32 s59, s59, 12
  s_add_u32 s60, s52, 4
  s_and_b32 s60, s60, 7
  s_lshl_b32 s60, s60, 12
  s_add_u32 s61, s52, 6
  s_and_b32 s61, s61, 7
  s_lshl_b32 s61, s61, 12
  s_lshl_b32 s52, s50, 4
  s_sub_u32 s52, s52, 2
  v_min_u32 v14, 17, v0
  v_add_u32 v14, s52, v14
  v_max_i32 v14, 0, v14
  v_lshlrev_b32 v14, 7, v14
  v_add_u32 v14, 786432, v14
  s_and_b32 s52, s2, 3
  s_lshl_b32 s52, s52, 8
  v_add_u32 v40, s52, v10
  v_mul_u32_u24 v40, 12288, v40
  s_lshr_b32 s53, s2, 2
  s_add_u32 s53, s53, 32
  s_lshl_b32 s53, s53, 7
  v_lshl_add_u32 v10, v10, 11, v11
  v_add3_u32 v11, v40, v11, s53
  s_and_b32 s52, s44, 1
  s_lshl_b32 s53, s50, 3
  s_add_u32 s53, s53, s52
  s_lshl_b32 s73, s53, 15
  s_lshl_b32 s53, s51, 1
  s_lshr_b32 s57, s44, 1
  s_add_u32 s53, s53, s57
  s_lshl_b32 s53, s53, 10
  s_add_u32 s73, s73, s53
  s_add_u32 s73, s73, 7340032
  s_mul_i32 s57, s57, 3072
  s_add_u32 s57, s57, 131072
  v_add_u32 v19, s57, v1
  s_lshl_b32 s53, s52, 3
  v_add_u32 v18, s53, v19
  s_lshl_b32 s53, s52, 10
  v_add_u32 v17, s53, v19
  v_lshrrev_b32 v40, 2, v0
  v_and_b32 v20, 3, v0
  v_lshl_add_u32 v40, v20, 4, v40
  v_lshl_add_u32 v20, v40, 4, s57
  s_mov_b32 s80, 0xfff0ffff
  s_mov_b32 s81, 0xf000ff00
  s_mov_b32 s82, 0xffe0fffe
  s_mov_b32 s83, 0xe000fe00
  s_mov_b32 s84, 0xffc0fffc
  s_mov_b32 s85, 0xc000fc00
  s_mov_b32 s86, 0xff80fff8
  s_mov_b32 s87, 0x8000f800
  s_mov_b32 s88, 0xaaaaaaaa
  s_mov_b32 s89, 0xaaaaaaaa
  s_mov_b32 s90, 0x000f0000
  s_mov_b32 s91, 0x0fff00ff
  s_mov_b32 s92, 0x003f0003
  s_mov_b32 s93, 0x3fff03ff
  v_mov_b32 v41, 0xffff
  v_mov_b32 v24, 0xffff0000
  v_cndmask_b32 v41, v41, v24, s[88:89]
  v_cndmask_b32 v24, 0, v41, s[90:91]
  v_cndmask_b32 v25, 0, v41, s[92:93]
  v_xor_b32 v26, v24, v41
  v_xor_b32 v27, v25, v41
  s_or_b32 s52, s52, s50
  s_cmp_eq_u32 s52, 0
  s_cselect_b64 s[90:91], s[90:91], 0
  s_cselect_b64 s[92:93], s[92:93], 0
  s_waitcnt vmcnt(15)
  v_lshlrev_b32 v15, 16, v15
  v_mul_f32 v16, 0xbfb8aa3b, v15
  v_exp_f32 v16, v16
  s_nop 0
  v_add_f32 v16, 1.0, v16
  v_rcp_f32 v16, v16
  s_nop 0
  v_mul_f32 v15, v15, v16
  v_cvt_pk_bf16_f32 v15, v15, v15
  ds_write_b16 v30, v15
  s_waitcnt vmcnt(11) lgkmcnt(0)
  s_barrier
  ds_read_b64_tr_b16 v[60:61], v35 offset:0
  ds_read_b64_tr_b16 v[62:63], v35 offset:2048
  ds_read_b128 v[76:79], v31 offset:0
  ds_read_b64_tr_b16 v[64:65], v35 offset:4096
  ds_read_b64_tr_b16 v[66:67], v35 offset:6144
  ds_read_b128 v[80:83], v31 offset:64
  ds_read_b64_tr_b16 v[68:69], v35 offset:8192
  ds_read_b64_tr_b16 v[70:71], v35 offset:10240
  ds_read_b128 v[84:87], v31 offset:128
  ds_read_b64_tr_b16 v[72:73], v35 offset:12288
  ds_read_b64_tr_b16 v[74:75], v35 offset:14336
  ds_read_b128 v[88:91], v31 offset:192
  s_waitcnt vmcnt(10)
  v_readfirstlane_b32 s46, v36
  s_nop 0
  s_add_u32 s46, s46, 8
  s_mul_i32 s52, s46, 0x13c6ef37
  v_mov_b32 v36, 0xff
  s_bfe_u32 s55, s52, 0x80000
  s_bfe_u32 s56, s52, 0x80008
  s_bfe_u32 s69, s52, 0x80010
  s_bfe_u32 s54, s52, 0x80018
  s_waitcnt lgkmcnt(9)
  v_mfma_f32_16x16x32_bf16 v[40:43], v[60:63], v[76:79], 0
  s_waitcnt lgkmcnt(6)
  v_mfma_f32_16x16x32_bf16 v[40:43], v[64:67], v[80:83], v[40:43]
  s_waitcnt lgkmcnt(3)
  v_mfma_f32_16x16x32_bf16 v[40:43], v[68:71], v[84:87], v[40:43]
  s_waitcnt lgkmcnt(0)
  v_mfma_f32_16x16x32_bf16 v[40:43], v[72:75], v[88:91], v[40:43]
  s_nop 7
  v_bfi_b32 v40, v36, s55, v40
  v_bfi_b32 v41, v36, s56, v41
  v_bfi_b32 v42, v36, s69, v42
  v_bfi_b32 v43, v36, s54, v43
  buffer_store_dwordx4 v[40:43], v32, s[8:11], s42 offen sc1
  s_lshr_b32 s52, s2, 3
  s_mul_i32 s52, s52, 98304
  s_lshl_b32 s53, s44, 11
  s_add_u32 s52, s52, s53
  s_and_b32 s53, s2, 3
  s_lshl_b32 s53, s53, 9
  s_add_u32 s52, s52, s53
  s_add_u32 s52, s52, 3145728
  s_cmp_lt_u32 s44, 3
  s_cselect_b32 s52, s52, 1073741824
  v_lshrrev_b32 v43, 2, v0
  v_mul_u32_u24 v43, 5632, v43
  v_lshl_add_u32 v43, v0, 7, v43
  buffer_load_dword a252, v43, s[12:15], s52 offen
  s_bfe_u32 s53, s2, 0x30003
  s_lshl_b32 s43, s53, 1
  s_and_b32 s52, s2, 1
  s_add_u32 s43, s43, s52
  s_and_b32 s79, s2, 4
  s_lshr_b32 s52, s2, 6
  s_add_u32 s79, s79, s52
  s_lshl_b32 s79, s79, 1
  s_add_u32 s67, s79, s53
  s_bfe_u32 s52, s2, 0x10001
  s_add_u32 s79, s79, s52
  s_and_b32 s52, s44, 1
  s_add_u32 s52, s52, s67
  s_add_u32 s62, s52, 0
  s_and_b32 s62, s62, 7
  s_lshl_b32 s62, s62, 12
  s_add_u32 s63, s52, 2
  s_and_b32 s63, s63, 7
  s_lshl_b32 s63, s63, 12
  s_add_u32 s64, s52, 4
  s_and_b32 s64, s64, 7
  s_lshl_b32 s64, s64, 12
  s_add_u32 s65, s52, 6
  s_and_b32 s65, s65, 7
  s_lshl_b32 s65, s65, 12
  s_lshl_b32 s52, s43, 7
  v_add_u32 v10, s52, v10
  s_lshl_b32 s52, s79, 18
  s_lshr_b32 s53, s44, 1
  s_lshl_b32 s53, s53, 15
  s_add_u32 s53, s52, s53
  s_add_u32 s78, s53, 7340032
  s_and_b32 s53, s44, 1
  s_lshl_b32 s53, s53, 15
  s_add_u32 s52, s52, s53
  s_lshl_b32 s53, s43, 1
  s_lshr_b32 s57, s44, 1
  s_add_u32 s53, s53, s57
  s_lshl_b32 s76, s53, 7
  s_lshl_b32 s53, s53, 10
  s_add_u32 s47, s52, s53
  s_lshr_b32 s53, s53, 1
  s_lshl_b32 s52, s79, 1
  s_and_b32 s57, s44, 1
  s_add_u32 s52, s52, s57
  s_lshl_b32 s52, s52, 14
  s_add_u32 s52, s52, s53
  s_add_u32 s48, s52, 6291456
  s_lshl_b32 s52, s79, 11
  s_lshl_b32 s53, s43, 7
  s_add_u32 s53, s53, s52
  s_lshl_b32 s57, s44, 28
  s_add_u32 s53, s53, s57
  s_add_u32 s49, s53, 753664
  s_add_u32 s77, s52, 655360
  s_lshl_b32 s53, s44, 5
  v_lshlrev_b32 v31, 7, v21
  v_add_u32 v31, 159744, v31
  v_and_b32 v30, 8, v0
  v_lshl_add_u32 v30, v30, 1, v31
  v_add_u32 v30, s53, v30
  v_mov_b32 v108, 0x3f803f80
  v_mov_b32 v109, 0x3f803f80
  v_mov_b32 v110, 0x3f803f80
  v_mov_b32 v111, 0x3f803f80
  s_mov_b32 vcc_lo, 0xaaaaaaaa
  s_mov_b32 vcc_hi, 0xaaaaaaaa
  s_waitcnt vmcnt(7)
  v_mfma_f32_16x16x32_bf16 v[60:63], v[108:111], v[44:47], 0
  v_mfma_f32_16x16x32_bf16 v[64:67], v[44:47], v[44:47], 0
  v_mfma_f32_16x16x32_bf16 v[68:71], v[108:111], v[52:55], 0
  v_mfma_f32_16x16x32_bf16 v[72:75], v[52:55], v[52:55], 0
  v_mfma_f32_16x16x32_bf16 v[60:63], v[108:111], v[48:51], v[60:63]
  v_mfma_f32_16x16x32_bf16 v[64:67], v[48:51], v[48:51], v[64:67]
  v_mfma_f32_16x16x32_bf16 v[68:71], v[108:111], v[56:59], v[68:71]
  v_mfma_f32_16x16x32_bf16 v[72:75], v[56:59], v[56:59], v[72:75]
  s_waitcnt vmcnt(3)
  v_mfma_f32_16x16x32_bf16 v[60:63], v[108:111], v[92:95], v[60:63]
  v_mfma_f32_16x16x32_bf16 v[64:67], v[92:95], v[92:95], v[64:67]
  v_mfma_f32_16x16x32_bf16 v[68:71], v[108:111], v[100:103], v[68:71]
  v_mfma_f32_16x16x32_bf16 v[72:75], v[100:103], v[100:103], v[72:75]
  v_mfma_f32_16x16x32_bf16 v[60:63], v[108:111], v[96:99], v[60:63]
  v_mfma_f32_16x16x32_bf16 v[64:67], v[96:99], v[96:99], v[64:67]
  v_mfma_f32_16x16x32_bf16 v[68:71], v[108:111], v[104:107], v[68:71]
  v_mfma_f32_16x16x32_bf16 v[72:75], v[104:107], v[104:107], v[72:75]
  s_nop 4
  v_mov_b32 v36, v60
  v_cndmask_b32 v64, v64, v65, vcc
  v_cndmask_b32 v66, v66, v67, vcc
  v_mov_b32 v38, v68
  v_cndmask_b32 v72, v72, v73, vcc
  v_cndmask_b32 v74, v74, v75, vcc
  s_mov_b32 vcc_lo, 0xcccccccc
  s_mov_b32 vcc_hi, 0xcccccccc
  v_cndmask_b32 v37, v64, v66, vcc
  v_cndmask_b32 v39, v72, v74, vcc
  s_mov_b32 exec_lo, 0x00f0000f
  s_mov_b32 exec_hi, 0xf0000f00
  ds_write_b128 v30, v[36:39]
  s_mov_b64 exec, -1
  v_lshlrev_b32 v60, 16, v44
  v_and_b32 v61, 0xffff0000, v44
  v_lshlrev_b32 v62, 16, v45
  v_and_b32 v63, 0xffff0000, v45
  v_lshlrev_b32 v64, 16, v46
  v_and_b32 v65, 0xffff0000, v46
  v_lshlrev_b32 v66, 16, v47
  v_and_b32 v67, 0xffff0000, v47
  v_lshlrev_b32 v68, 16, v48
  v_and_b32 v69, 0xffff0000, v48
  v_lshlrev_b32 v70, 16, v49
  v_and_b32 v71, 0xffff0000, v49
  v_lshlrev_b32 v72, 16, v50
  v_and_b32 v73, 0xffff0000, v50
  v_lshlrev_b32 v74, 16, v51
  v_and_b32 v75, 0xffff0000, v51
  v_lshlrev_b32 v76, 16, v52
  v_and_b32 v77, 0xffff0000, v52
  v_lshlrev_b32 v78, 16, v53
  v_and_b32 v79, 0xffff0000, v53
  v_lshlrev_b32 v80, 16, v54
  v_and_b32 v81, 0xffff0000, v54
  v_lshlrev_b32 v82, 16, v55
  v_and_b32 v83, 0xffff0000, v55
  v_lshlrev_b32 v84, 16, v56
  v_and_b32 v85, 0xffff0000, v56
  v_lshlrev_b32 v86, 16, v57
  v_and_b32 v87, 0xffff0000, v57
  v_lshlrev_b32 v88, 16, v58
  v_and_b32 v89, 0xffff0000, v58
  v_lshlrev_b32 v90, 16, v59
  v_and_b32 v91, 0xffff0000, v59
  s_waitcnt lgkmcnt(0)
  s_barrier
  ds_read_b128 v[92:95], v31 offset:0
  ds_read_b128 v[96:99], v31 offset:16
  ds_read_b128 v[100:103], v31 offset:32
  ds_read_b128 v[104:107], v31 offset:48
  ds_read_b128 v[108:111], v31 offset:64
  ds_read_b128 v[112:115], v31 offset:80
  ds_read_b128 v[116:119], v31 offset:96
  ds_read_b128 v[120:123], v31 offset:112
  v_permlane16_swap_b32 v44, v46
  v_permlane16_swap_b32 v45, v47
  v_permlane16_swap_b32 v48, v50
  v_permlane16_swap_b32 v49, v51
  v_permlane16_swap_b32 v52, v54
  v_permlane16_swap_b32 v53, v55
  v_permlane16_swap_b32 v56, v58
  v_permlane16_swap_b32 v57, v59
  v_bfe_u32 v36, v0, 3, 1
  v_lshlrev_b32 v28, 9, v36
  v_bfe_u32 v36, v0, 4, 1
  v_lshl_add_u32 v28, v36, 8, v28
  v_lshrrev_b32 v34, 5, v0
  v_lshl_add_u32 v28, v34, 10, v28
  v_lshl_add_u32 v28, v21, 4, v28
  v_and_b32 v29, 31, v0
  v_lshlrev_b32 v29, 4, v29
  v_lshl_add_u32 v29, v34, 12, v29
  v_cvt_f32_u32 v34, v34
  s_add_u32 s53, s45, 151552
  v_add_u32 v32, s53, v1
  v_lshl_add_u32 v33, v22, 5, s53
  v_lshlrev_b32 v36, 14, v36
  v_and_b32 v35, 15, v0
  v_lshl_add_u32 v35, v35, 7, v36
  s_waitcnt lgkmcnt(0)
  v_pk_add_f32 v[92:93], v[92:93], v[108:109]
  v_pk_add_f32 v[94:95], v[94:95], v[110:111]
  v_pk_add_f32 v[96:97], v[96:97], v[112:113]
  v_pk_add_f32 v[98:99], v[98:99], v[114:115]
  v_pk_add_f32 v[100:101], v[100:101], v[116:117]
  v_pk_add_f32 v[102:103], v[102:103], v[118:119]
  v_pk_add_f32 v[104:105], v[104:105], v[120:121]
  v_pk_add_f32 v[106:107], v[106:107], v[122:123]
  v_pk_add_f32 v[92:93], v[92:93], v[100:101]
  v_pk_add_f32 v[94:95], v[94:95], v[102:103]
  v_pk_add_f32 v[96:97], v[96:97], v[104:105]
  v_pk_add_f32 v[98:99], v[98:99], v[106:107]
  v_pk_add_f32 v[92:93], v[92:93], v[96:97]
  v_pk_add_f32 v[94:95], v[94:95], v[98:99]
  v_mul_f32 v92, 0x3a800000, v92
  v_mul_f32 v94, 0x3a800000, v94
  v_mul_f32 v93, 0x3a800000, v93
  v_mul_f32 v95, 0x3a800000, v95
  v_fma_f32 v93, -v92, v92, v93
  v_fma_f32 v95, -v94, v94, v95
  v_max_f32 v93, 0, v93
  v_max_f32 v95, 0, v95
  v_cvt_pk_bf16_f32 v93, v93, v93
  v_cvt_pk_bf16_f32 v95, v95, v95
  v_lshlrev_b32 v93, 16, v93
  v_lshlrev_b32 v95, 16, v95
  v_add_f32 v93, 0x3727c5ac, v93
  v_add_f32 v95, 0x3727c5ac, v95
  v_cvt_pk_bf16_f32 v93, v93, v93
  v_cvt_pk_bf16_f32 v95, v95, v95
  v_lshlrev_b32 v93, 16, v93
  v_lshlrev_b32 v95, 16, v95
  v_sqrt_f32 v93, v93
  v_sqrt_f32 v95, v95
  v_cvt_pk_bf16_f32 v92, v92, v92
  v_cvt_pk_bf16_f32 v94, v94, v94
  v_lshlrev_b32 v92, 16, v92
  v_lshlrev_b32 v94, 16, v94
  v_cvt_pk_bf16_f32 v93, v93, v93
  v_cvt_pk_bf16_f32 v95, v95, v95
  v_lshlrev_b32 v93, 16, v93
  v_lshlrev_b32 v95, 16, v95
  v_rcp_f32 v93, v93
  v_rcp_f32 v95, v95
  v_mul_f32 v92, v92, v93
  v_mul_f32 v94, v94, v95
  v_fma_f32 v60, v60, v93, -v92
  v_fma_f32 v61, v61, v93, -v92
  v_fma_f32 v62, v62, v93, -v92
  v_fma_f32 v63, v63, v93, -v92
  v_fma_f32 v64, v64, v93, -v92
  v_fma_f32 v65, v65, v93, -v92
  v_fma_f32 v66, v66, v93, -v92
  v_fma_f32 v67, v67, v93, -v92
  v_fma_f32 v68, v68, v93, -v92
  v_fma_f32 v69, v69, v93, -v92
  v_fma_f32 v70, v70, v93, -v92
  v_fma_f32 v71, v71, v93, -v92
  v_fma_f32 v72, v72, v93, -v92
  v_fma_f32 v73, v73, v93, -v92
  v_fma_f32 v74, v74, v93, -v92
  v_fma_f32 v75, v75, v93, -v92
  v_fma_f32 v76, v76, v95, -v94
  v_fma_f32 v77, v77, v95, -v94
  v_fma_f32 v78, v78, v95, -v94
  v_fma_f32 v79, v79, v95, -v94
  v_fma_f32 v80, v80, v95, -v94
  v_fma_f32 v81, v81, v95, -v94
  v_fma_f32 v82, v82, v95, -v94
  v_fma_f32 v83, v83, v95, -v94
  v_fma_f32 v84, v84, v95, -v94
  v_fma_f32 v85, v85, v95, -v94
  v_fma_f32 v86, v86, v95, -v94
  v_fma_f32 v87, v87, v95, -v94
  v_fma_f32 v88, v88, v95, -v94
  v_fma_f32 v89, v89, v95, -v94
  v_fma_f32 v90, v90, v95, -v94
  v_fma_f32 v91, v91, v95, -v94
  s_waitcnt vmcnt(11)
  v_lshlrev_b32 v15, 16, v23
  v_mul_f32 v16, 0xbfb8aa3b, v15
  v_exp_f32 v16, v16
  v_lshrrev_b32 v21, 5, v0
  v_add_f32 v16, 1.0, v16
  v_rcp_f32 v16, v16
  v_lshlrev_b32 v21, 6, v21
  v_mul_f32 v15, v15, v16
  v_cvt_pk_bf16_f32 v16, v15, v15
  v_bfe_u32 v15, v0, 2, 2
  v_lshl_add_u32 v21, v15, 4, v21
  v_bfe_u32 v15, v0, 4, 1
  v_lshl_add_u32 v21, v15, 3, v21
  v_and_b32 v15, 3, v0
  v_lshl_add_u32 v21, v15, 1, v21
  s_lshl_b32 s53, s44, 7
  s_add_u32 s53, s53, 160768
  v_add_u32 v21, s53, v21
  s_mov_b64 exec, 0
  s_cmp_eq_u32 s44, 0
  s_cbranch_scc1 HOP0
  s_cmp_eq_u32 s44, 1
  s_cbranch_scc1 HOP1
  s_cmp_eq_u32 s44, 2
  s_cbranch_scc1 HOP2
  s_cmp_eq_u32 s44, 3
  s_cbranch_scc1 HOP3
WRET0:
  s_mov_b64 exec, -1
  s_add_u32 m0, s45, 0
  s_add_u32 s68, s66, 0
  s_and_b32 s68, s68, 7
  s_mul_i32 s68, s68, 786432
  buffer_load_dwordx4 v9, s[12:15], s68 offen lds
  s_add_u32 m0, s45, 4096
  s_add_u32 s68, s68, 196608
  buffer_load_dwordx4 v9, s[12:15], s68 offen lds
  s_add_u32 m0, s45, 8192
  s_add_u32 s68, s68, 196608
  buffer_load_dwordx4 v9, s[12:15], s68 offen lds
  s_add_u32 m0, s45, 12288
  s_add_u32 s68, s68, 196608
  buffer_load_dwordx4 v9, s[12:15], s68 offen lds
  s_add_u32 m0, s45, 16384
  s_add_u32 s68, s66, 1
  s_and_b32 s68, s68, 7
  s_mul_i32 s68, s68, 786432
  buffer_load_dwordx4 v9, s[12:15], s68 offen lds
  s_add_u32 m0, s45, 20480
  s_add_u32 s68, s68, 196608
  buffer_load_dwordx4 v9, s[12:15], s68 offen lds
  s_add_u32 m0, s45, 24576
  s_add_u32 s68, s68, 196608
  buffer_load_dwordx4 v9, s[12:15], s68 offen lds
  s_add_u32 m0, s45, 28672
  s_add_u32 s68, s68, 196608
  buffer_load_dwordx4 v9, s[12:15], s68 offen lds
  s_add_u32 s52, s34, 0
  buffer_load_dwordx4 v[92:95], v29, s[8:11], s52 offen sc1
  s_add_u32 s52, s34, 8192
  buffer_load_dwordx4 v[96:99], v29, s[8:11], s52 offen sc1
  s_add_u32 s52, s34, 16384
  buffer_load_dwordx4 v[100:103], v29, s[8:11], s52 offen sc1
  s_add_u32 s52, s34, 24576
  buffer_load_dwordx4 v[104:107], v29, s[8:11], s52 offen sc1
  s_add_u32 s52, s34, 32768
  buffer_load_dwordx4 v[108:111], v29, s[8:11], s52 offen sc1
  s_add_u32 s52, s34, 40960
  buffer_load_dwordx4 v[112:115], v29, s[8:11], s52 offen sc1
  s_add_u32 s52, s34, 49152
  buffer_load_dwordx4 v[116:119], v29, s[8:11], s52 offen sc1
  s_add_u32 s52, s34, 57344
  buffer_load_dwordx4 v[120:123], v29, s[8:11], s52 offen sc1
  s_add_u32 m0, s45, 32768
  s_add_u32 s68, s66, 0
  s_and_b32 s68, s68, 7
  s_mul_i32 s68, s68, 786432
  s_add_u32 s68, s68, 2048
  buffer_load_dwordx4 v9, s[12:15], s68 offen lds
  s_add_u32 m0, s45, 36864
  s_add_u32 s68, s68, 196608
  buffer_load_dwordx4 v9, s[12:15], s68 offen lds
  s_add_u32 m0, s45, 40960
  s_add_u32 s68, s68, 196608
  buffer_load_dwordx4 v9, s[12:15], s68 offen lds
  s_add_u32 m0, s45, 45056
  s_add_u32 s68, s68, 196608
  buffer_load_dwordx4 v9, s[12:15], s68 offen lds
  s_add_u32 m0, s45, 49152
  s_add_u32 s68, s66, 0
  s_and_b32 s68, s68, 7
  s_mul_i32 s68, s68, 786432
  s_add_u32 s68, s68, 4096
  buffer_load_dwordx4 v9, s[12:15], s68 offen lds
  s_add_u32 m0, s45, 53248
  s_add_u32 s68, s68, 196608
  buffer_load_dwordx4 v9, s[12:15], s68 offen lds
  s_add_u32 m0, s45, 57344
  s_add_u32 s68, s68, 196608
  buffer_load_dwordx4 v9, s[12:15], s68 offen lds
  s_add_u32 m0, s45, 61440
  s_add_u32 s68, s68, 196608
  buffer_load_dwordx4 v9, s[12:15], s68 offen lds
  s_mov_b32 s57, 20000
  s_branch MT2_adaLN_cond__sliding_local_dilated__swiglu_ffn__prompt_kernelt
MT2_adaLN_cond__sliding_local_dilated__swiglu_ffn__prompt_kernel:
  s_add_u32 s52, s34, 0
  buffer_load_dwordx4 v[92:95], v29, s[8:11], s52 offen sc1
  s_add_u32 s52, s34, 8192
  buffer_load_dwordx4 v[96:99], v29, s[8:11], s52 offen sc1
  s_add_u32 s52, s34, 16384
  buffer_load_dwordx4 v[100:103], v29, s[8:11], s52 offen sc1
  s_add_u32 s52, s34, 24576
  buffer_load_dwordx4 v[104:107], v29, s[8:11], s52 offen sc1
  s_add_u32 s52, s34, 32768
  buffer_load_dwordx4 v[108:111], v29, s[8:11], s52 offen sc1
  s_add_u32 s52, s34, 40960
  buffer_load_dwordx4 v[112:115], v29, s[8:11], s52 offen sc1
  s_add_u32 s52, s34, 49152
  buffer_load_dwordx4 v[116:119], v29, s[8:11], s52 offen sc1
  s_add_u32 s52, s34, 57344
  buffer_load_dwordx4 v[120:123], v29, s[8:11], s52 offen sc1
  s_waitcnt vmcnt(0)
MT2_adaLN_cond__sliding_local_dilated__swiglu_ffn__prompt_kernelt:
  s_waitcnt vmcnt(15)
  v_xor_b32 v92, s55, v92
  v_xor_b32 v93, s56, v93
  v_xor_b32 v94, s69, v94
  v_xor_b32 v95, s54, v95
  v_or3_b32 v36, v92, v93, 0
  v_or3_b32 v36, v94, v95, v36
  s_waitcnt vmcnt(14)
  v_xor_b32 v96, s55, v96
  v_xor_b32 v97, s56, v97
  v_xor_b32 v98, s69, v98
  v_xor_b32 v99, s54, v99
  v_or3_b32 v36, v96, v97, v36
  v_or3_b32 v36, v98, v99, v36
  s_waitcnt vmcnt(13)
  v_xor_b32 v100, s55, v100
  v_xor_b32 v101, s56, v101
  v_xor_b32 v102, s69, v102
  v_xor_b32 v103, s54, v103
  v_or3_b32 v36, v100, v101, v36
  v_or3_b32 v36, v102, v103, v36
  s_waitcnt vmcnt(12)
  v_xor_b32 v104, s55, v104
  v_xor_b32 v105, s56, v105
  v_xor_b32 v106, s69, v106
  v_xor_b32 v107, s54, v107
  v_or3_b32 v36, v104, v105, v36
  v_or3_b32 v36, v106, v107, v36
  s_waitcnt vmcnt(11)
  v_xor_b32 v108, s55, v108
  v_xor_b32 v109, s56, v109
  v_xor_b32 v110, s69, v110
  v_xor_b32 v111, s54, v111
  v_or3_b32 v36, v108, v109, v36
  v_or3_b32 v36, v110, v111, v36
  s_waitcnt vmcnt(10)
  v_xor_b32 v112, s55, v112
  v_xor_b32 v113, s56, v113
  v_xor_b32 v114, s69, v114
  v_xor_b32 v115, s54, v115
  v_or3_b32 v36, v112, v113, v36
  v_or3_b32 v36, v114, v115, v36
  s_waitcnt vmcnt(9)
  v_xor_b32 v116, s55, v116
  v_xor_b32 v117, s56, v117
  v_xor_b32 v118, s69, v118
  v_xor_b32 v119, s54, v119
  v_or3_b32 v36, v116, v117, v36
  v_or3_b32 v36, v118, v119, v36
  s_waitcnt vmcnt(8)
  v_xor_b32 v120, s55, v120
  v_xor_b32 v121, s56, v121
  v_xor_b32 v122, s69, v122
  v_xor_b32 v123, s54, v123
  v_or3_b32 v36, v120, v121, v36
  v_or3_b32 v36, v122, v123, v36
  v_and_b32 v36, 0xff, v36
  v_cmp_ne_u32 vcc, 0, v36
  s_sub_u32 s57, s57, 1
  s_cmp_eq_u32 s57, 0
  s_cbranch_scc1 MT2_adaLN_cond__sliding_local_dilated__swiglu_ffn__prompt_kernelx
  s_nop 1
  s_cbranch_vccnz MT2_adaLN_cond__sliding_local_dilated__swiglu_ffn__prompt_kernel
MT2_adaLN_cond__sliding_local_dilated__swiglu_ffn__prompt_kernelx:
  s_waitcnt vmcnt(14)
  v_pk_add_f32 v[92:93], v[92:93], v[96:97]
  v_pk_add_f32 v[94:95], v[94:95], v[98:99]
  s_waitcnt vmcnt(13)
  v_pk_add_f32 v[92:93], v[92:93], v[100:101]
  v_pk_add_f32 v[94:95], v[94:95], v[102:103]
  s_waitcnt vmcnt(12)
  v_pk_add_f32 v[92:93], v[92:93], v[104:105]
  v_pk_add_f32 v[94:95], v[94:95], v[106:107]
  s_waitcnt vmcnt(11)
  v_pk_add_f32 v[92:93], v[92:93], v[108:109]
  v_pk_add_f32 v[94:95], v[94:95], v[110:111]
HOP0:
  s_cbranch_execz HOP4
  s_waitcnt vmcnt(10)
  v_pk_add_f32 v[92:93], v[92:93], v[112:113]
  v_pk_add_f32 v[94:95], v[94:95], v[114:115]
  s_waitcnt vmcnt(9)
  v_pk_add_f32 v[92:93], v[92:93], v[116:117]
  v_pk_add_f32 v[94:95], v[94:95], v[118:119]
  s_waitcnt vmcnt(8)
  v_pk_add_f32 v[92:93], v[92:93], v[120:121]
  v_pk_add_f32 v[94:95], v[94:95], v[122:123]
  v_cvt_pk_bf16_f32 v96, v92, v93
  v_cvt_pk_bf16_f32 v97, v94, v95
  v_lshlrev_b32 v92, 16, v96
  v_and_b32 v93, 0xffff0000, v96
  v_lshlrev_b32 v94, 16, v97
  v_and_b32 v95, 0xffff0000, v97
  v_add_f32 v92, v34, v92
  v_add_f32 v93, v34, v93
  v_add_f32 v94, v34, v94
  v_add_f32 v95, v34, v95
  v_cvt_pk_bf16_f32 v96, v92, v93
  v_cvt_pk_bf16_f32 v97, v94, v95
  v_lshlrev_b32 v92, 16, v96
  v_and_b32 v93, 0xffff0000, v96
  v_lshlrev_b32 v94, 16, v97
  v_and_b32 v95, 0xffff0000, v97
  ds_write_b128 v32, v[92:95]
  ds_read_b128 v[92:95], v33 offset:512
  ds_read_b128 v[108:111], v33 offset:0
  ds_read_b128 v[96:99], v33 offset:528
  ds_read_b128 v[112:115], v33 offset:16
  ds_read_b128 v[100:103], v33 offset:768
  ds_read_b128 v[116:119], v33 offset:256
  ds_read_b128 v[104:107], v33 offset:784
  ds_read_b128 v[120:123], v33 offset:272
  s_waitcnt lgkmcnt(4)
  v_pk_fma_f32 v[60:61], v[60:61], v[92:93], v[108:109]
  v_pk_fma_f32 v[62:63], v[62:63], v[94:95], v[110:111]
  v_pk_fma_f32 v[64:65], v[64:65], v[96:97], v[112:113]
  v_pk_fma_f32 v[66:67], v[66:67], v[98:99], v[114:115]
  v_pk_fma_f32 v[76:77], v[76:77], v[92:93], v[108:109]
  v_pk_fma_f32 v[78:79], v[78:79], v[94:95], v[110:111]
  v_pk_fma_f32 v[80:81], v[80:81], v[96:97], v[112:113]
  v_pk_fma_f32 v[82:83], v[82:83], v[98:99], v[114:115]
  v_cvt_pk_bf16_f32 v60, v60, v61
  v_cvt_pk_bf16_f32 v61, v62, v63
  v_cvt_pk_bf16_f32 v62, v64, v65
  v_cvt_pk_bf16_f32 v63, v66, v67
  v_cvt_pk_bf16_f32 v76, v76, v77
  v_cvt_pk_bf16_f32 v77, v78, v79
  v_cvt_pk_bf16_f32 v78, v80, v81
  v_cvt_pk_bf16_f32 v79, v82, v83
  v_permlane16_swap_b32 v60, v62
  v_permlane16_swap_b32 v61, v63
  buffer_store_dwordx4 v[60:63], v28, s[8:11], s38 offen offset:0 sc1
  v_permlane16_swap_b32 v76, v78
  v_permlane16_swap_b32 v77, v79
  buffer_store_dwordx4 v[76:79], v28, s[8:11], s38 offen offset:128 sc1
  s_waitcnt lgkmcnt(0)
  v_pk_fma_f32 v[68:69], v[68:69], v[100:101], v[116:117]
  v_pk_fma_f32 v[70:71], v[70:71], v[102:103], v[118:119]
  v_pk_fma_f32 v[72:73], v[72:73], v[104:105], v[120:121]
  v_pk_fma_f32 v[74:75], v[74:75], v[106:107], v[122:123]
  v_pk_fma_f32 v[84:85], v[84:85], v[100:101], v[116:117]
  v_pk_fma_f32 v[86:87], v[86:87], v[102:103], v[118:119]
  v_pk_fma_f32 v[88:89], v[88:89], v[104:105], v[120:121]
  v_pk_fma_f32 v[90:91], v[90:91], v[106:107], v[122:123]
  v_cvt_pk_bf16_f32 v68, v68, v69
  v_cvt_pk_bf16_f32 v69, v70, v71
  v_cvt_pk_bf16_f32 v70, v72, v73
  v_cvt_pk_bf16_f32 v71, v74, v75
  v_cvt_pk_bf16_f32 v84, v84, v85
  v_cvt_pk_bf16_f32 v85, v86, v87
  v_cvt_pk_bf16_f32 v86, v88, v89
  v_cvt_pk_bf16_f32 v87, v90, v91
  v_permlane16_swap_b32 v68, v70
  v_permlane16_swap_b32 v69, v71
  buffer_store_dwordx4 v[68:71], v28, s[8:11], s38 offen offset:2048 sc1
  v_permlane16_swap_b32 v84, v86
  v_permlane16_swap_b32 v85, v87
  buffer_store_dwordx4 v[84:87], v28, s[8:11], s38 offen offset:2176 sc1
  buffer_store_dwordx4 v[44:47], v28, s[8:11], s39 offen offset:0 sc1
  buffer_store_dwordx4 v[48:51], v28, s[8:11], s39 offen offset:2048 sc1
  buffer_store_dwordx4 v[52:55], v28, s[8:11], s39 offen offset:128 sc1
  buffer_store_dwordx4 v[56:59], v28, s[8:11], s39 offen offset:2176 sc1
  s_add_u32 m0, s45, 65536
  s_add_u32 s68, s66, 1
  s_and_b32 s68, s68, 7
  s_mul_i32 s68, s68, 786432
  s_add_u32 s68, s68, 2048
  buffer_load_dwordx4 v9, s[12:15], s68 offen lds
  s_add_u32 m0, s45, 69632
  s_add_u32 s68, s68, 196608
  buffer_load_dwordx4 v9, s[12:15], s68 offen lds
  s_add_u32 m0, s45, 73728
  s_add_u32 s68, s68, 196608
  buffer_load_dwordx4 v9, s[12:15], s68 offen lds
  s_add_u32 m0, s45, 77824
  s_add_u32 s68, s68, 196608
  buffer_load_dwordx4 v9, s[12:15], s68 offen lds
  s_add_u32 m0, s45, 81920
  s_add_u32 s68, s66, 1
  s_and_b32 s68, s68, 7
  s_mul_i32 s68, s68, 786432
  s_add_u32 s68, s68, 4096
  buffer_load_dwordx4 v9, s[12:15], s68 offen lds
  s_add_u32 m0, s45, 86016
  s_add_u32 s68, s68, 196608
  buffer_load_dwordx4 v9, s[12:15], s68 offen lds
  s_add_u32 m0, s45, 90112
  s_add_u32 s68, s68, 196608
  buffer_load_dwordx4 v9, s[12:15], s68 offen lds
  s_add_u32 m0, s45, 94208
  s_add_u32 s68, s68, 196608
  buffer_load_dwordx4 v9, s[12:15], s68 offen lds
  v_add_u32 v15, s46, v0
  s_waitcnt vmcnt(12)
  s_barrier
  s_mov_b64 exec, 1
  buffer_store_dword v15, v0, s[8:11], s75 offen offset:0 sc1
  s_mov_b64 exec, -1
  s_waitcnt vmcnt(33) lgkmcnt(0)
  s_barrier
  s_add_u32 m0, s45, 98304
  s_add_u32 s68, s66, 2
  s_and_b32 s68, s68, 7
  s_mul_i32 s68, s68, 786432
  buffer_load_dwordx4 v9, s[12:15], s68 offen lds
  ds_read_b64_tr_b16 a[0:1], v3 offset:0
  ds_read_b64_tr_b16 a[2:3], v3 offset:2048
  s_add_u32 m0, s45, 102400
  s_add_u32 s68, s68, 196608
  buffer_load_dwordx4 v9, s[12:15], s68 offen lds
  ds_read_b64_tr_b16 a[12:13], v3 offset:4096
  ds_read_b64_tr_b16 a[14:15], v3 offset:6144
  s_add_u32 m0, s45, 106496
  s_add_u32 s68, s68, 196608
  buffer_load_dwordx4 v9, s[12:15], s68 offen lds
  ds_read_b64_tr_b16 a[24:25], v3 offset:8192
  ds_read_b64_tr_b16 a[26:27], v3 offset:10240
  s_add_u32 m0, s45, 110592
  s_add_u32 s68, s68, 196608
  buffer_load_dwordx4 v9, s[12:15], s68 offen lds
  ds_read_b64_tr_b16 a[36:37], v3 offset:12288
  ds_read_b64_tr_b16 a[38:39], v3 offset:14336
  s_add_u32 m0, s45, 114688
  s_add_u32 s68, s66, 3
  s_and_b32 s68, s68, 7
  s_mul_i32 s68, s68, 786432
  buffer_load_dwordx4 v9, s[12:15], s68 offen lds
  ds_read_b64_tr_b16 a[48:49], v3 offset:16384
  ds_read_b64_tr_b16 a[50:51], v3 offset:18432
  s_add_u32 m0, s45, 118784
  s_add_u32 s68, s68, 196608
  buffer_load_dwordx4 v9, s[12:15], s68 offen lds
  ds_read_b64_tr_b16 a[60:61], v3 offset:20480
  ds_read_b64_tr_b16 a[62:63], v3 offset:22528
  s_add_u32 m0, s45, 122880
  s_add_u32 s68, s68, 196608
  buffer_load_dwordx4 v9, s[12:15], s68 offen lds
  ds_read_b64_tr_b16 a[72:73], v3 offset:24576
  ds_read_b64_tr_b16 a[74:75], v3 offset:26624
  s_add_u32 m0, s45, 126976
  s_add_u32 s68, s68, 196608
  buffer_load_dwordx4 v9, s[12:15], s68 offen lds
  ds_read_b64_tr_b16 a[84:85], v3 offset:28672
  ds_read_b64_tr_b16 a[86:87], v3 offset:30720
  s_waitcnt vmcnt(25) lgkmcnt(0)
  s_barrier
  s_add_u32 m0, s45, 0
  s_add_u32 s68, s66, 2
  s_and_b32 s68, s68, 7
  s_mul_i32 s68, s68, 786432
  s_add_u32 s68, s68, 2048
  buffer_load_dwordx4 v9, s[12:15], s68 offen lds
  ds_read_b64_tr_b16 a[4:5], v4 offset:32768
  ds_read_b64_tr_b16 a[6:7], v4 offset:34816
  s_add_u32 m0, s45, 4096
  s_add_u32 s68, s68, 196608
  buffer_load_dwordx4 v9, s[12:15], s68 offen lds
  ds_read_b64_tr_b16 a[8:9], v5 offset:32768
  ds_read_b64_tr_b16 a[10:11], v5 offset:34816
  s_add_u32 m0, s45, 8192
  s_add_u32 s68, s68, 196608
  buffer_load_dwordx4 v9, s[12:15], s68 offen lds
  ds_read_b64_tr_b16 a[16:17], v4 offset:36864
  ds_read_b64_tr_b16 a[18:19], v4 offset:38912
  s_add_u32 m0, s45, 12288
  s_add_u32 s68, s68, 196608
  buffer_load_dwordx4 v9, s[12:15], s68 offen lds
  ds_read_b64_tr_b16 a[20:21], v5 offset:36864
  ds_read_b64_tr_b16 a[22:23], v5 offset:38912
  s_add_u32 m0, s45, 16384
  s_add_u32 s68, s66, 2
  s_and_b32 s68, s68, 7
  s_mul_i32 s68, s68, 786432
  s_add_u32 s68, s68, 4096
  buffer_load_dwordx4 v9, s[12:15], s68 offen lds
  ds_read_b64_tr_b16 a[28:29], v4 offset:40960
  ds_read_b64_tr_b16 a[30:31], v4 offset:43008
  s_add_u32 m0, s45, 20480
  s_add_u32 s68, s68, 196608
  buffer_load_dwordx4 v9, s[12:15], s68 offen lds
  ds_read_b64_tr_b16 a[32:33], v5 offset:40960
  ds_read_b64_tr_b16 a[34:35], v5 offset:43008
  s_add_u32 m0, s45, 24576
  s_add_u32 s68, s68, 196608
  buffer_load_dwordx4 v9, s[12:15], s68 offen lds
  ds_read_b64_tr_b16 a[40:41], v4 offset:45056
  ds_read_b64_tr_b16 a[42:43], v4 offset:47104
  s_add_u32 m0, s45, 28672
  s_add_u32 s68, s68, 196608
  buffer_load_dwordx4 v9, s[12:15], s68 offen lds
  ds_read_b64_tr_b16 a[44:45], v5 offset:45056
  ds_read_b64_tr_b16 a[46:47], v5 offset:47104
  s_waitcnt vmcnt(17) lgkmcnt(0)
  s_barrier
  s_add_u32 m0, s45, 32768
  s_add_u32 s68, s66, 3
  s_and_b32 s68, s68, 7
  s_mul_i32 s68, s68, 786432
  s_add_u32 s68, s68, 2048
  buffer_load_dwordx4 v9, s[12:15], s68 offen lds
  ds_read_b64_tr_b16 a[52:53], v7 offset:0
  ds_read_b64_tr_b16 a[54:55], v7 offset:2048
  s_add_u32 m0, s45, 36864
  s_add_u32 s68, s68, 196608
  buffer_load_dwordx4 v9, s[12:15], s68 offen lds
  ds_read_b64_tr_b16 a[56:57], v8 offset:0
  ds_read_b64_tr_b16 a[58:59], v8 offset:2048
  s_add_u32 m0, s45, 40960
  s_add_u32 s68, s68, 196608
  buffer_load_dwordx4 v9, s[12:15], s68 offen lds
  ds_read_b64_tr_b16 a[64:65], v7 offset:4096
  ds_read_b64_tr_b16 a[66:67], v7 offset:6144
  s_add_u32 m0, s45, 45056
  s_add_u32 s68, s68, 196608
  buffer_load_dwordx4 v9, s[12:15], s68 offen lds
  ds_read_b64_tr_b16 a[68:69], v8 offset:4096
  ds_read_b64_tr_b16 a[70:71], v8 offset:6144
  s_add_u32 m0, s45, 49152
  s_add_u32 s68, s66, 3
  s_and_b32 s68, s68, 7
  s_mul_i32 s68, s68, 786432
  s_add_u32 s68, s68, 4096
  buffer_load_dwordx4 v9, s[12:15], s68 offen lds
  ds_read_b64_tr_b16 a[76:77], v7 offset:8192
  ds_read_b64_tr_b16 a[78:79], v7 offset:10240
  s_add_u32 m0, s45, 53248
  s_add_u32 s68, s68, 196608
  buffer_load_dwordx4 v9, s[12:15], s68 offen lds
  ds_read_b64_tr_b16 a[80:81], v8 offset:8192
  ds_read_b64_tr_b16 a[82:83], v8 offset:10240
  s_add_u32 m0, s45, 57344
  s_add_u32 s68, s68, 196608
  buffer_load_dwordx4 v9, s[12:15], s68 offen lds
  ds_read_b64_tr_b16 a[88:89], v7 offset:12288
  ds_read_b64_tr_b16 a[90:91], v7 offset:14336
  s_add_u32 m0, s45, 61440
  s_add_u32 s68, s68, 196608
  buffer_load_dwordx4 v9, s[12:15], s68 offen lds
  ds_read_b64_tr_b16 a[92:93], v8 offset:12288
  ds_read_b64_tr_b16 a[94:95], v8 offset:14336
  s_lshl_b32 s57, s44, 28
  buffer_load_dword v36, v14, s[8:11], s57 offen sc1
  s_waitcnt vmcnt(17) lgkmcnt(0)
  s_barrier
  s_add_u32 m0, s45, 65536
  s_add_u32 s68, s66, 4
  s_and_b32 s68, s68, 7
  s_mul_i32 s68, s68, 786432
  buffer_load_dwordx4 v9, s[12:15], s68 offen lds
  ds_read_b64_tr_b16 a[96:97], v6 offset:32768
  ds_read_b64_tr_b16 a[98:99], v6 offset:34816
  s_add_u32 m0, s45, 69632
  s_add_u32 s68, s68, 196608
  buffer_load_dwordx4 v9, s[12:15], s68 offen lds
  ds_read_b64_tr_b16 a[108:109], v6 offset:36864
  ds_read_b64_tr_b16 a[110:111], v6 offset:38912
  s_add_u32 m0, s45, 73728
  s_add_u32 s68, s68, 196608
  buffer_load_dwordx4 v9, s[12:15], s68 offen lds
  ds_read_b64_tr_b16 a[120:121], v6 offset:40960
  ds_read_b64_tr_b16 a[122:123], v6 offset:43008
  s_add_u32 m0, s45, 77824
  s_add_u32 s68, s68, 196608
  buffer_load_dwordx4 v9, s[12:15], s68 offen lds
  ds_read_b64_tr_b16 a[132:133], v6 offset:45056
  ds_read_b64_tr_b16 a[134:135], v6 offset:47104
  s_add_u32 m0, s45, 81920
  s_add_u32 s68, s66, 5
  s_and_b32 s68, s68, 7
  s_mul_i32 s68, s68, 786432
  buffer_load_dwordx4 v9, s[12:15], s68 offen lds
  ds_read_b64_tr_b16 a[144:145], v6 offset:49152
  ds_read_b64_tr_b16 a[146:147], v6 offset:51200
  s_add_u32 m0, s45, 86016
  s_add_u32 s68, s68, 196608
  buffer_load_dwordx4 v9, s[12:15], s68 offen lds
  ds_read_b64_tr_b16 a[156:157], v6 offset:53248
  ds_read_b64_tr_b16 a[158:159], v6 offset:55296
  s_add_u32 m0, s45, 90112
  s_add_u32 s68, s68, 196608
  buffer_load_dwordx4 v9, s[12:15], s68 offen lds
  ds_read_b64_tr_b16 a[168:169], v6 offset:57344
  ds_read_b64_tr_b16 a[170:171], v6 offset:59392
  s_add_u32 m0, s45, 94208
  s_add_u32 s68, s68, 196608
  buffer_load_dwordx4 v9, s[12:15], s68 offen lds
  ds_read_b64_tr_b16 a[180:181], v6 offset:61440
  ds_read_b64_tr_b16 a[182:183], v6 offset:63488
  s_waitcnt vmcnt(17) lgkmcnt(0)
  s_barrier
  ds_read_b64_tr_b16 a[100:101], v4 offset:0
  ds_read_b64_tr_b16 a[102:103], v4 offset:2048
  ds_read_b64_tr_b16 a[104:105], v5 offset:0
  ds_read_b64_tr_b16 a[106:107], v5 offset:2048
  ds_read_b64_tr_b16 a[112:113], v4 offset:4096
  ds_read_b64_tr_b16 a[114:115], v4 offset:6144
  ds_read_b64_tr_b16 a[116:117], v5 offset:4096
  ds_read_b64_tr_b16 a[118:119], v5 offset:6144
  ds_read_b64_tr_b16 a[124:125], v4 offset:8192
  ds_read_b64_tr_b16 a[126:127], v4 offset:10240
  ds_read_b64_tr_b16 a[128:129], v5 offset:8192
  ds_read_b64_tr_b16 a[130:131], v5 offset:10240
  ds_read_b64_tr_b16 a[136:137], v4 offset:12288
  ds_read_b64_tr_b16 a[138:139], v4 offset:14336
  ds_read_b64_tr_b16 a[140:141], v5 offset:12288
  ds_read_b64_tr_b16 a[142:143], v5 offset:14336
  s_waitcnt vmcnt(8)
  s_cmp_lg_u32 s44, 0
  s_cbranch_scc1 PL3_adaLN_cond__sliding_local_dilated__swiglu_ffn__prompt_kernelx
  v_cmp_ne_u32 vcc, s46, v36
  s_nop 4
  s_cbranch_vccz PL3_adaLN_cond__sliding_local_dilated__swiglu_ffn__prompt_kernelx
  s_mov_b32 s57, 60000
PL3_adaLN_cond__sliding_local_dilated__swiglu_ffn__prompt_kernel:
  buffer_load_dword v36, v14, s[8:11], 0 offen sc1
  s_sub_u32 s57, s57, 1
  s_cmp_eq_u32 s57, 0
  s_waitcnt vmcnt(0)
  s_cbranch_scc1 PL3_adaLN_cond__sliding_local_dilated__swiglu_ffn__prompt_kernelx
  v_cmp_ne_u32 vcc, s46, v36
  s_nop 4
  s_cbranch_vccnz PL3_adaLN_cond__sliding_local_dilated__swiglu_ffn__prompt_kernel
PL3_adaLN_cond__sliding_local_dilated__swiglu_ffn__prompt_kernelx:
  s_barrier
  s_add_u32 m0, s70, 98304
  s_add_u32 s69, s58, 32768
  buffer_load_dwordx4 v12, s[8:11], s69 offen offset:0 sc1 lds
  buffer_load_dwordx4 v12, s[8:11], s69 offen offset:1024 sc1 lds
  buffer_load_dwordx4 v12, s[8:11], s69 offen offset:2048 sc1 lds
  buffer_load_dwordx4 v12, s[8:11], s69 offen offset:3072 sc1 lds
  s_add_u32 m0, s71, 131072
  s_add_u32 s69, s58, s72
  buffer_load_dwordx4 v1, s[8:11], s69 offen offset:0 sc1 lds
  buffer_load_dwordx4 v1, s[8:11], s69 offen offset:1024 sc1 lds
  s_add_u32 m0, s70, 114688
  s_add_u32 s69, s59, 32768
  buffer_load_dwordx4 v12, s[8:11], s69 offen offset:0 sc1 lds
  buffer_load_dwordx4 v12, s[8:11], s69 offen offset:1024 sc1 lds
  buffer_load_dwordx4 v12, s[8:11], s69 offen offset:2048 sc1 lds
  buffer_load_dwordx4 v12, s[8:11], s69 offen offset:3072 sc1 lds
  s_add_u32 m0, s71, 139264
  s_add_u32 s69, s59, s72
  buffer_load_dwordx4 v1, s[8:11], s69 offen offset:0 sc1 lds
  buffer_load_dwordx4 v1, s[8:11], s69 offen offset:1024 sc1 lds
  s_waitcnt vmcnt(21) lgkmcnt(0)
  s_barrier
  s_add_u32 m0, s45, 0
  s_add_u32 s68, s66, 4
  s_and_b32 s68, s68, 7
  s_mul_i32 s68, s68, 786432
  s_add_u32 s68, s68, 2048
  buffer_load_dwordx4 v9, s[12:15], s68 offen lds
  ds_read_b64_tr_b16 a[148:149], v4 offset:32768
  ds_read_b64_tr_b16 a[150:151], v4 offset:34816
  s_add_u32 m0, s45, 4096
  s_add_u32 s68, s68, 196608
  buffer_load_dwordx4 v9, s[12:15], s68 offen lds
  ds_read_b64_tr_b16 a[152:153], v5 offset:32768
  ds_read_b64_tr_b16 a[154:155], v5 offset:34816
  s_add_u32 m0, s45, 8192
  s_add_u32 s68, s68, 196608
  buffer_load_dwordx4 v9, s[12:15], s68 offen lds
  ds_read_b64_tr_b16 a[160:161], v4 offset:36864
  ds_read_b64_tr_b16 a[162:163], v4 offset:38912
  s_add_u32 m0, s45, 12288
  s_add_u32 s68, s68, 196608
  buffer_load_dwordx4 v9, s[12:15], s68 offen lds
  ds_read_b64_tr_b16 a[164:165], v5 offset:36864
  ds_read_b64_tr_b16 a[166:167], v5 offset:38912
  s_add_u32 m0, s45, 16384
  s_add_u32 s68, s66, 4
  s_and_b32 s68, s68, 7
  s_mul_i32 s68, s68, 786432
  s_add_u32 s68, s68, 4096
  buffer_load_dwordx4 v9, s[12:15], s68 offen lds
  ds_read_b64_tr_b16 a[172:173], v4 offset:40960
  ds_read_b64_tr_b16 a[174:175], v4 offset:43008
  s_add_u32 m0, s45, 20480
  s_add_u32 s68, s68, 196608
  buffer_load_dwordx4 v9, s[12:15], s68 offen lds
  ds_read_b64_tr_b16 a[176:177], v5 offset:40960
  ds_read_b64_tr_b16 a[178:179], v5 offset:43008
  s_add_u32 m0, s45, 24576
  s_add_u32 s68, s68, 196608
  buffer_load_dwordx4 v9, s[12:15], s68 offen lds
  ds_read_b64_tr_b16 a[184:185], v4 offset:45056
  ds_read_b64_tr_b16 a[186:187], v4 offset:47104
  s_add_u32 m0, s45, 28672
  s_add_u32 s68, s68, 196608
  buffer_load_dwordx4 v9, s[12:15], s68 offen lds
  ds_read_b64_tr_b16 a[188:189], v5 offset:45056
  ds_read_b64_tr_b16 a[190:191], v5 offset:47104
  s_waitcnt vmcnt(14) lgkmcnt(0)
  s_barrier
  ds_read_b128 v[76:79], v2 offset:32768
  ds_read_b128 v[80:83], v2 offset:33792
  ds_read_b128 v[84:87], v2 offset:40960
  ds_read_b128 v[88:91], v2 offset:41984
  ds_read_b128 v[92:95], v13 offset:0
  ds_read_b128 v[96:99], v13 offset:1024
  ds_read_b128 v[100:103], v2 offset:34816
  ds_read_b128 v[104:107], v2 offset:35840
  s_waitcnt lgkmcnt(2)
  v_mfma_f32_16x16x32_bf16 v[28:31], a[0:3], v[76:79], 0
  ds_read_b64_tr_b16 a[192:193], v6 offset:0
  s_add_u32 m0, s45, 32768
  s_add_u32 s68, s66, 5
  s_and_b32 s68, s68, 7
  s_mul_i32 s68, s68, 786432
  s_add_u32 s68, s68, 2048
  v_mfma_f32_16x16x32_bf16 v[28:31], a[12:15], v[80:83], v[28:31]
  ds_read_b128 v[108:111], v2 offset:43008
  buffer_load_dwordx4 v9, s[12:15], s68 offen lds
  v_mfma_f32_16x16x32_bf16 v[32:35], a[12:15], v[88:91], 0
  ds_read_b64_tr_b16 a[194:195], v6 offset:2048
  v_mfma_f32_16x16x32_bf16 v[32:35], a[0:3], v[84:87], v[32:35]
  ds_read_b64_tr_b16 a[204:205], v6 offset:4096
  v_mfma_f32_16x16x32_bf16 v[40:43], a[4:7], v[84:87], 0
  ds_read_b128 v[112:115], v2 offset:44032
  s_add_u32 m0, s45, 36864
  s_add_u32 s68, s68, 196608
  v_mfma_f32_16x16x32_bf16 v[40:43], a[16:19], v[88:91], v[40:43]
  ds_read_b64_tr_b16 a[206:207], v6 offset:6144
  buffer_load_dwordx4 v9, s[12:15], s68 offen lds
  v_mfma_f32_16x16x32_bf16 v[36:39], a[16:19], v[80:83], 0
  ds_read_b128 v[116:119], v13 offset:2048
  v_mfma_f32_16x16x32_bf16 v[36:39], a[4:7], v[76:79], v[36:39]
  ds_read_b64_tr_b16 a[216:217], v6 offset:8192
  v_mfma_f32_16x16x32_bf16 v[44:47], a[8:11], v[76:79], 0
  ds_read_b64_tr_b16 a[218:219], v6 offset:10240
  s_add_u32 m0, s45, 40960
  s_add_u32 s68, s68, 196608
  v_mfma_f32_16x16x32_bf16 v[44:47], a[20:23], v[80:83], v[44:47]
  ds_read_b128 v[120:123], v13 offset:3072
  buffer_load_dwordx4 v9, s[12:15], s68 offen lds
  v_mfma_f32_16x16x32_bf16 v[48:51], a[20:23], v[88:91], 0
  ds_read_b64_tr_b16 a[228:229], v6 offset:12288
  v_mfma_f32_16x16x32_bf16 v[48:51], a[8:11], v[84:87], v[48:51]
  ds_read_b64_tr_b16 a[230:231], v6 offset:14336
  v_mfma_f32_16x16x32_bf16 v[68:71], a[8:11], v[92:95], 0
  ds_read_b128 v[76:79], v2 offset:36864
  s_add_u32 m0, s45, 45056
  s_add_u32 s68, s68, 196608
  v_mfma_f32_16x16x32_bf16 v[68:71], a[20:23], v[96:99], v[68:71]
  ds_read_b64_tr_b16 a[240:241], v6 offset:16384
  buffer_load_dwordx4 v9, s[12:15], s68 offen lds
  v_mfma_f32_16x16x32_bf16 v[60:63], a[16:19], v[96:99], 0
  ds_read_b128 v[80:83], v2 offset:37888
  v_mfma_f32_16x16x32_bf16 v[60:63], a[4:7], v[92:95], v[60:63]
  s_waitcnt lgkmcnt(5)
  ds_read_b64_tr_b16 a[242:243], v6 offset:18432
  v_mfma_f32_16x16x32_bf16 v[28:31], a[24:27], v[100:103], v[28:31]
  ds_read_b64_tr_b16 v[124:125], v6 offset:20480
  s_add_u32 m0, s45, 49152
  s_add_u32 s68, s66, 5
  s_and_b32 s68, s68, 7
  s_mul_i32 s68, s68, 786432
  s_add_u32 s68, s68, 4096
  v_mfma_f32_16x16x32_bf16 v[28:31], a[36:39], v[104:107], v[28:31]
  ds_read_b128 v[88:91], v2 offset:45056
  buffer_load_dwordx4 v9, s[12:15], s68 offen lds
  v_mfma_f32_16x16x32_bf16 v[32:35], a[36:39], v[112:115], v[32:35]
  ds_read_b64_tr_b16 v[126:127], v6 offset:22528
  v_mfma_f32_16x16x32_bf16 v[32:35], a[24:27], v[108:111], v[32:35]
  ds_read_b64_tr_b16 v[136:137], v6 offset:24576
  v_mfma_f32_16x16x32_bf16 v[40:43], a[28:31], v[108:111], v[40:43]
  ds_read_b128 v[84:87], v2 offset:46080
  s_add_u32 m0, s45, 53248
  s_add_u32 s68, s68, 196608
  v_mfma_f32_16x16x32_bf16 v[40:43], a[40:43], v[112:115], v[40:43]
  ds_read_b64_tr_b16 v[138:139], v6 offset:26624
  buffer_load_dwordx4 v9, s[12:15], s68 offen lds
  v_mfma_f32_16x16x32_bf16 v[36:39], a[40:43], v[104:107], v[36:39]
  ds_read_b128 v[96:99], v13 offset:4096
  v_mfma_f32_16x16x32_bf16 v[36:39], a[28:31], v[100:103], v[36:39]
  ds_read_b64_tr_b16 v[148:149], v6 offset:28672
  v_mfma_f32_16x16x32_bf16 v[44:47], a[32:35], v[100:103], v[44:47]
  ds_read_b64_tr_b16 v[150:151], v6 offset:30720
  v_mfma_f32_16x16x32_bf16 v[44:47], a[44:47], v[104:107], v[44:47]
  ds_read_b128 v[92:95], v13 offset:5120
  s_add_u32 m0, s45, 57344
  s_add_u32 s68, s68, 196608
  v_mfma_f32_16x16x32_bf16 v[48:51], a[44:47], v[112:115], v[48:51]
  buffer_load_dwordx4 v9, s[12:15], s68 offen lds
  v_mfma_f32_16x16x32_bf16 v[48:51], a[32:35], v[108:111], v[48:51]
  s_add_u32 m0, s45, 61440
  s_add_u32 s68, s68, 196608
  v_mfma_f32_16x16x32_bf16 v[68:71], a[32:35], v[116:119], v[68:71]
  ds_read_b128 v[100:103], v2 offset:38912
  v_mfma_f32_16x16x32_bf16 v[68:71], a[44:47], v[120:123], v[68:71]
  buffer_load_dwordx4 v9, s[12:15], s68 offen lds
  v_mfma_f32_16x16x32_bf16 v[60:63], a[40:43], v[120:123], v[60:63]
  ds_read_b128 v[104:107], v2 offset:39936
  v_mfma_f32_16x16x32_bf16 v[60:63], a[28:31], v[116:119], v[60:63]
  s_waitcnt lgkmcnt(2)
  v_mfma_f32_16x16x32_bf16 v[28:31], a[48:51], v[76:79], v[28:31]
  s_add_u32 m0, s71, 147456
  s_add_u32 s69, s60, s72
  v_mfma_f32_16x16x32_bf16 v[28:31], a[60:63], v[80:83], v[28:31]
  ds_read_b128 v[112:115], v2 offset:47104
  v_mfma_f32_16x16x32_bf16 v[32:35], a[60:63], v[84:87], v[32:35]
  buffer_load_dwordx4 v1, s[8:11], s69 offen offset:0 sc1 lds
  v_mfma_f32_16x16x32_bf16 v[32:35], a[48:51], v[88:91], v[32:35]
  v_mfma_f32_16x16x32_bf16 v[40:43], a[52:55], v[88:91], v[40:43]
  ds_read_b128 v[108:111], v2 offset:48128
  v_mfma_f32_16x16x32_bf16 v[40:43], a[64:67], v[84:87], v[40:43]
  buffer_load_dwordx4 v1, s[8:11], s69 offen offset:1024 sc1 lds
  v_mfma_f32_16x16x32_bf16 v[36:39], a[64:67], v[80:83], v[36:39]
  ds_read_b128 v[120:123], v13 offset:6144
  v_mfma_f32_16x16x32_bf16 v[36:39], a[52:55], v[76:79], v[36:39]
  v_mfma_f32_16x16x32_bf16 v[44:47], a[56:59], v[76:79], v[44:47]
  s_add_u32 m0, s71, 155648
  s_add_u32 s69, s61, s72
  v_mfma_f32_16x16x32_bf16 v[44:47], a[68:71], v[80:83], v[44:47]
  ds_read_b128 v[116:119], v13 offset:7168
  v_mfma_f32_16x16x32_bf16 v[48:51], a[68:71], v[84:87], v[48:51]
  buffer_load_dwordx4 v1, s[8:11], s69 offen offset:0 sc1 lds
  v_mfma_f32_16x16x32_bf16 v[48:51], a[56:59], v[88:91], v[48:51]
  s_waitcnt vmcnt(11) lgkmcnt(7)
  s_barrier
  v_mfma_f32_16x16x32_bf16 v[68:71], a[56:59], v[96:99], v[68:71]
  ds_read_b128 v[76:79], v2 offset:49152
  v_mfma_f32_16x16x32_bf16 v[68:71], a[68:71], v[92:95], v[68:71]
  ds_read_b64_tr_b16 a[196:197], v4 offset:0
  buffer_load_dwordx4 v1, s[8:11], s69 offen offset:1024 sc1 lds
  v_mfma_f32_16x16x32_bf16 v[60:63], a[64:67], v[92:95], v[60:63]
  ds_read_b128 v[80:83], v2 offset:50176
  v_mfma_f32_16x16x32_bf16 v[60:63], a[52:55], v[96:99], v[60:63]
  s_waitcnt lgkmcnt(3)
  ds_read_b64_tr_b16 a[198:199], v4 offset:2048
  v_mfma_f32_16x16x32_bf16 v[28:31], a[72:75], v[100:103], v[28:31]
  ds_read_b64_tr_b16 a[200:201], v5 offset:0
  s_add_u32 m0, s70, 65536
  s_add_u32 s69, s60, 32768
  v_mfma_f32_16x16x32_bf16 v[28:31], a[84:87], v[104:107], v[28:31]
  ds_read_b128 v[84:87], v2 offset:57344
  buffer_load_dwordx4 v12, s[8:11], s69 offen offset:0 sc1 lds
  v_mfma_f32_16x16x32_bf16 v[32:35], a[84:87], v[108:111], v[32:35]
  ds_read_b64_tr_b16 a[202:203], v5 offset:2048
HOP1:
  s_cbranch_execz HOP5
  v_mfma_f32_16x16x32_bf16 v[32:35], a[72:75], v[112:115], v[32:35]
  ds_read_b64_tr_b16 a[208:209], v4 offset:4096
  v_mfma_f32_16x16x32_bf16 v[40:43], a[76:79], v[112:115], v[40:43]
  ds_read_b128 v[88:91], v2 offset:58368
  v_mfma_f32_16x16x32_bf16 v[40:43], a[88:91], v[108:111], v[40:43]
  ds_read_b64_tr_b16 a[210:211], v4 offset:6144
  buffer_load_dwordx4 v12, s[8:11], s69 offen offset:1024 sc1 lds
  v_mfma_f32_16x16x32_bf16 v[36:39], a[88:91], v[104:107], v[36:39]
  ds_read_b128 v[92:95], v13 offset:8192
  v_mfma_f32_16x16x32_bf16 v[36:39], a[76:79], v[100:103], v[36:39]
  ds_read_b64_tr_b16 a[212:213], v5 offset:4096
  v_mfma_f32_16x16x32_bf16 v[44:47], a[80:83], v[100:103], v[44:47]
  ds_read_b64_tr_b16 a[214:215], v5 offset:6144
  v_mfma_f32_16x16x32_bf16 v[44:47], a[92:95], v[104:107], v[44:47]
  ds_read_b128 v[96:99], v13 offset:9216
  buffer_load_dwordx4 v12, s[8:11], s69 offen offset:2048 sc1 lds
  v_mfma_f32_16x16x32_bf16 v[48:51], a[92:95], v[108:111], v[48:51]
  ds_read_b64_tr_b16 a[220:221], v4 offset:8192
  v_mfma_f32_16x16x32_bf16 v[48:51], a[80:83], v[112:115], v[48:51]
  ds_read_b64_tr_b16 a[222:223], v4 offset:10240
  v_mfma_f32_16x16x32_bf16 v[68:71], a[80:83], v[120:123], v[68:71]
  ds_read_b128 v[100:103], v2 offset:51200
  v_mfma_f32_16x16x32_bf16 v[68:71], a[92:95], v[116:119], v[68:71]
  ds_read_b64_tr_b16 a[224:225], v5 offset:8192
  buffer_load_dwordx4 v12, s[8:11], s69 offen offset:3072 sc1 lds
  v_mfma_f32_16x16x32_bf16 v[60:63], a[88:91], v[116:119], v[60:63]
  ds_read_b128 v[104:107], v2 offset:52224
  v_mfma_f32_16x16x32_bf16 v[60:63], a[76:79], v[120:123], v[60:63]
  s_waitcnt lgkmcnt(5)
  ds_read_b64_tr_b16 a[226:227], v5 offset:10240
  v_mfma_f32_16x16x32_bf16 v[28:31], a[96:99], v[76:79], v[28:31]
  ds_read_b64_tr_b16 a[232:233], v4 offset:12288
  s_add_u32 m0, s45, 81920
  s_add_u32 s68, s66, 6
  s_and_b32 s68, s68, 7
  s_mul_i32 s68, s68, 786432
  v_mfma_f32_16x16x32_bf16 v[28:31], a[108:111], v[80:83], v[28:31]
  ds_read_b128 v[108:111], v2 offset:59392
  buffer_load_dwordx4 v9, s[12:15], s68 offen lds
  v_mfma_f32_16x16x32_bf16 v[32:35], a[108:111], v[88:91], v[32:35]
  ds_read_b64_tr_b16 a[234:235], v4 offset:14336
  v_mfma_f32_16x16x32_bf16 v[32:35], a[96:99], v[84:87], v[32:35]
  ds_read_b64_tr_b16 a[236:237], v5 offset:12288
  v_mfma_f32_16x16x32_bf16 v[40:43], a[100:103], v[84:87], v[40:43]
  ds_read_b128 v[112:115], v2 offset:60416
  s_add_u32 m0, s45, 86016
  s_add_u32 s68, s68, 196608
  v_mfma_f32_16x16x32_bf16 v[40:43], a[112:115], v[88:91], v[40:43]
  ds_read_b64_tr_b16 a[238:239], v5 offset:14336
  buffer_load_dwordx4 v9, s[12:15], s68 offen lds
  v_mfma_f32_16x16x32_bf16 v[36:39], a[112:115], v[80:83], v[36:39]
  ds_read_b128 v[116:119], v13 offset:10240
  v_mfma_f32_16x16x32_bf16 v[36:39], a[100:103], v[76:79], v[36:39]
  v_mfma_f32_16x16x32_bf16 v[44:47], a[104:107], v[76:79], v[44:47]
  s_add_u32 m0, s45, 90112
  s_add_u32 s68, s68, 196608
  v_mfma_f32_16x16x32_bf16 v[44:47], a[116:119], v[80:83], v[44:47]
  ds_read_b128 v[120:123], v13 offset:11264
  v_mfma_f32_16x16x32_bf16 v[48:51], a[116:119], v[88:91], v[48:51]
  buffer_load_dwordx4 v9, s[12:15], s68 offen lds
  v_mfma_f32_16x16x32_bf16 v[48:51], a[104:107], v[84:87], v[48:51]
  s_waitcnt vmcnt(11) lgkmcnt(2)
  s_barrier
  v_mfma_f32_16x16x32_bf16 v[68:71], a[104:107], v[92:95], v[68:71]
  ds_read_b128 v[76:79], v2 offset:53248
  s_add_u32 m0, s45, 94208
  s_add_u32 s68, s68, 196608
  v_mfma_f32_16x16x32_bf16 v[68:71], a[116:119], v[96:99], v[68:71]
  ds_read_b64_tr_b16 a[244:245], v4 offset:32768
  buffer_load_dwordx4 v9, s[12:15], s68 offen lds
  v_mfma_f32_16x16x32_bf16 v[60:63], a[112:115], v[96:99], v[60:63]
  ds_read_b128 v[80:83], v2 offset:54272
  v_mfma_f32_16x16x32_bf16 v[60:63], a[100:103], v[92:95], v[60:63]
  s_waitcnt lgkmcnt(3)
  ds_read_b64_tr_b16 a[246:247], v4 offset:34816
  v_mfma_f32_16x16x32_bf16 v[28:31], a[120:123], v[100:103], v[28:31]
  ds_read_b64_tr_b16 a[248:249], v5 offset:32768
  s_add_u32 m0, s45, 98304
  s_add_u32 s68, s66, 7
  s_and_b32 s68, s68, 7
  s_mul_i32 s68, s68, 786432
  v_mfma_f32_16x16x32_bf16 v[28:31], a[132:135], v[104:107], v[28:31]
  ds_read_b128 v[88:91], v2 offset:61440
  buffer_load_dwordx4 v9, s[12:15], s68 offen lds
  v_mfma_f32_16x16x32_bf16 v[32:35], a[132:135], v[112:115], v[32:35]
  ds_read_b64_tr_b16 a[250:251], v5 offset:34816
  v_mfma_f32_16x16x32_bf16 v[32:35], a[120:123], v[108:111], v[32:35]
  ds_read_b64_tr_b16 v[128:129], v4 offset:36864
  v_mfma_f32_16x16x32_bf16 v[40:43], a[124:127], v[108:111], v[40:43]
  ds_read_b128 v[84:87], v2 offset:62464
  s_add_u32 m0, s45, 102400
  s_add_u32 s68, s68, 196608
  v_mfma_f32_16x16x32_bf16 v[40:43], a[136:139], v[112:115], v[40:43]
  ds_read_b64_tr_b16 v[130:131], v4 offset:38912
  buffer_load_dwordx4 v9, s[12:15], s68 offen lds
  v_mfma_f32_16x16x32_bf16 v[36:39], a[136:139], v[104:107], v[36:39]
  ds_read_b128 v[96:99], v13 offset:12288
  v_mfma_f32_16x16x32_bf16 v[36:39], a[124:127], v[100:103], v[36:39]
  ds_read_b64_tr_b16 v[132:133], v5 offset:36864
  v_mfma_f32_16x16x32_bf16 v[44:47], a[128:131], v[100:103], v[44:47]
  ds_read_b64_tr_b16 v[134:135], v5 offset:38912
  s_add_u32 m0, s45, 106496
  s_add_u32 s68, s68, 196608
  v_mfma_f32_16x16x32_bf16 v[44:47], a[140:143], v[104:107], v[44:47]
  ds_read_b128 v[92:95], v13 offset:13312
  buffer_load_dwordx4 v9, s[12:15], s68 offen lds
  v_mfma_f32_16x16x32_bf16 v[48:51], a[140:143], v[112:115], v[48:51]
  ds_read_b64_tr_b16 v[140:141], v4 offset:40960
  v_mfma_f32_16x16x32_bf16 v[48:51], a[128:131], v[108:111], v[48:51]
  ds_read_b64_tr_b16 v[142:143], v4 offset:43008
  v_mfma_f32_16x16x32_bf16 v[68:71], a[128:131], v[116:119], v[68:71]
  ds_read_b128 v[100:103], v2 offset:55296
  s_add_u32 m0, s45, 110592
  s_add_u32 s68, s68, 196608
  v_mfma_f32_16x16x32_bf16 v[68:71], a[140:143], v[120:123], v[68:71]
  ds_read_b64_tr_b16 v[144:145], v5 offset:40960
  buffer_load_dwordx4 v9, s[12:15], s68 offen lds
  v_mfma_f32_16x16x32_bf16 v[60:63], a[136:139], v[120:123], v[60:63]
  ds_read_b128 v[104:107], v2 offset:56320
  v_mfma_f32_16x16x32_bf16 v[60:63], a[124:127], v[116:119], v[60:63]
  s_waitcnt lgkmcnt(5)
  ds_read_b64_tr_b16 v[146:147], v5 offset:43008
  v_mfma_f32_16x16x32_bf16 v[28:31], a[144:147], v[76:79], v[28:31]
  ds_read_b64_tr_b16 v[152:153], v4 offset:45056
  s_add_u32 m0, s45, 0
  s_add_u32 s68, s66, 6
  s_and_b32 s68, s68, 7
  s_mul_i32 s68, s68, 786432
  s_add_u32 s68, s68, 2048
  v_mfma_f32_16x16x32_bf16 v[28:31], a[156:159], v[80:83], v[28:31]
  ds_read_b128 v[112:115], v2 offset:63488
  buffer_load_dwordx4 v9, s[12:15], s68 offen lds
  v_mfma_f32_16x16x32_bf16 v[32:35], a[156:159], v[84:87], v[32:35]
  ds_read_b64_tr_b16 v[154:155], v4 offset:47104
  v_mfma_f32_16x16x32_bf16 v[32:35], a[144:147], v[88:91], v[32:35]
  ds_read_b64_tr_b16 v[156:157], v5 offset:45056
  v_mfma_f32_16x16x32_bf16 v[40:43], a[148:151], v[88:91], v[40:43]
  ds_read_b128 v[108:111], v2 offset:64512
  s_add_u32 m0, s45, 4096
  s_add_u32 s68, s68, 196608
  v_mfma_f32_16x16x32_bf16 v[40:43], a[160:163], v[84:87], v[40:43]
  ds_read_b64_tr_b16 v[158:159], v5 offset:47104
  buffer_load_dwordx4 v9, s[12:15], s68 offen lds
  v_mfma_f32_16x16x32_bf16 v[36:39], a[160:163], v[80:83], v[36:39]
  ds_read_b128 v[120:123], v13 offset:14336
  v_mfma_f32_16x16x32_bf16 v[36:39], a[148:151], v[76:79], v[36:39]
  v_mfma_f32_16x16x32_bf16 v[44:47], a[152:155], v[76:79], v[44:47]
  s_add_u32 m0, s45, 8192
  s_add_u32 s68, s68, 196608
  v_mfma_f32_16x16x32_bf16 v[44:47], a[164:167], v[80:83], v[44:47]
  ds_read_b128 v[116:119], v13 offset:15360
  v_mfma_f32_16x16x32_bf16 v[48:51], a[164:167], v[84:87], v[48:51]
  buffer_load_dwordx4 v9, s[12:15], s68 offen lds
  v_mfma_f32_16x16x32_bf16 v[48:51], a[152:155], v[88:91], v[48:51]
  s_waitcnt vmcnt(3) lgkmcnt(2)
  s_barrier
  v_mfma_f32_16x16x32_bf16 v[68:71], a[152:155], v[96:99], v[68:71]
  ds_read_b128 v[76:79], v2 offset:0
  s_add_u32 m0, s45, 12288
  s_add_u32 s68, s68, 196608
  v_mfma_f32_16x16x32_bf16 v[68:71], a[164:167], v[92:95], v[68:71]
  ds_read_b64_tr_b16 v[160:161], v6 offset:16384
  buffer_load_dwordx4 v9, s[12:15], s68 offen lds
  v_mfma_f32_16x16x32_bf16 v[60:63], a[160:163], v[92:95], v[60:63]
  ds_read_b128 v[80:83], v2 offset:1024
  v_mfma_f32_16x16x32_bf16 v[60:63], a[148:151], v[96:99], v[60:63]
  s_waitcnt lgkmcnt(3)
  ds_read_b64_tr_b16 v[162:163], v6 offset:18432
  v_mfma_f32_16x16x32_bf16 v[28:31], a[168:171], v[100:103], v[28:31]
  ds_read_b64_tr_b16 v[172:173], v6 offset:20480
  s_add_u32 m0, s45, 16384
  s_add_u32 s68, s66, 6
  s_and_b32 s68, s68, 7
  s_mul_i32 s68, s68, 786432
  s_add_u32 s68, s68, 4096
  v_mfma_f32_16x16x32_bf16 v[28:31], a[180:183], v[104:107], v[28:31]
  ds_read_b128 v[84:87], v2 offset:8192
  buffer_load_dwordx4 v9, s[12:15], s68 offen lds
  v_mfma_f32_16x16x32_bf16 v[32:35], a[180:183], v[108:111], v[32:35]
  ds_read_b64_tr_b16 v[174:175], v6 offset:22528
  v_mfma_f32_16x16x32_bf16 v[32:35], a[168:171], v[112:115], v[32:35]
  ds_read_b64_tr_b16 v[184:185], v6 offset:24576
  v_mfma_f32_16x16x32_bf16 v[40:43], a[172:175], v[112:115], v[40:43]
  ds_read_b128 v[88:91], v2 offset:9216
  s_add_u32 m0, s45, 20480
  s_add_u32 s68, s68, 196608
  v_mfma_f32_16x16x32_bf16 v[40:43], a[184:187], v[108:111], v[40:43]
  ds_read_b64_tr_b16 v[186:187], v6 offset:26624
  buffer_load_dwordx4 v9, s[12:15], s68 offen lds
  v_mfma_f32_16x16x32_bf16 v[36:39], a[184:187], v[104:107], v[36:39]
  ds_read_b128 v[92:95], v13 offset:16384
  v_mfma_f32_16x16x32_bf16 v[36:39], a[172:175], v[100:103], v[36:39]
  ds_read_b64_tr_b16 v[196:197], v6 offset:28672
  v_mfma_f32_16x16x32_bf16 v[44:47], a[176:179], v[100:103], v[44:47]
  ds_read_b64_tr_b16 v[198:199], v6 offset:30720
  s_add_u32 m0, s45, 24576
  s_add_u32 s68, s68, 196608
  v_mfma_f32_16x16x32_bf16 v[44:47], a[188:191], v[104:107], v[44:47]
  ds_read_b128 v[96:99], v13 offset:17408
  buffer_load_dwordx4 v9, s[12:15], s68 offen lds
  v_mfma_f32_16x16x32_bf16 v[48:51], a[188:191], v[108:111], v[48:51]
  ds_read_b64_tr_b16 v[208:209], v6 offset:32768
  v_mfma_f32_16x16x32_bf16 v[48:51], a[176:179], v[112:115], v[48:51]
  ds_read_b64_tr_b16 v[210:211], v6 offset:34816
  v_mfma_f32_16x16x32_bf16 v[68:71], a[176:179], v[120:123], v[68:71]
  ds_read_b128 v[100:103], v2 offset:2048
  s_add_u32 m0, s45, 28672
  s_add_u32 s68, s68, 196608
  v_mfma_f32_16x16x32_bf16 v[68:71], a[188:191], v[116:119], v[68:71]
  ds_read_b64_tr_b16 v[220:221], v6 offset:36864
  buffer_load_dwordx4 v9, s[12:15], s68 offen lds
  v_mfma_f32_16x16x32_bf16 v[60:63], a[184:187], v[116:119], v[60:63]
  ds_read_b128 v[104:107], v2 offset:3072
  v_mfma_f32_16x16x32_bf16 v[60:63], a[172:175], v[120:123], v[60:63]
  s_waitcnt lgkmcnt(5)
  ds_read_b64_tr_b16 v[222:223], v6 offset:38912
  v_mfma_f32_16x16x32_bf16 v[28:31], a[192:195], v[76:79], v[28:31]
  ds_read_b64_tr_b16 v[232:233], v6 offset:40960
  s_add_u32 m0, s70, 32768
  s_add_u32 s69, s61, 32768
  v_mfma_f32_16x16x32_bf16 v[28:31], a[204:207], v[80:83], v[28:31]
  ds_read_b128 v[108:111], v2 offset:10240
  buffer_load_dwordx4 v12, s[8:11], s69 offen offset:0 sc1 lds
  v_mfma_f32_16x16x32_bf16 v[32:35], a[204:207], v[88:91], v[32:35]
  ds_read_b64_tr_b16 v[234:235], v6 offset:43008
  v_mfma_f32_16x16x32_bf16 v[32:35], a[192:195], v[84:87], v[32:35]
  ds_read_b64_tr_b16 v[244:245], v6 offset:45056
  v_mfma_f32_16x16x32_bf16 v[40:43], a[196:199], v[84:87], v[40:43]
  ds_read_b128 v[112:115], v2 offset:11264
  v_mfma_f32_16x16x32_bf16 v[40:43], a[208:211], v[88:91], v[40:43]
  ds_read_b64_tr_b16 v[246:247], v6 offset:47104
  buffer_load_dwordx4 v12, s[8:11], s69 offen offset:1024 sc1 lds
  v_mfma_f32_16x16x32_bf16 v[36:39], a[208:211], v[80:83], v[36:39]
  ds_read_b128 v[116:119], v13 offset:18432
  v_mfma_f32_16x16x32_bf16 v[36:39], a[196:199], v[76:79], v[36:39]
  v_mfma_f32_16x16x32_bf16 v[44:47], a[200:203], v[76:79], v[44:47]
  v_mfma_f32_16x16x32_bf16 v[44:47], a[212:215], v[80:83], v[44:47]
  ds_read_b128 v[120:123], v13 offset:19456
  v_mfma_f32_16x16x32_bf16 v[48:51], a[212:215], v[88:91], v[48:51]
  buffer_load_dwordx4 v12, s[8:11], s69 offen offset:2048 sc1 lds
  v_mfma_f32_16x16x32_bf16 v[48:51], a[200:203], v[84:87], v[48:51]
  s_waitcnt vmcnt(3) lgkmcnt(2)
  s_barrier
  v_mfma_f32_16x16x32_bf16 v[68:71], a[200:203], v[92:95], v[68:71]
  ds_read_b128 v[76:79], v2 offset:4096
  v_mfma_f32_16x16x32_bf16 v[68:71], a[212:215], v[96:99], v[68:71]
  ds_read_b64_tr_b16 v[164:165], v4 offset:0
  buffer_load_dwordx4 v12, s[8:11], s69 offen offset:3072 sc1 lds
  v_mfma_f32_16x16x32_bf16 v[60:63], a[208:211], v[96:99], v[60:63]
  ds_read_b128 v[80:83], v2 offset:5120
  v_mfma_f32_16x16x32_bf16 v[60:63], a[196:199], v[92:95], v[60:63]
  s_waitcnt lgkmcnt(3)
  ds_read_b64_tr_b16 v[166:167], v4 offset:2048
  v_mfma_f32_16x16x32_bf16 v[28:31], a[216:219], v[100:103], v[28:31]
  ds_read_b64_tr_b16 v[168:169], v5 offset:0
  s_add_u32 m0, s45, 81920
  s_add_u32 s68, s66, 7
  s_and_b32 s68, s68, 7
  s_mul_i32 s68, s68, 786432
  s_add_u32 s68, s68, 2048
  v_mfma_f32_16x16x32_bf16 v[28:31], a[228:231], v[104:107], v[28:31]
  ds_read_b128 v[88:91], v2 offset:12288
  buffer_load_dwordx4 v9, s[12:15], s68 offen lds
  v_mfma_f32_16x16x32_bf16 v[32:35], a[228:231], v[112:115], v[32:35]
  ds_read_b64_tr_b16 v[170:171], v5 offset:2048
  v_mfma_f32_16x16x32_bf16 v[32:35], a[216:219], v[108:111], v[32:35]
  ds_read_b64_tr_b16 v[176:177], v4 offset:4096
  v_mfma_f32_16x16x32_bf16 v[40:43], a[220:223], v[108:111], v[40:43]
  ds_read_b128 v[84:87], v2 offset:13312
  s_add_u32 m0, s45, 86016
  s_add_u32 s68, s68, 196608
  v_mfma_f32_16x16x32_bf16 v[40:43], a[232:235], v[112:115], v[40:43]
  ds_read_b64_tr_b16 v[178:179], v4 offset:6144
  buffer_load_dwordx4 v9, s[12:15], s68 offen lds
  v_mfma_f32_16x16x32_bf16 v[36:39], a[232:235], v[104:107], v[36:39]
  ds_read_b128 v[96:99], v13 offset:20480
  v_mfma_f32_16x16x32_bf16 v[36:39], a[220:223], v[100:103], v[36:39]
  ds_read_b64_tr_b16 v[180:181], v5 offset:4096
  v_mfma_f32_16x16x32_bf16 v[44:47], a[224:227], v[100:103], v[44:47]
  ds_read_b64_tr_b16 v[182:183], v5 offset:6144
  s_add_u32 m0, s45, 90112
  s_add_u32 s68, s68, 196608
  v_mfma_f32_16x16x32_bf16 v[44:47], a[236:239], v[104:107], v[44:47]
  ds_read_b128 v[92:95], v13 offset:21504
  buffer_load_dwordx4 v9, s[12:15], s68 offen lds
  v_mfma_f32_16x16x32_bf16 v[48:51], a[236:239], v[112:115], v[48:51]
  ds_read_b64_tr_b16 v[188:189], v4 offset:8192
  v_mfma_f32_16x16x32_bf16 v[48:51], a[224:227], v[108:111], v[48:51]
  ds_read_b64_tr_b16 v[190:191], v4 offset:10240
  v_mfma_f32_16x16x32_bf16 v[68:71], a[224:227], v[116:119], v[68:71]
  ds_read_b128 v[100:103], v2 offset:6144
  s_add_u32 m0, s45, 94208
  s_add_u32 s68, s68, 196608
  v_mfma_f32_16x16x32_bf16 v[68:71], a[236:239], v[120:123], v[68:71]
  ds_read_b64_tr_b16 v[192:193], v5 offset:8192
  buffer_load_dwordx4 v9, s[12:15], s68 offen lds
  v_mfma_f32_16x16x32_bf16 v[60:63], a[232:235], v[120:123], v[60:63]
  ds_read_b128 v[104:107], v2 offset:7168
  v_mfma_f32_16x16x32_bf16 v[60:63], a[220:223], v[116:119], v[60:63]
  s_waitcnt lgkmcnt(5)
  ds_read_b64_tr_b16 v[194:195], v5 offset:10240
  v_mfma_f32_16x16x32_bf16 v[28:31], a[240:243], v[76:79], v[28:31]
  ds_read_b64_tr_b16 v[200:201], v4 offset:12288
  s_add_u32 m0, s45, 98304
  s_add_u32 s68, s66, 7
  s_and_b32 s68, s68, 7
  s_mul_i32 s68, s68, 786432
  s_add_u32 s68, s68, 4096
  v_mfma_f32_16x16x32_bf16 v[28:31], v[124:127], v[80:83], v[28:31]
  ds_read_b128 v[112:115], v2 offset:14336
  buffer_load_dwordx4 v9, s[12:15], s68 offen lds
  v_mfma_f32_16x16x32_bf16 v[32:35], v[124:127], v[84:87], v[32:35]
  ds_read_b64_tr_b16 v[202:203], v4 offset:14336
  v_mfma_f32_16x16x32_bf16 v[32:35], a[240:243], v[88:91], v[32:35]
  ds_read_b64_tr_b16 v[204:205], v5 offset:12288
  v_mfma_f32_16x16x32_bf16 v[40:43], a[244:247], v[88:91], v[40:43]
  ds_read_b128 v[108:111], v2 offset:15360
  s_add_u32 m0, s45, 102400
  s_add_u32 s68, s68, 196608
  v_mfma_f32_16x16x32_bf16 v[40:43], v[128:131], v[84:87], v[40:43]
  ds_read_b64_tr_b16 v[206:207], v5 offset:14336
  buffer_load_dwordx4 v9, s[12:15], s68 offen lds
  v_mfma_f32_16x16x32_bf16 v[36:39], v[128:131], v[80:83], v[36:39]
  ds_read_b128 v[120:123], v13 offset:22528
  v_mfma_f32_16x16x32_bf16 v[36:39], a[244:247], v[76:79], v[36:39]
  v_mfma_f32_16x16x32_bf16 v[44:47], a[248:251], v[76:79], v[44:47]
  s_add_u32 m0, s45, 106496
  s_add_u32 s68, s68, 196608
  v_mfma_f32_16x16x32_bf16 v[44:47], v[132:135], v[80:83], v[44:47]
  ds_read_b128 v[116:119], v13 offset:23552
  v_mfma_f32_16x16x32_bf16 v[48:51], v[132:135], v[84:87], v[48:51]
  buffer_load_dwordx4 v9, s[12:15], s68 offen lds
  v_mfma_f32_16x16x32_bf16 v[48:51], a[248:251], v[88:91], v[48:51]
  s_waitcnt vmcnt(7) lgkmcnt(2)
  s_barrier
  v_mfma_f32_16x16x32_bf16 v[68:71], a[248:251], v[96:99], v[68:71]
  ds_read_b128 v[76:79], v1 offset:32768
  s_add_u32 m0, s45, 110592
  s_add_u32 s68, s68, 196608
  v_mfma_f32_16x16x32_bf16 v[68:71], v[132:135], v[92:95], v[68:71]
  buffer_load_dwordx4 v9, s[12:15], s68 offen lds
  v_mfma_f32_16x16x32_bf16 v[60:63], v[128:131], v[92:95], v[60:63]
  ds_read_b128 v[80:83], v1 offset:33792
  v_mfma_f32_16x16x32_bf16 v[60:63], a[244:247], v[96:99], v[60:63]
  s_waitcnt lgkmcnt(2)
  v_mfma_f32_16x16x32_bf16 v[28:31], v[136:139], v[100:103], v[28:31]
  s_add_u32 m0, s70, 49152
  s_add_u32 s69, s58, 98304
  v_mfma_f32_16x16x32_bf16 v[28:31], v[148:151], v[104:107], v[28:31]
  ds_read_b128 v[84:87], v1 offset:40960
  v_mfma_f32_16x16x32_bf16 v[32:35], v[148:151], v[108:111], v[32:35]
  buffer_load_dwordx4 v12, s[8:11], s69 offen offset:0 sc1 lds
  v_mfma_f32_16x16x32_bf16 v[32:35], v[136:139], v[112:115], v[32:35]
  v_mfma_f32_16x16x32_bf16 v[40:43], v[140:143], v[112:115], v[40:43]
  ds_read_b128 v[88:91], v1 offset:41984
  v_mfma_f32_16x16x32_bf16 v[40:43], v[152:155], v[108:111], v[40:43]
  buffer_load_dwordx4 v12, s[8:11], s69 offen offset:1024 sc1 lds
  v_mfma_f32_16x16x32_bf16 v[36:39], v[152:155], v[104:107], v[36:39]
  ds_read_b128 v[92:95], v13 offset:24576
  v_mfma_f32_16x16x32_bf16 v[36:39], v[140:143], v[100:103], v[36:39]
  v_mfma_f32_16x16x32_bf16 v[44:47], v[144:147], v[100:103], v[44:47]
  v_mfma_f32_16x16x32_bf16 v[44:47], v[156:159], v[104:107], v[44:47]
  ds_read_b128 v[96:99], v13 offset:25600
  v_mfma_f32_16x16x32_bf16 v[48:51], v[156:159], v[108:111], v[48:51]
  buffer_load_dwordx4 v12, s[8:11], s69 offen offset:2048 sc1 lds
  v_mfma_f32_16x16x32_bf16 v[48:51], v[144:147], v[112:115], v[48:51]
  s_waitcnt vmcnt(3)
  s_barrier
  v_mfma_f32_16x16x32_bf16 v[68:71], v[144:147], v[120:123], v[68:71]
  ds_read_b128 v[100:103], v1 offset:34816
  v_mfma_f32_16x16x32_bf16 v[68:71], v[156:159], v[116:119], v[68:71]
  ds_read_b64_tr_b16 v[212:213], v7 offset:16384
  buffer_load_dwordx4 v12, s[8:11], s69 offen offset:3072 sc1 lds
  v_mfma_f32_16x16x32_bf16 v[60:63], v[152:155], v[116:119], v[60:63]
  ds_read_b128 v[104:107], v1 offset:35840
  v_mfma_f32_16x16x32_bf16 v[60:63], v[140:143], v[120:123], v[60:63]
  s_waitcnt lgkmcnt(3)
  ds_read_b64_tr_b16 v[214:215], v7 offset:18432
  v_mfma_f32_16x16x32_bf16 v[28:31], v[160:163], v[76:79], v[28:31]
  ds_read_b64_tr_b16 v[216:217], v8 offset:16384
  s_add_u32 m0, s70, 114688
  s_add_u32 s69, s59, 98304
  v_mfma_f32_16x16x32_bf16 v[28:31], v[172:175], v[80:83], v[28:31]
  ds_read_b128 v[108:111], v1 offset:43008
  buffer_load_dwordx4 v12, s[8:11], s69 offen offset:0 sc1 lds
  v_mfma_f32_16x16x32_bf16 v[32:35], v[172:175], v[88:91], v[32:35]
  ds_read_b64_tr_b16 v[218:219], v8 offset:18432
  v_mfma_f32_16x16x32_bf16 v[32:35], v[160:163], v[84:87], v[32:35]
  ds_read_b64_tr_b16 v[224:225], v7 offset:20480
  v_mfma_f32_16x16x32_bf16 v[40:43], v[164:167], v[84:87], v[40:43]
  ds_read_b128 v[112:115], v1 offset:44032
  v_mfma_f32_16x16x32_bf16 v[40:43], v[176:179], v[88:91], v[40:43]
  ds_read_b64_tr_b16 v[226:227], v7 offset:22528
  buffer_load_dwordx4 v12, s[8:11], s69 offen offset:1024 sc1 lds
  v_mfma_f32_16x16x32_bf16 v[36:39], v[176:179], v[80:83], v[36:39]
  ds_read_b128 v[116:119], v13 offset:26624
  v_mfma_f32_16x16x32_bf16 v[36:39], v[164:167], v[76:79], v[36:39]
  ds_read_b64_tr_b16 v[228:229], v8 offset:20480
  v_mfma_f32_16x16x32_bf16 v[44:47], v[168:171], v[76:79], v[44:47]
  ds_read_b64_tr_b16 v[230:231], v8 offset:22528
  v_mfma_f32_16x16x32_bf16 v[44:47], v[180:183], v[80:83], v[44:47]
  ds_read_b128 v[120:123], v13 offset:27648
  buffer_load_dwordx4 v12, s[8:11], s69 offen offset:2048 sc1 lds
  v_mfma_f32_16x16x32_bf16 v[48:51], v[180:183], v[88:91], v[48:51]
  ds_read_b64_tr_b16 v[236:237], v7 offset:24576
  v_mfma_f32_16x16x32_bf16 v[48:51], v[168:171], v[84:87], v[48:51]
  ds_read_b64_tr_b16 v[238:239], v7 offset:26624
  v_mfma_f32_16x16x32_bf16 v[68:71], v[168:171], v[92:95], v[68:71]
  ds_read_b128 v[76:79], v1 offset:36864
  v_mfma_f32_16x16x32_bf16 v[68:71], v[180:183], v[96:99], v[68:71]
  ds_read_b64_tr_b16 v[240:241], v8 offset:24576
  buffer_load_dwordx4 v12, s[8:11], s69 offen offset:3072 sc1 lds
  v_mfma_f32_16x16x32_bf16 v[60:63], v[176:179], v[96:99], v[60:63]
  ds_read_b128 v[80:83], v1 offset:37888
  v_mfma_f32_16x16x32_bf16 v[60:63], v[164:167], v[92:95], v[60:63]
  s_waitcnt lgkmcnt(5)
  ds_read_b64_tr_b16 v[242:243], v8 offset:26624
  v_mfma_f32_16x16x32_bf16 v[28:31], v[184:187], v[100:103], v[28:31]
  ds_read_b64_tr_b16 v[248:249], v7 offset:28672
  s_add_u32 m0, s70, 0
  s_add_u32 s69, s60, 98304
  v_mfma_f32_16x16x32_bf16 v[28:31], v[196:199], v[104:107], v[28:31]
  ds_read_b128 v[88:91], v1 offset:45056
  buffer_load_dwordx4 v12, s[8:11], s69 offen offset:0 sc1 lds
  v_mfma_f32_16x16x32_bf16 v[32:35], v[196:199], v[112:115], v[32:35]
  ds_read_b64_tr_b16 v[250:251], v7 offset:30720
  v_mfma_f32_16x16x32_bf16 v[32:35], v[184:187], v[108:111], v[32:35]
  ds_read_b64_tr_b16 v[252:253], v8 offset:28672
  v_mfma_f32_16x16x32_bf16 v[40:43], v[188:191], v[108:111], v[40:43]
  ds_read_b128 v[84:87], v1 offset:46080
  v_mfma_f32_16x16x32_bf16 v[40:43], v[200:203], v[112:115], v[40:43]
  ds_read_b64_tr_b16 v[254:255], v8 offset:30720
  buffer_load_dwordx4 v12, s[8:11], s69 offen offset:1024 sc1 lds
  v_mfma_f32_16x16x32_bf16 v[36:39], v[200:203], v[104:107], v[36:39]
  ds_read_b128 v[96:99], v13 offset:28672
  v_mfma_f32_16x16x32_bf16 v[36:39], v[188:191], v[100:103], v[36:39]
  v_mfma_f32_16x16x32_bf16 v[44:47], v[192:195], v[100:103], v[44:47]
  v_mfma_f32_16x16x32_bf16 v[44:47], v[204:207], v[104:107], v[44:47]
  ds_read_b128 v[92:95], v13 offset:29696
  v_mfma_f32_16x16x32_bf16 v[48:51], v[204:207], v[112:115], v[48:51]
  buffer_load_dwordx4 v12, s[8:11], s69 offen offset:2048 sc1 lds
  v_mfma_f32_16x16x32_bf16 v[48:51], v[192:195], v[108:111], v[48:51]
  v_mfma_f32_16x16x32_bf16 v[68:71], v[192:195], v[116:119], v[68:71]
  ds_read_b128 v[100:103], v1 offset:38912
  v_mfma_f32_16x16x32_bf16 v[68:71], v[204:207], v[120:123], v[68:71]
  buffer_load_dwordx4 v12, s[8:11], s69 offen offset:3072 sc1 lds
  v_mfma_f32_16x16x32_bf16 v[60:63], v[200:203], v[120:123], v[60:63]
  ds_read_b128 v[104:107], v1 offset:39936
  s_mov_b32 s30, 7340032
  v_mfma_f32_16x16x32_bf16 v[60:63], v[188:191], v[116:119], v[60:63]
  s_waitcnt lgkmcnt(2)
  s_mov_b32 s31, 131072
  s_mov_b32 s34, 7340032
  v_mfma_f32_16x16x32_bf16 v[28:31], v[208:211], v[76:79], v[28:31]
  s_add_u32 m0, s45, 16384
  s_mov_b32 s68, 0
  v_mfma_f32_16x16x32_bf16 v[28:31], v[220:223], v[80:83], v[28:31]
  ds_read_b128 v[112:115], v1 offset:47104
  s_mov_b32 s35, 131072
  v_mfma_f32_16x16x32_bf16 v[32:35], v[220:223], v[84:87], v[32:35]
  buffer_load_dwordx4 v11, s[20:23], s68 offen nt lds
  s_mov_b32 s38, 7340032
  s_mov_b32 s39, 131072
  v_mfma_f32_16x16x32_bf16 v[32:35], v[208:211], v[88:91], v[32:35]
  s_add_u32 m0, s45, 20480
  s_add_u32 s68, s68, 393216
  s_mov_b32 s42, 4194304
  v_mfma_f32_16x16x32_bf16 v[40:43], v[212:215], v[88:91], v[40:43]
  ds_read_b128 v[108:111], v1 offset:48128
  s_mov_b32 s43, 131072
  v_mfma_f32_16x16x32_bf16 v[40:43], v[224:227], v[84:87], v[40:43]
  buffer_load_dwordx4 v11, s[20:23], s68 offen nt lds
  v_add_u32 v9, s78, v1
  v_and_b32 v4, 0xffffbfff, v4
  v_mfma_f32_16x16x32_bf16 v[36:39], v[224:227], v[80:83], v[36:39]
  ds_read_b128 v[120:123], v13 offset:30720
  v_and_b32 v5, 0xffffbfff, v5
  v_mfma_f32_16x16x32_bf16 v[36:39], v[212:215], v[76:79], v[36:39]
  v_and_b32 v7, 0xffffbfff, v7
  v_and_b32 v8, 0xffffbfff, v8
  v_mfma_f32_16x16x32_bf16 v[44:47], v[216:219], v[76:79], v[44:47]
  s_add_u32 m0, s45, 24576
  s_add_u32 s68, s68, 393216
  s_lshl_b32 s52, s44, 13
  v_mfma_f32_16x16x32_bf16 v[44:47], v[228:231], v[80:83], v[44:47]
  ds_read_b128 v[116:119], v13 offset:31744
  s_and_b32 s52, s52, 8192
  v_mfma_f32_16x16x32_bf16 v[48:51], v[228:231], v[84:87], v[48:51]
  buffer_load_dwordx4 v11, s[20:23], s68 offen nt lds
  v_add_u32 v22, s52, v1
  v_add_u32 v23, s52, v2
  v_mfma_f32_16x16x32_bf16 v[48:51], v[216:219], v[88:91], v[48:51]
  s_waitcnt vmcnt(11) lgkmcnt(8)
  s_barrier
  v_mfma_f32_16x16x32_bf16 v[68:71], v[216:219], v[96:99], v[68:71]
  ds_read_b128 v[76:79], v1 offset:49152
  s_add_u32 m0, s45, 28672
  s_add_u32 s68, s68, 393216
  v_mfma_f32_16x16x32_bf16 v[68:71], v[228:231], v[92:95], v[68:71]
  buffer_load_dwordx4 v11, s[20:23], s68 offen nt lds
  v_and_b32 v14, 15, v0
  v_lshlrev_b32 v14, 7, v14
  v_mfma_f32_16x16x32_bf16 v[60:63], v[224:227], v[92:95], v[60:63]
  v_mfma_f32_16x16x32_bf16 v[60:63], v[212:215], v[96:99], v[60:63]
  s_waitcnt lgkmcnt(1)
  ds_read_b128 v[80:83], v1 offset:50176
  v_mfma_f32_16x16x32_bf16 v[28:31], v[232:235], v[100:103], v[28:31]
  v_mfma_f32_16x16x32_bf16 v[28:31], v[244:247], v[104:107], v[28:31]
  v_mfma_f32_16x16x32_bf16 v[32:35], v[244:247], v[108:111], v[32:35]
  ds_read_b128 v[84:87], v1 offset:57344
  v_mfma_f32_16x16x32_bf16 v[32:35], v[232:235], v[112:115], v[32:35]
  v_mfma_f32_16x16x32_bf16 v[40:43], v[236:239], v[112:115], v[40:43]
  v_mfma_f32_16x16x32_bf16 v[40:43], v[248:251], v[108:111], v[40:43]
  ds_read_b128 v[88:91], v1 offset:58368
  v_mfma_f32_16x16x32_bf16 v[36:39], v[248:251], v[104:107], v[36:39]
  v_mfma_f32_16x16x32_bf16 v[36:39], v[236:239], v[100:103], v[36:39]
  v_mfma_f32_16x16x32_bf16 v[44:47], v[240:243], v[100:103], v[44:47]
  ds_read_b128 v[92:95], v1 offset:51200
  v_mfma_f32_16x16x32_bf16 v[44:47], v[252:255], v[104:107], v[44:47]
  v_mfma_f32_16x16x32_bf16 v[48:51], v[252:255], v[108:111], v[48:51]
  v_mfma_f32_16x16x32_bf16 v[48:51], v[240:243], v[112:115], v[48:51]
  ds_read_b128 v[96:99], v1 offset:52224
  v_mfma_f32_16x16x32_bf16 v[68:71], v[240:243], v[120:123], v[68:71]
  v_mfma_f32_16x16x32_bf16 v[68:71], v[252:255], v[116:119], v[68:71]
  v_mfma_f32_16x16x32_bf16 v[60:63], v[248:251], v[116:119], v[60:63]
  ds_read_b128 v[100:103], v1 offset:59392
  v_mfma_f32_16x16x32_bf16 v[60:63], v[236:239], v[120:123], v[60:63]
  s_waitcnt lgkmcnt(3)
  v_mfma_f32_16x16x32_bf16 v[52:55], a[0:3], v[76:79], 0
  v_mfma_f32_16x16x32_bf16 v[52:55], a[12:15], v[80:83], v[52:55]
  ds_read_b128 v[104:107], v1 offset:60416
  v_mfma_f32_16x16x32_bf16 v[56:59], a[12:15], v[88:91], 0
  s_nop 2
  v_cvt_pk_bf16_f32 v60, v60, v61
  v_cvt_pk_bf16_f32 v61, v62, v63
HOP2:
  s_cbranch_execz HOP6
  v_cvt_pk_bf16_f32 v62, v68, v69
  v_cvt_pk_bf16_f32 v63, v70, v71
  ds_write_b128 v17, v[60:63] offset:1024
  v_mfma_f32_16x16x32_bf16 v[56:59], a[0:3], v[84:87], v[56:59]
  v_cvt_pk_bf16_f32 v28, v28, v29
  v_cvt_pk_bf16_f32 v29, v30, v31
  v_mfma_f32_16x16x32_bf16 v[64:67], a[4:7], v[84:87], 0
  ds_read_b128 v[108:111], v1 offset:53248
  v_mfma_f32_16x16x32_bf16 v[64:67], a[16:19], v[88:91], v[64:67]
  ds_write_b64 v18, v[28:29] offset:6144
  v_mfma_f32_16x16x32_bf16 v[60:63], a[16:19], v[80:83], 0
  v_cvt_pk_bf16_f32 v36, v36, v37
  v_cvt_pk_bf16_f32 v37, v38, v39
  v_mfma_f32_16x16x32_bf16 v[60:63], a[4:7], v[76:79], v[60:63]
  ds_read_b128 v[112:115], v1 offset:54272
  v_cvt_pk_bf16_f32 v38, v44, v45
  v_mfma_f32_16x16x32_bf16 v[68:71], a[8:11], v[76:79], 0
  v_cvt_pk_bf16_f32 v39, v46, v47
  v_mfma_f32_16x16x32_bf16 v[68:71], a[20:23], v[80:83], v[68:71]
  ds_write_b128 v17, v[36:39] offset:7168
  v_mfma_f32_16x16x32_bf16 v[72:75], a[20:23], v[88:91], 0
  ds_read_b128 v[76:79], v1 offset:61440
  v_cvt_pk_bf16_f32 v32, v32, v33
  v_mfma_f32_16x16x32_bf16 v[72:75], a[8:11], v[84:87], v[72:75]
  s_waitcnt lgkmcnt(6)
  v_cvt_pk_bf16_f32 v33, v34, v35
  v_mfma_f32_16x16x32_bf16 v[52:55], a[24:27], v[92:95], v[52:55]
  s_add_u32 m0, s70, 65536
  s_add_u32 s69, s61, 98304
  v_mfma_f32_16x16x32_bf16 v[52:55], a[36:39], v[96:99], v[52:55]
  ds_read_b128 v[80:83], v1 offset:62464
  v_mfma_f32_16x16x32_bf16 v[56:59], a[36:39], v[104:107], v[56:59]
  buffer_load_dwordx4 v12, s[8:11], s69 offen offset:0 sc1 lds
  ds_write_b64 v18, v[32:33] offset:12288
  v_mfma_f32_16x16x32_bf16 v[56:59], a[24:27], v[100:103], v[56:59]
  v_cvt_pk_bf16_f32 v40, v40, v41
  v_cvt_pk_bf16_f32 v41, v42, v43
  v_mfma_f32_16x16x32_bf16 v[64:67], a[28:31], v[100:103], v[64:67]
  ds_read_b128 v[88:91], v1 offset:55296
  v_cvt_pk_bf16_f32 v42, v48, v49
  v_mfma_f32_16x16x32_bf16 v[64:67], a[40:43], v[104:107], v[64:67]
  v_cvt_pk_bf16_f32 v43, v50, v51
  v_mfma_f32_16x16x32_bf16 v[60:63], a[40:43], v[96:99], v[60:63]
  buffer_load_dwordx4 v12, s[8:11], s69 offen offset:1024 sc1 lds
  ds_write_b128 v17, v[40:43] offset:13312
  v_mfma_f32_16x16x32_bf16 v[60:63], a[28:31], v[92:95], v[60:63]
  ds_read_b128 v[84:87], v1 offset:56320
  v_mfma_f32_16x16x32_bf16 v[68:71], a[32:35], v[92:95], v[68:71]
  s_bitcmp1_b32 s44, 0
  s_mov_b32 s52, 6144
  s_cselect_b32 s52, 12288, s52
  s_mov_b32 s53, 0
  s_cselect_b32 s53, 6144, s53
  v_mfma_f32_16x16x32_bf16 v[68:71], a[44:47], v[96:99], v[68:71]
  v_add_u32 v116, s52, v19
  v_add_u32 v117, s53, v19
  v_mfma_f32_16x16x32_bf16 v[72:75], a[44:47], v[104:107], v[72:75]
  ds_read_b128 v[92:95], v1 offset:63488
  v_add_u32 v118, s52, v20
  v_mfma_f32_16x16x32_bf16 v[72:75], a[32:35], v[100:103], v[72:75]
  s_waitcnt lgkmcnt(5)
  buffer_load_dwordx4 v12, s[8:11], s69 offen offset:2048 sc1 lds
  v_add_u32 v119, s53, v20
  v_mfma_f32_16x16x32_bf16 v[52:55], a[48:51], v[108:111], v[52:55]
  s_waitcnt vmcnt(11) lgkmcnt(2)
  s_barrier
  v_mfma_f32_16x16x32_bf16 v[52:55], a[60:63], v[112:115], v[52:55]
  ds_read_b128 v[96:99], v1 offset:64512
  ds_write_b16 v21, v16
  v_mfma_f32_16x16x32_bf16 v[56:59], a[60:63], v[80:83], v[56:59]
  ds_read_b128 v[28:31], v116
  v_mfma_f32_16x16x32_bf16 v[56:59], a[48:51], v[76:79], v[56:59]
  ds_read_b128 v[32:35], v117 offset:1024
  v_mfma_f32_16x16x32_bf16 v[64:67], a[52:55], v[76:79], v[64:67]
  ds_read_b128 v[104:107], v2 offset:49152
  v_mfma_f32_16x16x32_bf16 v[64:67], a[64:67], v[80:83], v[64:67]
  buffer_load_dwordx4 v12, s[8:11], s69 offen offset:3072 sc1 lds
  ds_read_b128 v[36:39], v116 offset:1024
  v_mfma_f32_16x16x32_bf16 v[60:63], a[64:67], v[112:115], v[60:63]
  ds_read_b64_tr_b16 v[40:41], v119 offset:2048
  v_mfma_f32_16x16x32_bf16 v[60:63], a[52:55], v[108:111], v[60:63]
  ds_read_b128 v[100:103], v2 offset:50176
  v_mfma_f32_16x16x32_bf16 v[68:71], a[56:59], v[108:111], v[68:71]
  s_add_u32 m0, s70, 98304
  s_add_u32 s69, s58, 163840
  v_mfma_f32_16x16x32_bf16 v[68:71], a[68:71], v[112:115], v[68:71]
  buffer_load_dwordx4 v12, s[8:11], s69 offen offset:0 sc1 lds
  ds_read_b64_tr_b16 v[42:43], v118 offset:2048
  v_mfma_f32_16x16x32_bf16 v[72:75], a[68:71], v[80:83], v[72:75]
  ds_read_b128 v[108:111], v2 offset:57344
  v_mfma_f32_16x16x32_bf16 v[72:75], a[56:59], v[76:79], v[72:75]
  s_waitcnt lgkmcnt(9)
  ds_read_b64_tr_b16 v[44:45], v119 offset:2056
  v_mfma_f32_16x16x32_bf16 v[52:55], a[72:75], v[88:91], v[52:55]
  ds_read_b64_tr_b16 v[46:47], v118 offset:2056
  v_mfma_f32_16x16x32_bf16 v[52:55], a[84:87], v[84:87], v[52:55]
  ds_read_b128 v[112:115], v2 offset:58368
  v_mfma_f32_16x16x32_bf16 v[56:59], a[84:87], v[96:99], v[56:59]
  buffer_load_dwordx4 v12, s[8:11], s69 offen offset:1024 sc1 lds
  v_mfma_f32_16x16x32_bf16 v[56:59], a[72:75], v[92:95], v[56:59]
  v_mfma_f32_16x16x32_bf16 v[64:67], a[76:79], v[92:95], v[64:67]
  ds_read_b128 v[80:83], v2 offset:51200
  v_mfma_f32_16x16x32_bf16 v[64:67], a[88:91], v[96:99], v[64:67]
  s_waitcnt lgkmcnt(2)
  v_mfma_f32_16x16x32_bf16 v[116:119], v[32:35], v[28:31], 0
  v_mfma_f32_16x16x32_bf16 v[120:123], v[36:39], v[28:31], 0
  v_mfma_f32_16x16x32_bf16 v[60:63], a[88:91], v[84:87], v[60:63]
  v_mfma_f32_16x16x32_bf16 v[60:63], a[76:79], v[88:91], v[60:63]
  ds_read_b128 v[76:79], v2 offset:52224
  v_mfma_f32_16x16x32_bf16 v[68:71], a[80:83], v[88:91], v[68:71]
  buffer_load_dwordx4 v12, s[8:11], s69 offen offset:2048 sc1 lds
  v_mfma_f32_16x16x32_bf16 v[68:71], a[92:95], v[84:87], v[68:71]
  s_nop 1
  v_cndmask_b32 v48, v116, v120, s[80:81]
  v_cndmask_b32 v49, v117, v121, s[82:83]
  v_mfma_f32_16x16x32_bf16 v[72:75], a[92:95], v[96:99], v[72:75]
  ds_read_b128 v[88:91], v2 offset:59392
  v_cndmask_b32 v50, v118, v122, s[84:85]
  v_mfma_f32_16x16x32_bf16 v[72:75], a[80:83], v[92:95], v[72:75]
  s_waitcnt lgkmcnt(3)
  v_cndmask_b32 v51, v119, v123, s[86:87]
  v_cndmask_b32 v48, v48, v49, s[88:89]
  v_mfma_f32_16x16x32_bf16 v[52:55], a[96:99], v[104:107], v[52:55]
  buffer_load_dwordx4 v12, s[8:11], s69 offen offset:3072 sc1 lds
  v_cndmask_b32 v49, v50, v51, s[88:89]
  v_mul_f32 v48, 0x3e8293ee, v48
  v_mfma_f32_16x16x32_bf16 v[52:55], a[108:111], v[100:103], v[52:55]
  ds_read_b128 v[84:87], v2 offset:60416
  v_mul_f32 v49, 0x3e8293ee, v49
  v_mfma_f32_16x16x32_bf16 v[56:59], a[108:111], v[112:115], v[56:59]
  v_mov_b32 v50, 0xce6e6b28
  v_cndmask_b32 v48, v48, v50, s[90:91]
  v_mfma_f32_16x16x32_bf16 v[56:59], a[96:99], v[108:111], v[56:59]
  s_add_u32 m0, s45, 81920
  s_mov_b32 s68, 1572864
  v_mfma_f32_16x16x32_bf16 v[64:67], a[100:103], v[108:111], v[64:67]
  ds_read_b128 v[96:99], v2 offset:53248
  v_cndmask_b32 v49, v49, v50, s[92:93]
  v_mfma_f32_16x16x32_bf16 v[64:67], a[112:115], v[112:115], v[64:67]
  buffer_load_dwordx4 v11, s[20:23], s68 offen nt lds
  v_max_f32 v50, v48, v49
  v_mov_b32 v51, v50
  v_mfma_f32_16x16x32_bf16 v[60:63], a[112:115], v[100:103], v[60:63]
  s_nop 0
  v_permlane16_swap_b32 v50, v51
  v_mfma_f32_16x16x32_bf16 v[60:63], a[100:103], v[104:107], v[60:63]
  ds_read_b128 v[92:95], v2 offset:54272
  v_max_f32 v50, v50, v51
  v_mfma_f32_16x16x32_bf16 v[68:71], a[104:107], v[104:107], v[68:71]
  v_mov_b32 v51, v50
  v_mfma_f32_16x16x32_bf16 v[68:71], a[116:119], v[100:103], v[68:71]
  s_add_u32 m0, s45, 86016
  s_add_u32 s68, s68, 393216
  v_mfma_f32_16x16x32_bf16 v[72:75], a[116:119], v[112:115], v[72:75]
  ds_read_b128 v[104:107], v2 offset:61440
  v_mfma_f32_16x16x32_bf16 v[72:75], a[104:107], v[108:111], v[72:75]
  s_waitcnt lgkmcnt(3)
  buffer_load_dwordx4 v11, s[20:23], s68 offen nt lds
  v_mfma_f32_16x16x32_bf16 v[52:55], a[120:123], v[80:83], v[52:55]
  v_permlane32_swap_b32 v50, v51
  v_mfma_f32_16x16x32_bf16 v[52:55], a[132:135], v[76:79], v[52:55]
  ds_read_b128 v[100:103], v2 offset:62464
  v_max_f32 v50, v50, v51
  v_mfma_f32_16x16x32_bf16 v[56:59], a[132:135], v[84:87], v[56:59]
  s_add_u32 m0, s45, 90112
  s_add_u32 s68, s68, 393216
  v_sub_f32 v48, v48, v50
  v_mfma_f32_16x16x32_bf16 v[56:59], a[120:123], v[88:91], v[56:59]
  buffer_load_dwordx4 v11, s[20:23], s68 offen nt lds
  v_sub_f32 v49, v49, v50
  v_mfma_f32_16x16x32_bf16 v[64:67], a[124:127], v[88:91], v[64:67]
  ds_read_b128 v[112:115], v2 offset:55296
  v_mfma_f32_16x16x32_bf16 v[64:67], a[136:139], v[84:87], v[64:67]
  v_exp_f32 v48, v48
  v_mfma_f32_16x16x32_bf16 v[60:63], a[136:139], v[76:79], v[60:63]
  s_add_u32 m0, s45, 94208
  s_add_u32 s68, s68, 393216
  v_mfma_f32_16x16x32_bf16 v[60:63], a[124:127], v[80:83], v[60:63]
  ds_read_b128 v[108:111], v2 offset:56320
  v_mfma_f32_16x16x32_bf16 v[68:71], a[128:131], v[80:83], v[68:71]
  buffer_load_dwordx4 v11, s[20:23], s68 offen nt lds
  v_exp_f32 v49, v49
  v_mfma_f32_16x16x32_bf16 v[68:71], a[140:143], v[76:79], v[68:71]
  v_add_f32 v50, v48, v49
  v_mov_b32 v51, v50
  v_mfma_f32_16x16x32_bf16 v[72:75], a[140:143], v[84:87], v[72:75]
  ds_read_b128 v[80:83], v2 offset:63488
  v_mfma_f32_16x16x32_bf16 v[72:75], a[128:131], v[88:91], v[72:75]
  s_waitcnt lgkmcnt(3)
  v_permlane16_swap_b32 v50, v51
  v_mfma_f32_16x16x32_bf16 v[52:55], a[144:147], v[96:99], v[52:55]
  v_add_f32 v50, v50, v51
  v_mov_b32 v51, v50
  v_mfma_f32_16x16x32_bf16 v[52:55], a[156:159], v[92:95], v[52:55]
  ds_read_b128 v[76:79], v2 offset:64512
  v_mfma_f32_16x16x32_bf16 v[56:59], a[156:159], v[100:103], v[56:59]
  v_permlane32_swap_b32 v50, v51
  v_mfma_f32_16x16x32_bf16 v[56:59], a[144:147], v[104:107], v[56:59]
  s_waitcnt vmcnt(8) lgkmcnt(15)
  s_barrier
  v_mfma_f32_16x16x32_bf16 v[64:67], a[148:151], v[104:107], v[64:67]
  ds_read_b128 v[84:87], v1 offset:0
  v_add_f32 v50, v50, v51
  v_mfma_f32_16x16x32_bf16 v[64:67], a[160:163], v[100:103], v[64:67]
  v_rcp_f32 v50, v50
  v_mfma_f32_16x16x32_bf16 v[60:63], a[160:163], v[92:95], v[60:63]
  v_mul_f32 v48, v48, v50
  v_mul_f32 v49, v49, v50
  v_mfma_f32_16x16x32_bf16 v[60:63], a[148:151], v[96:99], v[60:63]
  ds_read_b128 v[88:91], v1 offset:1024
  v_cvt_pk_bf16_f32 v48, v48, v48
  v_mfma_f32_16x16x32_bf16 v[68:71], a[152:155], v[96:99], v[68:71]
  v_cvt_pk_bf16_f32 v49, v49, v49
  v_and_b32 v28, v24, v48
  v_mfma_f32_16x16x32_bf16 v[68:71], a[164:167], v[92:95], v[68:71]
  v_and_b32 v29, v25, v49
  v_and_b32 v30, v26, v48
  v_mfma_f32_16x16x32_bf16 v[72:75], a[164:167], v[100:103], v[72:75]
  ds_read_b128 v[96:99], v1 offset:8192
  v_and_b32 v31, v27, v49
  v_mfma_f32_16x16x32_bf16 v[72:75], a[152:155], v[104:107], v[72:75]
  s_waitcnt lgkmcnt(3)
  v_mfma_f32_16x16x32_bf16 v[32:35], v[40:43], v[28:31], 0
  v_mfma_f32_16x16x32_bf16 v[36:39], v[44:47], v[28:31], 0
  v_mfma_f32_16x16x32_bf16 v[52:55], a[168:171], v[112:115], v[52:55]
  v_mfma_f32_16x16x32_bf16 v[52:55], a[180:183], v[108:111], v[52:55]
  ds_read_b128 v[92:95], v1 offset:9216
  v_mfma_f32_16x16x32_bf16 v[56:59], a[180:183], v[76:79], v[56:59]
  v_mfma_f32_16x16x32_bf16 v[56:59], a[168:171], v[80:83], v[56:59]
  s_nop 1
  v_cvt_pk_bf16_f32 v116, v32, v33
  v_cvt_pk_bf16_f32 v117, v34, v35
  v_mfma_f32_16x16x32_bf16 v[64:67], a[172:175], v[80:83], v[64:67]
  ds_read_b128 v[100:103], v1 offset:2048
  v_cvt_pk_bf16_f32 v118, v36, v37
  v_mfma_f32_16x16x32_bf16 v[64:67], a[184:187], v[76:79], v[64:67]
  v_cvt_pk_bf16_f32 v119, v38, v39
  v_mfma_f32_16x16x32_bf16 v[60:63], a[184:187], v[108:111], v[60:63]
  buffer_store_dwordx4 v[116:119], v1, s[8:11], s73 offen sc1
  v_mfma_f32_16x16x32_bf16 v[60:63], a[172:175], v[112:115], v[60:63]
  ds_read_b128 v[104:107], v1 offset:3072
  s_add_u32 s73, s73, 65536
  v_mfma_f32_16x16x32_bf16 v[68:71], a[176:179], v[112:115], v[68:71]
  v_mfma_f32_16x16x32_bf16 v[68:71], a[188:191], v[108:111], v[68:71]
  v_mfma_f32_16x16x32_bf16 v[72:75], a[188:191], v[76:79], v[72:75]
  ds_read_b128 v[112:115], v1 offset:10240
  v_mfma_f32_16x16x32_bf16 v[72:75], a[176:179], v[80:83], v[72:75]
  s_waitcnt lgkmcnt(3)
  v_mfma_f32_16x16x32_bf16 v[52:55], a[192:195], v[84:87], v[52:55]
  v_mfma_f32_16x16x32_bf16 v[52:55], a[204:207], v[88:91], v[52:55]
  ds_read_b128 v[108:111], v1 offset:11264
  v_mfma_f32_16x16x32_bf16 v[56:59], a[204:207], v[92:95], v[56:59]
  v_mfma_f32_16x16x32_bf16 v[56:59], a[192:195], v[96:99], v[56:59]
  v_mfma_f32_16x16x32_bf16 v[64:67], a[196:199], v[96:99], v[64:67]
  ds_read_b128 v[76:79], v1 offset:4096
  v_lshrrev_b32 v40, 4, v0
  v_lshlrev_b32 v40, 4, v40
  v_mfma_f32_16x16x32_bf16 v[64:67], a[208:211], v[92:95], v[64:67]
  v_add_u32 v41, 160768, v40
  v_mfma_f32_16x16x32_bf16 v[60:63], a[208:211], v[88:91], v[60:63]
  ds_read_b64_tr_b16 v[116:117], v3 offset:16384
  v_mfma_f32_16x16x32_bf16 v[60:63], a[196:199], v[84:87], v[60:63]
  ds_read_b128 v[80:83], v1 offset:5120
  ds_read_b64_tr_b16 v[118:119], v3 offset:18432
  v_mfma_f32_16x16x32_bf16 v[68:71], a[200:203], v[84:87], v[68:71]
  ds_read_b128 v[28:31], v41 offset:0
  v_mfma_f32_16x16x32_bf16 v[68:71], a[212:215], v[88:91], v[68:71]
  v_mfma_f32_16x16x32_bf16 v[72:75], a[212:215], v[92:95], v[72:75]
  ds_read_b128 v[84:87], v1 offset:12288
  v_mfma_f32_16x16x32_bf16 v[72:75], a[200:203], v[96:99], v[72:75]
  s_waitcnt lgkmcnt(6)
  s_add_u32 m0, s70, 32768
  s_add_u32 s69, s59, 163840
  v_mfma_f32_16x16x32_bf16 v[52:55], a[216:219], v[100:103], v[52:55]
  buffer_load_dwordx4 v12, s[8:11], s69 offen offset:0 sc1 lds
  v_mfma_f32_16x16x32_bf16 v[52:55], a[228:231], v[104:107], v[52:55]
  ds_read_b128 v[88:91], v1 offset:13312
  v_mfma_f32_16x16x32_bf16 v[56:59], a[228:231], v[108:111], v[56:59]
  v_mfma_f32_16x16x32_bf16 v[56:59], a[216:219], v[112:115], v[56:59]
  v_mfma_f32_16x16x32_bf16 v[64:67], a[220:223], v[112:115], v[64:67]
  ds_read_b128 v[92:95], v1 offset:6144
  ds_read_b64_tr_b16 v[120:121], v3 offset:20480
  v_mfma_f32_16x16x32_bf16 v[64:67], a[232:235], v[108:111], v[64:67]
  ds_read_b64_tr_b16 v[122:123], v3 offset:22528
  s_waitcnt lgkmcnt(5)
  v_mfma_f32_16x16x32_bf16 v[36:39], v[116:119], v[28:31], 0
  v_mfma_f32_16x16x32_bf16 v[60:63], a[232:235], v[104:107], v[60:63]
  buffer_load_dwordx4 v12, s[8:11], s69 offen offset:1024 sc1 lds
  ds_read_b128 v[32:35], v41 offset:64
  v_mfma_f32_16x16x32_bf16 v[60:63], a[220:223], v[100:103], v[60:63]
  ds_read_b128 v[96:99], v1 offset:7168
  v_mfma_f32_16x16x32_bf16 v[68:71], a[224:227], v[100:103], v[68:71]
  v_mfma_f32_16x16x32_bf16 v[68:71], a[236:239], v[104:107], v[68:71]
  v_mfma_f32_16x16x32_bf16 v[72:75], a[236:239], v[108:111], v[72:75]
  ds_read_b128 v[100:103], v1 offset:14336
  v_mfma_f32_16x16x32_bf16 v[72:75], a[224:227], v[112:115], v[72:75]
  s_waitcnt lgkmcnt(6)
  buffer_load_dwordx4 v12, s[8:11], s69 offen offset:2048 sc1 lds
  v_mfma_f32_16x16x32_bf16 v[52:55], a[240:243], v[76:79], v[52:55]
  v_mfma_f32_16x16x32_bf16 v[52:55], v[124:127], v[80:83], v[52:55]
  ds_read_b128 v[104:107], v1 offset:15360
  v_mfma_f32_16x16x32_bf16 v[56:59], v[124:127], v[88:91], v[56:59]
  ds_read_b64_tr_b16 v[116:117], v3 offset:24576
  v_and_b32 v42, 15, v0
  v_mfma_f32_16x16x32_bf16 v[56:59], a[240:243], v[84:87], v[56:59]
  ds_read_b64_tr_b16 v[118:119], v3 offset:26624
  buffer_load_dwordx4 v12, s[8:11], s69 offen offset:3072 sc1 lds
  s_waitcnt lgkmcnt(5)
  v_mfma_f32_16x16x32_bf16 v[36:39], v[120:123], v[32:35], v[36:39]
  v_lshl_add_u32 v40, v42, 27, v40
  s_lshr_b32 s52, s2, 2
  v_mfma_f32_16x16x32_bf16 v[64:67], a[244:247], v[84:87], v[64:67]
  ds_read_b128 v[108:111], v2 offset:0
  ds_read_b128 v[28:31], v41 offset:128
  v_mfma_f32_16x16x32_bf16 v[64:67], v[128:131], v[88:91], v[64:67]
  s_lshl_b32 s54, s52, 7
  s_lshl_b32 s52, s52, 8
  s_and_b32 s53, s2, 3
  v_mfma_f32_16x16x32_bf16 v[60:63], v[128:131], v[80:83], v[60:63]
  s_add_u32 m0, s70, 49152
  s_add_u32 s69, s60, 163840
  s_mul_i32 s79, s53, 24576
  v_mfma_f32_16x16x32_bf16 v[60:63], a[244:247], v[76:79], v[60:63]
  ds_read_b128 v[112:115], v2 offset:1024
  s_add_u32 s52, s52, s79
  v_mfma_f32_16x16x32_bf16 v[68:71], a[248:251], v[76:79], v[68:71]
  buffer_load_dwordx4 v12, s[8:11], s69 offen offset:0 sc1 lds
  s_lshl_b32 s79, s44, 6
  s_add_u32 s52, s52, s79
  v_mfma_f32_16x16x32_bf16 v[68:71], v[132:135], v[80:83], v[68:71]
  s_add_u32 s52, s52, 8192
  s_lshl_b32 s53, s53, 2
  s_add_u32 s54, s54, s53
  v_mfma_f32_16x16x32_bf16 v[72:75], v[132:135], v[88:91], v[72:75]
  ds_read_b128 v[76:79], v2 offset:8192
  s_add_u32 s54, s54, 720896
  v_mfma_f32_16x16x32_bf16 v[72:75], a[248:251], v[84:87], v[72:75]
  s_waitcnt lgkmcnt(6)
  s_cmp_eq_u32 s44, 0
  s_cselect_b32 s79, s54, 1073741824
  v_mfma_f32_16x16x32_bf16 v[52:55], v[136:139], v[92:95], v[52:55]
  ds_read_b64_tr_b16 v[120:121], v3 offset:28672
  v_mfma_f32_16x16x32_bf16 v[52:55], v[148:151], v[96:99], v[52:55]
  ds_read_b128 v[80:83], v2 offset:9216
  ds_read_b64_tr_b16 v[122:123], v3 offset:30720
  s_waitcnt lgkmcnt(5)
  v_mfma_f32_16x16x32_bf16 v[36:39], v[116:119], v[28:31], v[36:39]
  v_mfma_f32_16x16x32_bf16 v[56:59], v[148:151], v[104:107], v[56:59]
  buffer_load_dwordx4 v12, s[8:11], s69 offen offset:1024 sc1 lds
  ds_read_b128 v[32:35], v41 offset:192
  v_mfma_f32_16x16x32_bf16 v[56:59], v[136:139], v[100:103], v[56:59]
  v_mfma_f32_16x16x32_bf16 v[64:67], v[140:143], v[100:103], v[64:67]
  ds_read_b128 v[88:91], v2 offset:2048
  v_mfma_f32_16x16x32_bf16 v[64:67], v[152:155], v[104:107], v[64:67]
  v_mfma_f32_16x16x32_bf16 v[60:63], v[152:155], v[96:99], v[60:63]
  buffer_load_dwordx4 v12, s[8:11], s69 offen offset:2048 sc1 lds
  v_mfma_f32_16x16x32_bf16 v[60:63], v[140:143], v[92:95], v[60:63]
  ds_read_b128 v[84:87], v2 offset:3072
  v_mfma_f32_16x16x32_bf16 v[68:71], v[144:147], v[92:95], v[68:71]
  v_mfma_f32_16x16x32_bf16 v[68:71], v[156:159], v[96:99], v[68:71]
  s_waitcnt vmcnt(8)
  s_barrier
  v_mfma_f32_16x16x32_bf16 v[72:75], v[156:159], v[104:107], v[72:75]
  ds_read_b128 v[92:95], v2 offset:10240
  ds_read_b64_tr_b16 v[116:117], v6 offset:16384
  v_mfma_f32_16x16x32_bf16 v[72:75], v[144:147], v[100:103], v[72:75]
  s_waitcnt lgkmcnt(6)
  ds_read_b64_tr_b16 v[118:119], v6 offset:18432
  s_waitcnt lgkmcnt(5)
  v_mfma_f32_16x16x32_bf16 v[36:39], v[120:123], v[32:35], v[36:39]
  v_mfma_f32_16x16x32_bf16 v[52:55], v[160:163], v[108:111], v[52:55]
  buffer_load_dwordx4 v12, s[8:11], s69 offen offset:3072 sc1 lds
  ds_read_b128 v[28:31], v41 offset:256
  v_mfma_f32_16x16x32_bf16 v[52:55], v[172:175], v[112:115], v[52:55]
  ds_read_b128 v[96:99], v2 offset:11264
  v_mfma_f32_16x16x32_bf16 v[56:59], v[172:175], v[80:83], v[56:59]
  v_mfma_f32_16x16x32_bf16 v[56:59], v[160:163], v[76:79], v[56:59]
  s_add_u32 m0, s70, 114688
  s_add_u32 s69, s61, 163840
  v_mfma_f32_16x16x32_bf16 v[64:67], v[164:167], v[76:79], v[64:67]
  ds_read_b128 v[104:107], v2 offset:4096
  v_mfma_f32_16x16x32_bf16 v[64:67], v[176:179], v[80:83], v[64:67]
  buffer_load_dwordx4 v12, s[8:11], s69 offen offset:0 sc1 lds
  v_mfma_f32_16x16x32_bf16 v[60:63], v[176:179], v[112:115], v[60:63]
  v_mfma_f32_16x16x32_bf16 v[60:63], v[164:167], v[108:111], v[60:63]
  ds_read_b128 v[100:103], v2 offset:5120
  v_mfma_f32_16x16x32_bf16 v[68:71], v[168:171], v[108:111], v[68:71]
  ds_read_b64_tr_b16 v[120:121], v6 offset:20480
  v_mfma_f32_16x16x32_bf16 v[68:71], v[180:183], v[112:115], v[68:71]
  ds_read_b64_tr_b16 v[122:123], v6 offset:22528
  buffer_load_dwordx4 v12, s[8:11], s69 offen offset:1024 sc1 lds
  s_waitcnt lgkmcnt(5)
  v_mfma_f32_16x16x32_bf16 v[36:39], v[116:119], v[28:31], v[36:39]
  v_mfma_f32_16x16x32_bf16 v[72:75], v[180:183], v[80:83], v[72:75]
  ds_read_b128 v[108:111], v2 offset:12288
  ds_read_b128 v[32:35], v41 offset:320
  v_mfma_f32_16x16x32_bf16 v[72:75], v[168:171], v[76:79], v[72:75]
  s_waitcnt lgkmcnt(6)
  v_mfma_f32_16x16x32_bf16 v[52:55], v[184:187], v[88:91], v[52:55]
  v_mfma_f32_16x16x32_bf16 v[52:55], v[196:199], v[84:87], v[52:55]
  ds_read_b128 v[112:115], v2 offset:13312
  v_mfma_f32_16x16x32_bf16 v[56:59], v[196:199], v[96:99], v[56:59]
  buffer_load_dwordx4 v12, s[8:11], s69 offen offset:2048 sc1 lds
  v_mfma_f32_16x16x32_bf16 v[56:59], v[184:187], v[92:95], v[56:59]
  v_mfma_f32_16x16x32_bf16 v[64:67], v[188:191], v[92:95], v[64:67]
  ds_read_b128 v[80:83], v2 offset:6144
  v_mfma_f32_16x16x32_bf16 v[64:67], v[200:203], v[96:99], v[64:67]
  v_mfma_f32_16x16x32_bf16 v[60:63], v[200:203], v[84:87], v[60:63]
  ds_read_b64_tr_b16 v[116:117], v6 offset:24576
  v_mfma_f32_16x16x32_bf16 v[60:63], v[188:191], v[88:91], v[60:63]
  ds_read_b128 v[76:79], v2 offset:7168
  ds_read_b64_tr_b16 v[118:119], v6 offset:26624
  s_waitcnt lgkmcnt(5)
  v_mfma_f32_16x16x32_bf16 v[36:39], v[120:123], v[32:35], v[36:39]
  v_mfma_f32_16x16x32_bf16 v[68:71], v[192:195], v[88:91], v[68:71]
  buffer_load_dwordx4 v12, s[8:11], s69 offen offset:3072 sc1 lds
  ds_read_b128 v[28:31], v41 offset:384
  v_mfma_f32_16x16x32_bf16 v[68:71], v[204:207], v[84:87], v[68:71]
  v_mfma_f32_16x16x32_bf16 v[72:75], v[204:207], v[96:99], v[72:75]
  ds_read_b128 v[88:91], v2 offset:14336
  v_mfma_f32_16x16x32_bf16 v[72:75], v[192:195], v[92:95], v[72:75]
  s_waitcnt lgkmcnt(6)
  s_add_u32 m0, s70, 0
  s_add_u32 s69, s58, 229376
  v_mfma_f32_16x16x32_bf16 v[52:55], v[208:211], v[104:107], v[52:55]
  buffer_load_dwordx4 v12, s[8:11], s69 offen offset:0 sc1 lds
  v_mfma_f32_16x16x32_bf16 v[52:55], v[220:223], v[100:103], v[52:55]
  ds_read_b128 v[84:87], v2 offset:15360
  v_mfma_f32_16x16x32_bf16 v[56:59], v[220:223], v[112:115], v[56:59]
  v_mfma_f32_16x16x32_bf16 v[56:59], v[208:211], v[108:111], v[56:59]
  v_mfma_f32_16x16x32_bf16 v[64:67], v[212:215], v[108:111], v[64:67]
  ds_read_b128 v[96:99], v2 offset:32768
  ds_read_b64_tr_b16 v[120:121], v6 offset:28672
  v_mfma_f32_16x16x32_bf16 v[64:67], v[224:227], v[112:115], v[64:67]
  ds_read_b64_tr_b16 v[122:123], v6 offset:30720
  s_waitcnt lgkmcnt(5)
  v_mfma_f32_16x16x32_bf16 v[36:39], v[116:119], v[28:31], v[36:39]
  v_mfma_f32_16x16x32_bf16 v[60:63], v[224:227], v[100:103], v[60:63]
  buffer_load_dwordx4 v12, s[8:11], s69 offen offset:1024 sc1 lds
  ds_read_b128 v[32:35], v41 offset:448
  v_mfma_f32_16x16x32_bf16 v[60:63], v[212:215], v[104:107], v[60:63]
  ds_read_b128 v[92:95], v2 offset:33792
  v_mfma_f32_16x16x32_bf16 v[68:71], v[216:219], v[104:107], v[68:71]
  v_mfma_f32_16x16x32_bf16 v[68:71], v[228:231], v[100:103], v[68:71]
  v_mfma_f32_16x16x32_bf16 v[72:75], v[228:231], v[112:115], v[72:75]
  ds_read_b128 v[104:107], v2 offset:40960
  v_mfma_f32_16x16x32_bf16 v[72:75], v[216:219], v[108:111], v[72:75]
  s_waitcnt lgkmcnt(6)
  buffer_load_dwordx4 v12, s[8:11], s69 offen offset:2048 sc1 lds
  v_mfma_f32_16x16x32_bf16 v[52:55], v[232:235], v[80:83], v[52:55]
  v_mfma_f32_16x16x32_bf16 v[52:55], v[244:247], v[76:79], v[52:55]
  ds_read_b128 v[100:103], v2 offset:41984
  v_mfma_f32_16x16x32_bf16 v[56:59], v[244:247], v[84:87], v[56:59]
  v_mfma_f32_16x16x32_bf16 v[56:59], v[232:235], v[88:91], v[56:59]
  buffer_load_dwordx4 v12, s[8:11], s69 offen offset:3072 sc1 lds
  s_waitcnt lgkmcnt(3)
  v_mfma_f32_16x16x32_bf16 v[36:39], v[120:123], v[32:35], v[36:39]
  v_mfma_f32_16x16x32_bf16 v[64:67], v[236:239], v[88:91], v[64:67]
  ds_read_b128 v[112:115], v2 offset:34816
  v_mfma_f32_16x16x32_bf16 v[64:67], v[248:251], v[84:87], v[64:67]
  v_mfma_f32_16x16x32_bf16 v[60:63], v[248:251], v[76:79], v[60:63]
  v_mfma_f32_16x16x32_bf16 v[60:63], v[236:239], v[80:83], v[60:63]
  ds_read_b128 v[108:111], v2 offset:35840
  v_mfma_f32_16x16x32_bf16 v[68:71], v[240:243], v[80:83], v[68:71]
  s_nop 0
  buffer_store_dwordx4 v[36:39], v40, s[8:11], s52 offen sc1
  v_mfma_f32_16x16x32_bf16 v[68:71], v[252:255], v[76:79], v[68:71]
  v_mfma_f32_16x16x32_bf16 v[72:75], v[252:255], v[84:87], v[72:75]
  ds_read_b128 v[80:83], v2 offset:43008
  v_mfma_f32_16x16x32_bf16 v[72:75], v[240:243], v[88:91], v[72:75]
  s_waitcnt lgkmcnt(3)
  v_mfma_f32_16x16x32_bf16 v[28:31], a[0:3], v[96:99], 0
  v_mfma_f32_16x16x32_bf16 v[28:31], a[12:15], v[92:95], v[28:31]
  ds_read_b128 v[76:79], v2 offset:44032
  v_mfma_f32_16x16x32_bf16 v[32:35], a[12:15], v[100:103], 0
  v_mfma_f32_16x16x32_bf16 v[32:35], a[0:3], v[104:107], v[32:35]
  v_cvt_pk_bf16_f32 v52, v52, v53
  v_cvt_pk_bf16_f32 v53, v54, v55
  v_mfma_f32_16x16x32_bf16 v[40:43], a[4:7], v[104:107], 0
  ds_read_b128 v[84:87], v2 offset:36864
  v_mfma_f32_16x16x32_bf16 v[40:43], a[16:19], v[100:103], v[40:43]
  ds_write_b64 v18, v[52:53] offset:0
  v_mfma_f32_16x16x32_bf16 v[36:39], a[16:19], v[92:95], 0
  v_cvt_pk_bf16_f32 v60, v60, v61
  v_cvt_pk_bf16_f32 v61, v62, v63
  v_mfma_f32_16x16x32_bf16 v[36:39], a[4:7], v[96:99], v[36:39]
  ds_read_b128 v[88:91], v2 offset:37888
  v_cvt_pk_bf16_f32 v62, v68, v69
  v_cvt_pk_bf16_f32 v63, v70, v71
  v_mfma_f32_16x16x32_bf16 v[44:47], a[8:11], v[96:99], 0
  ds_write_b128 v17, v[60:63] offset:1024
  v_mfma_f32_16x16x32_bf16 v[44:47], a[20:23], v[92:95], v[44:47]
  v_cvt_pk_bf16_f32 v56, v56, v57
  v_cvt_pk_bf16_f32 v57, v58, v59
  v_mfma_f32_16x16x32_bf16 v[48:51], a[20:23], v[100:103], 0
  ds_read_b128 v[96:99], v2 offset:45056
  v_mfma_f32_16x16x32_bf16 v[48:51], a[8:11], v[104:107], v[48:51]
  s_waitcnt lgkmcnt(5)
  ds_write_b64 v18, v[56:57] offset:6144
  v_mfma_f32_16x16x32_bf16 v[28:31], a[24:27], v[112:115], v[28:31]
  v_cvt_pk_bf16_f32 v64, v64, v65
  v_cvt_pk_bf16_f32 v65, v66, v67
  v_mfma_f32_16x16x32_bf16 v[28:31], a[36:39], v[108:111], v[28:31]
  ds_read_b128 v[92:95], v2 offset:46080
  v_cvt_pk_bf16_f32 v66, v72, v73
  v_mfma_f32_16x16x32_bf16 v[32:35], a[36:39], v[76:79], v[32:35]
  v_cvt_pk_bf16_f32 v67, v74, v75
  v_mfma_f32_16x16x32_bf16 v[32:35], a[24:27], v[80:83], v[32:35]
  ds_write_b128 v17, v[64:67] offset:7168
  v_mfma_f32_16x16x32_bf16 v[40:43], a[28:31], v[80:83], v[40:43]
  ds_read_b128 v[100:103], v2 offset:38912
  v_mfma_f32_16x16x32_bf16 v[40:43], a[40:43], v[76:79], v[40:43]
  s_bitcmp1_b32 s44, 0
  s_mov_b32 s52, 0
  s_cselect_b32 s52, 6144, s52
  s_mov_b32 s53, 12288
  s_cselect_b32 s53, 0, s53
  v_mfma_f32_16x16x32_bf16 v[36:39], a[40:43], v[108:111], v[36:39]
  v_add_u32 v116, s52, v19
  v_add_u32 v117, s53, v19
  v_mfma_f32_16x16x32_bf16 v[36:39], a[28:31], v[112:115], v[36:39]
  ds_read_b128 v[104:107], v2 offset:39936
  v_add_u32 v118, s52, v20
  v_mfma_f32_16x16x32_bf16 v[44:47], a[32:35], v[112:115], v[44:47]
  v_add_u32 v119, s53, v20
  v_mfma_f32_16x16x32_bf16 v[44:47], a[44:47], v[108:111], v[44:47]
  s_waitcnt vmcnt(13) lgkmcnt(2)
  s_barrier
  v_mfma_f32_16x16x32_bf16 v[48:51], a[44:47], v[76:79], v[48:51]
  ds_read_b128 v[112:115], v2 offset:47104
  v_mfma_f32_16x16x32_bf16 v[48:51], a[32:35], v[80:83], v[48:51]
  s_waitcnt lgkmcnt(4)
  s_add_u32 m0, s45, 16384
  s_add_u32 s68, s67, 0
  s_and_b32 s68, s68, 7
  s_mul_i32 s68, s68, 262144
  v_mfma_f32_16x16x32_bf16 v[28:31], a[48:51], v[84:87], v[28:31]
  buffer_load_dwordx4 v10, s[16:19], s68 offen lds
  ds_read_b128 v[52:55], v116
  v_mfma_f32_16x16x32_bf16 v[28:31], a[60:63], v[88:91], v[28:31]
  ds_read_b128 v[108:111], v2 offset:48128
  v_mfma_f32_16x16x32_bf16 v[32:35], a[60:63], v[92:95], v[32:35]
  ds_read_b128 v[56:59], v117 offset:1024
  v_mfma_f32_16x16x32_bf16 v[32:35], a[48:51], v[96:99], v[32:35]
  s_add_u32 m0, s45, 20480
  s_add_u32 s68, s68, 65536
  v_mfma_f32_16x16x32_bf16 v[40:43], a[52:55], v[96:99], v[40:43]
  ds_read_b128 v[76:79], v1 offset:32768
  v_mfma_f32_16x16x32_bf16 v[40:43], a[64:67], v[92:95], v[40:43]
  buffer_load_dwordx4 v10, s[16:19], s68 offen lds
  ds_read_b128 v[60:63], v116 offset:1024
  v_mfma_f32_16x16x32_bf16 v[36:39], a[64:67], v[88:91], v[36:39]
  ds_read_b64_tr_b16 v[64:65], v119 offset:2048
  v_mfma_f32_16x16x32_bf16 v[36:39], a[52:55], v[84:87], v[36:39]
  ds_read_b128 v[80:83], v1 offset:33792
  v_mfma_f32_16x16x32_bf16 v[44:47], a[56:59], v[84:87], v[44:47]
  s_add_u32 m0, s45, 24576
  s_add_u32 s68, s68, 65536
HOP3:
  s_cbranch_execz HOP7
  v_mfma_f32_16x16x32_bf16 v[44:47], a[68:71], v[88:91], v[44:47]
  buffer_load_dwordx4 v10, s[16:19], s68 offen lds
  ds_read_b64_tr_b16 v[66:67], v118 offset:2048
  v_mfma_f32_16x16x32_bf16 v[48:51], a[68:71], v[92:95], v[48:51]
  ds_read_b128 v[84:87], v1 offset:40960
  v_mfma_f32_16x16x32_bf16 v[48:51], a[56:59], v[96:99], v[48:51]
  s_waitcnt lgkmcnt(7)
  ds_read_b64_tr_b16 v[68:69], v119 offset:2056
  v_mfma_f32_16x16x32_bf16 v[28:31], a[72:75], v[100:103], v[28:31]
  s_add_u32 m0, s45, 28672
  s_add_u32 s68, s68, 65536
  v_mfma_f32_16x16x32_bf16 v[28:31], a[84:87], v[104:107], v[28:31]
  ds_read_b128 v[88:91], v1 offset:41984
  v_mfma_f32_16x16x32_bf16 v[32:35], a[84:87], v[108:111], v[32:35]
  buffer_load_dwordx4 v10, s[16:19], s68 offen lds
  ds_read_b64_tr_b16 v[70:71], v118 offset:2056
  v_mfma_f32_16x16x32_bf16 v[32:35], a[72:75], v[112:115], v[32:35]
  v_mfma_f32_16x16x32_bf16 v[40:43], a[76:79], v[112:115], v[40:43]
  ds_read_b128 v[92:95], v1 offset:34816
  v_mfma_f32_16x16x32_bf16 v[40:43], a[88:91], v[108:111], v[40:43]
  v_mfma_f32_16x16x32_bf16 v[36:39], a[88:91], v[104:107], v[36:39]
  s_add_u32 m0, s70, 65536
  s_add_u32 s69, s59, 229376
  v_mfma_f32_16x16x32_bf16 v[36:39], a[76:79], v[100:103], v[36:39]
  ds_read_b128 v[96:99], v1 offset:35840
  s_waitcnt lgkmcnt(2)
  v_mfma_f32_16x16x32_bf16 v[116:119], v[56:59], v[52:55], 0
  v_mfma_f32_16x16x32_bf16 v[120:123], v[60:63], v[52:55], 0
  v_mfma_f32_16x16x32_bf16 v[44:47], a[80:83], v[100:103], v[44:47]
  buffer_load_dwordx4 v12, s[8:11], s69 offen offset:0 sc1 lds
  v_mfma_f32_16x16x32_bf16 v[44:47], a[92:95], v[104:107], v[44:47]
  v_mfma_f32_16x16x32_bf16 v[48:51], a[92:95], v[108:111], v[48:51]
  ds_read_b128 v[100:103], v1 offset:43008
  v_mfma_f32_16x16x32_bf16 v[48:51], a[80:83], v[112:115], v[48:51]
  s_waitcnt lgkmcnt(4)
  s_nop 0
  v_cndmask_b32 v72, v116, v120, s[80:81]
  v_cndmask_b32 v73, v117, v121, s[82:83]
  v_mfma_f32_16x16x32_bf16 v[28:31], a[96:99], v[76:79], v[28:31]
  buffer_load_dwordx4 v12, s[8:11], s69 offen offset:1024 sc1 lds
  v_cndmask_b32 v74, v118, v122, s[84:85]
  v_cndmask_b32 v75, v119, v123, s[86:87]
  v_mfma_f32_16x16x32_bf16 v[28:31], a[108:111], v[80:83], v[28:31]
  ds_read_b128 v[104:107], v1 offset:44032
  v_cndmask_b32 v72, v72, v73, s[88:89]
  v_mfma_f32_16x16x32_bf16 v[32:35], a[108:111], v[88:91], v[32:35]
  v_cndmask_b32 v73, v74, v75, s[88:89]
  v_mul_f32 v72, 0x3e8293ee, v72
  v_mfma_f32_16x16x32_bf16 v[32:35], a[96:99], v[84:87], v[32:35]
  v_mul_f32 v73, 0x3e8293ee, v73
  v_max_f32 v74, v72, v73
  v_mfma_f32_16x16x32_bf16 v[40:43], a[100:103], v[84:87], v[40:43]
  ds_read_b128 v[108:111], v1 offset:36864
  v_mov_b32 v75, v74
  v_mfma_f32_16x16x32_bf16 v[40:43], a[112:115], v[88:91], v[40:43]
  buffer_load_dwordx4 v12, s[8:11], s69 offen offset:2048 sc1 lds
  v_permlane16_swap_b32 v74, v75
  v_mfma_f32_16x16x32_bf16 v[36:39], a[112:115], v[80:83], v[36:39]
  v_max_f32 v74, v74, v75
  v_mov_b32 v75, v74
  v_mfma_f32_16x16x32_bf16 v[36:39], a[100:103], v[76:79], v[36:39]
  ds_read_b128 v[112:115], v1 offset:37888
  v_mfma_f32_16x16x32_bf16 v[44:47], a[104:107], v[76:79], v[44:47]
  v_permlane32_swap_b32 v74, v75
  v_mfma_f32_16x16x32_bf16 v[44:47], a[116:119], v[80:83], v[44:47]
  v_max_f32 v74, v74, v75
  v_sub_f32 v72, v72, v74
  v_mfma_f32_16x16x32_bf16 v[48:51], a[116:119], v[88:91], v[48:51]
  ds_read_b128 v[76:79], v1 offset:45056
  v_sub_f32 v73, v73, v74
  v_mfma_f32_16x16x32_bf16 v[48:51], a[104:107], v[84:87], v[48:51]
  s_waitcnt lgkmcnt(3)
  buffer_load_dwordx4 v12, s[8:11], s69 offen offset:3072 sc1 lds
  v_mfma_f32_16x16x32_bf16 v[28:31], a[120:123], v[92:95], v[28:31]
  v_exp_f32 v72, v72
  v_mfma_f32_16x16x32_bf16 v[28:31], a[132:135], v[96:99], v[28:31]
  ds_read_b128 v[80:83], v1 offset:46080
  v_mfma_f32_16x16x32_bf16 v[32:35], a[132:135], v[104:107], v[32:35]
  s_add_u32 m0, s45, 81920
  s_add_u32 s68, s67, 1
  s_and_b32 s68, s68, 7
  s_mul_i32 s68, s68, 262144
  v_mfma_f32_16x16x32_bf16 v[32:35], a[120:123], v[100:103], v[32:35]
  buffer_load_dwordx4 v10, s[16:19], s68 offen lds
  v_exp_f32 v73, v73
  v_mfma_f32_16x16x32_bf16 v[40:43], a[124:127], v[100:103], v[40:43]
  ds_read_b128 v[88:91], v1 offset:38912
  v_add_f32 v74, v72, v73
  v_mfma_f32_16x16x32_bf16 v[40:43], a[136:139], v[104:107], v[40:43]
  v_mov_b32 v75, v74
  v_mfma_f32_16x16x32_bf16 v[36:39], a[136:139], v[96:99], v[36:39]
  s_add_u32 m0, s45, 86016
  s_add_u32 s68, s68, 65536
  v_mfma_f32_16x16x32_bf16 v[36:39], a[124:127], v[92:95], v[36:39]
  ds_read_b128 v[84:87], v1 offset:39936
  v_mfma_f32_16x16x32_bf16 v[44:47], a[128:131], v[92:95], v[44:47]
  buffer_load_dwordx4 v10, s[16:19], s68 offen lds
  v_permlane16_swap_b32 v74, v75
  v_mfma_f32_16x16x32_bf16 v[44:47], a[140:143], v[96:99], v[44:47]
  v_add_f32 v74, v74, v75
  v_mov_b32 v75, v74
  v_mfma_f32_16x16x32_bf16 v[48:51], a[140:143], v[104:107], v[48:51]
  ds_read_b128 v[92:95], v1 offset:47104
  v_mfma_f32_16x16x32_bf16 v[48:51], a[128:131], v[100:103], v[48:51]
  s_waitcnt lgkmcnt(3)
  v_permlane32_swap_b32 v74, v75
  v_mfma_f32_16x16x32_bf16 v[28:31], a[144:147], v[108:111], v[28:31]
  s_add_u32 m0, s45, 90112
  s_add_u32 s68, s68, 65536
  v_add_f32 v74, v74, v75
  v_mfma_f32_16x16x32_bf16 v[28:31], a[156:159], v[112:115], v[28:31]
  ds_read_b128 v[96:99], v1 offset:48128
  v_mfma_f32_16x16x32_bf16 v[32:35], a[156:159], v[80:83], v[32:35]
  buffer_load_dwordx4 v10, s[16:19], s68 offen lds
  v_rcp_f32 v74, v74
  v_mfma_f32_16x16x32_bf16 v[32:35], a[144:147], v[76:79], v[32:35]
  s_waitcnt vmcnt(11)
  s_barrier
  v_mfma_f32_16x16x32_bf16 v[40:43], a[148:151], v[76:79], v[40:43]
  ds_read_b128 v[104:107], v1 offset:49152
  v_mul_f32 v72, v72, v74
  v_add_u32 v15, s46, v0
  s_mov_b64 exec, 1
  buffer_store_dword v15, v0, s[8:11], s79 offen offset:0 sc1
  s_mov_b64 exec, -1
  v_mfma_f32_16x16x32_bf16 v[40:43], a[160:163], v[80:83], v[40:43]
  s_add_u32 m0, s45, 94208
  s_add_u32 s68, s68, 65536
  v_mul_f32 v73, v73, v74
  v_mfma_f32_16x16x32_bf16 v[36:39], a[160:163], v[112:115], v[36:39]
  buffer_load_dwordx4 v10, s[16:19], s68 offen lds
  v_cvt_pk_bf16_f32 v72, v72, v72
  v_cvt_pk_bf16_f32 v73, v73, v73
  v_mfma_f32_16x16x32_bf16 v[36:39], a[148:151], v[108:111], v[36:39]
  ds_read_b128 v[100:103], v1 offset:50176
  v_and_b32 v52, v24, v72
  v_mfma_f32_16x16x32_bf16 v[44:47], a[152:155], v[108:111], v[44:47]
  v_and_b32 v53, v25, v73
  v_and_b32 v54, v26, v72
  v_mfma_f32_16x16x32_bf16 v[44:47], a[164:167], v[112:115], v[44:47]
  v_and_b32 v55, v27, v73
  v_mfma_f32_16x16x32_bf16 v[48:51], a[164:167], v[80:83], v[48:51]
  ds_read_b128 v[108:111], v1 offset:57344
  v_mfma_f32_16x16x32_bf16 v[56:59], v[64:67], v[52:55], 0
  v_mfma_f32_16x16x32_bf16 v[60:63], v[68:71], v[52:55], 0
  v_mfma_f32_16x16x32_bf16 v[48:51], a[152:155], v[76:79], v[48:51]
  s_waitcnt lgkmcnt(3)
  s_add_u32 m0, s70, 98304
  s_add_u32 s69, s60, 229376
  v_mfma_f32_16x16x32_bf16 v[28:31], a[168:171], v[88:91], v[28:31]
  buffer_load_dwordx4 v12, s[8:11], s69 offen offset:0 sc1 lds
  v_mfma_f32_16x16x32_bf16 v[28:31], a[180:183], v[84:87], v[28:31]
  ds_read_b128 v[112:115], v1 offset:58368
  v_mfma_f32_16x16x32_bf16 v[32:35], a[180:183], v[96:99], v[32:35]
  v_cvt_pk_bf16_f32 v116, v56, v57
  v_cvt_pk_bf16_f32 v117, v58, v59
  v_mfma_f32_16x16x32_bf16 v[32:35], a[168:171], v[92:95], v[32:35]
  v_cvt_pk_bf16_f32 v118, v60, v61
  v_cvt_pk_bf16_f32 v119, v62, v63
  v_mfma_f32_16x16x32_bf16 v[40:43], a[172:175], v[92:95], v[40:43]
  ds_read_b128 v[80:83], v1 offset:51200
  v_mfma_f32_16x16x32_bf16 v[40:43], a[184:187], v[96:99], v[40:43]
  buffer_load_dwordx4 v12, s[8:11], s69 offen offset:1024 sc1 lds
  buffer_store_dwordx4 v[116:119], v1, s[8:11], s73 offen sc1
  v_mfma_f32_16x16x32_bf16 v[36:39], a[184:187], v[84:87], v[36:39]
  s_add_u32 s73, s73, 65536
  v_mfma_f32_16x16x32_bf16 v[36:39], a[172:175], v[88:91], v[36:39]
  ds_read_b128 v[76:79], v1 offset:52224
  v_mfma_f32_16x16x32_bf16 v[44:47], a[176:179], v[88:91], v[44:47]
  v_mfma_f32_16x16x32_bf16 v[44:47], a[188:191], v[84:87], v[44:47]
  buffer_load_dwordx4 v12, s[8:11], s69 offen offset:2048 sc1 lds
  v_mfma_f32_16x16x32_bf16 v[48:51], a[188:191], v[96:99], v[48:51]
  ds_read_b128 v[88:91], v1 offset:59392
  v_mfma_f32_16x16x32_bf16 v[48:51], a[176:179], v[92:95], v[48:51]
  s_waitcnt lgkmcnt(3)
  v_mfma_f32_16x16x32_bf16 v[28:31], a[192:195], v[104:107], v[28:31]
  v_mfma_f32_16x16x32_bf16 v[28:31], a[204:207], v[100:103], v[28:31]
  ds_read_b128 v[84:87], v1 offset:60416
  v_mfma_f32_16x16x32_bf16 v[32:35], a[204:207], v[112:115], v[32:35]
  buffer_load_dwordx4 v12, s[8:11], s69 offen offset:3072 sc1 lds
  v_mfma_f32_16x16x32_bf16 v[32:35], a[192:195], v[108:111], v[32:35]
  v_mfma_f32_16x16x32_bf16 v[40:43], a[196:199], v[108:111], v[40:43]
  ds_read_b128 v[96:99], v1 offset:53248
  v_mfma_f32_16x16x32_bf16 v[40:43], a[208:211], v[112:115], v[40:43]
  v_mfma_f32_16x16x32_bf16 v[36:39], a[208:211], v[100:103], v[36:39]
  v_lshrrev_b32 v116, 3, v0
  v_bfe_u32 v117, v116, 1, 2
  v_mfma_f32_16x16x32_bf16 v[36:39], a[196:199], v[104:107], v[36:39]
  ds_read_b128 v[92:95], v1 offset:54272
  v_bfe_u32 v118, v0, 1, 2
  v_mfma_f32_16x16x32_bf16 v[44:47], a[200:203], v[104:107], v[44:47]
  v_xor_b32 v117, v117, v118
  s_lshl_b32 s52, s44, 3
  v_mfma_f32_16x16x32_bf16 v[44:47], a[212:215], v[100:103], v[44:47]
  v_add_u32 v116, s52, v116
  v_mul_u32_u24 v116, 7168, v116
  v_mfma_f32_16x16x32_bf16 v[48:51], a[212:215], v[112:115], v[48:51]
  ds_read_b128 v[104:107], v1 offset:61440
  v_and_b32 v118, 1, v0
  v_mfma_f32_16x16x32_bf16 v[48:51], a[200:203], v[108:111], v[48:51]
  s_waitcnt lgkmcnt(3)
  v_lshl_add_u32 v116, v118, 4, v116
  s_and_b32 s52, s2, 7
  v_mfma_f32_16x16x32_bf16 v[28:31], a[216:219], v[80:83], v[28:31]
  s_mul_i32 s52, s52, 896
  v_add_u32 v116, s52, v116
  v_lshlrev_b32 v118, 5, v117
  v_mfma_f32_16x16x32_bf16 v[28:31], a[228:231], v[76:79], v[28:31]
  ds_read_b128 v[100:103], v1 offset:62464
  s_and_b32 s53, s2, 24
  v_mfma_f32_16x16x32_bf16 v[32:35], a[228:231], v[84:87], v[32:35]
  s_lshl_b32 s52, s53, 5
  v_add3_u32 v16, v116, v118, s52
  s_lshr_b32 s52, 0x0b070602, s53
  v_mfma_f32_16x16x32_bf16 v[32:35], a[216:219], v[88:91], v[32:35]
  s_and_b32 s52, s52, 15
  s_lshl_b32 s52, s52, 6
  v_add_u32 v118, s52, v118
  v_mfma_f32_16x16x32_bf16 v[40:43], a[220:223], v[88:91], v[40:43]
  ds_read_b128 v[112:115], v1 offset:55296
  s_lshr_b32 s52, 0x15140706, s53
  v_mfma_f32_16x16x32_bf16 v[40:43], a[232:235], v[84:87], v[40:43]
  s_and_b32 s52, s52, 31
  s_lshl_b32 s52, s52, 5
  v_mov_b32 v119, s52
  v_mfma_f32_16x16x32_bf16 v[36:39], a[232:235], v[76:79], v[36:39]
  v_cmp_gt_u32 vcc, 2, v117
  s_nop 1
  v_cndmask_b32 v118, v119, v118, vcc
  v_mfma_f32_16x16x32_bf16 v[36:39], a[220:223], v[80:83], v[36:39]
  ds_read_b128 v[108:111], v1 offset:56320
  v_add_u32 v11, v116, v118
  v_mfma_f32_16x16x32_bf16 v[44:47], a[224:227], v[80:83], v[44:47]
  v_add_u32 v117, 1, v117
  v_lshrrev_b32 v117, 2, v117
  v_mfma_f32_16x16x32_bf16 v[44:47], a[236:239], v[76:79], v[44:47]
  v_lshl_add_u32 v11, v117, 30, v11
  v_mfma_f32_16x16x32_bf16 v[48:51], a[236:239], v[84:87], v[48:51]
  ds_read_b128 v[80:83], v1 offset:63488
  v_mfma_f32_16x16x32_bf16 v[48:51], a[224:227], v[88:91], v[48:51]
  s_waitcnt lgkmcnt(3)
  v_mfma_f32_16x16x32_bf16 v[28:31], a[240:243], v[96:99], v[28:31]
  v_mfma_f32_16x16x32_bf16 v[28:31], v[124:127], v[92:95], v[28:31]
  ds_read_b128 v[76:79], v1 offset:64512
  v_mfma_f32_16x16x32_bf16 v[32:35], v[124:127], v[100:103], v[32:35]
  v_mfma_f32_16x16x32_bf16 v[32:35], a[240:243], v[104:107], v[32:35]
  s_waitcnt vmcnt(23)
  s_barrier
  v_mfma_f32_16x16x32_bf16 v[40:43], a[244:247], v[104:107], v[40:43]
  ds_read_b128 v[84:87], v2 offset:49152
  s_add_u32 m0, s45, 32768
  s_add_u32 s68, s67, 2
  s_and_b32 s68, s68, 7
  s_mul_i32 s68, s68, 262144
  v_mfma_f32_16x16x32_bf16 v[40:43], v[128:131], v[100:103], v[40:43]
  buffer_load_dwordx4 v10, s[16:19], s68 offen lds
  v_mfma_f32_16x16x32_bf16 v[36:39], v[128:131], v[92:95], v[36:39]
  v_mfma_f32_16x16x32_bf16 v[36:39], a[244:247], v[96:99], v[36:39]
  ds_read_b128 v[88:91], v2 offset:50176
  v_mfma_f32_16x16x32_bf16 v[44:47], a[248:251], v[96:99], v[44:47]
  v_mfma_f32_16x16x32_bf16 v[44:47], v[132:135], v[92:95], v[44:47]
  s_add_u32 m0, s45, 36864
  s_add_u32 s68, s68, 65536
  v_mfma_f32_16x16x32_bf16 v[48:51], v[132:135], v[100:103], v[48:51]
  ds_read_b128 v[96:99], v2 offset:57344
  v_mfma_f32_16x16x32_bf16 v[48:51], a[248:251], v[104:107], v[48:51]
  s_waitcnt lgkmcnt(3)
  buffer_load_dwordx4 v10, s[16:19], s68 offen lds
  v_mfma_f32_16x16x32_bf16 v[28:31], v[136:139], v[112:115], v[28:31]
  v_mfma_f32_16x16x32_bf16 v[28:31], v[148:151], v[108:111], v[28:31]
  ds_read_b128 v[92:95], v2 offset:58368
  v_mfma_f32_16x16x32_bf16 v[32:35], v[148:151], v[76:79], v[32:35]
  s_add_u32 m0, s45, 40960
  s_add_u32 s68, s68, 65536
  v_mfma_f32_16x16x32_bf16 v[32:35], v[136:139], v[80:83], v[32:35]
  buffer_load_dwordx4 v10, s[16:19], s68 offen lds
  v_mfma_f32_16x16x32_bf16 v[40:43], v[140:143], v[80:83], v[40:43]
  ds_read_b128 v[100:103], v2 offset:51200
  v_mfma_f32_16x16x32_bf16 v[40:43], v[152:155], v[76:79], v[40:43]
  s_add_u32 m0, s45, 45056
  s_add_u32 s68, s68, 65536
  v_mfma_f32_16x16x32_bf16 v[36:39], v[152:155], v[108:111], v[36:39]
  buffer_load_dwordx4 v10, s[16:19], s68 offen lds
  v_mfma_f32_16x16x32_bf16 v[36:39], v[140:143], v[112:115], v[36:39]
  ds_read_b128 v[104:107], v2 offset:52224
  v_mfma_f32_16x16x32_bf16 v[44:47], v[144:147], v[112:115], v[44:47]
  v_mfma_f32_16x16x32_bf16 v[44:47], v[156:159], v[108:111], v[44:47]
  v_mfma_f32_16x16x32_bf16 v[48:51], v[156:159], v[76:79], v[48:51]
  ds_read_b128 v[112:115], v2 offset:59392
  s_cmp_gt_u32 s44, 1
  s_cbranch_scc1 TH4_adaLN_cond__sliding_local_dilated__swiglu_ffn__prompt_kernel
  s_cmp_eq_u32 s44, 0
  s_cselect_b64 s[4:5], s[28:29], s[32:33]
  s_lshr_b32 s57, s2, 3
  s_mul_i32 s57, s57, 57344
  s_and_b32 vcc_lo, s2, 7
  s_mul_i32 vcc_lo, vcc_lo, 896
  s_add_u32 s57, s57, vcc_lo
  v_lshrrev_b32 v15, 3, v0
  v_mul_u32_u24 v15, 6144, v15
  v_lshl_add_u32 v15, v0, 7, v15
  s_mov_b32 exec_lo, 0x7f7f7f7f
  s_mov_b32 exec_hi, 0x7f7f7f7f
  buffer_load_dword a253, v15, s[4:7], s57 offen
  s_mov_b64 exec, -1
TH4_adaLN_cond__sliding_local_dilated__swiglu_ffn__prompt_kernel:
  v_mfma_f32_16x16x32_bf16 v[48:51], v[144:147], v[80:83], v[48:51]
  s_waitcnt lgkmcnt(3)
  v_mfma_f32_16x16x32_bf16 v[28:31], v[160:163], v[84:87], v[28:31]
  v_mfma_f32_16x16x32_bf16 v[28:31], v[172:175], v[88:91], v[28:31]
  ds_read_b128 v[108:111], v2 offset:60416
  v_mfma_f32_16x16x32_bf16 v[32:35], v[172:175], v[92:95], v[32:35]
  v_mfma_f32_16x16x32_bf16 v[32:35], v[160:163], v[96:99], v[32:35]
  v_mfma_f32_16x16x32_bf16 v[40:43], v[164:167], v[96:99], v[40:43]
  ds_read_b128 v[76:79], v2 offset:53248
  v_mfma_f32_16x16x32_bf16 v[40:43], v[176:179], v[92:95], v[40:43]
  v_mfma_f32_16x16x32_bf16 v[36:39], v[176:179], v[88:91], v[36:39]
  v_mfma_f32_16x16x32_bf16 v[36:39], v[164:167], v[84:87], v[36:39]
  ds_read_b128 v[80:83], v2 offset:54272
  v_mfma_f32_16x16x32_bf16 v[44:47], v[168:171], v[84:87], v[44:47]
  v_mfma_f32_16x16x32_bf16 v[44:47], v[180:183], v[88:91], v[44:47]
  v_mfma_f32_16x16x32_bf16 v[48:51], v[180:183], v[92:95], v[48:51]
  ds_read_b128 v[84:87], v2 offset:61440
  v_mfma_f32_16x16x32_bf16 v[48:51], v[168:171], v[96:99], v[48:51]
  s_waitcnt lgkmcnt(3)
  v_mfma_f32_16x16x32_bf16 v[28:31], v[184:187], v[100:103], v[28:31]
  v_mfma_f32_16x16x32_bf16 v[28:31], v[196:199], v[104:107], v[28:31]
  ds_read_b128 v[88:91], v2 offset:62464
  v_mfma_f32_16x16x32_bf16 v[32:35], v[196:199], v[108:111], v[32:35]
  v_mfma_f32_16x16x32_bf16 v[32:35], v[184:187], v[112:115], v[32:35]
  v_mfma_f32_16x16x32_bf16 v[40:43], v[188:191], v[112:115], v[40:43]
  ds_read_b128 v[92:95], v2 offset:55296
  v_mfma_f32_16x16x32_bf16 v[40:43], v[200:203], v[108:111], v[40:43]
  v_mfma_f32_16x16x32_bf16 v[36:39], v[200:203], v[104:107], v[36:39]
  v_mfma_f32_16x16x32_bf16 v[36:39], v[188:191], v[100:103], v[36:39]
  ds_read_b128 v[96:99], v2 offset:56320
  v_mfma_f32_16x16x32_bf16 v[44:47], v[192:195], v[100:103], v[44:47]
  v_mfma_f32_16x16x32_bf16 v[44:47], v[204:207], v[104:107], v[44:47]
  v_mfma_f32_16x16x32_bf16 v[48:51], v[204:207], v[108:111], v[48:51]
  ds_read_b128 v[100:103], v2 offset:63488
  v_mfma_f32_16x16x32_bf16 v[48:51], v[192:195], v[112:115], v[48:51]
  s_waitcnt lgkmcnt(3)
  v_mfma_f32_16x16x32_bf16 v[28:31], v[208:211], v[76:79], v[28:31]
  v_mfma_f32_16x16x32_bf16 v[28:31], v[220:223], v[80:83], v[28:31]
  ds_read_b128 v[104:107], v2 offset:64512
  v_mfma_f32_16x16x32_bf16 v[32:35], v[220:223], v[88:91], v[32:35]
  v_mfma_f32_16x16x32_bf16 v[32:35], v[208:211], v[84:87], v[32:35]
  s_waitcnt vmcnt(6)
  s_barrier
  v_add_u32 v15, s46, v0
  v_add_u32 v15, 1, v15
  s_mov_b64 exec, 1
  buffer_store_dword v15, v0, s[8:11], s74 offen offset:0 sc1
  s_mov_b64 exec, -1
  v_mfma_f32_16x16x32_bf16 v[40:43], v[212:215], v[84:87], v[40:43]
  ds_read_b128 v[108:111], v1 offset:0
  s_add_u32 m0, s45, 49152
  s_add_u32 s68, s67, 3
  s_and_b32 s68, s68, 7
  s_mul_i32 s68, s68, 262144
  v_mfma_f32_16x16x32_bf16 v[40:43], v[224:227], v[88:91], v[40:43]
  buffer_load_dwordx4 v10, s[16:19], s68 offen lds
  v_mfma_f32_16x16x32_bf16 v[36:39], v[224:227], v[80:83], v[36:39]
  s_add_u32 m0, s45, 53248
  s_add_u32 s68, s68, 65536
  v_mfma_f32_16x16x32_bf16 v[36:39], v[212:215], v[76:79], v[36:39]
  ds_read_b128 v[112:115], v1 offset:1024
  v_mfma_f32_16x16x32_bf16 v[44:47], v[216:219], v[76:79], v[44:47]
  buffer_load_dwordx4 v10, s[16:19], s68 offen lds
  v_mfma_f32_16x16x32_bf16 v[44:47], v[228:231], v[80:83], v[44:47]
  v_mfma_f32_16x16x32_bf16 v[48:51], v[228:231], v[88:91], v[48:51]
  ds_read_b128 v[76:79], v1 offset:8192
  v_mfma_f32_16x16x32_bf16 v[48:51], v[216:219], v[84:87], v[48:51]
  s_waitcnt lgkmcnt(3)
  s_add_u32 m0, s45, 57344
  s_add_u32 s68, s68, 65536
  v_mfma_f32_16x16x32_bf16 v[28:31], v[232:235], v[92:95], v[28:31]
  buffer_load_dwordx4 v10, s[16:19], s68 offen lds
  s_add_u32 m0, s45, 61440
  s_add_u32 s68, s68, 65536
  v_mfma_f32_16x16x32_bf16 v[28:31], v[244:247], v[96:99], v[28:31]
  ds_read_b128 v[80:83], v1 offset:9216
  v_mfma_f32_16x16x32_bf16 v[32:35], v[244:247], v[104:107], v[32:35]
  buffer_load_dwordx4 v10, s[16:19], s68 offen lds
  v_mfma_f32_16x16x32_bf16 v[32:35], v[232:235], v[100:103], v[32:35]
  v_mfma_f32_16x16x32_bf16 v[40:43], v[236:239], v[100:103], v[40:43]
  ds_read_b128 v[88:91], v1 offset:2048
  v_mfma_f32_16x16x32_bf16 v[40:43], v[248:251], v[104:107], v[40:43]
  v_mfma_f32_16x16x32_bf16 v[36:39], v[248:251], v[96:99], v[36:39]
  v_mfma_f32_16x16x32_bf16 v[36:39], v[236:239], v[92:95], v[36:39]
  ds_read_b128 v[84:87], v1 offset:3072
  v_mfma_f32_16x16x32_bf16 v[44:47], v[240:243], v[92:95], v[44:47]
  v_mfma_f32_16x16x32_bf16 v[44:47], v[252:255], v[96:99], v[44:47]
  v_mfma_f32_16x16x32_bf16 v[48:51], v[252:255], v[104:107], v[48:51]
  ds_read_b128 v[92:95], v1 offset:10240
  v_mfma_f32_16x16x32_bf16 v[48:51], v[240:243], v[100:103], v[48:51]
  s_waitcnt lgkmcnt(3)
  v_mfma_f32_16x16x32_bf16 v[52:55], a[0:3], v[108:111], 0
  v_mfma_f32_16x16x32_bf16 v[52:55], a[12:15], v[112:115], v[52:55]
  ds_read_b128 v[96:99], v1 offset:11264
  v_mfma_f32_16x16x32_bf16 v[56:59], a[12:15], v[80:83], 0
  v_mfma_f32_16x16x32_bf16 v[56:59], a[0:3], v[76:79], v[56:59]
  v_cvt_pk_bf16_f32 v28, v28, v29
  v_cvt_pk_bf16_f32 v29, v30, v31
  v_mfma_f32_16x16x32_bf16 v[64:67], a[4:7], v[76:79], 0
  ds_read_b128 v[104:107], v1 offset:4096
  v_mfma_f32_16x16x32_bf16 v[64:67], a[16:19], v[80:83], v[64:67]
  ds_write_b64 v18, v[28:29] offset:12288
  v_mfma_f32_16x16x32_bf16 v[60:63], a[16:19], v[112:115], 0
  v_cvt_pk_bf16_f32 v36, v36, v37
  v_cvt_pk_bf16_f32 v37, v38, v39
  v_mfma_f32_16x16x32_bf16 v[60:63], a[4:7], v[108:111], v[60:63]
  ds_read_b128 v[100:103], v1 offset:5120
  v_cvt_pk_bf16_f32 v38, v44, v45
  v_cvt_pk_bf16_f32 v39, v46, v47
  v_mfma_f32_16x16x32_bf16 v[68:71], a[8:11], v[108:111], 0
  ds_write_b128 v17, v[36:39] offset:13312
  v_mfma_f32_16x16x32_bf16 v[68:71], a[20:23], v[112:115], v[68:71]
  v_cvt_pk_bf16_f32 v32, v32, v33
  v_cvt_pk_bf16_f32 v33, v34, v35
  v_mfma_f32_16x16x32_bf16 v[72:75], a[20:23], v[80:83], 0
  ds_read_b128 v[108:111], v1 offset:12288
  v_mfma_f32_16x16x32_bf16 v[72:75], a[8:11], v[76:79], v[72:75]
  s_waitcnt lgkmcnt(5)
  ds_write_b64 v18, v[32:33] offset:0
  v_mfma_f32_16x16x32_bf16 v[52:55], a[24:27], v[88:91], v[52:55]
  v_cvt_pk_bf16_f32 v40, v40, v41
  v_cvt_pk_bf16_f32 v41, v42, v43
  v_mfma_f32_16x16x32_bf16 v[52:55], a[36:39], v[84:87], v[52:55]
  ds_read_b128 v[112:115], v1 offset:13312
  v_cvt_pk_bf16_f32 v42, v48, v49
  v_mfma_f32_16x16x32_bf16 v[56:59], a[36:39], v[96:99], v[56:59]
  v_cvt_pk_bf16_f32 v43, v50, v51
  v_mfma_f32_16x16x32_bf16 v[56:59], a[24:27], v[92:95], v[56:59]
  ds_write_b128 v17, v[40:43] offset:1024
  v_mfma_f32_16x16x32_bf16 v[64:67], a[28:31], v[92:95], v[64:67]
  ds_read_b128 v[80:83], v1 offset:6144
  v_mfma_f32_16x16x32_bf16 v[64:67], a[40:43], v[96:99], v[64:67]
  s_bitcmp1_b32 s44, 0
  s_mov_b32 s52, 12288
  s_cselect_b32 s52, 0, s52
  s_mov_b32 s53, 6144
  s_cselect_b32 s53, 12288, s53
  v_mfma_f32_16x16x32_bf16 v[60:63], a[40:43], v[84:87], v[60:63]
  v_add_u32 v116, s52, v19
  v_add_u32 v117, s53, v19
  v_mfma_f32_16x16x32_bf16 v[60:63], a[28:31], v[88:91], v[60:63]
  ds_read_b128 v[76:79], v1 offset:7168
  v_add_u32 v118, s52, v20
  v_mfma_f32_16x16x32_bf16 v[68:71], a[32:35], v[88:91], v[68:71]
  v_add_u32 v119, s53, v20
  v_mfma_f32_16x16x32_bf16 v[68:71], a[44:47], v[84:87], v[68:71]
  s_waitcnt vmcnt(19) lgkmcnt(2)
  s_barrier
  v_mfma_f32_16x16x32_bf16 v[72:75], a[44:47], v[96:99], v[72:75]
  ds_read_b128 v[88:91], v1 offset:14336
  s_add_u32 m0, s45, 114688
  s_add_u32 s68, s67, 4
  s_and_b32 s68, s68, 7
  s_mul_i32 s68, s68, 262144
  v_mfma_f32_16x16x32_bf16 v[72:75], a[32:35], v[92:95], v[72:75]
  s_waitcnt lgkmcnt(4)
  buffer_load_dwordx4 v10, s[16:19], s68 offen lds
  ds_read_b128 v[28:31], v116
  v_mfma_f32_16x16x32_bf16 v[52:55], a[48:51], v[104:107], v[52:55]
  ds_read_b64_tr_b16 a[0:1], v4 offset:16384
  ds_read_b128 v[32:35], v117 offset:1024
  v_mfma_f32_16x16x32_bf16 v[52:55], a[60:63], v[100:103], v[52:55]
  ds_read_b128 v[84:87], v1 offset:15360
  s_add_u32 m0, s45, 118784
  s_add_u32 s68, s68, 65536
  v_mfma_f32_16x16x32_bf16 v[56:59], a[60:63], v[112:115], v[56:59]
  ds_read_b64_tr_b16 a[2:3], v4 offset:18432
  buffer_load_dwordx4 v10, s[16:19], s68 offen lds
  v_mfma_f32_16x16x32_bf16 v[56:59], a[48:51], v[108:111], v[56:59]
  ds_read_b64_tr_b16 a[4:5], v5 offset:16384
  ds_read_b128 v[36:39], v116 offset:1024
  v_mfma_f32_16x16x32_bf16 v[64:67], a[52:55], v[108:111], v[64:67]
  ds_read_b128 v[96:99], v2 offset:0
  s_add_u32 m0, s45, 122880
  s_add_u32 s68, s68, 65536
  v_mfma_f32_16x16x32_bf16 v[64:67], a[64:67], v[112:115], v[64:67]
  ds_read_b64_tr_b16 a[6:7], v5 offset:18432
  buffer_load_dwordx4 v10, s[16:19], s68 offen lds
  v_mfma_f32_16x16x32_bf16 v[60:63], a[64:67], v[100:103], v[60:63]
  ds_read_b64_tr_b16 a[8:9], v4 offset:20480
  ds_read_b64_tr_b16 v[40:41], v119 offset:2048
  v_mfma_f32_16x16x32_bf16 v[60:63], a[52:55], v[104:107], v[60:63]
  ds_read_b128 v[92:95], v2 offset:1024
  s_add_u32 m0, s45, 126976
  s_add_u32 s68, s68, 65536
  v_mfma_f32_16x16x32_bf16 v[68:71], a[56:59], v[104:107], v[68:71]
  ds_read_b64_tr_b16 a[10:11], v4 offset:22528
  buffer_load_dwordx4 v10, s[16:19], s68 offen lds
  v_mfma_f32_16x16x32_bf16 v[68:71], a[68:71], v[100:103], v[68:71]
  ds_read_b64_tr_b16 a[12:13], v5 offset:20480
  ds_read_b64_tr_b16 v[42:43], v118 offset:2048
  v_mfma_f32_16x16x32_bf16 v[72:75], a[68:71], v[112:115], v[72:75]
  ds_read_b128 v[104:107], v2 offset:8192
  ds_read_b64_tr_b16 v[44:45], v119 offset:2056
  v_mfma_f32_16x16x32_bf16 v[72:75], a[56:59], v[108:111], v[72:75]
  s_waitcnt lgkmcnt(13)
  ds_read_b64_tr_b16 a[14:15], v5 offset:22528
  v_mfma_f32_16x16x32_bf16 v[52:55], a[72:75], v[80:83], v[52:55]
  ds_read_b64_tr_b16 a[16:17], v4 offset:24576
  ds_read_b64_tr_b16 v[46:47], v118 offset:2056
  v_mfma_f32_16x16x32_bf16 v[52:55], a[84:87], v[76:79], v[52:55]
  ds_read_b128 v[100:103], v2 offset:9216
  v_mfma_f32_16x16x32_bf16 v[56:59], a[84:87], v[84:87], v[56:59]
  ds_read_b64_tr_b16 a[18:19], v4 offset:26624
  v_mfma_f32_16x16x32_bf16 v[56:59], a[72:75], v[88:91], v[56:59]
  ds_read_b64_tr_b16 a[20:21], v5 offset:24576
  v_mfma_f32_16x16x32_bf16 v[64:67], a[76:79], v[88:91], v[64:67]
  ds_read_b128 v[112:115], v2 offset:2048
  v_mfma_f32_16x16x32_bf16 v[64:67], a[88:91], v[84:87], v[64:67]
  ds_read_b64_tr_b16 a[22:23], v5 offset:26624
  s_waitcnt lgkmcnt(5)
  v_mfma_f32_16x16x32_bf16 v[116:119], v[32:35], v[28:31], 0
  v_mfma_f32_16x16x32_bf16 v[120:123], v[36:39], v[28:31], 0
  v_mfma_f32_16x16x32_bf16 v[60:63], a[88:91], v[76:79], v[60:63]
  ds_read_b64_tr_b16 a[24:25], v4 offset:28672
  v_mfma_f32_16x16x32_bf16 v[60:63], a[76:79], v[80:83], v[60:63]
  ds_read_b128 v[108:111], v2 offset:3072
  v_mfma_f32_16x16x32_bf16 v[68:71], a[80:83], v[80:83], v[68:71]
  ds_read_b64_tr_b16 a[26:27], v4 offset:30720
  v_mfma_f32_16x16x32_bf16 v[68:71], a[92:95], v[76:79], v[68:71]
  ds_read_b64_tr_b16 a[28:29], v5 offset:28672
  v_cndmask_b32 v48, v116, v120, s[80:81]
  v_cndmask_b32 v49, v117, v121, s[82:83]
  v_mfma_f32_16x16x32_bf16 v[72:75], a[92:95], v[84:87], v[72:75]
  ds_read_b128 v[80:83], v2 offset:10240
  v_cndmask_b32 v50, v118, v122, s[84:85]
  v_cndmask_b32 v51, v119, v123, s[86:87]
  v_mfma_f32_16x16x32_bf16 v[72:75], a[80:83], v[88:91], v[72:75]
  s_waitcnt lgkmcnt(9)
  ds_read_b64_tr_b16 a[30:31], v5 offset:30720
  v_cndmask_b32 v48, v48, v49, s[88:89]
  v_mfma_f32_16x16x32_bf16 v[52:55], a[96:99], v[96:99], v[52:55]
  s_lshl_b32 s57, s44, 28
  s_add_u32 s57, s57, s77
  buffer_load_dword v13, v14, s[8:11], s57 offen sc1
  v_cndmask_b32 v49, v50, v51, s[88:89]
  v_mfma_f32_16x16x32_bf16 v[52:55], a[108:111], v[92:95], v[52:55]
  ds_read_b128 v[76:79], v2 offset:11264
  v_mul_f32 v48, 0x3e8293ee, v48
  v_mul_f32 v49, 0x3e8293ee, v49
  v_mfma_f32_16x16x32_bf16 v[56:59], a[108:111], v[100:103], v[56:59]
  v_max_f32 v50, v48, v49
  v_mov_b32 v51, v50
  v_mfma_f32_16x16x32_bf16 v[56:59], a[96:99], v[104:107], v[56:59]
  s_nop 0
  v_permlane16_swap_b32 v50, v51
  v_max_f32 v50, v50, v51
  v_mfma_f32_16x16x32_bf16 v[64:67], a[100:103], v[104:107], v[64:67]
  ds_read_b128 v[84:87], v2 offset:4096
  s_waitcnt vmcnt(14)
  s_barrier
  v_mfma_f32_16x16x32_bf16 v[64:67], a[112:115], v[100:103], v[64:67]
  ds_read_b64_tr_b16 a[32:33], v7 offset:16384
  s_add_u32 m0, s70, 0
  s_add_u32 s69, s61, 229376
  v_mfma_f32_16x16x32_bf16 v[60:63], a[112:115], v[92:95], v[60:63]
  ds_read_b64_tr_b16 a[34:35], v7 offset:18432
  buffer_load_dwordx4 v12, s[8:11], s69 offen offset:0 sc1 lds
  v_mov_b32 v51, v50
  v_mfma_f32_16x16x32_bf16 v[60:63], a[100:103], v[96:99], v[60:63]
  ds_read_b128 v[88:91], v2 offset:5120
  v_permlane32_swap_b32 v50, v51
  v_mfma_f32_16x16x32_bf16 v[68:71], a[104:107], v[96:99], v[68:71]
  ds_read_b64_tr_b16 a[36:37], v8 offset:16384
  v_max_f32 v50, v50, v51
  v_sub_f32 v48, v48, v50
  v_mfma_f32_16x16x32_bf16 v[68:71], a[116:119], v[92:95], v[68:71]
HOP4:
  s_cbranch_execz HOP8
  ds_read_b64_tr_b16 a[38:39], v8 offset:18432
  buffer_load_dwordx4 v12, s[8:11], s69 offen offset:1024 sc1 lds
  v_sub_f32 v49, v49, v50
  v_mfma_f32_16x16x32_bf16 v[72:75], a[116:119], v[100:103], v[72:75]
  ds_read_b128 v[96:99], v2 offset:12288
  v_exp_f32 v48, v48
  v_mfma_f32_16x16x32_bf16 v[72:75], a[104:107], v[104:107], v[72:75]
  s_waitcnt lgkmcnt(7)
  ds_read_b64_tr_b16 a[40:41], v7 offset:20480
  v_mfma_f32_16x16x32_bf16 v[52:55], a[120:123], v[112:115], v[52:55]
  ds_read_b64_tr_b16 a[42:43], v7 offset:22528
  buffer_load_dwordx4 v12, s[8:11], s69 offen offset:2048 sc1 lds
  v_mfma_f32_16x16x32_bf16 v[52:55], a[132:135], v[108:111], v[52:55]
  ds_read_b128 v[92:95], v2 offset:13312
  v_exp_f32 v49, v49
  v_mfma_f32_16x16x32_bf16 v[56:59], a[132:135], v[76:79], v[56:59]
  ds_read_b64_tr_b16 a[44:45], v8 offset:20480
  v_add_f32 v50, v48, v49
  v_mov_b32 v51, v50
  v_mfma_f32_16x16x32_bf16 v[56:59], a[120:123], v[80:83], v[56:59]
  ds_read_b64_tr_b16 a[46:47], v8 offset:22528
  buffer_load_dwordx4 v12, s[8:11], s69 offen offset:3072 sc1 lds
  v_mfma_f32_16x16x32_bf16 v[64:67], a[124:127], v[80:83], v[64:67]
  ds_read_b128 v[100:103], v2 offset:6144
  v_permlane16_swap_b32 v50, v51
  v_mfma_f32_16x16x32_bf16 v[64:67], a[136:139], v[76:79], v[64:67]
  ds_read_b64_tr_b16 a[48:49], v7 offset:24576
  v_add_f32 v50, v50, v51
  v_mov_b32 v51, v50
  v_mfma_f32_16x16x32_bf16 v[60:63], a[136:139], v[108:111], v[60:63]
  ds_read_b64_tr_b16 a[50:51], v7 offset:26624
  v_permlane32_swap_b32 v50, v51
  v_mfma_f32_16x16x32_bf16 v[60:63], a[124:127], v[112:115], v[60:63]
  ds_read_b128 v[104:107], v2 offset:7168
  v_add_f32 v50, v50, v51
  v_mfma_f32_16x16x32_bf16 v[68:71], a[128:131], v[112:115], v[68:71]
  ds_read_b64_tr_b16 a[52:53], v8 offset:24576
  v_rcp_f32 v50, v50
  v_mfma_f32_16x16x32_bf16 v[68:71], a[140:143], v[108:111], v[68:71]
  ds_read_b64_tr_b16 a[54:55], v8 offset:26624
  v_mul_f32 v48, v48, v50
  v_mul_f32 v49, v49, v50
  v_mfma_f32_16x16x32_bf16 v[72:75], a[140:143], v[76:79], v[72:75]
  ds_read_b128 v[112:115], v2 offset:14336
  v_cvt_pk_bf16_f32 v48, v48, v48
  v_cvt_pk_bf16_f32 v49, v49, v49
  v_mfma_f32_16x16x32_bf16 v[72:75], a[128:131], v[80:83], v[72:75]
  s_waitcnt lgkmcnt(9)
  ds_read_b64_tr_b16 a[56:57], v7 offset:28672
  v_and_b32 v28, v24, v48
  v_mfma_f32_16x16x32_bf16 v[52:55], a[144:147], v[84:87], v[52:55]
  ds_read_b64_tr_b16 a[58:59], v7 offset:30720
  v_and_b32 v29, v25, v49
  v_and_b32 v30, v26, v48
  v_mfma_f32_16x16x32_bf16 v[52:55], a[156:159], v[88:91], v[52:55]
  ds_read_b128 v[108:111], v2 offset:15360
  v_and_b32 v31, v27, v49
  v_mfma_f32_16x16x32_bf16 v[56:59], a[156:159], v[92:95], v[56:59]
  ds_read_b64_tr_b16 a[60:61], v8 offset:28672
  v_mfma_f32_16x16x32_bf16 v[32:35], v[40:43], v[28:31], 0
  v_mfma_f32_16x16x32_bf16 v[36:39], v[44:47], v[28:31], 0
  v_mfma_f32_16x16x32_bf16 v[56:59], a[144:147], v[96:99], v[56:59]
  ds_read_b64_tr_b16 a[62:63], v8 offset:30720
  v_mfma_f32_16x16x32_bf16 v[64:67], a[148:151], v[96:99], v[64:67]
  ds_read_b128 v[76:79], v2 offset:32768
  v_mfma_f32_16x16x32_bf16 v[64:67], a[160:163], v[92:95], v[64:67]
  v_mfma_f32_16x16x32_bf16 v[60:63], a[160:163], v[88:91], v[60:63]
  s_nop 0
  v_cvt_pk_bf16_f32 v116, v32, v33
  v_cvt_pk_bf16_f32 v117, v34, v35
  v_cvt_pk_bf16_f32 v118, v36, v37
  v_mfma_f32_16x16x32_bf16 v[60:63], a[148:151], v[84:87], v[60:63]
  ds_read_b128 v[80:83], v2 offset:33792
  v_cvt_pk_bf16_f32 v119, v38, v39
  v_mfma_f32_16x16x32_bf16 v[68:71], a[152:155], v[84:87], v[68:71]
  buffer_store_dwordx4 v[116:119], v1, s[8:11], s73 offen sc1
  v_mfma_f32_16x16x32_bf16 v[68:71], a[164:167], v[88:91], v[68:71]
  s_add_u32 s73, s73, 65536
  v_mfma_f32_16x16x32_bf16 v[72:75], a[164:167], v[92:95], v[72:75]
  ds_read_b128 v[84:87], v2 offset:40960
  v_mfma_f32_16x16x32_bf16 v[72:75], a[152:155], v[96:99], v[72:75]
  s_waitcnt lgkmcnt(5)
  s_waitcnt vmcnt(5)
  s_cmp_lg_u32 s44, 0
  s_cbranch_scc1 PL5_adaLN_cond__sliding_local_dilated__swiglu_ffn__prompt_kernelx
  v_subrev_u32 v13, s46, v13
  v_subrev_u32 v13, 1, v13
  v_cmp_lt_u32 vcc, 3, v13
  s_nop 4
  s_cbranch_vccz PL5_adaLN_cond__sliding_local_dilated__swiglu_ffn__prompt_kernelx
  s_mov_b32 s57, 60000
PL5_adaLN_cond__sliding_local_dilated__swiglu_ffn__prompt_kernel:
  buffer_load_dword v13, v14, s[8:11], s77 offen sc1
  s_sub_u32 s57, s57, 1
  s_cmp_eq_u32 s57, 0
  s_waitcnt vmcnt(0)
  s_cbranch_scc1 PL5_adaLN_cond__sliding_local_dilated__swiglu_ffn__prompt_kernelx
  v_subrev_u32 v13, s46, v13
  v_subrev_u32 v13, 1, v13
  v_cmp_lt_u32 vcc, 3, v13
  s_nop 4
  s_cbranch_vccnz PL5_adaLN_cond__sliding_local_dilated__swiglu_ffn__prompt_kernel
PL5_adaLN_cond__sliding_local_dilated__swiglu_ffn__prompt_kernelx:
  s_waitcnt vmcnt(10) lgkmcnt(3)
  s_barrier
  v_mfma_f32_16x16x32_bf16 v[52:55], a[168:171], v[100:103], v[52:55]
  ds_read_b64_tr_b16 a[64:65], v4 offset:32768
  s_add_u32 m0, s45, 16384
  s_add_u32 s68, s67, 5
  s_and_b32 s68, s68, 7
  s_mul_i32 s68, s68, 262144
  v_mfma_f32_16x16x32_bf16 v[52:55], a[180:183], v[104:107], v[52:55]
  ds_read_b128 v[88:91], v2 offset:41984
  ds_read_b64_tr_b16 a[66:67], v4 offset:34816
  v_mfma_f32_16x16x32_bf16 v[56:59], a[180:183], v[108:111], v[56:59]
  ds_read_b64_tr_b16 a[68:69], v5 offset:32768
  buffer_load_dwordx4 v10, s[16:19], s68 offen lds
  v_mfma_f32_16x16x32_bf16 v[56:59], a[168:171], v[112:115], v[56:59]
  ds_read_b64_tr_b16 a[70:71], v5 offset:34816
  ds_read_b64_tr_b16 a[72:73], v4 offset:36864
  v_mfma_f32_16x16x32_bf16 v[64:67], a[172:175], v[112:115], v[64:67]
  ds_read_b128 v[92:95], v2 offset:34816
  ds_read_b64_tr_b16 a[74:75], v4 offset:38912
  s_add_u32 m0, s45, 20480
  s_add_u32 s68, s68, 65536
  v_mfma_f32_16x16x32_bf16 v[64:67], a[184:187], v[108:111], v[64:67]
  ds_read_b64_tr_b16 a[76:77], v5 offset:36864
  buffer_load_dwordx4 v10, s[16:19], s68 offen lds
  v_mfma_f32_16x16x32_bf16 v[60:63], a[184:187], v[104:107], v[60:63]
  ds_read_b64_tr_b16 a[78:79], v5 offset:38912
  ds_read_b64_tr_b16 a[80:81], v4 offset:40960
  v_mfma_f32_16x16x32_bf16 v[60:63], a[172:175], v[100:103], v[60:63]
  ds_read_b128 v[96:99], v2 offset:35840
  ds_read_b64_tr_b16 a[82:83], v4 offset:43008
  s_add_u32 m0, s45, 24576
  s_add_u32 s68, s68, 65536
  v_mfma_f32_16x16x32_bf16 v[68:71], a[176:179], v[100:103], v[68:71]
  ds_read_b64_tr_b16 a[84:85], v5 offset:40960
  buffer_load_dwordx4 v10, s[16:19], s68 offen lds
  v_mfma_f32_16x16x32_bf16 v[68:71], a[188:191], v[104:107], v[68:71]
  ds_read_b64_tr_b16 a[86:87], v5 offset:43008
  ds_read_b64_tr_b16 a[88:89], v4 offset:45056
  v_mfma_f32_16x16x32_bf16 v[72:75], a[188:191], v[108:111], v[72:75]
  ds_read_b128 v[100:103], v2 offset:43008
  ds_read_b64_tr_b16 a[90:91], v4 offset:47104
  s_add_u32 m0, s45, 28672
  s_add_u32 s68, s68, 65536
  v_mfma_f32_16x16x32_bf16 v[72:75], a[176:179], v[112:115], v[72:75]
  s_waitcnt lgkmcnt(15)
  ds_read_b64_tr_b16 a[92:93], v5 offset:45056
  buffer_load_dwordx4 v10, s[16:19], s68 offen lds
  v_mfma_f32_16x16x32_bf16 v[52:55], a[192:195], v[76:79], v[52:55]
  ds_read_b64_tr_b16 a[94:95], v5 offset:47104
  ds_read_b64_tr_b16 a[96:97], v4 offset:49152
  v_mfma_f32_16x16x32_bf16 v[52:55], a[204:207], v[80:83], v[52:55]
  ds_read_b128 v[104:107], v2 offset:44032
  ds_read_b64_tr_b16 a[98:99], v4 offset:51200
  s_add_u32 m0, s45, 81920
  s_add_u32 s68, s67, 6
  s_and_b32 s68, s68, 7
  s_mul_i32 s68, s68, 262144
  v_mfma_f32_16x16x32_bf16 v[56:59], a[204:207], v[88:91], v[56:59]
  ds_read_b64_tr_b16 a[100:101], v5 offset:49152
  buffer_load_dwordx4 v10, s[16:19], s68 offen lds
  v_mfma_f32_16x16x32_bf16 v[56:59], a[192:195], v[84:87], v[56:59]
  ds_read_b64_tr_b16 a[102:103], v5 offset:51200
  ds_read_b64_tr_b16 a[104:105], v4 offset:53248
  v_mfma_f32_16x16x32_bf16 v[64:67], a[196:199], v[84:87], v[64:67]
  ds_read_b128 v[108:111], v2 offset:36864
  ds_read_b64_tr_b16 a[106:107], v4 offset:55296
  s_add_u32 m0, s45, 86016
  s_add_u32 s68, s68, 65536
  v_mfma_f32_16x16x32_bf16 v[64:67], a[208:211], v[88:91], v[64:67]
  ds_read_b64_tr_b16 a[108:109], v5 offset:53248
  buffer_load_dwordx4 v10, s[16:19], s68 offen lds
  v_mfma_f32_16x16x32_bf16 v[60:63], a[208:211], v[80:83], v[60:63]
  ds_read_b64_tr_b16 a[110:111], v5 offset:55296
  ds_read_b64_tr_b16 a[112:113], v4 offset:57344
  v_mfma_f32_16x16x32_bf16 v[60:63], a[196:199], v[76:79], v[60:63]
  ds_read_b128 v[112:115], v2 offset:37888
  ds_read_b64_tr_b16 a[114:115], v4 offset:59392
  s_add_u32 m0, s45, 90112
  s_add_u32 s68, s68, 65536
  v_mfma_f32_16x16x32_bf16 v[68:71], a[200:203], v[76:79], v[68:71]
  ds_read_b64_tr_b16 a[116:117], v5 offset:57344
  buffer_load_dwordx4 v10, s[16:19], s68 offen lds
  v_mfma_f32_16x16x32_bf16 v[68:71], a[212:215], v[80:83], v[68:71]
  ds_read_b64_tr_b16 a[118:119], v5 offset:59392
  ds_read_b64_tr_b16 a[120:121], v4 offset:61440
  v_mfma_f32_16x16x32_bf16 v[72:75], a[212:215], v[88:91], v[72:75]
  ds_read_b128 v[76:79], v2 offset:45056
  ds_read_b64_tr_b16 a[122:123], v4 offset:63488
  s_add_u32 m0, s45, 94208
  s_add_u32 s68, s68, 65536
  v_mfma_f32_16x16x32_bf16 v[72:75], a[200:203], v[84:87], v[72:75]
  s_waitcnt lgkmcnt(15)
  ds_read_b64_tr_b16 a[124:125], v5 offset:61440
  buffer_load_dwordx4 v10, s[16:19], s68 offen lds
  v_mfma_f32_16x16x32_bf16 v[52:55], a[216:219], v[92:95], v[52:55]
  ds_read_b64_tr_b16 a[126:127], v5 offset:63488
  v_mfma_f32_16x16x32_bf16 v[52:55], a[228:231], v[96:99], v[52:55]
  ds_read_b128 v[80:83], v2 offset:46080
  v_mfma_f32_16x16x32_bf16 v[56:59], a[228:231], v[104:107], v[56:59]
  v_mfma_f32_16x16x32_bf16 v[56:59], a[216:219], v[100:103], v[56:59]
  v_mfma_f32_16x16x32_bf16 v[64:67], a[220:223], v[100:103], v[64:67]
  ds_read_b128 v[88:91], v2 offset:38912
  v_mfma_f32_16x16x32_bf16 v[64:67], a[232:235], v[104:107], v[64:67]
  v_lshlrev_b32 v21, 7, v0
  v_add_u32 v21, 720896, v21
  v_mfma_f32_16x16x32_bf16 v[60:63], a[232:235], v[96:99], v[60:63]
  s_waitcnt vmcnt(4) lgkmcnt(2)
  s_barrier
  v_add_u32 v15, s46, v0
  v_add_u32 v15, 2, v15
  s_mov_b64 exec, 1
  buffer_store_dword v15, v0, s[8:11], s74 offen offset:0 sc1
  s_mov_b64 exec, -1
  v_mfma_f32_16x16x32_bf16 v[60:63], a[220:223], v[92:95], v[60:63]
  ds_read_b128 v[84:87], v2 offset:39936
  ds_read_b64_tr_b16 a[128:129], v7 offset:49152
  s_add_u32 m0, s45, 65536
  s_add_u32 s68, s67, 7
  s_and_b32 s68, s68, 7
  s_mul_i32 s68, s68, 262144
  v_mfma_f32_16x16x32_bf16 v[68:71], a[224:227], v[92:95], v[68:71]
  ds_read_b64_tr_b16 a[130:131], v7 offset:51200
  buffer_load_dwordx4 v10, s[16:19], s68 offen lds
  v_mfma_f32_16x16x32_bf16 v[68:71], a[236:239], v[96:99], v[68:71]
  ds_read_b64_tr_b16 a[132:133], v8 offset:49152
  v_mfma_f32_16x16x32_bf16 v[72:75], a[236:239], v[104:107], v[72:75]
  ds_read_b128 v[92:95], v2 offset:47104
  ds_read_b64_tr_b16 a[134:135], v8 offset:51200
  ds_read_b64_tr_b16 a[136:137], v7 offset:53248
  v_mfma_f32_16x16x32_bf16 v[72:75], a[224:227], v[100:103], v[72:75]
  s_waitcnt lgkmcnt(8)
  ds_read_b64_tr_b16 a[138:139], v7 offset:55296
  s_add_u32 m0, s45, 69632
  s_add_u32 s68, s68, 65536
  v_mfma_f32_16x16x32_bf16 v[52:55], a[240:243], v[108:111], v[52:55]
  ds_read_b64_tr_b16 a[140:141], v8 offset:53248
  buffer_load_dwordx4 v10, s[16:19], s68 offen lds
  s_add_u32 m0, s45, 73728
  s_add_u32 s68, s68, 65536
  v_mfma_f32_16x16x32_bf16 v[52:55], v[124:127], v[112:115], v[52:55]
  ds_read_b128 v[96:99], v2 offset:48128
  ds_read_b64_tr_b16 a[142:143], v8 offset:55296
  ds_read_b64_tr_b16 a[144:145], v7 offset:57344
  v_mfma_f32_16x16x32_bf16 v[56:59], v[124:127], v[80:83], v[56:59]
  ds_read_b64_tr_b16 a[146:147], v7 offset:59392
  buffer_load_dwordx4 v10, s[16:19], s68 offen lds
  v_mfma_f32_16x16x32_bf16 v[56:59], a[240:243], v[76:79], v[56:59]
  ds_read_b64_tr_b16 a[148:149], v8 offset:57344
  s_add_u32 m0, s45, 77824
  s_add_u32 s68, s68, 65536
  v_mfma_f32_16x16x32_bf16 v[64:67], a[244:247], v[76:79], v[64:67]
  ds_read_b128 v[104:107], v1 offset:0
  ds_read_b64_tr_b16 a[150:151], v8 offset:59392
  ds_read_b64_tr_b16 a[152:153], v7 offset:61440
  v_mfma_f32_16x16x32_bf16 v[64:67], v[128:131], v[80:83], v[64:67]
  ds_read_b64_tr_b16 a[154:155], v7 offset:63488
  buffer_load_dwordx4 v10, s[16:19], s68 offen lds
  v_mfma_f32_16x16x32_bf16 v[60:63], v[128:131], v[112:115], v[60:63]
  ds_read_b64_tr_b16 a[156:157], v8 offset:61440
  s_add_u32 m0, s70, 32768
  s_add_u32 s69, s62, 0
  v_mfma_f32_16x16x32_bf16 v[60:63], a[244:247], v[108:111], v[60:63]
  ds_read_b128 v[100:103], v1 offset:1024
  ds_read_b64_tr_b16 a[158:159], v8 offset:63488
  ds_read_b64_tr_b16 a[160:161], v4 offset:16384
  v_mfma_f32_16x16x32_bf16 v[68:71], a[248:251], v[108:111], v[68:71]
  ds_read_b64_tr_b16 a[162:163], v4 offset:18432
  buffer_load_dwordx4 v9, s[8:11], s69 offen offset:0 sc1 lds
  v_mfma_f32_16x16x32_bf16 v[68:71], v[132:135], v[112:115], v[68:71]
  ds_read_b64_tr_b16 a[164:165], v5 offset:16384
  v_mfma_f32_16x16x32_bf16 v[72:75], v[132:135], v[80:83], v[72:75]
  ds_read_b128 v[108:111], v1 offset:8192
  ds_read_b64_tr_b16 a[166:167], v5 offset:18432
  ds_read_b64_tr_b16 a[168:169], v4 offset:20480
  s_lshl_b32 s57, s44, 28
  buffer_load_dwordx4 v[116:119], v21, s[8:11], s57 offen sc1
  v_mfma_f32_16x16x32_bf16 v[72:75], a[248:251], v[76:79], v[72:75]
  s_waitcnt lgkmcnt(15)
  ds_read_b64_tr_b16 a[170:171], v4 offset:22528
  v_mfma_f32_16x16x32_bf16 v[52:55], v[136:139], v[88:91], v[52:55]
  ds_read_b64_tr_b16 a[172:173], v5 offset:20480
  buffer_load_dwordx4 v9, s[8:11], s69 offen offset:1024 sc1 lds
  v_mfma_f32_16x16x32_bf16 v[52:55], v[148:151], v[84:87], v[52:55]
  ds_read_b128 v[112:115], v1 offset:9216
  ds_read_b64_tr_b16 a[174:175], v5 offset:22528
  ds_read_b64_tr_b16 a[176:177], v4 offset:24576
  v_mfma_f32_16x16x32_bf16 v[56:59], v[148:151], v[96:99], v[56:59]
  ds_read_b64_tr_b16 a[178:179], v4 offset:26624
  buffer_load_dwordx4 v9, s[8:11], s69 offen offset:2048 sc1 lds
  v_mfma_f32_16x16x32_bf16 v[56:59], v[136:139], v[92:95], v[56:59]
  ds_read_b64_tr_b16 a[180:181], v5 offset:24576
  v_mfma_f32_16x16x32_bf16 v[64:67], v[140:143], v[92:95], v[64:67]
  ds_read_b128 v[80:83], v1 offset:2048
  ds_read_b64_tr_b16 a[182:183], v5 offset:26624
  ds_read_b64_tr_b16 a[184:185], v4 offset:28672
  v_mfma_f32_16x16x32_bf16 v[64:67], v[152:155], v[96:99], v[64:67]
  ds_read_b64_tr_b16 a[186:187], v4 offset:30720
  buffer_load_dwordx4 v9, s[8:11], s69 offen offset:3072 sc1 lds
  v_mfma_f32_16x16x32_bf16 v[60:63], v[152:155], v[84:87], v[60:63]
  ds_read_b64_tr_b16 a[188:189], v5 offset:28672
  s_add_u32 m0, s70, 49152
  s_add_u32 s69, s63, 0
  v_mfma_f32_16x16x32_bf16 v[60:63], v[140:143], v[88:91], v[60:63]
  ds_read_b128 v[76:79], v1 offset:3072
  ds_read_b64_tr_b16 a[190:191], v5 offset:30720
  v_mfma_f32_16x16x32_bf16 v[68:71], v[144:147], v[88:91], v[68:71]
  buffer_load_dwordx4 v9, s[8:11], s69 offen offset:0 sc1 lds
  v_mfma_f32_16x16x32_bf16 v[68:71], v[156:159], v[84:87], v[68:71]
  v_mfma_f32_16x16x32_bf16 v[72:75], v[156:159], v[96:99], v[72:75]
  ds_read_b128 v[88:91], v1 offset:10240
  v_mfma_f32_16x16x32_bf16 v[72:75], v[144:147], v[92:95], v[72:75]
  s_waitcnt lgkmcnt(12)
  buffer_load_dwordx4 v9, s[8:11], s69 offen offset:1024 sc1 lds
  v_mfma_f32_16x16x32_bf16 v[52:55], v[160:163], v[104:107], v[52:55]
  s_waitcnt vmcnt(7) lgkmcnt(15)
  s_barrier
  v_mfma_f32_16x16x32_bf16 v[52:55], v[172:175], v[100:103], v[52:55]
  ds_read_b128 v[84:87], v1 offset:11264
  ds_read_b64_tr_b16 a[192:193], v7 offset:16384
  v_mfma_f32_16x16x32_bf16 v[56:59], v[172:175], v[112:115], v[56:59]
  ds_read_b64_tr_b16 a[194:195], v7 offset:18432
  buffer_load_dwordx4 v9, s[8:11], s69 offen offset:2048 sc1 lds
  v_mfma_f32_16x16x32_bf16 v[56:59], v[160:163], v[108:111], v[56:59]
  ds_read_b64_tr_b16 a[196:197], v8 offset:16384
  v_mfma_f32_16x16x32_bf16 v[64:67], v[164:167], v[108:111], v[64:67]
  ds_read_b128 v[96:99], v1 offset:4096
  ds_read_b64_tr_b16 a[198:199], v8 offset:18432
  ds_read_b64_tr_b16 a[200:201], v7 offset:20480
  v_mfma_f32_16x16x32_bf16 v[64:67], v[176:179], v[112:115], v[64:67]
  ds_read_b64_tr_b16 a[202:203], v7 offset:22528
  buffer_load_dwordx4 v9, s[8:11], s69 offen offset:3072 sc1 lds
  v_mfma_f32_16x16x32_bf16 v[60:63], v[176:179], v[100:103], v[60:63]
  ds_read_b64_tr_b16 a[204:205], v8 offset:20480
  s_add_u32 m0, s70, 98304
  s_add_u32 s69, s64, 0
  v_mfma_f32_16x16x32_bf16 v[60:63], v[164:167], v[104:107], v[60:63]
  ds_read_b128 v[92:95], v1 offset:5120
  ds_read_b64_tr_b16 a[206:207], v8 offset:22528
  ds_read_b64_tr_b16 a[208:209], v7 offset:24576
  v_mfma_f32_16x16x32_bf16 v[68:71], v[168:171], v[104:107], v[68:71]
  ds_read_b64_tr_b16 a[210:211], v7 offset:26624
  buffer_load_dwordx4 v9, s[8:11], s69 offen offset:0 sc1 lds
  v_mfma_f32_16x16x32_bf16 v[68:71], v[180:183], v[100:103], v[68:71]
  ds_read_b64_tr_b16 a[212:213], v8 offset:24576
  v_mfma_f32_16x16x32_bf16 v[72:75], v[180:183], v[112:115], v[72:75]
  ds_read_b128 v[104:107], v1 offset:12288
  ds_read_b64_tr_b16 a[214:215], v8 offset:26624
  ds_read_b64_tr_b16 a[216:217], v7 offset:28672
  v_mfma_f32_16x16x32_bf16 v[72:75], v[168:171], v[108:111], v[72:75]
  s_waitcnt lgkmcnt(15)
  ds_read_b64_tr_b16 a[218:219], v7 offset:30720
  v_mfma_f32_16x16x32_bf16 v[52:55], v[184:187], v[80:83], v[52:55]
  ds_read_b64_tr_b16 a[220:221], v8 offset:28672
  buffer_load_dwordx4 v9, s[8:11], s69 offen offset:1024 sc1 lds
  v_mfma_f32_16x16x32_bf16 v[52:55], v[196:199], v[76:79], v[52:55]
  ds_read_b128 v[100:103], v1 offset:13312
  ds_read_b64_tr_b16 a[222:223], v8 offset:30720
  ds_read_b64_tr_b16 a[224:225], v7 offset:0
  v_mfma_f32_16x16x32_bf16 v[56:59], v[196:199], v[84:87], v[56:59]
  ds_read_b64_tr_b16 a[226:227], v7 offset:2048
  buffer_load_dwordx4 v9, s[8:11], s69 offen offset:2048 sc1 lds
  v_mfma_f32_16x16x32_bf16 v[56:59], v[184:187], v[88:91], v[56:59]
  ds_read_b64_tr_b16 a[228:229], v8 offset:0
  v_mfma_f32_16x16x32_bf16 v[64:67], v[188:191], v[88:91], v[64:67]
  ds_read_b128 v[112:115], v1 offset:6144
  ds_read_b64_tr_b16 a[230:231], v8 offset:2048
  ds_read_b64_tr_b16 a[232:233], v7 offset:4096
  v_mfma_f32_16x16x32_bf16 v[64:67], v[200:203], v[84:87], v[64:67]
  ds_read_b64_tr_b16 a[234:235], v7 offset:6144
  buffer_load_dwordx4 v9, s[8:11], s69 offen offset:3072 sc1 lds
  v_mfma_f32_16x16x32_bf16 v[60:63], v[200:203], v[76:79], v[60:63]
  ds_read_b64_tr_b16 a[236:237], v8 offset:4096
  s_add_u32 m0, s70, 114688
  s_add_u32 s69, s65, 0
  v_mfma_f32_16x16x32_bf16 v[60:63], v[188:191], v[80:83], v[60:63]
  ds_read_b128 v[108:111], v1 offset:7168
  ds_read_b64_tr_b16 a[238:239], v8 offset:6144
  ds_read_b64_tr_b16 a[240:241], v7 offset:8192
  v_mfma_f32_16x16x32_bf16 v[68:71], v[192:195], v[80:83], v[68:71]
  ds_read_b64_tr_b16 a[242:243], v7 offset:10240
  buffer_load_dwordx4 v9, s[8:11], s69 offen offset:0 sc1 lds
  v_mfma_f32_16x16x32_bf16 v[68:71], v[204:207], v[76:79], v[68:71]
  ds_read_b64_tr_b16 a[244:245], v8 offset:8192
  v_mfma_f32_16x16x32_bf16 v[72:75], v[204:207], v[84:87], v[72:75]
  ds_read_b128 v[80:83], v1 offset:14336
  ds_read_b64_tr_b16 a[246:247], v8 offset:10240
  ds_read_b64_tr_b16 a[248:249], v7 offset:12288
  v_mfma_f32_16x16x32_bf16 v[72:75], v[192:195], v[88:91], v[72:75]
  s_waitcnt lgkmcnt(15)
  ds_read_b64_tr_b16 a[250:251], v7 offset:14336
  v_mfma_f32_16x16x32_bf16 v[52:55], v[208:211], v[96:99], v[52:55]
  ds_read_b64_tr_b16 v[124:125], v8 offset:12288
  buffer_load_dwordx4 v9, s[8:11], s69 offen offset:1024 sc1 lds
  v_mfma_f32_16x16x32_bf16 v[52:55], v[220:223], v[92:95], v[52:55]
  ds_read_b128 v[76:79], v1 offset:15360
  ds_read_b64_tr_b16 v[126:127], v8 offset:14336
  v_mfma_f32_16x16x32_bf16 v[56:59], v[220:223], v[100:103], v[56:59]
  buffer_load_dwordx4 v9, s[8:11], s69 offen offset:2048 sc1 lds
  v_mfma_f32_16x16x32_bf16 v[56:59], v[208:211], v[104:107], v[56:59]
  v_mfma_f32_16x16x32_bf16 v[64:67], v[212:215], v[104:107], v[64:67]
  v_mfma_f32_16x16x32_bf16 v[64:67], v[224:227], v[100:103], v[64:67]
  buffer_load_dwordx4 v9, s[8:11], s69 offen offset:3072 sc1 lds
  v_mfma_f32_16x16x32_bf16 v[60:63], v[224:227], v[92:95], v[60:63]
  v_mfma_f32_16x16x32_bf16 v[60:63], v[212:215], v[96:99], v[60:63]
  s_waitcnt vmcnt(15)
  s_cmp_lg_u32 s44, 0
  s_cbranch_scc1 PL6_adaLN_cond__sliding_local_dilated__swiglu_ffn__prompt_kernelx
  v_bitop3_b32 v116, v116, v117, s46 bitop3:0x7e
  v_bitop3_b32 v118, v118, v119, s46 bitop3:0x7e
  v_or_b32 v116, v116, v118
  v_cmp_ne_u32 vcc, 0, v116
  s_nop 4
  s_cbranch_vccz PL6_adaLN_cond__sliding_local_dilated__swiglu_ffn__prompt_kernelx
  s_mov_b32 s57, 60000
PL6_adaLN_cond__sliding_local_dilated__swiglu_ffn__prompt_kernel:
  buffer_load_dwordx4 v[116:119], v21, s[8:11], 0 offen sc1
  s_sub_u32 s57, s57, 1
  s_cmp_eq_u32 s57, 0
  s_waitcnt vmcnt(0)
  s_cbranch_scc1 PL6_adaLN_cond__sliding_local_dilated__swiglu_ffn__prompt_kernelx
  v_bitop3_b32 v116, v116, v117, s46 bitop3:0x7e
  v_bitop3_b32 v118, v118, v119, s46 bitop3:0x7e
  v_or_b32 v116, v116, v118
  v_cmp_ne_u32 vcc, 0, v116
  s_nop 4
  s_cbranch_vccnz PL6_adaLN_cond__sliding_local_dilated__swiglu_ffn__prompt_kernel
PL6_adaLN_cond__sliding_local_dilated__swiglu_ffn__prompt_kernelx:
  s_waitcnt vmcnt(8) lgkmcnt(0)
  s_barrier
  v_mfma_f32_16x16x32_bf16 v[68:71], v[216:219], v[96:99], v[68:71]
  ds_read_b128 v[84:87], v22 offset:32768
  s_add_u32 m0, s70, 16384
  s_add_u32 s69, s62, 65536
  v_mfma_f32_16x16x32_bf16 v[68:71], v[228:231], v[92:95], v[68:71]
  v_and_b32 v21, 31, v0
  v_lshlrev_b32 v21, 2, v21
  v_lshrrev_b32 v181, 5, v0
  v_lshl_add_u32 v21, v181, 13, v21
  v_mfma_f32_16x16x32_bf16 v[72:75], v[228:231], v[100:103], v[72:75]
  ds_read_b128 v[88:91], v22 offset:33792
  buffer_load_dwordx4 v9, s[8:11], s69 offen offset:0 sc1 lds
  v_mfma_f32_16x16x32_bf16 v[72:75], v[216:219], v[104:107], v[72:75]
  s_waitcnt lgkmcnt(3)
  v_mfma_f32_16x16x32_bf16 v[52:55], v[232:235], v[112:115], v[52:55]
  ds_read_b128 v[96:99], v22 offset:34816
  v_mfma_f32_16x16x32_bf16 v[52:55], v[244:247], v[108:111], v[52:55]
  buffer_load_dwordx4 v9, s[8:11], s69 offen offset:1024 sc1 lds
  v_mfma_f32_16x16x32_bf16 v[56:59], v[244:247], v[76:79], v[56:59]
  ds_read_b128 v[92:95], v22 offset:35840
  v_mfma_f32_16x16x32_bf16 v[56:59], v[232:235], v[80:83], v[56:59]
  buffer_load_dwordx4 v9, s[8:11], s69 offen offset:2048 sc1 lds
  v_mfma_f32_16x16x32_bf16 v[64:67], v[236:239], v[80:83], v[64:67]
  ds_read_b128 v[100:103], v22 offset:36864
  v_mfma_f32_16x16x32_bf16 v[64:67], v[248:251], v[76:79], v[64:67]
  v_mfma_f32_16x16x32_bf16 v[60:63], v[248:251], v[108:111], v[60:63]
  ds_read_b128 v[104:107], v22 offset:37888
  v_mfma_f32_16x16x32_bf16 v[60:63], v[236:239], v[112:115], v[60:63]
  buffer_load_dwordx4 v9, s[8:11], s69 offen offset:3072 sc1 lds
  s_add_u32 s56, s76, 8192
  v_mfma_f32_16x16x32_bf16 v[68:71], v[240:243], v[112:115], v[68:71]
  ds_read_b128 v[112:115], v22 offset:38912
  v_mfma_f32_16x16x32_bf16 v[68:71], v[252:255], v[108:111], v[68:71]
  buffer_load_dword v160, v21, s[8:11], s56 offen sc1
  s_add_u32 s56, s76, 32768
  v_mfma_f32_16x16x32_bf16 v[72:75], v[252:255], v[76:79], v[72:75]
  ds_read_b128 v[108:111], v22 offset:39936
  v_mfma_f32_16x16x32_bf16 v[72:75], v[240:243], v[80:83], v[72:75]
  s_waitcnt lgkmcnt(4)
  buffer_load_dword v161, v21, s[8:11], s56 offen sc1
  s_add_u32 s56, s76, 57344
  v_mfma_f32_16x16x32_bf16 v[128:131], a[0:3], v[84:87], 0
  ds_read_b128 v[76:79], v22 offset:49152
  buffer_load_dword v162, v21, s[8:11], s56 offen sc1
  v_mfma_f32_16x16x32_bf16 v[128:131], a[8:11], v[88:91], v[128:131]
  s_add_u32 s56, s76, 81920
  v_mfma_f32_16x16x32_bf16 v[132:135], a[12:15], v[88:91], 0
  ds_read_b128 v[80:83], v22 offset:50176
  s_lshr_b32 s79, s2, 6
  s_lshl_b32 s79, s79, 2
  s_add_u32 s79, s79, s44
  s_lshl_b32 s79, s79, 8
  buffer_load_dword v163, v21, s[8:11], s56 offen sc1
  s_add_u32 s56, s47, 41943040
  v_mfma_f32_16x16x32_bf16 v[132:135], a[4:7], v[84:87], v[132:135]
  buffer_load_dwordx4 v[144:147], v1, s[8:11], s56 offen sc1
  s_add_u32 s56, s47, 42008576
  v_cvt_pk_bf16_f32 v52, v52, v53
  v_cvt_pk_bf16_f32 v53, v54, v55
  ds_write_b64 v18, v[52:53] offset:6144
  v_cvt_pk_bf16_f32 v60, v60, v61
  v_cvt_pk_bf16_f32 v61, v62, v63
  v_mfma_f32_16x16x32_bf16 v[128:131], a[16:19], v[96:99], v[128:131]
  ds_read_b128 v[88:91], v22 offset:51200
  v_cvt_pk_bf16_f32 v62, v68, v69
  v_cvt_pk_bf16_f32 v63, v70, v71
  ds_write_b128 v17, v[60:63] offset:7168
  v_mfma_f32_16x16x32_bf16 v[128:131], a[24:27], v[92:95], v[128:131]
  buffer_load_dwordx4 v[148:151], v1, s[8:11], s56 offen sc1
  s_add_u32 s56, s47, 42074112
  v_cvt_pk_bf16_f32 v56, v56, v57
  v_cvt_pk_bf16_f32 v57, v58, v59
  ds_write_b64 v18, v[56:57] offset:12288
  v_cvt_pk_bf16_f32 v64, v64, v65
  v_cvt_pk_bf16_f32 v65, v66, v67
  v_mfma_f32_16x16x32_bf16 v[132:135], a[28:31], v[92:95], v[132:135]
  ds_read_b128 v[84:87], v22 offset:52224
  v_cvt_pk_bf16_f32 v66, v72, v73
  v_cvt_pk_bf16_f32 v67, v74, v75
  ds_write_b128 v17, v[64:67] offset:13312
  v_mfma_f32_16x16x32_bf16 v[132:135], a[20:23], v[96:99], v[132:135]
  s_waitcnt lgkmcnt(8)
  buffer_load_dwordx4 v[152:155], v1, s[8:11], s56 offen sc1
  s_add_u32 s56, s47, 42139648
  s_bitcmp1_b32 s44, 0
  s_mov_b32 s52, 6144
  s_cselect_b32 s52, 12288, s52
  s_mov_b32 s53, 0
  s_cselect_b32 s53, 6144, s53
  v_add_u32 v116, s52, v19
  v_add_u32 v117, s53, v19
  v_mfma_f32_16x16x32_bf16 v[128:131], a[32:35], v[100:103], v[128:131]
  ds_read_b128 v[92:95], v22 offset:53248
  v_add_u32 v118, s52, v20
  v_add_u32 v119, s53, v20
  s_waitcnt vmcnt(11) lgkmcnt(1)
  s_barrier
  v_mfma_f32_16x16x32_bf16 v[128:131], a[40:43], v[104:107], v[128:131]
  buffer_load_dwordx4 v[156:159], v1, s[8:11], s56 offen sc1
  s_add_u32 m0, s70, 81920
  s_add_u32 s69, s63, 65536
  ds_read_b128 v[52:55], v116
  ds_read_b128 v[56:59], v117 offset:1024
  v_mfma_f32_16x16x32_bf16 v[132:135], a[44:47], v[104:107], v[132:135]
  ds_read_b128 v[96:99], v22 offset:54272
  ds_read_b128 v[60:63], v116 offset:1024
  ds_read_b64_tr_b16 v[64:65], v119 offset:2048
  ds_read_b64_tr_b16 v[66:67], v118 offset:2048
  v_mfma_f32_16x16x32_bf16 v[132:135], a[36:39], v[100:103], v[132:135]
  buffer_load_dwordx4 v9, s[8:11], s69 offen offset:0 sc1 lds
  ds_read_b64_tr_b16 v[68:69], v119 offset:2056
  ds_read_b64_tr_b16 v[70:71], v118 offset:2056
  v_mfma_f32_16x16x32_bf16 v[128:131], a[48:51], v[112:115], v[128:131]
  ds_read_b128 v[104:107], v22 offset:55296
  s_lshl_b32 s57, s44, 28
  s_add_u32 s57, s57, s77
  buffer_load_dword v13, v14, s[8:11], s57 offen sc1
  v_mfma_f32_16x16x32_bf16 v[128:131], a[56:59], v[108:111], v[128:131]
  v_mfma_f32_16x16x32_bf16 v[132:135], a[60:63], v[108:111], v[132:135]
  ds_read_b128 v[100:103], v22 offset:56320
  v_mfma_f32_16x16x32_bf16 v[132:135], a[52:55], v[112:115], v[132:135]
  s_waitcnt lgkmcnt(12)
  buffer_load_dwordx4 v9, s[8:11], s69 offen offset:1024 sc1 lds
  v_mfma_f32_16x16x32_bf16 v[128:131], a[64:67], v[76:79], v[128:131]
  ds_read_b128 v[108:111], v23 offset:32768
  s_waitcnt lgkmcnt(3)
  v_mfma_f32_16x16x32_bf16 v[116:119], v[56:59], v[52:55], 0
  v_mfma_f32_16x16x32_bf16 v[120:123], v[60:63], v[52:55], 0
  v_mfma_f32_16x16x32_bf16 v[128:131], a[72:75], v[80:83], v[128:131]
  buffer_load_dwordx4 v9, s[8:11], s69 offen offset:2048 sc1 lds
  v_mfma_f32_16x16x32_bf16 v[132:135], a[76:79], v[80:83], v[132:135]
  ds_read_b128 v[112:115], v23 offset:33792
  v_mfma_f32_16x16x32_bf16 v[132:135], a[68:71], v[76:79], v[132:135]
  v_mfma_f32_16x16x32_bf16 v[128:131], a[80:83], v[88:91], v[128:131]
  ds_read_b128 v[80:83], v23 offset:34816
HOP5:
  s_cbranch_execz HOP9
  s_nop 0
  v_cndmask_b32 v72, v116, v120, s[80:81]
  v_cndmask_b32 v73, v117, v121, s[82:83]
  v_cndmask_b32 v74, v118, v122, s[84:85]
  v_cndmask_b32 v75, v119, v123, s[86:87]
  v_cndmask_b32 v72, v72, v73, s[88:89]
  v_cndmask_b32 v73, v74, v75, s[88:89]
  v_mfma_f32_16x16x32_bf16 v[128:131], a[88:91], v[84:87], v[128:131]
  buffer_load_dwordx4 v9, s[8:11], s69 offen offset:3072 sc1 lds
  s_add_u32 m0, s70, 65536
  s_add_u32 s69, s64, 65536
  v_mul_f32 v72, 0x3e8293ee, v72
  v_mul_f32 v73, 0x3e8293ee, v73
  v_max_f32 v74, v72, v73
  v_mov_b32 v75, v74
  v_mfma_f32_16x16x32_bf16 v[132:135], a[92:95], v[84:87], v[132:135]
  ds_read_b128 v[76:79], v23 offset:35840
  v_permlane16_swap_b32 v74, v75
  v_max_f32 v74, v74, v75
  v_mov_b32 v75, v74
  v_mfma_f32_16x16x32_bf16 v[132:135], a[84:87], v[88:91], v[132:135]
  s_waitcnt lgkmcnt(4)
  buffer_load_dwordx4 v9, s[8:11], s69 offen offset:0 sc1 lds
  v_permlane32_swap_b32 v74, v75
  v_max_f32 v74, v74, v75
  v_sub_f32 v72, v72, v74
  v_sub_f32 v73, v73, v74
  v_mfma_f32_16x16x32_bf16 v[128:131], a[96:99], v[92:95], v[128:131]
  ds_read_b128 v[84:87], v23 offset:36864
  v_exp_f32 v72, v72
  v_exp_f32 v73, v73
  v_mfma_f32_16x16x32_bf16 v[128:131], a[104:107], v[96:99], v[128:131]
  v_add_f32 v74, v72, v73
  v_mov_b32 v75, v74
  v_mfma_f32_16x16x32_bf16 v[132:135], a[108:111], v[96:99], v[132:135]
  ds_read_b128 v[88:91], v23 offset:37888
  v_permlane16_swap_b32 v74, v75
  v_add_f32 v74, v74, v75
  v_mov_b32 v75, v74
  v_mfma_f32_16x16x32_bf16 v[132:135], a[100:103], v[92:95], v[132:135]
  buffer_load_dwordx4 v9, s[8:11], s69 offen offset:1024 sc1 lds
  v_permlane32_swap_b32 v74, v75
  v_add_f32 v74, v74, v75
  v_rcp_f32 v74, v74
  v_mfma_f32_16x16x32_bf16 v[128:131], a[112:115], v[104:107], v[128:131]
  ds_read_b128 v[96:99], v23 offset:38912
  v_mul_f32 v72, v72, v74
  v_mul_f32 v73, v73, v74
  v_cvt_pk_bf16_f32 v72, v72, v72
  v_cvt_pk_bf16_f32 v73, v73, v73
  v_and_b32 v52, v24, v72
  v_and_b32 v53, v25, v73
  v_mfma_f32_16x16x32_bf16 v[128:131], a[120:123], v[100:103], v[128:131]
  buffer_load_dwordx4 v9, s[8:11], s69 offen offset:2048 sc1 lds
  v_and_b32 v54, v26, v72
  v_and_b32 v55, v27, v73
  v_mfma_f32_16x16x32_bf16 v[132:135], a[124:127], v[100:103], v[132:135]
  ds_read_b128 v[92:95], v23 offset:39936
  v_mfma_f32_16x16x32_bf16 v[56:59], v[64:67], v[52:55], 0
  v_mfma_f32_16x16x32_bf16 v[60:63], v[68:71], v[52:55], 0
  v_mfma_f32_16x16x32_bf16 v[132:135], a[116:119], v[104:107], v[132:135]
  s_waitcnt lgkmcnt(4)
  v_mfma_f32_16x16x32_bf16 v[128:131], a[128:131], v[108:111], v[128:131]
  ds_read_b128 v[100:103], v23 offset:49152
  v_mfma_f32_16x16x32_bf16 v[128:131], a[136:139], v[112:115], v[128:131]
  buffer_load_dwordx4 v9, s[8:11], s69 offen offset:3072 sc1 lds
  s_add_u32 m0, s70, 0
  s_add_u32 s69, s65, 65536
  v_mfma_f32_16x16x32_bf16 v[132:135], a[140:143], v[112:115], v[132:135]
  ds_read_b128 v[104:107], v23 offset:50176
  v_cvt_pk_bf16_f32 v116, v56, v57
  v_cvt_pk_bf16_f32 v117, v58, v59
  v_cvt_pk_bf16_f32 v118, v60, v61
  v_cvt_pk_bf16_f32 v119, v62, v63
  v_mfma_f32_16x16x32_bf16 v[132:135], a[132:135], v[108:111], v[132:135]
  buffer_load_dwordx4 v9, s[8:11], s69 offen offset:0 sc1 lds
  buffer_store_dwordx4 v[116:119], v1, s[8:11], s73 offen sc1
  s_add_u32 s73, s73, 65536
  v_mfma_f32_16x16x32_bf16 v[128:131], a[144:147], v[80:83], v[128:131]
  ds_read_b128 v[112:115], v23 offset:51200
  v_mfma_f32_16x16x32_bf16 v[128:131], a[152:155], v[76:79], v[128:131]
  v_mfma_f32_16x16x32_bf16 v[132:135], a[156:159], v[76:79], v[132:135]
  ds_read_b128 v[108:111], v23 offset:52224
  v_mfma_f32_16x16x32_bf16 v[132:135], a[148:151], v[80:83], v[132:135]
  s_waitcnt lgkmcnt(4)
  buffer_load_dwordx4 v9, s[8:11], s69 offen offset:1024 sc1 lds
  v_mfma_f32_16x16x32_bf16 v[128:131], a[160:163], v[84:87], v[128:131]
  ds_read_b128 v[76:79], v23 offset:53248
  s_waitcnt vmcnt(16)
  v_add_f32 v160, v160, v161
  v_mfma_f32_16x16x32_bf16 v[128:131], a[168:171], v[88:91], v[128:131]
  buffer_load_dwordx4 v9, s[8:11], s69 offen offset:2048 sc1 lds
  v_add_f32 v162, v162, v163
  v_add_f32 v160, v160, v162
  v_cvt_pk_bf16_f32 v160, v160, v160
  v_mfma_f32_16x16x32_bf16 v[132:135], a[172:175], v[88:91], v[132:135]
  ds_read_b128 v[80:83], v23 offset:54272
  v_lshlrev_b32 v160, 16, v160
  v_cvt_f32_u32 v181, v181
  v_mfma_f32_16x16x32_bf16 v[132:135], a[164:167], v[84:87], v[132:135]
  v_add_f32 v160, v160, v181
  v_cvt_pk_bf16_f32 v160, v160, v160
  v_lshlrev_b32 v160, 16, v160
  v_mfma_f32_16x16x32_bf16 v[128:131], a[176:179], v[96:99], v[128:131]
  ds_read_b128 v[88:91], v23 offset:55296
  s_lshl_b32 s54, s44, 8
  s_add_u32 s54, s54, 161792
  v_mfma_f32_16x16x32_bf16 v[128:131], a[184:187], v[92:95], v[128:131]
  buffer_load_dwordx4 v9, s[8:11], s69 offen offset:3072 sc1 lds
  v_lshl_add_u32 v180, v0, 2, s54
  v_lshrrev_b32 v161, 4, v0
  v_lshl_add_u32 v181, v161, 4, s54
  v_mfma_f32_16x16x32_bf16 v[132:135], a[188:191], v[92:95], v[132:135]
  ds_read_b128 v[84:87], v23 offset:56320
  ds_write_b32 v180, v160
  v_mfma_f32_16x16x32_bf16 v[132:135], a[180:183], v[96:99], v[132:135]
  s_waitcnt lgkmcnt(5)
  s_waitcnt vmcnt(12)
  s_cmp_lg_u32 s44, 0
  s_cbranch_scc1 PL7_adaLN_cond__sliding_local_dilated__swiglu_ffn__prompt_kernelx
  v_subrev_u32 v13, s46, v13
  v_subrev_u32 v13, 2, v13
  v_cmp_lt_u32 vcc, 3, v13
  s_nop 4
  s_cbranch_vccz PL7_adaLN_cond__sliding_local_dilated__swiglu_ffn__prompt_kernelx
  s_mov_b32 s57, 60000
PL7_adaLN_cond__sliding_local_dilated__swiglu_ffn__prompt_kernel:
  buffer_load_dword v13, v14, s[8:11], s77 offen sc1
  s_sub_u32 s57, s57, 1
  s_cmp_eq_u32 s57, 0
  s_waitcnt vmcnt(0)
  s_cbranch_scc1 PL7_adaLN_cond__sliding_local_dilated__swiglu_ffn__prompt_kernelx
  v_subrev_u32 v13, s46, v13
  v_subrev_u32 v13, 2, v13
  v_cmp_lt_u32 vcc, 3, v13
  s_nop 4
  s_cbranch_vccnz PL7_adaLN_cond__sliding_local_dilated__swiglu_ffn__prompt_kernel
PL7_adaLN_cond__sliding_local_dilated__swiglu_ffn__prompt_kernelx:
  s_waitcnt vmcnt(9)
  s_barrier
  v_mfma_f32_16x16x32_bf16 v[128:131], a[192:195], v[100:103], v[128:131]
  ds_read_b128 v[92:95], v22 offset:16384
  s_add_u32 m0, s70, 32768
  s_add_u32 s69, s62, 131072
  v_mfma_f32_16x16x32_bf16 v[128:131], a[200:203], v[104:107], v[128:131]
  buffer_load_dwordx4 v9, s[8:11], s69 offen offset:0 sc1 lds
  v_bfe_u32 v180, v0, 2, 2
  v_xor_b32 v180, v180, v161
  v_lshlrev_b32 v180, 27, v180
  v_mfma_f32_16x16x32_bf16 v[132:135], a[204:207], v[104:107], v[132:135]
  ds_read_b128 v[96:99], v22 offset:17408
  v_and_b32 v162, 15, v0
  v_lshl_add_u32 v180, v162, 4, v180
  v_mfma_f32_16x16x32_bf16 v[132:135], a[196:199], v[100:103], v[132:135]
  s_and_b32 s54, s44, 1
  s_lshl_b32 s54, s54, 11
  v_add_u32 v182, s54, v1
  s_and_b32 s54, s44, 2
  v_mfma_f32_16x16x32_bf16 v[128:131], a[208:211], v[112:115], v[128:131]
  ds_read_b128 v[104:107], v22 offset:18432
  s_lshl_b32 s54, s54, 9
  s_add_u32 s54, s54, 135168
  v_mfma_f32_16x16x32_bf16 v[128:131], a[216:219], v[108:111], v[128:131]
  buffer_load_dwordx4 v9, s[8:11], s69 offen offset:1024 sc1 lds
  v_add_u32 v182, s54, v182
  ds_read_b128 v[160:163], v181 offset:0
  v_mfma_f32_16x16x32_bf16 v[132:135], a[220:223], v[108:111], v[132:135]
  ds_read_b128 v[100:103], v22 offset:19456
  ds_read_b128 v[164:167], v181 offset:64
  v_mfma_f32_16x16x32_bf16 v[132:135], a[212:215], v[112:115], v[132:135]
  s_waitcnt lgkmcnt(7)
  buffer_load_dwordx4 v9, s[8:11], s69 offen offset:2048 sc1 lds
  ds_read_b128 v[168:171], v181 offset:128
  v_mfma_f32_16x16x32_bf16 v[128:131], a[224:227], v[76:79], v[128:131]
  ds_read_b128 v[108:111], v22 offset:20480
  ds_read_b128 v[172:175], v181 offset:192
  v_mfma_f32_16x16x32_bf16 v[128:131], a[232:235], v[80:83], v[128:131]
  v_mov_b32 v176, 0x3f803f80
  v_mov_b32 v177, 0x3f803f80
  v_mov_b32 v178, 0x3f803f80
  v_mfma_f32_16x16x32_bf16 v[132:135], a[236:239], v[80:83], v[132:135]
  ds_read_b128 v[112:115], v22 offset:21504
  v_mov_b32 v179, 0x3f803f80
  s_mov_b32 s90, 0xcccccccc
  v_mfma_f32_16x16x32_bf16 v[132:135], a[228:231], v[76:79], v[132:135]
  buffer_load_dwordx4 v9, s[8:11], s69 offen offset:3072 sc1 lds
  s_add_u32 m0, s70, 49152
  s_add_u32 s69, s63, 131072
  s_mov_b32 s91, 0xcccccccc
  v_mfma_f32_16x16x32_bf16 v[128:131], a[240:243], v[88:91], v[128:131]
  ds_read_b128 v[80:83], v22 offset:22528
  v_lshrrev_b32 v220, 5, v0
  v_xor_b32 v220, 1, v220
  v_lshlrev_b32 v220, 12, v220
  v_mfma_f32_16x16x32_bf16 v[128:131], a[248:251], v[84:87], v[128:131]
  buffer_load_dwordx4 v9, s[8:11], s69 offen offset:0 sc1 lds
  s_waitcnt vmcnt(22) lgkmcnt(2)
  v_lshlrev_b32 v184, 16, v144
  v_and_b32 v185, 0xffff0000, v144
  v_mfma_f32_16x16x32_bf16 v[132:135], v[124:127], v[84:87], v[132:135]
  ds_read_b128 v[76:79], v22 offset:23552
  v_and_b32 v221, 31, v0
  v_lshl_add_u32 v220, v221, 3, v220
  v_mfma_f32_16x16x32_bf16 v[132:135], a[244:247], v[88:91], v[132:135]
  s_waitcnt lgkmcnt(7)
  v_add_u32 v15, s46, v0
  v_add_u32 v15, 3, v15
  s_waitcnt vmcnt(8)
  s_barrier
  s_mov_b64 exec, 1
  buffer_store_dword v15, v0, s[8:11], s74 offen offset:0 sc1
  s_mov_b64 exec, -1
  v_mfma_f32_16x16x32_bf16 v[136:139], a[0:3], v[92:95], 0
  ds_read_b128 v[84:87], v23 offset:16384
  v_lshlrev_b32 v186, 16, v145
  v_and_b32 v187, 0xffff0000, v145
  v_mfma_f32_16x16x32_bf16 v[136:139], a[8:11], v[96:99], v[136:139]
  buffer_load_dwordx4 v9, s[8:11], s69 offen offset:1024 sc1 lds
  v_lshlrev_b32 v188, 16, v146
  v_and_b32 v189, 0xffff0000, v146
  v_lshlrev_b32 v190, 16, v147
  v_mfma_f32_16x16x32_bf16 v[140:143], a[12:15], v[96:99], 0
  ds_read_b128 v[88:91], v23 offset:17408
  v_and_b32 v191, 0xffff0000, v147
  v_fmac_f32 v184, v160, v128
  v_mfma_f32_16x16x32_bf16 v[140:143], a[4:7], v[92:95], v[140:143]
  buffer_load_dwordx4 v9, s[8:11], s69 offen offset:2048 sc1 lds
  v_fmac_f32 v185, v161, v129
  v_fmac_f32 v186, v162, v130
  v_fmac_f32 v187, v163, v131
  v_mfma_f32_16x16x32_bf16 v[136:139], a[16:19], v[104:107], v[136:139]
  ds_read_b128 v[96:99], v23 offset:18432
  v_fmac_f32 v188, v164, v132
  v_fmac_f32 v189, v165, v133
  v_mfma_f32_16x16x32_bf16 v[136:139], a[24:27], v[100:103], v[136:139]
  v_fmac_f32 v190, v166, v134
  v_fmac_f32 v191, v167, v135
  v_mul_f32 v128, v184, v168
  v_mfma_f32_16x16x32_bf16 v[140:143], a[28:31], v[100:103], v[140:143]
  ds_read_b128 v[92:95], v23 offset:19456
  v_mul_f32 v129, v185, v169
  v_mul_f32 v130, v186, v170
  v_mfma_f32_16x16x32_bf16 v[140:143], a[20:23], v[104:107], v[140:143]
  s_waitcnt lgkmcnt(4)
  buffer_load_dwordx4 v9, s[8:11], s69 offen offset:3072 sc1 lds
  v_mul_f32 v131, v187, v171
  v_mul_f32 v132, v188, v172
  v_mfma_f32_16x16x32_bf16 v[136:139], a[32:35], v[108:111], v[136:139]
  ds_read_b128 v[100:103], v23 offset:20480
  s_add_u32 m0, s70, 98304
  s_add_u32 s69, s64, 131072
  v_mfma_f32_16x16x32_bf16 v[136:139], a[40:43], v[112:115], v[136:139]
  buffer_load_dwordx4 v9, s[8:11], s69 offen offset:0 sc1 lds
  v_mul_f32 v133, v189, v173
  v_mul_f32 v134, v190, v174
  v_mul_f32 v135, v191, v175
  v_mfma_f32_16x16x32_bf16 v[140:143], a[44:47], v[112:115], v[140:143]
  ds_read_b128 v[104:107], v23 offset:21504
  v_cvt_pk_bf16_f32 v196, v128, v129
  v_cvt_pk_bf16_f32 v197, v130, v131
  v_mfma_f32_16x16x32_bf16 v[140:143], a[36:39], v[108:111], v[140:143]
  v_cvt_pk_bf16_f32 v198, v132, v133
  v_cvt_pk_bf16_f32 v199, v134, v135
  v_mfma_f32_16x16x32_bf16 v[136:139], a[48:51], v[80:83], v[136:139]
  ds_read_b128 v[112:115], v23 offset:22528
  v_mfma_f32_16x16x32_bf16 v[136:139], a[56:59], v[76:79], v[136:139]
  buffer_load_dwordx4 v9, s[8:11], s69 offen offset:1024 sc1 lds
  s_add_u32 s54, s47, 36700160
  buffer_store_dwordx4 v[196:199], v1, s[8:11], s54 offen sc1
  v_mfma_f32_16x16x32_bf16 v[140:143], a[60:63], v[76:79], v[140:143]
  ds_read_b128 v[108:111], v23 offset:23552
  v_cvt_pk_bf16_f32 v144, v184, v185
  v_cvt_pk_bf16_f32 v145, v186, v187
  v_mfma_f32_16x16x32_bf16 v[140:143], a[52:55], v[80:83], v[140:143]
  s_waitcnt lgkmcnt(4)
  v_cvt_pk_bf16_f32 v146, v188, v189
  s_waitcnt vmcnt(12)
  s_barrier
  v_mfma_f32_16x16x32_bf16 v[136:139], a[64:67], v[84:87], v[136:139]
  ds_read_b128 v[76:79], v23 offset:0
  buffer_load_dwordx4 v9, s[8:11], s69 offen offset:2048 sc1 lds
  v_cvt_pk_bf16_f32 v147, v190, v191
  v_mfma_f32_16x16x32_bf16 v[136:139], a[72:75], v[88:91], v[136:139]
  s_nop 0
  v_mfma_f32_16x16x32_bf16 v[224:227], v[176:179], v[144:147], 0
  v_mfma_f32_16x16x32_bf16 v[192:195], v[144:147], v[144:147], 0
  v_mfma_f32_16x16x32_bf16 v[140:143], a[76:79], v[88:91], v[140:143]
  ds_read_b128 v[80:83], v23 offset:1024
  v_mfma_f32_16x16x32_bf16 v[140:143], a[68:71], v[84:87], v[140:143]
  buffer_load_dwordx4 v9, s[8:11], s69 offen offset:3072 sc1 lds
  s_add_u32 m0, s70, 114688
  s_add_u32 s69, s65, 131072
  v_mfma_f32_16x16x32_bf16 v[136:139], a[80:83], v[96:99], v[136:139]
  ds_read_b128 v[88:91], v23 offset:2048
  v_cndmask_b32 v192, v192, v193, s[88:89]
  v_cndmask_b32 v194, v194, v195, s[88:89]
  v_mfma_f32_16x16x32_bf16 v[136:139], a[88:91], v[92:95], v[136:139]
  buffer_load_dwordx4 v9, s[8:11], s69 offen offset:0 sc1 lds
  v_cndmask_b32 v225, v192, v194, s[90:91]
  v_mfma_f32_16x16x32_bf16 v[140:143], a[92:95], v[92:95], v[140:143]
  ds_read_b128 v[84:87], v23 offset:3072
  v_mfma_f32_16x16x32_bf16 v[140:143], a[84:87], v[96:99], v[140:143]
  s_waitcnt lgkmcnt(4)
  ds_write_b128 v182, v[144:147] offset:0
  v_mfma_f32_16x16x32_bf16 v[136:139], a[96:99], v[100:103], v[136:139]
  ds_read_b128 v[92:95], v23 offset:4096
  v_mfma_f32_16x16x32_bf16 v[136:139], a[104:107], v[104:107], v[136:139]
  buffer_load_dwordx4 v9, s[8:11], s69 offen offset:1024 sc1 lds
  v_mfma_f32_16x16x32_bf16 v[140:143], a[108:111], v[104:107], v[140:143]
  ds_read_b128 v[96:99], v23 offset:5120
  v_mfma_f32_16x16x32_bf16 v[140:143], a[100:103], v[100:103], v[140:143]
  buffer_load_dwordx4 v9, s[8:11], s69 offen offset:2048 sc1 lds
  v_mfma_f32_16x16x32_bf16 v[136:139], a[112:115], v[112:115], v[136:139]
  ds_read_b128 v[104:107], v23 offset:6144
  v_lshrrev_b32 v29, 2, v0
  v_mfma_f32_16x16x32_bf16 v[136:139], a[120:123], v[108:111], v[136:139]
  v_bfe_u32 v28, v29, 1, 2
  v_lshlrev_b32 v28, 5, v28
  v_mfma_f32_16x16x32_bf16 v[140:143], a[124:127], v[108:111], v[140:143]
  ds_read_b128 v[100:103], v23 offset:7168
  v_lshl_add_u32 v28, v29, 7, v28
  v_mfma_f32_16x16x32_bf16 v[140:143], a[116:119], v[112:115], v[140:143]
  s_waitcnt lgkmcnt(5)
  buffer_load_dwordx4 v9, s[8:11], s69 offen offset:3072 sc1 lds
  v_and_b32 v29, 3, v0
  v_mfma_f32_16x16x32_bf16 v[136:139], a[128:131], v[76:79], v[136:139]
  ds_read_b128 v[108:111], v22 offset:0
  v_lshl_add_u32 v2, v29, 3, v28
  v_mfma_f32_16x16x32_bf16 v[136:139], a[136:139], v[80:83], v[136:139]
  v_xor_b32 v3, 32, v2
  v_xor_b32 v4, 64, v2
  v_mfma_f32_16x16x32_bf16 v[140:143], a[140:143], v[80:83], v[140:143]
  ds_read_b128 v[112:115], v22 offset:1024
  v_xor_b32 v5, 96, v2
  v_mfma_f32_16x16x32_bf16 v[140:143], a[132:135], v[76:79], v[140:143]
  v_add_u32 v6, 65536, v2
  v_add_u32 v7, 65536, v3
  v_mfma_f32_16x16x32_bf16 v[136:139], a[144:147], v[88:91], v[136:139]
  ds_read_b128 v[80:83], v22 offset:2048
  v_add_u32 v8, 65536, v4
  v_mfma_f32_16x16x32_bf16 v[136:139], a[152:155], v[84:87], v[136:139]
  s_lshr_b32 s52, s2, 5
  s_lshl_b32 s52, s52, 19
  s_lshr_b32 s53, s44, 1
  v_mfma_f32_16x16x32_bf16 v[140:143], a[156:159], v[84:87], v[140:143]
  ds_read_b128 v[76:79], v22 offset:3072
  s_lshl_b32 s53, s53, 18
  v_mfma_f32_16x16x32_bf16 v[140:143], a[148:151], v[88:91], v[140:143]
  s_waitcnt lgkmcnt(4)
  s_add_u32 s52, s52, s53
  s_and_b32 s53, s44, 1
  v_mfma_f32_16x16x32_bf16 v[136:139], a[160:163], v[92:95], v[136:139]
  ds_read_b128 v[84:87], v22 offset:4096
  s_lshl_b32 s53, s53, 15
  v_mfma_f32_16x16x32_bf16 v[136:139], a[168:171], v[96:99], v[136:139]
  s_or_b32 s57, s2, s44
  s_mov_b32 s57, 851968
  s_cselect_b32 s57, 1073741824, s57
  v_add_u32 v15, s46, v0
  s_mov_b64 exec, 1
  buffer_store_dword v15, v0, s[8:11], s57 offen offset:0 sc1
  s_mov_b64 exec, -1
  s_add_u32 s56, s79, 12288
  v_mfma_f32_16x16x32_bf16 v[140:143], a[172:175], v[96:99], v[140:143]
  ds_read_b128 v[88:91], v22 offset:5120
  buffer_load_dwordx2 v[212:213], v220, s[8:11], s56 offen sc1
  v_mfma_f32_16x16x32_bf16 v[140:143], a[164:167], v[92:95], v[140:143]
  s_add_u32 s56, s79, 36864
  s_add_u32 s52, s52, s53
  s_add_u32 s24, s52, 36700160
  v_mfma_f32_16x16x32_bf16 v[136:139], a[176:179], v[104:107], v[136:139]
  ds_read_b128 v[96:99], v22 offset:6144
  s_lshl_b32 s57, s44, 28
  s_add_u32 s57, s57, s77
  buffer_load_dword v13, v14, s[8:11], s57 offen sc1
  buffer_load_dwordx2 v[214:215], v220, s[8:11], s56 offen sc1
  s_add_u32 s56, s79, 61440
  v_mfma_f32_16x16x32_bf16 v[136:139], a[184:187], v[100:103], v[136:139]
  buffer_load_dwordx2 v[216:217], v220, s[8:11], s56 offen sc1
  s_add_u32 s56, s79, 86016
  v_mfma_f32_16x16x32_bf16 v[140:143], a[188:191], v[100:103], v[140:143]
  ds_read_b128 v[92:95], v22 offset:7168
  v_mfma_f32_16x16x32_bf16 v[140:143], a[180:183], v[104:107], v[140:143]
  s_waitcnt lgkmcnt(4)
  buffer_load_dwordx2 v[218:219], v220, s[8:11], s56 offen sc1
  s_waitcnt vmcnt(15)
  s_barrier
  v_mfma_f32_16x16x32_bf16 v[136:139], a[192:195], v[108:111], v[136:139]
  ds_read_b128 v[100:103], v22 offset:32768
  s_bitcmp1_b32 s2, 3
  s_cselect_b64 s[12:13], s[32:33], s[28:29]
  v_mfma_f32_16x16x32_bf16 v[136:139], a[200:203], v[112:115], v[136:139]
  s_mov_b32 s14, 7340032
  s_mov_b32 s16, 0x03030303
  s_mov_b32 s17, 0x03030303
  v_mfma_f32_16x16x32_bf16 v[140:143], a[204:207], v[112:115], v[140:143]
  ds_read_b128 v[104:107], v22 offset:33792
  s_mov_b32 s18, 0x0c0c0c0c
  v_mfma_f32_16x16x32_bf16 v[140:143], a[196:199], v[108:111], v[140:143]
  s_mov_b32 s19, 0x0c0c0c0c
  s_mov_b32 s20, 0x30303030
  s_mov_b32 s21, 0x30303030
  v_mfma_f32_16x16x32_bf16 v[136:139], a[208:211], v[80:83], v[136:139]
  ds_read_b128 v[112:115], v22 offset:34816
  s_waitcnt vmcnt(40) lgkmcnt(15)
  v_lshlrev_b32 v184, 16, v148
  v_and_b32 v185, 0xffff0000, v148
  v_lshlrev_b32 v186, 16, v149
  v_mfma_f32_16x16x32_bf16 v[136:139], a[216:219], v[76:79], v[136:139]
  v_and_b32 v187, 0xffff0000, v149
  v_lshlrev_b32 v188, 16, v150
  v_and_b32 v189, 0xffff0000, v150
  v_lshlrev_b32 v190, 16, v151
  v_and_b32 v191, 0xffff0000, v151
  v_mfma_f32_16x16x32_bf16 v[140:143], a[220:223], v[76:79], v[140:143]
  ds_read_b128 v[108:111], v22 offset:35840
  s_mov_b32 s22, 0xc0c0c0c0
  v_mfma_f32_16x16x32_bf16 v[140:143], a[212:215], v[80:83], v[140:143]
  s_waitcnt lgkmcnt(4)
  s_mov_b32 s23, 0xc0c0c0c0
  v_mfma_f32_16x16x32_bf16 v[136:139], a[224:227], v[84:87], v[136:139]
  ds_read_b128 v[76:79], v22 offset:36864
  v_mfma_f32_16x16x32_bf16 v[136:139], a[232:235], v[88:91], v[136:139]
  v_mfma_f32_16x16x32_bf16 v[140:143], a[236:239], v[88:91], v[140:143]
  ds_read_b128 v[80:83], v22 offset:37888
  v_mfma_f32_16x16x32_bf16 v[140:143], a[228:231], v[84:87], v[140:143]
  v_mfma_f32_16x16x32_bf16 v[136:139], a[240:243], v[96:99], v[136:139]
  ds_read_b128 v[88:91], v22 offset:38912
  v_mfma_f32_16x16x32_bf16 v[136:139], a[248:251], v[92:95], v[136:139]
  v_mfma_f32_16x16x32_bf16 v[140:143], v[124:127], v[92:95], v[140:143]
  ds_read_b128 v[84:87], v22 offset:39936
  v_mfma_f32_16x16x32_bf16 v[140:143], a[244:247], v[96:99], v[140:143]
  s_waitcnt lgkmcnt(4)
  v_mfma_f32_16x16x32_bf16 v[128:131], a[0:3], v[100:103], 0
  ds_read_b128 v[92:95], v22 offset:49152
  v_mfma_f32_16x16x32_bf16 v[128:131], a[8:11], v[104:107], v[128:131]
  v_mfma_f32_16x16x32_bf16 v[132:135], a[12:15], v[104:107], 0
  ds_read_b128 v[96:99], v22 offset:50176
  v_fmac_f32 v184, v160, v136
  v_fmac_f32 v185, v161, v137
  v_fmac_f32 v186, v162, v138
  v_fmac_f32 v187, v163, v139
  v_mfma_f32_16x16x32_bf16 v[132:135], a[4:7], v[100:103], v[132:135]
  v_fmac_f32 v188, v164, v140
  v_fmac_f32 v189, v165, v141
  v_fmac_f32 v190, v166, v142
  v_fmac_f32 v191, v167, v143
  v_mul_f32 v136, v184, v168
  v_mfma_f32_16x16x32_bf16 v[128:131], a[16:19], v[112:115], v[128:131]
  ds_read_b128 v[104:107], v22 offset:51200
  v_mul_f32 v137, v185, v169
  v_mul_f32 v138, v186, v170
  v_mul_f32 v139, v187, v171
  v_mul_f32 v140, v188, v172
  v_mfma_f32_16x16x32_bf16 v[128:131], a[24:27], v[108:111], v[128:131]
  v_mul_f32 v141, v189, v173
  v_mul_f32 v142, v190, v174
  v_mul_f32 v143, v191, v175
  v_cvt_pk_bf16_f32 v200, v136, v137
  v_cvt_pk_bf16_f32 v201, v138, v139
  v_mfma_f32_16x16x32_bf16 v[132:135], a[28:31], v[108:111], v[132:135]
  ds_read_b128 v[100:103], v22 offset:52224
  v_cvt_pk_bf16_f32 v202, v140, v141
  v_cvt_pk_bf16_f32 v203, v142, v143
  v_mfma_f32_16x16x32_bf16 v[132:135], a[20:23], v[112:115], v[132:135]
  s_waitcnt lgkmcnt(4)
  s_add_u32 s54, s47, 36765696
  buffer_store_dwordx4 v[200:203], v1, s[8:11], s54 offen sc1
  v_mfma_f32_16x16x32_bf16 v[128:131], a[32:35], v[76:79], v[128:131]
  ds_read_b128 v[108:111], v22 offset:53248
  v_cvt_pk_bf16_f32 v148, v184, v185
  v_cvt_pk_bf16_f32 v149, v186, v187
  v_cvt_pk_bf16_f32 v150, v188, v189
  v_cvt_pk_bf16_f32 v151, v190, v191
  v_mfma_f32_16x16x32_bf16 v[128:131], a[40:43], v[80:83], v[128:131]
  s_nop 0
  v_mfma_f32_16x16x32_bf16 v[226:229], v[176:179], v[148:151], 0
  v_mfma_f32_16x16x32_bf16 v[192:195], v[148:151], v[148:151], 0
  v_mfma_f32_16x16x32_bf16 v[132:135], a[44:47], v[80:83], v[132:135]
  ds_read_b128 v[112:115], v22 offset:54272
  v_mfma_f32_16x16x32_bf16 v[132:135], a[36:39], v[76:79], v[132:135]
  v_mfma_f32_16x16x32_bf16 v[128:131], a[48:51], v[88:91], v[128:131]
  ds_read_b128 v[80:83], v22 offset:55296
  s_nop 2
  v_cndmask_b32 v192, v192, v193, s[88:89]
  v_cndmask_b32 v194, v194, v195, s[88:89]
  v_cndmask_b32 v227, v192, v194, s[90:91]
  v_mfma_f32_16x16x32_bf16 v[128:131], a[56:59], v[84:87], v[128:131]
  buffer_store_dwordx4 v[224:227], v180, s[8:11], s48 offen offset:0 sc1
  v_mfma_f32_16x16x32_bf16 v[132:135], a[60:63], v[84:87], v[132:135]
  ds_read_b128 v[76:79], v22 offset:56320
  v_mfma_f32_16x16x32_bf16 v[132:135], a[52:55], v[88:91], v[132:135]
  s_waitcnt lgkmcnt(4)
  s_waitcnt vmcnt(5)
  s_cmp_lg_u32 s44, 0
  s_cbranch_scc1 PL8_adaLN_cond__sliding_local_dilated__swiglu_ffn__prompt_kernelx
  v_subrev_u32 v13, s46, v13
  v_subrev_u32 v13, 3, v13
  v_cmp_lt_u32 vcc, 3, v13
  s_nop 4
  s_cbranch_vccz PL8_adaLN_cond__sliding_local_dilated__swiglu_ffn__prompt_kernelx
  s_mov_b32 s57, 60000
PL8_adaLN_cond__sliding_local_dilated__swiglu_ffn__prompt_kernel:
  buffer_load_dword v13, v14, s[8:11], s77 offen sc1
  s_sub_u32 s57, s57, 1
  s_cmp_eq_u32 s57, 0
  s_waitcnt vmcnt(0)
  s_cbranch_scc1 PL8_adaLN_cond__sliding_local_dilated__swiglu_ffn__prompt_kernelx
  v_subrev_u32 v13, s46, v13
  v_subrev_u32 v13, 3, v13
  v_cmp_lt_u32 vcc, 3, v13
  s_nop 4
  s_cbranch_vccnz PL8_adaLN_cond__sliding_local_dilated__swiglu_ffn__prompt_kernel
PL8_adaLN_cond__sliding_local_dilated__swiglu_ffn__prompt_kernelx:
  s_waitcnt vmcnt(8)
  s_barrier
  v_mfma_f32_16x16x32_bf16 v[128:131], a[64:67], v[92:95], v[128:131]
  ds_read_b128 v[84:87], v23 offset:32768
  s_add_u32 m0, s70, 16384
  s_add_u32 s69, s62, 196608
  ds_write_b128 v182, v[148:151] offset:4096
  v_mfma_f32_16x16x32_bf16 v[128:131], a[72:75], v[96:99], v[128:131]
  buffer_load_dwordx4 v9, s[8:11], s69 offen offset:0 sc1 lds
  v_mfma_f32_16x16x32_bf16 v[132:135], a[76:79], v[96:99], v[132:135]
  ds_read_b128 v[88:91], v23 offset:33792
  v_mfma_f32_16x16x32_bf16 v[132:135], a[68:71], v[92:95], v[132:135]
  buffer_load_dwordx4 v9, s[8:11], s69 offen offset:1024 sc1 lds
  v_mfma_f32_16x16x32_bf16 v[128:131], a[80:83], v[104:107], v[128:131]
  ds_read_b128 v[96:99], v23 offset:34816
  buffer_load_dwordx4 v9, s[8:11], s69 offen offset:2048 sc1 lds
  v_mfma_f32_16x16x32_bf16 v[128:131], a[88:91], v[100:103], v[128:131]
  v_mfma_f32_16x16x32_bf16 v[132:135], a[92:95], v[100:103], v[132:135]
  ds_read_b128 v[92:95], v23 offset:35840
  buffer_load_dwordx4 v9, s[8:11], s69 offen offset:3072 sc1 lds
  s_add_u32 m0, s70, 81920
  s_add_u32 s69, s63, 196608
  v_mfma_f32_16x16x32_bf16 v[132:135], a[84:87], v[104:107], v[132:135]
  s_waitcnt lgkmcnt(5)
  buffer_load_dwordx4 v9, s[8:11], s69 offen offset:0 sc1 lds
  v_mfma_f32_16x16x32_bf16 v[128:131], a[96:99], v[108:111], v[128:131]
  ds_read_b128 v[100:103], v23 offset:36864
  v_mfma_f32_16x16x32_bf16 v[128:131], a[104:107], v[112:115], v[128:131]
  buffer_load_dwordx4 v9, s[8:11], s69 offen offset:1024 sc1 lds
  v_mfma_f32_16x16x32_bf16 v[132:135], a[108:111], v[112:115], v[132:135]
  ds_read_b128 v[104:107], v23 offset:37888
  buffer_load_dwordx4 v9, s[8:11], s69 offen offset:2048 sc1 lds
  v_mfma_f32_16x16x32_bf16 v[132:135], a[100:103], v[108:111], v[132:135]
  v_mfma_f32_16x16x32_bf16 v[128:131], a[112:115], v[80:83], v[128:131]
  ds_read_b128 v[112:115], v23 offset:38912
  buffer_load_dwordx4 v9, s[8:11], s69 offen offset:3072 sc1 lds
  s_add_u32 m0, s70, 65536
  s_add_u32 s69, s64, 196608
  v_mfma_f32_16x16x32_bf16 v[128:131], a[120:123], v[76:79], v[128:131]
  buffer_load_dwordx4 v9, s[8:11], s69 offen offset:0 sc1 lds
  v_mfma_f32_16x16x32_bf16 v[132:135], a[124:127], v[76:79], v[132:135]
  ds_read_b128 v[108:111], v23 offset:39936
  v_mfma_f32_16x16x32_bf16 v[132:135], a[116:119], v[80:83], v[132:135]
  s_waitcnt lgkmcnt(4)
  buffer_load_dwordx4 v9, s[8:11], s69 offen offset:1024 sc1 lds
  v_mfma_f32_16x16x32_bf16 v[128:131], a[128:131], v[84:87], v[128:131]
  ds_read_b128 v[76:79], v23 offset:49152
  buffer_load_dwordx4 v9, s[8:11], s69 offen offset:2048 sc1 lds
  v_mfma_f32_16x16x32_bf16 v[128:131], a[136:139], v[88:91], v[128:131]
  v_mfma_f32_16x16x32_bf16 v[132:135], a[140:143], v[88:91], v[132:135]
  ds_read_b128 v[80:83], v23 offset:50176
  buffer_load_dwordx4 v9, s[8:11], s69 offen offset:3072 sc1 lds
  s_add_u32 m0, s70, 0
  s_add_u32 s69, s65, 196608
  v_mfma_f32_16x16x32_bf16 v[132:135], a[132:135], v[84:87], v[132:135]
  buffer_load_dwordx4 v9, s[8:11], s69 offen offset:0 sc1 lds
  v_mfma_f32_16x16x32_bf16 v[128:131], a[144:147], v[96:99], v[128:131]
  ds_read_b128 v[88:91], v23 offset:51200
  v_mfma_f32_16x16x32_bf16 v[128:131], a[152:155], v[92:95], v[128:131]
  buffer_load_dwordx4 v9, s[8:11], s69 offen offset:1024 sc1 lds
  v_mfma_f32_16x16x32_bf16 v[132:135], a[156:159], v[92:95], v[132:135]
  ds_read_b128 v[84:87], v23 offset:52224
  buffer_load_dwordx4 v9, s[8:11], s69 offen offset:2048 sc1 lds
  v_mfma_f32_16x16x32_bf16 v[132:135], a[148:151], v[96:99], v[132:135]
  s_waitcnt lgkmcnt(4)
  v_mfma_f32_16x16x32_bf16 v[128:131], a[160:163], v[100:103], v[128:131]
  ds_read_b128 v[92:95], v23 offset:53248
  v_mfma_f32_16x16x32_bf16 v[128:131], a[168:171], v[104:107], v[128:131]
  buffer_load_dwordx4 v9, s[8:11], s69 offen offset:3072 sc1 lds
  v_mfma_f32_16x16x32_bf16 v[132:135], a[172:175], v[104:107], v[132:135]
  ds_read_b128 v[96:99], v23 offset:54272
  v_mfma_f32_16x16x32_bf16 v[132:135], a[164:167], v[100:103], v[132:135]
  v_mfma_f32_16x16x32_bf16 v[128:131], a[176:179], v[112:115], v[128:131]
  ds_read_b128 v[104:107], v23 offset:55296
  s_waitcnt vmcnt(18)
  v_mfma_f32_16x16x32_bf16 v[128:131], a[184:187], v[108:111], v[128:131]
  s_mov_b32 s55, 0
  s_add_u32 m0, s45, 32768
  v_add_f32 v212, v212, v214
  s_sub_u32 s73, s49, 524288
  v_mfma_f32_16x16x32_bf16 v[132:135], a[188:191], v[108:111], v[132:135]
  ds_read_b128 v[100:103], v23 offset:56320
  buffer_load_dwordx4 v16, s[28:31], s55 offen lds
  v_mfma_f32_16x16x32_bf16 v[132:135], a[180:183], v[112:115], v[132:135]
  s_waitcnt lgkmcnt(4)
  s_waitcnt vmcnt(9)
  s_barrier
  v_add_u32 v15, s46, v0
  s_mov_b64 exec, 1
  buffer_store_dword v15, v0, s[8:11], s73 offen offset:0 sc1
  s_mov_b64 exec, -1
  v_mfma_f32_16x16x32_bf16 v[128:131], a[192:195], v[76:79], v[128:131]
  ds_read_b128 v[108:111], v22 offset:16384
  v_add_f32 v216, v216, v218
  v_mfma_f32_16x16x32_bf16 v[128:131], a[200:203], v[80:83], v[128:131]
  v_add_f32 v212, v212, v216
  v_add_f32 v213, v213, v215
  v_mfma_f32_16x16x32_bf16 v[132:135], a[204:207], v[80:83], v[132:135]
  ds_read_b128 v[112:115], v22 offset:17408
  v_add_f32 v217, v217, v219
  v_mfma_f32_16x16x32_bf16 v[132:135], a[196:199], v[76:79], v[132:135]
HOP6:
  s_cbranch_execz HOP10
  s_mov_b32 s55, 0
  s_add_u32 m0, s45, 40960
  v_add_f32 v213, v213, v217
  v_mfma_f32_16x16x32_bf16 v[128:131], a[208:211], v[88:91], v[128:131]
  ds_read_b128 v[80:83], v22 offset:18432
  s_waitcnt vmcnt(59) lgkmcnt(15)
  v_lshlrev_b32 v184, 16, v152
  v_mfma_f32_16x16x32_bf16 v[128:131], a[216:219], v[84:87], v[128:131]
  buffer_load_dwordx4 v16, s[32:35], s55 offen lds
  v_and_b32 v185, 0xffff0000, v152
  v_lshlrev_b32 v186, 16, v153
  v_and_b32 v187, 0xffff0000, v153
  v_mfma_f32_16x16x32_bf16 v[132:135], a[220:223], v[84:87], v[132:135]
  ds_read_b128 v[76:79], v22 offset:19456
  v_lshlrev_b32 v188, 16, v154
  v_and_b32 v189, 0xffff0000, v154
  v_mfma_f32_16x16x32_bf16 v[132:135], a[212:215], v[88:91], v[132:135]
  s_waitcnt lgkmcnt(4)
  v_lshlrev_b32 v190, 16, v155
  v_and_b32 v191, 0xffff0000, v155
  v_mfma_f32_16x16x32_bf16 v[128:131], a[224:227], v[92:95], v[128:131]
  ds_read_b128 v[84:87], v22 offset:20480
  v_lshrrev_b32 v28, 5, v0
  v_mfma_f32_16x16x32_bf16 v[128:131], a[232:235], v[96:99], v[128:131]
  s_mov_b32 s55, 229376
  s_add_u32 m0, s45, 36864
  v_xor_b32 v29, 1, v28
  v_mfma_f32_16x16x32_bf16 v[132:135], a[236:239], v[96:99], v[132:135]
  ds_read_b128 v[88:91], v22 offset:21504
  v_cvt_f32_u32 v29, v29
  v_mfma_f32_16x16x32_bf16 v[132:135], a[228:231], v[92:95], v[132:135]
  buffer_load_dwordx4 v16, s[28:31], s55 offen lds
  v_cvt_pk_bf16_f32 v214, v212, v213
  v_lshlrev_b32 v212, 16, v214
  v_mfma_f32_16x16x32_bf16 v[128:131], a[240:243], v[104:107], v[128:131]
  ds_read_b128 v[96:99], v22 offset:22528
  v_and_b32 v213, 0xffff0000, v214
  v_mfma_f32_16x16x32_bf16 v[128:131], a[248:251], v[100:103], v[128:131]
  v_add_f32 v212, v212, v29
  v_add_f32 v213, v213, v29
  v_mfma_f32_16x16x32_bf16 v[132:135], v[124:127], v[100:103], v[132:135]
  ds_read_b128 v[92:95], v22 offset:23552
  v_cvt_pk_bf16_f32 v214, v212, v213
  v_mfma_f32_16x16x32_bf16 v[132:135], a[244:247], v[104:107], v[132:135]
  s_waitcnt lgkmcnt(4)
  s_mov_b32 s55, 229376
  s_add_u32 m0, s45, 45056
  v_mfma_f32_16x16x32_bf16 v[136:139], a[0:3], v[108:111], 0
  ds_read_b128 v[100:103], v23 offset:16384
  v_lshlrev_b32 v212, 16, v214
  v_mfma_f32_16x16x32_bf16 v[136:139], a[8:11], v[112:115], v[136:139]
  buffer_load_dwordx4 v16, s[32:35], s55 offen lds
  v_and_b32 v213, 0xffff0000, v214
  v_lshrrev_b32 v215, 16, v214
  v_mfma_f32_16x16x32_bf16 v[140:143], a[12:15], v[112:115], 0
  ds_read_b128 v[104:107], v23 offset:17408
  v_fmac_f32 v184, v160, v128
  v_fmac_f32 v185, v161, v129
  v_mfma_f32_16x16x32_bf16 v[140:143], a[4:7], v[108:111], v[140:143]
  v_fmac_f32 v186, v162, v130
  v_fmac_f32 v187, v163, v131
  v_fmac_f32 v188, v164, v132
  v_mfma_f32_16x16x32_bf16 v[136:139], a[16:19], v[80:83], v[136:139]
  ds_read_b128 v[112:115], v23 offset:18432
  v_fmac_f32 v189, v165, v133
  v_fmac_f32 v190, v166, v134
  v_mfma_f32_16x16x32_bf16 v[136:139], a[24:27], v[76:79], v[136:139]
  s_mov_b32 s55, 0
  s_add_u32 m0, s45, 98304
  v_fmac_f32 v191, v167, v135
  v_mul_f32 v128, v184, v168
  v_mfma_f32_16x16x32_bf16 v[140:143], a[28:31], v[76:79], v[140:143]
  ds_read_b128 v[108:111], v23 offset:19456
  v_mul_f32 v129, v185, v169
  v_mul_f32 v130, v186, v170
  v_mfma_f32_16x16x32_bf16 v[140:143], a[20:23], v[80:83], v[140:143]
  s_waitcnt lgkmcnt(4)
  buffer_load_dwordx4 v11, s[28:31], s55 offen lds
  v_mul_f32 v131, v187, v171
  v_mul_f32 v132, v188, v172
  v_mfma_f32_16x16x32_bf16 v[136:139], a[32:35], v[84:87], v[136:139]
  ds_read_b128 v[76:79], v23 offset:20480
  v_mul_f32 v133, v189, v173
  v_mul_f32 v134, v190, v174
  v_mfma_f32_16x16x32_bf16 v[136:139], a[40:43], v[88:91], v[136:139]
  v_mul_f32 v135, v191, v175
  v_cvt_pk_bf16_f32 v204, v128, v129
  v_cvt_pk_bf16_f32 v205, v130, v131
  v_and_b32 v214, 0xffff, v214
  v_mfma_f32_16x16x32_bf16 v[140:143], a[44:47], v[88:91], v[140:143]
  ds_read_b128 v[80:83], v23 offset:21504
  v_cvt_pk_bf16_f32 v206, v132, v133
  v_cvt_pk_bf16_f32 v207, v134, v135
  v_mfma_f32_16x16x32_bf16 v[140:143], a[36:39], v[84:87], v[140:143]
  s_mov_b32 s55, 0
  s_add_u32 m0, s45, 106496
  s_add_u32 s52, s45, 151552
  v_mfma_f32_16x16x32_bf16 v[136:139], a[48:51], v[96:99], v[136:139]
  ds_read_b128 v[88:91], v23 offset:22528
  v_lshlrev_b32 v28, 8, v28
  v_mfma_f32_16x16x32_bf16 v[136:139], a[56:59], v[92:95], v[136:139]
  buffer_load_dwordx4 v11, s[32:35], s55 offen lds
  s_add_u32 s54, s47, 36831232
  buffer_store_dwordx4 v[204:207], v1, s[8:11], s54 offen sc1
  v_mfma_f32_16x16x32_bf16 v[140:143], a[60:63], v[92:95], v[140:143]
  ds_read_b128 v[84:87], v23 offset:23552
  v_cvt_pk_bf16_f32 v152, v184, v185
  v_cvt_pk_bf16_f32 v153, v186, v187
  v_mfma_f32_16x16x32_bf16 v[140:143], a[52:55], v[96:99], v[140:143]
  s_waitcnt lgkmcnt(4)
  v_cvt_pk_bf16_f32 v154, v188, v189
  s_waitcnt vmcnt(8)
  s_barrier
  v_mfma_f32_16x16x32_bf16 v[136:139], a[64:67], v[100:103], v[136:139]
  ds_read_b128 v[92:95], v23 offset:0
  v_cvt_pk_bf16_f32 v155, v190, v191
  v_mfma_f32_16x16x32_bf16 v[136:139], a[72:75], v[104:107], v[136:139]
  s_mov_b32 s55, 229376
  s_add_u32 m0, s45, 102400
  v_mfma_f32_16x16x32_bf16 v[228:231], v[176:179], v[152:155], 0
  v_mfma_f32_16x16x32_bf16 v[192:195], v[152:155], v[152:155], 0
  v_lshl_add_u32 v28, v0, 3, v28
  v_add_u32 v28, s52, v28
  v_mfma_f32_16x16x32_bf16 v[140:143], a[76:79], v[104:107], v[140:143]
  ds_read_b128 v[96:99], v23 offset:1024
  v_mfma_f32_16x16x32_bf16 v[140:143], a[68:71], v[100:103], v[140:143]
  buffer_load_dwordx4 v11, s[28:31], s55 offen lds
  ds_write_b64 v28, v[214:215]
  v_mfma_f32_16x16x32_bf16 v[136:139], a[80:83], v[112:115], v[136:139]
  ds_read_b128 v[104:107], v23 offset:2048
  v_cndmask_b32 v192, v192, v193, s[88:89]
  v_cndmask_b32 v194, v194, v195, s[88:89]
  v_mfma_f32_16x16x32_bf16 v[136:139], a[88:91], v[108:111], v[136:139]
  ds_write_b64 v28, v[212:213] offset:256
  v_cndmask_b32 v229, v192, v194, s[90:91]
  v_mfma_f32_16x16x32_bf16 v[140:143], a[92:95], v[108:111], v[140:143]
  ds_read_b128 v[100:103], v23 offset:3072
  v_mfma_f32_16x16x32_bf16 v[140:143], a[84:87], v[112:115], v[140:143]
  s_waitcnt lgkmcnt(6)
  s_mov_b32 s55, 229376
  s_add_u32 m0, s45, 110592
  v_mfma_f32_16x16x32_bf16 v[136:139], a[96:99], v[76:79], v[136:139]
  ds_read_b128 v[108:111], v23 offset:4096
  ds_write_b128 v182, v[152:155] offset:8192
  v_mfma_f32_16x16x32_bf16 v[136:139], a[104:107], v[80:83], v[136:139]
  buffer_load_dwordx4 v11, s[32:35], s55 offen lds
  v_mfma_f32_16x16x32_bf16 v[140:143], a[108:111], v[80:83], v[140:143]
  ds_read_b128 v[112:115], v23 offset:5120
  v_mfma_f32_16x16x32_bf16 v[140:143], a[100:103], v[76:79], v[140:143]
  v_mfma_f32_16x16x32_bf16 v[136:139], a[112:115], v[88:91], v[136:139]
  ds_read_b128 v[80:83], v23 offset:6144
  v_mfma_f32_16x16x32_bf16 v[136:139], a[120:123], v[84:87], v[136:139]
  s_mov_b32 s55, 458752
  s_add_u32 m0, s45, 114688
  v_mfma_f32_16x16x32_bf16 v[140:143], a[124:127], v[84:87], v[140:143]
  ds_read_b128 v[76:79], v23 offset:7168
  v_mfma_f32_16x16x32_bf16 v[140:143], a[116:119], v[88:91], v[140:143]
  s_waitcnt lgkmcnt(5)
  buffer_load_dwordx4 v11, s[28:31], s55 offen lds
  v_mfma_f32_16x16x32_bf16 v[136:139], a[128:131], v[92:95], v[136:139]
  ds_read_b128 v[84:87], v22 offset:0
  v_mfma_f32_16x16x32_bf16 v[136:139], a[136:139], v[96:99], v[136:139]
  v_mfma_f32_16x16x32_bf16 v[140:143], a[140:143], v[96:99], v[140:143]
  ds_read_b128 v[88:91], v22 offset:1024
  v_mfma_f32_16x16x32_bf16 v[140:143], a[132:135], v[92:95], v[140:143]
  s_mov_b32 s55, 458752
  s_add_u32 m0, s45, 122880
  v_mfma_f32_16x16x32_bf16 v[136:139], a[144:147], v[104:107], v[136:139]
  ds_read_b128 v[96:99], v22 offset:2048
  v_mfma_f32_16x16x32_bf16 v[136:139], a[152:155], v[100:103], v[136:139]
  buffer_load_dwordx4 v11, s[32:35], s55 offen lds
  v_mfma_f32_16x16x32_bf16 v[140:143], a[156:159], v[100:103], v[140:143]
  ds_read_b128 v[92:95], v22 offset:3072
  v_mfma_f32_16x16x32_bf16 v[140:143], a[148:151], v[104:107], v[140:143]
  s_waitcnt lgkmcnt(4)
  v_mfma_f32_16x16x32_bf16 v[136:139], a[160:163], v[108:111], v[136:139]
  ds_read_b128 v[100:103], v22 offset:4096
  v_mfma_f32_16x16x32_bf16 v[136:139], a[168:171], v[112:115], v[136:139]
  s_mov_b32 s55, 688128
  s_add_u32 m0, s45, 118784
  v_mfma_f32_16x16x32_bf16 v[140:143], a[172:175], v[112:115], v[140:143]
  ds_read_b128 v[104:107], v22 offset:5120
  v_mfma_f32_16x16x32_bf16 v[140:143], a[164:167], v[108:111], v[140:143]
  buffer_load_dwordx4 v11, s[28:31], s55 offen lds
  v_mfma_f32_16x16x32_bf16 v[136:139], a[176:179], v[80:83], v[136:139]
  ds_read_b128 v[112:115], v22 offset:6144
  s_waitcnt vmcnt(63) lgkmcnt(15)
  v_mfma_f32_16x16x32_bf16 v[136:139], a[184:187], v[76:79], v[136:139]
  s_lshr_b32 s77, s2, 5
  s_lshl_b32 s77, s77, 12
  s_add_u32 s77, s77, 229376
  v_mfma_f32_16x16x32_bf16 v[140:143], a[188:191], v[76:79], v[140:143]
  ds_read_b128 v[108:111], v22 offset:7168
  s_mov_b32 s55, 688128
  s_add_u32 m0, s45, 126976
  v_mfma_f32_16x16x32_bf16 v[140:143], a[180:183], v[80:83], v[140:143]
  s_waitcnt lgkmcnt(4)
  v_and_b32 v14, 31, v0
  v_lshlrev_b32 v14, 7, v14
  v_mfma_f32_16x16x32_bf16 v[136:139], a[192:195], v[84:87], v[136:139]
  buffer_load_dwordx4 v11, s[32:35], s55 offen lds
  v_lshlrev_b32 v184, 16, v156
  v_and_b32 v185, 0xffff0000, v156
  v_mfma_f32_16x16x32_bf16 v[136:139], a[200:203], v[88:91], v[136:139]
  s_lshl_b32 s57, s44, 28
  s_add_u32 s57, s57, s77
  buffer_load_dword v13, v14, s[8:11], s57 offen sc1
  v_mfma_f32_16x16x32_bf16 v[140:143], a[204:207], v[88:91], v[140:143]
  v_lshlrev_b32 v186, 16, v157
  v_and_b32 v187, 0xffff0000, v157
  v_mfma_f32_16x16x32_bf16 v[140:143], a[196:199], v[84:87], v[140:143]
  v_lshlrev_b32 v188, 16, v158
  v_and_b32 v189, 0xffff0000, v158
  v_mfma_f32_16x16x32_bf16 v[136:139], a[208:211], v[96:99], v[136:139]
  v_lshlrev_b32 v190, 16, v159
  v_and_b32 v191, 0xffff0000, v159
  v_mfma_f32_16x16x32_bf16 v[136:139], a[216:219], v[92:95], v[136:139]
  s_mov_b32 s55, 458752
  s_add_u32 m0, s45, 49152
  v_mfma_f32_16x16x32_bf16 v[140:143], a[220:223], v[92:95], v[140:143]
  buffer_load_dwordx4 v16, s[28:31], s55 offen lds
  v_mfma_f32_16x16x32_bf16 v[140:143], a[212:215], v[96:99], v[140:143]
  s_waitcnt lgkmcnt(0)
  v_mfma_f32_16x16x32_bf16 v[136:139], a[224:227], v[100:103], v[136:139]
  v_mfma_f32_16x16x32_bf16 v[136:139], a[232:235], v[104:107], v[136:139]
  v_mfma_f32_16x16x32_bf16 v[140:143], a[236:239], v[104:107], v[140:143]
  v_mfma_f32_16x16x32_bf16 v[140:143], a[228:231], v[100:103], v[140:143]
  s_mov_b32 s55, 458752
  s_add_u32 m0, s45, 57344
  v_mfma_f32_16x16x32_bf16 v[136:139], a[240:243], v[112:115], v[136:139]
  buffer_load_dwordx4 v16, s[32:35], s55 offen lds
  v_mfma_f32_16x16x32_bf16 v[136:139], a[248:251], v[108:111], v[136:139]
  v_mfma_f32_16x16x32_bf16 v[140:143], v[124:127], v[108:111], v[140:143]
  v_mfma_f32_16x16x32_bf16 v[140:143], a[244:247], v[112:115], v[140:143]
  s_nop 5
  v_fmac_f32 v184, v160, v136
  v_fmac_f32 v185, v161, v137
  v_fmac_f32 v186, v162, v138
  v_fmac_f32 v187, v163, v139
  v_fmac_f32 v188, v164, v140
  v_fmac_f32 v189, v165, v141
  v_fmac_f32 v190, v166, v142
  v_fmac_f32 v191, v167, v143
  v_mul_f32 v136, v184, v168
  v_mul_f32 v137, v185, v169
  v_mul_f32 v138, v186, v170
  v_mul_f32 v139, v187, v171
  v_mul_f32 v140, v188, v172
  v_mul_f32 v141, v189, v173
  v_mul_f32 v142, v190, v174
  v_mul_f32 v143, v191, v175
  v_cvt_pk_bf16_f32 v208, v136, v137
  v_cvt_pk_bf16_f32 v209, v138, v139
  v_cvt_pk_bf16_f32 v210, v140, v141
  v_cvt_pk_bf16_f32 v211, v142, v143
  s_add_u32 s54, s47, 36896768
  buffer_store_dwordx4 v[208:211], v1, s[8:11], s54 offen sc1
  v_cvt_pk_bf16_f32 v156, v184, v185
  v_cvt_pk_bf16_f32 v157, v186, v187
  v_cvt_pk_bf16_f32 v158, v188, v189
  v_cvt_pk_bf16_f32 v159, v190, v191
  s_nop 1
  v_mfma_f32_16x16x32_bf16 v[230:233], v[176:179], v[156:159], 0
  v_mfma_f32_16x16x32_bf16 v[192:195], v[156:159], v[156:159], 0
  s_nop 7
  v_cndmask_b32 v192, v192, v193, s[88:89]
  v_cndmask_b32 v194, v194, v195, s[88:89]
  v_cndmask_b32 v231, v192, v194, s[90:91]
  buffer_store_dwordx4 v[228:231], v180, s[8:11], s48 offen offset:256 sc1
  ds_write_b128 v182, v[156:159] offset:12288
  s_mov_b64 exec, 0
  s_cmp_eq_u32 s44, 0
  s_cbranch_scc1 HOP15
  s_cmp_eq_u32 s44, 1
  s_cbranch_scc1 HOP16
  s_cmp_eq_u32 s44, 2
  s_cbranch_scc1 HOP17
  s_cmp_eq_u32 s44, 3
  s_cbranch_scc1 HOP18
WRET1:
  s_mov_b64 exec, -1
  s_waitcnt vmcnt(9) lgkmcnt(0)
  s_waitcnt vmcnt(4)
  s_cmp_lg_u32 s44, 0
  s_cbranch_scc1 PL9_adaLN_cond__sliding_local_dilated__swiglu_ffn__prompt_kernelx
  v_cmp_ne_u32 vcc, s46, v13
  s_nop 4
  s_cbranch_vccz PL9_adaLN_cond__sliding_local_dilated__swiglu_ffn__prompt_kernelx
  s_mov_b32 s57, 60000
PL9_adaLN_cond__sliding_local_dilated__swiglu_ffn__prompt_kernel:
  buffer_load_dword v13, v14, s[8:11], s77 offen sc1
  s_sub_u32 s57, s57, 1
  s_cmp_eq_u32 s57, 0
  s_waitcnt vmcnt(0)
  s_cbranch_scc1 PL9_adaLN_cond__sliding_local_dilated__swiglu_ffn__prompt_kernelx
  v_cmp_ne_u32 vcc, s46, v13
  s_nop 4
  s_cbranch_vccnz PL9_adaLN_cond__sliding_local_dilated__swiglu_ffn__prompt_kernel
PL9_adaLN_cond__sliding_local_dilated__swiglu_ffn__prompt_kernelx:
  s_barrier
  s_mov_b32 s63, 0
  s_add_u32 s71, s24, 0
  buffer_load_dwordx4 a[0:3], v1, s[8:11], s71 offen offset:0 sc1
  buffer_load_dwordx4 a[16:19], v1, s[8:11], s71 offen offset:1024 sc1
  s_add_u32 s71, s71, 65536
  buffer_load_dwordx4 a[4:7], v1, s[8:11], s71 offen offset:0 sc1
  buffer_load_dwordx4 a[20:23], v1, s[8:11], s71 offen offset:1024 sc1
  s_mov_b32 s64, 458752
  s_add_u32 s72, s24, 2048
  buffer_load_dwordx4 a[32:35], v1, s[8:11], s72 offen offset:0 sc1
  buffer_load_dwordx4 a[48:51], v1, s[8:11], s72 offen offset:1024 sc1
  s_add_u32 s72, s72, 65536
  buffer_load_dwordx4 a[36:39], v1, s[8:11], s72 offen offset:0 sc1
  buffer_load_dwordx4 a[52:55], v1, s[8:11], s72 offen offset:1024 sc1
  s_waitcnt vmcnt(17) lgkmcnt(0)
  v_add_u32 v9, s46, v0
  s_waitcnt vmcnt(8)
  s_barrier
  s_mov_b64 exec, 1
  buffer_store_dword v9, v0, s[8:11], s49 offen offset:0 sc1
  s_mov_b64 exec, -1
  s_mov_b32 s55, 688128
  s_add_u32 m0, s45, 53248
  s_nop 0
  buffer_load_dwordx4 v16, s[28:31], s55 offen lds
  s_mov_b32 s55, 688128
  s_add_u32 m0, s45, 61440
  s_nop 0
  buffer_load_dwordx4 v16, s[32:35], s55 offen lds
  v_mov_b32 v10, v16
  ds_read_b64_tr_b16 a[160:161], v6 offset:32768
  ds_read_b64_tr_b16 a[162:163], v6 offset:34816
  ds_read_b64_tr_b16 a[164:165], v6 offset:36864
  ds_read_b64_tr_b16 a[166:167], v6 offset:38912
  ds_read_b64_tr_b16 a[168:169], v6 offset:40960
  ds_read_b64_tr_b16 a[170:171], v6 offset:43008
  ds_read_b64_tr_b16 a[172:173], v6 offset:45056
  ds_read_b64_tr_b16 a[174:175], v6 offset:47104
  ds_read_b64_tr_b16 a[176:177], v7 offset:32768
  ds_read_b64_tr_b16 a[178:179], v7 offset:34816
  ds_read_b64_tr_b16 a[180:181], v7 offset:36864
  ds_read_b64_tr_b16 a[182:183], v7 offset:38912
  ds_read_b64_tr_b16 a[188:189], v7 offset:40960
  ds_read_b64_tr_b16 a[190:191], v7 offset:43008
  ds_read_b64_tr_b16 a[192:193], v7 offset:45056
  ds_read_b64_tr_b16 a[194:195], v7 offset:47104
  s_waitcnt vmcnt(7) lgkmcnt(8)
  v_mfma_f32_16x16x32_bf16 v[64:67], a[160:163], a[0:3], 0
  ds_read_b64_tr_b16 a[196:197], v8 offset:32768
  s_mov_b32 s65, 917504
  s_add_u32 s73, s24, 4096
  s_add_u32 m0, s45, 81920
  v_mfma_f32_16x16x32_bf16 v[64:67], a[164:167], a[16:19], v[64:67]
  ds_read_b64_tr_b16 a[198:199], v8 offset:34816
  buffer_load_dwordx4 v11, s[28:31], s65 offen lds
  v_mfma_f32_16x16x32_bf16 v[68:71], a[164:167], a[20:23], 0
  ds_read_b64_tr_b16 a[200:201], v8 offset:36864
  s_lshr_b32 s53, s2, 5
  v_mfma_f32_16x16x32_bf16 v[68:71], a[160:163], a[4:7], v[68:71]
  ds_read_b64_tr_b16 a[202:203], v8 offset:38912
  s_lshl_b32 s53, s53, 12
  v_mfma_f32_16x16x32_bf16 v[84:87], a[168:171], a[4:7], 0
  ds_read_b64_tr_b16 a[204:205], v8 offset:40960
  s_add_u32 m0, s45, 90112
  v_mfma_f32_16x16x32_bf16 v[84:87], a[172:175], a[20:23], v[84:87]
  ds_read_b64_tr_b16 a[206:207], v8 offset:43008
  buffer_load_dwordx4 v11, s[32:35], s65 offen lds
  v_mfma_f32_16x16x32_bf16 v[80:83], a[172:175], a[16:19], 0
  ds_read_b64_tr_b16 a[208:209], v8 offset:45056
  s_add_u32 s81, s53, 753664
  v_mfma_f32_16x16x32_bf16 v[80:83], a[168:171], a[0:3], v[80:83]
  s_waitcnt lgkmcnt(7)
  ds_read_b64_tr_b16 a[210:211], v8 offset:47104
  v_mfma_f32_16x16x32_bf16 v[96:99], a[176:179], a[0:3], 0
  ds_read_b64_tr_b16 a[164:165], v2 offset:32768
  s_add_u32 m0, s45, 86016
  s_add_u32 s60, s65, 229376
  v_mfma_f32_16x16x32_bf16 v[96:99], a[180:183], a[16:19], v[96:99]
  ds_read_b64_tr_b16 a[166:167], v2 offset:34816
  buffer_load_dwordx4 v11, s[28:31], s60 offen lds
  v_mfma_f32_16x16x32_bf16 v[100:103], a[180:183], a[20:23], 0
  ds_read_b64_tr_b16 a[160:161], v2 offset:36864
  v_and_b32 v15, 31, v0
  v_mfma_f32_16x16x32_bf16 v[100:103], a[176:179], a[4:7], v[100:103]
  ds_read_b64_tr_b16 a[162:163], v2 offset:38912
  v_lshlrev_b32 v15, 7, v15
  v_mfma_f32_16x16x32_bf16 v[116:119], a[188:191], a[4:7], 0
  ds_read_b64_tr_b16 a[172:173], v2 offset:40960
  s_add_u32 m0, s45, 94208
  s_add_u32 s60, s65, 229376
  v_mfma_f32_16x16x32_bf16 v[116:119], a[192:195], a[20:23], v[116:119]
  ds_read_b64_tr_b16 a[174:175], v2 offset:43008
  buffer_load_dwordx4 v11, s[32:35], s60 offen lds
  v_mfma_f32_16x16x32_bf16 v[112:115], a[192:195], a[16:19], 0
  ds_read_b64_tr_b16 a[168:169], v2 offset:45056
  s_and_b32 s52, s2, 7
  v_mfma_f32_16x16x32_bf16 v[112:115], a[188:191], a[0:3], v[112:115]
  s_waitcnt lgkmcnt(7)
  ds_read_b64_tr_b16 a[170:171], v2 offset:47104
  v_mfma_f32_16x16x32_bf16 v[32:35], a[196:199], a[0:3], 0
  ds_read_b64_tr_b16 a[180:181], v3 offset:32768
  s_add_u32 m0, s45, 16384
  v_mfma_f32_16x16x32_bf16 v[32:35], a[200:203], a[16:19], v[32:35]
  ds_read_b64_tr_b16 a[182:183], v3 offset:34816
  buffer_load_dwordx4 v10, s[28:31], s65 offen lds
  v_mfma_f32_16x16x32_bf16 v[36:39], a[200:203], a[20:23], 0
  ds_read_b64_tr_b16 a[176:177], v3 offset:36864
  s_bfe_u32 s51, s2, 0x20003
  v_mfma_f32_16x16x32_bf16 v[36:39], a[196:199], a[4:7], v[36:39]
  ds_read_b64_tr_b16 a[178:179], v3 offset:38912
  s_lshr_b32 s50, s2, 5
  v_mfma_f32_16x16x32_bf16 v[52:55], a[204:207], a[4:7], 0
  ds_read_b64_tr_b16 a[192:193], v3 offset:40960
  s_add_u32 m0, s45, 24576
  v_mfma_f32_16x16x32_bf16 v[52:55], a[208:211], a[20:23], v[52:55]
  ds_read_b64_tr_b16 a[194:195], v3 offset:43008
  buffer_load_dwordx4 v10, s[32:35], s65 offen lds
  v_mfma_f32_16x16x32_bf16 v[48:51], a[208:211], a[16:19], 0
  ds_read_b64_tr_b16 a[188:189], v3 offset:45056
  s_add_u32 s56, s51, s50
  v_mfma_f32_16x16x32_bf16 v[48:51], a[204:207], a[0:3], v[48:51]
  s_waitcnt lgkmcnt(7)
  ds_read_b64_tr_b16 a[190:191], v3 offset:47104
  v_mfma_f32_16x16x32_bf16 v[128:131], a[164:167], a[0:3], 0
  ds_read_b64_tr_b16 a[200:201], v4 offset:32768
  s_add_u32 m0, s45, 20480
  s_add_u32 s60, s65, 229376
  v_mfma_f32_16x16x32_bf16 v[128:131], a[160:163], a[16:19], v[128:131]
  ds_read_b64_tr_b16 a[202:203], v4 offset:34816
  buffer_load_dwordx4 v10, s[28:31], s60 offen lds
  v_mfma_f32_16x16x32_bf16 v[132:135], a[160:163], a[20:23], 0
  ds_read_b64_tr_b16 a[196:197], v4 offset:36864
  s_and_b32 s56, s56, 3
  v_mfma_f32_16x16x32_bf16 v[132:135], a[164:167], a[4:7], v[132:135]
  ds_read_b64_tr_b16 a[198:199], v4 offset:38912
  s_lshl_b32 s53, s50, 1
  v_mfma_f32_16x16x32_bf16 v[148:151], a[172:175], a[4:7], 0
  ds_read_b64_tr_b16 a[208:209], v4 offset:40960
  s_add_u32 m0, s45, 28672
  s_add_u32 s60, s65, 229376
  v_mfma_f32_16x16x32_bf16 v[148:151], a[168:171], a[20:23], v[148:151]
  ds_read_b64_tr_b16 a[210:211], v4 offset:43008
  buffer_load_dwordx4 v10, s[32:35], s60 offen lds
  v_mfma_f32_16x16x32_bf16 v[144:147], a[168:171], a[16:19], 0
  ds_read_b64_tr_b16 a[204:205], v4 offset:45056
  s_lshr_b32 s54, s44, 1
  v_mfma_f32_16x16x32_bf16 v[144:147], a[172:175], a[0:3], v[144:147]
  s_waitcnt lgkmcnt(7)
  ds_read_b64_tr_b16 a[206:207], v4 offset:47104
  v_mfma_f32_16x16x32_bf16 v[160:163], a[180:183], a[0:3], 0
  ds_read_b64_tr_b16 a[160:161], v5 offset:32768
  v_mfma_f32_16x16x32_bf16 v[160:163], a[176:179], a[16:19], v[160:163]
  ds_read_b64_tr_b16 a[162:163], v5 offset:34816
  buffer_load_dwordx4 a[64:67], v1, s[8:11], s73 offen offset:0 sc1
  v_mfma_f32_16x16x32_bf16 v[164:167], a[176:179], a[20:23], 0
  ds_read_b64_tr_b16 a[164:165], v5 offset:36864
  s_add_u32 s53, s53, s54
  v_mfma_f32_16x16x32_bf16 v[164:167], a[180:183], a[4:7], v[164:167]
  ds_read_b64_tr_b16 a[166:167], v5 offset:38912
  s_lshl_b32 s62, s53, 3
  v_mfma_f32_16x16x32_bf16 v[180:183], a[192:195], a[4:7], 0
  ds_read_b64_tr_b16 a[168:169], v5 offset:40960
  s_and_b32 s55, s44, 1
  v_mfma_f32_16x16x32_bf16 v[180:183], a[188:191], a[20:23], v[180:183]
  ds_read_b64_tr_b16 a[170:171], v5 offset:43008
  buffer_load_dwordx4 a[80:83], v1, s[8:11], s73 offen offset:1024 sc1
  v_mfma_f32_16x16x32_bf16 v[176:179], a[188:191], a[16:19], 0
  ds_read_b64_tr_b16 a[172:173], v5 offset:45056
  s_add_u32 s62, s62, s55
  v_mfma_f32_16x16x32_bf16 v[176:179], a[192:195], a[0:3], v[176:179]
  s_waitcnt lgkmcnt(7)
  ds_read_b64_tr_b16 a[174:175], v5 offset:47104
  s_waitcnt vmcnt(10)
  s_barrier
  v_mfma_f32_16x16x32_bf16 v[192:195], a[200:203], a[0:3], 0
  ds_read_b64_tr_b16 a[176:177], v6 offset:49152
  s_lshl_b32 s82, s44, 28
  s_add_u32 s82, s82, s81
  buffer_load_dword v9, v15, s[8:11], s82 offen sc1
  s_add_u32 s73, s73, 65536
  v_mfma_f32_16x16x32_bf16 v[192:195], a[196:199], a[16:19], v[192:195]
  ds_read_b64_tr_b16 a[178:179], v6 offset:51200
  buffer_load_dwordx4 a[68:71], v1, s[8:11], s73 offen offset:0 sc1
  v_mfma_f32_16x16x32_bf16 v[196:199], a[196:199], a[20:23], 0
  ds_read_b64_tr_b16 a[180:181], v6 offset:53248
  s_lshl_b32 s79, s2, 7
  v_mfma_f32_16x16x32_bf16 v[196:199], a[200:203], a[4:7], v[196:199]
  ds_read_b64_tr_b16 a[182:183], v6 offset:55296
  s_lshl_b32 s53, s44, 28
  v_mfma_f32_16x16x32_bf16 v[212:215], a[208:211], a[4:7], 0
  ds_read_b64_tr_b16 a[188:189], v6 offset:57344
  s_add_u32 s79, s79, s53
  v_mfma_f32_16x16x32_bf16 v[212:215], a[204:207], a[20:23], v[212:215]
  ds_read_b64_tr_b16 a[190:191], v6 offset:59392
  buffer_load_dwordx4 a[84:87], v1, s[8:11], s73 offen offset:1024 sc1
  v_mfma_f32_16x16x32_bf16 v[208:211], a[204:207], a[16:19], 0
  ds_read_b64_tr_b16 a[192:193], v6 offset:61440
  s_add_u32 s79, s79, 884736
  v_mfma_f32_16x16x32_bf16 v[208:211], a[208:211], a[0:3], v[208:211]
  s_waitcnt lgkmcnt(7)
  ds_read_b64_tr_b16 a[194:195], v6 offset:63488
  v_mfma_f32_16x16x32_bf16 v[224:227], a[160:163], a[0:3], 0
  ds_read_b64_tr_b16 a[196:197], v7 offset:49152
  s_mov_b32 s66, 1376256
  s_add_u32 s74, s24, 6144
  s_add_u32 m0, s45, 65536
  v_mfma_f32_16x16x32_bf16 v[224:227], a[164:167], a[16:19], v[224:227]
  ds_read_b64_tr_b16 a[198:199], v7 offset:51200
  buffer_load_dwordx4 v11, s[28:31], s66 offen lds
  v_mfma_f32_16x16x32_bf16 v[228:231], a[164:167], a[20:23], 0
  ds_read_b64_tr_b16 a[200:201], v7 offset:53248
  s_lshl_b32 s53, s2, 2
  v_mfma_f32_16x16x32_bf16 v[228:231], a[160:163], a[4:7], v[228:231]
  ds_read_b64_tr_b16 a[202:203], v7 offset:55296
  s_add_u32 s53, s53, s44
  v_mfma_f32_16x16x32_bf16 v[244:247], a[168:171], a[4:7], 0
  ds_read_b64_tr_b16 a[204:205], v7 offset:57344
  s_add_u32 m0, s45, 73728
  v_mfma_f32_16x16x32_bf16 v[244:247], a[172:175], a[20:23], v[244:247]
  ds_read_b64_tr_b16 a[206:207], v7 offset:59392
  buffer_load_dwordx4 v11, s[32:35], s66 offen lds
  v_mfma_f32_16x16x32_bf16 v[240:243], a[172:175], a[16:19], 0
  ds_read_b64_tr_b16 a[208:209], v7 offset:61440
  s_lshl_b32 s53, s53, 7
  v_mfma_f32_16x16x32_bf16 v[240:243], a[168:171], a[0:3], v[240:243]
  s_waitcnt vmcnt(18) lgkmcnt(7)
  ds_read_b64_tr_b16 a[210:211], v7 offset:63488
  v_mfma_f32_16x16x32_bf16 v[64:67], a[176:179], a[32:35], v[64:67]
  ds_read_b64_tr_b16 a[164:165], v8 offset:49152
  s_add_u32 m0, s45, 69632
  s_add_u32 s60, s66, 229376
  v_mfma_f32_16x16x32_bf16 v[64:67], a[180:183], a[48:51], v[64:67]
  ds_read_b64_tr_b16 a[166:167], v8 offset:51200
  buffer_load_dwordx4 v11, s[28:31], s60 offen lds
  v_mfma_f32_16x16x32_bf16 v[68:71], a[180:183], a[52:55], v[68:71]
  ds_read_b64_tr_b16 a[160:161], v8 offset:53248
  s_add_u32 s80, s53, 917504
  v_mfma_f32_16x16x32_bf16 v[68:71], a[176:179], a[36:39], v[68:71]
  ds_read_b64_tr_b16 a[162:163], v8 offset:55296
  s_add_u32 s53, s45, 151552
  v_mfma_f32_16x16x32_bf16 v[84:87], a[188:191], a[36:39], v[84:87]
  ds_read_b64_tr_b16 a[172:173], v8 offset:57344
  s_add_u32 m0, s45, 77824
  s_add_u32 s60, s66, 229376
  v_mfma_f32_16x16x32_bf16 v[84:87], a[192:195], a[52:55], v[84:87]
  ds_read_b64_tr_b16 a[174:175], v8 offset:59392
  buffer_load_dwordx4 v11, s[32:35], s60 offen lds
  v_mfma_f32_16x16x32_bf16 v[80:83], a[192:195], a[48:51], v[80:83]
  ds_read_b64_tr_b16 a[168:169], v8 offset:61440
  v_bfe_u32 v24, v0, 3, 1
  v_mfma_f32_16x16x32_bf16 v[80:83], a[188:191], a[32:35], v[80:83]
  s_waitcnt lgkmcnt(7)
  ds_read_b64_tr_b16 a[170:171], v8 offset:63488
  v_mfma_f32_16x16x32_bf16 v[96:99], a[196:199], a[32:35], v[96:99]
  ds_read_b64_tr_b16 a[180:181], v2 offset:49152
  s_add_u32 m0, s45, 0
  v_mfma_f32_16x16x32_bf16 v[96:99], a[200:203], a[48:51], v[96:99]
  ds_read_b64_tr_b16 a[182:183], v2 offset:51200
  buffer_load_dwordx4 v10, s[28:31], s66 offen lds
  v_mfma_f32_16x16x32_bf16 v[100:103], a[200:203], a[52:55], v[100:103]
  ds_read_b64_tr_b16 a[176:177], v2 offset:53248
  v_lshlrev_b32 v24, 9, v24
  v_mfma_f32_16x16x32_bf16 v[100:103], a[196:199], a[36:39], v[100:103]
  ds_read_b64_tr_b16 a[178:179], v2 offset:55296
  v_and_b32 v25, 1, v0
  v_mfma_f32_16x16x32_bf16 v[116:119], a[204:207], a[36:39], v[116:119]
  ds_read_b64_tr_b16 a[192:193], v2 offset:57344
  s_add_u32 m0, s45, 8192
  v_mfma_f32_16x16x32_bf16 v[116:119], a[208:211], a[52:55], v[116:119]
  ds_read_b64_tr_b16 a[194:195], v2 offset:59392
  buffer_load_dwordx4 v10, s[32:35], s66 offen lds
  v_mfma_f32_16x16x32_bf16 v[112:115], a[208:211], a[48:51], v[112:115]
  ds_read_b64_tr_b16 a[188:189], v2 offset:61440
  v_lshl_add_u32 v24, v25, 8, v24
  v_mfma_f32_16x16x32_bf16 v[112:115], a[204:207], a[32:35], v[112:115]
  s_waitcnt lgkmcnt(7)
  ds_read_b64_tr_b16 a[190:191], v2 offset:63488
  v_mfma_f32_16x16x32_bf16 v[32:35], a[164:167], a[32:35], v[32:35]
  ds_read_b64_tr_b16 a[200:201], v3 offset:49152
  s_add_u32 m0, s45, 4096
  s_add_u32 s60, s66, 229376
  v_mfma_f32_16x16x32_bf16 v[32:35], a[160:163], a[48:51], v[32:35]
  ds_read_b64_tr_b16 a[202:203], v3 offset:51200
  buffer_load_dwordx4 v10, s[28:31], s60 offen lds
  v_mfma_f32_16x16x32_bf16 v[36:39], a[160:163], a[52:55], v[36:39]
  ds_read_b64_tr_b16 a[196:197], v3 offset:53248
  v_lshrrev_b32 v25, 4, v0
  v_mfma_f32_16x16x32_bf16 v[36:39], a[164:167], a[36:39], v[36:39]
  ds_read_b64_tr_b16 a[198:199], v3 offset:55296
HOP7:
  s_cbranch_execz HOP11
  v_lshl_add_u32 v24, v25, 6, v24
  v_mfma_f32_16x16x32_bf16 v[52:55], a[172:175], a[36:39], v[52:55]
  ds_read_b64_tr_b16 a[208:209], v3 offset:57344
  s_add_u32 m0, s45, 12288
  s_add_u32 s60, s66, 229376
  v_mfma_f32_16x16x32_bf16 v[52:55], a[168:171], a[52:55], v[52:55]
  ds_read_b64_tr_b16 a[210:211], v3 offset:59392
  buffer_load_dwordx4 v10, s[32:35], s60 offen lds
  v_mfma_f32_16x16x32_bf16 v[48:51], a[168:171], a[48:51], v[48:51]
  ds_read_b64_tr_b16 a[204:205], v3 offset:61440
  v_add_u32 v14, s53, v24
  v_mfma_f32_16x16x32_bf16 v[48:51], a[172:175], a[32:35], v[48:51]
  s_waitcnt lgkmcnt(7)
  ds_read_b64_tr_b16 a[206:207], v3 offset:63488
  v_mfma_f32_16x16x32_bf16 v[128:131], a[180:183], a[32:35], v[128:131]
  ds_read_b64_tr_b16 a[160:161], v4 offset:49152
  s_waitcnt vmcnt(10)
  s_cmp_lg_u32 s44, 0
  s_cbranch_scc1 PL10_adaLN_cond__sliding_local_dilated__swiglu_ffn__prompt_kernelx
  v_cmp_ne_u32 vcc, s46, v9
  s_nop 4
  s_cbranch_vccz PL10_adaLN_cond__sliding_local_dilated__swiglu_ffn__prompt_kernelx
  s_mov_b32 s82, 60000
PL10_adaLN_cond__sliding_local_dilated__swiglu_ffn__prompt_kernel:
  buffer_load_dword v9, v15, s[8:11], s81 offen sc1
  s_sub_u32 s82, s82, 1
  s_cmp_eq_u32 s82, 0
  s_waitcnt vmcnt(0)
  s_cbranch_scc1 PL10_adaLN_cond__sliding_local_dilated__swiglu_ffn__prompt_kernelx
  v_cmp_ne_u32 vcc, s46, v9
  s_nop 4
  s_cbranch_vccnz PL10_adaLN_cond__sliding_local_dilated__swiglu_ffn__prompt_kernel
PL10_adaLN_cond__sliding_local_dilated__swiglu_ffn__prompt_kernelx:
  s_barrier
  v_mfma_f32_16x16x32_bf16 v[128:131], a[176:179], a[48:51], v[128:131]
  ds_read_b64_tr_b16 a[162:163], v4 offset:51200
  buffer_load_dwordx4 a[96:99], v1, s[8:11], s74 offen offset:0 sc1
  v_mfma_f32_16x16x32_bf16 v[132:135], a[176:179], a[52:55], v[132:135]
  ds_read_b64_tr_b16 a[164:165], v4 offset:53248
  s_bfe_u32 s53, s2, 0x20004
  v_mfma_f32_16x16x32_bf16 v[132:135], a[180:183], a[36:39], v[132:135]
  ds_read_b64_tr_b16 a[166:167], v4 offset:55296
  s_lshl_b32 s53, s53, 8
  v_mfma_f32_16x16x32_bf16 v[148:151], a[192:195], a[36:39], v[148:151]
  ds_read_b64_tr_b16 a[168:169], v4 offset:57344
  s_add_u32 s71, s71, 65536
  v_mfma_f32_16x16x32_bf16 v[148:151], a[188:191], a[52:55], v[148:151]
  ds_read_b64_tr_b16 a[170:171], v4 offset:59392
  buffer_load_dwordx4 a[8:11], v1, s[8:11], s71 offen offset:0 sc1
  v_mfma_f32_16x16x32_bf16 v[144:147], a[188:191], a[48:51], v[144:147]
  ds_read_b64_tr_b16 a[172:173], v4 offset:61440
  v_and_b32 v24, 15, v0
  v_mfma_f32_16x16x32_bf16 v[144:147], a[192:195], a[32:35], v[144:147]
  s_waitcnt lgkmcnt(7)
  ds_read_b64_tr_b16 a[174:175], v4 offset:63488
  buffer_load_dwordx4 a[24:27], v1, s[8:11], s71 offen offset:1024 sc1
  v_mfma_f32_16x16x32_bf16 v[160:163], a[200:203], a[32:35], v[160:163]
  ds_read_b64_tr_b16 a[176:177], v5 offset:49152
  s_add_u32 s71, s71, 65536
  v_mfma_f32_16x16x32_bf16 v[160:163], a[196:199], a[48:51], v[160:163]
  ds_read_b64_tr_b16 a[178:179], v5 offset:51200
  buffer_load_dwordx4 a[12:15], v1, s[8:11], s71 offen offset:0 sc1
  v_mfma_f32_16x16x32_bf16 v[164:167], a[196:199], a[52:55], v[164:167]
  ds_read_b64_tr_b16 a[180:181], v5 offset:53248
  v_lshl_add_u32 v24, v24, 4, s53
  v_mfma_f32_16x16x32_bf16 v[164:167], a[200:203], a[36:39], v[164:167]
  ds_read_b64_tr_b16 a[182:183], v5 offset:55296
  buffer_load_dwordx4 a[28:31], v1, s[8:11], s71 offen offset:1024 sc1
  v_mfma_f32_16x16x32_bf16 v[180:183], a[208:211], a[36:39], v[180:183]
  ds_read_b64_tr_b16 a[188:189], v5 offset:57344
  s_add_u32 s72, s72, 65536
  v_mfma_f32_16x16x32_bf16 v[180:183], a[204:207], a[52:55], v[180:183]
  ds_read_b64_tr_b16 a[190:191], v5 offset:59392
  buffer_load_dwordx4 a[40:43], v1, s[8:11], s72 offen offset:0 sc1
  v_cmp_gt_u32 vcc, 896, v24
  v_mov_b32 v26, 1073741824
  v_mul_u32_u24 v25, 114688, v25
  v_cndmask_b32 v24, v26, v24, vcc
  v_mfma_f32_16x16x32_bf16 v[176:179], a[204:207], a[48:51], v[176:179]
  ds_read_b64_tr_b16 a[192:193], v5 offset:61440
  s_lshr_b32 s53, s2, 6
  v_mfma_f32_16x16x32_bf16 v[176:179], a[208:211], a[32:35], v[176:179]
  s_waitcnt lgkmcnt(7)
  ds_read_b64_tr_b16 a[194:195], v5 offset:63488
  buffer_load_dwordx4 a[56:59], v1, s[8:11], s72 offen offset:1024 sc1
  v_mfma_f32_16x16x32_bf16 v[192:195], a[160:163], a[32:35], v[192:195]
  ds_read_b64_tr_b16 a[196:197], v6 offset:32768
  s_add_u32 s72, s72, 65536
  v_mfma_f32_16x16x32_bf16 v[192:195], a[164:167], a[48:51], v[192:195]
  ds_read_b64_tr_b16 a[198:199], v6 offset:34816
  buffer_load_dwordx4 a[44:47], v1, s[8:11], s72 offen offset:0 sc1
  v_mfma_f32_16x16x32_bf16 v[196:199], a[164:167], a[52:55], v[196:199]
  ds_read_b64_tr_b16 a[200:201], v6 offset:36864
  s_lshl_b32 s53, s53, 2
  v_mfma_f32_16x16x32_bf16 v[196:199], a[160:163], a[36:39], v[196:199]
  ds_read_b64_tr_b16 a[202:203], v6 offset:38912
  buffer_load_dwordx4 a[60:63], v1, s[8:11], s72 offen offset:1024 sc1
  v_mfma_f32_16x16x32_bf16 v[212:215], a[168:171], a[36:39], v[212:215]
  ds_read_b64_tr_b16 a[204:205], v6 offset:40960
  s_add_u32 s73, s73, 65536
  v_mfma_f32_16x16x32_bf16 v[212:215], a[172:175], a[52:55], v[212:215]
  ds_read_b64_tr_b16 a[206:207], v6 offset:43008
  buffer_load_dwordx4 a[72:75], v1, s[8:11], s73 offen offset:0 sc1
  v_mfma_f32_16x16x32_bf16 v[208:211], a[172:175], a[48:51], v[208:211]
  ds_read_b64_tr_b16 a[208:209], v6 offset:45056
  s_add_u32 s53, s53, s44
  v_mfma_f32_16x16x32_bf16 v[208:211], a[168:171], a[32:35], v[208:211]
  s_waitcnt lgkmcnt(7)
  ds_read_b64_tr_b16 a[210:211], v6 offset:47104
  v_mfma_f32_16x16x32_bf16 v[224:227], a[176:179], a[32:35], v[224:227]
  ds_read_b64_tr_b16 a[164:165], v7 offset:32768
  s_mul_i32 s53, s53, 458752
  v_mfma_f32_16x16x32_bf16 v[224:227], a[180:183], a[48:51], v[224:227]
  ds_read_b64_tr_b16 a[166:167], v7 offset:34816
  buffer_load_dwordx4 a[88:91], v1, s[8:11], s73 offen offset:1024 sc1
  v_mfma_f32_16x16x32_bf16 v[228:231], a[180:183], a[52:55], v[228:231]
  ds_read_b64_tr_b16 a[160:161], v7 offset:36864
  s_mul_i32 s54, s52, 896
  v_mfma_f32_16x16x32_bf16 v[228:231], a[176:179], a[36:39], v[228:231]
  ds_read_b64_tr_b16 a[162:163], v7 offset:38912
  s_add_u32 s53, s53, s54
  v_mfma_f32_16x16x32_bf16 v[244:247], a[188:191], a[36:39], v[244:247]
  ds_read_b64_tr_b16 a[172:173], v7 offset:40960
  s_add_u32 s73, s73, 65536
  v_mfma_f32_16x16x32_bf16 v[244:247], a[192:195], a[52:55], v[244:247]
  ds_read_b64_tr_b16 a[174:175], v7 offset:43008
  buffer_load_dwordx4 a[76:79], v1, s[8:11], s73 offen offset:0 sc1
  v_mfma_f32_16x16x32_bf16 v[240:243], a[192:195], a[48:51], v[240:243]
  ds_read_b64_tr_b16 a[168:169], v7 offset:45056
  v_add3_u32 v13, v24, v25, s53
  v_mfma_f32_16x16x32_bf16 v[240:243], a[188:191], a[32:35], v[240:243]
  s_waitcnt vmcnt(7) lgkmcnt(7)
  ds_read_b64_tr_b16 a[170:171], v7 offset:47104
  v_mfma_f32_16x16x32_bf16 v[72:75], a[196:199], a[8:11], 0
  ds_read_b64_tr_b16 a[180:181], v8 offset:32768
  s_lshl_b32 s57, s51, 12
  v_mfma_f32_16x16x32_bf16 v[72:75], a[200:203], a[24:27], v[72:75]
  ds_read_b64_tr_b16 a[182:183], v8 offset:34816
  buffer_load_dwordx4 a[92:95], v1, s[8:11], s73 offen offset:1024 sc1
  v_mfma_f32_16x16x32_bf16 v[76:79], a[200:203], a[28:31], 0
  ds_read_b64_tr_b16 a[176:177], v8 offset:36864
  s_lshl_b32 s54, s51, 3
  v_mfma_f32_16x16x32_bf16 v[76:79], a[196:199], a[12:15], v[76:79]
  ds_read_b64_tr_b16 a[178:179], v8 offset:38912
  s_lshr_b32 s53, 0x0b070602, s54
  v_mfma_f32_16x16x32_bf16 v[92:95], a[204:207], a[12:15], 0
  ds_read_b64_tr_b16 a[192:193], v8 offset:40960
  s_and_b32 s53, s53, 15
  v_mfma_f32_16x16x32_bf16 v[92:95], a[208:211], a[28:31], v[92:95]
  ds_read_b64_tr_b16 a[194:195], v8 offset:43008
  s_lshl_b32 s58, s53, 10
  v_mfma_f32_16x16x32_bf16 v[88:91], a[208:211], a[24:27], 0
  ds_read_b64_tr_b16 a[188:189], v8 offset:45056
  buffer_load_dwordx4 a[112:115], v1, s[8:11], s74 offen offset:1024 sc1
  v_mfma_f32_16x16x32_bf16 v[88:91], a[204:207], a[8:11], v[88:91]
  s_waitcnt lgkmcnt(7)
  ds_read_b64_tr_b16 a[190:191], v8 offset:47104
  v_mfma_f32_16x16x32_bf16 v[104:107], a[164:167], a[8:11], 0
  ds_read_b64_tr_b16 a[200:201], v2 offset:32768
  s_lshr_b32 s53, s51, 1
  v_mfma_f32_16x16x32_bf16 v[104:107], a[160:163], a[24:27], v[104:107]
  ds_read_b64_tr_b16 a[202:203], v2 offset:34816
  s_mul_i32 s53, s53, 7168
  v_mfma_f32_16x16x32_bf16 v[108:111], a[160:163], a[28:31], 0
  ds_read_b64_tr_b16 a[196:197], v2 offset:36864
  s_mov_b32 s61, 0
  v_mfma_f32_16x16x32_bf16 v[108:111], a[164:167], a[12:15], v[108:111]
  ds_read_b64_tr_b16 a[198:199], v2 offset:38912
  buffer_load_dwordx4 a[220:223], v13, s[12:15], s61 offen
  v_mfma_f32_16x16x32_bf16 v[124:127], a[172:175], a[12:15], 0
  ds_read_b64_tr_b16 a[208:209], v2 offset:40960
  s_mov_b32 s61, 7168
  v_mfma_f32_16x16x32_bf16 v[124:127], a[168:171], a[28:31], v[124:127]
  ds_read_b64_tr_b16 a[210:211], v2 offset:43008
  buffer_load_dwordx4 a[224:227], v13, s[12:15], s61 offen
  v_mfma_f32_16x16x32_bf16 v[120:123], a[168:171], a[24:27], 0
  ds_read_b64_tr_b16 a[204:205], v2 offset:45056
  s_mov_b32 s61, 14336
  s_and_b32 s54, s54, 8
  v_mfma_f32_16x16x32_bf16 v[120:123], a[172:175], a[8:11], v[120:123]
  s_waitcnt lgkmcnt(7)
  ds_read_b64_tr_b16 a[206:207], v2 offset:47104
  buffer_load_dwordx4 a[228:231], v13, s[12:15], s61 offen
  v_mfma_f32_16x16x32_bf16 v[40:43], a[180:183], a[8:11], 0
  ds_read_b64_tr_b16 a[160:161], v3 offset:32768
  s_mov_b32 s61, 21504
  v_mfma_f32_16x16x32_bf16 v[40:43], a[176:179], a[24:27], v[40:43]
  ds_read_b64_tr_b16 a[162:163], v3 offset:34816
  buffer_load_dwordx4 a[232:235], v13, s[12:15], s61 offen
  v_mfma_f32_16x16x32_bf16 v[44:47], a[176:179], a[28:31], 0
  ds_read_b64_tr_b16 a[164:165], v3 offset:36864
  s_add_u32 s53, s53, s54
  v_mfma_f32_16x16x32_bf16 v[44:47], a[180:183], a[12:15], v[44:47]
  ds_read_b64_tr_b16 a[166:167], v3 offset:38912
  s_add_u32 s59, s53, 3072
  v_mfma_f32_16x16x32_bf16 v[60:63], a[192:195], a[12:15], 0
  ds_read_b64_tr_b16 a[168:169], v3 offset:40960
  s_mul_i32 s53, s52, 14336
  v_mfma_f32_16x16x32_bf16 v[60:63], a[188:191], a[28:31], v[60:63]
  ds_read_b64_tr_b16 a[170:171], v3 offset:43008
  s_mul_i32 s54, s62, 131072
  v_mfma_f32_16x16x32_bf16 v[56:59], a[188:191], a[24:27], 0
  ds_read_b64_tr_b16 a[172:173], v3 offset:45056
  s_add_u32 s53, s53, s54
  v_mfma_f32_16x16x32_bf16 v[56:59], a[192:195], a[8:11], v[56:59]
  s_waitcnt lgkmcnt(7)
  ds_read_b64_tr_b16 a[174:175], v3 offset:47104
  v_mfma_f32_16x16x32_bf16 v[136:139], a[200:203], a[8:11], 0
  ds_read_b64_tr_b16 a[176:177], v4 offset:32768
  s_add_u32 s53, s53, 19922944
  v_mfma_f32_16x16x32_bf16 v[136:139], a[196:199], a[24:27], v[136:139]
  ds_read_b64_tr_b16 a[178:179], v4 offset:34816
  s_add_u32 s57, s57, s53
  v_mfma_f32_16x16x32_bf16 v[140:143], a[196:199], a[28:31], 0
  ds_read_b64_tr_b16 a[180:181], v4 offset:36864
  s_add_u32 s58, s58, s53
  v_mfma_f32_16x16x32_bf16 v[140:143], a[200:203], a[12:15], v[140:143]
  ds_read_b64_tr_b16 a[182:183], v4 offset:38912
  s_add_u32 s59, s59, s53
  v_mfma_f32_16x16x32_bf16 v[156:159], a[208:211], a[12:15], 0
  ds_read_b64_tr_b16 a[188:189], v4 offset:40960
  s_lshl_b32 s62, s50, 2
  v_mfma_f32_16x16x32_bf16 v[156:159], a[204:207], a[28:31], v[156:159]
  ds_read_b64_tr_b16 a[190:191], v4 offset:43008
  s_add_u32 s62, s62, s44
  v_mfma_f32_16x16x32_bf16 v[152:155], a[204:207], a[24:27], 0
  ds_read_b64_tr_b16 a[192:193], v4 offset:45056
  s_lshl_b32 s62, s62, 14
  v_mfma_f32_16x16x32_bf16 v[152:155], a[208:211], a[8:11], v[152:155]
  s_waitcnt lgkmcnt(7)
  ds_read_b64_tr_b16 a[194:195], v4 offset:47104
  v_mfma_f32_16x16x32_bf16 v[168:171], a[160:163], a[8:11], 0
  ds_read_b64_tr_b16 a[196:197], v5 offset:32768
  s_add_u32 s62, s62, 6291456
  v_mfma_f32_16x16x32_bf16 v[168:171], a[164:167], a[24:27], v[168:171]
  ds_read_b64_tr_b16 a[198:199], v5 offset:34816
  v_and_b32 v12, 0x300, v1
  v_mfma_f32_16x16x32_bf16 v[172:175], a[164:167], a[28:31], 0
  ds_read_b64_tr_b16 a[200:201], v5 offset:36864
  v_add_u32 v12, v12, v1
  v_mfma_f32_16x16x32_bf16 v[172:175], a[160:163], a[12:15], v[172:175]
  ds_read_b64_tr_b16 a[202:203], v5 offset:38912
  v_mfma_f32_16x16x32_bf16 v[188:191], a[168:171], a[12:15], 0
  ds_read_b64_tr_b16 a[204:205], v5 offset:40960
  v_mfma_f32_16x16x32_bf16 v[188:191], a[172:175], a[28:31], v[188:191]
  ds_read_b64_tr_b16 a[206:207], v5 offset:43008
  v_mfma_f32_16x16x32_bf16 v[184:187], a[172:175], a[24:27], 0
  ds_read_b64_tr_b16 a[208:209], v5 offset:45056
  v_mfma_f32_16x16x32_bf16 v[184:187], a[168:171], a[8:11], v[184:187]
  s_waitcnt lgkmcnt(7)
  ds_read_b64_tr_b16 a[210:211], v5 offset:47104
  v_mfma_f32_16x16x32_bf16 v[200:203], a[176:179], a[8:11], 0
  ds_read_b64_tr_b16 a[164:165], v6 offset:49152
  v_mfma_f32_16x16x32_bf16 v[200:203], a[180:183], a[24:27], v[200:203]
  ds_read_b64_tr_b16 a[166:167], v6 offset:51200
  v_mfma_f32_16x16x32_bf16 v[204:207], a[180:183], a[28:31], 0
  ds_read_b64_tr_b16 a[160:161], v6 offset:53248
  v_mfma_f32_16x16x32_bf16 v[204:207], a[176:179], a[12:15], v[204:207]
  ds_read_b64_tr_b16 a[162:163], v6 offset:55296
  v_mfma_f32_16x16x32_bf16 v[220:223], a[188:191], a[12:15], 0
  ds_read_b64_tr_b16 a[172:173], v6 offset:57344
  v_mfma_f32_16x16x32_bf16 v[220:223], a[192:195], a[28:31], v[220:223]
  ds_read_b64_tr_b16 a[174:175], v6 offset:59392
  v_mfma_f32_16x16x32_bf16 v[216:219], a[192:195], a[24:27], 0
  ds_read_b64_tr_b16 a[168:169], v6 offset:61440
  s_add_u32 s74, s74, 65536
  v_mfma_f32_16x16x32_bf16 v[216:219], a[188:191], a[8:11], v[216:219]
  s_waitcnt lgkmcnt(7)
  ds_read_b64_tr_b16 a[170:171], v6 offset:63488
  v_mfma_f32_16x16x32_bf16 v[232:235], a[196:199], a[8:11], 0
  ds_read_b64_tr_b16 a[180:181], v7 offset:49152
  buffer_load_dwordx4 a[100:103], v1, s[8:11], s74 offen offset:0 sc1
  v_mfma_f32_16x16x32_bf16 v[232:235], a[200:203], a[24:27], v[232:235]
  ds_read_b64_tr_b16 a[182:183], v7 offset:51200
  v_mfma_f32_16x16x32_bf16 v[236:239], a[200:203], a[28:31], 0
  ds_read_b64_tr_b16 a[176:177], v7 offset:53248
  v_mfma_f32_16x16x32_bf16 v[236:239], a[196:199], a[12:15], v[236:239]
  ds_read_b64_tr_b16 a[178:179], v7 offset:55296
  v_mfma_f32_16x16x32_bf16 v[252:255], a[204:207], a[12:15], 0
  ds_read_b64_tr_b16 a[192:193], v7 offset:57344
  s_barrier
  v_mfma_f32_16x16x32_bf16 v[252:255], a[208:211], a[28:31], v[252:255]
  ds_read_b64_tr_b16 a[194:195], v7 offset:59392
  buffer_load_dwordx4 a[116:119], v1, s[8:11], s74 offen offset:1024 sc1
  v_mfma_f32_16x16x32_bf16 v[248:251], a[208:211], a[24:27], 0
  ds_read_b64_tr_b16 a[188:189], v7 offset:61440
  v_mfma_f32_16x16x32_bf16 v[248:251], a[204:207], a[8:11], v[248:251]
  s_waitcnt vmcnt(11) lgkmcnt(7)
  ds_read_b64_tr_b16 a[190:191], v7 offset:63488
  v_mfma_f32_16x16x32_bf16 v[72:75], a[164:167], a[40:43], v[72:75]
  ds_read_b64_tr_b16 a[200:201], v8 offset:49152
  s_add_u32 s74, s74, 65536
  v_mfma_f32_16x16x32_bf16 v[72:75], a[160:163], a[56:59], v[72:75]
  ds_read_b64_tr_b16 a[202:203], v8 offset:51200
  buffer_load_dwordx4 a[104:107], v1, s[8:11], s74 offen offset:0 sc1
  v_mfma_f32_16x16x32_bf16 v[76:79], a[160:163], a[60:63], v[76:79]
  ds_read_b64_tr_b16 a[196:197], v8 offset:53248
  v_mfma_f32_16x16x32_bf16 v[76:79], a[164:167], a[44:47], v[76:79]
  ds_read_b64_tr_b16 a[198:199], v8 offset:55296
  v_mfma_f32_16x16x32_bf16 v[92:95], a[172:175], a[44:47], v[92:95]
  ds_read_b64_tr_b16 a[208:209], v8 offset:57344
  v_mfma_f32_16x16x32_bf16 v[92:95], a[168:171], a[60:63], v[92:95]
  ds_read_b64_tr_b16 a[210:211], v8 offset:59392
  v_mfma_f32_16x16x32_bf16 v[88:91], a[168:171], a[56:59], v[88:91]
  ds_read_b64_tr_b16 a[204:205], v8 offset:61440
  buffer_load_dwordx4 a[120:123], v1, s[8:11], s74 offen offset:1024 sc1
  v_mfma_f32_16x16x32_bf16 v[88:91], a[172:175], a[40:43], v[88:91]
  s_waitcnt lgkmcnt(7)
  ds_read_b64_tr_b16 a[206:207], v8 offset:63488
  v_mfma_f32_16x16x32_bf16 v[104:107], a[180:183], a[40:43], v[104:107]
  ds_read_b64_tr_b16 a[160:161], v2 offset:49152
  v_mfma_f32_16x16x32_bf16 v[104:107], a[176:179], a[56:59], v[104:107]
  ds_read_b64_tr_b16 a[162:163], v2 offset:51200
  v_mfma_f32_16x16x32_bf16 v[108:111], a[176:179], a[60:63], v[108:111]
  ds_read_b64_tr_b16 a[164:165], v2 offset:53248
  s_add_u32 s74, s74, 65536
  v_mfma_f32_16x16x32_bf16 v[108:111], a[180:183], a[44:47], v[108:111]
  ds_read_b64_tr_b16 a[166:167], v2 offset:55296
  buffer_load_dwordx4 a[108:111], v1, s[8:11], s74 offen offset:0 sc1
  v_mfma_f32_16x16x32_bf16 v[124:127], a[192:195], a[44:47], v[124:127]
  ds_read_b64_tr_b16 a[168:169], v2 offset:57344
  v_mfma_f32_16x16x32_bf16 v[124:127], a[188:191], a[60:63], v[124:127]
  ds_read_b64_tr_b16 a[170:171], v2 offset:59392
  v_mfma_f32_16x16x32_bf16 v[120:123], a[188:191], a[56:59], v[120:123]
  ds_read_b64_tr_b16 a[172:173], v2 offset:61440
  v_mfma_f32_16x16x32_bf16 v[120:123], a[192:195], a[40:43], v[120:123]
  s_waitcnt lgkmcnt(7)
  ds_read_b64_tr_b16 a[174:175], v2 offset:63488
  v_mfma_f32_16x16x32_bf16 v[40:43], a[200:203], a[40:43], v[40:43]
  ds_read_b64_tr_b16 a[176:177], v3 offset:49152
  buffer_load_dwordx4 a[124:127], v1, s[8:11], s74 offen offset:1024 sc1
  v_mfma_f32_16x16x32_bf16 v[40:43], a[196:199], a[56:59], v[40:43]
  ds_read_b64_tr_b16 a[178:179], v3 offset:51200
  v_mfma_f32_16x16x32_bf16 v[44:47], a[196:199], a[60:63], v[44:47]
  ds_read_b64_tr_b16 a[180:181], v3 offset:53248
  v_mfma_f32_16x16x32_bf16 v[44:47], a[200:203], a[44:47], v[44:47]
  ds_read_b64_tr_b16 a[182:183], v3 offset:55296
  v_mfma_f32_16x16x32_bf16 v[60:63], a[208:211], a[44:47], v[60:63]
  ds_read_b64_tr_b16 a[188:189], v3 offset:57344
  s_mov_b32 s61, 28672
  v_mfma_f32_16x16x32_bf16 v[60:63], a[204:207], a[60:63], v[60:63]
  ds_read_b64_tr_b16 a[190:191], v3 offset:59392
  buffer_load_dwordx4 a[236:239], v13, s[12:15], s61 offen
  v_mfma_f32_16x16x32_bf16 v[56:59], a[204:207], a[56:59], v[56:59]
  ds_read_b64_tr_b16 a[192:193], v3 offset:61440
  s_mov_b32 s61, 35840
  v_mfma_f32_16x16x32_bf16 v[56:59], a[208:211], a[40:43], v[56:59]
  s_waitcnt lgkmcnt(7)
  ds_read_b64_tr_b16 a[194:195], v3 offset:63488
  buffer_load_dwordx4 a[240:243], v13, s[12:15], s61 offen
  v_mfma_f32_16x16x32_bf16 v[136:139], a[160:163], a[40:43], v[136:139]
  ds_read_b64_tr_b16 a[196:197], v4 offset:49152
  s_mov_b32 s61, 43008
  v_mfma_f32_16x16x32_bf16 v[136:139], a[164:167], a[56:59], v[136:139]
  ds_read_b64_tr_b16 a[198:199], v4 offset:51200
  buffer_load_dwordx4 a[244:247], v13, s[12:15], s61 offen
  v_mfma_f32_16x16x32_bf16 v[140:143], a[164:167], a[60:63], v[140:143]
  ds_read_b64_tr_b16 a[200:201], v4 offset:53248
  s_mov_b32 s61, 50176
  v_mfma_f32_16x16x32_bf16 v[140:143], a[160:163], a[44:47], v[140:143]
  ds_read_b64_tr_b16 a[202:203], v4 offset:55296
  buffer_load_dwordx4 a[248:251], v13, s[12:15], s61 offen
  v_mfma_f32_16x16x32_bf16 v[156:159], a[168:171], a[44:47], v[156:159]
  ds_read_b64_tr_b16 a[204:205], v4 offset:57344
  v_mfma_f32_16x16x32_bf16 v[156:159], a[172:175], a[60:63], v[156:159]
  ds_read_b64_tr_b16 a[206:207], v4 offset:59392
  v_mfma_f32_16x16x32_bf16 v[152:155], a[172:175], a[56:59], v[152:155]
  ds_read_b64_tr_b16 a[208:209], v4 offset:61440
  v_mfma_f32_16x16x32_bf16 v[152:155], a[168:171], a[40:43], v[152:155]
  s_waitcnt lgkmcnt(7)
  ds_read_b64_tr_b16 a[210:211], v4 offset:63488
  v_mfma_f32_16x16x32_bf16 v[168:171], a[176:179], a[40:43], v[168:171]
  ds_read_b64_tr_b16 a[164:165], v5 offset:49152
  v_mfma_f32_16x16x32_bf16 v[168:171], a[180:183], a[56:59], v[168:171]
  ds_read_b64_tr_b16 a[166:167], v5 offset:51200
  v_mfma_f32_16x16x32_bf16 v[172:175], a[180:183], a[60:63], v[172:175]
  ds_read_b64_tr_b16 a[160:161], v5 offset:53248
  v_mfma_f32_16x16x32_bf16 v[172:175], a[176:179], a[44:47], v[172:175]
  ds_read_b64_tr_b16 a[162:163], v5 offset:55296
  v_mfma_f32_16x16x32_bf16 v[188:191], a[188:191], a[44:47], v[188:191]
  ds_read_b64_tr_b16 a[172:173], v5 offset:57344
  v_mfma_f32_16x16x32_bf16 v[188:191], a[192:195], a[60:63], v[188:191]
  ds_read_b64_tr_b16 a[174:175], v5 offset:59392
  s_waitcnt vmcnt(41)
  s_barrier
  v_mfma_f32_16x16x32_bf16 v[184:187], a[192:195], a[56:59], v[184:187]
  ds_read_b64_tr_b16 a[168:169], v5 offset:61440
  ds_read_b64_tr_b16 a[180:181], v6 offset:16384
  v_mfma_f32_16x16x32_bf16 v[184:187], a[188:191], a[40:43], v[184:187]
  s_waitcnt lgkmcnt(8)
  ds_read_b64_tr_b16 a[170:171], v5 offset:63488
  v_mfma_f32_16x16x32_bf16 v[200:203], a[196:199], a[40:43], v[200:203]
  ds_read_b64_tr_b16 a[182:183], v6 offset:18432
  v_mfma_f32_16x16x32_bf16 v[200:203], a[200:203], a[56:59], v[200:203]
  v_mfma_f32_16x16x32_bf16 v[204:207], a[200:203], a[60:63], v[204:207]
  ds_read_b64_tr_b16 a[176:177], v6 offset:20480
  v_mfma_f32_16x16x32_bf16 v[204:207], a[196:199], a[44:47], v[204:207]
  v_mfma_f32_16x16x32_bf16 v[220:223], a[204:207], a[44:47], v[220:223]
  ds_read_b64_tr_b16 a[178:179], v6 offset:22528
  v_mfma_f32_16x16x32_bf16 v[220:223], a[208:211], a[60:63], v[220:223]
  ds_read_b128 v[24:27], v14 offset:0
  v_mfma_f32_16x16x32_bf16 v[216:219], a[208:211], a[56:59], v[216:219]
  ds_read_b64_tr_b16 a[192:193], v6 offset:24576
  v_mfma_f32_16x16x32_bf16 v[216:219], a[204:207], a[40:43], v[216:219]
  s_waitcnt lgkmcnt(5)
  v_mfma_f32_16x16x32_bf16 v[232:235], a[164:167], a[40:43], v[232:235]
  ds_read_b64_tr_b16 a[194:195], v6 offset:26624
  v_mfma_f32_16x16x32_bf16 v[232:235], a[160:163], a[56:59], v[232:235]
  v_mfma_f32_16x16x32_bf16 v[236:239], a[160:163], a[60:63], v[236:239]
  ds_read_b64_tr_b16 a[188:189], v6 offset:28672
  v_mfma_f32_16x16x32_bf16 v[236:239], a[164:167], a[44:47], v[236:239]
  s_waitcnt vmcnt(10) lgkmcnt(3)
  v_cndmask_b32 v28, 0, v24, s[16:17]
  v_cndmask_b32 v29, 0, v24, s[18:19]
  v_mfma_f32_16x16x32_bf16 v[252:255], a[172:175], a[44:47], v[252:255]
  ds_read_b64_tr_b16 a[190:191], v6 offset:30720
  v_cndmask_b32 v30, 0, v24, s[20:21]
  v_mfma_f32_16x16x32_bf16 v[252:255], a[168:171], a[60:63], v[252:255]
  v_cndmask_b32 v31, 0, v24, s[22:23]
  v_mfma_f32_16x16x32_bf16 v[248:251], a[168:171], a[56:59], v[248:251]
  ds_read_b64_tr_b16 a[200:201], v7 offset:16384
  v_mfma_f32_16x16x32_bf16 a[184:187], v[28:31], a[220:223], 0
  v_cndmask_b32 v28, 0, v25, s[16:17]
  v_cndmask_b32 v29, 0, v25, s[18:19]
  v_mfma_f32_16x16x32_bf16 v[248:251], a[172:175], a[40:43], v[248:251]
  s_waitcnt vmcnt(15) lgkmcnt(6)
  s_mov_b32 s67, 1835008
  s_add_u32 s75, s24, 8192
  s_add_u32 m0, s45, 98304
  v_cndmask_b32 v30, 0, v25, s[20:21]
  v_mfma_f32_16x16x32_bf16 v[64:67], a[180:183], a[64:67], v[64:67]
  ds_read_b64_tr_b16 a[202:203], v7 offset:18432
  v_cndmask_b32 v31, 0, v25, s[22:23]
  v_mfma_f32_16x16x32_bf16 v[64:67], a[176:179], a[80:83], v[64:67]
  buffer_load_dwordx4 v11, s[28:31], s67 offen lds
  v_mfma_f32_16x16x32_bf16 a[184:187], v[28:31], a[224:227], a[184:187]
  v_cndmask_b32 v28, 0, v26, s[16:17]
  v_cndmask_b32 v29, 0, v26, s[18:19]
  v_mfma_f32_16x16x32_bf16 v[68:71], a[176:179], a[84:87], v[68:71]
  ds_read_b64_tr_b16 a[196:197], v7 offset:20480
  v_cndmask_b32 v30, 0, v26, s[20:21]
  v_mfma_f32_16x16x32_bf16 v[68:71], a[180:183], a[68:71], v[68:71]
  v_cndmask_b32 v31, 0, v26, s[22:23]
  v_mfma_f32_16x16x32_bf16 v[72:75], a[180:183], a[72:75], v[72:75]
  ds_read_b64_tr_b16 a[198:199], v7 offset:22528
  v_mfma_f32_16x16x32_bf16 a[184:187], v[28:31], a[228:231], a[184:187]
  v_cndmask_b32 v28, 0, v27, s[16:17]
  v_cndmask_b32 v29, 0, v27, s[18:19]
  v_mfma_f32_16x16x32_bf16 v[72:75], a[176:179], a[88:91], v[72:75]
  s_add_u32 m0, s45, 106496
  v_cndmask_b32 v30, 0, v27, s[20:21]
  v_cndmask_b32 v31, 0, v27, s[22:23]
  v_mfma_f32_16x16x32_bf16 v[76:79], a[176:179], a[92:95], v[76:79]
  ds_read_b64_tr_b16 a[160:161], v7 offset:24576
  v_mfma_f32_16x16x32_bf16 a[184:187], v[28:31], a[232:235], a[184:187]
  v_mfma_f32_16x16x32_bf16 v[76:79], a[180:183], a[76:79], v[76:79]
  s_waitcnt lgkmcnt(5)
  buffer_load_dwordx4 v11, s[32:35], s67 offen lds
  v_mfma_f32_16x16x32_bf16 v[92:95], a[192:195], a[76:79], v[92:95]
  ds_read_b64_tr_b16 a[162:163], v7 offset:26624
  v_mfma_f32_16x16x32_bf16 v[92:95], a[188:191], a[92:95], v[92:95]
  s_add_u32 m0, s45, 102400
  s_add_u32 s60, s67, 229376
  v_mfma_f32_16x16x32_bf16 v[88:91], a[188:191], a[88:91], v[88:91]
  ds_read_b64_tr_b16 a[164:165], v7 offset:28672
  v_mfma_f32_16x16x32_bf16 v[88:91], a[192:195], a[72:75], v[88:91]
  buffer_load_dwordx4 v11, s[28:31], s60 offen lds
  v_mfma_f32_16x16x32_bf16 v[84:87], a[192:195], a[68:71], v[84:87]
  ds_read_b64_tr_b16 a[166:167], v7 offset:30720
  v_mfma_f32_16x16x32_bf16 v[84:87], a[188:191], a[84:87], v[84:87]
  v_mfma_f32_16x16x32_bf16 v[80:83], a[188:191], a[80:83], v[80:83]
  ds_read_b64_tr_b16 a[168:169], v8 offset:16384
  v_mfma_f32_16x16x32_bf16 v[80:83], a[192:195], a[64:67], v[80:83]
  s_waitcnt lgkmcnt(5)
  s_add_u32 m0, s45, 110592
  s_add_u32 s60, s67, 229376
  v_mfma_f32_16x16x32_bf16 v[96:99], a[200:203], a[64:67], v[96:99]
  ds_read_b64_tr_b16 a[170:171], v8 offset:18432
  v_mfma_f32_16x16x32_bf16 v[96:99], a[196:199], a[80:83], v[96:99]
  buffer_load_dwordx4 v11, s[32:35], s60 offen lds
  v_mfma_f32_16x16x32_bf16 v[100:103], a[196:199], a[84:87], v[100:103]
  ds_read_b64_tr_b16 a[172:173], v8 offset:20480
  v_mfma_f32_16x16x32_bf16 v[100:103], a[200:203], a[68:71], v[100:103]
  s_add_u32 m0, s45, 32768
  v_mfma_f32_16x16x32_bf16 v[104:107], a[200:203], a[72:75], v[104:107]
  ds_read_b64_tr_b16 a[174:175], v8 offset:22528
  v_mfma_f32_16x16x32_bf16 v[104:107], a[196:199], a[88:91], v[104:107]
  buffer_load_dwordx4 v10, s[28:31], s67 offen lds
  v_mfma_f32_16x16x32_bf16 v[108:111], a[196:199], a[92:95], v[108:111]
  ds_read_b64_tr_b16 a[176:177], v8 offset:24576
  v_mfma_f32_16x16x32_bf16 v[108:111], a[200:203], a[76:79], v[108:111]
  s_waitcnt lgkmcnt(5)
  v_mfma_f32_16x16x32_bf16 v[124:127], a[160:163], a[76:79], v[124:127]
  ds_read_b64_tr_b16 a[178:179], v8 offset:26624
  v_mfma_f32_16x16x32_bf16 v[124:127], a[164:167], a[92:95], v[124:127]
  s_add_u32 m0, s45, 40960
  v_mfma_f32_16x16x32_bf16 v[120:123], a[164:167], a[88:91], v[120:123]
  ds_read_b64_tr_b16 a[180:181], v8 offset:28672
  v_mfma_f32_16x16x32_bf16 v[120:123], a[160:163], a[72:75], v[120:123]
  buffer_load_dwordx4 v10, s[32:35], s67 offen lds
  v_mfma_f32_16x16x32_bf16 v[116:119], a[160:163], a[68:71], v[116:119]
  ds_read_b64_tr_b16 a[182:183], v8 offset:30720
  v_mfma_f32_16x16x32_bf16 v[116:119], a[164:167], a[84:87], v[116:119]
  s_add_u32 m0, s45, 36864
  s_add_u32 s60, s67, 229376
  v_mfma_f32_16x16x32_bf16 v[112:115], a[164:167], a[80:83], v[112:115]
  ds_read_b64_tr_b16 a[164:165], v2 offset:16384
  v_mfma_f32_16x16x32_bf16 v[112:115], a[160:163], a[64:67], v[112:115]
  s_waitcnt lgkmcnt(5)
  buffer_load_dwordx4 v10, s[28:31], s60 offen lds
  v_mfma_f32_16x16x32_bf16 v[32:35], a[168:171], a[64:67], v[32:35]
  ds_read_b64_tr_b16 a[166:167], v2 offset:18432
  v_mfma_f32_16x16x32_bf16 v[32:35], a[172:175], a[80:83], v[32:35]
  v_mfma_f32_16x16x32_bf16 v[36:39], a[172:175], a[84:87], v[36:39]
  ds_read_b64_tr_b16 a[160:161], v2 offset:20480
  v_mfma_f32_16x16x32_bf16 v[36:39], a[168:171], a[68:71], v[36:39]
  s_add_u32 m0, s45, 45056
  s_add_u32 s60, s67, 229376
  v_mfma_f32_16x16x32_bf16 v[40:43], a[168:171], a[72:75], v[40:43]
  ds_read_b64_tr_b16 a[162:163], v2 offset:22528
  v_mfma_f32_16x16x32_bf16 v[40:43], a[172:175], a[88:91], v[40:43]
  buffer_load_dwordx4 v10, s[32:35], s60 offen lds
  v_mfma_f32_16x16x32_bf16 v[44:47], a[172:175], a[92:95], v[44:47]
  ds_read_b64_tr_b16 a[172:173], v2 offset:24576
  v_mfma_f32_16x16x32_bf16 v[44:47], a[168:171], a[76:79], v[44:47]
  s_waitcnt lgkmcnt(5)
  s_mov_b32 s61, 57344
  v_mfma_f32_16x16x32_bf16 v[60:63], a[176:179], a[76:79], v[60:63]
  ds_read_b64_tr_b16 a[174:175], v2 offset:26624
  v_mfma_f32_16x16x32_bf16 v[60:63], a[180:183], a[92:95], v[60:63]
  buffer_load_dwordx4 a[220:223], v13, s[12:15], s61 offen
  s_mov_b32 s61, 64512
  v_mfma_f32_16x16x32_bf16 v[56:59], a[180:183], a[88:91], v[56:59]
  ds_read_b64_tr_b16 a[168:169], v2 offset:28672
  v_mfma_f32_16x16x32_bf16 v[56:59], a[176:179], a[72:75], v[56:59]
  buffer_load_dwordx4 a[224:227], v13, s[12:15], s61 offen
  s_mov_b32 s61, 71680
  v_mfma_f32_16x16x32_bf16 v[52:55], a[176:179], a[68:71], v[52:55]
  ds_read_b64_tr_b16 a[170:171], v2 offset:30720
  v_mfma_f32_16x16x32_bf16 v[52:55], a[180:183], a[84:87], v[52:55]
  buffer_load_dwordx4 a[228:231], v13, s[12:15], s61 offen
  s_mov_b32 s61, 78848
  v_mfma_f32_16x16x32_bf16 v[48:51], a[180:183], a[80:83], v[48:51]
  ds_read_b64_tr_b16 a[180:181], v3 offset:16384
  v_mfma_f32_16x16x32_bf16 v[48:51], a[176:179], a[64:67], v[48:51]
  s_waitcnt lgkmcnt(5)
  buffer_load_dwordx4 a[232:235], v13, s[12:15], s61 offen
  v_mfma_f32_16x16x32_bf16 v[128:131], a[164:167], a[64:67], v[128:131]
HOP8:
  s_cbranch_execz HOP12
  ds_read_b64_tr_b16 a[182:183], v3 offset:18432
  v_mfma_f32_16x16x32_bf16 v[128:131], a[160:163], a[80:83], v[128:131]
  v_mfma_f32_16x16x32_bf16 v[132:135], a[160:163], a[84:87], v[132:135]
  ds_read_b64_tr_b16 a[176:177], v3 offset:20480
  v_mfma_f32_16x16x32_bf16 v[132:135], a[164:167], a[68:71], v[132:135]
  v_mfma_f32_16x16x32_bf16 v[136:139], a[164:167], a[72:75], v[136:139]
  ds_read_b64_tr_b16 a[178:179], v3 offset:22528
  v_mfma_f32_16x16x32_bf16 v[136:139], a[160:163], a[88:91], v[136:139]
  v_mfma_f32_16x16x32_bf16 v[140:143], a[160:163], a[92:95], v[140:143]
  ds_read_b64_tr_b16 a[160:161], v3 offset:24576
  v_mfma_f32_16x16x32_bf16 v[140:143], a[164:167], a[76:79], v[140:143]
  s_waitcnt lgkmcnt(5)
  v_mfma_f32_16x16x32_bf16 v[156:159], a[172:175], a[76:79], v[156:159]
  ds_read_b64_tr_b16 a[162:163], v3 offset:26624
  v_mfma_f32_16x16x32_bf16 v[156:159], a[168:171], a[92:95], v[156:159]
  ds_read_b128 v[24:27], v14 offset:16
  v_mfma_f32_16x16x32_bf16 v[152:155], a[168:171], a[88:91], v[152:155]
  ds_read_b64_tr_b16 a[164:165], v3 offset:28672
  v_mfma_f32_16x16x32_bf16 v[152:155], a[172:175], a[72:75], v[152:155]
  v_mfma_f32_16x16x32_bf16 v[148:151], a[172:175], a[68:71], v[148:151]
  ds_read_b64_tr_b16 a[166:167], v3 offset:30720
  v_mfma_f32_16x16x32_bf16 v[148:151], a[168:171], a[84:87], v[148:151]
  v_mfma_f32_16x16x32_bf16 v[144:147], a[168:171], a[80:83], v[144:147]
  ds_read_b64_tr_b16 a[168:169], v4 offset:16384
  v_mfma_f32_16x16x32_bf16 v[144:147], a[172:175], a[64:67], v[144:147]
  s_waitcnt lgkmcnt(6)
  s_waitcnt vmcnt(12) lgkmcnt(3)
  v_cndmask_b32 v28, 0, v24, s[16:17]
  v_mfma_f32_16x16x32_bf16 v[160:163], a[180:183], a[64:67], v[160:163]
  ds_read_b64_tr_b16 a[170:171], v4 offset:18432
  v_cndmask_b32 v29, 0, v24, s[18:19]
  v_mfma_f32_16x16x32_bf16 v[160:163], a[176:179], a[80:83], v[160:163]
  v_cndmask_b32 v30, 0, v24, s[20:21]
  v_cndmask_b32 v31, 0, v24, s[22:23]
  v_mfma_f32_16x16x32_bf16 v[164:167], a[176:179], a[84:87], v[164:167]
  ds_read_b64_tr_b16 a[172:173], v4 offset:20480
  v_mfma_f32_16x16x32_bf16 a[184:187], v[28:31], a[236:239], a[184:187]
  v_cndmask_b32 v28, 0, v25, s[16:17]
  v_cndmask_b32 v29, 0, v25, s[18:19]
  v_mfma_f32_16x16x32_bf16 v[164:167], a[180:183], a[68:71], v[164:167]
  v_cndmask_b32 v30, 0, v25, s[20:21]
  v_cndmask_b32 v31, 0, v25, s[22:23]
  v_mfma_f32_16x16x32_bf16 v[168:171], a[180:183], a[72:75], v[168:171]
  ds_read_b64_tr_b16 a[174:175], v4 offset:22528
  v_mfma_f32_16x16x32_bf16 a[184:187], v[28:31], a[240:243], a[184:187]
  v_cndmask_b32 v28, 0, v26, s[16:17]
  v_cndmask_b32 v29, 0, v26, s[18:19]
  v_mfma_f32_16x16x32_bf16 v[168:171], a[176:179], a[88:91], v[168:171]
  v_cndmask_b32 v30, 0, v26, s[20:21]
  v_cndmask_b32 v31, 0, v26, s[22:23]
  v_mfma_f32_16x16x32_bf16 v[172:175], a[176:179], a[92:95], v[172:175]
  ds_read_b64_tr_b16 a[176:177], v4 offset:24576
  v_mfma_f32_16x16x32_bf16 a[184:187], v[28:31], a[244:247], a[184:187]
  v_cndmask_b32 v28, 0, v27, s[16:17]
  v_cndmask_b32 v29, 0, v27, s[18:19]
  v_mfma_f32_16x16x32_bf16 v[172:175], a[180:183], a[76:79], v[172:175]
  s_waitcnt lgkmcnt(5)
  v_cndmask_b32 v30, 0, v27, s[20:21]
  v_cndmask_b32 v31, 0, v27, s[22:23]
  v_mfma_f32_16x16x32_bf16 v[188:191], a[160:163], a[76:79], v[188:191]
  ds_read_b64_tr_b16 a[178:179], v4 offset:26624
  v_mfma_f32_16x16x32_bf16 a[184:187], v[28:31], a[248:251], a[184:187]
  v_mfma_f32_16x16x32_bf16 v[188:191], a[164:167], a[92:95], v[188:191]
  v_mfma_f32_16x16x32_bf16 v[184:187], a[164:167], a[88:91], v[184:187]
  ds_read_b64_tr_b16 a[180:181], v4 offset:28672
  v_mfma_f32_16x16x32_bf16 v[184:187], a[160:163], a[72:75], v[184:187]
  v_mfma_f32_16x16x32_bf16 v[180:183], a[160:163], a[68:71], v[180:183]
  ds_read_b64_tr_b16 a[182:183], v4 offset:30720
  s_add_u32 s61, s62, 0
  v_mfma_f32_16x16x32_bf16 v[180:183], a[164:167], a[84:87], v[180:183]
  buffer_load_dwordx4 a[188:191], v12, s[8:11], s61 offen offset:0 sc1
  v_mfma_f32_16x16x32_bf16 v[176:179], a[164:167], a[80:83], v[176:179]
  ds_read_b64_tr_b16 a[164:165], v5 offset:16384
  v_mfma_f32_16x16x32_bf16 v[176:179], a[160:163], a[64:67], v[176:179]
  s_waitcnt lgkmcnt(5)
  v_mfma_f32_16x16x32_bf16 v[192:195], a[168:171], a[64:67], v[192:195]
  ds_read_b64_tr_b16 a[166:167], v5 offset:18432
  v_mfma_f32_16x16x32_bf16 v[192:195], a[172:175], a[80:83], v[192:195]
  s_add_u32 s61, s62, 0
  v_mfma_f32_16x16x32_bf16 v[196:199], a[172:175], a[84:87], v[196:199]
  ds_read_b64_tr_b16 a[160:161], v5 offset:20480
  v_mfma_f32_16x16x32_bf16 v[196:199], a[168:171], a[68:71], v[196:199]
  buffer_load_dwordx4 a[192:195], v12, s[8:11], s61 offen offset:256 sc1
  v_mfma_f32_16x16x32_bf16 v[200:203], a[168:171], a[72:75], v[200:203]
  ds_read_b64_tr_b16 a[162:163], v5 offset:22528
  v_mfma_f32_16x16x32_bf16 v[200:203], a[172:175], a[88:91], v[200:203]
  s_add_u32 s61, s62, 2048
  v_mfma_f32_16x16x32_bf16 v[204:207], a[172:175], a[92:95], v[204:207]
  ds_read_b64_tr_b16 a[172:173], v5 offset:24576
  v_mfma_f32_16x16x32_bf16 v[204:207], a[168:171], a[76:79], v[204:207]
  s_waitcnt lgkmcnt(5)
  buffer_load_dwordx4 a[196:199], v12, s[8:11], s61 offen offset:0 sc1
  v_mfma_f32_16x16x32_bf16 v[220:223], a[176:179], a[76:79], v[220:223]
  ds_read_b64_tr_b16 a[174:175], v5 offset:26624
  v_mfma_f32_16x16x32_bf16 v[220:223], a[180:183], a[92:95], v[220:223]
  v_mfma_f32_16x16x32_bf16 v[216:219], a[180:183], a[88:91], v[216:219]
  ds_read_b64_tr_b16 a[168:169], v5 offset:28672
  v_mfma_f32_16x16x32_bf16 v[216:219], a[176:179], a[72:75], v[216:219]
  s_add_u32 s61, s62, 2048
  v_mfma_f32_16x16x32_bf16 v[212:215], a[176:179], a[68:71], v[212:215]
  ds_read_b64_tr_b16 a[170:171], v5 offset:30720
  buffer_load_dwordx4 a[200:203], v12, s[8:11], s61 offen offset:256 sc1
  v_mfma_f32_16x16x32_bf16 v[212:215], a[180:183], a[84:87], v[212:215]
  s_waitcnt vmcnt(44)
  s_barrier
  v_mfma_f32_16x16x32_bf16 v[208:211], a[180:183], a[80:83], v[208:211]
  ds_read_b64_tr_b16 a[180:181], v6 offset:0
  v_mfma_f32_16x16x32_bf16 v[208:211], a[176:179], a[64:67], v[208:211]
  s_waitcnt lgkmcnt(5)
  s_add_u32 s61, s62, 4096
  v_mfma_f32_16x16x32_bf16 v[224:227], a[164:167], a[64:67], v[224:227]
  ds_read_b64_tr_b16 a[182:183], v6 offset:2048
  v_mfma_f32_16x16x32_bf16 v[224:227], a[160:163], a[80:83], v[224:227]
  buffer_load_dwordx4 a[204:207], v12, s[8:11], s61 offen offset:0 sc1
  v_mfma_f32_16x16x32_bf16 v[228:231], a[160:163], a[84:87], v[228:231]
  ds_read_b64_tr_b16 a[176:177], v6 offset:4096
  v_mfma_f32_16x16x32_bf16 v[228:231], a[164:167], a[68:71], v[228:231]
  v_mfma_f32_16x16x32_bf16 v[232:235], a[164:167], a[72:75], v[232:235]
  ds_read_b64_tr_b16 a[178:179], v6 offset:6144
  v_mfma_f32_16x16x32_bf16 v[232:235], a[160:163], a[88:91], v[232:235]
  s_add_u32 s61, s62, 4096
  v_mfma_f32_16x16x32_bf16 v[236:239], a[160:163], a[92:95], v[236:239]
  ds_read_b64_tr_b16 a[160:161], v6 offset:8192
  v_mfma_f32_16x16x32_bf16 v[236:239], a[164:167], a[76:79], v[236:239]
  s_waitcnt lgkmcnt(5)
  buffer_load_dwordx4 a[208:211], v12, s[8:11], s61 offen offset:256 sc1
  v_mfma_f32_16x16x32_bf16 v[252:255], a[172:175], a[76:79], v[252:255]
  ds_read_b64_tr_b16 a[162:163], v6 offset:10240
  v_mfma_f32_16x16x32_bf16 v[252:255], a[168:171], a[92:95], v[252:255]
  s_add_u32 s61, s62, 6144
  v_mfma_f32_16x16x32_bf16 v[248:251], a[168:171], a[88:91], v[248:251]
  ds_read_b64_tr_b16 a[164:165], v6 offset:12288
  v_mfma_f32_16x16x32_bf16 v[248:251], a[172:175], a[72:75], v[248:251]
  buffer_load_dwordx4 a[212:215], v12, s[8:11], s61 offen offset:0 sc1
  v_mfma_f32_16x16x32_bf16 v[244:247], a[172:175], a[68:71], v[244:247]
  ds_read_b64_tr_b16 a[166:167], v6 offset:14336
  v_mfma_f32_16x16x32_bf16 v[244:247], a[168:171], a[84:87], v[244:247]
  v_mfma_f32_16x16x32_bf16 v[240:243], a[168:171], a[80:83], v[240:243]
  ds_read_b64_tr_b16 a[168:169], v7 offset:0
  v_mfma_f32_16x16x32_bf16 v[240:243], a[172:175], a[64:67], v[240:243]
  s_waitcnt vmcnt(23) lgkmcnt(5)
  s_add_u32 s61, s62, 6144
  v_mfma_f32_16x16x32_bf16 v[64:67], a[180:183], a[96:99], v[64:67]
  ds_read_b64_tr_b16 a[170:171], v7 offset:2048
  v_mfma_f32_16x16x32_bf16 v[64:67], a[176:179], a[112:115], v[64:67]
  buffer_load_dwordx4 a[216:219], v12, s[8:11], s61 offen offset:256 sc1
  v_mfma_f32_16x16x32_bf16 v[68:71], a[176:179], a[116:119], v[68:71]
  ds_read_b64_tr_b16 a[172:173], v7 offset:4096
  v_mfma_f32_16x16x32_bf16 v[68:71], a[180:183], a[100:103], v[68:71]
  v_mfma_f32_16x16x32_bf16 v[72:75], a[180:183], a[104:107], v[72:75]
  ds_read_b64_tr_b16 a[174:175], v7 offset:6144
  v_mfma_f32_16x16x32_bf16 v[72:75], a[176:179], a[120:123], v[72:75]
  buffer_load_dwordx4 a[128:131], v1, s[8:11], s75 offen offset:0 sc1
  v_mfma_f32_16x16x32_bf16 v[76:79], a[176:179], a[124:127], v[76:79]
  ds_read_b64_tr_b16 a[176:177], v7 offset:8192
  v_mfma_f32_16x16x32_bf16 v[76:79], a[180:183], a[108:111], v[76:79]
  s_waitcnt lgkmcnt(5)
  v_mfma_f32_16x16x32_bf16 v[92:95], a[160:163], a[108:111], v[92:95]
  ds_read_b64_tr_b16 a[178:179], v7 offset:10240
  v_mfma_f32_16x16x32_bf16 v[92:95], a[164:167], a[124:127], v[92:95]
  v_mfma_f32_16x16x32_bf16 v[88:91], a[164:167], a[120:123], v[88:91]
  ds_read_b64_tr_b16 a[180:181], v7 offset:12288
  v_mfma_f32_16x16x32_bf16 v[88:91], a[160:163], a[104:107], v[88:91]
  buffer_load_dwordx4 a[144:147], v1, s[8:11], s75 offen offset:1024 sc1
  v_mfma_f32_16x16x32_bf16 v[84:87], a[160:163], a[100:103], v[84:87]
  ds_read_b64_tr_b16 a[182:183], v7 offset:14336
  v_mfma_f32_16x16x32_bf16 v[84:87], a[164:167], a[116:119], v[84:87]
  v_mfma_f32_16x16x32_bf16 v[80:83], a[164:167], a[112:115], v[80:83]
  ds_read_b64_tr_b16 a[164:165], v8 offset:0
  s_mov_b32 s61, 86016
  v_mfma_f32_16x16x32_bf16 v[80:83], a[160:163], a[96:99], v[80:83]
  s_waitcnt lgkmcnt(5)
  buffer_load_dwordx4 a[236:239], v13, s[12:15], s61 offen
  v_mfma_f32_16x16x32_bf16 v[96:99], a[168:171], a[96:99], v[96:99]
  ds_read_b64_tr_b16 a[166:167], v8 offset:2048
  s_mov_b32 s61, 93184
  v_mfma_f32_16x16x32_bf16 v[96:99], a[172:175], a[112:115], v[96:99]
  buffer_load_dwordx4 a[240:243], v13, s[12:15], s61 offen
  s_mov_b32 s61, 100352
  v_mfma_f32_16x16x32_bf16 v[100:103], a[172:175], a[116:119], v[100:103]
  ds_read_b64_tr_b16 a[160:161], v8 offset:4096
  v_mfma_f32_16x16x32_bf16 v[100:103], a[168:171], a[100:103], v[100:103]
  buffer_load_dwordx4 a[244:247], v13, s[12:15], s61 offen
  s_mov_b32 s61, 107520
  v_mfma_f32_16x16x32_bf16 v[104:107], a[168:171], a[104:107], v[104:107]
  ds_read_b64_tr_b16 a[162:163], v8 offset:6144
  v_mfma_f32_16x16x32_bf16 v[104:107], a[172:175], a[120:123], v[104:107]
  buffer_load_dwordx4 a[248:251], v13, s[12:15], s61 offen
  ds_read_b128 v[24:27], v14 offset:32
  v_mfma_f32_16x16x32_bf16 v[108:111], a[172:175], a[124:127], v[108:111]
  ds_read_b64_tr_b16 a[172:173], v8 offset:8192
  v_mfma_f32_16x16x32_bf16 v[108:111], a[168:171], a[108:111], v[108:111]
  s_waitcnt lgkmcnt(6)
  v_mfma_f32_16x16x32_bf16 v[124:127], a[176:179], a[108:111], v[124:127]
  ds_read_b64_tr_b16 a[174:175], v8 offset:10240
  v_mfma_f32_16x16x32_bf16 v[124:127], a[180:183], a[124:127], v[124:127]
  v_mfma_f32_16x16x32_bf16 v[120:123], a[180:183], a[120:123], v[120:123]
  ds_read_b64_tr_b16 a[168:169], v8 offset:12288
  v_mfma_f32_16x16x32_bf16 v[120:123], a[176:179], a[104:107], v[120:123]
  s_waitcnt vmcnt(14) lgkmcnt(3)
  v_cndmask_b32 v28, 0, v24, s[16:17]
  v_cndmask_b32 v29, 0, v24, s[18:19]
  v_mfma_f32_16x16x32_bf16 v[116:119], a[176:179], a[100:103], v[116:119]
  ds_read_b64_tr_b16 a[170:171], v8 offset:14336
  v_cndmask_b32 v30, 0, v24, s[20:21]
  v_mfma_f32_16x16x32_bf16 v[116:119], a[180:183], a[116:119], v[116:119]
  v_cndmask_b32 v31, 0, v24, s[22:23]
  v_mfma_f32_16x16x32_bf16 v[112:115], a[180:183], a[112:115], v[112:115]
  ds_read_b64_tr_b16 a[180:181], v2 offset:0
  v_mfma_f32_16x16x32_bf16 a[184:187], v[28:31], a[220:223], a[184:187]
  v_cndmask_b32 v28, 0, v25, s[16:17]
  v_cndmask_b32 v29, 0, v25, s[18:19]
  v_mfma_f32_16x16x32_bf16 v[112:115], a[176:179], a[96:99], v[112:115]
  s_waitcnt lgkmcnt(6)
  v_cndmask_b32 v30, 0, v25, s[20:21]
  v_cndmask_b32 v31, 0, v25, s[22:23]
  v_mfma_f32_16x16x32_bf16 v[32:35], a[164:167], a[96:99], v[32:35]
  ds_read_b64_tr_b16 a[182:183], v2 offset:2048
  v_mfma_f32_16x16x32_bf16 a[184:187], v[28:31], a[224:227], a[184:187]
  v_cndmask_b32 v28, 0, v26, s[16:17]
  v_cndmask_b32 v29, 0, v26, s[18:19]
  v_mfma_f32_16x16x32_bf16 v[32:35], a[160:163], a[112:115], v[32:35]
  v_cndmask_b32 v30, 0, v26, s[20:21]
  v_cndmask_b32 v31, 0, v26, s[22:23]
  v_mfma_f32_16x16x32_bf16 v[36:39], a[160:163], a[116:119], v[36:39]
  ds_read_b64_tr_b16 a[176:177], v2 offset:4096
  v_mfma_f32_16x16x32_bf16 a[184:187], v[28:31], a[228:231], a[184:187]
  v_cndmask_b32 v28, 0, v27, s[16:17]
  v_cndmask_b32 v29, 0, v27, s[18:19]
  v_mfma_f32_16x16x32_bf16 v[36:39], a[164:167], a[100:103], v[36:39]
  v_cndmask_b32 v30, 0, v27, s[20:21]
  v_cndmask_b32 v31, 0, v27, s[22:23]
  v_mfma_f32_16x16x32_bf16 v[40:43], a[164:167], a[104:107], v[40:43]
  ds_read_b64_tr_b16 a[178:179], v2 offset:6144
  v_mfma_f32_16x16x32_bf16 a[184:187], v[28:31], a[232:235], a[184:187]
  v_mfma_f32_16x16x32_bf16 v[40:43], a[160:163], a[120:123], v[40:43]
  v_mfma_f32_16x16x32_bf16 v[44:47], a[160:163], a[124:127], v[44:47]
  ds_read_b64_tr_b16 a[160:161], v2 offset:8192
  v_mfma_f32_16x16x32_bf16 v[44:47], a[164:167], a[108:111], v[44:47]
  s_waitcnt lgkmcnt(5)
  v_mfma_f32_16x16x32_bf16 v[60:63], a[172:175], a[108:111], v[60:63]
  ds_read_b64_tr_b16 a[162:163], v2 offset:10240
  v_mfma_f32_16x16x32_bf16 v[60:63], a[168:171], a[124:127], v[60:63]
  v_mfma_f32_16x16x32_bf16 v[56:59], a[168:171], a[120:123], v[56:59]
  ds_read_b64_tr_b16 a[164:165], v2 offset:12288
  v_mfma_f32_16x16x32_bf16 v[56:59], a[172:175], a[104:107], v[56:59]
  v_mfma_f32_16x16x32_bf16 v[52:55], a[172:175], a[100:103], v[52:55]
  ds_read_b64_tr_b16 a[166:167], v2 offset:14336
  v_mfma_f32_16x16x32_bf16 v[52:55], a[168:171], a[116:119], v[52:55]
  v_mfma_f32_16x16x32_bf16 v[48:51], a[168:171], a[112:115], v[48:51]
  ds_read_b64_tr_b16 a[168:169], v3 offset:0
  v_mfma_f32_16x16x32_bf16 v[48:51], a[172:175], a[96:99], v[48:51]
  s_waitcnt lgkmcnt(5)
  v_mfma_f32_16x16x32_bf16 v[128:131], a[180:183], a[96:99], v[128:131]
  ds_read_b64_tr_b16 a[170:171], v3 offset:2048
  v_mfma_f32_16x16x32_bf16 v[128:131], a[176:179], a[112:115], v[128:131]
  s_add_u32 s75, s75, 65536
  v_mfma_f32_16x16x32_bf16 v[132:135], a[176:179], a[116:119], v[132:135]
  ds_read_b64_tr_b16 a[172:173], v3 offset:4096
  v_mfma_f32_16x16x32_bf16 v[132:135], a[180:183], a[100:103], v[132:135]
  buffer_load_dwordx4 a[132:135], v1, s[8:11], s75 offen offset:0 sc1
  v_mfma_f32_16x16x32_bf16 v[136:139], a[180:183], a[104:107], v[136:139]
  ds_read_b64_tr_b16 a[174:175], v3 offset:6144
  v_mfma_f32_16x16x32_bf16 v[136:139], a[176:179], a[120:123], v[136:139]
  v_mfma_f32_16x16x32_bf16 v[140:143], a[176:179], a[124:127], v[140:143]
  ds_read_b64_tr_b16 a[176:177], v3 offset:8192
  v_mfma_f32_16x16x32_bf16 v[140:143], a[180:183], a[108:111], v[140:143]
  s_waitcnt lgkmcnt(5)
  v_mfma_f32_16x16x32_bf16 v[156:159], a[160:163], a[108:111], v[156:159]
  ds_read_b64_tr_b16 a[178:179], v3 offset:10240
  v_mfma_f32_16x16x32_bf16 v[156:159], a[164:167], a[124:127], v[156:159]
  buffer_load_dwordx4 a[148:151], v1, s[8:11], s75 offen offset:1024 sc1
  v_mfma_f32_16x16x32_bf16 v[152:155], a[164:167], a[120:123], v[152:155]
  ds_read_b64_tr_b16 a[180:181], v3 offset:12288
  v_mfma_f32_16x16x32_bf16 v[152:155], a[160:163], a[104:107], v[152:155]
  s_add_u32 s75, s75, 65536
  v_mfma_f32_16x16x32_bf16 v[148:151], a[160:163], a[100:103], v[148:151]
  ds_read_b64_tr_b16 a[182:183], v3 offset:14336
  v_mfma_f32_16x16x32_bf16 v[148:151], a[164:167], a[116:119], v[148:151]
  buffer_load_dwordx4 a[136:139], v1, s[8:11], s75 offen offset:0 sc1
  v_mfma_f32_16x16x32_bf16 v[144:147], a[164:167], a[112:115], v[144:147]
  ds_read_b64_tr_b16 a[164:165], v4 offset:0
  v_mfma_f32_16x16x32_bf16 v[144:147], a[160:163], a[96:99], v[144:147]
  s_waitcnt lgkmcnt(5)
  v_mfma_f32_16x16x32_bf16 v[160:163], a[168:171], a[96:99], v[160:163]
  ds_read_b64_tr_b16 a[166:167], v4 offset:2048
  s_waitcnt vmcnt(9)
  v_mfma_f32_16x16x32_bf16 v[160:163], a[172:175], a[112:115], v[160:163]
  v_accvgpr_read_b32 v16, a188
  v_accvgpr_read_b32 v17, a189
  v_mfma_f32_16x16x32_bf16 v[164:167], a[172:175], a[116:119], v[164:167]
  ds_read_b64_tr_b16 a[160:161], v4 offset:4096
  v_accvgpr_read_b32 v18, a190
  v_mfma_f32_16x16x32_bf16 v[164:167], a[168:171], a[100:103], v[164:167]
  buffer_load_dwordx4 a[152:155], v1, s[8:11], s75 offen offset:1024 sc1
  v_accvgpr_read_b32 v19, a191
  v_accvgpr_read_b32 v20, a192
  v_mfma_f32_16x16x32_bf16 v[168:171], a[168:171], a[104:107], v[168:171]
  ds_read_b64_tr_b16 a[162:163], v4 offset:6144
  v_accvgpr_read_b32 v21, a193
  v_mfma_f32_16x16x32_bf16 v[168:171], a[172:175], a[120:123], v[168:171]
  s_add_u32 s75, s75, 65536
  v_accvgpr_read_b32 v22, a194
  v_accvgpr_read_b32 v23, a195
  v_mfma_f32_16x16x32_bf16 v[172:175], a[172:175], a[124:127], v[172:175]
  ds_read_b64_tr_b16 a[172:173], v4 offset:8192
  v_accvgpr_read_b32 v24, a196
  v_mfma_f32_16x16x32_bf16 v[172:175], a[168:171], a[108:111], v[172:175]
  s_waitcnt lgkmcnt(5)
  buffer_load_dwordx4 a[140:143], v1, s[8:11], s75 offen offset:0 sc1
  v_accvgpr_read_b32 v25, a197
  v_mfma_f32_16x16x32_bf16 v[188:191], a[176:179], a[108:111], v[188:191]
  ds_read_b64_tr_b16 a[174:175], v4 offset:10240
  v_accvgpr_read_b32 v26, a198
  v_mfma_f32_16x16x32_bf16 v[188:191], a[180:183], a[124:127], v[188:191]
  v_accvgpr_read_b32 v27, a199
  v_accvgpr_read_b32 v28, a200
  v_mfma_f32_16x16x32_bf16 v[184:187], a[180:183], a[120:123], v[184:187]
  ds_read_b64_tr_b16 a[168:169], v4 offset:12288
  v_accvgpr_read_b32 v29, a201
  v_mfma_f32_16x16x32_bf16 v[184:187], a[176:179], a[104:107], v[184:187]
  v_accvgpr_read_b32 v30, a202
  v_accvgpr_read_b32 v31, a203
  v_mfma_f32_16x16x32_bf16 v[180:183], a[176:179], a[100:103], v[180:183]
  ds_read_b64_tr_b16 a[170:171], v4 offset:14336
  v_add_f32 v16, v16, v24
  v_mfma_f32_16x16x32_bf16 v[180:183], a[180:183], a[116:119], v[180:183]
  buffer_load_dwordx4 a[156:159], v1, s[8:11], s75 offen offset:1024 sc1
  v_add_f32 v17, v17, v25
  v_add_f32 v18, v18, v26
  v_mfma_f32_16x16x32_bf16 v[176:179], a[180:183], a[112:115], v[176:179]
  ds_read_b64_tr_b16 a[180:181], v5 offset:0
  v_add_f32 v19, v19, v27
  v_mfma_f32_16x16x32_bf16 v[176:179], a[176:179], a[96:99], v[176:179]
  s_waitcnt lgkmcnt(5)
  s_mov_b32 s68, 2293760
  s_add_u32 s76, s24, 10240
  s_add_u32 m0, s45, 114688
  v_add_f32 v20, v20, v28
  v_mfma_f32_16x16x32_bf16 v[192:195], a[164:167], a[96:99], v[192:195]
  ds_read_b64_tr_b16 a[182:183], v5 offset:2048
  v_add_f32 v21, v21, v29
  v_mfma_f32_16x16x32_bf16 v[192:195], a[160:163], a[112:115], v[192:195]
  buffer_load_dwordx4 v11, s[28:31], s68 offen lds
  v_add_f32 v22, v22, v30
  v_add_f32 v23, v23, v31
  v_mfma_f32_16x16x32_bf16 v[196:199], a[160:163], a[116:119], v[196:199]
  ds_read_b64_tr_b16 a[176:177], v5 offset:4096
  v_accvgpr_read_b32 v24, a204
  v_mfma_f32_16x16x32_bf16 v[196:199], a[164:167], a[100:103], v[196:199]
  v_accvgpr_read_b32 v25, a205
  v_accvgpr_read_b32 v26, a206
  v_mfma_f32_16x16x32_bf16 v[200:203], a[164:167], a[104:107], v[200:203]
  ds_read_b64_tr_b16 a[178:179], v5 offset:6144
  v_accvgpr_read_b32 v27, a207
  v_mfma_f32_16x16x32_bf16 v[200:203], a[160:163], a[120:123], v[200:203]
  s_add_u32 m0, s45, 122880
  v_accvgpr_read_b32 v28, a208
  v_accvgpr_read_b32 v29, a209
  v_mfma_f32_16x16x32_bf16 v[204:207], a[160:163], a[124:127], v[204:207]
  ds_read_b64_tr_b16 a[160:161], v5 offset:8192
  v_accvgpr_read_b32 v30, a210
  v_mfma_f32_16x16x32_bf16 v[204:207], a[164:167], a[108:111], v[204:207]
  s_waitcnt lgkmcnt(5)
  buffer_load_dwordx4 v11, s[32:35], s68 offen lds
  v_accvgpr_read_b32 v31, a211
  v_mfma_f32_16x16x32_bf16 v[220:223], a[172:175], a[108:111], v[220:223]
  ds_read_b64_tr_b16 a[162:163], v5 offset:10240
  v_add_f32 v16, v16, v24
  v_mfma_f32_16x16x32_bf16 v[220:223], a[168:171], a[124:127], v[220:223]
  s_add_u32 m0, s45, 118784
  s_add_u32 s60, s68, 229376
  v_add_f32 v17, v17, v25
  v_mfma_f32_16x16x32_bf16 v[216:219], a[168:171], a[120:123], v[216:219]
  ds_read_b64_tr_b16 a[164:165], v5 offset:12288
  v_add_f32 v18, v18, v26
  v_mfma_f32_16x16x32_bf16 v[216:219], a[172:175], a[104:107], v[216:219]
  buffer_load_dwordx4 v11, s[28:31], s60 offen lds
  v_add_f32 v19, v19, v27
  v_add_f32 v20, v20, v28
  v_mfma_f32_16x16x32_bf16 v[212:215], a[172:175], a[100:103], v[212:215]
  ds_read_b64_tr_b16 a[166:167], v5 offset:14336
  v_add_f32 v21, v21, v29
  v_mfma_f32_16x16x32_bf16 v[212:215], a[168:171], a[116:119], v[212:215]
  s_waitcnt vmcnt(27)
  s_barrier
  v_mfma_f32_16x16x32_bf16 v[208:211], a[168:171], a[112:115], v[208:211]
  ds_read_b64_tr_b16 a[168:169], v6 offset:32768
  v_add_f32 v22, v22, v30
  v_mfma_f32_16x16x32_bf16 v[208:211], a[172:175], a[96:99], v[208:211]
  s_waitcnt lgkmcnt(5)
  s_add_u32 m0, s45, 126976
  s_add_u32 s60, s68, 229376
  v_mfma_f32_16x16x32_bf16 v[224:227], a[180:183], a[96:99], v[224:227]
  ds_read_b64_tr_b16 a[170:171], v6 offset:34816
  v_add_f32 v23, v23, v31
  v_mfma_f32_16x16x32_bf16 v[224:227], a[176:179], a[112:115], v[224:227]
  buffer_load_dwordx4 v11, s[32:35], s60 offen lds
  v_accvgpr_read_b32 v24, a212
  v_accvgpr_read_b32 v25, a213
  v_mfma_f32_16x16x32_bf16 v[228:231], a[176:179], a[116:119], v[228:231]
  ds_read_b64_tr_b16 a[172:173], v6 offset:36864
  v_accvgpr_read_b32 v26, a214
  v_mfma_f32_16x16x32_bf16 v[228:231], a[180:183], a[100:103], v[228:231]
  s_add_u32 m0, s45, 49152
  v_accvgpr_read_b32 v27, a215
  v_accvgpr_read_b32 v28, a216
  v_mfma_f32_16x16x32_bf16 v[232:235], a[180:183], a[104:107], v[232:235]
  ds_read_b64_tr_b16 a[174:175], v6 offset:38912
  v_accvgpr_read_b32 v29, a217
  v_mfma_f32_16x16x32_bf16 v[232:235], a[176:179], a[120:123], v[232:235]
  buffer_load_dwordx4 v10, s[28:31], s68 offen lds
  v_accvgpr_read_b32 v30, a218
  v_accvgpr_read_b32 v31, a219
  v_mfma_f32_16x16x32_bf16 v[236:239], a[176:179], a[124:127], v[236:239]
  ds_read_b64_tr_b16 a[176:177], v6 offset:40960
  v_add_f32 v16, v16, v24
  v_mfma_f32_16x16x32_bf16 v[236:239], a[180:183], a[108:111], v[236:239]
  s_waitcnt lgkmcnt(5)
  v_add_f32 v17, v17, v25
  v_add_f32 v18, v18, v26
  v_mfma_f32_16x16x32_bf16 v[252:255], a[160:163], a[108:111], v[252:255]
  ds_read_b64_tr_b16 a[178:179], v6 offset:43008
  v_add_f32 v19, v19, v27
  v_mfma_f32_16x16x32_bf16 v[252:255], a[164:167], a[124:127], v[252:255]
  s_add_u32 m0, s45, 57344
  v_add_f32 v20, v20, v28
  v_add_f32 v21, v21, v29
  v_mfma_f32_16x16x32_bf16 v[248:251], a[164:167], a[120:123], v[248:251]
  ds_read_b64_tr_b16 a[180:181], v6 offset:45056
  v_add_f32 v22, v22, v30
  v_mfma_f32_16x16x32_bf16 v[248:251], a[160:163], a[104:107], v[248:251]
  buffer_load_dwordx4 v10, s[32:35], s68 offen lds
  v_add_f32 v23, v23, v31
  v_mfma_f32_16x16x32_bf16 v[244:247], a[160:163], a[100:103], v[244:247]
  ds_read_b64_tr_b16 a[182:183], v6 offset:47104
  v_mfma_f32_16x16x32_bf16 v[244:247], a[164:167], a[116:119], v[244:247]
  s_add_u32 m0, s45, 53248
  s_add_u32 s60, s68, 229376
  v_mfma_f32_16x16x32_bf16 v[240:243], a[164:167], a[112:115], v[240:243]
  ds_read_b64_tr_b16 a[164:165], v7 offset:32768
  v_mfma_f32_16x16x32_bf16 v[240:243], a[160:163], a[96:99], v[240:243]
  s_waitcnt vmcnt(6) lgkmcnt(5)
  buffer_load_dwordx4 v10, s[28:31], s60 offen lds
  v_mfma_f32_16x16x32_bf16 v[64:67], a[168:171], a[128:131], v[64:67]
  ds_read_b64_tr_b16 a[166:167], v7 offset:34816
  v_mfma_f32_16x16x32_bf16 v[64:67], a[172:175], a[144:147], v[64:67]
  ds_read_b128 v[24:27], v14 offset:48
  v_mfma_f32_16x16x32_bf16 v[68:71], a[172:175], a[148:151], v[68:71]
  ds_read_b64_tr_b16 a[160:161], v7 offset:36864
  v_mfma_f32_16x16x32_bf16 v[68:71], a[168:171], a[132:135], v[68:71]
  s_add_u32 m0, s45, 61440
  s_add_u32 s60, s68, 229376
  v_mfma_f32_16x16x32_bf16 v[72:75], a[168:171], a[136:139], v[72:75]
  ds_read_b64_tr_b16 a[162:163], v7 offset:38912
  v_mfma_f32_16x16x32_bf16 v[72:75], a[172:175], a[152:155], v[72:75]
  buffer_load_dwordx4 v10, s[32:35], s60 offen lds
  v_mfma_f32_16x16x32_bf16 v[76:79], a[172:175], a[156:159], v[76:79]
  ds_read_b64_tr_b16 a[172:173], v7 offset:40960
  v_mfma_f32_16x16x32_bf16 v[76:79], a[168:171], a[140:143], v[76:79]
  s_waitcnt lgkmcnt(6)
  s_waitcnt vmcnt(14) lgkmcnt(3)
  v_mfma_f32_16x16x32_bf16 v[92:95], a[176:179], a[140:143], v[92:95]
  ds_read_b64_tr_b16 a[174:175], v7 offset:43008
  v_cndmask_b32 v28, 0, v24, s[16:17]
  v_mfma_f32_16x16x32_bf16 v[92:95], a[180:183], a[156:159], v[92:95]
  buffer_load_dwordx4 a[0:3], v1, s[8:11], s76 offen offset:0 sc1
  v_cndmask_b32 v29, 0, v24, s[18:19]
  v_cndmask_b32 v30, 0, v24, s[20:21]
  v_mfma_f32_16x16x32_bf16 v[88:91], a[180:183], a[152:155], v[88:91]
  ds_read_b64_tr_b16 a[168:169], v7 offset:45056
  v_cndmask_b32 v31, 0, v24, s[22:23]
  v_mfma_f32_16x16x32_bf16 v[88:91], a[176:179], a[136:139], v[88:91]
  s_nop 0
  v_mfma_f32_16x16x32_bf16 a[184:187], v[28:31], a[236:239], a[184:187]
  v_cndmask_b32 v28, 0, v25, s[16:17]
  v_cndmask_b32 v29, 0, v25, s[18:19]
  v_mfma_f32_16x16x32_bf16 v[84:87], a[176:179], a[132:135], v[84:87]
  ds_read_b64_tr_b16 a[170:171], v7 offset:47104
  v_cndmask_b32 v30, 0, v25, s[20:21]
  v_mfma_f32_16x16x32_bf16 v[84:87], a[180:183], a[148:151], v[84:87]
  v_cndmask_b32 v31, 0, v25, s[22:23]
  v_mfma_f32_16x16x32_bf16 v[80:83], a[180:183], a[144:147], v[80:83]
  ds_read_b64_tr_b16 a[180:181], v8 offset:32768
  v_mfma_f32_16x16x32_bf16 a[184:187], v[28:31], a[240:243], a[184:187]
  v_cndmask_b32 v28, 0, v26, s[16:17]
  v_cndmask_b32 v29, 0, v26, s[18:19]
  v_mfma_f32_16x16x32_bf16 v[80:83], a[176:179], a[128:131], v[80:83]
  s_waitcnt lgkmcnt(5)
  buffer_load_dwordx4 a[16:19], v1, s[8:11], s76 offen offset:1024 sc1
  v_cndmask_b32 v30, 0, v26, s[20:21]
  v_mfma_f32_16x16x32_bf16 v[96:99], a[164:167], a[128:131], v[96:99]
  ds_read_b64_tr_b16 a[182:183], v8 offset:34816
  v_cndmask_b32 v31, 0, v26, s[22:23]
  v_mfma_f32_16x16x32_bf16 v[96:99], a[160:163], a[144:147], v[96:99]
  s_add_u32 s76, s76, 65536
  v_mfma_f32_16x16x32_bf16 a[184:187], v[28:31], a[244:247], a[184:187]
  v_cndmask_b32 v28, 0, v27, s[16:17]
  v_cndmask_b32 v29, 0, v27, s[18:19]
  v_mfma_f32_16x16x32_bf16 v[100:103], a[160:163], a[148:151], v[100:103]
  ds_read_b64_tr_b16 a[176:177], v8 offset:36864
  v_cndmask_b32 v30, 0, v27, s[20:21]
  v_mfma_f32_16x16x32_bf16 v[100:103], a[164:167], a[132:135], v[100:103]
  buffer_load_dwordx4 a[4:7], v1, s[8:11], s76 offen offset:0 sc1
  v_cndmask_b32 v31, 0, v27, s[22:23]
  v_mfma_f32_16x16x32_bf16 v[104:107], a[164:167], a[136:139], v[104:107]
  ds_read_b64_tr_b16 a[178:179], v8 offset:38912
  v_mfma_f32_16x16x32_bf16 a[184:187], v[28:31], a[248:251], a[184:187]
  v_mfma_f32_16x16x32_bf16 v[104:107], a[160:163], a[152:155], v[104:107]
  v_mfma_f32_16x16x32_bf16 v[108:111], a[160:163], a[156:159], v[108:111]
  ds_read_b64_tr_b16 a[160:161], v8 offset:40960
  v_mfma_f32_16x16x32_bf16 v[108:111], a[164:167], a[140:143], v[108:111]
  s_waitcnt lgkmcnt(5)
  s_add_u32 s61, s62, 8192
  v_mfma_f32_16x16x32_bf16 v[124:127], a[172:175], a[140:143], v[124:127]
  ds_read_b64_tr_b16 a[162:163], v8 offset:43008
  s_bfe_u32 s53, s2, 0x20004
  v_mfma_f32_16x16x32_bf16 v[124:127], a[168:171], a[156:159], v[124:127]
  buffer_load_dwordx4 a[188:191], v12, s[8:11], s61 offen offset:0 sc1
  s_lshl_b32 s53, s53, 9
  v_and_b32 v14, 15, v0
  v_mfma_f32_16x16x32_bf16 v[120:123], a[168:171], a[152:155], v[120:123]
  ds_read_b64_tr_b16 a[164:165], v8 offset:45056
  v_lshl_add_u32 v14, v14, 5, s53
  v_mfma_f32_16x16x32_bf16 v[120:123], a[172:175], a[136:139], v[120:123]
  s_add_u32 s61, s62, 8192
  v_cmp_gt_u32 vcc, 1792, v14
  v_mov_b32 v15, 134217728
  v_bfe_u32 v13, v0, 4, 1
  v_cndmask_b32 v14, v15, v14, vcc
  v_mfma_f32_16x16x32_bf16 v[116:119], a[172:175], a[132:135], v[116:119]
  ds_read_b64_tr_b16 a[166:167], v8 offset:47104
  v_lshl_add_u32 v14, v13, 4, v14
  v_mfma_f32_16x16x32_bf16 v[116:119], a[168:171], a[148:151], v[116:119]
  buffer_load_dwordx4 a[192:195], v12, s[8:11], s61 offen offset:256 sc1
  v_lshrrev_b32 v13, 5, v0
  v_mul_u32_u24 v13, 14336, v13
  v_mfma_f32_16x16x32_bf16 v[112:115], a[168:171], a[144:147], v[112:115]
  ds_read_b64_tr_b16 a[168:169], v2 offset:32768
  v_add_u32 v14, v14, v13
  v_mfma_f32_16x16x32_bf16 v[112:115], a[172:175], a[128:131], v[112:115]
  s_waitcnt lgkmcnt(5)
  s_lshr_b32 s53, s2, 6
  s_lshl_b32 s53, s53, 2
  v_mfma_f32_16x16x32_bf16 v[32:35], a[180:183], a[128:131], v[32:35]
HOP9:
  s_cbranch_execz HOP13
  ds_read_b64_tr_b16 a[170:171], v2 offset:34816
  s_add_u32 s53, s53, s44
  v_mfma_f32_16x16x32_bf16 v[32:35], a[176:179], a[144:147], v[32:35]
  s_add_u32 s61, s62, 10240
  s_lshl_b32 s53, s53, 1
  s_bfe_u32 s54, s2, 0x10003
  v_mfma_f32_16x16x32_bf16 v[36:39], a[176:179], a[148:151], v[36:39]
  ds_read_b64_tr_b16 a[172:173], v2 offset:36864
  s_add_u32 s53, s53, s54
  v_mfma_f32_16x16x32_bf16 v[36:39], a[180:183], a[132:135], v[36:39]
  buffer_load_dwordx4 a[196:199], v12, s[8:11], s61 offen offset:0 sc1
  s_mul_i32 s53, s53, 28672
  s_mul_i32 s54, s52, 1792
  v_mfma_f32_16x16x32_bf16 v[40:43], a[180:183], a[136:139], v[40:43]
  ds_read_b64_tr_b16 a[174:175], v2 offset:38912
  s_add_u32 s53, s53, s54
  v_mfma_f32_16x16x32_bf16 v[40:43], a[176:179], a[152:155], v[40:43]
  s_add_u32 s61, s62, 10240
  s_add_u32 s53, s53, 46137344
  v_mfma_f32_16x16x32_bf16 v[44:47], a[176:179], a[156:159], v[44:47]
  ds_read_b64_tr_b16 a[176:177], v2 offset:40960
  v_mfma_f32_16x16x32_bf16 v[44:47], a[180:183], a[140:143], v[44:47]
  s_waitcnt lgkmcnt(5)
  buffer_load_dwordx4 a[200:203], v12, s[8:11], s61 offen offset:256 sc1
  v_mfma_f32_16x16x32_bf16 v[60:63], a[160:163], a[140:143], v[60:63]
  ds_read_b64_tr_b16 a[178:179], v2 offset:43008
  buffer_store_dwordx4 a[184:187], v14, s[8:11], s53 offen sc1
  v_mfma_f32_16x16x32_bf16 v[60:63], a[164:167], a[156:159], v[60:63]
  s_lshl_b32 s53, s52, 7
  s_add_u32 s53, s53, 884736
  v_and_b32 v13, 31, v0
  v_mfma_f32_16x16x32_bf16 v[56:59], a[164:167], a[152:155], v[56:59]
  ds_read_b64_tr_b16 a[180:181], v2 offset:45056
  v_min_u32 v15, 27, v13
  v_mfma_f32_16x16x32_bf16 v[56:59], a[160:163], a[136:139], v[56:59]
  s_add_u32 s61, s62, 12288
  v_lshl_add_u32 v13, v13, 10, s53
  v_lshlrev_b32 v15, 4, v15
  v_mfma_f32_16x16x32_bf16 v[52:55], a[160:163], a[132:135], v[52:55]
  ds_read_b64_tr_b16 a[182:183], v2 offset:47104
  s_lshl_b32 s53, s51, 9
  v_mfma_f32_16x16x32_bf16 v[52:55], a[164:167], a[148:151], v[52:55]
  buffer_load_dwordx4 a[204:207], v12, s[8:11], s61 offen offset:0 sc1
  v_mov_b32 v14, s53
  s_lshl_b32 s55, s51, 3
  v_mfma_f32_16x16x32_bf16 v[48:51], a[164:167], a[144:147], v[48:51]
  ds_read_b64_tr_b16 a[164:165], v3 offset:32768
  s_lshr_b32 s53, 0x0b070602, s55
  v_mfma_f32_16x16x32_bf16 v[48:51], a[160:163], a[128:131], v[48:51]
  s_waitcnt lgkmcnt(5)
  s_add_u32 s61, s62, 12288
  s_and_b32 s53, s53, 15
  v_mfma_f32_16x16x32_bf16 v[128:131], a[168:171], a[128:131], v[128:131]
  ds_read_b64_tr_b16 a[166:167], v3 offset:34816
  s_lshl_b32 s53, s53, 7
  v_mfma_f32_16x16x32_bf16 v[128:131], a[172:175], a[144:147], v[128:131]
  buffer_load_dwordx4 a[208:211], v12, s[8:11], s61 offen offset:256 sc1
  s_sub_u32 s53, s53, 256
  v_mov_b32 v24, s53
  v_mfma_f32_16x16x32_bf16 v[132:135], a[172:175], a[148:151], v[132:135]
  ds_read_b64_tr_b16 a[160:161], v3 offset:36864
  v_mfma_f32_16x16x32_bf16 v[132:135], a[168:171], a[132:135], v[132:135]
  v_cmp_gt_u32 vcc, 256, v15
  s_nop 1
  v_cndmask_b32 v14, v24, v14, vcc
  v_mfma_f32_16x16x32_bf16 v[136:139], a[168:171], a[136:139], v[136:139]
  ds_read_b64_tr_b16 a[162:163], v3 offset:38912
  s_lshr_b32 s53, 0x15140706, s55
  v_mfma_f32_16x16x32_bf16 v[136:139], a[172:175], a[152:155], v[136:139]
  s_add_u32 s61, s62, 14336
  s_and_b32 s53, s53, 31
  s_lshl_b32 s53, s53, 6
  v_mfma_f32_16x16x32_bf16 v[140:143], a[172:175], a[156:159], v[140:143]
  ds_read_b64_tr_b16 a[172:173], v3 offset:40960
  s_sub_u32 s53, s53, 384
  v_mfma_f32_16x16x32_bf16 v[140:143], a[168:171], a[140:143], v[140:143]
  s_waitcnt lgkmcnt(5)
  buffer_load_dwordx4 a[212:215], v12, s[8:11], s61 offen offset:0 sc1
  v_mov_b32 v24, s53
  v_mfma_f32_16x16x32_bf16 v[156:159], a[176:179], a[140:143], v[156:159]
  ds_read_b64_tr_b16 a[174:175], v3 offset:43008
  v_mfma_f32_16x16x32_bf16 v[156:159], a[180:183], a[156:159], v[156:159]
  s_add_u32 s61, s62, 14336
  v_cmp_gt_u32 vcc, 384, v15
  s_nop 1
  v_cndmask_b32 v14, v24, v14, vcc
  v_mfma_f32_16x16x32_bf16 v[152:155], a[180:183], a[152:155], v[152:155]
  ds_read_b64_tr_b16 a[168:169], v3 offset:45056
  v_lshrrev_b32 v24, 5, v0
  v_mfma_f32_16x16x32_bf16 v[152:155], a[176:179], a[136:139], v[152:155]
  buffer_load_dwordx4 a[216:219], v12, s[8:11], s61 offen offset:256 sc1
  v_mul_u32_u24 v24, 57344, v24
  v_add3_u32 v14, v14, v15, v24
  v_mfma_f32_16x16x32_bf16 v[148:151], a[176:179], a[132:135], v[148:151]
  ds_read_b64_tr_b16 a[170:171], v3 offset:47104
  s_mul_i32 s53, s44, 14336
  v_mfma_f32_16x16x32_bf16 v[148:151], a[180:183], a[148:151], v[148:151]
  s_add_u32 s53, s53, s54
  s_add_u32 s53, s53, 46137344
  v_add_u32 v14, s53, v14
  v_mfma_f32_16x16x32_bf16 v[144:147], a[180:183], a[144:147], v[144:147]
  ds_read_b64_tr_b16 a[180:181], v4 offset:32768
  s_lshl_b32 s53, s44, 9
  v_mfma_f32_16x16x32_bf16 v[144:147], a[176:179], a[128:131], v[144:147]
  s_waitcnt lgkmcnt(5)
  s_add_u32 s53, s53, 131072
  v_add_u32 v15, s53, v15
  v_mfma_f32_16x16x32_bf16 v[160:163], a[164:167], a[128:131], v[160:163]
  ds_read_b64_tr_b16 a[182:183], v4 offset:34816
  s_and_b32 s50, s2, 4
  v_mfma_f32_16x16x32_bf16 v[160:163], a[160:163], a[144:147], v[160:163]
  buffer_load_dwordx4 a[20:23], v1, s[8:11], s76 offen offset:1024 sc1
  s_lshr_b32 s53, s2, 6
  s_add_u32 s50, s50, s53
  v_mfma_f32_16x16x32_bf16 v[164:167], a[160:163], a[148:151], v[164:167]
  ds_read_b64_tr_b16 a[176:177], v4 offset:36864
  s_bfe_u32 s51, s2, 0x30003
  v_mfma_f32_16x16x32_bf16 v[164:167], a[164:167], a[132:135], v[164:167]
  s_add_u32 s76, s76, 65536
  s_and_b32 s52, s2, 3
  s_add_u32 s90, s50, s51
  v_mfma_f32_16x16x32_bf16 v[168:171], a[164:167], a[136:139], v[168:171]
  ds_read_b64_tr_b16 a[178:179], v4 offset:38912
  s_and_b32 s90, s90, 3
  v_mfma_f32_16x16x32_bf16 v[168:171], a[160:163], a[152:155], v[168:171]
  buffer_load_dwordx4 a[8:11], v1, s[8:11], s76 offen offset:0 sc1
  s_lshl_b32 s53, s50, 4
  s_and_b32 s54, s52, 2
  v_mfma_f32_16x16x32_bf16 v[172:175], a[160:163], a[156:159], v[172:175]
  ds_read_b64_tr_b16 a[160:161], v4 offset:40960
  s_mul_i32 s88, s54, 4293918720
  v_mfma_f32_16x16x32_bf16 v[172:175], a[164:167], a[140:143], v[172:175]
  s_waitcnt lgkmcnt(5)
  s_add_u32 s88, s88, 917504
  s_lshl_b32 s54, s54, 2
  v_mfma_f32_16x16x32_bf16 v[188:191], a[172:175], a[140:143], v[188:191]
  ds_read_b64_tr_b16 a[162:163], v4 offset:43008
  s_add_u32 s53, s53, s54
  v_mfma_f32_16x16x32_bf16 v[188:191], a[168:171], a[156:159], v[188:191]
  s_lshl_b32 s54, s44, 1
  s_add_u32 s53, s53, s54
  s_mul_i32 s83, s53, 131072
  v_mfma_f32_16x16x32_bf16 v[184:187], a[168:171], a[152:155], v[184:187]
  ds_read_b64_tr_b16 a[164:165], v4 offset:45056
  s_mul_i32 s54, s52, 28672
  v_mfma_f32_16x16x32_bf16 v[184:187], a[172:175], a[136:139], v[184:187]
  buffer_load_dwordx4 a[24:27], v1, s[8:11], s76 offen offset:1024 sc1
  s_add_u32 s83, s83, s54
  s_add_u32 s83, s83, 19922944
  v_mfma_f32_16x16x32_bf16 v[180:183], a[172:175], a[132:135], v[180:183]
  ds_read_b64_tr_b16 a[166:167], v4 offset:47104
  s_lshl_b32 s84, s53, 15
  v_mfma_f32_16x16x32_bf16 v[180:183], a[168:171], a[148:151], v[180:183]
  s_add_u32 s76, s76, 65536
  s_lshl_b32 s51, s51, 1
  s_and_b32 s54, s52, 1
  v_mfma_f32_16x16x32_bf16 v[176:179], a[168:171], a[144:147], v[176:179]
  ds_read_b64_tr_b16 a[168:169], v5 offset:32768
  s_add_u32 s51, s51, s54
  v_mfma_f32_16x16x32_bf16 v[176:179], a[172:175], a[128:131], v[176:179]
  s_waitcnt lgkmcnt(5)
  buffer_load_dwordx4 a[12:15], v1, s[8:11], s76 offen offset:0 sc1
  s_lshl_b32 s53, s51, 7
  v_mfma_f32_16x16x32_bf16 v[192:195], a[180:183], a[128:131], v[192:195]
  ds_read_b64_tr_b16 a[170:171], v5 offset:34816
  s_add_u32 s84, s84, s53
  v_mfma_f32_16x16x32_bf16 v[192:195], a[176:179], a[144:147], v[192:195]
  s_lshl_b32 s87, s51, 8
  s_add_u32 s87, s87, 20480
  s_lshl_b32 s53, s50, 12
  v_mfma_f32_16x16x32_bf16 v[196:199], a[176:179], a[148:151], v[196:199]
  ds_read_b64_tr_b16 a[172:173], v5 offset:36864
  s_lshl_b32 s54, s52, 8
  v_mfma_f32_16x16x32_bf16 v[196:199], a[180:183], a[132:135], v[196:199]
  s_add_u32 s53, s53, s54
  s_add_u32 s81, s53, 688128
  s_lshl_b32 s89, s44, 12
  v_mfma_f32_16x16x32_bf16 v[200:203], a[180:183], a[136:139], v[200:203]
  ds_read_b64_tr_b16 a[174:175], v5 offset:38912
  s_add_u32 s89, s89, 135168
  v_mfma_f32_16x16x32_bf16 v[200:203], a[176:179], a[152:155], v[200:203]
  buffer_load_dwordx4 a[28:31], v1, s[8:11], s76 offen offset:1024 sc1
  s_lshl_b32 s85, s2, 16
  s_lshl_b32 s53, s44, 14
  v_mfma_f32_16x16x32_bf16 v[204:207], a[176:179], a[156:159], v[204:207]
  ds_read_b64_tr_b16 a[176:177], v5 offset:40960
  s_add_u32 s85, s85, s53
  v_mfma_f32_16x16x32_bf16 v[204:207], a[180:183], a[140:143], v[204:207]
  s_waitcnt lgkmcnt(5)
  s_mov_b32 s69, 2752512
  s_add_u32 s77, s24, 12288
  s_add_u32 m0, s45, 81920
  s_add_u32 s85, s85, 67108864
  v_mfma_f32_16x16x32_bf16 v[220:223], a[160:163], a[140:143], v[220:223]
  ds_read_b64_tr_b16 a[178:179], v5 offset:43008
  s_lshr_b32 s53, s2, 3
  v_mfma_f32_16x16x32_bf16 v[220:223], a[164:167], a[156:159], v[220:223]
  buffer_load_dwordx4 v11, s[28:31], s69 offen lds
  s_lshl_b32 s53, s53, 2
  s_add_u32 s53, s53, s44
  v_mfma_f32_16x16x32_bf16 v[216:219], a[164:167], a[152:155], v[216:219]
  ds_read_b64_tr_b16 a[180:181], v5 offset:45056
  s_mul_i32 s91, s53, 14336
  v_mfma_f32_16x16x32_bf16 v[216:219], a[160:163], a[136:139], v[216:219]
  s_mul_i32 s53, s52, 1835008
  s_add_u32 s91, s91, s53
  s_nop 0
  v_mfma_f32_16x16x32_bf16 v[212:215], a[160:163], a[132:135], v[212:215]
  ds_read_b64_tr_b16 a[182:183], v5 offset:47104
  v_mfma_f32_16x16x32_bf16 v[212:215], a[164:167], a[148:151], v[212:215]
  s_waitcnt vmcnt(18)
  s_barrier
  v_mfma_f32_16x16x32_bf16 v[208:211], a[164:167], a[144:147], v[208:211]
  ds_read_b64_tr_b16 a[164:165], v6 offset:49152
  s_add_u32 m0, s45, 90112
  v_mfma_f32_16x16x32_bf16 v[208:211], a[160:163], a[128:131], v[208:211]
  s_waitcnt lgkmcnt(5)
  buffer_load_dwordx4 v11, s[32:35], s69 offen lds
  v_mfma_f32_16x16x32_bf16 v[224:227], a[168:171], a[128:131], v[224:227]
  ds_read_b64_tr_b16 a[166:167], v6 offset:51200
  v_mfma_f32_16x16x32_bf16 v[224:227], a[172:175], a[144:147], v[224:227]
  s_add_u32 m0, s45, 86016
  s_add_u32 s60, s69, 229376
  v_mfma_f32_16x16x32_bf16 v[228:231], a[172:175], a[148:151], v[228:231]
  ds_read_b64_tr_b16 a[160:161], v6 offset:53248
  v_mfma_f32_16x16x32_bf16 v[228:231], a[168:171], a[132:135], v[228:231]
  buffer_load_dwordx4 v11, s[28:31], s60 offen lds
  v_mfma_f32_16x16x32_bf16 v[232:235], a[168:171], a[136:139], v[232:235]
  ds_read_b64_tr_b16 a[162:163], v6 offset:55296
  v_add_u32 v9, s46, v0
  s_waitcnt vmcnt(12)
  s_barrier
  s_mov_b64 exec, 1
  buffer_store_dword v9, v0, s[8:11], s79 offen offset:0 sc1
  s_mov_b64 exec, -1
  s_sub_u32 s79, s79, 196608
  v_mfma_f32_16x16x32_bf16 v[232:235], a[172:175], a[152:155], v[232:235]
  v_mfma_f32_16x16x32_bf16 v[236:239], a[172:175], a[156:159], v[236:239]
  ds_read_b64_tr_b16 a[172:173], v6 offset:57344
  v_mfma_f32_16x16x32_bf16 v[236:239], a[168:171], a[140:143], v[236:239]
  s_waitcnt lgkmcnt(5)
  s_add_u32 m0, s45, 94208
  s_add_u32 s60, s69, 229376
  v_mfma_f32_16x16x32_bf16 v[252:255], a[176:179], a[140:143], v[252:255]
  ds_read_b64_tr_b16 a[174:175], v6 offset:59392
  v_mfma_f32_16x16x32_bf16 v[252:255], a[180:183], a[156:159], v[252:255]
  buffer_load_dwordx4 v11, s[32:35], s60 offen lds
  v_mfma_f32_16x16x32_bf16 v[248:251], a[180:183], a[152:155], v[248:251]
  ds_read_b64_tr_b16 a[168:169], v6 offset:61440
  v_mfma_f32_16x16x32_bf16 v[248:251], a[176:179], a[136:139], v[248:251]
  s_add_u32 m0, s45, 16384
  v_mfma_f32_16x16x32_bf16 v[244:247], a[176:179], a[132:135], v[244:247]
  ds_read_b64_tr_b16 a[170:171], v6 offset:63488
  v_mfma_f32_16x16x32_bf16 v[244:247], a[180:183], a[148:151], v[244:247]
  buffer_load_dwordx4 v10, s[28:31], s69 offen lds
  v_mfma_f32_16x16x32_bf16 v[240:243], a[180:183], a[144:147], v[240:243]
  ds_read_b64_tr_b16 a[180:181], v7 offset:49152
  v_mfma_f32_16x16x32_bf16 v[240:243], a[176:179], a[128:131], v[240:243]
  s_waitcnt vmcnt(6) lgkmcnt(5)
  v_mfma_f32_16x16x32_bf16 v[64:67], a[164:167], a[0:3], v[64:67]
  ds_read_b64_tr_b16 a[182:183], v7 offset:51200
  v_mfma_f32_16x16x32_bf16 v[64:67], a[160:163], a[16:19], v[64:67]
  s_add_u32 m0, s45, 24576
  v_mfma_f32_16x16x32_bf16 v[68:71], a[160:163], a[20:23], v[68:71]
  ds_read_b64_tr_b16 a[176:177], v7 offset:53248
  v_mfma_f32_16x16x32_bf16 v[68:71], a[164:167], a[4:7], v[68:71]
  buffer_load_dwordx4 v10, s[32:35], s69 offen lds
  v_mfma_f32_16x16x32_bf16 v[72:75], a[164:167], a[8:11], v[72:75]
  ds_read_b64_tr_b16 a[178:179], v7 offset:55296
  v_mfma_f32_16x16x32_bf16 v[72:75], a[160:163], a[24:27], v[72:75]
  s_add_u32 m0, s45, 20480
  s_add_u32 s60, s69, 229376
  v_mfma_f32_16x16x32_bf16 v[76:79], a[160:163], a[28:31], v[76:79]
  ds_read_b64_tr_b16 a[160:161], v7 offset:57344
  v_mfma_f32_16x16x32_bf16 v[76:79], a[164:167], a[12:15], v[76:79]
  s_waitcnt lgkmcnt(5)
  buffer_load_dwordx4 v10, s[28:31], s60 offen lds
  v_mfma_f32_16x16x32_bf16 v[92:95], a[172:175], a[12:15], v[92:95]
  ds_read_b64_tr_b16 a[162:163], v7 offset:59392
  v_mfma_f32_16x16x32_bf16 v[92:95], a[168:171], a[28:31], v[92:95]
  v_mfma_f32_16x16x32_bf16 v[88:91], a[168:171], a[24:27], v[88:91]
  ds_read_b64_tr_b16 a[164:165], v7 offset:61440
  s_waitcnt vmcnt(13)
  v_mfma_f32_16x16x32_bf16 v[88:91], a[172:175], a[8:11], v[88:91]
  s_add_u32 m0, s45, 28672
  s_add_u32 s60, s69, 229376
  v_accvgpr_read_b32 v24, a188
  v_mfma_f32_16x16x32_bf16 v[84:87], a[172:175], a[4:7], v[84:87]
  ds_read_b64_tr_b16 a[166:167], v7 offset:63488
  v_accvgpr_read_b32 v25, a189
  v_mfma_f32_16x16x32_bf16 v[84:87], a[168:171], a[20:23], v[84:87]
  buffer_load_dwordx4 v10, s[32:35], s60 offen lds
  v_accvgpr_read_b32 v26, a190
  v_accvgpr_read_b32 v27, a191
  v_mfma_f32_16x16x32_bf16 v[80:83], a[168:171], a[16:19], v[80:83]
  ds_read_b64_tr_b16 a[168:169], v8 offset:49152
  v_accvgpr_read_b32 v28, a192
  v_mfma_f32_16x16x32_bf16 v[80:83], a[172:175], a[0:3], v[80:83]
  s_waitcnt lgkmcnt(5)
  v_accvgpr_read_b32 v29, a193
  v_mfma_f32_16x16x32_bf16 v[96:99], a[180:183], a[0:3], v[96:99]
  ds_read_b64_tr_b16 a[170:171], v8 offset:51200
  v_accvgpr_read_b32 v30, a194
  v_mfma_f32_16x16x32_bf16 v[96:99], a[176:179], a[16:19], v[96:99]
  buffer_load_dwordx4 a[32:35], v1, s[8:11], s77 offen offset:0 sc1
  v_accvgpr_read_b32 v31, a195
  v_add_f32 v16, v16, v24
  v_mfma_f32_16x16x32_bf16 v[100:103], a[176:179], a[20:23], v[100:103]
  ds_read_b64_tr_b16 a[172:173], v8 offset:53248
  v_add_f32 v17, v17, v25
  v_mfma_f32_16x16x32_bf16 v[100:103], a[180:183], a[4:7], v[100:103]
  v_add_f32 v18, v18, v26
  v_add_f32 v19, v19, v27
  v_mfma_f32_16x16x32_bf16 v[104:107], a[180:183], a[8:11], v[104:107]
  ds_read_b64_tr_b16 a[174:175], v8 offset:55296
  v_add_f32 v20, v20, v28
  v_mfma_f32_16x16x32_bf16 v[104:107], a[176:179], a[24:27], v[104:107]
  v_add_f32 v21, v21, v29
  v_add_f32 v22, v22, v30
  v_mfma_f32_16x16x32_bf16 v[108:111], a[176:179], a[28:31], v[108:111]
  ds_read_b64_tr_b16 a[176:177], v8 offset:57344
  v_add_f32 v23, v23, v31
  v_mfma_f32_16x16x32_bf16 v[108:111], a[180:183], a[12:15], v[108:111]
  s_waitcnt lgkmcnt(5)
  buffer_load_dwordx4 a[48:51], v1, s[8:11], s77 offen offset:1024 sc1
  v_accvgpr_read_b32 v24, a196
  v_mfma_f32_16x16x32_bf16 v[124:127], a[160:163], a[12:15], v[124:127]
  ds_read_b64_tr_b16 a[178:179], v8 offset:59392
  v_accvgpr_read_b32 v25, a197
  v_mfma_f32_16x16x32_bf16 v[124:127], a[164:167], a[28:31], v[124:127]
  s_add_u32 s77, s77, 65536
  v_accvgpr_read_b32 v26, a198
  v_accvgpr_read_b32 v27, a199
  v_mfma_f32_16x16x32_bf16 v[120:123], a[164:167], a[24:27], v[120:123]
  ds_read_b64_tr_b16 a[180:181], v8 offset:61440
  v_accvgpr_read_b32 v28, a200
  v_mfma_f32_16x16x32_bf16 v[120:123], a[160:163], a[8:11], v[120:123]
  buffer_load_dwordx4 a[36:39], v1, s[8:11], s77 offen offset:0 sc1
  v_accvgpr_read_b32 v29, a201
  v_accvgpr_read_b32 v30, a202
  v_mfma_f32_16x16x32_bf16 v[116:119], a[160:163], a[4:7], v[116:119]
  ds_read_b64_tr_b16 a[182:183], v8 offset:63488
  v_accvgpr_read_b32 v31, a203
  v_mfma_f32_16x16x32_bf16 v[116:119], a[164:167], a[20:23], v[116:119]
  v_add_f32 v16, v16, v24
  v_add_f32 v17, v17, v25
  v_mfma_f32_16x16x32_bf16 v[112:115], a[164:167], a[16:19], v[112:115]
  ds_read_b64_tr_b16 a[164:165], v2 offset:49152
  v_add_f32 v18, v18, v26
  v_mfma_f32_16x16x32_bf16 v[112:115], a[160:163], a[0:3], v[112:115]
  s_waitcnt lgkmcnt(5)
  v_add_f32 v19, v19, v27
  v_add_f32 v20, v20, v28
  v_mfma_f32_16x16x32_bf16 v[32:35], a[168:171], a[0:3], v[32:35]
  ds_read_b64_tr_b16 a[166:167], v2 offset:51200
  v_add_f32 v21, v21, v29
  v_mfma_f32_16x16x32_bf16 v[32:35], a[172:175], a[16:19], v[32:35]
  buffer_load_dwordx4 a[52:55], v1, s[8:11], s77 offen offset:1024 sc1
  v_add_f32 v22, v22, v30
  v_add_f32 v23, v23, v31
  v_mfma_f32_16x16x32_bf16 v[36:39], a[172:175], a[20:23], v[36:39]
  ds_read_b64_tr_b16 a[160:161], v2 offset:53248
  v_accvgpr_read_b32 v24, a204
  v_mfma_f32_16x16x32_bf16 v[36:39], a[168:171], a[4:7], v[36:39]
  s_add_u32 s77, s77, 65536
  v_accvgpr_read_b32 v25, a205
  v_accvgpr_read_b32 v26, a206
  v_mfma_f32_16x16x32_bf16 v[40:43], a[168:171], a[8:11], v[40:43]
  ds_read_b64_tr_b16 a[162:163], v2 offset:55296
  v_accvgpr_read_b32 v27, a207
  v_mfma_f32_16x16x32_bf16 v[40:43], a[172:175], a[24:27], v[40:43]
  buffer_load_dwordx4 a[40:43], v1, s[8:11], s77 offen offset:0 sc1
  v_accvgpr_read_b32 v28, a208
  v_accvgpr_read_b32 v29, a209
  v_mfma_f32_16x16x32_bf16 v[44:47], a[172:175], a[28:31], v[44:47]
  ds_read_b64_tr_b16 a[172:173], v2 offset:57344
  v_accvgpr_read_b32 v30, a210
  v_mfma_f32_16x16x32_bf16 v[44:47], a[168:171], a[12:15], v[44:47]
  s_waitcnt lgkmcnt(5)
  v_accvgpr_read_b32 v31, a211
  v_add_f32 v16, v16, v24
  v_mfma_f32_16x16x32_bf16 v[60:63], a[176:179], a[12:15], v[60:63]
  ds_read_b64_tr_b16 a[174:175], v2 offset:59392
  v_add_f32 v17, v17, v25
  v_mfma_f32_16x16x32_bf16 v[60:63], a[180:183], a[28:31], v[60:63]
  v_add_f32 v18, v18, v26
  v_add_f32 v19, v19, v27
  v_mfma_f32_16x16x32_bf16 v[56:59], a[180:183], a[24:27], v[56:59]
  ds_read_b64_tr_b16 a[168:169], v2 offset:61440
  v_add_f32 v20, v20, v28
  v_mfma_f32_16x16x32_bf16 v[56:59], a[176:179], a[8:11], v[56:59]
  buffer_load_dwordx4 a[56:59], v1, s[8:11], s77 offen offset:1024 sc1
  v_add_f32 v21, v21, v29
  v_add_f32 v22, v22, v30
  v_mfma_f32_16x16x32_bf16 v[52:55], a[176:179], a[4:7], v[52:55]
  ds_read_b64_tr_b16 a[170:171], v2 offset:63488
  v_add_f32 v23, v23, v31
  v_mfma_f32_16x16x32_bf16 v[52:55], a[180:183], a[20:23], v[52:55]
  s_add_u32 s77, s77, 65536
  v_accvgpr_read_b32 v24, a212
  v_accvgpr_read_b32 v25, a213
  v_mfma_f32_16x16x32_bf16 v[48:51], a[180:183], a[16:19], v[48:51]
  ds_read_b64_tr_b16 a[180:181], v3 offset:49152
  v_accvgpr_read_b32 v26, a214
  v_mfma_f32_16x16x32_bf16 v[48:51], a[176:179], a[0:3], v[48:51]
  s_waitcnt lgkmcnt(5)
  buffer_load_dwordx4 a[44:47], v1, s[8:11], s77 offen offset:0 sc1
  v_accvgpr_read_b32 v27, a215
  v_mfma_f32_16x16x32_bf16 v[128:131], a[164:167], a[0:3], v[128:131]
  ds_read_b64_tr_b16 a[182:183], v3 offset:51200
  v_accvgpr_read_b32 v28, a216
  v_mfma_f32_16x16x32_bf16 v[128:131], a[160:163], a[16:19], v[128:131]
  v_accvgpr_read_b32 v29, a217
  v_accvgpr_read_b32 v30, a218
  v_mfma_f32_16x16x32_bf16 v[132:135], a[160:163], a[20:23], v[132:135]
  ds_read_b64_tr_b16 a[176:177], v3 offset:53248
  v_accvgpr_read_b32 v31, a219
  v_mfma_f32_16x16x32_bf16 v[132:135], a[164:167], a[4:7], v[132:135]
  v_add_f32 v16, v16, v24
  v_add_f32 v17, v17, v25
  v_mfma_f32_16x16x32_bf16 v[136:139], a[164:167], a[8:11], v[136:139]
  ds_read_b64_tr_b16 a[178:179], v3 offset:55296
  v_add_f32 v18, v18, v26
  v_mfma_f32_16x16x32_bf16 v[136:139], a[160:163], a[24:27], v[136:139]
  buffer_load_dwordx4 a[60:63], v1, s[8:11], s77 offen offset:1024 sc1
  v_add_f32 v19, v19, v27
  v_add_f32 v20, v20, v28
  v_mfma_f32_16x16x32_bf16 v[140:143], a[160:163], a[28:31], v[140:143]
  ds_read_b64_tr_b16 a[160:161], v3 offset:57344
  v_add_f32 v21, v21, v29
  v_mfma_f32_16x16x32_bf16 v[140:143], a[164:167], a[12:15], v[140:143]
  s_waitcnt lgkmcnt(5)
  s_mov_b32 s70, 3211264
  s_add_u32 s78, s24, 14336
  s_add_u32 m0, s45, 65536
  v_add_f32 v22, v22, v30
  v_mfma_f32_16x16x32_bf16 v[156:159], a[172:175], a[12:15], v[156:159]
  ds_read_b64_tr_b16 a[162:163], v3 offset:59392
  v_add_f32 v23, v23, v31
  v_mfma_f32_16x16x32_bf16 v[156:159], a[168:171], a[28:31], v[156:159]
  buffer_load_dwordx4 v11, s[28:31], s70 offen lds
  v_permlane32_swap_b32 v16, v20
  v_mfma_f32_16x16x32_bf16 v[152:155], a[168:171], a[24:27], v[152:155]
  ds_read_b64_tr_b16 a[164:165], v3 offset:61440
  v_mfma_f32_16x16x32_bf16 v[152:155], a[172:175], a[8:11], v[152:155]
  v_permlane32_swap_b32 v17, v21
  v_mfma_f32_16x16x32_bf16 v[148:151], a[172:175], a[4:7], v[148:151]
  ds_read_b64_tr_b16 a[166:167], v3 offset:63488
  v_mfma_f32_16x16x32_bf16 v[148:151], a[168:171], a[20:23], v[148:151]
  s_add_u32 m0, s45, 73728
  v_permlane32_swap_b32 v18, v22
  v_mfma_f32_16x16x32_bf16 v[144:147], a[168:171], a[16:19], v[144:147]
  ds_read_b64_tr_b16 a[168:169], v4 offset:49152
  v_mfma_f32_16x16x32_bf16 v[144:147], a[172:175], a[0:3], v[144:147]
  s_waitcnt lgkmcnt(5)
  buffer_load_dwordx4 v11, s[32:35], s70 offen lds
  v_mfma_f32_16x16x32_bf16 v[160:163], a[180:183], a[0:3], v[160:163]
  ds_read_b64_tr_b16 a[170:171], v4 offset:51200
  v_mfma_f32_16x16x32_bf16 v[160:163], a[176:179], a[16:19], v[160:163]
  s_add_u32 m0, s45, 69632
  s_add_u32 s60, s70, 229376
  v_mfma_f32_16x16x32_bf16 v[164:167], a[176:179], a[20:23], v[164:167]
  ds_read_b64_tr_b16 a[172:173], v4 offset:53248
  v_permlane32_swap_b32 v19, v23
  v_mfma_f32_16x16x32_bf16 v[164:167], a[180:183], a[4:7], v[164:167]
  buffer_load_dwordx4 v11, s[28:31], s60 offen lds
  v_add_f32 v16, v16, v20
  v_add_f32 v17, v17, v21
  v_mfma_f32_16x16x32_bf16 v[168:171], a[180:183], a[8:11], v[168:171]
  ds_read_b64_tr_b16 a[174:175], v4 offset:55296
  v_add_f32 v18, v18, v22
  v_mfma_f32_16x16x32_bf16 v[168:171], a[176:179], a[24:27], v[168:171]
  v_add_f32 v19, v19, v23
  v_mfma_f32_16x16x32_bf16 v[172:175], a[176:179], a[28:31], v[172:175]
  ds_read_b64_tr_b16 a[176:177], v4 offset:57344
  v_mfma_f32_16x16x32_bf16 v[172:175], a[180:183], a[12:15], v[172:175]
  s_waitcnt lgkmcnt(5)
  s_add_u32 m0, s45, 77824
  s_add_u32 s60, s70, 229376
  v_mfma_f32_16x16x32_bf16 v[188:191], a[160:163], a[12:15], v[188:191]
  ds_read_b64_tr_b16 a[178:179], v4 offset:59392
  v_mfma_f32_16x16x32_bf16 v[188:191], a[164:167], a[28:31], v[188:191]
  buffer_load_dwordx4 v11, s[32:35], s60 offen lds
  v_permlane16_swap_b32 v16, v18
  v_mfma_f32_16x16x32_bf16 v[184:187], a[164:167], a[24:27], v[184:187]
  ds_read_b64_tr_b16 a[180:181], v4 offset:61440
  v_mfma_f32_16x16x32_bf16 v[184:187], a[160:163], a[8:11], v[184:187]
  s_add_u32 m0, s45, 0
  v_permlane16_swap_b32 v17, v19
  v_mfma_f32_16x16x32_bf16 v[180:183], a[160:163], a[4:7], v[180:183]
  ds_read_b64_tr_b16 a[182:183], v4 offset:63488
  v_add_f32 v16, v16, v18
  v_mfma_f32_16x16x32_bf16 v[180:183], a[164:167], a[20:23], v[180:183]
  buffer_load_dwordx4 v10, s[28:31], s70 offen lds
  v_add_f32 v17, v17, v19
  v_mul_f32 v16, 0x3a800000, v16
  v_mfma_f32_16x16x32_bf16 v[176:179], a[164:167], a[16:19], v[176:179]
  ds_read_b64_tr_b16 a[164:165], v5 offset:49152
  v_mul_f32 v17, 0x3a800000, v17
  v_mfma_f32_16x16x32_bf16 v[176:179], a[160:163], a[0:3], v[176:179]
  s_waitcnt lgkmcnt(5)
  v_fma_f32 v17, -v16, v16, v17
  v_max_f32 v17, 0, v17
  v_mfma_f32_16x16x32_bf16 v[192:195], a[168:171], a[0:3], v[192:195]
  ds_read_b64_tr_b16 a[166:167], v5 offset:51200
  v_cvt_pk_bf16_f32 v17, v17, v17
  v_mfma_f32_16x16x32_bf16 v[192:195], a[172:175], a[16:19], v[192:195]
  s_add_u32 m0, s45, 8192
  v_lshlrev_b32 v17, 16, v17
  v_add_f32 v17, 0x3727c5ac, v17
  v_mfma_f32_16x16x32_bf16 v[196:199], a[172:175], a[20:23], v[196:199]
  ds_read_b64_tr_b16 a[160:161], v5 offset:53248
  v_cvt_pk_bf16_f32 v17, v17, v17
  v_mfma_f32_16x16x32_bf16 v[196:199], a[168:171], a[4:7], v[196:199]
  buffer_load_dwordx4 v10, s[32:35], s70 offen lds
  v_lshlrev_b32 v17, 16, v17
  v_mfma_f32_16x16x32_bf16 v[200:203], a[168:171], a[8:11], v[200:203]
  ds_read_b64_tr_b16 a[162:163], v5 offset:55296
  v_mfma_f32_16x16x32_bf16 v[200:203], a[172:175], a[24:27], v[200:203]
  s_add_u32 m0, s45, 4096
  s_add_u32 s60, s70, 229376
  v_mfma_f32_16x16x32_bf16 v[204:207], a[172:175], a[28:31], v[204:207]
  ds_read_b64_tr_b16 a[172:173], v5 offset:57344
  v_mfma_f32_16x16x32_bf16 v[204:207], a[168:171], a[12:15], v[204:207]
  s_waitcnt lgkmcnt(5)
  buffer_load_dwordx4 v10, s[28:31], s60 offen lds
  v_mfma_f32_16x16x32_bf16 v[220:223], a[176:179], a[12:15], v[220:223]
  ds_read_b64_tr_b16 a[174:175], v5 offset:59392
  v_sqrt_f32 v17, v17
  v_mfma_f32_16x16x32_bf16 v[220:223], a[180:183], a[28:31], v[220:223]
  v_cvt_pk_bf16_f32 v16, v16, v16
  v_lshlrev_b32 v16, 16, v16
  v_mfma_f32_16x16x32_bf16 v[216:219], a[180:183], a[24:27], v[216:219]
  ds_read_b64_tr_b16 a[168:169], v5 offset:61440
  v_cvt_pk_bf16_f32 v17, v17, v17
  v_mfma_f32_16x16x32_bf16 v[216:219], a[176:179], a[8:11], v[216:219]
  s_add_u32 m0, s45, 12288
  s_add_u32 s60, s70, 229376
  v_lshlrev_b32 v17, 16, v17
  v_mfma_f32_16x16x32_bf16 v[212:215], a[176:179], a[4:7], v[212:215]
  ds_read_b64_tr_b16 a[170:171], v5 offset:63488
  buffer_load_dwordx4 v10, s[32:35], s60 offen lds
  v_mfma_f32_16x16x32_bf16 v[212:215], a[180:183], a[20:23], v[212:215]
  s_waitcnt vmcnt(16)
  s_barrier
  v_mfma_f32_16x16x32_bf16 v[208:211], a[180:183], a[16:19], v[208:211]
  ds_read_b64_tr_b16 a[180:181], v6 offset:16384
  v_sub_f32 v16, 0, v16
  v_mfma_f32_16x16x32_bf16 v[208:211], a[176:179], a[0:3], v[208:211]
  s_waitcnt lgkmcnt(5)
  v_mov_b32 v18, v16
  v_mfma_f32_16x16x32_bf16 v[224:227], a[164:167], a[0:3], v[224:227]
  ds_read_b64_tr_b16 a[182:183], v6 offset:18432
  v_mov_b32 v19, v17
  v_mfma_f32_16x16x32_bf16 v[224:227], a[160:163], a[16:19], v[224:227]
  buffer_load_dwordx4 a[64:67], v1, s[8:11], s78 offen offset:0 sc1
  v_permlane16_swap_b32 v16, v18
  v_mfma_f32_16x16x32_bf16 v[228:231], a[160:163], a[20:23], v[228:231]
  ds_read_b64_tr_b16 a[176:177], v6 offset:20480
  v_mfma_f32_16x16x32_bf16 v[228:231], a[164:167], a[4:7], v[228:231]
  v_permlane16_swap_b32 v17, v19
  v_mfma_f32_16x16x32_bf16 v[232:235], a[164:167], a[8:11], v[232:235]
  ds_read_b64_tr_b16 a[178:179], v6 offset:22528
  v_mov_b32 v20, v16
  v_mfma_f32_16x16x32_bf16 v[232:235], a[160:163], a[24:27], v[232:235]
  v_mov_b32 v21, v17
  v_mov_b32 v22, v18
  v_mfma_f32_16x16x32_bf16 v[236:239], a[160:163], a[28:31], v[236:239]
  ds_read_b64_tr_b16 a[160:161], v6 offset:24576
  v_mov_b32 v23, v19
  v_mfma_f32_16x16x32_bf16 v[236:239], a[164:167], a[12:15], v[236:239]
  s_waitcnt lgkmcnt(5)
  buffer_load_dwordx4 a[80:83], v1, s[8:11], s78 offen offset:1024 sc1
  v_mfma_f32_16x16x32_bf16 v[252:255], a[172:175], a[12:15], v[252:255]
  ds_read_b64_tr_b16 a[162:163], v6 offset:26624
  v_mfma_f32_16x16x32_bf16 v[252:255], a[168:171], a[28:31], v[252:255]
  s_add_u32 s78, s78, 65536
  v_permlane32_swap_b32 v16, v20
  v_mfma_f32_16x16x32_bf16 v[248:251], a[168:171], a[24:27], v[248:251]
  ds_read_b64_tr_b16 a[164:165], v6 offset:28672
  v_mfma_f32_16x16x32_bf16 v[248:251], a[172:175], a[8:11], v[248:251]
  buffer_load_dwordx4 a[68:71], v1, s[8:11], s78 offen offset:0 sc1
  v_permlane32_swap_b32 v17, v21
  v_mfma_f32_16x16x32_bf16 v[244:247], a[172:175], a[4:7], v[244:247]
  ds_read_b64_tr_b16 a[166:167], v6 offset:30720
  v_mfma_f32_16x16x32_bf16 v[244:247], a[168:171], a[20:23], v[244:247]
  v_permlane32_swap_b32 v18, v22
  v_mfma_f32_16x16x32_bf16 v[240:243], a[168:171], a[16:19], v[240:243]
  ds_read_b64_tr_b16 a[168:169], v7 offset:16384
HOP10:
  s_cbranch_execz HOP14
  v_mfma_f32_16x16x32_bf16 v[240:243], a[172:175], a[0:3], v[240:243]
  s_waitcnt vmcnt(11) lgkmcnt(5)
  v_permlane32_swap_b32 v19, v23
  v_mfma_f32_16x16x32_bf16 v[64:67], a[180:183], a[32:35], v[64:67]
  ds_read_b64_tr_b16 a[170:171], v7 offset:18432
  v_lshrrev_b32 v12, 8, v1
  v_mfma_f32_16x16x32_bf16 v[64:67], a[176:179], a[48:51], v[64:67]
  buffer_load_dwordx4 a[84:87], v1, s[8:11], s78 offen offset:1024 sc1
  v_lshlrev_b32 v12, 4, v12
  v_add_u32 v12, 131072, v12
  v_mfma_f32_16x16x32_bf16 v[68:71], a[176:179], a[52:55], v[68:71]
  ds_read_b64_tr_b16 a[172:173], v7 offset:20480
  v_mfma_f32_16x16x32_bf16 v[68:71], a[180:183], a[36:39], v[68:71]
  s_add_u32 s78, s78, 65536
  v_mfma_f32_16x16x32_bf16 v[72:75], a[180:183], a[40:43], v[72:75]
  ds_read_b64_tr_b16 a[174:175], v7 offset:22528
  v_mfma_f32_16x16x32_bf16 v[72:75], a[176:179], a[56:59], v[72:75]
  buffer_load_dwordx4 a[72:75], v1, s[8:11], s78 offen offset:0 sc1
  v_mfma_f32_16x16x32_bf16 v[76:79], a[176:179], a[60:63], v[76:79]
  ds_read_b64_tr_b16 a[176:177], v7 offset:24576
  v_mfma_f32_16x16x32_bf16 v[76:79], a[180:183], a[44:47], v[76:79]
  s_waitcnt lgkmcnt(5)
  v_mfma_f32_16x16x32_bf16 v[92:95], a[160:163], a[44:47], v[92:95]
  ds_read_b64_tr_b16 a[178:179], v7 offset:26624
  v_mfma_f32_16x16x32_bf16 v[92:95], a[164:167], a[60:63], v[92:95]
  v_mfma_f32_16x16x32_bf16 v[88:91], a[164:167], a[56:59], v[88:91]
  ds_read_b64_tr_b16 a[180:181], v7 offset:28672
  v_mfma_f32_16x16x32_bf16 v[88:91], a[160:163], a[40:43], v[88:91]
  buffer_load_dwordx4 a[88:91], v1, s[8:11], s78 offen offset:1024 sc1
  v_mfma_f32_16x16x32_bf16 v[84:87], a[160:163], a[36:39], v[84:87]
  ds_read_b64_tr_b16 a[182:183], v7 offset:30720
  v_mfma_f32_16x16x32_bf16 v[84:87], a[164:167], a[52:55], v[84:87]
  s_lshl_b32 s82, s44, 28
  buffer_load_dword v9, v13, s[8:11], s82 offen sc1
  v_mfma_f32_16x16x32_bf16 v[80:83], a[164:167], a[48:51], v[80:83]
  ds_read_b64_tr_b16 a[164:165], v8 offset:16384
  s_add_u32 s78, s78, 65536
  v_mfma_f32_16x16x32_bf16 v[80:83], a[160:163], a[32:35], v[80:83]
  s_waitcnt lgkmcnt(5)
  buffer_load_dwordx4 a[76:79], v1, s[8:11], s78 offen offset:0 sc1
  v_mfma_f32_16x16x32_bf16 v[96:99], a[168:171], a[32:35], v[96:99]
  ds_read_b64_tr_b16 a[166:167], v8 offset:18432
  v_mfma_f32_16x16x32_bf16 v[96:99], a[172:175], a[48:51], v[96:99]
  v_mfma_f32_16x16x32_bf16 v[100:103], a[172:175], a[52:55], v[100:103]
  ds_read_b64_tr_b16 a[160:161], v8 offset:20480
  v_mfma_f32_16x16x32_bf16 v[100:103], a[168:171], a[36:39], v[100:103]
  v_mfma_f32_16x16x32_bf16 v[104:107], a[168:171], a[40:43], v[104:107]
  ds_read_b64_tr_b16 a[162:163], v8 offset:22528
  v_mfma_f32_16x16x32_bf16 v[104:107], a[172:175], a[56:59], v[104:107]
  buffer_load_dwordx4 a[92:95], v1, s[8:11], s78 offen offset:1024 sc1
  v_mfma_f32_16x16x32_bf16 v[108:111], a[172:175], a[60:63], v[108:111]
  ds_read_b64_tr_b16 a[172:173], v8 offset:24576
  v_mfma_f32_16x16x32_bf16 v[108:111], a[168:171], a[44:47], v[108:111]
  s_waitcnt lgkmcnt(5)
  s_mov_b32 s63, 3670016
  s_add_u32 s71, s24, 16384
  s_add_u32 m0, s45, 98304
  v_mfma_f32_16x16x32_bf16 v[124:127], a[176:179], a[44:47], v[124:127]
  ds_read_b64_tr_b16 a[174:175], v8 offset:26624
  v_mfma_f32_16x16x32_bf16 v[124:127], a[180:183], a[60:63], v[124:127]
  buffer_load_dwordx4 v11, s[28:31], s63 offen lds
  v_mfma_f32_16x16x32_bf16 v[120:123], a[180:183], a[56:59], v[120:123]
  ds_read_b64_tr_b16 a[168:169], v8 offset:28672
  v_mfma_f32_16x16x32_bf16 v[120:123], a[176:179], a[40:43], v[120:123]
  v_mfma_f32_16x16x32_bf16 v[116:119], a[176:179], a[36:39], v[116:119]
  ds_read_b64_tr_b16 a[170:171], v8 offset:30720
  v_mfma_f32_16x16x32_bf16 v[116:119], a[180:183], a[52:55], v[116:119]
  s_add_u32 m0, s45, 106496
  v_mfma_f32_16x16x32_bf16 v[112:115], a[180:183], a[48:51], v[112:115]
  ds_read_b64_tr_b16 a[180:181], v2 offset:16384
  v_mfma_f32_16x16x32_bf16 v[112:115], a[176:179], a[32:35], v[112:115]
  s_waitcnt lgkmcnt(5)
  buffer_load_dwordx4 v11, s[32:35], s63 offen lds
  v_mfma_f32_16x16x32_bf16 v[32:35], a[164:167], a[32:35], v[32:35]
  ds_read_b64_tr_b16 a[182:183], v2 offset:18432
  v_mfma_f32_16x16x32_bf16 v[32:35], a[160:163], a[48:51], v[32:35]
  s_add_u32 m0, s45, 102400
  s_add_u32 s60, s63, 229376
  v_mfma_f32_16x16x32_bf16 v[36:39], a[160:163], a[52:55], v[36:39]
  ds_read_b64_tr_b16 a[176:177], v2 offset:20480
  v_mfma_f32_16x16x32_bf16 v[36:39], a[164:167], a[36:39], v[36:39]
  buffer_load_dwordx4 v11, s[28:31], s60 offen lds
  v_mfma_f32_16x16x32_bf16 v[40:43], a[164:167], a[40:43], v[40:43]
  ds_read_b64_tr_b16 a[178:179], v2 offset:22528
  v_mfma_f32_16x16x32_bf16 v[40:43], a[160:163], a[56:59], v[40:43]
  v_mfma_f32_16x16x32_bf16 v[44:47], a[160:163], a[60:63], v[44:47]
  ds_read_b64_tr_b16 a[160:161], v2 offset:24576
  v_mfma_f32_16x16x32_bf16 v[44:47], a[164:167], a[44:47], v[44:47]
  s_waitcnt lgkmcnt(5)
  s_add_u32 m0, s45, 110592
  s_add_u32 s60, s63, 229376
  v_mfma_f32_16x16x32_bf16 v[60:63], a[172:175], a[44:47], v[60:63]
  ds_read_b64_tr_b16 a[162:163], v2 offset:26624
  v_mfma_f32_16x16x32_bf16 v[60:63], a[168:171], a[60:63], v[60:63]
  buffer_load_dwordx4 v11, s[32:35], s60 offen lds
  v_mfma_f32_16x16x32_bf16 v[56:59], a[168:171], a[56:59], v[56:59]
  ds_read_b64_tr_b16 a[164:165], v2 offset:28672
  v_mfma_f32_16x16x32_bf16 v[56:59], a[172:175], a[40:43], v[56:59]
  s_add_u32 m0, s45, 32768
  v_mfma_f32_16x16x32_bf16 v[52:55], a[172:175], a[36:39], v[52:55]
  ds_read_b64_tr_b16 a[166:167], v2 offset:30720
  v_mfma_f32_16x16x32_bf16 v[52:55], a[168:171], a[52:55], v[52:55]
  buffer_load_dwordx4 v10, s[28:31], s63 offen lds
  v_mfma_f32_16x16x32_bf16 v[48:51], a[168:171], a[48:51], v[48:51]
  ds_read_b64_tr_b16 a[168:169], v3 offset:16384
  v_mfma_f32_16x16x32_bf16 v[48:51], a[172:175], a[32:35], v[48:51]
  s_waitcnt lgkmcnt(5)
  v_mfma_f32_16x16x32_bf16 v[128:131], a[180:183], a[32:35], v[128:131]
  ds_read_b64_tr_b16 a[170:171], v3 offset:18432
  v_mfma_f32_16x16x32_bf16 v[128:131], a[176:179], a[48:51], v[128:131]
  s_add_u32 m0, s45, 40960
  v_mfma_f32_16x16x32_bf16 v[132:135], a[176:179], a[52:55], v[132:135]
  ds_read_b64_tr_b16 a[172:173], v3 offset:20480
  v_mfma_f32_16x16x32_bf16 v[132:135], a[180:183], a[36:39], v[132:135]
  buffer_load_dwordx4 v10, s[32:35], s63 offen lds
  v_mfma_f32_16x16x32_bf16 v[136:139], a[180:183], a[40:43], v[136:139]
  ds_read_b64_tr_b16 a[174:175], v3 offset:22528
  v_mfma_f32_16x16x32_bf16 v[136:139], a[176:179], a[56:59], v[136:139]
  s_waitcnt vmcnt(8)
  s_cmp_lg_u32 s44, 0
  s_cbranch_scc1 PL11_adaLN_cond__sliding_local_dilated__swiglu_ffn__prompt_kernelx
  v_cmp_ne_u32 vcc, s46, v9
  s_nop 4
  s_cbranch_vccz PL11_adaLN_cond__sliding_local_dilated__swiglu_ffn__prompt_kernelx
  s_mov_b32 s82, 60000
PL11_adaLN_cond__sliding_local_dilated__swiglu_ffn__prompt_kernel:
  buffer_load_dword v9, v13, s[8:11], 0 offen sc1
  s_sub_u32 s82, s82, 1
  s_cmp_eq_u32 s82, 0
  s_waitcnt vmcnt(0)
  s_cbranch_scc1 PL11_adaLN_cond__sliding_local_dilated__swiglu_ffn__prompt_kernelx
  v_cmp_ne_u32 vcc, s46, v9
  s_nop 4
  s_cbranch_vccnz PL11_adaLN_cond__sliding_local_dilated__swiglu_ffn__prompt_kernel
PL11_adaLN_cond__sliding_local_dilated__swiglu_ffn__prompt_kernelx:
  s_barrier
  v_mfma_f32_16x16x32_bf16 v[140:143], a[176:179], a[60:63], v[140:143]
  ds_read_b64_tr_b16 a[176:177], v3 offset:24576
  s_add_u32 m0, s45, 36864
  s_add_u32 s60, s63, 229376
  v_mfma_f32_16x16x32_bf16 v[140:143], a[180:183], a[44:47], v[140:143]
  s_waitcnt lgkmcnt(5)
  buffer_load_dwordx4 v10, s[28:31], s60 offen lds
  v_mfma_f32_16x16x32_bf16 v[156:159], a[160:163], a[44:47], v[156:159]
  ds_read_b64_tr_b16 a[178:179], v3 offset:26624
  v_mfma_f32_16x16x32_bf16 v[156:159], a[164:167], a[60:63], v[156:159]
  v_mfma_f32_16x16x32_bf16 v[152:155], a[164:167], a[56:59], v[152:155]
  ds_read_b64_tr_b16 a[180:181], v3 offset:28672
  v_mfma_f32_16x16x32_bf16 v[152:155], a[160:163], a[40:43], v[152:155]
  s_add_u32 m0, s45, 45056
  s_add_u32 s60, s63, 229376
  v_mfma_f32_16x16x32_bf16 v[148:151], a[160:163], a[36:39], v[148:151]
  ds_read_b64_tr_b16 a[182:183], v3 offset:30720
  v_mfma_f32_16x16x32_bf16 v[148:151], a[164:167], a[52:55], v[148:151]
  buffer_load_dwordx4 v10, s[32:35], s60 offen lds
  v_mfma_f32_16x16x32_bf16 v[144:147], a[164:167], a[48:51], v[144:147]
  ds_read_b64_tr_b16 a[164:165], v4 offset:16384
  v_mfma_f32_16x16x32_bf16 v[144:147], a[160:163], a[32:35], v[144:147]
  s_waitcnt lgkmcnt(5)
  s_mov_b32 s61, 0
  v_mfma_f32_16x16x32_bf16 v[160:163], a[168:171], a[32:35], v[160:163]
  ds_read_b64_tr_b16 a[166:167], v4 offset:18432
  v_mfma_f32_16x16x32_bf16 v[160:163], a[172:175], a[48:51], v[160:163]
  buffer_load_dwordx4 a[220:223], v14, s[8:11], s61 offen sc1
  v_mfma_f32_16x16x32_bf16 v[164:167], a[172:175], a[52:55], v[164:167]
  ds_read_b64_tr_b16 a[160:161], v4 offset:20480
  v_mfma_f32_16x16x32_bf16 v[164:167], a[168:171], a[36:39], v[164:167]
  s_mov_b32 s61, 114688
  v_mfma_f32_16x16x32_bf16 v[168:171], a[168:171], a[40:43], v[168:171]
  ds_read_b64_tr_b16 a[162:163], v4 offset:22528
  buffer_load_dwordx4 a[224:227], v14, s[8:11], s61 offen sc1
  v_mfma_f32_16x16x32_bf16 v[168:171], a[172:175], a[56:59], v[168:171]
  s_mov_b32 s61, 229376
  v_mfma_f32_16x16x32_bf16 v[172:175], a[172:175], a[60:63], v[172:175]
  ds_read_b64_tr_b16 a[172:173], v4 offset:24576
  buffer_load_dwordx4 a[228:231], v14, s[8:11], s61 offen sc1
  v_mfma_f32_16x16x32_bf16 v[172:175], a[168:171], a[44:47], v[172:175]
  s_waitcnt lgkmcnt(5)
  s_mov_b32 s61, 344064
  v_mfma_f32_16x16x32_bf16 v[188:191], a[176:179], a[44:47], v[188:191]
  ds_read_b64_tr_b16 a[174:175], v4 offset:26624
  v_mfma_f32_16x16x32_bf16 v[188:191], a[180:183], a[60:63], v[188:191]
  buffer_load_dwordx4 a[232:235], v14, s[8:11], s61 offen sc1
  s_mov_b32 s61, 458752
  v_mfma_f32_16x16x32_bf16 v[184:187], a[180:183], a[56:59], v[184:187]
  ds_read_b64_tr_b16 a[168:169], v4 offset:28672
  v_mfma_f32_16x16x32_bf16 v[184:187], a[176:179], a[40:43], v[184:187]
  buffer_load_dwordx4 a[236:239], v14, s[8:11], s61 offen sc1
  v_mfma_f32_16x16x32_bf16 v[180:183], a[176:179], a[36:39], v[180:183]
  ds_read_b64_tr_b16 a[170:171], v4 offset:30720
  v_mfma_f32_16x16x32_bf16 v[180:183], a[180:183], a[52:55], v[180:183]
  s_mov_b32 s61, 573440
  v_mfma_f32_16x16x32_bf16 v[176:179], a[180:183], a[48:51], v[176:179]
  ds_read_b64_tr_b16 a[180:181], v5 offset:16384
  buffer_load_dwordx4 a[240:243], v14, s[8:11], s61 offen sc1
  v_mfma_f32_16x16x32_bf16 v[176:179], a[176:179], a[32:35], v[176:179]
  s_waitcnt lgkmcnt(5)
  s_mov_b32 s61, 688128
  v_mfma_f32_16x16x32_bf16 v[192:195], a[164:167], a[32:35], v[192:195]
  ds_read_b64_tr_b16 a[182:183], v5 offset:18432
  buffer_load_dwordx4 a[244:247], v14, s[8:11], s61 offen sc1
  v_mfma_f32_16x16x32_bf16 v[192:195], a[160:163], a[48:51], v[192:195]
  s_mov_b32 s61, 802816
  v_mfma_f32_16x16x32_bf16 v[196:199], a[160:163], a[52:55], v[196:199]
  ds_read_b64_tr_b16 a[176:177], v5 offset:20480
  v_mfma_f32_16x16x32_bf16 v[196:199], a[164:167], a[36:39], v[196:199]
  buffer_load_dwordx4 a[248:251], v14, s[8:11], s61 offen sc1
  v_mfma_f32_16x16x32_bf16 v[200:203], a[164:167], a[40:43], v[200:203]
  ds_read_b64_tr_b16 a[178:179], v5 offset:22528
  v_mfma_f32_16x16x32_bf16 v[200:203], a[160:163], a[56:59], v[200:203]
  buffer_load_dwordx4 a[96:99], v1, s[8:11], s71 offen offset:0 sc1
  v_mfma_f32_16x16x32_bf16 v[204:207], a[160:163], a[60:63], v[204:207]
  ds_read_b64_tr_b16 a[160:161], v5 offset:24576
  v_mfma_f32_16x16x32_bf16 v[204:207], a[164:167], a[44:47], v[204:207]
  s_waitcnt lgkmcnt(5)
  v_mfma_f32_16x16x32_bf16 v[220:223], a[172:175], a[44:47], v[220:223]
  ds_read_b64_tr_b16 a[162:163], v5 offset:26624
  v_mfma_f32_16x16x32_bf16 v[220:223], a[168:171], a[60:63], v[220:223]
  v_mfma_f32_16x16x32_bf16 v[216:219], a[168:171], a[56:59], v[216:219]
  ds_read_b64_tr_b16 a[164:165], v5 offset:28672
  v_mfma_f32_16x16x32_bf16 v[216:219], a[172:175], a[40:43], v[216:219]
  buffer_load_dwordx4 a[112:115], v1, s[8:11], s71 offen offset:1024 sc1
  v_mfma_f32_16x16x32_bf16 v[212:215], a[172:175], a[36:39], v[212:215]
  ds_read_b64_tr_b16 a[166:167], v5 offset:30720
  v_mfma_f32_16x16x32_bf16 v[212:215], a[168:171], a[52:55], v[212:215]
  s_waitcnt vmcnt(27)
  s_barrier
  v_mfma_f32_16x16x32_bf16 v[208:211], a[168:171], a[48:51], v[208:211]
  ds_read_b64_tr_b16 a[168:169], v6 offset:0
  s_add_u32 s71, s71, 65536
  v_mfma_f32_16x16x32_bf16 v[208:211], a[172:175], a[32:35], v[208:211]
  s_waitcnt lgkmcnt(5)
  buffer_load_dwordx4 a[100:103], v1, s[8:11], s71 offen offset:0 sc1
  v_mfma_f32_16x16x32_bf16 v[224:227], a[180:183], a[32:35], v[224:227]
  ds_read_b64_tr_b16 a[170:171], v6 offset:2048
  v_mfma_f32_16x16x32_bf16 v[224:227], a[176:179], a[48:51], v[224:227]
  v_mfma_f32_16x16x32_bf16 v[228:231], a[176:179], a[52:55], v[228:231]
  ds_read_b64_tr_b16 a[172:173], v6 offset:4096
  v_mfma_f32_16x16x32_bf16 v[228:231], a[180:183], a[36:39], v[228:231]
  v_mfma_f32_16x16x32_bf16 v[232:235], a[180:183], a[40:43], v[232:235]
  ds_read_b64_tr_b16 a[174:175], v6 offset:6144
  v_mfma_f32_16x16x32_bf16 v[232:235], a[176:179], a[56:59], v[232:235]
  buffer_load_dwordx4 a[116:119], v1, s[8:11], s71 offen offset:1024 sc1
  v_mfma_f32_16x16x32_bf16 v[236:239], a[176:179], a[60:63], v[236:239]
  ds_read_b64_tr_b16 a[176:177], v6 offset:8192
  v_mfma_f32_16x16x32_bf16 v[236:239], a[180:183], a[44:47], v[236:239]
  s_waitcnt lgkmcnt(5)
  s_add_u32 s71, s71, 65536
  v_mfma_f32_16x16x32_bf16 v[252:255], a[160:163], a[44:47], v[252:255]
  ds_read_b64_tr_b16 a[178:179], v6 offset:10240
  v_mfma_f32_16x16x32_bf16 v[252:255], a[164:167], a[60:63], v[252:255]
  buffer_load_dwordx4 a[104:107], v1, s[8:11], s71 offen offset:0 sc1
  v_mfma_f32_16x16x32_bf16 v[248:251], a[164:167], a[56:59], v[248:251]
  ds_read_b64_tr_b16 a[180:181], v6 offset:12288
  v_mfma_f32_16x16x32_bf16 v[248:251], a[160:163], a[40:43], v[248:251]
  v_mfma_f32_16x16x32_bf16 v[244:247], a[160:163], a[36:39], v[244:247]
  ds_read_b64_tr_b16 a[182:183], v6 offset:14336
  v_mfma_f32_16x16x32_bf16 v[244:247], a[164:167], a[52:55], v[244:247]
  v_mfma_f32_16x16x32_bf16 v[240:243], a[164:167], a[48:51], v[240:243]
  ds_read_b64_tr_b16 a[164:165], v7 offset:0
  v_mfma_f32_16x16x32_bf16 v[240:243], a[160:163], a[32:35], v[240:243]
  s_waitcnt vmcnt(21) lgkmcnt(5)
  buffer_load_dwordx4 a[120:123], v1, s[8:11], s71 offen offset:1024 sc1
  v_mfma_f32_16x16x32_bf16 v[64:67], a[168:171], a[64:67], v[64:67]
  ds_read_b64_tr_b16 a[166:167], v7 offset:2048
  v_mfma_f32_16x16x32_bf16 v[64:67], a[172:175], a[80:83], v[64:67]
  s_add_u32 s71, s71, 65536
  v_mfma_f32_16x16x32_bf16 v[68:71], a[172:175], a[84:87], v[68:71]
  ds_read_b64_tr_b16 a[160:161], v7 offset:4096
  v_mfma_f32_16x16x32_bf16 v[68:71], a[168:171], a[68:71], v[68:71]
  buffer_load_dwordx4 a[108:111], v1, s[8:11], s71 offen offset:0 sc1
  v_mfma_f32_16x16x32_bf16 v[72:75], a[168:171], a[72:75], v[72:75]
  ds_read_b64_tr_b16 a[162:163], v7 offset:6144
  v_mfma_f32_16x16x32_bf16 v[72:75], a[172:175], a[88:91], v[72:75]
  v_mfma_f32_16x16x32_bf16 v[76:79], a[172:175], a[92:95], v[76:79]
  ds_read_b64_tr_b16 a[172:173], v7 offset:8192
  s_waitcnt vmcnt(7)
  v_mfma_f32_16x16x32_bf16 v[76:79], a[168:171], a[76:79], v[76:79]
  s_waitcnt lgkmcnt(5)
  v_accvgpr_read_b32 v24, a220
  v_accvgpr_read_b32 v25, a221
  v_accvgpr_read_b32 v26, a222
  v_mfma_f32_16x16x32_bf16 v[92:95], a[176:179], a[76:79], v[92:95]
  ds_read_b64_tr_b16 a[174:175], v7 offset:10240
  v_accvgpr_read_b32 v27, a223
  v_mfma_f32_16x16x32_bf16 v[92:95], a[180:183], a[92:95], v[92:95]
  buffer_load_dwordx4 a[124:127], v1, s[8:11], s71 offen offset:1024 sc1
  v_accvgpr_read_b32 v28, a224
  v_accvgpr_read_b32 v29, a225
  v_mfma_f32_16x16x32_bf16 v[88:91], a[180:183], a[88:91], v[88:91]
  ds_read_b64_tr_b16 a[168:169], v7 offset:12288
  v_accvgpr_read_b32 v30, a226
  v_mfma_f32_16x16x32_bf16 v[88:91], a[176:179], a[72:75], v[88:91]
  s_mov_b32 s64, 4128768
  s_add_u32 s72, s24, 18432
  s_add_u32 m0, s45, 114688
  v_accvgpr_read_b32 v31, a227
  v_add_f32 v24, v24, v28
  v_add_f32 v25, v25, v29
  v_mfma_f32_16x16x32_bf16 v[84:87], a[176:179], a[68:71], v[84:87]
  ds_read_b64_tr_b16 a[170:171], v7 offset:14336
  v_add_f32 v26, v26, v30
  v_mfma_f32_16x16x32_bf16 v[84:87], a[180:183], a[84:87], v[84:87]
  buffer_load_dwordx4 v11, s[28:31], s64 offen lds
  v_add_f32 v27, v27, v31
  v_accvgpr_read_b32 v28, a228
  v_mfma_f32_16x16x32_bf16 v[80:83], a[180:183], a[80:83], v[80:83]
  ds_read_b64_tr_b16 a[180:181], v8 offset:0
  v_accvgpr_read_b32 v29, a229
  v_mfma_f32_16x16x32_bf16 v[80:83], a[176:179], a[64:67], v[80:83]
  s_waitcnt lgkmcnt(5)
  v_accvgpr_read_b32 v30, a230
  v_accvgpr_read_b32 v31, a231
  v_add_f32 v24, v24, v28
  v_mfma_f32_16x16x32_bf16 v[96:99], a[164:167], a[64:67], v[96:99]
  ds_read_b64_tr_b16 a[182:183], v8 offset:2048
  v_add_f32 v25, v25, v29
  v_mfma_f32_16x16x32_bf16 v[96:99], a[160:163], a[80:83], v[96:99]
  s_add_u32 m0, s45, 122880
  v_add_f32 v26, v26, v30
  v_add_f32 v27, v27, v31
  v_mfma_f32_16x16x32_bf16 v[100:103], a[160:163], a[84:87], v[100:103]
  ds_read_b64_tr_b16 a[176:177], v8 offset:4096
  v_accvgpr_read_b32 v28, a232
  v_mfma_f32_16x16x32_bf16 v[100:103], a[164:167], a[68:71], v[100:103]
  buffer_load_dwordx4 v11, s[32:35], s64 offen lds
  v_accvgpr_read_b32 v29, a233
  v_accvgpr_read_b32 v30, a234
  v_accvgpr_read_b32 v31, a235
  v_mfma_f32_16x16x32_bf16 v[104:107], a[164:167], a[72:75], v[104:107]
  ds_read_b64_tr_b16 a[178:179], v8 offset:6144
  v_add_f32 v24, v24, v28
  v_mfma_f32_16x16x32_bf16 v[104:107], a[160:163], a[88:91], v[104:107]
  s_add_u32 m0, s45, 118784
  s_add_u32 s60, s64, 229376
  v_add_f32 v25, v25, v29
  v_mfma_f32_16x16x32_bf16 v[108:111], a[160:163], a[92:95], v[108:111]
  ds_read_b64_tr_b16 a[160:161], v8 offset:8192
  v_add_f32 v26, v26, v30
  v_mfma_f32_16x16x32_bf16 v[108:111], a[164:167], a[76:79], v[108:111]
  s_waitcnt lgkmcnt(5)
  buffer_load_dwordx4 v11, s[28:31], s60 offen lds
  v_add_f32 v27, v27, v31
  v_accvgpr_read_b32 v28, a236
  v_mfma_f32_16x16x32_bf16 v[124:127], a[172:175], a[76:79], v[124:127]
  ds_read_b64_tr_b16 a[162:163], v8 offset:10240
  v_accvgpr_read_b32 v29, a237
  v_mfma_f32_16x16x32_bf16 v[124:127], a[168:171], a[92:95], v[124:127]
  v_accvgpr_read_b32 v30, a238
  v_accvgpr_read_b32 v31, a239
  v_mfma_f32_16x16x32_bf16 v[120:123], a[168:171], a[88:91], v[120:123]
  ds_read_b64_tr_b16 a[164:165], v8 offset:12288
  v_add_f32 v24, v24, v28
  v_mfma_f32_16x16x32_bf16 v[120:123], a[172:175], a[72:75], v[120:123]
  s_add_u32 m0, s45, 126976
  s_add_u32 s60, s64, 229376
  v_add_f32 v25, v25, v29
  v_add_f32 v26, v26, v30
  v_mfma_f32_16x16x32_bf16 v[116:119], a[172:175], a[68:71], v[116:119]
  ds_read_b64_tr_b16 a[166:167], v8 offset:14336
  v_add_f32 v27, v27, v31
  v_mfma_f32_16x16x32_bf16 v[116:119], a[168:171], a[84:87], v[116:119]
  buffer_load_dwordx4 v11, s[32:35], s60 offen lds
  v_accvgpr_read_b32 v28, a240
  v_accvgpr_read_b32 v29, a241
  v_mfma_f32_16x16x32_bf16 v[112:115], a[168:171], a[80:83], v[112:115]
  ds_read_b64_tr_b16 a[168:169], v2 offset:0
  v_accvgpr_read_b32 v30, a242
  v_mfma_f32_16x16x32_bf16 v[112:115], a[172:175], a[64:67], v[112:115]
  s_waitcnt lgkmcnt(5)
  s_add_u32 m0, s45, 49152
  v_accvgpr_read_b32 v31, a243
  v_add_f32 v24, v24, v28
  v_mfma_f32_16x16x32_bf16 v[32:35], a[180:183], a[64:67], v[32:35]
  ds_read_b64_tr_b16 a[170:171], v2 offset:2048
  v_add_f32 v25, v25, v29
  v_mfma_f32_16x16x32_bf16 v[32:35], a[176:179], a[80:83], v[32:35]
  buffer_load_dwordx4 v10, s[28:31], s64 offen lds
  v_add_f32 v26, v26, v30
  v_add_f32 v27, v27, v31
  v_mfma_f32_16x16x32_bf16 v[36:39], a[176:179], a[84:87], v[36:39]
  ds_read_b64_tr_b16 a[172:173], v2 offset:4096
  v_accvgpr_read_b32 v28, a244
  v_mfma_f32_16x16x32_bf16 v[36:39], a[180:183], a[68:71], v[36:39]
  v_accvgpr_read_b32 v29, a245
  v_accvgpr_read_b32 v30, a246
  v_accvgpr_read_b32 v31, a247
  v_mfma_f32_16x16x32_bf16 v[40:43], a[180:183], a[72:75], v[40:43]
  ds_read_b64_tr_b16 a[174:175], v2 offset:6144
  v_add_f32 v24, v24, v28
  v_mfma_f32_16x16x32_bf16 v[40:43], a[176:179], a[88:91], v[40:43]
  s_add_u32 m0, s45, 57344
  v_add_f32 v25, v25, v29
  v_add_f32 v26, v26, v30
  v_mfma_f32_16x16x32_bf16 v[44:47], a[176:179], a[92:95], v[44:47]
  ds_read_b64_tr_b16 a[176:177], v2 offset:8192
  v_add_f32 v27, v27, v31
  v_mfma_f32_16x16x32_bf16 v[44:47], a[180:183], a[76:79], v[44:47]
  s_waitcnt lgkmcnt(5)
  buffer_load_dwordx4 v10, s[32:35], s64 offen lds
  v_accvgpr_read_b32 v28, a248
  v_accvgpr_read_b32 v29, a249
  v_mfma_f32_16x16x32_bf16 v[60:63], a[160:163], a[76:79], v[60:63]
  ds_read_b64_tr_b16 a[178:179], v2 offset:10240
  v_accvgpr_read_b32 v30, a250
  v_mfma_f32_16x16x32_bf16 v[60:63], a[164:167], a[92:95], v[60:63]
  s_add_u32 m0, s45, 53248
  s_add_u32 s60, s64, 229376
  v_accvgpr_read_b32 v31, a251
  v_mfma_f32_16x16x32_bf16 v[56:59], a[164:167], a[88:91], v[56:59]
  ds_read_b64_tr_b16 a[180:181], v2 offset:12288
  v_add_f32 v24, v24, v28
  v_mfma_f32_16x16x32_bf16 v[56:59], a[160:163], a[72:75], v[56:59]
  buffer_load_dwordx4 v10, s[28:31], s60 offen lds
  v_add_f32 v25, v25, v29
  v_add_f32 v26, v26, v30
  v_add_f32 v27, v27, v31
  v_mfma_f32_16x16x32_bf16 v[52:55], a[160:163], a[68:71], v[52:55]
  ds_read_b64_tr_b16 a[182:183], v2 offset:14336
  v_mov_b32 v28, v24
  v_mfma_f32_16x16x32_bf16 v[52:55], a[164:167], a[84:87], v[52:55]
  v_mov_b32 v29, v25
  v_mov_b32 v30, v26
  v_mfma_f32_16x16x32_bf16 v[48:51], a[164:167], a[80:83], v[48:51]
  ds_read_b64_tr_b16 a[164:165], v3 offset:0
  v_mov_b32 v31, v27
  v_mfma_f32_16x16x32_bf16 v[48:51], a[160:163], a[64:67], v[48:51]
  s_waitcnt lgkmcnt(5)
  s_add_u32 m0, s45, 61440
  s_add_u32 s60, s64, 229376
  v_mfma_f32_16x16x32_bf16 v[128:131], a[168:171], a[64:67], v[128:131]
  ds_read_b64_tr_b16 a[166:167], v3 offset:2048
  v_mfma_f32_16x16x32_bf16 v[128:131], a[172:175], a[80:83], v[128:131]
  buffer_load_dwordx4 v10, s[32:35], s60 offen lds
  v_permlane32_swap_b32 v24, v28
  v_mfma_f32_16x16x32_bf16 v[132:135], a[172:175], a[84:87], v[132:135]
  ds_read_b64_tr_b16 a[160:161], v3 offset:4096
  v_mfma_f32_16x16x32_bf16 v[132:135], a[168:171], a[68:71], v[132:135]
  v_permlane32_swap_b32 v25, v29
  v_mfma_f32_16x16x32_bf16 v[136:139], a[168:171], a[72:75], v[136:139]
  ds_read_b64_tr_b16 a[162:163], v3 offset:6144
  v_mfma_f32_16x16x32_bf16 v[136:139], a[172:175], a[88:91], v[136:139]
  buffer_load_dwordx4 a[128:131], v1, s[8:11], s72 offen offset:0 sc1
  v_permlane32_swap_b32 v26, v30
  v_mfma_f32_16x16x32_bf16 v[140:143], a[172:175], a[92:95], v[140:143]
  ds_read_b64_tr_b16 a[172:173], v3 offset:8192
  v_mfma_f32_16x16x32_bf16 v[140:143], a[168:171], a[76:79], v[140:143]
  s_waitcnt lgkmcnt(5)
  v_permlane32_swap_b32 v27, v31
  v_add_f32 v24, v24, v28
  v_mfma_f32_16x16x32_bf16 v[156:159], a[176:179], a[76:79], v[156:159]
  ds_read_b64_tr_b16 a[174:175], v3 offset:10240
  v_add_f32 v25, v25, v29
  v_mfma_f32_16x16x32_bf16 v[156:159], a[180:183], a[92:95], v[156:159]
  v_add_f32 v26, v26, v30
  v_add_f32 v27, v27, v31
  v_mfma_f32_16x16x32_bf16 v[152:155], a[180:183], a[88:91], v[152:155]
  ds_read_b64_tr_b16 a[168:169], v3 offset:12288
  v_mfma_f32_16x16x32_bf16 v[152:155], a[176:179], a[72:75], v[152:155]
  buffer_load_dwordx4 a[144:147], v1, s[8:11], s72 offen offset:1024 sc1
  s_cmp_eq_u32 s44, 1
  s_cselect_b32 s55, 0xbfb8aa3b, 1.0
  v_mul_f32 v24, s55, v24
  v_mfma_f32_16x16x32_bf16 v[148:151], a[176:179], a[68:71], v[148:151]
  ds_read_b64_tr_b16 a[170:171], v3 offset:14336
  v_lshrrev_b32 v13, 8, v1
  v_lshlrev_b32 v13, 28, v13
  v_mfma_f32_16x16x32_bf16 v[148:151], a[180:183], a[84:87], v[148:151]
  v_lshl_add_u32 v13, v1, 3, v13
  v_xor_b32 v9, 96, v6
  v_mfma_f32_16x16x32_bf16 v[144:147], a[180:183], a[80:83], v[144:147]
  ds_read_b64_tr_b16 a[180:181], v4 offset:0
  s_add_u32 s72, s72, 65536
  v_mfma_f32_16x16x32_bf16 v[144:147], a[176:179], a[64:67], v[144:147]
  s_waitcnt lgkmcnt(5)
  buffer_load_dwordx4 a[132:135], v1, s[8:11], s72 offen offset:0 sc1
  v_mul_f32 v25, s55, v25
  v_mul_f32 v26, s55, v26
  v_mfma_f32_16x16x32_bf16 v[160:163], a[164:167], a[64:67], v[160:163]
  ds_read_b64_tr_b16 a[182:183], v4 offset:2048
  v_mul_f32 v27, s55, v27
  v_mfma_f32_16x16x32_bf16 v[160:163], a[160:163], a[80:83], v[160:163]
  ds_write_b128 v15, v[24:27]
  v_mfma_f32_16x16x32_bf16 v[164:167], a[160:163], a[84:87], v[164:167]
  ds_read_b64_tr_b16 a[176:177], v4 offset:4096
  v_mfma_f32_16x16x32_bf16 v[164:167], a[164:167], a[68:71], v[164:167]
  v_mfma_f32_16x16x32_bf16 v[168:171], a[164:167], a[72:75], v[168:171]
  ds_read_b64_tr_b16 a[178:179], v4 offset:6144
  s_waitcnt lgkmcnt(2)
  s_barrier
  v_mfma_f32_16x16x32_bf16 v[168:171], a[160:163], a[88:91], v[168:171]
  buffer_load_dwordx4 a[148:151], v1, s[8:11], s72 offen offset:1024 sc1
  ds_read_b128 v[24:27], v12 offset:384
  v_mfma_f32_16x16x32_bf16 v[172:175], a[160:163], a[92:95], v[172:175]
  ds_read_b64_tr_b16 a[160:161], v4 offset:8192
  v_mfma_f32_16x16x32_bf16 v[172:175], a[164:167], a[76:79], v[172:175]
  s_waitcnt lgkmcnt(7)
  s_add_u32 s72, s72, 65536
  v_mfma_f32_16x16x32_bf16 v[188:191], a[172:175], a[76:79], v[188:191]
  ds_read_b64_tr_b16 a[162:163], v4 offset:10240
  v_mfma_f32_16x16x32_bf16 v[188:191], a[168:171], a[92:95], v[188:191]
  buffer_load_dwordx4 a[136:139], v1, s[8:11], s72 offen offset:0 sc1
  v_mfma_f32_16x16x32_bf16 v[184:187], a[168:171], a[88:91], v[184:187]
  ds_read_b64_tr_b16 a[164:165], v4 offset:12288
  v_mfma_f32_16x16x32_bf16 v[184:187], a[172:175], a[72:75], v[184:187]
  v_mfma_f32_16x16x32_bf16 v[180:183], a[172:175], a[68:71], v[180:183]
  ds_read_b64_tr_b16 a[166:167], v4 offset:14336
  v_mfma_f32_16x16x32_bf16 v[180:183], a[168:171], a[84:87], v[180:183]
  ds_read_b128 v[28:31], v12 offset:1408
  s_waitcnt lgkmcnt(5)
  v_mfma_f32_16x16x32_bf16 v[176:179], a[168:171], a[80:83], v[176:179]
  ds_read_b64_tr_b16 a[168:169], v5 offset:0
  v_fmac_f32 v32, v16, v24
  v_mfma_f32_16x16x32_bf16 v[176:179], a[172:175], a[64:67], v[176:179]
  s_waitcnt lgkmcnt(7)
  buffer_load_dwordx4 a[152:155], v1, s[8:11], s72 offen offset:1024 sc1
  v_fmac_f32 v33, v16, v25
  v_mfma_f32_16x16x32_bf16 v[192:195], a[180:183], a[64:67], v[192:195]
  ds_read_b64_tr_b16 a[170:171], v5 offset:2048
  v_fmac_f32 v34, v16, v26
  v_mfma_f32_16x16x32_bf16 v[192:195], a[176:179], a[80:83], v[192:195]
  s_add_u32 s72, s72, 65536
  v_fmac_f32 v35, v16, v27
  v_fmac_f32 v36, v18, v24
  v_mfma_f32_16x16x32_bf16 v[196:199], a[176:179], a[84:87], v[196:199]
  ds_read_b64_tr_b16 a[172:173], v5 offset:4096
  v_fmac_f32 v37, v18, v25
  v_mfma_f32_16x16x32_bf16 v[196:199], a[180:183], a[68:71], v[196:199]
  buffer_load_dwordx4 a[140:143], v1, s[8:11], s72 offen offset:0 sc1
  v_fmac_f32 v38, v18, v26
  v_fmac_f32 v39, v18, v27
  v_mfma_f32_16x16x32_bf16 v[200:203], a[180:183], a[72:75], v[200:203]
  ds_read_b64_tr_b16 a[174:175], v5 offset:6144
  v_fmac_f32 v40, v20, v24
  v_mfma_f32_16x16x32_bf16 v[200:203], a[176:179], a[88:91], v[200:203]
  v_fmac_f32 v41, v20, v25
  v_fmac_f32 v42, v20, v26
  v_mfma_f32_16x16x32_bf16 v[204:207], a[176:179], a[92:95], v[204:207]
  ds_read_b64_tr_b16 a[176:177], v5 offset:8192
  v_fmac_f32 v43, v20, v27
  v_mfma_f32_16x16x32_bf16 v[204:207], a[180:183], a[76:79], v[204:207]
  s_waitcnt lgkmcnt(6)
  v_fmac_f32 v44, v22, v24
  v_fmac_f32 v45, v22, v25
  v_mfma_f32_16x16x32_bf16 v[220:223], a[160:163], a[76:79], v[220:223]
  ds_read_b64_tr_b16 a[178:179], v5 offset:10240
  v_fmac_f32 v46, v22, v26
  v_mfma_f32_16x16x32_bf16 v[220:223], a[164:167], a[92:95], v[220:223]
  buffer_load_dwordx4 a[156:159], v1, s[8:11], s72 offen offset:1024 sc1
  v_fmac_f32 v47, v22, v27
  v_mfma_f32_16x16x32_bf16 v[216:219], a[164:167], a[88:91], v[216:219]
  ds_read_b64_tr_b16 a[180:181], v5 offset:12288
  v_mfma_f32_16x16x32_bf16 v[216:219], a[160:163], a[72:75], v[216:219]
  s_mov_b32 s65, 4587520
  s_add_u32 s73, s24, 20480
  s_add_u32 m0, s45, 81920
  ds_read_b128 v[24:27], v12 offset:1920
  v_mfma_f32_16x16x32_bf16 v[212:215], a[160:163], a[68:71], v[212:215]
  ds_read_b64_tr_b16 a[182:183], v5 offset:14336
  s_waitcnt lgkmcnt(9)
  v_mfma_f32_16x16x32_bf16 v[212:215], a[164:167], a[84:87], v[212:215]
  buffer_load_dwordx4 v11, s[28:31], s65 offen lds
  s_waitcnt vmcnt(33)
  s_barrier
  v_mfma_f32_16x16x32_bf16 v[208:211], a[164:167], a[80:83], v[208:211]
  ds_read_b64_tr_b16 a[164:165], v6 offset:32768
  v_fmac_f32 v48, v16, v28
  v_mfma_f32_16x16x32_bf16 v[208:211], a[160:163], a[64:67], v[208:211]
  s_waitcnt lgkmcnt(6)
  v_fmac_f32 v49, v16, v29
  v_fmac_f32 v50, v16, v30
  v_mfma_f32_16x16x32_bf16 v[224:227], a[168:171], a[64:67], v[224:227]
  ds_read_b64_tr_b16 a[166:167], v6 offset:34816
  v_fmac_f32 v51, v16, v31
HOP11:
  s_cbranch_execz WRET0
  v_mfma_f32_16x16x32_bf16 v[224:227], a[172:175], a[80:83], v[224:227]
  s_add_u32 m0, s45, 90112
  v_fmac_f32 v52, v18, v28
  v_fmac_f32 v53, v18, v29
  v_mfma_f32_16x16x32_bf16 v[228:231], a[172:175], a[84:87], v[228:231]
  ds_read_b64_tr_b16 a[160:161], v6 offset:36864
  v_fmac_f32 v54, v18, v30
  v_mfma_f32_16x16x32_bf16 v[228:231], a[168:171], a[68:71], v[228:231]
  buffer_load_dwordx4 v11, s[32:35], s65 offen lds
  v_fmac_f32 v55, v18, v31
  v_fmac_f32 v56, v20, v28
  v_mfma_f32_16x16x32_bf16 v[232:235], a[168:171], a[72:75], v[232:235]
  ds_read_b64_tr_b16 a[162:163], v6 offset:38912
  v_fmac_f32 v57, v20, v29
  v_mfma_f32_16x16x32_bf16 v[232:235], a[172:175], a[88:91], v[232:235]
  s_add_u32 m0, s45, 86016
  s_add_u32 s60, s65, 229376
  v_fmac_f32 v58, v20, v30
  v_mfma_f32_16x16x32_bf16 v[236:239], a[172:175], a[92:95], v[236:239]
  ds_read_b64_tr_b16 a[172:173], v6 offset:40960
  v_fmac_f32 v59, v20, v31
  v_mfma_f32_16x16x32_bf16 v[236:239], a[168:171], a[76:79], v[236:239]
  s_waitcnt lgkmcnt(5)
  buffer_load_dwordx4 v11, s[28:31], s60 offen lds
  v_fmac_f32 v60, v22, v28
  v_mfma_f32_16x16x32_bf16 v[252:255], a[176:179], a[76:79], v[252:255]
  ds_read_b64_tr_b16 a[174:175], v6 offset:43008
  v_fmac_f32 v61, v22, v29
  v_mfma_f32_16x16x32_bf16 v[252:255], a[180:183], a[92:95], v[252:255]
  v_fmac_f32 v62, v22, v30
  v_fmac_f32 v63, v22, v31
  v_mfma_f32_16x16x32_bf16 v[248:251], a[180:183], a[88:91], v[248:251]
  ds_read_b64_tr_b16 a[168:169], v6 offset:45056
  v_mfma_f32_16x16x32_bf16 v[248:251], a[176:179], a[72:75], v[248:251]
  s_add_u32 m0, s45, 94208
  s_add_u32 s60, s65, 229376
  v_mfma_f32_16x16x32_bf16 v[244:247], a[176:179], a[68:71], v[244:247]
  ds_read_b64_tr_b16 a[170:171], v6 offset:47104
  v_mfma_f32_16x16x32_bf16 v[244:247], a[180:183], a[84:87], v[244:247]
  buffer_load_dwordx4 v11, s[32:35], s60 offen lds
  ds_read_b128 v[28:31], v12 offset:0
  v_mfma_f32_16x16x32_bf16 v[240:243], a[180:183], a[80:83], v[240:243]
  ds_read_b64_tr_b16 a[180:181], v7 offset:32768
  s_waitcnt lgkmcnt(11)
  v_mfma_f32_16x16x32_bf16 v[240:243], a[176:179], a[64:67], v[240:243]
  s_waitcnt vmcnt(20) lgkmcnt(6)
  s_mov_b32 s66, 5046272
  s_add_u32 s74, s24, 22528
  s_add_u32 m0, s45, 65536
  v_fmac_f32 v48, v17, v24
  v_mfma_f32_16x16x32_bf16 v[64:67], a[164:167], a[96:99], v[64:67]
  ds_read_b64_tr_b16 a[182:183], v7 offset:34816
  v_fmac_f32 v49, v17, v25
  v_mfma_f32_16x16x32_bf16 v[64:67], a[160:163], a[112:115], v[64:67]
  buffer_load_dwordx4 v11, s[28:31], s66 offen lds
  v_fmac_f32 v50, v17, v26
  v_fmac_f32 v51, v17, v27
  v_mfma_f32_16x16x32_bf16 v[68:71], a[160:163], a[116:119], v[68:71]
  ds_read_b64_tr_b16 a[176:177], v7 offset:36864
  v_fmac_f32 v52, v19, v24
  v_mfma_f32_16x16x32_bf16 v[68:71], a[164:167], a[100:103], v[68:71]
  v_fmac_f32 v53, v19, v25
  v_fmac_f32 v54, v19, v26
  v_mfma_f32_16x16x32_bf16 v[72:75], a[164:167], a[104:107], v[72:75]
  ds_read_b64_tr_b16 a[178:179], v7 offset:38912
  v_fmac_f32 v55, v19, v27
  v_mfma_f32_16x16x32_bf16 v[72:75], a[160:163], a[120:123], v[72:75]
  s_add_u32 m0, s45, 73728
  v_fmac_f32 v56, v21, v24
  v_fmac_f32 v57, v21, v25
  v_mfma_f32_16x16x32_bf16 v[76:79], a[160:163], a[124:127], v[76:79]
  ds_read_b64_tr_b16 a[160:161], v7 offset:40960
  v_fmac_f32 v58, v21, v26
  v_mfma_f32_16x16x32_bf16 v[76:79], a[164:167], a[108:111], v[76:79]
  s_waitcnt lgkmcnt(6)
  buffer_load_dwordx4 v11, s[32:35], s66 offen lds
  v_fmac_f32 v59, v21, v27
  v_mfma_f32_16x16x32_bf16 v[92:95], a[172:175], a[108:111], v[92:95]
  ds_read_b64_tr_b16 a[162:163], v7 offset:43008
  v_fmac_f32 v60, v23, v24
  v_mfma_f32_16x16x32_bf16 v[92:95], a[168:171], a[124:127], v[92:95]
  s_add_u32 m0, s45, 69632
  s_add_u32 s60, s66, 229376
  v_fmac_f32 v61, v23, v25
  v_mfma_f32_16x16x32_bf16 v[88:91], a[168:171], a[120:123], v[88:91]
  ds_read_b64_tr_b16 a[164:165], v7 offset:45056
  v_fmac_f32 v62, v23, v26
  v_mfma_f32_16x16x32_bf16 v[88:91], a[172:175], a[104:107], v[88:91]
  buffer_load_dwordx4 v11, s[28:31], s60 offen lds
  v_fmac_f32 v63, v23, v27
  v_mfma_f32_16x16x32_bf16 v[84:87], a[172:175], a[100:103], v[84:87]
  ds_read_b64_tr_b16 a[166:167], v7 offset:47104
  v_mfma_f32_16x16x32_bf16 v[84:87], a[168:171], a[116:119], v[84:87]
  ds_read_b128 v[24:27], v12 offset:256
  s_waitcnt lgkmcnt(9)
  v_mfma_f32_16x16x32_bf16 v[80:83], a[168:171], a[112:115], v[80:83]
  ds_read_b64_tr_b16 a[168:169], v8 offset:32768
  v_fmac_f32 v128, v16, v28
  v_mfma_f32_16x16x32_bf16 v[80:83], a[172:175], a[96:99], v[80:83]
  s_waitcnt lgkmcnt(6)
  s_add_u32 m0, s45, 77824
  s_add_u32 s60, s66, 229376
  v_mfma_f32_16x16x32_bf16 v[96:99], a[180:183], a[96:99], v[96:99]
  ds_read_b64_tr_b16 a[170:171], v8 offset:34816
  v_fmac_f32 v129, v16, v29
  v_mfma_f32_16x16x32_bf16 v[96:99], a[176:179], a[112:115], v[96:99]
  buffer_load_dwordx4 v11, s[32:35], s60 offen lds
  v_fmac_f32 v130, v16, v30
  v_fmac_f32 v131, v16, v31
  v_mfma_f32_16x16x32_bf16 v[100:103], a[176:179], a[116:119], v[100:103]
  ds_read_b64_tr_b16 a[172:173], v8 offset:36864
  v_fmac_f32 v132, v18, v28
  v_mfma_f32_16x16x32_bf16 v[100:103], a[180:183], a[100:103], v[100:103]
  s_add_u32 m0, s45, 16384
  v_fmac_f32 v133, v18, v29
  v_fmac_f32 v134, v18, v30
  v_mfma_f32_16x16x32_bf16 v[104:107], a[180:183], a[104:107], v[104:107]
  ds_read_b64_tr_b16 a[174:175], v8 offset:38912
  v_fmac_f32 v135, v18, v31
  v_mfma_f32_16x16x32_bf16 v[104:107], a[176:179], a[120:123], v[104:107]
  buffer_load_dwordx4 v10, s[28:31], s65 offen lds
  v_fmac_f32 v136, v20, v28
  v_fmac_f32 v137, v20, v29
  v_mfma_f32_16x16x32_bf16 v[108:111], a[176:179], a[124:127], v[108:111]
  ds_read_b64_tr_b16 a[176:177], v8 offset:40960
  v_fmac_f32 v138, v20, v30
  v_mfma_f32_16x16x32_bf16 v[108:111], a[180:183], a[108:111], v[108:111]
  s_waitcnt lgkmcnt(6)
  v_fmac_f32 v139, v20, v31
  v_fmac_f32 v140, v22, v28
  v_mfma_f32_16x16x32_bf16 v[124:127], a[160:163], a[108:111], v[124:127]
  ds_read_b64_tr_b16 a[178:179], v8 offset:43008
  v_fmac_f32 v141, v22, v29
  v_mfma_f32_16x16x32_bf16 v[124:127], a[164:167], a[124:127], v[124:127]
  s_add_u32 m0, s45, 24576
  v_fmac_f32 v142, v22, v30
  v_fmac_f32 v143, v22, v31
  v_mfma_f32_16x16x32_bf16 v[120:123], a[164:167], a[120:123], v[120:123]
  ds_read_b64_tr_b16 a[180:181], v8 offset:45056
  v_mfma_f32_16x16x32_bf16 v[120:123], a[160:163], a[104:107], v[120:123]
  buffer_load_dwordx4 v10, s[32:35], s65 offen lds
  ds_read_b128 v[28:31], v12 offset:1280
  v_mfma_f32_16x16x32_bf16 v[116:119], a[160:163], a[100:103], v[116:119]
  ds_read_b64_tr_b16 a[182:183], v8 offset:47104
  s_waitcnt lgkmcnt(9)
  v_mfma_f32_16x16x32_bf16 v[116:119], a[164:167], a[116:119], v[116:119]
  s_add_u32 m0, s45, 20480
  s_add_u32 s60, s65, 229376
  v_fmac_f32 v64, v16, v24
  v_mfma_f32_16x16x32_bf16 v[112:115], a[164:167], a[112:115], v[112:115]
  ds_read_b64_tr_b16 a[164:165], v2 offset:32768
  v_fmac_f32 v65, v16, v25
  v_mfma_f32_16x16x32_bf16 v[112:115], a[160:163], a[96:99], v[112:115]
  s_waitcnt lgkmcnt(6)
  buffer_load_dwordx4 v10, s[28:31], s60 offen lds
  v_fmac_f32 v66, v16, v26
  v_mfma_f32_16x16x32_bf16 v[32:35], a[168:171], a[96:99], v[32:35]
  ds_read_b64_tr_b16 a[166:167], v2 offset:34816
  v_fmac_f32 v67, v16, v27
  v_mfma_f32_16x16x32_bf16 v[32:35], a[172:175], a[112:115], v[32:35]
  v_fmac_f32 v68, v18, v24
  v_fmac_f32 v69, v18, v25
  v_mfma_f32_16x16x32_bf16 v[36:39], a[172:175], a[116:119], v[36:39]
  ds_read_b64_tr_b16 a[160:161], v2 offset:36864
  v_fmac_f32 v70, v18, v26
  v_mfma_f32_16x16x32_bf16 v[36:39], a[168:171], a[100:103], v[36:39]
  s_add_u32 m0, s45, 28672
  s_add_u32 s60, s65, 229376
  v_fmac_f32 v71, v18, v27
  v_mfma_f32_16x16x32_bf16 v[40:43], a[168:171], a[104:107], v[40:43]
  ds_read_b64_tr_b16 a[162:163], v2 offset:38912
  v_fmac_f32 v72, v20, v24
  v_mfma_f32_16x16x32_bf16 v[40:43], a[172:175], a[120:123], v[40:43]
  buffer_load_dwordx4 v10, s[32:35], s60 offen lds
  v_fmac_f32 v73, v20, v25
  v_fmac_f32 v74, v20, v26
  v_mfma_f32_16x16x32_bf16 v[44:47], a[172:175], a[124:127], v[44:47]
  ds_read_b64_tr_b16 a[172:173], v2 offset:40960
  v_fmac_f32 v75, v20, v27
  v_mfma_f32_16x16x32_bf16 v[44:47], a[168:171], a[108:111], v[44:47]
  s_waitcnt lgkmcnt(5)
  v_fmac_f32 v76, v22, v24
  v_mfma_f32_16x16x32_bf16 v[60:63], a[176:179], a[108:111], v[60:63]
  ds_read_b64_tr_b16 a[174:175], v2 offset:43008
  v_fmac_f32 v77, v22, v25
  v_mfma_f32_16x16x32_bf16 v[60:63], a[180:183], a[124:127], v[60:63]
  buffer_load_dwordx4 a[0:3], v1, s[8:11], s73 offen offset:0 sc1
  v_fmac_f32 v78, v22, v26
  v_fmac_f32 v79, v22, v27
  v_mfma_f32_16x16x32_bf16 v[56:59], a[180:183], a[120:123], v[56:59]
  ds_read_b64_tr_b16 a[168:169], v2 offset:45056
  v_mfma_f32_16x16x32_bf16 v[56:59], a[176:179], a[104:107], v[56:59]
  ds_read_b128 v[24:27], v12 offset:1792
  s_waitcnt lgkmcnt(9)
  v_mfma_f32_16x16x32_bf16 v[52:55], a[176:179], a[100:103], v[52:55]
  ds_read_b64_tr_b16 a[170:171], v2 offset:47104
  v_fmac_f32 v80, v16, v28
  v_mfma_f32_16x16x32_bf16 v[52:55], a[180:183], a[116:119], v[52:55]
  v_fmac_f32 v81, v16, v29
  v_fmac_f32 v82, v16, v30
  v_mfma_f32_16x16x32_bf16 v[48:51], a[180:183], a[112:115], v[48:51]
  ds_read_b64_tr_b16 a[180:181], v3 offset:32768
  v_fmac_f32 v83, v16, v31
  v_mfma_f32_16x16x32_bf16 v[48:51], a[176:179], a[96:99], v[48:51]
  s_waitcnt lgkmcnt(6)
  buffer_load_dwordx4 a[16:19], v1, s[8:11], s73 offen offset:1024 sc1
  v_fmac_f32 v84, v18, v28
  v_mfma_f32_16x16x32_bf16 v[128:131], a[164:167], a[96:99], v[128:131]
  ds_read_b64_tr_b16 a[182:183], v3 offset:34816
  v_fmac_f32 v85, v18, v29
  v_mfma_f32_16x16x32_bf16 v[128:131], a[160:163], a[112:115], v[128:131]
  s_add_u32 s73, s73, 65536
  v_fmac_f32 v86, v18, v30
  v_fmac_f32 v87, v18, v31
  v_mfma_f32_16x16x32_bf16 v[132:135], a[160:163], a[116:119], v[132:135]
  ds_read_b64_tr_b16 a[176:177], v3 offset:36864
  v_fmac_f32 v88, v20, v28
  v_mfma_f32_16x16x32_bf16 v[132:135], a[164:167], a[100:103], v[132:135]
  buffer_load_dwordx4 a[4:7], v1, s[8:11], s73 offen offset:0 sc1
  v_fmac_f32 v89, v20, v29
  v_fmac_f32 v90, v20, v30
  v_mfma_f32_16x16x32_bf16 v[136:139], a[164:167], a[104:107], v[136:139]
  ds_read_b64_tr_b16 a[178:179], v3 offset:38912
  v_fmac_f32 v91, v20, v31
  v_mfma_f32_16x16x32_bf16 v[136:139], a[160:163], a[120:123], v[136:139]
  v_fmac_f32 v92, v22, v28
  v_fmac_f32 v93, v22, v29
  v_mfma_f32_16x16x32_bf16 v[140:143], a[160:163], a[124:127], v[140:143]
  ds_read_b64_tr_b16 a[160:161], v3 offset:40960
  v_fmac_f32 v94, v22, v30
  v_mfma_f32_16x16x32_bf16 v[140:143], a[164:167], a[108:111], v[140:143]
  s_waitcnt lgkmcnt(5)
  v_fmac_f32 v95, v22, v31
  v_mfma_f32_16x16x32_bf16 v[156:159], a[172:175], a[108:111], v[156:159]
  ds_read_b64_tr_b16 a[162:163], v3 offset:43008
  v_mfma_f32_16x16x32_bf16 v[156:159], a[168:171], a[124:127], v[156:159]
  buffer_load_dwordx4 a[20:23], v1, s[8:11], s73 offen offset:1024 sc1
  ds_read_b128 v[28:31], v12 offset:320
  v_mfma_f32_16x16x32_bf16 v[152:155], a[168:171], a[120:123], v[152:155]
  ds_read_b64_tr_b16 a[164:165], v3 offset:45056
  s_waitcnt lgkmcnt(9)
  v_mfma_f32_16x16x32_bf16 v[152:155], a[172:175], a[104:107], v[152:155]
  s_add_u32 s73, s73, 65536
  v_fmac_f32 v80, v17, v24
  v_fmac_f32 v81, v17, v25
  v_mfma_f32_16x16x32_bf16 v[148:151], a[172:175], a[100:103], v[148:151]
  ds_read_b64_tr_b16 a[166:167], v3 offset:47104
  v_fmac_f32 v82, v17, v26
  v_mfma_f32_16x16x32_bf16 v[148:151], a[168:171], a[116:119], v[148:151]
  buffer_load_dwordx4 a[8:11], v1, s[8:11], s73 offen offset:0 sc1
  v_fmac_f32 v83, v17, v27
  v_fmac_f32 v84, v19, v24
  v_mfma_f32_16x16x32_bf16 v[144:147], a[168:171], a[112:115], v[144:147]
  ds_read_b64_tr_b16 a[168:169], v4 offset:32768
  v_fmac_f32 v85, v19, v25
  v_mfma_f32_16x16x32_bf16 v[144:147], a[172:175], a[96:99], v[144:147]
  s_waitcnt lgkmcnt(6)
  v_fmac_f32 v86, v19, v26
  v_fmac_f32 v87, v19, v27
  v_mfma_f32_16x16x32_bf16 v[160:163], a[180:183], a[96:99], v[160:163]
  ds_read_b64_tr_b16 a[170:171], v4 offset:34816
  v_fmac_f32 v88, v21, v24
  v_mfma_f32_16x16x32_bf16 v[160:163], a[176:179], a[112:115], v[160:163]
  v_fmac_f32 v89, v21, v25
  v_fmac_f32 v90, v21, v26
  v_mfma_f32_16x16x32_bf16 v[164:167], a[176:179], a[116:119], v[164:167]
  ds_read_b64_tr_b16 a[172:173], v4 offset:36864
  v_fmac_f32 v91, v21, v27
  v_mfma_f32_16x16x32_bf16 v[164:167], a[180:183], a[100:103], v[164:167]
  buffer_load_dwordx4 a[24:27], v1, s[8:11], s73 offen offset:1024 sc1
  v_fmac_f32 v92, v23, v24
  v_fmac_f32 v93, v23, v25
  v_mfma_f32_16x16x32_bf16 v[168:171], a[180:183], a[104:107], v[168:171]
  ds_read_b64_tr_b16 a[174:175], v4 offset:38912
  v_fmac_f32 v94, v23, v26
  v_mfma_f32_16x16x32_bf16 v[168:171], a[176:179], a[120:123], v[168:171]
  s_add_u32 s73, s73, 65536
  v_fmac_f32 v95, v23, v27
  v_mfma_f32_16x16x32_bf16 v[172:175], a[176:179], a[124:127], v[172:175]
  ds_read_b64_tr_b16 a[176:177], v4 offset:40960
  v_mfma_f32_16x16x32_bf16 v[172:175], a[180:183], a[108:111], v[172:175]
  s_waitcnt lgkmcnt(5)
  buffer_load_dwordx4 a[12:15], v1, s[8:11], s73 offen offset:0 sc1
  v_mfma_f32_16x16x32_bf16 v[188:191], a[160:163], a[108:111], v[188:191]
  ds_read_b64_tr_b16 a[178:179], v4 offset:43008
  v_mfma_f32_16x16x32_bf16 v[188:191], a[164:167], a[124:127], v[188:191]
  ds_read_b128 v[24:27], v12 offset:1344
  s_waitcnt lgkmcnt(9)
  v_mfma_f32_16x16x32_bf16 v[184:187], a[164:167], a[120:123], v[184:187]
  ds_read_b64_tr_b16 a[180:181], v4 offset:45056
  v_fmac_f32 v96, v16, v28
  v_mfma_f32_16x16x32_bf16 v[184:187], a[160:163], a[104:107], v[184:187]
  v_fmac_f32 v97, v16, v29
  v_fmac_f32 v98, v16, v30
  v_mfma_f32_16x16x32_bf16 v[180:183], a[160:163], a[100:103], v[180:183]
  ds_read_b64_tr_b16 a[182:183], v4 offset:47104
  v_fmac_f32 v99, v16, v31
  v_mfma_f32_16x16x32_bf16 v[180:183], a[164:167], a[116:119], v[180:183]
  buffer_load_dwordx4 a[28:31], v1, s[8:11], s73 offen offset:1024 sc1
  v_fmac_f32 v100, v18, v28
  v_fmac_f32 v101, v18, v29
  v_mfma_f32_16x16x32_bf16 v[176:179], a[164:167], a[112:115], v[176:179]
  ds_read_b64_tr_b16 a[164:165], v5 offset:32768
  v_fmac_f32 v102, v18, v30
  v_mfma_f32_16x16x32_bf16 v[176:179], a[160:163], a[96:99], v[176:179]
  s_waitcnt lgkmcnt(6)
  v_fmac_f32 v103, v18, v31
  v_mfma_f32_16x16x32_bf16 v[192:195], a[168:171], a[96:99], v[192:195]
  ds_read_b64_tr_b16 a[166:167], v5 offset:34816
  v_fmac_f32 v104, v20, v28
  v_mfma_f32_16x16x32_bf16 v[192:195], a[172:175], a[112:115], v[192:195]
  buffer_load_dwordx4 a[32:35], v1, s[8:11], s74 offen offset:0 sc1
  v_fmac_f32 v105, v20, v29
  v_fmac_f32 v106, v20, v30
  v_mfma_f32_16x16x32_bf16 v[196:199], a[172:175], a[116:119], v[196:199]
  ds_read_b64_tr_b16 a[160:161], v5 offset:36864
  v_fmac_f32 v107, v20, v31
  v_mfma_f32_16x16x32_bf16 v[196:199], a[168:171], a[100:103], v[196:199]
  v_fmac_f32 v108, v22, v28
  v_fmac_f32 v109, v22, v29
  v_mfma_f32_16x16x32_bf16 v[200:203], a[168:171], a[104:107], v[200:203]
  ds_read_b64_tr_b16 a[162:163], v5 offset:38912
  v_fmac_f32 v110, v22, v30
  v_mfma_f32_16x16x32_bf16 v[200:203], a[172:175], a[120:123], v[200:203]
  v_fmac_f32 v111, v22, v31
  v_mfma_f32_16x16x32_bf16 v[204:207], a[172:175], a[124:127], v[204:207]
  ds_read_b64_tr_b16 a[172:173], v5 offset:40960
  v_mfma_f32_16x16x32_bf16 v[204:207], a[168:171], a[108:111], v[204:207]
  s_waitcnt lgkmcnt(5)
  buffer_load_dwordx4 a[48:51], v1, s[8:11], s74 offen offset:1024 sc1
  v_mfma_f32_16x16x32_bf16 v[220:223], a[176:179], a[108:111], v[220:223]
  ds_read_b64_tr_b16 a[174:175], v5 offset:43008
  v_mfma_f32_16x16x32_bf16 v[220:223], a[180:183], a[124:127], v[220:223]
  s_add_u32 s74, s74, 65536
  ds_read_b128 v[28:31], v12 offset:1856
  v_mfma_f32_16x16x32_bf16 v[216:219], a[180:183], a[120:123], v[216:219]
  ds_read_b64_tr_b16 a[168:169], v5 offset:45056
  s_waitcnt lgkmcnt(10)
  v_mfma_f32_16x16x32_bf16 v[216:219], a[176:179], a[104:107], v[216:219]
  buffer_load_dwordx4 a[36:39], v1, s[8:11], s74 offen offset:0 sc1
  v_fmac_f32 v112, v16, v24
  v_fmac_f32 v113, v16, v25
  v_mfma_f32_16x16x32_bf16 v[212:215], a[176:179], a[100:103], v[212:215]
  ds_read_b64_tr_b16 a[170:171], v5 offset:47104
  v_fmac_f32 v114, v16, v26
  v_mfma_f32_16x16x32_bf16 v[212:215], a[180:183], a[116:119], v[212:215]
  s_waitcnt vmcnt(31)
  s_barrier
  v_mfma_f32_16x16x32_bf16 v[208:211], a[180:183], a[112:115], v[208:211]
  ds_read_b64_tr_b16 a[180:181], v6 offset:49152
  v_fmac_f32 v115, v16, v27
  v_mfma_f32_16x16x32_bf16 v[208:211], a[176:179], a[96:99], v[208:211]
  s_waitcnt lgkmcnt(6)
  v_fmac_f32 v116, v18, v24
  v_fmac_f32 v117, v18, v25
  v_mfma_f32_16x16x32_bf16 v[224:227], a[164:167], a[96:99], v[224:227]
  ds_read_b64_tr_b16 a[182:183], v6 offset:51200
  v_fmac_f32 v118, v18, v26
  v_mfma_f32_16x16x32_bf16 v[224:227], a[160:163], a[112:115], v[224:227]
  buffer_load_dwordx4 a[52:55], v1, s[8:11], s74 offen offset:1024 sc1
  v_fmac_f32 v119, v18, v27
  v_fmac_f32 v120, v20, v24
  v_mfma_f32_16x16x32_bf16 v[228:231], a[160:163], a[116:119], v[228:231]
  ds_read_b64_tr_b16 a[176:177], v6 offset:53248
  v_fmac_f32 v121, v20, v25
  v_mfma_f32_16x16x32_bf16 v[228:231], a[164:167], a[100:103], v[228:231]
  s_add_u32 s74, s74, 65536
  v_fmac_f32 v122, v20, v26
  v_fmac_f32 v123, v20, v27
  v_mfma_f32_16x16x32_bf16 v[232:235], a[164:167], a[104:107], v[232:235]
  ds_read_b64_tr_b16 a[178:179], v6 offset:55296
  v_fmac_f32 v124, v22, v24
  v_mfma_f32_16x16x32_bf16 v[232:235], a[160:163], a[120:123], v[232:235]
  buffer_load_dwordx4 a[40:43], v1, s[8:11], s74 offen offset:0 sc1
  v_fmac_f32 v125, v22, v25
  v_fmac_f32 v126, v22, v26
  v_mfma_f32_16x16x32_bf16 v[236:239], a[160:163], a[124:127], v[236:239]
  ds_read_b64_tr_b16 a[160:161], v6 offset:57344
  v_fmac_f32 v127, v22, v27
  v_mfma_f32_16x16x32_bf16 v[236:239], a[164:167], a[108:111], v[236:239]
  s_waitcnt lgkmcnt(5)
  ds_read_b128 v[24:27], v12 offset:1024
  v_mfma_f32_16x16x32_bf16 v[252:255], a[172:175], a[108:111], v[252:255]
  ds_read_b64_tr_b16 a[162:163], v6 offset:59392
  s_waitcnt lgkmcnt(9)
  v_mfma_f32_16x16x32_bf16 v[252:255], a[168:171], a[124:127], v[252:255]
  v_fmac_f32 v112, v17, v28
  v_fmac_f32 v113, v17, v29
  v_mfma_f32_16x16x32_bf16 v[248:251], a[168:171], a[120:123], v[248:251]
  ds_read_b64_tr_b16 a[164:165], v6 offset:61440
  v_fmac_f32 v114, v17, v30
  v_mfma_f32_16x16x32_bf16 v[248:251], a[172:175], a[104:107], v[248:251]
  buffer_load_dwordx4 a[56:59], v1, s[8:11], s74 offen offset:1024 sc1
  v_fmac_f32 v115, v17, v31
  v_fmac_f32 v116, v19, v28
  v_mfma_f32_16x16x32_bf16 v[244:247], a[172:175], a[100:103], v[244:247]
  ds_read_b64_tr_b16 a[166:167], v6 offset:63488
  v_fmac_f32 v117, v19, v29
  v_mfma_f32_16x16x32_bf16 v[244:247], a[168:171], a[116:119], v[244:247]
  s_add_u32 s74, s74, 65536
  v_fmac_f32 v118, v19, v30
  v_fmac_f32 v119, v19, v31
  v_mfma_f32_16x16x32_bf16 v[240:243], a[168:171], a[112:115], v[240:243]
  ds_read_b64_tr_b16 a[168:169], v7 offset:49152
  v_fmac_f32 v120, v21, v28
  v_mfma_f32_16x16x32_bf16 v[240:243], a[172:175], a[96:99], v[240:243]
  s_waitcnt vmcnt(26) lgkmcnt(6)
  buffer_load_dwordx4 a[44:47], v1, s[8:11], s74 offen offset:0 sc1
  v_fmac_f32 v121, v21, v29
  v_mfma_f32_16x16x32_bf16 v[64:67], a[180:183], a[128:131], v[64:67]
  ds_read_b64_tr_b16 a[170:171], v7 offset:51200
  v_fmac_f32 v122, v21, v30
  v_mfma_f32_16x16x32_bf16 v[64:67], a[176:179], a[144:147], v[64:67]
  v_fmac_f32 v123, v21, v31
  v_fmac_f32 v124, v23, v28
  v_mfma_f32_16x16x32_bf16 v[68:71], a[176:179], a[148:151], v[68:71]
  ds_read_b64_tr_b16 a[172:173], v7 offset:53248
  v_fmac_f32 v125, v23, v29
  v_mfma_f32_16x16x32_bf16 v[68:71], a[180:183], a[132:135], v[68:71]
  v_fmac_f32 v126, v23, v30
  v_fmac_f32 v127, v23, v31
  v_mfma_f32_16x16x32_bf16 v[72:75], a[180:183], a[136:139], v[72:75]
  ds_read_b64_tr_b16 a[174:175], v7 offset:55296
  v_mfma_f32_16x16x32_bf16 v[72:75], a[176:179], a[152:155], v[72:75]
  buffer_load_dwordx4 a[60:63], v1, s[8:11], s74 offen offset:1024 sc1
  ds_read_b128 v[28:31], v12 offset:1536
  v_mfma_f32_16x16x32_bf16 v[76:79], a[176:179], a[156:159], v[76:79]
  ds_read_b64_tr_b16 a[176:177], v7 offset:57344
  s_waitcnt lgkmcnt(9)
  v_mfma_f32_16x16x32_bf16 v[76:79], a[180:183], a[140:143], v[76:79]
  s_waitcnt lgkmcnt(6)
  s_mov_b32 s67, 5505024
  s_add_u32 s75, s24, 24576
  s_add_u32 m0, s45, 98304
  v_fmac_f32 v144, v16, v24
  v_mfma_f32_16x16x32_bf16 v[92:95], a[160:163], a[140:143], v[92:95]
  ds_read_b64_tr_b16 a[178:179], v7 offset:59392
  v_fmac_f32 v145, v16, v25
  v_mfma_f32_16x16x32_bf16 v[92:95], a[164:167], a[156:159], v[92:95]
  buffer_load_dwordx4 v11, s[28:31], s67 offen lds
  v_fmac_f32 v146, v16, v26
  v_fmac_f32 v147, v16, v27
  v_mfma_f32_16x16x32_bf16 v[88:91], a[164:167], a[152:155], v[88:91]
  ds_read_b64_tr_b16 a[180:181], v7 offset:61440
  v_fmac_f32 v148, v18, v24
  v_mfma_f32_16x16x32_bf16 v[88:91], a[160:163], a[136:139], v[88:91]
  v_fmac_f32 v149, v18, v25
  v_fmac_f32 v150, v18, v26
  v_mfma_f32_16x16x32_bf16 v[84:87], a[160:163], a[132:135], v[84:87]
  ds_read_b64_tr_b16 a[182:183], v7 offset:63488
  v_fmac_f32 v151, v18, v27
  v_mfma_f32_16x16x32_bf16 v[84:87], a[164:167], a[148:151], v[84:87]
  s_add_u32 m0, s45, 106496
  v_fmac_f32 v152, v20, v24
  v_fmac_f32 v153, v20, v25
  v_mfma_f32_16x16x32_bf16 v[80:83], a[164:167], a[144:147], v[80:83]
  ds_read_b64_tr_b16 a[164:165], v8 offset:49152
  v_fmac_f32 v154, v20, v26
  v_mfma_f32_16x16x32_bf16 v[80:83], a[160:163], a[128:131], v[80:83]
  s_waitcnt lgkmcnt(6)
  buffer_load_dwordx4 v11, s[32:35], s67 offen lds
  v_fmac_f32 v155, v20, v27
  v_mfma_f32_16x16x32_bf16 v[96:99], a[168:171], a[128:131], v[96:99]
  ds_read_b64_tr_b16 a[166:167], v8 offset:51200
  v_fmac_f32 v156, v22, v24
  v_mfma_f32_16x16x32_bf16 v[96:99], a[172:175], a[144:147], v[96:99]
  s_add_u32 m0, s45, 102400
  s_add_u32 s60, s67, 229376
  v_fmac_f32 v157, v22, v25
  v_mfma_f32_16x16x32_bf16 v[100:103], a[172:175], a[148:151], v[100:103]
  ds_read_b64_tr_b16 a[160:161], v8 offset:53248
  v_fmac_f32 v158, v22, v26
  v_mfma_f32_16x16x32_bf16 v[100:103], a[168:171], a[132:135], v[100:103]
  buffer_load_dwordx4 v11, s[28:31], s60 offen lds
  v_fmac_f32 v159, v22, v27
  v_mfma_f32_16x16x32_bf16 v[104:107], a[168:171], a[136:139], v[104:107]
  ds_read_b64_tr_b16 a[162:163], v8 offset:55296
  v_mfma_f32_16x16x32_bf16 v[104:107], a[172:175], a[152:155], v[104:107]
  ds_read_b128 v[24:27], v12 offset:64
  s_waitcnt lgkmcnt(9)
  v_mfma_f32_16x16x32_bf16 v[108:111], a[172:175], a[156:159], v[108:111]
  ds_read_b64_tr_b16 a[172:173], v8 offset:57344
  v_fmac_f32 v144, v17, v28
  v_mfma_f32_16x16x32_bf16 v[108:111], a[168:171], a[140:143], v[108:111]
  s_waitcnt lgkmcnt(6)
  s_add_u32 m0, s45, 110592
  s_add_u32 s60, s67, 229376
  v_mfma_f32_16x16x32_bf16 v[124:127], a[176:179], a[140:143], v[124:127]
  ds_read_b64_tr_b16 a[174:175], v8 offset:59392
  v_fmac_f32 v145, v17, v29
  v_mfma_f32_16x16x32_bf16 v[124:127], a[180:183], a[156:159], v[124:127]
  buffer_load_dwordx4 v11, s[32:35], s60 offen lds
  v_fmac_f32 v146, v17, v30
  v_fmac_f32 v147, v17, v31
  v_mfma_f32_16x16x32_bf16 v[120:123], a[180:183], a[152:155], v[120:123]
  ds_read_b64_tr_b16 a[168:169], v8 offset:61440
  v_fmac_f32 v148, v19, v28
  v_mfma_f32_16x16x32_bf16 v[120:123], a[176:179], a[136:139], v[120:123]
  s_add_u32 s61, s91, 0
  v_fmac_f32 v149, v19, v29
  v_fmac_f32 v150, v19, v30
  v_mfma_f32_16x16x32_bf16 v[116:119], a[176:179], a[132:135], v[116:119]
  ds_read_b64_tr_b16 a[170:171], v8 offset:63488
  v_fmac_f32 v151, v19, v31
  v_mfma_f32_16x16x32_bf16 v[116:119], a[180:183], a[148:151], v[116:119]
  buffer_load_dword a253, v13, s[36:39], s61 offen
  v_fmac_f32 v152, v21, v28
  v_fmac_f32 v153, v21, v29
  v_mfma_f32_16x16x32_bf16 v[112:115], a[180:183], a[144:147], v[112:115]
  ds_read_b64_tr_b16 a[180:181], v2 offset:49152
  v_fmac_f32 v154, v21, v30
  v_mfma_f32_16x16x32_bf16 v[112:115], a[176:179], a[128:131], v[112:115]
  s_waitcnt lgkmcnt(6)
  v_fmac_f32 v155, v21, v31
  v_fmac_f32 v156, v23, v28
  v_mfma_f32_16x16x32_bf16 v[32:35], a[164:167], a[128:131], v[32:35]
  ds_read_b64_tr_b16 a[182:183], v2 offset:51200
  v_fmac_f32 v157, v23, v29
  v_mfma_f32_16x16x32_bf16 v[32:35], a[160:163], a[144:147], v[32:35]
  v_fmac_f32 v158, v23, v30
  v_fmac_f32 v159, v23, v31
  v_mfma_f32_16x16x32_bf16 v[36:39], a[160:163], a[148:151], v[36:39]
  ds_read_b64_tr_b16 a[176:177], v2 offset:53248
  v_mfma_f32_16x16x32_bf16 v[36:39], a[164:167], a[132:135], v[36:39]
  ds_read_b128 v[28:31], v12 offset:1088
  s_waitcnt lgkmcnt(8)
  v_mfma_f32_16x16x32_bf16 v[40:43], a[164:167], a[136:139], v[40:43]
  ds_read_b64_tr_b16 a[178:179], v2 offset:55296
  v_fmac_f32 v160, v16, v24
  v_mfma_f32_16x16x32_bf16 v[40:43], a[160:163], a[152:155], v[40:43]
  v_fmac_f32 v161, v16, v25
  v_fmac_f32 v162, v16, v26
  v_mfma_f32_16x16x32_bf16 v[44:47], a[160:163], a[156:159], v[44:47]
  ds_read_b64_tr_b16 a[160:161], v2 offset:57344
  v_fmac_f32 v163, v16, v27
  v_mfma_f32_16x16x32_bf16 v[44:47], a[164:167], a[140:143], v[44:47]
  s_waitcnt lgkmcnt(6)
  buffer_load_dwordx4 a[64:67], v1, s[8:11], s75 offen offset:0 sc1
  v_fmac_f32 v164, v18, v24
  v_mfma_f32_16x16x32_bf16 v[60:63], a[172:175], a[140:143], v[60:63]
  ds_read_b64_tr_b16 a[162:163], v2 offset:59392
  v_fmac_f32 v165, v18, v25
  v_mfma_f32_16x16x32_bf16 v[60:63], a[168:171], a[156:159], v[60:63]
  v_fmac_f32 v166, v18, v26
  v_fmac_f32 v167, v18, v27
  v_mfma_f32_16x16x32_bf16 v[56:59], a[168:171], a[152:155], v[56:59]
  ds_read_b64_tr_b16 a[164:165], v2 offset:61440
  v_fmac_f32 v168, v20, v24
  v_mfma_f32_16x16x32_bf16 v[56:59], a[172:175], a[136:139], v[56:59]
  v_fmac_f32 v169, v20, v25
  v_fmac_f32 v170, v20, v26
  v_mfma_f32_16x16x32_bf16 v[52:55], a[172:175], a[132:135], v[52:55]
  ds_read_b64_tr_b16 a[166:167], v2 offset:63488
  v_fmac_f32 v171, v20, v27
  v_mfma_f32_16x16x32_bf16 v[52:55], a[168:171], a[148:151], v[52:55]
  buffer_load_dwordx4 a[80:83], v1, s[8:11], s75 offen offset:1024 sc1
  v_fmac_f32 v172, v22, v24
  v_fmac_f32 v173, v22, v25
  v_mfma_f32_16x16x32_bf16 v[48:51], a[168:171], a[144:147], v[48:51]
  ds_read_b64_tr_b16 a[168:169], v3 offset:49152
  v_fmac_f32 v174, v22, v26
  v_mfma_f32_16x16x32_bf16 v[48:51], a[172:175], a[128:131], v[48:51]
  s_waitcnt lgkmcnt(5)
  s_add_u32 s75, s75, 65536
  v_fmac_f32 v175, v22, v27
  v_mfma_f32_16x16x32_bf16 v[128:131], a[180:183], a[128:131], v[128:131]
  ds_read_b64_tr_b16 a[170:171], v3 offset:51200
  v_mfma_f32_16x16x32_bf16 v[128:131], a[176:179], a[144:147], v[128:131]
  buffer_load_dwordx4 a[68:71], v1, s[8:11], s75 offen offset:0 sc1
  ds_read_b128 v[24:27], v12 offset:1152
  v_mfma_f32_16x16x32_bf16 v[132:135], a[176:179], a[148:151], v[132:135]
  ds_read_b64_tr_b16 a[172:173], v3 offset:53248
  s_waitcnt lgkmcnt(9)
  v_mfma_f32_16x16x32_bf16 v[132:135], a[180:183], a[132:135], v[132:135]
  v_fmac_f32 v176, v16, v28
  v_fmac_f32 v177, v16, v29
  v_mfma_f32_16x16x32_bf16 v[136:139], a[180:183], a[136:139], v[136:139]
  ds_read_b64_tr_b16 a[174:175], v3 offset:55296
  v_fmac_f32 v178, v16, v30
  v_mfma_f32_16x16x32_bf16 v[136:139], a[176:179], a[152:155], v[136:139]
  v_fmac_f32 v179, v16, v31
  v_fmac_f32 v180, v18, v28
  v_mfma_f32_16x16x32_bf16 v[140:143], a[176:179], a[156:159], v[140:143]
  ds_read_b64_tr_b16 a[176:177], v3 offset:57344
  v_fmac_f32 v181, v18, v29
  v_mfma_f32_16x16x32_bf16 v[140:143], a[180:183], a[140:143], v[140:143]
  s_waitcnt lgkmcnt(6)
  buffer_load_dwordx4 a[84:87], v1, s[8:11], s75 offen offset:1024 sc1
  v_fmac_f32 v182, v18, v30
  v_mfma_f32_16x16x32_bf16 v[156:159], a[160:163], a[140:143], v[156:159]
  ds_read_b64_tr_b16 a[178:179], v3 offset:59392
  v_fmac_f32 v183, v18, v31
  v_mfma_f32_16x16x32_bf16 v[156:159], a[164:167], a[156:159], v[156:159]
  s_add_u32 s75, s75, 65536
  v_fmac_f32 v184, v20, v28
  v_fmac_f32 v185, v20, v29
  v_mfma_f32_16x16x32_bf16 v[152:155], a[164:167], a[152:155], v[152:155]
  ds_read_b64_tr_b16 a[180:181], v3 offset:61440
  v_fmac_f32 v186, v20, v30
  v_mfma_f32_16x16x32_bf16 v[152:155], a[160:163], a[136:139], v[152:155]
  buffer_load_dwordx4 a[72:75], v1, s[8:11], s75 offen offset:0 sc1
  v_fmac_f32 v187, v20, v31
  v_fmac_f32 v188, v22, v28
  v_mfma_f32_16x16x32_bf16 v[148:151], a[160:163], a[132:135], v[148:151]
  ds_read_b64_tr_b16 a[182:183], v3 offset:63488
  v_fmac_f32 v189, v22, v29
  v_mfma_f32_16x16x32_bf16 v[148:151], a[164:167], a[148:151], v[148:151]
  v_fmac_f32 v190, v22, v30
  v_fmac_f32 v191, v22, v31
  v_mfma_f32_16x16x32_bf16 v[144:147], a[164:167], a[144:147], v[144:147]
  ds_read_b64_tr_b16 a[164:165], v4 offset:49152
  v_mfma_f32_16x16x32_bf16 v[144:147], a[160:163], a[128:131], v[144:147]
  s_waitcnt lgkmcnt(5)
  ds_read_b128 v[28:31], v12 offset:192
  v_mfma_f32_16x16x32_bf16 v[160:163], a[168:171], a[128:131], v[160:163]
  ds_read_b64_tr_b16 a[166:167], v4 offset:51200
  s_waitcnt lgkmcnt(9)
  v_mfma_f32_16x16x32_bf16 v[160:163], a[172:175], a[144:147], v[160:163]
  buffer_load_dwordx4 a[88:91], v1, s[8:11], s75 offen offset:1024 sc1
  v_fmac_f32 v208, v16, v24
  v_fmac_f32 v209, v16, v25
  v_mfma_f32_16x16x32_bf16 v[164:167], a[172:175], a[148:151], v[164:167]
  ds_read_b64_tr_b16 a[160:161], v4 offset:53248
  v_fmac_f32 v210, v16, v26
  v_mfma_f32_16x16x32_bf16 v[164:167], a[168:171], a[132:135], v[164:167]
  s_add_u32 s75, s75, 65536
  v_fmac_f32 v211, v16, v27
  v_fmac_f32 v212, v18, v24
  v_mfma_f32_16x16x32_bf16 v[168:171], a[168:171], a[136:139], v[168:171]
  ds_read_b64_tr_b16 a[162:163], v4 offset:55296
  v_fmac_f32 v213, v18, v25
  v_mfma_f32_16x16x32_bf16 v[168:171], a[172:175], a[152:155], v[168:171]
  buffer_load_dwordx4 a[76:79], v1, s[8:11], s75 offen offset:0 sc1
  v_fmac_f32 v214, v18, v26
  v_fmac_f32 v215, v18, v27
  v_mfma_f32_16x16x32_bf16 v[172:175], a[172:175], a[156:159], v[172:175]
  ds_read_b64_tr_b16 a[172:173], v4 offset:57344
  v_fmac_f32 v216, v20, v24
HOP12:
  s_cbranch_execz WRET0
  v_mfma_f32_16x16x32_bf16 v[172:175], a[168:171], a[140:143], v[172:175]
  s_waitcnt lgkmcnt(6)
  v_fmac_f32 v217, v20, v25
  v_fmac_f32 v218, v20, v26
  v_mfma_f32_16x16x32_bf16 v[188:191], a[176:179], a[140:143], v[188:191]
  ds_read_b64_tr_b16 a[174:175], v4 offset:59392
  v_fmac_f32 v219, v20, v27
  v_mfma_f32_16x16x32_bf16 v[188:191], a[180:183], a[156:159], v[188:191]
  v_fmac_f32 v220, v22, v24
  v_fmac_f32 v221, v22, v25
  v_mfma_f32_16x16x32_bf16 v[184:187], a[180:183], a[152:155], v[184:187]
  ds_read_b64_tr_b16 a[168:169], v4 offset:61440
  v_fmac_f32 v222, v22, v26
  v_mfma_f32_16x16x32_bf16 v[184:187], a[176:179], a[136:139], v[184:187]
  buffer_load_dwordx4 a[92:95], v1, s[8:11], s75 offen offset:1024 sc1
  v_fmac_f32 v223, v22, v27
  v_mfma_f32_16x16x32_bf16 v[180:183], a[176:179], a[132:135], v[180:183]
  ds_read_b64_tr_b16 a[170:171], v4 offset:63488
  v_mfma_f32_16x16x32_bf16 v[180:183], a[180:183], a[148:151], v[180:183]
  s_mov_b32 s68, 5963776
  s_add_u32 s76, s24, 26624
  ds_read_b128 v[24:27], v12 offset:1600
  v_mfma_f32_16x16x32_bf16 v[176:179], a[180:183], a[144:147], v[176:179]
  ds_read_b64_tr_b16 a[180:181], v5 offset:49152
  s_waitcnt lgkmcnt(9)
  v_mfma_f32_16x16x32_bf16 v[176:179], a[176:179], a[128:131], v[176:179]
  s_waitcnt lgkmcnt(6)
  buffer_load_dwordx4 a[96:99], v1, s[8:11], s76 offen offset:0 sc1
  v_fmac_f32 v224, v16, v28
  v_mfma_f32_16x16x32_bf16 v[192:195], a[164:167], a[128:131], v[192:195]
  ds_read_b64_tr_b16 a[182:183], v5 offset:51200
  v_fmac_f32 v225, v16, v29
  v_mfma_f32_16x16x32_bf16 v[192:195], a[160:163], a[144:147], v[192:195]
  v_fmac_f32 v226, v16, v30
  v_fmac_f32 v227, v16, v31
  v_mfma_f32_16x16x32_bf16 v[196:199], a[160:163], a[148:151], v[196:199]
  ds_read_b64_tr_b16 a[176:177], v5 offset:53248
  v_fmac_f32 v228, v18, v28
  v_mfma_f32_16x16x32_bf16 v[196:199], a[164:167], a[132:135], v[196:199]
  v_fmac_f32 v229, v18, v29
  v_fmac_f32 v230, v18, v30
  v_mfma_f32_16x16x32_bf16 v[200:203], a[164:167], a[136:139], v[200:203]
  ds_read_b64_tr_b16 a[178:179], v5 offset:55296
  v_fmac_f32 v231, v18, v31
  v_mfma_f32_16x16x32_bf16 v[200:203], a[160:163], a[152:155], v[200:203]
  buffer_load_dwordx4 a[112:115], v1, s[8:11], s76 offen offset:1024 sc1
  v_fmac_f32 v232, v20, v28
  v_fmac_f32 v233, v20, v29
  v_mfma_f32_16x16x32_bf16 v[204:207], a[160:163], a[156:159], v[204:207]
  ds_read_b64_tr_b16 a[160:161], v5 offset:57344
  v_fmac_f32 v234, v20, v30
  v_mfma_f32_16x16x32_bf16 v[204:207], a[164:167], a[140:143], v[204:207]
  s_waitcnt lgkmcnt(6)
  s_add_u32 s76, s76, 65536
  v_fmac_f32 v235, v20, v31
  v_mfma_f32_16x16x32_bf16 v[220:223], a[172:175], a[140:143], v[220:223]
  ds_read_b64_tr_b16 a[162:163], v5 offset:59392
  v_fmac_f32 v236, v22, v28
  v_mfma_f32_16x16x32_bf16 v[220:223], a[168:171], a[156:159], v[220:223]
  buffer_load_dwordx4 a[100:103], v1, s[8:11], s76 offen offset:0 sc1
  v_fmac_f32 v237, v22, v29
  v_fmac_f32 v238, v22, v30
  v_mfma_f32_16x16x32_bf16 v[216:219], a[168:171], a[152:155], v[216:219]
  ds_read_b64_tr_b16 a[164:165], v5 offset:61440
  v_fmac_f32 v239, v22, v31
  v_mfma_f32_16x16x32_bf16 v[216:219], a[172:175], a[136:139], v[216:219]
  ds_read_b128 v[28:31], v12 offset:128
  s_waitcnt lgkmcnt(8)
  v_mfma_f32_16x16x32_bf16 v[212:215], a[172:175], a[132:135], v[212:215]
  ds_read_b64_tr_b16 a[166:167], v5 offset:63488
  v_fmac_f32 v176, v17, v24
  v_mfma_f32_16x16x32_bf16 v[212:215], a[168:171], a[148:151], v[212:215]
  s_waitcnt vmcnt(32)
  s_barrier
  v_mfma_f32_16x16x32_bf16 v[208:211], a[168:171], a[144:147], v[208:211]
  ds_read_b64_tr_b16 a[168:169], v6 offset:16384
  s_add_u32 s61, s91, 2048
  v_mfma_f32_16x16x32_bf16 v[208:211], a[172:175], a[128:131], v[208:211]
  s_waitcnt lgkmcnt(6)
  buffer_load_dword a253, v13, s[36:39], s61 offen
  v_fmac_f32 v177, v17, v25
  v_mfma_f32_16x16x32_bf16 v[224:227], a[180:183], a[128:131], v[224:227]
  ds_read_b64_tr_b16 a[170:171], v6 offset:18432
  v_fmac_f32 v178, v17, v26
  v_mfma_f32_16x16x32_bf16 v[224:227], a[176:179], a[144:147], v[224:227]
  v_fmac_f32 v179, v17, v27
  v_fmac_f32 v180, v19, v24
  v_mfma_f32_16x16x32_bf16 v[228:231], a[176:179], a[148:151], v[228:231]
  ds_read_b64_tr_b16 a[172:173], v6 offset:20480
  v_fmac_f32 v181, v19, v25
  v_mfma_f32_16x16x32_bf16 v[228:231], a[180:183], a[132:135], v[228:231]
  v_fmac_f32 v182, v19, v26
  v_fmac_f32 v183, v19, v27
  v_mfma_f32_16x16x32_bf16 v[232:235], a[180:183], a[136:139], v[232:235]
  ds_read_b64_tr_b16 a[174:175], v6 offset:22528
  v_fmac_f32 v184, v21, v24
  v_mfma_f32_16x16x32_bf16 v[232:235], a[176:179], a[152:155], v[232:235]
  v_fmac_f32 v185, v21, v25
  v_fmac_f32 v186, v21, v26
  v_mfma_f32_16x16x32_bf16 v[236:239], a[176:179], a[156:159], v[236:239]
  ds_read_b64_tr_b16 a[176:177], v6 offset:24576
  v_fmac_f32 v187, v21, v27
  v_mfma_f32_16x16x32_bf16 v[236:239], a[180:183], a[140:143], v[236:239]
  s_waitcnt lgkmcnt(5)
  s_add_u32 m0, s45, 114688
  v_fmac_f32 v188, v23, v24
  v_mfma_f32_16x16x32_bf16 v[252:255], a[160:163], a[140:143], v[252:255]
  ds_read_b64_tr_b16 a[178:179], v6 offset:26624
  v_fmac_f32 v189, v23, v25
  v_mfma_f32_16x16x32_bf16 v[252:255], a[164:167], a[156:159], v[252:255]
  buffer_load_dwordx4 v11, s[28:31], s68 offen lds
  v_fmac_f32 v190, v23, v26
  v_fmac_f32 v191, v23, v27
  v_mfma_f32_16x16x32_bf16 v[248:251], a[164:167], a[152:155], v[248:251]
  ds_read_b64_tr_b16 a[180:181], v6 offset:28672
  v_mfma_f32_16x16x32_bf16 v[248:251], a[160:163], a[136:139], v[248:251]
  s_add_u32 m0, s45, 122880
  ds_read_b128 v[24:27], v12 offset:1664
  v_mfma_f32_16x16x32_bf16 v[244:247], a[160:163], a[132:135], v[244:247]
  ds_read_b64_tr_b16 a[182:183], v6 offset:30720
  s_waitcnt lgkmcnt(10)
  v_mfma_f32_16x16x32_bf16 v[244:247], a[164:167], a[148:151], v[244:247]
  buffer_load_dwordx4 v11, s[32:35], s68 offen lds
  v_fmac_f32 v192, v16, v28
  v_fmac_f32 v193, v16, v29
  v_mfma_f32_16x16x32_bf16 v[240:243], a[164:167], a[144:147], v[240:243]
  ds_read_b64_tr_b16 a[164:165], v7 offset:16384
  v_fmac_f32 v194, v16, v30
  v_mfma_f32_16x16x32_bf16 v[240:243], a[160:163], a[128:131], v[240:243]
  s_waitcnt vmcnt(27) lgkmcnt(6)
  v_fmac_f32 v195, v16, v31
  v_fmac_f32 v196, v18, v28
  v_mfma_f32_16x16x32_bf16 v[64:67], a[168:171], a[0:3], v[64:67]
  ds_read_b64_tr_b16 a[166:167], v7 offset:18432
  v_fmac_f32 v197, v18, v29
  v_mfma_f32_16x16x32_bf16 v[64:67], a[172:175], a[16:19], v[64:67]
  s_add_u32 m0, s45, 118784
  s_add_u32 s60, s68, 229376
  v_fmac_f32 v198, v18, v30
  v_mfma_f32_16x16x32_bf16 v[68:71], a[172:175], a[20:23], v[68:71]
  ds_read_b64_tr_b16 a[160:161], v7 offset:20480
  v_fmac_f32 v199, v18, v31
  v_mfma_f32_16x16x32_bf16 v[68:71], a[168:171], a[4:7], v[68:71]
  buffer_load_dwordx4 v11, s[28:31], s60 offen lds
  v_fmac_f32 v200, v20, v28
  v_fmac_f32 v201, v20, v29
  v_mfma_f32_16x16x32_bf16 v[72:75], a[168:171], a[8:11], v[72:75]
  ds_read_b64_tr_b16 a[162:163], v7 offset:22528
  v_fmac_f32 v202, v20, v30
  v_mfma_f32_16x16x32_bf16 v[72:75], a[172:175], a[24:27], v[72:75]
  s_add_u32 m0, s45, 126976
  s_add_u32 s60, s68, 229376
  v_fmac_f32 v203, v20, v31
  v_mfma_f32_16x16x32_bf16 v[76:79], a[172:175], a[28:31], v[76:79]
  ds_read_b64_tr_b16 a[172:173], v7 offset:24576
  v_fmac_f32 v204, v22, v28
  v_mfma_f32_16x16x32_bf16 v[76:79], a[168:171], a[12:15], v[76:79]
  s_waitcnt lgkmcnt(5)
  buffer_load_dwordx4 v11, s[32:35], s60 offen lds
  v_fmac_f32 v205, v22, v29
  v_mfma_f32_16x16x32_bf16 v[92:95], a[176:179], a[12:15], v[92:95]
  ds_read_b64_tr_b16 a[174:175], v7 offset:26624
  v_fmac_f32 v206, v22, v30
  v_mfma_f32_16x16x32_bf16 v[92:95], a[180:183], a[28:31], v[92:95]
  v_fmac_f32 v207, v22, v31
  v_mfma_f32_16x16x32_bf16 v[88:91], a[180:183], a[24:27], v[88:91]
  ds_read_b64_tr_b16 a[168:169], v7 offset:28672
  v_mfma_f32_16x16x32_bf16 v[88:91], a[176:179], a[8:11], v[88:91]
  ds_read_b128 v[28:31], v12 offset:1216
  s_waitcnt lgkmcnt(9)
  v_mfma_f32_16x16x32_bf16 v[84:87], a[176:179], a[4:7], v[84:87]
  ds_read_b64_tr_b16 a[170:171], v7 offset:30720
  v_fmac_f32 v208, v17, v24
  v_mfma_f32_16x16x32_bf16 v[84:87], a[180:183], a[20:23], v[84:87]
  buffer_load_dwordx4 a[116:119], v1, s[8:11], s76 offen offset:1024 sc1
  v_fmac_f32 v209, v17, v25
  v_fmac_f32 v210, v17, v26
  v_mfma_f32_16x16x32_bf16 v[80:83], a[180:183], a[16:19], v[80:83]
  ds_read_b64_tr_b16 a[180:181], v8 offset:16384
  v_fmac_f32 v211, v17, v27
  v_mfma_f32_16x16x32_bf16 v[80:83], a[176:179], a[0:3], v[80:83]
  s_waitcnt lgkmcnt(6)
  s_add_u32 s76, s76, 65536
  v_fmac_f32 v212, v19, v24
  v_mfma_f32_16x16x32_bf16 v[96:99], a[164:167], a[0:3], v[96:99]
  ds_read_b64_tr_b16 a[182:183], v8 offset:18432
  v_fmac_f32 v213, v19, v25
  v_mfma_f32_16x16x32_bf16 v[96:99], a[160:163], a[16:19], v[96:99]
  buffer_load_dwordx4 a[104:107], v1, s[8:11], s76 offen offset:0 sc1
  v_fmac_f32 v214, v19, v26
  v_fmac_f32 v215, v19, v27
  v_mfma_f32_16x16x32_bf16 v[100:103], a[160:163], a[20:23], v[100:103]
  ds_read_b64_tr_b16 a[176:177], v8 offset:20480
  v_fmac_f32 v216, v21, v24
  v_mfma_f32_16x16x32_bf16 v[100:103], a[164:167], a[4:7], v[100:103]
  v_fmac_f32 v217, v21, v25
  v_fmac_f32 v218, v21, v26
  v_mfma_f32_16x16x32_bf16 v[104:107], a[164:167], a[8:11], v[104:107]
  ds_read_b64_tr_b16 a[178:179], v8 offset:22528
  v_fmac_f32 v219, v21, v27
  v_mfma_f32_16x16x32_bf16 v[104:107], a[160:163], a[24:27], v[104:107]
  v_fmac_f32 v220, v23, v24
  v_fmac_f32 v221, v23, v25
  v_mfma_f32_16x16x32_bf16 v[108:111], a[160:163], a[28:31], v[108:111]
  ds_read_b64_tr_b16 a[160:161], v8 offset:24576
  v_fmac_f32 v222, v23, v26
  v_mfma_f32_16x16x32_bf16 v[108:111], a[164:167], a[12:15], v[108:111]
  s_waitcnt lgkmcnt(5)
  buffer_load_dwordx4 a[120:123], v1, s[8:11], s76 offen offset:1024 sc1
  v_fmac_f32 v223, v23, v27
  v_mfma_f32_16x16x32_bf16 v[124:127], a[172:175], a[12:15], v[124:127]
  ds_read_b64_tr_b16 a[162:163], v8 offset:26624
  v_mfma_f32_16x16x32_bf16 v[124:127], a[168:171], a[28:31], v[124:127]
  s_add_u32 s76, s76, 65536
  ds_read_b128 v[24:27], v12 offset:1728
  v_mfma_f32_16x16x32_bf16 v[120:123], a[168:171], a[24:27], v[120:123]
  ds_read_b64_tr_b16 a[164:165], v8 offset:28672
  s_waitcnt lgkmcnt(9)
  v_mfma_f32_16x16x32_bf16 v[120:123], a[172:175], a[8:11], v[120:123]
  buffer_load_dwordx4 a[108:111], v1, s[8:11], s76 offen offset:0 sc1
  v_fmac_f32 v240, v16, v28
  v_fmac_f32 v241, v16, v29
  v_mfma_f32_16x16x32_bf16 v[116:119], a[172:175], a[4:7], v[116:119]
  ds_read_b64_tr_b16 a[166:167], v8 offset:30720
  v_fmac_f32 v242, v16, v30
  v_mfma_f32_16x16x32_bf16 v[116:119], a[168:171], a[20:23], v[116:119]
  v_fmac_f32 v243, v16, v31
  v_fmac_f32 v244, v18, v28
  v_mfma_f32_16x16x32_bf16 v[112:115], a[168:171], a[16:19], v[112:115]
  ds_read_b64_tr_b16 a[168:169], v6 offset:0
  v_fmac_f32 v245, v18, v29
  v_mfma_f32_16x16x32_bf16 v[112:115], a[172:175], a[0:3], v[112:115]
  s_waitcnt lgkmcnt(6)
  v_fmac_f32 v246, v18, v30
  v_fmac_f32 v247, v18, v31
  v_mfma_f32_16x16x32_bf16 v[32:35], a[180:183], a[0:3], v[32:35]
  ds_read_b64_tr_b16 a[170:171], v6 offset:2048
  v_fmac_f32 v248, v20, v28
  v_mfma_f32_16x16x32_bf16 v[32:35], a[176:179], a[16:19], v[32:35]
  buffer_load_dwordx4 a[124:127], v1, s[8:11], s76 offen offset:1024 sc1
  v_fmac_f32 v249, v20, v29
  v_fmac_f32 v250, v20, v30
  v_mfma_f32_16x16x32_bf16 v[36:39], a[176:179], a[20:23], v[36:39]
  ds_read_b64_tr_b16 a[172:173], v6 offset:4096
  v_fmac_f32 v251, v20, v31
  v_mfma_f32_16x16x32_bf16 v[36:39], a[180:183], a[4:7], v[36:39]
  s_mov_b32 s69, 6422528
  s_add_u32 s77, s24, 28672
  v_fmac_f32 v252, v22, v28
  v_fmac_f32 v253, v22, v29
  v_mfma_f32_16x16x32_bf16 v[40:43], a[180:183], a[8:11], v[40:43]
  ds_read_b64_tr_b16 a[174:175], v6 offset:6144
  v_fmac_f32 v254, v22, v30
  v_mfma_f32_16x16x32_bf16 v[40:43], a[176:179], a[24:27], v[40:43]
  buffer_load_dwordx4 a[128:131], v1, s[8:11], s77 offen offset:0 sc1
  v_fmac_f32 v255, v22, v31
  v_mfma_f32_16x16x32_bf16 v[44:47], a[176:179], a[28:31], v[44:47]
  ds_read_b64_tr_b16 a[176:177], v6 offset:8192
  s_waitcnt lgkmcnt(7)
  v_mfma_f32_16x16x32_bf16 v[44:47], a[180:183], a[12:15], v[44:47]
  s_waitcnt lgkmcnt(5)
  v_fmac_f32 v240, v17, v24
  v_fmac_f32 v241, v17, v25
  v_mfma_f32_16x16x32_bf16 v[60:63], a[160:163], a[12:15], v[60:63]
  ds_read_b64_tr_b16 a[178:179], v6 offset:10240
  v_fmac_f32 v242, v17, v26
  v_mfma_f32_16x16x32_bf16 v[60:63], a[164:167], a[28:31], v[60:63]
  v_fmac_f32 v243, v17, v27
  v_fmac_f32 v244, v19, v24
  v_mfma_f32_16x16x32_bf16 v[56:59], a[164:167], a[24:27], v[56:59]
  ds_read_b64_tr_b16 a[180:181], v6 offset:12288
  v_fmac_f32 v245, v19, v25
  v_mfma_f32_16x16x32_bf16 v[56:59], a[160:163], a[8:11], v[56:59]
  buffer_load_dwordx4 a[144:147], v1, s[8:11], s77 offen offset:1024 sc1
  v_fmac_f32 v246, v19, v26
  v_fmac_f32 v247, v19, v27
  v_mfma_f32_16x16x32_bf16 v[52:55], a[160:163], a[4:7], v[52:55]
  ds_read_b64_tr_b16 a[182:183], v6 offset:14336
  v_fmac_f32 v248, v21, v24
  v_mfma_f32_16x16x32_bf16 v[52:55], a[164:167], a[20:23], v[52:55]
  s_add_u32 s77, s77, 65536
  v_fmac_f32 v249, v21, v25
  v_fmac_f32 v250, v21, v26
  v_mfma_f32_16x16x32_bf16 v[48:51], a[164:167], a[16:19], v[48:51]
  ds_read_b64_tr_b16 a[164:165], v7 offset:0
  v_fmac_f32 v251, v21, v27
  v_mfma_f32_16x16x32_bf16 v[48:51], a[160:163], a[0:3], v[48:51]
  s_waitcnt vmcnt(28) lgkmcnt(5)
  buffer_load_dwordx4 a[132:135], v1, s[8:11], s77 offen offset:0 sc1
  v_fmac_f32 v252, v23, v24
  v_mfma_f32_16x16x32_bf16 v[64:67], a[168:171], a[32:35], v[64:67]
  ds_read_b64_tr_b16 a[166:167], v7 offset:2048
  v_fmac_f32 v253, v23, v25
  v_mfma_f32_16x16x32_bf16 v[64:67], a[172:175], a[48:51], v[64:67]
  v_fmac_f32 v254, v23, v26
  v_fmac_f32 v255, v23, v27
  v_mfma_f32_16x16x32_bf16 v[68:71], a[172:175], a[52:55], v[68:71]
  ds_read_b64_tr_b16 a[160:161], v7 offset:4096
  v_mfma_f32_16x16x32_bf16 v[68:71], a[168:171], a[36:39], v[68:71]
  s_add_u32 s61, s91, 4096
  ds_read_b128 v[28:31], v12 offset:896
  v_mfma_f32_16x16x32_bf16 v[72:75], a[168:171], a[40:43], v[72:75]
  ds_read_b64_tr_b16 a[162:163], v7 offset:6144
  v_mfma_f32_16x16x32_bf16 v[72:75], a[172:175], a[56:59], v[72:75]
  buffer_load_dword a253, v13, s[36:39], s61 offen
  v_rcp_f32 v16, v17
  v_mfma_f32_16x16x32_bf16 v[76:79], a[172:175], a[60:63], v[76:79]
  ds_read_b64_tr_b16 a[172:173], v7 offset:8192
  v_mfma_f32_16x16x32_bf16 v[76:79], a[168:171], a[44:47], v[76:79]
  s_waitcnt lgkmcnt(6)
  v_rcp_f32 v18, v19
  v_mfma_f32_16x16x32_bf16 v[92:95], a[176:179], a[44:47], v[92:95]
  ds_read_b64_tr_b16 a[174:175], v7 offset:10240
  v_mfma_f32_16x16x32_bf16 v[92:95], a[180:183], a[60:63], v[92:95]
  v_rcp_f32 v20, v21
  v_mfma_f32_16x16x32_bf16 v[88:91], a[180:183], a[56:59], v[88:91]
  ds_read_b64_tr_b16 a[168:169], v7 offset:12288
  v_mfma_f32_16x16x32_bf16 v[88:91], a[176:179], a[40:43], v[88:91]
  v_rcp_f32 v22, v23
  v_mfma_f32_16x16x32_bf16 v[84:87], a[176:179], a[36:39], v[84:87]
  ds_read_b64_tr_b16 a[170:171], v7 offset:14336
  v_mul_f32 v17, 0xbfb8aa3b, v17
  v_mfma_f32_16x16x32_bf16 v[84:87], a[180:183], a[52:55], v[84:87]
  v_mul_f32 v19, 0xbfb8aa3b, v19
  v_mul_f32 v21, 0xbfb8aa3b, v21
  v_mfma_f32_16x16x32_bf16 v[80:83], a[180:183], a[48:51], v[80:83]
  ds_read_b64_tr_b16 a[180:181], v8 offset:0
  v_mul_f32 v23, 0xbfb8aa3b, v23
  v_mfma_f32_16x16x32_bf16 v[80:83], a[176:179], a[32:35], v[80:83]
  s_waitcnt lgkmcnt(5)
  buffer_load_dwordx4 a[148:151], v1, s[8:11], s77 offen offset:1024 sc1
  v_mul_f32 v16, 0xbfb8aa3b, v16
  v_mfma_f32_16x16x32_bf16 v[96:99], a[164:167], a[32:35], v[96:99]
  ds_read_b64_tr_b16 a[182:183], v8 offset:2048
  v_mul_f32 v18, 0xbfb8aa3b, v18
  v_mfma_f32_16x16x32_bf16 v[96:99], a[160:163], a[48:51], v[96:99]
  s_add_u32 s77, s77, 65536
  v_mul_f32 v20, 0xbfb8aa3b, v20
  v_mul_f32 v22, 0xbfb8aa3b, v22
  v_mfma_f32_16x16x32_bf16 v[100:103], a[160:163], a[52:55], v[100:103]
  ds_read_b64_tr_b16 a[176:177], v8 offset:4096
  v_mfma_f32_16x16x32_bf16 v[100:103], a[164:167], a[36:39], v[100:103]
  buffer_load_dwordx4 a[136:139], v1, s[8:11], s77 offen offset:0 sc1
  v_mfma_f32_16x16x32_bf16 v[104:107], a[164:167], a[40:43], v[104:107]
  ds_read_b64_tr_b16 a[178:179], v8 offset:6144
  v_mfma_f32_16x16x32_bf16 v[104:107], a[160:163], a[56:59], v[104:107]
  v_mfma_f32_16x16x32_bf16 v[108:111], a[160:163], a[60:63], v[108:111]
  ds_read_b64_tr_b16 a[160:161], v8 offset:8192
  v_mfma_f32_16x16x32_bf16 v[108:111], a[164:167], a[44:47], v[108:111]
  s_waitcnt lgkmcnt(5)
  v_mfma_f32_16x16x32_bf16 v[124:127], a[172:175], a[44:47], v[124:127]
  ds_read_b64_tr_b16 a[162:163], v8 offset:10240
  v_mfma_f32_16x16x32_bf16 v[124:127], a[168:171], a[60:63], v[124:127]
  buffer_load_dwordx4 a[152:155], v1, s[8:11], s77 offen offset:1024 sc1
  v_mfma_f32_16x16x32_bf16 v[120:123], a[168:171], a[56:59], v[120:123]
  ds_read_b64_tr_b16 a[164:165], v8 offset:12288
  v_mfma_f32_16x16x32_bf16 v[120:123], a[172:175], a[40:43], v[120:123]
  s_add_u32 s77, s77, 65536
  v_mfma_f32_16x16x32_bf16 v[116:119], a[172:175], a[36:39], v[116:119]
  ds_read_b64_tr_b16 a[166:167], v8 offset:14336
  v_mfma_f32_16x16x32_bf16 v[116:119], a[168:171], a[52:55], v[116:119]
  buffer_load_dwordx4 a[140:143], v1, s[8:11], s77 offen offset:0 sc1
  v_mfma_f32_16x16x32_bf16 v[112:115], a[168:171], a[48:51], v[112:115]
  ds_read_b64_tr_b16 a[168:169], v2 offset:16384
  v_mfma_f32_16x16x32_bf16 v[112:115], a[172:175], a[32:35], v[112:115]
  s_waitcnt lgkmcnt(5)
  v_mfma_f32_16x16x32_bf16 v[32:35], a[180:183], a[32:35], v[32:35]
  ds_read_b64_tr_b16 a[170:171], v2 offset:18432
  v_mfma_f32_16x16x32_bf16 v[32:35], a[176:179], a[48:51], v[32:35]
  v_mfma_f32_16x16x32_bf16 v[36:39], a[176:179], a[52:55], v[36:39]
  ds_read_b64_tr_b16 a[172:173], v2 offset:20480
  v_mfma_f32_16x16x32_bf16 v[36:39], a[180:183], a[36:39], v[36:39]
  buffer_load_dwordx4 a[156:159], v1, s[8:11], s77 offen offset:1024 sc1
  v_mfma_f32_16x16x32_bf16 v[40:43], a[180:183], a[40:43], v[40:43]
  ds_read_b64_tr_b16 a[174:175], v2 offset:22528
  v_mfma_f32_16x16x32_bf16 v[40:43], a[176:179], a[56:59], v[40:43]
  s_mov_b32 s70, 6881280
  s_add_u32 s78, s24, 30720
  v_mfma_f32_16x16x32_bf16 v[44:47], a[176:179], a[60:63], v[44:47]
  ds_read_b64_tr_b16 a[176:177], v2 offset:24576
  v_mfma_f32_16x16x32_bf16 v[44:47], a[180:183], a[44:47], v[44:47]
  s_waitcnt lgkmcnt(5)
  buffer_load_dwordx4 a[188:191], v1, s[8:11], s78 offen offset:0 sc1
  v_mfma_f32_16x16x32_bf16 v[60:63], a[160:163], a[44:47], v[60:63]
  ds_read_b64_tr_b16 a[178:179], v2 offset:26624
  s_barrier
  v_mfma_f32_16x16x32_bf16 v[60:63], a[164:167], a[60:63], v[60:63]
  v_mfma_f32_16x16x32_bf16 v[56:59], a[164:167], a[56:59], v[56:59]
  ds_read_b64_tr_b16 a[180:181], v2 offset:28672
  v_mfma_f32_16x16x32_bf16 v[56:59], a[160:163], a[40:43], v[56:59]
  s_add_u32 m0, s45, 81920
  v_mfma_f32_16x16x32_bf16 v[52:55], a[160:163], a[36:39], v[52:55]
  ds_read_b64_tr_b16 a[182:183], v2 offset:30720
  v_mfma_f32_16x16x32_bf16 v[52:55], a[164:167], a[52:55], v[52:55]
  buffer_load_dwordx4 v11, s[28:31], s69 offen lds
  v_mfma_f32_16x16x32_bf16 v[48:51], a[164:167], a[48:51], v[48:51]
  ds_read_b64_tr_b16 a[164:165], v3 offset:16384
  v_mfma_f32_16x16x32_bf16 v[48:51], a[160:163], a[32:35], v[48:51]
  s_waitcnt lgkmcnt(5)
  s_add_u32 m0, s45, 90112
  v_mfma_f32_16x16x32_bf16 v[128:131], a[168:171], a[0:3], v[128:131]
  ds_read_b64_tr_b16 a[166:167], v3 offset:18432
  v_mfma_f32_16x16x32_bf16 v[128:131], a[172:175], a[16:19], v[128:131]
  buffer_load_dwordx4 v11, s[32:35], s69 offen lds
  v_mfma_f32_16x16x32_bf16 v[132:135], a[172:175], a[20:23], v[132:135]
  ds_read_b64_tr_b16 a[160:161], v3 offset:20480
  v_mfma_f32_16x16x32_bf16 v[132:135], a[168:171], a[4:7], v[132:135]
  v_mfma_f32_16x16x32_bf16 v[136:139], a[168:171], a[8:11], v[136:139]
  ds_read_b64_tr_b16 a[162:163], v3 offset:22528
  v_mfma_f32_16x16x32_bf16 v[136:139], a[172:175], a[24:27], v[136:139]
  s_add_u32 m0, s45, 86016
  s_add_u32 s60, s69, 229376
  v_mfma_f32_16x16x32_bf16 v[140:143], a[172:175], a[28:31], v[140:143]
  ds_read_b64_tr_b16 a[172:173], v3 offset:24576
  v_mfma_f32_16x16x32_bf16 v[140:143], a[168:171], a[12:15], v[140:143]
  s_waitcnt lgkmcnt(5)
  buffer_load_dwordx4 v11, s[28:31], s60 offen lds
  v_mfma_f32_16x16x32_bf16 v[156:159], a[176:179], a[12:15], v[156:159]
  ds_read_b64_tr_b16 a[174:175], v3 offset:26624
  v_mfma_f32_16x16x32_bf16 v[156:159], a[180:183], a[28:31], v[156:159]
  s_add_u32 m0, s45, 94208
  s_add_u32 s60, s69, 229376
  v_mfma_f32_16x16x32_bf16 v[152:155], a[180:183], a[24:27], v[152:155]
  ds_read_b64_tr_b16 a[168:169], v3 offset:28672
  v_mfma_f32_16x16x32_bf16 v[152:155], a[176:179], a[8:11], v[152:155]
  buffer_load_dwordx4 v11, s[32:35], s60 offen lds
  v_mfma_f32_16x16x32_bf16 v[148:151], a[176:179], a[4:7], v[148:151]
  ds_read_b64_tr_b16 a[170:171], v3 offset:30720
  v_mfma_f32_16x16x32_bf16 v[148:151], a[180:183], a[20:23], v[148:151]
  v_mfma_f32_16x16x32_bf16 v[144:147], a[180:183], a[16:19], v[144:147]
  ds_read_b64_tr_b16 a[180:181], v4 offset:16384
  v_mfma_f32_16x16x32_bf16 v[144:147], a[176:179], a[0:3], v[144:147]
  s_waitcnt lgkmcnt(5)
  s_add_u32 m0, s45, 65536
  v_mfma_f32_16x16x32_bf16 v[160:163], a[164:167], a[0:3], v[160:163]
  ds_read_b64_tr_b16 a[182:183], v4 offset:18432
  v_mfma_f32_16x16x32_bf16 v[160:163], a[160:163], a[16:19], v[160:163]
  buffer_load_dwordx4 v11, s[28:31], s70 offen lds
  v_mfma_f32_16x16x32_bf16 v[164:167], a[160:163], a[20:23], v[164:167]
  ds_read_b64_tr_b16 a[176:177], v4 offset:20480
  v_mfma_f32_16x16x32_bf16 v[164:167], a[164:167], a[4:7], v[164:167]
  s_add_u32 m0, s45, 73728
  v_mfma_f32_16x16x32_bf16 v[168:171], a[164:167], a[8:11], v[168:171]
  ds_read_b64_tr_b16 a[178:179], v4 offset:22528
  v_mfma_f32_16x16x32_bf16 v[168:171], a[160:163], a[24:27], v[168:171]
  buffer_load_dwordx4 v11, s[32:35], s70 offen lds
  v_mfma_f32_16x16x32_bf16 v[172:175], a[160:163], a[28:31], v[172:175]
  ds_read_b64_tr_b16 a[160:161], v4 offset:24576
  v_mfma_f32_16x16x32_bf16 v[172:175], a[164:167], a[12:15], v[172:175]
  s_waitcnt lgkmcnt(5)
  v_mfma_f32_16x16x32_bf16 v[188:191], a[172:175], a[12:15], v[188:191]
  ds_read_b64_tr_b16 a[162:163], v4 offset:26624
  v_mfma_f32_16x16x32_bf16 v[188:191], a[168:171], a[28:31], v[188:191]
  s_add_u32 m0, s45, 69632
  s_add_u32 s60, s70, 229376
  v_mfma_f32_16x16x32_bf16 v[184:187], a[168:171], a[24:27], v[184:187]
  ds_read_b64_tr_b16 a[164:165], v4 offset:28672
  v_mfma_f32_16x16x32_bf16 v[184:187], a[172:175], a[8:11], v[184:187]
  buffer_load_dwordx4 v11, s[28:31], s60 offen lds
  v_mfma_f32_16x16x32_bf16 v[180:183], a[172:175], a[4:7], v[180:183]
  ds_read_b64_tr_b16 a[166:167], v4 offset:30720
  v_mfma_f32_16x16x32_bf16 v[180:183], a[168:171], a[20:23], v[180:183]
  s_add_u32 m0, s45, 77824
  s_add_u32 s60, s70, 229376
  v_mfma_f32_16x16x32_bf16 v[176:179], a[168:171], a[16:19], v[176:179]
  ds_read_b64_tr_b16 a[168:169], v5 offset:16384
  v_mfma_f32_16x16x32_bf16 v[176:179], a[172:175], a[0:3], v[176:179]
  s_waitcnt lgkmcnt(5)
  buffer_load_dwordx4 v11, s[32:35], s60 offen lds
  v_mfma_f32_16x16x32_bf16 v[192:195], a[180:183], a[0:3], v[192:195]
  ds_read_b64_tr_b16 a[170:171], v5 offset:18432
  v_mfma_f32_16x16x32_bf16 v[192:195], a[176:179], a[16:19], v[192:195]
  v_mfma_f32_16x16x32_bf16 v[196:199], a[176:179], a[20:23], v[196:199]
  ds_read_b64_tr_b16 a[172:173], v5 offset:20480
  v_mfma_f32_16x16x32_bf16 v[196:199], a[180:183], a[4:7], v[196:199]
  s_add_u32 s61, s91, 6144
  v_mfma_f32_16x16x32_bf16 v[200:203], a[180:183], a[8:11], v[200:203]
  ds_read_b64_tr_b16 a[174:175], v5 offset:22528
  v_mfma_f32_16x16x32_bf16 v[200:203], a[176:179], a[24:27], v[200:203]
  buffer_load_dword a253, v13, s[36:39], s61 offen
  v_mfma_f32_16x16x32_bf16 v[204:207], a[176:179], a[28:31], v[204:207]
  ds_read_b64_tr_b16 a[176:177], v5 offset:24576
  v_mfma_f32_16x16x32_bf16 v[204:207], a[180:183], a[12:15], v[204:207]
  s_waitcnt lgkmcnt(5)
  v_mfma_f32_16x16x32_bf16 v[220:223], a[160:163], a[12:15], v[220:223]
  ds_read_b64_tr_b16 a[178:179], v5 offset:26624
  v_mfma_f32_16x16x32_bf16 v[220:223], a[164:167], a[28:31], v[220:223]
  v_mfma_f32_16x16x32_bf16 v[216:219], a[164:167], a[24:27], v[216:219]
  ds_read_b64_tr_b16 a[180:181], v5 offset:28672
  v_mfma_f32_16x16x32_bf16 v[216:219], a[160:163], a[8:11], v[216:219]
  v_mfma_f32_16x16x32_bf16 v[212:215], a[160:163], a[4:7], v[212:215]
  ds_read_b64_tr_b16 a[182:183], v5 offset:30720
  v_mfma_f32_16x16x32_bf16 v[212:215], a[164:167], a[20:23], v[212:215]
  s_waitcnt vmcnt(24)
  s_barrier
  v_mfma_f32_16x16x32_bf16 v[208:211], a[164:167], a[16:19], v[208:211]
  ds_read_b64_tr_b16 a[164:165], v8 offset:32768
  v_mfma_f32_16x16x32_bf16 v[208:211], a[160:163], a[0:3], v[208:211]
  s_waitcnt lgkmcnt(5)
  buffer_load_dwordx4 a[204:207], v1, s[8:11], s78 offen offset:1024 sc1
  v_mfma_f32_16x16x32_bf16 v[224:227], a[168:171], a[0:3], v[224:227]
  ds_read_b64_tr_b16 a[166:167], v8 offset:34816
  v_mfma_f32_16x16x32_bf16 v[224:227], a[172:175], a[16:19], v[224:227]
  s_add_u32 s78, s78, 65536
  v_mfma_f32_16x16x32_bf16 v[228:231], a[172:175], a[20:23], v[228:231]
  ds_read_b64_tr_b16 a[160:161], v8 offset:36864
  v_mfma_f32_16x16x32_bf16 v[228:231], a[168:171], a[4:7], v[228:231]
  buffer_load_dwordx4 a[192:195], v1, s[8:11], s78 offen offset:0 sc1
  v_mfma_f32_16x16x32_bf16 v[232:235], a[168:171], a[8:11], v[232:235]
  ds_read_b64_tr_b16 a[162:163], v8 offset:38912
  v_mfma_f32_16x16x32_bf16 v[232:235], a[172:175], a[24:27], v[232:235]
  v_mfma_f32_16x16x32_bf16 v[236:239], a[172:175], a[28:31], v[236:239]
  ds_read_b64_tr_b16 a[172:173], v8 offset:40960
  v_mfma_f32_16x16x32_bf16 v[236:239], a[168:171], a[12:15], v[236:239]
  s_waitcnt lgkmcnt(5)
  v_mfma_f32_16x16x32_bf16 v[252:255], a[176:179], a[12:15], v[252:255]
  ds_read_b64_tr_b16 a[174:175], v8 offset:43008
  v_mfma_f32_16x16x32_bf16 v[252:255], a[180:183], a[28:31], v[252:255]
  buffer_load_dwordx4 a[208:211], v1, s[8:11], s78 offen offset:1024 sc1
  v_mfma_f32_16x16x32_bf16 v[248:251], a[180:183], a[24:27], v[248:251]
  ds_read_b64_tr_b16 a[168:169], v8 offset:45056
  v_mfma_f32_16x16x32_bf16 v[248:251], a[176:179], a[8:11], v[248:251]
  s_add_u32 s78, s78, 65536
  v_mfma_f32_16x16x32_bf16 v[244:247], a[176:179], a[4:7], v[244:247]
  ds_read_b64_tr_b16 a[170:171], v8 offset:47104
  v_mfma_f32_16x16x32_bf16 v[244:247], a[180:183], a[20:23], v[244:247]
  buffer_load_dwordx4 a[196:199], v1, s[8:11], s78 offen offset:0 sc1
  v_mfma_f32_16x16x32_bf16 v[240:243], a[180:183], a[16:19], v[240:243]
  ds_read_b64_tr_b16 a[180:181], v8 offset:49152
  v_mfma_f32_16x16x32_bf16 v[240:243], a[176:179], a[0:3], v[240:243]
  s_waitcnt vmcnt(36) lgkmcnt(5)
  v_mfma_f32_16x16x32_bf16 v[32:35], a[164:167], a[64:67], v[32:35]
  ds_read_b64_tr_b16 a[182:183], v8 offset:51200
  v_mfma_f32_16x16x32_bf16 v[32:35], a[160:163], a[80:83], v[32:35]
  v_mfma_f32_16x16x32_bf16 v[36:39], a[160:163], a[84:87], v[36:39]
  ds_read_b64_tr_b16 a[176:177], v8 offset:53248
  v_mfma_f32_16x16x32_bf16 v[36:39], a[164:167], a[68:71], v[36:39]
  buffer_load_dwordx4 a[212:215], v1, s[8:11], s78 offen offset:1024 sc1
  v_mfma_f32_16x16x32_bf16 v[40:43], a[164:167], a[72:75], v[40:43]
  ds_read_b64_tr_b16 a[178:179], v8 offset:55296
  v_mfma_f32_16x16x32_bf16 v[40:43], a[160:163], a[88:91], v[40:43]
  s_add_u32 s78, s78, 65536
  v_mfma_f32_16x16x32_bf16 v[44:47], a[160:163], a[92:95], v[44:47]
  ds_read_b64_tr_b16 a[160:161], v8 offset:57344
  v_mfma_f32_16x16x32_bf16 v[44:47], a[164:167], a[76:79], v[44:47]
  s_waitcnt lgkmcnt(5)
  buffer_load_dwordx4 a[200:203], v1, s[8:11], s78 offen offset:0 sc1
  v_mfma_f32_16x16x32_bf16 v[60:63], a[172:175], a[76:79], v[60:63]
  ds_read_b64_tr_b16 a[162:163], v8 offset:59392
  v_mfma_f32_16x16x32_bf16 v[60:63], a[168:171], a[92:95], v[60:63]
  v_mfma_f32_16x16x32_bf16 v[56:59], a[168:171], a[88:91], v[56:59]
  ds_read_b64_tr_b16 a[164:165], v8 offset:61440
  v_mfma_f32_16x16x32_bf16 v[56:59], a[172:175], a[72:75], v[56:59]
  buffer_load_dwordx4 a[216:219], v1, s[8:11], s78 offen offset:1024 sc1
  v_mfma_f32_16x16x32_bf16 v[52:55], a[172:175], a[68:71], v[52:55]
  ds_read_b64_tr_b16 a[166:167], v8 offset:63488
  v_mfma_f32_16x16x32_bf16 v[52:55], a[168:171], a[84:87], v[52:55]
  s_waitcnt vmcnt(8)
  s_barrier
  v_mfma_f32_16x16x32_bf16 v[48:51], a[168:171], a[80:83], v[48:51]
  ds_read_b64_tr_b16 a[168:169], v8 offset:16384
  s_add_u32 m0, s45, 0
  v_mfma_f32_16x16x32_bf16 v[48:51], a[172:175], a[64:67], v[48:51]
  s_waitcnt vmcnt(26) lgkmcnt(5)
  buffer_load_dwordx4 v10, s[28:31], s66 offen lds
  v_mfma_f32_16x16x32_bf16 v[32:35], a[180:183], a[96:99], v[32:35]
  ds_read_b64_tr_b16 a[170:171], v8 offset:18432
  v_mfma_f32_16x16x32_bf16 v[32:35], a[176:179], a[112:115], v[32:35]
  s_add_u32 m0, s45, 8192
  v_mfma_f32_16x16x32_bf16 v[36:39], a[176:179], a[116:119], v[36:39]
  ds_read_b64_tr_b16 a[172:173], v8 offset:20480
  v_mfma_f32_16x16x32_bf16 v[36:39], a[180:183], a[100:103], v[36:39]
  buffer_load_dwordx4 v10, s[32:35], s66 offen lds
  v_mfma_f32_16x16x32_bf16 v[40:43], a[180:183], a[104:107], v[40:43]
  ds_read_b64_tr_b16 a[174:175], v8 offset:22528
  v_mfma_f32_16x16x32_bf16 v[40:43], a[176:179], a[120:123], v[40:43]
  s_add_u32 m0, s45, 4096
  s_add_u32 s60, s66, 229376
  v_mfma_f32_16x16x32_bf16 v[44:47], a[176:179], a[124:127], v[44:47]
  ds_read_b64_tr_b16 a[176:177], v8 offset:24576
  v_mfma_f32_16x16x32_bf16 v[44:47], a[180:183], a[108:111], v[44:47]
  s_waitcnt lgkmcnt(5)
  buffer_load_dwordx4 v10, s[28:31], s60 offen lds
  v_mfma_f32_16x16x32_bf16 v[60:63], a[160:163], a[108:111], v[60:63]
  ds_read_b64_tr_b16 a[178:179], v8 offset:26624
  v_mfma_f32_16x16x32_bf16 v[60:63], a[164:167], a[124:127], v[60:63]
  s_add_u32 m0, s45, 12288
HOP13:
  s_cbranch_execz WRET0
  s_add_u32 s60, s66, 229376
  v_mfma_f32_16x16x32_bf16 v[56:59], a[164:167], a[120:123], v[56:59]
  ds_read_b64_tr_b16 a[180:181], v8 offset:28672
  v_mfma_f32_16x16x32_bf16 v[56:59], a[160:163], a[104:107], v[56:59]
  buffer_load_dwordx4 v10, s[32:35], s60 offen lds
  v_mfma_f32_16x16x32_bf16 v[52:55], a[160:163], a[100:103], v[52:55]
  ds_read_b64_tr_b16 a[182:183], v8 offset:30720
  v_mfma_f32_16x16x32_bf16 v[52:55], a[164:167], a[116:119], v[52:55]
  s_add_u32 m0, s45, 32768
  v_mfma_f32_16x16x32_bf16 v[48:51], a[164:167], a[112:115], v[48:51]
  ds_read_b64_tr_b16 a[164:165], v8 offset:0
  v_mfma_f32_16x16x32_bf16 v[48:51], a[160:163], a[96:99], v[48:51]
  s_waitcnt vmcnt(21) lgkmcnt(5)
  buffer_load_dwordx4 v10, s[28:31], s67 offen lds
  v_mfma_f32_16x16x32_bf16 v[32:35], a[168:171], a[128:131], v[32:35]
  ds_read_b64_tr_b16 a[166:167], v8 offset:2048
  v_mfma_f32_16x16x32_bf16 v[32:35], a[172:175], a[144:147], v[32:35]
  s_add_u32 m0, s45, 40960
  v_mfma_f32_16x16x32_bf16 v[36:39], a[172:175], a[148:151], v[36:39]
  ds_read_b64_tr_b16 a[160:161], v8 offset:4096
  v_mfma_f32_16x16x32_bf16 v[36:39], a[168:171], a[132:135], v[36:39]
  buffer_load_dwordx4 v10, s[32:35], s67 offen lds
  v_mfma_f32_16x16x32_bf16 v[40:43], a[168:171], a[136:139], v[40:43]
  ds_read_b64_tr_b16 a[162:163], v8 offset:6144
  v_mfma_f32_16x16x32_bf16 v[40:43], a[172:175], a[152:155], v[40:43]
  s_add_u32 m0, s45, 36864
  s_add_u32 s60, s67, 229376
  v_mfma_f32_16x16x32_bf16 v[44:47], a[172:175], a[156:159], v[44:47]
  ds_read_b64_tr_b16 a[172:173], v8 offset:8192
  v_mfma_f32_16x16x32_bf16 v[44:47], a[168:171], a[140:143], v[44:47]
  s_waitcnt lgkmcnt(5)
  buffer_load_dwordx4 v10, s[28:31], s60 offen lds
  v_mfma_f32_16x16x32_bf16 v[60:63], a[176:179], a[140:143], v[60:63]
  ds_read_b64_tr_b16 a[174:175], v8 offset:10240
  v_mfma_f32_16x16x32_bf16 v[60:63], a[180:183], a[156:159], v[60:63]
  s_add_u32 m0, s45, 45056
  s_add_u32 s60, s67, 229376
  v_mfma_f32_16x16x32_bf16 v[56:59], a[180:183], a[152:155], v[56:59]
  ds_read_b64_tr_b16 a[168:169], v8 offset:12288
  v_mfma_f32_16x16x32_bf16 v[56:59], a[176:179], a[136:139], v[56:59]
  buffer_load_dwordx4 v10, s[32:35], s60 offen lds
  v_mfma_f32_16x16x32_bf16 v[52:55], a[176:179], a[132:135], v[52:55]
  ds_read_b64_tr_b16 a[170:171], v8 offset:14336
  v_mfma_f32_16x16x32_bf16 v[52:55], a[180:183], a[148:151], v[52:55]
  s_add_u32 s61, s91, 8192
  v_mfma_f32_16x16x32_bf16 v[48:51], a[180:183], a[144:147], v[48:51]
  ds_read_b64_tr_b16 a[180:181], v6 offset:32768
  v_mfma_f32_16x16x32_bf16 v[48:51], a[176:179], a[128:131], v[48:51]
  s_waitcnt vmcnt(8) lgkmcnt(5)
  buffer_load_dword a253, v13, s[36:39], s61 offen
  v_mfma_f32_16x16x32_bf16 v[32:35], a[164:167], a[188:191], v[32:35]
  ds_read_b64_tr_b16 a[182:183], v6 offset:34816
  v_mfma_f32_16x16x32_bf16 v[32:35], a[160:163], a[204:207], v[32:35]
  v_mfma_f32_16x16x32_bf16 v[36:39], a[160:163], a[208:211], v[36:39]
  ds_read_b64_tr_b16 a[176:177], v6 offset:36864
  v_mfma_f32_16x16x32_bf16 v[36:39], a[164:167], a[192:195], v[36:39]
  v_mfma_f32_16x16x32_bf16 v[40:43], a[164:167], a[196:199], v[40:43]
  ds_read_b64_tr_b16 a[178:179], v6 offset:38912
  v_mfma_f32_16x16x32_bf16 v[40:43], a[160:163], a[212:215], v[40:43]
  s_add_u32 m0, s45, 49152
  v_mfma_f32_16x16x32_bf16 v[44:47], a[160:163], a[216:219], v[44:47]
  ds_read_b64_tr_b16 a[160:161], v6 offset:40960
  v_mfma_f32_16x16x32_bf16 v[44:47], a[164:167], a[200:203], v[44:47]
  s_waitcnt lgkmcnt(5)
  buffer_load_dwordx4 v10, s[28:31], s68 offen lds
  v_mfma_f32_16x16x32_bf16 v[60:63], a[172:175], a[200:203], v[60:63]
  ds_read_b64_tr_b16 a[162:163], v6 offset:43008
  v_mfma_f32_16x16x32_bf16 v[60:63], a[168:171], a[216:219], v[60:63]
  s_add_u32 m0, s45, 57344
  v_mfma_f32_16x16x32_bf16 v[56:59], a[168:171], a[212:215], v[56:59]
  ds_read_b64_tr_b16 a[164:165], v6 offset:45056
  v_mfma_f32_16x16x32_bf16 v[56:59], a[172:175], a[196:199], v[56:59]
  buffer_load_dwordx4 v10, s[32:35], s68 offen lds
  v_mfma_f32_16x16x32_bf16 v[52:55], a[172:175], a[192:195], v[52:55]
  ds_read_b64_tr_b16 a[166:167], v6 offset:47104
  v_mfma_f32_16x16x32_bf16 v[52:55], a[168:171], a[208:211], v[52:55]
  s_add_u32 m0, s45, 53248
  s_add_u32 s60, s68, 229376
  v_mfma_f32_16x16x32_bf16 v[48:51], a[168:171], a[204:207], v[48:51]
  ds_read_b64_tr_b16 a[168:169], v6 offset:49152
  v_mfma_f32_16x16x32_bf16 v[48:51], a[172:175], a[188:191], v[48:51]
  s_waitcnt lgkmcnt(5)
  buffer_load_dwordx4 v10, s[28:31], s60 offen lds
  v_mfma_f32_16x16x32_bf16 v[64:67], a[180:183], a[64:67], v[64:67]
  ds_read_b64_tr_b16 a[170:171], v6 offset:51200
  v_mfma_f32_16x16x32_bf16 v[64:67], a[176:179], a[80:83], v[64:67]
  s_add_u32 m0, s45, 61440
  s_add_u32 s60, s68, 229376
  v_mfma_f32_16x16x32_bf16 v[68:71], a[176:179], a[84:87], v[68:71]
  ds_read_b64_tr_b16 a[172:173], v6 offset:53248
  s_waitcnt lgkmcnt(15)
  v_fma_f32 v32, v32, v16, v28
  v_mfma_f32_16x16x32_bf16 v[68:71], a[180:183], a[68:71], v[68:71]
  buffer_load_dwordx4 v10, s[32:35], s60 offen lds
  v_exp_f32 v24, v32
  v_fma_f32 v33, v33, v16, v29
  v_mfma_f32_16x16x32_bf16 v[72:75], a[180:183], a[72:75], v[72:75]
  ds_read_b64_tr_b16 a[174:175], v6 offset:55296
  v_exp_f32 v25, v33
  v_mfma_f32_16x16x32_bf16 v[72:75], a[176:179], a[88:91], v[72:75]
  s_add_u32 m0, s45, 16384
  v_fma_f32 v34, v34, v16, v30
  v_exp_f32 v26, v34
  v_mfma_f32_16x16x32_bf16 v[76:79], a[176:179], a[92:95], v[76:79]
  ds_read_b64_tr_b16 a[176:177], v6 offset:57344
  v_fma_f32 v35, v35, v16, v31
  v_mul_f32 v48, v32, v48
  v_mfma_f32_16x16x32_bf16 v[76:79], a[180:183], a[76:79], v[76:79]
  s_waitcnt lgkmcnt(5)
  buffer_load_dwordx4 v10, s[28:31], s69 offen lds
  v_exp_f32 v27, v35
  v_mfma_f32_16x16x32_bf16 v[92:95], a[160:163], a[76:79], v[92:95]
  ds_read_b64_tr_b16 a[178:179], v6 offset:59392
  v_mul_f32 v49, v33, v49
  v_mfma_f32_16x16x32_bf16 v[92:95], a[164:167], a[92:95], v[92:95]
  s_add_u32 m0, s45, 24576
  v_mul_f32 v50, v34, v50
  v_mul_f32 v51, v35, v51
  v_fma_f32 v24, v24, v17, v17
  v_mfma_f32_16x16x32_bf16 v[88:91], a[164:167], a[88:91], v[88:91]
  ds_read_b64_tr_b16 a[180:181], v6 offset:61440
  v_rcp_f32 v24, v24
  v_mfma_f32_16x16x32_bf16 v[88:91], a[160:163], a[72:75], v[88:91]
  buffer_load_dwordx4 v10, s[32:35], s69 offen lds
  v_fma_f32 v25, v25, v17, v17
  v_rcp_f32 v25, v25
  v_mfma_f32_16x16x32_bf16 v[84:87], a[160:163], a[68:71], v[84:87]
  ds_read_b64_tr_b16 a[182:183], v6 offset:63488
  v_fma_f32 v26, v26, v17, v17
  v_fma_f32 v27, v27, v17, v17
  v_mfma_f32_16x16x32_bf16 v[84:87], a[164:167], a[84:87], v[84:87]
  s_add_u32 m0, s45, 20480
  s_add_u32 s60, s69, 229376
  v_rcp_f32 v26, v26
  v_mfma_f32_16x16x32_bf16 v[80:83], a[164:167], a[80:83], v[80:83]
  ds_read_b64_tr_b16 a[164:165], v6 offset:16384
  v_rcp_f32 v27, v27
  v_mfma_f32_16x16x32_bf16 v[80:83], a[160:163], a[64:67], v[80:83]
  s_waitcnt lgkmcnt(5)
  buffer_load_dwordx4 v10, s[28:31], s60 offen lds
  v_mul_f32 v48, v48, v24
  v_mul_f32 v49, v49, v25
  v_mfma_f32_16x16x32_bf16 v[64:67], a[168:171], a[96:99], v[64:67]
  ds_read_b64_tr_b16 a[166:167], v6 offset:18432
  v_mul_f32 v50, v50, v26
  v_mfma_f32_16x16x32_bf16 v[64:67], a[172:175], a[112:115], v[64:67]
  s_add_u32 m0, s45, 28672
  s_add_u32 s60, s69, 229376
  v_mul_f32 v51, v51, v27
  v_cvt_pk_bf16_f32 v32, v48, v49
  v_mfma_f32_16x16x32_bf16 v[68:71], a[172:175], a[116:119], v[68:71]
  ds_read_b64_tr_b16 a[160:161], v6 offset:20480
  v_cvt_pk_bf16_f32 v33, v50, v51
  v_fma_f32 v36, v36, v18, v28
  v_mfma_f32_16x16x32_bf16 v[68:71], a[168:171], a[100:103], v[68:71]
  buffer_load_dwordx4 v10, s[32:35], s60 offen lds
  buffer_store_dwordx2 v[32:33], v1, s[8:11], s59 offen sc1
  v_mfma_f32_16x16x32_bf16 v[72:75], a[168:171], a[104:107], v[72:75]
  ds_read_b64_tr_b16 a[162:163], v6 offset:22528
  v_exp_f32 v24, v36
  v_mfma_f32_16x16x32_bf16 v[72:75], a[172:175], a[120:123], v[72:75]
  v_fma_f32 v37, v37, v18, v29
  v_exp_f32 v25, v37
  v_mfma_f32_16x16x32_bf16 v[76:79], a[172:175], a[124:127], v[76:79]
  ds_read_b64_tr_b16 a[172:173], v6 offset:24576
  v_fma_f32 v38, v38, v18, v30
  v_fma_f32 v39, v39, v18, v31
  v_mfma_f32_16x16x32_bf16 v[76:79], a[168:171], a[108:111], v[76:79]
  s_waitcnt lgkmcnt(5)
  v_exp_f32 v26, v38
  v_mul_f32 v52, v36, v52
  v_mfma_f32_16x16x32_bf16 v[92:95], a[176:179], a[108:111], v[92:95]
  ds_read_b64_tr_b16 a[174:175], v6 offset:26624
  v_mul_f32 v53, v37, v53
  v_mfma_f32_16x16x32_bf16 v[92:95], a[180:183], a[124:127], v[92:95]
  v_exp_f32 v27, v39
  v_mul_f32 v54, v38, v54
  v_mfma_f32_16x16x32_bf16 v[88:91], a[180:183], a[120:123], v[88:91]
  ds_read_b64_tr_b16 a[168:169], v6 offset:28672
  v_mul_f32 v55, v39, v55
  v_fma_f32 v24, v24, v19, v19
  v_mfma_f32_16x16x32_bf16 v[88:91], a[176:179], a[104:107], v[88:91]
  v_rcp_f32 v24, v24
  v_fma_f32 v25, v25, v19, v19
  v_mfma_f32_16x16x32_bf16 v[84:87], a[176:179], a[100:103], v[84:87]
  ds_read_b64_tr_b16 a[170:171], v6 offset:30720
  v_rcp_f32 v25, v25
  v_mfma_f32_16x16x32_bf16 v[84:87], a[180:183], a[116:119], v[84:87]
  v_fma_f32 v26, v26, v19, v19
  v_rcp_f32 v26, v26
  v_mfma_f32_16x16x32_bf16 v[80:83], a[180:183], a[112:115], v[80:83]
  ds_read_b64_tr_b16 a[180:181], v6 offset:0
  v_fma_f32 v27, v27, v19, v19
  v_mul_f32 v52, v52, v24
  v_mfma_f32_16x16x32_bf16 v[80:83], a[176:179], a[96:99], v[80:83]
  s_waitcnt lgkmcnt(5)
  v_rcp_f32 v27, v27
  v_mul_f32 v53, v53, v25
  v_mfma_f32_16x16x32_bf16 v[64:67], a[164:167], a[128:131], v[64:67]
  ds_read_b64_tr_b16 a[182:183], v6 offset:2048
  v_mul_f32 v54, v54, v26
  v_mfma_f32_16x16x32_bf16 v[64:67], a[160:163], a[144:147], v[64:67]
  v_mul_f32 v55, v55, v27
  v_cvt_pk_bf16_f32 v36, v52, v53
  v_cvt_pk_bf16_f32 v37, v54, v55
  v_mfma_f32_16x16x32_bf16 v[68:71], a[160:163], a[148:151], v[68:71]
  ds_read_b64_tr_b16 a[176:177], v6 offset:4096
  v_fma_f32 v40, v40, v20, v28
  v_fma_f32 v41, v41, v20, v29
  v_mfma_f32_16x16x32_bf16 v[68:71], a[164:167], a[132:135], v[68:71]
  s_add_u32 s55, s59, 262144
  buffer_store_dwordx2 v[36:37], v1, s[8:11], s55 offen sc1
  v_mfma_f32_16x16x32_bf16 v[72:75], a[164:167], a[136:139], v[72:75]
  ds_read_b64_tr_b16 a[178:179], v6 offset:6144
  s_add_u32 s61, s91, 10240
  v_fma_f32 v42, v42, v20, v30
  v_mfma_f32_16x16x32_bf16 v[72:75], a[160:163], a[152:155], v[72:75]
  buffer_load_dword a253, v13, s[36:39], s61 offen
  v_exp_f32 v24, v40
  v_fma_f32 v43, v43, v20, v31
  v_mfma_f32_16x16x32_bf16 v[76:79], a[160:163], a[156:159], v[76:79]
  ds_read_b64_tr_b16 a[160:161], v6 offset:8192
  v_exp_f32 v25, v41
  v_mfma_f32_16x16x32_bf16 v[76:79], a[164:167], a[140:143], v[76:79]
  s_waitcnt lgkmcnt(5)
  v_exp_f32 v26, v42
  v_mul_f32 v56, v40, v56
  v_mfma_f32_16x16x32_bf16 v[92:95], a[172:175], a[140:143], v[92:95]
  ds_read_b64_tr_b16 a[162:163], v6 offset:10240
  v_mul_f32 v57, v41, v57
  v_mfma_f32_16x16x32_bf16 v[92:95], a[168:171], a[156:159], v[92:95]
  v_exp_f32 v27, v43
  v_mul_f32 v58, v42, v58
  v_mfma_f32_16x16x32_bf16 v[88:91], a[168:171], a[152:155], v[88:91]
  ds_read_b64_tr_b16 a[164:165], v6 offset:12288
  v_mul_f32 v59, v43, v59
  v_fma_f32 v24, v24, v21, v21
  v_mfma_f32_16x16x32_bf16 v[88:91], a[172:175], a[136:139], v[88:91]
  v_rcp_f32 v24, v24
  v_fma_f32 v25, v25, v21, v21
  v_mfma_f32_16x16x32_bf16 v[84:87], a[172:175], a[132:135], v[84:87]
  ds_read_b64_tr_b16 a[166:167], v6 offset:14336
  v_rcp_f32 v25, v25
  v_mfma_f32_16x16x32_bf16 v[84:87], a[168:171], a[148:151], v[84:87]
  v_fma_f32 v26, v26, v21, v21
  v_rcp_f32 v26, v26
  v_mfma_f32_16x16x32_bf16 v[80:83], a[168:171], a[144:147], v[80:83]
  ds_read_b64_tr_b16 a[168:169], v7 offset:32768
  v_fma_f32 v27, v27, v21, v21
  v_mul_f32 v56, v56, v24
  v_mfma_f32_16x16x32_bf16 v[80:83], a[172:175], a[128:131], v[80:83]
  s_waitcnt lgkmcnt(5)
  v_rcp_f32 v27, v27
  v_mul_f32 v57, v57, v25
  v_mfma_f32_16x16x32_bf16 v[64:67], a[180:183], a[188:191], v[64:67]
  ds_read_b64_tr_b16 a[170:171], v7 offset:34816
  v_mul_f32 v58, v58, v26
  v_mfma_f32_16x16x32_bf16 v[64:67], a[176:179], a[204:207], v[64:67]
  v_mul_f32 v59, v59, v27
  v_cvt_pk_bf16_f32 v40, v56, v57
  v_cvt_pk_bf16_f32 v41, v58, v59
  v_mfma_f32_16x16x32_bf16 v[68:71], a[176:179], a[208:211], v[68:71]
  ds_read_b64_tr_b16 a[172:173], v7 offset:36864
  v_fma_f32 v44, v44, v22, v28
  v_fma_f32 v45, v45, v22, v29
  v_mfma_f32_16x16x32_bf16 v[68:71], a[180:183], a[192:195], v[68:71]
  s_add_u32 s55, s59, 524288
  buffer_store_dwordx2 v[40:41], v1, s[8:11], s55 offen sc1
  v_mfma_f32_16x16x32_bf16 v[72:75], a[180:183], a[196:199], v[72:75]
  ds_read_b64_tr_b16 a[174:175], v7 offset:38912
  v_exp_f32 v24, v44
  v_mfma_f32_16x16x32_bf16 v[72:75], a[176:179], a[212:215], v[72:75]
  v_exp_f32 v25, v45
  v_fma_f32 v46, v46, v22, v30
  v_mfma_f32_16x16x32_bf16 v[76:79], a[176:179], a[216:219], v[76:79]
  ds_read_b64_tr_b16 a[176:177], v7 offset:40960
  v_exp_f32 v26, v46
  v_mfma_f32_16x16x32_bf16 v[76:79], a[180:183], a[200:203], v[76:79]
  s_waitcnt lgkmcnt(5)
  v_fma_f32 v47, v47, v22, v31
  v_exp_f32 v27, v47
  v_mfma_f32_16x16x32_bf16 v[92:95], a[160:163], a[200:203], v[92:95]
  ds_read_b64_tr_b16 a[178:179], v7 offset:43008
  v_mul_f32 v60, v44, v60
  v_mfma_f32_16x16x32_bf16 v[92:95], a[164:167], a[216:219], v[92:95]
  v_mul_f32 v61, v45, v61
  v_mul_f32 v62, v46, v62
  v_mul_f32 v63, v47, v63
  v_mfma_f32_16x16x32_bf16 v[88:91], a[164:167], a[212:215], v[88:91]
  ds_read_b64_tr_b16 a[180:181], v7 offset:45056
  v_fma_f32 v24, v24, v23, v23
  v_fma_f32 v25, v25, v23, v23
  v_mfma_f32_16x16x32_bf16 v[88:91], a[160:163], a[196:199], v[88:91]
  v_rcp_f32 v24, v24
  v_fma_f32 v26, v26, v23, v23
  v_mfma_f32_16x16x32_bf16 v[84:87], a[160:163], a[192:195], v[84:87]
  ds_read_b64_tr_b16 a[182:183], v7 offset:47104
  v_rcp_f32 v25, v25
  v_mfma_f32_16x16x32_bf16 v[84:87], a[164:167], a[208:211], v[84:87]
  v_rcp_f32 v26, v26
  v_fma_f32 v27, v27, v23, v23
  v_mfma_f32_16x16x32_bf16 v[80:83], a[164:167], a[204:207], v[80:83]
  ds_read_b64_tr_b16 a[164:165], v7 offset:49152
  v_rcp_f32 v27, v27
  v_mfma_f32_16x16x32_bf16 v[80:83], a[160:163], a[188:191], v[80:83]
  s_waitcnt lgkmcnt(5)
  v_mul_f32 v60, v60, v24
  v_mul_f32 v61, v61, v25
  v_mul_f32 v62, v62, v26
  v_mfma_f32_16x16x32_bf16 v[96:99], a[168:171], a[64:67], v[96:99]
  ds_read_b64_tr_b16 a[166:167], v7 offset:51200
  v_mul_f32 v63, v63, v27
  v_mfma_f32_16x16x32_bf16 v[96:99], a[172:175], a[80:83], v[96:99]
  v_cvt_pk_bf16_f32 v44, v60, v61
  v_cvt_pk_bf16_f32 v45, v62, v63
  v_mfma_f32_16x16x32_bf16 v[100:103], a[172:175], a[84:87], v[100:103]
  ds_read_b64_tr_b16 a[160:161], v7 offset:53248
  ds_read_b128 v[60:63], v12 offset:768
  v_mfma_f32_16x16x32_bf16 v[100:103], a[168:171], a[68:71], v[100:103]
  s_add_u32 s55, s59, 786432
  buffer_store_dwordx2 v[44:45], v1, s[8:11], s55 offen sc1
  v_mfma_f32_16x16x32_bf16 v[104:107], a[168:171], a[72:75], v[104:107]
  ds_read_b64_tr_b16 a[162:163], v7 offset:55296
  v_mfma_f32_16x16x32_bf16 v[104:107], a[172:175], a[88:91], v[104:107]
  v_mfma_f32_16x16x32_bf16 v[108:111], a[172:175], a[92:95], v[108:111]
  ds_read_b64_tr_b16 a[172:173], v7 offset:57344
  v_mfma_f32_16x16x32_bf16 v[108:111], a[168:171], a[76:79], v[108:111]
  s_waitcnt lgkmcnt(6)
  v_mfma_f32_16x16x32_bf16 v[124:127], a[176:179], a[76:79], v[124:127]
  ds_read_b64_tr_b16 a[174:175], v7 offset:59392
  s_waitcnt lgkmcnt(3)
  v_fma_f32 v64, v64, v16, v60
  v_mfma_f32_16x16x32_bf16 v[124:127], a[180:183], a[92:95], v[124:127]
  v_exp_f32 v24, v64
  v_mfma_f32_16x16x32_bf16 v[120:123], a[180:183], a[88:91], v[120:123]
  ds_read_b64_tr_b16 a[168:169], v7 offset:61440
  v_fma_f32 v65, v65, v16, v61
  v_fma_f32 v66, v66, v16, v62
  v_mfma_f32_16x16x32_bf16 v[120:123], a[176:179], a[72:75], v[120:123]
  v_exp_f32 v25, v65
  v_mfma_f32_16x16x32_bf16 v[116:119], a[176:179], a[68:71], v[116:119]
  ds_read_b64_tr_b16 a[170:171], v7 offset:63488
  v_exp_f32 v26, v66
  v_mfma_f32_16x16x32_bf16 v[116:119], a[180:183], a[84:87], v[116:119]
  v_fma_f32 v67, v67, v16, v63
  v_fma_f32 v68, v68, v18, v60
  v_mfma_f32_16x16x32_bf16 v[112:115], a[180:183], a[80:83], v[112:115]
  ds_read_b64_tr_b16 a[180:181], v7 offset:16384
  v_exp_f32 v27, v67
  v_mfma_f32_16x16x32_bf16 v[112:115], a[176:179], a[64:67], v[112:115]
  s_waitcnt lgkmcnt(5)
  v_exp_f32 v28, v68
  v_fma_f32 v69, v69, v18, v61
  v_mfma_f32_16x16x32_bf16 v[96:99], a[164:167], a[96:99], v[96:99]
  ds_read_b64_tr_b16 a[182:183], v7 offset:18432
  v_fma_f32 v70, v70, v18, v62
  v_mfma_f32_16x16x32_bf16 v[96:99], a[160:163], a[112:115], v[96:99]
  v_exp_f32 v29, v69
  v_fma_f32 v71, v71, v18, v63
  v_mfma_f32_16x16x32_bf16 v[100:103], a[160:163], a[116:119], v[100:103]
  ds_read_b64_tr_b16 a[176:177], v7 offset:20480
  v_mul_f32 v80, v64, v80
  v_mfma_f32_16x16x32_bf16 v[100:103], a[164:167], a[100:103], v[100:103]
  v_mul_f32 v81, v65, v81
  v_mul_f32 v82, v66, v82
  v_mul_f32 v83, v67, v83
  v_mfma_f32_16x16x32_bf16 v[104:107], a[164:167], a[104:107], v[104:107]
  ds_read_b64_tr_b16 a[178:179], v7 offset:22528
  v_mul_f32 v84, v68, v84
  v_mfma_f32_16x16x32_bf16 v[104:107], a[160:163], a[120:123], v[104:107]
  v_lshrrev_b32 v48, 3, v0
  v_bfe_u32 v49, v48, 1, 2
  v_bfe_u32 v50, v0, 1, 2
  v_mfma_f32_16x16x32_bf16 v[108:111], a[160:163], a[124:127], v[108:111]
  ds_read_b64_tr_b16 a[160:161], v7 offset:24576
  v_xor_b32 v49, v49, v50
  v_mfma_f32_16x16x32_bf16 v[108:111], a[164:167], a[108:111], v[108:111]
  s_waitcnt lgkmcnt(5)
  v_lshlrev_b32 v49, 5, v49
  v_and_b32 v50, 1, v0
  v_lshl_add_u32 v49, v50, 4, v49
  v_mfma_f32_16x16x32_bf16 v[124:127], a[172:175], a[108:111], v[124:127]
  ds_read_b64_tr_b16 a[162:163], v7 offset:26624
  v_exp_f32 v30, v70
  v_mfma_f32_16x16x32_bf16 v[124:127], a[168:171], a[124:127], v[124:127]
  s_lshl_b32 s53, s44, 3
  v_exp_f32 v31, v71
  v_mfma_f32_16x16x32_bf16 v[120:123], a[168:171], a[120:123], v[120:123]
  ds_read_b64_tr_b16 a[164:165], v7 offset:28672
  v_add_u32 v48, s53, v48
  v_lshl_add_u32 v48, v48, 11, v49
  v_mfma_f32_16x16x32_bf16 v[120:123], a[172:175], a[104:107], v[120:123]
  s_mul_i32 s53, s52, 1835008
  s_lshl_b32 s54, s51, 7
  s_add_u32 s53, s53, s54
  v_mfma_f32_16x16x32_bf16 v[116:119], a[172:175], a[100:103], v[116:119]
  ds_read_b64_tr_b16 a[166:167], v7 offset:30720
  v_add_u32 v33, s53, v48
  v_xor_b32 v32, 128, v33
  v_mfma_f32_16x16x32_bf16 v[116:119], a[168:171], a[116:119], v[116:119]
  v_and_b32 v48, 3, v0
  v_bfe_u32 v49, v0, 2, 1
  v_mfma_f32_16x16x32_bf16 v[112:115], a[168:171], a[112:115], v[112:115]
  ds_read_b64_tr_b16 a[168:169], v7 offset:0
  v_lshl_add_u32 v48, v48, 3, v49
  v_lshlrev_b32 v37, 7, v48
  v_mfma_f32_16x16x32_bf16 v[112:115], a[172:175], a[96:99], v[112:115]
  s_waitcnt lgkmcnt(5)
  v_mul_f32 v85, v69, v85
  v_mul_f32 v86, v70, v86
  v_mul_f32 v87, v71, v87
  v_mfma_f32_16x16x32_bf16 v[96:99], a[180:183], a[128:131], v[96:99]
  ds_read_b64_tr_b16 a[170:171], v7 offset:2048
  v_fma_f32 v24, v24, v17, v17
  v_mfma_f32_16x16x32_bf16 v[96:99], a[176:179], a[144:147], v[96:99]
  v_rcp_f32 v24, v24
  v_fma_f32 v25, v25, v17, v17
  v_mfma_f32_16x16x32_bf16 v[100:103], a[176:179], a[148:151], v[100:103]
  ds_read_b64_tr_b16 a[172:173], v7 offset:4096
  v_fma_f32 v26, v26, v17, v17
  v_mfma_f32_16x16x32_bf16 v[100:103], a[180:183], a[132:135], v[100:103]
  v_rcp_f32 v25, v25
  v_fma_f32 v27, v27, v17, v17
  v_mfma_f32_16x16x32_bf16 v[104:107], a[180:183], a[136:139], v[104:107]
  ds_read_b64_tr_b16 a[174:175], v7 offset:6144
  v_fma_f32 v28, v28, v19, v19
  v_mfma_f32_16x16x32_bf16 v[104:107], a[176:179], a[152:155], v[104:107]
  v_rcp_f32 v26, v26
  v_fma_f32 v29, v29, v19, v19
  v_mfma_f32_16x16x32_bf16 v[108:111], a[176:179], a[156:159], v[108:111]
  ds_read_b64_tr_b16 a[176:177], v7 offset:8192
  v_fma_f32 v30, v30, v19, v19
  v_mfma_f32_16x16x32_bf16 v[108:111], a[180:183], a[140:143], v[108:111]
  s_waitcnt lgkmcnt(5)
  v_rcp_f32 v27, v27
  v_fma_f32 v31, v31, v19, v19
  v_mfma_f32_16x16x32_bf16 v[124:127], a[160:163], a[140:143], v[124:127]
  ds_read_b64_tr_b16 a[178:179], v7 offset:10240
  v_rcp_f32 v28, v28
  v_mfma_f32_16x16x32_bf16 v[124:127], a[164:167], a[156:159], v[124:127]
  v_rcp_f32 v29, v29
  v_mfma_f32_16x16x32_bf16 v[120:123], a[164:167], a[152:155], v[120:123]
  ds_read_b64_tr_b16 a[180:181], v7 offset:12288
  s_add_u32 s61, s91, 12288
  v_mul_f32 v80, v80, v24
  v_mfma_f32_16x16x32_bf16 v[120:123], a[160:163], a[136:139], v[120:123]
  buffer_load_dword a253, v13, s[36:39], s61 offen
  v_rcp_f32 v30, v30
  v_mfma_f32_16x16x32_bf16 v[116:119], a[160:163], a[132:135], v[116:119]
  ds_read_b64_tr_b16 a[182:183], v7 offset:14336
  v_rcp_f32 v31, v31
  v_mfma_f32_16x16x32_bf16 v[116:119], a[164:167], a[148:151], v[116:119]
  s_waitcnt vmcnt(19)
  s_barrier
  v_mfma_f32_16x16x32_bf16 v[112:115], a[164:167], a[144:147], v[112:115]
  ds_read_b64_tr_b16 a[164:165], v2 offset:0
  v_mul_f32 v81, v81, v25
  v_mul_f32 v82, v82, v26
  v_mfma_f32_16x16x32_bf16 v[112:115], a[160:163], a[128:131], v[112:115]
  s_waitcnt lgkmcnt(5)
  v_mul_f32 v83, v83, v27
  v_mul_f32 v84, v84, v28
  v_mul_f32 v85, v85, v29
  v_mfma_f32_16x16x32_bf16 v[96:99], a[168:171], a[188:191], v[96:99]
  ds_read_b64_tr_b16 a[166:167], v2 offset:2048
  v_mul_f32 v86, v86, v30
  v_mfma_f32_16x16x32_bf16 v[96:99], a[172:175], a[204:207], v[96:99]
  s_add_u32 m0, s45, 98304
  v_mul_f32 v87, v87, v31
  v_cvt_pk_bf16_f32 v64, v80, v81
  v_cvt_pk_bf16_f32 v65, v82, v83
  v_mfma_f32_16x16x32_bf16 v[100:103], a[172:175], a[208:211], v[100:103]
  ds_read_b64_tr_b16 a[160:161], v2 offset:4096
  v_cvt_pk_bf16_f32 v68, v84, v85
  v_mfma_f32_16x16x32_bf16 v[100:103], a[168:171], a[192:195], v[100:103]
  buffer_load_dwordx4 v10, s[28:31], s70 offen lds
  v_cvt_pk_bf16_f32 v69, v86, v87
  v_fma_f32 v72, v72, v20, v60
  v_fma_f32 v73, v73, v20, v61
  v_mfma_f32_16x16x32_bf16 v[104:107], a[168:171], a[196:199], v[104:107]
  ds_read_b64_tr_b16 a[162:163], v2 offset:6144
  v_fma_f32 v74, v74, v20, v62
  v_mfma_f32_16x16x32_bf16 v[104:107], a[172:175], a[212:215], v[104:107]
  s_add_u32 m0, s45, 106496
  v_exp_f32 v24, v72
  v_fma_f32 v75, v75, v20, v63
  v_mfma_f32_16x16x32_bf16 v[108:111], a[172:175], a[216:219], v[108:111]
  ds_read_b64_tr_b16 a[172:173], v2 offset:8192
  v_fma_f32 v76, v76, v22, v60
  v_mfma_f32_16x16x32_bf16 v[108:111], a[168:171], a[200:203], v[108:111]
  s_waitcnt lgkmcnt(5)
  buffer_load_dwordx4 v10, s[32:35], s70 offen lds
  v_exp_f32 v25, v73
  v_mfma_f32_16x16x32_bf16 v[124:127], a[176:179], a[200:203], v[124:127]
  ds_read_b64_tr_b16 a[174:175], v2 offset:10240
  s_waitcnt vmcnt(8)
  s_barrier
  v_mfma_f32_16x16x32_bf16 v[124:127], a[180:183], a[216:219], v[124:127]
  s_add_u32 m0, s45, 102400
  s_add_u32 s60, s70, 229376
  v_fma_f32 v77, v77, v22, v61
  v_mfma_f32_16x16x32_bf16 v[120:123], a[180:183], a[212:215], v[120:123]
  ds_read_b64_tr_b16 a[168:169], v2 offset:12288
  v_exp_f32 v26, v74
  v_mfma_f32_16x16x32_bf16 v[120:123], a[176:179], a[196:199], v[120:123]
  buffer_load_dwordx4 v10, s[28:31], s60 offen lds
  v_exp_f32 v27, v75
  v_mfma_f32_16x16x32_bf16 v[116:119], a[176:179], a[192:195], v[116:119]
  ds_read_b64_tr_b16 a[170:171], v2 offset:14336
  v_exp_f32 v28, v76
  v_mfma_f32_16x16x32_bf16 v[116:119], a[180:183], a[208:211], v[116:119]
  s_add_u32 m0, s45, 110592
  s_add_u32 s60, s70, 229376
  v_fma_f32 v78, v78, v22, v62
  v_mfma_f32_16x16x32_bf16 v[112:115], a[180:183], a[204:207], v[112:115]
  ds_read_b64_tr_b16 a[180:181], v3 offset:0
  v_exp_f32 v29, v77
  v_mfma_f32_16x16x32_bf16 v[112:115], a[176:179], a[188:191], v[112:115]
  s_waitcnt lgkmcnt(5)
  buffer_load_dwordx4 v10, s[32:35], s60 offen lds
  v_exp_f32 v30, v78
  v_mfma_f32_16x16x32_bf16 v[128:131], a[164:167], a[32:35], v[128:131]
  ds_read_b64_tr_b16 a[182:183], v3 offset:2048
  v_fma_f32 v79, v79, v22, v63
  v_mfma_f32_16x16x32_bf16 v[128:131], a[160:163], a[48:51], v[128:131]
  v_exp_f32 v31, v79
  v_mul_f32 v88, v72, v88
  v_mfma_f32_16x16x32_bf16 v[132:135], a[160:163], a[52:55], v[132:135]
  ds_read_b64_tr_b16 a[176:177], v3 offset:4096
  v_mul_f32 v89, v73, v89
  v_mfma_f32_16x16x32_bf16 v[132:135], a[164:167], a[36:39], v[132:135]
  ds_read_b128 v[60:63], v12 offset:832
  v_mul_f32 v90, v74, v90
  v_mul_f32 v91, v75, v91
  v_mfma_f32_16x16x32_bf16 v[136:139], a[164:167], a[40:43], v[136:139]
  ds_read_b64_tr_b16 a[178:179], v3 offset:6144
  v_mul_f32 v92, v76, v92
  v_mfma_f32_16x16x32_bf16 v[136:139], a[160:163], a[56:59], v[136:139]
  v_mul_f32 v93, v77, v93
  v_mul_f32 v94, v78, v94
  v_mul_f32 v95, v79, v95
  v_mfma_f32_16x16x32_bf16 v[140:143], a[160:163], a[60:63], v[140:143]
  ds_read_b64_tr_b16 a[160:161], v3 offset:8192
  v_fma_f32 v24, v24, v21, v21
  v_mfma_f32_16x16x32_bf16 v[140:143], a[164:167], a[44:47], v[140:143]
  s_waitcnt lgkmcnt(6)
  v_rcp_f32 v24, v24
  v_fma_f32 v25, v25, v21, v21
  v_mfma_f32_16x16x32_bf16 v[156:159], a[172:175], a[44:47], v[156:159]
  ds_read_b64_tr_b16 a[162:163], v3 offset:10240
  v_rcp_f32 v25, v25
  v_mfma_f32_16x16x32_bf16 v[156:159], a[168:171], a[60:63], v[156:159]
  v_fma_f32 v26, v26, v21, v21
  v_fma_f32 v27, v27, v21, v21
  v_mfma_f32_16x16x32_bf16 v[152:155], a[168:171], a[56:59], v[152:155]
  ds_read_b64_tr_b16 a[164:165], v3 offset:12288
  v_rcp_f32 v26, v26
  v_mfma_f32_16x16x32_bf16 v[152:155], a[172:175], a[40:43], v[152:155]
  v_rcp_f32 v27, v27
  v_mfma_f32_16x16x32_bf16 v[148:151], a[172:175], a[36:39], v[148:151]
  ds_read_b64_tr_b16 a[166:167], v3 offset:14336
  v_fma_f32 v28, v28, v23, v23
  v_fma_f32 v29, v29, v23, v23
  v_mfma_f32_16x16x32_bf16 v[148:151], a[168:171], a[52:55], v[148:151]
  v_rcp_f32 v28, v28
  v_mfma_f32_16x16x32_bf16 v[144:147], a[168:171], a[48:51], v[144:147]
  ds_read_b64_tr_b16 a[168:169], v4 offset:0
  v_rcp_f32 v29, v29
  v_mfma_f32_16x16x32_bf16 v[144:147], a[172:175], a[32:35], v[144:147]
  s_waitcnt lgkmcnt(5)
  v_fma_f32 v30, v30, v23, v23
  v_rcp_f32 v30, v30
  v_mfma_f32_16x16x32_bf16 v[160:163], a[180:183], a[32:35], v[160:163]
  ds_read_b64_tr_b16 a[170:171], v4 offset:2048
  v_fma_f32 v31, v31, v23, v23
  v_mfma_f32_16x16x32_bf16 v[160:163], a[176:179], a[48:51], v[160:163]
  v_rcp_f32 v31, v31
  v_mul_f32 v88, v88, v24
  v_mfma_f32_16x16x32_bf16 v[164:167], a[176:179], a[52:55], v[164:167]
  ds_read_b64_tr_b16 a[172:173], v4 offset:4096
  v_mul_f32 v89, v89, v25
  v_mfma_f32_16x16x32_bf16 v[164:167], a[180:183], a[36:39], v[164:167]
  v_mul_f32 v90, v90, v26
  v_mul_f32 v91, v91, v27
  v_mul_f32 v92, v92, v28
  v_mfma_f32_16x16x32_bf16 v[168:171], a[180:183], a[40:43], v[168:171]
  ds_read_b64_tr_b16 a[174:175], v4 offset:6144
  v_mul_f32 v93, v93, v29
  v_mfma_f32_16x16x32_bf16 v[168:171], a[176:179], a[56:59], v[168:171]
  v_mul_f32 v94, v94, v30
  v_mul_f32 v95, v95, v31
  v_cvt_pk_bf16_f32 v72, v88, v89
  v_mfma_f32_16x16x32_bf16 v[172:175], a[176:179], a[60:63], v[172:175]
  ds_read_b64_tr_b16 a[176:177], v4 offset:8192
  v_cvt_pk_bf16_f32 v73, v90, v91
HOP14:
  s_cbranch_execz WRET0
  v_mfma_f32_16x16x32_bf16 v[172:175], a[180:183], a[44:47], v[172:175]
  s_waitcnt lgkmcnt(5)
  v_cvt_pk_bf16_f32 v76, v92, v93
  v_cvt_pk_bf16_f32 v77, v94, v95
  v_mfma_f32_16x16x32_bf16 v[188:191], a[160:163], a[44:47], v[188:191]
  ds_read_b64_tr_b16 a[178:179], v4 offset:10240
  s_cmp_eq_u32 s90, 0
  s_cselect_b32 s71, 8, 1
  s_lshl_b32 s63, s71, 17
  s_lshl_b32 s71, s71, 11
  s_add_u32 s71, s71, s83
  s_add_u32 m0, s45, 114688
  s_waitcnt lgkmcnt(11)
  v_mfma_f32_16x16x32_bf16 v[188:191], a[164:167], a[60:63], v[188:191]
  buffer_load_dwordx4 v32, s[36:39], s63 offen lds
  v_fma_f32 v96, v96, v16, v60
  v_exp_f32 v24, v96
  v_mfma_f32_16x16x32_bf16 v[184:187], a[164:167], a[56:59], v[184:187]
  ds_read_b64_tr_b16 a[180:181], v4 offset:12288
  v_fma_f32 v97, v97, v16, v61
  v_fma_f32 v98, v98, v16, v62
  v_mfma_f32_16x16x32_bf16 v[184:187], a[160:163], a[40:43], v[184:187]
  s_add_u32 m0, s45, 118784
  s_add_u32 s60, s63, 65536
  v_exp_f32 v25, v97
  v_mfma_f32_16x16x32_bf16 v[180:183], a[160:163], a[36:39], v[180:183]
  ds_read_b64_tr_b16 a[182:183], v4 offset:14336
  v_exp_f32 v26, v98
  v_mfma_f32_16x16x32_bf16 v[180:183], a[164:167], a[52:55], v[180:183]
  buffer_load_dwordx4 v32, s[36:39], s60 offen lds
  v_fma_f32 v99, v99, v16, v63
  v_exp_f32 v27, v99
  v_mfma_f32_16x16x32_bf16 v[176:179], a[164:167], a[48:51], v[176:179]
  ds_read_b64_tr_b16 a[164:165], v5 offset:0
  v_fma_f32 v100, v100, v18, v60
  v_fma_f32 v101, v101, v18, v61
  v_mfma_f32_16x16x32_bf16 v[176:179], a[160:163], a[32:35], v[176:179]
  s_waitcnt lgkmcnt(5)
  s_add_u32 m0, s45, 122880
  v_exp_f32 v28, v100
  v_mfma_f32_16x16x32_bf16 v[192:195], a[168:171], a[32:35], v[192:195]
  ds_read_b64_tr_b16 a[166:167], v5 offset:2048
  v_fma_f32 v102, v102, v18, v62
  v_mfma_f32_16x16x32_bf16 v[192:195], a[172:175], a[48:51], v[192:195]
  buffer_load_dwordx4 v33, s[36:39], s63 offen lds
  v_exp_f32 v29, v101
  v_fma_f32 v103, v103, v18, v63
  v_mfma_f32_16x16x32_bf16 v[196:199], a[172:175], a[52:55], v[196:199]
  ds_read_b64_tr_b16 a[160:161], v5 offset:4096
  v_exp_f32 v30, v102
  v_mfma_f32_16x16x32_bf16 v[196:199], a[168:171], a[36:39], v[196:199]
  s_add_u32 m0, s45, 126976
  s_add_u32 s60, s63, 65536
  v_exp_f32 v31, v103
  v_mfma_f32_16x16x32_bf16 v[200:203], a[168:171], a[40:43], v[200:203]
  ds_read_b64_tr_b16 a[162:163], v5 offset:6144
  v_mul_f32 v112, v96, v112
  v_mul_f32 v113, v97, v113
  v_mfma_f32_16x16x32_bf16 v[200:203], a[172:175], a[56:59], v[200:203]
  buffer_load_dwordx4 v33, s[36:39], s60 offen lds
  v_mul_f32 v114, v98, v114
  v_mul_f32 v115, v99, v115
  v_mul_f32 v116, v100, v116
  v_mfma_f32_16x16x32_bf16 v[204:207], a[172:175], a[60:63], v[204:207]
  ds_read_b64_tr_b16 a[172:173], v5 offset:8192
  v_mul_f32 v117, v101, v117
  v_mul_f32 v118, v102, v118
  v_mfma_f32_16x16x32_bf16 v[204:207], a[168:171], a[44:47], v[204:207]
  s_waitcnt lgkmcnt(5)
  s_cmp_eq_u32 s90, 1
  s_cselect_b32 s72, 10, 3
  s_lshl_b32 s64, s72, 17
  s_lshl_b32 s72, s72, 11
  s_add_u32 s72, s72, s83
  s_add_u32 m0, s45, 81920
  v_mul_f32 v119, v103, v119
  v_fma_f32 v24, v24, v17, v17
  v_mfma_f32_16x16x32_bf16 v[220:223], a[176:179], a[44:47], v[220:223]
  ds_read_b64_tr_b16 a[174:175], v5 offset:10240
  v_rcp_f32 v24, v24
  v_mfma_f32_16x16x32_bf16 v[220:223], a[180:183], a[60:63], v[220:223]
  buffer_load_dwordx4 v32, s[36:39], s64 offen lds
  v_fma_f32 v25, v25, v17, v17
  v_rcp_f32 v25, v25
  v_mfma_f32_16x16x32_bf16 v[216:219], a[180:183], a[56:59], v[216:219]
  ds_read_b64_tr_b16 a[168:169], v5 offset:12288
  v_fma_f32 v26, v26, v17, v17
  v_fma_f32 v27, v27, v17, v17
  v_mfma_f32_16x16x32_bf16 v[216:219], a[176:179], a[40:43], v[216:219]
  s_add_u32 m0, s45, 86016
  s_add_u32 s60, s64, 65536
  v_rcp_f32 v26, v26
  v_mfma_f32_16x16x32_bf16 v[212:215], a[176:179], a[36:39], v[212:215]
  ds_read_b64_tr_b16 a[170:171], v5 offset:14336
  v_rcp_f32 v27, v27
  v_mfma_f32_16x16x32_bf16 v[212:215], a[180:183], a[52:55], v[212:215]
  buffer_load_dwordx4 v32, s[36:39], s60 offen lds
  v_fma_f32 v28, v28, v19, v19
  v_rcp_f32 v28, v28
  v_mfma_f32_16x16x32_bf16 v[208:211], a[180:183], a[48:51], v[208:211]
  ds_read_b64_tr_b16 a[180:181], v2 offset:32768
  v_fma_f32 v29, v29, v19, v19
  v_fma_f32 v30, v30, v19, v19
  v_mfma_f32_16x16x32_bf16 v[208:211], a[176:179], a[32:35], v[208:211]
  s_waitcnt lgkmcnt(5)
  s_add_u32 m0, s45, 90112
  v_rcp_f32 v29, v29
  v_mfma_f32_16x16x32_bf16 v[224:227], a[164:167], a[32:35], v[224:227]
  ds_read_b64_tr_b16 a[182:183], v2 offset:34816
  v_fma_f32 v31, v31, v19, v19
  v_mfma_f32_16x16x32_bf16 v[224:227], a[160:163], a[48:51], v[224:227]
  buffer_load_dwordx4 v33, s[36:39], s64 offen lds
  v_rcp_f32 v30, v30
  v_mul_f32 v112, v112, v24
  v_mfma_f32_16x16x32_bf16 v[228:231], a[160:163], a[52:55], v[228:231]
  ds_read_b64_tr_b16 a[176:177], v2 offset:36864
  v_rcp_f32 v31, v31
  v_mfma_f32_16x16x32_bf16 v[228:231], a[164:167], a[36:39], v[228:231]
  s_add_u32 m0, s45, 94208
  s_add_u32 s60, s64, 65536
  v_mul_f32 v113, v113, v25
  v_mul_f32 v114, v114, v26
  v_mfma_f32_16x16x32_bf16 v[232:235], a[164:167], a[40:43], v[232:235]
  ds_read_b64_tr_b16 a[178:179], v2 offset:38912
  v_mul_f32 v115, v115, v27
  v_mul_f32 v116, v116, v28
  v_mfma_f32_16x16x32_bf16 v[232:235], a[160:163], a[56:59], v[232:235]
  buffer_load_dwordx4 v33, s[36:39], s60 offen lds
  v_mul_f32 v117, v117, v29
  v_mul_f32 v118, v118, v30
  v_mul_f32 v119, v119, v31
  v_mfma_f32_16x16x32_bf16 v[236:239], a[160:163], a[60:63], v[236:239]
  ds_read_b64_tr_b16 a[160:161], v2 offset:40960
  v_cvt_pk_bf16_f32 v66, v112, v113
  v_cvt_pk_bf16_f32 v67, v114, v115
  v_mfma_f32_16x16x32_bf16 v[236:239], a[164:167], a[44:47], v[236:239]
  s_waitcnt lgkmcnt(5)
  s_cmp_eq_u32 s90, 2
  s_cselect_b32 s73, 12, 5
  s_lshl_b32 s65, s73, 17
  s_lshl_b32 s73, s73, 11
  s_add_u32 s73, s73, s83
  s_add_u32 m0, s45, 65536
  v_cvt_pk_bf16_f32 v70, v116, v117
  v_cvt_pk_bf16_f32 v71, v118, v119
  v_mfma_f32_16x16x32_bf16 v[252:255], a[172:175], a[44:47], v[252:255]
  ds_read_b64_tr_b16 a[162:163], v2 offset:43008
  v_fma_f32 v104, v104, v20, v60
  v_fma_f32 v105, v105, v20, v61
  v_mfma_f32_16x16x32_bf16 v[252:255], a[168:171], a[60:63], v[252:255]
  buffer_load_dwordx4 v32, s[36:39], s65 offen lds
  buffer_store_dwordx4 v[64:67], v1, s[8:11], s58 offen offset:0 sc1
  v_mfma_f32_16x16x32_bf16 v[248:251], a[168:171], a[56:59], v[248:251]
  ds_read_b64_tr_b16 a[164:165], v2 offset:45056
  v_exp_f32 v24, v104
  v_mfma_f32_16x16x32_bf16 v[248:251], a[172:175], a[40:43], v[248:251]
  s_add_u32 m0, s45, 69632
  s_add_u32 s60, s65, 65536
  v_exp_f32 v25, v105
  v_mfma_f32_16x16x32_bf16 v[244:247], a[172:175], a[36:39], v[244:247]
  ds_read_b64_tr_b16 a[166:167], v2 offset:47104
  s_add_u32 s55, s58, 262144
  buffer_store_dwordx4 v[68:71], v1, s[8:11], s55 offen offset:0 sc1
  v_mfma_f32_16x16x32_bf16 v[244:247], a[168:171], a[52:55], v[244:247]
  buffer_load_dwordx4 v32, s[36:39], s60 offen lds
  v_fma_f32 v106, v106, v20, v62
  v_exp_f32 v26, v106
  v_mfma_f32_16x16x32_bf16 v[240:243], a[168:171], a[48:51], v[240:243]
  ds_read_b64_tr_b16 a[168:169], v2 offset:49152
  v_fma_f32 v107, v107, v20, v63
  v_fma_f32 v108, v108, v22, v60
  v_mfma_f32_16x16x32_bf16 v[240:243], a[172:175], a[32:35], v[240:243]
  s_waitcnt lgkmcnt(5)
  s_add_u32 m0, s45, 73728
  v_exp_f32 v27, v107
  v_mfma_f32_16x16x32_bf16 v[128:131], a[180:183], a[64:67], v[128:131]
  ds_read_b64_tr_b16 a[170:171], v2 offset:51200
  v_fma_f32 v109, v109, v22, v61
  v_mfma_f32_16x16x32_bf16 v[128:131], a[176:179], a[80:83], v[128:131]
  buffer_load_dwordx4 v33, s[36:39], s65 offen lds
  v_exp_f32 v28, v108
  v_fma_f32 v110, v110, v22, v62
  v_mfma_f32_16x16x32_bf16 v[132:135], a[176:179], a[84:87], v[132:135]
  ds_read_b64_tr_b16 a[172:173], v2 offset:53248
  v_exp_f32 v29, v109
  v_mfma_f32_16x16x32_bf16 v[132:135], a[180:183], a[68:71], v[132:135]
  s_add_u32 m0, s45, 77824
  s_add_u32 s60, s65, 65536
  v_exp_f32 v30, v110
  v_mfma_f32_16x16x32_bf16 v[136:139], a[180:183], a[72:75], v[136:139]
  ds_read_b64_tr_b16 a[174:175], v2 offset:55296
  v_fma_f32 v111, v111, v22, v63
  v_mul_f32 v120, v104, v120
  v_mfma_f32_16x16x32_bf16 v[136:139], a[176:179], a[88:91], v[136:139]
  buffer_load_dwordx4 v33, s[36:39], s60 offen lds
  v_exp_f32 v31, v111
  v_mul_f32 v121, v105, v121
  v_mfma_f32_16x16x32_bf16 v[140:143], a[176:179], a[92:95], v[140:143]
  ds_read_b64_tr_b16 a[176:177], v2 offset:57344
  ds_read_b128 v[60:63], v12 offset:512
  v_mfma_f32_16x16x32_bf16 v[140:143], a[180:183], a[76:79], v[140:143]
  s_waitcnt lgkmcnt(6)
  v_mul_f32 v122, v106, v122
  v_mul_f32 v123, v107, v123
  v_mul_f32 v124, v108, v124
  v_mfma_f32_16x16x32_bf16 v[156:159], a[160:163], a[76:79], v[156:159]
  ds_read_b64_tr_b16 a[178:179], v2 offset:59392
  v_mul_f32 v125, v109, v125
  v_mul_f32 v126, v110, v126
  v_mfma_f32_16x16x32_bf16 v[156:159], a[164:167], a[92:95], v[156:159]
  v_mul_f32 v127, v111, v127
  v_fma_f32 v24, v24, v21, v21
  v_fma_f32 v25, v25, v21, v21
  v_mfma_f32_16x16x32_bf16 v[152:155], a[164:167], a[88:91], v[152:155]
  ds_read_b64_tr_b16 a[180:181], v2 offset:61440
  v_rcp_f32 v24, v24
  v_mfma_f32_16x16x32_bf16 v[152:155], a[160:163], a[72:75], v[152:155]
  v_rcp_f32 v25, v25
  v_fma_f32 v26, v26, v21, v21
  v_mfma_f32_16x16x32_bf16 v[148:151], a[160:163], a[68:71], v[148:151]
  ds_read_b64_tr_b16 a[182:183], v2 offset:63488
  v_rcp_f32 v26, v26
  v_mfma_f32_16x16x32_bf16 v[148:151], a[164:167], a[84:87], v[148:151]
  v_fma_f32 v27, v27, v21, v21
  v_rcp_f32 v27, v27
  v_mfma_f32_16x16x32_bf16 v[144:147], a[164:167], a[80:83], v[144:147]
  ds_read_b64_tr_b16 a[164:165], v2 offset:16384
  v_fma_f32 v28, v28, v23, v23
  v_fma_f32 v29, v29, v23, v23
  v_mfma_f32_16x16x32_bf16 v[144:147], a[160:163], a[64:67], v[144:147]
  s_waitcnt lgkmcnt(6)
  v_rcp_f32 v28, v28
  v_fma_f32 v30, v30, v23, v23
  v_mfma_f32_16x16x32_bf16 v[128:131], a[168:171], a[96:99], v[128:131]
  ds_read_b64_tr_b16 a[166:167], v2 offset:18432
  v_fma_f32 v31, v31, v23, v23
  v_mfma_f32_16x16x32_bf16 v[128:131], a[172:175], a[112:115], v[128:131]
  v_rcp_f32 v29, v29
  v_mul_f32 v120, v120, v24
  v_mfma_f32_16x16x32_bf16 v[132:135], a[172:175], a[116:119], v[132:135]
  ds_read_b64_tr_b16 a[160:161], v2 offset:20480
  v_rcp_f32 v30, v30
  v_mfma_f32_16x16x32_bf16 v[132:135], a[168:171], a[100:103], v[132:135]
  v_rcp_f32 v31, v31
  v_mul_f32 v121, v121, v25
  v_mfma_f32_16x16x32_bf16 v[136:139], a[168:171], a[104:107], v[136:139]
  ds_read_b64_tr_b16 a[162:163], v2 offset:22528
  v_mul_f32 v122, v122, v26
  v_mul_f32 v123, v123, v27
  v_mfma_f32_16x16x32_bf16 v[136:139], a[172:175], a[120:123], v[136:139]
  v_mul_f32 v124, v124, v28
  v_mul_f32 v125, v125, v29
  v_mul_f32 v126, v126, v30
  v_mfma_f32_16x16x32_bf16 v[140:143], a[172:175], a[124:127], v[140:143]
  ds_read_b64_tr_b16 a[172:173], v2 offset:24576
  v_mul_f32 v127, v127, v31
  v_cvt_pk_bf16_f32 v74, v120, v121
  v_mfma_f32_16x16x32_bf16 v[140:143], a[168:171], a[108:111], v[140:143]
  s_waitcnt lgkmcnt(5)
  v_cvt_pk_bf16_f32 v75, v122, v123
  v_cvt_pk_bf16_f32 v78, v124, v125
  v_cvt_pk_bf16_f32 v79, v126, v127
  v_mfma_f32_16x16x32_bf16 v[156:159], a[176:179], a[108:111], v[156:159]
  ds_read_b64_tr_b16 a[174:175], v2 offset:26624
  v_mfma_f32_16x16x32_bf16 v[156:159], a[180:183], a[124:127], v[156:159]
  s_add_u32 s55, s58, 524288
  buffer_store_dwordx4 v[72:75], v1, s[8:11], s55 offen offset:0 sc1
  v_mfma_f32_16x16x32_bf16 v[152:155], a[180:183], a[120:123], v[152:155]
  ds_read_b64_tr_b16 a[168:169], v2 offset:28672
  v_mfma_f32_16x16x32_bf16 v[152:155], a[176:179], a[104:107], v[152:155]
  s_add_u32 s55, s58, 786432
  buffer_store_dwordx4 v[76:79], v1, s[8:11], s55 offen offset:0 sc1
  v_mfma_f32_16x16x32_bf16 v[148:151], a[176:179], a[100:103], v[148:151]
  ds_read_b64_tr_b16 a[170:171], v2 offset:30720
  v_mfma_f32_16x16x32_bf16 v[148:151], a[180:183], a[116:119], v[148:151]
  s_waitcnt vmcnt(16)
  s_barrier
  v_mfma_f32_16x16x32_bf16 v[144:147], a[180:183], a[112:115], v[144:147]
  ds_read_b64_tr_b16 a[180:181], v6 offset:32768
  s_cmp_eq_u32 s90, 0
  s_cselect_b32 s74, 1, 8
  s_lshl_b32 s66, s74, 17
  s_lshl_b32 s74, s74, 11
  s_add_u32 s74, s74, s83
  s_add_u32 m0, s45, 0
  v_mfma_f32_16x16x32_bf16 v[144:147], a[176:179], a[96:99], v[144:147]
  s_waitcnt lgkmcnt(5)
  buffer_load_dwordx4 v32, s[36:39], s66 offen lds
  v_mfma_f32_16x16x32_bf16 v[128:131], a[164:167], a[128:131], v[128:131]
  ds_read_b64_tr_b16 a[182:183], v6 offset:34816
  v_mfma_f32_16x16x32_bf16 v[128:131], a[160:163], a[144:147], v[128:131]
  s_add_u32 m0, s45, 4096
  s_add_u32 s60, s66, 65536
  v_mfma_f32_16x16x32_bf16 v[132:135], a[160:163], a[148:151], v[132:135]
  ds_read_b64_tr_b16 a[176:177], v6 offset:36864
  v_mfma_f32_16x16x32_bf16 v[132:135], a[164:167], a[132:135], v[132:135]
  buffer_load_dwordx4 v32, s[36:39], s60 offen lds
  v_mfma_f32_16x16x32_bf16 v[136:139], a[164:167], a[136:139], v[136:139]
  ds_read_b64_tr_b16 a[178:179], v6 offset:38912
  v_mfma_f32_16x16x32_bf16 v[136:139], a[160:163], a[152:155], v[136:139]
  s_add_u32 m0, s45, 8192
  v_mfma_f32_16x16x32_bf16 v[140:143], a[160:163], a[156:159], v[140:143]
  ds_read_b64_tr_b16 a[160:161], v6 offset:40960
  v_mfma_f32_16x16x32_bf16 v[140:143], a[164:167], a[140:143], v[140:143]
  s_waitcnt lgkmcnt(5)
  buffer_load_dwordx4 v33, s[36:39], s66 offen lds
  v_mfma_f32_16x16x32_bf16 v[156:159], a[172:175], a[140:143], v[156:159]
  ds_read_b64_tr_b16 a[162:163], v6 offset:43008
  v_mfma_f32_16x16x32_bf16 v[156:159], a[168:171], a[156:159], v[156:159]
  s_add_u32 m0, s45, 12288
  s_add_u32 s60, s66, 65536
  v_mfma_f32_16x16x32_bf16 v[152:155], a[168:171], a[152:155], v[152:155]
  ds_read_b64_tr_b16 a[164:165], v6 offset:45056
  v_mfma_f32_16x16x32_bf16 v[152:155], a[172:175], a[136:139], v[152:155]
  buffer_load_dwordx4 v33, s[36:39], s60 offen lds
  v_mfma_f32_16x16x32_bf16 v[148:151], a[172:175], a[132:135], v[148:151]
  ds_read_b64_tr_b16 a[166:167], v6 offset:47104
  v_mfma_f32_16x16x32_bf16 v[148:151], a[168:171], a[148:151], v[148:151]
  v_mfma_f32_16x16x32_bf16 v[144:147], a[168:171], a[144:147], v[144:147]
  ds_read_b64_tr_b16 a[168:169], v3 offset:32768
  v_mfma_f32_16x16x32_bf16 v[144:147], a[172:175], a[128:131], v[144:147]
  s_waitcnt lgkmcnt(5)
  v_mfma_f32_16x16x32_bf16 v[128:131], a[180:183], a[188:191], v[128:131]
  ds_read_b64_tr_b16 a[170:171], v3 offset:34816
  v_mfma_f32_16x16x32_bf16 v[128:131], a[176:179], a[204:207], v[128:131]
  v_mfma_f32_16x16x32_bf16 v[132:135], a[176:179], a[208:211], v[132:135]
  ds_read_b64_tr_b16 a[172:173], v3 offset:36864
  v_mfma_f32_16x16x32_bf16 v[132:135], a[180:183], a[192:195], v[132:135]
  v_mfma_f32_16x16x32_bf16 v[136:139], a[180:183], a[196:199], v[136:139]
  ds_read_b64_tr_b16 a[174:175], v3 offset:38912
  v_mfma_f32_16x16x32_bf16 v[136:139], a[176:179], a[212:215], v[136:139]
  v_mfma_f32_16x16x32_bf16 v[140:143], a[176:179], a[216:219], v[140:143]
  ds_read_b64_tr_b16 a[176:177], v3 offset:40960
  v_mfma_f32_16x16x32_bf16 v[140:143], a[180:183], a[200:203], v[140:143]
  s_waitcnt lgkmcnt(5)
  v_mfma_f32_16x16x32_bf16 v[156:159], a[160:163], a[200:203], v[156:159]
  ds_read_b64_tr_b16 a[178:179], v3 offset:43008
  v_mfma_f32_16x16x32_bf16 v[156:159], a[164:167], a[216:219], v[156:159]
  v_mfma_f32_16x16x32_bf16 v[152:155], a[164:167], a[212:215], v[152:155]
  ds_read_b64_tr_b16 a[180:181], v3 offset:45056
  v_mfma_f32_16x16x32_bf16 v[152:155], a[160:163], a[196:199], v[152:155]
  v_mfma_f32_16x16x32_bf16 v[148:151], a[160:163], a[192:195], v[148:151]
  ds_read_b64_tr_b16 a[182:183], v3 offset:47104
  v_mfma_f32_16x16x32_bf16 v[148:151], a[164:167], a[208:211], v[148:151]
  v_mfma_f32_16x16x32_bf16 v[144:147], a[164:167], a[204:207], v[144:147]
  ds_read_b64_tr_b16 a[164:165], v3 offset:49152
  v_mfma_f32_16x16x32_bf16 v[144:147], a[160:163], a[188:191], v[144:147]
  s_waitcnt lgkmcnt(5)
  v_mfma_f32_16x16x32_bf16 v[160:163], a[168:171], a[64:67], v[160:163]
  ds_read_b64_tr_b16 a[166:167], v3 offset:51200
  v_mfma_f32_16x16x32_bf16 v[160:163], a[172:175], a[80:83], v[160:163]
  v_mfma_f32_16x16x32_bf16 v[164:167], a[172:175], a[84:87], v[164:167]
  ds_read_b64_tr_b16 a[160:161], v3 offset:53248
  s_waitcnt lgkmcnt(15)
  v_mfma_f32_16x16x32_bf16 v[164:167], a[168:171], a[68:71], v[164:167]
  v_fma_f32 v128, v128, v16, v60
  v_fma_f32 v129, v129, v16, v61
  v_mfma_f32_16x16x32_bf16 v[168:171], a[168:171], a[72:75], v[168:171]
  ds_read_b64_tr_b16 a[162:163], v3 offset:55296
  v_fma_f32 v130, v130, v16, v62
  v_mfma_f32_16x16x32_bf16 v[168:171], a[172:175], a[88:91], v[168:171]
  v_exp_f32 v24, v128
  v_mfma_f32_16x16x32_bf16 v[172:175], a[172:175], a[92:95], v[172:175]
  ds_read_b64_tr_b16 a[172:173], v3 offset:57344
  v_fma_f32 v131, v131, v16, v63
  v_mfma_f32_16x16x32_bf16 v[172:175], a[168:171], a[76:79], v[172:175]
  s_waitcnt lgkmcnt(5)
  v_exp_f32 v25, v129
  v_mfma_f32_16x16x32_bf16 v[188:191], a[176:179], a[76:79], v[188:191]
  ds_read_b64_tr_b16 a[174:175], v3 offset:59392
  v_fma_f32 v132, v132, v18, v60
  v_mfma_f32_16x16x32_bf16 v[188:191], a[180:183], a[92:95], v[188:191]
  v_exp_f32 v26, v130
  v_mfma_f32_16x16x32_bf16 v[184:187], a[180:183], a[88:91], v[184:187]
  ds_read_b64_tr_b16 a[168:169], v3 offset:61440
  v_fma_f32 v133, v133, v18, v61
  v_mfma_f32_16x16x32_bf16 v[184:187], a[176:179], a[72:75], v[184:187]
  v_exp_f32 v27, v131
  v_mfma_f32_16x16x32_bf16 v[180:183], a[176:179], a[68:71], v[180:183]
  ds_read_b64_tr_b16 a[170:171], v3 offset:63488
  v_fma_f32 v134, v134, v18, v62
  v_mfma_f32_16x16x32_bf16 v[180:183], a[180:183], a[84:87], v[180:183]
  v_exp_f32 v28, v132
  v_mfma_f32_16x16x32_bf16 v[176:179], a[180:183], a[80:83], v[176:179]
  ds_read_b64_tr_b16 a[180:181], v3 offset:16384
  v_fma_f32 v135, v135, v18, v63
  v_mfma_f32_16x16x32_bf16 v[176:179], a[176:179], a[64:67], v[176:179]
  s_waitcnt lgkmcnt(5)
  v_exp_f32 v29, v133
  v_mul_f32 v144, v128, v144
  v_mfma_f32_16x16x32_bf16 v[160:163], a[164:167], a[96:99], v[160:163]
  ds_read_b64_tr_b16 a[182:183], v3 offset:18432
  v_mul_f32 v145, v129, v145
  v_mfma_f32_16x16x32_bf16 v[160:163], a[160:163], a[112:115], v[160:163]
  v_exp_f32 v30, v134
  v_mfma_f32_16x16x32_bf16 v[164:167], a[160:163], a[116:119], v[164:167]
  ds_read_b64_tr_b16 a[176:177], v3 offset:20480
  v_mul_f32 v146, v130, v146
  v_mfma_f32_16x16x32_bf16 v[164:167], a[164:167], a[100:103], v[164:167]
  v_exp_f32 v31, v135
  v_mfma_f32_16x16x32_bf16 v[168:171], a[164:167], a[104:107], v[168:171]
  ds_read_b64_tr_b16 a[178:179], v3 offset:22528
  v_add_u32 v38, s46, v0
  s_waitcnt vmcnt(4)
  s_barrier
  s_mov_b64 exec, 1
  buffer_store_dword v38, v0, s[8:11], s79 offen offset:0 sc1
  s_mov_b64 exec, -1
  v_mfma_f32_16x16x32_bf16 v[168:171], a[160:163], a[120:123], v[168:171]
  v_mul_f32 v147, v131, v147
  v_mul_f32 v148, v132, v148
  v_mfma_f32_16x16x32_bf16 v[172:175], a[160:163], a[124:127], v[172:175]
  ds_read_b64_tr_b16 a[160:161], v3 offset:24576
  v_mul_f32 v149, v133, v149
  v_mfma_f32_16x16x32_bf16 v[172:175], a[164:167], a[108:111], v[172:175]
  s_waitcnt lgkmcnt(5)
  v_mul_f32 v150, v134, v150
  v_mul_f32 v151, v135, v151
  v_mfma_f32_16x16x32_bf16 v[188:191], a[172:175], a[108:111], v[188:191]
  ds_read_b64_tr_b16 a[162:163], v3 offset:26624
  v_fma_f32 v24, v24, v17, v17
  v_mfma_f32_16x16x32_bf16 v[188:191], a[168:171], a[124:127], v[188:191]
  v_rcp_f32 v24, v24
  v_mfma_f32_16x16x32_bf16 v[184:187], a[168:171], a[120:123], v[184:187]
  ds_read_b64_tr_b16 a[164:165], v3 offset:28672
  v_fma_f32 v25, v25, v17, v17
  v_mfma_f32_16x16x32_bf16 v[184:187], a[172:175], a[104:107], v[184:187]
  v_rcp_f32 v25, v25
  v_mfma_f32_16x16x32_bf16 v[180:183], a[172:175], a[100:103], v[180:183]
  ds_read_b64_tr_b16 a[166:167], v3 offset:30720
  v_fma_f32 v26, v26, v17, v17
  v_mfma_f32_16x16x32_bf16 v[180:183], a[168:171], a[116:119], v[180:183]
  v_rcp_f32 v26, v26
  v_mfma_f32_16x16x32_bf16 v[176:179], a[168:171], a[112:115], v[176:179]
  ds_read_b64_tr_b16 a[168:169], v7 offset:32768
  v_fma_f32 v27, v27, v17, v17
  v_mfma_f32_16x16x32_bf16 v[176:179], a[172:175], a[96:99], v[176:179]
  s_waitcnt lgkmcnt(5)
  v_rcp_f32 v27, v27
  v_fma_f32 v28, v28, v19, v19
  v_mfma_f32_16x16x32_bf16 v[160:163], a[180:183], a[128:131], v[160:163]
  ds_read_b64_tr_b16 a[170:171], v7 offset:34816
  v_fma_f32 v29, v29, v19, v19
  v_mfma_f32_16x16x32_bf16 v[160:163], a[176:179], a[144:147], v[160:163]
  v_rcp_f32 v28, v28
  v_mfma_f32_16x16x32_bf16 v[164:167], a[176:179], a[148:151], v[164:167]
  ds_read_b64_tr_b16 a[172:173], v7 offset:36864
  v_fma_f32 v30, v30, v19, v19
  v_mfma_f32_16x16x32_bf16 v[164:167], a[180:183], a[132:135], v[164:167]
  v_rcp_f32 v29, v29
  v_mfma_f32_16x16x32_bf16 v[168:171], a[180:183], a[136:139], v[168:171]
  ds_read_b64_tr_b16 a[174:175], v7 offset:38912
  v_fma_f32 v31, v31, v19, v19
  v_mfma_f32_16x16x32_bf16 v[168:171], a[176:179], a[152:155], v[168:171]
  v_rcp_f32 v30, v30
  v_mfma_f32_16x16x32_bf16 v[172:175], a[176:179], a[156:159], v[172:175]
  ds_read_b64_tr_b16 a[176:177], v7 offset:40960
  v_mul_f32 v144, v144, v24
  v_mfma_f32_16x16x32_bf16 v[172:175], a[180:183], a[140:143], v[172:175]
  s_waitcnt lgkmcnt(5)
  v_rcp_f32 v31, v31
  v_mfma_f32_16x16x32_bf16 v[188:191], a[160:163], a[140:143], v[188:191]
  ds_read_b64_tr_b16 a[178:179], v7 offset:43008
  v_mul_f32 v145, v145, v25
  v_mfma_f32_16x16x32_bf16 v[188:191], a[164:167], a[156:159], v[188:191]
  v_mul_f32 v146, v146, v26
  v_mul_f32 v147, v147, v27
  v_mfma_f32_16x16x32_bf16 v[184:187], a[164:167], a[152:155], v[184:187]
  ds_read_b64_tr_b16 a[180:181], v7 offset:45056
  v_mul_f32 v148, v148, v28
  v_mfma_f32_16x16x32_bf16 v[184:187], a[160:163], a[136:139], v[184:187]
  v_mul_f32 v149, v149, v29
  v_mul_f32 v150, v150, v30
  v_mfma_f32_16x16x32_bf16 v[180:183], a[160:163], a[132:135], v[180:183]
  ds_read_b64_tr_b16 a[182:183], v7 offset:47104
  v_mul_f32 v151, v151, v31
  v_mfma_f32_16x16x32_bf16 v[180:183], a[164:167], a[148:151], v[180:183]
  v_cvt_pk_bf16_f32 v128, v144, v145
  v_cvt_pk_bf16_f32 v129, v146, v147
  v_mfma_f32_16x16x32_bf16 v[176:179], a[164:167], a[144:147], v[176:179]
  ds_read_b64_tr_b16 a[164:165], v4 offset:32768
  v_cvt_pk_bf16_f32 v132, v148, v149
  v_mfma_f32_16x16x32_bf16 v[176:179], a[160:163], a[128:131], v[176:179]
  s_waitcnt lgkmcnt(5)
  v_cvt_pk_bf16_f32 v133, v150, v151
  v_fma_f32 v136, v136, v20, v60
  v_fma_f32 v137, v137, v20, v61
  v_mfma_f32_16x16x32_bf16 v[160:163], a[168:171], a[188:191], v[160:163]
  ds_read_b64_tr_b16 a[166:167], v4 offset:34816
  v_fma_f32 v138, v138, v20, v62
  v_mfma_f32_16x16x32_bf16 v[160:163], a[172:175], a[204:207], v[160:163]
  v_exp_f32 v24, v136
  v_mfma_f32_16x16x32_bf16 v[164:167], a[172:175], a[208:211], v[164:167]
  ds_read_b64_tr_b16 a[160:161], v4 offset:36864
  v_fma_f32 v139, v139, v20, v63
  v_mfma_f32_16x16x32_bf16 v[164:167], a[168:171], a[192:195], v[164:167]
  v_exp_f32 v25, v137
  v_mfma_f32_16x16x32_bf16 v[168:171], a[168:171], a[196:199], v[168:171]
  ds_read_b64_tr_b16 a[162:163], v4 offset:38912
  v_fma_f32 v140, v140, v22, v60
  v_mfma_f32_16x16x32_bf16 v[168:171], a[172:175], a[212:215], v[168:171]
  v_exp_f32 v26, v138
  v_mfma_f32_16x16x32_bf16 v[172:175], a[172:175], a[216:219], v[172:175]
  ds_read_b64_tr_b16 a[172:173], v4 offset:40960
  v_fma_f32 v141, v141, v22, v61
  v_mfma_f32_16x16x32_bf16 v[172:175], a[168:171], a[200:203], v[172:175]
  s_waitcnt lgkmcnt(5)
  v_exp_f32 v27, v139
  v_mfma_f32_16x16x32_bf16 v[188:191], a[176:179], a[200:203], v[188:191]
  ds_read_b64_tr_b16 a[174:175], v4 offset:43008
  v_fma_f32 v142, v142, v22, v62
  v_mfma_f32_16x16x32_bf16 v[188:191], a[180:183], a[216:219], v[188:191]
  v_exp_f32 v28, v140
  v_mfma_f32_16x16x32_bf16 v[184:187], a[180:183], a[212:215], v[184:187]
  ds_read_b64_tr_b16 a[168:169], v4 offset:45056
  v_fma_f32 v143, v143, v22, v63
  v_mfma_f32_16x16x32_bf16 v[184:187], a[176:179], a[196:199], v[184:187]
  v_exp_f32 v29, v141
  v_mfma_f32_16x16x32_bf16 v[180:183], a[176:179], a[192:195], v[180:183]
  ds_read_b64_tr_b16 a[170:171], v4 offset:47104
  v_mul_f32 v152, v136, v152
  v_mfma_f32_16x16x32_bf16 v[180:183], a[180:183], a[208:211], v[180:183]
  v_exp_f32 v30, v142
  v_mfma_f32_16x16x32_bf16 v[176:179], a[180:183], a[204:207], v[176:179]
  ds_read_b64_tr_b16 a[180:181], v4 offset:49152
  v_mul_f32 v153, v137, v153
  v_mfma_f32_16x16x32_bf16 v[176:179], a[176:179], a[188:191], v[176:179]
  s_waitcnt lgkmcnt(5)
  v_exp_f32 v31, v143
  v_mul_f32 v154, v138, v154
  v_mfma_f32_16x16x32_bf16 v[192:195], a[164:167], a[64:67], v[192:195]
  ds_read_b64_tr_b16 a[182:183], v4 offset:51200
  ds_read_b128 v[60:63], v12 offset:576
  v_mfma_f32_16x16x32_bf16 v[192:195], a[160:163], a[80:83], v[192:195]
  v_mul_f32 v155, v139, v155
  v_mul_f32 v156, v140, v156
  v_mfma_f32_16x16x32_bf16 v[196:199], a[160:163], a[84:87], v[196:199]
  ds_read_b64_tr_b16 a[176:177], v4 offset:53248
  v_mul_f32 v157, v141, v157
  v_mfma_f32_16x16x32_bf16 v[196:199], a[164:167], a[68:71], v[196:199]
  v_mul_f32 v158, v142, v158
  v_mul_f32 v159, v143, v159
  v_mfma_f32_16x16x32_bf16 v[200:203], a[164:167], a[72:75], v[200:203]
  ds_read_b64_tr_b16 a[178:179], v4 offset:55296
  v_fma_f32 v24, v24, v21, v21
  v_mfma_f32_16x16x32_bf16 v[200:203], a[160:163], a[88:91], v[200:203]
  v_rcp_f32 v24, v24
  v_mfma_f32_16x16x32_bf16 v[204:207], a[160:163], a[92:95], v[204:207]
  ds_read_b64_tr_b16 a[160:161], v4 offset:57344
  v_fma_f32 v25, v25, v21, v21
  v_mfma_f32_16x16x32_bf16 v[204:207], a[164:167], a[76:79], v[204:207]
  s_waitcnt lgkmcnt(6)
  v_rcp_f32 v25, v25
  v_mfma_f32_16x16x32_bf16 v[220:223], a[172:175], a[76:79], v[220:223]
  ds_read_b64_tr_b16 a[162:163], v4 offset:59392
  v_fma_f32 v26, v26, v21, v21
  v_mfma_f32_16x16x32_bf16 v[220:223], a[168:171], a[92:95], v[220:223]
  v_rcp_f32 v26, v26
  v_mfma_f32_16x16x32_bf16 v[216:219], a[168:171], a[88:91], v[216:219]
  ds_read_b64_tr_b16 a[164:165], v4 offset:61440
  v_fma_f32 v27, v27, v21, v21
  v_mfma_f32_16x16x32_bf16 v[216:219], a[172:175], a[72:75], v[216:219]
  v_rcp_f32 v27, v27
  v_mfma_f32_16x16x32_bf16 v[212:215], a[172:175], a[68:71], v[212:215]
  ds_read_b64_tr_b16 a[166:167], v4 offset:63488
  v_fma_f32 v28, v28, v23, v23
  v_mfma_f32_16x16x32_bf16 v[212:215], a[168:171], a[84:87], v[212:215]
  v_rcp_f32 v28, v28
  v_mfma_f32_16x16x32_bf16 v[208:211], a[168:171], a[80:83], v[208:211]
  ds_read_b64_tr_b16 a[168:169], v4 offset:16384
  v_fma_f32 v29, v29, v23, v23
  v_mfma_f32_16x16x32_bf16 v[208:211], a[172:175], a[64:67], v[208:211]
  s_waitcnt lgkmcnt(5)
  v_rcp_f32 v29, v29
  v_fma_f32 v30, v30, v23, v23
  v_mfma_f32_16x16x32_bf16 v[192:195], a[180:183], a[96:99], v[192:195]
  ds_read_b64_tr_b16 a[170:171], v4 offset:18432
  v_fma_f32 v31, v31, v23, v23
  v_mfma_f32_16x16x32_bf16 v[192:195], a[176:179], a[112:115], v[192:195]
  v_rcp_f32 v30, v30
  v_mfma_f32_16x16x32_bf16 v[196:199], a[176:179], a[116:119], v[196:199]
  ds_read_b64_tr_b16 a[172:173], v4 offset:20480
  v_mul_f32 v152, v152, v24
  v_mfma_f32_16x16x32_bf16 v[196:199], a[180:183], a[100:103], v[196:199]
  v_rcp_f32 v31, v31
  v_mfma_f32_16x16x32_bf16 v[200:203], a[180:183], a[104:107], v[200:203]
  ds_read_b64_tr_b16 a[174:175], v4 offset:22528
  v_mul_f32 v153, v153, v25
  v_mfma_f32_16x16x32_bf16 v[200:203], a[176:179], a[120:123], v[200:203]
  v_mul_f32 v154, v154, v26
  v_mul_f32 v155, v155, v27
  v_mfma_f32_16x16x32_bf16 v[204:207], a[176:179], a[124:127], v[204:207]
  ds_read_b64_tr_b16 a[176:177], v4 offset:24576
  v_mul_f32 v156, v156, v28
  v_mfma_f32_16x16x32_bf16 v[204:207], a[180:183], a[108:111], v[204:207]
  s_waitcnt lgkmcnt(5)
  v_mul_f32 v157, v157, v29
  v_mul_f32 v158, v158, v30
  v_mfma_f32_16x16x32_bf16 v[220:223], a[160:163], a[108:111], v[220:223]
  ds_read_b64_tr_b16 a[178:179], v4 offset:26624
  v_mul_f32 v159, v159, v31
  v_mfma_f32_16x16x32_bf16 v[220:223], a[164:167], a[124:127], v[220:223]
  v_cvt_pk_bf16_f32 v136, v152, v153
HOP15:
  s_cbranch_execz HOP19
  v_cvt_pk_bf16_f32 v137, v154, v155
  v_mfma_f32_16x16x32_bf16 v[216:219], a[164:167], a[120:123], v[216:219]
  ds_read_b64_tr_b16 a[180:181], v4 offset:28672
  v_cvt_pk_bf16_f32 v140, v156, v157
  v_mfma_f32_16x16x32_bf16 v[216:219], a[160:163], a[104:107], v[216:219]
  v_cvt_pk_bf16_f32 v141, v158, v159
  v_mfma_f32_16x16x32_bf16 v[212:215], a[160:163], a[100:103], v[212:215]
  ds_read_b64_tr_b16 a[182:183], v4 offset:30720
  s_lshl_b32 s82, s44, 28
  s_add_u32 s82, s82, s81
  buffer_load_dword v36, v37, s[8:11], s82 offen sc1
  v_mfma_f32_16x16x32_bf16 v[212:215], a[164:167], a[116:119], v[212:215]
  s_waitcnt lgkmcnt(14)
  v_fma_f32 v160, v160, v16, v60
  v_fma_f32 v161, v161, v16, v61
  v_mfma_f32_16x16x32_bf16 v[208:211], a[164:167], a[112:115], v[208:211]
  ds_read_b64_tr_b16 a[164:165], v8 offset:32768
  v_fma_f32 v162, v162, v16, v62
  v_mfma_f32_16x16x32_bf16 v[208:211], a[160:163], a[96:99], v[208:211]
  s_waitcnt lgkmcnt(5)
  v_exp_f32 v24, v160
  v_fma_f32 v163, v163, v16, v63
  v_mfma_f32_16x16x32_bf16 v[192:195], a[168:171], a[128:131], v[192:195]
  ds_read_b64_tr_b16 a[166:167], v8 offset:34816
  v_fma_f32 v164, v164, v18, v60
  v_mfma_f32_16x16x32_bf16 v[192:195], a[172:175], a[144:147], v[192:195]
  v_exp_f32 v25, v161
  v_mfma_f32_16x16x32_bf16 v[196:199], a[172:175], a[148:151], v[196:199]
  ds_read_b64_tr_b16 a[160:161], v8 offset:36864
  v_fma_f32 v165, v165, v18, v61
  v_mfma_f32_16x16x32_bf16 v[196:199], a[168:171], a[132:135], v[196:199]
  v_exp_f32 v26, v162
  v_fma_f32 v166, v166, v18, v62
  v_mfma_f32_16x16x32_bf16 v[200:203], a[168:171], a[136:139], v[200:203]
  ds_read_b64_tr_b16 a[162:163], v8 offset:38912
  v_fma_f32 v167, v167, v18, v63
  v_mfma_f32_16x16x32_bf16 v[200:203], a[172:175], a[152:155], v[200:203]
  v_exp_f32 v27, v163
  v_mfma_f32_16x16x32_bf16 v[204:207], a[172:175], a[156:159], v[204:207]
  ds_read_b64_tr_b16 a[172:173], v8 offset:40960
  v_mul_f32 v176, v160, v176
  v_mfma_f32_16x16x32_bf16 v[204:207], a[168:171], a[140:143], v[204:207]
  s_waitcnt lgkmcnt(5)
  v_exp_f32 v28, v164
  v_mul_f32 v177, v161, v177
  v_mfma_f32_16x16x32_bf16 v[220:223], a[176:179], a[140:143], v[220:223]
  ds_read_b64_tr_b16 a[174:175], v8 offset:43008
  v_mul_f32 v178, v162, v178
  v_mfma_f32_16x16x32_bf16 v[220:223], a[180:183], a[156:159], v[220:223]
  v_exp_f32 v29, v165
  v_mfma_f32_16x16x32_bf16 v[216:219], a[180:183], a[152:155], v[216:219]
  ds_read_b64_tr_b16 a[168:169], v8 offset:45056
  v_mul_f32 v179, v163, v179
  v_mfma_f32_16x16x32_bf16 v[216:219], a[176:179], a[136:139], v[216:219]
  v_exp_f32 v30, v166
  v_mul_f32 v180, v164, v180
  v_mfma_f32_16x16x32_bf16 v[212:215], a[176:179], a[132:135], v[212:215]
  ds_read_b64_tr_b16 a[170:171], v8 offset:47104
  v_mul_f32 v181, v165, v181
  v_mfma_f32_16x16x32_bf16 v[212:215], a[180:183], a[148:151], v[212:215]
  v_exp_f32 v31, v167
  v_mfma_f32_16x16x32_bf16 v[208:211], a[180:183], a[144:147], v[208:211]
  ds_read_b64_tr_b16 a[180:181], v5 offset:32768
  v_mul_f32 v182, v166, v182
  v_mfma_f32_16x16x32_bf16 v[208:211], a[176:179], a[128:131], v[208:211]
  s_waitcnt lgkmcnt(5)
  v_mul_f32 v183, v167, v183
  v_fma_f32 v24, v24, v17, v17
  v_fma_f32 v25, v25, v17, v17
  v_mfma_f32_16x16x32_bf16 v[192:195], a[164:167], a[188:191], v[192:195]
  ds_read_b64_tr_b16 a[182:183], v5 offset:34816
  v_fma_f32 v26, v26, v17, v17
  v_mfma_f32_16x16x32_bf16 v[192:195], a[160:163], a[204:207], v[192:195]
  v_rcp_f32 v24, v24
  v_mfma_f32_16x16x32_bf16 v[196:199], a[160:163], a[208:211], v[196:199]
  ds_read_b64_tr_b16 a[176:177], v5 offset:36864
  v_fma_f32 v27, v27, v17, v17
  v_mfma_f32_16x16x32_bf16 v[196:199], a[164:167], a[192:195], v[196:199]
  v_rcp_f32 v25, v25
  v_fma_f32 v28, v28, v19, v19
  v_mfma_f32_16x16x32_bf16 v[200:203], a[164:167], a[196:199], v[200:203]
  ds_read_b64_tr_b16 a[178:179], v5 offset:38912
  v_fma_f32 v29, v29, v19, v19
  v_mfma_f32_16x16x32_bf16 v[200:203], a[160:163], a[212:215], v[200:203]
  v_rcp_f32 v26, v26
  v_mfma_f32_16x16x32_bf16 v[204:207], a[160:163], a[216:219], v[204:207]
  ds_read_b64_tr_b16 a[160:161], v5 offset:40960
  v_fma_f32 v30, v30, v19, v19
  v_mfma_f32_16x16x32_bf16 v[204:207], a[164:167], a[200:203], v[204:207]
  s_waitcnt lgkmcnt(5)
  v_rcp_f32 v27, v27
  v_fma_f32 v31, v31, v19, v19
  v_mfma_f32_16x16x32_bf16 v[220:223], a[172:175], a[200:203], v[220:223]
  ds_read_b64_tr_b16 a[162:163], v5 offset:43008
  v_mul_f32 v176, v176, v24
  v_mfma_f32_16x16x32_bf16 v[220:223], a[168:171], a[216:219], v[220:223]
  v_rcp_f32 v28, v28
  v_mfma_f32_16x16x32_bf16 v[216:219], a[168:171], a[212:215], v[216:219]
  ds_read_b64_tr_b16 a[164:165], v5 offset:45056
  v_mul_f32 v177, v177, v25
  v_mfma_f32_16x16x32_bf16 v[216:219], a[172:175], a[196:199], v[216:219]
  v_rcp_f32 v29, v29
  v_mul_f32 v178, v178, v26
  v_mfma_f32_16x16x32_bf16 v[212:215], a[172:175], a[192:195], v[212:215]
  ds_read_b64_tr_b16 a[166:167], v5 offset:47104
  v_mul_f32 v179, v179, v27
  v_mfma_f32_16x16x32_bf16 v[212:215], a[168:171], a[208:211], v[212:215]
  v_rcp_f32 v30, v30
  v_mfma_f32_16x16x32_bf16 v[208:211], a[168:171], a[204:207], v[208:211]
  ds_read_b64_tr_b16 a[168:169], v5 offset:49152
  v_mul_f32 v180, v180, v28
  v_mfma_f32_16x16x32_bf16 v[208:211], a[172:175], a[188:191], v[208:211]
  s_waitcnt lgkmcnt(5)
  v_rcp_f32 v31, v31
  v_mul_f32 v181, v181, v29
  v_mfma_f32_16x16x32_bf16 v[224:227], a[180:183], a[64:67], v[224:227]
  ds_read_b64_tr_b16 a[170:171], v5 offset:51200
  v_mul_f32 v182, v182, v30
  v_mfma_f32_16x16x32_bf16 v[224:227], a[176:179], a[80:83], v[224:227]
  v_mul_f32 v183, v183, v31
  v_cvt_pk_bf16_f32 v130, v176, v177
  v_mfma_f32_16x16x32_bf16 v[228:231], a[176:179], a[84:87], v[228:231]
  ds_read_b64_tr_b16 a[172:173], v5 offset:53248
  v_cvt_pk_bf16_f32 v131, v178, v179
  v_mfma_f32_16x16x32_bf16 v[228:231], a[180:183], a[68:71], v[228:231]
  buffer_store_dwordx4 v[128:131], v1, s[8:11], s57 offen offset:0 sc1
  v_mfma_f32_16x16x32_bf16 v[232:235], a[180:183], a[72:75], v[232:235]
  ds_read_b64_tr_b16 a[174:175], v5 offset:55296
  s_waitcnt vmcnt(1)
  s_cmp_lg_u32 s44, 0
  s_cbranch_scc1 PL12_adaLN_cond__sliding_local_dilated__swiglu_ffn__prompt_kernelx
  v_cmp_ne_u32 vcc, s46, v36
  s_nop 4
  s_cbranch_vccz PL12_adaLN_cond__sliding_local_dilated__swiglu_ffn__prompt_kernelx
  s_mov_b32 s82, 60000
PL12_adaLN_cond__sliding_local_dilated__swiglu_ffn__prompt_kernel:
  buffer_load_dword v36, v37, s[8:11], s81 offen sc1
  s_sub_u32 s82, s82, 1
  s_cmp_eq_u32 s82, 0
  s_waitcnt vmcnt(0)
  s_cbranch_scc1 PL12_adaLN_cond__sliding_local_dilated__swiglu_ffn__prompt_kernelx
  v_cmp_ne_u32 vcc, s46, v36
  s_nop 4
  s_cbranch_vccnz PL12_adaLN_cond__sliding_local_dilated__swiglu_ffn__prompt_kernel
PL12_adaLN_cond__sliding_local_dilated__swiglu_ffn__prompt_kernelx:
  s_barrier
  v_mfma_f32_16x16x32_bf16 v[232:235], a[176:179], a[88:91], v[232:235]
  v_cvt_pk_bf16_f32 v134, v180, v181
  v_cvt_pk_bf16_f32 v135, v182, v183
  v_mfma_f32_16x16x32_bf16 v[236:239], a[176:179], a[92:95], v[236:239]
  ds_read_b64_tr_b16 a[176:177], v5 offset:57344
  v_fma_f32 v168, v168, v20, v60
  v_mfma_f32_16x16x32_bf16 v[236:239], a[180:183], a[76:79], v[236:239]
  s_waitcnt lgkmcnt(5)
  buffer_load_dwordx4 a[220:223], v1, s[8:11], s71 offen offset:0 sc1
  v_exp_f32 v24, v168
  v_mfma_f32_16x16x32_bf16 v[252:255], a[160:163], a[76:79], v[252:255]
  ds_read_b64_tr_b16 a[178:179], v5 offset:59392
  s_add_u32 s55, s57, 262144
  buffer_store_dwordx4 v[132:135], v1, s[8:11], s55 offen offset:0 sc1
  v_mfma_f32_16x16x32_bf16 v[252:255], a[164:167], a[92:95], v[252:255]
  v_fma_f32 v169, v169, v20, v61
  v_fma_f32 v170, v170, v20, v62
  v_mfma_f32_16x16x32_bf16 v[248:251], a[164:167], a[88:91], v[248:251]
  ds_read_b64_tr_b16 a[180:181], v5 offset:61440
  v_fma_f32 v171, v171, v20, v63
  v_mfma_f32_16x16x32_bf16 v[248:251], a[160:163], a[72:75], v[248:251]
  buffer_load_dwordx4 a[236:239], v1, s[8:11], s71 offen offset:1024 sc1
  v_exp_f32 v25, v169
  v_fma_f32 v172, v172, v22, v60
  v_mfma_f32_16x16x32_bf16 v[244:247], a[160:163], a[68:71], v[244:247]
  ds_read_b64_tr_b16 a[182:183], v5 offset:63488
  v_fma_f32 v173, v173, v22, v61
  v_mfma_f32_16x16x32_bf16 v[244:247], a[164:167], a[84:87], v[244:247]
  s_add_u32 s71, s71, 131072
  v_exp_f32 v26, v170
  v_mfma_f32_16x16x32_bf16 v[240:243], a[164:167], a[80:83], v[240:243]
  ds_read_b64_tr_b16 a[164:165], v5 offset:16384
  v_fma_f32 v174, v174, v22, v62
  v_mfma_f32_16x16x32_bf16 v[240:243], a[160:163], a[64:67], v[240:243]
  s_waitcnt lgkmcnt(5)
  buffer_load_dwordx4 a[224:227], v1, s[8:11], s71 offen offset:0 sc1
  v_exp_f32 v27, v171
  v_mfma_f32_16x16x32_bf16 v[224:227], a[168:171], a[96:99], v[224:227]
  ds_read_b64_tr_b16 a[166:167], v5 offset:18432
  v_fma_f32 v175, v175, v22, v63
  v_mfma_f32_16x16x32_bf16 v[224:227], a[172:175], a[112:115], v[224:227]
  v_exp_f32 v28, v172
  v_mfma_f32_16x16x32_bf16 v[228:231], a[172:175], a[116:119], v[228:231]
  ds_read_b64_tr_b16 a[160:161], v5 offset:20480
  v_mul_f32 v184, v168, v184
  v_mfma_f32_16x16x32_bf16 v[228:231], a[168:171], a[100:103], v[228:231]
  buffer_load_dwordx4 a[240:243], v1, s[8:11], s71 offen offset:1024 sc1
  v_exp_f32 v29, v173
  v_mul_f32 v185, v169, v185
  v_mfma_f32_16x16x32_bf16 v[232:235], a[168:171], a[104:107], v[232:235]
  ds_read_b64_tr_b16 a[162:163], v5 offset:22528
  v_mul_f32 v186, v170, v186
  v_mfma_f32_16x16x32_bf16 v[232:235], a[172:175], a[120:123], v[232:235]
  s_add_u32 s71, s71, s88
  v_exp_f32 v30, v174
  v_mfma_f32_16x16x32_bf16 v[236:239], a[172:175], a[124:127], v[236:239]
  ds_read_b64_tr_b16 a[172:173], v5 offset:24576
  ds_read_b128 v[60:63], v12 offset:640
  v_mfma_f32_16x16x32_bf16 v[236:239], a[168:171], a[108:111], v[236:239]
  s_waitcnt lgkmcnt(6)
  buffer_load_dwordx4 a[228:231], v1, s[8:11], s71 offen offset:0 sc1
  v_exp_f32 v31, v175
  v_mfma_f32_16x16x32_bf16 v[252:255], a[176:179], a[108:111], v[252:255]
  ds_read_b64_tr_b16 a[174:175], v5 offset:26624
  v_mul_f32 v187, v171, v187
  v_mfma_f32_16x16x32_bf16 v[252:255], a[180:183], a[124:127], v[252:255]
  v_mul_f32 v188, v172, v188
  v_mul_f32 v189, v173, v189
  v_mfma_f32_16x16x32_bf16 v[248:251], a[180:183], a[120:123], v[248:251]
  ds_read_b64_tr_b16 a[168:169], v5 offset:28672
  v_mul_f32 v190, v174, v190
  v_mfma_f32_16x16x32_bf16 v[248:251], a[176:179], a[104:107], v[248:251]
  buffer_load_dwordx4 a[244:247], v1, s[8:11], s71 offen offset:1024 sc1
  v_mul_f32 v191, v175, v191
  v_fma_f32 v24, v24, v21, v21
  v_fma_f32 v25, v25, v21, v21
  v_mfma_f32_16x16x32_bf16 v[244:247], a[176:179], a[100:103], v[244:247]
  ds_read_b64_tr_b16 a[170:171], v5 offset:30720
  v_fma_f32 v26, v26, v21, v21
  v_mfma_f32_16x16x32_bf16 v[244:247], a[180:183], a[116:119], v[244:247]
  s_add_u32 s71, s71, 131072
  v_rcp_f32 v24, v24
  v_mfma_f32_16x16x32_bf16 v[240:243], a[180:183], a[112:115], v[240:243]
  ds_read_b64_tr_b16 a[180:181], v9 offset:32768
  v_fma_f32 v27, v27, v21, v21
  v_mfma_f32_16x16x32_bf16 v[240:243], a[176:179], a[96:99], v[240:243]
  s_waitcnt lgkmcnt(6)
  buffer_load_dwordx4 a[232:235], v1, s[8:11], s71 offen offset:0 sc1
  v_rcp_f32 v25, v25
  v_mfma_f32_16x16x32_bf16 v[224:227], a[164:167], a[128:131], v[224:227]
  ds_read_b64_tr_b16 a[182:183], v9 offset:34816
  v_fma_f32 v28, v28, v23, v23
  v_mfma_f32_16x16x32_bf16 v[224:227], a[160:163], a[144:147], v[224:227]
  v_rcp_f32 v26, v26
  v_mfma_f32_16x16x32_bf16 v[228:231], a[160:163], a[148:151], v[228:231]
  ds_read_b64_tr_b16 a[176:177], v9 offset:36864
  v_fma_f32 v29, v29, v23, v23
  v_mfma_f32_16x16x32_bf16 v[228:231], a[164:167], a[132:135], v[228:231]
  buffer_load_dwordx4 a[248:251], v1, s[8:11], s71 offen offset:1024 sc1
  v_rcp_f32 v27, v27
  v_fma_f32 v30, v30, v23, v23
  v_mfma_f32_16x16x32_bf16 v[232:235], a[164:167], a[136:139], v[232:235]
  ds_read_b64_tr_b16 a[178:179], v9 offset:38912
  v_fma_f32 v31, v31, v23, v23
  v_mfma_f32_16x16x32_bf16 v[232:235], a[160:163], a[152:155], v[232:235]
  v_rcp_f32 v28, v28
  v_mfma_f32_16x16x32_bf16 v[236:239], a[160:163], a[156:159], v[236:239]
  ds_read_b64_tr_b16 a[160:161], v9 offset:40960
  v_mul_f32 v184, v184, v24
  v_mfma_f32_16x16x32_bf16 v[236:239], a[164:167], a[140:143], v[236:239]
  s_waitcnt lgkmcnt(5)
  buffer_load_dwordx4 a[0:3], v1, s[8:11], s72 offen offset:0 sc1
  v_rcp_f32 v29, v29
  v_mfma_f32_16x16x32_bf16 v[252:255], a[172:175], a[140:143], v[252:255]
  ds_read_b64_tr_b16 a[162:163], v9 offset:43008
  v_mul_f32 v185, v185, v25
  v_mfma_f32_16x16x32_bf16 v[252:255], a[168:171], a[156:159], v[252:255]
  v_rcp_f32 v30, v30
  v_mfma_f32_16x16x32_bf16 v[248:251], a[168:171], a[152:155], v[248:251]
  ds_read_b64_tr_b16 a[164:165], v9 offset:45056
  v_mul_f32 v186, v186, v26
  v_mfma_f32_16x16x32_bf16 v[248:251], a[172:175], a[136:139], v[248:251]
  buffer_load_dwordx4 a[16:19], v1, s[8:11], s72 offen offset:1024 sc1
  v_rcp_f32 v31, v31
  v_mul_f32 v187, v187, v27
  v_mfma_f32_16x16x32_bf16 v[244:247], a[172:175], a[132:135], v[244:247]
  ds_read_b64_tr_b16 a[166:167], v9 offset:47104
  v_mul_f32 v188, v188, v28
  v_mfma_f32_16x16x32_bf16 v[244:247], a[168:171], a[148:151], v[244:247]
  s_waitcnt vmcnt(32)
  s_barrier
  v_mfma_f32_16x16x32_bf16 v[240:243], a[168:171], a[144:147], v[240:243]
  ds_read_b64_tr_b16 a[168:169], v6 offset:49152
  s_add_u32 s72, s72, 131072
  v_mfma_f32_16x16x32_bf16 v[240:243], a[172:175], a[128:131], v[240:243]
  s_waitcnt lgkmcnt(5)
  buffer_load_dwordx4 a[4:7], v1, s[8:11], s72 offen offset:0 sc1
  v_mul_f32 v189, v189, v29
  v_mul_f32 v190, v190, v30
  v_mfma_f32_16x16x32_bf16 v[224:227], a[180:183], a[188:191], v[224:227]
  ds_read_b64_tr_b16 a[170:171], v6 offset:51200
  v_mul_f32 v191, v191, v31
  v_mfma_f32_16x16x32_bf16 v[224:227], a[176:179], a[204:207], v[224:227]
  v_cvt_pk_bf16_f32 v138, v184, v185
  v_cvt_pk_bf16_f32 v139, v186, v187
  v_mfma_f32_16x16x32_bf16 v[228:231], a[176:179], a[208:211], v[228:231]
  ds_read_b64_tr_b16 a[172:173], v6 offset:53248
  v_cvt_pk_bf16_f32 v142, v188, v189
  v_mfma_f32_16x16x32_bf16 v[228:231], a[180:183], a[192:195], v[228:231]
  buffer_load_dwordx4 a[20:23], v1, s[8:11], s72 offen offset:1024 sc1
  s_add_u32 s55, s57, 524288
  buffer_store_dwordx4 v[136:139], v1, s[8:11], s55 offen offset:0 sc1
  v_mfma_f32_16x16x32_bf16 v[232:235], a[180:183], a[196:199], v[232:235]
  ds_read_b64_tr_b16 a[174:175], v6 offset:55296
  v_cvt_pk_bf16_f32 v143, v190, v191
  v_mfma_f32_16x16x32_bf16 v[232:235], a[176:179], a[212:215], v[232:235]
  s_add_u32 s72, s72, s88
  s_add_u32 s55, s57, 786432
  buffer_store_dwordx4 v[140:143], v1, s[8:11], s55 offen offset:0 sc1
  v_mfma_f32_16x16x32_bf16 v[236:239], a[176:179], a[216:219], v[236:239]
  ds_read_b64_tr_b16 a[176:177], v7 offset:49152
  s_waitcnt lgkmcnt(15)
  v_mfma_f32_16x16x32_bf16 v[236:239], a[180:183], a[200:203], v[236:239]
  s_waitcnt lgkmcnt(5)
  buffer_load_dwordx4 a[8:11], v1, s[8:11], s72 offen offset:0 sc1
  v_fma_f32 v192, v192, v16, v60
  v_fma_f32 v193, v193, v16, v61
  v_mfma_f32_16x16x32_bf16 v[252:255], a[160:163], a[200:203], v[252:255]
  ds_read_b64_tr_b16 a[178:179], v7 offset:51200
  v_fma_f32 v194, v194, v16, v62
  v_mfma_f32_16x16x32_bf16 v[252:255], a[164:167], a[216:219], v[252:255]
  s_waitcnt vmcnt(31)
  s_barrier
  v_mfma_f32_16x16x32_bf16 v[248:251], a[164:167], a[212:215], v[248:251]
  ds_read_b64_tr_b16 a[180:181], v7 offset:53248
  v_exp_f32 v24, v192
  v_mfma_f32_16x16x32_bf16 v[248:251], a[160:163], a[196:199], v[248:251]
  buffer_load_dwordx4 a[24:27], v1, s[8:11], s72 offen offset:1024 sc1
  v_exp_f32 v25, v193
  v_mfma_f32_16x16x32_bf16 v[244:247], a[160:163], a[192:195], v[244:247]
  ds_read_b64_tr_b16 a[182:183], v7 offset:55296
  v_fma_f32 v195, v195, v16, v63
  v_mfma_f32_16x16x32_bf16 v[244:247], a[164:167], a[208:211], v[244:247]
  s_add_u32 s72, s72, 131072
  v_exp_f32 v26, v194
  v_fma_f32 v196, v196, v18, v60
  v_mfma_f32_16x16x32_bf16 v[240:243], a[164:167], a[204:207], v[240:243]
  ds_read_b64_tr_b16 a[164:165], v8 offset:49152
  v_fma_f32 v197, v197, v18, v61
  v_mfma_f32_16x16x32_bf16 v[240:243], a[160:163], a[188:191], v[240:243]
  s_waitcnt vmcnt(8) lgkmcnt(5)
  buffer_load_dwordx4 a[12:15], v1, s[8:11], s72 offen offset:0 sc1
  v_exp_f32 v27, v195
  v_mfma_f32_16x16x32_bf16 v[64:67], a[168:171], a[220:223], 0
  ds_read_b64_tr_b16 a[166:167], v8 offset:51200
  v_fma_f32 v198, v198, v18, v62
  v_mfma_f32_16x16x32_bf16 v[64:67], a[172:175], a[236:239], v[64:67]
  v_exp_f32 v28, v196
  v_mfma_f32_16x16x32_bf16 v[68:71], a[172:175], a[240:243], 0
  ds_read_b64_tr_b16 a[160:161], v8 offset:53248
  v_exp_f32 v29, v197
  v_mfma_f32_16x16x32_bf16 v[68:71], a[168:171], a[224:227], v[68:71]
  buffer_load_dwordx4 a[28:31], v1, s[8:11], s72 offen offset:1024 sc1
  v_exp_f32 v30, v198
  v_mfma_f32_16x16x32_bf16 v[72:75], a[168:171], a[228:231], 0
  ds_read_b64_tr_b16 a[162:163], v8 offset:55296
  v_fma_f32 v199, v199, v18, v63
  v_mfma_f32_16x16x32_bf16 v[72:75], a[172:175], a[244:247], v[72:75]
  v_exp_f32 v31, v199
  v_mul_f32 v208, v192, v208
  v_mfma_f32_16x16x32_bf16 v[76:79], a[172:175], a[248:251], 0
  ds_read_b64_tr_b16 a[172:173], v9 offset:49152
  v_mul_f32 v209, v193, v209
  v_mfma_f32_16x16x32_bf16 v[76:79], a[168:171], a[232:235], v[76:79]
  s_waitcnt lgkmcnt(5)
  buffer_load_dwordx4 a[32:35], v1, s[8:11], s73 offen offset:0 sc1
  v_mul_f32 v210, v194, v210
  v_mul_f32 v211, v195, v211
  v_mfma_f32_16x16x32_bf16 v[92:95], a[176:179], a[232:235], 0
  ds_read_b64_tr_b16 a[174:175], v9 offset:51200
  v_mul_f32 v212, v196, v212
  v_mfma_f32_16x16x32_bf16 v[92:95], a[180:183], a[248:251], v[92:95]
  v_mul_f32 v213, v197, v213
  v_mul_f32 v214, v198, v214
  v_mfma_f32_16x16x32_bf16 v[88:91], a[180:183], a[244:247], 0
  ds_read_b64_tr_b16 a[168:169], v9 offset:53248
  v_mul_f32 v215, v199, v215
  v_fma_f32 v24, v24, v17, v17
  v_mfma_f32_16x16x32_bf16 v[88:91], a[176:179], a[228:231], v[88:91]
  buffer_load_dwordx4 a[48:51], v1, s[8:11], s73 offen offset:1024 sc1
  v_rcp_f32 v24, v24
  v_mfma_f32_16x16x32_bf16 v[84:87], a[176:179], a[224:227], 0
  ds_read_b64_tr_b16 a[170:171], v9 offset:55296
  v_fma_f32 v25, v25, v17, v17
  v_mfma_f32_16x16x32_bf16 v[84:87], a[180:183], a[240:243], v[84:87]
  v_rcp_f32 v25, v25
  v_fma_f32 v26, v26, v17, v17
  v_mfma_f32_16x16x32_bf16 v[80:83], a[180:183], a[236:239], 0
  ds_read_b64_tr_b16 a[180:181], v6 offset:57344
  v_fma_f32 v27, v27, v17, v17
  v_mfma_f32_16x16x32_bf16 v[80:83], a[176:179], a[220:223], v[80:83]
  s_waitcnt lgkmcnt(5)
  s_add_u32 s73, s73, 131072
  v_rcp_f32 v26, v26
  v_mfma_f32_16x16x32_bf16 v[96:99], a[164:167], a[220:223], 0
  ds_read_b64_tr_b16 a[182:183], v6 offset:59392
  v_fma_f32 v28, v28, v19, v19
  v_mfma_f32_16x16x32_bf16 v[96:99], a[160:163], a[236:239], v[96:99]
  buffer_load_dwordx4 a[36:39], v1, s[8:11], s73 offen offset:0 sc1
  v_rcp_f32 v27, v27
  v_mfma_f32_16x16x32_bf16 v[100:103], a[160:163], a[240:243], 0
  ds_read_b64_tr_b16 a[176:177], v6 offset:61440
  v_rcp_f32 v28, v28
  v_mfma_f32_16x16x32_bf16 v[100:103], a[164:167], a[224:227], v[100:103]
  v_fma_f32 v29, v29, v19, v19
  v_fma_f32 v30, v30, v19, v19
  v_mfma_f32_16x16x32_bf16 v[104:107], a[164:167], a[228:231], 0
  ds_read_b64_tr_b16 a[178:179], v6 offset:63488
  v_fma_f32 v31, v31, v19, v19
  v_mfma_f32_16x16x32_bf16 v[104:107], a[160:163], a[244:247], v[104:107]
  buffer_load_dwordx4 a[52:55], v1, s[8:11], s73 offen offset:1024 sc1
  v_rcp_f32 v29, v29
  v_mul_f32 v208, v208, v24
  v_mfma_f32_16x16x32_bf16 v[108:111], a[160:163], a[248:251], 0
  ds_read_b64_tr_b16 a[160:161], v7 offset:57344
  v_mul_f32 v209, v209, v25
  v_mfma_f32_16x16x32_bf16 v[108:111], a[164:167], a[232:235], v[108:111]
  s_waitcnt lgkmcnt(5)
  s_add_u32 s73, s73, s88
  v_rcp_f32 v30, v30
  v_mfma_f32_16x16x32_bf16 v[124:127], a[172:175], a[232:235], 0
  ds_read_b64_tr_b16 a[162:163], v7 offset:59392
  v_mul_f32 v210, v210, v26
  v_mfma_f32_16x16x32_bf16 v[124:127], a[168:171], a[248:251], v[124:127]
  buffer_load_dwordx4 a[40:43], v1, s[8:11], s73 offen offset:0 sc1
  v_rcp_f32 v31, v31
  v_mfma_f32_16x16x32_bf16 v[120:123], a[168:171], a[244:247], 0
  ds_read_b64_tr_b16 a[164:165], v7 offset:61440
  v_mul_f32 v211, v211, v27
  v_mul_f32 v212, v212, v28
  v_mfma_f32_16x16x32_bf16 v[120:123], a[172:175], a[228:231], v[120:123]
  v_mul_f32 v213, v213, v29
  v_mul_f32 v214, v214, v30
  v_mfma_f32_16x16x32_bf16 v[116:119], a[172:175], a[224:227], 0
  ds_read_b64_tr_b16 a[166:167], v7 offset:63488
  v_mul_f32 v215, v215, v31
  v_mfma_f32_16x16x32_bf16 v[116:119], a[168:171], a[240:243], v[116:119]
  buffer_load_dwordx4 a[56:59], v1, s[8:11], s73 offen offset:1024 sc1
  v_cvt_pk_bf16_f32 v192, v208, v209
  v_cvt_pk_bf16_f32 v193, v210, v211
  v_cvt_pk_bf16_f32 v196, v212, v213
  v_mfma_f32_16x16x32_bf16 v[112:115], a[168:171], a[236:239], 0
  ds_read_b64_tr_b16 a[168:169], v8 offset:57344
  v_cvt_pk_bf16_f32 v197, v214, v215
  v_mfma_f32_16x16x32_bf16 v[112:115], a[172:175], a[220:223], v[112:115]
  s_waitcnt lgkmcnt(5)
  v_fma_f32 v200, v200, v20, v60
  v_exp_f32 v24, v200
  v_mfma_f32_16x16x32_bf16 v[128:131], a[180:183], a[220:223], 0
  ds_read_b64_tr_b16 a[170:171], v8 offset:59392
  v_fma_f32 v201, v201, v20, v61
  v_mfma_f32_16x16x32_bf16 v[128:131], a[176:179], a[236:239], v[128:131]
  s_add_u32 s73, s73, 131072
  v_exp_f32 v25, v201
  v_mfma_f32_16x16x32_bf16 v[132:135], a[176:179], a[240:243], 0
  ds_read_b64_tr_b16 a[172:173], v8 offset:61440
  v_fma_f32 v202, v202, v20, v62
  v_fma_f32 v203, v203, v20, v63
  v_mfma_f32_16x16x32_bf16 v[132:135], a[180:183], a[224:227], v[132:135]
  buffer_load_dwordx4 a[44:47], v1, s[8:11], s73 offen offset:0 sc1
  v_exp_f32 v26, v202
  v_mfma_f32_16x16x32_bf16 v[136:139], a[180:183], a[228:231], 0
  ds_read_b64_tr_b16 a[174:175], v8 offset:63488
  v_fma_f32 v204, v204, v22, v60
  v_mfma_f32_16x16x32_bf16 v[136:139], a[176:179], a[244:247], v[136:139]
  v_exp_f32 v27, v203
  v_fma_f32 v205, v205, v22, v61
  v_mfma_f32_16x16x32_bf16 v[140:143], a[176:179], a[248:251], 0
  ds_read_b64_tr_b16 a[176:177], v9 offset:57344
  v_fma_f32 v206, v206, v22, v62
  v_mfma_f32_16x16x32_bf16 v[140:143], a[180:183], a[232:235], v[140:143]
  s_waitcnt lgkmcnt(5)
  buffer_load_dwordx4 a[60:63], v1, s[8:11], s73 offen offset:1024 sc1
  v_exp_f32 v28, v204
  v_mfma_f32_16x16x32_bf16 v[156:159], a[160:163], a[232:235], 0
  ds_read_b64_tr_b16 a[178:179], v9 offset:59392
  v_fma_f32 v207, v207, v22, v63
  v_mfma_f32_16x16x32_bf16 v[156:159], a[164:167], a[248:251], v[156:159]
  v_exp_f32 v29, v205
  v_mfma_f32_16x16x32_bf16 v[152:155], a[164:167], a[244:247], 0
  ds_read_b64_tr_b16 a[180:181], v9 offset:61440
  v_exp_f32 v30, v206
  v_mfma_f32_16x16x32_bf16 v[152:155], a[160:163], a[228:231], v[152:155]
  buffer_load_dwordx4 a[64:67], v1, s[8:11], s74 offen offset:0 sc1
  v_exp_f32 v31, v207
  v_mfma_f32_16x16x32_bf16 v[148:151], a[160:163], a[224:227], 0
  ds_read_b64_tr_b16 a[182:183], v9 offset:63488
  v_mul_f32 v216, v200, v216
  v_mfma_f32_16x16x32_bf16 v[148:151], a[164:167], a[240:243], v[148:151]
  ds_read_b128 v[60:63], v12 offset:704
  v_mul_f32 v217, v201, v217
  v_mul_f32 v218, v202, v218
  v_mfma_f32_16x16x32_bf16 v[144:147], a[164:167], a[236:239], 0
  ds_read_b64_tr_b16 a[164:165], v6 offset:16384
  v_mul_f32 v219, v203, v219
  v_mfma_f32_16x16x32_bf16 v[144:147], a[160:163], a[220:223], v[144:147]
  s_waitcnt lgkmcnt(6)
  buffer_load_dwordx4 a[80:83], v1, s[8:11], s74 offen offset:1024 sc1
  v_mul_f32 v220, v204, v220
  v_mul_f32 v221, v205, v221
  v_mfma_f32_16x16x32_bf16 v[160:163], a[168:171], a[220:223], 0
  ds_read_b64_tr_b16 a[166:167], v6 offset:18432
  v_mul_f32 v222, v206, v222
  v_mfma_f32_16x16x32_bf16 v[160:163], a[172:175], a[236:239], v[160:163]
  v_mul_f32 v223, v207, v223
  v_fma_f32 v24, v24, v21, v21
  v_mfma_f32_16x16x32_bf16 v[164:167], a[172:175], a[240:243], 0
  ds_read_b64_tr_b16 a[160:161], v6 offset:20480
  v_rcp_f32 v24, v24
  v_mfma_f32_16x16x32_bf16 v[164:167], a[168:171], a[224:227], v[164:167]
  s_add_u32 s74, s74, 131072
  v_fma_f32 v25, v25, v21, v21
  v_fma_f32 v26, v26, v21, v21
  v_mfma_f32_16x16x32_bf16 v[168:171], a[168:171], a[228:231], 0
  ds_read_b64_tr_b16 a[162:163], v6 offset:22528
  v_fma_f32 v27, v27, v21, v21
  v_mfma_f32_16x16x32_bf16 v[168:171], a[172:175], a[244:247], v[168:171]
  buffer_load_dwordx4 a[68:71], v1, s[8:11], s74 offen offset:0 sc1
  v_rcp_f32 v25, v25
  v_fma_f32 v28, v28, v23, v23
  v_mfma_f32_16x16x32_bf16 v[172:175], a[172:175], a[248:251], 0
  ds_read_b64_tr_b16 a[172:173], v7 offset:16384
  v_fma_f32 v29, v29, v23, v23
  v_mfma_f32_16x16x32_bf16 v[172:175], a[168:171], a[232:235], v[172:175]
  s_waitcnt lgkmcnt(6)
  v_rcp_f32 v26, v26
  v_fma_f32 v30, v30, v23, v23
  v_mfma_f32_16x16x32_bf16 v[188:191], a[176:179], a[232:235], 0
  ds_read_b64_tr_b16 a[174:175], v7 offset:18432
  v_fma_f32 v31, v31, v23, v23
  v_mfma_f32_16x16x32_bf16 v[188:191], a[180:183], a[248:251], v[188:191]
  buffer_load_dwordx4 a[84:87], v1, s[8:11], s74 offen offset:1024 sc1
  v_rcp_f32 v27, v27
  v_mfma_f32_16x16x32_bf16 v[184:187], a[180:183], a[244:247], 0
  ds_read_b64_tr_b16 a[168:169], v7 offset:20480
  v_rcp_f32 v28, v28
  v_mfma_f32_16x16x32_bf16 v[184:187], a[176:179], a[228:231], v[184:187]
  s_add_u32 s74, s74, s88
  v_rcp_f32 v29, v29
  v_mfma_f32_16x16x32_bf16 v[180:183], a[176:179], a[224:227], 0
  ds_read_b64_tr_b16 a[170:171], v7 offset:22528
  v_mul_f32 v216, v216, v24
  v_mfma_f32_16x16x32_bf16 v[180:183], a[180:183], a[240:243], v[180:183]
  buffer_load_dwordx4 a[72:75], v1, s[8:11], s74 offen offset:0 sc1
  v_rcp_f32 v30, v30
  v_mul_f32 v217, v217, v25
  v_mfma_f32_16x16x32_bf16 v[176:179], a[180:183], a[236:239], 0
  ds_read_b64_tr_b16 a[180:181], v8 offset:16384
  v_mul_f32 v218, v218, v26
  v_mfma_f32_16x16x32_bf16 v[176:179], a[176:179], a[220:223], v[176:179]
  s_waitcnt vmcnt(13) lgkmcnt(5)
  v_rcp_f32 v31, v31
  v_mul_f32 v219, v219, v27
  v_mfma_f32_16x16x32_bf16 v[64:67], a[164:167], a[0:3], v[64:67]
  ds_read_b64_tr_b16 a[182:183], v8 offset:18432
  v_mul_f32 v220, v220, v28
  v_mfma_f32_16x16x32_bf16 v[64:67], a[160:163], a[16:19], v[64:67]
  buffer_load_dwordx4 a[88:91], v1, s[8:11], s74 offen offset:1024 sc1
  v_mul_f32 v221, v221, v29
  v_mul_f32 v222, v222, v30
  v_mfma_f32_16x16x32_bf16 v[68:71], a[160:163], a[20:23], v[68:71]
  ds_read_b64_tr_b16 a[176:177], v8 offset:20480
  v_mul_f32 v223, v223, v31
  v_cvt_pk_bf16_f32 v200, v216, v217
  v_mfma_f32_16x16x32_bf16 v[68:71], a[164:167], a[4:7], v[68:71]
  v_cvt_pk_bf16_f32 v201, v218, v219
  v_cvt_pk_bf16_f32 v204, v220, v221
  v_mfma_f32_16x16x32_bf16 v[72:75], a[164:167], a[8:11], v[72:75]
  ds_read_b64_tr_b16 a[178:179], v8 offset:22528
  v_cvt_pk_bf16_f32 v205, v222, v223
  v_mfma_f32_16x16x32_bf16 v[72:75], a[160:163], a[24:27], v[72:75]
  s_add_u32 s74, s74, 131072
  v_mfma_f32_16x16x32_bf16 v[76:79], a[160:163], a[28:31], v[76:79]
  ds_read_b64_tr_b16 a[160:161], v9 offset:16384
  s_waitcnt lgkmcnt(13)
  v_fma_f32 v224, v224, v16, v60
  v_mfma_f32_16x16x32_bf16 v[76:79], a[164:167], a[12:15], v[76:79]
  s_waitcnt lgkmcnt(5)
  buffer_load_dwordx4 a[76:79], v1, s[8:11], s74 offen offset:0 sc1
  v_exp_f32 v24, v224
  v_mfma_f32_16x16x32_bf16 v[92:95], a[172:175], a[12:15], v[92:95]
  ds_read_b64_tr_b16 a[162:163], v9 offset:18432
  v_fma_f32 v225, v225, v16, v61
  v_fma_f32 v226, v226, v16, v62
  v_mfma_f32_16x16x32_bf16 v[92:95], a[168:171], a[28:31], v[92:95]
  v_exp_f32 v25, v225
  v_fma_f32 v227, v227, v16, v63
  v_mfma_f32_16x16x32_bf16 v[88:91], a[168:171], a[24:27], v[88:91]
  ds_read_b64_tr_b16 a[164:165], v9 offset:20480
  v_fma_f32 v228, v228, v18, v60
  v_mfma_f32_16x16x32_bf16 v[88:91], a[172:175], a[8:11], v[88:91]
  buffer_load_dwordx4 a[92:95], v1, s[8:11], s74 offen offset:1024 sc1
  v_exp_f32 v26, v226
  v_fma_f32 v229, v229, v18, v61
  v_mfma_f32_16x16x32_bf16 v[84:87], a[172:175], a[4:7], v[84:87]
  ds_read_b64_tr_b16 a[166:167], v9 offset:22528
  v_exp_f32 v27, v227
  v_mfma_f32_16x16x32_bf16 v[84:87], a[168:171], a[20:23], v[84:87]
  s_cmp_eq_u32 s90, 1
  s_cselect_b32 s75, 3, 10
  s_lshl_b32 s67, s75, 17
  s_lshl_b32 s75, s75, 11
  s_add_u32 s75, s75, s83
  s_add_u32 m0, s45, 32768
  v_exp_f32 v28, v228
  v_fma_f32 v230, v230, v18, v62
  v_mfma_f32_16x16x32_bf16 v[80:83], a[168:171], a[16:19], v[80:83]
  ds_read_b64_tr_b16 a[168:169], v6 offset:24576
  v_exp_f32 v29, v229
  v_mfma_f32_16x16x32_bf16 v[80:83], a[172:175], a[0:3], v[80:83]
  s_waitcnt lgkmcnt(5)
  buffer_load_dwordx4 v32, s[36:39], s67 offen lds
HOP16:
  s_cbranch_execz WRET1
  v_exp_f32 v30, v230
  v_mfma_f32_16x16x32_bf16 v[96:99], a[180:183], a[0:3], v[96:99]
  ds_read_b64_tr_b16 a[170:171], v6 offset:26624
  v_fma_f32 v231, v231, v18, v63
  v_mfma_f32_16x16x32_bf16 v[96:99], a[176:179], a[16:19], v[96:99]
  s_add_u32 m0, s45, 36864
  s_add_u32 s60, s67, 65536
  v_exp_f32 v31, v231
  v_mfma_f32_16x16x32_bf16 v[100:103], a[176:179], a[20:23], v[100:103]
  ds_read_b64_tr_b16 a[172:173], v6 offset:28672
  v_mul_f32 v240, v224, v240
  v_mul_f32 v241, v225, v241
  v_mfma_f32_16x16x32_bf16 v[100:103], a[180:183], a[4:7], v[100:103]
  buffer_load_dwordx4 v32, s[36:39], s60 offen lds
  v_mul_f32 v242, v226, v242
  v_mul_f32 v243, v227, v243
  v_mul_f32 v244, v228, v244
  v_mfma_f32_16x16x32_bf16 v[104:107], a[180:183], a[8:11], v[104:107]
  ds_read_b64_tr_b16 a[174:175], v6 offset:30720
  v_mul_f32 v245, v229, v245
  v_mul_f32 v246, v230, v246
  v_mfma_f32_16x16x32_bf16 v[104:107], a[176:179], a[24:27], v[104:107]
  v_mul_f32 v247, v231, v247
  v_fma_f32 v24, v24, v17, v17
  v_mfma_f32_16x16x32_bf16 v[108:111], a[176:179], a[28:31], v[108:111]
  ds_read_b64_tr_b16 a[176:177], v7 offset:24576
  v_rcp_f32 v24, v24
  v_mfma_f32_16x16x32_bf16 v[108:111], a[180:183], a[12:15], v[108:111]
  s_waitcnt lgkmcnt(5)
  s_add_u32 m0, s45, 40960
  v_fma_f32 v25, v25, v17, v17
  v_fma_f32 v26, v26, v17, v17
  v_mfma_f32_16x16x32_bf16 v[124:127], a[160:163], a[12:15], v[124:127]
  ds_read_b64_tr_b16 a[178:179], v7 offset:26624
  v_rcp_f32 v25, v25
  v_mfma_f32_16x16x32_bf16 v[124:127], a[164:167], a[28:31], v[124:127]
  buffer_load_dwordx4 v33, s[36:39], s67 offen lds
  v_rcp_f32 v26, v26
  v_fma_f32 v27, v27, v17, v17
  v_mfma_f32_16x16x32_bf16 v[120:123], a[164:167], a[24:27], v[120:123]
  ds_read_b64_tr_b16 a[180:181], v7 offset:28672
  v_fma_f32 v28, v28, v19, v19
  v_mfma_f32_16x16x32_bf16 v[120:123], a[160:163], a[8:11], v[120:123]
  s_add_u32 m0, s45, 45056
  s_add_u32 s60, s67, 65536
  v_rcp_f32 v27, v27
  v_mfma_f32_16x16x32_bf16 v[116:119], a[160:163], a[4:7], v[116:119]
  ds_read_b64_tr_b16 a[182:183], v7 offset:30720
  v_rcp_f32 v28, v28
  v_mfma_f32_16x16x32_bf16 v[116:119], a[164:167], a[20:23], v[116:119]
  buffer_load_dwordx4 v33, s[36:39], s60 offen lds
  v_fma_f32 v29, v29, v19, v19
  v_rcp_f32 v29, v29
  v_mfma_f32_16x16x32_bf16 v[112:115], a[164:167], a[16:19], v[112:115]
  ds_read_b64_tr_b16 a[164:165], v8 offset:24576
  v_fma_f32 v30, v30, v19, v19
  v_fma_f32 v31, v31, v19, v19
  v_mfma_f32_16x16x32_bf16 v[112:115], a[160:163], a[0:3], v[112:115]
  s_waitcnt lgkmcnt(5)
  s_cmp_eq_u32 s90, 2
  s_cselect_b32 s76, 5, 12
  s_lshl_b32 s68, s76, 17
  s_lshl_b32 s76, s76, 11
  s_add_u32 s76, s76, s83
  s_add_u32 m0, s45, 49152
  v_rcp_f32 v30, v30
  v_mfma_f32_16x16x32_bf16 v[128:131], a[168:171], a[0:3], v[128:131]
  ds_read_b64_tr_b16 a[166:167], v8 offset:26624
  v_mul_f32 v240, v240, v24
  v_mfma_f32_16x16x32_bf16 v[128:131], a[172:175], a[16:19], v[128:131]
  buffer_load_dwordx4 v32, s[36:39], s68 offen lds
  v_rcp_f32 v31, v31
  v_mul_f32 v241, v241, v25
  v_mfma_f32_16x16x32_bf16 v[132:135], a[172:175], a[20:23], v[132:135]
  ds_read_b64_tr_b16 a[160:161], v8 offset:28672
  v_mul_f32 v242, v242, v26
  v_mul_f32 v243, v243, v27
  v_mfma_f32_16x16x32_bf16 v[132:135], a[168:171], a[4:7], v[132:135]
  s_add_u32 m0, s45, 53248
  s_add_u32 s60, s68, 65536
  v_mul_f32 v244, v244, v28
  v_mul_f32 v245, v245, v29
  v_mfma_f32_16x16x32_bf16 v[136:139], a[168:171], a[8:11], v[136:139]
  ds_read_b64_tr_b16 a[162:163], v8 offset:30720
  v_mul_f32 v246, v246, v30
  v_mul_f32 v247, v247, v31
  v_mfma_f32_16x16x32_bf16 v[136:139], a[172:175], a[24:27], v[136:139]
  buffer_load_dwordx4 v32, s[36:39], s60 offen lds
  v_cvt_pk_bf16_f32 v194, v240, v241
  v_cvt_pk_bf16_f32 v195, v242, v243
  v_mfma_f32_16x16x32_bf16 v[140:143], a[172:175], a[28:31], v[140:143]
  ds_read_b64_tr_b16 a[172:173], v9 offset:24576
  v_cvt_pk_bf16_f32 v198, v244, v245
  v_cvt_pk_bf16_f32 v199, v246, v247
  v_mfma_f32_16x16x32_bf16 v[140:143], a[168:171], a[12:15], v[140:143]
  s_waitcnt lgkmcnt(5)
  buffer_store_dwordx4 v[192:195], v1, s[8:11], s57 offen offset:1024 sc1
  v_mfma_f32_16x16x32_bf16 v[156:159], a[176:179], a[12:15], v[156:159]
  ds_read_b64_tr_b16 a[174:175], v9 offset:26624
  v_fma_f32 v232, v232, v20, v60
  v_fma_f32 v233, v233, v20, v61
  v_mfma_f32_16x16x32_bf16 v[156:159], a[180:183], a[28:31], v[156:159]
  s_add_u32 m0, s45, 57344
  s_add_u32 s55, s57, 262144
  buffer_store_dwordx4 v[196:199], v1, s[8:11], s55 offen offset:1024 sc1
  v_mfma_f32_16x16x32_bf16 v[152:155], a[180:183], a[24:27], v[152:155]
  ds_read_b64_tr_b16 a[168:169], v9 offset:28672
  v_fma_f32 v234, v234, v20, v62
  v_mfma_f32_16x16x32_bf16 v[152:155], a[176:179], a[8:11], v[152:155]
  buffer_load_dwordx4 v33, s[36:39], s68 offen lds
  v_exp_f32 v24, v232
  v_fma_f32 v235, v235, v20, v63
  v_mfma_f32_16x16x32_bf16 v[148:151], a[176:179], a[4:7], v[148:151]
  ds_read_b64_tr_b16 a[170:171], v9 offset:30720
  v_exp_f32 v25, v233
  v_mfma_f32_16x16x32_bf16 v[148:151], a[180:183], a[20:23], v[148:151]
  v_fma_f32 v236, v236, v22, v60
  s_waitcnt vmcnt(47)
  s_barrier
  v_mfma_f32_16x16x32_bf16 v[144:147], a[180:183], a[16:19], v[144:147]
  ds_read_b64_tr_b16 a[180:181], v6 offset:0
  s_add_u32 m0, s45, 61440
  s_add_u32 s60, s68, 65536
  v_mfma_f32_16x16x32_bf16 v[144:147], a[176:179], a[0:3], v[144:147]
  s_waitcnt lgkmcnt(5)
  buffer_load_dwordx4 v33, s[36:39], s60 offen lds
  v_exp_f32 v26, v234
  v_mfma_f32_16x16x32_bf16 v[160:163], a[164:167], a[0:3], v[160:163]
  ds_read_b64_tr_b16 a[182:183], v6 offset:2048
  v_fma_f32 v237, v237, v22, v61
  v_mfma_f32_16x16x32_bf16 v[160:163], a[160:163], a[16:19], v[160:163]
  v_exp_f32 v27, v235
  v_fma_f32 v238, v238, v22, v62
  v_mfma_f32_16x16x32_bf16 v[164:167], a[160:163], a[20:23], v[164:167]
  ds_read_b64_tr_b16 a[176:177], v6 offset:4096
  v_exp_f32 v28, v236
  v_mfma_f32_16x16x32_bf16 v[164:167], a[164:167], a[4:7], v[164:167]
  buffer_load_dwordx4 a[96:99], v1, s[8:11], s75 offen offset:0 sc1
  v_exp_f32 v29, v237
  v_fma_f32 v239, v239, v22, v63
  v_mfma_f32_16x16x32_bf16 v[168:171], a[164:167], a[8:11], v[168:171]
  ds_read_b64_tr_b16 a[178:179], v6 offset:6144
  v_exp_f32 v30, v238
  v_mfma_f32_16x16x32_bf16 v[168:171], a[160:163], a[24:27], v[168:171]
  v_exp_f32 v31, v239
  v_mfma_f32_16x16x32_bf16 v[172:175], a[160:163], a[28:31], v[172:175]
  ds_read_b64_tr_b16 a[160:161], v7 offset:0
  v_mul_f32 v248, v232, v248
  v_mul_f32 v249, v233, v249
  v_mfma_f32_16x16x32_bf16 v[172:175], a[164:167], a[12:15], v[172:175]
  s_waitcnt lgkmcnt(5)
  buffer_load_dwordx4 a[112:115], v1, s[8:11], s75 offen offset:1024 sc1
  v_mul_f32 v250, v234, v250
  v_mul_f32 v251, v235, v251
  v_mfma_f32_16x16x32_bf16 v[188:191], a[172:175], a[12:15], v[188:191]
  ds_read_b64_tr_b16 a[162:163], v7 offset:2048
  v_mul_f32 v252, v236, v252
  v_mul_f32 v253, v237, v253
  v_mfma_f32_16x16x32_bf16 v[188:191], a[168:171], a[28:31], v[188:191]
  v_mul_f32 v254, v238, v254
  v_mul_f32 v255, v239, v255
  v_fma_f32 v24, v24, v21, v21
  v_mfma_f32_16x16x32_bf16 v[184:187], a[168:171], a[24:27], v[184:187]
  ds_read_b64_tr_b16 a[164:165], v7 offset:4096
  v_fma_f32 v25, v25, v21, v21
  v_mfma_f32_16x16x32_bf16 v[184:187], a[172:175], a[8:11], v[184:187]
  s_add_u32 s75, s75, 131072
  v_rcp_f32 v24, v24
  v_fma_f32 v26, v26, v21, v21
  v_mfma_f32_16x16x32_bf16 v[180:183], a[172:175], a[4:7], v[180:183]
  ds_read_b64_tr_b16 a[166:167], v7 offset:6144
  v_rcp_f32 v25, v25
  v_mfma_f32_16x16x32_bf16 v[180:183], a[168:171], a[20:23], v[180:183]
  buffer_load_dwordx4 a[100:103], v1, s[8:11], s75 offen offset:0 sc1
  v_rcp_f32 v26, v26
  v_fma_f32 v27, v27, v21, v21
  v_mfma_f32_16x16x32_bf16 v[176:179], a[168:171], a[16:19], v[176:179]
  ds_read_b64_tr_b16 a[168:169], v8 offset:0
  v_rcp_f32 v27, v27
  v_mfma_f32_16x16x32_bf16 v[176:179], a[172:175], a[0:3], v[176:179]
  s_waitcnt vmcnt(21) lgkmcnt(5)
  v_fma_f32 v28, v28, v23, v23
  v_rcp_f32 v28, v28
  v_mfma_f32_16x16x32_bf16 v[64:67], a[180:183], a[32:35], v[64:67]
  ds_read_b64_tr_b16 a[170:171], v8 offset:2048
  v_fma_f32 v29, v29, v23, v23
  v_mfma_f32_16x16x32_bf16 v[64:67], a[176:179], a[48:51], v[64:67]
  buffer_load_dwordx4 a[116:119], v1, s[8:11], s75 offen offset:1024 sc1
  v_rcp_f32 v29, v29
  v_fma_f32 v30, v30, v23, v23
  v_mfma_f32_16x16x32_bf16 v[68:71], a[176:179], a[52:55], v[68:71]
  ds_read_b64_tr_b16 a[172:173], v8 offset:4096
  v_rcp_f32 v30, v30
  v_mfma_f32_16x16x32_bf16 v[68:71], a[180:183], a[36:39], v[68:71]
  s_add_u32 s75, s75, s88
  v_fma_f32 v31, v31, v23, v23
  v_rcp_f32 v31, v31
  v_mfma_f32_16x16x32_bf16 v[72:75], a[180:183], a[40:43], v[72:75]
  ds_read_b64_tr_b16 a[174:175], v8 offset:6144
  v_mul_f32 v248, v248, v24
  v_mul_f32 v249, v249, v25
  v_mfma_f32_16x16x32_bf16 v[72:75], a[176:179], a[56:59], v[72:75]
  buffer_load_dwordx4 a[104:107], v1, s[8:11], s75 offen offset:0 sc1
  v_mul_f32 v250, v250, v26
  v_mul_f32 v251, v251, v27
  v_mfma_f32_16x16x32_bf16 v[76:79], a[176:179], a[60:63], v[76:79]
  ds_read_b64_tr_b16 a[176:177], v9 offset:0
  v_mul_f32 v252, v252, v28
  v_mul_f32 v253, v253, v29
  v_mfma_f32_16x16x32_bf16 v[76:79], a[180:183], a[44:47], v[76:79]
  s_waitcnt lgkmcnt(5)
  v_mul_f32 v254, v254, v30
  v_mul_f32 v255, v255, v31
  v_cvt_pk_bf16_f32 v202, v248, v249
  v_mfma_f32_16x16x32_bf16 v[92:95], a[160:163], a[44:47], v[92:95]
  ds_read_b64_tr_b16 a[178:179], v9 offset:2048
  v_cvt_pk_bf16_f32 v203, v250, v251
  v_cvt_pk_bf16_f32 v206, v252, v253
  v_mfma_f32_16x16x32_bf16 v[92:95], a[164:167], a[60:63], v[92:95]
  buffer_load_dwordx4 a[120:123], v1, s[8:11], s75 offen offset:1024 sc1
  s_add_u32 s55, s57, 524288
  buffer_store_dwordx4 v[200:203], v1, s[8:11], s55 offen offset:1024 sc1
  v_mfma_f32_16x16x32_bf16 v[88:91], a[164:167], a[56:59], v[88:91]
  ds_read_b64_tr_b16 a[180:181], v9 offset:4096
  v_cvt_pk_bf16_f32 v207, v254, v255
  v_mfma_f32_16x16x32_bf16 v[88:91], a[160:163], a[40:43], v[88:91]
  s_add_u32 s55, s57, 786432
  buffer_store_dwordx4 v[204:207], v1, s[8:11], s55 offen offset:1024 sc1
  v_mfma_f32_16x16x32_bf16 v[84:87], a[160:163], a[36:39], v[84:87]
  ds_read_b64_tr_b16 a[182:183], v9 offset:6144
  s_sub_u32 s79, s79, 491520
  v_mfma_f32_16x16x32_bf16 v[84:87], a[164:167], a[52:55], v[84:87]
  s_add_u32 s75, s75, 131072
  v_mfma_f32_16x16x32_bf16 v[80:83], a[164:167], a[48:51], v[80:83]
  ds_read_b64_tr_b16 a[164:165], v6 offset:8192
  v_mfma_f32_16x16x32_bf16 v[80:83], a[160:163], a[32:35], v[80:83]
  s_waitcnt lgkmcnt(5)
  buffer_load_dwordx4 a[108:111], v1, s[8:11], s75 offen offset:0 sc1
  v_mfma_f32_16x16x32_bf16 v[96:99], a[168:171], a[32:35], v[96:99]
  ds_read_b64_tr_b16 a[166:167], v6 offset:10240
  v_mfma_f32_16x16x32_bf16 v[96:99], a[172:175], a[48:51], v[96:99]
  v_mfma_f32_16x16x32_bf16 v[100:103], a[172:175], a[52:55], v[100:103]
  ds_read_b64_tr_b16 a[160:161], v6 offset:12288
  v_mfma_f32_16x16x32_bf16 v[100:103], a[168:171], a[36:39], v[100:103]
  buffer_load_dwordx4 a[124:127], v1, s[8:11], s75 offen offset:1024 sc1
  v_mfma_f32_16x16x32_bf16 v[104:107], a[168:171], a[40:43], v[104:107]
  ds_read_b64_tr_b16 a[162:163], v6 offset:14336
  v_mfma_f32_16x16x32_bf16 v[104:107], a[172:175], a[56:59], v[104:107]
  v_mfma_f32_16x16x32_bf16 v[108:111], a[172:175], a[60:63], v[108:111]
  ds_read_b64_tr_b16 a[172:173], v7 offset:8192
  v_mfma_f32_16x16x32_bf16 v[108:111], a[168:171], a[44:47], v[108:111]
  s_waitcnt lgkmcnt(5)
  buffer_load_dwordx4 a[128:131], v1, s[8:11], s76 offen offset:0 sc1
  v_mfma_f32_16x16x32_bf16 v[124:127], a[176:179], a[44:47], v[124:127]
  ds_read_b64_tr_b16 a[174:175], v7 offset:10240
  v_mfma_f32_16x16x32_bf16 v[124:127], a[180:183], a[60:63], v[124:127]
  v_mfma_f32_16x16x32_bf16 v[120:123], a[180:183], a[56:59], v[120:123]
  ds_read_b64_tr_b16 a[168:169], v7 offset:12288
  v_mfma_f32_16x16x32_bf16 v[120:123], a[176:179], a[40:43], v[120:123]
  buffer_load_dwordx4 a[144:147], v1, s[8:11], s76 offen offset:1024 sc1
  v_mfma_f32_16x16x32_bf16 v[116:119], a[176:179], a[36:39], v[116:119]
  ds_read_b64_tr_b16 a[170:171], v7 offset:14336
  v_mfma_f32_16x16x32_bf16 v[116:119], a[180:183], a[52:55], v[116:119]
  v_mfma_f32_16x16x32_bf16 v[112:115], a[180:183], a[48:51], v[112:115]
  ds_read_b64_tr_b16 a[180:181], v8 offset:8192
  v_mfma_f32_16x16x32_bf16 v[112:115], a[176:179], a[32:35], v[112:115]
  s_waitcnt lgkmcnt(5)
  s_add_u32 s76, s76, 131072
  v_mfma_f32_16x16x32_bf16 v[128:131], a[164:167], a[32:35], v[128:131]
  ds_read_b64_tr_b16 a[182:183], v8 offset:10240
  v_mfma_f32_16x16x32_bf16 v[128:131], a[160:163], a[48:51], v[128:131]
  buffer_load_dwordx4 a[132:135], v1, s[8:11], s76 offen offset:0 sc1
  v_mfma_f32_16x16x32_bf16 v[132:135], a[160:163], a[52:55], v[132:135]
  ds_read_b64_tr_b16 a[176:177], v8 offset:12288
  v_mfma_f32_16x16x32_bf16 v[132:135], a[164:167], a[36:39], v[132:135]
  v_mfma_f32_16x16x32_bf16 v[136:139], a[164:167], a[40:43], v[136:139]
  ds_read_b64_tr_b16 a[178:179], v8 offset:14336
  v_mfma_f32_16x16x32_bf16 v[136:139], a[160:163], a[56:59], v[136:139]
  buffer_load_dwordx4 a[148:151], v1, s[8:11], s76 offen offset:1024 sc1
  v_mfma_f32_16x16x32_bf16 v[140:143], a[160:163], a[60:63], v[140:143]
  ds_read_b64_tr_b16 a[160:161], v9 offset:8192
  v_mfma_f32_16x16x32_bf16 v[140:143], a[164:167], a[44:47], v[140:143]
  s_waitcnt lgkmcnt(5)
  s_add_u32 s76, s76, s88
  v_mfma_f32_16x16x32_bf16 v[156:159], a[172:175], a[44:47], v[156:159]
  ds_read_b64_tr_b16 a[162:163], v9 offset:10240
  v_mfma_f32_16x16x32_bf16 v[156:159], a[168:171], a[60:63], v[156:159]
  buffer_load_dwordx4 a[136:139], v1, s[8:11], s76 offen offset:0 sc1
  v_mfma_f32_16x16x32_bf16 v[152:155], a[168:171], a[56:59], v[152:155]
  ds_read_b64_tr_b16 a[164:165], v9 offset:12288
  v_mfma_f32_16x16x32_bf16 v[152:155], a[172:175], a[40:43], v[152:155]
  v_mfma_f32_16x16x32_bf16 v[148:151], a[172:175], a[36:39], v[148:151]
  ds_read_b64_tr_b16 a[166:167], v9 offset:14336
  v_mfma_f32_16x16x32_bf16 v[148:151], a[168:171], a[52:55], v[148:151]
  buffer_load_dwordx4 a[152:155], v1, s[8:11], s76 offen offset:1024 sc1
  v_mfma_f32_16x16x32_bf16 v[144:147], a[168:171], a[48:51], v[144:147]
  ds_read_b64_tr_b16 a[168:169], v2 offset:0
  v_mfma_f32_16x16x32_bf16 v[144:147], a[172:175], a[32:35], v[144:147]
  s_waitcnt lgkmcnt(5)
  v_mfma_f32_16x16x32_bf16 v[160:163], a[180:183], a[32:35], v[160:163]
  ds_read_b64_tr_b16 a[170:171], v2 offset:2048
  v_mfma_f32_16x16x32_bf16 v[160:163], a[176:179], a[48:51], v[160:163]
  s_add_u32 s76, s76, 131072
  v_mfma_f32_16x16x32_bf16 v[164:167], a[176:179], a[52:55], v[164:167]
  ds_read_b64_tr_b16 a[172:173], v2 offset:4096
  v_mfma_f32_16x16x32_bf16 v[164:167], a[180:183], a[36:39], v[164:167]
  buffer_load_dwordx4 a[140:143], v1, s[8:11], s76 offen offset:0 sc1
  v_mfma_f32_16x16x32_bf16 v[168:171], a[180:183], a[40:43], v[168:171]
  ds_read_b64_tr_b16 a[174:175], v2 offset:6144
  v_mfma_f32_16x16x32_bf16 v[168:171], a[176:179], a[56:59], v[168:171]
  v_mfma_f32_16x16x32_bf16 v[172:175], a[176:179], a[60:63], v[172:175]
  ds_read_b64_tr_b16 a[176:177], v3 offset:0
  v_mfma_f32_16x16x32_bf16 v[172:175], a[180:183], a[44:47], v[172:175]
  s_waitcnt lgkmcnt(5)
  buffer_load_dwordx4 a[156:159], v1, s[8:11], s76 offen offset:1024 sc1
  v_mfma_f32_16x16x32_bf16 v[188:191], a[160:163], a[44:47], v[188:191]
  ds_read_b64_tr_b16 a[178:179], v3 offset:2048
  v_mfma_f32_16x16x32_bf16 v[188:191], a[164:167], a[60:63], v[188:191]
  s_cmp_eq_u32 s90, 0
  s_cselect_b32 s77, 7, 0
  s_lshl_b32 s69, s77, 17
  s_lshl_b32 s77, s77, 11
  s_add_u32 s77, s77, s83
  s_add_u32 m0, s45, 16384
  v_mfma_f32_16x16x32_bf16 v[184:187], a[164:167], a[56:59], v[184:187]
  ds_read_b64_tr_b16 a[180:181], v3 offset:4096
  v_mfma_f32_16x16x32_bf16 v[184:187], a[160:163], a[40:43], v[184:187]
  buffer_load_dwordx4 v32, s[36:39], s69 offen lds
  v_mfma_f32_16x16x32_bf16 v[180:183], a[160:163], a[36:39], v[180:183]
  ds_read_b64_tr_b16 a[182:183], v3 offset:6144
  v_mfma_f32_16x16x32_bf16 v[180:183], a[164:167], a[52:55], v[180:183]
  s_add_u32 m0, s45, 20480
  s_add_u32 s60, s69, 65536
  v_mfma_f32_16x16x32_bf16 v[176:179], a[164:167], a[48:51], v[176:179]
  ds_read_b64_tr_b16 a[164:165], v4 offset:0
  v_mfma_f32_16x16x32_bf16 v[176:179], a[160:163], a[32:35], v[176:179]
  s_waitcnt vmcnt(29) lgkmcnt(5)
  buffer_load_dwordx4 v32, s[36:39], s60 offen lds
  v_mfma_f32_16x16x32_bf16 v[64:67], a[168:171], a[64:67], v[64:67]
  ds_read_b64_tr_b16 a[166:167], v4 offset:2048
  v_mfma_f32_16x16x32_bf16 v[64:67], a[172:175], a[80:83], v[64:67]
  v_mfma_f32_16x16x32_bf16 v[68:71], a[172:175], a[84:87], v[68:71]
  ds_read_b64_tr_b16 a[160:161], v4 offset:4096
  v_mfma_f32_16x16x32_bf16 v[68:71], a[168:171], a[68:71], v[68:71]
  s_add_u32 m0, s45, 24576
  v_mfma_f32_16x16x32_bf16 v[72:75], a[168:171], a[72:75], v[72:75]
  ds_read_b64_tr_b16 a[162:163], v4 offset:6144
  v_mfma_f32_16x16x32_bf16 v[72:75], a[172:175], a[88:91], v[72:75]
  buffer_load_dwordx4 v33, s[36:39], s69 offen lds
  v_mfma_f32_16x16x32_bf16 v[76:79], a[172:175], a[92:95], v[76:79]
  ds_read_b64_tr_b16 a[172:173], v5 offset:0
  v_mfma_f32_16x16x32_bf16 v[76:79], a[168:171], a[76:79], v[76:79]
  s_waitcnt lgkmcnt(5)
  s_add_u32 m0, s45, 28672
  s_add_u32 s60, s69, 65536
  v_mfma_f32_16x16x32_bf16 v[92:95], a[176:179], a[76:79], v[92:95]
  ds_read_b64_tr_b16 a[174:175], v5 offset:2048
  v_mfma_f32_16x16x32_bf16 v[92:95], a[180:183], a[92:95], v[92:95]
  buffer_load_dwordx4 v33, s[36:39], s60 offen lds
  v_add_u32 v38, s46, v0
  s_waitcnt vmcnt(14)
  s_barrier
  s_mov_b64 exec, 1
  buffer_store_dword v38, v0, s[8:11], s79 offen offset:0 sc1
  s_mov_b64 exec, -1
  v_mfma_f32_16x16x32_bf16 v[88:91], a[180:183], a[88:91], v[88:91]
  ds_read_b64_tr_b16 a[168:169], v5 offset:4096
  s_lshl_b32 s53, s44, 8
  v_mfma_f32_16x16x32_bf16 v[88:91], a[176:179], a[72:75], v[88:91]
  s_cmp_eq_u32 s90, 1
  s_cselect_b32 s78, 9, 2
  s_lshl_b32 s70, s78, 17
  s_lshl_b32 s78, s78, 11
  s_add_u32 s78, s78, s83
  s_add_u32 m0, s45, 98304
  s_add_u32 s53, s53, 133120
  v_lshrrev_b32 v49, 4, v0
  v_mfma_f32_16x16x32_bf16 v[84:87], a[176:179], a[68:71], v[84:87]
  ds_read_b64_tr_b16 a[170:171], v5 offset:6144
  v_lshl_add_u32 v46, v49, 4, s53
  v_mfma_f32_16x16x32_bf16 v[84:87], a[180:183], a[84:87], v[84:87]
  buffer_load_dwordx4 v32, s[36:39], s70 offen lds
  v_lshlrev_b32 v47, 2, v0
  v_add_u32 v45, s53, v47
  v_mfma_f32_16x16x32_bf16 v[80:83], a[180:183], a[80:83], v[80:83]
  ds_read_b64_tr_b16 a[180:181], v2 offset:8192
  v_lshrrev_b32 v48, 3, v0
  v_mfma_f32_16x16x32_bf16 v[80:83], a[176:179], a[64:67], v[80:83]
  s_waitcnt lgkmcnt(5)
  s_add_u32 m0, s45, 102400
  s_add_u32 s60, s70, 65536
  v_mfma_f32_16x16x32_bf16 v[96:99], a[164:167], a[64:67], v[96:99]
  ds_read_b64_tr_b16 a[182:183], v2 offset:10240
  v_and_b32 v50, 7, v0
  v_mfma_f32_16x16x32_bf16 v[96:99], a[160:163], a[80:83], v[96:99]
  buffer_load_dwordx4 v32, s[36:39], s60 offen lds
  v_xor_b32 v51, v50, v48
  v_lshlrev_b32 v51, 4, v51
  v_mfma_f32_16x16x32_bf16 v[100:103], a[160:163], a[84:87], v[100:103]
  ds_read_b64_tr_b16 a[176:177], v2 offset:12288
  v_lshl_add_u32 v40, v48, 11, v51
  v_mfma_f32_16x16x32_bf16 v[100:103], a[164:167], a[68:71], v[100:103]
  v_bfe_u32 v48, v0, 4, 1
  v_lshrrev_b32 v51, 5, v0
  v_mfma_f32_16x16x32_bf16 v[104:107], a[164:167], a[72:75], v[104:107]
  ds_read_b64_tr_b16 a[178:179], v2 offset:14336
  v_lshl_add_u32 v48, v48, 1, v51
  v_mfma_f32_16x16x32_bf16 v[104:107], a[160:163], a[88:91], v[104:107]
  s_cmp_eq_u32 s90, 2
  s_cselect_b32 s71, 11, 4
  s_lshl_b32 s63, s71, 17
  s_lshl_b32 s71, s71, 11
  s_add_u32 s71, s71, s83
  s_add_u32 m0, s45, 114688
  v_xor_b32 v48, v48, v50
  v_lshlrev_b32 v48, 4, v48
  v_mfma_f32_16x16x32_bf16 v[108:111], a[160:163], a[92:95], v[108:111]
  ds_read_b64_tr_b16 a[160:161], v3 offset:8192
  v_and_b32 v50, 15, v0
  v_mfma_f32_16x16x32_bf16 v[108:111], a[164:167], a[76:79], v[108:111]
  s_waitcnt lgkmcnt(5)
  buffer_load_dwordx4 v32, s[36:39], s63 offen lds
  v_lshl_add_u32 v48, v50, 7, v48
  v_mfma_f32_16x16x32_bf16 v[124:127], a[172:175], a[76:79], v[124:127]
  ds_read_b64_tr_b16 a[162:163], v3 offset:10240
  v_add_u32 v42, s89, v48
  v_mfma_f32_16x16x32_bf16 v[124:127], a[168:171], a[92:95], v[124:127]
  s_add_u32 m0, s45, 118784
  s_add_u32 s60, s63, 65536
  v_xor_b32 v43, 64, v42
  v_mfma_f32_16x16x32_bf16 v[120:123], a[168:171], a[88:91], v[120:123]
  ds_read_b64_tr_b16 a[164:165], v3 offset:12288
  v_add_u32 v44, s89, v1
  v_mfma_f32_16x16x32_bf16 v[120:123], a[172:175], a[72:75], v[120:123]
  buffer_load_dwordx4 v32, s[36:39], s60 offen lds
  v_bfe_u32 v48, v0, 2, 2
  v_lshrrev_b32 v49, 4, v0
  v_mfma_f32_16x16x32_bf16 v[116:119], a[172:175], a[68:71], v[116:119]
  ds_read_b64_tr_b16 a[166:167], v3 offset:14336
  v_and_b32 v50, 1, v0
  v_mfma_f32_16x16x32_bf16 v[116:119], a[168:171], a[84:87], v[116:119]
  s_cmp_eq_u32 s90, 3
  s_cselect_b32 s72, 13, 6
  s_lshl_b32 s64, s72, 17
  s_lshl_b32 s72, s72, 11
  s_add_u32 s72, s72, s83
  s_add_u32 m0, s45, 81920
  v_lshlrev_b32 v50, 4, v50
  v_mov_b32 v51, 0xffff
  v_mfma_f32_16x16x32_bf16 v[112:115], a[168:171], a[80:83], v[112:115]
  ds_read_b64_tr_b16 a[168:169], v4 offset:8192
  v_lshlrev_b32 v50, v50, v51
  v_mfma_f32_16x16x32_bf16 v[112:115], a[172:175], a[64:67], v[112:115]
  s_waitcnt lgkmcnt(5)
  buffer_load_dwordx4 v32, s[36:39], s64 offen lds
  v_cmp_eq_u32 vcc, v48, v49
  v_mov_b32 v60, 0
  v_mov_b32 v61, 0
  v_cndmask_b32 v48, 0, v50, vcc
  v_mfma_f32_16x16x32_bf16 v[128:131], a[180:183], a[64:67], v[128:131]
  ds_read_b64_tr_b16 a[170:171], v4 offset:10240
  v_and_b32 v49, 2, v0
  v_mfma_f32_16x16x32_bf16 v[128:131], a[176:179], a[80:83], v[128:131]
  s_add_u32 m0, s45, 86016
  s_add_u32 s60, s64, 65536
  v_cmp_eq_u32 vcc, 0, v49
  v_mov_b32 v54, 0
  v_mov_b32 v55, 0
  v_cndmask_b32 v50, 0, v48, vcc
  v_mfma_f32_16x16x32_bf16 v[132:135], a[176:179], a[84:87], v[132:135]
  ds_read_b64_tr_b16 a[172:173], v4 offset:12288
  v_sub_u32 v51, v48, v50
  v_mfma_f32_16x16x32_bf16 v[132:135], a[180:183], a[68:71], v[132:135]
  buffer_load_dwordx4 v32, s[36:39], s60 offen lds
  v_mfma_f32_16x16x32_bf16 v[136:139], a[180:183], a[72:75], v[136:139]
  ds_read_b64_tr_b16 a[174:175], v4 offset:14336
  v_mfma_f32_16x16x32_bf16 v[136:139], a[176:179], a[88:91], v[136:139]
  v_mfma_f32_16x16x32_bf16 v[140:143], a[176:179], a[92:95], v[140:143]
  ds_read_b64_tr_b16 a[176:177], v5 offset:8192
  v_mfma_f32_16x16x32_bf16 v[140:143], a[180:183], a[76:79], v[140:143]
  s_waitcnt lgkmcnt(5)
  s_add_u32 m0, s45, 106496
  v_mfma_f32_16x16x32_bf16 v[156:159], a[160:163], a[76:79], v[156:159]
  ds_read_b64_tr_b16 a[178:179], v5 offset:10240
  v_mfma_f32_16x16x32_bf16 v[156:159], a[164:167], a[92:95], v[156:159]
  buffer_load_dwordx4 v33, s[36:39], s70 offen lds
  v_mfma_f32_16x16x32_bf16 v[152:155], a[164:167], a[88:91], v[152:155]
  ds_read_b64_tr_b16 a[180:181], v5 offset:12288
  v_mfma_f32_16x16x32_bf16 v[152:155], a[160:163], a[72:75], v[152:155]
  s_add_u32 m0, s45, 110592
  s_add_u32 s60, s70, 65536
  v_mfma_f32_16x16x32_bf16 v[148:151], a[160:163], a[68:71], v[148:151]
  ds_read_b64_tr_b16 a[182:183], v5 offset:14336
  buffer_load_dwordx4 v33, s[36:39], s60 offen lds
  v_mfma_f32_16x16x32_bf16 v[148:151], a[164:167], a[84:87], v[148:151]
  s_waitcnt vmcnt(31)
  s_barrier
  v_mfma_f32_16x16x32_bf16 v[144:147], a[164:167], a[80:83], v[144:147]
  ds_read_b64_tr_b16 a[164:165], v2 offset:32768
  v_mfma_f32_16x16x32_bf16 v[144:147], a[160:163], a[64:67], v[144:147]
  s_waitcnt lgkmcnt(5)
  s_cmp_eq_u32 s90, 0
  s_cselect_b32 s73, 0, 7
  s_lshl_b32 s65, s73, 17
  s_lshl_b32 s73, s73, 11
  s_add_u32 s73, s73, s83
  s_add_u32 m0, s45, 65536
  v_mfma_f32_16x16x32_bf16 v[160:163], a[168:171], a[64:67], v[160:163]
  ds_read_b64_tr_b16 a[166:167], v2 offset:34816
  v_mfma_f32_16x16x32_bf16 v[160:163], a[172:175], a[80:83], v[160:163]
  buffer_load_dwordx4 v32, s[36:39], s65 offen lds
  v_mfma_f32_16x16x32_bf16 v[164:167], a[172:175], a[84:87], v[164:167]
  ds_read_b64_tr_b16 a[160:161], v2 offset:36864
  v_mfma_f32_16x16x32_bf16 v[164:167], a[168:171], a[68:71], v[164:167]
  s_add_u32 m0, s45, 69632
  s_add_u32 s60, s65, 65536
  v_mfma_f32_16x16x32_bf16 v[168:171], a[168:171], a[72:75], v[168:171]
  ds_read_b64_tr_b16 a[162:163], v2 offset:38912
  v_mfma_f32_16x16x32_bf16 v[168:171], a[172:175], a[88:91], v[168:171]
  buffer_load_dwordx4 v32, s[36:39], s60 offen lds
  v_mfma_f32_16x16x32_bf16 v[172:175], a[172:175], a[92:95], v[172:175]
  ds_read_b64_tr_b16 a[172:173], v3 offset:32768
  v_mfma_f32_16x16x32_bf16 v[172:175], a[168:171], a[76:79], v[172:175]
  s_waitcnt lgkmcnt(5)
  v_mfma_f32_16x16x32_bf16 v[188:191], a[176:179], a[76:79], v[188:191]
  ds_read_b64_tr_b16 a[174:175], v3 offset:34816
  v_mfma_f32_16x16x32_bf16 v[188:191], a[180:183], a[92:95], v[188:191]
  s_add_u32 s61, s87, 0
  v_mfma_f32_16x16x32_bf16 v[184:187], a[180:183], a[88:91], v[184:187]
  ds_read_b64_tr_b16 a[168:169], v3 offset:36864
  v_mfma_f32_16x16x32_bf16 v[184:187], a[176:179], a[72:75], v[184:187]
  buffer_load_dword v240, v47, s[8:11], s61 offen sc1
  v_mfma_f32_16x16x32_bf16 v[180:183], a[176:179], a[68:71], v[180:183]
  ds_read_b64_tr_b16 a[170:171], v3 offset:38912
  v_mfma_f32_16x16x32_bf16 v[180:183], a[180:183], a[84:87], v[180:183]
  s_add_u32 s61, s87, 24576
  v_mfma_f32_16x16x32_bf16 v[176:179], a[180:183], a[80:83], v[176:179]
  ds_read_b64_tr_b16 a[180:181], v4 offset:32768
  v_mfma_f32_16x16x32_bf16 v[176:179], a[176:179], a[64:67], v[176:179]
  s_waitcnt vmcnt(24) lgkmcnt(5)
  buffer_load_dword v241, v47, s[8:11], s61 offen sc1
  v_mfma_f32_16x16x32_bf16 v[64:67], a[164:167], a[96:99], v[64:67]
  ds_read_b64_tr_b16 a[182:183], v4 offset:34816
  v_mfma_f32_16x16x32_bf16 v[64:67], a[160:163], a[112:115], v[64:67]
  s_add_u32 s61, s87, 49152
  v_mfma_f32_16x16x32_bf16 v[68:71], a[160:163], a[116:119], v[68:71]
  ds_read_b64_tr_b16 a[176:177], v4 offset:36864
  v_mfma_f32_16x16x32_bf16 v[68:71], a[164:167], a[100:103], v[68:71]
  buffer_load_dword v242, v47, s[8:11], s61 offen sc1
  v_mfma_f32_16x16x32_bf16 v[72:75], a[164:167], a[104:107], v[72:75]
  ds_read_b64_tr_b16 a[178:179], v4 offset:38912
  v_mfma_f32_16x16x32_bf16 v[72:75], a[160:163], a[120:123], v[72:75]
  s_add_u32 s61, s87, 73728
  v_mfma_f32_16x16x32_bf16 v[76:79], a[160:163], a[124:127], v[76:79]
  ds_read_b64_tr_b16 a[160:161], v5 offset:32768
  v_mfma_f32_16x16x32_bf16 v[76:79], a[164:167], a[108:111], v[76:79]
  s_waitcnt lgkmcnt(5)
  buffer_load_dword v243, v47, s[8:11], s61 offen sc1
  v_mfma_f32_16x16x32_bf16 v[92:95], a[172:175], a[108:111], v[92:95]
  ds_read_b64_tr_b16 a[162:163], v5 offset:34816
  v_mfma_f32_16x16x32_bf16 v[92:95], a[168:171], a[124:127], v[92:95]
  v_mfma_f32_16x16x32_bf16 v[88:91], a[168:171], a[120:123], v[88:91]
  ds_read_b64_tr_b16 a[164:165], v5 offset:36864
  v_mfma_f32_16x16x32_bf16 v[88:91], a[172:175], a[104:107], v[88:91]
  s_cmp_eq_u32 s90, 1
  s_cselect_b32 s74, 2, 9
  s_lshl_b32 s66, s74, 17
  s_lshl_b32 s74, s74, 11
  s_add_u32 s74, s74, s83
  s_add_u32 m0, s45, 0
  v_mfma_f32_16x16x32_bf16 v[84:87], a[172:175], a[100:103], v[84:87]
  ds_read_b64_tr_b16 a[166:167], v5 offset:38912
  v_mfma_f32_16x16x32_bf16 v[84:87], a[168:171], a[116:119], v[84:87]
  buffer_load_dwordx4 v32, s[36:39], s66 offen lds
  v_mfma_f32_16x16x32_bf16 v[80:83], a[168:171], a[112:115], v[80:83]
  ds_read_b64_tr_b16 a[168:169], v2 offset:40960
  v_mfma_f32_16x16x32_bf16 v[80:83], a[172:175], a[96:99], v[80:83]
  s_waitcnt lgkmcnt(5)
  s_add_u32 m0, s45, 4096
  s_add_u32 s60, s66, 65536
  v_mfma_f32_16x16x32_bf16 v[96:99], a[180:183], a[96:99], v[96:99]
  ds_read_b64_tr_b16 a[170:171], v2 offset:43008
  v_mfma_f32_16x16x32_bf16 v[96:99], a[176:179], a[112:115], v[96:99]
  s_sub_u32 s81, s81, 491520
  buffer_load_dwordx4 v32, s[36:39], s60 offen lds
  v_mfma_f32_16x16x32_bf16 v[100:103], a[176:179], a[116:119], v[100:103]
  ds_read_b64_tr_b16 a[172:173], v2 offset:45056
  s_lshl_b32 s82, s44, 28
  s_add_u32 s82, s82, s81
  buffer_load_dword v36, v37, s[8:11], s82 offen sc1
  v_mfma_f32_16x16x32_bf16 v[100:103], a[180:183], a[100:103], v[100:103]
  s_add_u32 m0, s45, 122880
HOP17:
  s_cbranch_execz WRET1
  v_mfma_f32_16x16x32_bf16 v[104:107], a[180:183], a[104:107], v[104:107]
  ds_read_b64_tr_b16 a[174:175], v2 offset:47104
  v_mfma_f32_16x16x32_bf16 v[104:107], a[176:179], a[120:123], v[104:107]
  buffer_load_dwordx4 v33, s[36:39], s63 offen lds
  v_mfma_f32_16x16x32_bf16 v[108:111], a[176:179], a[124:127], v[108:111]
  ds_read_b64_tr_b16 a[176:177], v3 offset:40960
  v_mfma_f32_16x16x32_bf16 v[108:111], a[180:183], a[108:111], v[108:111]
  s_waitcnt lgkmcnt(5)
  s_add_u32 m0, s45, 126976
  s_add_u32 s60, s63, 65536
  v_mfma_f32_16x16x32_bf16 v[124:127], a[160:163], a[108:111], v[124:127]
  ds_read_b64_tr_b16 a[178:179], v3 offset:43008
  v_mfma_f32_16x16x32_bf16 v[124:127], a[164:167], a[124:127], v[124:127]
  buffer_load_dwordx4 v33, s[36:39], s60 offen lds
  v_mfma_f32_16x16x32_bf16 v[120:123], a[164:167], a[120:123], v[120:123]
  ds_read_b64_tr_b16 a[180:181], v3 offset:45056
  v_mfma_f32_16x16x32_bf16 v[120:123], a[160:163], a[104:107], v[120:123]
  v_mfma_f32_16x16x32_bf16 v[116:119], a[160:163], a[100:103], v[116:119]
  ds_read_b64_tr_b16 a[182:183], v3 offset:47104
  v_mfma_f32_16x16x32_bf16 v[116:119], a[164:167], a[116:119], v[116:119]
  s_add_u32 m0, s45, 90112
  v_mfma_f32_16x16x32_bf16 v[112:115], a[164:167], a[112:115], v[112:115]
  ds_read_b64_tr_b16 a[164:165], v4 offset:40960
  v_mfma_f32_16x16x32_bf16 v[112:115], a[160:163], a[96:99], v[112:115]
  s_waitcnt lgkmcnt(5)
  buffer_load_dwordx4 v33, s[36:39], s64 offen lds
  v_mfma_f32_16x16x32_bf16 v[128:131], a[168:171], a[96:99], v[128:131]
  ds_read_b64_tr_b16 a[166:167], v4 offset:43008
  v_mfma_f32_16x16x32_bf16 v[128:131], a[172:175], a[112:115], v[128:131]
  s_add_u32 m0, s45, 94208
  s_add_u32 s60, s64, 65536
  v_mfma_f32_16x16x32_bf16 v[132:135], a[172:175], a[116:119], v[132:135]
  ds_read_b64_tr_b16 a[160:161], v4 offset:45056
  v_mfma_f32_16x16x32_bf16 v[132:135], a[168:171], a[100:103], v[132:135]
  buffer_load_dwordx4 v33, s[36:39], s60 offen lds
  v_mfma_f32_16x16x32_bf16 v[136:139], a[168:171], a[104:107], v[136:139]
  ds_read_b64_tr_b16 a[162:163], v4 offset:47104
  v_mfma_f32_16x16x32_bf16 v[136:139], a[172:175], a[120:123], v[136:139]
  s_add_u32 m0, s45, 73728
  v_mfma_f32_16x16x32_bf16 v[140:143], a[172:175], a[124:127], v[140:143]
  ds_read_b64_tr_b16 a[172:173], v5 offset:40960
  v_mfma_f32_16x16x32_bf16 v[140:143], a[168:171], a[108:111], v[140:143]
  s_waitcnt lgkmcnt(5)
  buffer_load_dwordx4 v33, s[36:39], s65 offen lds
  v_mfma_f32_16x16x32_bf16 v[156:159], a[176:179], a[108:111], v[156:159]
  ds_read_b64_tr_b16 a[174:175], v5 offset:43008
  v_mfma_f32_16x16x32_bf16 v[156:159], a[180:183], a[124:127], v[156:159]
  s_add_u32 m0, s45, 77824
  s_add_u32 s60, s65, 65536
  v_mfma_f32_16x16x32_bf16 v[152:155], a[180:183], a[120:123], v[152:155]
  ds_read_b64_tr_b16 a[168:169], v5 offset:45056
  v_mfma_f32_16x16x32_bf16 v[152:155], a[176:179], a[104:107], v[152:155]
  buffer_load_dwordx4 v33, s[36:39], s60 offen lds
  v_mfma_f32_16x16x32_bf16 v[148:151], a[176:179], a[100:103], v[148:151]
  ds_read_b64_tr_b16 a[170:171], v5 offset:47104
  v_mfma_f32_16x16x32_bf16 v[148:151], a[180:183], a[116:119], v[148:151]
  v_mfma_f32_16x16x32_bf16 v[144:147], a[180:183], a[112:115], v[144:147]
  ds_read_b64_tr_b16 a[180:181], v2 offset:49152
  v_mfma_f32_16x16x32_bf16 v[144:147], a[176:179], a[96:99], v[144:147]
  s_waitcnt lgkmcnt(5)
  v_mfma_f32_16x16x32_bf16 v[160:163], a[164:167], a[96:99], v[160:163]
  ds_read_b64_tr_b16 a[182:183], v2 offset:51200
  v_mfma_f32_16x16x32_bf16 v[160:163], a[160:163], a[112:115], v[160:163]
  v_mfma_f32_16x16x32_bf16 v[164:167], a[160:163], a[116:119], v[164:167]
  ds_read_b64_tr_b16 a[176:177], v2 offset:53248
  v_mfma_f32_16x16x32_bf16 v[164:167], a[164:167], a[100:103], v[164:167]
  v_mfma_f32_16x16x32_bf16 v[168:171], a[164:167], a[104:107], v[168:171]
  ds_read_b64_tr_b16 a[178:179], v2 offset:55296
  v_mfma_f32_16x16x32_bf16 v[168:171], a[160:163], a[120:123], v[168:171]
  v_mfma_f32_16x16x32_bf16 v[172:175], a[160:163], a[124:127], v[172:175]
  ds_read_b64_tr_b16 a[160:161], v3 offset:49152
  v_mfma_f32_16x16x32_bf16 v[172:175], a[164:167], a[108:111], v[172:175]
  s_waitcnt lgkmcnt(5)
  v_mfma_f32_16x16x32_bf16 v[188:191], a[172:175], a[108:111], v[188:191]
  ds_read_b64_tr_b16 a[162:163], v3 offset:51200
  v_mfma_f32_16x16x32_bf16 v[188:191], a[168:171], a[124:127], v[188:191]
  v_mfma_f32_16x16x32_bf16 v[184:187], a[168:171], a[120:123], v[184:187]
  ds_read_b64_tr_b16 a[164:165], v3 offset:53248
  s_waitcnt vmcnt(6)
  s_cmp_lg_u32 s44, 0
  s_cbranch_scc1 PL13_adaLN_cond__sliding_local_dilated__swiglu_ffn__prompt_kernelx
  v_cmp_ne_u32 vcc, s46, v36
  s_nop 4
  s_cbranch_vccz PL13_adaLN_cond__sliding_local_dilated__swiglu_ffn__prompt_kernelx
  s_mov_b32 s82, 60000
PL13_adaLN_cond__sliding_local_dilated__swiglu_ffn__prompt_kernel:
  buffer_load_dword v36, v37, s[8:11], s81 offen sc1
  s_sub_u32 s82, s82, 1
  s_cmp_eq_u32 s82, 0
  s_waitcnt vmcnt(0)
  s_cbranch_scc1 PL13_adaLN_cond__sliding_local_dilated__swiglu_ffn__prompt_kernelx
  v_cmp_ne_u32 vcc, s46, v36
  s_nop 4
  s_cbranch_vccnz PL13_adaLN_cond__sliding_local_dilated__swiglu_ffn__prompt_kernel
PL13_adaLN_cond__sliding_local_dilated__swiglu_ffn__prompt_kernelx:
  s_barrier
  v_mfma_f32_16x16x32_bf16 v[184:187], a[172:175], a[104:107], v[184:187]
  v_mfma_f32_16x16x32_bf16 v[180:183], a[172:175], a[100:103], v[180:183]
  ds_read_b64_tr_b16 a[166:167], v3 offset:55296
  v_mfma_f32_16x16x32_bf16 v[180:183], a[168:171], a[116:119], v[180:183]
  buffer_load_dwordx4 a[188:191], v1, s[8:11], s77 offen offset:0 sc1
  v_mfma_f32_16x16x32_bf16 v[176:179], a[168:171], a[112:115], v[176:179]
  ds_read_b64_tr_b16 a[168:169], v4 offset:49152
  v_mfma_f32_16x16x32_bf16 v[176:179], a[172:175], a[96:99], v[176:179]
  s_waitcnt vmcnt(29) lgkmcnt(5)
  v_mfma_f32_16x16x32_bf16 v[64:67], a[180:183], a[128:131], v[64:67]
  ds_read_b64_tr_b16 a[170:171], v4 offset:51200
  v_mfma_f32_16x16x32_bf16 v[64:67], a[176:179], a[144:147], v[64:67]
  buffer_load_dwordx4 a[204:207], v1, s[8:11], s77 offen offset:1024 sc1
  v_mfma_f32_16x16x32_bf16 v[68:71], a[176:179], a[148:151], v[68:71]
  ds_read_b64_tr_b16 a[172:173], v4 offset:53248
  v_mfma_f32_16x16x32_bf16 v[68:71], a[180:183], a[132:135], v[68:71]
  s_add_u32 s77, s77, 131072
  v_mfma_f32_16x16x32_bf16 v[72:75], a[180:183], a[136:139], v[72:75]
  ds_read_b64_tr_b16 a[174:175], v4 offset:55296
  v_mfma_f32_16x16x32_bf16 v[72:75], a[176:179], a[152:155], v[72:75]
  buffer_load_dwordx4 a[192:195], v1, s[8:11], s77 offen offset:0 sc1
  v_mfma_f32_16x16x32_bf16 v[76:79], a[176:179], a[156:159], v[76:79]
  ds_read_b64_tr_b16 a[176:177], v5 offset:49152
  v_mfma_f32_16x16x32_bf16 v[76:79], a[180:183], a[140:143], v[76:79]
  s_waitcnt lgkmcnt(5)
  v_mfma_f32_16x16x32_bf16 v[92:95], a[160:163], a[140:143], v[92:95]
  ds_read_b64_tr_b16 a[178:179], v5 offset:51200
  v_mfma_f32_16x16x32_bf16 v[92:95], a[164:167], a[156:159], v[92:95]
  v_mfma_f32_16x16x32_bf16 v[88:91], a[164:167], a[152:155], v[88:91]
  ds_read_b64_tr_b16 a[180:181], v5 offset:53248
  v_mfma_f32_16x16x32_bf16 v[88:91], a[160:163], a[136:139], v[88:91]
  buffer_load_dwordx4 a[208:211], v1, s[8:11], s77 offen offset:1024 sc1
  v_mfma_f32_16x16x32_bf16 v[84:87], a[160:163], a[132:135], v[84:87]
  ds_read_b64_tr_b16 a[182:183], v5 offset:55296
  v_mfma_f32_16x16x32_bf16 v[84:87], a[164:167], a[148:151], v[84:87]
  s_add_u32 s77, s77, s88
  v_mfma_f32_16x16x32_bf16 v[80:83], a[164:167], a[144:147], v[80:83]
  ds_read_b64_tr_b16 a[164:165], v2 offset:57344
  v_mfma_f32_16x16x32_bf16 v[80:83], a[160:163], a[128:131], v[80:83]
  s_waitcnt lgkmcnt(5)
  buffer_load_dwordx4 a[196:199], v1, s[8:11], s77 offen offset:0 sc1
  v_mfma_f32_16x16x32_bf16 v[96:99], a[168:171], a[128:131], v[96:99]
  ds_read_b64_tr_b16 a[166:167], v2 offset:59392
  v_mfma_f32_16x16x32_bf16 v[96:99], a[172:175], a[144:147], v[96:99]
  v_mfma_f32_16x16x32_bf16 v[100:103], a[172:175], a[148:151], v[100:103]
  ds_read_b64_tr_b16 a[160:161], v2 offset:61440
  v_mfma_f32_16x16x32_bf16 v[100:103], a[168:171], a[132:135], v[100:103]
  buffer_load_dwordx4 a[212:215], v1, s[8:11], s77 offen offset:1024 sc1
  v_mfma_f32_16x16x32_bf16 v[104:107], a[168:171], a[136:139], v[104:107]
  ds_read_b64_tr_b16 a[162:163], v2 offset:63488
  v_mfma_f32_16x16x32_bf16 v[104:107], a[172:175], a[152:155], v[104:107]
  s_add_u32 s77, s77, 131072
  v_mfma_f32_16x16x32_bf16 v[108:111], a[172:175], a[156:159], v[108:111]
  ds_read_b64_tr_b16 a[172:173], v3 offset:57344
  v_mfma_f32_16x16x32_bf16 v[108:111], a[168:171], a[140:143], v[108:111]
  s_waitcnt lgkmcnt(5)
  buffer_load_dwordx4 a[200:203], v1, s[8:11], s77 offen offset:0 sc1
  v_mfma_f32_16x16x32_bf16 v[124:127], a[176:179], a[140:143], v[124:127]
  ds_read_b64_tr_b16 a[174:175], v3 offset:59392
  v_mfma_f32_16x16x32_bf16 v[124:127], a[180:183], a[156:159], v[124:127]
  v_mfma_f32_16x16x32_bf16 v[120:123], a[180:183], a[152:155], v[120:123]
  ds_read_b64_tr_b16 a[168:169], v3 offset:61440
  v_mfma_f32_16x16x32_bf16 v[120:123], a[176:179], a[136:139], v[120:123]
  v_mfma_f32_16x16x32_bf16 v[116:119], a[176:179], a[132:135], v[116:119]
  ds_read_b64_tr_b16 a[170:171], v3 offset:63488
  v_mfma_f32_16x16x32_bf16 v[116:119], a[180:183], a[148:151], v[116:119]
  buffer_load_dwordx4 a[216:219], v1, s[8:11], s77 offen offset:1024 sc1
  v_mfma_f32_16x16x32_bf16 v[112:115], a[180:183], a[144:147], v[112:115]
  ds_read_b64_tr_b16 a[180:181], v4 offset:57344
  v_mfma_f32_16x16x32_bf16 v[112:115], a[176:179], a[128:131], v[112:115]
  s_waitcnt lgkmcnt(5)
  v_mfma_f32_16x16x32_bf16 v[128:131], a[164:167], a[128:131], v[128:131]
  ds_read_b64_tr_b16 a[182:183], v4 offset:59392
  v_mfma_f32_16x16x32_bf16 v[128:131], a[160:163], a[144:147], v[128:131]
  buffer_load_dwordx4 a[220:223], v1, s[8:11], s78 offen offset:0 sc1
  v_mfma_f32_16x16x32_bf16 v[132:135], a[160:163], a[148:151], v[132:135]
  ds_read_b64_tr_b16 a[176:177], v4 offset:61440
  v_mfma_f32_16x16x32_bf16 v[132:135], a[164:167], a[132:135], v[132:135]
  v_mfma_f32_16x16x32_bf16 v[136:139], a[164:167], a[136:139], v[136:139]
  ds_read_b64_tr_b16 a[178:179], v4 offset:63488
  v_mfma_f32_16x16x32_bf16 v[136:139], a[160:163], a[152:155], v[136:139]
  buffer_load_dwordx4 a[236:239], v1, s[8:11], s78 offen offset:1024 sc1
  v_mfma_f32_16x16x32_bf16 v[140:143], a[160:163], a[156:159], v[140:143]
  ds_read_b64_tr_b16 a[160:161], v5 offset:57344
  v_mfma_f32_16x16x32_bf16 v[140:143], a[164:167], a[140:143], v[140:143]
  s_waitcnt lgkmcnt(5)
  s_add_u32 s78, s78, 131072
  v_mfma_f32_16x16x32_bf16 v[156:159], a[172:175], a[140:143], v[156:159]
  ds_read_b64_tr_b16 a[162:163], v5 offset:59392
  v_mfma_f32_16x16x32_bf16 v[156:159], a[168:171], a[156:159], v[156:159]
  buffer_load_dwordx4 a[224:227], v1, s[8:11], s78 offen offset:0 sc1
  ds_read_b128 v[192:195], v44 offset:0
  v_mfma_f32_16x16x32_bf16 v[152:155], a[168:171], a[152:155], v[152:155]
  ds_read_b64_tr_b16 a[164:165], v5 offset:61440
  v_mfma_f32_16x16x32_bf16 v[152:155], a[172:175], a[136:139], v[152:155]
  ds_read_b128 v[196:199], v44 offset:1024
  v_mfma_f32_16x16x32_bf16 v[148:151], a[172:175], a[132:135], v[148:151]
  ds_read_b64_tr_b16 a[166:167], v5 offset:63488
  v_mfma_f32_16x16x32_bf16 v[148:151], a[168:171], a[148:151], v[148:151]
  s_waitcnt vmcnt(35)
  s_barrier
  v_mfma_f32_16x16x32_bf16 v[144:147], a[168:171], a[144:147], v[144:147]
  ds_read_b64_tr_b16 a[168:169], v2 offset:16384
  v_mfma_f32_16x16x32_bf16 v[144:147], a[172:175], a[128:131], v[144:147]
  s_waitcnt lgkmcnt(7)
  buffer_load_dwordx4 a[240:243], v1, s[8:11], s78 offen offset:1024 sc1
  v_mfma_f32_16x16x32_bf16 v[160:163], a[180:183], a[128:131], v[160:163]
  ds_read_b64_tr_b16 a[170:171], v2 offset:18432
  ds_read_b128 v[200:203], v44 offset:2048
  v_mfma_f32_16x16x32_bf16 v[160:163], a[176:179], a[144:147], v[160:163]
  s_add_u32 s78, s78, s88
  ds_read_b128 v[204:207], v44 offset:3072
  v_mfma_f32_16x16x32_bf16 v[164:167], a[176:179], a[148:151], v[164:167]
  ds_read_b64_tr_b16 a[172:173], v2 offset:20480
  s_waitcnt vmcnt(21)
  v_mfma_f32_16x16x32_bf16 v[164:167], a[180:183], a[132:135], v[164:167]
  buffer_load_dwordx4 a[228:231], v1, s[8:11], s78 offen offset:0 sc1
  v_add_f32 v240, v240, v241
  v_add_f32 v242, v242, v243
  v_mfma_f32_16x16x32_bf16 v[168:171], a[180:183], a[136:139], v[168:171]
  ds_read_b64_tr_b16 a[174:175], v2 offset:22528
  v_add_f32 v240, v240, v242
  v_mfma_f32_16x16x32_bf16 v[168:171], a[176:179], a[152:155], v[168:171]
  v_cvt_pk_bf16_f32 v240, v240, v240
  v_lshlrev_b32 v240, 16, v240
  v_mfma_f32_16x16x32_bf16 v[172:175], a[176:179], a[156:159], v[172:175]
  ds_read_b64_tr_b16 a[176:177], v3 offset:16384
  v_mfma_f32_16x16x32_bf16 v[172:175], a[180:183], a[140:143], v[172:175]
  s_waitcnt lgkmcnt(7)
  buffer_load_dwordx4 a[244:247], v1, s[8:11], s78 offen offset:1024 sc1
  v_mfma_f32_16x16x32_bf16 v[188:191], a[160:163], a[140:143], v[188:191]
  ds_read_b64_tr_b16 a[178:179], v3 offset:18432
  v_mfma_f32_16x16x32_bf16 v[188:191], a[164:167], a[156:159], v[188:191]
  s_add_u32 s78, s78, 131072
  ds_write_b32 v45, v240
  v_mfma_f32_16x16x32_bf16 v[184:187], a[164:167], a[152:155], v[184:187]
  ds_read_b64_tr_b16 a[180:181], v3 offset:20480
  v_mfma_f32_16x16x32_bf16 v[184:187], a[160:163], a[136:139], v[184:187]
  buffer_load_dwordx4 a[232:235], v1, s[8:11], s78 offen offset:0 sc1
  ds_read_b128 v[240:243], v46 offset:0
  v_mfma_f32_16x16x32_bf16 v[180:183], a[160:163], a[132:135], v[180:183]
  ds_read_b64_tr_b16 a[182:183], v3 offset:22528
  v_mfma_f32_16x16x32_bf16 v[180:183], a[164:167], a[148:151], v[180:183]
  ds_read_b128 v[244:247], v46 offset:64
  v_mfma_f32_16x16x32_bf16 v[176:179], a[164:167], a[144:147], v[176:179]
  ds_read_b64_tr_b16 a[164:165], v4 offset:16384
  v_mfma_f32_16x16x32_bf16 v[176:179], a[160:163], a[128:131], v[176:179]
  s_waitcnt vmcnt(7) lgkmcnt(8)
  ds_read_b128 v[248:251], v46 offset:128
  v_mfma_f32_16x16x32_bf16 v[64:67], a[168:171], a[188:191], v[64:67]
  ds_read_b64_tr_b16 a[166:167], v4 offset:18432
  v_mfma_f32_16x16x32_bf16 v[64:67], a[172:175], a[204:207], v[64:67]
  buffer_load_dwordx4 a[248:251], v1, s[8:11], s78 offen offset:1024 sc1
  ds_read_b128 v[252:255], v46 offset:192
  v_mfma_f32_16x16x32_bf16 v[68:71], a[172:175], a[208:211], v[68:71]
  ds_read_b64_tr_b16 a[160:161], v4 offset:20480
  s_waitcnt lgkmcnt(14)
  v_mfma_f32_16x16x32_bf16 v[68:71], a[168:171], a[192:195], v[68:71]
  v_lshlrev_b32 v208, 16, v192
  v_and_b32 v209, 0xffff0000, v192
  v_mfma_f32_16x16x32_bf16 v[72:75], a[168:171], a[196:199], v[72:75]
  ds_read_b64_tr_b16 a[162:163], v4 offset:22528
  v_lshlrev_b32 v210, 16, v193
  v_mfma_f32_16x16x32_bf16 v[72:75], a[172:175], a[212:215], v[72:75]
  buffer_load_dwordx4 a[0:3], v1, s[8:11], s71 offen offset:0 sc1
  v_and_b32 v211, 0xffff0000, v193
  v_lshlrev_b32 v212, 16, v194
  v_mfma_f32_16x16x32_bf16 v[76:79], a[172:175], a[216:219], v[76:79]
  ds_read_b64_tr_b16 a[172:173], v5 offset:16384
  v_and_b32 v213, 0xffff0000, v194
  v_mfma_f32_16x16x32_bf16 v[76:79], a[168:171], a[200:203], v[76:79]
  s_waitcnt lgkmcnt(8)
  v_lshlrev_b32 v214, 16, v195
  v_and_b32 v215, 0xffff0000, v195
  v_mfma_f32_16x16x32_bf16 v[92:95], a[176:179], a[200:203], v[92:95]
  ds_read_b64_tr_b16 a[174:175], v5 offset:18432
  v_lshlrev_b32 v216, 16, v196
  v_mfma_f32_16x16x32_bf16 v[92:95], a[180:183], a[216:219], v[92:95]
  buffer_load_dwordx4 a[16:19], v1, s[8:11], s71 offen offset:1024 sc1
  v_and_b32 v217, 0xffff0000, v196
  v_lshlrev_b32 v218, 16, v197
  v_mfma_f32_16x16x32_bf16 v[88:91], a[180:183], a[212:215], v[88:91]
  ds_read_b64_tr_b16 a[168:169], v5 offset:20480
  v_and_b32 v219, 0xffff0000, v197
  v_mfma_f32_16x16x32_bf16 v[88:91], a[176:179], a[196:199], v[88:91]
  s_add_u32 s71, s71, 131072
  v_lshlrev_b32 v220, 16, v198
  v_and_b32 v221, 0xffff0000, v198
  v_mfma_f32_16x16x32_bf16 v[84:87], a[176:179], a[192:195], v[84:87]
  ds_read_b64_tr_b16 a[170:171], v5 offset:22528
  v_lshlrev_b32 v222, 16, v199
  v_mfma_f32_16x16x32_bf16 v[84:87], a[180:183], a[208:211], v[84:87]
  buffer_load_dwordx4 a[4:7], v1, s[8:11], s71 offen offset:0 sc1
  v_and_b32 v223, 0xffff0000, v199
  v_lshlrev_b32 v224, 16, v200
  v_mfma_f32_16x16x32_bf16 v[80:83], a[180:183], a[204:207], v[80:83]
  ds_read_b64_tr_b16 a[180:181], v2 offset:24576
  v_and_b32 v225, 0xffff0000, v200
  v_mfma_f32_16x16x32_bf16 v[80:83], a[176:179], a[188:191], v[80:83]
  s_waitcnt lgkmcnt(5)
  v_lshlrev_b32 v226, 16, v201
  v_and_b32 v227, 0xffff0000, v201
  v_mfma_f32_16x16x32_bf16 v[96:99], a[164:167], a[188:191], v[96:99]
  ds_read_b64_tr_b16 a[182:183], v2 offset:26624
  v_lshlrev_b32 v228, 16, v202
  v_mfma_f32_16x16x32_bf16 v[96:99], a[160:163], a[204:207], v[96:99]
  v_and_b32 v229, 0xffff0000, v202
  v_lshlrev_b32 v230, 16, v203
  v_mfma_f32_16x16x32_bf16 v[100:103], a[160:163], a[208:211], v[100:103]
  ds_read_b64_tr_b16 a[176:177], v2 offset:28672
  v_and_b32 v231, 0xffff0000, v203
  v_mfma_f32_16x16x32_bf16 v[100:103], a[164:167], a[192:195], v[100:103]
  buffer_load_dwordx4 a[20:23], v1, s[8:11], s71 offen offset:1024 sc1
  v_lshlrev_b32 v232, 16, v204
  v_and_b32 v233, 0xffff0000, v204
  v_mfma_f32_16x16x32_bf16 v[104:107], a[164:167], a[196:199], v[104:107]
  ds_read_b64_tr_b16 a[178:179], v2 offset:30720
  v_lshlrev_b32 v234, 16, v205
  v_mfma_f32_16x16x32_bf16 v[104:107], a[160:163], a[212:215], v[104:107]
  s_add_u32 s71, s71, s88
  v_and_b32 v235, 0xffff0000, v205
  v_lshlrev_b32 v236, 16, v206
  v_mfma_f32_16x16x32_bf16 v[108:111], a[160:163], a[216:219], v[108:111]
  ds_read_b64_tr_b16 a[160:161], v3 offset:24576
  v_and_b32 v237, 0xffff0000, v206
  v_mfma_f32_16x16x32_bf16 v[108:111], a[164:167], a[200:203], v[108:111]
  s_waitcnt lgkmcnt(5)
  buffer_load_dwordx4 a[8:11], v1, s[8:11], s71 offen offset:0 sc1
  v_lshlrev_b32 v238, 16, v207
  v_mfma_f32_16x16x32_bf16 v[124:127], a[172:175], a[200:203], v[124:127]
  ds_read_b64_tr_b16 a[162:163], v3 offset:26624
  v_and_b32 v239, 0xffff0000, v207
  v_mfma_f32_16x16x32_bf16 v[124:127], a[168:171], a[216:219], v[124:127]
  v_mov_b32 v37, 0
  s_waitcnt lgkmcnt(12)
  v_mfma_f32_16x16x32_bf16 v[120:123], a[168:171], a[212:215], v[120:123]
  ds_read_b64_tr_b16 a[164:165], v3 offset:28672
  v_cvt_pk_bf16_f32 v52, v240, v241
  v_mfma_f32_16x16x32_bf16 v[120:123], a[172:175], a[196:199], v[120:123]
  buffer_load_dwordx4 a[24:27], v1, s[8:11], s71 offen offset:1024 sc1
  v_and_b32 v52, v52, v50
  v_cvt_pk_bf16_f32 v53, v242, v243
  v_mfma_f32_16x16x32_bf16 v[116:119], a[172:175], a[192:195], v[116:119]
  ds_read_b64_tr_b16 a[166:167], v3 offset:30720
  v_and_b32 v53, v53, v51
  v_mfma_f32_16x16x32_bf16 v[116:119], a[168:171], a[208:211], v[116:119]
  s_add_u32 s71, s71, 131072
  v_cvt_pk_bf16_f32 v56, v244, v245
  v_and_b32 v56, v56, v50
  v_mfma_f32_16x16x32_bf16 v[112:115], a[168:171], a[204:207], v[112:115]
  ds_read_b64_tr_b16 a[168:169], v4 offset:24576
  v_cvt_pk_bf16_f32 v57, v246, v247
  v_mfma_f32_16x16x32_bf16 v[112:115], a[172:175], a[188:191], v[112:115]
  s_waitcnt lgkmcnt(5)
  buffer_load_dwordx4 a[12:15], v1, s[8:11], s71 offen offset:0 sc1
  v_and_b32 v57, v57, v51
  v_mfma_f32_16x16x32_bf16 v[128:131], a[180:183], a[188:191], v[128:131]
  ds_read_b64_tr_b16 a[170:171], v4 offset:26624
  v_cvt_pk_bf16_f32 v58, v248, v249
  v_mfma_f32_16x16x32_bf16 v[128:131], a[176:179], a[204:207], v[128:131]
  v_and_b32 v58, v58, v50
  v_cvt_pk_bf16_f32 v59, v250, v251
  v_mfma_f32_16x16x32_bf16 v[132:135], a[176:179], a[208:211], v[132:135]
  ds_read_b64_tr_b16 a[172:173], v4 offset:28672
  v_and_b32 v59, v59, v51
  v_mfma_f32_16x16x32_bf16 v[132:135], a[180:183], a[192:195], v[132:135]
  v_cvt_pk_bf16_f32 v62, v252, v253
  v_and_b32 v62, v62, v50
  v_mfma_f32_16x16x32_bf16 v[136:139], a[180:183], a[196:199], v[136:139]
  ds_read_b64_tr_b16 a[174:175], v4 offset:30720
  v_cvt_pk_bf16_f32 v63, v254, v255
  v_mfma_f32_16x16x32_bf16 v[136:139], a[176:179], a[212:215], v[136:139]
  buffer_load_dwordx4 a[28:31], v1, s[8:11], s71 offen offset:1024 sc1
  v_and_b32 v63, v63, v51
  v_mfma_f32_16x16x32_bf16 v[140:143], a[176:179], a[216:219], v[140:143]
  ds_read_b64_tr_b16 a[176:177], v5 offset:24576
  v_mfma_f32_16x16x32_bf16 v[140:143], a[180:183], a[200:203], v[140:143]
  s_waitcnt lgkmcnt(5)
  s_cmp_eq_u32 s90, 2
  s_cselect_b32 s75, 4, 11
  s_lshl_b32 s67, s75, 17
  s_lshl_b32 s75, s75, 11
  s_add_u32 s75, s75, s83
  s_add_u32 m0, s45, 32768
  v_mfma_f32_16x16x32_bf16 v[156:159], a[160:163], a[200:203], v[156:159]
  ds_read_b64_tr_b16 a[178:179], v5 offset:26624
  v_mfma_f32_16x16x32_bf16 v[156:159], a[164:167], a[216:219], v[156:159]
  buffer_load_dwordx4 v32, s[36:39], s67 offen lds
  v_mfma_f32_16x16x32_bf16 v[152:155], a[164:167], a[212:215], v[152:155]
  ds_read_b64_tr_b16 a[180:181], v5 offset:28672
  v_mfma_f32_16x16x32_bf16 v[152:155], a[160:163], a[196:199], v[152:155]
  s_add_u32 m0, s45, 36864
  s_add_u32 s60, s67, 65536
  v_mfma_f32_16x16x32_bf16 v[148:151], a[160:163], a[192:195], v[148:151]
  ds_read_b64_tr_b16 a[182:183], v5 offset:30720
  v_mfma_f32_16x16x32_bf16 v[148:151], a[164:167], a[208:211], v[148:151]
  buffer_load_dwordx4 v32, s[36:39], s60 offen lds
  s_waitcnt vmcnt(45)
  s_barrier
  v_mfma_f32_16x16x32_bf16 v[144:147], a[164:167], a[204:207], v[144:147]
  ds_read_b64_tr_b16 a[164:165], v6 offset:32768
  v_mfma_f32_16x16x32_bf16 v[144:147], a[160:163], a[188:191], v[144:147]
  s_waitcnt lgkmcnt(5)
  s_cmp_eq_u32 s90, 3
  s_cselect_b32 s76, 6, 13
  s_lshl_b32 s68, s76, 17
  s_lshl_b32 s76, s76, 11
  s_add_u32 s76, s76, s83
  s_add_u32 m0, s45, 49152
  v_mfma_f32_16x16x32_bf16 v[160:163], a[168:171], a[188:191], v[160:163]
  ds_read_b64_tr_b16 a[166:167], v6 offset:34816
  v_mfma_f32_16x16x32_bf16 v[160:163], a[172:175], a[204:207], v[160:163]
  buffer_load_dwordx4 v32, s[36:39], s68 offen lds
  v_mfma_f32_16x16x32_bf16 v[164:167], a[172:175], a[208:211], v[164:167]
  ds_read_b64_tr_b16 a[160:161], v6 offset:36864
  v_mfma_f32_16x16x32_bf16 v[164:167], a[168:171], a[192:195], v[164:167]
  v_mfma_f32_16x16x32_bf16 v[168:171], a[168:171], a[196:199], v[168:171]
  ds_read_b64_tr_b16 a[162:163], v6 offset:38912
  v_mfma_f32_16x16x32_bf16 v[168:171], a[172:175], a[212:215], v[168:171]
  s_add_u32 m0, s45, 53248
  s_add_u32 s60, s68, 65536
  v_mfma_f32_16x16x32_bf16 v[172:175], a[172:175], a[216:219], v[172:175]
  ds_read_b64_tr_b16 a[172:173], v7 offset:32768
  v_mfma_f32_16x16x32_bf16 v[172:175], a[168:171], a[200:203], v[172:175]
  s_waitcnt lgkmcnt(5)
  buffer_load_dwordx4 v32, s[36:39], s60 offen lds
  v_mfma_f32_16x16x32_bf16 v[188:191], a[176:179], a[200:203], v[188:191]
  ds_read_b64_tr_b16 a[174:175], v7 offset:34816
  v_mfma_f32_16x16x32_bf16 v[188:191], a[180:183], a[216:219], v[188:191]
  v_mfma_f32_16x16x32_bf16 v[184:187], a[180:183], a[212:215], v[184:187]
  ds_read_b64_tr_b16 a[168:169], v7 offset:36864
  v_mfma_f32_16x16x32_bf16 v[184:187], a[176:179], a[196:199], v[184:187]
  buffer_load_dwordx4 a[32:35], v1, s[8:11], s72 offen offset:0 sc1
  v_mfma_f32_16x16x32_bf16 v[180:183], a[176:179], a[192:195], v[180:183]
  ds_read_b64_tr_b16 a[170:171], v7 offset:38912
  v_mfma_f32_16x16x32_bf16 v[180:183], a[180:183], a[208:211], v[180:183]
  v_mfma_f32_16x16x32_bf16 v[176:179], a[180:183], a[204:207], v[176:179]
  ds_read_b64_tr_b16 a[180:181], v8 offset:32768
  v_mfma_f32_16x16x32_bf16 v[176:179], a[176:179], a[188:191], v[176:179]
  s_waitcnt vmcnt(13) lgkmcnt(5)
  buffer_load_dwordx4 a[48:51], v1, s[8:11], s72 offen offset:1024 sc1
  v_mfma_f32_16x16x32_bf16 v[64:67], a[164:167], a[220:223], v[64:67]
  ds_read_b64_tr_b16 a[182:183], v8 offset:34816
  v_mfma_f32_16x16x32_bf16 v[64:67], a[160:163], a[236:239], v[64:67]
  s_add_u32 s72, s72, 131072
  v_mfma_f32_16x16x32_bf16 v[68:71], a[160:163], a[240:243], v[68:71]
  ds_read_b64_tr_b16 a[176:177], v8 offset:36864
  v_mfma_f32_16x16x32_bf16 v[68:71], a[164:167], a[224:227], v[68:71]
  buffer_load_dwordx4 a[36:39], v1, s[8:11], s72 offen offset:0 sc1
  v_mfma_f32_16x16x32_bf16 v[72:75], a[164:167], a[228:231], v[72:75]
  ds_read_b64_tr_b16 a[178:179], v8 offset:38912
  v_mfma_f32_16x16x32_bf16 v[72:75], a[160:163], a[244:247], v[72:75]
  v_mfma_f32_16x16x32_bf16 v[76:79], a[160:163], a[248:251], v[76:79]
  ds_read_b64_tr_b16 a[160:161], v9 offset:32768
  v_mfma_f32_16x16x32_bf16 v[76:79], a[164:167], a[232:235], v[76:79]
  s_waitcnt lgkmcnt(5)
  v_mfma_f32_16x16x32_bf16 v[92:95], a[172:175], a[232:235], v[92:95]
  ds_read_b64_tr_b16 a[162:163], v9 offset:34816
  v_mfma_f32_16x16x32_bf16 v[92:95], a[168:171], a[248:251], v[92:95]
  buffer_load_dwordx4 a[52:55], v1, s[8:11], s72 offen offset:1024 sc1
  v_mfma_f32_16x16x32_bf16 v[88:91], a[168:171], a[244:247], v[88:91]
  ds_read_b64_tr_b16 a[164:165], v9 offset:36864
  v_mfma_f32_16x16x32_bf16 v[88:91], a[172:175], a[228:231], v[88:91]
  s_add_u32 s72, s72, s88
  v_mfma_f32_16x16x32_bf16 v[84:87], a[172:175], a[224:227], v[84:87]
  ds_read_b64_tr_b16 a[166:167], v9 offset:38912
  v_mfma_f32_16x16x32_bf16 v[84:87], a[168:171], a[240:243], v[84:87]
  buffer_load_dwordx4 a[40:43], v1, s[8:11], s72 offen offset:0 sc1
  v_mfma_f32_16x16x32_bf16 v[80:83], a[168:171], a[236:239], v[80:83]
  ds_read_b64_tr_b16 a[168:169], v6 offset:49152
  v_mfma_f32_16x16x32_bf16 v[80:83], a[172:175], a[220:223], v[80:83]
  s_waitcnt lgkmcnt(5)
  v_mfma_f32_16x16x32_bf16 v[96:99], a[180:183], a[220:223], v[96:99]
  ds_read_b64_tr_b16 a[170:171], v6 offset:51200
  v_mfma_f32_16x16x32_bf16 v[96:99], a[176:179], a[236:239], v[96:99]
  buffer_load_dwordx4 a[56:59], v1, s[8:11], s72 offen offset:1024 sc1
  v_mfma_f32_16x16x32_bf16 v[100:103], a[176:179], a[240:243], v[100:103]
  ds_read_b64_tr_b16 a[172:173], v6 offset:53248
  v_mfma_f32_16x16x32_bf16 v[100:103], a[180:183], a[224:227], v[100:103]
  s_add_u32 s72, s72, 131072
  v_mfma_f32_16x16x32_bf16 v[104:107], a[180:183], a[228:231], v[104:107]
  ds_read_b64_tr_b16 a[174:175], v6 offset:55296
  v_mfma_f32_16x16x32_bf16 v[104:107], a[176:179], a[244:247], v[104:107]
  buffer_load_dwordx4 a[44:47], v1, s[8:11], s72 offen offset:0 sc1
  v_mfma_f32_16x16x32_bf16 v[108:111], a[176:179], a[248:251], v[108:111]
  ds_read_b64_tr_b16 a[176:177], v7 offset:49152
  v_mfma_f32_16x16x32_bf16 v[108:111], a[180:183], a[232:235], v[108:111]
  s_waitcnt lgkmcnt(5)
  v_mfma_f32_16x16x32_bf16 v[124:127], a[160:163], a[232:235], v[124:127]
  ds_read_b64_tr_b16 a[178:179], v7 offset:51200
  v_mfma_f32_16x16x32_bf16 v[124:127], a[164:167], a[248:251], v[124:127]
  v_mfma_f32_16x16x32_bf16 v[120:123], a[164:167], a[244:247], v[120:123]
  ds_read_b64_tr_b16 a[180:181], v7 offset:53248
  v_mfma_f32_16x16x32_bf16 v[120:123], a[160:163], a[228:231], v[120:123]
  buffer_load_dwordx4 a[60:63], v1, s[8:11], s72 offen offset:1024 sc1
  v_mfma_f32_16x16x32_bf16 v[116:119], a[160:163], a[224:227], v[116:119]
  ds_read_b64_tr_b16 a[182:183], v7 offset:55296
  v_mfma_f32_16x16x32_bf16 v[116:119], a[164:167], a[240:243], v[116:119]
  v_mfma_f32_16x16x32_bf16 v[112:115], a[164:167], a[236:239], v[112:115]
  ds_read_b64_tr_b16 a[164:165], v8 offset:49152
  v_mfma_f32_16x16x32_bf16 v[112:115], a[160:163], a[220:223], v[112:115]
  s_waitcnt vmcnt(12) lgkmcnt(5)
  buffer_load_dwordx4 a[64:67], v1, s[8:11], s73 offen offset:0 sc1
  v_mfma_f32_16x16x32_bf16 v[64:67], a[168:171], a[0:3], v[64:67]
  ds_read_b64_tr_b16 a[166:167], v8 offset:51200
  v_mfma_f32_16x16x32_bf16 v[64:67], a[172:175], a[16:19], v[64:67]
  v_mfma_f32_16x16x32_bf16 v[68:71], a[172:175], a[20:23], v[68:71]
  ds_read_b64_tr_b16 a[160:161], v8 offset:53248
  v_mfma_f32_16x16x32_bf16 v[68:71], a[168:171], a[4:7], v[68:71]
  buffer_load_dwordx4 a[80:83], v1, s[8:11], s73 offen offset:1024 sc1
  v_mfma_f32_16x16x32_bf16 v[72:75], a[168:171], a[8:11], v[72:75]
  ds_read_b64_tr_b16 a[162:163], v8 offset:55296
  v_mfma_f32_16x16x32_bf16 v[72:75], a[172:175], a[24:27], v[72:75]
  s_add_u32 s73, s73, 131072
  v_mfma_f32_16x16x32_bf16 v[76:79], a[172:175], a[28:31], v[76:79]
  ds_read_b64_tr_b16 a[172:173], v9 offset:49152
  v_mfma_f32_16x16x32_bf16 v[76:79], a[168:171], a[12:15], v[76:79]
  s_waitcnt lgkmcnt(5)
  buffer_load_dwordx4 a[68:71], v1, s[8:11], s73 offen offset:0 sc1
  v_mfma_f32_16x16x32_bf16 v[92:95], a[176:179], a[12:15], v[92:95]
  ds_read_b64_tr_b16 a[174:175], v9 offset:51200
  v_mfma_f32_16x16x32_bf16 v[92:95], a[180:183], a[28:31], v[92:95]
  v_mfma_f32_16x16x32_bf16 v[88:91], a[180:183], a[24:27], v[88:91]
  ds_read_b64_tr_b16 a[168:169], v9 offset:53248
  v_mfma_f32_16x16x32_bf16 v[88:91], a[176:179], a[8:11], v[88:91]
  v_mfma_f32_16x16x32_bf16 v[84:87], a[176:179], a[4:7], v[84:87]
  ds_read_b64_tr_b16 a[170:171], v9 offset:55296
  buffer_load_dwordx4 a[84:87], v1, s[8:11], s73 offen offset:1024 sc1
  v_mfma_f32_16x16x32_bf16 v[84:87], a[180:183], a[20:23], v[84:87]
  s_waitcnt vmcnt(12)
  s_barrier
  v_mfma_f32_16x16x32_bf16 v[80:83], a[180:183], a[16:19], v[80:83]
  ds_read_b64_tr_b16 a[180:181], v6 offset:16384
  v_mfma_f32_16x16x32_bf16 v[80:83], a[176:179], a[0:3], v[80:83]
  s_waitcnt lgkmcnt(5)
  s_add_u32 s73, s73, s88
  v_mfma_f32_16x16x32_bf16 v[96:99], a[164:167], a[0:3], v[96:99]
  ds_read_b64_tr_b16 a[182:183], v6 offset:18432
  v_mfma_f32_16x16x32_bf16 v[96:99], a[160:163], a[16:19], v[96:99]
  buffer_load_dwordx4 a[72:75], v1, s[8:11], s73 offen offset:0 sc1
  v_mfma_f32_16x16x32_bf16 v[100:103], a[160:163], a[20:23], v[100:103]
  ds_read_b64_tr_b16 a[176:177], v6 offset:20480
  v_mfma_f32_16x16x32_bf16 v[100:103], a[164:167], a[4:7], v[100:103]
  v_mfma_f32_16x16x32_bf16 v[104:107], a[164:167], a[8:11], v[104:107]
  ds_read_b64_tr_b16 a[178:179], v6 offset:22528
  v_mfma_f32_16x16x32_bf16 v[104:107], a[160:163], a[24:27], v[104:107]
  buffer_load_dwordx4 a[88:91], v1, s[8:11], s73 offen offset:1024 sc1
  v_mfma_f32_16x16x32_bf16 v[108:111], a[160:163], a[28:31], v[108:111]
  ds_read_b64_tr_b16 a[160:161], v7 offset:16384
  v_mfma_f32_16x16x32_bf16 v[108:111], a[164:167], a[12:15], v[108:111]
  s_waitcnt lgkmcnt(5)
  s_add_u32 s73, s73, 131072
  v_mfma_f32_16x16x32_bf16 v[124:127], a[172:175], a[12:15], v[124:127]
  ds_read_b64_tr_b16 a[162:163], v7 offset:18432
  v_mfma_f32_16x16x32_bf16 v[124:127], a[168:171], a[28:31], v[124:127]
  buffer_load_dwordx4 a[76:79], v1, s[8:11], s73 offen offset:0 sc1
  v_mfma_f32_16x16x32_bf16 v[120:123], a[168:171], a[24:27], v[120:123]
  ds_read_b64_tr_b16 a[164:165], v7 offset:20480
  v_mfma_f32_16x16x32_bf16 v[120:123], a[172:175], a[8:11], v[120:123]
  v_mfma_f32_16x16x32_bf16 v[116:119], a[172:175], a[4:7], v[116:119]
  ds_read_b64_tr_b16 a[166:167], v7 offset:22528
  v_mfma_f32_16x16x32_bf16 v[116:119], a[168:171], a[20:23], v[116:119]
  v_mfma_f32_16x16x32_bf16 v[112:115], a[168:171], a[16:19], v[112:115]
  ds_read_b64_tr_b16 a[168:169], v8 offset:16384
  v_mfma_f32_16x16x32_bf16 v[112:115], a[172:175], a[0:3], v[112:115]
  s_waitcnt vmcnt(7) lgkmcnt(5)
HOP18:
  s_cbranch_execz WRET1
  buffer_load_dwordx4 a[92:95], v1, s[8:11], s73 offen offset:1024 sc1
  v_mfma_f32_16x16x32_bf16 v[64:67], a[180:183], a[32:35], v[64:67]
  ds_read_b64_tr_b16 a[170:171], v8 offset:18432
  v_mfma_f32_16x16x32_bf16 v[64:67], a[176:179], a[48:51], v[64:67]
  v_mfma_f32_16x16x32_bf16 v[68:71], a[176:179], a[52:55], v[68:71]
  ds_read_b64_tr_b16 a[172:173], v8 offset:20480
  v_mfma_f32_16x16x32_bf16 v[68:71], a[180:183], a[36:39], v[68:71]
  buffer_load_dwordx4 a[96:99], v1, s[8:11], s74 offen offset:0 sc1
  v_mfma_f32_16x16x32_bf16 v[72:75], a[180:183], a[40:43], v[72:75]
  ds_read_b64_tr_b16 a[174:175], v8 offset:22528
  v_mfma_f32_16x16x32_bf16 v[72:75], a[176:179], a[56:59], v[72:75]
  v_mfma_f32_16x16x32_bf16 v[76:79], a[176:179], a[60:63], v[76:79]
  ds_read_b64_tr_b16 a[176:177], v9 offset:16384
  v_mfma_f32_16x16x32_bf16 v[76:79], a[180:183], a[44:47], v[76:79]
  s_waitcnt lgkmcnt(5)
  buffer_load_dwordx4 a[112:115], v1, s[8:11], s74 offen offset:1024 sc1
  v_mfma_f32_16x16x32_bf16 v[92:95], a[160:163], a[44:47], v[92:95]
  ds_read_b64_tr_b16 a[178:179], v9 offset:18432
  v_mfma_f32_16x16x32_bf16 v[92:95], a[164:167], a[60:63], v[92:95]
  s_add_u32 s74, s74, 131072
  v_mfma_f32_16x16x32_bf16 v[88:91], a[164:167], a[56:59], v[88:91]
  ds_read_b64_tr_b16 a[180:181], v9 offset:20480
  v_mfma_f32_16x16x32_bf16 v[88:91], a[160:163], a[40:43], v[88:91]
  buffer_load_dwordx4 a[100:103], v1, s[8:11], s74 offen offset:0 sc1
  v_mfma_f32_16x16x32_bf16 v[84:87], a[160:163], a[36:39], v[84:87]
  ds_read_b64_tr_b16 a[182:183], v9 offset:22528
  v_mfma_f32_16x16x32_bf16 v[84:87], a[164:167], a[52:55], v[84:87]
  v_mfma_f32_16x16x32_bf16 v[80:83], a[164:167], a[48:51], v[80:83]
  ds_read_b64_tr_b16 a[164:165], v6 offset:0
  v_mfma_f32_16x16x32_bf16 v[80:83], a[160:163], a[32:35], v[80:83]
  s_waitcnt lgkmcnt(5)
  v_mfma_f32_16x16x32_bf16 v[96:99], a[168:171], a[32:35], v[96:99]
  ds_read_b64_tr_b16 a[166:167], v6 offset:2048
  v_mfma_f32_16x16x32_bf16 v[96:99], a[172:175], a[48:51], v[96:99]
  buffer_load_dwordx4 a[116:119], v1, s[8:11], s74 offen offset:1024 sc1
  v_mfma_f32_16x16x32_bf16 v[100:103], a[172:175], a[52:55], v[100:103]
  ds_read_b64_tr_b16 a[160:161], v6 offset:4096
  v_mfma_f32_16x16x32_bf16 v[100:103], a[168:171], a[36:39], v[100:103]
  s_add_u32 s74, s74, s88
  v_mfma_f32_16x16x32_bf16 v[104:107], a[168:171], a[40:43], v[104:107]
  ds_read_b64_tr_b16 a[162:163], v6 offset:6144
  v_mfma_f32_16x16x32_bf16 v[104:107], a[172:175], a[56:59], v[104:107]
  buffer_load_dwordx4 a[104:107], v1, s[8:11], s74 offen offset:0 sc1
  v_mfma_f32_16x16x32_bf16 v[108:111], a[172:175], a[60:63], v[108:111]
  ds_read_b64_tr_b16 a[172:173], v7 offset:0
  v_mfma_f32_16x16x32_bf16 v[108:111], a[168:171], a[44:47], v[108:111]
  s_waitcnt lgkmcnt(5)
  v_mfma_f32_16x16x32_bf16 v[124:127], a[176:179], a[44:47], v[124:127]
  ds_read_b64_tr_b16 a[174:175], v7 offset:2048
  v_mfma_f32_16x16x32_bf16 v[124:127], a[180:183], a[60:63], v[124:127]
  buffer_load_dwordx4 a[120:123], v1, s[8:11], s74 offen offset:1024 sc1
  v_mfma_f32_16x16x32_bf16 v[120:123], a[180:183], a[56:59], v[120:123]
  ds_read_b64_tr_b16 a[168:169], v7 offset:4096
  v_mfma_f32_16x16x32_bf16 v[120:123], a[176:179], a[40:43], v[120:123]
  s_add_u32 s74, s74, 131072
  v_mfma_f32_16x16x32_bf16 v[116:119], a[176:179], a[36:39], v[116:119]
  ds_read_b64_tr_b16 a[170:171], v7 offset:6144
  v_mfma_f32_16x16x32_bf16 v[116:119], a[180:183], a[52:55], v[116:119]
  buffer_load_dwordx4 a[108:111], v1, s[8:11], s74 offen offset:0 sc1
  v_mfma_f32_16x16x32_bf16 v[112:115], a[180:183], a[48:51], v[112:115]
  ds_read_b64_tr_b16 a[180:181], v8 offset:0
  v_mfma_f32_16x16x32_bf16 v[112:115], a[176:179], a[32:35], v[112:115]
  s_waitcnt vmcnt(7) lgkmcnt(5)
  v_mfma_f32_16x16x32_bf16 v[64:67], a[164:167], a[64:67], v[64:67]
  ds_read_b64_tr_b16 a[182:183], v8 offset:2048
  v_mfma_f32_16x16x32_bf16 v[64:67], a[160:163], a[80:83], v[64:67]
  v_mfma_f32_16x16x32_bf16 v[68:71], a[160:163], a[84:87], v[68:71]
  ds_read_b64_tr_b16 a[176:177], v8 offset:4096
  v_mfma_f32_16x16x32_bf16 v[68:71], a[164:167], a[68:71], v[68:71]
  buffer_load_dwordx4 a[124:127], v1, s[8:11], s74 offen offset:1024 sc1
  v_mfma_f32_16x16x32_bf16 v[72:75], a[164:167], a[72:75], v[72:75]
  ds_read_b64_tr_b16 a[178:179], v8 offset:6144
  v_mfma_f32_16x16x32_bf16 v[72:75], a[160:163], a[88:91], v[72:75]
  v_mfma_f32_16x16x32_bf16 v[76:79], a[160:163], a[92:95], v[76:79]
  ds_read_b64_tr_b16 a[160:161], v9 offset:0
  v_mfma_f32_16x16x32_bf16 v[76:79], a[164:167], a[76:79], v[76:79]
  s_waitcnt lgkmcnt(5)
  buffer_load_dwordx4 a[128:131], v1, s[8:11], s75 offen offset:0 sc1
  v_mfma_f32_16x16x32_bf16 v[92:95], a[172:175], a[76:79], v[92:95]
  ds_read_b64_tr_b16 a[162:163], v9 offset:2048
  v_mfma_f32_16x16x32_bf16 v[92:95], a[168:171], a[92:95], v[92:95]
  v_mfma_f32_16x16x32_bf16 v[88:91], a[168:171], a[88:91], v[88:91]
  ds_read_b64_tr_b16 a[164:165], v9 offset:4096
  v_mfma_f32_16x16x32_bf16 v[88:91], a[172:175], a[72:75], v[88:91]
  buffer_load_dwordx4 a[144:147], v1, s[8:11], s75 offen offset:1024 sc1
  v_mfma_f32_16x16x32_bf16 v[84:87], a[172:175], a[68:71], v[84:87]
  ds_read_b64_tr_b16 a[166:167], v9 offset:6144
  v_mfma_f32_16x16x32_bf16 v[84:87], a[168:171], a[84:87], v[84:87]
  s_add_u32 s75, s75, 131072
  v_mfma_f32_16x16x32_bf16 v[80:83], a[168:171], a[80:83], v[80:83]
  ds_read_b64_tr_b16 a[168:169], v2 offset:0
  v_mfma_f32_16x16x32_bf16 v[80:83], a[172:175], a[64:67], v[80:83]
  s_waitcnt lgkmcnt(5)
  buffer_load_dwordx4 a[132:135], v1, s[8:11], s75 offen offset:0 sc1
  v_mfma_f32_16x16x32_bf16 v[96:99], a[180:183], a[64:67], v[96:99]
  ds_read_b64_tr_b16 a[170:171], v2 offset:2048
  v_mfma_f32_16x16x32_bf16 v[96:99], a[176:179], a[80:83], v[96:99]
  v_mfma_f32_16x16x32_bf16 v[100:103], a[176:179], a[84:87], v[100:103]
  ds_read_b64_tr_b16 a[172:173], v2 offset:4096
  v_mfma_f32_16x16x32_bf16 v[100:103], a[180:183], a[68:71], v[100:103]
  v_mfma_f32_16x16x32_bf16 v[104:107], a[180:183], a[72:75], v[104:107]
  ds_read_b64_tr_b16 a[174:175], v2 offset:6144
  v_mfma_f32_16x16x32_bf16 v[104:107], a[176:179], a[88:91], v[104:107]
  buffer_load_dwordx4 a[148:151], v1, s[8:11], s75 offen offset:1024 sc1
  v_mfma_f32_16x16x32_bf16 v[108:111], a[176:179], a[92:95], v[108:111]
  ds_read_b64_tr_b16 a[176:177], v3 offset:0
  v_mfma_f32_16x16x32_bf16 v[108:111], a[180:183], a[76:79], v[108:111]
  s_waitcnt lgkmcnt(5)
  s_add_u32 s75, s75, s88
  v_mfma_f32_16x16x32_bf16 v[124:127], a[160:163], a[76:79], v[124:127]
  ds_read_b64_tr_b16 a[178:179], v3 offset:2048
  v_mfma_f32_16x16x32_bf16 v[124:127], a[164:167], a[92:95], v[124:127]
  buffer_load_dwordx4 a[136:139], v1, s[8:11], s75 offen offset:0 sc1
  v_mfma_f32_16x16x32_bf16 v[120:123], a[164:167], a[88:91], v[120:123]
  ds_read_b64_tr_b16 a[180:181], v3 offset:4096
  v_mfma_f32_16x16x32_bf16 v[120:123], a[160:163], a[72:75], v[120:123]
  v_mfma_f32_16x16x32_bf16 v[116:119], a[160:163], a[68:71], v[116:119]
  ds_read_b64_tr_b16 a[182:183], v3 offset:6144
  v_mfma_f32_16x16x32_bf16 v[116:119], a[164:167], a[84:87], v[116:119]
  buffer_load_dwordx4 a[152:155], v1, s[8:11], s75 offen offset:1024 sc1
  v_mfma_f32_16x16x32_bf16 v[112:115], a[164:167], a[80:83], v[112:115]
  ds_read_b64_tr_b16 a[164:165], v4 offset:0
  v_mfma_f32_16x16x32_bf16 v[112:115], a[160:163], a[64:67], v[112:115]
  s_waitcnt vmcnt(6) lgkmcnt(5)
  s_add_u32 s75, s75, 131072
  v_mfma_f32_16x16x32_bf16 v[64:67], a[168:171], a[96:99], v[64:67]
  ds_read_b64_tr_b16 a[166:167], v4 offset:2048
  v_mfma_f32_16x16x32_bf16 v[64:67], a[172:175], a[112:115], v[64:67]
  buffer_load_dwordx4 a[140:143], v1, s[8:11], s75 offen offset:0 sc1
  v_mfma_f32_16x16x32_bf16 v[68:71], a[172:175], a[116:119], v[68:71]
  ds_read_b64_tr_b16 a[160:161], v4 offset:4096
  v_mfma_f32_16x16x32_bf16 v[68:71], a[168:171], a[100:103], v[68:71]
  v_mfma_f32_16x16x32_bf16 v[72:75], a[168:171], a[104:107], v[72:75]
  ds_read_b64_tr_b16 a[162:163], v4 offset:6144
  v_mfma_f32_16x16x32_bf16 v[72:75], a[172:175], a[120:123], v[72:75]
  v_mfma_f32_16x16x32_bf16 v[76:79], a[172:175], a[124:127], v[76:79]
  ds_read_b64_tr_b16 a[172:173], v5 offset:0
  v_mfma_f32_16x16x32_bf16 v[76:79], a[168:171], a[108:111], v[76:79]
  s_waitcnt lgkmcnt(5)
  buffer_load_dwordx4 a[156:159], v1, s[8:11], s75 offen offset:1024 sc1
  v_mfma_f32_16x16x32_bf16 v[92:95], a[176:179], a[108:111], v[92:95]
  ds_read_b64_tr_b16 a[174:175], v5 offset:2048
  v_mfma_f32_16x16x32_bf16 v[92:95], a[180:183], a[124:127], v[92:95]
  v_mfma_f32_16x16x32_bf16 v[88:91], a[180:183], a[120:123], v[88:91]
  ds_read_b64_tr_b16 a[168:169], v5 offset:4096
  v_mfma_f32_16x16x32_bf16 v[88:91], a[176:179], a[104:107], v[88:91]
  buffer_load_dwordx4 a[188:191], v1, s[8:11], s76 offen offset:0 sc1
  v_mfma_f32_16x16x32_bf16 v[84:87], a[176:179], a[100:103], v[84:87]
  ds_read_b64_tr_b16 a[170:171], v5 offset:6144
  v_mfma_f32_16x16x32_bf16 v[84:87], a[180:183], a[116:119], v[84:87]
  v_mfma_f32_16x16x32_bf16 v[80:83], a[180:183], a[112:115], v[80:83]
  ds_read_b64_tr_b16 a[180:181], v2 offset:32768
  v_mfma_f32_16x16x32_bf16 v[80:83], a[176:179], a[96:99], v[80:83]
  s_waitcnt lgkmcnt(5)
  buffer_load_dwordx4 a[204:207], v1, s[8:11], s76 offen offset:1024 sc1
  v_mfma_f32_16x16x32_bf16 v[96:99], a[164:167], a[96:99], v[96:99]
  ds_read_b64_tr_b16 a[182:183], v2 offset:34816
  v_mfma_f32_16x16x32_bf16 v[96:99], a[160:163], a[112:115], v[96:99]
  s_add_u32 s76, s76, 131072
  v_mfma_f32_16x16x32_bf16 v[100:103], a[160:163], a[116:119], v[100:103]
  ds_read_b64_tr_b16 a[176:177], v2 offset:36864
  v_mfma_f32_16x16x32_bf16 v[100:103], a[164:167], a[100:103], v[100:103]
  buffer_load_dwordx4 a[192:195], v1, s[8:11], s76 offen offset:0 sc1
  v_mfma_f32_16x16x32_bf16 v[104:107], a[164:167], a[104:107], v[104:107]
  ds_read_b64_tr_b16 a[178:179], v2 offset:38912
  v_mfma_f32_16x16x32_bf16 v[104:107], a[160:163], a[120:123], v[104:107]
  v_mfma_f32_16x16x32_bf16 v[108:111], a[160:163], a[124:127], v[108:111]
  ds_read_b64_tr_b16 a[160:161], v3 offset:32768
  v_mfma_f32_16x16x32_bf16 v[108:111], a[164:167], a[108:111], v[108:111]
  s_waitcnt lgkmcnt(5)
  v_mfma_f32_16x16x32_bf16 v[124:127], a[172:175], a[108:111], v[124:127]
  ds_read_b64_tr_b16 a[162:163], v3 offset:34816
  v_mfma_f32_16x16x32_bf16 v[124:127], a[168:171], a[124:127], v[124:127]
  buffer_load_dwordx4 a[208:211], v1, s[8:11], s76 offen offset:1024 sc1
  v_mfma_f32_16x16x32_bf16 v[120:123], a[168:171], a[120:123], v[120:123]
  ds_read_b64_tr_b16 a[164:165], v3 offset:36864
  v_mfma_f32_16x16x32_bf16 v[120:123], a[172:175], a[104:107], v[120:123]
  s_add_u32 s76, s76, s88
  v_mfma_f32_16x16x32_bf16 v[116:119], a[172:175], a[100:103], v[116:119]
  ds_read_b64_tr_b16 a[166:167], v3 offset:38912
  v_mfma_f32_16x16x32_bf16 v[116:119], a[168:171], a[116:119], v[116:119]
  buffer_load_dwordx4 a[196:199], v1, s[8:11], s76 offen offset:0 sc1
  v_mfma_f32_16x16x32_bf16 v[112:115], a[168:171], a[112:115], v[112:115]
  ds_read_b64_tr_b16 a[168:169], v4 offset:32768
  v_mfma_f32_16x16x32_bf16 v[112:115], a[172:175], a[96:99], v[112:115]
  s_waitcnt vmcnt(5) lgkmcnt(5)
  v_mfma_f32_16x16x32_bf16 v[64:67], a[180:183], a[128:131], v[64:67]
  ds_read_b64_tr_b16 a[170:171], v4 offset:34816
  v_mfma_f32_16x16x32_bf16 v[64:67], a[176:179], a[144:147], v[64:67]
  buffer_load_dwordx4 a[212:215], v1, s[8:11], s76 offen offset:1024 sc1
  v_mfma_f32_16x16x32_bf16 v[68:71], a[176:179], a[148:151], v[68:71]
  ds_read_b64_tr_b16 a[172:173], v4 offset:36864
  v_mfma_f32_16x16x32_bf16 v[68:71], a[180:183], a[132:135], v[68:71]
  s_add_u32 s76, s76, 131072
  v_mfma_f32_16x16x32_bf16 v[72:75], a[180:183], a[136:139], v[72:75]
  ds_read_b64_tr_b16 a[174:175], v4 offset:38912
  v_mfma_f32_16x16x32_bf16 v[72:75], a[176:179], a[152:155], v[72:75]
  buffer_load_dwordx4 a[200:203], v1, s[8:11], s76 offen offset:0 sc1
  v_mfma_f32_16x16x32_bf16 v[76:79], a[176:179], a[156:159], v[76:79]
  ds_read_b64_tr_b16 a[176:177], v5 offset:32768
  v_mfma_f32_16x16x32_bf16 v[76:79], a[180:183], a[140:143], v[76:79]
  s_waitcnt lgkmcnt(5)
  v_mfma_f32_16x16x32_bf16 v[92:95], a[160:163], a[140:143], v[92:95]
  ds_read_b64_tr_b16 a[178:179], v5 offset:34816
  v_mfma_f32_16x16x32_bf16 v[92:95], a[164:167], a[156:159], v[92:95]
  v_mfma_f32_16x16x32_bf16 v[88:91], a[164:167], a[152:155], v[88:91]
  ds_read_b64_tr_b16 a[180:181], v5 offset:36864
  v_mfma_f32_16x16x32_bf16 v[88:91], a[160:163], a[136:139], v[88:91]
  buffer_load_dwordx4 a[216:219], v1, s[8:11], s76 offen offset:1024 sc1
  v_mfma_f32_16x16x32_bf16 v[84:87], a[160:163], a[132:135], v[84:87]
  ds_read_b64_tr_b16 a[182:183], v5 offset:38912
  v_mfma_f32_16x16x32_bf16 v[84:87], a[164:167], a[148:151], v[84:87]
  s_add_u32 m0, s45, 8192
  v_mfma_f32_16x16x32_bf16 v[80:83], a[164:167], a[144:147], v[80:83]
  ds_read_b64_tr_b16 a[164:165], v2 offset:49152
  v_mfma_f32_16x16x32_bf16 v[80:83], a[160:163], a[128:131], v[80:83]
  s_waitcnt lgkmcnt(5)
  buffer_load_dwordx4 v33, s[36:39], s66 offen lds
  v_mfma_f32_16x16x32_bf16 v[96:99], a[168:171], a[128:131], v[96:99]
  ds_read_b64_tr_b16 a[166:167], v2 offset:51200
  v_mfma_f32_16x16x32_bf16 v[96:99], a[172:175], a[144:147], v[96:99]
  s_add_u32 m0, s45, 12288
  s_add_u32 s60, s66, 65536
  v_mfma_f32_16x16x32_bf16 v[100:103], a[172:175], a[148:151], v[100:103]
  ds_read_b64_tr_b16 a[160:161], v2 offset:53248
  v_mfma_f32_16x16x32_bf16 v[100:103], a[168:171], a[132:135], v[100:103]
  buffer_load_dwordx4 v33, s[36:39], s60 offen lds
  v_mfma_f32_16x16x32_bf16 v[104:107], a[168:171], a[136:139], v[104:107]
  ds_read_b64_tr_b16 a[162:163], v2 offset:55296
  v_mfma_f32_16x16x32_bf16 v[104:107], a[172:175], a[152:155], v[104:107]
  s_add_u32 m0, s45, 40960
  v_mfma_f32_16x16x32_bf16 v[108:111], a[172:175], a[156:159], v[108:111]
  ds_read_b64_tr_b16 a[172:173], v3 offset:49152
  v_mfma_f32_16x16x32_bf16 v[108:111], a[168:171], a[140:143], v[108:111]
  s_waitcnt lgkmcnt(5)
  buffer_load_dwordx4 v33, s[36:39], s67 offen lds
  v_mfma_f32_16x16x32_bf16 v[124:127], a[176:179], a[140:143], v[124:127]
  ds_read_b64_tr_b16 a[174:175], v3 offset:51200
  v_mfma_f32_16x16x32_bf16 v[124:127], a[180:183], a[156:159], v[124:127]
  v_mfma_f32_16x16x32_bf16 v[120:123], a[180:183], a[152:155], v[120:123]
  ds_read_b64_tr_b16 a[168:169], v3 offset:53248
  v_mfma_f32_16x16x32_bf16 v[120:123], a[176:179], a[136:139], v[120:123]
  s_add_u32 m0, s45, 45056
  s_add_u32 s60, s67, 65536
  v_mfma_f32_16x16x32_bf16 v[116:119], a[176:179], a[132:135], v[116:119]
  ds_read_b64_tr_b16 a[170:171], v3 offset:55296
  v_mfma_f32_16x16x32_bf16 v[116:119], a[180:183], a[148:151], v[116:119]
  buffer_load_dwordx4 v33, s[36:39], s60 offen lds
  v_mfma_f32_16x16x32_bf16 v[112:115], a[180:183], a[144:147], v[112:115]
  ds_read_b64_tr_b16 a[180:181], v4 offset:49152
  v_mfma_f32_16x16x32_bf16 v[112:115], a[176:179], a[128:131], v[112:115]
  s_waitcnt vmcnt(4) lgkmcnt(5)
  s_add_u32 m0, s45, 57344
  v_mfma_f32_16x16x32_bf16 v[64:67], a[164:167], a[188:191], v[64:67]
  ds_read_b64_tr_b16 a[182:183], v4 offset:51200
  v_mfma_f32_16x16x32_bf16 v[64:67], a[160:163], a[204:207], v[64:67]
  buffer_load_dwordx4 v33, s[36:39], s68 offen lds
  v_mfma_f32_16x16x32_bf16 v[68:71], a[160:163], a[208:211], v[68:71]
  ds_read_b64_tr_b16 a[176:177], v4 offset:53248
  v_mfma_f32_16x16x32_bf16 v[68:71], a[164:167], a[192:195], v[68:71]
  s_add_u32 m0, s45, 61440
  s_add_u32 s60, s68, 65536
  v_mfma_f32_16x16x32_bf16 v[72:75], a[164:167], a[196:199], v[72:75]
  ds_read_b64_tr_b16 a[178:179], v4 offset:55296
  v_mfma_f32_16x16x32_bf16 v[72:75], a[160:163], a[212:215], v[72:75]
  buffer_load_dwordx4 v33, s[36:39], s60 offen lds
  v_mfma_f32_16x16x32_bf16 v[76:79], a[160:163], a[216:219], v[76:79]
  ds_read_b64_tr_b16 a[160:161], v5 offset:49152
  v_mfma_f32_16x16x32_bf16 v[76:79], a[164:167], a[200:203], v[76:79]
  s_waitcnt lgkmcnt(5)
  v_mfma_f32_16x16x32_bf16 v[92:95], a[172:175], a[200:203], v[92:95]
  ds_read_b64_tr_b16 a[162:163], v5 offset:51200
  v_mfma_f32_16x16x32_bf16 v[92:95], a[168:171], a[216:219], v[92:95]
  v_mfma_f32_16x16x32_bf16 v[88:91], a[168:171], a[212:215], v[88:91]
  ds_read_b64_tr_b16 a[164:165], v5 offset:53248
  v_cvt_pk_bf16_f32 v72, v72, v73
  v_mfma_f32_16x16x32_bf16 v[88:91], a[172:175], a[196:199], v[88:91]
  v_cvt_pk_bf16_f32 v73, v74, v75
  v_cvt_pk_bf16_f32 v76, v76, v77
  v_mfma_f32_16x16x32_bf16 v[84:87], a[172:175], a[192:195], v[84:87]
  ds_read_b64_tr_b16 a[166:167], v5 offset:55296
  v_cvt_pk_bf16_f32 v77, v78, v79
  v_mfma_f32_16x16x32_bf16 v[84:87], a[168:171], a[208:211], v[84:87]
  v_cvt_pk_bf16_f32 v64, v64, v65
  v_cvt_pk_bf16_f32 v65, v66, v67
  v_mfma_f32_16x16x32_bf16 v[80:83], a[168:171], a[204:207], v[80:83]
  v_cvt_pk_bf16_f32 v68, v68, v69
  v_cvt_pk_bf16_f32 v69, v70, v71
  v_mfma_f32_16x16x32_bf16 v[80:83], a[172:175], a[188:191], v[80:83]
  s_waitcnt lgkmcnt(4)
  s_waitcnt vmcnt(0)
  s_barrier
  v_mfma_f32_16x16x32_bf16 v[96:99], a[180:183], a[188:191], v[96:99]
  ds_read_b64_tr_b16 v[16:17], v6 offset:40960
  v_mfma_f32_16x16x32_bf16 v[96:99], a[176:179], a[204:207], v[96:99]
  ds_read_b64_tr_b16 v[18:19], v6 offset:43008
  v_mfma_f32_16x16x32_bf16 v[100:103], a[176:179], a[208:211], v[100:103]
  ds_read_b64_tr_b16 v[20:21], v6 offset:45056
  v_cvt_pk_bf16_f32 v74, v88, v89
  v_mfma_f32_16x16x32_bf16 v[100:103], a[180:183], a[192:195], v[100:103]
  ds_read_b64_tr_b16 v[22:23], v6 offset:47104
  v_cvt_pk_bf16_f32 v75, v90, v91
  v_mfma_f32_16x16x32_bf16 v[104:107], a[180:183], a[196:199], v[104:107]
  ds_read_b64_tr_b16 v[24:25], v7 offset:40960
  v_mfma_f32_16x16x32_bf16 v[104:107], a[176:179], a[212:215], v[104:107]
  ds_read_b64_tr_b16 v[26:27], v7 offset:43008
  v_mfma_f32_16x16x32_bf16 v[108:111], a[176:179], a[216:219], v[108:111]
  ds_read_b64_tr_b16 v[28:29], v7 offset:45056
  s_add_u32 s86, s85, 0
  buffer_store_dwordx4 v[72:75], v1, s[8:11], s86 offen offset:0 sc1
  v_mfma_f32_16x16x32_bf16 v[108:111], a[180:183], a[200:203], v[108:111]
  s_waitcnt lgkmcnt(7)
  ds_read_b64_tr_b16 v[30:31], v7 offset:47104
  v_mfma_f32_16x16x32_bf16 v[124:127], a[160:163], a[200:203], v[124:127]
  ds_read_b64_tr_b16 a[168:169], v8 offset:40960
  v_cvt_pk_bf16_f32 v78, v92, v93
  v_mfma_f32_16x16x32_bf16 v[124:127], a[164:167], a[216:219], v[124:127]
  ds_read_b64_tr_b16 a[170:171], v8 offset:43008
  v_cvt_pk_bf16_f32 v79, v94, v95
  v_mfma_f32_16x16x32_bf16 v[120:123], a[164:167], a[212:215], v[120:123]
  ds_read_b64_tr_b16 a[172:173], v8 offset:45056
  v_mfma_f32_16x16x32_bf16 v[120:123], a[160:163], a[196:199], v[120:123]
  ds_read_b64_tr_b16 a[174:175], v8 offset:47104
  v_mfma_f32_16x16x32_bf16 v[116:119], a[160:163], a[192:195], v[116:119]
  ds_read_b64_tr_b16 a[176:177], v9 offset:40960
  s_add_u32 s86, s85, 0
  buffer_store_dwordx4 v[76:79], v1, s[8:11], s86 offen offset:2048 sc1
  v_mfma_f32_16x16x32_bf16 v[116:119], a[164:167], a[208:211], v[116:119]
  ds_read_b64_tr_b16 a[178:179], v9 offset:43008
  v_mfma_f32_16x16x32_bf16 v[112:115], a[164:167], a[204:207], v[112:115]
  ds_read_b64_tr_b16 a[180:181], v9 offset:45056
  v_cvt_pk_bf16_f32 v66, v80, v81
  v_mfma_f32_16x16x32_bf16 v[112:115], a[160:163], a[188:191], v[112:115]
  s_waitcnt lgkmcnt(7)
  ds_read_b64_tr_b16 a[182:183], v9 offset:47104
  v_mfma_f32_16x16x32_bf16 v[136:139], v[16:19], a[228:231], v[136:139]
  ds_read_b64_tr_b16 a[164:165], v6 offset:57344
  v_cvt_pk_bf16_f32 v67, v82, v83
  v_mfma_f32_16x16x32_bf16 v[136:139], v[20:23], a[244:247], v[136:139]
  ds_read_b64_tr_b16 a[166:167], v6 offset:59392
  v_mfma_f32_16x16x32_bf16 v[140:143], v[20:23], a[248:251], v[140:143]
  ds_read_b64_tr_b16 a[160:161], v6 offset:61440
  v_mfma_f32_16x16x32_bf16 v[140:143], v[16:19], a[232:235], v[140:143]
  ds_read_b64_tr_b16 a[162:163], v6 offset:63488
  s_add_u32 s86, s85, 4096
  buffer_store_dwordx4 v[64:67], v1, s[8:11], s86 offen offset:0 sc1
  v_mfma_f32_16x16x32_bf16 v[156:159], v[24:27], a[232:235], v[156:159]
  ds_read_b64_tr_b16 v[20:21], v7 offset:57344
  v_mfma_f32_16x16x32_bf16 v[156:159], v[28:31], a[248:251], v[156:159]
  ds_read_b64_tr_b16 v[22:23], v7 offset:59392
  v_cvt_pk_bf16_f32 v70, v84, v85
  v_mfma_f32_16x16x32_bf16 v[152:155], v[28:31], a[244:247], v[152:155]
  ds_read_b64_tr_b16 v[16:17], v7 offset:61440
  v_cvt_pk_bf16_f32 v71, v86, v87
  v_mfma_f32_16x16x32_bf16 v[152:155], v[24:27], a[228:231], v[152:155]
  s_waitcnt lgkmcnt(7)
  ds_read_b64_tr_b16 v[18:19], v7 offset:63488
  v_mfma_f32_16x16x32_bf16 v[168:171], a[168:171], a[228:231], v[168:171]
  ds_read_b64_tr_b16 v[28:29], v8 offset:57344
  v_mfma_f32_16x16x32_bf16 v[168:171], a[172:175], a[244:247], v[168:171]
  ds_read_b64_tr_b16 v[30:31], v8 offset:59392
  s_add_u32 s86, s85, 4096
  buffer_store_dwordx4 v[68:71], v1, s[8:11], s86 offen offset:2048 sc1
  v_mfma_f32_16x16x32_bf16 v[172:175], a[172:175], a[248:251], v[172:175]
  ds_read_b64_tr_b16 v[24:25], v8 offset:61440
  v_mfma_f32_16x16x32_bf16 v[172:175], a[168:171], a[232:235], v[172:175]
  ds_read_b64_tr_b16 v[26:27], v8 offset:63488
  v_cvt_pk_bf16_f32 v104, v104, v105
  v_mfma_f32_16x16x32_bf16 v[188:191], a[176:179], a[232:235], v[188:191]
  ds_read_b64_tr_b16 a[172:173], v9 offset:57344
  v_cvt_pk_bf16_f32 v105, v106, v107
  v_mfma_f32_16x16x32_bf16 v[188:191], a[180:183], a[248:251], v[188:191]
  ds_read_b64_tr_b16 a[174:175], v9 offset:59392
  v_cvt_pk_bf16_f32 v108, v108, v109
  v_mfma_f32_16x16x32_bf16 v[184:187], a[180:183], a[244:247], v[184:187]
  ds_read_b64_tr_b16 a[168:169], v9 offset:61440
  v_cvt_pk_bf16_f32 v109, v110, v111
  v_mfma_f32_16x16x32_bf16 v[184:187], a[176:179], a[228:231], v[184:187]
  s_waitcnt lgkmcnt(7)
  ds_read_b64_tr_b16 a[170:171], v9 offset:63488
  v_mfma_f32_16x16x32_bf16 v[136:139], a[164:167], a[8:11], v[136:139]
  ds_read_b64_tr_b16 a[180:181], v6 offset:24576
  v_cvt_pk_bf16_f32 v96, v96, v97
  v_mfma_f32_16x16x32_bf16 v[136:139], a[160:163], a[24:27], v[136:139]
  ds_read_b64_tr_b16 a[182:183], v6 offset:26624
  v_cvt_pk_bf16_f32 v97, v98, v99
  v_mfma_f32_16x16x32_bf16 v[140:143], a[160:163], a[28:31], v[140:143]
  ds_read_b64_tr_b16 a[176:177], v6 offset:28672
  v_cvt_pk_bf16_f32 v100, v100, v101
  v_mfma_f32_16x16x32_bf16 v[140:143], a[164:167], a[12:15], v[140:143]
  ds_read_b64_tr_b16 a[178:179], v6 offset:30720
  v_cvt_pk_bf16_f32 v101, v102, v103
  v_mfma_f32_16x16x32_bf16 v[156:159], v[20:23], a[12:15], v[156:159]
  ds_read_b64_tr_b16 a[160:161], v7 offset:24576
  v_cvt_pk_bf16_f32 v106, v120, v121
  v_mfma_f32_16x16x32_bf16 v[156:159], v[16:19], a[28:31], v[156:159]
  ds_read_b64_tr_b16 a[162:163], v7 offset:26624
  v_cvt_pk_bf16_f32 v107, v122, v123
  v_mfma_f32_16x16x32_bf16 v[152:155], v[16:19], a[24:27], v[152:155]
  ds_read_b64_tr_b16 a[164:165], v7 offset:28672
  v_mfma_f32_16x16x32_bf16 v[152:155], v[20:23], a[8:11], v[152:155]
  s_waitcnt lgkmcnt(7)
  ds_read_b64_tr_b16 a[166:167], v7 offset:30720
  v_mfma_f32_16x16x32_bf16 v[168:171], v[28:31], a[8:11], v[168:171]
  ds_read_b64_tr_b16 v[16:17], v8 offset:24576
  s_add_u32 s86, s85, 0
  buffer_store_dwordx4 v[104:107], v1, s[8:11], s86 offen offset:1024 sc1
  v_mfma_f32_16x16x32_bf16 v[168:171], v[24:27], a[24:27], v[168:171]
  ds_read_b64_tr_b16 v[18:19], v8 offset:26624
  v_mfma_f32_16x16x32_bf16 v[172:175], v[24:27], a[28:31], v[172:175]
  ds_read_b64_tr_b16 v[20:21], v8 offset:28672
  v_cvt_pk_bf16_f32 v110, v124, v125
  v_mfma_f32_16x16x32_bf16 v[172:175], v[28:31], a[12:15], v[172:175]
  ds_read_b64_tr_b16 v[22:23], v8 offset:30720
  v_cvt_pk_bf16_f32 v111, v126, v127
  v_mfma_f32_16x16x32_bf16 v[188:191], a[172:175], a[12:15], v[188:191]
  ds_read_b64_tr_b16 v[24:25], v9 offset:24576
  v_mfma_f32_16x16x32_bf16 v[188:191], a[168:171], a[28:31], v[188:191]
  ds_read_b64_tr_b16 v[26:27], v9 offset:26624
  v_mfma_f32_16x16x32_bf16 v[184:187], a[168:171], a[24:27], v[184:187]
  ds_read_b64_tr_b16 v[28:29], v9 offset:28672
  s_add_u32 s86, s85, 0
  buffer_store_dwordx4 v[108:111], v1, s[8:11], s86 offen offset:3072 sc1
  v_mfma_f32_16x16x32_bf16 v[184:187], a[172:175], a[8:11], v[184:187]
  s_waitcnt lgkmcnt(7)
  ds_read_b64_tr_b16 v[30:31], v9 offset:30720
  v_mfma_f32_16x16x32_bf16 v[136:139], a[180:183], a[40:43], v[136:139]
  ds_read_b64_tr_b16 a[168:169], v6 offset:8192
  v_cvt_pk_bf16_f32 v98, v112, v113
  v_mfma_f32_16x16x32_bf16 v[136:139], a[176:179], a[56:59], v[136:139]
  ds_read_b64_tr_b16 a[170:171], v6 offset:10240
  v_cvt_pk_bf16_f32 v99, v114, v115
  v_mfma_f32_16x16x32_bf16 v[140:143], a[176:179], a[60:63], v[140:143]
  ds_read_b64_tr_b16 a[172:173], v6 offset:12288
  v_mfma_f32_16x16x32_bf16 v[140:143], a[180:183], a[44:47], v[140:143]
  ds_read_b64_tr_b16 a[174:175], v6 offset:14336
  v_mfma_f32_16x16x32_bf16 v[156:159], a[160:163], a[44:47], v[156:159]
  ds_read_b64_tr_b16 a[176:177], v7 offset:8192
  s_add_u32 s86, s85, 4096
  buffer_store_dwordx4 v[96:99], v1, s[8:11], s86 offen offset:1024 sc1
  v_mfma_f32_16x16x32_bf16 v[156:159], a[164:167], a[60:63], v[156:159]
  ds_read_b64_tr_b16 a[178:179], v7 offset:10240
  v_mfma_f32_16x16x32_bf16 v[152:155], a[164:167], a[56:59], v[152:155]
  ds_read_b64_tr_b16 a[180:181], v7 offset:12288
  v_cvt_pk_bf16_f32 v102, v116, v117
  v_mfma_f32_16x16x32_bf16 v[152:155], a[160:163], a[40:43], v[152:155]
  s_waitcnt lgkmcnt(7)
  ds_read_b64_tr_b16 a[182:183], v7 offset:14336
  v_mfma_f32_16x16x32_bf16 v[168:171], v[16:19], a[40:43], v[168:171]
  ds_read_b64_tr_b16 a[164:165], v8 offset:8192
  v_cvt_pk_bf16_f32 v103, v118, v119
  v_mfma_f32_16x16x32_bf16 v[168:171], v[20:23], a[56:59], v[168:171]
  ds_read_b64_tr_b16 a[166:167], v8 offset:10240
  v_mfma_f32_16x16x32_bf16 v[172:175], v[20:23], a[60:63], v[172:175]
  ds_read_b64_tr_b16 a[160:161], v8 offset:12288
  v_mfma_f32_16x16x32_bf16 v[172:175], v[16:19], a[44:47], v[172:175]
  ds_read_b64_tr_b16 a[162:163], v8 offset:14336
  s_add_u32 s86, s85, 4096
  buffer_store_dwordx4 v[100:103], v1, s[8:11], s86 offen offset:3072 sc1
  v_mfma_f32_16x16x32_bf16 v[188:191], v[24:27], a[44:47], v[188:191]
  ds_read_b64_tr_b16 v[20:21], v9 offset:8192
  v_mfma_f32_16x16x32_bf16 v[188:191], v[28:31], a[60:63], v[188:191]
  ds_read_b64_tr_b16 v[22:23], v9 offset:10240
  v_mfma_f32_16x16x32_bf16 v[184:187], v[28:31], a[56:59], v[184:187]
  ds_read_b64_tr_b16 v[16:17], v9 offset:12288
  v_mfma_f32_16x16x32_bf16 v[184:187], v[24:27], a[40:43], v[184:187]
  s_waitcnt lgkmcnt(7)
  ds_read_b64_tr_b16 v[18:19], v9 offset:14336
  v_mfma_f32_16x16x32_bf16 v[136:139], a[168:171], a[72:75], v[136:139]
  ds_read_b64_tr_b16 v[28:29], v2 offset:8192
  v_mfma_f32_16x16x32_bf16 v[136:139], a[172:175], a[88:91], v[136:139]
  ds_read_b64_tr_b16 v[30:31], v2 offset:10240
  v_mfma_f32_16x16x32_bf16 v[140:143], a[172:175], a[92:95], v[140:143]
  ds_read_b64_tr_b16 v[24:25], v2 offset:12288
  v_mfma_f32_16x16x32_bf16 v[140:143], a[168:171], a[76:79], v[140:143]
  ds_read_b64_tr_b16 v[26:27], v2 offset:14336
  v_mfma_f32_16x16x32_bf16 v[156:159], a[176:179], a[76:79], v[156:159]
  ds_read_b64_tr_b16 a[172:173], v3 offset:8192
  v_mfma_f32_16x16x32_bf16 v[156:159], a[180:183], a[92:95], v[156:159]
  ds_read_b64_tr_b16 a[174:175], v3 offset:10240
  v_mfma_f32_16x16x32_bf16 v[152:155], a[180:183], a[88:91], v[152:155]
  ds_read_b64_tr_b16 a[168:169], v3 offset:12288
  v_mfma_f32_16x16x32_bf16 v[152:155], a[176:179], a[72:75], v[152:155]
  s_waitcnt lgkmcnt(7)
  ds_read_b64_tr_b16 a[170:171], v3 offset:14336
  v_mfma_f32_16x16x32_bf16 v[168:171], a[164:167], a[72:75], v[168:171]
  ds_read_b64_tr_b16 a[180:181], v4 offset:8192
  v_mfma_f32_16x16x32_bf16 v[168:171], a[160:163], a[88:91], v[168:171]
  ds_read_b64_tr_b16 a[182:183], v4 offset:10240
  v_mfma_f32_16x16x32_bf16 v[172:175], a[160:163], a[92:95], v[172:175]
  ds_read_b64_tr_b16 a[176:177], v4 offset:12288
  v_mfma_f32_16x16x32_bf16 v[172:175], a[164:167], a[76:79], v[172:175]
  ds_read_b64_tr_b16 a[178:179], v4 offset:14336
  v_mfma_f32_16x16x32_bf16 v[188:191], v[20:23], a[76:79], v[188:191]
  ds_read_b64_tr_b16 a[160:161], v5 offset:8192
  v_mfma_f32_16x16x32_bf16 v[188:191], v[16:19], a[92:95], v[188:191]
  ds_read_b64_tr_b16 a[162:163], v5 offset:10240
  v_mfma_f32_16x16x32_bf16 v[184:187], v[16:19], a[88:91], v[184:187]
  ds_read_b64_tr_b16 a[164:165], v5 offset:12288
  v_mfma_f32_16x16x32_bf16 v[184:187], v[20:23], a[72:75], v[184:187]
  s_waitcnt lgkmcnt(7)
  ds_read_b64_tr_b16 a[166:167], v5 offset:14336
  v_mfma_f32_16x16x32_bf16 v[136:139], v[28:31], a[104:107], v[136:139]
  ds_read_b64_tr_b16 v[16:17], v2 offset:40960
  v_mfma_f32_16x16x32_bf16 v[136:139], v[24:27], a[120:123], v[136:139]
  ds_read_b64_tr_b16 v[18:19], v2 offset:43008
  v_mfma_f32_16x16x32_bf16 v[140:143], v[24:27], a[124:127], v[140:143]
  ds_read_b64_tr_b16 v[20:21], v2 offset:45056
  v_mfma_f32_16x16x32_bf16 v[140:143], v[28:31], a[108:111], v[140:143]
  ds_read_b64_tr_b16 v[22:23], v2 offset:47104
  v_mfma_f32_16x16x32_bf16 v[156:159], a[172:175], a[108:111], v[156:159]
  ds_read_b64_tr_b16 v[24:25], v3 offset:40960
  v_mfma_f32_16x16x32_bf16 v[156:159], a[168:171], a[124:127], v[156:159]
  ds_read_b64_tr_b16 v[26:27], v3 offset:43008
  v_mfma_f32_16x16x32_bf16 v[152:155], a[168:171], a[120:123], v[152:155]
  ds_read_b64_tr_b16 v[28:29], v3 offset:45056
  v_mfma_f32_16x16x32_bf16 v[152:155], a[172:175], a[104:107], v[152:155]
  s_waitcnt lgkmcnt(7)
  ds_read_b64_tr_b16 v[30:31], v3 offset:47104
  v_mfma_f32_16x16x32_bf16 v[168:171], a[180:183], a[104:107], v[168:171]
  ds_read_b64_tr_b16 a[168:169], v4 offset:40960
  v_mfma_f32_16x16x32_bf16 v[168:171], a[176:179], a[120:123], v[168:171]
  ds_read_b64_tr_b16 a[170:171], v4 offset:43008
  v_mfma_f32_16x16x32_bf16 v[172:175], a[176:179], a[124:127], v[172:175]
  ds_read_b64_tr_b16 a[172:173], v4 offset:45056
  v_mfma_f32_16x16x32_bf16 v[172:175], a[180:183], a[108:111], v[172:175]
  ds_read_b64_tr_b16 a[174:175], v4 offset:47104
  v_mfma_f32_16x16x32_bf16 v[188:191], a[160:163], a[108:111], v[188:191]
  ds_read_b64_tr_b16 a[176:177], v5 offset:40960
  v_mfma_f32_16x16x32_bf16 v[188:191], a[164:167], a[124:127], v[188:191]
  ds_read_b64_tr_b16 a[178:179], v5 offset:43008
HOP19:
  s_cbranch_execz WRET1
  v_mfma_f32_16x16x32_bf16 v[184:187], a[164:167], a[120:123], v[184:187]
  ds_read_b64_tr_b16 a[180:181], v5 offset:45056
  v_mfma_f32_16x16x32_bf16 v[184:187], a[160:163], a[104:107], v[184:187]
  s_waitcnt lgkmcnt(7)
  ds_read_b64_tr_b16 a[182:183], v5 offset:47104
  v_mfma_f32_16x16x32_bf16 v[136:139], v[16:19], a[136:139], v[136:139]
  ds_read_b64_tr_b16 a[164:165], v2 offset:57344
  v_mfma_f32_16x16x32_bf16 v[136:139], v[20:23], a[152:155], v[136:139]
  ds_read_b64_tr_b16 a[166:167], v2 offset:59392
  v_mfma_f32_16x16x32_bf16 v[140:143], v[20:23], a[156:159], v[140:143]
  ds_read_b64_tr_b16 a[160:161], v2 offset:61440
  v_mfma_f32_16x16x32_bf16 v[140:143], v[16:19], a[140:143], v[140:143]
  ds_read_b64_tr_b16 a[162:163], v2 offset:63488
  v_mfma_f32_16x16x32_bf16 v[156:159], v[24:27], a[140:143], v[156:159]
  ds_read_b64_tr_b16 v[20:21], v3 offset:57344
  v_add_u32 v38, s46, v0
  s_waitcnt vmcnt(0)
  s_mov_b64 exec, 1
  buffer_store_dword v38, v0, s[8:11], s80 offen offset:0 sc1
  s_mov_b64 exec, -1
  v_mfma_f32_16x16x32_bf16 v[156:159], v[28:31], a[156:159], v[156:159]
  ds_read_b64_tr_b16 v[22:23], v3 offset:59392
  v_mfma_f32_16x16x32_bf16 v[152:155], v[28:31], a[152:155], v[152:155]
  ds_read_b64_tr_b16 v[16:17], v3 offset:61440
  v_mfma_f32_16x16x32_bf16 v[152:155], v[24:27], a[136:139], v[152:155]
  s_waitcnt lgkmcnt(7)
  ds_read_b64_tr_b16 v[18:19], v3 offset:63488
  v_mfma_f32_16x16x32_bf16 v[168:171], a[168:171], a[136:139], v[168:171]
  ds_read_b64_tr_b16 v[28:29], v4 offset:57344
  v_mfma_f32_16x16x32_bf16 v[168:171], a[172:175], a[152:155], v[168:171]
  ds_read_b64_tr_b16 v[30:31], v4 offset:59392
  v_mfma_f32_16x16x32_bf16 v[172:175], a[172:175], a[156:159], v[172:175]
  ds_read_b64_tr_b16 v[24:25], v4 offset:61440
  v_mfma_f32_16x16x32_bf16 v[172:175], a[168:171], a[140:143], v[172:175]
  ds_read_b64_tr_b16 v[26:27], v4 offset:63488
  v_mfma_f32_16x16x32_bf16 v[188:191], a[176:179], a[140:143], v[188:191]
  ds_read_b64_tr_b16 a[172:173], v5 offset:57344
  v_mfma_f32_16x16x32_bf16 v[188:191], a[180:183], a[156:159], v[188:191]
  ds_read_b64_tr_b16 a[174:175], v5 offset:59392
  v_mfma_f32_16x16x32_bf16 v[184:187], a[180:183], a[152:155], v[184:187]
  ds_read_b64_tr_b16 a[168:169], v5 offset:61440
  v_mfma_f32_16x16x32_bf16 v[184:187], a[176:179], a[136:139], v[184:187]
  s_waitcnt lgkmcnt(7)
  ds_read_b64_tr_b16 a[170:171], v5 offset:63488
  v_mfma_f32_16x16x32_bf16 v[136:139], a[164:167], a[196:199], v[136:139]
  ds_read_b64_tr_b16 a[180:181], v6 offset:40960
  v_mfma_f32_16x16x32_bf16 v[136:139], a[160:163], a[212:215], v[136:139]
  ds_read_b64_tr_b16 a[182:183], v6 offset:43008
  v_mfma_f32_16x16x32_bf16 v[140:143], a[160:163], a[216:219], v[140:143]
  ds_read_b64_tr_b16 a[176:177], v6 offset:45056
  v_mfma_f32_16x16x32_bf16 v[140:143], a[164:167], a[200:203], v[140:143]
  ds_read_b64_tr_b16 a[178:179], v6 offset:47104
  v_mfma_f32_16x16x32_bf16 v[156:159], v[20:23], a[200:203], v[156:159]
  ds_read_b64_tr_b16 a[160:161], v7 offset:40960
  v_mfma_f32_16x16x32_bf16 v[156:159], v[16:19], a[216:219], v[156:159]
  ds_read_b64_tr_b16 a[162:163], v7 offset:43008
  v_mfma_f32_16x16x32_bf16 v[152:155], v[16:19], a[212:215], v[152:155]
  ds_read_b64_tr_b16 a[164:165], v7 offset:45056
  v_cvt_pk_bf16_f32 v136, v136, v137
  v_cvt_pk_bf16_f32 v137, v138, v139
  v_cvt_pk_bf16_f32 v140, v140, v141
  v_cvt_pk_bf16_f32 v141, v142, v143
  v_mfma_f32_16x16x32_bf16 v[152:155], v[20:23], a[196:199], v[152:155]
  s_waitcnt lgkmcnt(7)
  ds_read_b64_tr_b16 a[166:167], v7 offset:47104
  v_mfma_f32_16x16x32_bf16 v[168:171], v[28:31], a[196:199], v[168:171]
  ds_read_b64_tr_b16 v[16:17], v8 offset:40960
  v_mfma_f32_16x16x32_bf16 v[168:171], v[24:27], a[212:215], v[168:171]
  ds_read_b64_tr_b16 v[18:19], v8 offset:43008
  v_mfma_f32_16x16x32_bf16 v[172:175], v[24:27], a[216:219], v[172:175]
  ds_read_b64_tr_b16 v[20:21], v8 offset:45056
  v_cvt_pk_bf16_f32 v138, v152, v153
  v_cvt_pk_bf16_f32 v139, v154, v155
  v_mfma_f32_16x16x32_bf16 v[172:175], v[28:31], a[200:203], v[172:175]
  ds_read_b64_tr_b16 v[22:23], v8 offset:47104
  v_mfma_f32_16x16x32_bf16 v[188:191], a[172:175], a[200:203], v[188:191]
  ds_read_b64_tr_b16 v[24:25], v9 offset:40960
  v_mfma_f32_16x16x32_bf16 v[188:191], a[168:171], a[216:219], v[188:191]
  ds_read_b64_tr_b16 v[26:27], v9 offset:43008
  s_add_u32 s86, s85, 8192
  buffer_store_dwordx4 v[136:139], v1, s[8:11], s86 offen offset:0 sc1
  v_mfma_f32_16x16x32_bf16 v[184:187], a[168:171], a[212:215], v[184:187]
  ds_read_b64_tr_b16 v[28:29], v9 offset:45056
  v_cvt_pk_bf16_f32 v142, v156, v157
  v_cvt_pk_bf16_f32 v143, v158, v159
  v_mfma_f32_16x16x32_bf16 v[184:187], a[172:175], a[196:199], v[184:187]
  s_waitcnt lgkmcnt(7)
  ds_read_b64_tr_b16 v[30:31], v9 offset:47104
  v_mfma_f32_16x16x32_bf16 v[128:131], a[180:183], a[220:223], v[128:131]
  ds_read_b64_tr_b16 a[168:169], v6 offset:57344
  v_mfma_f32_16x16x32_bf16 v[128:131], a[176:179], a[236:239], v[128:131]
  ds_read_b64_tr_b16 a[170:171], v6 offset:59392
  s_add_u32 s86, s85, 8192
  buffer_store_dwordx4 v[140:143], v1, s[8:11], s86 offen offset:2048 sc1
  v_mfma_f32_16x16x32_bf16 v[132:135], a[176:179], a[240:243], v[132:135]
  ds_read_b64_tr_b16 a[172:173], v6 offset:61440
  v_cvt_pk_bf16_f32 v168, v168, v169
  v_cvt_pk_bf16_f32 v169, v170, v171
  v_cvt_pk_bf16_f32 v172, v172, v173
  v_cvt_pk_bf16_f32 v173, v174, v175
  v_mfma_f32_16x16x32_bf16 v[132:135], a[180:183], a[224:227], v[132:135]
  ds_read_b64_tr_b16 a[174:175], v6 offset:63488
  v_cvt_pk_bf16_f32 v170, v184, v185
  v_cvt_pk_bf16_f32 v171, v186, v187
  v_mfma_f32_16x16x32_bf16 v[148:151], a[160:163], a[224:227], v[148:151]
  ds_read_b64_tr_b16 a[176:177], v7 offset:57344
  v_mfma_f32_16x16x32_bf16 v[148:151], a[164:167], a[240:243], v[148:151]
  ds_read_b64_tr_b16 a[178:179], v7 offset:59392
  v_mfma_f32_16x16x32_bf16 v[144:147], a[164:167], a[236:239], v[144:147]
  ds_read_b64_tr_b16 a[180:181], v7 offset:61440
  s_add_u32 s86, s85, 8192
  buffer_store_dwordx4 v[168:171], v1, s[8:11], s86 offen offset:1024 sc1
  v_mfma_f32_16x16x32_bf16 v[144:147], a[160:163], a[220:223], v[144:147]
  s_waitcnt lgkmcnt(7)
  ds_read_b64_tr_b16 a[182:183], v7 offset:63488
  v_cvt_pk_bf16_f32 v174, v188, v189
  v_cvt_pk_bf16_f32 v175, v190, v191
  v_mfma_f32_16x16x32_bf16 v[160:163], v[16:19], a[220:223], v[160:163]
  ds_read_b64_tr_b16 a[164:165], v8 offset:57344
  v_mfma_f32_16x16x32_bf16 v[160:163], v[20:23], a[236:239], v[160:163]
  ds_read_b64_tr_b16 a[166:167], v8 offset:59392
  v_mfma_f32_16x16x32_bf16 v[164:167], v[20:23], a[240:243], v[164:167]
  ds_read_b64_tr_b16 a[160:161], v8 offset:61440
  s_add_u32 s86, s85, 8192
  buffer_store_dwordx4 v[172:175], v1, s[8:11], s86 offen offset:3072 sc1
  v_mfma_f32_16x16x32_bf16 v[164:167], v[16:19], a[224:227], v[164:167]
  ds_read_b64_tr_b16 a[162:163], v8 offset:63488
  v_mfma_f32_16x16x32_bf16 v[180:183], v[24:27], a[224:227], v[180:183]
  ds_read_b64_tr_b16 v[20:21], v9 offset:57344
  v_mfma_f32_16x16x32_bf16 v[180:183], v[28:31], a[240:243], v[180:183]
  ds_read_b64_tr_b16 v[22:23], v9 offset:59392
  v_mfma_f32_16x16x32_bf16 v[176:179], v[28:31], a[236:239], v[176:179]
  ds_read_b64_tr_b16 v[16:17], v9 offset:61440
  v_mfma_f32_16x16x32_bf16 v[176:179], v[24:27], a[220:223], v[176:179]
  s_waitcnt lgkmcnt(7)
  ds_read_b64_tr_b16 v[18:19], v9 offset:63488
  v_mfma_f32_16x16x32_bf16 v[128:131], a[168:171], a[0:3], v[128:131]
  ds_read_b64_tr_b16 v[28:29], v6 offset:24576
  v_mfma_f32_16x16x32_bf16 v[128:131], a[172:175], a[16:19], v[128:131]
  ds_read_b64_tr_b16 v[30:31], v6 offset:26624
  v_mfma_f32_16x16x32_bf16 v[132:135], a[172:175], a[20:23], v[132:135]
  ds_read_b64_tr_b16 v[24:25], v6 offset:28672
  v_mfma_f32_16x16x32_bf16 v[132:135], a[168:171], a[4:7], v[132:135]
  ds_read_b64_tr_b16 v[26:27], v6 offset:30720
  v_mfma_f32_16x16x32_bf16 v[148:151], a[176:179], a[4:7], v[148:151]
  ds_read_b64_tr_b16 a[172:173], v7 offset:24576
  v_mfma_f32_16x16x32_bf16 v[148:151], a[180:183], a[20:23], v[148:151]
  ds_read_b64_tr_b16 a[174:175], v7 offset:26624
  v_mfma_f32_16x16x32_bf16 v[144:147], a[180:183], a[16:19], v[144:147]
  ds_read_b64_tr_b16 a[168:169], v7 offset:28672
  v_mfma_f32_16x16x32_bf16 v[144:147], a[176:179], a[0:3], v[144:147]
  s_waitcnt lgkmcnt(7)
  ds_read_b64_tr_b16 a[170:171], v7 offset:30720
  v_mfma_f32_16x16x32_bf16 v[160:163], a[164:167], a[0:3], v[160:163]
  ds_read_b64_tr_b16 a[180:181], v8 offset:24576
  v_mfma_f32_16x16x32_bf16 v[160:163], a[160:163], a[16:19], v[160:163]
  ds_read_b64_tr_b16 a[182:183], v8 offset:26624
  v_mfma_f32_16x16x32_bf16 v[164:167], a[160:163], a[20:23], v[164:167]
  ds_read_b64_tr_b16 a[176:177], v8 offset:28672
  v_mfma_f32_16x16x32_bf16 v[164:167], a[164:167], a[4:7], v[164:167]
  ds_read_b64_tr_b16 a[178:179], v8 offset:30720
  v_mfma_f32_16x16x32_bf16 v[180:183], v[20:23], a[4:7], v[180:183]
  ds_read_b64_tr_b16 a[160:161], v9 offset:24576
  v_mfma_f32_16x16x32_bf16 v[180:183], v[16:19], a[20:23], v[180:183]
  ds_read_b64_tr_b16 a[162:163], v9 offset:26624
  v_mfma_f32_16x16x32_bf16 v[176:179], v[16:19], a[16:19], v[176:179]
  ds_read_b64_tr_b16 a[164:165], v9 offset:28672
  v_mfma_f32_16x16x32_bf16 v[176:179], v[20:23], a[0:3], v[176:179]
  s_waitcnt lgkmcnt(7)
  ds_read_b64_tr_b16 a[166:167], v9 offset:30720
  v_mfma_f32_16x16x32_bf16 v[128:131], v[28:31], a[32:35], v[128:131]
  ds_read_b64_tr_b16 v[16:17], v6 offset:8192
  v_mfma_f32_16x16x32_bf16 v[128:131], v[24:27], a[48:51], v[128:131]
  ds_read_b64_tr_b16 v[18:19], v6 offset:10240
  v_mfma_f32_16x16x32_bf16 v[132:135], v[24:27], a[52:55], v[132:135]
  ds_read_b64_tr_b16 v[20:21], v6 offset:12288
  v_mfma_f32_16x16x32_bf16 v[132:135], v[28:31], a[36:39], v[132:135]
  ds_read_b64_tr_b16 v[22:23], v6 offset:14336
  v_mfma_f32_16x16x32_bf16 v[148:151], a[172:175], a[36:39], v[148:151]
  ds_read_b64_tr_b16 v[24:25], v7 offset:8192
  v_mfma_f32_16x16x32_bf16 v[148:151], a[168:171], a[52:55], v[148:151]
  ds_read_b64_tr_b16 v[26:27], v7 offset:10240
  s_xor_b32 s83, s80, 1536
  s_add_u32 s83, s83, 0
  buffer_load_dword v34, v37, s[8:11], s83 offen sc1
  v_mfma_f32_16x16x32_bf16 v[144:147], a[168:171], a[48:51], v[144:147]
  ds_read_b64_tr_b16 v[28:29], v7 offset:12288
  s_xor_b32 s90, s80, 512
  s_add_u32 s90, s90, 0
  buffer_load_dword v39, v37, s[8:11], s90 offen sc1
  v_mfma_f32_16x16x32_bf16 v[144:147], a[172:175], a[32:35], v[144:147]
  s_waitcnt lgkmcnt(7)
  ds_read_b64_tr_b16 v[30:31], v7 offset:14336
  v_mfma_f32_16x16x32_bf16 v[160:163], a[180:183], a[32:35], v[160:163]
  ds_read_b64_tr_b16 a[168:169], v8 offset:8192
  v_mfma_f32_16x16x32_bf16 v[160:163], a[176:179], a[48:51], v[160:163]
  ds_read_b64_tr_b16 a[170:171], v8 offset:10240
  v_mfma_f32_16x16x32_bf16 v[164:167], a[176:179], a[52:55], v[164:167]
  ds_read_b64_tr_b16 a[172:173], v8 offset:12288
  v_mfma_f32_16x16x32_bf16 v[164:167], a[180:183], a[36:39], v[164:167]
  ds_read_b64_tr_b16 a[174:175], v8 offset:14336
  v_mfma_f32_16x16x32_bf16 v[180:183], a[160:163], a[36:39], v[180:183]
  ds_read_b64_tr_b16 a[176:177], v9 offset:8192
  v_mfma_f32_16x16x32_bf16 v[180:183], a[164:167], a[52:55], v[180:183]
  ds_read_b64_tr_b16 a[178:179], v9 offset:10240
  v_mfma_f32_16x16x32_bf16 v[176:179], a[164:167], a[48:51], v[176:179]
  ds_read_b64_tr_b16 a[180:181], v9 offset:12288
  v_mfma_f32_16x16x32_bf16 v[176:179], a[160:163], a[32:35], v[176:179]
  s_waitcnt lgkmcnt(7)
  ds_read_b64_tr_b16 a[182:183], v9 offset:14336
  v_add_u32 v38, s46, v0
  s_waitcnt vmcnt(2)
  s_mov_b64 exec, 1
  buffer_store_dword v38, v0, s[8:11], s80 offen offset:16 sc1
  s_mov_b64 exec, -1
  v_mfma_f32_16x16x32_bf16 v[128:131], v[16:19], a[64:67], v[128:131]
  ds_read_b64_tr_b16 a[164:165], v2 offset:8192
  v_mfma_f32_16x16x32_bf16 v[128:131], v[20:23], a[80:83], v[128:131]
  ds_read_b64_tr_b16 a[166:167], v2 offset:10240
  v_mfma_f32_16x16x32_bf16 v[132:135], v[20:23], a[84:87], v[132:135]
  ds_read_b64_tr_b16 a[160:161], v2 offset:12288
  v_mfma_f32_16x16x32_bf16 v[132:135], v[16:19], a[68:71], v[132:135]
  ds_read_b64_tr_b16 a[162:163], v2 offset:14336
  s_xor_b32 s81, s80, 1024
  s_add_u32 s81, s81, 16
  buffer_load_dword v36, v37, s[8:11], s81 offen sc1
  v_mfma_f32_16x16x32_bf16 v[148:151], v[24:27], a[68:71], v[148:151]
  ds_read_b64_tr_b16 v[20:21], v3 offset:8192
  v_mfma_f32_16x16x32_bf16 v[148:151], v[28:31], a[84:87], v[148:151]
  ds_read_b64_tr_b16 v[22:23], v3 offset:10240
  v_mfma_f32_16x16x32_bf16 v[144:147], v[28:31], a[80:83], v[144:147]
  ds_read_b64_tr_b16 v[16:17], v3 offset:12288
  v_mfma_f32_16x16x32_bf16 v[144:147], v[24:27], a[64:67], v[144:147]
  s_waitcnt lgkmcnt(7)
  ds_read_b64_tr_b16 v[18:19], v3 offset:14336
  v_mfma_f32_16x16x32_bf16 v[160:163], a[168:171], a[64:67], v[160:163]
  ds_read_b64_tr_b16 v[28:29], v4 offset:8192
  v_mfma_f32_16x16x32_bf16 v[160:163], a[172:175], a[80:83], v[160:163]
  ds_read_b64_tr_b16 v[30:31], v4 offset:10240
  v_mfma_f32_16x16x32_bf16 v[164:167], a[172:175], a[84:87], v[164:167]
  ds_read_b64_tr_b16 v[24:25], v4 offset:12288
  v_mfma_f32_16x16x32_bf16 v[164:167], a[168:171], a[68:71], v[164:167]
  ds_read_b64_tr_b16 v[26:27], v4 offset:14336
  v_mfma_f32_16x16x32_bf16 v[180:183], a[176:179], a[68:71], v[180:183]
  ds_read_b64_tr_b16 a[172:173], v5 offset:8192
  v_mfma_f32_16x16x32_bf16 v[180:183], a[180:183], a[84:87], v[180:183]
  ds_read_b64_tr_b16 a[174:175], v5 offset:10240
  v_mfma_f32_16x16x32_bf16 v[176:179], a[180:183], a[80:83], v[176:179]
  ds_read_b64_tr_b16 a[168:169], v5 offset:12288
  v_mfma_f32_16x16x32_bf16 v[176:179], a[176:179], a[64:67], v[176:179]
  s_waitcnt lgkmcnt(7)
  ds_read_b64_tr_b16 a[170:171], v5 offset:14336
  v_mfma_f32_16x16x32_bf16 v[128:131], a[164:167], a[96:99], v[128:131]
  ds_read_b64_tr_b16 a[180:181], v2 offset:40960
  v_mfma_f32_16x16x32_bf16 v[128:131], a[160:163], a[112:115], v[128:131]
  ds_read_b64_tr_b16 a[182:183], v2 offset:43008
  s_waitcnt vmcnt(3)
  v_cmp_ne_u32 vcc, s46, v34
  s_nop 4
  s_cbranch_vccz PL14_adaLN_cond__sliding_local_dilated__swiglu_ffn__prompt_kernelx
  s_mov_b32 s82, 60000
PL14_adaLN_cond__sliding_local_dilated__swiglu_ffn__prompt_kernel:
  buffer_load_dword v34, v37, s[8:11], s83 offen sc1
  s_sub_u32 s82, s82, 1
  s_cmp_eq_u32 s82, 0
  s_waitcnt vmcnt(0)
  s_cbranch_scc1 PL14_adaLN_cond__sliding_local_dilated__swiglu_ffn__prompt_kernelx
  v_cmp_ne_u32 vcc, s46, v34
  s_nop 4
  s_cbranch_vccnz PL14_adaLN_cond__sliding_local_dilated__swiglu_ffn__prompt_kernel
PL14_adaLN_cond__sliding_local_dilated__swiglu_ffn__prompt_kernelx:
  v_mfma_f32_16x16x32_bf16 v[132:135], a[160:163], a[116:119], v[132:135]
  ds_read_b64_tr_b16 a[176:177], v2 offset:45056
  s_xor_b32 s55, s85, 196608
  s_add_u32 s55, s55, 0
  buffer_load_dwordx4 v[88:91], v1, s[8:11], s55 offen offset:0 sc1
  v_mfma_f32_16x16x32_bf16 v[132:135], a[164:167], a[100:103], v[132:135]
  ds_read_b64_tr_b16 a[178:179], v2 offset:47104
  s_xor_b32 s55, s85, 196608
  s_add_u32 s55, s55, 0
  buffer_load_dwordx4 v[120:123], v1, s[8:11], s55 offen offset:1024 sc1
  v_mfma_f32_16x16x32_bf16 v[148:151], v[20:23], a[100:103], v[148:151]
  ds_read_b64_tr_b16 a[160:161], v3 offset:40960
  s_xor_b32 s55, s85, 196608
  s_add_u32 s55, s55, 0
  buffer_load_dwordx4 v[92:95], v1, s[8:11], s55 offen offset:2048 sc1
  v_mfma_f32_16x16x32_bf16 v[148:151], v[16:19], a[116:119], v[148:151]
  ds_read_b64_tr_b16 a[162:163], v3 offset:43008
  s_xor_b32 s55, s85, 196608
  s_add_u32 s55, s55, 0
  buffer_load_dwordx4 v[124:127], v1, s[8:11], s55 offen offset:3072 sc1
  v_mfma_f32_16x16x32_bf16 v[144:147], v[16:19], a[112:115], v[144:147]
  ds_read_b64_tr_b16 a[164:165], v3 offset:45056
  s_waitcnt vmcnt(6)
  v_cmp_ne_u32 vcc, s46, v39
  s_nop 4
  s_cbranch_vccz PL15_adaLN_cond__sliding_local_dilated__swiglu_ffn__prompt_kernelx
  s_mov_b32 s82, 60000
PL15_adaLN_cond__sliding_local_dilated__swiglu_ffn__prompt_kernel:
  buffer_load_dword v39, v37, s[8:11], s90 offen sc1
  s_sub_u32 s82, s82, 1
  s_cmp_eq_u32 s82, 0
  s_waitcnt vmcnt(0)
  s_cbranch_scc1 PL15_adaLN_cond__sliding_local_dilated__swiglu_ffn__prompt_kernelx
  v_cmp_ne_u32 vcc, s46, v39
  s_nop 4
  s_cbranch_vccnz PL15_adaLN_cond__sliding_local_dilated__swiglu_ffn__prompt_kernel
PL15_adaLN_cond__sliding_local_dilated__swiglu_ffn__prompt_kernelx:
  v_mfma_f32_16x16x32_bf16 v[144:147], v[20:23], a[96:99], v[144:147]
  s_waitcnt lgkmcnt(7)
  ds_read_b64_tr_b16 a[166:167], v3 offset:47104
  s_xor_b32 s55, s85, 65536
  s_add_u32 s55, s55, 4096
  buffer_load_dwordx4 v[80:83], v1, s[8:11], s55 offen offset:0 sc1
  v_mfma_f32_16x16x32_bf16 v[160:163], v[28:31], a[96:99], v[160:163]
  ds_read_b64_tr_b16 v[16:17], v4 offset:40960
  s_xor_b32 s55, s85, 65536
  s_add_u32 s55, s55, 4096
  buffer_load_dwordx4 v[112:115], v1, s[8:11], s55 offen offset:1024 sc1
  v_mfma_f32_16x16x32_bf16 v[160:163], v[24:27], a[112:115], v[160:163]
  ds_read_b64_tr_b16 v[18:19], v4 offset:43008
  s_xor_b32 s55, s85, 65536
  s_add_u32 s55, s55, 4096
  buffer_load_dwordx4 v[84:87], v1, s[8:11], s55 offen offset:2048 sc1
  v_mfma_f32_16x16x32_bf16 v[164:167], v[24:27], a[116:119], v[164:167]
  ds_read_b64_tr_b16 v[20:21], v4 offset:45056
  s_xor_b32 s55, s85, 65536
  s_add_u32 s55, s55, 4096
  buffer_load_dwordx4 v[116:119], v1, s[8:11], s55 offen offset:3072 sc1
  v_mfma_f32_16x16x32_bf16 v[164:167], v[28:31], a[100:103], v[164:167]
  ds_read_b64_tr_b16 v[22:23], v4 offset:47104
  v_mfma_f32_16x16x32_bf16 v[180:183], a[172:175], a[100:103], v[180:183]
  ds_read_b64_tr_b16 v[24:25], v5 offset:40960
  v_mfma_f32_16x16x32_bf16 v[180:183], a[168:171], a[116:119], v[180:183]
  ds_read_b64_tr_b16 v[26:27], v5 offset:43008
  s_waitcnt vmcnt(8)
  v_cmp_ne_u32 vcc, s46, v36
  s_mov_b32 s86, 0
  s_nop 3
  s_cbranch_vccnz XL16_adaLN_cond__sliding_local_dilated__swiglu_ffn__prompt_kernel
  s_xor_b32 s55, s85, 131072
  s_add_u32 s55, s55, 8192
  buffer_load_dwordx4 v[152:155], v1, s[8:11], s55 offen offset:0 sc1
  buffer_load_dwordx4 v[184:187], v1, s[8:11], s55 offen offset:1024 sc1
  buffer_load_dwordx4 v[156:159], v1, s[8:11], s55 offen offset:2048 sc1
  buffer_load_dwordx4 v[188:191], v1, s[8:11], s55 offen offset:3072 sc1
  s_mov_b32 s86, 1
XL16_adaLN_cond__sliding_local_dilated__swiglu_ffn__prompt_kernel:
  v_mfma_f32_16x16x32_bf16 v[176:179], a[168:171], a[112:115], v[176:179]
  ds_read_b64_tr_b16 v[28:29], v5 offset:45056
  v_mfma_f32_16x16x32_bf16 v[176:179], a[172:175], a[96:99], v[176:179]
  s_waitcnt lgkmcnt(7)
  ds_read_b64_tr_b16 v[30:31], v5 offset:47104
  v_mfma_f32_16x16x32_bf16 v[128:131], a[180:183], a[128:131], v[128:131]
  ds_read_b64_tr_b16 a[168:169], v2 offset:57344
  v_mfma_f32_16x16x32_bf16 v[128:131], a[176:179], a[144:147], v[128:131]
  ds_read_b64_tr_b16 a[170:171], v2 offset:59392
  v_mfma_f32_16x16x32_bf16 v[132:135], a[176:179], a[148:151], v[132:135]
  ds_read_b64_tr_b16 a[172:173], v2 offset:61440
  v_mfma_f32_16x16x32_bf16 v[132:135], a[180:183], a[132:135], v[132:135]
  ds_read_b64_tr_b16 a[174:175], v2 offset:63488
  v_mfma_f32_16x16x32_bf16 v[148:151], a[160:163], a[132:135], v[148:151]
  ds_read_b64_tr_b16 a[176:177], v3 offset:57344
  v_mfma_f32_16x16x32_bf16 v[148:151], a[164:167], a[148:151], v[148:151]
  ds_read_b64_tr_b16 a[178:179], v3 offset:59392
  v_mfma_f32_16x16x32_bf16 v[144:147], a[164:167], a[144:147], v[144:147]
  ds_read_b64_tr_b16 a[180:181], v3 offset:61440
  v_mfma_f32_16x16x32_bf16 v[144:147], a[160:163], a[128:131], v[144:147]
  s_waitcnt lgkmcnt(7)
  ds_read_b64_tr_b16 a[182:183], v3 offset:63488
  v_mfma_f32_16x16x32_bf16 v[160:163], v[16:19], a[128:131], v[160:163]
  ds_read_b64_tr_b16 a[164:165], v4 offset:57344
  v_mfma_f32_16x16x32_bf16 v[160:163], v[20:23], a[144:147], v[160:163]
  ds_read_b64_tr_b16 a[166:167], v4 offset:59392
  v_mfma_f32_16x16x32_bf16 v[164:167], v[20:23], a[148:151], v[164:167]
  ds_read_b64_tr_b16 a[160:161], v4 offset:61440
  v_mfma_f32_16x16x32_bf16 v[164:167], v[16:19], a[132:135], v[164:167]
  ds_read_b64_tr_b16 a[162:163], v4 offset:63488
  v_mfma_f32_16x16x32_bf16 v[180:183], v[24:27], a[132:135], v[180:183]
  ds_read_b64_tr_b16 v[20:21], v5 offset:57344
  v_mfma_f32_16x16x32_bf16 v[180:183], v[28:31], a[148:151], v[180:183]
  ds_read_b64_tr_b16 v[22:23], v5 offset:59392
  v_mfma_f32_16x16x32_bf16 v[176:179], v[28:31], a[144:147], v[176:179]
  ds_read_b64_tr_b16 v[16:17], v5 offset:61440
  v_mfma_f32_16x16x32_bf16 v[176:179], v[24:27], a[128:131], v[176:179]
  s_waitcnt lgkmcnt(7)
  ds_read_b64_tr_b16 v[18:19], v5 offset:63488
  v_mfma_f32_16x16x32_bf16 v[128:131], a[168:171], a[188:191], v[128:131]
  v_mfma_f32_16x16x32_bf16 v[128:131], a[172:175], a[204:207], v[128:131]
  v_mfma_f32_16x16x32_bf16 v[132:135], a[172:175], a[208:211], v[132:135]
  v_mfma_f32_16x16x32_bf16 v[132:135], a[168:171], a[192:195], v[132:135]
  v_mfma_f32_16x16x32_bf16 v[148:151], a[176:179], a[192:195], v[148:151]
  v_mfma_f32_16x16x32_bf16 v[148:151], a[180:183], a[208:211], v[148:151]
  v_mfma_f32_16x16x32_bf16 v[144:147], a[180:183], a[204:207], v[144:147]
  v_mfma_f32_16x16x32_bf16 v[144:147], a[176:179], a[188:191], v[144:147]
  s_waitcnt lgkmcnt(0)
  v_mfma_f32_16x16x32_bf16 v[160:163], a[164:167], a[188:191], v[160:163]
  v_mfma_f32_16x16x32_bf16 v[160:163], a[160:163], a[204:207], v[160:163]
  v_mfma_f32_16x16x32_bf16 v[164:167], a[160:163], a[208:211], v[164:167]
  v_mfma_f32_16x16x32_bf16 v[164:167], a[164:167], a[192:195], v[164:167]
  v_mfma_f32_16x16x32_bf16 v[180:183], v[20:23], a[192:195], v[180:183]
  v_mfma_f32_16x16x32_bf16 v[180:183], v[16:19], a[208:211], v[180:183]
  v_mfma_f32_16x16x32_bf16 v[176:179], v[16:19], a[204:207], v[176:179]
  v_mfma_f32_16x16x32_bf16 v[176:179], v[20:23], a[188:191], v[176:179]
  s_waitcnt vmcnt(0)
  v_mfma_f32_16x16x32_bf16 v[208:211], v[52:55], v[88:91], v[208:211]
  v_mfma_f32_16x16x32_bf16 v[212:215], v[54:57], v[88:91], v[212:215]
  v_mfma_f32_16x16x32_bf16 v[216:219], v[58:61], v[120:123], v[216:219]
  v_mfma_f32_16x16x32_bf16 v[220:223], v[60:63], v[120:123], v[220:223]
  v_mfma_f32_16x16x32_bf16 v[224:227], v[52:55], v[92:95], v[224:227]
  v_mfma_f32_16x16x32_bf16 v[228:231], v[54:57], v[92:95], v[228:231]
  v_mfma_f32_16x16x32_bf16 v[232:235], v[58:61], v[124:127], v[232:235]
  v_mfma_f32_16x16x32_bf16 v[236:239], v[60:63], v[124:127], v[236:239]
  v_mfma_f32_16x16x32_bf16 v[208:211], v[52:55], v[80:83], v[208:211]
  v_mfma_f32_16x16x32_bf16 v[212:215], v[54:57], v[80:83], v[212:215]
  v_mfma_f32_16x16x32_bf16 v[216:219], v[58:61], v[112:115], v[216:219]
  v_mfma_f32_16x16x32_bf16 v[220:223], v[60:63], v[112:115], v[220:223]
  v_mfma_f32_16x16x32_bf16 v[224:227], v[52:55], v[84:87], v[224:227]
  v_mfma_f32_16x16x32_bf16 v[228:231], v[54:57], v[84:87], v[228:231]
  v_mfma_f32_16x16x32_bf16 v[232:235], v[58:61], v[116:119], v[232:235]
  v_mfma_f32_16x16x32_bf16 v[236:239], v[60:63], v[116:119], v[236:239]
  s_nop 0
  v_fmac_f32 v208, v240, v128
  v_fmac_f32 v209, v241, v129
  v_fmac_f32 v210, v242, v130
  v_fmac_f32 v211, v243, v131
  v_fmac_f32 v212, v244, v144
  v_fmac_f32 v213, v245, v145
  v_fmac_f32 v214, v246, v146
  v_fmac_f32 v215, v247, v147
  v_fmac_f32 v224, v240, v132
  v_fmac_f32 v225, v241, v133
  v_fmac_f32 v226, v242, v134
  v_fmac_f32 v227, v243, v135
  v_fmac_f32 v228, v244, v148
  v_fmac_f32 v229, v245, v149
  v_fmac_f32 v230, v246, v150
  v_fmac_f32 v231, v247, v151
  v_fmac_f32 v216, v248, v160
  v_fmac_f32 v217, v249, v161
  v_fmac_f32 v218, v250, v162
  v_fmac_f32 v219, v251, v163
  v_fmac_f32 v220, v252, v176
  v_fmac_f32 v221, v253, v177
  v_fmac_f32 v222, v254, v178
  v_fmac_f32 v223, v255, v179
  v_fmac_f32 v232, v248, v164
  v_fmac_f32 v233, v249, v165
  v_fmac_f32 v234, v250, v166
  v_fmac_f32 v235, v251, v167
  v_fmac_f32 v236, v252, v180
  v_fmac_f32 v237, v253, v181
  v_fmac_f32 v238, v254, v182
  v_fmac_f32 v239, v255, v183
  s_cmp_eq_u32 s86, 1
  s_cbranch_scc1 XA17_adaLN_cond__sliding_local_dilated__swiglu_ffn__prompt_kernelx
  s_mov_b32 s82, 60000
XA17_adaLN_cond__sliding_local_dilated__swiglu_ffn__prompt_kernel:
  buffer_load_dword v36, v37, s[8:11], s81 offen sc1
  s_sub_u32 s82, s82, 1
  s_cmp_eq_u32 s82, 0
  s_waitcnt vmcnt(0)
  s_cbranch_scc1 XA17_adaLN_cond__sliding_local_dilated__swiglu_ffn__prompt_kernely
  v_cmp_ne_u32 vcc, s46, v36
  s_nop 4
  s_cbranch_vccnz XA17_adaLN_cond__sliding_local_dilated__swiglu_ffn__prompt_kernel
XA17_adaLN_cond__sliding_local_dilated__swiglu_ffn__prompt_kernely:
  s_xor_b32 s55, s85, 131072
  s_add_u32 s55, s55, 8192
  buffer_load_dwordx4 v[152:155], v1, s[8:11], s55 offen offset:0 sc1
  buffer_load_dwordx4 v[184:187], v1, s[8:11], s55 offen offset:1024 sc1
  buffer_load_dwordx4 v[156:159], v1, s[8:11], s55 offen offset:2048 sc1
  buffer_load_dwordx4 v[188:191], v1, s[8:11], s55 offen offset:3072 sc1
XA17_adaLN_cond__sliding_local_dilated__swiglu_ffn__prompt_kernelx:
  s_waitcnt vmcnt(3)
  v_mfma_f32_16x16x32_bf16 v[208:211], v[52:55], v[152:155], v[208:211]
  v_mfma_f32_16x16x32_bf16 v[212:215], v[54:57], v[152:155], v[212:215]
  s_waitcnt vmcnt(2)
  v_mfma_f32_16x16x32_bf16 v[216:219], v[58:61], v[184:187], v[216:219]
  v_mfma_f32_16x16x32_bf16 v[220:223], v[60:63], v[184:187], v[220:223]
  s_waitcnt vmcnt(1)
  v_mfma_f32_16x16x32_bf16 v[224:227], v[52:55], v[156:159], v[224:227]
  v_mfma_f32_16x16x32_bf16 v[228:231], v[54:57], v[156:159], v[228:231]
  s_waitcnt vmcnt(0)
  v_mfma_f32_16x16x32_bf16 v[232:235], v[58:61], v[188:191], v[232:235]
  v_mfma_f32_16x16x32_bf16 v[236:239], v[60:63], v[188:191], v[236:239]
  v_cvt_pk_bf16_f32 v192, v208, v209
  v_cvt_pk_bf16_f32 v193, v210, v211
  v_cvt_pk_bf16_f32 v194, v212, v213
  v_cvt_pk_bf16_f32 v195, v214, v215
  s_nop 0
  v_permlane16_swap_b32 v192, v194
  v_permlane16_swap_b32 v193, v195
  ds_write_b128 v42, v[192:195] offset:0
  v_cvt_pk_bf16_f32 v196, v216, v217
  v_cvt_pk_bf16_f32 v197, v218, v219
  v_cvt_pk_bf16_f32 v198, v220, v221
  v_cvt_pk_bf16_f32 v199, v222, v223
  s_nop 0
  v_permlane16_swap_b32 v196, v198
  v_permlane16_swap_b32 v197, v199
  ds_write_b128 v43, v[196:199] offset:0
  ds_read_b128 v[208:211], v44 offset:0
  ds_read_b128 v[212:215], v44 offset:1024
  v_cvt_pk_bf16_f32 v200, v224, v225
  v_cvt_pk_bf16_f32 v201, v226, v227
  v_cvt_pk_bf16_f32 v202, v228, v229
  v_cvt_pk_bf16_f32 v203, v230, v231
  s_nop 0
  v_permlane16_swap_b32 v200, v202
  v_permlane16_swap_b32 v201, v203
  ds_write_b128 v42, v[200:203] offset:2048
  v_cvt_pk_bf16_f32 v204, v232, v233
  v_cvt_pk_bf16_f32 v205, v234, v235
  v_cvt_pk_bf16_f32 v206, v236, v237
  v_cvt_pk_bf16_f32 v207, v238, v239
  s_nop 0
  v_permlane16_swap_b32 v204, v206
  v_permlane16_swap_b32 v205, v207
  ds_write_b128 v43, v[204:207] offset:2048
  ds_read_b128 v[224:227], v44 offset:2048
  ds_read_b128 v[228:231], v44 offset:3072
  s_waitcnt lgkmcnt(5)
  buffer_store_dwordx4 v[208:211], v40, s[40:43], s84 offen sc1
  s_add_u32 s84, s84, 16384
  s_waitcnt lgkmcnt(4)
  buffer_store_dwordx4 v[212:215], v40, s[40:43], s84 offen sc1
  s_add_u32 s84, s84, 16384
  s_waitcnt lgkmcnt(1)
  buffer_store_dwordx4 v[224:227], v40, s[40:43], s84 offen sc1
  s_add_u32 s84, s84, 16384
  s_waitcnt lgkmcnt(0)
  buffer_store_dwordx4 v[228:231], v40, s[40:43], s84 offen sc1
E_adaLN_cond__sliding_local_dilated__swiglu_ffn__prompt_kernel:
X_adaLN_cond__sliding_local_dilated__swiglu_ffn__prompt_kernel:
  s_endpgm
code_end:
.fill 2048, 4, 0xBF800000
.section .rodata,"a"
.p2align 6
.amdhsa_kernel adaLN_cond__sliding_local_dilated__swiglu_ffn__prompt_kernel
  .amdhsa_next_free_vgpr 512
  .amdhsa_next_free_sgpr 102
  .amdhsa_accum_offset 256
  .amdhsa_group_segment_fixed_size 0
  .amdhsa_kernarg_size 96
  .amdhsa_user_sgpr_count 2
  .amdhsa_user_sgpr_kernarg_segment_ptr 1
  .amdhsa_system_sgpr_workgroup_id_x 1
  .amdhsa_float_denorm_mode_32 3
.end_amdhsa_kernel
```

```asm
; @launch grid=(256,1,1) block=(256,1,1) lds=163840
.amdgcn_target "amdgcn-amd-amdhsa--gfx950"
.text
.globl adaLN_cond__sliding_local_dilated__swiglu_ffn__prompt_kernel
.type adaLN_cond__sliding_local_dilated__swiglu_ffn__prompt_kernel,@function
.p2align 8
adaLN_cond__sliding_local_dilated__swiglu_ffn__prompt_kernel:
  s_cmp_ge_u32 s2, 256
  s_cbranch_scc1 X_adaLN_cond__sliding_local_dilated__swiglu_ffn__prompt_kernel
  s_load_dwordx2 s[4:5], s[0:1], 0
  s_load_dwordx2 s[8:9], s[0:1], 88
  s_load_dwordx2 s[12:13], s[0:1], 8
  s_load_dwordx2 s[16:17], s[0:1], 16
  s_load_dwordx2 s[20:21], s[0:1], 64
  s_load_dwordx2 s[24:25], s[0:1], 56
  s_load_dwordx2 s[28:29], s[0:1], 32
  s_load_dwordx2 s[32:33], s[0:1], 40
  s_load_dwordx2 s[36:37], s[0:1], 48
  s_load_dwordx2 s[40:41], s[0:1], 72
  v_lshrrev_b32 v21, 6, v0
  v_and_b32 v0, 63, v0
  v_readfirstlane_b32 s44, v21
  v_lshrrev_b32 v22, 3, v0
  v_lshlrev_b32 v1, 4, v0
  s_lshr_b32 s83, s2, 3
  s_lshl_b32 s83, s83, 2
  s_add_u32 s83, s83, s44
  s_lshl_b32 s83, s83, 10
  s_getpc_b64 s[80:81]
CT1_adaLN_cond__sliding_local_dilated__swiglu_ffn__prompt_kernel:
  s_min_u32 s82, s83, code_end-CB0
  s_add_u32 s82, s82, CB0-CT1_adaLN_cond__sliding_local_dilated__swiglu_ffn__prompt_kernel
  s_add_u32 s80, s80, s82
  s_addc_u32 s81, s81, 0
  v_and_b32 v24, 0x70, v1
  v_lshlrev_b32 v24, 3, v24
  global_load_dword a253, v24, s[80:81]
  v_bfe_u32 v11, v22, 1, 2
  v_bfe_u32 v23, v0, 1, 2
  v_xor_b32 v11, v11, v23
  v_lshlrev_b32 v11, 5, v11
  v_and_b32 v23, 1, v0
  v_lshl_add_u32 v11, v23, 4, v11
  s_lshl_b32 s45, s44, 10
  s_lshl_b32 s52, s44, 3
  v_add_u32 v10, s52, v22
  s_and_b32 s52, s2, 7
  s_lshl_b32 s52, s52, 7
  v_add_u32 v35, s52, v10
  v_mul_u32_u24 v35, 12288, v35
  s_lshr_b32 s53, s2, 3
  s_lshl_b32 s53, s53, 7
  v_add3_u32 v35, v35, v11, s53
  s_and_b32 s53, s44, 1
  s_lshl_b32 s53, s53, 6
  s_add_u32 s52, s52, s53
  v_add_lshl_u32 v16, s52, v0, 1
  s_and_b32 s52, s2, 7
  s_lshr_b32 s53, s2, 3
  s_and_b32 s51, s52, 3
  s_lshl_b32 s51, s51, 2
  s_and_b32 s50, s53, 3
  s_add_u32 s51, s51, s50
  s_lshr_b32 s50, s52, 2
  s_lshl_b32 s50, s50, 3
  s_lshr_b32 s53, s53, 2
  s_add_u32 s50, s50, s53
  s_lshl_b32 s54, s50, 4
  s_add_u32 s54, s54, s51
  v_and_b32 v21, 7, v0
  v_lshlrev_b32 v28, 11, v21
  v_lshl_add_u32 v28, v22, 4, v28
  v_mov_b32 v29, 851968
  s_lshr_b32 s38, s54, 1
  s_lshl_b32 s38, s38, 15
  s_and_b32 s53, s54, 1
  s_lshl_b32 s53, s53, 2
  s_add_u32 s53, s53, s44
  s_lshl_b32 s52, s53, 8
  s_add_u32 s30, s38, s52
  s_mov_b32 s6, 4194304
  s_mov_b32 s7, 0x20000
  s_mov_b32 s10, 134217728
  s_mov_b32 s11, 0x20000
  s_mov_b32 s14, 6291456
  s_mov_b32 s15, 0x20000
  s_mov_b32 s18, 2097152
  s_mov_b32 s19, 0x20000
  s_mov_b32 s22, 12582912
  s_mov_b32 s23, 0x20000
  s_mov_b32 s26, 2048
  s_mov_b32 s27, 0x20000
  s_waitcnt lgkmcnt(0)
  buffer_load_ushort v15, v16, s[24:27], 0 offen
  s_add_u32 m0, s45, 131072
  s_mov_b32 s68, 0
  buffer_load_dwordx4 v35, s[20:23], s68 offen nt lds
  s_add_u32 m0, s45, 135168
  s_add_u32 s68, s68, 393216
  buffer_load_dwordx4 v35, s[20:23], s68 offen nt lds
  s_add_u32 m0, s45, 139264
  s_add_u32 s68, s68, 393216
  buffer_load_dwordx4 v35, s[20:23], s68 offen nt lds
  s_add_u32 m0, s45, 143360
  s_add_u32 s68, s68, 393216
  buffer_load_dwordx4 v35, s[20:23], s68 offen nt lds
  buffer_load_dword v36, v29, s[8:11], 0 offen sc1
  s_and_b32 s52, s2, 3
  s_lshl_b32 s52, s52, 2
  s_add_u32 s52, s52, s44
  s_lshl_b32 s52, s52, 7
  v_lshlrev_b32 v23, 1, v0
  buffer_load_ushort v23, v23, s[24:27], s52 offen
  s_add_u32 s52, s30, 0
  buffer_load_dwordx4 v[44:47], v28, s[4:7], s52 offen offset:0
  buffer_load_dwordx4 v[48:51], v28, s[4:7], s52 offen offset:128
  s_add_u32 s52, s30, 16384
  buffer_load_dwordx4 v[52:55], v28, s[4:7], s52 offen offset:0
  buffer_load_dwordx4 v[56:59], v28, s[4:7], s52 offen offset:128
  s_branch BODY0
.p2align 12
BODY0:
CB0:
  v_lshlrev_b32 v1, 4, v0
  v_add_u32 v2, 65536, v1
  v_add_u32 v13, 131072, v1
  s_and_b32 s66, s51, 0
  v_mul_u32_u24 v9, 6144, v10
  s_lshl_b32 s52, s51, 7
  v_add3_u32 v9, v9, v11, s52
  s_lshl_b32 s52, s53, 12
  s_add_u32 s38, s38, s52
  s_add_u32 s39, s38, 41943040
  s_add_u32 s38, s38, 1048576
  s_lshl_b32 s34, s53, 9
  s_add_u32 s34, s34, 131072
  s_lshl_b32 s35, s53, 11
  s_add_u32 s35, s35, 819200
  s_xor_b32 s30, s30, 1024
  s_add_u32 s52, s30, 0
  buffer_load_dwordx4 v[92:95], v28, s[4:7], s52 offen offset:0
  buffer_load_dwordx4 v[96:99], v28, s[4:7], s52 offen offset:128
  s_add_u32 s52, s30, 16384
  buffer_load_dwordx4 v[100:103], v28, s[4:7], s52 offen offset:0
  buffer_load_dwordx4 v[104:107], v28, s[4:7], s52 offen offset:128
  s_lshr_b32 s52, s2, 3
  s_mul_i32 s52, s52, 98304
  s_lshl_b32 s53, s44, 11
  s_add_u32 s52, s52, s53
  s_and_b32 s53, s2, 3
  s_lshl_b32 s53, s53, 9
  s_add_u32 s52, s52, s53
  s_add_u32 s52, s52, 0
  s_cmp_lt_u32 s44, 3
  s_cselect_b32 s52, s52, 1073741824
  v_lshrrev_b32 v43, 2, v0
  v_mul_u32_u24 v43, 5632, v43
  v_lshl_add_u32 v43, v0, 7, v43
  buffer_load_dword a252, v43, s[12:15], s52 offen
  v_lshrrev_b32 v41, 2, v0
  v_bfe_u32 v40, v41, 1, 2
  v_lshlrev_b32 v40, 5, v40
  v_lshl_add_u32 v40, v41, 7, v40
  v_and_b32 v41, 3, v0
  v_lshl_add_u32 v40, v41, 3, v40
  s_lshl_b32 s52, s44, 5
  v_xor_b32 v3, s52, v40
  s_and_b32 s52, s52, 64
  s_and_b32 s53, s44, 1
  s_lshl_b32 s53, s53, 14
  s_add_u32 s52, s52, s53
  v_xor_b32 v4, s52, v40
  v_xor_b32 v5, 32, v4
  v_add_u32 v6, 65536, v3
  v_add_u32 v7, 65536, v4
  v_add_u32 v8, 65536, v5
  v_add_u32 v35, 131072, v3
  v_lshrrev_b32 v30, 5, v0
  v_lshlrev_b32 v30, 6, v30
  v_bfe_u32 v40, v0, 2, 2
  v_lshl_add_u32 v30, v40, 4, v30
  v_bfe_u32 v40, v0, 4, 1
  v_lshl_add_u32 v30, v40, 3, v30
  v_lshl_add_u32 v30, v41, 1, v30
  s_lshl_b32 s52, s44, 7
  s_add_u32 s52, s52, 160768
  v_add_u32 v30, s52, v30
  v_lshrrev_b32 v32, 4, v0
  v_lshlrev_b32 v32, 4, v32
  v_add_u32 v31, 160768, v32
  v_and_b32 v40, 15, v0
  v_lshl_add_u32 v32, v40, 27, v32
  s_and_b32 s52, s2, 7
  s_lshl_b32 s52, s52, 13
  s_lshr_b32 s53, s2, 3
  s_lshl_b32 s53, s53, 8
  s_add_u32 s52, s52, s53
  s_lshl_b32 s53, s44, 6
  s_add_u32 s52, s52, s53
  s_add_u32 s42, s52, 131072
  s_lshl_b32 s53, s44, 28
  s_lshl_b32 s31, s2, 7
  s_add_u32 s31, s31, s53
  s_add_u32 s31, s31, 819200
  s_lshl_b32 s74, s54, 7
  s_add_u32 s74, s74, s53
  s_add_u32 s75, s74, 786432
  s_add_u32 s74, s74, 655360
  s_lshl_b32 s52, s50, 18
  s_add_u32 s52, s52, 1015808
  s_max_u32 s72, s52, 1048576
  s_lshr_b32 s53, s44, 1
  s_lshl_b32 s70, s53, 15
  s_add_u32 s52, s52, s70
  v_add_u32 v12, s52, v1
  s_lshl_b32 s53, s53, 11
  s_add_u32 s72, s72, s53
  s_lshl_b32 s70, s44, 12
  s_and_b32 s52, s70, 4096
  s_add_u32 s71, s52, s53
  s_and_b32 s52, s44, 1
  s_add_u32 s52, s52, s66
  s_add_u32 s58, s52, 0
  s_and_b32 s58, s58, 7
  s_lshl_b32 s58, s58, 12
  s_add_u32 s59, s52, 2
  s_and_b32 s59, s59, 7
  s_lshl_b32 s59, s59, 12
  s_add_u32 s60, s52, 4
  s_and_b32 s60, s60, 7
  s_lshl_b32 s60, s60, 12
  s_add_u32 s61, s52, 6
  s_and_b32 s61, s61, 7
  s_lshl_b32 s61, s61, 12
  s_lshl_b32 s52, s50, 4
  s_sub_u32 s52, s52, 2
  v_min_u32 v14, 17, v0
  v_add_u32 v14, s52, v14
  v_max_i32 v14, 0, v14
  v_lshlrev_b32 v14, 7, v14
  v_add_u32 v14, 786432, v14
  s_and_b32 s52, s2, 3
  s_lshl_b32 s52, s52, 8
  v_add_u32 v40, s52, v10
  v_mul_u32_u24 v40, 12288, v40
  s_lshr_b32 s53, s2, 2
  s_add_u32 s53, s53, 32
  s_lshl_b32 s53, s53, 7
  v_lshl_add_u32 v10, v10, 11, v11
  v_add3_u32 v11, v40, v11, s53
  s_and_b32 s52, s44, 1
  s_lshl_b32 s53, s50, 3
  s_add_u32 s53, s53, s52
  s_lshl_b32 s73, s53, 15
  s_lshl_b32 s53, s51, 1
  s_lshr_b32 s57, s44, 1
  s_add_u32 s53, s53, s57
  s_lshl_b32 s53, s53, 10
  s_add_u32 s73, s73, s53
  s_add_u32 s73, s73, 7340032
  s_mul_i32 s57, s57, 3072
  s_add_u32 s57, s57, 131072
  v_add_u32 v19, s57, v1
  s_lshl_b32 s53, s52, 3
  v_add_u32 v18, s53, v19
  s_lshl_b32 s53, s52, 10
  v_add_u32 v17, s53, v19
  v_lshrrev_b32 v40, 2, v0
  v_and_b32 v20, 3, v0
  v_lshl_add_u32 v40, v20, 4, v40
  v_lshl_add_u32 v20, v40, 4, s57
  s_mov_b32 s80, 0xfff0ffff
  s_mov_b32 s81, 0xf000ff00
  s_mov_b32 s82, 0xffe0fffe
  s_mov_b32 s83, 0xe000fe00
  s_mov_b32 s84, 0xffc0fffc
  s_mov_b32 s85, 0xc000fc00
  s_mov_b32 s86, 0xff80fff8
  s_mov_b32 s87, 0x8000f800
  s_mov_b32 s88, 0xaaaaaaaa
  s_mov_b32 s89, 0xaaaaaaaa
  s_mov_b32 s90, 0x000f0000
  s_mov_b32 s91, 0x0fff00ff
  s_mov_b32 s92, 0x003f0003
  s_mov_b32 s93, 0x3fff03ff
  v_mov_b32 v41, 0xffff
  v_mov_b32 v24, 0xffff0000
  v_cndmask_b32 v41, v41, v24, s[88:89]
  v_cndmask_b32 v24, 0, v41, s[90:91]
  v_cndmask_b32 v25, 0, v41, s[92:93]
  v_xor_b32 v26, v24, v41
  v_xor_b32 v27, v25, v41
  s_or_b32 s52, s52, s50
  s_cmp_eq_u32 s52, 0
  s_cselect_b64 s[90:91], s[90:91], 0
  s_cselect_b64 s[92:93], s[92:93], 0
  s_waitcnt vmcnt(15)
  v_lshlrev_b32 v15, 16, v15
  v_mul_f32 v16, 0xbfb8aa3b, v15
  v_exp_f32 v16, v16
  s_nop 0
  v_add_f32 v16, 1.0, v16
  v_rcp_f32 v16, v16
  s_nop 0
  v_mul_f32 v15, v15, v16
  v_cvt_pk_bf16_f32 v15, v15, v15
  ds_write_b16 v30, v15
  s_waitcnt vmcnt(11) lgkmcnt(0)
  s_barrier
  ds_read_b64_tr_b16 v[60:61], v35 offset:0
  ds_read_b64_tr_b16 v[62:63], v35 offset:2048
  ds_read_b128 v[76:79], v31 offset:0
  ds_read_b64_tr_b16 v[64:65], v35 offset:4096
  ds_read_b64_tr_b16 v[66:67], v35 offset:6144
  ds_read_b128 v[80:83], v31 offset:64
  ds_read_b64_tr_b16 v[68:69], v35 offset:8192
  ds_read_b64_tr_b16 v[70:71], v35 offset:10240
  ds_read_b128 v[84:87], v31 offset:128
  ds_read_b64_tr_b16 v[72:73], v35 offset:12288
  ds_read_b64_tr_b16 v[74:75], v35 offset:14336
  ds_read_b128 v[88:91], v31 offset:192
  s_waitcnt vmcnt(10)
  v_readfirstlane_b32 s46, v36
  s_nop 0
  s_add_u32 s46, s46, 8
  s_mul_i32 s52, s46, 0x13c6ef37
  v_mov_b32 v36, 0xff
  s_bfe_u32 s55, s52, 0x80000
  s_bfe_u32 s56, s52, 0x80008
  s_bfe_u32 s69, s52, 0x80010
  s_bfe_u32 s54, s52, 0x80018
  s_waitcnt lgkmcnt(9)
  v_mfma_f32_16x16x32_bf16 v[40:43], v[60:63], v[76:79], 0
  s_waitcnt lgkmcnt(6)
  v_mfma_f32_16x16x32_bf16 v[40:43], v[64:67], v[80:83], v[40:43]
  s_waitcnt lgkmcnt(3)
  v_mfma_f32_16x16x32_bf16 v[40:43], v[68:71], v[84:87], v[40:43]
  s_waitcnt lgkmcnt(0)
  v_mfma_f32_16x16x32_bf16 v[40:43], v[72:75], v[88:91], v[40:43]
  s_nop 7
  v_bfi_b32 v40, v36, s55, v40
  v_bfi_b32 v41, v36, s56, v41
  v_bfi_b32 v42, v36, s69, v42
  v_bfi_b32 v43, v36, s54, v43
  buffer_store_dwordx4 v[40:43], v32, s[8:11], s42 offen sc1
  s_lshr_b32 s52, s2, 3
  s_mul_i32 s52, s52, 98304
  s_lshl_b32 s53, s44, 11
  s_add_u32 s52, s52, s53
  s_and_b32 s53, s2, 3
  s_lshl_b32 s53, s53, 9
  s_add_u32 s52, s52, s53
  s_add_u32 s52, s52, 3145728
  s_cmp_lt_u32 s44, 3
  s_cselect_b32 s52, s52, 1073741824
  v_lshrrev_b32 v43, 2, v0
  v_mul_u32_u24 v43, 5632, v43
  v_lshl_add_u32 v43, v0, 7, v43
  buffer_load_dword a252, v43, s[12:15], s52 offen
  s_mov_b64 exec, 0
  s_cmp_eq_u32 s44, 0
  s_cbranch_scc1 HOP0
  s_cmp_eq_u32 s44, 1
  s_cbranch_scc1 HOP1
  s_cmp_eq_u32 s44, 2
  s_cbranch_scc1 HOP2
  s_cmp_eq_u32 s44, 3
  s_cbranch_scc1 HOP3
WRET0:
  s_mov_b64 exec, -1
  s_lshl_b32 s53, s44, 5
  v_lshlrev_b32 v31, 7, v21
  v_add_u32 v31, 159744, v31
  v_and_b32 v30, 8, v0
  v_lshl_add_u32 v30, v30, 1, v31
  v_add_u32 v30, s53, v30
  v_mov_b32 v108, 0x3f803f80
  v_mov_b32 v109, 0x3f803f80
  v_mov_b32 v110, 0x3f803f80
  v_mov_b32 v111, 0x3f803f80
  s_mov_b32 vcc_lo, 0xaaaaaaaa
  s_mov_b32 vcc_hi, 0xaaaaaaaa
  s_waitcnt vmcnt(7)
  v_mfma_f32_16x16x32_bf16 v[60:63], v[108:111], v[44:47], 0
  v_mfma_f32_16x16x32_bf16 v[64:67], v[44:47], v[44:47], 0
  v_mfma_f32_16x16x32_bf16 v[68:71], v[108:111], v[52:55], 0
  v_mfma_f32_16x16x32_bf16 v[72:75], v[52:55], v[52:55], 0
  v_mfma_f32_16x16x32_bf16 v[60:63], v[108:111], v[48:51], v[60:63]
  v_mfma_f32_16x16x32_bf16 v[64:67], v[48:51], v[48:51], v[64:67]
  v_mfma_f32_16x16x32_bf16 v[68:71], v[108:111], v[56:59], v[68:71]
  v_mfma_f32_16x16x32_bf16 v[72:75], v[56:59], v[56:59], v[72:75]
  s_waitcnt vmcnt(3)
  v_mfma_f32_16x16x32_bf16 v[60:63], v[108:111], v[92:95], v[60:63]
  v_mfma_f32_16x16x32_bf16 v[64:67], v[92:95], v[92:95], v[64:67]
  v_mfma_f32_16x16x32_bf16 v[68:71], v[108:111], v[100:103], v[68:71]
  v_mfma_f32_16x16x32_bf16 v[72:75], v[100:103], v[100:103], v[72:75]
  v_mfma_f32_16x16x32_bf16 v[60:63], v[108:111], v[96:99], v[60:63]
  v_mfma_f32_16x16x32_bf16 v[64:67], v[96:99], v[96:99], v[64:67]
  v_mfma_f32_16x16x32_bf16 v[68:71], v[108:111], v[104:107], v[68:71]
  v_mfma_f32_16x16x32_bf16 v[72:75], v[104:107], v[104:107], v[72:75]
  s_nop 4
  v_mov_b32 v36, v60
  v_cndmask_b32 v64, v64, v65, vcc
  v_cndmask_b32 v66, v66, v67, vcc
  v_mov_b32 v38, v68
  v_cndmask_b32 v72, v72, v73, vcc
  v_cndmask_b32 v74, v74, v75, vcc
  s_mov_b32 vcc_lo, 0xcccccccc
  s_mov_b32 vcc_hi, 0xcccccccc
  v_cndmask_b32 v37, v64, v66, vcc
  v_cndmask_b32 v39, v72, v74, vcc
  s_mov_b32 exec_lo, 0x00f0000f
  s_mov_b32 exec_hi, 0xf0000f00
  ds_write_b128 v30, v[36:39]
  s_mov_b64 exec, -1
  s_add_u32 m0, s45, 0
  s_add_u32 s68, s66, 0
  s_and_b32 s68, s68, 7
  s_mul_i32 s68, s68, 786432
  buffer_load_dwordx4 v9, s[12:15], s68 offen lds
  v_lshlrev_b32 v60, 16, v44
  v_and_b32 v61, 0xffff0000, v44
  v_lshlrev_b32 v62, 16, v45
  v_and_b32 v63, 0xffff0000, v45
  v_lshlrev_b32 v64, 16, v46
  v_and_b32 v65, 0xffff0000, v46
  v_lshlrev_b32 v66, 16, v47
  v_and_b32 v67, 0xffff0000, v47
  v_lshlrev_b32 v68, 16, v48
  v_and_b32 v69, 0xffff0000, v48
  v_lshlrev_b32 v70, 16, v49
  v_and_b32 v71, 0xffff0000, v49
  v_lshlrev_b32 v72, 16, v50
  s_add_u32 m0, s45, 4096
  s_add_u32 s68, s68, 196608
  buffer_load_dwordx4 v9, s[12:15], s68 offen lds
  v_and_b32 v73, 0xffff0000, v50
  v_lshlrev_b32 v74, 16, v51
  v_and_b32 v75, 0xffff0000, v51
  v_lshlrev_b32 v76, 16, v52
  v_and_b32 v77, 0xffff0000, v52
  v_lshlrev_b32 v78, 16, v53
  v_and_b32 v79, 0xffff0000, v53
  v_lshlrev_b32 v80, 16, v54
  v_and_b32 v81, 0xffff0000, v54
  v_lshlrev_b32 v82, 16, v55
  v_and_b32 v83, 0xffff0000, v55
  v_lshlrev_b32 v84, 16, v56
  s_add_u32 m0, s45, 8192
  s_add_u32 s68, s68, 196608
  buffer_load_dwordx4 v9, s[12:15], s68 offen lds
  v_and_b32 v85, 0xffff0000, v56
  v_lshlrev_b32 v86, 16, v57
  v_and_b32 v87, 0xffff0000, v57
  v_lshlrev_b32 v88, 16, v58
  v_and_b32 v89, 0xffff0000, v58
  v_lshlrev_b32 v90, 16, v59
  v_and_b32 v91, 0xffff0000, v59
  s_waitcnt lgkmcnt(0)
  s_barrier
  ds_read_b128 v[92:95], v31 offset:0
  ds_read_b128 v[96:99], v31 offset:16
  ds_read_b128 v[100:103], v31 offset:32
  s_add_u32 m0, s45, 12288
  s_add_u32 s68, s68, 196608
  buffer_load_dwordx4 v9, s[12:15], s68 offen lds
  ds_read_b128 v[104:107], v31 offset:48
  ds_read_b128 v[108:111], v31 offset:64
  ds_read_b128 v[112:115], v31 offset:80
  ds_read_b128 v[116:119], v31 offset:96
  ds_read_b128 v[120:123], v31 offset:112
  v_permlane16_swap_b32 v44, v46
  v_permlane16_swap_b32 v45, v47
  v_permlane16_swap_b32 v48, v50
  v_permlane16_swap_b32 v49, v51
  v_permlane16_swap_b32 v52, v54
  v_permlane16_swap_b32 v53, v55
  v_permlane16_swap_b32 v56, v58
  s_add_u32 m0, s45, 16384
  s_add_u32 s68, s66, 1
  s_and_b32 s68, s68, 7
  s_mul_i32 s68, s68, 786432
  buffer_load_dwordx4 v9, s[12:15], s68 offen lds
  v_permlane16_swap_b32 v57, v59
  v_bfe_u32 v36, v0, 3, 1
  v_lshlrev_b32 v28, 9, v36
  v_bfe_u32 v36, v0, 4, 1
  v_lshl_add_u32 v28, v36, 8, v28
  v_lshrrev_b32 v34, 5, v0
  v_lshl_add_u32 v28, v34, 10, v28
  v_lshl_add_u32 v28, v21, 4, v28
  v_and_b32 v29, 31, v0
  v_lshlrev_b32 v29, 4, v29
  v_lshl_add_u32 v29, v34, 12, v29
  v_cvt_f32_u32 v34, v34
  s_add_u32 m0, s45, 20480
  s_add_u32 s68, s68, 196608
  buffer_load_dwordx4 v9, s[12:15], s68 offen lds
  s_add_u32 s53, s45, 151552
  v_add_u32 v32, s53, v1
  v_lshl_add_u32 v33, v22, 5, s53
  v_lshlrev_b32 v36, 14, v36
  v_and_b32 v35, 15, v0
  v_lshl_add_u32 v35, v35, 7, v36
  s_waitcnt lgkmcnt(0)
  v_pk_add_f32 v[92:93], v[92:93], v[108:109]
  v_pk_add_f32 v[94:95], v[94:95], v[110:111]
  v_pk_add_f32 v[96:97], v[96:97], v[112:113]
  v_pk_add_f32 v[98:99], v[98:99], v[114:115]
  v_pk_add_f32 v[100:101], v[100:101], v[116:117]
  s_add_u32 m0, s45, 24576
  s_add_u32 s68, s68, 196608
  buffer_load_dwordx4 v9, s[12:15], s68 offen lds
  v_pk_add_f32 v[102:103], v[102:103], v[118:119]
  v_pk_add_f32 v[104:105], v[104:105], v[120:121]
  v_pk_add_f32 v[106:107], v[106:107], v[122:123]
  v_pk_add_f32 v[92:93], v[92:93], v[100:101]
  v_pk_add_f32 v[94:95], v[94:95], v[102:103]
  v_pk_add_f32 v[96:97], v[96:97], v[104:105]
  v_pk_add_f32 v[98:99], v[98:99], v[106:107]
  v_pk_add_f32 v[92:93], v[92:93], v[96:97]
  v_pk_add_f32 v[94:95], v[94:95], v[98:99]
  v_mul_f32 v92, 0x3a800000, v92
  v_mul_f32 v94, 0x3a800000, v94
  v_mul_f32 v93, 0x3a800000, v93
  v_mul_f32 v95, 0x3a800000, v95
  s_add_u32 m0, s45, 28672
  s_add_u32 s68, s68, 196608
  buffer_load_dwordx4 v9, s[12:15], s68 offen lds
  v_fma_f32 v93, -v92, v92, v93
  v_fma_f32 v95, -v94, v94, v95
  v_max_f32 v93, 0, v93
  v_max_f32 v95, 0, v95
  v_cvt_pk_bf16_f32 v93, v93, v93
  v_cvt_pk_bf16_f32 v95, v95, v95
  v_lshlrev_b32 v93, 16, v93
  v_lshlrev_b32 v95, 16, v95
  v_add_f32 v93, 0x3727c5ac, v93
  v_add_f32 v95, 0x3727c5ac, v95
  v_cvt_pk_bf16_f32 v93, v93, v93
  v_cvt_pk_bf16_f32 v95, v95, v95
  s_add_u32 m0, s45, 32768
  s_add_u32 s68, s66, 0
  s_and_b32 s68, s68, 7
  s_mul_i32 s68, s68, 786432
  s_add_u32 s68, s68, 2048
  buffer_load_dwordx4 v9, s[12:15], s68 offen lds
  v_lshlrev_b32 v93, 16, v93
  v_lshlrev_b32 v95, 16, v95
  v_sqrt_f32 v93, v93
  v_sqrt_f32 v95, v95
  v_cvt_pk_bf16_f32 v92, v92, v92
  v_cvt_pk_bf16_f32 v94, v94, v94
  v_lshlrev_b32 v92, 16, v92
  v_lshlrev_b32 v94, 16, v94
  v_cvt_pk_bf16_f32 v93, v93, v93
  v_cvt_pk_bf16_f32 v95, v95, v95
  v_lshlrev_b32 v93, 16, v93
  v_lshlrev_b32 v95, 16, v95
  s_add_u32 m0, s45, 36864
  s_add_u32 s68, s68, 196608
  buffer_load_dwordx4 v9, s[12:15], s68 offen lds
  v_rcp_f32 v93, v93
  v_rcp_f32 v95, v95
  v_mul_f32 v92, v92, v93
  v_mul_f32 v94, v94, v95
  v_fma_f32 v60, v60, v93, -v92
  v_fma_f32 v61, v61, v93, -v92
  v_fma_f32 v62, v62, v93, -v92
  v_fma_f32 v63, v63, v93, -v92
  v_fma_f32 v64, v64, v93, -v92
  v_fma_f32 v65, v65, v93, -v92
  v_fma_f32 v66, v66, v93, -v92
  v_fma_f32 v67, v67, v93, -v92
  s_add_u32 m0, s45, 40960
  s_add_u32 s68, s68, 196608
  buffer_load_dwordx4 v9, s[12:15], s68 offen lds
  v_fma_f32 v68, v68, v93, -v92
  v_fma_f32 v69, v69, v93, -v92
  v_fma_f32 v70, v70, v93, -v92
  v_fma_f32 v71, v71, v93, -v92
  v_fma_f32 v72, v72, v93, -v92
  v_fma_f32 v73, v73, v93, -v92
  v_fma_f32 v74, v74, v93, -v92
  v_fma_f32 v75, v75, v93, -v92
  v_fma_f32 v76, v76, v95, -v94
  v_fma_f32 v77, v77, v95, -v94
  v_fma_f32 v78, v78, v95, -v94
  v_fma_f32 v79, v79, v95, -v94
  s_add_u32 m0, s45, 45056
  s_add_u32 s68, s68, 196608
  buffer_load_dwordx4 v9, s[12:15], s68 offen lds
  v_fma_f32 v80, v80, v95, -v94
  v_fma_f32 v81, v81, v95, -v94
  v_fma_f32 v82, v82, v95, -v94
  v_fma_f32 v83, v83, v95, -v94
  v_fma_f32 v84, v84, v95, -v94
  v_fma_f32 v85, v85, v95, -v94
  v_fma_f32 v86, v86, v95, -v94
  v_fma_f32 v87, v87, v95, -v94
  v_fma_f32 v88, v88, v95, -v94
  v_fma_f32 v89, v89, v95, -v94
  v_fma_f32 v90, v90, v95, -v94
  v_fma_f32 v91, v91, v95, -v94
  s_add_u32 s52, s34, 0
  buffer_load_dwordx4 v[92:95], v29, s[8:11], s52 offen sc1
  s_add_u32 s52, s34, 8192
  buffer_load_dwordx4 v[96:99], v29, s[8:11], s52 offen sc1
  s_add_u32 s52, s34, 16384
  buffer_load_dwordx4 v[100:103], v29, s[8:11], s52 offen sc1
  s_add_u32 s52, s34, 24576
  buffer_load_dwordx4 v[104:107], v29, s[8:11], s52 offen sc1
  s_add_u32 s52, s34, 32768
  buffer_load_dwordx4 v[108:111], v29, s[8:11], s52 offen sc1
  s_add_u32 s52, s34, 40960
  buffer_load_dwordx4 v[112:115], v29, s[8:11], s52 offen sc1
  s_add_u32 s52, s34, 49152
  buffer_load_dwordx4 v[116:119], v29, s[8:11], s52 offen sc1
  s_add_u32 s52, s34, 57344
  buffer_load_dwordx4 v[120:123], v29, s[8:11], s52 offen sc1
  s_add_u32 m0, s45, 49152
  s_add_u32 s68, s66, 0
  s_and_b32 s68, s68, 7
  s_mul_i32 s68, s68, 786432
  s_add_u32 s68, s68, 4096
  buffer_load_dwordx4 v9, s[12:15], s68 offen lds
  s_bfe_u32 s53, s2, 0x30003
  s_lshl_b32 s43, s53, 1
  s_and_b32 s52, s2, 1
  s_add_u32 s43, s43, s52
  s_and_b32 s79, s2, 4
  s_lshr_b32 s52, s2, 6
  s_add_u32 s79, s79, s52
  s_add_u32 m0, s45, 53248
  s_add_u32 s68, s68, 196608
  buffer_load_dwordx4 v9, s[12:15], s68 offen lds
  s_lshl_b32 s79, s79, 1
  s_add_u32 s67, s79, s53
  s_bfe_u32 s52, s2, 0x10001
  s_add_u32 s79, s79, s52
  s_and_b32 s52, s44, 1
  s_add_u32 s52, s52, s67
  s_add_u32 s62, s52, 0
  s_add_u32 m0, s45, 57344
  s_add_u32 s68, s68, 196608
  buffer_load_dwordx4 v9, s[12:15], s68 offen lds
  s_and_b32 s62, s62, 7
  s_lshl_b32 s62, s62, 12
  s_add_u32 s63, s52, 2
  s_and_b32 s63, s63, 7
  s_lshl_b32 s63, s63, 12
  s_add_u32 s64, s52, 4
  s_and_b32 s64, s64, 7
  s_add_u32 m0, s45, 61440
  s_add_u32 s68, s68, 196608
  buffer_load_dwordx4 v9, s[12:15], s68 offen lds
  s_lshl_b32 s64, s64, 12
  s_add_u32 s65, s52, 6
  s_and_b32 s65, s65, 7
  s_lshl_b32 s65, s65, 12
  s_lshl_b32 s52, s43, 7
  v_add_u32 v10, s52, v10
  s_lshl_b32 s52, s79, 18
  s_add_u32 m0, s45, 65536
  s_add_u32 s68, s66, 1
  s_and_b32 s68, s68, 7
  s_mul_i32 s68, s68, 786432
  s_add_u32 s68, s68, 2048
  buffer_load_dwordx4 v9, s[12:15], s68 offen lds
  s_lshr_b32 s53, s44, 1
  s_lshl_b32 s53, s53, 15
  s_add_u32 s53, s52, s53
  s_add_u32 s78, s53, 7340032
  s_and_b32 s53, s44, 1
  s_lshl_b32 s53, s53, 15
  s_add_u32 s52, s52, s53
  s_add_u32 m0, s45, 69632
  s_add_u32 s68, s68, 196608
  buffer_load_dwordx4 v9, s[12:15], s68 offen lds
  s_lshl_b32 s53, s43, 1
  s_lshr_b32 s57, s44, 1
  s_add_u32 s53, s53, s57
  s_lshl_b32 s76, s53, 7
  s_lshl_b32 s53, s53, 10
  s_add_u32 s47, s52, s53
  s_lshr_b32 s53, s53, 1
  s_add_u32 m0, s45, 73728
  s_add_u32 s68, s68, 196608
  buffer_load_dwordx4 v9, s[12:15], s68 offen lds
  s_lshl_b32 s52, s79, 1
  s_and_b32 s57, s44, 1
  s_add_u32 s52, s52, s57
  s_lshl_b32 s52, s52, 14
  s_add_u32 s52, s52, s53
  s_add_u32 s48, s52, 6291456
  s_lshl_b32 s52, s79, 11
  s_add_u32 m0, s45, 77824
  s_add_u32 s68, s68, 196608
  buffer_load_dwordx4 v9, s[12:15], s68 offen lds
  s_lshl_b32 s53, s43, 7
  s_add_u32 s53, s53, s52
  s_lshl_b32 s57, s44, 28
  s_add_u32 s53, s53, s57
  s_add_u32 s49, s53, 753664
  s_add_u32 s77, s52, 655360
  s_mov_b32 s57, 20000
  s_branch MT2_adaLN_cond__sliding_local_dilated__swiglu_ffn__prompt_kernelt
MT2_adaLN_cond__sliding_local_dilated__swiglu_ffn__prompt_kernel:
  s_add_u32 s52, s34, 0
  buffer_load_dwordx4 v[92:95], v29, s[8:11], s52 offen sc1
  s_add_u32 s52, s34, 8192
  buffer_load_dwordx4 v[96:99], v29, s[8:11], s52 offen sc1
  s_add_u32 s52, s34, 16384
  buffer_load_dwordx4 v[100:103], v29, s[8:11], s52 offen sc1
  s_add_u32 s52, s34, 24576
  buffer_load_dwordx4 v[104:107], v29, s[8:11], s52 offen sc1
  s_add_u32 s52, s34, 32768
  buffer_load_dwordx4 v[108:111], v29, s[8:11], s52 offen sc1
  s_add_u32 s52, s34, 40960
  buffer_load_dwordx4 v[112:115], v29, s[8:11], s52 offen sc1
  s_add_u32 s52, s34, 49152
  buffer_load_dwordx4 v[116:119], v29, s[8:11], s52 offen sc1
  s_add_u32 s52, s34, 57344
  buffer_load_dwordx4 v[120:123], v29, s[8:11], s52 offen sc1
  s_waitcnt vmcnt(0)
MT2_adaLN_cond__sliding_local_dilated__swiglu_ffn__prompt_kernelt:
  s_waitcnt vmcnt(15)
  v_xor_b32 v92, s55, v92
  v_xor_b32 v93, s56, v93
  v_xor_b32 v94, s69, v94
  v_xor_b32 v95, s54, v95
  v_or3_b32 v36, v92, v93, 0
  v_or3_b32 v36, v94, v95, v36
  s_waitcnt vmcnt(14)
  v_xor_b32 v96, s55, v96
  v_xor_b32 v97, s56, v97
  v_xor_b32 v98, s69, v98
  v_xor_b32 v99, s54, v99
  v_or3_b32 v36, v96, v97, v36
  v_or3_b32 v36, v98, v99, v36
  s_waitcnt vmcnt(13)
  v_xor_b32 v100, s55, v100
  v_xor_b32 v101, s56, v101
  v_xor_b32 v102, s69, v102
  v_xor_b32 v103, s54, v103
  v_or3_b32 v36, v100, v101, v36
  v_or3_b32 v36, v102, v103, v36
  s_waitcnt vmcnt(12)
  v_xor_b32 v104, s55, v104
  v_xor_b32 v105, s56, v105
  v_xor_b32 v106, s69, v106
  v_xor_b32 v107, s54, v107
  v_or3_b32 v36, v104, v105, v36
  v_or3_b32 v36, v106, v107, v36
  s_waitcnt vmcnt(11)
  v_xor_b32 v108, s55, v108
  v_xor_b32 v109, s56, v109
  v_xor_b32 v110, s69, v110
  v_xor_b32 v111, s54, v111
  v_or3_b32 v36, v108, v109, v36
  v_or3_b32 v36, v110, v111, v36
  s_waitcnt vmcnt(10)
  v_xor_b32 v112, s55, v112
  v_xor_b32 v113, s56, v113
  v_xor_b32 v114, s69, v114
  v_xor_b32 v115, s54, v115
  v_or3_b32 v36, v112, v113, v36
  v_or3_b32 v36, v114, v115, v36
  s_waitcnt vmcnt(9)
  v_xor_b32 v116, s55, v116
  v_xor_b32 v117, s56, v117
  v_xor_b32 v118, s69, v118
  v_xor_b32 v119, s54, v119
  v_or3_b32 v36, v116, v117, v36
  v_or3_b32 v36, v118, v119, v36
  s_waitcnt vmcnt(8)
  v_xor_b32 v120, s55, v120
  v_xor_b32 v121, s56, v121
  v_xor_b32 v122, s69, v122
  v_xor_b32 v123, s54, v123
  v_or3_b32 v36, v120, v121, v36
  v_or3_b32 v36, v122, v123, v36
  v_and_b32 v36, 0xff, v36
  v_cmp_ne_u32 vcc, 0, v36
  s_sub_u32 s57, s57, 1
  s_cmp_eq_u32 s57, 0
  s_cbranch_scc1 MT2_adaLN_cond__sliding_local_dilated__swiglu_ffn__prompt_kernelx
  s_nop 1
  s_cbranch_vccnz MT2_adaLN_cond__sliding_local_dilated__swiglu_ffn__prompt_kernel
MT2_adaLN_cond__sliding_local_dilated__swiglu_ffn__prompt_kernelx:
  s_waitcnt vmcnt(14)
  v_pk_add_f32 v[92:93], v[92:93], v[96:97]
  v_pk_add_f32 v[94:95], v[94:95], v[98:99]
  s_waitcnt vmcnt(13)
  v_pk_add_f32 v[92:93], v[92:93], v[100:101]
  v_pk_add_f32 v[94:95], v[94:95], v[102:103]
  s_waitcnt vmcnt(12)
  v_pk_add_f32 v[92:93], v[92:93], v[104:105]
  v_pk_add_f32 v[94:95], v[94:95], v[106:107]
  s_waitcnt vmcnt(11)
  v_pk_add_f32 v[92:93], v[92:93], v[108:109]
HOP0:
  s_cbranch_execz HOP4
  v_pk_add_f32 v[94:95], v[94:95], v[110:111]
  s_waitcnt vmcnt(10)
  v_pk_add_f32 v[92:93], v[92:93], v[112:113]
  v_pk_add_f32 v[94:95], v[94:95], v[114:115]
  s_waitcnt vmcnt(9)
  v_pk_add_f32 v[92:93], v[92:93], v[116:117]
  v_pk_add_f32 v[94:95], v[94:95], v[118:119]
  s_waitcnt vmcnt(8)
  v_pk_add_f32 v[92:93], v[92:93], v[120:121]
  v_pk_add_f32 v[94:95], v[94:95], v[122:123]
  v_cvt_pk_bf16_f32 v96, v92, v93
  v_cvt_pk_bf16_f32 v97, v94, v95
  v_lshlrev_b32 v92, 16, v96
  v_and_b32 v93, 0xffff0000, v96
  v_lshlrev_b32 v94, 16, v97
  v_and_b32 v95, 0xffff0000, v97
  v_add_f32 v92, v34, v92
  v_add_f32 v93, v34, v93
  v_add_f32 v94, v34, v94
  v_add_f32 v95, v34, v95
  v_cvt_pk_bf16_f32 v96, v92, v93
  v_cvt_pk_bf16_f32 v97, v94, v95
  v_lshlrev_b32 v92, 16, v96
  v_and_b32 v93, 0xffff0000, v96
  v_lshlrev_b32 v94, 16, v97
  v_and_b32 v95, 0xffff0000, v97
  ds_write_b128 v32, v[92:95]
  ds_read_b128 v[92:95], v33 offset:512
  ds_read_b128 v[108:111], v33 offset:0
  ds_read_b128 v[96:99], v33 offset:528
  ds_read_b128 v[112:115], v33 offset:16
  ds_read_b128 v[100:103], v33 offset:768
  ds_read_b128 v[116:119], v33 offset:256
  ds_read_b128 v[104:107], v33 offset:784
  ds_read_b128 v[120:123], v33 offset:272
  s_waitcnt lgkmcnt(4)
  v_pk_fma_f32 v[60:61], v[60:61], v[92:93], v[108:109]
  v_pk_fma_f32 v[62:63], v[62:63], v[94:95], v[110:111]
  v_pk_fma_f32 v[64:65], v[64:65], v[96:97], v[112:113]
  v_pk_fma_f32 v[66:67], v[66:67], v[98:99], v[114:115]
  v_pk_fma_f32 v[76:77], v[76:77], v[92:93], v[108:109]
  v_pk_fma_f32 v[78:79], v[78:79], v[94:95], v[110:111]
  v_pk_fma_f32 v[80:81], v[80:81], v[96:97], v[112:113]
  v_pk_fma_f32 v[82:83], v[82:83], v[98:99], v[114:115]
  v_cvt_pk_bf16_f32 v60, v60, v61
  v_cvt_pk_bf16_f32 v61, v62, v63
  v_cvt_pk_bf16_f32 v62, v64, v65
  v_cvt_pk_bf16_f32 v63, v66, v67
  v_cvt_pk_bf16_f32 v76, v76, v77
  v_cvt_pk_bf16_f32 v77, v78, v79
  v_cvt_pk_bf16_f32 v78, v80, v81
  v_cvt_pk_bf16_f32 v79, v82, v83
  v_permlane16_swap_b32 v60, v62
  v_permlane16_swap_b32 v61, v63
  buffer_store_dwordx4 v[60:63], v28, s[8:11], s38 offen offset:0 sc1
  v_permlane16_swap_b32 v76, v78
  v_permlane16_swap_b32 v77, v79
  buffer_store_dwordx4 v[76:79], v28, s[8:11], s38 offen offset:128 sc1
  s_waitcnt lgkmcnt(0)
  v_pk_fma_f32 v[68:69], v[68:69], v[100:101], v[116:117]
  v_pk_fma_f32 v[70:71], v[70:71], v[102:103], v[118:119]
  v_pk_fma_f32 v[72:73], v[72:73], v[104:105], v[120:121]
  v_pk_fma_f32 v[74:75], v[74:75], v[106:107], v[122:123]
  v_pk_fma_f32 v[84:85], v[84:85], v[100:101], v[116:117]
  v_pk_fma_f32 v[86:87], v[86:87], v[102:103], v[118:119]
  v_pk_fma_f32 v[88:89], v[88:89], v[104:105], v[120:121]
  v_pk_fma_f32 v[90:91], v[90:91], v[106:107], v[122:123]
  v_cvt_pk_bf16_f32 v68, v68, v69
  v_cvt_pk_bf16_f32 v69, v70, v71
  v_cvt_pk_bf16_f32 v70, v72, v73
  v_cvt_pk_bf16_f32 v71, v74, v75
  v_cvt_pk_bf16_f32 v84, v84, v85
  v_cvt_pk_bf16_f32 v85, v86, v87
  v_cvt_pk_bf16_f32 v86, v88, v89
  v_cvt_pk_bf16_f32 v87, v90, v91
  v_permlane16_swap_b32 v68, v70
  v_permlane16_swap_b32 v69, v71
  buffer_store_dwordx4 v[68:71], v28, s[8:11], s38 offen offset:2048 sc1
  v_permlane16_swap_b32 v84, v86
  v_permlane16_swap_b32 v85, v87
  buffer_store_dwordx4 v[84:87], v28, s[8:11], s38 offen offset:2176 sc1
  buffer_store_dwordx4 v[44:47], v28, s[8:11], s39 offen offset:0 sc1
  buffer_store_dwordx4 v[48:51], v28, s[8:11], s39 offen offset:2048 sc1
  buffer_store_dwordx4 v[52:55], v28, s[8:11], s39 offen offset:128 sc1
  buffer_store_dwordx4 v[56:59], v28, s[8:11], s39 offen offset:2176 sc1
  s_add_u32 m0, s45, 81920
  s_add_u32 s68, s66, 1
  s_and_b32 s68, s68, 7
  s_mul_i32 s68, s68, 786432
  s_add_u32 s68, s68, 4096
  buffer_load_dwordx4 v9, s[12:15], s68 offen lds
  s_waitcnt vmcnt(48)
  v_lshlrev_b32 v15, 16, v23
  v_mul_f32 v16, 0xbfb8aa3b, v15
  v_exp_f32 v16, v16
  v_lshrrev_b32 v21, 5, v0
  s_add_u32 m0, s45, 86016
  s_add_u32 s68, s68, 196608
  buffer_load_dwordx4 v9, s[12:15], s68 offen lds
  v_add_f32 v16, 1.0, v16
  v_rcp_f32 v16, v16
  v_lshlrev_b32 v21, 6, v21
  v_mul_f32 v15, v15, v16
  v_cvt_pk_bf16_f32 v16, v15, v15
  s_add_u32 m0, s45, 90112
  s_add_u32 s68, s68, 196608
  buffer_load_dwordx4 v9, s[12:15], s68 offen lds
  v_bfe_u32 v15, v0, 2, 2
  v_lshl_add_u32 v21, v15, 4, v21
  v_bfe_u32 v15, v0, 4, 1
  v_lshl_add_u32 v21, v15, 3, v21
  v_and_b32 v15, 3, v0
  s_add_u32 m0, s45, 94208
  s_add_u32 s68, s68, 196608
  buffer_load_dwordx4 v9, s[12:15], s68 offen lds
  v_lshl_add_u32 v21, v15, 1, v21
  s_lshl_b32 s53, s44, 7
  s_add_u32 s53, s53, 160768
  v_add_u32 v21, s53, v21
  v_add_u32 v15, s46, v0
  s_waitcnt vmcnt(8)
  s_barrier
  s_mov_b64 exec, 1
  buffer_store_dword v15, v0, s[8:11], s75 offen offset:0 sc1
  s_mov_b64 exec, -1
  s_waitcnt vmcnt(33) lgkmcnt(0)
  s_barrier
  s_add_u32 m0, s45, 98304
  s_add_u32 s68, s66, 2
  s_and_b32 s68, s68, 7
  s_mul_i32 s68, s68, 786432
  buffer_load_dwordx4 v9, s[12:15], s68 offen lds
  ds_read_b64_tr_b16 a[0:1], v3 offset:0
  ds_read_b64_tr_b16 a[2:3], v3 offset:2048
  s_add_u32 m0, s45, 102400
  s_add_u32 s68, s68, 196608
  buffer_load_dwordx4 v9, s[12:15], s68 offen lds
  ds_read_b64_tr_b16 a[12:13], v3 offset:4096
  ds_read_b64_tr_b16 a[14:15], v3 offset:6144
  s_add_u32 m0, s45, 106496
  s_add_u32 s68, s68, 196608
  buffer_load_dwordx4 v9, s[12:15], s68 offen lds
  ds_read_b64_tr_b16 a[24:25], v3 offset:8192
  ds_read_b64_tr_b16 a[26:27], v3 offset:10240
  s_add_u32 m0, s45, 110592
  s_add_u32 s68, s68, 196608
  buffer_load_dwordx4 v9, s[12:15], s68 offen lds
  ds_read_b64_tr_b16 a[36:37], v3 offset:12288
  ds_read_b64_tr_b16 a[38:39], v3 offset:14336
  s_add_u32 m0, s45, 114688
  s_add_u32 s68, s66, 3
  s_and_b32 s68, s68, 7
  s_mul_i32 s68, s68, 786432
  buffer_load_dwordx4 v9, s[12:15], s68 offen lds
  ds_read_b64_tr_b16 a[48:49], v3 offset:16384
  ds_read_b64_tr_b16 a[50:51], v3 offset:18432
  s_add_u32 m0, s45, 118784
  s_add_u32 s68, s68, 196608
  buffer_load_dwordx4 v9, s[12:15], s68 offen lds
  ds_read_b64_tr_b16 a[60:61], v3 offset:20480
  ds_read_b64_tr_b16 a[62:63], v3 offset:22528
  s_add_u32 m0, s45, 122880
  s_add_u32 s68, s68, 196608
  buffer_load_dwordx4 v9, s[12:15], s68 offen lds
  ds_read_b64_tr_b16 a[72:73], v3 offset:24576
  ds_read_b64_tr_b16 a[74:75], v3 offset:26624
  s_add_u32 m0, s45, 126976
  s_add_u32 s68, s68, 196608
  buffer_load_dwordx4 v9, s[12:15], s68 offen lds
  ds_read_b64_tr_b16 a[84:85], v3 offset:28672
  ds_read_b64_tr_b16 a[86:87], v3 offset:30720
  s_waitcnt vmcnt(25) lgkmcnt(0)
  s_barrier
  s_add_u32 m0, s45, 0
  s_add_u32 s68, s66, 2
  s_and_b32 s68, s68, 7
  s_mul_i32 s68, s68, 786432
  s_add_u32 s68, s68, 2048
  buffer_load_dwordx4 v9, s[12:15], s68 offen lds
  ds_read_b64_tr_b16 a[4:5], v4 offset:32768
  ds_read_b64_tr_b16 a[6:7], v4 offset:34816
  s_add_u32 m0, s45, 4096
  s_add_u32 s68, s68, 196608
  buffer_load_dwordx4 v9, s[12:15], s68 offen lds
  ds_read_b64_tr_b16 a[8:9], v5 offset:32768
  ds_read_b64_tr_b16 a[10:11], v5 offset:34816
  s_add_u32 m0, s45, 8192
  s_add_u32 s68, s68, 196608
  buffer_load_dwordx4 v9, s[12:15], s68 offen lds
  ds_read_b64_tr_b16 a[16:17], v4 offset:36864
  ds_read_b64_tr_b16 a[18:19], v4 offset:38912
  s_add_u32 m0, s45, 12288
  s_add_u32 s68, s68, 196608
  buffer_load_dwordx4 v9, s[12:15], s68 offen lds
  ds_read_b64_tr_b16 a[20:21], v5 offset:36864
  ds_read_b64_tr_b16 a[22:23], v5 offset:38912
  s_add_u32 m0, s45, 16384
  s_add_u32 s68, s66, 2
  s_and_b32 s68, s68, 7
  s_mul_i32 s68, s68, 786432
  s_add_u32 s68, s68, 4096
  buffer_load_dwordx4 v9, s[12:15], s68 offen lds
  ds_read_b64_tr_b16 a[28:29], v4 offset:40960
  ds_read_b64_tr_b16 a[30:31], v4 offset:43008
  s_add_u32 m0, s45, 20480
  s_add_u32 s68, s68, 196608
  buffer_load_dwordx4 v9, s[12:15], s68 offen lds
  ds_read_b64_tr_b16 a[32:33], v5 offset:40960
  ds_read_b64_tr_b16 a[34:35], v5 offset:43008
  s_add_u32 m0, s45, 24576
  s_add_u32 s68, s68, 196608
  buffer_load_dwordx4 v9, s[12:15], s68 offen lds
  ds_read_b64_tr_b16 a[40:41], v4 offset:45056
  ds_read_b64_tr_b16 a[42:43], v4 offset:47104
  s_add_u32 m0, s45, 28672
  s_add_u32 s68, s68, 196608
  buffer_load_dwordx4 v9, s[12:15], s68 offen lds
  ds_read_b64_tr_b16 a[44:45], v5 offset:45056
  ds_read_b64_tr_b16 a[46:47], v5 offset:47104
  s_waitcnt vmcnt(17) lgkmcnt(0)
  s_barrier
  s_add_u32 m0, s45, 32768
  s_add_u32 s68, s66, 3
  s_and_b32 s68, s68, 7
  s_mul_i32 s68, s68, 786432
  s_add_u32 s68, s68, 2048
  buffer_load_dwordx4 v9, s[12:15], s68 offen lds
  ds_read_b64_tr_b16 a[52:53], v7 offset:0
  ds_read_b64_tr_b16 a[54:55], v7 offset:2048
  s_add_u32 m0, s45, 36864
  s_add_u32 s68, s68, 196608
  buffer_load_dwordx4 v9, s[12:15], s68 offen lds
  ds_read_b64_tr_b16 a[56:57], v8 offset:0
  ds_read_b64_tr_b16 a[58:59], v8 offset:2048
  s_add_u32 m0, s45, 40960
  s_add_u32 s68, s68, 196608
  buffer_load_dwordx4 v9, s[12:15], s68 offen lds
  ds_read_b64_tr_b16 a[64:65], v7 offset:4096
  ds_read_b64_tr_b16 a[66:67], v7 offset:6144
  s_add_u32 m0, s45, 45056
  s_add_u32 s68, s68, 196608
  buffer_load_dwordx4 v9, s[12:15], s68 offen lds
  ds_read_b64_tr_b16 a[68:69], v8 offset:4096
  ds_read_b64_tr_b16 a[70:71], v8 offset:6144
  s_add_u32 m0, s45, 49152
  s_add_u32 s68, s66, 3
  s_and_b32 s68, s68, 7
  s_mul_i32 s68, s68, 786432
  s_add_u32 s68, s68, 4096
  buffer_load_dwordx4 v9, s[12:15], s68 offen lds
  ds_read_b64_tr_b16 a[76:77], v7 offset:8192
  ds_read_b64_tr_b16 a[78:79], v7 offset:10240
  s_add_u32 m0, s45, 53248
  s_add_u32 s68, s68, 196608
  buffer_load_dwordx4 v9, s[12:15], s68 offen lds
  ds_read_b64_tr_b16 a[80:81], v8 offset:8192
  ds_read_b64_tr_b16 a[82:83], v8 offset:10240
  s_add_u32 m0, s45, 57344
  s_add_u32 s68, s68, 196608
  buffer_load_dwordx4 v9, s[12:15], s68 offen lds
  ds_read_b64_tr_b16 a[88:89], v7 offset:12288
  ds_read_b64_tr_b16 a[90:91], v7 offset:14336
  s_add_u32 m0, s45, 61440
  s_add_u32 s68, s68, 196608
  buffer_load_dwordx4 v9, s[12:15], s68 offen lds
  ds_read_b64_tr_b16 a[92:93], v8 offset:12288
  ds_read_b64_tr_b16 a[94:95], v8 offset:14336
  s_lshl_b32 s57, s44, 28
  buffer_load_dword v36, v14, s[8:11], s57 offen sc1
  s_waitcnt vmcnt(17) lgkmcnt(0)
  s_barrier
  s_add_u32 m0, s45, 65536
  s_add_u32 s68, s66, 4
  s_and_b32 s68, s68, 7
  s_mul_i32 s68, s68, 786432
  buffer_load_dwordx4 v9, s[12:15], s68 offen lds
  ds_read_b64_tr_b16 a[96:97], v6 offset:32768
  ds_read_b64_tr_b16 a[98:99], v6 offset:34816
  s_add_u32 m0, s45, 69632
  s_add_u32 s68, s68, 196608
  buffer_load_dwordx4 v9, s[12:15], s68 offen lds
  ds_read_b64_tr_b16 a[108:109], v6 offset:36864
  ds_read_b64_tr_b16 a[110:111], v6 offset:38912
  s_add_u32 m0, s45, 73728
  s_add_u32 s68, s68, 196608
  buffer_load_dwordx4 v9, s[12:15], s68 offen lds
  ds_read_b64_tr_b16 a[120:121], v6 offset:40960
  ds_read_b64_tr_b16 a[122:123], v6 offset:43008
  s_add_u32 m0, s45, 77824
  s_add_u32 s68, s68, 196608
  buffer_load_dwordx4 v9, s[12:15], s68 offen lds
  ds_read_b64_tr_b16 a[132:133], v6 offset:45056
  ds_read_b64_tr_b16 a[134:135], v6 offset:47104
  s_add_u32 m0, s45, 81920
  s_add_u32 s68, s66, 5
  s_and_b32 s68, s68, 7
  s_mul_i32 s68, s68, 786432
  buffer_load_dwordx4 v9, s[12:15], s68 offen lds
  ds_read_b64_tr_b16 a[144:145], v6 offset:49152
  ds_read_b64_tr_b16 a[146:147], v6 offset:51200
  s_add_u32 m0, s45, 86016
  s_add_u32 s68, s68, 196608
  buffer_load_dwordx4 v9, s[12:15], s68 offen lds
  ds_read_b64_tr_b16 a[156:157], v6 offset:53248
  ds_read_b64_tr_b16 a[158:159], v6 offset:55296
  s_add_u32 m0, s45, 90112
  s_add_u32 s68, s68, 196608
  buffer_load_dwordx4 v9, s[12:15], s68 offen lds
  ds_read_b64_tr_b16 a[168:169], v6 offset:57344
  ds_read_b64_tr_b16 a[170:171], v6 offset:59392
  s_add_u32 m0, s45, 94208
  s_add_u32 s68, s68, 196608
  buffer_load_dwordx4 v9, s[12:15], s68 offen lds
  ds_read_b64_tr_b16 a[180:181], v6 offset:61440
  ds_read_b64_tr_b16 a[182:183], v6 offset:63488
  s_waitcnt vmcnt(17) lgkmcnt(0)
  s_barrier
  ds_read_b64_tr_b16 a[100:101], v4 offset:0
  ds_read_b64_tr_b16 a[102:103], v4 offset:2048
  ds_read_b64_tr_b16 a[104:105], v5 offset:0
  ds_read_b64_tr_b16 a[106:107], v5 offset:2048
  ds_read_b64_tr_b16 a[112:113], v4 offset:4096
  ds_read_b64_tr_b16 a[114:115], v4 offset:6144
  ds_read_b64_tr_b16 a[116:117], v5 offset:4096
  ds_read_b64_tr_b16 a[118:119], v5 offset:6144
  ds_read_b64_tr_b16 a[124:125], v4 offset:8192
  ds_read_b64_tr_b16 a[126:127], v4 offset:10240
  ds_read_b64_tr_b16 a[128:129], v5 offset:8192
  ds_read_b64_tr_b16 a[130:131], v5 offset:10240
  ds_read_b64_tr_b16 a[136:137], v4 offset:12288
  ds_read_b64_tr_b16 a[138:139], v4 offset:14336
  ds_read_b64_tr_b16 a[140:141], v5 offset:12288
  ds_read_b64_tr_b16 a[142:143], v5 offset:14336
  s_waitcnt vmcnt(8)
  s_cmp_lg_u32 s44, 0
  s_cbranch_scc1 PL3_adaLN_cond__sliding_local_dilated__swiglu_ffn__prompt_kernelx
  v_cmp_ne_u32 vcc, s46, v36
  s_nop 4
  s_cbranch_vccz PL3_adaLN_cond__sliding_local_dilated__swiglu_ffn__prompt_kernelx
  s_mov_b32 s57, 60000
PL3_adaLN_cond__sliding_local_dilated__swiglu_ffn__prompt_kernel:
  buffer_load_dword v36, v14, s[8:11], 0 offen sc1
  s_sub_u32 s57, s57, 1
  s_cmp_eq_u32 s57, 0
  s_waitcnt vmcnt(0)
  s_cbranch_scc1 PL3_adaLN_cond__sliding_local_dilated__swiglu_ffn__prompt_kernelx
  v_cmp_ne_u32 vcc, s46, v36
  s_nop 4
  s_cbranch_vccnz PL3_adaLN_cond__sliding_local_dilated__swiglu_ffn__prompt_kernel
PL3_adaLN_cond__sliding_local_dilated__swiglu_ffn__prompt_kernelx:
  s_barrier
  s_add_u32 m0, s70, 98304
  s_add_u32 s69, s58, 32768
  buffer_load_dwordx4 v12, s[8:11], s69 offen offset:0 sc1 lds
  buffer_load_dwordx4 v12, s[8:11], s69 offen offset:1024 sc1 lds
  buffer_load_dwordx4 v12, s[8:11], s69 offen offset:2048 sc1 lds
  buffer_load_dwordx4 v12, s[8:11], s69 offen offset:3072 sc1 lds
  s_add_u32 m0, s71, 131072
  s_add_u32 s69, s58, s72
  buffer_load_dwordx4 v1, s[8:11], s69 offen offset:0 sc1 lds
  buffer_load_dwordx4 v1, s[8:11], s69 offen offset:1024 sc1 lds
  s_add_u32 m0, s70, 114688
  s_add_u32 s69, s59, 32768
  buffer_load_dwordx4 v12, s[8:11], s69 offen offset:0 sc1 lds
  buffer_load_dwordx4 v12, s[8:11], s69 offen offset:1024 sc1 lds
  buffer_load_dwordx4 v12, s[8:11], s69 offen offset:2048 sc1 lds
  buffer_load_dwordx4 v12, s[8:11], s69 offen offset:3072 sc1 lds
  s_add_u32 m0, s71, 139264
  s_add_u32 s69, s59, s72
  buffer_load_dwordx4 v1, s[8:11], s69 offen offset:0 sc1 lds
  buffer_load_dwordx4 v1, s[8:11], s69 offen offset:1024 sc1 lds
  s_waitcnt vmcnt(21) lgkmcnt(0)
  s_barrier
  s_add_u32 m0, s45, 0
  s_add_u32 s68, s66, 4
  s_and_b32 s68, s68, 7
  s_mul_i32 s68, s68, 786432
  s_add_u32 s68, s68, 2048
  buffer_load_dwordx4 v9, s[12:15], s68 offen lds
  ds_read_b64_tr_b16 a[148:149], v4 offset:32768
  ds_read_b64_tr_b16 a[150:151], v4 offset:34816
  s_add_u32 m0, s45, 4096
  s_add_u32 s68, s68, 196608
  buffer_load_dwordx4 v9, s[12:15], s68 offen lds
  ds_read_b64_tr_b16 a[152:153], v5 offset:32768
  ds_read_b64_tr_b16 a[154:155], v5 offset:34816
  s_add_u32 m0, s45, 8192
  s_add_u32 s68, s68, 196608
  buffer_load_dwordx4 v9, s[12:15], s68 offen lds
  ds_read_b64_tr_b16 a[160:161], v4 offset:36864
  ds_read_b64_tr_b16 a[162:163], v4 offset:38912
  s_add_u32 m0, s45, 12288
  s_add_u32 s68, s68, 196608
  buffer_load_dwordx4 v9, s[12:15], s68 offen lds
  ds_read_b64_tr_b16 a[164:165], v5 offset:36864
  ds_read_b64_tr_b16 a[166:167], v5 offset:38912
  s_add_u32 m0, s45, 16384
  s_add_u32 s68, s66, 4
  s_and_b32 s68, s68, 7
  s_mul_i32 s68, s68, 786432
  s_add_u32 s68, s68, 4096
  buffer_load_dwordx4 v9, s[12:15], s68 offen lds
  ds_read_b64_tr_b16 a[172:173], v4 offset:40960
  ds_read_b64_tr_b16 a[174:175], v4 offset:43008
  s_add_u32 m0, s45, 20480
  s_add_u32 s68, s68, 196608
  buffer_load_dwordx4 v9, s[12:15], s68 offen lds
  ds_read_b64_tr_b16 a[176:177], v5 offset:40960
  ds_read_b64_tr_b16 a[178:179], v5 offset:43008
  s_add_u32 m0, s45, 24576
  s_add_u32 s68, s68, 196608
  buffer_load_dwordx4 v9, s[12:15], s68 offen lds
  ds_read_b64_tr_b16 a[184:185], v4 offset:45056
  ds_read_b64_tr_b16 a[186:187], v4 offset:47104
  s_add_u32 m0, s45, 28672
  s_add_u32 s68, s68, 196608
  buffer_load_dwordx4 v9, s[12:15], s68 offen lds
  ds_read_b64_tr_b16 a[188:189], v5 offset:45056
  ds_read_b64_tr_b16 a[190:191], v5 offset:47104
  s_waitcnt vmcnt(14) lgkmcnt(0)
  s_barrier
  ds_read_b128 v[76:79], v2 offset:32768
  ds_read_b128 v[80:83], v2 offset:33792
  ds_read_b128 v[84:87], v2 offset:40960
  ds_read_b128 v[88:91], v2 offset:41984
  ds_read_b128 v[92:95], v13 offset:0
  ds_read_b128 v[96:99], v13 offset:1024
  ds_read_b128 v[100:103], v2 offset:34816
  ds_read_b128 v[104:107], v2 offset:35840
  s_waitcnt lgkmcnt(2)
  v_mfma_f32_16x16x32_bf16 v[28:31], a[0:3], v[76:79], 0
  ds_read_b64_tr_b16 a[192:193], v6 offset:0
  s_add_u32 m0, s45, 32768
  s_add_u32 s68, s66, 5
  s_and_b32 s68, s68, 7
  s_mul_i32 s68, s68, 786432
  s_add_u32 s68, s68, 2048
  v_mfma_f32_16x16x32_bf16 v[28:31], a[12:15], v[80:83], v[28:31]
  ds_read_b128 v[108:111], v2 offset:43008
  buffer_load_dwordx4 v9, s[12:15], s68 offen lds
  v_mfma_f32_16x16x32_bf16 v[32:35], a[12:15], v[88:91], 0
  ds_read_b64_tr_b16 a[194:195], v6 offset:2048
  v_mfma_f32_16x16x32_bf16 v[32:35], a[0:3], v[84:87], v[32:35]
  ds_read_b64_tr_b16 a[204:205], v6 offset:4096
  v_mfma_f32_16x16x32_bf16 v[40:43], a[4:7], v[84:87], 0
  ds_read_b128 v[112:115], v2 offset:44032
  s_add_u32 m0, s45, 36864
  s_add_u32 s68, s68, 196608
  v_mfma_f32_16x16x32_bf16 v[40:43], a[16:19], v[88:91], v[40:43]
  ds_read_b64_tr_b16 a[206:207], v6 offset:6144
  buffer_load_dwordx4 v9, s[12:15], s68 offen lds
  v_mfma_f32_16x16x32_bf16 v[36:39], a[16:19], v[80:83], 0
  ds_read_b128 v[116:119], v13 offset:2048
  v_mfma_f32_16x16x32_bf16 v[36:39], a[4:7], v[76:79], v[36:39]
  ds_read_b64_tr_b16 a[216:217], v6 offset:8192
  v_mfma_f32_16x16x32_bf16 v[44:47], a[8:11], v[76:79], 0
  ds_read_b64_tr_b16 a[218:219], v6 offset:10240
  s_add_u32 m0, s45, 40960
  s_add_u32 s68, s68, 196608
  v_mfma_f32_16x16x32_bf16 v[44:47], a[20:23], v[80:83], v[44:47]
  ds_read_b128 v[120:123], v13 offset:3072
  buffer_load_dwordx4 v9, s[12:15], s68 offen lds
  v_mfma_f32_16x16x32_bf16 v[48:51], a[20:23], v[88:91], 0
  ds_read_b64_tr_b16 a[228:229], v6 offset:12288
  v_mfma_f32_16x16x32_bf16 v[48:51], a[8:11], v[84:87], v[48:51]
  ds_read_b64_tr_b16 a[230:231], v6 offset:14336
  v_mfma_f32_16x16x32_bf16 v[68:71], a[8:11], v[92:95], 0
  ds_read_b128 v[76:79], v2 offset:36864
  s_add_u32 m0, s45, 45056
  s_add_u32 s68, s68, 196608
  v_mfma_f32_16x16x32_bf16 v[68:71], a[20:23], v[96:99], v[68:71]
  ds_read_b64_tr_b16 a[240:241], v6 offset:16384
  buffer_load_dwordx4 v9, s[12:15], s68 offen lds
  v_mfma_f32_16x16x32_bf16 v[60:63], a[16:19], v[96:99], 0
  ds_read_b128 v[80:83], v2 offset:37888
  v_mfma_f32_16x16x32_bf16 v[60:63], a[4:7], v[92:95], v[60:63]
  s_waitcnt lgkmcnt(5)
  ds_read_b64_tr_b16 a[242:243], v6 offset:18432
  v_mfma_f32_16x16x32_bf16 v[28:31], a[24:27], v[100:103], v[28:31]
  ds_read_b64_tr_b16 v[124:125], v6 offset:20480
  s_add_u32 m0, s45, 49152
  s_add_u32 s68, s66, 5
  s_and_b32 s68, s68, 7
  s_mul_i32 s68, s68, 786432
  s_add_u32 s68, s68, 4096
  v_mfma_f32_16x16x32_bf16 v[28:31], a[36:39], v[104:107], v[28:31]
  ds_read_b128 v[88:91], v2 offset:45056
  buffer_load_dwordx4 v9, s[12:15], s68 offen lds
  v_mfma_f32_16x16x32_bf16 v[32:35], a[36:39], v[112:115], v[32:35]
  ds_read_b64_tr_b16 v[126:127], v6 offset:22528
  v_mfma_f32_16x16x32_bf16 v[32:35], a[24:27], v[108:111], v[32:35]
  ds_read_b64_tr_b16 v[136:137], v6 offset:24576
  v_mfma_f32_16x16x32_bf16 v[40:43], a[28:31], v[108:111], v[40:43]
  ds_read_b128 v[84:87], v2 offset:46080
  s_add_u32 m0, s45, 53248
  s_add_u32 s68, s68, 196608
  v_mfma_f32_16x16x32_bf16 v[40:43], a[40:43], v[112:115], v[40:43]
  ds_read_b64_tr_b16 v[138:139], v6 offset:26624
  buffer_load_dwordx4 v9, s[12:15], s68 offen lds
  v_mfma_f32_16x16x32_bf16 v[36:39], a[40:43], v[104:107], v[36:39]
  ds_read_b128 v[96:99], v13 offset:4096
  v_mfma_f32_16x16x32_bf16 v[36:39], a[28:31], v[100:103], v[36:39]
  ds_read_b64_tr_b16 v[148:149], v6 offset:28672
  v_mfma_f32_16x16x32_bf16 v[44:47], a[32:35], v[100:103], v[44:47]
  ds_read_b64_tr_b16 v[150:151], v6 offset:30720
  v_mfma_f32_16x16x32_bf16 v[44:47], a[44:47], v[104:107], v[44:47]
  ds_read_b128 v[92:95], v13 offset:5120
  s_add_u32 m0, s45, 57344
  s_add_u32 s68, s68, 196608
  v_mfma_f32_16x16x32_bf16 v[48:51], a[44:47], v[112:115], v[48:51]
  buffer_load_dwordx4 v9, s[12:15], s68 offen lds
  v_mfma_f32_16x16x32_bf16 v[48:51], a[32:35], v[108:111], v[48:51]
  s_add_u32 m0, s45, 61440
  s_add_u32 s68, s68, 196608
  v_mfma_f32_16x16x32_bf16 v[68:71], a[32:35], v[116:119], v[68:71]
  ds_read_b128 v[100:103], v2 offset:38912
  v_mfma_f32_16x16x32_bf16 v[68:71], a[44:47], v[120:123], v[68:71]
  buffer_load_dwordx4 v9, s[12:15], s68 offen lds
  v_mfma_f32_16x16x32_bf16 v[60:63], a[40:43], v[120:123], v[60:63]
  ds_read_b128 v[104:107], v2 offset:39936
  v_mfma_f32_16x16x32_bf16 v[60:63], a[28:31], v[116:119], v[60:63]
  s_waitcnt lgkmcnt(2)
  v_mfma_f32_16x16x32_bf16 v[28:31], a[48:51], v[76:79], v[28:31]
  s_add_u32 m0, s71, 147456
  s_add_u32 s69, s60, s72
  v_mfma_f32_16x16x32_bf16 v[28:31], a[60:63], v[80:83], v[28:31]
  ds_read_b128 v[112:115], v2 offset:47104
  v_mfma_f32_16x16x32_bf16 v[32:35], a[60:63], v[84:87], v[32:35]
  buffer_load_dwordx4 v1, s[8:11], s69 offen offset:0 sc1 lds
  v_mfma_f32_16x16x32_bf16 v[32:35], a[48:51], v[88:91], v[32:35]
  v_mfma_f32_16x16x32_bf16 v[40:43], a[52:55], v[88:91], v[40:43]
  ds_read_b128 v[108:111], v2 offset:48128
  v_mfma_f32_16x16x32_bf16 v[40:43], a[64:67], v[84:87], v[40:43]
  buffer_load_dwordx4 v1, s[8:11], s69 offen offset:1024 sc1 lds
  v_mfma_f32_16x16x32_bf16 v[36:39], a[64:67], v[80:83], v[36:39]
  ds_read_b128 v[120:123], v13 offset:6144
  v_mfma_f32_16x16x32_bf16 v[36:39], a[52:55], v[76:79], v[36:39]
  v_mfma_f32_16x16x32_bf16 v[44:47], a[56:59], v[76:79], v[44:47]
  s_add_u32 m0, s71, 155648
  s_add_u32 s69, s61, s72
  v_mfma_f32_16x16x32_bf16 v[44:47], a[68:71], v[80:83], v[44:47]
  ds_read_b128 v[116:119], v13 offset:7168
  v_mfma_f32_16x16x32_bf16 v[48:51], a[68:71], v[84:87], v[48:51]
  buffer_load_dwordx4 v1, s[8:11], s69 offen offset:0 sc1 lds
  v_mfma_f32_16x16x32_bf16 v[48:51], a[56:59], v[88:91], v[48:51]
  s_waitcnt vmcnt(11) lgkmcnt(7)
  s_barrier
  v_mfma_f32_16x16x32_bf16 v[68:71], a[56:59], v[96:99], v[68:71]
  ds_read_b128 v[76:79], v2 offset:49152
  v_mfma_f32_16x16x32_bf16 v[68:71], a[68:71], v[92:95], v[68:71]
  ds_read_b64_tr_b16 a[196:197], v4 offset:0
  buffer_load_dwordx4 v1, s[8:11], s69 offen offset:1024 sc1 lds
  v_mfma_f32_16x16x32_bf16 v[60:63], a[64:67], v[92:95], v[60:63]
  ds_read_b128 v[80:83], v2 offset:50176
  v_mfma_f32_16x16x32_bf16 v[60:63], a[52:55], v[96:99], v[60:63]
  s_waitcnt lgkmcnt(3)
  ds_read_b64_tr_b16 a[198:199], v4 offset:2048
  v_mfma_f32_16x16x32_bf16 v[28:31], a[72:75], v[100:103], v[28:31]
  ds_read_b64_tr_b16 a[200:201], v5 offset:0
  s_add_u32 m0, s70, 65536
  s_add_u32 s69, s60, 32768
  v_mfma_f32_16x16x32_bf16 v[28:31], a[84:87], v[104:107], v[28:31]
  ds_read_b128 v[84:87], v2 offset:57344
  buffer_load_dwordx4 v12, s[8:11], s69 offen offset:0 sc1 lds
  v_mfma_f32_16x16x32_bf16 v[32:35], a[84:87], v[108:111], v[32:35]
  ds_read_b64_tr_b16 a[202:203], v5 offset:2048
HOP1:
  s_cbranch_execz HOP5
  v_mfma_f32_16x16x32_bf16 v[32:35], a[72:75], v[112:115], v[32:35]
  ds_read_b64_tr_b16 a[208:209], v4 offset:4096
  v_mfma_f32_16x16x32_bf16 v[40:43], a[76:79], v[112:115], v[40:43]
  ds_read_b128 v[88:91], v2 offset:58368
  v_mfma_f32_16x16x32_bf16 v[40:43], a[88:91], v[108:111], v[40:43]
  ds_read_b64_tr_b16 a[210:211], v4 offset:6144
  buffer_load_dwordx4 v12, s[8:11], s69 offen offset:1024 sc1 lds
  v_mfma_f32_16x16x32_bf16 v[36:39], a[88:91], v[104:107], v[36:39]
  ds_read_b128 v[92:95], v13 offset:8192
  v_mfma_f32_16x16x32_bf16 v[36:39], a[76:79], v[100:103], v[36:39]
  ds_read_b64_tr_b16 a[212:213], v5 offset:4096
  v_mfma_f32_16x16x32_bf16 v[44:47], a[80:83], v[100:103], v[44:47]
  ds_read_b64_tr_b16 a[214:215], v5 offset:6144
  v_mfma_f32_16x16x32_bf16 v[44:47], a[92:95], v[104:107], v[44:47]
  ds_read_b128 v[96:99], v13 offset:9216
  buffer_load_dwordx4 v12, s[8:11], s69 offen offset:2048 sc1 lds
  v_mfma_f32_16x16x32_bf16 v[48:51], a[92:95], v[108:111], v[48:51]
  ds_read_b64_tr_b16 a[220:221], v4 offset:8192
  v_mfma_f32_16x16x32_bf16 v[48:51], a[80:83], v[112:115], v[48:51]
  ds_read_b64_tr_b16 a[222:223], v4 offset:10240
  v_mfma_f32_16x16x32_bf16 v[68:71], a[80:83], v[120:123], v[68:71]
  ds_read_b128 v[100:103], v2 offset:51200
  v_mfma_f32_16x16x32_bf16 v[68:71], a[92:95], v[116:119], v[68:71]
  ds_read_b64_tr_b16 a[224:225], v5 offset:8192
  buffer_load_dwordx4 v12, s[8:11], s69 offen offset:3072 sc1 lds
  v_mfma_f32_16x16x32_bf16 v[60:63], a[88:91], v[116:119], v[60:63]
  ds_read_b128 v[104:107], v2 offset:52224
  v_mfma_f32_16x16x32_bf16 v[60:63], a[76:79], v[120:123], v[60:63]
  s_waitcnt lgkmcnt(5)
  ds_read_b64_tr_b16 a[226:227], v5 offset:10240
  v_mfma_f32_16x16x32_bf16 v[28:31], a[96:99], v[76:79], v[28:31]
  ds_read_b64_tr_b16 a[232:233], v4 offset:12288
  s_add_u32 m0, s45, 81920
  s_add_u32 s68, s66, 6
  s_and_b32 s68, s68, 7
  s_mul_i32 s68, s68, 786432
  v_mfma_f32_16x16x32_bf16 v[28:31], a[108:111], v[80:83], v[28:31]
  ds_read_b128 v[108:111], v2 offset:59392
  buffer_load_dwordx4 v9, s[12:15], s68 offen lds
  v_mfma_f32_16x16x32_bf16 v[32:35], a[108:111], v[88:91], v[32:35]
  ds_read_b64_tr_b16 a[234:235], v4 offset:14336
  v_mfma_f32_16x16x32_bf16 v[32:35], a[96:99], v[84:87], v[32:35]
  ds_read_b64_tr_b16 a[236:237], v5 offset:12288
  v_mfma_f32_16x16x32_bf16 v[40:43], a[100:103], v[84:87], v[40:43]
  ds_read_b128 v[112:115], v2 offset:60416
  s_add_u32 m0, s45, 86016
  s_add_u32 s68, s68, 196608
  v_mfma_f32_16x16x32_bf16 v[40:43], a[112:115], v[88:91], v[40:43]
  ds_read_b64_tr_b16 a[238:239], v5 offset:14336
  buffer_load_dwordx4 v9, s[12:15], s68 offen lds
  v_mfma_f32_16x16x32_bf16 v[36:39], a[112:115], v[80:83], v[36:39]
  ds_read_b128 v[116:119], v13 offset:10240
  v_mfma_f32_16x16x32_bf16 v[36:39], a[100:103], v[76:79], v[36:39]
  v_mfma_f32_16x16x32_bf16 v[44:47], a[104:107], v[76:79], v[44:47]
  s_add_u32 m0, s45, 90112
  s_add_u32 s68, s68, 196608
  v_mfma_f32_16x16x32_bf16 v[44:47], a[116:119], v[80:83], v[44:47]
  ds_read_b128 v[120:123], v13 offset:11264
  v_mfma_f32_16x16x32_bf16 v[48:51], a[116:119], v[88:91], v[48:51]
  buffer_load_dwordx4 v9, s[12:15], s68 offen lds
  v_mfma_f32_16x16x32_bf16 v[48:51], a[104:107], v[84:87], v[48:51]
  s_waitcnt vmcnt(11) lgkmcnt(2)
  s_barrier
  v_mfma_f32_16x16x32_bf16 v[68:71], a[104:107], v[92:95], v[68:71]
  ds_read_b128 v[76:79], v2 offset:53248
  s_add_u32 m0, s45, 94208
  s_add_u32 s68, s68, 196608
  v_mfma_f32_16x16x32_bf16 v[68:71], a[116:119], v[96:99], v[68:71]
  ds_read_b64_tr_b16 a[244:245], v4 offset:32768
  buffer_load_dwordx4 v9, s[12:15], s68 offen lds
  v_mfma_f32_16x16x32_bf16 v[60:63], a[112:115], v[96:99], v[60:63]
  ds_read_b128 v[80:83], v2 offset:54272
  v_mfma_f32_16x16x32_bf16 v[60:63], a[100:103], v[92:95], v[60:63]
  s_waitcnt lgkmcnt(3)
  ds_read_b64_tr_b16 a[246:247], v4 offset:34816
  v_mfma_f32_16x16x32_bf16 v[28:31], a[120:123], v[100:103], v[28:31]
  ds_read_b64_tr_b16 a[248:249], v5 offset:32768
  s_add_u32 m0, s45, 98304
  s_add_u32 s68, s66, 7
  s_and_b32 s68, s68, 7
  s_mul_i32 s68, s68, 786432
  v_mfma_f32_16x16x32_bf16 v[28:31], a[132:135], v[104:107], v[28:31]
  ds_read_b128 v[88:91], v2 offset:61440
  buffer_load_dwordx4 v9, s[12:15], s68 offen lds
  v_mfma_f32_16x16x32_bf16 v[32:35], a[132:135], v[112:115], v[32:35]
  ds_read_b64_tr_b16 a[250:251], v5 offset:34816
  v_mfma_f32_16x16x32_bf16 v[32:35], a[120:123], v[108:111], v[32:35]
  ds_read_b64_tr_b16 v[128:129], v4 offset:36864
  v_mfma_f32_16x16x32_bf16 v[40:43], a[124:127], v[108:111], v[40:43]
  ds_read_b128 v[84:87], v2 offset:62464
  s_add_u32 m0, s45, 102400
  s_add_u32 s68, s68, 196608
  v_mfma_f32_16x16x32_bf16 v[40:43], a[136:139], v[112:115], v[40:43]
  ds_read_b64_tr_b16 v[130:131], v4 offset:38912
  buffer_load_dwordx4 v9, s[12:15], s68 offen lds
  v_mfma_f32_16x16x32_bf16 v[36:39], a[136:139], v[104:107], v[36:39]
  ds_read_b128 v[96:99], v13 offset:12288
  v_mfma_f32_16x16x32_bf16 v[36:39], a[124:127], v[100:103], v[36:39]
  ds_read_b64_tr_b16 v[132:133], v5 offset:36864
  v_mfma_f32_16x16x32_bf16 v[44:47], a[128:131], v[100:103], v[44:47]
  ds_read_b64_tr_b16 v[134:135], v5 offset:38912
  s_add_u32 m0, s45, 106496
  s_add_u32 s68, s68, 196608
  v_mfma_f32_16x16x32_bf16 v[44:47], a[140:143], v[104:107], v[44:47]
  ds_read_b128 v[92:95], v13 offset:13312
  buffer_load_dwordx4 v9, s[12:15], s68 offen lds
  v_mfma_f32_16x16x32_bf16 v[48:51], a[140:143], v[112:115], v[48:51]
  ds_read_b64_tr_b16 v[140:141], v4 offset:40960
  v_mfma_f32_16x16x32_bf16 v[48:51], a[128:131], v[108:111], v[48:51]
  ds_read_b64_tr_b16 v[142:143], v4 offset:43008
  v_mfma_f32_16x16x32_bf16 v[68:71], a[128:131], v[116:119], v[68:71]
  ds_read_b128 v[100:103], v2 offset:55296
  s_add_u32 m0, s45, 110592
  s_add_u32 s68, s68, 196608
  v_mfma_f32_16x16x32_bf16 v[68:71], a[140:143], v[120:123], v[68:71]
  ds_read_b64_tr_b16 v[144:145], v5 offset:40960
  buffer_load_dwordx4 v9, s[12:15], s68 offen lds
  v_mfma_f32_16x16x32_bf16 v[60:63], a[136:139], v[120:123], v[60:63]
  ds_read_b128 v[104:107], v2 offset:56320
  v_mfma_f32_16x16x32_bf16 v[60:63], a[124:127], v[116:119], v[60:63]
  s_waitcnt lgkmcnt(5)
  ds_read_b64_tr_b16 v[146:147], v5 offset:43008
  v_mfma_f32_16x16x32_bf16 v[28:31], a[144:147], v[76:79], v[28:31]
  ds_read_b64_tr_b16 v[152:153], v4 offset:45056
  s_add_u32 m0, s45, 0
  s_add_u32 s68, s66, 6
  s_and_b32 s68, s68, 7
  s_mul_i32 s68, s68, 786432
  s_add_u32 s68, s68, 2048
  v_mfma_f32_16x16x32_bf16 v[28:31], a[156:159], v[80:83], v[28:31]
  ds_read_b128 v[112:115], v2 offset:63488
  buffer_load_dwordx4 v9, s[12:15], s68 offen lds
  v_mfma_f32_16x16x32_bf16 v[32:35], a[156:159], v[84:87], v[32:35]
  ds_read_b64_tr_b16 v[154:155], v4 offset:47104
  v_mfma_f32_16x16x32_bf16 v[32:35], a[144:147], v[88:91], v[32:35]
  ds_read_b64_tr_b16 v[156:157], v5 offset:45056
  v_mfma_f32_16x16x32_bf16 v[40:43], a[148:151], v[88:91], v[40:43]
  ds_read_b128 v[108:111], v2 offset:64512
  s_add_u32 m0, s45, 4096
  s_add_u32 s68, s68, 196608
  v_mfma_f32_16x16x32_bf16 v[40:43], a[160:163], v[84:87], v[40:43]
  ds_read_b64_tr_b16 v[158:159], v5 offset:47104
  buffer_load_dwordx4 v9, s[12:15], s68 offen lds
  v_mfma_f32_16x16x32_bf16 v[36:39], a[160:163], v[80:83], v[36:39]
  ds_read_b128 v[120:123], v13 offset:14336
  v_mfma_f32_16x16x32_bf16 v[36:39], a[148:151], v[76:79], v[36:39]
  v_mfma_f32_16x16x32_bf16 v[44:47], a[152:155], v[76:79], v[44:47]
  s_add_u32 m0, s45, 8192
  s_add_u32 s68, s68, 196608
  v_mfma_f32_16x16x32_bf16 v[44:47], a[164:167], v[80:83], v[44:47]
  ds_read_b128 v[116:119], v13 offset:15360
  v_mfma_f32_16x16x32_bf16 v[48:51], a[164:167], v[84:87], v[48:51]
  buffer_load_dwordx4 v9, s[12:15], s68 offen lds
  v_mfma_f32_16x16x32_bf16 v[48:51], a[152:155], v[88:91], v[48:51]
  s_waitcnt vmcnt(3) lgkmcnt(2)
  s_barrier
  v_mfma_f32_16x16x32_bf16 v[68:71], a[152:155], v[96:99], v[68:71]
  ds_read_b128 v[76:79], v2 offset:0
  s_add_u32 m0, s45, 12288
  s_add_u32 s68, s68, 196608
  v_mfma_f32_16x16x32_bf16 v[68:71], a[164:167], v[92:95], v[68:71]
  ds_read_b64_tr_b16 v[160:161], v6 offset:16384
  buffer_load_dwordx4 v9, s[12:15], s68 offen lds
  v_mfma_f32_16x16x32_bf16 v[60:63], a[160:163], v[92:95], v[60:63]
  ds_read_b128 v[80:83], v2 offset:1024
  v_mfma_f32_16x16x32_bf16 v[60:63], a[148:151], v[96:99], v[60:63]
  s_waitcnt lgkmcnt(3)
  ds_read_b64_tr_b16 v[162:163], v6 offset:18432
  v_mfma_f32_16x16x32_bf16 v[28:31], a[168:171], v[100:103], v[28:31]
  ds_read_b64_tr_b16 v[172:173], v6 offset:20480
  s_add_u32 m0, s45, 16384
  s_add_u32 s68, s66, 6
  s_and_b32 s68, s68, 7
  s_mul_i32 s68, s68, 786432
  s_add_u32 s68, s68, 4096
  v_mfma_f32_16x16x32_bf16 v[28:31], a[180:183], v[104:107], v[28:31]
  ds_read_b128 v[84:87], v2 offset:8192
  buffer_load_dwordx4 v9, s[12:15], s68 offen lds
  v_mfma_f32_16x16x32_bf16 v[32:35], a[180:183], v[108:111], v[32:35]
  ds_read_b64_tr_b16 v[174:175], v6 offset:22528
  v_mfma_f32_16x16x32_bf16 v[32:35], a[168:171], v[112:115], v[32:35]
  ds_read_b64_tr_b16 v[184:185], v6 offset:24576
  v_mfma_f32_16x16x32_bf16 v[40:43], a[172:175], v[112:115], v[40:43]
  ds_read_b128 v[88:91], v2 offset:9216
  s_add_u32 m0, s45, 20480
  s_add_u32 s68, s68, 196608
  v_mfma_f32_16x16x32_bf16 v[40:43], a[184:187], v[108:111], v[40:43]
  ds_read_b64_tr_b16 v[186:187], v6 offset:26624
  buffer_load_dwordx4 v9, s[12:15], s68 offen lds
  v_mfma_f32_16x16x32_bf16 v[36:39], a[184:187], v[104:107], v[36:39]
  ds_read_b128 v[92:95], v13 offset:16384
  v_mfma_f32_16x16x32_bf16 v[36:39], a[172:175], v[100:103], v[36:39]
  ds_read_b64_tr_b16 v[196:197], v6 offset:28672
  v_mfma_f32_16x16x32_bf16 v[44:47], a[176:179], v[100:103], v[44:47]
  ds_read_b64_tr_b16 v[198:199], v6 offset:30720
  s_add_u32 m0, s45, 24576
  s_add_u32 s68, s68, 196608
  v_mfma_f32_16x16x32_bf16 v[44:47], a[188:191], v[104:107], v[44:47]
  ds_read_b128 v[96:99], v13 offset:17408
  buffer_load_dwordx4 v9, s[12:15], s68 offen lds
  v_mfma_f32_16x16x32_bf16 v[48:51], a[188:191], v[108:111], v[48:51]
  ds_read_b64_tr_b16 v[208:209], v6 offset:32768
  v_mfma_f32_16x16x32_bf16 v[48:51], a[176:179], v[112:115], v[48:51]
  ds_read_b64_tr_b16 v[210:211], v6 offset:34816
  v_mfma_f32_16x16x32_bf16 v[68:71], a[176:179], v[120:123], v[68:71]
  ds_read_b128 v[100:103], v2 offset:2048
  s_add_u32 m0, s45, 28672
  s_add_u32 s68, s68, 196608
  v_mfma_f32_16x16x32_bf16 v[68:71], a[188:191], v[116:119], v[68:71]
  ds_read_b64_tr_b16 v[220:221], v6 offset:36864
  buffer_load_dwordx4 v9, s[12:15], s68 offen lds
  v_mfma_f32_16x16x32_bf16 v[60:63], a[184:187], v[116:119], v[60:63]
  ds_read_b128 v[104:107], v2 offset:3072
  v_mfma_f32_16x16x32_bf16 v[60:63], a[172:175], v[120:123], v[60:63]
  s_waitcnt lgkmcnt(5)
  ds_read_b64_tr_b16 v[222:223], v6 offset:38912
  v_mfma_f32_16x16x32_bf16 v[28:31], a[192:195], v[76:79], v[28:31]
  ds_read_b64_tr_b16 v[232:233], v6 offset:40960
  s_add_u32 m0, s70, 32768
  s_add_u32 s69, s61, 32768
  v_mfma_f32_16x16x32_bf16 v[28:31], a[204:207], v[80:83], v[28:31]
  ds_read_b128 v[108:111], v2 offset:10240
  buffer_load_dwordx4 v12, s[8:11], s69 offen offset:0 sc1 lds
  v_mfma_f32_16x16x32_bf16 v[32:35], a[204:207], v[88:91], v[32:35]
  ds_read_b64_tr_b16 v[234:235], v6 offset:43008
  v_mfma_f32_16x16x32_bf16 v[32:35], a[192:195], v[84:87], v[32:35]
  ds_read_b64_tr_b16 v[244:245], v6 offset:45056
  v_mfma_f32_16x16x32_bf16 v[40:43], a[196:199], v[84:87], v[40:43]
  ds_read_b128 v[112:115], v2 offset:11264
  v_mfma_f32_16x16x32_bf16 v[40:43], a[208:211], v[88:91], v[40:43]
  ds_read_b64_tr_b16 v[246:247], v6 offset:47104
  buffer_load_dwordx4 v12, s[8:11], s69 offen offset:1024 sc1 lds
  v_mfma_f32_16x16x32_bf16 v[36:39], a[208:211], v[80:83], v[36:39]
  ds_read_b128 v[116:119], v13 offset:18432
  v_mfma_f32_16x16x32_bf16 v[36:39], a[196:199], v[76:79], v[36:39]
  v_mfma_f32_16x16x32_bf16 v[44:47], a[200:203], v[76:79], v[44:47]
  v_mfma_f32_16x16x32_bf16 v[44:47], a[212:215], v[80:83], v[44:47]
  ds_read_b128 v[120:123], v13 offset:19456
  v_mfma_f32_16x16x32_bf16 v[48:51], a[212:215], v[88:91], v[48:51]
  buffer_load_dwordx4 v12, s[8:11], s69 offen offset:2048 sc1 lds
  v_mfma_f32_16x16x32_bf16 v[48:51], a[200:203], v[84:87], v[48:51]
  s_waitcnt vmcnt(3) lgkmcnt(2)
  s_barrier
  v_mfma_f32_16x16x32_bf16 v[68:71], a[200:203], v[92:95], v[68:71]
  ds_read_b128 v[76:79], v2 offset:4096
  v_mfma_f32_16x16x32_bf16 v[68:71], a[212:215], v[96:99], v[68:71]
  ds_read_b64_tr_b16 v[164:165], v4 offset:0
  buffer_load_dwordx4 v12, s[8:11], s69 offen offset:3072 sc1 lds
  v_mfma_f32_16x16x32_bf16 v[60:63], a[208:211], v[96:99], v[60:63]
  ds_read_b128 v[80:83], v2 offset:5120
  v_mfma_f32_16x16x32_bf16 v[60:63], a[196:199], v[92:95], v[60:63]
  s_waitcnt lgkmcnt(3)
  ds_read_b64_tr_b16 v[166:167], v4 offset:2048
  v_mfma_f32_16x16x32_bf16 v[28:31], a[216:219], v[100:103], v[28:31]
  ds_read_b64_tr_b16 v[168:169], v5 offset:0
  s_add_u32 m0, s45, 81920
  s_add_u32 s68, s66, 7
  s_and_b32 s68, s68, 7
  s_mul_i32 s68, s68, 786432
  s_add_u32 s68, s68, 2048
  v_mfma_f32_16x16x32_bf16 v[28:31], a[228:231], v[104:107], v[28:31]
  ds_read_b128 v[88:91], v2 offset:12288
  buffer_load_dwordx4 v9, s[12:15], s68 offen lds
  v_mfma_f32_16x16x32_bf16 v[32:35], a[228:231], v[112:115], v[32:35]
  ds_read_b64_tr_b16 v[170:171], v5 offset:2048
  v_mfma_f32_16x16x32_bf16 v[32:35], a[216:219], v[108:111], v[32:35]
  ds_read_b64_tr_b16 v[176:177], v4 offset:4096
  v_mfma_f32_16x16x32_bf16 v[40:43], a[220:223], v[108:111], v[40:43]
  ds_read_b128 v[84:87], v2 offset:13312
  s_add_u32 m0, s45, 86016
  s_add_u32 s68, s68, 196608
  v_mfma_f32_16x16x32_bf16 v[40:43], a[232:235], v[112:115], v[40:43]
  ds_read_b64_tr_b16 v[178:179], v4 offset:6144
  buffer_load_dwordx4 v9, s[12:15], s68 offen lds
  v_mfma_f32_16x16x32_bf16 v[36:39], a[232:235], v[104:107], v[36:39]
  ds_read_b128 v[96:99], v13 offset:20480
  v_mfma_f32_16x16x32_bf16 v[36:39], a[220:223], v[100:103], v[36:39]
  ds_read_b64_tr_b16 v[180:181], v5 offset:4096
  v_mfma_f32_16x16x32_bf16 v[44:47], a[224:227], v[100:103], v[44:47]
  ds_read_b64_tr_b16 v[182:183], v5 offset:6144
  s_add_u32 m0, s45, 90112
  s_add_u32 s68, s68, 196608
  v_mfma_f32_16x16x32_bf16 v[44:47], a[236:239], v[104:107], v[44:47]
  ds_read_b128 v[92:95], v13 offset:21504
  buffer_load_dwordx4 v9, s[12:15], s68 offen lds
  v_mfma_f32_16x16x32_bf16 v[48:51], a[236:239], v[112:115], v[48:51]
  ds_read_b64_tr_b16 v[188:189], v4 offset:8192
  v_mfma_f32_16x16x32_bf16 v[48:51], a[224:227], v[108:111], v[48:51]
  ds_read_b64_tr_b16 v[190:191], v4 offset:10240
  v_mfma_f32_16x16x32_bf16 v[68:71], a[224:227], v[116:119], v[68:71]
  ds_read_b128 v[100:103], v2 offset:6144
  s_add_u32 m0, s45, 94208
  s_add_u32 s68, s68, 196608
  v_mfma_f32_16x16x32_bf16 v[68:71], a[236:239], v[120:123], v[68:71]
  ds_read_b64_tr_b16 v[192:193], v5 offset:8192
  buffer_load_dwordx4 v9, s[12:15], s68 offen lds
  v_mfma_f32_16x16x32_bf16 v[60:63], a[232:235], v[120:123], v[60:63]
  ds_read_b128 v[104:107], v2 offset:7168
  v_mfma_f32_16x16x32_bf16 v[60:63], a[220:223], v[116:119], v[60:63]
  s_waitcnt lgkmcnt(5)
  ds_read_b64_tr_b16 v[194:195], v5 offset:10240
  v_mfma_f32_16x16x32_bf16 v[28:31], a[240:243], v[76:79], v[28:31]
  ds_read_b64_tr_b16 v[200:201], v4 offset:12288
  s_add_u32 m0, s45, 98304
  s_add_u32 s68, s66, 7
  s_and_b32 s68, s68, 7
  s_mul_i32 s68, s68, 786432
  s_add_u32 s68, s68, 4096
  v_mfma_f32_16x16x32_bf16 v[28:31], v[124:127], v[80:83], v[28:31]
  ds_read_b128 v[112:115], v2 offset:14336
  buffer_load_dwordx4 v9, s[12:15], s68 offen lds
  v_mfma_f32_16x16x32_bf16 v[32:35], v[124:127], v[84:87], v[32:35]
  ds_read_b64_tr_b16 v[202:203], v4 offset:14336
  v_mfma_f32_16x16x32_bf16 v[32:35], a[240:243], v[88:91], v[32:35]
  ds_read_b64_tr_b16 v[204:205], v5 offset:12288
  v_mfma_f32_16x16x32_bf16 v[40:43], a[244:247], v[88:91], v[40:43]
  ds_read_b128 v[108:111], v2 offset:15360
  s_add_u32 m0, s45, 102400
  s_add_u32 s68, s68, 196608
  v_mfma_f32_16x16x32_bf16 v[40:43], v[128:131], v[84:87], v[40:43]
  ds_read_b64_tr_b16 v[206:207], v5 offset:14336
  buffer_load_dwordx4 v9, s[12:15], s68 offen lds
  v_mfma_f32_16x16x32_bf16 v[36:39], v[128:131], v[80:83], v[36:39]
  ds_read_b128 v[120:123], v13 offset:22528
  v_mfma_f32_16x16x32_bf16 v[36:39], a[244:247], v[76:79], v[36:39]
  v_mfma_f32_16x16x32_bf16 v[44:47], a[248:251], v[76:79], v[44:47]
  s_add_u32 m0, s45, 106496
  s_add_u32 s68, s68, 196608
  v_mfma_f32_16x16x32_bf16 v[44:47], v[132:135], v[80:83], v[44:47]
  ds_read_b128 v[116:119], v13 offset:23552
  v_mfma_f32_16x16x32_bf16 v[48:51], v[132:135], v[84:87], v[48:51]
  buffer_load_dwordx4 v9, s[12:15], s68 offen lds
  v_mfma_f32_16x16x32_bf16 v[48:51], a[248:251], v[88:91], v[48:51]
  s_waitcnt vmcnt(7) lgkmcnt(2)
  s_barrier
  v_mfma_f32_16x16x32_bf16 v[68:71], a[248:251], v[96:99], v[68:71]
  ds_read_b128 v[76:79], v1 offset:32768
  s_add_u32 m0, s45, 110592
  s_add_u32 s68, s68, 196608
  v_mfma_f32_16x16x32_bf16 v[68:71], v[132:135], v[92:95], v[68:71]
  buffer_load_dwordx4 v9, s[12:15], s68 offen lds
  v_mfma_f32_16x16x32_bf16 v[60:63], v[128:131], v[92:95], v[60:63]
  ds_read_b128 v[80:83], v1 offset:33792
  v_mfma_f32_16x16x32_bf16 v[60:63], a[244:247], v[96:99], v[60:63]
  s_waitcnt lgkmcnt(2)
  v_mfma_f32_16x16x32_bf16 v[28:31], v[136:139], v[100:103], v[28:31]
  s_add_u32 m0, s70, 49152
  s_add_u32 s69, s58, 98304
  v_mfma_f32_16x16x32_bf16 v[28:31], v[148:151], v[104:107], v[28:31]
  ds_read_b128 v[84:87], v1 offset:40960
  v_mfma_f32_16x16x32_bf16 v[32:35], v[148:151], v[108:111], v[32:35]
  buffer_load_dwordx4 v12, s[8:11], s69 offen offset:0 sc1 lds
  v_mfma_f32_16x16x32_bf16 v[32:35], v[136:139], v[112:115], v[32:35]
  v_mfma_f32_16x16x32_bf16 v[40:43], v[140:143], v[112:115], v[40:43]
  ds_read_b128 v[88:91], v1 offset:41984
  v_mfma_f32_16x16x32_bf16 v[40:43], v[152:155], v[108:111], v[40:43]
  buffer_load_dwordx4 v12, s[8:11], s69 offen offset:1024 sc1 lds
  v_mfma_f32_16x16x32_bf16 v[36:39], v[152:155], v[104:107], v[36:39]
  ds_read_b128 v[92:95], v13 offset:24576
  v_mfma_f32_16x16x32_bf16 v[36:39], v[140:143], v[100:103], v[36:39]
  v_mfma_f32_16x16x32_bf16 v[44:47], v[144:147], v[100:103], v[44:47]
  v_mfma_f32_16x16x32_bf16 v[44:47], v[156:159], v[104:107], v[44:47]
  ds_read_b128 v[96:99], v13 offset:25600
  v_mfma_f32_16x16x32_bf16 v[48:51], v[156:159], v[108:111], v[48:51]
  buffer_load_dwordx4 v12, s[8:11], s69 offen offset:2048 sc1 lds
  v_mfma_f32_16x16x32_bf16 v[48:51], v[144:147], v[112:115], v[48:51]
  s_waitcnt vmcnt(3)
  s_barrier
  v_mfma_f32_16x16x32_bf16 v[68:71], v[144:147], v[120:123], v[68:71]
  ds_read_b128 v[100:103], v1 offset:34816
  v_mfma_f32_16x16x32_bf16 v[68:71], v[156:159], v[116:119], v[68:71]
  ds_read_b64_tr_b16 v[212:213], v7 offset:16384
  buffer_load_dwordx4 v12, s[8:11], s69 offen offset:3072 sc1 lds
  v_mfma_f32_16x16x32_bf16 v[60:63], v[152:155], v[116:119], v[60:63]
  ds_read_b128 v[104:107], v1 offset:35840
  v_mfma_f32_16x16x32_bf16 v[60:63], v[140:143], v[120:123], v[60:63]
  s_waitcnt lgkmcnt(3)
  ds_read_b64_tr_b16 v[214:215], v7 offset:18432
  v_mfma_f32_16x16x32_bf16 v[28:31], v[160:163], v[76:79], v[28:31]
  ds_read_b64_tr_b16 v[216:217], v8 offset:16384
  s_add_u32 m0, s70, 114688
  s_add_u32 s69, s59, 98304
  v_mfma_f32_16x16x32_bf16 v[28:31], v[172:175], v[80:83], v[28:31]
  ds_read_b128 v[108:111], v1 offset:43008
  buffer_load_dwordx4 v12, s[8:11], s69 offen offset:0 sc1 lds
  v_mfma_f32_16x16x32_bf16 v[32:35], v[172:175], v[88:91], v[32:35]
  ds_read_b64_tr_b16 v[218:219], v8 offset:18432
  v_mfma_f32_16x16x32_bf16 v[32:35], v[160:163], v[84:87], v[32:35]
  ds_read_b64_tr_b16 v[224:225], v7 offset:20480
  v_mfma_f32_16x16x32_bf16 v[40:43], v[164:167], v[84:87], v[40:43]
  ds_read_b128 v[112:115], v1 offset:44032
  v_mfma_f32_16x16x32_bf16 v[40:43], v[176:179], v[88:91], v[40:43]
  ds_read_b64_tr_b16 v[226:227], v7 offset:22528
  buffer_load_dwordx4 v12, s[8:11], s69 offen offset:1024 sc1 lds
  v_mfma_f32_16x16x32_bf16 v[36:39], v[176:179], v[80:83], v[36:39]
  ds_read_b128 v[116:119], v13 offset:26624
  v_mfma_f32_16x16x32_bf16 v[36:39], v[164:167], v[76:79], v[36:39]
  ds_read_b64_tr_b16 v[228:229], v8 offset:20480
  v_mfma_f32_16x16x32_bf16 v[44:47], v[168:171], v[76:79], v[44:47]
  ds_read_b64_tr_b16 v[230:231], v8 offset:22528
  v_mfma_f32_16x16x32_bf16 v[44:47], v[180:183], v[80:83], v[44:47]
  ds_read_b128 v[120:123], v13 offset:27648
  buffer_load_dwordx4 v12, s[8:11], s69 offen offset:2048 sc1 lds
  v_mfma_f32_16x16x32_bf16 v[48:51], v[180:183], v[88:91], v[48:51]
  ds_read_b64_tr_b16 v[236:237], v7 offset:24576
  v_mfma_f32_16x16x32_bf16 v[48:51], v[168:171], v[84:87], v[48:51]
  ds_read_b64_tr_b16 v[238:239], v7 offset:26624
  v_mfma_f32_16x16x32_bf16 v[68:71], v[168:171], v[92:95], v[68:71]
  ds_read_b128 v[76:79], v1 offset:36864
  v_mfma_f32_16x16x32_bf16 v[68:71], v[180:183], v[96:99], v[68:71]
  ds_read_b64_tr_b16 v[240:241], v8 offset:24576
  buffer_load_dwordx4 v12, s[8:11], s69 offen offset:3072 sc1 lds
  v_mfma_f32_16x16x32_bf16 v[60:63], v[176:179], v[96:99], v[60:63]
  ds_read_b128 v[80:83], v1 offset:37888
  v_mfma_f32_16x16x32_bf16 v[60:63], v[164:167], v[92:95], v[60:63]
  s_waitcnt lgkmcnt(5)
  ds_read_b64_tr_b16 v[242:243], v8 offset:26624
  v_mfma_f32_16x16x32_bf16 v[28:31], v[184:187], v[100:103], v[28:31]
  ds_read_b64_tr_b16 v[248:249], v7 offset:28672
  s_add_u32 m0, s70, 0
  s_add_u32 s69, s60, 98304
  v_mfma_f32_16x16x32_bf16 v[28:31], v[196:199], v[104:107], v[28:31]
  ds_read_b128 v[88:91], v1 offset:45056
  buffer_load_dwordx4 v12, s[8:11], s69 offen offset:0 sc1 lds
  v_mfma_f32_16x16x32_bf16 v[32:35], v[196:199], v[112:115], v[32:35]
  ds_read_b64_tr_b16 v[250:251], v7 offset:30720
  v_mfma_f32_16x16x32_bf16 v[32:35], v[184:187], v[108:111], v[32:35]
  ds_read_b64_tr_b16 v[252:253], v8 offset:28672
  v_mfma_f32_16x16x32_bf16 v[40:43], v[188:191], v[108:111], v[40:43]
  ds_read_b128 v[84:87], v1 offset:46080
  v_mfma_f32_16x16x32_bf16 v[40:43], v[200:203], v[112:115], v[40:43]
  ds_read_b64_tr_b16 v[254:255], v8 offset:30720
  buffer_load_dwordx4 v12, s[8:11], s69 offen offset:1024 sc1 lds
  v_mfma_f32_16x16x32_bf16 v[36:39], v[200:203], v[104:107], v[36:39]
  ds_read_b128 v[96:99], v13 offset:28672
  v_mfma_f32_16x16x32_bf16 v[36:39], v[188:191], v[100:103], v[36:39]
  v_mfma_f32_16x16x32_bf16 v[44:47], v[192:195], v[100:103], v[44:47]
  v_mfma_f32_16x16x32_bf16 v[44:47], v[204:207], v[104:107], v[44:47]
  ds_read_b128 v[92:95], v13 offset:29696
  v_mfma_f32_16x16x32_bf16 v[48:51], v[204:207], v[112:115], v[48:51]
  buffer_load_dwordx4 v12, s[8:11], s69 offen offset:2048 sc1 lds
  v_mfma_f32_16x16x32_bf16 v[48:51], v[192:195], v[108:111], v[48:51]
  v_mfma_f32_16x16x32_bf16 v[68:71], v[192:195], v[116:119], v[68:71]
  ds_read_b128 v[100:103], v1 offset:38912
  v_mfma_f32_16x16x32_bf16 v[68:71], v[204:207], v[120:123], v[68:71]
  buffer_load_dwordx4 v12, s[8:11], s69 offen offset:3072 sc1 lds
  v_mfma_f32_16x16x32_bf16 v[60:63], v[200:203], v[120:123], v[60:63]
  ds_read_b128 v[104:107], v1 offset:39936
  s_mov_b32 s30, 7340032
  v_mfma_f32_16x16x32_bf16 v[60:63], v[188:191], v[116:119], v[60:63]
  s_waitcnt lgkmcnt(2)
  s_mov_b32 s31, 131072
  s_mov_b32 s34, 7340032
  v_mfma_f32_16x16x32_bf16 v[28:31], v[208:211], v[76:79], v[28:31]
  s_add_u32 m0, s45, 16384
  s_mov_b32 s68, 0
  v_mfma_f32_16x16x32_bf16 v[28:31], v[220:223], v[80:83], v[28:31]
  ds_read_b128 v[112:115], v1 offset:47104
  s_mov_b32 s35, 131072
  v_mfma_f32_16x16x32_bf16 v[32:35], v[220:223], v[84:87], v[32:35]
  buffer_load_dwordx4 v11, s[20:23], s68 offen nt lds
  s_mov_b32 s38, 7340032
  s_mov_b32 s39, 131072
  v_mfma_f32_16x16x32_bf16 v[32:35], v[208:211], v[88:91], v[32:35]
  s_add_u32 m0, s45, 20480
  s_add_u32 s68, s68, 393216
  s_mov_b32 s42, 4194304
  v_mfma_f32_16x16x32_bf16 v[40:43], v[212:215], v[88:91], v[40:43]
  ds_read_b128 v[108:111], v1 offset:48128
  s_mov_b32 s43, 131072
  v_mfma_f32_16x16x32_bf16 v[40:43], v[224:227], v[84:87], v[40:43]
  buffer_load_dwordx4 v11, s[20:23], s68 offen nt lds
  v_add_u32 v9, s78, v1
  v_and_b32 v4, 0xffffbfff, v4
  v_mfma_f32_16x16x32_bf16 v[36:39], v[224:227], v[80:83], v[36:39]
  ds_read_b128 v[120:123], v13 offset:30720
  v_and_b32 v5, 0xffffbfff, v5
  v_mfma_f32_16x16x32_bf16 v[36:39], v[212:215], v[76:79], v[36:39]
  v_and_b32 v7, 0xffffbfff, v7
  v_and_b32 v8, 0xffffbfff, v8
  v_mfma_f32_16x16x32_bf16 v[44:47], v[216:219], v[76:79], v[44:47]
  s_add_u32 m0, s45, 24576
  s_add_u32 s68, s68, 393216
  s_lshl_b32 s52, s44, 13
  v_mfma_f32_16x16x32_bf16 v[44:47], v[228:231], v[80:83], v[44:47]
  ds_read_b128 v[116:119], v13 offset:31744
  s_and_b32 s52, s52, 8192
  v_mfma_f32_16x16x32_bf16 v[48:51], v[228:231], v[84:87], v[48:51]
  buffer_load_dwordx4 v11, s[20:23], s68 offen nt lds
  v_add_u32 v22, s52, v1
  v_add_u32 v23, s52, v2
  v_mfma_f32_16x16x32_bf16 v[48:51], v[216:219], v[88:91], v[48:51]
  s_waitcnt vmcnt(11) lgkmcnt(8)
  s_barrier
  v_mfma_f32_16x16x32_bf16 v[68:71], v[216:219], v[96:99], v[68:71]
  ds_read_b128 v[76:79], v1 offset:49152
  s_add_u32 m0, s45, 28672
  s_add_u32 s68, s68, 393216
  v_mfma_f32_16x16x32_bf16 v[68:71], v[228:231], v[92:95], v[68:71]
  buffer_load_dwordx4 v11, s[20:23], s68 offen nt lds
  v_and_b32 v14, 15, v0
  v_lshlrev_b32 v14, 7, v14
  v_mfma_f32_16x16x32_bf16 v[60:63], v[224:227], v[92:95], v[60:63]
  v_mfma_f32_16x16x32_bf16 v[60:63], v[212:215], v[96:99], v[60:63]
  s_waitcnt lgkmcnt(1)
  ds_read_b128 v[80:83], v1 offset:50176
  v_mfma_f32_16x16x32_bf16 v[28:31], v[232:235], v[100:103], v[28:31]
  v_mfma_f32_16x16x32_bf16 v[28:31], v[244:247], v[104:107], v[28:31]
  v_mfma_f32_16x16x32_bf16 v[32:35], v[244:247], v[108:111], v[32:35]
  ds_read_b128 v[84:87], v1 offset:57344
  v_mfma_f32_16x16x32_bf16 v[32:35], v[232:235], v[112:115], v[32:35]
  v_mfma_f32_16x16x32_bf16 v[40:43], v[236:239], v[112:115], v[40:43]
  v_mfma_f32_16x16x32_bf16 v[40:43], v[248:251], v[108:111], v[40:43]
  ds_read_b128 v[88:91], v1 offset:58368
  v_mfma_f32_16x16x32_bf16 v[36:39], v[248:251], v[104:107], v[36:39]
  v_mfma_f32_16x16x32_bf16 v[36:39], v[236:239], v[100:103], v[36:39]
  v_mfma_f32_16x16x32_bf16 v[44:47], v[240:243], v[100:103], v[44:47]
  ds_read_b128 v[92:95], v1 offset:51200
  v_mfma_f32_16x16x32_bf16 v[44:47], v[252:255], v[104:107], v[44:47]
  v_mfma_f32_16x16x32_bf16 v[48:51], v[252:255], v[108:111], v[48:51]
  v_mfma_f32_16x16x32_bf16 v[48:51], v[240:243], v[112:115], v[48:51]
  ds_read_b128 v[96:99], v1 offset:52224
  v_mfma_f32_16x16x32_bf16 v[68:71], v[240:243], v[120:123], v[68:71]
  v_mfma_f32_16x16x32_bf16 v[68:71], v[252:255], v[116:119], v[68:71]
  v_mfma_f32_16x16x32_bf16 v[60:63], v[248:251], v[116:119], v[60:63]
  ds_read_b128 v[100:103], v1 offset:59392
  v_mfma_f32_16x16x32_bf16 v[60:63], v[236:239], v[120:123], v[60:63]
  s_waitcnt lgkmcnt(3)
  v_mfma_f32_16x16x32_bf16 v[52:55], a[0:3], v[76:79], 0
  v_mfma_f32_16x16x32_bf16 v[52:55], a[12:15], v[80:83], v[52:55]
  ds_read_b128 v[104:107], v1 offset:60416
  v_mfma_f32_16x16x32_bf16 v[56:59], a[12:15], v[88:91], 0
  s_nop 2
  v_cvt_pk_bf16_f32 v60, v60, v61
  v_cvt_pk_bf16_f32 v61, v62, v63
HOP2:
  s_cbranch_execz HOP6
  v_cvt_pk_bf16_f32 v62, v68, v69
  v_cvt_pk_bf16_f32 v63, v70, v71
  ds_write_b128 v17, v[60:63] offset:1024
  v_mfma_f32_16x16x32_bf16 v[56:59], a[0:3], v[84:87], v[56:59]
  v_cvt_pk_bf16_f32 v28, v28, v29
  v_cvt_pk_bf16_f32 v29, v30, v31
  v_mfma_f32_16x16x32_bf16 v[64:67], a[4:7], v[84:87], 0
  ds_read_b128 v[108:111], v1 offset:53248
  v_mfma_f32_16x16x32_bf16 v[64:67], a[16:19], v[88:91], v[64:67]
  ds_write_b64 v18, v[28:29] offset:6144
  v_mfma_f32_16x16x32_bf16 v[60:63], a[16:19], v[80:83], 0
  v_cvt_pk_bf16_f32 v36, v36, v37
  v_cvt_pk_bf16_f32 v37, v38, v39
  v_mfma_f32_16x16x32_bf16 v[60:63], a[4:7], v[76:79], v[60:63]
  ds_read_b128 v[112:115], v1 offset:54272
  v_cvt_pk_bf16_f32 v38, v44, v45
  v_mfma_f32_16x16x32_bf16 v[68:71], a[8:11], v[76:79], 0
  v_cvt_pk_bf16_f32 v39, v46, v47
  v_mfma_f32_16x16x32_bf16 v[68:71], a[20:23], v[80:83], v[68:71]
  ds_write_b128 v17, v[36:39] offset:7168
  v_mfma_f32_16x16x32_bf16 v[72:75], a[20:23], v[88:91], 0
  ds_read_b128 v[76:79], v1 offset:61440
  v_cvt_pk_bf16_f32 v32, v32, v33
  v_mfma_f32_16x16x32_bf16 v[72:75], a[8:11], v[84:87], v[72:75]
  s_waitcnt lgkmcnt(6)
  v_cvt_pk_bf16_f32 v33, v34, v35
  v_mfma_f32_16x16x32_bf16 v[52:55], a[24:27], v[92:95], v[52:55]
  s_add_u32 m0, s70, 65536
  s_add_u32 s69, s61, 98304
  v_mfma_f32_16x16x32_bf16 v[52:55], a[36:39], v[96:99], v[52:55]
  ds_read_b128 v[80:83], v1 offset:62464
  v_mfma_f32_16x16x32_bf16 v[56:59], a[36:39], v[104:107], v[56:59]
  buffer_load_dwordx4 v12, s[8:11], s69 offen offset:0 sc1 lds
  ds_write_b64 v18, v[32:33] offset:12288
  v_mfma_f32_16x16x32_bf16 v[56:59], a[24:27], v[100:103], v[56:59]
  v_cvt_pk_bf16_f32 v40, v40, v41
  v_cvt_pk_bf16_f32 v41, v42, v43
  v_mfma_f32_16x16x32_bf16 v[64:67], a[28:31], v[100:103], v[64:67]
  ds_read_b128 v[88:91], v1 offset:55296
  v_cvt_pk_bf16_f32 v42, v48, v49
  v_mfma_f32_16x16x32_bf16 v[64:67], a[40:43], v[104:107], v[64:67]
  v_cvt_pk_bf16_f32 v43, v50, v51
  v_mfma_f32_16x16x32_bf16 v[60:63], a[40:43], v[96:99], v[60:63]
  buffer_load_dwordx4 v12, s[8:11], s69 offen offset:1024 sc1 lds
  ds_write_b128 v17, v[40:43] offset:13312
  v_mfma_f32_16x16x32_bf16 v[60:63], a[28:31], v[92:95], v[60:63]
  ds_read_b128 v[84:87], v1 offset:56320
  v_mfma_f32_16x16x32_bf16 v[68:71], a[32:35], v[92:95], v[68:71]
  s_bitcmp1_b32 s44, 0
  s_mov_b32 s52, 6144
  s_cselect_b32 s52, 12288, s52
  s_mov_b32 s53, 0
  s_cselect_b32 s53, 6144, s53
  v_mfma_f32_16x16x32_bf16 v[68:71], a[44:47], v[96:99], v[68:71]
  v_add_u32 v116, s52, v19
  v_add_u32 v117, s53, v19
  v_mfma_f32_16x16x32_bf16 v[72:75], a[44:47], v[104:107], v[72:75]
  ds_read_b128 v[92:95], v1 offset:63488
  v_add_u32 v118, s52, v20
  v_mfma_f32_16x16x32_bf16 v[72:75], a[32:35], v[100:103], v[72:75]
  s_waitcnt lgkmcnt(5)
  buffer_load_dwordx4 v12, s[8:11], s69 offen offset:2048 sc1 lds
  v_add_u32 v119, s53, v20
  v_mfma_f32_16x16x32_bf16 v[52:55], a[48:51], v[108:111], v[52:55]
  s_waitcnt vmcnt(11) lgkmcnt(2)
  s_barrier
  v_mfma_f32_16x16x32_bf16 v[52:55], a[60:63], v[112:115], v[52:55]
  ds_read_b128 v[96:99], v1 offset:64512
  ds_write_b16 v21, v16
  v_mfma_f32_16x16x32_bf16 v[56:59], a[60:63], v[80:83], v[56:59]
  ds_read_b128 v[28:31], v116
  v_mfma_f32_16x16x32_bf16 v[56:59], a[48:51], v[76:79], v[56:59]
  ds_read_b128 v[32:35], v117 offset:1024
  v_mfma_f32_16x16x32_bf16 v[64:67], a[52:55], v[76:79], v[64:67]
  ds_read_b128 v[104:107], v2 offset:49152
  v_mfma_f32_16x16x32_bf16 v[64:67], a[64:67], v[80:83], v[64:67]
  buffer_load_dwordx4 v12, s[8:11], s69 offen offset:3072 sc1 lds
  ds_read_b128 v[36:39], v116 offset:1024
  v_mfma_f32_16x16x32_bf16 v[60:63], a[64:67], v[112:115], v[60:63]
  ds_read_b64_tr_b16 v[40:41], v119 offset:2048
  v_mfma_f32_16x16x32_bf16 v[60:63], a[52:55], v[108:111], v[60:63]
  ds_read_b128 v[100:103], v2 offset:50176
  v_mfma_f32_16x16x32_bf16 v[68:71], a[56:59], v[108:111], v[68:71]
  s_add_u32 m0, s70, 98304
  s_add_u32 s69, s58, 163840
  v_mfma_f32_16x16x32_bf16 v[68:71], a[68:71], v[112:115], v[68:71]
  buffer_load_dwordx4 v12, s[8:11], s69 offen offset:0 sc1 lds
  ds_read_b64_tr_b16 v[42:43], v118 offset:2048
  v_mfma_f32_16x16x32_bf16 v[72:75], a[68:71], v[80:83], v[72:75]
  ds_read_b128 v[108:111], v2 offset:57344
  v_mfma_f32_16x16x32_bf16 v[72:75], a[56:59], v[76:79], v[72:75]
  s_waitcnt lgkmcnt(9)
  ds_read_b64_tr_b16 v[44:45], v119 offset:2056
  v_mfma_f32_16x16x32_bf16 v[52:55], a[72:75], v[88:91], v[52:55]
  ds_read_b64_tr_b16 v[46:47], v118 offset:2056
  v_mfma_f32_16x16x32_bf16 v[52:55], a[84:87], v[84:87], v[52:55]
  ds_read_b128 v[112:115], v2 offset:58368
  v_mfma_f32_16x16x32_bf16 v[56:59], a[84:87], v[96:99], v[56:59]
  buffer_load_dwordx4 v12, s[8:11], s69 offen offset:1024 sc1 lds
  v_mfma_f32_16x16x32_bf16 v[56:59], a[72:75], v[92:95], v[56:59]
  v_mfma_f32_16x16x32_bf16 v[64:67], a[76:79], v[92:95], v[64:67]
  ds_read_b128 v[80:83], v2 offset:51200
  v_mfma_f32_16x16x32_bf16 v[64:67], a[88:91], v[96:99], v[64:67]
  s_waitcnt lgkmcnt(2)
  v_mfma_f32_16x16x32_bf16 v[116:119], v[32:35], v[28:31], 0
  v_mfma_f32_16x16x32_bf16 v[120:123], v[36:39], v[28:31], 0
  v_mfma_f32_16x16x32_bf16 v[60:63], a[88:91], v[84:87], v[60:63]
  v_mfma_f32_16x16x32_bf16 v[60:63], a[76:79], v[88:91], v[60:63]
  ds_read_b128 v[76:79], v2 offset:52224
  v_mfma_f32_16x16x32_bf16 v[68:71], a[80:83], v[88:91], v[68:71]
  buffer_load_dwordx4 v12, s[8:11], s69 offen offset:2048 sc1 lds
  v_mfma_f32_16x16x32_bf16 v[68:71], a[92:95], v[84:87], v[68:71]
  s_nop 1
  v_cndmask_b32 v48, v116, v120, s[80:81]
  v_cndmask_b32 v49, v117, v121, s[82:83]
  v_mfma_f32_16x16x32_bf16 v[72:75], a[92:95], v[96:99], v[72:75]
  ds_read_b128 v[88:91], v2 offset:59392
  v_cndmask_b32 v50, v118, v122, s[84:85]
  v_mfma_f32_16x16x32_bf16 v[72:75], a[80:83], v[92:95], v[72:75]
  s_waitcnt lgkmcnt(3)
  v_cndmask_b32 v51, v119, v123, s[86:87]
  v_cndmask_b32 v48, v48, v49, s[88:89]
  v_mfma_f32_16x16x32_bf16 v[52:55], a[96:99], v[104:107], v[52:55]
  buffer_load_dwordx4 v12, s[8:11], s69 offen offset:3072 sc1 lds
  v_cndmask_b32 v49, v50, v51, s[88:89]
  v_mul_f32 v48, 0x3e8293ee, v48
  v_mfma_f32_16x16x32_bf16 v[52:55], a[108:111], v[100:103], v[52:55]
  ds_read_b128 v[84:87], v2 offset:60416
  v_mul_f32 v49, 0x3e8293ee, v49
  v_mfma_f32_16x16x32_bf16 v[56:59], a[108:111], v[112:115], v[56:59]
  v_mov_b32 v50, 0xce6e6b28
  v_cndmask_b32 v48, v48, v50, s[90:91]
  v_mfma_f32_16x16x32_bf16 v[56:59], a[96:99], v[108:111], v[56:59]
  s_add_u32 m0, s45, 81920
  s_mov_b32 s68, 1572864
  v_mfma_f32_16x16x32_bf16 v[64:67], a[100:103], v[108:111], v[64:67]
  ds_read_b128 v[96:99], v2 offset:53248
  v_cndmask_b32 v49, v49, v50, s[92:93]
  v_mfma_f32_16x16x32_bf16 v[64:67], a[112:115], v[112:115], v[64:67]
  buffer_load_dwordx4 v11, s[20:23], s68 offen nt lds
  v_max_f32 v50, v48, v49
  v_mov_b32 v51, v50
  v_mfma_f32_16x16x32_bf16 v[60:63], a[112:115], v[100:103], v[60:63]
  s_nop 0
  v_permlane16_swap_b32 v50, v51
  v_mfma_f32_16x16x32_bf16 v[60:63], a[100:103], v[104:107], v[60:63]
  ds_read_b128 v[92:95], v2 offset:54272
  v_max_f32 v50, v50, v51
  v_mfma_f32_16x16x32_bf16 v[68:71], a[104:107], v[104:107], v[68:71]
  v_mov_b32 v51, v50
  v_mfma_f32_16x16x32_bf16 v[68:71], a[116:119], v[100:103], v[68:71]
  s_add_u32 m0, s45, 86016
  s_add_u32 s68, s68, 393216
  v_mfma_f32_16x16x32_bf16 v[72:75], a[116:119], v[112:115], v[72:75]
  ds_read_b128 v[104:107], v2 offset:61440
  v_mfma_f32_16x16x32_bf16 v[72:75], a[104:107], v[108:111], v[72:75]
  s_waitcnt lgkmcnt(3)
  buffer_load_dwordx4 v11, s[20:23], s68 offen nt lds
  v_mfma_f32_16x16x32_bf16 v[52:55], a[120:123], v[80:83], v[52:55]
  v_permlane32_swap_b32 v50, v51
  v_mfma_f32_16x16x32_bf16 v[52:55], a[132:135], v[76:79], v[52:55]
  ds_read_b128 v[100:103], v2 offset:62464
  v_max_f32 v50, v50, v51
  v_mfma_f32_16x16x32_bf16 v[56:59], a[132:135], v[84:87], v[56:59]
  s_add_u32 m0, s45, 90112
  s_add_u32 s68, s68, 393216
  v_sub_f32 v48, v48, v50
  v_mfma_f32_16x16x32_bf16 v[56:59], a[120:123], v[88:91], v[56:59]
  buffer_load_dwordx4 v11, s[20:23], s68 offen nt lds
  v_sub_f32 v49, v49, v50
  v_mfma_f32_16x16x32_bf16 v[64:67], a[124:127], v[88:91], v[64:67]
  ds_read_b128 v[112:115], v2 offset:55296
  v_mfma_f32_16x16x32_bf16 v[64:67], a[136:139], v[84:87], v[64:67]
  v_exp_f32 v48, v48
  v_mfma_f32_16x16x32_bf16 v[60:63], a[136:139], v[76:79], v[60:63]
  s_add_u32 m0, s45, 94208
  s_add_u32 s68, s68, 393216
  v_mfma_f32_16x16x32_bf16 v[60:63], a[124:127], v[80:83], v[60:63]
  ds_read_b128 v[108:111], v2 offset:56320
  v_mfma_f32_16x16x32_bf16 v[68:71], a[128:131], v[80:83], v[68:71]
  buffer_load_dwordx4 v11, s[20:23], s68 offen nt lds
  v_exp_f32 v49, v49
  v_mfma_f32_16x16x32_bf16 v[68:71], a[140:143], v[76:79], v[68:71]
  v_add_f32 v50, v48, v49
  v_mov_b32 v51, v50
  v_mfma_f32_16x16x32_bf16 v[72:75], a[140:143], v[84:87], v[72:75]
  ds_read_b128 v[80:83], v2 offset:63488
  v_mfma_f32_16x16x32_bf16 v[72:75], a[128:131], v[88:91], v[72:75]
  s_waitcnt lgkmcnt(3)
  v_permlane16_swap_b32 v50, v51
  v_mfma_f32_16x16x32_bf16 v[52:55], a[144:147], v[96:99], v[52:55]
  v_add_f32 v50, v50, v51
  v_mov_b32 v51, v50
  v_mfma_f32_16x16x32_bf16 v[52:55], a[156:159], v[92:95], v[52:55]
  ds_read_b128 v[76:79], v2 offset:64512
  v_mfma_f32_16x16x32_bf16 v[56:59], a[156:159], v[100:103], v[56:59]
  v_permlane32_swap_b32 v50, v51
  v_mfma_f32_16x16x32_bf16 v[56:59], a[144:147], v[104:107], v[56:59]
  s_waitcnt vmcnt(8) lgkmcnt(15)
  s_barrier
  v_mfma_f32_16x16x32_bf16 v[64:67], a[148:151], v[104:107], v[64:67]
  ds_read_b128 v[84:87], v1 offset:0
  v_add_f32 v50, v50, v51
  v_mfma_f32_16x16x32_bf16 v[64:67], a[160:163], v[100:103], v[64:67]
  v_rcp_f32 v50, v50
  v_mfma_f32_16x16x32_bf16 v[60:63], a[160:163], v[92:95], v[60:63]
  v_mul_f32 v48, v48, v50
  v_mul_f32 v49, v49, v50
  v_mfma_f32_16x16x32_bf16 v[60:63], a[148:151], v[96:99], v[60:63]
  ds_read_b128 v[88:91], v1 offset:1024
  v_cvt_pk_bf16_f32 v48, v48, v48
  v_mfma_f32_16x16x32_bf16 v[68:71], a[152:155], v[96:99], v[68:71]
  v_cvt_pk_bf16_f32 v49, v49, v49
  v_and_b32 v28, v24, v48
  v_mfma_f32_16x16x32_bf16 v[68:71], a[164:167], v[92:95], v[68:71]
  v_and_b32 v29, v25, v49
  v_and_b32 v30, v26, v48
  v_mfma_f32_16x16x32_bf16 v[72:75], a[164:167], v[100:103], v[72:75]
  ds_read_b128 v[96:99], v1 offset:8192
  v_and_b32 v31, v27, v49
  v_mfma_f32_16x16x32_bf16 v[72:75], a[152:155], v[104:107], v[72:75]
  s_waitcnt lgkmcnt(3)
  v_mfma_f32_16x16x32_bf16 v[32:35], v[40:43], v[28:31], 0
  v_mfma_f32_16x16x32_bf16 v[36:39], v[44:47], v[28:31], 0
  v_mfma_f32_16x16x32_bf16 v[52:55], a[168:171], v[112:115], v[52:55]
  v_mfma_f32_16x16x32_bf16 v[52:55], a[180:183], v[108:111], v[52:55]
  ds_read_b128 v[92:95], v1 offset:9216
  v_mfma_f32_16x16x32_bf16 v[56:59], a[180:183], v[76:79], v[56:59]
  v_mfma_f32_16x16x32_bf16 v[56:59], a[168:171], v[80:83], v[56:59]
  s_nop 1
  v_cvt_pk_bf16_f32 v116, v32, v33
  v_cvt_pk_bf16_f32 v117, v34, v35
  v_mfma_f32_16x16x32_bf16 v[64:67], a[172:175], v[80:83], v[64:67]
  ds_read_b128 v[100:103], v1 offset:2048
  v_cvt_pk_bf16_f32 v118, v36, v37
  v_mfma_f32_16x16x32_bf16 v[64:67], a[184:187], v[76:79], v[64:67]
  v_cvt_pk_bf16_f32 v119, v38, v39
  v_mfma_f32_16x16x32_bf16 v[60:63], a[184:187], v[108:111], v[60:63]
  buffer_store_dwordx4 v[116:119], v1, s[8:11], s73 offen sc1
  v_mfma_f32_16x16x32_bf16 v[60:63], a[172:175], v[112:115], v[60:63]
  ds_read_b128 v[104:107], v1 offset:3072
  s_add_u32 s73, s73, 65536
  v_mfma_f32_16x16x32_bf16 v[68:71], a[176:179], v[112:115], v[68:71]
  v_mfma_f32_16x16x32_bf16 v[68:71], a[188:191], v[108:111], v[68:71]
  v_mfma_f32_16x16x32_bf16 v[72:75], a[188:191], v[76:79], v[72:75]
  ds_read_b128 v[112:115], v1 offset:10240
  v_mfma_f32_16x16x32_bf16 v[72:75], a[176:179], v[80:83], v[72:75]
  s_waitcnt lgkmcnt(3)
  v_mfma_f32_16x16x32_bf16 v[52:55], a[192:195], v[84:87], v[52:55]
  v_mfma_f32_16x16x32_bf16 v[52:55], a[204:207], v[88:91], v[52:55]
  ds_read_b128 v[108:111], v1 offset:11264
  v_mfma_f32_16x16x32_bf16 v[56:59], a[204:207], v[92:95], v[56:59]
  v_mfma_f32_16x16x32_bf16 v[56:59], a[192:195], v[96:99], v[56:59]
  v_mfma_f32_16x16x32_bf16 v[64:67], a[196:199], v[96:99], v[64:67]
  ds_read_b128 v[76:79], v1 offset:4096
  v_lshrrev_b32 v40, 4, v0
  v_lshlrev_b32 v40, 4, v40
  v_mfma_f32_16x16x32_bf16 v[64:67], a[208:211], v[92:95], v[64:67]
  v_add_u32 v41, 160768, v40
  v_mfma_f32_16x16x32_bf16 v[60:63], a[208:211], v[88:91], v[60:63]
  ds_read_b64_tr_b16 v[116:117], v3 offset:16384
  v_mfma_f32_16x16x32_bf16 v[60:63], a[196:199], v[84:87], v[60:63]
  ds_read_b128 v[80:83], v1 offset:5120
  ds_read_b64_tr_b16 v[118:119], v3 offset:18432
  v_mfma_f32_16x16x32_bf16 v[68:71], a[200:203], v[84:87], v[68:71]
  ds_read_b128 v[28:31], v41 offset:0
  v_mfma_f32_16x16x32_bf16 v[68:71], a[212:215], v[88:91], v[68:71]
  v_mfma_f32_16x16x32_bf16 v[72:75], a[212:215], v[92:95], v[72:75]
  ds_read_b128 v[84:87], v1 offset:12288
  v_mfma_f32_16x16x32_bf16 v[72:75], a[200:203], v[96:99], v[72:75]
  s_waitcnt lgkmcnt(6)
  s_add_u32 m0, s70, 32768
  s_add_u32 s69, s59, 163840
  v_mfma_f32_16x16x32_bf16 v[52:55], a[216:219], v[100:103], v[52:55]
  buffer_load_dwordx4 v12, s[8:11], s69 offen offset:0 sc1 lds
  v_mfma_f32_16x16x32_bf16 v[52:55], a[228:231], v[104:107], v[52:55]
  ds_read_b128 v[88:91], v1 offset:13312
  v_mfma_f32_16x16x32_bf16 v[56:59], a[228:231], v[108:111], v[56:59]
  v_mfma_f32_16x16x32_bf16 v[56:59], a[216:219], v[112:115], v[56:59]
  v_mfma_f32_16x16x32_bf16 v[64:67], a[220:223], v[112:115], v[64:67]
  ds_read_b128 v[92:95], v1 offset:6144
  ds_read_b64_tr_b16 v[120:121], v3 offset:20480
  v_mfma_f32_16x16x32_bf16 v[64:67], a[232:235], v[108:111], v[64:67]
  ds_read_b64_tr_b16 v[122:123], v3 offset:22528
  s_waitcnt lgkmcnt(5)
  v_mfma_f32_16x16x32_bf16 v[36:39], v[116:119], v[28:31], 0
  v_mfma_f32_16x16x32_bf16 v[60:63], a[232:235], v[104:107], v[60:63]
  buffer_load_dwordx4 v12, s[8:11], s69 offen offset:1024 sc1 lds
  ds_read_b128 v[32:35], v41 offset:64
  v_mfma_f32_16x16x32_bf16 v[60:63], a[220:223], v[100:103], v[60:63]
  ds_read_b128 v[96:99], v1 offset:7168
  v_mfma_f32_16x16x32_bf16 v[68:71], a[224:227], v[100:103], v[68:71]
  v_mfma_f32_16x16x32_bf16 v[68:71], a[236:239], v[104:107], v[68:71]
  v_mfma_f32_16x16x32_bf16 v[72:75], a[236:239], v[108:111], v[72:75]
  ds_read_b128 v[100:103], v1 offset:14336
  v_mfma_f32_16x16x32_bf16 v[72:75], a[224:227], v[112:115], v[72:75]
  s_waitcnt lgkmcnt(6)
  buffer_load_dwordx4 v12, s[8:11], s69 offen offset:2048 sc1 lds
  v_mfma_f32_16x16x32_bf16 v[52:55], a[240:243], v[76:79], v[52:55]
  v_mfma_f32_16x16x32_bf16 v[52:55], v[124:127], v[80:83], v[52:55]
  ds_read_b128 v[104:107], v1 offset:15360
  v_mfma_f32_16x16x32_bf16 v[56:59], v[124:127], v[88:91], v[56:59]
  ds_read_b64_tr_b16 v[116:117], v3 offset:24576
  v_and_b32 v42, 15, v0
  v_mfma_f32_16x16x32_bf16 v[56:59], a[240:243], v[84:87], v[56:59]
  ds_read_b64_tr_b16 v[118:119], v3 offset:26624
  buffer_load_dwordx4 v12, s[8:11], s69 offen offset:3072 sc1 lds
  s_waitcnt lgkmcnt(5)
  v_mfma_f32_16x16x32_bf16 v[36:39], v[120:123], v[32:35], v[36:39]
  v_lshl_add_u32 v40, v42, 27, v40
  s_lshr_b32 s52, s2, 2
  v_mfma_f32_16x16x32_bf16 v[64:67], a[244:247], v[84:87], v[64:67]
  ds_read_b128 v[108:111], v2 offset:0
  ds_read_b128 v[28:31], v41 offset:128
  v_mfma_f32_16x16x32_bf16 v[64:67], v[128:131], v[88:91], v[64:67]
  s_lshl_b32 s54, s52, 7
  s_lshl_b32 s52, s52, 8
  s_and_b32 s53, s2, 3
  v_mfma_f32_16x16x32_bf16 v[60:63], v[128:131], v[80:83], v[60:63]
  s_add_u32 m0, s70, 49152
  s_add_u32 s69, s60, 163840
  s_mul_i32 s79, s53, 24576
  v_mfma_f32_16x16x32_bf16 v[60:63], a[244:247], v[76:79], v[60:63]
  ds_read_b128 v[112:115], v2 offset:1024
  s_add_u32 s52, s52, s79
  v_mfma_f32_16x16x32_bf16 v[68:71], a[248:251], v[76:79], v[68:71]
  buffer_load_dwordx4 v12, s[8:11], s69 offen offset:0 sc1 lds
  s_lshl_b32 s79, s44, 6
  s_add_u32 s52, s52, s79
  v_mfma_f32_16x16x32_bf16 v[68:71], v[132:135], v[80:83], v[68:71]
  s_add_u32 s52, s52, 8192
  s_lshl_b32 s53, s53, 2
  s_add_u32 s54, s54, s53
  v_mfma_f32_16x16x32_bf16 v[72:75], v[132:135], v[88:91], v[72:75]
  ds_read_b128 v[76:79], v2 offset:8192
  s_add_u32 s54, s54, 720896
  v_mfma_f32_16x16x32_bf16 v[72:75], a[248:251], v[84:87], v[72:75]
  s_waitcnt lgkmcnt(6)
  s_cmp_eq_u32 s44, 0
  s_cselect_b32 s79, s54, 1073741824
  v_mfma_f32_16x16x32_bf16 v[52:55], v[136:139], v[92:95], v[52:55]
  ds_read_b64_tr_b16 v[120:121], v3 offset:28672
  v_mfma_f32_16x16x32_bf16 v[52:55], v[148:151], v[96:99], v[52:55]
  ds_read_b128 v[80:83], v2 offset:9216
  ds_read_b64_tr_b16 v[122:123], v3 offset:30720
  s_waitcnt lgkmcnt(5)
  v_mfma_f32_16x16x32_bf16 v[36:39], v[116:119], v[28:31], v[36:39]
  v_mfma_f32_16x16x32_bf16 v[56:59], v[148:151], v[104:107], v[56:59]
  buffer_load_dwordx4 v12, s[8:11], s69 offen offset:1024 sc1 lds
  ds_read_b128 v[32:35], v41 offset:192
  v_mfma_f32_16x16x32_bf16 v[56:59], v[136:139], v[100:103], v[56:59]
  v_mfma_f32_16x16x32_bf16 v[64:67], v[140:143], v[100:103], v[64:67]
  ds_read_b128 v[88:91], v2 offset:2048
  v_mfma_f32_16x16x32_bf16 v[64:67], v[152:155], v[104:107], v[64:67]
  v_mfma_f32_16x16x32_bf16 v[60:63], v[152:155], v[96:99], v[60:63]
  buffer_load_dwordx4 v12, s[8:11], s69 offen offset:2048 sc1 lds
  v_mfma_f32_16x16x32_bf16 v[60:63], v[140:143], v[92:95], v[60:63]
  ds_read_b128 v[84:87], v2 offset:3072
  v_mfma_f32_16x16x32_bf16 v[68:71], v[144:147], v[92:95], v[68:71]
  v_mfma_f32_16x16x32_bf16 v[68:71], v[156:159], v[96:99], v[68:71]
  s_waitcnt vmcnt(8)
  s_barrier
  v_mfma_f32_16x16x32_bf16 v[72:75], v[156:159], v[104:107], v[72:75]
  ds_read_b128 v[92:95], v2 offset:10240
  ds_read_b64_tr_b16 v[116:117], v6 offset:16384
  v_mfma_f32_16x16x32_bf16 v[72:75], v[144:147], v[100:103], v[72:75]
  s_waitcnt lgkmcnt(6)
  ds_read_b64_tr_b16 v[118:119], v6 offset:18432
  s_waitcnt lgkmcnt(5)
  v_mfma_f32_16x16x32_bf16 v[36:39], v[120:123], v[32:35], v[36:39]
  v_mfma_f32_16x16x32_bf16 v[52:55], v[160:163], v[108:111], v[52:55]
  buffer_load_dwordx4 v12, s[8:11], s69 offen offset:3072 sc1 lds
  ds_read_b128 v[28:31], v41 offset:256
  v_mfma_f32_16x16x32_bf16 v[52:55], v[172:175], v[112:115], v[52:55]
  ds_read_b128 v[96:99], v2 offset:11264
  v_mfma_f32_16x16x32_bf16 v[56:59], v[172:175], v[80:83], v[56:59]
  v_mfma_f32_16x16x32_bf16 v[56:59], v[160:163], v[76:79], v[56:59]
  s_add_u32 m0, s70, 114688
  s_add_u32 s69, s61, 163840
  v_mfma_f32_16x16x32_bf16 v[64:67], v[164:167], v[76:79], v[64:67]
  ds_read_b128 v[104:107], v2 offset:4096
  v_mfma_f32_16x16x32_bf16 v[64:67], v[176:179], v[80:83], v[64:67]
  buffer_load_dwordx4 v12, s[8:11], s69 offen offset:0 sc1 lds
  v_mfma_f32_16x16x32_bf16 v[60:63], v[176:179], v[112:115], v[60:63]
  v_mfma_f32_16x16x32_bf16 v[60:63], v[164:167], v[108:111], v[60:63]
  ds_read_b128 v[100:103], v2 offset:5120
  v_mfma_f32_16x16x32_bf16 v[68:71], v[168:171], v[108:111], v[68:71]
  ds_read_b64_tr_b16 v[120:121], v6 offset:20480
  v_mfma_f32_16x16x32_bf16 v[68:71], v[180:183], v[112:115], v[68:71]
  ds_read_b64_tr_b16 v[122:123], v6 offset:22528
  buffer_load_dwordx4 v12, s[8:11], s69 offen offset:1024 sc1 lds
  s_waitcnt lgkmcnt(5)
  v_mfma_f32_16x16x32_bf16 v[36:39], v[116:119], v[28:31], v[36:39]
  v_mfma_f32_16x16x32_bf16 v[72:75], v[180:183], v[80:83], v[72:75]
  ds_read_b128 v[108:111], v2 offset:12288
  ds_read_b128 v[32:35], v41 offset:320
  v_mfma_f32_16x16x32_bf16 v[72:75], v[168:171], v[76:79], v[72:75]
  s_waitcnt lgkmcnt(6)
  v_mfma_f32_16x16x32_bf16 v[52:55], v[184:187], v[88:91], v[52:55]
  v_mfma_f32_16x16x32_bf16 v[52:55], v[196:199], v[84:87], v[52:55]
  ds_read_b128 v[112:115], v2 offset:13312
  v_mfma_f32_16x16x32_bf16 v[56:59], v[196:199], v[96:99], v[56:59]
  buffer_load_dwordx4 v12, s[8:11], s69 offen offset:2048 sc1 lds
  v_mfma_f32_16x16x32_bf16 v[56:59], v[184:187], v[92:95], v[56:59]
  v_mfma_f32_16x16x32_bf16 v[64:67], v[188:191], v[92:95], v[64:67]
  ds_read_b128 v[80:83], v2 offset:6144
  v_mfma_f32_16x16x32_bf16 v[64:67], v[200:203], v[96:99], v[64:67]
  v_mfma_f32_16x16x32_bf16 v[60:63], v[200:203], v[84:87], v[60:63]
  ds_read_b64_tr_b16 v[116:117], v6 offset:24576
  v_mfma_f32_16x16x32_bf16 v[60:63], v[188:191], v[88:91], v[60:63]
  ds_read_b128 v[76:79], v2 offset:7168
  ds_read_b64_tr_b16 v[118:119], v6 offset:26624
  s_waitcnt lgkmcnt(5)
  v_mfma_f32_16x16x32_bf16 v[36:39], v[120:123], v[32:35], v[36:39]
  v_mfma_f32_16x16x32_bf16 v[68:71], v[192:195], v[88:91], v[68:71]
  buffer_load_dwordx4 v12, s[8:11], s69 offen offset:3072 sc1 lds
  ds_read_b128 v[28:31], v41 offset:384
  v_mfma_f32_16x16x32_bf16 v[68:71], v[204:207], v[84:87], v[68:71]
  v_mfma_f32_16x16x32_bf16 v[72:75], v[204:207], v[96:99], v[72:75]
  ds_read_b128 v[88:91], v2 offset:14336
  v_mfma_f32_16x16x32_bf16 v[72:75], v[192:195], v[92:95], v[72:75]
  s_waitcnt lgkmcnt(6)
  s_add_u32 m0, s70, 0
  s_add_u32 s69, s58, 229376
  v_mfma_f32_16x16x32_bf16 v[52:55], v[208:211], v[104:107], v[52:55]
  buffer_load_dwordx4 v12, s[8:11], s69 offen offset:0 sc1 lds
  v_mfma_f32_16x16x32_bf16 v[52:55], v[220:223], v[100:103], v[52:55]
  ds_read_b128 v[84:87], v2 offset:15360
  v_mfma_f32_16x16x32_bf16 v[56:59], v[220:223], v[112:115], v[56:59]
  v_mfma_f32_16x16x32_bf16 v[56:59], v[208:211], v[108:111], v[56:59]
  v_mfma_f32_16x16x32_bf16 v[64:67], v[212:215], v[108:111], v[64:67]
  ds_read_b128 v[96:99], v2 offset:32768
  ds_read_b64_tr_b16 v[120:121], v6 offset:28672
  v_mfma_f32_16x16x32_bf16 v[64:67], v[224:227], v[112:115], v[64:67]
  ds_read_b64_tr_b16 v[122:123], v6 offset:30720
  s_waitcnt lgkmcnt(5)
  v_mfma_f32_16x16x32_bf16 v[36:39], v[116:119], v[28:31], v[36:39]
  v_mfma_f32_16x16x32_bf16 v[60:63], v[224:227], v[100:103], v[60:63]
  buffer_load_dwordx4 v12, s[8:11], s69 offen offset:1024 sc1 lds
  ds_read_b128 v[32:35], v41 offset:448
  v_mfma_f32_16x16x32_bf16 v[60:63], v[212:215], v[104:107], v[60:63]
  ds_read_b128 v[92:95], v2 offset:33792
  v_mfma_f32_16x16x32_bf16 v[68:71], v[216:219], v[104:107], v[68:71]
  v_mfma_f32_16x16x32_bf16 v[68:71], v[228:231], v[100:103], v[68:71]
  v_mfma_f32_16x16x32_bf16 v[72:75], v[228:231], v[112:115], v[72:75]
  ds_read_b128 v[104:107], v2 offset:40960
  v_mfma_f32_16x16x32_bf16 v[72:75], v[216:219], v[108:111], v[72:75]
  s_waitcnt lgkmcnt(6)
  buffer_load_dwordx4 v12, s[8:11], s69 offen offset:2048 sc1 lds
  v_mfma_f32_16x16x32_bf16 v[52:55], v[232:235], v[80:83], v[52:55]
  v_mfma_f32_16x16x32_bf16 v[52:55], v[244:247], v[76:79], v[52:55]
  ds_read_b128 v[100:103], v2 offset:41984
  v_mfma_f32_16x16x32_bf16 v[56:59], v[244:247], v[84:87], v[56:59]
  v_mfma_f32_16x16x32_bf16 v[56:59], v[232:235], v[88:91], v[56:59]
  buffer_load_dwordx4 v12, s[8:11], s69 offen offset:3072 sc1 lds
  s_waitcnt lgkmcnt(3)
  v_mfma_f32_16x16x32_bf16 v[36:39], v[120:123], v[32:35], v[36:39]
  v_mfma_f32_16x16x32_bf16 v[64:67], v[236:239], v[88:91], v[64:67]
  ds_read_b128 v[112:115], v2 offset:34816
  v_mfma_f32_16x16x32_bf16 v[64:67], v[248:251], v[84:87], v[64:67]
  v_mfma_f32_16x16x32_bf16 v[60:63], v[248:251], v[76:79], v[60:63]
  v_mfma_f32_16x16x32_bf16 v[60:63], v[236:239], v[80:83], v[60:63]
  ds_read_b128 v[108:111], v2 offset:35840
  v_mfma_f32_16x16x32_bf16 v[68:71], v[240:243], v[80:83], v[68:71]
  s_nop 0
  buffer_store_dwordx4 v[36:39], v40, s[8:11], s52 offen sc1
  v_mfma_f32_16x16x32_bf16 v[68:71], v[252:255], v[76:79], v[68:71]
  v_mfma_f32_16x16x32_bf16 v[72:75], v[252:255], v[84:87], v[72:75]
  ds_read_b128 v[80:83], v2 offset:43008
  v_mfma_f32_16x16x32_bf16 v[72:75], v[240:243], v[88:91], v[72:75]
  s_waitcnt lgkmcnt(3)
  v_mfma_f32_16x16x32_bf16 v[28:31], a[0:3], v[96:99], 0
  v_mfma_f32_16x16x32_bf16 v[28:31], a[12:15], v[92:95], v[28:31]
  ds_read_b128 v[76:79], v2 offset:44032
  v_mfma_f32_16x16x32_bf16 v[32:35], a[12:15], v[100:103], 0
  v_mfma_f32_16x16x32_bf16 v[32:35], a[0:3], v[104:107], v[32:35]
  v_cvt_pk_bf16_f32 v52, v52, v53
  v_cvt_pk_bf16_f32 v53, v54, v55
  v_mfma_f32_16x16x32_bf16 v[40:43], a[4:7], v[104:107], 0
  ds_read_b128 v[84:87], v2 offset:36864
  v_mfma_f32_16x16x32_bf16 v[40:43], a[16:19], v[100:103], v[40:43]
  ds_write_b64 v18, v[52:53] offset:0
  v_mfma_f32_16x16x32_bf16 v[36:39], a[16:19], v[92:95], 0
  v_cvt_pk_bf16_f32 v60, v60, v61
  v_cvt_pk_bf16_f32 v61, v62, v63
  v_mfma_f32_16x16x32_bf16 v[36:39], a[4:7], v[96:99], v[36:39]
  ds_read_b128 v[88:91], v2 offset:37888
  v_cvt_pk_bf16_f32 v62, v68, v69
  v_cvt_pk_bf16_f32 v63, v70, v71
  v_mfma_f32_16x16x32_bf16 v[44:47], a[8:11], v[96:99], 0
  ds_write_b128 v17, v[60:63] offset:1024
  v_mfma_f32_16x16x32_bf16 v[44:47], a[20:23], v[92:95], v[44:47]
  v_cvt_pk_bf16_f32 v56, v56, v57
  v_cvt_pk_bf16_f32 v57, v58, v59
  v_mfma_f32_16x16x32_bf16 v[48:51], a[20:23], v[100:103], 0
  ds_read_b128 v[96:99], v2 offset:45056
  v_mfma_f32_16x16x32_bf16 v[48:51], a[8:11], v[104:107], v[48:51]
  s_waitcnt lgkmcnt(5)
  ds_write_b64 v18, v[56:57] offset:6144
  v_mfma_f32_16x16x32_bf16 v[28:31], a[24:27], v[112:115], v[28:31]
  v_cvt_pk_bf16_f32 v64, v64, v65
  v_cvt_pk_bf16_f32 v65, v66, v67
  v_mfma_f32_16x16x32_bf16 v[28:31], a[36:39], v[108:111], v[28:31]
  ds_read_b128 v[92:95], v2 offset:46080
  v_cvt_pk_bf16_f32 v66, v72, v73
  v_mfma_f32_16x16x32_bf16 v[32:35], a[36:39], v[76:79], v[32:35]
  v_cvt_pk_bf16_f32 v67, v74, v75
  v_mfma_f32_16x16x32_bf16 v[32:35], a[24:27], v[80:83], v[32:35]
  ds_write_b128 v17, v[64:67] offset:7168
  v_mfma_f32_16x16x32_bf16 v[40:43], a[28:31], v[80:83], v[40:43]
  ds_read_b128 v[100:103], v2 offset:38912
  v_mfma_f32_16x16x32_bf16 v[40:43], a[40:43], v[76:79], v[40:43]
  s_bitcmp1_b32 s44, 0
  s_mov_b32 s52, 0
  s_cselect_b32 s52, 6144, s52
  s_mov_b32 s53, 12288
  s_cselect_b32 s53, 0, s53
  v_mfma_f32_16x16x32_bf16 v[36:39], a[40:43], v[108:111], v[36:39]
  v_add_u32 v116, s52, v19
  v_add_u32 v117, s53, v19
  v_mfma_f32_16x16x32_bf16 v[36:39], a[28:31], v[112:115], v[36:39]
  ds_read_b128 v[104:107], v2 offset:39936
  v_add_u32 v118, s52, v20
  v_mfma_f32_16x16x32_bf16 v[44:47], a[32:35], v[112:115], v[44:47]
  v_add_u32 v119, s53, v20
  v_mfma_f32_16x16x32_bf16 v[44:47], a[44:47], v[108:111], v[44:47]
  s_waitcnt vmcnt(13) lgkmcnt(2)
  s_barrier
  v_mfma_f32_16x16x32_bf16 v[48:51], a[44:47], v[76:79], v[48:51]
  ds_read_b128 v[112:115], v2 offset:47104
  v_mfma_f32_16x16x32_bf16 v[48:51], a[32:35], v[80:83], v[48:51]
  s_waitcnt lgkmcnt(4)
  s_add_u32 m0, s45, 16384
  s_add_u32 s68, s67, 0
  s_and_b32 s68, s68, 7
  s_mul_i32 s68, s68, 262144
  v_mfma_f32_16x16x32_bf16 v[28:31], a[48:51], v[84:87], v[28:31]
  buffer_load_dwordx4 v10, s[16:19], s68 offen lds
  ds_read_b128 v[52:55], v116
  v_mfma_f32_16x16x32_bf16 v[28:31], a[60:63], v[88:91], v[28:31]
  ds_read_b128 v[108:111], v2 offset:48128
  v_mfma_f32_16x16x32_bf16 v[32:35], a[60:63], v[92:95], v[32:35]
  ds_read_b128 v[56:59], v117 offset:1024
  v_mfma_f32_16x16x32_bf16 v[32:35], a[48:51], v[96:99], v[32:35]
  s_add_u32 m0, s45, 20480
  s_add_u32 s68, s68, 65536
  v_mfma_f32_16x16x32_bf16 v[40:43], a[52:55], v[96:99], v[40:43]
  ds_read_b128 v[76:79], v1 offset:32768
  v_mfma_f32_16x16x32_bf16 v[40:43], a[64:67], v[92:95], v[40:43]
  buffer_load_dwordx4 v10, s[16:19], s68 offen lds
  ds_read_b128 v[60:63], v116 offset:1024
  v_mfma_f32_16x16x32_bf16 v[36:39], a[64:67], v[88:91], v[36:39]
  ds_read_b64_tr_b16 v[64:65], v119 offset:2048
  v_mfma_f32_16x16x32_bf16 v[36:39], a[52:55], v[84:87], v[36:39]
  ds_read_b128 v[80:83], v1 offset:33792
  v_mfma_f32_16x16x32_bf16 v[44:47], a[56:59], v[84:87], v[44:47]
  s_add_u32 m0, s45, 24576
  s_add_u32 s68, s68, 65536
HOP3:
  s_cbranch_execz HOP7
  v_mfma_f32_16x16x32_bf16 v[44:47], a[68:71], v[88:91], v[44:47]
  buffer_load_dwordx4 v10, s[16:19], s68 offen lds
  ds_read_b64_tr_b16 v[66:67], v118 offset:2048
  v_mfma_f32_16x16x32_bf16 v[48:51], a[68:71], v[92:95], v[48:51]
  ds_read_b128 v[84:87], v1 offset:40960
  v_mfma_f32_16x16x32_bf16 v[48:51], a[56:59], v[96:99], v[48:51]
  s_waitcnt lgkmcnt(7)
  ds_read_b64_tr_b16 v[68:69], v119 offset:2056
  v_mfma_f32_16x16x32_bf16 v[28:31], a[72:75], v[100:103], v[28:31]
  s_add_u32 m0, s45, 28672
  s_add_u32 s68, s68, 65536
  v_mfma_f32_16x16x32_bf16 v[28:31], a[84:87], v[104:107], v[28:31]
  ds_read_b128 v[88:91], v1 offset:41984
  v_mfma_f32_16x16x32_bf16 v[32:35], a[84:87], v[108:111], v[32:35]
  buffer_load_dwordx4 v10, s[16:19], s68 offen lds
  ds_read_b64_tr_b16 v[70:71], v118 offset:2056
  v_mfma_f32_16x16x32_bf16 v[32:35], a[72:75], v[112:115], v[32:35]
  v_mfma_f32_16x16x32_bf16 v[40:43], a[76:79], v[112:115], v[40:43]
  ds_read_b128 v[92:95], v1 offset:34816
  v_mfma_f32_16x16x32_bf16 v[40:43], a[88:91], v[108:111], v[40:43]
  v_mfma_f32_16x16x32_bf16 v[36:39], a[88:91], v[104:107], v[36:39]
  s_add_u32 m0, s70, 65536
  s_add_u32 s69, s59, 229376
  v_mfma_f32_16x16x32_bf16 v[36:39], a[76:79], v[100:103], v[36:39]
  ds_read_b128 v[96:99], v1 offset:35840
  s_waitcnt lgkmcnt(2)
  v_mfma_f32_16x16x32_bf16 v[116:119], v[56:59], v[52:55], 0
  v_mfma_f32_16x16x32_bf16 v[120:123], v[60:63], v[52:55], 0
  v_mfma_f32_16x16x32_bf16 v[44:47], a[80:83], v[100:103], v[44:47]
  buffer_load_dwordx4 v12, s[8:11], s69 offen offset:0 sc1 lds
  v_mfma_f32_16x16x32_bf16 v[44:47], a[92:95], v[104:107], v[44:47]
  v_mfma_f32_16x16x32_bf16 v[48:51], a[92:95], v[108:111], v[48:51]
  ds_read_b128 v[100:103], v1 offset:43008
  v_mfma_f32_16x16x32_bf16 v[48:51], a[80:83], v[112:115], v[48:51]
  s_waitcnt lgkmcnt(4)
  s_nop 0
  v_cndmask_b32 v72, v116, v120, s[80:81]
  v_cndmask_b32 v73, v117, v121, s[82:83]
  v_mfma_f32_16x16x32_bf16 v[28:31], a[96:99], v[76:79], v[28:31]
  buffer_load_dwordx4 v12, s[8:11], s69 offen offset:1024 sc1 lds
  v_cndmask_b32 v74, v118, v122, s[84:85]
  v_cndmask_b32 v75, v119, v123, s[86:87]
  v_mfma_f32_16x16x32_bf16 v[28:31], a[108:111], v[80:83], v[28:31]
  ds_read_b128 v[104:107], v1 offset:44032
  v_cndmask_b32 v72, v72, v73, s[88:89]
  v_mfma_f32_16x16x32_bf16 v[32:35], a[108:111], v[88:91], v[32:35]
  v_cndmask_b32 v73, v74, v75, s[88:89]
  v_mul_f32 v72, 0x3e8293ee, v72
  v_mfma_f32_16x16x32_bf16 v[32:35], a[96:99], v[84:87], v[32:35]
  v_mul_f32 v73, 0x3e8293ee, v73
  v_max_f32 v74, v72, v73
  v_mfma_f32_16x16x32_bf16 v[40:43], a[100:103], v[84:87], v[40:43]
  ds_read_b128 v[108:111], v1 offset:36864
  v_mov_b32 v75, v74
  v_mfma_f32_16x16x32_bf16 v[40:43], a[112:115], v[88:91], v[40:43]
  buffer_load_dwordx4 v12, s[8:11], s69 offen offset:2048 sc1 lds
  v_permlane16_swap_b32 v74, v75
  v_mfma_f32_16x16x32_bf16 v[36:39], a[112:115], v[80:83], v[36:39]
  v_max_f32 v74, v74, v75
  v_mov_b32 v75, v74
  v_mfma_f32_16x16x32_bf16 v[36:39], a[100:103], v[76:79], v[36:39]
  ds_read_b128 v[112:115], v1 offset:37888
  v_mfma_f32_16x16x32_bf16 v[44:47], a[104:107], v[76:79], v[44:47]
  v_permlane32_swap_b32 v74, v75
  v_mfma_f32_16x16x32_bf16 v[44:47], a[116:119], v[80:83], v[44:47]
  v_max_f32 v74, v74, v75
  v_sub_f32 v72, v72, v74
  v_mfma_f32_16x16x32_bf16 v[48:51], a[116:119], v[88:91], v[48:51]
  ds_read_b128 v[76:79], v1 offset:45056
  v_sub_f32 v73, v73, v74
  v_mfma_f32_16x16x32_bf16 v[48:51], a[104:107], v[84:87], v[48:51]
  s_waitcnt lgkmcnt(3)
  buffer_load_dwordx4 v12, s[8:11], s69 offen offset:3072 sc1 lds
  v_mfma_f32_16x16x32_bf16 v[28:31], a[120:123], v[92:95], v[28:31]
  v_exp_f32 v72, v72
  v_mfma_f32_16x16x32_bf16 v[28:31], a[132:135], v[96:99], v[28:31]
  ds_read_b128 v[80:83], v1 offset:46080
  v_mfma_f32_16x16x32_bf16 v[32:35], a[132:135], v[104:107], v[32:35]
  s_add_u32 m0, s45, 81920
  s_add_u32 s68, s67, 1
  s_and_b32 s68, s68, 7
  s_mul_i32 s68, s68, 262144
  v_mfma_f32_16x16x32_bf16 v[32:35], a[120:123], v[100:103], v[32:35]
  buffer_load_dwordx4 v10, s[16:19], s68 offen lds
  v_exp_f32 v73, v73
  v_mfma_f32_16x16x32_bf16 v[40:43], a[124:127], v[100:103], v[40:43]
  ds_read_b128 v[88:91], v1 offset:38912
  v_add_f32 v74, v72, v73
  v_mfma_f32_16x16x32_bf16 v[40:43], a[136:139], v[104:107], v[40:43]
  v_mov_b32 v75, v74
  v_mfma_f32_16x16x32_bf16 v[36:39], a[136:139], v[96:99], v[36:39]
  s_add_u32 m0, s45, 86016
  s_add_u32 s68, s68, 65536
  v_mfma_f32_16x16x32_bf16 v[36:39], a[124:127], v[92:95], v[36:39]
  ds_read_b128 v[84:87], v1 offset:39936
  v_mfma_f32_16x16x32_bf16 v[44:47], a[128:131], v[92:95], v[44:47]
  buffer_load_dwordx4 v10, s[16:19], s68 offen lds
  v_permlane16_swap_b32 v74, v75
  v_mfma_f32_16x16x32_bf16 v[44:47], a[140:143], v[96:99], v[44:47]
  v_add_f32 v74, v74, v75
  v_mov_b32 v75, v74
  v_mfma_f32_16x16x32_bf16 v[48:51], a[140:143], v[104:107], v[48:51]
  ds_read_b128 v[92:95], v1 offset:47104
  v_mfma_f32_16x16x32_bf16 v[48:51], a[128:131], v[100:103], v[48:51]
  s_waitcnt lgkmcnt(3)
  v_permlane32_swap_b32 v74, v75
  v_mfma_f32_16x16x32_bf16 v[28:31], a[144:147], v[108:111], v[28:31]
  s_add_u32 m0, s45, 90112
  s_add_u32 s68, s68, 65536
  v_add_f32 v74, v74, v75
  v_mfma_f32_16x16x32_bf16 v[28:31], a[156:159], v[112:115], v[28:31]
  ds_read_b128 v[96:99], v1 offset:48128
  v_mfma_f32_16x16x32_bf16 v[32:35], a[156:159], v[80:83], v[32:35]
  buffer_load_dwordx4 v10, s[16:19], s68 offen lds
  v_rcp_f32 v74, v74
  v_mfma_f32_16x16x32_bf16 v[32:35], a[144:147], v[76:79], v[32:35]
  s_waitcnt vmcnt(11)
  s_barrier
  v_mfma_f32_16x16x32_bf16 v[40:43], a[148:151], v[76:79], v[40:43]
  ds_read_b128 v[104:107], v1 offset:49152
  v_mul_f32 v72, v72, v74
  v_add_u32 v15, s46, v0
  s_mov_b64 exec, 1
  buffer_store_dword v15, v0, s[8:11], s79 offen offset:0 sc1
  s_mov_b64 exec, -1
  v_mfma_f32_16x16x32_bf16 v[40:43], a[160:163], v[80:83], v[40:43]
  s_add_u32 m0, s45, 94208
  s_add_u32 s68, s68, 65536
  v_mul_f32 v73, v73, v74
  v_mfma_f32_16x16x32_bf16 v[36:39], a[160:163], v[112:115], v[36:39]
  buffer_load_dwordx4 v10, s[16:19], s68 offen lds
  v_cvt_pk_bf16_f32 v72, v72, v72
  v_cvt_pk_bf16_f32 v73, v73, v73
  v_mfma_f32_16x16x32_bf16 v[36:39], a[148:151], v[108:111], v[36:39]
  ds_read_b128 v[100:103], v1 offset:50176
  v_and_b32 v52, v24, v72
  v_mfma_f32_16x16x32_bf16 v[44:47], a[152:155], v[108:111], v[44:47]
  v_and_b32 v53, v25, v73
  v_and_b32 v54, v26, v72
  v_mfma_f32_16x16x32_bf16 v[44:47], a[164:167], v[112:115], v[44:47]
  v_and_b32 v55, v27, v73
  v_mfma_f32_16x16x32_bf16 v[48:51], a[164:167], v[80:83], v[48:51]
  ds_read_b128 v[108:111], v1 offset:57344
  v_mfma_f32_16x16x32_bf16 v[56:59], v[64:67], v[52:55], 0
  v_mfma_f32_16x16x32_bf16 v[60:63], v[68:71], v[52:55], 0
  v_mfma_f32_16x16x32_bf16 v[48:51], a[152:155], v[76:79], v[48:51]
  s_waitcnt lgkmcnt(3)
  s_add_u32 m0, s70, 98304
  s_add_u32 s69, s60, 229376
  v_mfma_f32_16x16x32_bf16 v[28:31], a[168:171], v[88:91], v[28:31]
  buffer_load_dwordx4 v12, s[8:11], s69 offen offset:0 sc1 lds
  v_mfma_f32_16x16x32_bf16 v[28:31], a[180:183], v[84:87], v[28:31]
  ds_read_b128 v[112:115], v1 offset:58368
  v_mfma_f32_16x16x32_bf16 v[32:35], a[180:183], v[96:99], v[32:35]
  v_cvt_pk_bf16_f32 v116, v56, v57
  v_cvt_pk_bf16_f32 v117, v58, v59
  v_mfma_f32_16x16x32_bf16 v[32:35], a[168:171], v[92:95], v[32:35]
  v_cvt_pk_bf16_f32 v118, v60, v61
  v_cvt_pk_bf16_f32 v119, v62, v63
  v_mfma_f32_16x16x32_bf16 v[40:43], a[172:175], v[92:95], v[40:43]
  ds_read_b128 v[80:83], v1 offset:51200
  v_mfma_f32_16x16x32_bf16 v[40:43], a[184:187], v[96:99], v[40:43]
  buffer_load_dwordx4 v12, s[8:11], s69 offen offset:1024 sc1 lds
  buffer_store_dwordx4 v[116:119], v1, s[8:11], s73 offen sc1
  v_mfma_f32_16x16x32_bf16 v[36:39], a[184:187], v[84:87], v[36:39]
  s_add_u32 s73, s73, 65536
  v_mfma_f32_16x16x32_bf16 v[36:39], a[172:175], v[88:91], v[36:39]
  ds_read_b128 v[76:79], v1 offset:52224
  v_mfma_f32_16x16x32_bf16 v[44:47], a[176:179], v[88:91], v[44:47]
  v_mfma_f32_16x16x32_bf16 v[44:47], a[188:191], v[84:87], v[44:47]
  buffer_load_dwordx4 v12, s[8:11], s69 offen offset:2048 sc1 lds
  v_mfma_f32_16x16x32_bf16 v[48:51], a[188:191], v[96:99], v[48:51]
  ds_read_b128 v[88:91], v1 offset:59392
  v_mfma_f32_16x16x32_bf16 v[48:51], a[176:179], v[92:95], v[48:51]
  s_waitcnt lgkmcnt(3)
  v_mfma_f32_16x16x32_bf16 v[28:31], a[192:195], v[104:107], v[28:31]
  v_mfma_f32_16x16x32_bf16 v[28:31], a[204:207], v[100:103], v[28:31]
  ds_read_b128 v[84:87], v1 offset:60416
  v_mfma_f32_16x16x32_bf16 v[32:35], a[204:207], v[112:115], v[32:35]
  buffer_load_dwordx4 v12, s[8:11], s69 offen offset:3072 sc1 lds
  v_mfma_f32_16x16x32_bf16 v[32:35], a[192:195], v[108:111], v[32:35]
  v_mfma_f32_16x16x32_bf16 v[40:43], a[196:199], v[108:111], v[40:43]
  ds_read_b128 v[96:99], v1 offset:53248
  v_mfma_f32_16x16x32_bf16 v[40:43], a[208:211], v[112:115], v[40:43]
  v_mfma_f32_16x16x32_bf16 v[36:39], a[208:211], v[100:103], v[36:39]
  v_lshrrev_b32 v116, 3, v0
  v_bfe_u32 v117, v116, 1, 2
  v_mfma_f32_16x16x32_bf16 v[36:39], a[196:199], v[104:107], v[36:39]
  ds_read_b128 v[92:95], v1 offset:54272
  v_bfe_u32 v118, v0, 1, 2
  v_mfma_f32_16x16x32_bf16 v[44:47], a[200:203], v[104:107], v[44:47]
  v_xor_b32 v117, v117, v118
  s_lshl_b32 s52, s44, 3
  v_mfma_f32_16x16x32_bf16 v[44:47], a[212:215], v[100:103], v[44:47]
  v_add_u32 v116, s52, v116
  v_mul_u32_u24 v116, 7168, v116
  v_mfma_f32_16x16x32_bf16 v[48:51], a[212:215], v[112:115], v[48:51]
  ds_read_b128 v[104:107], v1 offset:61440
  v_and_b32 v118, 1, v0
  v_mfma_f32_16x16x32_bf16 v[48:51], a[200:203], v[108:111], v[48:51]
  s_waitcnt lgkmcnt(3)
  v_lshl_add_u32 v116, v118, 4, v116
  s_and_b32 s52, s2, 7
  v_mfma_f32_16x16x32_bf16 v[28:31], a[216:219], v[80:83], v[28:31]
  s_mul_i32 s52, s52, 896
  v_add_u32 v116, s52, v116
  v_lshlrev_b32 v118, 5, v117
  v_mfma_f32_16x16x32_bf16 v[28:31], a[228:231], v[76:79], v[28:31]
  ds_read_b128 v[100:103], v1 offset:62464
  s_and_b32 s53, s2, 24
  v_mfma_f32_16x16x32_bf16 v[32:35], a[228:231], v[84:87], v[32:35]
  s_lshl_b32 s52, s53, 5
  v_add3_u32 v16, v116, v118, s52
  s_lshr_b32 s52, 0x0b070602, s53
  v_mfma_f32_16x16x32_bf16 v[32:35], a[216:219], v[88:91], v[32:35]
  s_and_b32 s52, s52, 15
  s_lshl_b32 s52, s52, 6
  v_add_u32 v118, s52, v118
  v_mfma_f32_16x16x32_bf16 v[40:43], a[220:223], v[88:91], v[40:43]
  ds_read_b128 v[112:115], v1 offset:55296
  s_lshr_b32 s52, 0x15140706, s53
  v_mfma_f32_16x16x32_bf16 v[40:43], a[232:235], v[84:87], v[40:43]
  s_and_b32 s52, s52, 31
  s_lshl_b32 s52, s52, 5
  v_mov_b32 v119, s52
  v_mfma_f32_16x16x32_bf16 v[36:39], a[232:235], v[76:79], v[36:39]
  v_cmp_gt_u32 vcc, 2, v117
  s_nop 1
  v_cndmask_b32 v118, v119, v118, vcc
  v_mfma_f32_16x16x32_bf16 v[36:39], a[220:223], v[80:83], v[36:39]
  ds_read_b128 v[108:111], v1 offset:56320
  v_add_u32 v11, v116, v118
  v_mfma_f32_16x16x32_bf16 v[44:47], a[224:227], v[80:83], v[44:47]
  v_add_u32 v117, 1, v117
  v_lshrrev_b32 v117, 2, v117
  v_mfma_f32_16x16x32_bf16 v[44:47], a[236:239], v[76:79], v[44:47]
  v_lshl_add_u32 v11, v117, 30, v11
  v_mfma_f32_16x16x32_bf16 v[48:51], a[236:239], v[84:87], v[48:51]
  ds_read_b128 v[80:83], v1 offset:63488
  v_mfma_f32_16x16x32_bf16 v[48:51], a[224:227], v[88:91], v[48:51]
  s_waitcnt lgkmcnt(3)
  v_mfma_f32_16x16x32_bf16 v[28:31], a[240:243], v[96:99], v[28:31]
  v_mfma_f32_16x16x32_bf16 v[28:31], v[124:127], v[92:95], v[28:31]
  ds_read_b128 v[76:79], v1 offset:64512
  v_mfma_f32_16x16x32_bf16 v[32:35], v[124:127], v[100:103], v[32:35]
  v_mfma_f32_16x16x32_bf16 v[32:35], a[240:243], v[104:107], v[32:35]
  s_waitcnt vmcnt(23)
  s_barrier
  v_mfma_f32_16x16x32_bf16 v[40:43], a[244:247], v[104:107], v[40:43]
  ds_read_b128 v[84:87], v2 offset:49152
  s_add_u32 m0, s45, 32768
  s_add_u32 s68, s67, 2
  s_and_b32 s68, s68, 7
  s_mul_i32 s68, s68, 262144
  v_mfma_f32_16x16x32_bf16 v[40:43], v[128:131], v[100:103], v[40:43]
  buffer_load_dwordx4 v10, s[16:19], s68 offen lds
  v_mfma_f32_16x16x32_bf16 v[36:39], v[128:131], v[92:95], v[36:39]
  v_mfma_f32_16x16x32_bf16 v[36:39], a[244:247], v[96:99], v[36:39]
  ds_read_b128 v[88:91], v2 offset:50176
  v_mfma_f32_16x16x32_bf16 v[44:47], a[248:251], v[96:99], v[44:47]
  v_mfma_f32_16x16x32_bf16 v[44:47], v[132:135], v[92:95], v[44:47]
  s_add_u32 m0, s45, 36864
  s_add_u32 s68, s68, 65536
  v_mfma_f32_16x16x32_bf16 v[48:51], v[132:135], v[100:103], v[48:51]
  ds_read_b128 v[96:99], v2 offset:57344
  v_mfma_f32_16x16x32_bf16 v[48:51], a[248:251], v[104:107], v[48:51]
  s_waitcnt lgkmcnt(3)
  buffer_load_dwordx4 v10, s[16:19], s68 offen lds
  v_mfma_f32_16x16x32_bf16 v[28:31], v[136:139], v[112:115], v[28:31]
  v_mfma_f32_16x16x32_bf16 v[28:31], v[148:151], v[108:111], v[28:31]
  ds_read_b128 v[92:95], v2 offset:58368
  v_mfma_f32_16x16x32_bf16 v[32:35], v[148:151], v[76:79], v[32:35]
  s_add_u32 m0, s45, 40960
  s_add_u32 s68, s68, 65536
  v_mfma_f32_16x16x32_bf16 v[32:35], v[136:139], v[80:83], v[32:35]
  buffer_load_dwordx4 v10, s[16:19], s68 offen lds
  v_mfma_f32_16x16x32_bf16 v[40:43], v[140:143], v[80:83], v[40:43]
  ds_read_b128 v[100:103], v2 offset:51200
  v_mfma_f32_16x16x32_bf16 v[40:43], v[152:155], v[76:79], v[40:43]
  s_add_u32 m0, s45, 45056
  s_add_u32 s68, s68, 65536
  v_mfma_f32_16x16x32_bf16 v[36:39], v[152:155], v[108:111], v[36:39]
  buffer_load_dwordx4 v10, s[16:19], s68 offen lds
  v_mfma_f32_16x16x32_bf16 v[36:39], v[140:143], v[112:115], v[36:39]
  ds_read_b128 v[104:107], v2 offset:52224
  v_mfma_f32_16x16x32_bf16 v[44:47], v[144:147], v[112:115], v[44:47]
  v_mfma_f32_16x16x32_bf16 v[44:47], v[156:159], v[108:111], v[44:47]
  v_mfma_f32_16x16x32_bf16 v[48:51], v[156:159], v[76:79], v[48:51]
  ds_read_b128 v[112:115], v2 offset:59392
  s_cmp_gt_u32 s44, 1
  s_cbranch_scc1 TH4_adaLN_cond__sliding_local_dilated__swiglu_ffn__prompt_kernel
  s_cmp_eq_u32 s44, 0
  s_cselect_b64 s[4:5], s[28:29], s[32:33]
  s_lshr_b32 s57, s2, 3
  s_mul_i32 s57, s57, 57344
  s_and_b32 vcc_lo, s2, 7
  s_mul_i32 vcc_lo, vcc_lo, 896
  s_add_u32 s57, s57, vcc_lo
  v_lshrrev_b32 v15, 3, v0
  v_mul_u32_u24 v15, 6144, v15
  v_lshl_add_u32 v15, v0, 7, v15
  s_mov_b32 exec_lo, 0x7f7f7f7f
  s_mov_b32 exec_hi, 0x7f7f7f7f
  buffer_load_dword a253, v15, s[4:7], s57 offen
  s_mov_b64 exec, -1
TH4_adaLN_cond__sliding_local_dilated__swiglu_ffn__prompt_kernel:
  v_mfma_f32_16x16x32_bf16 v[48:51], v[144:147], v[80:83], v[48:51]
  s_waitcnt lgkmcnt(3)
  v_mfma_f32_16x16x32_bf16 v[28:31], v[160:163], v[84:87], v[28:31]
  v_mfma_f32_16x16x32_bf16 v[28:31], v[172:175], v[88:91], v[28:31]
  ds_read_b128 v[108:111], v2 offset:60416
  v_mfma_f32_16x16x32_bf16 v[32:35], v[172:175], v[92:95], v[32:35]
  v_mfma_f32_16x16x32_bf16 v[32:35], v[160:163], v[96:99], v[32:35]
  v_mfma_f32_16x16x32_bf16 v[40:43], v[164:167], v[96:99], v[40:43]
  ds_read_b128 v[76:79], v2 offset:53248
  v_mfma_f32_16x16x32_bf16 v[40:43], v[176:179], v[92:95], v[40:43]
  v_mfma_f32_16x16x32_bf16 v[36:39], v[176:179], v[88:91], v[36:39]
  v_mfma_f32_16x16x32_bf16 v[36:39], v[164:167], v[84:87], v[36:39]
  ds_read_b128 v[80:83], v2 offset:54272
  v_mfma_f32_16x16x32_bf16 v[44:47], v[168:171], v[84:87], v[44:47]
  v_mfma_f32_16x16x32_bf16 v[44:47], v[180:183], v[88:91], v[44:47]
  v_mfma_f32_16x16x32_bf16 v[48:51], v[180:183], v[92:95], v[48:51]
  ds_read_b128 v[84:87], v2 offset:61440
  v_mfma_f32_16x16x32_bf16 v[48:51], v[168:171], v[96:99], v[48:51]
  s_waitcnt lgkmcnt(3)
  v_mfma_f32_16x16x32_bf16 v[28:31], v[184:187], v[100:103], v[28:31]
  v_mfma_f32_16x16x32_bf16 v[28:31], v[196:199], v[104:107], v[28:31]
  ds_read_b128 v[88:91], v2 offset:62464
  v_mfma_f32_16x16x32_bf16 v[32:35], v[196:199], v[108:111], v[32:35]
  v_mfma_f32_16x16x32_bf16 v[32:35], v[184:187], v[112:115], v[32:35]
  v_mfma_f32_16x16x32_bf16 v[40:43], v[188:191], v[112:115], v[40:43]
  ds_read_b128 v[92:95], v2 offset:55296
  v_mfma_f32_16x16x32_bf16 v[40:43], v[200:203], v[108:111], v[40:43]
  v_mfma_f32_16x16x32_bf16 v[36:39], v[200:203], v[104:107], v[36:39]
  v_mfma_f32_16x16x32_bf16 v[36:39], v[188:191], v[100:103], v[36:39]
  ds_read_b128 v[96:99], v2 offset:56320
  v_mfma_f32_16x16x32_bf16 v[44:47], v[192:195], v[100:103], v[44:47]
  v_mfma_f32_16x16x32_bf16 v[44:47], v[204:207], v[104:107], v[44:47]
  v_mfma_f32_16x16x32_bf16 v[48:51], v[204:207], v[108:111], v[48:51]
  ds_read_b128 v[100:103], v2 offset:63488
  v_mfma_f32_16x16x32_bf16 v[48:51], v[192:195], v[112:115], v[48:51]
  s_waitcnt lgkmcnt(3)
  v_mfma_f32_16x16x32_bf16 v[28:31], v[208:211], v[76:79], v[28:31]
  v_mfma_f32_16x16x32_bf16 v[28:31], v[220:223], v[80:83], v[28:31]
  ds_read_b128 v[104:107], v2 offset:64512
  v_mfma_f32_16x16x32_bf16 v[32:35], v[220:223], v[88:91], v[32:35]
  v_mfma_f32_16x16x32_bf16 v[32:35], v[208:211], v[84:87], v[32:35]
  s_waitcnt vmcnt(6)
  s_barrier
  v_add_u32 v15, s46, v0
  v_add_u32 v15, 1, v15
  s_mov_b64 exec, 1
  buffer_store_dword v15, v0, s[8:11], s74 offen offset:0 sc1
  s_mov_b64 exec, -1
  v_mfma_f32_16x16x32_bf16 v[40:43], v[212:215], v[84:87], v[40:43]
  ds_read_b128 v[108:111], v1 offset:0
  s_add_u32 m0, s45, 49152
  s_add_u32 s68, s67, 3
  s_and_b32 s68, s68, 7
  s_mul_i32 s68, s68, 262144
  v_mfma_f32_16x16x32_bf16 v[40:43], v[224:227], v[88:91], v[40:43]
  buffer_load_dwordx4 v10, s[16:19], s68 offen lds
  v_mfma_f32_16x16x32_bf16 v[36:39], v[224:227], v[80:83], v[36:39]
  s_add_u32 m0, s45, 53248
  s_add_u32 s68, s68, 65536
  v_mfma_f32_16x16x32_bf16 v[36:39], v[212:215], v[76:79], v[36:39]
  ds_read_b128 v[112:115], v1 offset:1024
  v_mfma_f32_16x16x32_bf16 v[44:47], v[216:219], v[76:79], v[44:47]
  buffer_load_dwordx4 v10, s[16:19], s68 offen lds
  v_mfma_f32_16x16x32_bf16 v[44:47], v[228:231], v[80:83], v[44:47]
  v_mfma_f32_16x16x32_bf16 v[48:51], v[228:231], v[88:91], v[48:51]
  ds_read_b128 v[76:79], v1 offset:8192
  v_mfma_f32_16x16x32_bf16 v[48:51], v[216:219], v[84:87], v[48:51]
  s_waitcnt lgkmcnt(3)
  s_add_u32 m0, s45, 57344
  s_add_u32 s68, s68, 65536
  v_mfma_f32_16x16x32_bf16 v[28:31], v[232:235], v[92:95], v[28:31]
  buffer_load_dwordx4 v10, s[16:19], s68 offen lds
  s_add_u32 m0, s45, 61440
  s_add_u32 s68, s68, 65536
  v_mfma_f32_16x16x32_bf16 v[28:31], v[244:247], v[96:99], v[28:31]
  ds_read_b128 v[80:83], v1 offset:9216
  v_mfma_f32_16x16x32_bf16 v[32:35], v[244:247], v[104:107], v[32:35]
  buffer_load_dwordx4 v10, s[16:19], s68 offen lds
  v_mfma_f32_16x16x32_bf16 v[32:35], v[232:235], v[100:103], v[32:35]
  v_mfma_f32_16x16x32_bf16 v[40:43], v[236:239], v[100:103], v[40:43]
  ds_read_b128 v[88:91], v1 offset:2048
  v_mfma_f32_16x16x32_bf16 v[40:43], v[248:251], v[104:107], v[40:43]
  v_mfma_f32_16x16x32_bf16 v[36:39], v[248:251], v[96:99], v[36:39]
  v_mfma_f32_16x16x32_bf16 v[36:39], v[236:239], v[92:95], v[36:39]
  ds_read_b128 v[84:87], v1 offset:3072
  v_mfma_f32_16x16x32_bf16 v[44:47], v[240:243], v[92:95], v[44:47]
  v_mfma_f32_16x16x32_bf16 v[44:47], v[252:255], v[96:99], v[44:47]
  v_mfma_f32_16x16x32_bf16 v[48:51], v[252:255], v[104:107], v[48:51]
  ds_read_b128 v[92:95], v1 offset:10240
  v_mfma_f32_16x16x32_bf16 v[48:51], v[240:243], v[100:103], v[48:51]
  s_waitcnt lgkmcnt(3)
  v_mfma_f32_16x16x32_bf16 v[52:55], a[0:3], v[108:111], 0
  v_mfma_f32_16x16x32_bf16 v[52:55], a[12:15], v[112:115], v[52:55]
  ds_read_b128 v[96:99], v1 offset:11264
  v_mfma_f32_16x16x32_bf16 v[56:59], a[12:15], v[80:83], 0
  v_mfma_f32_16x16x32_bf16 v[56:59], a[0:3], v[76:79], v[56:59]
  v_cvt_pk_bf16_f32 v28, v28, v29
  v_cvt_pk_bf16_f32 v29, v30, v31
  v_mfma_f32_16x16x32_bf16 v[64:67], a[4:7], v[76:79], 0
  ds_read_b128 v[104:107], v1 offset:4096
  v_mfma_f32_16x16x32_bf16 v[64:67], a[16:19], v[80:83], v[64:67]
  ds_write_b64 v18, v[28:29] offset:12288
  v_mfma_f32_16x16x32_bf16 v[60:63], a[16:19], v[112:115], 0
  v_cvt_pk_bf16_f32 v36, v36, v37
  v_cvt_pk_bf16_f32 v37, v38, v39
  v_mfma_f32_16x16x32_bf16 v[60:63], a[4:7], v[108:111], v[60:63]
  ds_read_b128 v[100:103], v1 offset:5120
  v_cvt_pk_bf16_f32 v38, v44, v45
  v_cvt_pk_bf16_f32 v39, v46, v47
  v_mfma_f32_16x16x32_bf16 v[68:71], a[8:11], v[108:111], 0
  ds_write_b128 v17, v[36:39] offset:13312
  v_mfma_f32_16x16x32_bf16 v[68:71], a[20:23], v[112:115], v[68:71]
  v_cvt_pk_bf16_f32 v32, v32, v33
  v_cvt_pk_bf16_f32 v33, v34, v35
  v_mfma_f32_16x16x32_bf16 v[72:75], a[20:23], v[80:83], 0
  ds_read_b128 v[108:111], v1 offset:12288
  v_mfma_f32_16x16x32_bf16 v[72:75], a[8:11], v[76:79], v[72:75]
  s_waitcnt lgkmcnt(5)
  ds_write_b64 v18, v[32:33] offset:0
  v_mfma_f32_16x16x32_bf16 v[52:55], a[24:27], v[88:91], v[52:55]
  v_cvt_pk_bf16_f32 v40, v40, v41
  v_cvt_pk_bf16_f32 v41, v42, v43
  v_mfma_f32_16x16x32_bf16 v[52:55], a[36:39], v[84:87], v[52:55]
  ds_read_b128 v[112:115], v1 offset:13312
  v_cvt_pk_bf16_f32 v42, v48, v49
  v_mfma_f32_16x16x32_bf16 v[56:59], a[36:39], v[96:99], v[56:59]
  v_cvt_pk_bf16_f32 v43, v50, v51
  v_mfma_f32_16x16x32_bf16 v[56:59], a[24:27], v[92:95], v[56:59]
  ds_write_b128 v17, v[40:43] offset:1024
  v_mfma_f32_16x16x32_bf16 v[64:67], a[28:31], v[92:95], v[64:67]
  ds_read_b128 v[80:83], v1 offset:6144
  v_mfma_f32_16x16x32_bf16 v[64:67], a[40:43], v[96:99], v[64:67]
  s_bitcmp1_b32 s44, 0
  s_mov_b32 s52, 12288
  s_cselect_b32 s52, 0, s52
  s_mov_b32 s53, 6144
  s_cselect_b32 s53, 12288, s53
  v_mfma_f32_16x16x32_bf16 v[60:63], a[40:43], v[84:87], v[60:63]
  v_add_u32 v116, s52, v19
  v_add_u32 v117, s53, v19
  v_mfma_f32_16x16x32_bf16 v[60:63], a[28:31], v[88:91], v[60:63]
  ds_read_b128 v[76:79], v1 offset:7168
  v_add_u32 v118, s52, v20
  v_mfma_f32_16x16x32_bf16 v[68:71], a[32:35], v[88:91], v[68:71]
  v_add_u32 v119, s53, v20
  v_mfma_f32_16x16x32_bf16 v[68:71], a[44:47], v[84:87], v[68:71]
  s_waitcnt vmcnt(19) lgkmcnt(2)
  s_barrier
  v_mfma_f32_16x16x32_bf16 v[72:75], a[44:47], v[96:99], v[72:75]
  ds_read_b128 v[88:91], v1 offset:14336
  s_add_u32 m0, s45, 114688
  s_add_u32 s68, s67, 4
  s_and_b32 s68, s68, 7
  s_mul_i32 s68, s68, 262144
  v_mfma_f32_16x16x32_bf16 v[72:75], a[32:35], v[92:95], v[72:75]
  s_waitcnt lgkmcnt(4)
  buffer_load_dwordx4 v10, s[16:19], s68 offen lds
  ds_read_b128 v[28:31], v116
  v_mfma_f32_16x16x32_bf16 v[52:55], a[48:51], v[104:107], v[52:55]
  ds_read_b64_tr_b16 a[0:1], v4 offset:16384
  ds_read_b128 v[32:35], v117 offset:1024
  v_mfma_f32_16x16x32_bf16 v[52:55], a[60:63], v[100:103], v[52:55]
  ds_read_b128 v[84:87], v1 offset:15360
  s_add_u32 m0, s45, 118784
  s_add_u32 s68, s68, 65536
  v_mfma_f32_16x16x32_bf16 v[56:59], a[60:63], v[112:115], v[56:59]
  ds_read_b64_tr_b16 a[2:3], v4 offset:18432
  buffer_load_dwordx4 v10, s[16:19], s68 offen lds
  v_mfma_f32_16x16x32_bf16 v[56:59], a[48:51], v[108:111], v[56:59]
  ds_read_b64_tr_b16 a[4:5], v5 offset:16384
  ds_read_b128 v[36:39], v116 offset:1024
  v_mfma_f32_16x16x32_bf16 v[64:67], a[52:55], v[108:111], v[64:67]
  ds_read_b128 v[96:99], v2 offset:0
  s_add_u32 m0, s45, 122880
  s_add_u32 s68, s68, 65536
  v_mfma_f32_16x16x32_bf16 v[64:67], a[64:67], v[112:115], v[64:67]
  ds_read_b64_tr_b16 a[6:7], v5 offset:18432
  buffer_load_dwordx4 v10, s[16:19], s68 offen lds
  v_mfma_f32_16x16x32_bf16 v[60:63], a[64:67], v[100:103], v[60:63]
  ds_read_b64_tr_b16 a[8:9], v4 offset:20480
  ds_read_b64_tr_b16 v[40:41], v119 offset:2048
  v_mfma_f32_16x16x32_bf16 v[60:63], a[52:55], v[104:107], v[60:63]
  ds_read_b128 v[92:95], v2 offset:1024
  s_add_u32 m0, s45, 126976
  s_add_u32 s68, s68, 65536
  v_mfma_f32_16x16x32_bf16 v[68:71], a[56:59], v[104:107], v[68:71]
  ds_read_b64_tr_b16 a[10:11], v4 offset:22528
  buffer_load_dwordx4 v10, s[16:19], s68 offen lds
  v_mfma_f32_16x16x32_bf16 v[68:71], a[68:71], v[100:103], v[68:71]
  ds_read_b64_tr_b16 a[12:13], v5 offset:20480
  ds_read_b64_tr_b16 v[42:43], v118 offset:2048
  v_mfma_f32_16x16x32_bf16 v[72:75], a[68:71], v[112:115], v[72:75]
  ds_read_b128 v[104:107], v2 offset:8192
  ds_read_b64_tr_b16 v[44:45], v119 offset:2056
  v_mfma_f32_16x16x32_bf16 v[72:75], a[56:59], v[108:111], v[72:75]
  s_waitcnt lgkmcnt(13)
  ds_read_b64_tr_b16 a[14:15], v5 offset:22528
  v_mfma_f32_16x16x32_bf16 v[52:55], a[72:75], v[80:83], v[52:55]
  ds_read_b64_tr_b16 a[16:17], v4 offset:24576
  ds_read_b64_tr_b16 v[46:47], v118 offset:2056
  v_mfma_f32_16x16x32_bf16 v[52:55], a[84:87], v[76:79], v[52:55]
  ds_read_b128 v[100:103], v2 offset:9216
  v_mfma_f32_16x16x32_bf16 v[56:59], a[84:87], v[84:87], v[56:59]
  ds_read_b64_tr_b16 a[18:19], v4 offset:26624
  v_mfma_f32_16x16x32_bf16 v[56:59], a[72:75], v[88:91], v[56:59]
  ds_read_b64_tr_b16 a[20:21], v5 offset:24576
  v_mfma_f32_16x16x32_bf16 v[64:67], a[76:79], v[88:91], v[64:67]
  ds_read_b128 v[112:115], v2 offset:2048
  v_mfma_f32_16x16x32_bf16 v[64:67], a[88:91], v[84:87], v[64:67]
  ds_read_b64_tr_b16 a[22:23], v5 offset:26624
  s_waitcnt lgkmcnt(5)
  v_mfma_f32_16x16x32_bf16 v[116:119], v[32:35], v[28:31], 0
  v_mfma_f32_16x16x32_bf16 v[120:123], v[36:39], v[28:31], 0
  v_mfma_f32_16x16x32_bf16 v[60:63], a[88:91], v[76:79], v[60:63]
  ds_read_b64_tr_b16 a[24:25], v4 offset:28672
  v_mfma_f32_16x16x32_bf16 v[60:63], a[76:79], v[80:83], v[60:63]
  ds_read_b128 v[108:111], v2 offset:3072
  v_mfma_f32_16x16x32_bf16 v[68:71], a[80:83], v[80:83], v[68:71]
  ds_read_b64_tr_b16 a[26:27], v4 offset:30720
  v_mfma_f32_16x16x32_bf16 v[68:71], a[92:95], v[76:79], v[68:71]
  ds_read_b64_tr_b16 a[28:29], v5 offset:28672
  v_cndmask_b32 v48, v116, v120, s[80:81]
  v_cndmask_b32 v49, v117, v121, s[82:83]
  v_mfma_f32_16x16x32_bf16 v[72:75], a[92:95], v[84:87], v[72:75]
  ds_read_b128 v[80:83], v2 offset:10240
  v_cndmask_b32 v50, v118, v122, s[84:85]
  v_cndmask_b32 v51, v119, v123, s[86:87]
  v_mfma_f32_16x16x32_bf16 v[72:75], a[80:83], v[88:91], v[72:75]
  s_waitcnt lgkmcnt(9)
  ds_read_b64_tr_b16 a[30:31], v5 offset:30720
  v_cndmask_b32 v48, v48, v49, s[88:89]
  v_mfma_f32_16x16x32_bf16 v[52:55], a[96:99], v[96:99], v[52:55]
  s_lshl_b32 s57, s44, 28
  s_add_u32 s57, s57, s77
  buffer_load_dword v13, v14, s[8:11], s57 offen sc1
  v_cndmask_b32 v49, v50, v51, s[88:89]
  v_mfma_f32_16x16x32_bf16 v[52:55], a[108:111], v[92:95], v[52:55]
  ds_read_b128 v[76:79], v2 offset:11264
  v_mul_f32 v48, 0x3e8293ee, v48
  v_mul_f32 v49, 0x3e8293ee, v49
  v_mfma_f32_16x16x32_bf16 v[56:59], a[108:111], v[100:103], v[56:59]
  v_max_f32 v50, v48, v49
  v_mov_b32 v51, v50
  v_mfma_f32_16x16x32_bf16 v[56:59], a[96:99], v[104:107], v[56:59]
  s_nop 0
  v_permlane16_swap_b32 v50, v51
  v_max_f32 v50, v50, v51
  v_mfma_f32_16x16x32_bf16 v[64:67], a[100:103], v[104:107], v[64:67]
  ds_read_b128 v[84:87], v2 offset:4096
  s_waitcnt vmcnt(14)
  s_barrier
  v_mfma_f32_16x16x32_bf16 v[64:67], a[112:115], v[100:103], v[64:67]
  ds_read_b64_tr_b16 a[32:33], v7 offset:16384
  s_add_u32 m0, s70, 0
  s_add_u32 s69, s61, 229376
  v_mfma_f32_16x16x32_bf16 v[60:63], a[112:115], v[92:95], v[60:63]
  ds_read_b64_tr_b16 a[34:35], v7 offset:18432
  buffer_load_dwordx4 v12, s[8:11], s69 offen offset:0 sc1 lds
  v_mov_b32 v51, v50
  v_mfma_f32_16x16x32_bf16 v[60:63], a[100:103], v[96:99], v[60:63]
  ds_read_b128 v[88:91], v2 offset:5120
  v_permlane32_swap_b32 v50, v51
  v_mfma_f32_16x16x32_bf16 v[68:71], a[104:107], v[96:99], v[68:71]
  ds_read_b64_tr_b16 a[36:37], v8 offset:16384
  v_max_f32 v50, v50, v51
  v_sub_f32 v48, v48, v50
  v_mfma_f32_16x16x32_bf16 v[68:71], a[116:119], v[92:95], v[68:71]
HOP4:
  s_cbranch_execz HOP8
  ds_read_b64_tr_b16 a[38:39], v8 offset:18432
  buffer_load_dwordx4 v12, s[8:11], s69 offen offset:1024 sc1 lds
  v_sub_f32 v49, v49, v50
  v_mfma_f32_16x16x32_bf16 v[72:75], a[116:119], v[100:103], v[72:75]
  ds_read_b128 v[96:99], v2 offset:12288
  v_exp_f32 v48, v48
  v_mfma_f32_16x16x32_bf16 v[72:75], a[104:107], v[104:107], v[72:75]
  s_waitcnt lgkmcnt(7)
  ds_read_b64_tr_b16 a[40:41], v7 offset:20480
  v_mfma_f32_16x16x32_bf16 v[52:55], a[120:123], v[112:115], v[52:55]
  ds_read_b64_tr_b16 a[42:43], v7 offset:22528
  buffer_load_dwordx4 v12, s[8:11], s69 offen offset:2048 sc1 lds
  v_mfma_f32_16x16x32_bf16 v[52:55], a[132:135], v[108:111], v[52:55]
  ds_read_b128 v[92:95], v2 offset:13312
  v_exp_f32 v49, v49
  v_mfma_f32_16x16x32_bf16 v[56:59], a[132:135], v[76:79], v[56:59]
  ds_read_b64_tr_b16 a[44:45], v8 offset:20480
  v_add_f32 v50, v48, v49
  v_mov_b32 v51, v50
  v_mfma_f32_16x16x32_bf16 v[56:59], a[120:123], v[80:83], v[56:59]
  ds_read_b64_tr_b16 a[46:47], v8 offset:22528
  buffer_load_dwordx4 v12, s[8:11], s69 offen offset:3072 sc1 lds
  v_mfma_f32_16x16x32_bf16 v[64:67], a[124:127], v[80:83], v[64:67]
  ds_read_b128 v[100:103], v2 offset:6144
  v_permlane16_swap_b32 v50, v51
  v_mfma_f32_16x16x32_bf16 v[64:67], a[136:139], v[76:79], v[64:67]
  ds_read_b64_tr_b16 a[48:49], v7 offset:24576
  v_add_f32 v50, v50, v51
  v_mov_b32 v51, v50
  v_mfma_f32_16x16x32_bf16 v[60:63], a[136:139], v[108:111], v[60:63]
  ds_read_b64_tr_b16 a[50:51], v7 offset:26624
  v_permlane32_swap_b32 v50, v51
  v_mfma_f32_16x16x32_bf16 v[60:63], a[124:127], v[112:115], v[60:63]
  ds_read_b128 v[104:107], v2 offset:7168
  v_add_f32 v50, v50, v51
  v_mfma_f32_16x16x32_bf16 v[68:71], a[128:131], v[112:115], v[68:71]
  ds_read_b64_tr_b16 a[52:53], v8 offset:24576
  v_rcp_f32 v50, v50
  v_mfma_f32_16x16x32_bf16 v[68:71], a[140:143], v[108:111], v[68:71]
  ds_read_b64_tr_b16 a[54:55], v8 offset:26624
  v_mul_f32 v48, v48, v50
  v_mul_f32 v49, v49, v50
  v_mfma_f32_16x16x32_bf16 v[72:75], a[140:143], v[76:79], v[72:75]
  ds_read_b128 v[112:115], v2 offset:14336
  v_cvt_pk_bf16_f32 v48, v48, v48
  v_cvt_pk_bf16_f32 v49, v49, v49
  v_mfma_f32_16x16x32_bf16 v[72:75], a[128:131], v[80:83], v[72:75]
  s_waitcnt lgkmcnt(9)
  ds_read_b64_tr_b16 a[56:57], v7 offset:28672
  v_and_b32 v28, v24, v48
  v_mfma_f32_16x16x32_bf16 v[52:55], a[144:147], v[84:87], v[52:55]
  ds_read_b64_tr_b16 a[58:59], v7 offset:30720
  v_and_b32 v29, v25, v49
  v_and_b32 v30, v26, v48
  v_mfma_f32_16x16x32_bf16 v[52:55], a[156:159], v[88:91], v[52:55]
  ds_read_b128 v[108:111], v2 offset:15360
  v_and_b32 v31, v27, v49
  v_mfma_f32_16x16x32_bf16 v[56:59], a[156:159], v[92:95], v[56:59]
  ds_read_b64_tr_b16 a[60:61], v8 offset:28672
  v_mfma_f32_16x16x32_bf16 v[32:35], v[40:43], v[28:31], 0
  v_mfma_f32_16x16x32_bf16 v[36:39], v[44:47], v[28:31], 0
  v_mfma_f32_16x16x32_bf16 v[56:59], a[144:147], v[96:99], v[56:59]
  ds_read_b64_tr_b16 a[62:63], v8 offset:30720
  v_mfma_f32_16x16x32_bf16 v[64:67], a[148:151], v[96:99], v[64:67]
  ds_read_b128 v[76:79], v2 offset:32768
  v_mfma_f32_16x16x32_bf16 v[64:67], a[160:163], v[92:95], v[64:67]
  v_mfma_f32_16x16x32_bf16 v[60:63], a[160:163], v[88:91], v[60:63]
  s_nop 0
  v_cvt_pk_bf16_f32 v116, v32, v33
  v_cvt_pk_bf16_f32 v117, v34, v35
  v_cvt_pk_bf16_f32 v118, v36, v37
  v_mfma_f32_16x16x32_bf16 v[60:63], a[148:151], v[84:87], v[60:63]
  ds_read_b128 v[80:83], v2 offset:33792
  v_cvt_pk_bf16_f32 v119, v38, v39
  v_mfma_f32_16x16x32_bf16 v[68:71], a[152:155], v[84:87], v[68:71]
  buffer_store_dwordx4 v[116:119], v1, s[8:11], s73 offen sc1
  v_mfma_f32_16x16x32_bf16 v[68:71], a[164:167], v[88:91], v[68:71]
  s_add_u32 s73, s73, 65536
  v_mfma_f32_16x16x32_bf16 v[72:75], a[164:167], v[92:95], v[72:75]
  ds_read_b128 v[84:87], v2 offset:40960
  v_mfma_f32_16x16x32_bf16 v[72:75], a[152:155], v[96:99], v[72:75]
  s_waitcnt lgkmcnt(5)
  s_waitcnt vmcnt(5)
  s_cmp_lg_u32 s44, 0
  s_cbranch_scc1 PL5_adaLN_cond__sliding_local_dilated__swiglu_ffn__prompt_kernelx
  v_subrev_u32 v13, s46, v13
  v_subrev_u32 v13, 1, v13
  v_cmp_lt_u32 vcc, 3, v13
  s_nop 4
  s_cbranch_vccz PL5_adaLN_cond__sliding_local_dilated__swiglu_ffn__prompt_kernelx
  s_mov_b32 s57, 60000
PL5_adaLN_cond__sliding_local_dilated__swiglu_ffn__prompt_kernel:
  buffer_load_dword v13, v14, s[8:11], s77 offen sc1
  s_sub_u32 s57, s57, 1
  s_cmp_eq_u32 s57, 0
  s_waitcnt vmcnt(0)
  s_cbranch_scc1 PL5_adaLN_cond__sliding_local_dilated__swiglu_ffn__prompt_kernelx
  v_subrev_u32 v13, s46, v13
  v_subrev_u32 v13, 1, v13
  v_cmp_lt_u32 vcc, 3, v13
  s_nop 4
  s_cbranch_vccnz PL5_adaLN_cond__sliding_local_dilated__swiglu_ffn__prompt_kernel
PL5_adaLN_cond__sliding_local_dilated__swiglu_ffn__prompt_kernelx:
  s_waitcnt vmcnt(10) lgkmcnt(3)
  s_barrier
  v_mfma_f32_16x16x32_bf16 v[52:55], a[168:171], v[100:103], v[52:55]
  ds_read_b64_tr_b16 a[64:65], v4 offset:32768
  s_add_u32 m0, s45, 16384
  s_add_u32 s68, s67, 5
  s_and_b32 s68, s68, 7
  s_mul_i32 s68, s68, 262144
  v_mfma_f32_16x16x32_bf16 v[52:55], a[180:183], v[104:107], v[52:55]
  ds_read_b128 v[88:91], v2 offset:41984
  ds_read_b64_tr_b16 a[66:67], v4 offset:34816
  v_mfma_f32_16x16x32_bf16 v[56:59], a[180:183], v[108:111], v[56:59]
  ds_read_b64_tr_b16 a[68:69], v5 offset:32768
  buffer_load_dwordx4 v10, s[16:19], s68 offen lds
  v_mfma_f32_16x16x32_bf16 v[56:59], a[168:171], v[112:115], v[56:59]
  ds_read_b64_tr_b16 a[70:71], v5 offset:34816
  ds_read_b64_tr_b16 a[72:73], v4 offset:36864
  v_mfma_f32_16x16x32_bf16 v[64:67], a[172:175], v[112:115], v[64:67]
  ds_read_b128 v[92:95], v2 offset:34816
  ds_read_b64_tr_b16 a[74:75], v4 offset:38912
  s_add_u32 m0, s45, 20480
  s_add_u32 s68, s68, 65536
  v_mfma_f32_16x16x32_bf16 v[64:67], a[184:187], v[108:111], v[64:67]
  ds_read_b64_tr_b16 a[76:77], v5 offset:36864
  buffer_load_dwordx4 v10, s[16:19], s68 offen lds
  v_mfma_f32_16x16x32_bf16 v[60:63], a[184:187], v[104:107], v[60:63]
  ds_read_b64_tr_b16 a[78:79], v5 offset:38912
  ds_read_b64_tr_b16 a[80:81], v4 offset:40960
  v_mfma_f32_16x16x32_bf16 v[60:63], a[172:175], v[100:103], v[60:63]
  ds_read_b128 v[96:99], v2 offset:35840
  ds_read_b64_tr_b16 a[82:83], v4 offset:43008
  s_add_u32 m0, s45, 24576
  s_add_u32 s68, s68, 65536
  v_mfma_f32_16x16x32_bf16 v[68:71], a[176:179], v[100:103], v[68:71]
  ds_read_b64_tr_b16 a[84:85], v5 offset:40960
  buffer_load_dwordx4 v10, s[16:19], s68 offen lds
  v_mfma_f32_16x16x32_bf16 v[68:71], a[188:191], v[104:107], v[68:71]
  ds_read_b64_tr_b16 a[86:87], v5 offset:43008
  ds_read_b64_tr_b16 a[88:89], v4 offset:45056
  v_mfma_f32_16x16x32_bf16 v[72:75], a[188:191], v[108:111], v[72:75]
  ds_read_b128 v[100:103], v2 offset:43008
  ds_read_b64_tr_b16 a[90:91], v4 offset:47104
  s_add_u32 m0, s45, 28672
  s_add_u32 s68, s68, 65536
  v_mfma_f32_16x16x32_bf16 v[72:75], a[176:179], v[112:115], v[72:75]
  s_waitcnt lgkmcnt(15)
  ds_read_b64_tr_b16 a[92:93], v5 offset:45056
  buffer_load_dwordx4 v10, s[16:19], s68 offen lds
  v_mfma_f32_16x16x32_bf16 v[52:55], a[192:195], v[76:79], v[52:55]
  ds_read_b64_tr_b16 a[94:95], v5 offset:47104
  ds_read_b64_tr_b16 a[96:97], v4 offset:49152
  v_mfma_f32_16x16x32_bf16 v[52:55], a[204:207], v[80:83], v[52:55]
  ds_read_b128 v[104:107], v2 offset:44032
  ds_read_b64_tr_b16 a[98:99], v4 offset:51200
  s_add_u32 m0, s45, 81920
  s_add_u32 s68, s67, 6
  s_and_b32 s68, s68, 7
  s_mul_i32 s68, s68, 262144
  v_mfma_f32_16x16x32_bf16 v[56:59], a[204:207], v[88:91], v[56:59]
  ds_read_b64_tr_b16 a[100:101], v5 offset:49152
  buffer_load_dwordx4 v10, s[16:19], s68 offen lds
  v_mfma_f32_16x16x32_bf16 v[56:59], a[192:195], v[84:87], v[56:59]
  ds_read_b64_tr_b16 a[102:103], v5 offset:51200
  ds_read_b64_tr_b16 a[104:105], v4 offset:53248
  v_mfma_f32_16x16x32_bf16 v[64:67], a[196:199], v[84:87], v[64:67]
  ds_read_b128 v[108:111], v2 offset:36864
  ds_read_b64_tr_b16 a[106:107], v4 offset:55296
  s_add_u32 m0, s45, 86016
  s_add_u32 s68, s68, 65536
  v_mfma_f32_16x16x32_bf16 v[64:67], a[208:211], v[88:91], v[64:67]
  ds_read_b64_tr_b16 a[108:109], v5 offset:53248
  buffer_load_dwordx4 v10, s[16:19], s68 offen lds
  v_mfma_f32_16x16x32_bf16 v[60:63], a[208:211], v[80:83], v[60:63]
  ds_read_b64_tr_b16 a[110:111], v5 offset:55296
  ds_read_b64_tr_b16 a[112:113], v4 offset:57344
  v_mfma_f32_16x16x32_bf16 v[60:63], a[196:199], v[76:79], v[60:63]
  ds_read_b128 v[112:115], v2 offset:37888
  ds_read_b64_tr_b16 a[114:115], v4 offset:59392
  s_add_u32 m0, s45, 90112
  s_add_u32 s68, s68, 65536
  v_mfma_f32_16x16x32_bf16 v[68:71], a[200:203], v[76:79], v[68:71]
  ds_read_b64_tr_b16 a[116:117], v5 offset:57344
  buffer_load_dwordx4 v10, s[16:19], s68 offen lds
  v_mfma_f32_16x16x32_bf16 v[68:71], a[212:215], v[80:83], v[68:71]
  ds_read_b64_tr_b16 a[118:119], v5 offset:59392
  ds_read_b64_tr_b16 a[120:121], v4 offset:61440
  v_mfma_f32_16x16x32_bf16 v[72:75], a[212:215], v[88:91], v[72:75]
  ds_read_b128 v[76:79], v2 offset:45056
  ds_read_b64_tr_b16 a[122:123], v4 offset:63488
  s_add_u32 m0, s45, 94208
  s_add_u32 s68, s68, 65536
  v_mfma_f32_16x16x32_bf16 v[72:75], a[200:203], v[84:87], v[72:75]
  s_waitcnt lgkmcnt(15)
  ds_read_b64_tr_b16 a[124:125], v5 offset:61440
  buffer_load_dwordx4 v10, s[16:19], s68 offen lds
  v_mfma_f32_16x16x32_bf16 v[52:55], a[216:219], v[92:95], v[52:55]
  ds_read_b64_tr_b16 a[126:127], v5 offset:63488
  v_mfma_f32_16x16x32_bf16 v[52:55], a[228:231], v[96:99], v[52:55]
  ds_read_b128 v[80:83], v2 offset:46080
  v_mfma_f32_16x16x32_bf16 v[56:59], a[228:231], v[104:107], v[56:59]
  v_mfma_f32_16x16x32_bf16 v[56:59], a[216:219], v[100:103], v[56:59]
  v_mfma_f32_16x16x32_bf16 v[64:67], a[220:223], v[100:103], v[64:67]
  ds_read_b128 v[88:91], v2 offset:38912
  v_mfma_f32_16x16x32_bf16 v[64:67], a[232:235], v[104:107], v[64:67]
  v_lshlrev_b32 v21, 7, v0
  v_add_u32 v21, 720896, v21
  v_mfma_f32_16x16x32_bf16 v[60:63], a[232:235], v[96:99], v[60:63]
  s_waitcnt vmcnt(4) lgkmcnt(2)
  s_barrier
  v_add_u32 v15, s46, v0
  v_add_u32 v15, 2, v15
  s_mov_b64 exec, 1
  buffer_store_dword v15, v0, s[8:11], s74 offen offset:0 sc1
  s_mov_b64 exec, -1
  v_mfma_f32_16x16x32_bf16 v[60:63], a[220:223], v[92:95], v[60:63]
  ds_read_b128 v[84:87], v2 offset:39936
  ds_read_b64_tr_b16 a[128:129], v7 offset:49152
  s_add_u32 m0, s45, 65536
  s_add_u32 s68, s67, 7
  s_and_b32 s68, s68, 7
  s_mul_i32 s68, s68, 262144
  v_mfma_f32_16x16x32_bf16 v[68:71], a[224:227], v[92:95], v[68:71]
  ds_read_b64_tr_b16 a[130:131], v7 offset:51200
  buffer_load_dwordx4 v10, s[16:19], s68 offen lds
  v_mfma_f32_16x16x32_bf16 v[68:71], a[236:239], v[96:99], v[68:71]
  ds_read_b64_tr_b16 a[132:133], v8 offset:49152
  v_mfma_f32_16x16x32_bf16 v[72:75], a[236:239], v[104:107], v[72:75]
  ds_read_b128 v[92:95], v2 offset:47104
  ds_read_b64_tr_b16 a[134:135], v8 offset:51200
  ds_read_b64_tr_b16 a[136:137], v7 offset:53248
  v_mfma_f32_16x16x32_bf16 v[72:75], a[224:227], v[100:103], v[72:75]
  s_waitcnt lgkmcnt(8)
  ds_read_b64_tr_b16 a[138:139], v7 offset:55296
  s_add_u32 m0, s45, 69632
  s_add_u32 s68, s68, 65536
  v_mfma_f32_16x16x32_bf16 v[52:55], a[240:243], v[108:111], v[52:55]
  ds_read_b64_tr_b16 a[140:141], v8 offset:53248
  buffer_load_dwordx4 v10, s[16:19], s68 offen lds
  s_add_u32 m0, s45, 73728
  s_add_u32 s68, s68, 65536
  v_mfma_f32_16x16x32_bf16 v[52:55], v[124:127], v[112:115], v[52:55]
  ds_read_b128 v[96:99], v2 offset:48128
  ds_read_b64_tr_b16 a[142:143], v8 offset:55296
  ds_read_b64_tr_b16 a[144:145], v7 offset:57344
  v_mfma_f32_16x16x32_bf16 v[56:59], v[124:127], v[80:83], v[56:59]
  ds_read_b64_tr_b16 a[146:147], v7 offset:59392
  buffer_load_dwordx4 v10, s[16:19], s68 offen lds
  v_mfma_f32_16x16x32_bf16 v[56:59], a[240:243], v[76:79], v[56:59]
  ds_read_b64_tr_b16 a[148:149], v8 offset:57344
  s_add_u32 m0, s45, 77824
  s_add_u32 s68, s68, 65536
  v_mfma_f32_16x16x32_bf16 v[64:67], a[244:247], v[76:79], v[64:67]
  ds_read_b128 v[104:107], v1 offset:0
  ds_read_b64_tr_b16 a[150:151], v8 offset:59392
  ds_read_b64_tr_b16 a[152:153], v7 offset:61440
  v_mfma_f32_16x16x32_bf16 v[64:67], v[128:131], v[80:83], v[64:67]
  ds_read_b64_tr_b16 a[154:155], v7 offset:63488
  buffer_load_dwordx4 v10, s[16:19], s68 offen lds
  v_mfma_f32_16x16x32_bf16 v[60:63], v[128:131], v[112:115], v[60:63]
  ds_read_b64_tr_b16 a[156:157], v8 offset:61440
  s_add_u32 m0, s70, 32768
  s_add_u32 s69, s62, 0
  v_mfma_f32_16x16x32_bf16 v[60:63], a[244:247], v[108:111], v[60:63]
  ds_read_b128 v[100:103], v1 offset:1024
  ds_read_b64_tr_b16 a[158:159], v8 offset:63488
  ds_read_b64_tr_b16 a[160:161], v4 offset:16384
  v_mfma_f32_16x16x32_bf16 v[68:71], a[248:251], v[108:111], v[68:71]
  ds_read_b64_tr_b16 a[162:163], v4 offset:18432
  buffer_load_dwordx4 v9, s[8:11], s69 offen offset:0 sc1 lds
  v_mfma_f32_16x16x32_bf16 v[68:71], v[132:135], v[112:115], v[68:71]
  ds_read_b64_tr_b16 a[164:165], v5 offset:16384
  v_mfma_f32_16x16x32_bf16 v[72:75], v[132:135], v[80:83], v[72:75]
  ds_read_b128 v[108:111], v1 offset:8192
  ds_read_b64_tr_b16 a[166:167], v5 offset:18432
  ds_read_b64_tr_b16 a[168:169], v4 offset:20480
  s_lshl_b32 s57, s44, 28
  buffer_load_dwordx4 v[116:119], v21, s[8:11], s57 offen sc1
  v_mfma_f32_16x16x32_bf16 v[72:75], a[248:251], v[76:79], v[72:75]
  s_waitcnt lgkmcnt(15)
  ds_read_b64_tr_b16 a[170:171], v4 offset:22528
  v_mfma_f32_16x16x32_bf16 v[52:55], v[136:139], v[88:91], v[52:55]
  ds_read_b64_tr_b16 a[172:173], v5 offset:20480
  buffer_load_dwordx4 v9, s[8:11], s69 offen offset:1024 sc1 lds
  v_mfma_f32_16x16x32_bf16 v[52:55], v[148:151], v[84:87], v[52:55]
  ds_read_b128 v[112:115], v1 offset:9216
  ds_read_b64_tr_b16 a[174:175], v5 offset:22528
  ds_read_b64_tr_b16 a[176:177], v4 offset:24576
  v_mfma_f32_16x16x32_bf16 v[56:59], v[148:151], v[96:99], v[56:59]
  ds_read_b64_tr_b16 a[178:179], v4 offset:26624
  buffer_load_dwordx4 v9, s[8:11], s69 offen offset:2048 sc1 lds
  v_mfma_f32_16x16x32_bf16 v[56:59], v[136:139], v[92:95], v[56:59]
  ds_read_b64_tr_b16 a[180:181], v5 offset:24576
  v_mfma_f32_16x16x32_bf16 v[64:67], v[140:143], v[92:95], v[64:67]
  ds_read_b128 v[80:83], v1 offset:2048
  ds_read_b64_tr_b16 a[182:183], v5 offset:26624
  ds_read_b64_tr_b16 a[184:185], v4 offset:28672
  v_mfma_f32_16x16x32_bf16 v[64:67], v[152:155], v[96:99], v[64:67]
  ds_read_b64_tr_b16 a[186:187], v4 offset:30720
  buffer_load_dwordx4 v9, s[8:11], s69 offen offset:3072 sc1 lds
  v_mfma_f32_16x16x32_bf16 v[60:63], v[152:155], v[84:87], v[60:63]
  ds_read_b64_tr_b16 a[188:189], v5 offset:28672
  s_add_u32 m0, s70, 49152
  s_add_u32 s69, s63, 0
  v_mfma_f32_16x16x32_bf16 v[60:63], v[140:143], v[88:91], v[60:63]
  ds_read_b128 v[76:79], v1 offset:3072
  ds_read_b64_tr_b16 a[190:191], v5 offset:30720
  v_mfma_f32_16x16x32_bf16 v[68:71], v[144:147], v[88:91], v[68:71]
  buffer_load_dwordx4 v9, s[8:11], s69 offen offset:0 sc1 lds
  v_mfma_f32_16x16x32_bf16 v[68:71], v[156:159], v[84:87], v[68:71]
  v_mfma_f32_16x16x32_bf16 v[72:75], v[156:159], v[96:99], v[72:75]
  ds_read_b128 v[88:91], v1 offset:10240
  v_mfma_f32_16x16x32_bf16 v[72:75], v[144:147], v[92:95], v[72:75]
  s_waitcnt lgkmcnt(12)
  buffer_load_dwordx4 v9, s[8:11], s69 offen offset:1024 sc1 lds
  v_mfma_f32_16x16x32_bf16 v[52:55], v[160:163], v[104:107], v[52:55]
  s_waitcnt vmcnt(7) lgkmcnt(15)
  s_barrier
  v_mfma_f32_16x16x32_bf16 v[52:55], v[172:175], v[100:103], v[52:55]
  ds_read_b128 v[84:87], v1 offset:11264
  ds_read_b64_tr_b16 a[192:193], v7 offset:16384
  v_mfma_f32_16x16x32_bf16 v[56:59], v[172:175], v[112:115], v[56:59]
  ds_read_b64_tr_b16 a[194:195], v7 offset:18432
  buffer_load_dwordx4 v9, s[8:11], s69 offen offset:2048 sc1 lds
  v_mfma_f32_16x16x32_bf16 v[56:59], v[160:163], v[108:111], v[56:59]
  ds_read_b64_tr_b16 a[196:197], v8 offset:16384
  v_mfma_f32_16x16x32_bf16 v[64:67], v[164:167], v[108:111], v[64:67]
  ds_read_b128 v[96:99], v1 offset:4096
  ds_read_b64_tr_b16 a[198:199], v8 offset:18432
  ds_read_b64_tr_b16 a[200:201], v7 offset:20480
  v_mfma_f32_16x16x32_bf16 v[64:67], v[176:179], v[112:115], v[64:67]
  ds_read_b64_tr_b16 a[202:203], v7 offset:22528
  buffer_load_dwordx4 v9, s[8:11], s69 offen offset:3072 sc1 lds
  v_mfma_f32_16x16x32_bf16 v[60:63], v[176:179], v[100:103], v[60:63]
  ds_read_b64_tr_b16 a[204:205], v8 offset:20480
  s_add_u32 m0, s70, 98304
  s_add_u32 s69, s64, 0
  v_mfma_f32_16x16x32_bf16 v[60:63], v[164:167], v[104:107], v[60:63]
  ds_read_b128 v[92:95], v1 offset:5120
  ds_read_b64_tr_b16 a[206:207], v8 offset:22528
  ds_read_b64_tr_b16 a[208:209], v7 offset:24576
  v_mfma_f32_16x16x32_bf16 v[68:71], v[168:171], v[104:107], v[68:71]
  ds_read_b64_tr_b16 a[210:211], v7 offset:26624
  buffer_load_dwordx4 v9, s[8:11], s69 offen offset:0 sc1 lds
  v_mfma_f32_16x16x32_bf16 v[68:71], v[180:183], v[100:103], v[68:71]
  ds_read_b64_tr_b16 a[212:213], v8 offset:24576
  v_mfma_f32_16x16x32_bf16 v[72:75], v[180:183], v[112:115], v[72:75]
  ds_read_b128 v[104:107], v1 offset:12288
  ds_read_b64_tr_b16 a[214:215], v8 offset:26624
  ds_read_b64_tr_b16 a[216:217], v7 offset:28672
  v_mfma_f32_16x16x32_bf16 v[72:75], v[168:171], v[108:111], v[72:75]
  s_waitcnt lgkmcnt(15)
  ds_read_b64_tr_b16 a[218:219], v7 offset:30720
  v_mfma_f32_16x16x32_bf16 v[52:55], v[184:187], v[80:83], v[52:55]
  ds_read_b64_tr_b16 a[220:221], v8 offset:28672
  buffer_load_dwordx4 v9, s[8:11], s69 offen offset:1024 sc1 lds
  v_mfma_f32_16x16x32_bf16 v[52:55], v[196:199], v[76:79], v[52:55]
  ds_read_b128 v[100:103], v1 offset:13312
  ds_read_b64_tr_b16 a[222:223], v8 offset:30720
  ds_read_b64_tr_b16 a[224:225], v7 offset:0
  v_mfma_f32_16x16x32_bf16 v[56:59], v[196:199], v[84:87], v[56:59]
  ds_read_b64_tr_b16 a[226:227], v7 offset:2048
  buffer_load_dwordx4 v9, s[8:11], s69 offen offset:2048 sc1 lds
  v_mfma_f32_16x16x32_bf16 v[56:59], v[184:187], v[88:91], v[56:59]
  ds_read_b64_tr_b16 a[228:229], v8 offset:0
  v_mfma_f32_16x16x32_bf16 v[64:67], v[188:191], v[88:91], v[64:67]
  ds_read_b128 v[112:115], v1 offset:6144
  ds_read_b64_tr_b16 a[230:231], v8 offset:2048
  ds_read_b64_tr_b16 a[232:233], v7 offset:4096
  v_mfma_f32_16x16x32_bf16 v[64:67], v[200:203], v[84:87], v[64:67]
  ds_read_b64_tr_b16 a[234:235], v7 offset:6144
  buffer_load_dwordx4 v9, s[8:11], s69 offen offset:3072 sc1 lds
  v_mfma_f32_16x16x32_bf16 v[60:63], v[200:203], v[76:79], v[60:63]
  ds_read_b64_tr_b16 a[236:237], v8 offset:4096
  s_add_u32 m0, s70, 114688
  s_add_u32 s69, s65, 0
  v_mfma_f32_16x16x32_bf16 v[60:63], v[188:191], v[80:83], v[60:63]
  ds_read_b128 v[108:111], v1 offset:7168
  ds_read_b64_tr_b16 a[238:239], v8 offset:6144
  ds_read_b64_tr_b16 a[240:241], v7 offset:8192
  v_mfma_f32_16x16x32_bf16 v[68:71], v[192:195], v[80:83], v[68:71]
  ds_read_b64_tr_b16 a[242:243], v7 offset:10240
  buffer_load_dwordx4 v9, s[8:11], s69 offen offset:0 sc1 lds
  v_mfma_f32_16x16x32_bf16 v[68:71], v[204:207], v[76:79], v[68:71]
  ds_read_b64_tr_b16 a[244:245], v8 offset:8192
  v_mfma_f32_16x16x32_bf16 v[72:75], v[204:207], v[84:87], v[72:75]
  ds_read_b128 v[80:83], v1 offset:14336
  ds_read_b64_tr_b16 a[246:247], v8 offset:10240
  ds_read_b64_tr_b16 a[248:249], v7 offset:12288
  v_mfma_f32_16x16x32_bf16 v[72:75], v[192:195], v[88:91], v[72:75]
  s_waitcnt lgkmcnt(15)
  ds_read_b64_tr_b16 a[250:251], v7 offset:14336
  v_mfma_f32_16x16x32_bf16 v[52:55], v[208:211], v[96:99], v[52:55]
  ds_read_b64_tr_b16 v[124:125], v8 offset:12288
  buffer_load_dwordx4 v9, s[8:11], s69 offen offset:1024 sc1 lds
  v_mfma_f32_16x16x32_bf16 v[52:55], v[220:223], v[92:95], v[52:55]
  ds_read_b128 v[76:79], v1 offset:15360
  ds_read_b64_tr_b16 v[126:127], v8 offset:14336
  v_mfma_f32_16x16x32_bf16 v[56:59], v[220:223], v[100:103], v[56:59]
  buffer_load_dwordx4 v9, s[8:11], s69 offen offset:2048 sc1 lds
  v_mfma_f32_16x16x32_bf16 v[56:59], v[208:211], v[104:107], v[56:59]
  v_mfma_f32_16x16x32_bf16 v[64:67], v[212:215], v[104:107], v[64:67]
  v_mfma_f32_16x16x32_bf16 v[64:67], v[224:227], v[100:103], v[64:67]
  buffer_load_dwordx4 v9, s[8:11], s69 offen offset:3072 sc1 lds
  v_mfma_f32_16x16x32_bf16 v[60:63], v[224:227], v[92:95], v[60:63]
  v_mfma_f32_16x16x32_bf16 v[60:63], v[212:215], v[96:99], v[60:63]
  s_waitcnt vmcnt(15)
  s_cmp_lg_u32 s44, 0
  s_cbranch_scc1 PL6_adaLN_cond__sliding_local_dilated__swiglu_ffn__prompt_kernelx
  v_bitop3_b32 v116, v116, v117, s46 bitop3:0x7e
  v_bitop3_b32 v118, v118, v119, s46 bitop3:0x7e
  v_or_b32 v116, v116, v118
  v_cmp_ne_u32 vcc, 0, v116
  s_nop 4
  s_cbranch_vccz PL6_adaLN_cond__sliding_local_dilated__swiglu_ffn__prompt_kernelx
  s_mov_b32 s57, 60000
PL6_adaLN_cond__sliding_local_dilated__swiglu_ffn__prompt_kernel:
  buffer_load_dwordx4 v[116:119], v21, s[8:11], 0 offen sc1
  s_sub_u32 s57, s57, 1
  s_cmp_eq_u32 s57, 0
  s_waitcnt vmcnt(0)
  s_cbranch_scc1 PL6_adaLN_cond__sliding_local_dilated__swiglu_ffn__prompt_kernelx
  v_bitop3_b32 v116, v116, v117, s46 bitop3:0x7e
  v_bitop3_b32 v118, v118, v119, s46 bitop3:0x7e
  v_or_b32 v116, v116, v118
  v_cmp_ne_u32 vcc, 0, v116
  s_nop 4
  s_cbranch_vccnz PL6_adaLN_cond__sliding_local_dilated__swiglu_ffn__prompt_kernel
PL6_adaLN_cond__sliding_local_dilated__swiglu_ffn__prompt_kernelx:
  s_waitcnt vmcnt(8) lgkmcnt(0)
  s_barrier
  v_mfma_f32_16x16x32_bf16 v[68:71], v[216:219], v[96:99], v[68:71]
  ds_read_b128 v[84:87], v22 offset:32768
  s_add_u32 m0, s70, 16384
  s_add_u32 s69, s62, 65536
  v_mfma_f32_16x16x32_bf16 v[68:71], v[228:231], v[92:95], v[68:71]
  v_and_b32 v21, 31, v0
  v_lshlrev_b32 v21, 2, v21
  v_lshrrev_b32 v181, 5, v0
  v_lshl_add_u32 v21, v181, 13, v21
  v_mfma_f32_16x16x32_bf16 v[72:75], v[228:231], v[100:103], v[72:75]
  ds_read_b128 v[88:91], v22 offset:33792
  buffer_load_dwordx4 v9, s[8:11], s69 offen offset:0 sc1 lds
  v_mfma_f32_16x16x32_bf16 v[72:75], v[216:219], v[104:107], v[72:75]
  s_waitcnt lgkmcnt(3)
  v_mfma_f32_16x16x32_bf16 v[52:55], v[232:235], v[112:115], v[52:55]
  ds_read_b128 v[96:99], v22 offset:34816
  v_mfma_f32_16x16x32_bf16 v[52:55], v[244:247], v[108:111], v[52:55]
  buffer_load_dwordx4 v9, s[8:11], s69 offen offset:1024 sc1 lds
  v_mfma_f32_16x16x32_bf16 v[56:59], v[244:247], v[76:79], v[56:59]
  ds_read_b128 v[92:95], v22 offset:35840
  v_mfma_f32_16x16x32_bf16 v[56:59], v[232:235], v[80:83], v[56:59]
  buffer_load_dwordx4 v9, s[8:11], s69 offen offset:2048 sc1 lds
  v_mfma_f32_16x16x32_bf16 v[64:67], v[236:239], v[80:83], v[64:67]
  ds_read_b128 v[100:103], v22 offset:36864
  v_mfma_f32_16x16x32_bf16 v[64:67], v[248:251], v[76:79], v[64:67]
  v_mfma_f32_16x16x32_bf16 v[60:63], v[248:251], v[108:111], v[60:63]
  ds_read_b128 v[104:107], v22 offset:37888
  v_mfma_f32_16x16x32_bf16 v[60:63], v[236:239], v[112:115], v[60:63]
  buffer_load_dwordx4 v9, s[8:11], s69 offen offset:3072 sc1 lds
  s_add_u32 s56, s76, 8192
  v_mfma_f32_16x16x32_bf16 v[68:71], v[240:243], v[112:115], v[68:71]
  ds_read_b128 v[112:115], v22 offset:38912
  v_mfma_f32_16x16x32_bf16 v[68:71], v[252:255], v[108:111], v[68:71]
  buffer_load_dword v160, v21, s[8:11], s56 offen sc1
  s_add_u32 s56, s76, 32768
  v_mfma_f32_16x16x32_bf16 v[72:75], v[252:255], v[76:79], v[72:75]
  ds_read_b128 v[108:111], v22 offset:39936
  v_mfma_f32_16x16x32_bf16 v[72:75], v[240:243], v[80:83], v[72:75]
  s_waitcnt lgkmcnt(4)
  buffer_load_dword v161, v21, s[8:11], s56 offen sc1
  s_add_u32 s56, s76, 57344
  v_mfma_f32_16x16x32_bf16 v[128:131], a[0:3], v[84:87], 0
  ds_read_b128 v[76:79], v22 offset:49152
  buffer_load_dword v162, v21, s[8:11], s56 offen sc1
  v_mfma_f32_16x16x32_bf16 v[128:131], a[8:11], v[88:91], v[128:131]
  s_add_u32 s56, s76, 81920
  v_mfma_f32_16x16x32_bf16 v[132:135], a[12:15], v[88:91], 0
  ds_read_b128 v[80:83], v22 offset:50176
  s_lshr_b32 s79, s2, 6
  s_lshl_b32 s79, s79, 2
  s_add_u32 s79, s79, s44
  s_lshl_b32 s79, s79, 8
  buffer_load_dword v163, v21, s[8:11], s56 offen sc1
  s_add_u32 s56, s47, 41943040
  v_mfma_f32_16x16x32_bf16 v[132:135], a[4:7], v[84:87], v[132:135]
  buffer_load_dwordx4 v[144:147], v1, s[8:11], s56 offen sc1
  s_add_u32 s56, s47, 42008576
  v_cvt_pk_bf16_f32 v52, v52, v53
  v_cvt_pk_bf16_f32 v53, v54, v55
  ds_write_b64 v18, v[52:53] offset:6144
  v_cvt_pk_bf16_f32 v60, v60, v61
  v_cvt_pk_bf16_f32 v61, v62, v63
  v_mfma_f32_16x16x32_bf16 v[128:131], a[16:19], v[96:99], v[128:131]
  ds_read_b128 v[88:91], v22 offset:51200
  v_cvt_pk_bf16_f32 v62, v68, v69
  v_cvt_pk_bf16_f32 v63, v70, v71
  ds_write_b128 v17, v[60:63] offset:7168
  v_mfma_f32_16x16x32_bf16 v[128:131], a[24:27], v[92:95], v[128:131]
  buffer_load_dwordx4 v[148:151], v1, s[8:11], s56 offen sc1
  s_add_u32 s56, s47, 42074112
  v_cvt_pk_bf16_f32 v56, v56, v57
  v_cvt_pk_bf16_f32 v57, v58, v59
  ds_write_b64 v18, v[56:57] offset:12288
  v_cvt_pk_bf16_f32 v64, v64, v65
  v_cvt_pk_bf16_f32 v65, v66, v67
  v_mfma_f32_16x16x32_bf16 v[132:135], a[28:31], v[92:95], v[132:135]
  ds_read_b128 v[84:87], v22 offset:52224
  v_cvt_pk_bf16_f32 v66, v72, v73
  v_cvt_pk_bf16_f32 v67, v74, v75
  ds_write_b128 v17, v[64:67] offset:13312
  v_mfma_f32_16x16x32_bf16 v[132:135], a[20:23], v[96:99], v[132:135]
  s_waitcnt lgkmcnt(8)
  buffer_load_dwordx4 v[152:155], v1, s[8:11], s56 offen sc1
  s_add_u32 s56, s47, 42139648
  s_bitcmp1_b32 s44, 0
  s_mov_b32 s52, 6144
  s_cselect_b32 s52, 12288, s52
  s_mov_b32 s53, 0
  s_cselect_b32 s53, 6144, s53
  v_add_u32 v116, s52, v19
  v_add_u32 v117, s53, v19
  v_mfma_f32_16x16x32_bf16 v[128:131], a[32:35], v[100:103], v[128:131]
  ds_read_b128 v[92:95], v22 offset:53248
  v_add_u32 v118, s52, v20
  v_add_u32 v119, s53, v20
  s_waitcnt vmcnt(11) lgkmcnt(1)
  s_barrier
  v_mfma_f32_16x16x32_bf16 v[128:131], a[40:43], v[104:107], v[128:131]
  buffer_load_dwordx4 v[156:159], v1, s[8:11], s56 offen sc1
  s_add_u32 m0, s70, 81920
  s_add_u32 s69, s63, 65536
  ds_read_b128 v[52:55], v116
  ds_read_b128 v[56:59], v117 offset:1024
  v_mfma_f32_16x16x32_bf16 v[132:135], a[44:47], v[104:107], v[132:135]
  ds_read_b128 v[96:99], v22 offset:54272
  ds_read_b128 v[60:63], v116 offset:1024
  ds_read_b64_tr_b16 v[64:65], v119 offset:2048
  ds_read_b64_tr_b16 v[66:67], v118 offset:2048
  v_mfma_f32_16x16x32_bf16 v[132:135], a[36:39], v[100:103], v[132:135]
  buffer_load_dwordx4 v9, s[8:11], s69 offen offset:0 sc1 lds
  ds_read_b64_tr_b16 v[68:69], v119 offset:2056
  ds_read_b64_tr_b16 v[70:71], v118 offset:2056
  v_mfma_f32_16x16x32_bf16 v[128:131], a[48:51], v[112:115], v[128:131]
  ds_read_b128 v[104:107], v22 offset:55296
  s_lshl_b32 s57, s44, 28
  s_add_u32 s57, s57, s77
  buffer_load_dword v13, v14, s[8:11], s57 offen sc1
  v_mfma_f32_16x16x32_bf16 v[128:131], a[56:59], v[108:111], v[128:131]
  v_mfma_f32_16x16x32_bf16 v[132:135], a[60:63], v[108:111], v[132:135]
  ds_read_b128 v[100:103], v22 offset:56320
  v_mfma_f32_16x16x32_bf16 v[132:135], a[52:55], v[112:115], v[132:135]
  s_waitcnt lgkmcnt(12)
  buffer_load_dwordx4 v9, s[8:11], s69 offen offset:1024 sc1 lds
  v_mfma_f32_16x16x32_bf16 v[128:131], a[64:67], v[76:79], v[128:131]
  ds_read_b128 v[108:111], v23 offset:32768
  s_waitcnt lgkmcnt(3)
  v_mfma_f32_16x16x32_bf16 v[116:119], v[56:59], v[52:55], 0
  v_mfma_f32_16x16x32_bf16 v[120:123], v[60:63], v[52:55], 0
  v_mfma_f32_16x16x32_bf16 v[128:131], a[72:75], v[80:83], v[128:131]
  buffer_load_dwordx4 v9, s[8:11], s69 offen offset:2048 sc1 lds
  v_mfma_f32_16x16x32_bf16 v[132:135], a[76:79], v[80:83], v[132:135]
  ds_read_b128 v[112:115], v23 offset:33792
  v_mfma_f32_16x16x32_bf16 v[132:135], a[68:71], v[76:79], v[132:135]
  v_mfma_f32_16x16x32_bf16 v[128:131], a[80:83], v[88:91], v[128:131]
  ds_read_b128 v[80:83], v23 offset:34816
HOP5:
  s_cbranch_execz HOP9
  s_nop 0
  v_cndmask_b32 v72, v116, v120, s[80:81]
  v_cndmask_b32 v73, v117, v121, s[82:83]
  v_cndmask_b32 v74, v118, v122, s[84:85]
  v_cndmask_b32 v75, v119, v123, s[86:87]
  v_cndmask_b32 v72, v72, v73, s[88:89]
  v_cndmask_b32 v73, v74, v75, s[88:89]
  v_mfma_f32_16x16x32_bf16 v[128:131], a[88:91], v[84:87], v[128:131]
  buffer_load_dwordx4 v9, s[8:11], s69 offen offset:3072 sc1 lds
  s_add_u32 m0, s70, 65536
  s_add_u32 s69, s64, 65536
  v_mul_f32 v72, 0x3e8293ee, v72
  v_mul_f32 v73, 0x3e8293ee, v73
  v_max_f32 v74, v72, v73
  v_mov_b32 v75, v74
  v_mfma_f32_16x16x32_bf16 v[132:135], a[92:95], v[84:87], v[132:135]
  ds_read_b128 v[76:79], v23 offset:35840
  v_permlane16_swap_b32 v74, v75
  v_max_f32 v74, v74, v75
  v_mov_b32 v75, v74
  v_mfma_f32_16x16x32_bf16 v[132:135], a[84:87], v[88:91], v[132:135]
  s_waitcnt lgkmcnt(4)
  buffer_load_dwordx4 v9, s[8:11], s69 offen offset:0 sc1 lds
  v_permlane32_swap_b32 v74, v75
  v_max_f32 v74, v74, v75
  v_sub_f32 v72, v72, v74
  v_sub_f32 v73, v73, v74
  v_mfma_f32_16x16x32_bf16 v[128:131], a[96:99], v[92:95], v[128:131]
  ds_read_b128 v[84:87], v23 offset:36864
  v_exp_f32 v72, v72
  v_exp_f32 v73, v73
  v_mfma_f32_16x16x32_bf16 v[128:131], a[104:107], v[96:99], v[128:131]
  v_add_f32 v74, v72, v73
  v_mov_b32 v75, v74
  v_mfma_f32_16x16x32_bf16 v[132:135], a[108:111], v[96:99], v[132:135]
  ds_read_b128 v[88:91], v23 offset:37888
  v_permlane16_swap_b32 v74, v75
  v_add_f32 v74, v74, v75
  v_mov_b32 v75, v74
  v_mfma_f32_16x16x32_bf16 v[132:135], a[100:103], v[92:95], v[132:135]
  buffer_load_dwordx4 v9, s[8:11], s69 offen offset:1024 sc1 lds
  v_permlane32_swap_b32 v74, v75
  v_add_f32 v74, v74, v75
  v_rcp_f32 v74, v74
  v_mfma_f32_16x16x32_bf16 v[128:131], a[112:115], v[104:107], v[128:131]
  ds_read_b128 v[96:99], v23 offset:38912
  v_mul_f32 v72, v72, v74
  v_mul_f32 v73, v73, v74
  v_cvt_pk_bf16_f32 v72, v72, v72
  v_cvt_pk_bf16_f32 v73, v73, v73
  v_and_b32 v52, v24, v72
  v_and_b32 v53, v25, v73
  v_mfma_f32_16x16x32_bf16 v[128:131], a[120:123], v[100:103], v[128:131]
  buffer_load_dwordx4 v9, s[8:11], s69 offen offset:2048 sc1 lds
  v_and_b32 v54, v26, v72
  v_and_b32 v55, v27, v73
  v_mfma_f32_16x16x32_bf16 v[132:135], a[124:127], v[100:103], v[132:135]
  ds_read_b128 v[92:95], v23 offset:39936
  v_mfma_f32_16x16x32_bf16 v[56:59], v[64:67], v[52:55], 0
  v_mfma_f32_16x16x32_bf16 v[60:63], v[68:71], v[52:55], 0
  v_mfma_f32_16x16x32_bf16 v[132:135], a[116:119], v[104:107], v[132:135]
  s_waitcnt lgkmcnt(4)
  v_mfma_f32_16x16x32_bf16 v[128:131], a[128:131], v[108:111], v[128:131]
  ds_read_b128 v[100:103], v23 offset:49152
  v_mfma_f32_16x16x32_bf16 v[128:131], a[136:139], v[112:115], v[128:131]
  buffer_load_dwordx4 v9, s[8:11], s69 offen offset:3072 sc1 lds
  s_add_u32 m0, s70, 0
  s_add_u32 s69, s65, 65536
  v_mfma_f32_16x16x32_bf16 v[132:135], a[140:143], v[112:115], v[132:135]
  ds_read_b128 v[104:107], v23 offset:50176
  v_cvt_pk_bf16_f32 v116, v56, v57
  v_cvt_pk_bf16_f32 v117, v58, v59
  v_cvt_pk_bf16_f32 v118, v60, v61
  v_cvt_pk_bf16_f32 v119, v62, v63
  v_mfma_f32_16x16x32_bf16 v[132:135], a[132:135], v[108:111], v[132:135]
  buffer_load_dwordx4 v9, s[8:11], s69 offen offset:0 sc1 lds
  buffer_store_dwordx4 v[116:119], v1, s[8:11], s73 offen sc1
  s_add_u32 s73, s73, 65536
  v_mfma_f32_16x16x32_bf16 v[128:131], a[144:147], v[80:83], v[128:131]
  ds_read_b128 v[112:115], v23 offset:51200
  v_mfma_f32_16x16x32_bf16 v[128:131], a[152:155], v[76:79], v[128:131]
  v_mfma_f32_16x16x32_bf16 v[132:135], a[156:159], v[76:79], v[132:135]
  ds_read_b128 v[108:111], v23 offset:52224
  v_mfma_f32_16x16x32_bf16 v[132:135], a[148:151], v[80:83], v[132:135]
  s_waitcnt lgkmcnt(4)
  buffer_load_dwordx4 v9, s[8:11], s69 offen offset:1024 sc1 lds
  v_mfma_f32_16x16x32_bf16 v[128:131], a[160:163], v[84:87], v[128:131]
  ds_read_b128 v[76:79], v23 offset:53248
  s_waitcnt vmcnt(16)
  v_add_f32 v160, v160, v161
  v_mfma_f32_16x16x32_bf16 v[128:131], a[168:171], v[88:91], v[128:131]
  buffer_load_dwordx4 v9, s[8:11], s69 offen offset:2048 sc1 lds
  v_add_f32 v162, v162, v163
  v_add_f32 v160, v160, v162
  v_cvt_pk_bf16_f32 v160, v160, v160
  v_mfma_f32_16x16x32_bf16 v[132:135], a[172:175], v[88:91], v[132:135]
  ds_read_b128 v[80:83], v23 offset:54272
  v_lshlrev_b32 v160, 16, v160
  v_cvt_f32_u32 v181, v181
  v_mfma_f32_16x16x32_bf16 v[132:135], a[164:167], v[84:87], v[132:135]
  v_add_f32 v160, v160, v181
  v_cvt_pk_bf16_f32 v160, v160, v160
  v_lshlrev_b32 v160, 16, v160
  v_mfma_f32_16x16x32_bf16 v[128:131], a[176:179], v[96:99], v[128:131]
  ds_read_b128 v[88:91], v23 offset:55296
  s_lshl_b32 s54, s44, 8
  s_add_u32 s54, s54, 161792
  v_mfma_f32_16x16x32_bf16 v[128:131], a[184:187], v[92:95], v[128:131]
  buffer_load_dwordx4 v9, s[8:11], s69 offen offset:3072 sc1 lds
  v_lshl_add_u32 v180, v0, 2, s54
  v_lshrrev_b32 v161, 4, v0
  v_lshl_add_u32 v181, v161, 4, s54
  v_mfma_f32_16x16x32_bf16 v[132:135], a[188:191], v[92:95], v[132:135]
  ds_read_b128 v[84:87], v23 offset:56320
  ds_write_b32 v180, v160
  v_mfma_f32_16x16x32_bf16 v[132:135], a[180:183], v[96:99], v[132:135]
  s_waitcnt lgkmcnt(5)
  s_waitcnt vmcnt(12)
  s_cmp_lg_u32 s44, 0
  s_cbranch_scc1 PL7_adaLN_cond__sliding_local_dilated__swiglu_ffn__prompt_kernelx
  v_subrev_u32 v13, s46, v13
  v_subrev_u32 v13, 2, v13
  v_cmp_lt_u32 vcc, 3, v13
  s_nop 4
  s_cbranch_vccz PL7_adaLN_cond__sliding_local_dilated__swiglu_ffn__prompt_kernelx
  s_mov_b32 s57, 60000
PL7_adaLN_cond__sliding_local_dilated__swiglu_ffn__prompt_kernel:
  buffer_load_dword v13, v14, s[8:11], s77 offen sc1
  s_sub_u32 s57, s57, 1
  s_cmp_eq_u32 s57, 0
  s_waitcnt vmcnt(0)
  s_cbranch_scc1 PL7_adaLN_cond__sliding_local_dilated__swiglu_ffn__prompt_kernelx
  v_subrev_u32 v13, s46, v13
  v_subrev_u32 v13, 2, v13
  v_cmp_lt_u32 vcc, 3, v13
  s_nop 4
  s_cbranch_vccnz PL7_adaLN_cond__sliding_local_dilated__swiglu_ffn__prompt_kernel
PL7_adaLN_cond__sliding_local_dilated__swiglu_ffn__prompt_kernelx:
  s_waitcnt vmcnt(9)
  s_barrier
  v_mfma_f32_16x16x32_bf16 v[128:131], a[192:195], v[100:103], v[128:131]
  ds_read_b128 v[92:95], v22 offset:16384
  s_add_u32 m0, s70, 32768
  s_add_u32 s69, s62, 131072
  v_mfma_f32_16x16x32_bf16 v[128:131], a[200:203], v[104:107], v[128:131]
  buffer_load_dwordx4 v9, s[8:11], s69 offen offset:0 sc1 lds
  v_bfe_u32 v180, v0, 2, 2
  v_xor_b32 v180, v180, v161
  v_lshlrev_b32 v180, 27, v180
  v_mfma_f32_16x16x32_bf16 v[132:135], a[204:207], v[104:107], v[132:135]
  ds_read_b128 v[96:99], v22 offset:17408
  v_and_b32 v162, 15, v0
  v_lshl_add_u32 v180, v162, 4, v180
  v_mfma_f32_16x16x32_bf16 v[132:135], a[196:199], v[100:103], v[132:135]
  s_and_b32 s54, s44, 1
  s_lshl_b32 s54, s54, 11
  v_add_u32 v182, s54, v1
  s_and_b32 s54, s44, 2
  v_mfma_f32_16x16x32_bf16 v[128:131], a[208:211], v[112:115], v[128:131]
  ds_read_b128 v[104:107], v22 offset:18432
  s_lshl_b32 s54, s54, 9
  s_add_u32 s54, s54, 135168
  v_mfma_f32_16x16x32_bf16 v[128:131], a[216:219], v[108:111], v[128:131]
  buffer_load_dwordx4 v9, s[8:11], s69 offen offset:1024 sc1 lds
  v_add_u32 v182, s54, v182
  ds_read_b128 v[160:163], v181 offset:0
  v_mfma_f32_16x16x32_bf16 v[132:135], a[220:223], v[108:111], v[132:135]
  ds_read_b128 v[100:103], v22 offset:19456
  ds_read_b128 v[164:167], v181 offset:64
  v_mfma_f32_16x16x32_bf16 v[132:135], a[212:215], v[112:115], v[132:135]
  s_waitcnt lgkmcnt(7)
  buffer_load_dwordx4 v9, s[8:11], s69 offen offset:2048 sc1 lds
  ds_read_b128 v[168:171], v181 offset:128
  v_mfma_f32_16x16x32_bf16 v[128:131], a[224:227], v[76:79], v[128:131]
  ds_read_b128 v[108:111], v22 offset:20480
  ds_read_b128 v[172:175], v181 offset:192
  v_mfma_f32_16x16x32_bf16 v[128:131], a[232:235], v[80:83], v[128:131]
  v_mov_b32 v176, 0x3f803f80
  v_mov_b32 v177, 0x3f803f80
  v_mov_b32 v178, 0x3f803f80
  v_mfma_f32_16x16x32_bf16 v[132:135], a[236:239], v[80:83], v[132:135]
  ds_read_b128 v[112:115], v22 offset:21504
  v_mov_b32 v179, 0x3f803f80
  s_mov_b32 s90, 0xcccccccc
  v_mfma_f32_16x16x32_bf16 v[132:135], a[228:231], v[76:79], v[132:135]
  buffer_load_dwordx4 v9, s[8:11], s69 offen offset:3072 sc1 lds
  s_add_u32 m0, s70, 49152
  s_add_u32 s69, s63, 131072
  s_mov_b32 s91, 0xcccccccc
  v_mfma_f32_16x16x32_bf16 v[128:131], a[240:243], v[88:91], v[128:131]
  ds_read_b128 v[80:83], v22 offset:22528
  v_lshrrev_b32 v220, 5, v0
  v_xor_b32 v220, 1, v220
  v_lshlrev_b32 v220, 12, v220
  v_mfma_f32_16x16x32_bf16 v[128:131], a[248:251], v[84:87], v[128:131]
  buffer_load_dwordx4 v9, s[8:11], s69 offen offset:0 sc1 lds
  s_waitcnt vmcnt(22) lgkmcnt(2)
  v_lshlrev_b32 v184, 16, v144
  v_and_b32 v185, 0xffff0000, v144
  v_mfma_f32_16x16x32_bf16 v[132:135], v[124:127], v[84:87], v[132:135]
  ds_read_b128 v[76:79], v22 offset:23552
  v_and_b32 v221, 31, v0
  v_lshl_add_u32 v220, v221, 3, v220
  v_mfma_f32_16x16x32_bf16 v[132:135], a[244:247], v[88:91], v[132:135]
  s_waitcnt lgkmcnt(7)
  v_add_u32 v15, s46, v0
  v_add_u32 v15, 3, v15
  s_waitcnt vmcnt(8)
  s_barrier
  s_mov_b64 exec, 1
  buffer_store_dword v15, v0, s[8:11], s74 offen offset:0 sc1
  s_mov_b64 exec, -1
  v_mfma_f32_16x16x32_bf16 v[136:139], a[0:3], v[92:95], 0
  ds_read_b128 v[84:87], v23 offset:16384
  v_lshlrev_b32 v186, 16, v145
  v_and_b32 v187, 0xffff0000, v145
  v_mfma_f32_16x16x32_bf16 v[136:139], a[8:11], v[96:99], v[136:139]
  buffer_load_dwordx4 v9, s[8:11], s69 offen offset:1024 sc1 lds
  v_lshlrev_b32 v188, 16, v146
  v_and_b32 v189, 0xffff0000, v146
  v_lshlrev_b32 v190, 16, v147
  v_mfma_f32_16x16x32_bf16 v[140:143], a[12:15], v[96:99], 0
  ds_read_b128 v[88:91], v23 offset:17408
  v_and_b32 v191, 0xffff0000, v147
  v_fmac_f32 v184, v160, v128
  v_mfma_f32_16x16x32_bf16 v[140:143], a[4:7], v[92:95], v[140:143]
  buffer_load_dwordx4 v9, s[8:11], s69 offen offset:2048 sc1 lds
  v_fmac_f32 v185, v161, v129
  v_fmac_f32 v186, v162, v130
  v_fmac_f32 v187, v163, v131
  v_mfma_f32_16x16x32_bf16 v[136:139], a[16:19], v[104:107], v[136:139]
  ds_read_b128 v[96:99], v23 offset:18432
  v_fmac_f32 v188, v164, v132
  v_fmac_f32 v189, v165, v133
  v_mfma_f32_16x16x32_bf16 v[136:139], a[24:27], v[100:103], v[136:139]
  v_fmac_f32 v190, v166, v134
  v_fmac_f32 v191, v167, v135
  v_mul_f32 v128, v184, v168
  v_mfma_f32_16x16x32_bf16 v[140:143], a[28:31], v[100:103], v[140:143]
  ds_read_b128 v[92:95], v23 offset:19456
  v_mul_f32 v129, v185, v169
  v_mul_f32 v130, v186, v170
  v_mfma_f32_16x16x32_bf16 v[140:143], a[20:23], v[104:107], v[140:143]
  s_waitcnt lgkmcnt(4)
  buffer_load_dwordx4 v9, s[8:11], s69 offen offset:3072 sc1 lds
  v_mul_f32 v131, v187, v171
  v_mul_f32 v132, v188, v172
  v_mfma_f32_16x16x32_bf16 v[136:139], a[32:35], v[108:111], v[136:139]
  ds_read_b128 v[100:103], v23 offset:20480
  s_add_u32 m0, s70, 98304
  s_add_u32 s69, s64, 131072
  v_mfma_f32_16x16x32_bf16 v[136:139], a[40:43], v[112:115], v[136:139]
  buffer_load_dwordx4 v9, s[8:11], s69 offen offset:0 sc1 lds
  v_mul_f32 v133, v189, v173
  v_mul_f32 v134, v190, v174
  v_mul_f32 v135, v191, v175
  v_mfma_f32_16x16x32_bf16 v[140:143], a[44:47], v[112:115], v[140:143]
  ds_read_b128 v[104:107], v23 offset:21504
  v_cvt_pk_bf16_f32 v196, v128, v129
  v_cvt_pk_bf16_f32 v197, v130, v131
  v_mfma_f32_16x16x32_bf16 v[140:143], a[36:39], v[108:111], v[140:143]
  v_cvt_pk_bf16_f32 v198, v132, v133
  v_cvt_pk_bf16_f32 v199, v134, v135
  v_mfma_f32_16x16x32_bf16 v[136:139], a[48:51], v[80:83], v[136:139]
  ds_read_b128 v[112:115], v23 offset:22528
  v_mfma_f32_16x16x32_bf16 v[136:139], a[56:59], v[76:79], v[136:139]
  buffer_load_dwordx4 v9, s[8:11], s69 offen offset:1024 sc1 lds
  s_add_u32 s54, s47, 36700160
  buffer_store_dwordx4 v[196:199], v1, s[8:11], s54 offen sc1
  v_mfma_f32_16x16x32_bf16 v[140:143], a[60:63], v[76:79], v[140:143]
  ds_read_b128 v[108:111], v23 offset:23552
  v_cvt_pk_bf16_f32 v144, v184, v185
  v_cvt_pk_bf16_f32 v145, v186, v187
  v_mfma_f32_16x16x32_bf16 v[140:143], a[52:55], v[80:83], v[140:143]
  s_waitcnt lgkmcnt(4)
  v_cvt_pk_bf16_f32 v146, v188, v189
  s_waitcnt vmcnt(12)
  s_barrier
  v_mfma_f32_16x16x32_bf16 v[136:139], a[64:67], v[84:87], v[136:139]
  ds_read_b128 v[76:79], v23 offset:0
  buffer_load_dwordx4 v9, s[8:11], s69 offen offset:2048 sc1 lds
  v_cvt_pk_bf16_f32 v147, v190, v191
  v_mfma_f32_16x16x32_bf16 v[136:139], a[72:75], v[88:91], v[136:139]
  s_nop 0
  v_mfma_f32_16x16x32_bf16 v[224:227], v[176:179], v[144:147], 0
  v_mfma_f32_16x16x32_bf16 v[192:195], v[144:147], v[144:147], 0
  v_mfma_f32_16x16x32_bf16 v[140:143], a[76:79], v[88:91], v[140:143]
  ds_read_b128 v[80:83], v23 offset:1024
  v_mfma_f32_16x16x32_bf16 v[140:143], a[68:71], v[84:87], v[140:143]
  buffer_load_dwordx4 v9, s[8:11], s69 offen offset:3072 sc1 lds
  s_add_u32 m0, s70, 114688
  s_add_u32 s69, s65, 131072
  v_mfma_f32_16x16x32_bf16 v[136:139], a[80:83], v[96:99], v[136:139]
  ds_read_b128 v[88:91], v23 offset:2048
  v_cndmask_b32 v192, v192, v193, s[88:89]
  v_cndmask_b32 v194, v194, v195, s[88:89]
  v_mfma_f32_16x16x32_bf16 v[136:139], a[88:91], v[92:95], v[136:139]
  buffer_load_dwordx4 v9, s[8:11], s69 offen offset:0 sc1 lds
  v_cndmask_b32 v225, v192, v194, s[90:91]
  v_mfma_f32_16x16x32_bf16 v[140:143], a[92:95], v[92:95], v[140:143]
  ds_read_b128 v[84:87], v23 offset:3072
  v_mfma_f32_16x16x32_bf16 v[140:143], a[84:87], v[96:99], v[140:143]
  s_waitcnt lgkmcnt(4)
  ds_write_b128 v182, v[144:147] offset:0
  v_mfma_f32_16x16x32_bf16 v[136:139], a[96:99], v[100:103], v[136:139]
  ds_read_b128 v[92:95], v23 offset:4096
  v_mfma_f32_16x16x32_bf16 v[136:139], a[104:107], v[104:107], v[136:139]
  buffer_load_dwordx4 v9, s[8:11], s69 offen offset:1024 sc1 lds
  v_mfma_f32_16x16x32_bf16 v[140:143], a[108:111], v[104:107], v[140:143]
  ds_read_b128 v[96:99], v23 offset:5120
  v_mfma_f32_16x16x32_bf16 v[140:143], a[100:103], v[100:103], v[140:143]
  buffer_load_dwordx4 v9, s[8:11], s69 offen offset:2048 sc1 lds
  v_mfma_f32_16x16x32_bf16 v[136:139], a[112:115], v[112:115], v[136:139]
  ds_read_b128 v[104:107], v23 offset:6144
  v_lshrrev_b32 v29, 2, v0
  v_mfma_f32_16x16x32_bf16 v[136:139], a[120:123], v[108:111], v[136:139]
  v_bfe_u32 v28, v29, 1, 2
  v_lshlrev_b32 v28, 5, v28
  v_mfma_f32_16x16x32_bf16 v[140:143], a[124:127], v[108:111], v[140:143]
  ds_read_b128 v[100:103], v23 offset:7168
  v_lshl_add_u32 v28, v29, 7, v28
  v_mfma_f32_16x16x32_bf16 v[140:143], a[116:119], v[112:115], v[140:143]
  s_waitcnt lgkmcnt(5)
  buffer_load_dwordx4 v9, s[8:11], s69 offen offset:3072 sc1 lds
  v_and_b32 v29, 3, v0
  v_mfma_f32_16x16x32_bf16 v[136:139], a[128:131], v[76:79], v[136:139]
  ds_read_b128 v[108:111], v22 offset:0
  v_lshl_add_u32 v2, v29, 3, v28
  v_mfma_f32_16x16x32_bf16 v[136:139], a[136:139], v[80:83], v[136:139]
  v_xor_b32 v3, 32, v2
  v_xor_b32 v4, 64, v2
  v_mfma_f32_16x16x32_bf16 v[140:143], a[140:143], v[80:83], v[140:143]
  ds_read_b128 v[112:115], v22 offset:1024
  v_xor_b32 v5, 96, v2
  v_mfma_f32_16x16x32_bf16 v[140:143], a[132:135], v[76:79], v[140:143]
  v_add_u32 v6, 65536, v2
  v_add_u32 v7, 65536, v3
  v_mfma_f32_16x16x32_bf16 v[136:139], a[144:147], v[88:91], v[136:139]
  ds_read_b128 v[80:83], v22 offset:2048
  v_add_u32 v8, 65536, v4
  v_mfma_f32_16x16x32_bf16 v[136:139], a[152:155], v[84:87], v[136:139]
  s_lshr_b32 s52, s2, 5
  s_lshl_b32 s52, s52, 19
  s_lshr_b32 s53, s44, 1
  v_mfma_f32_16x16x32_bf16 v[140:143], a[156:159], v[84:87], v[140:143]
  ds_read_b128 v[76:79], v22 offset:3072
  s_lshl_b32 s53, s53, 18
  v_mfma_f32_16x16x32_bf16 v[140:143], a[148:151], v[88:91], v[140:143]
  s_waitcnt lgkmcnt(4)
  s_add_u32 s52, s52, s53
  s_and_b32 s53, s44, 1
  v_mfma_f32_16x16x32_bf16 v[136:139], a[160:163], v[92:95], v[136:139]
  ds_read_b128 v[84:87], v22 offset:4096
  s_lshl_b32 s53, s53, 15
  v_mfma_f32_16x16x32_bf16 v[136:139], a[168:171], v[96:99], v[136:139]
  s_or_b32 s57, s2, s44
  s_mov_b32 s57, 851968
  s_cselect_b32 s57, 1073741824, s57
  v_add_u32 v15, s46, v0
  s_mov_b64 exec, 1
  buffer_store_dword v15, v0, s[8:11], s57 offen offset:0 sc1
  s_mov_b64 exec, -1
  s_add_u32 s56, s79, 12288
  v_mfma_f32_16x16x32_bf16 v[140:143], a[172:175], v[96:99], v[140:143]
  ds_read_b128 v[88:91], v22 offset:5120
  buffer_load_dwordx2 v[212:213], v220, s[8:11], s56 offen sc1
  v_mfma_f32_16x16x32_bf16 v[140:143], a[164:167], v[92:95], v[140:143]
  s_add_u32 s56, s79, 36864
  s_add_u32 s52, s52, s53
  s_add_u32 s24, s52, 36700160
  v_mfma_f32_16x16x32_bf16 v[136:139], a[176:179], v[104:107], v[136:139]
  ds_read_b128 v[96:99], v22 offset:6144
  s_lshl_b32 s57, s44, 28
  s_add_u32 s57, s57, s77
  buffer_load_dword v13, v14, s[8:11], s57 offen sc1
  buffer_load_dwordx2 v[214:215], v220, s[8:11], s56 offen sc1
  s_add_u32 s56, s79, 61440
  v_mfma_f32_16x16x32_bf16 v[136:139], a[184:187], v[100:103], v[136:139]
  buffer_load_dwordx2 v[216:217], v220, s[8:11], s56 offen sc1
  s_add_u32 s56, s79, 86016
  v_mfma_f32_16x16x32_bf16 v[140:143], a[188:191], v[100:103], v[140:143]
  ds_read_b128 v[92:95], v22 offset:7168
  v_mfma_f32_16x16x32_bf16 v[140:143], a[180:183], v[104:107], v[140:143]
  s_waitcnt lgkmcnt(4)
  buffer_load_dwordx2 v[218:219], v220, s[8:11], s56 offen sc1
  s_waitcnt vmcnt(15)
  s_barrier
  v_mfma_f32_16x16x32_bf16 v[136:139], a[192:195], v[108:111], v[136:139]
  ds_read_b128 v[100:103], v22 offset:32768
  s_bitcmp1_b32 s2, 3
  s_cselect_b64 s[12:13], s[32:33], s[28:29]
  v_mfma_f32_16x16x32_bf16 v[136:139], a[200:203], v[112:115], v[136:139]
  s_mov_b32 s14, 7340032
  s_mov_b32 s16, 0x03030303
  s_mov_b32 s17, 0x03030303
  v_mfma_f32_16x16x32_bf16 v[140:143], a[204:207], v[112:115], v[140:143]
  ds_read_b128 v[104:107], v22 offset:33792
  s_mov_b32 s18, 0x0c0c0c0c
  v_mfma_f32_16x16x32_bf16 v[140:143], a[196:199], v[108:111], v[140:143]
  s_mov_b32 s19, 0x0c0c0c0c
  s_mov_b32 s20, 0x30303030
  s_mov_b32 s21, 0x30303030
  v_mfma_f32_16x16x32_bf16 v[136:139], a[208:211], v[80:83], v[136:139]
  ds_read_b128 v[112:115], v22 offset:34816
  s_waitcnt vmcnt(40) lgkmcnt(15)
  v_lshlrev_b32 v184, 16, v148
  v_and_b32 v185, 0xffff0000, v148
  v_lshlrev_b32 v186, 16, v149
  v_mfma_f32_16x16x32_bf16 v[136:139], a[216:219], v[76:79], v[136:139]
  v_and_b32 v187, 0xffff0000, v149
  v_lshlrev_b32 v188, 16, v150
  v_and_b32 v189, 0xffff0000, v150
  v_lshlrev_b32 v190, 16, v151
  v_and_b32 v191, 0xffff0000, v151
  v_mfma_f32_16x16x32_bf16 v[140:143], a[220:223], v[76:79], v[140:143]
  ds_read_b128 v[108:111], v22 offset:35840
  s_mov_b32 s22, 0xc0c0c0c0
  v_mfma_f32_16x16x32_bf16 v[140:143], a[212:215], v[80:83], v[140:143]
  s_waitcnt lgkmcnt(4)
  s_mov_b32 s23, 0xc0c0c0c0
  v_mfma_f32_16x16x32_bf16 v[136:139], a[224:227], v[84:87], v[136:139]
  ds_read_b128 v[76:79], v22 offset:36864
  v_mfma_f32_16x16x32_bf16 v[136:139], a[232:235], v[88:91], v[136:139]
  v_mfma_f32_16x16x32_bf16 v[140:143], a[236:239], v[88:91], v[140:143]
  ds_read_b128 v[80:83], v22 offset:37888
  v_mfma_f32_16x16x32_bf16 v[140:143], a[228:231], v[84:87], v[140:143]
  v_mfma_f32_16x16x32_bf16 v[136:139], a[240:243], v[96:99], v[136:139]
  ds_read_b128 v[88:91], v22 offset:38912
  v_mfma_f32_16x16x32_bf16 v[136:139], a[248:251], v[92:95], v[136:139]
  v_mfma_f32_16x16x32_bf16 v[140:143], v[124:127], v[92:95], v[140:143]
  ds_read_b128 v[84:87], v22 offset:39936
  v_mfma_f32_16x16x32_bf16 v[140:143], a[244:247], v[96:99], v[140:143]
  s_waitcnt lgkmcnt(4)
  v_mfma_f32_16x16x32_bf16 v[128:131], a[0:3], v[100:103], 0
  ds_read_b128 v[92:95], v22 offset:49152
  v_mfma_f32_16x16x32_bf16 v[128:131], a[8:11], v[104:107], v[128:131]
  v_mfma_f32_16x16x32_bf16 v[132:135], a[12:15], v[104:107], 0
  ds_read_b128 v[96:99], v22 offset:50176
  v_fmac_f32 v184, v160, v136
  v_fmac_f32 v185, v161, v137
  v_fmac_f32 v186, v162, v138
  v_fmac_f32 v187, v163, v139
  v_mfma_f32_16x16x32_bf16 v[132:135], a[4:7], v[100:103], v[132:135]
  v_fmac_f32 v188, v164, v140
  v_fmac_f32 v189, v165, v141
  v_fmac_f32 v190, v166, v142
  v_fmac_f32 v191, v167, v143
  v_mul_f32 v136, v184, v168
  v_mfma_f32_16x16x32_bf16 v[128:131], a[16:19], v[112:115], v[128:131]
  ds_read_b128 v[104:107], v22 offset:51200
  v_mul_f32 v137, v185, v169
  v_mul_f32 v138, v186, v170
  v_mul_f32 v139, v187, v171
  v_mul_f32 v140, v188, v172
  v_mfma_f32_16x16x32_bf16 v[128:131], a[24:27], v[108:111], v[128:131]
  v_mul_f32 v141, v189, v173
  v_mul_f32 v142, v190, v174
  v_mul_f32 v143, v191, v175
  v_cvt_pk_bf16_f32 v200, v136, v137
  v_cvt_pk_bf16_f32 v201, v138, v139
  v_mfma_f32_16x16x32_bf16 v[132:135], a[28:31], v[108:111], v[132:135]
  ds_read_b128 v[100:103], v22 offset:52224
  v_cvt_pk_bf16_f32 v202, v140, v141
  v_cvt_pk_bf16_f32 v203, v142, v143
  v_mfma_f32_16x16x32_bf16 v[132:135], a[20:23], v[112:115], v[132:135]
  s_waitcnt lgkmcnt(4)
  s_add_u32 s54, s47, 36765696
  buffer_store_dwordx4 v[200:203], v1, s[8:11], s54 offen sc1
  v_mfma_f32_16x16x32_bf16 v[128:131], a[32:35], v[76:79], v[128:131]
  ds_read_b128 v[108:111], v22 offset:53248
  v_cvt_pk_bf16_f32 v148, v184, v185
  v_cvt_pk_bf16_f32 v149, v186, v187
  v_cvt_pk_bf16_f32 v150, v188, v189
  v_cvt_pk_bf16_f32 v151, v190, v191
  v_mfma_f32_16x16x32_bf16 v[128:131], a[40:43], v[80:83], v[128:131]
  s_nop 0
  v_mfma_f32_16x16x32_bf16 v[226:229], v[176:179], v[148:151], 0
  v_mfma_f32_16x16x32_bf16 v[192:195], v[148:151], v[148:151], 0
  v_mfma_f32_16x16x32_bf16 v[132:135], a[44:47], v[80:83], v[132:135]
  ds_read_b128 v[112:115], v22 offset:54272
  v_mfma_f32_16x16x32_bf16 v[132:135], a[36:39], v[76:79], v[132:135]
  v_mfma_f32_16x16x32_bf16 v[128:131], a[48:51], v[88:91], v[128:131]
  ds_read_b128 v[80:83], v22 offset:55296
  s_nop 2
  v_cndmask_b32 v192, v192, v193, s[88:89]
  v_cndmask_b32 v194, v194, v195, s[88:89]
  v_cndmask_b32 v227, v192, v194, s[90:91]
  v_mfma_f32_16x16x32_bf16 v[128:131], a[56:59], v[84:87], v[128:131]
  buffer_store_dwordx4 v[224:227], v180, s[8:11], s48 offen offset:0 sc1
  v_mfma_f32_16x16x32_bf16 v[132:135], a[60:63], v[84:87], v[132:135]
  ds_read_b128 v[76:79], v22 offset:56320
  v_mfma_f32_16x16x32_bf16 v[132:135], a[52:55], v[88:91], v[132:135]
  s_waitcnt lgkmcnt(4)
  s_waitcnt vmcnt(5)
  s_cmp_lg_u32 s44, 0
  s_cbranch_scc1 PL8_adaLN_cond__sliding_local_dilated__swiglu_ffn__prompt_kernelx
  v_subrev_u32 v13, s46, v13
  v_subrev_u32 v13, 3, v13
  v_cmp_lt_u32 vcc, 3, v13
  s_nop 4
  s_cbranch_vccz PL8_adaLN_cond__sliding_local_dilated__swiglu_ffn__prompt_kernelx
  s_mov_b32 s57, 60000
PL8_adaLN_cond__sliding_local_dilated__swiglu_ffn__prompt_kernel:
  buffer_load_dword v13, v14, s[8:11], s77 offen sc1
  s_sub_u32 s57, s57, 1
  s_cmp_eq_u32 s57, 0
  s_waitcnt vmcnt(0)
  s_cbranch_scc1 PL8_adaLN_cond__sliding_local_dilated__swiglu_ffn__prompt_kernelx
  v_subrev_u32 v13, s46, v13
  v_subrev_u32 v13, 3, v13
  v_cmp_lt_u32 vcc, 3, v13
  s_nop 4
  s_cbranch_vccnz PL8_adaLN_cond__sliding_local_dilated__swiglu_ffn__prompt_kernel
PL8_adaLN_cond__sliding_local_dilated__swiglu_ffn__prompt_kernelx:
  s_waitcnt vmcnt(8)
  s_barrier
  v_mfma_f32_16x16x32_bf16 v[128:131], a[64:67], v[92:95], v[128:131]
  ds_read_b128 v[84:87], v23 offset:32768
  s_add_u32 m0, s70, 16384
  s_add_u32 s69, s62, 196608
  ds_write_b128 v182, v[148:151] offset:4096
  v_mfma_f32_16x16x32_bf16 v[128:131], a[72:75], v[96:99], v[128:131]
  buffer_load_dwordx4 v9, s[8:11], s69 offen offset:0 sc1 lds
  v_mfma_f32_16x16x32_bf16 v[132:135], a[76:79], v[96:99], v[132:135]
  ds_read_b128 v[88:91], v23 offset:33792
  v_mfma_f32_16x16x32_bf16 v[132:135], a[68:71], v[92:95], v[132:135]
  buffer_load_dwordx4 v9, s[8:11], s69 offen offset:1024 sc1 lds
  v_mfma_f32_16x16x32_bf16 v[128:131], a[80:83], v[104:107], v[128:131]
  ds_read_b128 v[96:99], v23 offset:34816
  buffer_load_dwordx4 v9, s[8:11], s69 offen offset:2048 sc1 lds
  v_mfma_f32_16x16x32_bf16 v[128:131], a[88:91], v[100:103], v[128:131]
  v_mfma_f32_16x16x32_bf16 v[132:135], a[92:95], v[100:103], v[132:135]
  ds_read_b128 v[92:95], v23 offset:35840
  buffer_load_dwordx4 v9, s[8:11], s69 offen offset:3072 sc1 lds
  s_add_u32 m0, s70, 81920
  s_add_u32 s69, s63, 196608
  v_mfma_f32_16x16x32_bf16 v[132:135], a[84:87], v[104:107], v[132:135]
  s_waitcnt lgkmcnt(5)
  buffer_load_dwordx4 v9, s[8:11], s69 offen offset:0 sc1 lds
  v_mfma_f32_16x16x32_bf16 v[128:131], a[96:99], v[108:111], v[128:131]
  ds_read_b128 v[100:103], v23 offset:36864
  v_mfma_f32_16x16x32_bf16 v[128:131], a[104:107], v[112:115], v[128:131]
  buffer_load_dwordx4 v9, s[8:11], s69 offen offset:1024 sc1 lds
  v_mfma_f32_16x16x32_bf16 v[132:135], a[108:111], v[112:115], v[132:135]
  ds_read_b128 v[104:107], v23 offset:37888
  buffer_load_dwordx4 v9, s[8:11], s69 offen offset:2048 sc1 lds
  v_mfma_f32_16x16x32_bf16 v[132:135], a[100:103], v[108:111], v[132:135]
  v_mfma_f32_16x16x32_bf16 v[128:131], a[112:115], v[80:83], v[128:131]
  ds_read_b128 v[112:115], v23 offset:38912
  buffer_load_dwordx4 v9, s[8:11], s69 offen offset:3072 sc1 lds
  s_add_u32 m0, s70, 65536
  s_add_u32 s69, s64, 196608
  v_mfma_f32_16x16x32_bf16 v[128:131], a[120:123], v[76:79], v[128:131]
  buffer_load_dwordx4 v9, s[8:11], s69 offen offset:0 sc1 lds
  v_mfma_f32_16x16x32_bf16 v[132:135], a[124:127], v[76:79], v[132:135]
  ds_read_b128 v[108:111], v23 offset:39936
  v_mfma_f32_16x16x32_bf16 v[132:135], a[116:119], v[80:83], v[132:135]
  s_waitcnt lgkmcnt(4)
  buffer_load_dwordx4 v9, s[8:11], s69 offen offset:1024 sc1 lds
  v_mfma_f32_16x16x32_bf16 v[128:131], a[128:131], v[84:87], v[128:131]
  ds_read_b128 v[76:79], v23 offset:49152
  buffer_load_dwordx4 v9, s[8:11], s69 offen offset:2048 sc1 lds
  v_mfma_f32_16x16x32_bf16 v[128:131], a[136:139], v[88:91], v[128:131]
  v_mfma_f32_16x16x32_bf16 v[132:135], a[140:143], v[88:91], v[132:135]
  ds_read_b128 v[80:83], v23 offset:50176
  buffer_load_dwordx4 v9, s[8:11], s69 offen offset:3072 sc1 lds
  s_add_u32 m0, s70, 0
  s_add_u32 s69, s65, 196608
  v_mfma_f32_16x16x32_bf16 v[132:135], a[132:135], v[84:87], v[132:135]
  buffer_load_dwordx4 v9, s[8:11], s69 offen offset:0 sc1 lds
  v_mfma_f32_16x16x32_bf16 v[128:131], a[144:147], v[96:99], v[128:131]
  ds_read_b128 v[88:91], v23 offset:51200
  v_mfma_f32_16x16x32_bf16 v[128:131], a[152:155], v[92:95], v[128:131]
  buffer_load_dwordx4 v9, s[8:11], s69 offen offset:1024 sc1 lds
  v_mfma_f32_16x16x32_bf16 v[132:135], a[156:159], v[92:95], v[132:135]
  ds_read_b128 v[84:87], v23 offset:52224
  buffer_load_dwordx4 v9, s[8:11], s69 offen offset:2048 sc1 lds
  v_mfma_f32_16x16x32_bf16 v[132:135], a[148:151], v[96:99], v[132:135]
  s_waitcnt lgkmcnt(4)
  v_mfma_f32_16x16x32_bf16 v[128:131], a[160:163], v[100:103], v[128:131]
  ds_read_b128 v[92:95], v23 offset:53248
  v_mfma_f32_16x16x32_bf16 v[128:131], a[168:171], v[104:107], v[128:131]
  buffer_load_dwordx4 v9, s[8:11], s69 offen offset:3072 sc1 lds
  v_mfma_f32_16x16x32_bf16 v[132:135], a[172:175], v[104:107], v[132:135]
  ds_read_b128 v[96:99], v23 offset:54272
  v_mfma_f32_16x16x32_bf16 v[132:135], a[164:167], v[100:103], v[132:135]
  v_mfma_f32_16x16x32_bf16 v[128:131], a[176:179], v[112:115], v[128:131]
  ds_read_b128 v[104:107], v23 offset:55296
  s_waitcnt vmcnt(18)
  v_mfma_f32_16x16x32_bf16 v[128:131], a[184:187], v[108:111], v[128:131]
  s_mov_b32 s55, 0
  s_add_u32 m0, s45, 32768
  v_add_f32 v212, v212, v214
  s_sub_u32 s73, s49, 524288
  v_mfma_f32_16x16x32_bf16 v[132:135], a[188:191], v[108:111], v[132:135]
  ds_read_b128 v[100:103], v23 offset:56320
  buffer_load_dwordx4 v16, s[28:31], s55 offen lds
  v_mfma_f32_16x16x32_bf16 v[132:135], a[180:183], v[112:115], v[132:135]
  s_waitcnt lgkmcnt(4)
  s_waitcnt vmcnt(9)
  s_barrier
  v_add_u32 v15, s46, v0
  s_mov_b64 exec, 1
  buffer_store_dword v15, v0, s[8:11], s73 offen offset:0 sc1
  s_mov_b64 exec, -1
  v_mfma_f32_16x16x32_bf16 v[128:131], a[192:195], v[76:79], v[128:131]
  ds_read_b128 v[108:111], v22 offset:16384
  v_add_f32 v216, v216, v218
  v_mfma_f32_16x16x32_bf16 v[128:131], a[200:203], v[80:83], v[128:131]
  v_add_f32 v212, v212, v216
  v_add_f32 v213, v213, v215
  v_mfma_f32_16x16x32_bf16 v[132:135], a[204:207], v[80:83], v[132:135]
  ds_read_b128 v[112:115], v22 offset:17408
  v_add_f32 v217, v217, v219
  v_mfma_f32_16x16x32_bf16 v[132:135], a[196:199], v[76:79], v[132:135]
HOP6:
  s_cbranch_execz HOP10
  s_mov_b32 s55, 0
  s_add_u32 m0, s45, 40960
  v_add_f32 v213, v213, v217
  v_mfma_f32_16x16x32_bf16 v[128:131], a[208:211], v[88:91], v[128:131]
  ds_read_b128 v[80:83], v22 offset:18432
  s_waitcnt vmcnt(59) lgkmcnt(15)
  v_lshlrev_b32 v184, 16, v152
  v_mfma_f32_16x16x32_bf16 v[128:131], a[216:219], v[84:87], v[128:131]
  buffer_load_dwordx4 v16, s[32:35], s55 offen lds
  v_and_b32 v185, 0xffff0000, v152
  v_lshlrev_b32 v186, 16, v153
  v_and_b32 v187, 0xffff0000, v153
  v_mfma_f32_16x16x32_bf16 v[132:135], a[220:223], v[84:87], v[132:135]
  ds_read_b128 v[76:79], v22 offset:19456
  v_lshlrev_b32 v188, 16, v154
  v_and_b32 v189, 0xffff0000, v154
  v_mfma_f32_16x16x32_bf16 v[132:135], a[212:215], v[88:91], v[132:135]
  s_waitcnt lgkmcnt(4)
  v_lshlrev_b32 v190, 16, v155
  v_and_b32 v191, 0xffff0000, v155
  v_mfma_f32_16x16x32_bf16 v[128:131], a[224:227], v[92:95], v[128:131]
  ds_read_b128 v[84:87], v22 offset:20480
  v_lshrrev_b32 v28, 5, v0
  v_mfma_f32_16x16x32_bf16 v[128:131], a[232:235], v[96:99], v[128:131]
  s_mov_b32 s55, 229376
  s_add_u32 m0, s45, 36864
  v_xor_b32 v29, 1, v28
  v_mfma_f32_16x16x32_bf16 v[132:135], a[236:239], v[96:99], v[132:135]
  ds_read_b128 v[88:91], v22 offset:21504
  v_cvt_f32_u32 v29, v29
  v_mfma_f32_16x16x32_bf16 v[132:135], a[228:231], v[92:95], v[132:135]
  buffer_load_dwordx4 v16, s[28:31], s55 offen lds
  v_cvt_pk_bf16_f32 v214, v212, v213
  v_lshlrev_b32 v212, 16, v214
  v_mfma_f32_16x16x32_bf16 v[128:131], a[240:243], v[104:107], v[128:131]
  ds_read_b128 v[96:99], v22 offset:22528
  v_and_b32 v213, 0xffff0000, v214
  v_mfma_f32_16x16x32_bf16 v[128:131], a[248:251], v[100:103], v[128:131]
  v_add_f32 v212, v212, v29
  v_add_f32 v213, v213, v29
  v_mfma_f32_16x16x32_bf16 v[132:135], v[124:127], v[100:103], v[132:135]
  ds_read_b128 v[92:95], v22 offset:23552
  v_cvt_pk_bf16_f32 v214, v212, v213
  v_mfma_f32_16x16x32_bf16 v[132:135], a[244:247], v[104:107], v[132:135]
  s_waitcnt lgkmcnt(4)
  s_mov_b32 s55, 229376
  s_add_u32 m0, s45, 45056
  v_mfma_f32_16x16x32_bf16 v[136:139], a[0:3], v[108:111], 0
  ds_read_b128 v[100:103], v23 offset:16384
  v_lshlrev_b32 v212, 16, v214
  v_mfma_f32_16x16x32_bf16 v[136:139], a[8:11], v[112:115], v[136:139]
  buffer_load_dwordx4 v16, s[32:35], s55 offen lds
  v_and_b32 v213, 0xffff0000, v214
  v_lshrrev_b32 v215, 16, v214
  v_mfma_f32_16x16x32_bf16 v[140:143], a[12:15], v[112:115], 0
  ds_read_b128 v[104:107], v23 offset:17408
  v_fmac_f32 v184, v160, v128
  v_fmac_f32 v185, v161, v129
  v_mfma_f32_16x16x32_bf16 v[140:143], a[4:7], v[108:111], v[140:143]
  v_fmac_f32 v186, v162, v130
  v_fmac_f32 v187, v163, v131
  v_fmac_f32 v188, v164, v132
  v_mfma_f32_16x16x32_bf16 v[136:139], a[16:19], v[80:83], v[136:139]
  ds_read_b128 v[112:115], v23 offset:18432
  v_fmac_f32 v189, v165, v133
  v_fmac_f32 v190, v166, v134
  v_mfma_f32_16x16x32_bf16 v[136:139], a[24:27], v[76:79], v[136:139]
  s_mov_b32 s55, 0
  s_add_u32 m0, s45, 98304
  v_fmac_f32 v191, v167, v135
  v_mul_f32 v128, v184, v168
  v_mfma_f32_16x16x32_bf16 v[140:143], a[28:31], v[76:79], v[140:143]
  ds_read_b128 v[108:111], v23 offset:19456
  v_mul_f32 v129, v185, v169
  v_mul_f32 v130, v186, v170
  v_mfma_f32_16x16x32_bf16 v[140:143], a[20:23], v[80:83], v[140:143]
  s_waitcnt lgkmcnt(4)
  buffer_load_dwordx4 v11, s[28:31], s55 offen lds
  v_mul_f32 v131, v187, v171
  v_mul_f32 v132, v188, v172
  v_mfma_f32_16x16x32_bf16 v[136:139], a[32:35], v[84:87], v[136:139]
  ds_read_b128 v[76:79], v23 offset:20480
  v_mul_f32 v133, v189, v173
  v_mul_f32 v134, v190, v174
  v_mfma_f32_16x16x32_bf16 v[136:139], a[40:43], v[88:91], v[136:139]
  v_mul_f32 v135, v191, v175
  v_cvt_pk_bf16_f32 v204, v128, v129
  v_cvt_pk_bf16_f32 v205, v130, v131
  v_and_b32 v214, 0xffff, v214
  v_mfma_f32_16x16x32_bf16 v[140:143], a[44:47], v[88:91], v[140:143]
  ds_read_b128 v[80:83], v23 offset:21504
  v_cvt_pk_bf16_f32 v206, v132, v133
  v_cvt_pk_bf16_f32 v207, v134, v135
  v_mfma_f32_16x16x32_bf16 v[140:143], a[36:39], v[84:87], v[140:143]
  s_mov_b32 s55, 0
  s_add_u32 m0, s45, 106496
  s_add_u32 s52, s45, 151552
  v_mfma_f32_16x16x32_bf16 v[136:139], a[48:51], v[96:99], v[136:139]
  ds_read_b128 v[88:91], v23 offset:22528
  v_lshlrev_b32 v28, 8, v28
  v_mfma_f32_16x16x32_bf16 v[136:139], a[56:59], v[92:95], v[136:139]
  buffer_load_dwordx4 v11, s[32:35], s55 offen lds
  s_add_u32 s54, s47, 36831232
  buffer_store_dwordx4 v[204:207], v1, s[8:11], s54 offen sc1
  v_mfma_f32_16x16x32_bf16 v[140:143], a[60:63], v[92:95], v[140:143]
  ds_read_b128 v[84:87], v23 offset:23552
  v_cvt_pk_bf16_f32 v152, v184, v185
  v_cvt_pk_bf16_f32 v153, v186, v187
  v_mfma_f32_16x16x32_bf16 v[140:143], a[52:55], v[96:99], v[140:143]
  s_waitcnt lgkmcnt(4)
  v_cvt_pk_bf16_f32 v154, v188, v189
  s_waitcnt vmcnt(8)
  s_barrier
  v_mfma_f32_16x16x32_bf16 v[136:139], a[64:67], v[100:103], v[136:139]
  ds_read_b128 v[92:95], v23 offset:0
  v_cvt_pk_bf16_f32 v155, v190, v191
  v_mfma_f32_16x16x32_bf16 v[136:139], a[72:75], v[104:107], v[136:139]
  s_mov_b32 s55, 229376
  s_add_u32 m0, s45, 102400
  v_mfma_f32_16x16x32_bf16 v[228:231], v[176:179], v[152:155], 0
  v_mfma_f32_16x16x32_bf16 v[192:195], v[152:155], v[152:155], 0
  v_lshl_add_u32 v28, v0, 3, v28
  v_add_u32 v28, s52, v28
  v_mfma_f32_16x16x32_bf16 v[140:143], a[76:79], v[104:107], v[140:143]
  ds_read_b128 v[96:99], v23 offset:1024
  v_mfma_f32_16x16x32_bf16 v[140:143], a[68:71], v[100:103], v[140:143]
  buffer_load_dwordx4 v11, s[28:31], s55 offen lds
  ds_write_b64 v28, v[214:215]
  v_mfma_f32_16x16x32_bf16 v[136:139], a[80:83], v[112:115], v[136:139]
  ds_read_b128 v[104:107], v23 offset:2048
  v_cndmask_b32 v192, v192, v193, s[88:89]
  v_cndmask_b32 v194, v194, v195, s[88:89]
  v_mfma_f32_16x16x32_bf16 v[136:139], a[88:91], v[108:111], v[136:139]
  ds_write_b64 v28, v[212:213] offset:256
  v_cndmask_b32 v229, v192, v194, s[90:91]
  v_mfma_f32_16x16x32_bf16 v[140:143], a[92:95], v[108:111], v[140:143]
  ds_read_b128 v[100:103], v23 offset:3072
  v_mfma_f32_16x16x32_bf16 v[140:143], a[84:87], v[112:115], v[140:143]
  s_waitcnt lgkmcnt(6)
  s_mov_b32 s55, 229376
  s_add_u32 m0, s45, 110592
  v_mfma_f32_16x16x32_bf16 v[136:139], a[96:99], v[76:79], v[136:139]
  ds_read_b128 v[108:111], v23 offset:4096
  ds_write_b128 v182, v[152:155] offset:8192
  v_mfma_f32_16x16x32_bf16 v[136:139], a[104:107], v[80:83], v[136:139]
  buffer_load_dwordx4 v11, s[32:35], s55 offen lds
  v_mfma_f32_16x16x32_bf16 v[140:143], a[108:111], v[80:83], v[140:143]
  ds_read_b128 v[112:115], v23 offset:5120
  v_mfma_f32_16x16x32_bf16 v[140:143], a[100:103], v[76:79], v[140:143]
  v_mfma_f32_16x16x32_bf16 v[136:139], a[112:115], v[88:91], v[136:139]
  ds_read_b128 v[80:83], v23 offset:6144
  v_mfma_f32_16x16x32_bf16 v[136:139], a[120:123], v[84:87], v[136:139]
  s_mov_b32 s55, 458752
  s_add_u32 m0, s45, 114688
  v_mfma_f32_16x16x32_bf16 v[140:143], a[124:127], v[84:87], v[140:143]
  ds_read_b128 v[76:79], v23 offset:7168
  v_mfma_f32_16x16x32_bf16 v[140:143], a[116:119], v[88:91], v[140:143]
  s_waitcnt lgkmcnt(5)
  buffer_load_dwordx4 v11, s[28:31], s55 offen lds
  v_mfma_f32_16x16x32_bf16 v[136:139], a[128:131], v[92:95], v[136:139]
  ds_read_b128 v[84:87], v22 offset:0
  v_mfma_f32_16x16x32_bf16 v[136:139], a[136:139], v[96:99], v[136:139]
  v_mfma_f32_16x16x32_bf16 v[140:143], a[140:143], v[96:99], v[140:143]
  ds_read_b128 v[88:91], v22 offset:1024
  v_mfma_f32_16x16x32_bf16 v[140:143], a[132:135], v[92:95], v[140:143]
  s_mov_b32 s55, 458752
  s_add_u32 m0, s45, 122880
  v_mfma_f32_16x16x32_bf16 v[136:139], a[144:147], v[104:107], v[136:139]
  ds_read_b128 v[96:99], v22 offset:2048
  v_mfma_f32_16x16x32_bf16 v[136:139], a[152:155], v[100:103], v[136:139]
  buffer_load_dwordx4 v11, s[32:35], s55 offen lds
  v_mfma_f32_16x16x32_bf16 v[140:143], a[156:159], v[100:103], v[140:143]
  ds_read_b128 v[92:95], v22 offset:3072
  v_mfma_f32_16x16x32_bf16 v[140:143], a[148:151], v[104:107], v[140:143]
  s_waitcnt lgkmcnt(4)
  v_mfma_f32_16x16x32_bf16 v[136:139], a[160:163], v[108:111], v[136:139]
  ds_read_b128 v[100:103], v22 offset:4096
  v_mfma_f32_16x16x32_bf16 v[136:139], a[168:171], v[112:115], v[136:139]
  s_mov_b32 s55, 688128
  s_add_u32 m0, s45, 118784
  v_mfma_f32_16x16x32_bf16 v[140:143], a[172:175], v[112:115], v[140:143]
  ds_read_b128 v[104:107], v22 offset:5120
  v_mfma_f32_16x16x32_bf16 v[140:143], a[164:167], v[108:111], v[140:143]
  buffer_load_dwordx4 v11, s[28:31], s55 offen lds
  v_mfma_f32_16x16x32_bf16 v[136:139], a[176:179], v[80:83], v[136:139]
  ds_read_b128 v[112:115], v22 offset:6144
  s_waitcnt vmcnt(63) lgkmcnt(15)
  v_mfma_f32_16x16x32_bf16 v[136:139], a[184:187], v[76:79], v[136:139]
  s_lshr_b32 s77, s2, 5
  s_lshl_b32 s77, s77, 12
  s_add_u32 s77, s77, 229376
  v_mfma_f32_16x16x32_bf16 v[140:143], a[188:191], v[76:79], v[140:143]
  ds_read_b128 v[108:111], v22 offset:7168
  s_mov_b32 s55, 688128
  s_add_u32 m0, s45, 126976
  v_mfma_f32_16x16x32_bf16 v[140:143], a[180:183], v[80:83], v[140:143]
  s_waitcnt lgkmcnt(4)
  v_and_b32 v14, 31, v0
  v_lshlrev_b32 v14, 7, v14
  v_mfma_f32_16x16x32_bf16 v[136:139], a[192:195], v[84:87], v[136:139]
  buffer_load_dwordx4 v11, s[32:35], s55 offen lds
  v_lshlrev_b32 v184, 16, v156
  v_and_b32 v185, 0xffff0000, v156
  v_mfma_f32_16x16x32_bf16 v[136:139], a[200:203], v[88:91], v[136:139]
  s_lshl_b32 s57, s44, 28
  s_add_u32 s57, s57, s77
  buffer_load_dword v13, v14, s[8:11], s57 offen sc1
  v_mfma_f32_16x16x32_bf16 v[140:143], a[204:207], v[88:91], v[140:143]
  v_lshlrev_b32 v186, 16, v157
  v_and_b32 v187, 0xffff0000, v157
  v_mfma_f32_16x16x32_bf16 v[140:143], a[196:199], v[84:87], v[140:143]
  v_lshlrev_b32 v188, 16, v158
  v_and_b32 v189, 0xffff0000, v158
  v_mfma_f32_16x16x32_bf16 v[136:139], a[208:211], v[96:99], v[136:139]
  v_lshlrev_b32 v190, 16, v159
  v_and_b32 v191, 0xffff0000, v159
  v_mfma_f32_16x16x32_bf16 v[136:139], a[216:219], v[92:95], v[136:139]
  s_mov_b32 s55, 458752
  s_add_u32 m0, s45, 49152
  v_mfma_f32_16x16x32_bf16 v[140:143], a[220:223], v[92:95], v[140:143]
  buffer_load_dwordx4 v16, s[28:31], s55 offen lds
  v_mfma_f32_16x16x32_bf16 v[140:143], a[212:215], v[96:99], v[140:143]
  s_waitcnt lgkmcnt(0)
  v_mfma_f32_16x16x32_bf16 v[136:139], a[224:227], v[100:103], v[136:139]
  v_mfma_f32_16x16x32_bf16 v[136:139], a[232:235], v[104:107], v[136:139]
  v_mfma_f32_16x16x32_bf16 v[140:143], a[236:239], v[104:107], v[140:143]
  v_mfma_f32_16x16x32_bf16 v[140:143], a[228:231], v[100:103], v[140:143]
  s_mov_b32 s55, 458752
  s_add_u32 m0, s45, 57344
  v_mfma_f32_16x16x32_bf16 v[136:139], a[240:243], v[112:115], v[136:139]
  buffer_load_dwordx4 v16, s[32:35], s55 offen lds
  v_mfma_f32_16x16x32_bf16 v[136:139], a[248:251], v[108:111], v[136:139]
  v_mfma_f32_16x16x32_bf16 v[140:143], v[124:127], v[108:111], v[140:143]
  v_mfma_f32_16x16x32_bf16 v[140:143], a[244:247], v[112:115], v[140:143]
  s_nop 5
  v_fmac_f32 v184, v160, v136
  v_fmac_f32 v185, v161, v137
  v_fmac_f32 v186, v162, v138
  v_fmac_f32 v187, v163, v139
  v_fmac_f32 v188, v164, v140
  v_fmac_f32 v189, v165, v141
  v_fmac_f32 v190, v166, v142
  v_fmac_f32 v191, v167, v143
  v_mul_f32 v136, v184, v168
  v_mul_f32 v137, v185, v169
  v_mul_f32 v138, v186, v170
  v_mul_f32 v139, v187, v171
  v_mul_f32 v140, v188, v172
  v_mul_f32 v141, v189, v173
  v_mul_f32 v142, v190, v174
  v_mul_f32 v143, v191, v175
  v_cvt_pk_bf16_f32 v208, v136, v137
  v_cvt_pk_bf16_f32 v209, v138, v139
  v_cvt_pk_bf16_f32 v210, v140, v141
  v_cvt_pk_bf16_f32 v211, v142, v143
  s_add_u32 s54, s47, 36896768
  buffer_store_dwordx4 v[208:211], v1, s[8:11], s54 offen sc1
  v_cvt_pk_bf16_f32 v156, v184, v185
  v_cvt_pk_bf16_f32 v157, v186, v187
  v_cvt_pk_bf16_f32 v158, v188, v189
  v_cvt_pk_bf16_f32 v159, v190, v191
  s_nop 1
  v_mfma_f32_16x16x32_bf16 v[230:233], v[176:179], v[156:159], 0
  v_mfma_f32_16x16x32_bf16 v[192:195], v[156:159], v[156:159], 0
  s_nop 7
  v_cndmask_b32 v192, v192, v193, s[88:89]
  v_cndmask_b32 v194, v194, v195, s[88:89]
  v_cndmask_b32 v231, v192, v194, s[90:91]
  buffer_store_dwordx4 v[228:231], v180, s[8:11], s48 offen offset:256 sc1
  ds_write_b128 v182, v[156:159] offset:12288
  s_mov_b64 exec, 0
  s_cmp_eq_u32 s44, 0
  s_cbranch_scc1 HOP12
  s_cmp_eq_u32 s44, 1
  s_cbranch_scc1 HOP13
  s_cmp_eq_u32 s44, 2
  s_cbranch_scc1 HOP14
  s_cmp_eq_u32 s44, 3
  s_cbranch_scc1 HOP15
WRET1:
  s_mov_b64 exec, -1
  s_waitcnt vmcnt(9) lgkmcnt(0)
  s_waitcnt vmcnt(4)
  s_cmp_lg_u32 s44, 0
  s_cbranch_scc1 PL9_adaLN_cond__sliding_local_dilated__swiglu_ffn__prompt_kernelx
  v_cmp_ne_u32 vcc, s46, v13
  s_nop 4
  s_cbranch_vccz PL9_adaLN_cond__sliding_local_dilated__swiglu_ffn__prompt_kernelx
  s_mov_b32 s57, 60000
PL9_adaLN_cond__sliding_local_dilated__swiglu_ffn__prompt_kernel:
  buffer_load_dword v13, v14, s[8:11], s77 offen sc1
  s_sub_u32 s57, s57, 1
  s_cmp_eq_u32 s57, 0
  s_waitcnt vmcnt(0)
  s_cbranch_scc1 PL9_adaLN_cond__sliding_local_dilated__swiglu_ffn__prompt_kernelx
  v_cmp_ne_u32 vcc, s46, v13
  s_nop 4
  s_cbranch_vccnz PL9_adaLN_cond__sliding_local_dilated__swiglu_ffn__prompt_kernel
PL9_adaLN_cond__sliding_local_dilated__swiglu_ffn__prompt_kernelx:
  s_barrier
  s_mov_b32 s63, 0
  s_add_u32 s71, s24, 0
  buffer_load_dwordx4 a[0:3], v1, s[8:11], s71 offen offset:0 sc1
  buffer_load_dwordx4 a[16:19], v1, s[8:11], s71 offen offset:1024 sc1
  s_add_u32 s71, s71, 65536
  buffer_load_dwordx4 a[4:7], v1, s[8:11], s71 offen offset:0 sc1
  buffer_load_dwordx4 a[20:23], v1, s[8:11], s71 offen offset:1024 sc1
  s_mov_b32 s64, 458752
  s_add_u32 s72, s24, 2048
  buffer_load_dwordx4 a[32:35], v1, s[8:11], s72 offen offset:0 sc1
  buffer_load_dwordx4 a[48:51], v1, s[8:11], s72 offen offset:1024 sc1
  s_add_u32 s72, s72, 65536
  buffer_load_dwordx4 a[36:39], v1, s[8:11], s72 offen offset:0 sc1
  buffer_load_dwordx4 a[52:55], v1, s[8:11], s72 offen offset:1024 sc1
  s_waitcnt vmcnt(17) lgkmcnt(0)
  v_add_u32 v9, s46, v0
  s_waitcnt vmcnt(8)
  s_barrier
  s_mov_b64 exec, 1
  buffer_store_dword v9, v0, s[8:11], s49 offen offset:0 sc1
  s_mov_b64 exec, -1
  s_mov_b32 s55, 688128
  s_add_u32 m0, s45, 53248
  s_nop 0
  buffer_load_dwordx4 v16, s[28:31], s55 offen lds
  s_mov_b32 s55, 688128
  s_add_u32 m0, s45, 61440
  s_nop 0
  buffer_load_dwordx4 v16, s[32:35], s55 offen lds
  v_mov_b32 v10, v16
  ds_read_b64_tr_b16 a[160:161], v6 offset:32768
  ds_read_b64_tr_b16 a[162:163], v6 offset:34816
  ds_read_b64_tr_b16 a[164:165], v6 offset:36864
  ds_read_b64_tr_b16 a[166:167], v6 offset:38912
  ds_read_b64_tr_b16 a[168:169], v6 offset:40960
  ds_read_b64_tr_b16 a[170:171], v6 offset:43008
  ds_read_b64_tr_b16 a[172:173], v6 offset:45056
  ds_read_b64_tr_b16 a[174:175], v6 offset:47104
  ds_read_b64_tr_b16 a[176:177], v7 offset:32768
  ds_read_b64_tr_b16 a[178:179], v7 offset:34816
  ds_read_b64_tr_b16 a[180:181], v7 offset:36864
  ds_read_b64_tr_b16 a[182:183], v7 offset:38912
  ds_read_b64_tr_b16 a[188:189], v7 offset:40960
  ds_read_b64_tr_b16 a[190:191], v7 offset:43008
  ds_read_b64_tr_b16 a[192:193], v7 offset:45056
  ds_read_b64_tr_b16 a[194:195], v7 offset:47104
  s_waitcnt vmcnt(7) lgkmcnt(8)
  v_mfma_f32_16x16x32_bf16 v[64:67], a[160:163], a[0:3], 0
  ds_read_b64_tr_b16 a[196:197], v8 offset:32768
  s_mov_b32 s65, 917504
  s_add_u32 s73, s24, 4096
  s_add_u32 m0, s45, 81920
  v_mfma_f32_16x16x32_bf16 v[64:67], a[164:167], a[16:19], v[64:67]
  ds_read_b64_tr_b16 a[198:199], v8 offset:34816
  buffer_load_dwordx4 v11, s[28:31], s65 offen lds
  v_mfma_f32_16x16x32_bf16 v[68:71], a[164:167], a[20:23], 0
  ds_read_b64_tr_b16 a[200:201], v8 offset:36864
  s_lshr_b32 s53, s2, 5
  v_mfma_f32_16x16x32_bf16 v[68:71], a[160:163], a[4:7], v[68:71]
  ds_read_b64_tr_b16 a[202:203], v8 offset:38912
  s_lshl_b32 s53, s53, 12
  v_mfma_f32_16x16x32_bf16 v[84:87], a[168:171], a[4:7], 0
  ds_read_b64_tr_b16 a[204:205], v8 offset:40960
  s_add_u32 m0, s45, 90112
  v_mfma_f32_16x16x32_bf16 v[84:87], a[172:175], a[20:23], v[84:87]
  ds_read_b64_tr_b16 a[206:207], v8 offset:43008
  buffer_load_dwordx4 v11, s[32:35], s65 offen lds
  v_mfma_f32_16x16x32_bf16 v[80:83], a[172:175], a[16:19], 0
  ds_read_b64_tr_b16 a[208:209], v8 offset:45056
  s_add_u32 s81, s53, 753664
  v_mfma_f32_16x16x32_bf16 v[80:83], a[168:171], a[0:3], v[80:83]
  s_waitcnt lgkmcnt(7)
  ds_read_b64_tr_b16 a[210:211], v8 offset:47104
  v_mfma_f32_16x16x32_bf16 v[96:99], a[176:179], a[0:3], 0
  ds_read_b64_tr_b16 a[164:165], v2 offset:32768
  s_add_u32 m0, s45, 86016
  s_add_u32 s60, s65, 229376
  v_mfma_f32_16x16x32_bf16 v[96:99], a[180:183], a[16:19], v[96:99]
  ds_read_b64_tr_b16 a[166:167], v2 offset:34816
  buffer_load_dwordx4 v11, s[28:31], s60 offen lds
  v_mfma_f32_16x16x32_bf16 v[100:103], a[180:183], a[20:23], 0
  ds_read_b64_tr_b16 a[160:161], v2 offset:36864
  v_and_b32 v15, 31, v0
  v_mfma_f32_16x16x32_bf16 v[100:103], a[176:179], a[4:7], v[100:103]
  ds_read_b64_tr_b16 a[162:163], v2 offset:38912
  v_lshlrev_b32 v15, 7, v15
  v_mfma_f32_16x16x32_bf16 v[116:119], a[188:191], a[4:7], 0
  ds_read_b64_tr_b16 a[172:173], v2 offset:40960
  s_add_u32 m0, s45, 94208
  s_add_u32 s60, s65, 229376
  v_mfma_f32_16x16x32_bf16 v[116:119], a[192:195], a[20:23], v[116:119]
  ds_read_b64_tr_b16 a[174:175], v2 offset:43008
  buffer_load_dwordx4 v11, s[32:35], s60 offen lds
  v_mfma_f32_16x16x32_bf16 v[112:115], a[192:195], a[16:19], 0
  ds_read_b64_tr_b16 a[168:169], v2 offset:45056
  s_and_b32 s52, s2, 7
  v_mfma_f32_16x16x32_bf16 v[112:115], a[188:191], a[0:3], v[112:115]
  s_waitcnt lgkmcnt(7)
  ds_read_b64_tr_b16 a[170:171], v2 offset:47104
  v_mfma_f32_16x16x32_bf16 v[32:35], a[196:199], a[0:3], 0
  ds_read_b64_tr_b16 a[180:181], v3 offset:32768
  s_add_u32 m0, s45, 16384
  v_mfma_f32_16x16x32_bf16 v[32:35], a[200:203], a[16:19], v[32:35]
  ds_read_b64_tr_b16 a[182:183], v3 offset:34816
  buffer_load_dwordx4 v10, s[28:31], s65 offen lds
  v_mfma_f32_16x16x32_bf16 v[36:39], a[200:203], a[20:23], 0
  ds_read_b64_tr_b16 a[176:177], v3 offset:36864
  s_bfe_u32 s51, s2, 0x20003
  v_mfma_f32_16x16x32_bf16 v[36:39], a[196:199], a[4:7], v[36:39]
  ds_read_b64_tr_b16 a[178:179], v3 offset:38912
  s_lshr_b32 s50, s2, 5
  v_mfma_f32_16x16x32_bf16 v[52:55], a[204:207], a[4:7], 0
  ds_read_b64_tr_b16 a[192:193], v3 offset:40960
  s_add_u32 m0, s45, 24576
  v_mfma_f32_16x16x32_bf16 v[52:55], a[208:211], a[20:23], v[52:55]
  ds_read_b64_tr_b16 a[194:195], v3 offset:43008
  buffer_load_dwordx4 v10, s[32:35], s65 offen lds
  v_mfma_f32_16x16x32_bf16 v[48:51], a[208:211], a[16:19], 0
  ds_read_b64_tr_b16 a[188:189], v3 offset:45056
  s_add_u32 s56, s51, s50
  v_mfma_f32_16x16x32_bf16 v[48:51], a[204:207], a[0:3], v[48:51]
  s_waitcnt lgkmcnt(7)
  ds_read_b64_tr_b16 a[190:191], v3 offset:47104
  v_mfma_f32_16x16x32_bf16 v[128:131], a[164:167], a[0:3], 0
  ds_read_b64_tr_b16 a[200:201], v4 offset:32768
  s_add_u32 m0, s45, 20480
  s_add_u32 s60, s65, 229376
  v_mfma_f32_16x16x32_bf16 v[128:131], a[160:163], a[16:19], v[128:131]
  ds_read_b64_tr_b16 a[202:203], v4 offset:34816
  buffer_load_dwordx4 v10, s[28:31], s60 offen lds
  v_mfma_f32_16x16x32_bf16 v[132:135], a[160:163], a[20:23], 0
  ds_read_b64_tr_b16 a[196:197], v4 offset:36864
  s_and_b32 s56, s56, 3
  v_mfma_f32_16x16x32_bf16 v[132:135], a[164:167], a[4:7], v[132:135]
  ds_read_b64_tr_b16 a[198:199], v4 offset:38912
  s_lshl_b32 s53, s50, 1
  v_mfma_f32_16x16x32_bf16 v[148:151], a[172:175], a[4:7], 0
  ds_read_b64_tr_b16 a[208:209], v4 offset:40960
  s_add_u32 m0, s45, 28672
  s_add_u32 s60, s65, 229376
  v_mfma_f32_16x16x32_bf16 v[148:151], a[168:171], a[20:23], v[148:151]
  ds_read_b64_tr_b16 a[210:211], v4 offset:43008
  buffer_load_dwordx4 v10, s[32:35], s60 offen lds
  v_mfma_f32_16x16x32_bf16 v[144:147], a[168:171], a[16:19], 0
  ds_read_b64_tr_b16 a[204:205], v4 offset:45056
  s_lshr_b32 s54, s44, 1
  v_mfma_f32_16x16x32_bf16 v[144:147], a[172:175], a[0:3], v[144:147]
  s_waitcnt lgkmcnt(7)
  ds_read_b64_tr_b16 a[206:207], v4 offset:47104
  v_mfma_f32_16x16x32_bf16 v[160:163], a[180:183], a[0:3], 0
  ds_read_b64_tr_b16 a[160:161], v5 offset:32768
  v_mfma_f32_16x16x32_bf16 v[160:163], a[176:179], a[16:19], v[160:163]
  ds_read_b64_tr_b16 a[162:163], v5 offset:34816
  buffer_load_dwordx4 a[64:67], v1, s[8:11], s73 offen offset:0 sc1
  v_mfma_f32_16x16x32_bf16 v[164:167], a[176:179], a[20:23], 0
  ds_read_b64_tr_b16 a[164:165], v5 offset:36864
  s_add_u32 s53, s53, s54
  v_mfma_f32_16x16x32_bf16 v[164:167], a[180:183], a[4:7], v[164:167]
  ds_read_b64_tr_b16 a[166:167], v5 offset:38912
  s_lshl_b32 s62, s53, 3
  v_mfma_f32_16x16x32_bf16 v[180:183], a[192:195], a[4:7], 0
  ds_read_b64_tr_b16 a[168:169], v5 offset:40960
  s_and_b32 s55, s44, 1
  v_mfma_f32_16x16x32_bf16 v[180:183], a[188:191], a[20:23], v[180:183]
  ds_read_b64_tr_b16 a[170:171], v5 offset:43008
  buffer_load_dwordx4 a[80:83], v1, s[8:11], s73 offen offset:1024 sc1
  v_mfma_f32_16x16x32_bf16 v[176:179], a[188:191], a[16:19], 0
  ds_read_b64_tr_b16 a[172:173], v5 offset:45056
  s_add_u32 s62, s62, s55
  v_mfma_f32_16x16x32_bf16 v[176:179], a[192:195], a[0:3], v[176:179]
  s_waitcnt lgkmcnt(7)
  ds_read_b64_tr_b16 a[174:175], v5 offset:47104
  s_waitcnt vmcnt(10)
  s_barrier
  v_mfma_f32_16x16x32_bf16 v[192:195], a[200:203], a[0:3], 0
  ds_read_b64_tr_b16 a[176:177], v6 offset:49152
  s_lshl_b32 s82, s44, 28
  s_add_u32 s82, s82, s81
  buffer_load_dword v9, v15, s[8:11], s82 offen sc1
  s_add_u32 s73, s73, 65536
  v_mfma_f32_16x16x32_bf16 v[192:195], a[196:199], a[16:19], v[192:195]
  ds_read_b64_tr_b16 a[178:179], v6 offset:51200
  buffer_load_dwordx4 a[68:71], v1, s[8:11], s73 offen offset:0 sc1
  v_mfma_f32_16x16x32_bf16 v[196:199], a[196:199], a[20:23], 0
  ds_read_b64_tr_b16 a[180:181], v6 offset:53248
  s_lshl_b32 s79, s2, 7
  v_mfma_f32_16x16x32_bf16 v[196:199], a[200:203], a[4:7], v[196:199]
  ds_read_b64_tr_b16 a[182:183], v6 offset:55296
  s_lshl_b32 s53, s44, 28
  v_mfma_f32_16x16x32_bf16 v[212:215], a[208:211], a[4:7], 0
  ds_read_b64_tr_b16 a[188:189], v6 offset:57344
  s_add_u32 s79, s79, s53
  v_mfma_f32_16x16x32_bf16 v[212:215], a[204:207], a[20:23], v[212:215]
  ds_read_b64_tr_b16 a[190:191], v6 offset:59392
  buffer_load_dwordx4 a[84:87], v1, s[8:11], s73 offen offset:1024 sc1
  v_mfma_f32_16x16x32_bf16 v[208:211], a[204:207], a[16:19], 0
  ds_read_b64_tr_b16 a[192:193], v6 offset:61440
  s_add_u32 s79, s79, 884736
  v_mfma_f32_16x16x32_bf16 v[208:211], a[208:211], a[0:3], v[208:211]
  s_waitcnt lgkmcnt(7)
  ds_read_b64_tr_b16 a[194:195], v6 offset:63488
  v_mfma_f32_16x16x32_bf16 v[224:227], a[160:163], a[0:3], 0
  ds_read_b64_tr_b16 a[196:197], v7 offset:49152
  s_mov_b32 s66, 1376256
  s_add_u32 s74, s24, 6144
  s_add_u32 m0, s45, 65536
  v_mfma_f32_16x16x32_bf16 v[224:227], a[164:167], a[16:19], v[224:227]
  ds_read_b64_tr_b16 a[198:199], v7 offset:51200
  buffer_load_dwordx4 v11, s[28:31], s66 offen lds
  v_mfma_f32_16x16x32_bf16 v[228:231], a[164:167], a[20:23], 0
  ds_read_b64_tr_b16 a[200:201], v7 offset:53248
  s_lshl_b32 s53, s2, 2
  v_mfma_f32_16x16x32_bf16 v[228:231], a[160:163], a[4:7], v[228:231]
  ds_read_b64_tr_b16 a[202:203], v7 offset:55296
  s_add_u32 s53, s53, s44
  v_mfma_f32_16x16x32_bf16 v[244:247], a[168:171], a[4:7], 0
  ds_read_b64_tr_b16 a[204:205], v7 offset:57344
  s_add_u32 m0, s45, 73728
  v_mfma_f32_16x16x32_bf16 v[244:247], a[172:175], a[20:23], v[244:247]
  ds_read_b64_tr_b16 a[206:207], v7 offset:59392
  buffer_load_dwordx4 v11, s[32:35], s66 offen lds
  v_mfma_f32_16x16x32_bf16 v[240:243], a[172:175], a[16:19], 0
  ds_read_b64_tr_b16 a[208:209], v7 offset:61440
  s_lshl_b32 s53, s53, 7
  v_mfma_f32_16x16x32_bf16 v[240:243], a[168:171], a[0:3], v[240:243]
  s_waitcnt vmcnt(18) lgkmcnt(7)
  ds_read_b64_tr_b16 a[210:211], v7 offset:63488
  v_mfma_f32_16x16x32_bf16 v[64:67], a[176:179], a[32:35], v[64:67]
  ds_read_b64_tr_b16 a[164:165], v8 offset:49152
  s_add_u32 m0, s45, 69632
  s_add_u32 s60, s66, 229376
  v_mfma_f32_16x16x32_bf16 v[64:67], a[180:183], a[48:51], v[64:67]
  ds_read_b64_tr_b16 a[166:167], v8 offset:51200
  buffer_load_dwordx4 v11, s[28:31], s60 offen lds
  v_mfma_f32_16x16x32_bf16 v[68:71], a[180:183], a[52:55], v[68:71]
  ds_read_b64_tr_b16 a[160:161], v8 offset:53248
  s_add_u32 s80, s53, 917504
  v_mfma_f32_16x16x32_bf16 v[68:71], a[176:179], a[36:39], v[68:71]
  ds_read_b64_tr_b16 a[162:163], v8 offset:55296
  s_add_u32 s53, s45, 151552
  v_mfma_f32_16x16x32_bf16 v[84:87], a[188:191], a[36:39], v[84:87]
  ds_read_b64_tr_b16 a[172:173], v8 offset:57344
  s_add_u32 m0, s45, 77824
  s_add_u32 s60, s66, 229376
  v_mfma_f32_16x16x32_bf16 v[84:87], a[192:195], a[52:55], v[84:87]
  ds_read_b64_tr_b16 a[174:175], v8 offset:59392
  buffer_load_dwordx4 v11, s[32:35], s60 offen lds
  v_mfma_f32_16x16x32_bf16 v[80:83], a[192:195], a[48:51], v[80:83]
  ds_read_b64_tr_b16 a[168:169], v8 offset:61440
  v_bfe_u32 v24, v0, 3, 1
  v_mfma_f32_16x16x32_bf16 v[80:83], a[188:191], a[32:35], v[80:83]
  s_waitcnt lgkmcnt(7)
  ds_read_b64_tr_b16 a[170:171], v8 offset:63488
  v_mfma_f32_16x16x32_bf16 v[96:99], a[196:199], a[32:35], v[96:99]
  ds_read_b64_tr_b16 a[180:181], v2 offset:49152
  s_add_u32 m0, s45, 0
  v_mfma_f32_16x16x32_bf16 v[96:99], a[200:203], a[48:51], v[96:99]
  ds_read_b64_tr_b16 a[182:183], v2 offset:51200
  buffer_load_dwordx4 v10, s[28:31], s66 offen lds
  v_mfma_f32_16x16x32_bf16 v[100:103], a[200:203], a[52:55], v[100:103]
  ds_read_b64_tr_b16 a[176:177], v2 offset:53248
  v_lshlrev_b32 v24, 9, v24
  v_mfma_f32_16x16x32_bf16 v[100:103], a[196:199], a[36:39], v[100:103]
  ds_read_b64_tr_b16 a[178:179], v2 offset:55296
  v_and_b32 v25, 1, v0
  v_mfma_f32_16x16x32_bf16 v[116:119], a[204:207], a[36:39], v[116:119]
  ds_read_b64_tr_b16 a[192:193], v2 offset:57344
  s_add_u32 m0, s45, 8192
  v_mfma_f32_16x16x32_bf16 v[116:119], a[208:211], a[52:55], v[116:119]
  ds_read_b64_tr_b16 a[194:195], v2 offset:59392
  buffer_load_dwordx4 v10, s[32:35], s66 offen lds
  v_mfma_f32_16x16x32_bf16 v[112:115], a[208:211], a[48:51], v[112:115]
  ds_read_b64_tr_b16 a[188:189], v2 offset:61440
  v_lshl_add_u32 v24, v25, 8, v24
  v_mfma_f32_16x16x32_bf16 v[112:115], a[204:207], a[32:35], v[112:115]
  s_waitcnt lgkmcnt(7)
  ds_read_b64_tr_b16 a[190:191], v2 offset:63488
  v_mfma_f32_16x16x32_bf16 v[32:35], a[164:167], a[32:35], v[32:35]
  ds_read_b64_tr_b16 a[200:201], v3 offset:49152
  s_add_u32 m0, s45, 4096
  s_add_u32 s60, s66, 229376
  v_mfma_f32_16x16x32_bf16 v[32:35], a[160:163], a[48:51], v[32:35]
  ds_read_b64_tr_b16 a[202:203], v3 offset:51200
  buffer_load_dwordx4 v10, s[28:31], s60 offen lds
  v_mfma_f32_16x16x32_bf16 v[36:39], a[160:163], a[52:55], v[36:39]
  ds_read_b64_tr_b16 a[196:197], v3 offset:53248
  v_lshrrev_b32 v25, 4, v0
  v_mfma_f32_16x16x32_bf16 v[36:39], a[164:167], a[36:39], v[36:39]
  ds_read_b64_tr_b16 a[198:199], v3 offset:55296
HOP7:
  s_cbranch_execz HOP11
  v_lshl_add_u32 v24, v25, 6, v24
  v_mfma_f32_16x16x32_bf16 v[52:55], a[172:175], a[36:39], v[52:55]
  ds_read_b64_tr_b16 a[208:209], v3 offset:57344
  s_add_u32 m0, s45, 12288
  s_add_u32 s60, s66, 229376
  v_mfma_f32_16x16x32_bf16 v[52:55], a[168:171], a[52:55], v[52:55]
  ds_read_b64_tr_b16 a[210:211], v3 offset:59392
  buffer_load_dwordx4 v10, s[32:35], s60 offen lds
  v_mfma_f32_16x16x32_bf16 v[48:51], a[168:171], a[48:51], v[48:51]
  ds_read_b64_tr_b16 a[204:205], v3 offset:61440
  v_add_u32 v14, s53, v24
  v_mfma_f32_16x16x32_bf16 v[48:51], a[172:175], a[32:35], v[48:51]
  s_waitcnt lgkmcnt(7)
  ds_read_b64_tr_b16 a[206:207], v3 offset:63488
  v_mfma_f32_16x16x32_bf16 v[128:131], a[180:183], a[32:35], v[128:131]
  ds_read_b64_tr_b16 a[160:161], v4 offset:49152
  s_waitcnt vmcnt(10)
  s_cmp_lg_u32 s44, 0
  s_cbranch_scc1 PL10_adaLN_cond__sliding_local_dilated__swiglu_ffn__prompt_kernelx
  v_cmp_ne_u32 vcc, s46, v9
  s_nop 4
  s_cbranch_vccz PL10_adaLN_cond__sliding_local_dilated__swiglu_ffn__prompt_kernelx
  s_mov_b32 s82, 60000
PL10_adaLN_cond__sliding_local_dilated__swiglu_ffn__prompt_kernel:
  buffer_load_dword v9, v15, s[8:11], s81 offen sc1
  s_sub_u32 s82, s82, 1
  s_cmp_eq_u32 s82, 0
  s_waitcnt vmcnt(0)
  s_cbranch_scc1 PL10_adaLN_cond__sliding_local_dilated__swiglu_ffn__prompt_kernelx
  v_cmp_ne_u32 vcc, s46, v9
  s_nop 4
  s_cbranch_vccnz PL10_adaLN_cond__sliding_local_dilated__swiglu_ffn__prompt_kernel
PL10_adaLN_cond__sliding_local_dilated__swiglu_ffn__prompt_kernelx:
  s_barrier
  v_mfma_f32_16x16x32_bf16 v[128:131], a[176:179], a[48:51], v[128:131]
  ds_read_b64_tr_b16 a[162:163], v4 offset:51200
  buffer_load_dwordx4 a[96:99], v1, s[8:11], s74 offen offset:0 sc1
  v_mfma_f32_16x16x32_bf16 v[132:135], a[176:179], a[52:55], v[132:135]
  ds_read_b64_tr_b16 a[164:165], v4 offset:53248
  s_bfe_u32 s53, s2, 0x20004
  v_mfma_f32_16x16x32_bf16 v[132:135], a[180:183], a[36:39], v[132:135]
  ds_read_b64_tr_b16 a[166:167], v4 offset:55296
  s_lshl_b32 s53, s53, 8
  v_mfma_f32_16x16x32_bf16 v[148:151], a[192:195], a[36:39], v[148:151]
  ds_read_b64_tr_b16 a[168:169], v4 offset:57344
  s_add_u32 s71, s71, 65536
  v_mfma_f32_16x16x32_bf16 v[148:151], a[188:191], a[52:55], v[148:151]
  ds_read_b64_tr_b16 a[170:171], v4 offset:59392
  buffer_load_dwordx4 a[8:11], v1, s[8:11], s71 offen offset:0 sc1
  v_mfma_f32_16x16x32_bf16 v[144:147], a[188:191], a[48:51], v[144:147]
  ds_read_b64_tr_b16 a[172:173], v4 offset:61440
  v_and_b32 v24, 15, v0
  v_mfma_f32_16x16x32_bf16 v[144:147], a[192:195], a[32:35], v[144:147]
  s_waitcnt lgkmcnt(7)
  ds_read_b64_tr_b16 a[174:175], v4 offset:63488
  buffer_load_dwordx4 a[24:27], v1, s[8:11], s71 offen offset:1024 sc1
  v_mfma_f32_16x16x32_bf16 v[160:163], a[200:203], a[32:35], v[160:163]
  ds_read_b64_tr_b16 a[176:177], v5 offset:49152
  s_add_u32 s71, s71, 65536
  v_mfma_f32_16x16x32_bf16 v[160:163], a[196:199], a[48:51], v[160:163]
  ds_read_b64_tr_b16 a[178:179], v5 offset:51200
  buffer_load_dwordx4 a[12:15], v1, s[8:11], s71 offen offset:0 sc1
  v_mfma_f32_16x16x32_bf16 v[164:167], a[196:199], a[52:55], v[164:167]
  ds_read_b64_tr_b16 a[180:181], v5 offset:53248
  v_lshl_add_u32 v24, v24, 4, s53
  v_mfma_f32_16x16x32_bf16 v[164:167], a[200:203], a[36:39], v[164:167]
  ds_read_b64_tr_b16 a[182:183], v5 offset:55296
  buffer_load_dwordx4 a[28:31], v1, s[8:11], s71 offen offset:1024 sc1
  v_mfma_f32_16x16x32_bf16 v[180:183], a[208:211], a[36:39], v[180:183]
  ds_read_b64_tr_b16 a[188:189], v5 offset:57344
  s_add_u32 s72, s72, 65536
  v_mfma_f32_16x16x32_bf16 v[180:183], a[204:207], a[52:55], v[180:183]
  ds_read_b64_tr_b16 a[190:191], v5 offset:59392
  buffer_load_dwordx4 a[40:43], v1, s[8:11], s72 offen offset:0 sc1
  v_cmp_gt_u32 vcc, 896, v24
  v_mov_b32 v26, 1073741824
  v_mul_u32_u24 v25, 114688, v25
  v_cndmask_b32 v24, v26, v24, vcc
  v_mfma_f32_16x16x32_bf16 v[176:179], a[204:207], a[48:51], v[176:179]
  ds_read_b64_tr_b16 a[192:193], v5 offset:61440
  s_lshr_b32 s53, s2, 6
  v_mfma_f32_16x16x32_bf16 v[176:179], a[208:211], a[32:35], v[176:179]
  s_waitcnt lgkmcnt(7)
  ds_read_b64_tr_b16 a[194:195], v5 offset:63488
  buffer_load_dwordx4 a[56:59], v1, s[8:11], s72 offen offset:1024 sc1
  v_mfma_f32_16x16x32_bf16 v[192:195], a[160:163], a[32:35], v[192:195]
  ds_read_b64_tr_b16 a[196:197], v6 offset:32768
  s_add_u32 s72, s72, 65536
  v_mfma_f32_16x16x32_bf16 v[192:195], a[164:167], a[48:51], v[192:195]
  ds_read_b64_tr_b16 a[198:199], v6 offset:34816
  buffer_load_dwordx4 a[44:47], v1, s[8:11], s72 offen offset:0 sc1
  v_mfma_f32_16x16x32_bf16 v[196:199], a[164:167], a[52:55], v[196:199]
  ds_read_b64_tr_b16 a[200:201], v6 offset:36864
  s_lshl_b32 s53, s53, 2
  v_mfma_f32_16x16x32_bf16 v[196:199], a[160:163], a[36:39], v[196:199]
  ds_read_b64_tr_b16 a[202:203], v6 offset:38912
  buffer_load_dwordx4 a[60:63], v1, s[8:11], s72 offen offset:1024 sc1
  v_mfma_f32_16x16x32_bf16 v[212:215], a[168:171], a[36:39], v[212:215]
  ds_read_b64_tr_b16 a[204:205], v6 offset:40960
  s_add_u32 s73, s73, 65536
  v_mfma_f32_16x16x32_bf16 v[212:215], a[172:175], a[52:55], v[212:215]
  ds_read_b64_tr_b16 a[206:207], v6 offset:43008
  buffer_load_dwordx4 a[72:75], v1, s[8:11], s73 offen offset:0 sc1
  v_mfma_f32_16x16x32_bf16 v[208:211], a[172:175], a[48:51], v[208:211]
  ds_read_b64_tr_b16 a[208:209], v6 offset:45056
  s_add_u32 s53, s53, s44
  v_mfma_f32_16x16x32_bf16 v[208:211], a[168:171], a[32:35], v[208:211]
  s_waitcnt lgkmcnt(7)
  ds_read_b64_tr_b16 a[210:211], v6 offset:47104
  v_mfma_f32_16x16x32_bf16 v[224:227], a[176:179], a[32:35], v[224:227]
  ds_read_b64_tr_b16 a[164:165], v7 offset:32768
  s_mul_i32 s53, s53, 458752
  v_mfma_f32_16x16x32_bf16 v[224:227], a[180:183], a[48:51], v[224:227]
  ds_read_b64_tr_b16 a[166:167], v7 offset:34816
  buffer_load_dwordx4 a[88:91], v1, s[8:11], s73 offen offset:1024 sc1
  v_mfma_f32_16x16x32_bf16 v[228:231], a[180:183], a[52:55], v[228:231]
  ds_read_b64_tr_b16 a[160:161], v7 offset:36864
  s_mul_i32 s54, s52, 896
  v_mfma_f32_16x16x32_bf16 v[228:231], a[176:179], a[36:39], v[228:231]
  ds_read_b64_tr_b16 a[162:163], v7 offset:38912
  s_add_u32 s53, s53, s54
  v_mfma_f32_16x16x32_bf16 v[244:247], a[188:191], a[36:39], v[244:247]
  ds_read_b64_tr_b16 a[172:173], v7 offset:40960
  s_add_u32 s73, s73, 65536
  v_mfma_f32_16x16x32_bf16 v[244:247], a[192:195], a[52:55], v[244:247]
  ds_read_b64_tr_b16 a[174:175], v7 offset:43008
  buffer_load_dwordx4 a[76:79], v1, s[8:11], s73 offen offset:0 sc1
  v_mfma_f32_16x16x32_bf16 v[240:243], a[192:195], a[48:51], v[240:243]
  ds_read_b64_tr_b16 a[168:169], v7 offset:45056
  v_add3_u32 v13, v24, v25, s53
  v_mfma_f32_16x16x32_bf16 v[240:243], a[188:191], a[32:35], v[240:243]
  s_waitcnt vmcnt(7) lgkmcnt(7)
  ds_read_b64_tr_b16 a[170:171], v7 offset:47104
  v_mfma_f32_16x16x32_bf16 v[72:75], a[196:199], a[8:11], 0
  ds_read_b64_tr_b16 a[180:181], v8 offset:32768
  s_lshl_b32 s57, s51, 12
  v_mfma_f32_16x16x32_bf16 v[72:75], a[200:203], a[24:27], v[72:75]
  ds_read_b64_tr_b16 a[182:183], v8 offset:34816
  buffer_load_dwordx4 a[92:95], v1, s[8:11], s73 offen offset:1024 sc1
  v_mfma_f32_16x16x32_bf16 v[76:79], a[200:203], a[28:31], 0
  ds_read_b64_tr_b16 a[176:177], v8 offset:36864
  s_lshl_b32 s54, s51, 3
  v_mfma_f32_16x16x32_bf16 v[76:79], a[196:199], a[12:15], v[76:79]
  ds_read_b64_tr_b16 a[178:179], v8 offset:38912
  s_lshr_b32 s53, 0x0b070602, s54
  v_mfma_f32_16x16x32_bf16 v[92:95], a[204:207], a[12:15], 0
  ds_read_b64_tr_b16 a[192:193], v8 offset:40960
  s_and_b32 s53, s53, 15
  v_mfma_f32_16x16x32_bf16 v[92:95], a[208:211], a[28:31], v[92:95]
  ds_read_b64_tr_b16 a[194:195], v8 offset:43008
  s_lshl_b32 s58, s53, 10
  v_mfma_f32_16x16x32_bf16 v[88:91], a[208:211], a[24:27], 0
  ds_read_b64_tr_b16 a[188:189], v8 offset:45056
  buffer_load_dwordx4 a[112:115], v1, s[8:11], s74 offen offset:1024 sc1
  v_mfma_f32_16x16x32_bf16 v[88:91], a[204:207], a[8:11], v[88:91]
  s_waitcnt lgkmcnt(7)
  ds_read_b64_tr_b16 a[190:191], v8 offset:47104
  v_mfma_f32_16x16x32_bf16 v[104:107], a[164:167], a[8:11], 0
  ds_read_b64_tr_b16 a[200:201], v2 offset:32768
  s_lshr_b32 s53, s51, 1
  v_mfma_f32_16x16x32_bf16 v[104:107], a[160:163], a[24:27], v[104:107]
  ds_read_b64_tr_b16 a[202:203], v2 offset:34816
  s_mul_i32 s53, s53, 7168
  v_mfma_f32_16x16x32_bf16 v[108:111], a[160:163], a[28:31], 0
  ds_read_b64_tr_b16 a[196:197], v2 offset:36864
  s_mov_b32 s61, 0
  v_mfma_f32_16x16x32_bf16 v[108:111], a[164:167], a[12:15], v[108:111]
  ds_read_b64_tr_b16 a[198:199], v2 offset:38912
  buffer_load_dwordx4 a[220:223], v13, s[12:15], s61 offen
  v_mfma_f32_16x16x32_bf16 v[124:127], a[172:175], a[12:15], 0
  ds_read_b64_tr_b16 a[208:209], v2 offset:40960
  s_mov_b32 s61, 7168
  v_mfma_f32_16x16x32_bf16 v[124:127], a[168:171], a[28:31], v[124:127]
  ds_read_b64_tr_b16 a[210:211], v2 offset:43008
  buffer_load_dwordx4 a[224:227], v13, s[12:15], s61 offen
  v_mfma_f32_16x16x32_bf16 v[120:123], a[168:171], a[24:27], 0
  ds_read_b64_tr_b16 a[204:205], v2 offset:45056
  s_mov_b32 s61, 14336
  s_and_b32 s54, s54, 8
  v_mfma_f32_16x16x32_bf16 v[120:123], a[172:175], a[8:11], v[120:123]
  s_waitcnt lgkmcnt(7)
  ds_read_b64_tr_b16 a[206:207], v2 offset:47104
  buffer_load_dwordx4 a[228:231], v13, s[12:15], s61 offen
  v_mfma_f32_16x16x32_bf16 v[40:43], a[180:183], a[8:11], 0
  ds_read_b64_tr_b16 a[160:161], v3 offset:32768
  s_mov_b32 s61, 21504
  v_mfma_f32_16x16x32_bf16 v[40:43], a[176:179], a[24:27], v[40:43]
  ds_read_b64_tr_b16 a[162:163], v3 offset:34816
  buffer_load_dwordx4 a[232:235], v13, s[12:15], s61 offen
  v_mfma_f32_16x16x32_bf16 v[44:47], a[176:179], a[28:31], 0
  ds_read_b64_tr_b16 a[164:165], v3 offset:36864
  s_add_u32 s53, s53, s54
  v_mfma_f32_16x16x32_bf16 v[44:47], a[180:183], a[12:15], v[44:47]
  ds_read_b64_tr_b16 a[166:167], v3 offset:38912
  s_add_u32 s59, s53, 3072
  v_mfma_f32_16x16x32_bf16 v[60:63], a[192:195], a[12:15], 0
  ds_read_b64_tr_b16 a[168:169], v3 offset:40960
  s_mul_i32 s53, s52, 14336
  v_mfma_f32_16x16x32_bf16 v[60:63], a[188:191], a[28:31], v[60:63]
  ds_read_b64_tr_b16 a[170:171], v3 offset:43008
  s_mul_i32 s54, s62, 131072
  v_mfma_f32_16x16x32_bf16 v[56:59], a[188:191], a[24:27], 0
  ds_read_b64_tr_b16 a[172:173], v3 offset:45056
  s_add_u32 s53, s53, s54
  v_mfma_f32_16x16x32_bf16 v[56:59], a[192:195], a[8:11], v[56:59]
  s_waitcnt lgkmcnt(7)
  ds_read_b64_tr_b16 a[174:175], v3 offset:47104
  v_mfma_f32_16x16x32_bf16 v[136:139], a[200:203], a[8:11], 0
  ds_read_b64_tr_b16 a[176:177], v4 offset:32768
  s_add_u32 s53, s53, 19922944
  v_mfma_f32_16x16x32_bf16 v[136:139], a[196:199], a[24:27], v[136:139]
  ds_read_b64_tr_b16 a[178:179], v4 offset:34816
  s_add_u32 s57, s57, s53
  v_mfma_f32_16x16x32_bf16 v[140:143], a[196:199], a[28:31], 0
  ds_read_b64_tr_b16 a[180:181], v4 offset:36864
  s_add_u32 s58, s58, s53
  v_mfma_f32_16x16x32_bf16 v[140:143], a[200:203], a[12:15], v[140:143]
  ds_read_b64_tr_b16 a[182:183], v4 offset:38912
  s_add_u32 s59, s59, s53
  v_mfma_f32_16x16x32_bf16 v[156:159], a[208:211], a[12:15], 0
  ds_read_b64_tr_b16 a[188:189], v4 offset:40960
  s_lshl_b32 s62, s50, 2
  v_mfma_f32_16x16x32_bf16 v[156:159], a[204:207], a[28:31], v[156:159]
  ds_read_b64_tr_b16 a[190:191], v4 offset:43008
  s_add_u32 s62, s62, s44
  v_mfma_f32_16x16x32_bf16 v[152:155], a[204:207], a[24:27], 0
  ds_read_b64_tr_b16 a[192:193], v4 offset:45056
  s_lshl_b32 s62, s62, 14
  v_mfma_f32_16x16x32_bf16 v[152:155], a[208:211], a[8:11], v[152:155]
  s_waitcnt lgkmcnt(7)
  ds_read_b64_tr_b16 a[194:195], v4 offset:47104
  v_mfma_f32_16x16x32_bf16 v[168:171], a[160:163], a[8:11], 0
  ds_read_b64_tr_b16 a[196:197], v5 offset:32768
  s_add_u32 s62, s62, 6291456
  v_mfma_f32_16x16x32_bf16 v[168:171], a[164:167], a[24:27], v[168:171]
  ds_read_b64_tr_b16 a[198:199], v5 offset:34816
  v_and_b32 v12, 0x300, v1
  v_mfma_f32_16x16x32_bf16 v[172:175], a[164:167], a[28:31], 0
  ds_read_b64_tr_b16 a[200:201], v5 offset:36864
  v_add_u32 v12, v12, v1
  v_mfma_f32_16x16x32_bf16 v[172:175], a[160:163], a[12:15], v[172:175]
  ds_read_b64_tr_b16 a[202:203], v5 offset:38912
  v_mfma_f32_16x16x32_bf16 v[188:191], a[168:171], a[12:15], 0
  ds_read_b64_tr_b16 a[204:205], v5 offset:40960
  v_mfma_f32_16x16x32_bf16 v[188:191], a[172:175], a[28:31], v[188:191]
  ds_read_b64_tr_b16 a[206:207], v5 offset:43008
  v_mfma_f32_16x16x32_bf16 v[184:187], a[172:175], a[24:27], 0
  ds_read_b64_tr_b16 a[208:209], v5 offset:45056
  v_mfma_f32_16x16x32_bf16 v[184:187], a[168:171], a[8:11], v[184:187]
  s_waitcnt lgkmcnt(7)
  ds_read_b64_tr_b16 a[210:211], v5 offset:47104
  v_mfma_f32_16x16x32_bf16 v[200:203], a[176:179], a[8:11], 0
  ds_read_b64_tr_b16 a[164:165], v6 offset:49152
  v_mfma_f32_16x16x32_bf16 v[200:203], a[180:183], a[24:27], v[200:203]
  ds_read_b64_tr_b16 a[166:167], v6 offset:51200
  v_mfma_f32_16x16x32_bf16 v[204:207], a[180:183], a[28:31], 0
  ds_read_b64_tr_b16 a[160:161], v6 offset:53248
  v_mfma_f32_16x16x32_bf16 v[204:207], a[176:179], a[12:15], v[204:207]
  ds_read_b64_tr_b16 a[162:163], v6 offset:55296
  v_mfma_f32_16x16x32_bf16 v[220:223], a[188:191], a[12:15], 0
  ds_read_b64_tr_b16 a[172:173], v6 offset:57344
  v_mfma_f32_16x16x32_bf16 v[220:223], a[192:195], a[28:31], v[220:223]
  ds_read_b64_tr_b16 a[174:175], v6 offset:59392
  v_mfma_f32_16x16x32_bf16 v[216:219], a[192:195], a[24:27], 0
  ds_read_b64_tr_b16 a[168:169], v6 offset:61440
  s_add_u32 s74, s74, 65536
  v_mfma_f32_16x16x32_bf16 v[216:219], a[188:191], a[8:11], v[216:219]
  s_waitcnt lgkmcnt(7)
  ds_read_b64_tr_b16 a[170:171], v6 offset:63488
  v_mfma_f32_16x16x32_bf16 v[232:235], a[196:199], a[8:11], 0
  ds_read_b64_tr_b16 a[180:181], v7 offset:49152
  buffer_load_dwordx4 a[100:103], v1, s[8:11], s74 offen offset:0 sc1
  v_mfma_f32_16x16x32_bf16 v[232:235], a[200:203], a[24:27], v[232:235]
  ds_read_b64_tr_b16 a[182:183], v7 offset:51200
  v_mfma_f32_16x16x32_bf16 v[236:239], a[200:203], a[28:31], 0
  ds_read_b64_tr_b16 a[176:177], v7 offset:53248
  v_mfma_f32_16x16x32_bf16 v[236:239], a[196:199], a[12:15], v[236:239]
  ds_read_b64_tr_b16 a[178:179], v7 offset:55296
  v_mfma_f32_16x16x32_bf16 v[252:255], a[204:207], a[12:15], 0
  ds_read_b64_tr_b16 a[192:193], v7 offset:57344
  s_barrier
  v_mfma_f32_16x16x32_bf16 v[252:255], a[208:211], a[28:31], v[252:255]
  ds_read_b64_tr_b16 a[194:195], v7 offset:59392
  buffer_load_dwordx4 a[116:119], v1, s[8:11], s74 offen offset:1024 sc1
  v_mfma_f32_16x16x32_bf16 v[248:251], a[208:211], a[24:27], 0
  ds_read_b64_tr_b16 a[188:189], v7 offset:61440
  v_mfma_f32_16x16x32_bf16 v[248:251], a[204:207], a[8:11], v[248:251]
  s_waitcnt vmcnt(11) lgkmcnt(7)
  ds_read_b64_tr_b16 a[190:191], v7 offset:63488
  v_mfma_f32_16x16x32_bf16 v[72:75], a[164:167], a[40:43], v[72:75]
  ds_read_b64_tr_b16 a[200:201], v8 offset:49152
  s_add_u32 s74, s74, 65536
  v_mfma_f32_16x16x32_bf16 v[72:75], a[160:163], a[56:59], v[72:75]
  ds_read_b64_tr_b16 a[202:203], v8 offset:51200
  buffer_load_dwordx4 a[104:107], v1, s[8:11], s74 offen offset:0 sc1
  v_mfma_f32_16x16x32_bf16 v[76:79], a[160:163], a[60:63], v[76:79]
  ds_read_b64_tr_b16 a[196:197], v8 offset:53248
  v_mfma_f32_16x16x32_bf16 v[76:79], a[164:167], a[44:47], v[76:79]
  ds_read_b64_tr_b16 a[198:199], v8 offset:55296
  v_mfma_f32_16x16x32_bf16 v[92:95], a[172:175], a[44:47], v[92:95]
  ds_read_b64_tr_b16 a[208:209], v8 offset:57344
  v_mfma_f32_16x16x32_bf16 v[92:95], a[168:171], a[60:63], v[92:95]
  ds_read_b64_tr_b16 a[210:211], v8 offset:59392
  v_mfma_f32_16x16x32_bf16 v[88:91], a[168:171], a[56:59], v[88:91]
  ds_read_b64_tr_b16 a[204:205], v8 offset:61440
  buffer_load_dwordx4 a[120:123], v1, s[8:11], s74 offen offset:1024 sc1
  v_mfma_f32_16x16x32_bf16 v[88:91], a[172:175], a[40:43], v[88:91]
  s_waitcnt lgkmcnt(7)
  ds_read_b64_tr_b16 a[206:207], v8 offset:63488
  v_mfma_f32_16x16x32_bf16 v[104:107], a[180:183], a[40:43], v[104:107]
  ds_read_b64_tr_b16 a[160:161], v2 offset:49152
  v_mfma_f32_16x16x32_bf16 v[104:107], a[176:179], a[56:59], v[104:107]
  ds_read_b64_tr_b16 a[162:163], v2 offset:51200
  v_mfma_f32_16x16x32_bf16 v[108:111], a[176:179], a[60:63], v[108:111]
  ds_read_b64_tr_b16 a[164:165], v2 offset:53248
  s_add_u32 s74, s74, 65536
  v_mfma_f32_16x16x32_bf16 v[108:111], a[180:183], a[44:47], v[108:111]
  ds_read_b64_tr_b16 a[166:167], v2 offset:55296
  buffer_load_dwordx4 a[108:111], v1, s[8:11], s74 offen offset:0 sc1
  v_mfma_f32_16x16x32_bf16 v[124:127], a[192:195], a[44:47], v[124:127]
  ds_read_b64_tr_b16 a[168:169], v2 offset:57344
  v_mfma_f32_16x16x32_bf16 v[124:127], a[188:191], a[60:63], v[124:127]
  ds_read_b64_tr_b16 a[170:171], v2 offset:59392
  v_mfma_f32_16x16x32_bf16 v[120:123], a[188:191], a[56:59], v[120:123]
  ds_read_b64_tr_b16 a[172:173], v2 offset:61440
  v_mfma_f32_16x16x32_bf16 v[120:123], a[192:195], a[40:43], v[120:123]
  s_waitcnt lgkmcnt(7)
  ds_read_b64_tr_b16 a[174:175], v2 offset:63488
  v_mfma_f32_16x16x32_bf16 v[40:43], a[200:203], a[40:43], v[40:43]
  ds_read_b64_tr_b16 a[176:177], v3 offset:49152
  buffer_load_dwordx4 a[124:127], v1, s[8:11], s74 offen offset:1024 sc1
  v_mfma_f32_16x16x32_bf16 v[40:43], a[196:199], a[56:59], v[40:43]
  ds_read_b64_tr_b16 a[178:179], v3 offset:51200
  v_mfma_f32_16x16x32_bf16 v[44:47], a[196:199], a[60:63], v[44:47]
  ds_read_b64_tr_b16 a[180:181], v3 offset:53248
  v_mfma_f32_16x16x32_bf16 v[44:47], a[200:203], a[44:47], v[44:47]
  ds_read_b64_tr_b16 a[182:183], v3 offset:55296
  v_mfma_f32_16x16x32_bf16 v[60:63], a[208:211], a[44:47], v[60:63]
  ds_read_b64_tr_b16 a[188:189], v3 offset:57344
  s_mov_b32 s61, 28672
  v_mfma_f32_16x16x32_bf16 v[60:63], a[204:207], a[60:63], v[60:63]
  ds_read_b64_tr_b16 a[190:191], v3 offset:59392
  buffer_load_dwordx4 a[236:239], v13, s[12:15], s61 offen
  v_mfma_f32_16x16x32_bf16 v[56:59], a[204:207], a[56:59], v[56:59]
  ds_read_b64_tr_b16 a[192:193], v3 offset:61440
  s_mov_b32 s61, 35840
  v_mfma_f32_16x16x32_bf16 v[56:59], a[208:211], a[40:43], v[56:59]
  s_waitcnt lgkmcnt(7)
  ds_read_b64_tr_b16 a[194:195], v3 offset:63488
  buffer_load_dwordx4 a[240:243], v13, s[12:15], s61 offen
  v_mfma_f32_16x16x32_bf16 v[136:139], a[160:163], a[40:43], v[136:139]
  ds_read_b64_tr_b16 a[196:197], v4 offset:49152
  s_mov_b32 s61, 43008
  v_mfma_f32_16x16x32_bf16 v[136:139], a[164:167], a[56:59], v[136:139]
  ds_read_b64_tr_b16 a[198:199], v4 offset:51200
  buffer_load_dwordx4 a[244:247], v13, s[12:15], s61 offen
  v_mfma_f32_16x16x32_bf16 v[140:143], a[164:167], a[60:63], v[140:143]
  ds_read_b64_tr_b16 a[200:201], v4 offset:53248
  s_mov_b32 s61, 50176
  v_mfma_f32_16x16x32_bf16 v[140:143], a[160:163], a[44:47], v[140:143]
  ds_read_b64_tr_b16 a[202:203], v4 offset:55296
  buffer_load_dwordx4 a[248:251], v13, s[12:15], s61 offen
  v_mfma_f32_16x16x32_bf16 v[156:159], a[168:171], a[44:47], v[156:159]
  ds_read_b64_tr_b16 a[204:205], v4 offset:57344
  v_mfma_f32_16x16x32_bf16 v[156:159], a[172:175], a[60:63], v[156:159]
  ds_read_b64_tr_b16 a[206:207], v4 offset:59392
  v_mfma_f32_16x16x32_bf16 v[152:155], a[172:175], a[56:59], v[152:155]
  ds_read_b64_tr_b16 a[208:209], v4 offset:61440
  v_mfma_f32_16x16x32_bf16 v[152:155], a[168:171], a[40:43], v[152:155]
  s_waitcnt lgkmcnt(7)
  ds_read_b64_tr_b16 a[210:211], v4 offset:63488
  v_mfma_f32_16x16x32_bf16 v[168:171], a[176:179], a[40:43], v[168:171]
  ds_read_b64_tr_b16 a[164:165], v5 offset:49152
  v_mfma_f32_16x16x32_bf16 v[168:171], a[180:183], a[56:59], v[168:171]
  ds_read_b64_tr_b16 a[166:167], v5 offset:51200
  v_mfma_f32_16x16x32_bf16 v[172:175], a[180:183], a[60:63], v[172:175]
  ds_read_b64_tr_b16 a[160:161], v5 offset:53248
  v_mfma_f32_16x16x32_bf16 v[172:175], a[176:179], a[44:47], v[172:175]
  ds_read_b64_tr_b16 a[162:163], v5 offset:55296
  v_mfma_f32_16x16x32_bf16 v[188:191], a[188:191], a[44:47], v[188:191]
  ds_read_b64_tr_b16 a[172:173], v5 offset:57344
  v_mfma_f32_16x16x32_bf16 v[188:191], a[192:195], a[60:63], v[188:191]
  ds_read_b64_tr_b16 a[174:175], v5 offset:59392
  s_waitcnt vmcnt(41)
  s_barrier
  v_mfma_f32_16x16x32_bf16 v[184:187], a[192:195], a[56:59], v[184:187]
  ds_read_b64_tr_b16 a[168:169], v5 offset:61440
  ds_read_b64_tr_b16 a[180:181], v6 offset:16384
  v_mfma_f32_16x16x32_bf16 v[184:187], a[188:191], a[40:43], v[184:187]
  s_waitcnt lgkmcnt(8)
  ds_read_b64_tr_b16 a[170:171], v5 offset:63488
  v_mfma_f32_16x16x32_bf16 v[200:203], a[196:199], a[40:43], v[200:203]
  ds_read_b64_tr_b16 a[182:183], v6 offset:18432
  v_mfma_f32_16x16x32_bf16 v[200:203], a[200:203], a[56:59], v[200:203]
  v_mfma_f32_16x16x32_bf16 v[204:207], a[200:203], a[60:63], v[204:207]
  ds_read_b64_tr_b16 a[176:177], v6 offset:20480
  v_mfma_f32_16x16x32_bf16 v[204:207], a[196:199], a[44:47], v[204:207]
  v_mfma_f32_16x16x32_bf16 v[220:223], a[204:207], a[44:47], v[220:223]
  ds_read_b64_tr_b16 a[178:179], v6 offset:22528
  v_mfma_f32_16x16x32_bf16 v[220:223], a[208:211], a[60:63], v[220:223]
  ds_read_b128 v[24:27], v14 offset:0
  v_mfma_f32_16x16x32_bf16 v[216:219], a[208:211], a[56:59], v[216:219]
  ds_read_b64_tr_b16 a[192:193], v6 offset:24576
  v_mfma_f32_16x16x32_bf16 v[216:219], a[204:207], a[40:43], v[216:219]
  s_waitcnt lgkmcnt(5)
  v_mfma_f32_16x16x32_bf16 v[232:235], a[164:167], a[40:43], v[232:235]
  ds_read_b64_tr_b16 a[194:195], v6 offset:26624
  v_mfma_f32_16x16x32_bf16 v[232:235], a[160:163], a[56:59], v[232:235]
  v_mfma_f32_16x16x32_bf16 v[236:239], a[160:163], a[60:63], v[236:239]
  ds_read_b64_tr_b16 a[188:189], v6 offset:28672
  v_mfma_f32_16x16x32_bf16 v[236:239], a[164:167], a[44:47], v[236:239]
  s_waitcnt vmcnt(10) lgkmcnt(3)
  v_cndmask_b32 v28, 0, v24, s[16:17]
  v_cndmask_b32 v29, 0, v24, s[18:19]
  v_mfma_f32_16x16x32_bf16 v[252:255], a[172:175], a[44:47], v[252:255]
  ds_read_b64_tr_b16 a[190:191], v6 offset:30720
  v_cndmask_b32 v30, 0, v24, s[20:21]
  v_mfma_f32_16x16x32_bf16 v[252:255], a[168:171], a[60:63], v[252:255]
  v_cndmask_b32 v31, 0, v24, s[22:23]
  v_mfma_f32_16x16x32_bf16 v[248:251], a[168:171], a[56:59], v[248:251]
  ds_read_b64_tr_b16 a[200:201], v7 offset:16384
  v_mfma_f32_16x16x32_bf16 a[184:187], v[28:31], a[220:223], 0
  v_cndmask_b32 v28, 0, v25, s[16:17]
  v_cndmask_b32 v29, 0, v25, s[18:19]
  v_mfma_f32_16x16x32_bf16 v[248:251], a[172:175], a[40:43], v[248:251]
  s_waitcnt vmcnt(15) lgkmcnt(6)
  s_mov_b32 s67, 1835008
  s_add_u32 s75, s24, 8192
  s_add_u32 m0, s45, 98304
  v_cndmask_b32 v30, 0, v25, s[20:21]
  v_mfma_f32_16x16x32_bf16 v[64:67], a[180:183], a[64:67], v[64:67]
  ds_read_b64_tr_b16 a[202:203], v7 offset:18432
  v_cndmask_b32 v31, 0, v25, s[22:23]
  v_mfma_f32_16x16x32_bf16 v[64:67], a[176:179], a[80:83], v[64:67]
  buffer_load_dwordx4 v11, s[28:31], s67 offen lds
  v_mfma_f32_16x16x32_bf16 a[184:187], v[28:31], a[224:227], a[184:187]
  v_cndmask_b32 v28, 0, v26, s[16:17]
  v_cndmask_b32 v29, 0, v26, s[18:19]
  v_mfma_f32_16x16x32_bf16 v[68:71], a[176:179], a[84:87], v[68:71]
  ds_read_b64_tr_b16 a[196:197], v7 offset:20480
  v_cndmask_b32 v30, 0, v26, s[20:21]
  v_mfma_f32_16x16x32_bf16 v[68:71], a[180:183], a[68:71], v[68:71]
  v_cndmask_b32 v31, 0, v26, s[22:23]
  v_mfma_f32_16x16x32_bf16 v[72:75], a[180:183], a[72:75], v[72:75]
  ds_read_b64_tr_b16 a[198:199], v7 offset:22528
  v_mfma_f32_16x16x32_bf16 a[184:187], v[28:31], a[228:231], a[184:187]
  v_cndmask_b32 v28, 0, v27, s[16:17]
  v_cndmask_b32 v29, 0, v27, s[18:19]
  v_mfma_f32_16x16x32_bf16 v[72:75], a[176:179], a[88:91], v[72:75]
  s_add_u32 m0, s45, 106496
  v_cndmask_b32 v30, 0, v27, s[20:21]
  v_cndmask_b32 v31, 0, v27, s[22:23]
  v_mfma_f32_16x16x32_bf16 v[76:79], a[176:179], a[92:95], v[76:79]
  ds_read_b64_tr_b16 a[160:161], v7 offset:24576
  v_mfma_f32_16x16x32_bf16 a[184:187], v[28:31], a[232:235], a[184:187]
  v_mfma_f32_16x16x32_bf16 v[76:79], a[180:183], a[76:79], v[76:79]
  s_waitcnt lgkmcnt(5)
  buffer_load_dwordx4 v11, s[32:35], s67 offen lds
  v_mfma_f32_16x16x32_bf16 v[92:95], a[192:195], a[76:79], v[92:95]
  ds_read_b64_tr_b16 a[162:163], v7 offset:26624
  v_mfma_f32_16x16x32_bf16 v[92:95], a[188:191], a[92:95], v[92:95]
  s_add_u32 m0, s45, 102400
  s_add_u32 s60, s67, 229376
  v_mfma_f32_16x16x32_bf16 v[88:91], a[188:191], a[88:91], v[88:91]
  ds_read_b64_tr_b16 a[164:165], v7 offset:28672
  v_mfma_f32_16x16x32_bf16 v[88:91], a[192:195], a[72:75], v[88:91]
  buffer_load_dwordx4 v11, s[28:31], s60 offen lds
  v_mfma_f32_16x16x32_bf16 v[84:87], a[192:195], a[68:71], v[84:87]
  ds_read_b64_tr_b16 a[166:167], v7 offset:30720
  v_mfma_f32_16x16x32_bf16 v[84:87], a[188:191], a[84:87], v[84:87]
  v_mfma_f32_16x16x32_bf16 v[80:83], a[188:191], a[80:83], v[80:83]
  ds_read_b64_tr_b16 a[168:169], v8 offset:16384
  v_mfma_f32_16x16x32_bf16 v[80:83], a[192:195], a[64:67], v[80:83]
  s_waitcnt lgkmcnt(5)
  s_add_u32 m0, s45, 110592
  s_add_u32 s60, s67, 229376
  v_mfma_f32_16x16x32_bf16 v[96:99], a[200:203], a[64:67], v[96:99]
  ds_read_b64_tr_b16 a[170:171], v8 offset:18432
  v_mfma_f32_16x16x32_bf16 v[96:99], a[196:199], a[80:83], v[96:99]
  buffer_load_dwordx4 v11, s[32:35], s60 offen lds
  v_mfma_f32_16x16x32_bf16 v[100:103], a[196:199], a[84:87], v[100:103]
  ds_read_b64_tr_b16 a[172:173], v8 offset:20480
  v_mfma_f32_16x16x32_bf16 v[100:103], a[200:203], a[68:71], v[100:103]
  s_add_u32 m0, s45, 32768
  v_mfma_f32_16x16x32_bf16 v[104:107], a[200:203], a[72:75], v[104:107]
  ds_read_b64_tr_b16 a[174:175], v8 offset:22528
  v_mfma_f32_16x16x32_bf16 v[104:107], a[196:199], a[88:91], v[104:107]
  buffer_load_dwordx4 v10, s[28:31], s67 offen lds
  v_mfma_f32_16x16x32_bf16 v[108:111], a[196:199], a[92:95], v[108:111]
  ds_read_b64_tr_b16 a[176:177], v8 offset:24576
  v_mfma_f32_16x16x32_bf16 v[108:111], a[200:203], a[76:79], v[108:111]
  s_waitcnt lgkmcnt(5)
  v_mfma_f32_16x16x32_bf16 v[124:127], a[160:163], a[76:79], v[124:127]
  ds_read_b64_tr_b16 a[178:179], v8 offset:26624
  v_mfma_f32_16x16x32_bf16 v[124:127], a[164:167], a[92:95], v[124:127]
  s_add_u32 m0, s45, 40960
  v_mfma_f32_16x16x32_bf16 v[120:123], a[164:167], a[88:91], v[120:123]
  ds_read_b64_tr_b16 a[180:181], v8 offset:28672
  v_mfma_f32_16x16x32_bf16 v[120:123], a[160:163], a[72:75], v[120:123]
  buffer_load_dwordx4 v10, s[32:35], s67 offen lds
  v_mfma_f32_16x16x32_bf16 v[116:119], a[160:163], a[68:71], v[116:119]
  ds_read_b64_tr_b16 a[182:183], v8 offset:30720
  v_mfma_f32_16x16x32_bf16 v[116:119], a[164:167], a[84:87], v[116:119]
  s_add_u32 m0, s45, 36864
  s_add_u32 s60, s67, 229376
  v_mfma_f32_16x16x32_bf16 v[112:115], a[164:167], a[80:83], v[112:115]
  ds_read_b64_tr_b16 a[164:165], v2 offset:16384
  v_mfma_f32_16x16x32_bf16 v[112:115], a[160:163], a[64:67], v[112:115]
  s_waitcnt lgkmcnt(5)
  buffer_load_dwordx4 v10, s[28:31], s60 offen lds
  v_mfma_f32_16x16x32_bf16 v[32:35], a[168:171], a[64:67], v[32:35]
  ds_read_b64_tr_b16 a[166:167], v2 offset:18432
  v_mfma_f32_16x16x32_bf16 v[32:35], a[172:175], a[80:83], v[32:35]
  v_mfma_f32_16x16x32_bf16 v[36:39], a[172:175], a[84:87], v[36:39]
  ds_read_b64_tr_b16 a[160:161], v2 offset:20480
  v_mfma_f32_16x16x32_bf16 v[36:39], a[168:171], a[68:71], v[36:39]
  s_add_u32 m0, s45, 45056
  s_add_u32 s60, s67, 229376
  v_mfma_f32_16x16x32_bf16 v[40:43], a[168:171], a[72:75], v[40:43]
  ds_read_b64_tr_b16 a[162:163], v2 offset:22528
  v_mfma_f32_16x16x32_bf16 v[40:43], a[172:175], a[88:91], v[40:43]
  buffer_load_dwordx4 v10, s[32:35], s60 offen lds
  v_mfma_f32_16x16x32_bf16 v[44:47], a[172:175], a[92:95], v[44:47]
  ds_read_b64_tr_b16 a[172:173], v2 offset:24576
  v_mfma_f32_16x16x32_bf16 v[44:47], a[168:171], a[76:79], v[44:47]
  s_waitcnt lgkmcnt(5)
  s_mov_b32 s61, 57344
  v_mfma_f32_16x16x32_bf16 v[60:63], a[176:179], a[76:79], v[60:63]
  ds_read_b64_tr_b16 a[174:175], v2 offset:26624
  v_mfma_f32_16x16x32_bf16 v[60:63], a[180:183], a[92:95], v[60:63]
  buffer_load_dwordx4 a[220:223], v13, s[12:15], s61 offen
  s_mov_b32 s61, 64512
  v_mfma_f32_16x16x32_bf16 v[56:59], a[180:183], a[88:91], v[56:59]
  ds_read_b64_tr_b16 a[168:169], v2 offset:28672
  v_mfma_f32_16x16x32_bf16 v[56:59], a[176:179], a[72:75], v[56:59]
  buffer_load_dwordx4 a[224:227], v13, s[12:15], s61 offen
  s_mov_b32 s61, 71680
  v_mfma_f32_16x16x32_bf16 v[52:55], a[176:179], a[68:71], v[52:55]
  ds_read_b64_tr_b16 a[170:171], v2 offset:30720
  v_mfma_f32_16x16x32_bf16 v[52:55], a[180:183], a[84:87], v[52:55]
  buffer_load_dwordx4 a[228:231], v13, s[12:15], s61 offen
  s_mov_b32 s61, 78848
  v_mfma_f32_16x16x32_bf16 v[48:51], a[180:183], a[80:83], v[48:51]
  ds_read_b64_tr_b16 a[180:181], v3 offset:16384
  v_mfma_f32_16x16x32_bf16 v[48:51], a[176:179], a[64:67], v[48:51]
  s_waitcnt lgkmcnt(5)
  buffer_load_dwordx4 a[232:235], v13, s[12:15], s61 offen
  v_mfma_f32_16x16x32_bf16 v[128:131], a[164:167], a[64:67], v[128:131]
HOP8:
  s_cbranch_execz WRET0
  ds_read_b64_tr_b16 a[182:183], v3 offset:18432
  v_mfma_f32_16x16x32_bf16 v[128:131], a[160:163], a[80:83], v[128:131]
  v_mfma_f32_16x16x32_bf16 v[132:135], a[160:163], a[84:87], v[132:135]
  ds_read_b64_tr_b16 a[176:177], v3 offset:20480
  v_mfma_f32_16x16x32_bf16 v[132:135], a[164:167], a[68:71], v[132:135]
  v_mfma_f32_16x16x32_bf16 v[136:139], a[164:167], a[72:75], v[136:139]
  ds_read_b64_tr_b16 a[178:179], v3 offset:22528
  v_mfma_f32_16x16x32_bf16 v[136:139], a[160:163], a[88:91], v[136:139]
  v_mfma_f32_16x16x32_bf16 v[140:143], a[160:163], a[92:95], v[140:143]
  ds_read_b64_tr_b16 a[160:161], v3 offset:24576
  v_mfma_f32_16x16x32_bf16 v[140:143], a[164:167], a[76:79], v[140:143]
  s_waitcnt lgkmcnt(5)
  v_mfma_f32_16x16x32_bf16 v[156:159], a[172:175], a[76:79], v[156:159]
  ds_read_b64_tr_b16 a[162:163], v3 offset:26624
  v_mfma_f32_16x16x32_bf16 v[156:159], a[168:171], a[92:95], v[156:159]
  ds_read_b128 v[24:27], v14 offset:16
  v_mfma_f32_16x16x32_bf16 v[152:155], a[168:171], a[88:91], v[152:155]
  ds_read_b64_tr_b16 a[164:165], v3 offset:28672
  v_mfma_f32_16x16x32_bf16 v[152:155], a[172:175], a[72:75], v[152:155]
  v_mfma_f32_16x16x32_bf16 v[148:151], a[172:175], a[68:71], v[148:151]
  ds_read_b64_tr_b16 a[166:167], v3 offset:30720
  v_mfma_f32_16x16x32_bf16 v[148:151], a[168:171], a[84:87], v[148:151]
  v_mfma_f32_16x16x32_bf16 v[144:147], a[168:171], a[80:83], v[144:147]
  ds_read_b64_tr_b16 a[168:169], v4 offset:16384
  v_mfma_f32_16x16x32_bf16 v[144:147], a[172:175], a[64:67], v[144:147]
  s_waitcnt lgkmcnt(6)
  s_waitcnt vmcnt(12) lgkmcnt(3)
  v_cndmask_b32 v28, 0, v24, s[16:17]
  v_mfma_f32_16x16x32_bf16 v[160:163], a[180:183], a[64:67], v[160:163]
  ds_read_b64_tr_b16 a[170:171], v4 offset:18432
  v_cndmask_b32 v29, 0, v24, s[18:19]
  v_mfma_f32_16x16x32_bf16 v[160:163], a[176:179], a[80:83], v[160:163]
  v_cndmask_b32 v30, 0, v24, s[20:21]
  v_cndmask_b32 v31, 0, v24, s[22:23]
  v_mfma_f32_16x16x32_bf16 v[164:167], a[176:179], a[84:87], v[164:167]
  ds_read_b64_tr_b16 a[172:173], v4 offset:20480
  v_mfma_f32_16x16x32_bf16 a[184:187], v[28:31], a[236:239], a[184:187]
  v_cndmask_b32 v28, 0, v25, s[16:17]
  v_cndmask_b32 v29, 0, v25, s[18:19]
  v_mfma_f32_16x16x32_bf16 v[164:167], a[180:183], a[68:71], v[164:167]
  v_cndmask_b32 v30, 0, v25, s[20:21]
  v_cndmask_b32 v31, 0, v25, s[22:23]
  v_mfma_f32_16x16x32_bf16 v[168:171], a[180:183], a[72:75], v[168:171]
  ds_read_b64_tr_b16 a[174:175], v4 offset:22528
  v_mfma_f32_16x16x32_bf16 a[184:187], v[28:31], a[240:243], a[184:187]
  v_cndmask_b32 v28, 0, v26, s[16:17]
  v_cndmask_b32 v29, 0, v26, s[18:19]
  v_mfma_f32_16x16x32_bf16 v[168:171], a[176:179], a[88:91], v[168:171]
  v_cndmask_b32 v30, 0, v26, s[20:21]
  v_cndmask_b32 v31, 0, v26, s[22:23]
  v_mfma_f32_16x16x32_bf16 v[172:175], a[176:179], a[92:95], v[172:175]
  ds_read_b64_tr_b16 a[176:177], v4 offset:24576
  v_mfma_f32_16x16x32_bf16 a[184:187], v[28:31], a[244:247], a[184:187]
  v_cndmask_b32 v28, 0, v27, s[16:17]
  v_cndmask_b32 v29, 0, v27, s[18:19]
  v_mfma_f32_16x16x32_bf16 v[172:175], a[180:183], a[76:79], v[172:175]
  s_waitcnt lgkmcnt(5)
  v_cndmask_b32 v30, 0, v27, s[20:21]
  v_cndmask_b32 v31, 0, v27, s[22:23]
  v_mfma_f32_16x16x32_bf16 v[188:191], a[160:163], a[76:79], v[188:191]
  ds_read_b64_tr_b16 a[178:179], v4 offset:26624
  v_mfma_f32_16x16x32_bf16 a[184:187], v[28:31], a[248:251], a[184:187]
  v_mfma_f32_16x16x32_bf16 v[188:191], a[164:167], a[92:95], v[188:191]
  v_mfma_f32_16x16x32_bf16 v[184:187], a[164:167], a[88:91], v[184:187]
  ds_read_b64_tr_b16 a[180:181], v4 offset:28672
  v_mfma_f32_16x16x32_bf16 v[184:187], a[160:163], a[72:75], v[184:187]
  v_mfma_f32_16x16x32_bf16 v[180:183], a[160:163], a[68:71], v[180:183]
  ds_read_b64_tr_b16 a[182:183], v4 offset:30720
  s_add_u32 s61, s62, 0
  v_mfma_f32_16x16x32_bf16 v[180:183], a[164:167], a[84:87], v[180:183]
  buffer_load_dwordx4 a[188:191], v12, s[8:11], s61 offen offset:0 sc1
  v_mfma_f32_16x16x32_bf16 v[176:179], a[164:167], a[80:83], v[176:179]
  ds_read_b64_tr_b16 a[164:165], v5 offset:16384
  v_mfma_f32_16x16x32_bf16 v[176:179], a[160:163], a[64:67], v[176:179]
  s_waitcnt lgkmcnt(5)
  v_mfma_f32_16x16x32_bf16 v[192:195], a[168:171], a[64:67], v[192:195]
  ds_read_b64_tr_b16 a[166:167], v5 offset:18432
  v_mfma_f32_16x16x32_bf16 v[192:195], a[172:175], a[80:83], v[192:195]
  s_add_u32 s61, s62, 0
  v_mfma_f32_16x16x32_bf16 v[196:199], a[172:175], a[84:87], v[196:199]
  ds_read_b64_tr_b16 a[160:161], v5 offset:20480
  v_mfma_f32_16x16x32_bf16 v[196:199], a[168:171], a[68:71], v[196:199]
  buffer_load_dwordx4 a[192:195], v12, s[8:11], s61 offen offset:256 sc1
  v_mfma_f32_16x16x32_bf16 v[200:203], a[168:171], a[72:75], v[200:203]
  ds_read_b64_tr_b16 a[162:163], v5 offset:22528
  v_mfma_f32_16x16x32_bf16 v[200:203], a[172:175], a[88:91], v[200:203]
  s_add_u32 s61, s62, 2048
  v_mfma_f32_16x16x32_bf16 v[204:207], a[172:175], a[92:95], v[204:207]
  ds_read_b64_tr_b16 a[172:173], v5 offset:24576
  v_mfma_f32_16x16x32_bf16 v[204:207], a[168:171], a[76:79], v[204:207]
  s_waitcnt lgkmcnt(5)
  buffer_load_dwordx4 a[196:199], v12, s[8:11], s61 offen offset:0 sc1
  v_mfma_f32_16x16x32_bf16 v[220:223], a[176:179], a[76:79], v[220:223]
  ds_read_b64_tr_b16 a[174:175], v5 offset:26624
  v_mfma_f32_16x16x32_bf16 v[220:223], a[180:183], a[92:95], v[220:223]
  v_mfma_f32_16x16x32_bf16 v[216:219], a[180:183], a[88:91], v[216:219]
  ds_read_b64_tr_b16 a[168:169], v5 offset:28672
  v_mfma_f32_16x16x32_bf16 v[216:219], a[176:179], a[72:75], v[216:219]
  s_add_u32 s61, s62, 2048
  v_mfma_f32_16x16x32_bf16 v[212:215], a[176:179], a[68:71], v[212:215]
  ds_read_b64_tr_b16 a[170:171], v5 offset:30720
  buffer_load_dwordx4 a[200:203], v12, s[8:11], s61 offen offset:256 sc1
  v_mfma_f32_16x16x32_bf16 v[212:215], a[180:183], a[84:87], v[212:215]
  s_waitcnt vmcnt(44)
  s_barrier
  v_mfma_f32_16x16x32_bf16 v[208:211], a[180:183], a[80:83], v[208:211]
  ds_read_b64_tr_b16 a[180:181], v6 offset:0
  v_mfma_f32_16x16x32_bf16 v[208:211], a[176:179], a[64:67], v[208:211]
  s_waitcnt lgkmcnt(5)
  s_add_u32 s61, s62, 4096
  v_mfma_f32_16x16x32_bf16 v[224:227], a[164:167], a[64:67], v[224:227]
  ds_read_b64_tr_b16 a[182:183], v6 offset:2048
  v_mfma_f32_16x16x32_bf16 v[224:227], a[160:163], a[80:83], v[224:227]
  buffer_load_dwordx4 a[204:207], v12, s[8:11], s61 offen offset:0 sc1
  v_mfma_f32_16x16x32_bf16 v[228:231], a[160:163], a[84:87], v[228:231]
  ds_read_b64_tr_b16 a[176:177], v6 offset:4096
  v_mfma_f32_16x16x32_bf16 v[228:231], a[164:167], a[68:71], v[228:231]
  v_mfma_f32_16x16x32_bf16 v[232:235], a[164:167], a[72:75], v[232:235]
  ds_read_b64_tr_b16 a[178:179], v6 offset:6144
  v_mfma_f32_16x16x32_bf16 v[232:235], a[160:163], a[88:91], v[232:235]
  s_add_u32 s61, s62, 4096
  v_mfma_f32_16x16x32_bf16 v[236:239], a[160:163], a[92:95], v[236:239]
  ds_read_b64_tr_b16 a[160:161], v6 offset:8192
  v_mfma_f32_16x16x32_bf16 v[236:239], a[164:167], a[76:79], v[236:239]
  s_waitcnt lgkmcnt(5)
  buffer_load_dwordx4 a[208:211], v12, s[8:11], s61 offen offset:256 sc1
  v_mfma_f32_16x16x32_bf16 v[252:255], a[172:175], a[76:79], v[252:255]
  ds_read_b64_tr_b16 a[162:163], v6 offset:10240
  v_mfma_f32_16x16x32_bf16 v[252:255], a[168:171], a[92:95], v[252:255]
  s_add_u32 s61, s62, 6144
  v_mfma_f32_16x16x32_bf16 v[248:251], a[168:171], a[88:91], v[248:251]
  ds_read_b64_tr_b16 a[164:165], v6 offset:12288
  v_mfma_f32_16x16x32_bf16 v[248:251], a[172:175], a[72:75], v[248:251]
  buffer_load_dwordx4 a[212:215], v12, s[8:11], s61 offen offset:0 sc1
  v_mfma_f32_16x16x32_bf16 v[244:247], a[172:175], a[68:71], v[244:247]
  ds_read_b64_tr_b16 a[166:167], v6 offset:14336
  v_mfma_f32_16x16x32_bf16 v[244:247], a[168:171], a[84:87], v[244:247]
  v_mfma_f32_16x16x32_bf16 v[240:243], a[168:171], a[80:83], v[240:243]
  ds_read_b64_tr_b16 a[168:169], v7 offset:0
  v_mfma_f32_16x16x32_bf16 v[240:243], a[172:175], a[64:67], v[240:243]
  s_waitcnt vmcnt(23) lgkmcnt(5)
  s_add_u32 s61, s62, 6144
  v_mfma_f32_16x16x32_bf16 v[64:67], a[180:183], a[96:99], v[64:67]
  ds_read_b64_tr_b16 a[170:171], v7 offset:2048
  v_mfma_f32_16x16x32_bf16 v[64:67], a[176:179], a[112:115], v[64:67]
  buffer_load_dwordx4 a[216:219], v12, s[8:11], s61 offen offset:256 sc1
  v_mfma_f32_16x16x32_bf16 v[68:71], a[176:179], a[116:119], v[68:71]
  ds_read_b64_tr_b16 a[172:173], v7 offset:4096
  v_mfma_f32_16x16x32_bf16 v[68:71], a[180:183], a[100:103], v[68:71]
  v_mfma_f32_16x16x32_bf16 v[72:75], a[180:183], a[104:107], v[72:75]
  ds_read_b64_tr_b16 a[174:175], v7 offset:6144
  v_mfma_f32_16x16x32_bf16 v[72:75], a[176:179], a[120:123], v[72:75]
  buffer_load_dwordx4 a[128:131], v1, s[8:11], s75 offen offset:0 sc1
  v_mfma_f32_16x16x32_bf16 v[76:79], a[176:179], a[124:127], v[76:79]
  ds_read_b64_tr_b16 a[176:177], v7 offset:8192
  v_mfma_f32_16x16x32_bf16 v[76:79], a[180:183], a[108:111], v[76:79]
  s_waitcnt lgkmcnt(5)
  v_mfma_f32_16x16x32_bf16 v[92:95], a[160:163], a[108:111], v[92:95]
  ds_read_b64_tr_b16 a[178:179], v7 offset:10240
  v_mfma_f32_16x16x32_bf16 v[92:95], a[164:167], a[124:127], v[92:95]
  v_mfma_f32_16x16x32_bf16 v[88:91], a[164:167], a[120:123], v[88:91]
  ds_read_b64_tr_b16 a[180:181], v7 offset:12288
  v_mfma_f32_16x16x32_bf16 v[88:91], a[160:163], a[104:107], v[88:91]
  buffer_load_dwordx4 a[144:147], v1, s[8:11], s75 offen offset:1024 sc1
  v_mfma_f32_16x16x32_bf16 v[84:87], a[160:163], a[100:103], v[84:87]
  ds_read_b64_tr_b16 a[182:183], v7 offset:14336
  v_mfma_f32_16x16x32_bf16 v[84:87], a[164:167], a[116:119], v[84:87]
  v_mfma_f32_16x16x32_bf16 v[80:83], a[164:167], a[112:115], v[80:83]
  ds_read_b64_tr_b16 a[164:165], v8 offset:0
  s_mov_b32 s61, 86016
  v_mfma_f32_16x16x32_bf16 v[80:83], a[160:163], a[96:99], v[80:83]
  s_waitcnt lgkmcnt(5)
  buffer_load_dwordx4 a[236:239], v13, s[12:15], s61 offen
  v_mfma_f32_16x16x32_bf16 v[96:99], a[168:171], a[96:99], v[96:99]
  ds_read_b64_tr_b16 a[166:167], v8 offset:2048
  s_mov_b32 s61, 93184
  v_mfma_f32_16x16x32_bf16 v[96:99], a[172:175], a[112:115], v[96:99]
  buffer_load_dwordx4 a[240:243], v13, s[12:15], s61 offen
  s_mov_b32 s61, 100352
  v_mfma_f32_16x16x32_bf16 v[100:103], a[172:175], a[116:119], v[100:103]
  ds_read_b64_tr_b16 a[160:161], v8 offset:4096
  v_mfma_f32_16x16x32_bf16 v[100:103], a[168:171], a[100:103], v[100:103]
  buffer_load_dwordx4 a[244:247], v13, s[12:15], s61 offen
  s_mov_b32 s61, 107520
  v_mfma_f32_16x16x32_bf16 v[104:107], a[168:171], a[104:107], v[104:107]
  ds_read_b64_tr_b16 a[162:163], v8 offset:6144
  v_mfma_f32_16x16x32_bf16 v[104:107], a[172:175], a[120:123], v[104:107]
  buffer_load_dwordx4 a[248:251], v13, s[12:15], s61 offen
  ds_read_b128 v[24:27], v14 offset:32
  v_mfma_f32_16x16x32_bf16 v[108:111], a[172:175], a[124:127], v[108:111]
  ds_read_b64_tr_b16 a[172:173], v8 offset:8192
  v_mfma_f32_16x16x32_bf16 v[108:111], a[168:171], a[108:111], v[108:111]
  s_waitcnt lgkmcnt(6)
  v_mfma_f32_16x16x32_bf16 v[124:127], a[176:179], a[108:111], v[124:127]
  ds_read_b64_tr_b16 a[174:175], v8 offset:10240
  v_mfma_f32_16x16x32_bf16 v[124:127], a[180:183], a[124:127], v[124:127]
  v_mfma_f32_16x16x32_bf16 v[120:123], a[180:183], a[120:123], v[120:123]
  ds_read_b64_tr_b16 a[168:169], v8 offset:12288
  v_mfma_f32_16x16x32_bf16 v[120:123], a[176:179], a[104:107], v[120:123]
  s_waitcnt vmcnt(14) lgkmcnt(3)
  v_cndmask_b32 v28, 0, v24, s[16:17]
  v_cndmask_b32 v29, 0, v24, s[18:19]
  v_mfma_f32_16x16x32_bf16 v[116:119], a[176:179], a[100:103], v[116:119]
  ds_read_b64_tr_b16 a[170:171], v8 offset:14336
  v_cndmask_b32 v30, 0, v24, s[20:21]
  v_mfma_f32_16x16x32_bf16 v[116:119], a[180:183], a[116:119], v[116:119]
  v_cndmask_b32 v31, 0, v24, s[22:23]
  v_mfma_f32_16x16x32_bf16 v[112:115], a[180:183], a[112:115], v[112:115]
  ds_read_b64_tr_b16 a[180:181], v2 offset:0
  v_mfma_f32_16x16x32_bf16 a[184:187], v[28:31], a[220:223], a[184:187]
  v_cndmask_b32 v28, 0, v25, s[16:17]
  v_cndmask_b32 v29, 0, v25, s[18:19]
  v_mfma_f32_16x16x32_bf16 v[112:115], a[176:179], a[96:99], v[112:115]
  s_waitcnt lgkmcnt(6)
  v_cndmask_b32 v30, 0, v25, s[20:21]
  v_cndmask_b32 v31, 0, v25, s[22:23]
  v_mfma_f32_16x16x32_bf16 v[32:35], a[164:167], a[96:99], v[32:35]
  ds_read_b64_tr_b16 a[182:183], v2 offset:2048
  v_mfma_f32_16x16x32_bf16 a[184:187], v[28:31], a[224:227], a[184:187]
  v_cndmask_b32 v28, 0, v26, s[16:17]
  v_cndmask_b32 v29, 0, v26, s[18:19]
  v_mfma_f32_16x16x32_bf16 v[32:35], a[160:163], a[112:115], v[32:35]
  v_cndmask_b32 v30, 0, v26, s[20:21]
  v_cndmask_b32 v31, 0, v26, s[22:23]
  v_mfma_f32_16x16x32_bf16 v[36:39], a[160:163], a[116:119], v[36:39]
  ds_read_b64_tr_b16 a[176:177], v2 offset:4096
  v_mfma_f32_16x16x32_bf16 a[184:187], v[28:31], a[228:231], a[184:187]
  v_cndmask_b32 v28, 0, v27, s[16:17]
  v_cndmask_b32 v29, 0, v27, s[18:19]
  v_mfma_f32_16x16x32_bf16 v[36:39], a[164:167], a[100:103], v[36:39]
  v_cndmask_b32 v30, 0, v27, s[20:21]
  v_cndmask_b32 v31, 0, v27, s[22:23]
  v_mfma_f32_16x16x32_bf16 v[40:43], a[164:167], a[104:107], v[40:43]
  ds_read_b64_tr_b16 a[178:179], v2 offset:6144
  v_mfma_f32_16x16x32_bf16 a[184:187], v[28:31], a[232:235], a[184:187]
  v_mfma_f32_16x16x32_bf16 v[40:43], a[160:163], a[120:123], v[40:43]
  v_mfma_f32_16x16x32_bf16 v[44:47], a[160:163], a[124:127], v[44:47]
  ds_read_b64_tr_b16 a[160:161], v2 offset:8192
  v_mfma_f32_16x16x32_bf16 v[44:47], a[164:167], a[108:111], v[44:47]
  s_waitcnt lgkmcnt(5)
  v_mfma_f32_16x16x32_bf16 v[60:63], a[172:175], a[108:111], v[60:63]
  ds_read_b64_tr_b16 a[162:163], v2 offset:10240
  v_mfma_f32_16x16x32_bf16 v[60:63], a[168:171], a[124:127], v[60:63]
  v_mfma_f32_16x16x32_bf16 v[56:59], a[168:171], a[120:123], v[56:59]
  ds_read_b64_tr_b16 a[164:165], v2 offset:12288
  v_mfma_f32_16x16x32_bf16 v[56:59], a[172:175], a[104:107], v[56:59]
  v_mfma_f32_16x16x32_bf16 v[52:55], a[172:175], a[100:103], v[52:55]
  ds_read_b64_tr_b16 a[166:167], v2 offset:14336
  v_mfma_f32_16x16x32_bf16 v[52:55], a[168:171], a[116:119], v[52:55]
  v_mfma_f32_16x16x32_bf16 v[48:51], a[168:171], a[112:115], v[48:51]
  ds_read_b64_tr_b16 a[168:169], v3 offset:0
  v_mfma_f32_16x16x32_bf16 v[48:51], a[172:175], a[96:99], v[48:51]
  s_waitcnt lgkmcnt(5)
  v_mfma_f32_16x16x32_bf16 v[128:131], a[180:183], a[96:99], v[128:131]
  ds_read_b64_tr_b16 a[170:171], v3 offset:2048
  v_mfma_f32_16x16x32_bf16 v[128:131], a[176:179], a[112:115], v[128:131]
  s_add_u32 s75, s75, 65536
  v_mfma_f32_16x16x32_bf16 v[132:135], a[176:179], a[116:119], v[132:135]
  ds_read_b64_tr_b16 a[172:173], v3 offset:4096
  v_mfma_f32_16x16x32_bf16 v[132:135], a[180:183], a[100:103], v[132:135]
  buffer_load_dwordx4 a[132:135], v1, s[8:11], s75 offen offset:0 sc1
  v_mfma_f32_16x16x32_bf16 v[136:139], a[180:183], a[104:107], v[136:139]
  ds_read_b64_tr_b16 a[174:175], v3 offset:6144
  v_mfma_f32_16x16x32_bf16 v[136:139], a[176:179], a[120:123], v[136:139]
  v_mfma_f32_16x16x32_bf16 v[140:143], a[176:179], a[124:127], v[140:143]
  ds_read_b64_tr_b16 a[176:177], v3 offset:8192
  v_mfma_f32_16x16x32_bf16 v[140:143], a[180:183], a[108:111], v[140:143]
  s_waitcnt lgkmcnt(5)
  v_mfma_f32_16x16x32_bf16 v[156:159], a[160:163], a[108:111], v[156:159]
  ds_read_b64_tr_b16 a[178:179], v3 offset:10240
  v_mfma_f32_16x16x32_bf16 v[156:159], a[164:167], a[124:127], v[156:159]
  buffer_load_dwordx4 a[148:151], v1, s[8:11], s75 offen offset:1024 sc1
  v_mfma_f32_16x16x32_bf16 v[152:155], a[164:167], a[120:123], v[152:155]
  ds_read_b64_tr_b16 a[180:181], v3 offset:12288
  v_mfma_f32_16x16x32_bf16 v[152:155], a[160:163], a[104:107], v[152:155]
  s_add_u32 s75, s75, 65536
  v_mfma_f32_16x16x32_bf16 v[148:151], a[160:163], a[100:103], v[148:151]
  ds_read_b64_tr_b16 a[182:183], v3 offset:14336
  v_mfma_f32_16x16x32_bf16 v[148:151], a[164:167], a[116:119], v[148:151]
  buffer_load_dwordx4 a[136:139], v1, s[8:11], s75 offen offset:0 sc1
  v_mfma_f32_16x16x32_bf16 v[144:147], a[164:167], a[112:115], v[144:147]
  ds_read_b64_tr_b16 a[164:165], v4 offset:0
  v_mfma_f32_16x16x32_bf16 v[144:147], a[160:163], a[96:99], v[144:147]
  s_waitcnt lgkmcnt(5)
  v_mfma_f32_16x16x32_bf16 v[160:163], a[168:171], a[96:99], v[160:163]
  ds_read_b64_tr_b16 a[166:167], v4 offset:2048
  s_waitcnt vmcnt(9)
  v_mfma_f32_16x16x32_bf16 v[160:163], a[172:175], a[112:115], v[160:163]
  v_accvgpr_read_b32 v16, a188
  v_accvgpr_read_b32 v17, a189
  v_mfma_f32_16x16x32_bf16 v[164:167], a[172:175], a[116:119], v[164:167]
  ds_read_b64_tr_b16 a[160:161], v4 offset:4096
  v_accvgpr_read_b32 v18, a190
  v_mfma_f32_16x16x32_bf16 v[164:167], a[168:171], a[100:103], v[164:167]
  buffer_load_dwordx4 a[152:155], v1, s[8:11], s75 offen offset:1024 sc1
  v_accvgpr_read_b32 v19, a191
  v_accvgpr_read_b32 v20, a192
  v_mfma_f32_16x16x32_bf16 v[168:171], a[168:171], a[104:107], v[168:171]
  ds_read_b64_tr_b16 a[162:163], v4 offset:6144
  v_accvgpr_read_b32 v21, a193
  v_mfma_f32_16x16x32_bf16 v[168:171], a[172:175], a[120:123], v[168:171]
  s_add_u32 s75, s75, 65536
  v_accvgpr_read_b32 v22, a194
  v_accvgpr_read_b32 v23, a195
  v_mfma_f32_16x16x32_bf16 v[172:175], a[172:175], a[124:127], v[172:175]
  ds_read_b64_tr_b16 a[172:173], v4 offset:8192
  v_accvgpr_read_b32 v24, a196
  v_mfma_f32_16x16x32_bf16 v[172:175], a[168:171], a[108:111], v[172:175]
  s_waitcnt lgkmcnt(5)
  buffer_load_dwordx4 a[140:143], v1, s[8:11], s75 offen offset:0 sc1
  v_accvgpr_read_b32 v25, a197
  v_mfma_f32_16x16x32_bf16 v[188:191], a[176:179], a[108:111], v[188:191]
  ds_read_b64_tr_b16 a[174:175], v4 offset:10240
  v_accvgpr_read_b32 v26, a198
  v_mfma_f32_16x16x32_bf16 v[188:191], a[180:183], a[124:127], v[188:191]
  v_accvgpr_read_b32 v27, a199
  v_accvgpr_read_b32 v28, a200
  v_mfma_f32_16x16x32_bf16 v[184:187], a[180:183], a[120:123], v[184:187]
  ds_read_b64_tr_b16 a[168:169], v4 offset:12288
  v_accvgpr_read_b32 v29, a201
  v_mfma_f32_16x16x32_bf16 v[184:187], a[176:179], a[104:107], v[184:187]
  v_accvgpr_read_b32 v30, a202
  v_accvgpr_read_b32 v31, a203
  v_mfma_f32_16x16x32_bf16 v[180:183], a[176:179], a[100:103], v[180:183]
  ds_read_b64_tr_b16 a[170:171], v4 offset:14336
  v_add_f32 v16, v16, v24
  v_mfma_f32_16x16x32_bf16 v[180:183], a[180:183], a[116:119], v[180:183]
  buffer_load_dwordx4 a[156:159], v1, s[8:11], s75 offen offset:1024 sc1
  v_add_f32 v17, v17, v25
  v_add_f32 v18, v18, v26
  v_mfma_f32_16x16x32_bf16 v[176:179], a[180:183], a[112:115], v[176:179]
  ds_read_b64_tr_b16 a[180:181], v5 offset:0
  v_add_f32 v19, v19, v27
  v_mfma_f32_16x16x32_bf16 v[176:179], a[176:179], a[96:99], v[176:179]
  s_waitcnt lgkmcnt(5)
  s_mov_b32 s68, 2293760
  s_add_u32 s76, s24, 10240
  s_add_u32 m0, s45, 114688
  v_add_f32 v20, v20, v28
  v_mfma_f32_16x16x32_bf16 v[192:195], a[164:167], a[96:99], v[192:195]
  ds_read_b64_tr_b16 a[182:183], v5 offset:2048
  v_add_f32 v21, v21, v29
  v_mfma_f32_16x16x32_bf16 v[192:195], a[160:163], a[112:115], v[192:195]
  buffer_load_dwordx4 v11, s[28:31], s68 offen lds
  v_add_f32 v22, v22, v30
  v_add_f32 v23, v23, v31
  v_mfma_f32_16x16x32_bf16 v[196:199], a[160:163], a[116:119], v[196:199]
  ds_read_b64_tr_b16 a[176:177], v5 offset:4096
  v_accvgpr_read_b32 v24, a204
  v_mfma_f32_16x16x32_bf16 v[196:199], a[164:167], a[100:103], v[196:199]
  v_accvgpr_read_b32 v25, a205
  v_accvgpr_read_b32 v26, a206
  v_mfma_f32_16x16x32_bf16 v[200:203], a[164:167], a[104:107], v[200:203]
  ds_read_b64_tr_b16 a[178:179], v5 offset:6144
  v_accvgpr_read_b32 v27, a207
  v_mfma_f32_16x16x32_bf16 v[200:203], a[160:163], a[120:123], v[200:203]
  s_add_u32 m0, s45, 122880
  v_accvgpr_read_b32 v28, a208
  v_accvgpr_read_b32 v29, a209
  v_mfma_f32_16x16x32_bf16 v[204:207], a[160:163], a[124:127], v[204:207]
  ds_read_b64_tr_b16 a[160:161], v5 offset:8192
  v_accvgpr_read_b32 v30, a210
  v_mfma_f32_16x16x32_bf16 v[204:207], a[164:167], a[108:111], v[204:207]
  s_waitcnt lgkmcnt(5)
  buffer_load_dwordx4 v11, s[32:35], s68 offen lds
  v_accvgpr_read_b32 v31, a211
  v_mfma_f32_16x16x32_bf16 v[220:223], a[172:175], a[108:111], v[220:223]
  ds_read_b64_tr_b16 a[162:163], v5 offset:10240
  v_add_f32 v16, v16, v24
  v_mfma_f32_16x16x32_bf16 v[220:223], a[168:171], a[124:127], v[220:223]
  s_add_u32 m0, s45, 118784
  s_add_u32 s60, s68, 229376
  v_add_f32 v17, v17, v25
  v_mfma_f32_16x16x32_bf16 v[216:219], a[168:171], a[120:123], v[216:219]
  ds_read_b64_tr_b16 a[164:165], v5 offset:12288
  v_add_f32 v18, v18, v26
  v_mfma_f32_16x16x32_bf16 v[216:219], a[172:175], a[104:107], v[216:219]
  buffer_load_dwordx4 v11, s[28:31], s60 offen lds
  v_add_f32 v19, v19, v27
  v_add_f32 v20, v20, v28
  v_mfma_f32_16x16x32_bf16 v[212:215], a[172:175], a[100:103], v[212:215]
  ds_read_b64_tr_b16 a[166:167], v5 offset:14336
  v_add_f32 v21, v21, v29
  v_mfma_f32_16x16x32_bf16 v[212:215], a[168:171], a[116:119], v[212:215]
  s_waitcnt vmcnt(27)
  s_barrier
  v_mfma_f32_16x16x32_bf16 v[208:211], a[168:171], a[112:115], v[208:211]
  ds_read_b64_tr_b16 a[168:169], v6 offset:32768
  v_add_f32 v22, v22, v30
  v_mfma_f32_16x16x32_bf16 v[208:211], a[172:175], a[96:99], v[208:211]
  s_waitcnt lgkmcnt(5)
  s_add_u32 m0, s45, 126976
  s_add_u32 s60, s68, 229376
  v_mfma_f32_16x16x32_bf16 v[224:227], a[180:183], a[96:99], v[224:227]
  ds_read_b64_tr_b16 a[170:171], v6 offset:34816
  v_add_f32 v23, v23, v31
  v_mfma_f32_16x16x32_bf16 v[224:227], a[176:179], a[112:115], v[224:227]
  buffer_load_dwordx4 v11, s[32:35], s60 offen lds
  v_accvgpr_read_b32 v24, a212
  v_accvgpr_read_b32 v25, a213
  v_mfma_f32_16x16x32_bf16 v[228:231], a[176:179], a[116:119], v[228:231]
  ds_read_b64_tr_b16 a[172:173], v6 offset:36864
  v_accvgpr_read_b32 v26, a214
  v_mfma_f32_16x16x32_bf16 v[228:231], a[180:183], a[100:103], v[228:231]
  s_add_u32 m0, s45, 49152
  v_accvgpr_read_b32 v27, a215
  v_accvgpr_read_b32 v28, a216
  v_mfma_f32_16x16x32_bf16 v[232:235], a[180:183], a[104:107], v[232:235]
  ds_read_b64_tr_b16 a[174:175], v6 offset:38912
  v_accvgpr_read_b32 v29, a217
  v_mfma_f32_16x16x32_bf16 v[232:235], a[176:179], a[120:123], v[232:235]
  buffer_load_dwordx4 v10, s[28:31], s68 offen lds
  v_accvgpr_read_b32 v30, a218
  v_accvgpr_read_b32 v31, a219
  v_mfma_f32_16x16x32_bf16 v[236:239], a[176:179], a[124:127], v[236:239]
  ds_read_b64_tr_b16 a[176:177], v6 offset:40960
  v_add_f32 v16, v16, v24
  v_mfma_f32_16x16x32_bf16 v[236:239], a[180:183], a[108:111], v[236:239]
  s_waitcnt lgkmcnt(5)
  v_add_f32 v17, v17, v25
  v_add_f32 v18, v18, v26
  v_mfma_f32_16x16x32_bf16 v[252:255], a[160:163], a[108:111], v[252:255]
  ds_read_b64_tr_b16 a[178:179], v6 offset:43008
  v_add_f32 v19, v19, v27
  v_mfma_f32_16x16x32_bf16 v[252:255], a[164:167], a[124:127], v[252:255]
  s_add_u32 m0, s45, 57344
  v_add_f32 v20, v20, v28
  v_add_f32 v21, v21, v29
  v_mfma_f32_16x16x32_bf16 v[248:251], a[164:167], a[120:123], v[248:251]
  ds_read_b64_tr_b16 a[180:181], v6 offset:45056
  v_add_f32 v22, v22, v30
  v_mfma_f32_16x16x32_bf16 v[248:251], a[160:163], a[104:107], v[248:251]
  buffer_load_dwordx4 v10, s[32:35], s68 offen lds
  v_add_f32 v23, v23, v31
  v_mfma_f32_16x16x32_bf16 v[244:247], a[160:163], a[100:103], v[244:247]
  ds_read_b64_tr_b16 a[182:183], v6 offset:47104
  v_mfma_f32_16x16x32_bf16 v[244:247], a[164:167], a[116:119], v[244:247]
  s_add_u32 m0, s45, 53248
  s_add_u32 s60, s68, 229376
  v_mfma_f32_16x16x32_bf16 v[240:243], a[164:167], a[112:115], v[240:243]
  ds_read_b64_tr_b16 a[164:165], v7 offset:32768
  v_mfma_f32_16x16x32_bf16 v[240:243], a[160:163], a[96:99], v[240:243]
  s_waitcnt vmcnt(6) lgkmcnt(5)
  buffer_load_dwordx4 v10, s[28:31], s60 offen lds
  v_mfma_f32_16x16x32_bf16 v[64:67], a[168:171], a[128:131], v[64:67]
  ds_read_b64_tr_b16 a[166:167], v7 offset:34816
  v_mfma_f32_16x16x32_bf16 v[64:67], a[172:175], a[144:147], v[64:67]
  ds_read_b128 v[24:27], v14 offset:48
  v_mfma_f32_16x16x32_bf16 v[68:71], a[172:175], a[148:151], v[68:71]
  ds_read_b64_tr_b16 a[160:161], v7 offset:36864
  v_mfma_f32_16x16x32_bf16 v[68:71], a[168:171], a[132:135], v[68:71]
  s_add_u32 m0, s45, 61440
  s_add_u32 s60, s68, 229376
  v_mfma_f32_16x16x32_bf16 v[72:75], a[168:171], a[136:139], v[72:75]
  ds_read_b64_tr_b16 a[162:163], v7 offset:38912
  v_mfma_f32_16x16x32_bf16 v[72:75], a[172:175], a[152:155], v[72:75]
  buffer_load_dwordx4 v10, s[32:35], s60 offen lds
  v_mfma_f32_16x16x32_bf16 v[76:79], a[172:175], a[156:159], v[76:79]
  ds_read_b64_tr_b16 a[172:173], v7 offset:40960
  v_mfma_f32_16x16x32_bf16 v[76:79], a[168:171], a[140:143], v[76:79]
  s_waitcnt lgkmcnt(6)
  s_waitcnt vmcnt(14) lgkmcnt(3)
  v_mfma_f32_16x16x32_bf16 v[92:95], a[176:179], a[140:143], v[92:95]
  ds_read_b64_tr_b16 a[174:175], v7 offset:43008
  v_cndmask_b32 v28, 0, v24, s[16:17]
  v_mfma_f32_16x16x32_bf16 v[92:95], a[180:183], a[156:159], v[92:95]
  buffer_load_dwordx4 a[0:3], v1, s[8:11], s76 offen offset:0 sc1
  v_cndmask_b32 v29, 0, v24, s[18:19]
  v_cndmask_b32 v30, 0, v24, s[20:21]
  v_mfma_f32_16x16x32_bf16 v[88:91], a[180:183], a[152:155], v[88:91]
  ds_read_b64_tr_b16 a[168:169], v7 offset:45056
  v_cndmask_b32 v31, 0, v24, s[22:23]
  v_mfma_f32_16x16x32_bf16 v[88:91], a[176:179], a[136:139], v[88:91]
  s_nop 0
  v_mfma_f32_16x16x32_bf16 a[184:187], v[28:31], a[236:239], a[184:187]
  v_cndmask_b32 v28, 0, v25, s[16:17]
  v_cndmask_b32 v29, 0, v25, s[18:19]
  v_mfma_f32_16x16x32_bf16 v[84:87], a[176:179], a[132:135], v[84:87]
  ds_read_b64_tr_b16 a[170:171], v7 offset:47104
  v_cndmask_b32 v30, 0, v25, s[20:21]
  v_mfma_f32_16x16x32_bf16 v[84:87], a[180:183], a[148:151], v[84:87]
  v_cndmask_b32 v31, 0, v25, s[22:23]
  v_mfma_f32_16x16x32_bf16 v[80:83], a[180:183], a[144:147], v[80:83]
  ds_read_b64_tr_b16 a[180:181], v8 offset:32768
  v_mfma_f32_16x16x32_bf16 a[184:187], v[28:31], a[240:243], a[184:187]
  v_cndmask_b32 v28, 0, v26, s[16:17]
  v_cndmask_b32 v29, 0, v26, s[18:19]
  v_mfma_f32_16x16x32_bf16 v[80:83], a[176:179], a[128:131], v[80:83]
  s_waitcnt lgkmcnt(5)
  buffer_load_dwordx4 a[16:19], v1, s[8:11], s76 offen offset:1024 sc1
  v_cndmask_b32 v30, 0, v26, s[20:21]
  v_mfma_f32_16x16x32_bf16 v[96:99], a[164:167], a[128:131], v[96:99]
  ds_read_b64_tr_b16 a[182:183], v8 offset:34816
  v_cndmask_b32 v31, 0, v26, s[22:23]
  v_mfma_f32_16x16x32_bf16 v[96:99], a[160:163], a[144:147], v[96:99]
  s_add_u32 s76, s76, 65536
  v_mfma_f32_16x16x32_bf16 a[184:187], v[28:31], a[244:247], a[184:187]
  v_cndmask_b32 v28, 0, v27, s[16:17]
  v_cndmask_b32 v29, 0, v27, s[18:19]
  v_mfma_f32_16x16x32_bf16 v[100:103], a[160:163], a[148:151], v[100:103]
  ds_read_b64_tr_b16 a[176:177], v8 offset:36864
  v_cndmask_b32 v30, 0, v27, s[20:21]
  v_mfma_f32_16x16x32_bf16 v[100:103], a[164:167], a[132:135], v[100:103]
  buffer_load_dwordx4 a[4:7], v1, s[8:11], s76 offen offset:0 sc1
  v_cndmask_b32 v31, 0, v27, s[22:23]
  v_mfma_f32_16x16x32_bf16 v[104:107], a[164:167], a[136:139], v[104:107]
  ds_read_b64_tr_b16 a[178:179], v8 offset:38912
  v_mfma_f32_16x16x32_bf16 a[184:187], v[28:31], a[248:251], a[184:187]
  v_mfma_f32_16x16x32_bf16 v[104:107], a[160:163], a[152:155], v[104:107]
  v_mfma_f32_16x16x32_bf16 v[108:111], a[160:163], a[156:159], v[108:111]
  ds_read_b64_tr_b16 a[160:161], v8 offset:40960
  v_mfma_f32_16x16x32_bf16 v[108:111], a[164:167], a[140:143], v[108:111]
  s_waitcnt lgkmcnt(5)
  s_add_u32 s61, s62, 8192
  v_mfma_f32_16x16x32_bf16 v[124:127], a[172:175], a[140:143], v[124:127]
  ds_read_b64_tr_b16 a[162:163], v8 offset:43008
  s_bfe_u32 s53, s2, 0x20004
  v_mfma_f32_16x16x32_bf16 v[124:127], a[168:171], a[156:159], v[124:127]
  buffer_load_dwordx4 a[188:191], v12, s[8:11], s61 offen offset:0 sc1
  s_lshl_b32 s53, s53, 9
  v_and_b32 v14, 15, v0
  v_mfma_f32_16x16x32_bf16 v[120:123], a[168:171], a[152:155], v[120:123]
  ds_read_b64_tr_b16 a[164:165], v8 offset:45056
  v_lshl_add_u32 v14, v14, 5, s53
  v_mfma_f32_16x16x32_bf16 v[120:123], a[172:175], a[136:139], v[120:123]
  s_add_u32 s61, s62, 8192
  v_cmp_gt_u32 vcc, 1792, v14
  v_mov_b32 v15, 134217728
  v_bfe_u32 v13, v0, 4, 1
  v_cndmask_b32 v14, v15, v14, vcc
  v_mfma_f32_16x16x32_bf16 v[116:119], a[172:175], a[132:135], v[116:119]
  ds_read_b64_tr_b16 a[166:167], v8 offset:47104
  v_lshl_add_u32 v14, v13, 4, v14
  v_mfma_f32_16x16x32_bf16 v[116:119], a[168:171], a[148:151], v[116:119]
  buffer_load_dwordx4 a[192:195], v12, s[8:11], s61 offen offset:256 sc1
  v_lshrrev_b32 v13, 5, v0
  v_mul_u32_u24 v13, 14336, v13
  v_mfma_f32_16x16x32_bf16 v[112:115], a[168:171], a[144:147], v[112:115]
  ds_read_b64_tr_b16 a[168:169], v2 offset:32768
  v_add_u32 v14, v14, v13
  v_mfma_f32_16x16x32_bf16 v[112:115], a[172:175], a[128:131], v[112:115]
  s_waitcnt lgkmcnt(5)
  s_lshr_b32 s53, s2, 6
  s_lshl_b32 s53, s53, 2
  v_mfma_f32_16x16x32_bf16 v[32:35], a[180:183], a[128:131], v[32:35]
HOP9:
  s_cbranch_execz WRET0
  ds_read_b64_tr_b16 a[170:171], v2 offset:34816
  s_add_u32 s53, s53, s44
  v_mfma_f32_16x16x32_bf16 v[32:35], a[176:179], a[144:147], v[32:35]
  s_add_u32 s61, s62, 10240
  s_lshl_b32 s53, s53, 1
  s_bfe_u32 s54, s2, 0x10003
  v_mfma_f32_16x16x32_bf16 v[36:39], a[176:179], a[148:151], v[36:39]
  ds_read_b64_tr_b16 a[172:173], v2 offset:36864
  s_add_u32 s53, s53, s54
  v_mfma_f32_16x16x32_bf16 v[36:39], a[180:183], a[132:135], v[36:39]
  buffer_load_dwordx4 a[196:199], v12, s[8:11], s61 offen offset:0 sc1
  s_mul_i32 s53, s53, 28672
  s_mul_i32 s54, s52, 1792
  v_mfma_f32_16x16x32_bf16 v[40:43], a[180:183], a[136:139], v[40:43]
  ds_read_b64_tr_b16 a[174:175], v2 offset:38912
  s_add_u32 s53, s53, s54
  v_mfma_f32_16x16x32_bf16 v[40:43], a[176:179], a[152:155], v[40:43]
  s_add_u32 s61, s62, 10240
  s_add_u32 s53, s53, 46137344
  v_mfma_f32_16x16x32_bf16 v[44:47], a[176:179], a[156:159], v[44:47]
  ds_read_b64_tr_b16 a[176:177], v2 offset:40960
  v_mfma_f32_16x16x32_bf16 v[44:47], a[180:183], a[140:143], v[44:47]
  s_waitcnt lgkmcnt(5)
  buffer_load_dwordx4 a[200:203], v12, s[8:11], s61 offen offset:256 sc1
  v_mfma_f32_16x16x32_bf16 v[60:63], a[160:163], a[140:143], v[60:63]
  ds_read_b64_tr_b16 a[178:179], v2 offset:43008
  buffer_store_dwordx4 a[184:187], v14, s[8:11], s53 offen sc1
  v_mfma_f32_16x16x32_bf16 v[60:63], a[164:167], a[156:159], v[60:63]
  s_lshl_b32 s53, s52, 7
  s_add_u32 s53, s53, 884736
  v_and_b32 v13, 31, v0
  v_mfma_f32_16x16x32_bf16 v[56:59], a[164:167], a[152:155], v[56:59]
  ds_read_b64_tr_b16 a[180:181], v2 offset:45056
  v_min_u32 v15, 27, v13
  v_mfma_f32_16x16x32_bf16 v[56:59], a[160:163], a[136:139], v[56:59]
  s_add_u32 s61, s62, 12288
  v_lshl_add_u32 v13, v13, 10, s53
  v_lshlrev_b32 v15, 4, v15
  v_mfma_f32_16x16x32_bf16 v[52:55], a[160:163], a[132:135], v[52:55]
  ds_read_b64_tr_b16 a[182:183], v2 offset:47104
  s_lshl_b32 s53, s51, 9
  v_mfma_f32_16x16x32_bf16 v[52:55], a[164:167], a[148:151], v[52:55]
  buffer_load_dwordx4 a[204:207], v12, s[8:11], s61 offen offset:0 sc1
  v_mov_b32 v14, s53
  s_lshl_b32 s55, s51, 3
  v_mfma_f32_16x16x32_bf16 v[48:51], a[164:167], a[144:147], v[48:51]
  ds_read_b64_tr_b16 a[164:165], v3 offset:32768
  s_lshr_b32 s53, 0x0b070602, s55
  v_mfma_f32_16x16x32_bf16 v[48:51], a[160:163], a[128:131], v[48:51]
  s_waitcnt lgkmcnt(5)
  s_add_u32 s61, s62, 12288
  s_and_b32 s53, s53, 15
  v_mfma_f32_16x16x32_bf16 v[128:131], a[168:171], a[128:131], v[128:131]
  ds_read_b64_tr_b16 a[166:167], v3 offset:34816
  s_lshl_b32 s53, s53, 7
  v_mfma_f32_16x16x32_bf16 v[128:131], a[172:175], a[144:147], v[128:131]
  buffer_load_dwordx4 a[208:211], v12, s[8:11], s61 offen offset:256 sc1
  s_sub_u32 s53, s53, 256
  v_mov_b32 v24, s53
  v_mfma_f32_16x16x32_bf16 v[132:135], a[172:175], a[148:151], v[132:135]
  ds_read_b64_tr_b16 a[160:161], v3 offset:36864
  v_mfma_f32_16x16x32_bf16 v[132:135], a[168:171], a[132:135], v[132:135]
  v_cmp_gt_u32 vcc, 256, v15
  s_nop 1
  v_cndmask_b32 v14, v24, v14, vcc
  v_mfma_f32_16x16x32_bf16 v[136:139], a[168:171], a[136:139], v[136:139]
  ds_read_b64_tr_b16 a[162:163], v3 offset:38912
  s_lshr_b32 s53, 0x15140706, s55
  v_mfma_f32_16x16x32_bf16 v[136:139], a[172:175], a[152:155], v[136:139]
  s_add_u32 s61, s62, 14336
  s_and_b32 s53, s53, 31
  s_lshl_b32 s53, s53, 6
  v_mfma_f32_16x16x32_bf16 v[140:143], a[172:175], a[156:159], v[140:143]
  ds_read_b64_tr_b16 a[172:173], v3 offset:40960
  s_sub_u32 s53, s53, 384
  v_mfma_f32_16x16x32_bf16 v[140:143], a[168:171], a[140:143], v[140:143]
  s_waitcnt lgkmcnt(5)
  buffer_load_dwordx4 a[212:215], v12, s[8:11], s61 offen offset:0 sc1
  v_mov_b32 v24, s53
  v_mfma_f32_16x16x32_bf16 v[156:159], a[176:179], a[140:143], v[156:159]
  ds_read_b64_tr_b16 a[174:175], v3 offset:43008
  v_mfma_f32_16x16x32_bf16 v[156:159], a[180:183], a[156:159], v[156:159]
  s_add_u32 s61, s62, 14336
  v_cmp_gt_u32 vcc, 384, v15
  s_nop 1
  v_cndmask_b32 v14, v24, v14, vcc
  v_mfma_f32_16x16x32_bf16 v[152:155], a[180:183], a[152:155], v[152:155]
  ds_read_b64_tr_b16 a[168:169], v3 offset:45056
  v_lshrrev_b32 v24, 5, v0
  v_mfma_f32_16x16x32_bf16 v[152:155], a[176:179], a[136:139], v[152:155]
  buffer_load_dwordx4 a[216:219], v12, s[8:11], s61 offen offset:256 sc1
  v_mul_u32_u24 v24, 57344, v24
  v_add3_u32 v14, v14, v15, v24
  v_mfma_f32_16x16x32_bf16 v[148:151], a[176:179], a[132:135], v[148:151]
  ds_read_b64_tr_b16 a[170:171], v3 offset:47104
  s_mul_i32 s53, s44, 14336
  v_mfma_f32_16x16x32_bf16 v[148:151], a[180:183], a[148:151], v[148:151]
  s_add_u32 s53, s53, s54
  s_add_u32 s53, s53, 46137344
  v_add_u32 v14, s53, v14
  v_mfma_f32_16x16x32_bf16 v[144:147], a[180:183], a[144:147], v[144:147]
  ds_read_b64_tr_b16 a[180:181], v4 offset:32768
  s_lshl_b32 s53, s44, 9
  v_mfma_f32_16x16x32_bf16 v[144:147], a[176:179], a[128:131], v[144:147]
  s_waitcnt lgkmcnt(5)
  s_add_u32 s53, s53, 131072
  v_add_u32 v15, s53, v15
  v_mfma_f32_16x16x32_bf16 v[160:163], a[164:167], a[128:131], v[160:163]
  ds_read_b64_tr_b16 a[182:183], v4 offset:34816
  s_and_b32 s50, s2, 4
  v_mfma_f32_16x16x32_bf16 v[160:163], a[160:163], a[144:147], v[160:163]
  buffer_load_dwordx4 a[20:23], v1, s[8:11], s76 offen offset:1024 sc1
  s_lshr_b32 s53, s2, 6
  s_add_u32 s50, s50, s53
  v_mfma_f32_16x16x32_bf16 v[164:167], a[160:163], a[148:151], v[164:167]
  ds_read_b64_tr_b16 a[176:177], v4 offset:36864
  s_bfe_u32 s51, s2, 0x30003
  v_mfma_f32_16x16x32_bf16 v[164:167], a[164:167], a[132:135], v[164:167]
  s_add_u32 s76, s76, 65536
  s_and_b32 s52, s2, 3
  s_add_u32 s90, s50, s51
  v_mfma_f32_16x16x32_bf16 v[168:171], a[164:167], a[136:139], v[168:171]
  ds_read_b64_tr_b16 a[178:179], v4 offset:38912
  s_and_b32 s90, s90, 3
  v_mfma_f32_16x16x32_bf16 v[168:171], a[160:163], a[152:155], v[168:171]
  buffer_load_dwordx4 a[8:11], v1, s[8:11], s76 offen offset:0 sc1
  s_lshl_b32 s53, s50, 4
  s_and_b32 s54, s52, 2
  v_mfma_f32_16x16x32_bf16 v[172:175], a[160:163], a[156:159], v[172:175]
  ds_read_b64_tr_b16 a[160:161], v4 offset:40960
  s_mul_i32 s88, s54, 4293918720
  v_mfma_f32_16x16x32_bf16 v[172:175], a[164:167], a[140:143], v[172:175]
  s_waitcnt lgkmcnt(5)
  s_add_u32 s88, s88, 917504
  s_lshl_b32 s54, s54, 2
  v_mfma_f32_16x16x32_bf16 v[188:191], a[172:175], a[140:143], v[188:191]
  ds_read_b64_tr_b16 a[162:163], v4 offset:43008
  s_add_u32 s53, s53, s54
  v_mfma_f32_16x16x32_bf16 v[188:191], a[168:171], a[156:159], v[188:191]
  s_lshl_b32 s54, s44, 1
  s_add_u32 s53, s53, s54
  s_mul_i32 s83, s53, 131072
  v_mfma_f32_16x16x32_bf16 v[184:187], a[168:171], a[152:155], v[184:187]
  ds_read_b64_tr_b16 a[164:165], v4 offset:45056
  s_mul_i32 s54, s52, 28672
  v_mfma_f32_16x16x32_bf16 v[184:187], a[172:175], a[136:139], v[184:187]
  buffer_load_dwordx4 a[24:27], v1, s[8:11], s76 offen offset:1024 sc1
  s_add_u32 s83, s83, s54
  s_add_u32 s83, s83, 19922944
  v_mfma_f32_16x16x32_bf16 v[180:183], a[172:175], a[132:135], v[180:183]
  ds_read_b64_tr_b16 a[166:167], v4 offset:47104
  s_lshl_b32 s84, s53, 15
  v_mfma_f32_16x16x32_bf16 v[180:183], a[168:171], a[148:151], v[180:183]
  s_add_u32 s76, s76, 65536
  s_lshl_b32 s51, s51, 1
  s_and_b32 s54, s52, 1
  v_mfma_f32_16x16x32_bf16 v[176:179], a[168:171], a[144:147], v[176:179]
  ds_read_b64_tr_b16 a[168:169], v5 offset:32768
  s_add_u32 s51, s51, s54
  v_mfma_f32_16x16x32_bf16 v[176:179], a[172:175], a[128:131], v[176:179]
  s_waitcnt lgkmcnt(5)
  buffer_load_dwordx4 a[12:15], v1, s[8:11], s76 offen offset:0 sc1
  s_lshl_b32 s53, s51, 7
  v_mfma_f32_16x16x32_bf16 v[192:195], a[180:183], a[128:131], v[192:195]
  ds_read_b64_tr_b16 a[170:171], v5 offset:34816
  s_add_u32 s84, s84, s53
  v_mfma_f32_16x16x32_bf16 v[192:195], a[176:179], a[144:147], v[192:195]
  s_lshl_b32 s87, s51, 8
  s_add_u32 s87, s87, 20480
  s_lshl_b32 s53, s50, 12
  v_mfma_f32_16x16x32_bf16 v[196:199], a[176:179], a[148:151], v[196:199]
  ds_read_b64_tr_b16 a[172:173], v5 offset:36864
  s_lshl_b32 s54, s52, 8
  v_mfma_f32_16x16x32_bf16 v[196:199], a[180:183], a[132:135], v[196:199]
  s_add_u32 s53, s53, s54
  s_add_u32 s81, s53, 688128
  s_lshl_b32 s89, s44, 12
  v_mfma_f32_16x16x32_bf16 v[200:203], a[180:183], a[136:139], v[200:203]
  ds_read_b64_tr_b16 a[174:175], v5 offset:38912
  s_add_u32 s89, s89, 135168
  v_mfma_f32_16x16x32_bf16 v[200:203], a[176:179], a[152:155], v[200:203]
  buffer_load_dwordx4 a[28:31], v1, s[8:11], s76 offen offset:1024 sc1
  s_lshl_b32 s85, s2, 16
  s_lshl_b32 s53, s44, 14
  v_mfma_f32_16x16x32_bf16 v[204:207], a[176:179], a[156:159], v[204:207]
  ds_read_b64_tr_b16 a[176:177], v5 offset:40960
  s_add_u32 s85, s85, s53
  v_mfma_f32_16x16x32_bf16 v[204:207], a[180:183], a[140:143], v[204:207]
  s_waitcnt lgkmcnt(5)
  s_mov_b32 s69, 2752512
  s_add_u32 s77, s24, 12288
  s_add_u32 m0, s45, 81920
  s_add_u32 s85, s85, 67108864
  v_mfma_f32_16x16x32_bf16 v[220:223], a[160:163], a[140:143], v[220:223]
  ds_read_b64_tr_b16 a[178:179], v5 offset:43008
  s_lshr_b32 s53, s2, 3
  v_mfma_f32_16x16x32_bf16 v[220:223], a[164:167], a[156:159], v[220:223]
  buffer_load_dwordx4 v11, s[28:31], s69 offen lds
  s_lshl_b32 s53, s53, 2
  s_add_u32 s53, s53, s44
  v_mfma_f32_16x16x32_bf16 v[216:219], a[164:167], a[152:155], v[216:219]
  ds_read_b64_tr_b16 a[180:181], v5 offset:45056
  s_mul_i32 s91, s53, 14336
  v_mfma_f32_16x16x32_bf16 v[216:219], a[160:163], a[136:139], v[216:219]
  s_mul_i32 s53, s52, 1835008
  s_add_u32 s91, s91, s53
  s_nop 0
  v_mfma_f32_16x16x32_bf16 v[212:215], a[160:163], a[132:135], v[212:215]
  ds_read_b64_tr_b16 a[182:183], v5 offset:47104
  v_mfma_f32_16x16x32_bf16 v[212:215], a[164:167], a[148:151], v[212:215]
  s_waitcnt vmcnt(18)
  s_barrier
  v_mfma_f32_16x16x32_bf16 v[208:211], a[164:167], a[144:147], v[208:211]
  ds_read_b64_tr_b16 a[164:165], v6 offset:49152
  s_add_u32 m0, s45, 90112
  v_mfma_f32_16x16x32_bf16 v[208:211], a[160:163], a[128:131], v[208:211]
  s_waitcnt lgkmcnt(5)
  buffer_load_dwordx4 v11, s[32:35], s69 offen lds
  v_mfma_f32_16x16x32_bf16 v[224:227], a[168:171], a[128:131], v[224:227]
  ds_read_b64_tr_b16 a[166:167], v6 offset:51200
  v_mfma_f32_16x16x32_bf16 v[224:227], a[172:175], a[144:147], v[224:227]
  s_add_u32 m0, s45, 86016
  s_add_u32 s60, s69, 229376
  v_mfma_f32_16x16x32_bf16 v[228:231], a[172:175], a[148:151], v[228:231]
  ds_read_b64_tr_b16 a[160:161], v6 offset:53248
  v_mfma_f32_16x16x32_bf16 v[228:231], a[168:171], a[132:135], v[228:231]
  buffer_load_dwordx4 v11, s[28:31], s60 offen lds
  v_mfma_f32_16x16x32_bf16 v[232:235], a[168:171], a[136:139], v[232:235]
  ds_read_b64_tr_b16 a[162:163], v6 offset:55296
  v_add_u32 v9, s46, v0
  s_waitcnt vmcnt(12)
  s_barrier
  s_mov_b64 exec, 1
  buffer_store_dword v9, v0, s[8:11], s79 offen offset:0 sc1
  s_mov_b64 exec, -1
  s_sub_u32 s79, s79, 196608
  v_mfma_f32_16x16x32_bf16 v[232:235], a[172:175], a[152:155], v[232:235]
  v_mfma_f32_16x16x32_bf16 v[236:239], a[172:175], a[156:159], v[236:239]
  ds_read_b64_tr_b16 a[172:173], v6 offset:57344
  v_mfma_f32_16x16x32_bf16 v[236:239], a[168:171], a[140:143], v[236:239]
  s_waitcnt lgkmcnt(5)
  s_add_u32 m0, s45, 94208
  s_add_u32 s60, s69, 229376
  v_mfma_f32_16x16x32_bf16 v[252:255], a[176:179], a[140:143], v[252:255]
  ds_read_b64_tr_b16 a[174:175], v6 offset:59392
  v_mfma_f32_16x16x32_bf16 v[252:255], a[180:183], a[156:159], v[252:255]
  buffer_load_dwordx4 v11, s[32:35], s60 offen lds
  v_mfma_f32_16x16x32_bf16 v[248:251], a[180:183], a[152:155], v[248:251]
  ds_read_b64_tr_b16 a[168:169], v6 offset:61440
  v_mfma_f32_16x16x32_bf16 v[248:251], a[176:179], a[136:139], v[248:251]
  s_add_u32 m0, s45, 16384
  v_mfma_f32_16x16x32_bf16 v[244:247], a[176:179], a[132:135], v[244:247]
  ds_read_b64_tr_b16 a[170:171], v6 offset:63488
  v_mfma_f32_16x16x32_bf16 v[244:247], a[180:183], a[148:151], v[244:247]
  buffer_load_dwordx4 v10, s[28:31], s69 offen lds
  v_mfma_f32_16x16x32_bf16 v[240:243], a[180:183], a[144:147], v[240:243]
  ds_read_b64_tr_b16 a[180:181], v7 offset:49152
  v_mfma_f32_16x16x32_bf16 v[240:243], a[176:179], a[128:131], v[240:243]
  s_waitcnt vmcnt(6) lgkmcnt(5)
  v_mfma_f32_16x16x32_bf16 v[64:67], a[164:167], a[0:3], v[64:67]
  ds_read_b64_tr_b16 a[182:183], v7 offset:51200
  v_mfma_f32_16x16x32_bf16 v[64:67], a[160:163], a[16:19], v[64:67]
  s_add_u32 m0, s45, 24576
  v_mfma_f32_16x16x32_bf16 v[68:71], a[160:163], a[20:23], v[68:71]
  ds_read_b64_tr_b16 a[176:177], v7 offset:53248
  v_mfma_f32_16x16x32_bf16 v[68:71], a[164:167], a[4:7], v[68:71]
  buffer_load_dwordx4 v10, s[32:35], s69 offen lds
  v_mfma_f32_16x16x32_bf16 v[72:75], a[164:167], a[8:11], v[72:75]
  ds_read_b64_tr_b16 a[178:179], v7 offset:55296
  v_mfma_f32_16x16x32_bf16 v[72:75], a[160:163], a[24:27], v[72:75]
  s_add_u32 m0, s45, 20480
  s_add_u32 s60, s69, 229376
  v_mfma_f32_16x16x32_bf16 v[76:79], a[160:163], a[28:31], v[76:79]
  ds_read_b64_tr_b16 a[160:161], v7 offset:57344
  v_mfma_f32_16x16x32_bf16 v[76:79], a[164:167], a[12:15], v[76:79]
  s_waitcnt lgkmcnt(5)
  buffer_load_dwordx4 v10, s[28:31], s60 offen lds
  v_mfma_f32_16x16x32_bf16 v[92:95], a[172:175], a[12:15], v[92:95]
  ds_read_b64_tr_b16 a[162:163], v7 offset:59392
  v_mfma_f32_16x16x32_bf16 v[92:95], a[168:171], a[28:31], v[92:95]
  v_mfma_f32_16x16x32_bf16 v[88:91], a[168:171], a[24:27], v[88:91]
  ds_read_b64_tr_b16 a[164:165], v7 offset:61440
  s_waitcnt vmcnt(13)
  v_mfma_f32_16x16x32_bf16 v[88:91], a[172:175], a[8:11], v[88:91]
  s_add_u32 m0, s45, 28672
  s_add_u32 s60, s69, 229376
  v_accvgpr_read_b32 v24, a188
  v_mfma_f32_16x16x32_bf16 v[84:87], a[172:175], a[4:7], v[84:87]
  ds_read_b64_tr_b16 a[166:167], v7 offset:63488
  v_accvgpr_read_b32 v25, a189
  v_mfma_f32_16x16x32_bf16 v[84:87], a[168:171], a[20:23], v[84:87]
  buffer_load_dwordx4 v10, s[32:35], s60 offen lds
  v_accvgpr_read_b32 v26, a190
  v_accvgpr_read_b32 v27, a191
  v_mfma_f32_16x16x32_bf16 v[80:83], a[168:171], a[16:19], v[80:83]
  ds_read_b64_tr_b16 a[168:169], v8 offset:49152
  v_accvgpr_read_b32 v28, a192
  v_mfma_f32_16x16x32_bf16 v[80:83], a[172:175], a[0:3], v[80:83]
  s_waitcnt lgkmcnt(5)
  v_accvgpr_read_b32 v29, a193
  v_mfma_f32_16x16x32_bf16 v[96:99], a[180:183], a[0:3], v[96:99]
  ds_read_b64_tr_b16 a[170:171], v8 offset:51200
  v_accvgpr_read_b32 v30, a194
  v_mfma_f32_16x16x32_bf16 v[96:99], a[176:179], a[16:19], v[96:99]
  buffer_load_dwordx4 a[32:35], v1, s[8:11], s77 offen offset:0 sc1
  v_accvgpr_read_b32 v31, a195
  v_add_f32 v16, v16, v24
  v_mfma_f32_16x16x32_bf16 v[100:103], a[176:179], a[20:23], v[100:103]
  ds_read_b64_tr_b16 a[172:173], v8 offset:53248
  v_add_f32 v17, v17, v25
  v_mfma_f32_16x16x32_bf16 v[100:103], a[180:183], a[4:7], v[100:103]
  v_add_f32 v18, v18, v26
  v_add_f32 v19, v19, v27
  v_mfma_f32_16x16x32_bf16 v[104:107], a[180:183], a[8:11], v[104:107]
  ds_read_b64_tr_b16 a[174:175], v8 offset:55296
  v_add_f32 v20, v20, v28
  v_mfma_f32_16x16x32_bf16 v[104:107], a[176:179], a[24:27], v[104:107]
  v_add_f32 v21, v21, v29
  v_add_f32 v22, v22, v30
  v_mfma_f32_16x16x32_bf16 v[108:111], a[176:179], a[28:31], v[108:111]
  ds_read_b64_tr_b16 a[176:177], v8 offset:57344
  v_add_f32 v23, v23, v31
  v_mfma_f32_16x16x32_bf16 v[108:111], a[180:183], a[12:15], v[108:111]
  s_waitcnt lgkmcnt(5)
  buffer_load_dwordx4 a[48:51], v1, s[8:11], s77 offen offset:1024 sc1
  v_accvgpr_read_b32 v24, a196
  v_mfma_f32_16x16x32_bf16 v[124:127], a[160:163], a[12:15], v[124:127]
  ds_read_b64_tr_b16 a[178:179], v8 offset:59392
  v_accvgpr_read_b32 v25, a197
  v_mfma_f32_16x16x32_bf16 v[124:127], a[164:167], a[28:31], v[124:127]
  s_add_u32 s77, s77, 65536
  v_accvgpr_read_b32 v26, a198
  v_accvgpr_read_b32 v27, a199
  v_mfma_f32_16x16x32_bf16 v[120:123], a[164:167], a[24:27], v[120:123]
  ds_read_b64_tr_b16 a[180:181], v8 offset:61440
  v_accvgpr_read_b32 v28, a200
  v_mfma_f32_16x16x32_bf16 v[120:123], a[160:163], a[8:11], v[120:123]
  buffer_load_dwordx4 a[36:39], v1, s[8:11], s77 offen offset:0 sc1
  v_accvgpr_read_b32 v29, a201
  v_accvgpr_read_b32 v30, a202
  v_mfma_f32_16x16x32_bf16 v[116:119], a[160:163], a[4:7], v[116:119]
  ds_read_b64_tr_b16 a[182:183], v8 offset:63488
  v_accvgpr_read_b32 v31, a203
  v_mfma_f32_16x16x32_bf16 v[116:119], a[164:167], a[20:23], v[116:119]
  v_add_f32 v16, v16, v24
  v_add_f32 v17, v17, v25
  v_mfma_f32_16x16x32_bf16 v[112:115], a[164:167], a[16:19], v[112:115]
  ds_read_b64_tr_b16 a[164:165], v2 offset:49152
  v_add_f32 v18, v18, v26
  v_mfma_f32_16x16x32_bf16 v[112:115], a[160:163], a[0:3], v[112:115]
  s_waitcnt lgkmcnt(5)
  v_add_f32 v19, v19, v27
  v_add_f32 v20, v20, v28
  v_mfma_f32_16x16x32_bf16 v[32:35], a[168:171], a[0:3], v[32:35]
  ds_read_b64_tr_b16 a[166:167], v2 offset:51200
  v_add_f32 v21, v21, v29
  v_mfma_f32_16x16x32_bf16 v[32:35], a[172:175], a[16:19], v[32:35]
  buffer_load_dwordx4 a[52:55], v1, s[8:11], s77 offen offset:1024 sc1
  v_add_f32 v22, v22, v30
  v_add_f32 v23, v23, v31
  v_mfma_f32_16x16x32_bf16 v[36:39], a[172:175], a[20:23], v[36:39]
  ds_read_b64_tr_b16 a[160:161], v2 offset:53248
  v_accvgpr_read_b32 v24, a204
  v_mfma_f32_16x16x32_bf16 v[36:39], a[168:171], a[4:7], v[36:39]
  s_add_u32 s77, s77, 65536
  v_accvgpr_read_b32 v25, a205
  v_accvgpr_read_b32 v26, a206
  v_mfma_f32_16x16x32_bf16 v[40:43], a[168:171], a[8:11], v[40:43]
  ds_read_b64_tr_b16 a[162:163], v2 offset:55296
  v_accvgpr_read_b32 v27, a207
  v_mfma_f32_16x16x32_bf16 v[40:43], a[172:175], a[24:27], v[40:43]
  buffer_load_dwordx4 a[40:43], v1, s[8:11], s77 offen offset:0 sc1
  v_accvgpr_read_b32 v28, a208
  v_accvgpr_read_b32 v29, a209
  v_mfma_f32_16x16x32_bf16 v[44:47], a[172:175], a[28:31], v[44:47]
  ds_read_b64_tr_b16 a[172:173], v2 offset:57344
  v_accvgpr_read_b32 v30, a210
  v_mfma_f32_16x16x32_bf16 v[44:47], a[168:171], a[12:15], v[44:47]
  s_waitcnt lgkmcnt(5)
  v_accvgpr_read_b32 v31, a211
  v_add_f32 v16, v16, v24
  v_mfma_f32_16x16x32_bf16 v[60:63], a[176:179], a[12:15], v[60:63]
  ds_read_b64_tr_b16 a[174:175], v2 offset:59392
  v_add_f32 v17, v17, v25
  v_mfma_f32_16x16x32_bf16 v[60:63], a[180:183], a[28:31], v[60:63]
  v_add_f32 v18, v18, v26
  v_add_f32 v19, v19, v27
  v_mfma_f32_16x16x32_bf16 v[56:59], a[180:183], a[24:27], v[56:59]
  ds_read_b64_tr_b16 a[168:169], v2 offset:61440
  v_add_f32 v20, v20, v28
  v_mfma_f32_16x16x32_bf16 v[56:59], a[176:179], a[8:11], v[56:59]
  buffer_load_dwordx4 a[56:59], v1, s[8:11], s77 offen offset:1024 sc1
  v_add_f32 v21, v21, v29
  v_add_f32 v22, v22, v30
  v_mfma_f32_16x16x32_bf16 v[52:55], a[176:179], a[4:7], v[52:55]
  ds_read_b64_tr_b16 a[170:171], v2 offset:63488
  v_add_f32 v23, v23, v31
  v_mfma_f32_16x16x32_bf16 v[52:55], a[180:183], a[20:23], v[52:55]
  s_add_u32 s77, s77, 65536
  v_accvgpr_read_b32 v24, a212
  v_accvgpr_read_b32 v25, a213
  v_mfma_f32_16x16x32_bf16 v[48:51], a[180:183], a[16:19], v[48:51]
  ds_read_b64_tr_b16 a[180:181], v3 offset:49152
  v_accvgpr_read_b32 v26, a214
  v_mfma_f32_16x16x32_bf16 v[48:51], a[176:179], a[0:3], v[48:51]
  s_waitcnt lgkmcnt(5)
  buffer_load_dwordx4 a[44:47], v1, s[8:11], s77 offen offset:0 sc1
  v_accvgpr_read_b32 v27, a215
  v_mfma_f32_16x16x32_bf16 v[128:131], a[164:167], a[0:3], v[128:131]
  ds_read_b64_tr_b16 a[182:183], v3 offset:51200
  v_accvgpr_read_b32 v28, a216
  v_mfma_f32_16x16x32_bf16 v[128:131], a[160:163], a[16:19], v[128:131]
  v_accvgpr_read_b32 v29, a217
  v_accvgpr_read_b32 v30, a218
  v_mfma_f32_16x16x32_bf16 v[132:135], a[160:163], a[20:23], v[132:135]
  ds_read_b64_tr_b16 a[176:177], v3 offset:53248
  v_accvgpr_read_b32 v31, a219
  v_mfma_f32_16x16x32_bf16 v[132:135], a[164:167], a[4:7], v[132:135]
  v_add_f32 v16, v16, v24
  v_add_f32 v17, v17, v25
  v_mfma_f32_16x16x32_bf16 v[136:139], a[164:167], a[8:11], v[136:139]
  ds_read_b64_tr_b16 a[178:179], v3 offset:55296
  v_add_f32 v18, v18, v26
  v_mfma_f32_16x16x32_bf16 v[136:139], a[160:163], a[24:27], v[136:139]
  buffer_load_dwordx4 a[60:63], v1, s[8:11], s77 offen offset:1024 sc1
  v_add_f32 v19, v19, v27
  v_add_f32 v20, v20, v28
  v_mfma_f32_16x16x32_bf16 v[140:143], a[160:163], a[28:31], v[140:143]
  ds_read_b64_tr_b16 a[160:161], v3 offset:57344
  v_add_f32 v21, v21, v29
  v_mfma_f32_16x16x32_bf16 v[140:143], a[164:167], a[12:15], v[140:143]
  s_waitcnt lgkmcnt(5)
  s_mov_b32 s70, 3211264
  s_add_u32 s78, s24, 14336
  s_add_u32 m0, s45, 65536
  v_add_f32 v22, v22, v30
  v_mfma_f32_16x16x32_bf16 v[156:159], a[172:175], a[12:15], v[156:159]
  ds_read_b64_tr_b16 a[162:163], v3 offset:59392
  v_add_f32 v23, v23, v31
  v_mfma_f32_16x16x32_bf16 v[156:159], a[168:171], a[28:31], v[156:159]
  buffer_load_dwordx4 v11, s[28:31], s70 offen lds
  v_permlane32_swap_b32 v16, v20
  v_mfma_f32_16x16x32_bf16 v[152:155], a[168:171], a[24:27], v[152:155]
  ds_read_b64_tr_b16 a[164:165], v3 offset:61440
  v_mfma_f32_16x16x32_bf16 v[152:155], a[172:175], a[8:11], v[152:155]
  v_permlane32_swap_b32 v17, v21
  v_mfma_f32_16x16x32_bf16 v[148:151], a[172:175], a[4:7], v[148:151]
  ds_read_b64_tr_b16 a[166:167], v3 offset:63488
  v_mfma_f32_16x16x32_bf16 v[148:151], a[168:171], a[20:23], v[148:151]
  s_add_u32 m0, s45, 73728
  v_permlane32_swap_b32 v18, v22
  v_mfma_f32_16x16x32_bf16 v[144:147], a[168:171], a[16:19], v[144:147]
  ds_read_b64_tr_b16 a[168:169], v4 offset:49152
  v_mfma_f32_16x16x32_bf16 v[144:147], a[172:175], a[0:3], v[144:147]
  s_waitcnt lgkmcnt(5)
  buffer_load_dwordx4 v11, s[32:35], s70 offen lds
  v_mfma_f32_16x16x32_bf16 v[160:163], a[180:183], a[0:3], v[160:163]
  ds_read_b64_tr_b16 a[170:171], v4 offset:51200
  v_mfma_f32_16x16x32_bf16 v[160:163], a[176:179], a[16:19], v[160:163]
  s_add_u32 m0, s45, 69632
  s_add_u32 s60, s70, 229376
  v_mfma_f32_16x16x32_bf16 v[164:167], a[176:179], a[20:23], v[164:167]
  ds_read_b64_tr_b16 a[172:173], v4 offset:53248
  v_permlane32_swap_b32 v19, v23
  v_mfma_f32_16x16x32_bf16 v[164:167], a[180:183], a[4:7], v[164:167]
  buffer_load_dwordx4 v11, s[28:31], s60 offen lds
  v_add_f32 v16, v16, v20
  v_add_f32 v17, v17, v21
  v_mfma_f32_16x16x32_bf16 v[168:171], a[180:183], a[8:11], v[168:171]
  ds_read_b64_tr_b16 a[174:175], v4 offset:55296
  v_add_f32 v18, v18, v22
  v_mfma_f32_16x16x32_bf16 v[168:171], a[176:179], a[24:27], v[168:171]
  v_add_f32 v19, v19, v23
  v_mfma_f32_16x16x32_bf16 v[172:175], a[176:179], a[28:31], v[172:175]
  ds_read_b64_tr_b16 a[176:177], v4 offset:57344
  v_mfma_f32_16x16x32_bf16 v[172:175], a[180:183], a[12:15], v[172:175]
  s_waitcnt lgkmcnt(5)
  s_add_u32 m0, s45, 77824
  s_add_u32 s60, s70, 229376
  v_mfma_f32_16x16x32_bf16 v[188:191], a[160:163], a[12:15], v[188:191]
  ds_read_b64_tr_b16 a[178:179], v4 offset:59392
  v_mfma_f32_16x16x32_bf16 v[188:191], a[164:167], a[28:31], v[188:191]
  buffer_load_dwordx4 v11, s[32:35], s60 offen lds
  v_permlane16_swap_b32 v16, v18
  v_mfma_f32_16x16x32_bf16 v[184:187], a[164:167], a[24:27], v[184:187]
  ds_read_b64_tr_b16 a[180:181], v4 offset:61440
  v_mfma_f32_16x16x32_bf16 v[184:187], a[160:163], a[8:11], v[184:187]
  s_add_u32 m0, s45, 0
  v_permlane16_swap_b32 v17, v19
  v_mfma_f32_16x16x32_bf16 v[180:183], a[160:163], a[4:7], v[180:183]
  ds_read_b64_tr_b16 a[182:183], v4 offset:63488
  v_add_f32 v16, v16, v18
  v_mfma_f32_16x16x32_bf16 v[180:183], a[164:167], a[20:23], v[180:183]
  buffer_load_dwordx4 v10, s[28:31], s70 offen lds
  v_add_f32 v17, v17, v19
  v_mul_f32 v16, 0x3a800000, v16
  v_mfma_f32_16x16x32_bf16 v[176:179], a[164:167], a[16:19], v[176:179]
  ds_read_b64_tr_b16 a[164:165], v5 offset:49152
  v_mul_f32 v17, 0x3a800000, v17
  v_mfma_f32_16x16x32_bf16 v[176:179], a[160:163], a[0:3], v[176:179]
  s_waitcnt lgkmcnt(5)
  v_fma_f32 v17, -v16, v16, v17
  v_max_f32 v17, 0, v17
  v_mfma_f32_16x16x32_bf16 v[192:195], a[168:171], a[0:3], v[192:195]
  ds_read_b64_tr_b16 a[166:167], v5 offset:51200
  v_cvt_pk_bf16_f32 v17, v17, v17
  v_mfma_f32_16x16x32_bf16 v[192:195], a[172:175], a[16:19], v[192:195]
  s_add_u32 m0, s45, 8192
  v_lshlrev_b32 v17, 16, v17
  v_add_f32 v17, 0x3727c5ac, v17
  v_mfma_f32_16x16x32_bf16 v[196:199], a[172:175], a[20:23], v[196:199]
  ds_read_b64_tr_b16 a[160:161], v5 offset:53248
  v_cvt_pk_bf16_f32 v17, v17, v17
  v_mfma_f32_16x16x32_bf16 v[196:199], a[168:171], a[4:7], v[196:199]
  buffer_load_dwordx4 v10, s[32:35], s70 offen lds
  v_lshlrev_b32 v17, 16, v17
  v_mfma_f32_16x16x32_bf16 v[200:203], a[168:171], a[8:11], v[200:203]
  ds_read_b64_tr_b16 a[162:163], v5 offset:55296
  v_mfma_f32_16x16x32_bf16 v[200:203], a[172:175], a[24:27], v[200:203]
  s_add_u32 m0, s45, 4096
  s_add_u32 s60, s70, 229376
  v_mfma_f32_16x16x32_bf16 v[204:207], a[172:175], a[28:31], v[204:207]
  ds_read_b64_tr_b16 a[172:173], v5 offset:57344
  v_mfma_f32_16x16x32_bf16 v[204:207], a[168:171], a[12:15], v[204:207]
  s_waitcnt lgkmcnt(5)
  buffer_load_dwordx4 v10, s[28:31], s60 offen lds
  v_mfma_f32_16x16x32_bf16 v[220:223], a[176:179], a[12:15], v[220:223]
  ds_read_b64_tr_b16 a[174:175], v5 offset:59392
  v_sqrt_f32 v17, v17
  v_mfma_f32_16x16x32_bf16 v[220:223], a[180:183], a[28:31], v[220:223]
  v_cvt_pk_bf16_f32 v16, v16, v16
  v_lshlrev_b32 v16, 16, v16
  v_mfma_f32_16x16x32_bf16 v[216:219], a[180:183], a[24:27], v[216:219]
  ds_read_b64_tr_b16 a[168:169], v5 offset:61440
  v_cvt_pk_bf16_f32 v17, v17, v17
  v_mfma_f32_16x16x32_bf16 v[216:219], a[176:179], a[8:11], v[216:219]
  s_add_u32 m0, s45, 12288
  s_add_u32 s60, s70, 229376
  v_lshlrev_b32 v17, 16, v17
  v_mfma_f32_16x16x32_bf16 v[212:215], a[176:179], a[4:7], v[212:215]
  ds_read_b64_tr_b16 a[170:171], v5 offset:63488
  buffer_load_dwordx4 v10, s[32:35], s60 offen lds
  v_mfma_f32_16x16x32_bf16 v[212:215], a[180:183], a[20:23], v[212:215]
  s_waitcnt vmcnt(16)
  s_barrier
  v_mfma_f32_16x16x32_bf16 v[208:211], a[180:183], a[16:19], v[208:211]
  ds_read_b64_tr_b16 a[180:181], v6 offset:16384
  v_sub_f32 v16, 0, v16
  v_mfma_f32_16x16x32_bf16 v[208:211], a[176:179], a[0:3], v[208:211]
  s_waitcnt lgkmcnt(5)
  v_mov_b32 v18, v16
  v_mfma_f32_16x16x32_bf16 v[224:227], a[164:167], a[0:3], v[224:227]
  ds_read_b64_tr_b16 a[182:183], v6 offset:18432
  v_mov_b32 v19, v17
  v_mfma_f32_16x16x32_bf16 v[224:227], a[160:163], a[16:19], v[224:227]
  buffer_load_dwordx4 a[64:67], v1, s[8:11], s78 offen offset:0 sc1
  v_permlane16_swap_b32 v16, v18
  v_mfma_f32_16x16x32_bf16 v[228:231], a[160:163], a[20:23], v[228:231]
  ds_read_b64_tr_b16 a[176:177], v6 offset:20480
  v_mfma_f32_16x16x32_bf16 v[228:231], a[164:167], a[4:7], v[228:231]
  v_permlane16_swap_b32 v17, v19
  v_mfma_f32_16x16x32_bf16 v[232:235], a[164:167], a[8:11], v[232:235]
  ds_read_b64_tr_b16 a[178:179], v6 offset:22528
  v_mov_b32 v20, v16
  v_mfma_f32_16x16x32_bf16 v[232:235], a[160:163], a[24:27], v[232:235]
  v_mov_b32 v21, v17
  v_mov_b32 v22, v18
  v_mfma_f32_16x16x32_bf16 v[236:239], a[160:163], a[28:31], v[236:239]
  ds_read_b64_tr_b16 a[160:161], v6 offset:24576
  v_mov_b32 v23, v19
  v_mfma_f32_16x16x32_bf16 v[236:239], a[164:167], a[12:15], v[236:239]
  s_waitcnt lgkmcnt(5)
  buffer_load_dwordx4 a[80:83], v1, s[8:11], s78 offen offset:1024 sc1
  v_mfma_f32_16x16x32_bf16 v[252:255], a[172:175], a[12:15], v[252:255]
  ds_read_b64_tr_b16 a[162:163], v6 offset:26624
  v_mfma_f32_16x16x32_bf16 v[252:255], a[168:171], a[28:31], v[252:255]
  s_add_u32 s78, s78, 65536
  v_permlane32_swap_b32 v16, v20
  v_mfma_f32_16x16x32_bf16 v[248:251], a[168:171], a[24:27], v[248:251]
  ds_read_b64_tr_b16 a[164:165], v6 offset:28672
  v_mfma_f32_16x16x32_bf16 v[248:251], a[172:175], a[8:11], v[248:251]
  buffer_load_dwordx4 a[68:71], v1, s[8:11], s78 offen offset:0 sc1
  v_permlane32_swap_b32 v17, v21
  v_mfma_f32_16x16x32_bf16 v[244:247], a[172:175], a[4:7], v[244:247]
  ds_read_b64_tr_b16 a[166:167], v6 offset:30720
  v_mfma_f32_16x16x32_bf16 v[244:247], a[168:171], a[20:23], v[244:247]
  v_permlane32_swap_b32 v18, v22
  v_mfma_f32_16x16x32_bf16 v[240:243], a[168:171], a[16:19], v[240:243]
  ds_read_b64_tr_b16 a[168:169], v7 offset:16384
HOP10:
  s_cbranch_execz WRET0
  v_mfma_f32_16x16x32_bf16 v[240:243], a[172:175], a[0:3], v[240:243]
  s_waitcnt vmcnt(11) lgkmcnt(5)
  v_permlane32_swap_b32 v19, v23
  v_mfma_f32_16x16x32_bf16 v[64:67], a[180:183], a[32:35], v[64:67]
  ds_read_b64_tr_b16 a[170:171], v7 offset:18432
  v_lshrrev_b32 v12, 8, v1
  v_mfma_f32_16x16x32_bf16 v[64:67], a[176:179], a[48:51], v[64:67]
  buffer_load_dwordx4 a[84:87], v1, s[8:11], s78 offen offset:1024 sc1
  v_lshlrev_b32 v12, 4, v12
  v_add_u32 v12, 131072, v12
  v_mfma_f32_16x16x32_bf16 v[68:71], a[176:179], a[52:55], v[68:71]
  ds_read_b64_tr_b16 a[172:173], v7 offset:20480
  v_mfma_f32_16x16x32_bf16 v[68:71], a[180:183], a[36:39], v[68:71]
  s_add_u32 s78, s78, 65536
  v_mfma_f32_16x16x32_bf16 v[72:75], a[180:183], a[40:43], v[72:75]
  ds_read_b64_tr_b16 a[174:175], v7 offset:22528
  v_mfma_f32_16x16x32_bf16 v[72:75], a[176:179], a[56:59], v[72:75]
  buffer_load_dwordx4 a[72:75], v1, s[8:11], s78 offen offset:0 sc1
  v_mfma_f32_16x16x32_bf16 v[76:79], a[176:179], a[60:63], v[76:79]
  ds_read_b64_tr_b16 a[176:177], v7 offset:24576
  v_mfma_f32_16x16x32_bf16 v[76:79], a[180:183], a[44:47], v[76:79]
  s_waitcnt lgkmcnt(5)
  v_mfma_f32_16x16x32_bf16 v[92:95], a[160:163], a[44:47], v[92:95]
  ds_read_b64_tr_b16 a[178:179], v7 offset:26624
  v_mfma_f32_16x16x32_bf16 v[92:95], a[164:167], a[60:63], v[92:95]
  v_mfma_f32_16x16x32_bf16 v[88:91], a[164:167], a[56:59], v[88:91]
  ds_read_b64_tr_b16 a[180:181], v7 offset:28672
  v_mfma_f32_16x16x32_bf16 v[88:91], a[160:163], a[40:43], v[88:91]
  buffer_load_dwordx4 a[88:91], v1, s[8:11], s78 offen offset:1024 sc1
  v_mfma_f32_16x16x32_bf16 v[84:87], a[160:163], a[36:39], v[84:87]
  ds_read_b64_tr_b16 a[182:183], v7 offset:30720
  v_mfma_f32_16x16x32_bf16 v[84:87], a[164:167], a[52:55], v[84:87]
  s_lshl_b32 s82, s44, 28
  buffer_load_dword v9, v13, s[8:11], s82 offen sc1
  v_mfma_f32_16x16x32_bf16 v[80:83], a[164:167], a[48:51], v[80:83]
  ds_read_b64_tr_b16 a[164:165], v8 offset:16384
  s_add_u32 s78, s78, 65536
  v_mfma_f32_16x16x32_bf16 v[80:83], a[160:163], a[32:35], v[80:83]
  s_waitcnt lgkmcnt(5)
  buffer_load_dwordx4 a[76:79], v1, s[8:11], s78 offen offset:0 sc1
  v_mfma_f32_16x16x32_bf16 v[96:99], a[168:171], a[32:35], v[96:99]
  ds_read_b64_tr_b16 a[166:167], v8 offset:18432
  v_mfma_f32_16x16x32_bf16 v[96:99], a[172:175], a[48:51], v[96:99]
  v_mfma_f32_16x16x32_bf16 v[100:103], a[172:175], a[52:55], v[100:103]
  ds_read_b64_tr_b16 a[160:161], v8 offset:20480
  v_mfma_f32_16x16x32_bf16 v[100:103], a[168:171], a[36:39], v[100:103]
  v_mfma_f32_16x16x32_bf16 v[104:107], a[168:171], a[40:43], v[104:107]
  ds_read_b64_tr_b16 a[162:163], v8 offset:22528
  v_mfma_f32_16x16x32_bf16 v[104:107], a[172:175], a[56:59], v[104:107]
  buffer_load_dwordx4 a[92:95], v1, s[8:11], s78 offen offset:1024 sc1
  v_mfma_f32_16x16x32_bf16 v[108:111], a[172:175], a[60:63], v[108:111]
  ds_read_b64_tr_b16 a[172:173], v8 offset:24576
  v_mfma_f32_16x16x32_bf16 v[108:111], a[168:171], a[44:47], v[108:111]
  s_waitcnt lgkmcnt(5)
  s_mov_b32 s63, 3670016
  s_add_u32 s71, s24, 16384
  s_add_u32 m0, s45, 98304
  v_mfma_f32_16x16x32_bf16 v[124:127], a[176:179], a[44:47], v[124:127]
  ds_read_b64_tr_b16 a[174:175], v8 offset:26624
  v_mfma_f32_16x16x32_bf16 v[124:127], a[180:183], a[60:63], v[124:127]
  buffer_load_dwordx4 v11, s[28:31], s63 offen lds
  v_mfma_f32_16x16x32_bf16 v[120:123], a[180:183], a[56:59], v[120:123]
  ds_read_b64_tr_b16 a[168:169], v8 offset:28672
  v_mfma_f32_16x16x32_bf16 v[120:123], a[176:179], a[40:43], v[120:123]
  v_mfma_f32_16x16x32_bf16 v[116:119], a[176:179], a[36:39], v[116:119]
  ds_read_b64_tr_b16 a[170:171], v8 offset:30720
  v_mfma_f32_16x16x32_bf16 v[116:119], a[180:183], a[52:55], v[116:119]
  s_add_u32 m0, s45, 106496
  v_mfma_f32_16x16x32_bf16 v[112:115], a[180:183], a[48:51], v[112:115]
  ds_read_b64_tr_b16 a[180:181], v2 offset:16384
  v_mfma_f32_16x16x32_bf16 v[112:115], a[176:179], a[32:35], v[112:115]
  s_waitcnt lgkmcnt(5)
  buffer_load_dwordx4 v11, s[32:35], s63 offen lds
  v_mfma_f32_16x16x32_bf16 v[32:35], a[164:167], a[32:35], v[32:35]
  ds_read_b64_tr_b16 a[182:183], v2 offset:18432
  v_mfma_f32_16x16x32_bf16 v[32:35], a[160:163], a[48:51], v[32:35]
  s_add_u32 m0, s45, 102400
  s_add_u32 s60, s63, 229376
  v_mfma_f32_16x16x32_bf16 v[36:39], a[160:163], a[52:55], v[36:39]
  ds_read_b64_tr_b16 a[176:177], v2 offset:20480
  v_mfma_f32_16x16x32_bf16 v[36:39], a[164:167], a[36:39], v[36:39]
  buffer_load_dwordx4 v11, s[28:31], s60 offen lds
  v_mfma_f32_16x16x32_bf16 v[40:43], a[164:167], a[40:43], v[40:43]
  ds_read_b64_tr_b16 a[178:179], v2 offset:22528
  v_mfma_f32_16x16x32_bf16 v[40:43], a[160:163], a[56:59], v[40:43]
  v_mfma_f32_16x16x32_bf16 v[44:47], a[160:163], a[60:63], v[44:47]
  ds_read_b64_tr_b16 a[160:161], v2 offset:24576
  v_mfma_f32_16x16x32_bf16 v[44:47], a[164:167], a[44:47], v[44:47]
  s_waitcnt lgkmcnt(5)
  s_add_u32 m0, s45, 110592
  s_add_u32 s60, s63, 229376
  v_mfma_f32_16x16x32_bf16 v[60:63], a[172:175], a[44:47], v[60:63]
  ds_read_b64_tr_b16 a[162:163], v2 offset:26624
  v_mfma_f32_16x16x32_bf16 v[60:63], a[168:171], a[60:63], v[60:63]
  buffer_load_dwordx4 v11, s[32:35], s60 offen lds
  v_mfma_f32_16x16x32_bf16 v[56:59], a[168:171], a[56:59], v[56:59]
  ds_read_b64_tr_b16 a[164:165], v2 offset:28672
  v_mfma_f32_16x16x32_bf16 v[56:59], a[172:175], a[40:43], v[56:59]
  s_add_u32 m0, s45, 32768
  v_mfma_f32_16x16x32_bf16 v[52:55], a[172:175], a[36:39], v[52:55]
  ds_read_b64_tr_b16 a[166:167], v2 offset:30720
  v_mfma_f32_16x16x32_bf16 v[52:55], a[168:171], a[52:55], v[52:55]
  buffer_load_dwordx4 v10, s[28:31], s63 offen lds
  v_mfma_f32_16x16x32_bf16 v[48:51], a[168:171], a[48:51], v[48:51]
  ds_read_b64_tr_b16 a[168:169], v3 offset:16384
  v_mfma_f32_16x16x32_bf16 v[48:51], a[172:175], a[32:35], v[48:51]
  s_waitcnt lgkmcnt(5)
  v_mfma_f32_16x16x32_bf16 v[128:131], a[180:183], a[32:35], v[128:131]
  ds_read_b64_tr_b16 a[170:171], v3 offset:18432
  v_mfma_f32_16x16x32_bf16 v[128:131], a[176:179], a[48:51], v[128:131]
  s_add_u32 m0, s45, 40960
  v_mfma_f32_16x16x32_bf16 v[132:135], a[176:179], a[52:55], v[132:135]
  ds_read_b64_tr_b16 a[172:173], v3 offset:20480
  v_mfma_f32_16x16x32_bf16 v[132:135], a[180:183], a[36:39], v[132:135]
  buffer_load_dwordx4 v10, s[32:35], s63 offen lds
  v_mfma_f32_16x16x32_bf16 v[136:139], a[180:183], a[40:43], v[136:139]
  ds_read_b64_tr_b16 a[174:175], v3 offset:22528
  v_mfma_f32_16x16x32_bf16 v[136:139], a[176:179], a[56:59], v[136:139]
  s_waitcnt vmcnt(8)
  s_cmp_lg_u32 s44, 0
  s_cbranch_scc1 PL11_adaLN_cond__sliding_local_dilated__swiglu_ffn__prompt_kernelx
  v_cmp_ne_u32 vcc, s46, v9
  s_nop 4
  s_cbranch_vccz PL11_adaLN_cond__sliding_local_dilated__swiglu_ffn__prompt_kernelx
  s_mov_b32 s82, 60000
PL11_adaLN_cond__sliding_local_dilated__swiglu_ffn__prompt_kernel:
  buffer_load_dword v9, v13, s[8:11], 0 offen sc1
  s_sub_u32 s82, s82, 1
  s_cmp_eq_u32 s82, 0
  s_waitcnt vmcnt(0)
  s_cbranch_scc1 PL11_adaLN_cond__sliding_local_dilated__swiglu_ffn__prompt_kernelx
  v_cmp_ne_u32 vcc, s46, v9
  s_nop 4
  s_cbranch_vccnz PL11_adaLN_cond__sliding_local_dilated__swiglu_ffn__prompt_kernel
PL11_adaLN_cond__sliding_local_dilated__swiglu_ffn__prompt_kernelx:
  s_barrier
  v_mfma_f32_16x16x32_bf16 v[140:143], a[176:179], a[60:63], v[140:143]
  ds_read_b64_tr_b16 a[176:177], v3 offset:24576
  s_add_u32 m0, s45, 36864
  s_add_u32 s60, s63, 229376
  v_mfma_f32_16x16x32_bf16 v[140:143], a[180:183], a[44:47], v[140:143]
  s_waitcnt lgkmcnt(5)
  buffer_load_dwordx4 v10, s[28:31], s60 offen lds
  v_mfma_f32_16x16x32_bf16 v[156:159], a[160:163], a[44:47], v[156:159]
  ds_read_b64_tr_b16 a[178:179], v3 offset:26624
  v_mfma_f32_16x16x32_bf16 v[156:159], a[164:167], a[60:63], v[156:159]
  v_mfma_f32_16x16x32_bf16 v[152:155], a[164:167], a[56:59], v[152:155]
  ds_read_b64_tr_b16 a[180:181], v3 offset:28672
  v_mfma_f32_16x16x32_bf16 v[152:155], a[160:163], a[40:43], v[152:155]
  s_add_u32 m0, s45, 45056
  s_add_u32 s60, s63, 229376
  v_mfma_f32_16x16x32_bf16 v[148:151], a[160:163], a[36:39], v[148:151]
  ds_read_b64_tr_b16 a[182:183], v3 offset:30720
  v_mfma_f32_16x16x32_bf16 v[148:151], a[164:167], a[52:55], v[148:151]
  buffer_load_dwordx4 v10, s[32:35], s60 offen lds
  v_mfma_f32_16x16x32_bf16 v[144:147], a[164:167], a[48:51], v[144:147]
  ds_read_b64_tr_b16 a[164:165], v4 offset:16384
  v_mfma_f32_16x16x32_bf16 v[144:147], a[160:163], a[32:35], v[144:147]
  s_waitcnt lgkmcnt(5)
  s_mov_b32 s61, 0
  v_mfma_f32_16x16x32_bf16 v[160:163], a[168:171], a[32:35], v[160:163]
  ds_read_b64_tr_b16 a[166:167], v4 offset:18432
  v_mfma_f32_16x16x32_bf16 v[160:163], a[172:175], a[48:51], v[160:163]
  buffer_load_dwordx4 a[220:223], v14, s[8:11], s61 offen sc1
  v_mfma_f32_16x16x32_bf16 v[164:167], a[172:175], a[52:55], v[164:167]
  ds_read_b64_tr_b16 a[160:161], v4 offset:20480
  v_mfma_f32_16x16x32_bf16 v[164:167], a[168:171], a[36:39], v[164:167]
  s_mov_b32 s61, 114688
  v_mfma_f32_16x16x32_bf16 v[168:171], a[168:171], a[40:43], v[168:171]
  ds_read_b64_tr_b16 a[162:163], v4 offset:22528
  buffer_load_dwordx4 a[224:227], v14, s[8:11], s61 offen sc1
  v_mfma_f32_16x16x32_bf16 v[168:171], a[172:175], a[56:59], v[168:171]
  s_mov_b32 s61, 229376
  v_mfma_f32_16x16x32_bf16 v[172:175], a[172:175], a[60:63], v[172:175]
  ds_read_b64_tr_b16 a[172:173], v4 offset:24576
  buffer_load_dwordx4 a[228:231], v14, s[8:11], s61 offen sc1
  v_mfma_f32_16x16x32_bf16 v[172:175], a[168:171], a[44:47], v[172:175]
  s_waitcnt lgkmcnt(5)
  s_mov_b32 s61, 344064
  v_mfma_f32_16x16x32_bf16 v[188:191], a[176:179], a[44:47], v[188:191]
  ds_read_b64_tr_b16 a[174:175], v4 offset:26624
  v_mfma_f32_16x16x32_bf16 v[188:191], a[180:183], a[60:63], v[188:191]
  buffer_load_dwordx4 a[232:235], v14, s[8:11], s61 offen sc1
  s_mov_b32 s61, 458752
  v_mfma_f32_16x16x32_bf16 v[184:187], a[180:183], a[56:59], v[184:187]
  ds_read_b64_tr_b16 a[168:169], v4 offset:28672
  v_mfma_f32_16x16x32_bf16 v[184:187], a[176:179], a[40:43], v[184:187]
  buffer_load_dwordx4 a[236:239], v14, s[8:11], s61 offen sc1
  v_mfma_f32_16x16x32_bf16 v[180:183], a[176:179], a[36:39], v[180:183]
  ds_read_b64_tr_b16 a[170:171], v4 offset:30720
  v_mfma_f32_16x16x32_bf16 v[180:183], a[180:183], a[52:55], v[180:183]
  s_mov_b32 s61, 573440
  v_mfma_f32_16x16x32_bf16 v[176:179], a[180:183], a[48:51], v[176:179]
  ds_read_b64_tr_b16 a[180:181], v5 offset:16384
  buffer_load_dwordx4 a[240:243], v14, s[8:11], s61 offen sc1
  v_mfma_f32_16x16x32_bf16 v[176:179], a[176:179], a[32:35], v[176:179]
  s_waitcnt lgkmcnt(5)
  s_mov_b32 s61, 688128
  v_mfma_f32_16x16x32_bf16 v[192:195], a[164:167], a[32:35], v[192:195]
  ds_read_b64_tr_b16 a[182:183], v5 offset:18432
  buffer_load_dwordx4 a[244:247], v14, s[8:11], s61 offen sc1
  v_mfma_f32_16x16x32_bf16 v[192:195], a[160:163], a[48:51], v[192:195]
  s_mov_b32 s61, 802816
  v_mfma_f32_16x16x32_bf16 v[196:199], a[160:163], a[52:55], v[196:199]
  ds_read_b64_tr_b16 a[176:177], v5 offset:20480
  v_mfma_f32_16x16x32_bf16 v[196:199], a[164:167], a[36:39], v[196:199]
  buffer_load_dwordx4 a[248:251], v14, s[8:11], s61 offen sc1
  v_mfma_f32_16x16x32_bf16 v[200:203], a[164:167], a[40:43], v[200:203]
  ds_read_b64_tr_b16 a[178:179], v5 offset:22528
  v_mfma_f32_16x16x32_bf16 v[200:203], a[160:163], a[56:59], v[200:203]
  buffer_load_dwordx4 a[96:99], v1, s[8:11], s71 offen offset:0 sc1
  v_mfma_f32_16x16x32_bf16 v[204:207], a[160:163], a[60:63], v[204:207]
  ds_read_b64_tr_b16 a[160:161], v5 offset:24576
  v_mfma_f32_16x16x32_bf16 v[204:207], a[164:167], a[44:47], v[204:207]
  s_waitcnt lgkmcnt(5)
  v_mfma_f32_16x16x32_bf16 v[220:223], a[172:175], a[44:47], v[220:223]
  ds_read_b64_tr_b16 a[162:163], v5 offset:26624
  v_mfma_f32_16x16x32_bf16 v[220:223], a[168:171], a[60:63], v[220:223]
  v_mfma_f32_16x16x32_bf16 v[216:219], a[168:171], a[56:59], v[216:219]
  ds_read_b64_tr_b16 a[164:165], v5 offset:28672
  v_mfma_f32_16x16x32_bf16 v[216:219], a[172:175], a[40:43], v[216:219]
  buffer_load_dwordx4 a[112:115], v1, s[8:11], s71 offen offset:1024 sc1
  v_mfma_f32_16x16x32_bf16 v[212:215], a[172:175], a[36:39], v[212:215]
  ds_read_b64_tr_b16 a[166:167], v5 offset:30720
  v_mfma_f32_16x16x32_bf16 v[212:215], a[168:171], a[52:55], v[212:215]
  s_waitcnt vmcnt(27)
  s_barrier
  v_mfma_f32_16x16x32_bf16 v[208:211], a[168:171], a[48:51], v[208:211]
  ds_read_b64_tr_b16 a[168:169], v6 offset:0
  s_add_u32 s71, s71, 65536
  v_mfma_f32_16x16x32_bf16 v[208:211], a[172:175], a[32:35], v[208:211]
  s_waitcnt lgkmcnt(5)
  buffer_load_dwordx4 a[100:103], v1, s[8:11], s71 offen offset:0 sc1
  v_mfma_f32_16x16x32_bf16 v[224:227], a[180:183], a[32:35], v[224:227]
  ds_read_b64_tr_b16 a[170:171], v6 offset:2048
  v_mfma_f32_16x16x32_bf16 v[224:227], a[176:179], a[48:51], v[224:227]
  v_mfma_f32_16x16x32_bf16 v[228:231], a[176:179], a[52:55], v[228:231]
  ds_read_b64_tr_b16 a[172:173], v6 offset:4096
  v_mfma_f32_16x16x32_bf16 v[228:231], a[180:183], a[36:39], v[228:231]
  v_mfma_f32_16x16x32_bf16 v[232:235], a[180:183], a[40:43], v[232:235]
  ds_read_b64_tr_b16 a[174:175], v6 offset:6144
  v_mfma_f32_16x16x32_bf16 v[232:235], a[176:179], a[56:59], v[232:235]
  buffer_load_dwordx4 a[116:119], v1, s[8:11], s71 offen offset:1024 sc1
  v_mfma_f32_16x16x32_bf16 v[236:239], a[176:179], a[60:63], v[236:239]
  ds_read_b64_tr_b16 a[176:177], v6 offset:8192
  v_mfma_f32_16x16x32_bf16 v[236:239], a[180:183], a[44:47], v[236:239]
  s_waitcnt lgkmcnt(5)
  s_add_u32 s71, s71, 65536
  v_mfma_f32_16x16x32_bf16 v[252:255], a[160:163], a[44:47], v[252:255]
  ds_read_b64_tr_b16 a[178:179], v6 offset:10240
  v_mfma_f32_16x16x32_bf16 v[252:255], a[164:167], a[60:63], v[252:255]
  buffer_load_dwordx4 a[104:107], v1, s[8:11], s71 offen offset:0 sc1
  v_mfma_f32_16x16x32_bf16 v[248:251], a[164:167], a[56:59], v[248:251]
  ds_read_b64_tr_b16 a[180:181], v6 offset:12288
  v_mfma_f32_16x16x32_bf16 v[248:251], a[160:163], a[40:43], v[248:251]
  v_mfma_f32_16x16x32_bf16 v[244:247], a[160:163], a[36:39], v[244:247]
  ds_read_b64_tr_b16 a[182:183], v6 offset:14336
  v_mfma_f32_16x16x32_bf16 v[244:247], a[164:167], a[52:55], v[244:247]
  v_mfma_f32_16x16x32_bf16 v[240:243], a[164:167], a[48:51], v[240:243]
  ds_read_b64_tr_b16 a[164:165], v7 offset:0
  v_mfma_f32_16x16x32_bf16 v[240:243], a[160:163], a[32:35], v[240:243]
  s_waitcnt vmcnt(21) lgkmcnt(5)
  buffer_load_dwordx4 a[120:123], v1, s[8:11], s71 offen offset:1024 sc1
  v_mfma_f32_16x16x32_bf16 v[64:67], a[168:171], a[64:67], v[64:67]
  ds_read_b64_tr_b16 a[166:167], v7 offset:2048
  v_mfma_f32_16x16x32_bf16 v[64:67], a[172:175], a[80:83], v[64:67]
  s_add_u32 s71, s71, 65536
  v_mfma_f32_16x16x32_bf16 v[68:71], a[172:175], a[84:87], v[68:71]
  ds_read_b64_tr_b16 a[160:161], v7 offset:4096
  v_mfma_f32_16x16x32_bf16 v[68:71], a[168:171], a[68:71], v[68:71]
  buffer_load_dwordx4 a[108:111], v1, s[8:11], s71 offen offset:0 sc1
  v_mfma_f32_16x16x32_bf16 v[72:75], a[168:171], a[72:75], v[72:75]
  ds_read_b64_tr_b16 a[162:163], v7 offset:6144
  v_mfma_f32_16x16x32_bf16 v[72:75], a[172:175], a[88:91], v[72:75]
  v_mfma_f32_16x16x32_bf16 v[76:79], a[172:175], a[92:95], v[76:79]
  ds_read_b64_tr_b16 a[172:173], v7 offset:8192
  s_waitcnt vmcnt(7)
  v_mfma_f32_16x16x32_bf16 v[76:79], a[168:171], a[76:79], v[76:79]
  s_waitcnt lgkmcnt(5)
  v_accvgpr_read_b32 v24, a220
  v_accvgpr_read_b32 v25, a221
  v_accvgpr_read_b32 v26, a222
  v_mfma_f32_16x16x32_bf16 v[92:95], a[176:179], a[76:79], v[92:95]
  ds_read_b64_tr_b16 a[174:175], v7 offset:10240
  v_accvgpr_read_b32 v27, a223
  v_mfma_f32_16x16x32_bf16 v[92:95], a[180:183], a[92:95], v[92:95]
  buffer_load_dwordx4 a[124:127], v1, s[8:11], s71 offen offset:1024 sc1
  v_accvgpr_read_b32 v28, a224
  v_accvgpr_read_b32 v29, a225
  v_mfma_f32_16x16x32_bf16 v[88:91], a[180:183], a[88:91], v[88:91]
  ds_read_b64_tr_b16 a[168:169], v7 offset:12288
  v_accvgpr_read_b32 v30, a226
  v_mfma_f32_16x16x32_bf16 v[88:91], a[176:179], a[72:75], v[88:91]
  s_mov_b32 s64, 4128768
  s_add_u32 s72, s24, 18432
  s_add_u32 m0, s45, 114688
  v_accvgpr_read_b32 v31, a227
  v_add_f32 v24, v24, v28
  v_add_f32 v25, v25, v29
  v_mfma_f32_16x16x32_bf16 v[84:87], a[176:179], a[68:71], v[84:87]
  ds_read_b64_tr_b16 a[170:171], v7 offset:14336
  v_add_f32 v26, v26, v30
  v_mfma_f32_16x16x32_bf16 v[84:87], a[180:183], a[84:87], v[84:87]
  buffer_load_dwordx4 v11, s[28:31], s64 offen lds
  v_add_f32 v27, v27, v31
  v_accvgpr_read_b32 v28, a228
  v_mfma_f32_16x16x32_bf16 v[80:83], a[180:183], a[80:83], v[80:83]
  ds_read_b64_tr_b16 a[180:181], v8 offset:0
  v_accvgpr_read_b32 v29, a229
  v_mfma_f32_16x16x32_bf16 v[80:83], a[176:179], a[64:67], v[80:83]
  s_waitcnt lgkmcnt(5)
  v_accvgpr_read_b32 v30, a230
  v_accvgpr_read_b32 v31, a231
  v_add_f32 v24, v24, v28
  v_mfma_f32_16x16x32_bf16 v[96:99], a[164:167], a[64:67], v[96:99]
  ds_read_b64_tr_b16 a[182:183], v8 offset:2048
  v_add_f32 v25, v25, v29
  v_mfma_f32_16x16x32_bf16 v[96:99], a[160:163], a[80:83], v[96:99]
  s_add_u32 m0, s45, 122880
  v_add_f32 v26, v26, v30
  v_add_f32 v27, v27, v31
  v_mfma_f32_16x16x32_bf16 v[100:103], a[160:163], a[84:87], v[100:103]
  ds_read_b64_tr_b16 a[176:177], v8 offset:4096
  v_accvgpr_read_b32 v28, a232
  v_mfma_f32_16x16x32_bf16 v[100:103], a[164:167], a[68:71], v[100:103]
  buffer_load_dwordx4 v11, s[32:35], s64 offen lds
  v_accvgpr_read_b32 v29, a233
  v_accvgpr_read_b32 v30, a234
  v_accvgpr_read_b32 v31, a235
  v_mfma_f32_16x16x32_bf16 v[104:107], a[164:167], a[72:75], v[104:107]
  ds_read_b64_tr_b16 a[178:179], v8 offset:6144
  v_add_f32 v24, v24, v28
  v_mfma_f32_16x16x32_bf16 v[104:107], a[160:163], a[88:91], v[104:107]
  s_add_u32 m0, s45, 118784
  s_add_u32 s60, s64, 229376
  v_add_f32 v25, v25, v29
  v_mfma_f32_16x16x32_bf16 v[108:111], a[160:163], a[92:95], v[108:111]
  ds_read_b64_tr_b16 a[160:161], v8 offset:8192
  v_add_f32 v26, v26, v30
  v_mfma_f32_16x16x32_bf16 v[108:111], a[164:167], a[76:79], v[108:111]
  s_waitcnt lgkmcnt(5)
  buffer_load_dwordx4 v11, s[28:31], s60 offen lds
  v_add_f32 v27, v27, v31
  v_accvgpr_read_b32 v28, a236
  v_mfma_f32_16x16x32_bf16 v[124:127], a[172:175], a[76:79], v[124:127]
  ds_read_b64_tr_b16 a[162:163], v8 offset:10240
  v_accvgpr_read_b32 v29, a237
  v_mfma_f32_16x16x32_bf16 v[124:127], a[168:171], a[92:95], v[124:127]
  v_accvgpr_read_b32 v30, a238
  v_accvgpr_read_b32 v31, a239
  v_mfma_f32_16x16x32_bf16 v[120:123], a[168:171], a[88:91], v[120:123]
  ds_read_b64_tr_b16 a[164:165], v8 offset:12288
  v_add_f32 v24, v24, v28
  v_mfma_f32_16x16x32_bf16 v[120:123], a[172:175], a[72:75], v[120:123]
  s_add_u32 m0, s45, 126976
  s_add_u32 s60, s64, 229376
  v_add_f32 v25, v25, v29
  v_add_f32 v26, v26, v30
  v_mfma_f32_16x16x32_bf16 v[116:119], a[172:175], a[68:71], v[116:119]
  ds_read_b64_tr_b16 a[166:167], v8 offset:14336
  v_add_f32 v27, v27, v31
  v_mfma_f32_16x16x32_bf16 v[116:119], a[168:171], a[84:87], v[116:119]
  buffer_load_dwordx4 v11, s[32:35], s60 offen lds
  v_accvgpr_read_b32 v28, a240
  v_accvgpr_read_b32 v29, a241
  v_mfma_f32_16x16x32_bf16 v[112:115], a[168:171], a[80:83], v[112:115]
  ds_read_b64_tr_b16 a[168:169], v2 offset:0
  v_accvgpr_read_b32 v30, a242
  v_mfma_f32_16x16x32_bf16 v[112:115], a[172:175], a[64:67], v[112:115]
  s_waitcnt lgkmcnt(5)
  s_add_u32 m0, s45, 49152
  v_accvgpr_read_b32 v31, a243
  v_add_f32 v24, v24, v28
  v_mfma_f32_16x16x32_bf16 v[32:35], a[180:183], a[64:67], v[32:35]
  ds_read_b64_tr_b16 a[170:171], v2 offset:2048
  v_add_f32 v25, v25, v29
  v_mfma_f32_16x16x32_bf16 v[32:35], a[176:179], a[80:83], v[32:35]
  buffer_load_dwordx4 v10, s[28:31], s64 offen lds
  v_add_f32 v26, v26, v30
  v_add_f32 v27, v27, v31
  v_mfma_f32_16x16x32_bf16 v[36:39], a[176:179], a[84:87], v[36:39]
  ds_read_b64_tr_b16 a[172:173], v2 offset:4096
  v_accvgpr_read_b32 v28, a244
  v_mfma_f32_16x16x32_bf16 v[36:39], a[180:183], a[68:71], v[36:39]
  v_accvgpr_read_b32 v29, a245
  v_accvgpr_read_b32 v30, a246
  v_accvgpr_read_b32 v31, a247
  v_mfma_f32_16x16x32_bf16 v[40:43], a[180:183], a[72:75], v[40:43]
  ds_read_b64_tr_b16 a[174:175], v2 offset:6144
  v_add_f32 v24, v24, v28
  v_mfma_f32_16x16x32_bf16 v[40:43], a[176:179], a[88:91], v[40:43]
  s_add_u32 m0, s45, 57344
  v_add_f32 v25, v25, v29
  v_add_f32 v26, v26, v30
  v_mfma_f32_16x16x32_bf16 v[44:47], a[176:179], a[92:95], v[44:47]
  ds_read_b64_tr_b16 a[176:177], v2 offset:8192
  v_add_f32 v27, v27, v31
  v_mfma_f32_16x16x32_bf16 v[44:47], a[180:183], a[76:79], v[44:47]
  s_waitcnt lgkmcnt(5)
  buffer_load_dwordx4 v10, s[32:35], s64 offen lds
  v_accvgpr_read_b32 v28, a248
  v_accvgpr_read_b32 v29, a249
  v_mfma_f32_16x16x32_bf16 v[60:63], a[160:163], a[76:79], v[60:63]
  ds_read_b64_tr_b16 a[178:179], v2 offset:10240
  v_accvgpr_read_b32 v30, a250
  v_mfma_f32_16x16x32_bf16 v[60:63], a[164:167], a[92:95], v[60:63]
  s_add_u32 m0, s45, 53248
  s_add_u32 s60, s64, 229376
  v_accvgpr_read_b32 v31, a251
  v_mfma_f32_16x16x32_bf16 v[56:59], a[164:167], a[88:91], v[56:59]
  ds_read_b64_tr_b16 a[180:181], v2 offset:12288
  v_add_f32 v24, v24, v28
  v_mfma_f32_16x16x32_bf16 v[56:59], a[160:163], a[72:75], v[56:59]
  buffer_load_dwordx4 v10, s[28:31], s60 offen lds
  v_add_f32 v25, v25, v29
  v_add_f32 v26, v26, v30
  v_add_f32 v27, v27, v31
  v_mfma_f32_16x16x32_bf16 v[52:55], a[160:163], a[68:71], v[52:55]
  ds_read_b64_tr_b16 a[182:183], v2 offset:14336
  v_mov_b32 v28, v24
  v_mfma_f32_16x16x32_bf16 v[52:55], a[164:167], a[84:87], v[52:55]
  v_mov_b32 v29, v25
  v_mov_b32 v30, v26
  v_mfma_f32_16x16x32_bf16 v[48:51], a[164:167], a[80:83], v[48:51]
  ds_read_b64_tr_b16 a[164:165], v3 offset:0
  v_mov_b32 v31, v27
  v_mfma_f32_16x16x32_bf16 v[48:51], a[160:163], a[64:67], v[48:51]
  s_waitcnt lgkmcnt(5)
  s_add_u32 m0, s45, 61440
  s_add_u32 s60, s64, 229376
  v_mfma_f32_16x16x32_bf16 v[128:131], a[168:171], a[64:67], v[128:131]
  ds_read_b64_tr_b16 a[166:167], v3 offset:2048
  v_mfma_f32_16x16x32_bf16 v[128:131], a[172:175], a[80:83], v[128:131]
  buffer_load_dwordx4 v10, s[32:35], s60 offen lds
  v_permlane32_swap_b32 v24, v28
  v_mfma_f32_16x16x32_bf16 v[132:135], a[172:175], a[84:87], v[132:135]
  ds_read_b64_tr_b16 a[160:161], v3 offset:4096
  v_mfma_f32_16x16x32_bf16 v[132:135], a[168:171], a[68:71], v[132:135]
  v_permlane32_swap_b32 v25, v29
  v_mfma_f32_16x16x32_bf16 v[136:139], a[168:171], a[72:75], v[136:139]
  ds_read_b64_tr_b16 a[162:163], v3 offset:6144
  v_mfma_f32_16x16x32_bf16 v[136:139], a[172:175], a[88:91], v[136:139]
  buffer_load_dwordx4 a[128:131], v1, s[8:11], s72 offen offset:0 sc1
  v_permlane32_swap_b32 v26, v30
  v_mfma_f32_16x16x32_bf16 v[140:143], a[172:175], a[92:95], v[140:143]
  ds_read_b64_tr_b16 a[172:173], v3 offset:8192
  v_mfma_f32_16x16x32_bf16 v[140:143], a[168:171], a[76:79], v[140:143]
  s_waitcnt lgkmcnt(5)
  v_permlane32_swap_b32 v27, v31
  v_add_f32 v24, v24, v28
  v_mfma_f32_16x16x32_bf16 v[156:159], a[176:179], a[76:79], v[156:159]
  ds_read_b64_tr_b16 a[174:175], v3 offset:10240
  v_add_f32 v25, v25, v29
  v_mfma_f32_16x16x32_bf16 v[156:159], a[180:183], a[92:95], v[156:159]
  v_add_f32 v26, v26, v30
  v_add_f32 v27, v27, v31
  v_mfma_f32_16x16x32_bf16 v[152:155], a[180:183], a[88:91], v[152:155]
  ds_read_b64_tr_b16 a[168:169], v3 offset:12288
  v_mfma_f32_16x16x32_bf16 v[152:155], a[176:179], a[72:75], v[152:155]
  buffer_load_dwordx4 a[144:147], v1, s[8:11], s72 offen offset:1024 sc1
  s_cmp_eq_u32 s44, 1
  s_cselect_b32 s55, 0xbfb8aa3b, 1.0
  v_mul_f32 v24, s55, v24
  v_mfma_f32_16x16x32_bf16 v[148:151], a[176:179], a[68:71], v[148:151]
  ds_read_b64_tr_b16 a[170:171], v3 offset:14336
  v_lshrrev_b32 v13, 8, v1
  v_lshlrev_b32 v13, 28, v13
  v_mfma_f32_16x16x32_bf16 v[148:151], a[180:183], a[84:87], v[148:151]
  v_lshl_add_u32 v13, v1, 3, v13
  v_xor_b32 v9, 96, v6
  v_mfma_f32_16x16x32_bf16 v[144:147], a[180:183], a[80:83], v[144:147]
  ds_read_b64_tr_b16 a[180:181], v4 offset:0
  s_add_u32 s72, s72, 65536
  v_mfma_f32_16x16x32_bf16 v[144:147], a[176:179], a[64:67], v[144:147]
  s_waitcnt lgkmcnt(5)
  buffer_load_dwordx4 a[132:135], v1, s[8:11], s72 offen offset:0 sc1
  v_mul_f32 v25, s55, v25
  v_mul_f32 v26, s55, v26
  v_mfma_f32_16x16x32_bf16 v[160:163], a[164:167], a[64:67], v[160:163]
  ds_read_b64_tr_b16 a[182:183], v4 offset:2048
  v_mul_f32 v27, s55, v27
  v_mfma_f32_16x16x32_bf16 v[160:163], a[160:163], a[80:83], v[160:163]
  ds_write_b128 v15, v[24:27]
  v_mfma_f32_16x16x32_bf16 v[164:167], a[160:163], a[84:87], v[164:167]
  ds_read_b64_tr_b16 a[176:177], v4 offset:4096
  v_mfma_f32_16x16x32_bf16 v[164:167], a[164:167], a[68:71], v[164:167]
  v_mfma_f32_16x16x32_bf16 v[168:171], a[164:167], a[72:75], v[168:171]
  ds_read_b64_tr_b16 a[178:179], v4 offset:6144
  s_waitcnt lgkmcnt(2)
  s_barrier
  v_mfma_f32_16x16x32_bf16 v[168:171], a[160:163], a[88:91], v[168:171]
  buffer_load_dwordx4 a[148:151], v1, s[8:11], s72 offen offset:1024 sc1
  ds_read_b128 v[24:27], v12 offset:384
  v_mfma_f32_16x16x32_bf16 v[172:175], a[160:163], a[92:95], v[172:175]
  ds_read_b64_tr_b16 a[160:161], v4 offset:8192
  v_mfma_f32_16x16x32_bf16 v[172:175], a[164:167], a[76:79], v[172:175]
  s_waitcnt lgkmcnt(7)
  s_add_u32 s72, s72, 65536
  v_mfma_f32_16x16x32_bf16 v[188:191], a[172:175], a[76:79], v[188:191]
  ds_read_b64_tr_b16 a[162:163], v4 offset:10240
  v_mfma_f32_16x16x32_bf16 v[188:191], a[168:171], a[92:95], v[188:191]
  buffer_load_dwordx4 a[136:139], v1, s[8:11], s72 offen offset:0 sc1
  v_mfma_f32_16x16x32_bf16 v[184:187], a[168:171], a[88:91], v[184:187]
  ds_read_b64_tr_b16 a[164:165], v4 offset:12288
  v_mfma_f32_16x16x32_bf16 v[184:187], a[172:175], a[72:75], v[184:187]
  v_mfma_f32_16x16x32_bf16 v[180:183], a[172:175], a[68:71], v[180:183]
  ds_read_b64_tr_b16 a[166:167], v4 offset:14336
  v_mfma_f32_16x16x32_bf16 v[180:183], a[168:171], a[84:87], v[180:183]
  ds_read_b128 v[28:31], v12 offset:1408
  s_waitcnt lgkmcnt(5)
  v_mfma_f32_16x16x32_bf16 v[176:179], a[168:171], a[80:83], v[176:179]
  ds_read_b64_tr_b16 a[168:169], v5 offset:0
  v_fmac_f32 v32, v16, v24
  v_mfma_f32_16x16x32_bf16 v[176:179], a[172:175], a[64:67], v[176:179]
  s_waitcnt lgkmcnt(7)
  buffer_load_dwordx4 a[152:155], v1, s[8:11], s72 offen offset:1024 sc1
  v_fmac_f32 v33, v16, v25
  v_mfma_f32_16x16x32_bf16 v[192:195], a[180:183], a[64:67], v[192:195]
  ds_read_b64_tr_b16 a[170:171], v5 offset:2048
  v_fmac_f32 v34, v16, v26
  v_mfma_f32_16x16x32_bf16 v[192:195], a[176:179], a[80:83], v[192:195]
  s_add_u32 s72, s72, 65536
  v_fmac_f32 v35, v16, v27
  v_fmac_f32 v36, v18, v24
  v_mfma_f32_16x16x32_bf16 v[196:199], a[176:179], a[84:87], v[196:199]
  ds_read_b64_tr_b16 a[172:173], v5 offset:4096
  v_fmac_f32 v37, v18, v25
  v_mfma_f32_16x16x32_bf16 v[196:199], a[180:183], a[68:71], v[196:199]
  buffer_load_dwordx4 a[140:143], v1, s[8:11], s72 offen offset:0 sc1
  v_fmac_f32 v38, v18, v26
  v_fmac_f32 v39, v18, v27
  v_mfma_f32_16x16x32_bf16 v[200:203], a[180:183], a[72:75], v[200:203]
  ds_read_b64_tr_b16 a[174:175], v5 offset:6144
  v_fmac_f32 v40, v20, v24
  v_mfma_f32_16x16x32_bf16 v[200:203], a[176:179], a[88:91], v[200:203]
  v_fmac_f32 v41, v20, v25
  v_fmac_f32 v42, v20, v26
  v_mfma_f32_16x16x32_bf16 v[204:207], a[176:179], a[92:95], v[204:207]
  ds_read_b64_tr_b16 a[176:177], v5 offset:8192
  v_fmac_f32 v43, v20, v27
  v_mfma_f32_16x16x32_bf16 v[204:207], a[180:183], a[76:79], v[204:207]
  s_waitcnt lgkmcnt(6)
  v_fmac_f32 v44, v22, v24
  v_fmac_f32 v45, v22, v25
  v_mfma_f32_16x16x32_bf16 v[220:223], a[160:163], a[76:79], v[220:223]
  ds_read_b64_tr_b16 a[178:179], v5 offset:10240
  v_fmac_f32 v46, v22, v26
  v_mfma_f32_16x16x32_bf16 v[220:223], a[164:167], a[92:95], v[220:223]
  buffer_load_dwordx4 a[156:159], v1, s[8:11], s72 offen offset:1024 sc1
  v_fmac_f32 v47, v22, v27
  v_mfma_f32_16x16x32_bf16 v[216:219], a[164:167], a[88:91], v[216:219]
  ds_read_b64_tr_b16 a[180:181], v5 offset:12288
  v_mfma_f32_16x16x32_bf16 v[216:219], a[160:163], a[72:75], v[216:219]
  s_mov_b32 s65, 4587520
  s_add_u32 s73, s24, 20480
  s_add_u32 m0, s45, 81920
  ds_read_b128 v[24:27], v12 offset:1920
  v_mfma_f32_16x16x32_bf16 v[212:215], a[160:163], a[68:71], v[212:215]
  ds_read_b64_tr_b16 a[182:183], v5 offset:14336
  s_waitcnt lgkmcnt(9)
  v_mfma_f32_16x16x32_bf16 v[212:215], a[164:167], a[84:87], v[212:215]
  buffer_load_dwordx4 v11, s[28:31], s65 offen lds
  s_waitcnt vmcnt(33)
  s_barrier
  v_mfma_f32_16x16x32_bf16 v[208:211], a[164:167], a[80:83], v[208:211]
  ds_read_b64_tr_b16 a[164:165], v6 offset:32768
  v_fmac_f32 v48, v16, v28
  v_mfma_f32_16x16x32_bf16 v[208:211], a[160:163], a[64:67], v[208:211]
  s_waitcnt lgkmcnt(6)
  v_fmac_f32 v49, v16, v29
  v_fmac_f32 v50, v16, v30
  v_mfma_f32_16x16x32_bf16 v[224:227], a[168:171], a[64:67], v[224:227]
  ds_read_b64_tr_b16 a[166:167], v6 offset:34816
  v_fmac_f32 v51, v16, v31
HOP11:
  s_cbranch_execz WRET0
  v_mfma_f32_16x16x32_bf16 v[224:227], a[172:175], a[80:83], v[224:227]
  s_add_u32 m0, s45, 90112
  v_fmac_f32 v52, v18, v28
  v_fmac_f32 v53, v18, v29
  v_mfma_f32_16x16x32_bf16 v[228:231], a[172:175], a[84:87], v[228:231]
  ds_read_b64_tr_b16 a[160:161], v6 offset:36864
  v_fmac_f32 v54, v18, v30
  v_mfma_f32_16x16x32_bf16 v[228:231], a[168:171], a[68:71], v[228:231]
  buffer_load_dwordx4 v11, s[32:35], s65 offen lds
  v_fmac_f32 v55, v18, v31
  v_fmac_f32 v56, v20, v28
  v_mfma_f32_16x16x32_bf16 v[232:235], a[168:171], a[72:75], v[232:235]
  ds_read_b64_tr_b16 a[162:163], v6 offset:38912
  v_fmac_f32 v57, v20, v29
  v_mfma_f32_16x16x32_bf16 v[232:235], a[172:175], a[88:91], v[232:235]
  s_add_u32 m0, s45, 86016
  s_add_u32 s60, s65, 229376
  v_fmac_f32 v58, v20, v30
  v_mfma_f32_16x16x32_bf16 v[236:239], a[172:175], a[92:95], v[236:239]
  ds_read_b64_tr_b16 a[172:173], v6 offset:40960
  v_fmac_f32 v59, v20, v31
  v_mfma_f32_16x16x32_bf16 v[236:239], a[168:171], a[76:79], v[236:239]
  s_waitcnt lgkmcnt(5)
  buffer_load_dwordx4 v11, s[28:31], s60 offen lds
  v_fmac_f32 v60, v22, v28
  v_mfma_f32_16x16x32_bf16 v[252:255], a[176:179], a[76:79], v[252:255]
  ds_read_b64_tr_b16 a[174:175], v6 offset:43008
  v_fmac_f32 v61, v22, v29
  v_mfma_f32_16x16x32_bf16 v[252:255], a[180:183], a[92:95], v[252:255]
  v_fmac_f32 v62, v22, v30
  v_fmac_f32 v63, v22, v31
  v_mfma_f32_16x16x32_bf16 v[248:251], a[180:183], a[88:91], v[248:251]
  ds_read_b64_tr_b16 a[168:169], v6 offset:45056
  v_mfma_f32_16x16x32_bf16 v[248:251], a[176:179], a[72:75], v[248:251]
  s_add_u32 m0, s45, 94208
  s_add_u32 s60, s65, 229376
  v_mfma_f32_16x16x32_bf16 v[244:247], a[176:179], a[68:71], v[244:247]
  ds_read_b64_tr_b16 a[170:171], v6 offset:47104
  v_mfma_f32_16x16x32_bf16 v[244:247], a[180:183], a[84:87], v[244:247]
  buffer_load_dwordx4 v11, s[32:35], s60 offen lds
  ds_read_b128 v[28:31], v12 offset:0
  v_mfma_f32_16x16x32_bf16 v[240:243], a[180:183], a[80:83], v[240:243]
  ds_read_b64_tr_b16 a[180:181], v7 offset:32768
  s_waitcnt lgkmcnt(11)
  v_mfma_f32_16x16x32_bf16 v[240:243], a[176:179], a[64:67], v[240:243]
  s_waitcnt vmcnt(20) lgkmcnt(6)
  s_mov_b32 s66, 5046272
  s_add_u32 s74, s24, 22528
  s_add_u32 m0, s45, 65536
  v_fmac_f32 v48, v17, v24
  v_mfma_f32_16x16x32_bf16 v[64:67], a[164:167], a[96:99], v[64:67]
  ds_read_b64_tr_b16 a[182:183], v7 offset:34816
  v_fmac_f32 v49, v17, v25
  v_mfma_f32_16x16x32_bf16 v[64:67], a[160:163], a[112:115], v[64:67]
  buffer_load_dwordx4 v11, s[28:31], s66 offen lds
  v_fmac_f32 v50, v17, v26
  v_fmac_f32 v51, v17, v27
  v_mfma_f32_16x16x32_bf16 v[68:71], a[160:163], a[116:119], v[68:71]
  ds_read_b64_tr_b16 a[176:177], v7 offset:36864
  v_fmac_f32 v52, v19, v24
  v_mfma_f32_16x16x32_bf16 v[68:71], a[164:167], a[100:103], v[68:71]
  v_fmac_f32 v53, v19, v25
  v_fmac_f32 v54, v19, v26
  v_mfma_f32_16x16x32_bf16 v[72:75], a[164:167], a[104:107], v[72:75]
  ds_read_b64_tr_b16 a[178:179], v7 offset:38912
  v_fmac_f32 v55, v19, v27
  v_mfma_f32_16x16x32_bf16 v[72:75], a[160:163], a[120:123], v[72:75]
  s_add_u32 m0, s45, 73728
  v_fmac_f32 v56, v21, v24
  v_fmac_f32 v57, v21, v25
  v_mfma_f32_16x16x32_bf16 v[76:79], a[160:163], a[124:127], v[76:79]
  ds_read_b64_tr_b16 a[160:161], v7 offset:40960
  v_fmac_f32 v58, v21, v26
  v_mfma_f32_16x16x32_bf16 v[76:79], a[164:167], a[108:111], v[76:79]
  s_waitcnt lgkmcnt(6)
  buffer_load_dwordx4 v11, s[32:35], s66 offen lds
  v_fmac_f32 v59, v21, v27
  v_mfma_f32_16x16x32_bf16 v[92:95], a[172:175], a[108:111], v[92:95]
  ds_read_b64_tr_b16 a[162:163], v7 offset:43008
  v_fmac_f32 v60, v23, v24
  v_mfma_f32_16x16x32_bf16 v[92:95], a[168:171], a[124:127], v[92:95]
  s_add_u32 m0, s45, 69632
  s_add_u32 s60, s66, 229376
  v_fmac_f32 v61, v23, v25
  v_mfma_f32_16x16x32_bf16 v[88:91], a[168:171], a[120:123], v[88:91]
  ds_read_b64_tr_b16 a[164:165], v7 offset:45056
  v_fmac_f32 v62, v23, v26
  v_mfma_f32_16x16x32_bf16 v[88:91], a[172:175], a[104:107], v[88:91]
  buffer_load_dwordx4 v11, s[28:31], s60 offen lds
  v_fmac_f32 v63, v23, v27
  v_mfma_f32_16x16x32_bf16 v[84:87], a[172:175], a[100:103], v[84:87]
  ds_read_b64_tr_b16 a[166:167], v7 offset:47104
  v_mfma_f32_16x16x32_bf16 v[84:87], a[168:171], a[116:119], v[84:87]
  ds_read_b128 v[24:27], v12 offset:256
  s_waitcnt lgkmcnt(9)
  v_mfma_f32_16x16x32_bf16 v[80:83], a[168:171], a[112:115], v[80:83]
  ds_read_b64_tr_b16 a[168:169], v8 offset:32768
  v_fmac_f32 v128, v16, v28
  v_mfma_f32_16x16x32_bf16 v[80:83], a[172:175], a[96:99], v[80:83]
  s_waitcnt lgkmcnt(6)
  s_add_u32 m0, s45, 77824
  s_add_u32 s60, s66, 229376
  v_mfma_f32_16x16x32_bf16 v[96:99], a[180:183], a[96:99], v[96:99]
  ds_read_b64_tr_b16 a[170:171], v8 offset:34816
  v_fmac_f32 v129, v16, v29
  v_mfma_f32_16x16x32_bf16 v[96:99], a[176:179], a[112:115], v[96:99]
  buffer_load_dwordx4 v11, s[32:35], s60 offen lds
  v_fmac_f32 v130, v16, v30
  v_fmac_f32 v131, v16, v31
  v_mfma_f32_16x16x32_bf16 v[100:103], a[176:179], a[116:119], v[100:103]
  ds_read_b64_tr_b16 a[172:173], v8 offset:36864
  v_fmac_f32 v132, v18, v28
  v_mfma_f32_16x16x32_bf16 v[100:103], a[180:183], a[100:103], v[100:103]
  s_add_u32 m0, s45, 16384
  v_fmac_f32 v133, v18, v29
  v_fmac_f32 v134, v18, v30
  v_mfma_f32_16x16x32_bf16 v[104:107], a[180:183], a[104:107], v[104:107]
  ds_read_b64_tr_b16 a[174:175], v8 offset:38912
  v_fmac_f32 v135, v18, v31
  v_mfma_f32_16x16x32_bf16 v[104:107], a[176:179], a[120:123], v[104:107]
  buffer_load_dwordx4 v10, s[28:31], s65 offen lds
  v_fmac_f32 v136, v20, v28
  v_fmac_f32 v137, v20, v29
  v_mfma_f32_16x16x32_bf16 v[108:111], a[176:179], a[124:127], v[108:111]
  ds_read_b64_tr_b16 a[176:177], v8 offset:40960
  v_fmac_f32 v138, v20, v30
  v_mfma_f32_16x16x32_bf16 v[108:111], a[180:183], a[108:111], v[108:111]
  s_waitcnt lgkmcnt(6)
  v_fmac_f32 v139, v20, v31
  v_fmac_f32 v140, v22, v28
  v_mfma_f32_16x16x32_bf16 v[124:127], a[160:163], a[108:111], v[124:127]
  ds_read_b64_tr_b16 a[178:179], v8 offset:43008
  v_fmac_f32 v141, v22, v29
  v_mfma_f32_16x16x32_bf16 v[124:127], a[164:167], a[124:127], v[124:127]
  s_add_u32 m0, s45, 24576
  v_fmac_f32 v142, v22, v30
  v_fmac_f32 v143, v22, v31
  v_mfma_f32_16x16x32_bf16 v[120:123], a[164:167], a[120:123], v[120:123]
  ds_read_b64_tr_b16 a[180:181], v8 offset:45056
  v_mfma_f32_16x16x32_bf16 v[120:123], a[160:163], a[104:107], v[120:123]
  buffer_load_dwordx4 v10, s[32:35], s65 offen lds
  ds_read_b128 v[28:31], v12 offset:1280
  v_mfma_f32_16x16x32_bf16 v[116:119], a[160:163], a[100:103], v[116:119]
  ds_read_b64_tr_b16 a[182:183], v8 offset:47104
  s_waitcnt lgkmcnt(9)
  v_mfma_f32_16x16x32_bf16 v[116:119], a[164:167], a[116:119], v[116:119]
  s_add_u32 m0, s45, 20480
  s_add_u32 s60, s65, 229376
  v_fmac_f32 v64, v16, v24
  v_mfma_f32_16x16x32_bf16 v[112:115], a[164:167], a[112:115], v[112:115]
  ds_read_b64_tr_b16 a[164:165], v2 offset:32768
  v_fmac_f32 v65, v16, v25
  v_mfma_f32_16x16x32_bf16 v[112:115], a[160:163], a[96:99], v[112:115]
  s_waitcnt lgkmcnt(6)
  buffer_load_dwordx4 v10, s[28:31], s60 offen lds
  v_fmac_f32 v66, v16, v26
  v_mfma_f32_16x16x32_bf16 v[32:35], a[168:171], a[96:99], v[32:35]
  ds_read_b64_tr_b16 a[166:167], v2 offset:34816
  v_fmac_f32 v67, v16, v27
  v_mfma_f32_16x16x32_bf16 v[32:35], a[172:175], a[112:115], v[32:35]
  v_fmac_f32 v68, v18, v24
  v_fmac_f32 v69, v18, v25
  v_mfma_f32_16x16x32_bf16 v[36:39], a[172:175], a[116:119], v[36:39]
  ds_read_b64_tr_b16 a[160:161], v2 offset:36864
  v_fmac_f32 v70, v18, v26
  v_mfma_f32_16x16x32_bf16 v[36:39], a[168:171], a[100:103], v[36:39]
  s_add_u32 m0, s45, 28672
  s_add_u32 s60, s65, 229376
  v_fmac_f32 v71, v18, v27
  v_mfma_f32_16x16x32_bf16 v[40:43], a[168:171], a[104:107], v[40:43]
  ds_read_b64_tr_b16 a[162:163], v2 offset:38912
  v_fmac_f32 v72, v20, v24
  v_mfma_f32_16x16x32_bf16 v[40:43], a[172:175], a[120:123], v[40:43]
  buffer_load_dwordx4 v10, s[32:35], s60 offen lds
  v_fmac_f32 v73, v20, v25
  v_fmac_f32 v74, v20, v26
  v_mfma_f32_16x16x32_bf16 v[44:47], a[172:175], a[124:127], v[44:47]
  ds_read_b64_tr_b16 a[172:173], v2 offset:40960
  v_fmac_f32 v75, v20, v27
  v_mfma_f32_16x16x32_bf16 v[44:47], a[168:171], a[108:111], v[44:47]
  s_waitcnt lgkmcnt(5)
  v_fmac_f32 v76, v22, v24
  v_mfma_f32_16x16x32_bf16 v[60:63], a[176:179], a[108:111], v[60:63]
  ds_read_b64_tr_b16 a[174:175], v2 offset:43008
  v_fmac_f32 v77, v22, v25
  v_mfma_f32_16x16x32_bf16 v[60:63], a[180:183], a[124:127], v[60:63]
  buffer_load_dwordx4 a[0:3], v1, s[8:11], s73 offen offset:0 sc1
  v_fmac_f32 v78, v22, v26
  v_fmac_f32 v79, v22, v27
  v_mfma_f32_16x16x32_bf16 v[56:59], a[180:183], a[120:123], v[56:59]
  ds_read_b64_tr_b16 a[168:169], v2 offset:45056
  v_mfma_f32_16x16x32_bf16 v[56:59], a[176:179], a[104:107], v[56:59]
  ds_read_b128 v[24:27], v12 offset:1792
  s_waitcnt lgkmcnt(9)
  v_mfma_f32_16x16x32_bf16 v[52:55], a[176:179], a[100:103], v[52:55]
  ds_read_b64_tr_b16 a[170:171], v2 offset:47104
  v_fmac_f32 v80, v16, v28
  v_mfma_f32_16x16x32_bf16 v[52:55], a[180:183], a[116:119], v[52:55]
  v_fmac_f32 v81, v16, v29
  v_fmac_f32 v82, v16, v30
  v_mfma_f32_16x16x32_bf16 v[48:51], a[180:183], a[112:115], v[48:51]
  ds_read_b64_tr_b16 a[180:181], v3 offset:32768
  v_fmac_f32 v83, v16, v31
  v_mfma_f32_16x16x32_bf16 v[48:51], a[176:179], a[96:99], v[48:51]
  s_waitcnt lgkmcnt(6)
  buffer_load_dwordx4 a[16:19], v1, s[8:11], s73 offen offset:1024 sc1
  v_fmac_f32 v84, v18, v28
  v_mfma_f32_16x16x32_bf16 v[128:131], a[164:167], a[96:99], v[128:131]
  ds_read_b64_tr_b16 a[182:183], v3 offset:34816
  v_fmac_f32 v85, v18, v29
  v_mfma_f32_16x16x32_bf16 v[128:131], a[160:163], a[112:115], v[128:131]
  s_add_u32 s73, s73, 65536
  v_fmac_f32 v86, v18, v30
  v_fmac_f32 v87, v18, v31
  v_mfma_f32_16x16x32_bf16 v[132:135], a[160:163], a[116:119], v[132:135]
  ds_read_b64_tr_b16 a[176:177], v3 offset:36864
  v_fmac_f32 v88, v20, v28
  v_mfma_f32_16x16x32_bf16 v[132:135], a[164:167], a[100:103], v[132:135]
  buffer_load_dwordx4 a[4:7], v1, s[8:11], s73 offen offset:0 sc1
  v_fmac_f32 v89, v20, v29
  v_fmac_f32 v90, v20, v30
  v_mfma_f32_16x16x32_bf16 v[136:139], a[164:167], a[104:107], v[136:139]
  ds_read_b64_tr_b16 a[178:179], v3 offset:38912
  v_fmac_f32 v91, v20, v31
  v_mfma_f32_16x16x32_bf16 v[136:139], a[160:163], a[120:123], v[136:139]
  v_fmac_f32 v92, v22, v28
  v_fmac_f32 v93, v22, v29
  v_mfma_f32_16x16x32_bf16 v[140:143], a[160:163], a[124:127], v[140:143]
  ds_read_b64_tr_b16 a[160:161], v3 offset:40960
  v_fmac_f32 v94, v22, v30
  v_mfma_f32_16x16x32_bf16 v[140:143], a[164:167], a[108:111], v[140:143]
  s_waitcnt lgkmcnt(5)
  v_fmac_f32 v95, v22, v31
  v_mfma_f32_16x16x32_bf16 v[156:159], a[172:175], a[108:111], v[156:159]
  ds_read_b64_tr_b16 a[162:163], v3 offset:43008
  v_mfma_f32_16x16x32_bf16 v[156:159], a[168:171], a[124:127], v[156:159]
  buffer_load_dwordx4 a[20:23], v1, s[8:11], s73 offen offset:1024 sc1
  ds_read_b128 v[28:31], v12 offset:320
  v_mfma_f32_16x16x32_bf16 v[152:155], a[168:171], a[120:123], v[152:155]
  ds_read_b64_tr_b16 a[164:165], v3 offset:45056
  s_waitcnt lgkmcnt(9)
  v_mfma_f32_16x16x32_bf16 v[152:155], a[172:175], a[104:107], v[152:155]
  s_add_u32 s73, s73, 65536
  v_fmac_f32 v80, v17, v24
  v_fmac_f32 v81, v17, v25
  v_mfma_f32_16x16x32_bf16 v[148:151], a[172:175], a[100:103], v[148:151]
  ds_read_b64_tr_b16 a[166:167], v3 offset:47104
  v_fmac_f32 v82, v17, v26
  v_mfma_f32_16x16x32_bf16 v[148:151], a[168:171], a[116:119], v[148:151]
  buffer_load_dwordx4 a[8:11], v1, s[8:11], s73 offen offset:0 sc1
  v_fmac_f32 v83, v17, v27
  v_fmac_f32 v84, v19, v24
  v_mfma_f32_16x16x32_bf16 v[144:147], a[168:171], a[112:115], v[144:147]
  ds_read_b64_tr_b16 a[168:169], v4 offset:32768
  v_fmac_f32 v85, v19, v25
  v_mfma_f32_16x16x32_bf16 v[144:147], a[172:175], a[96:99], v[144:147]
  s_waitcnt lgkmcnt(6)
  v_fmac_f32 v86, v19, v26
  v_fmac_f32 v87, v19, v27
  v_mfma_f32_16x16x32_bf16 v[160:163], a[180:183], a[96:99], v[160:163]
  ds_read_b64_tr_b16 a[170:171], v4 offset:34816
  v_fmac_f32 v88, v21, v24
  v_mfma_f32_16x16x32_bf16 v[160:163], a[176:179], a[112:115], v[160:163]
  v_fmac_f32 v89, v21, v25
  v_fmac_f32 v90, v21, v26
  v_mfma_f32_16x16x32_bf16 v[164:167], a[176:179], a[116:119], v[164:167]
  ds_read_b64_tr_b16 a[172:173], v4 offset:36864
  v_fmac_f32 v91, v21, v27
  v_mfma_f32_16x16x32_bf16 v[164:167], a[180:183], a[100:103], v[164:167]
  buffer_load_dwordx4 a[24:27], v1, s[8:11], s73 offen offset:1024 sc1
  v_fmac_f32 v92, v23, v24
  v_fmac_f32 v93, v23, v25
  v_mfma_f32_16x16x32_bf16 v[168:171], a[180:183], a[104:107], v[168:171]
  ds_read_b64_tr_b16 a[174:175], v4 offset:38912
  v_fmac_f32 v94, v23, v26
  v_mfma_f32_16x16x32_bf16 v[168:171], a[176:179], a[120:123], v[168:171]
  s_add_u32 s73, s73, 65536
  v_fmac_f32 v95, v23, v27
  v_mfma_f32_16x16x32_bf16 v[172:175], a[176:179], a[124:127], v[172:175]
  ds_read_b64_tr_b16 a[176:177], v4 offset:40960
  v_mfma_f32_16x16x32_bf16 v[172:175], a[180:183], a[108:111], v[172:175]
  s_waitcnt lgkmcnt(5)
  buffer_load_dwordx4 a[12:15], v1, s[8:11], s73 offen offset:0 sc1
  v_mfma_f32_16x16x32_bf16 v[188:191], a[160:163], a[108:111], v[188:191]
  ds_read_b64_tr_b16 a[178:179], v4 offset:43008
  v_mfma_f32_16x16x32_bf16 v[188:191], a[164:167], a[124:127], v[188:191]
  ds_read_b128 v[24:27], v12 offset:1344
  s_waitcnt lgkmcnt(9)
  v_mfma_f32_16x16x32_bf16 v[184:187], a[164:167], a[120:123], v[184:187]
  ds_read_b64_tr_b16 a[180:181], v4 offset:45056
  v_fmac_f32 v96, v16, v28
  v_mfma_f32_16x16x32_bf16 v[184:187], a[160:163], a[104:107], v[184:187]
  v_fmac_f32 v97, v16, v29
  v_fmac_f32 v98, v16, v30
  v_mfma_f32_16x16x32_bf16 v[180:183], a[160:163], a[100:103], v[180:183]
  ds_read_b64_tr_b16 a[182:183], v4 offset:47104
  v_fmac_f32 v99, v16, v31
  v_mfma_f32_16x16x32_bf16 v[180:183], a[164:167], a[116:119], v[180:183]
  buffer_load_dwordx4 a[28:31], v1, s[8:11], s73 offen offset:1024 sc1
  v_fmac_f32 v100, v18, v28
  v_fmac_f32 v101, v18, v29
  v_mfma_f32_16x16x32_bf16 v[176:179], a[164:167], a[112:115], v[176:179]
  ds_read_b64_tr_b16 a[164:165], v5 offset:32768
  v_fmac_f32 v102, v18, v30
  v_mfma_f32_16x16x32_bf16 v[176:179], a[160:163], a[96:99], v[176:179]
  s_waitcnt lgkmcnt(6)
  v_fmac_f32 v103, v18, v31
  v_mfma_f32_16x16x32_bf16 v[192:195], a[168:171], a[96:99], v[192:195]
  ds_read_b64_tr_b16 a[166:167], v5 offset:34816
  v_fmac_f32 v104, v20, v28
  v_mfma_f32_16x16x32_bf16 v[192:195], a[172:175], a[112:115], v[192:195]
  buffer_load_dwordx4 a[32:35], v1, s[8:11], s74 offen offset:0 sc1
  v_fmac_f32 v105, v20, v29
  v_fmac_f32 v106, v20, v30
  v_mfma_f32_16x16x32_bf16 v[196:199], a[172:175], a[116:119], v[196:199]
  ds_read_b64_tr_b16 a[160:161], v5 offset:36864
  v_fmac_f32 v107, v20, v31
  v_mfma_f32_16x16x32_bf16 v[196:199], a[168:171], a[100:103], v[196:199]
  v_fmac_f32 v108, v22, v28
  v_fmac_f32 v109, v22, v29
  v_mfma_f32_16x16x32_bf16 v[200:203], a[168:171], a[104:107], v[200:203]
  ds_read_b64_tr_b16 a[162:163], v5 offset:38912
  v_fmac_f32 v110, v22, v30
  v_mfma_f32_16x16x32_bf16 v[200:203], a[172:175], a[120:123], v[200:203]
  v_fmac_f32 v111, v22, v31
  v_mfma_f32_16x16x32_bf16 v[204:207], a[172:175], a[124:127], v[204:207]
  ds_read_b64_tr_b16 a[172:173], v5 offset:40960
  v_mfma_f32_16x16x32_bf16 v[204:207], a[168:171], a[108:111], v[204:207]
  s_waitcnt lgkmcnt(5)
  buffer_load_dwordx4 a[48:51], v1, s[8:11], s74 offen offset:1024 sc1
  v_mfma_f32_16x16x32_bf16 v[220:223], a[176:179], a[108:111], v[220:223]
  ds_read_b64_tr_b16 a[174:175], v5 offset:43008
  v_mfma_f32_16x16x32_bf16 v[220:223], a[180:183], a[124:127], v[220:223]
  s_add_u32 s74, s74, 65536
  ds_read_b128 v[28:31], v12 offset:1856
  v_mfma_f32_16x16x32_bf16 v[216:219], a[180:183], a[120:123], v[216:219]
  ds_read_b64_tr_b16 a[168:169], v5 offset:45056
  s_waitcnt lgkmcnt(10)
  v_mfma_f32_16x16x32_bf16 v[216:219], a[176:179], a[104:107], v[216:219]
  buffer_load_dwordx4 a[36:39], v1, s[8:11], s74 offen offset:0 sc1
  v_fmac_f32 v112, v16, v24
  v_fmac_f32 v113, v16, v25
  v_mfma_f32_16x16x32_bf16 v[212:215], a[176:179], a[100:103], v[212:215]
  ds_read_b64_tr_b16 a[170:171], v5 offset:47104
  v_fmac_f32 v114, v16, v26
  v_mfma_f32_16x16x32_bf16 v[212:215], a[180:183], a[116:119], v[212:215]
  s_waitcnt vmcnt(31)
  s_barrier
  v_mfma_f32_16x16x32_bf16 v[208:211], a[180:183], a[112:115], v[208:211]
  ds_read_b64_tr_b16 a[180:181], v6 offset:49152
  v_fmac_f32 v115, v16, v27
  v_mfma_f32_16x16x32_bf16 v[208:211], a[176:179], a[96:99], v[208:211]
  s_waitcnt lgkmcnt(6)
  v_fmac_f32 v116, v18, v24
  v_fmac_f32 v117, v18, v25
  v_mfma_f32_16x16x32_bf16 v[224:227], a[164:167], a[96:99], v[224:227]
  ds_read_b64_tr_b16 a[182:183], v6 offset:51200
  v_fmac_f32 v118, v18, v26
  v_mfma_f32_16x16x32_bf16 v[224:227], a[160:163], a[112:115], v[224:227]
  buffer_load_dwordx4 a[52:55], v1, s[8:11], s74 offen offset:1024 sc1
  v_fmac_f32 v119, v18, v27
  v_fmac_f32 v120, v20, v24
  v_mfma_f32_16x16x32_bf16 v[228:231], a[160:163], a[116:119], v[228:231]
  ds_read_b64_tr_b16 a[176:177], v6 offset:53248
  v_fmac_f32 v121, v20, v25
  v_mfma_f32_16x16x32_bf16 v[228:231], a[164:167], a[100:103], v[228:231]
  s_add_u32 s74, s74, 65536
  v_fmac_f32 v122, v20, v26
  v_fmac_f32 v123, v20, v27
  v_mfma_f32_16x16x32_bf16 v[232:235], a[164:167], a[104:107], v[232:235]
  ds_read_b64_tr_b16 a[178:179], v6 offset:55296
  v_fmac_f32 v124, v22, v24
  v_mfma_f32_16x16x32_bf16 v[232:235], a[160:163], a[120:123], v[232:235]
  buffer_load_dwordx4 a[40:43], v1, s[8:11], s74 offen offset:0 sc1
  v_fmac_f32 v125, v22, v25
  v_fmac_f32 v126, v22, v26
  v_mfma_f32_16x16x32_bf16 v[236:239], a[160:163], a[124:127], v[236:239]
  ds_read_b64_tr_b16 a[160:161], v6 offset:57344
  v_fmac_f32 v127, v22, v27
  v_mfma_f32_16x16x32_bf16 v[236:239], a[164:167], a[108:111], v[236:239]
  s_waitcnt lgkmcnt(5)
  ds_read_b128 v[24:27], v12 offset:1024
  v_mfma_f32_16x16x32_bf16 v[252:255], a[172:175], a[108:111], v[252:255]
  ds_read_b64_tr_b16 a[162:163], v6 offset:59392
  s_waitcnt lgkmcnt(9)
  v_mfma_f32_16x16x32_bf16 v[252:255], a[168:171], a[124:127], v[252:255]
  v_fmac_f32 v112, v17, v28
  v_fmac_f32 v113, v17, v29
  v_mfma_f32_16x16x32_bf16 v[248:251], a[168:171], a[120:123], v[248:251]
  ds_read_b64_tr_b16 a[164:165], v6 offset:61440
  v_fmac_f32 v114, v17, v30
  v_mfma_f32_16x16x32_bf16 v[248:251], a[172:175], a[104:107], v[248:251]
  buffer_load_dwordx4 a[56:59], v1, s[8:11], s74 offen offset:1024 sc1
  v_fmac_f32 v115, v17, v31
  v_fmac_f32 v116, v19, v28
  v_mfma_f32_16x16x32_bf16 v[244:247], a[172:175], a[100:103], v[244:247]
  ds_read_b64_tr_b16 a[166:167], v6 offset:63488
  v_fmac_f32 v117, v19, v29
  v_mfma_f32_16x16x32_bf16 v[244:247], a[168:171], a[116:119], v[244:247]
  s_add_u32 s74, s74, 65536
  v_fmac_f32 v118, v19, v30
  v_fmac_f32 v119, v19, v31
  v_mfma_f32_16x16x32_bf16 v[240:243], a[168:171], a[112:115], v[240:243]
  ds_read_b64_tr_b16 a[168:169], v7 offset:49152
  v_fmac_f32 v120, v21, v28
  v_mfma_f32_16x16x32_bf16 v[240:243], a[172:175], a[96:99], v[240:243]
  s_waitcnt vmcnt(26) lgkmcnt(6)
  buffer_load_dwordx4 a[44:47], v1, s[8:11], s74 offen offset:0 sc1
  v_fmac_f32 v121, v21, v29
  v_mfma_f32_16x16x32_bf16 v[64:67], a[180:183], a[128:131], v[64:67]
  ds_read_b64_tr_b16 a[170:171], v7 offset:51200
  v_fmac_f32 v122, v21, v30
  v_mfma_f32_16x16x32_bf16 v[64:67], a[176:179], a[144:147], v[64:67]
  v_fmac_f32 v123, v21, v31
  v_fmac_f32 v124, v23, v28
  v_mfma_f32_16x16x32_bf16 v[68:71], a[176:179], a[148:151], v[68:71]
  ds_read_b64_tr_b16 a[172:173], v7 offset:53248
  v_fmac_f32 v125, v23, v29
  v_mfma_f32_16x16x32_bf16 v[68:71], a[180:183], a[132:135], v[68:71]
  v_fmac_f32 v126, v23, v30
  v_fmac_f32 v127, v23, v31
  v_mfma_f32_16x16x32_bf16 v[72:75], a[180:183], a[136:139], v[72:75]
  ds_read_b64_tr_b16 a[174:175], v7 offset:55296
  v_mfma_f32_16x16x32_bf16 v[72:75], a[176:179], a[152:155], v[72:75]
  buffer_load_dwordx4 a[60:63], v1, s[8:11], s74 offen offset:1024 sc1
  ds_read_b128 v[28:31], v12 offset:1536
  v_mfma_f32_16x16x32_bf16 v[76:79], a[176:179], a[156:159], v[76:79]
  ds_read_b64_tr_b16 a[176:177], v7 offset:57344
  s_waitcnt lgkmcnt(9)
  v_mfma_f32_16x16x32_bf16 v[76:79], a[180:183], a[140:143], v[76:79]
  s_waitcnt lgkmcnt(6)
  s_mov_b32 s67, 5505024
  s_add_u32 s75, s24, 24576
  s_add_u32 m0, s45, 98304
  v_fmac_f32 v144, v16, v24
  v_mfma_f32_16x16x32_bf16 v[92:95], a[160:163], a[140:143], v[92:95]
  ds_read_b64_tr_b16 a[178:179], v7 offset:59392
  v_fmac_f32 v145, v16, v25
  v_mfma_f32_16x16x32_bf16 v[92:95], a[164:167], a[156:159], v[92:95]
  buffer_load_dwordx4 v11, s[28:31], s67 offen lds
  v_fmac_f32 v146, v16, v26
  v_fmac_f32 v147, v16, v27
  v_mfma_f32_16x16x32_bf16 v[88:91], a[164:167], a[152:155], v[88:91]
  ds_read_b64_tr_b16 a[180:181], v7 offset:61440
  v_fmac_f32 v148, v18, v24
  v_mfma_f32_16x16x32_bf16 v[88:91], a[160:163], a[136:139], v[88:91]
  v_fmac_f32 v149, v18, v25
  v_fmac_f32 v150, v18, v26
  v_mfma_f32_16x16x32_bf16 v[84:87], a[160:163], a[132:135], v[84:87]
  ds_read_b64_tr_b16 a[182:183], v7 offset:63488
  v_fmac_f32 v151, v18, v27
  v_mfma_f32_16x16x32_bf16 v[84:87], a[164:167], a[148:151], v[84:87]
  s_add_u32 m0, s45, 106496
  v_fmac_f32 v152, v20, v24
  v_fmac_f32 v153, v20, v25
  v_mfma_f32_16x16x32_bf16 v[80:83], a[164:167], a[144:147], v[80:83]
  ds_read_b64_tr_b16 a[164:165], v8 offset:49152
  v_fmac_f32 v154, v20, v26
  v_mfma_f32_16x16x32_bf16 v[80:83], a[160:163], a[128:131], v[80:83]
  s_waitcnt lgkmcnt(6)
  buffer_load_dwordx4 v11, s[32:35], s67 offen lds
  v_fmac_f32 v155, v20, v27
  v_mfma_f32_16x16x32_bf16 v[96:99], a[168:171], a[128:131], v[96:99]
  ds_read_b64_tr_b16 a[166:167], v8 offset:51200
  v_fmac_f32 v156, v22, v24
  v_mfma_f32_16x16x32_bf16 v[96:99], a[172:175], a[144:147], v[96:99]
  s_add_u32 m0, s45, 102400
  s_add_u32 s60, s67, 229376
  v_fmac_f32 v157, v22, v25
  v_mfma_f32_16x16x32_bf16 v[100:103], a[172:175], a[148:151], v[100:103]
  ds_read_b64_tr_b16 a[160:161], v8 offset:53248
  v_fmac_f32 v158, v22, v26
  v_mfma_f32_16x16x32_bf16 v[100:103], a[168:171], a[132:135], v[100:103]
  buffer_load_dwordx4 v11, s[28:31], s60 offen lds
  v_fmac_f32 v159, v22, v27
  v_mfma_f32_16x16x32_bf16 v[104:107], a[168:171], a[136:139], v[104:107]
  ds_read_b64_tr_b16 a[162:163], v8 offset:55296
  v_mfma_f32_16x16x32_bf16 v[104:107], a[172:175], a[152:155], v[104:107]
  ds_read_b128 v[24:27], v12 offset:64
  s_waitcnt lgkmcnt(9)
  v_mfma_f32_16x16x32_bf16 v[108:111], a[172:175], a[156:159], v[108:111]
  ds_read_b64_tr_b16 a[172:173], v8 offset:57344
  v_fmac_f32 v144, v17, v28
  v_mfma_f32_16x16x32_bf16 v[108:111], a[168:171], a[140:143], v[108:111]
  s_waitcnt lgkmcnt(6)
  s_add_u32 m0, s45, 110592
  s_add_u32 s60, s67, 229376
  v_mfma_f32_16x16x32_bf16 v[124:127], a[176:179], a[140:143], v[124:127]
  ds_read_b64_tr_b16 a[174:175], v8 offset:59392
  v_fmac_f32 v145, v17, v29
  v_mfma_f32_16x16x32_bf16 v[124:127], a[180:183], a[156:159], v[124:127]
  buffer_load_dwordx4 v11, s[32:35], s60 offen lds
  v_fmac_f32 v146, v17, v30
  v_fmac_f32 v147, v17, v31
  v_mfma_f32_16x16x32_bf16 v[120:123], a[180:183], a[152:155], v[120:123]
  ds_read_b64_tr_b16 a[168:169], v8 offset:61440
  v_fmac_f32 v148, v19, v28
  v_mfma_f32_16x16x32_bf16 v[120:123], a[176:179], a[136:139], v[120:123]
  s_add_u32 s61, s91, 0
  v_fmac_f32 v149, v19, v29
  v_fmac_f32 v150, v19, v30
  v_mfma_f32_16x16x32_bf16 v[116:119], a[176:179], a[132:135], v[116:119]
  ds_read_b64_tr_b16 a[170:171], v8 offset:63488
  v_fmac_f32 v151, v19, v31
  v_mfma_f32_16x16x32_bf16 v[116:119], a[180:183], a[148:151], v[116:119]
  buffer_load_dword a253, v13, s[36:39], s61 offen
  v_fmac_f32 v152, v21, v28
  v_fmac_f32 v153, v21, v29
  v_mfma_f32_16x16x32_bf16 v[112:115], a[180:183], a[144:147], v[112:115]
  ds_read_b64_tr_b16 a[180:181], v2 offset:49152
  v_fmac_f32 v154, v21, v30
  v_mfma_f32_16x16x32_bf16 v[112:115], a[176:179], a[128:131], v[112:115]
  s_waitcnt lgkmcnt(6)
  v_fmac_f32 v155, v21, v31
  v_fmac_f32 v156, v23, v28
  v_mfma_f32_16x16x32_bf16 v[32:35], a[164:167], a[128:131], v[32:35]
  ds_read_b64_tr_b16 a[182:183], v2 offset:51200
  v_fmac_f32 v157, v23, v29
  v_mfma_f32_16x16x32_bf16 v[32:35], a[160:163], a[144:147], v[32:35]
  v_fmac_f32 v158, v23, v30
  v_fmac_f32 v159, v23, v31
  v_mfma_f32_16x16x32_bf16 v[36:39], a[160:163], a[148:151], v[36:39]
  ds_read_b64_tr_b16 a[176:177], v2 offset:53248
  v_mfma_f32_16x16x32_bf16 v[36:39], a[164:167], a[132:135], v[36:39]
  ds_read_b128 v[28:31], v12 offset:1088
  s_waitcnt lgkmcnt(8)
  v_mfma_f32_16x16x32_bf16 v[40:43], a[164:167], a[136:139], v[40:43]
  ds_read_b64_tr_b16 a[178:179], v2 offset:55296
  v_fmac_f32 v160, v16, v24
  v_mfma_f32_16x16x32_bf16 v[40:43], a[160:163], a[152:155], v[40:43]
  v_fmac_f32 v161, v16, v25
  v_fmac_f32 v162, v16, v26
  v_mfma_f32_16x16x32_bf16 v[44:47], a[160:163], a[156:159], v[44:47]
  ds_read_b64_tr_b16 a[160:161], v2 offset:57344
  v_fmac_f32 v163, v16, v27
  v_mfma_f32_16x16x32_bf16 v[44:47], a[164:167], a[140:143], v[44:47]
  s_waitcnt lgkmcnt(6)
  buffer_load_dwordx4 a[64:67], v1, s[8:11], s75 offen offset:0 sc1
  v_fmac_f32 v164, v18, v24
  v_mfma_f32_16x16x32_bf16 v[60:63], a[172:175], a[140:143], v[60:63]
  ds_read_b64_tr_b16 a[162:163], v2 offset:59392
  v_fmac_f32 v165, v18, v25
  v_mfma_f32_16x16x32_bf16 v[60:63], a[168:171], a[156:159], v[60:63]
  v_fmac_f32 v166, v18, v26
  v_fmac_f32 v167, v18, v27
  v_mfma_f32_16x16x32_bf16 v[56:59], a[168:171], a[152:155], v[56:59]
  ds_read_b64_tr_b16 a[164:165], v2 offset:61440
  v_fmac_f32 v168, v20, v24
  v_mfma_f32_16x16x32_bf16 v[56:59], a[172:175], a[136:139], v[56:59]
  v_fmac_f32 v169, v20, v25
  v_fmac_f32 v170, v20, v26
  v_mfma_f32_16x16x32_bf16 v[52:55], a[172:175], a[132:135], v[52:55]
  ds_read_b64_tr_b16 a[166:167], v2 offset:63488
  v_fmac_f32 v171, v20, v27
  v_mfma_f32_16x16x32_bf16 v[52:55], a[168:171], a[148:151], v[52:55]
  buffer_load_dwordx4 a[80:83], v1, s[8:11], s75 offen offset:1024 sc1
  v_fmac_f32 v172, v22, v24
  v_fmac_f32 v173, v22, v25
  v_mfma_f32_16x16x32_bf16 v[48:51], a[168:171], a[144:147], v[48:51]
  ds_read_b64_tr_b16 a[168:169], v3 offset:49152
  v_fmac_f32 v174, v22, v26
  v_mfma_f32_16x16x32_bf16 v[48:51], a[172:175], a[128:131], v[48:51]
  s_waitcnt lgkmcnt(5)
  s_add_u32 s75, s75, 65536
  v_fmac_f32 v175, v22, v27
  v_mfma_f32_16x16x32_bf16 v[128:131], a[180:183], a[128:131], v[128:131]
  ds_read_b64_tr_b16 a[170:171], v3 offset:51200
  v_mfma_f32_16x16x32_bf16 v[128:131], a[176:179], a[144:147], v[128:131]
  buffer_load_dwordx4 a[68:71], v1, s[8:11], s75 offen offset:0 sc1
  ds_read_b128 v[24:27], v12 offset:1152
  v_mfma_f32_16x16x32_bf16 v[132:135], a[176:179], a[148:151], v[132:135]
  ds_read_b64_tr_b16 a[172:173], v3 offset:53248
  s_waitcnt lgkmcnt(9)
  v_mfma_f32_16x16x32_bf16 v[132:135], a[180:183], a[132:135], v[132:135]
  v_fmac_f32 v176, v16, v28
  v_fmac_f32 v177, v16, v29
  v_mfma_f32_16x16x32_bf16 v[136:139], a[180:183], a[136:139], v[136:139]
  ds_read_b64_tr_b16 a[174:175], v3 offset:55296
  v_fmac_f32 v178, v16, v30
  v_mfma_f32_16x16x32_bf16 v[136:139], a[176:179], a[152:155], v[136:139]
  v_fmac_f32 v179, v16, v31
  v_fmac_f32 v180, v18, v28
  v_mfma_f32_16x16x32_bf16 v[140:143], a[176:179], a[156:159], v[140:143]
  ds_read_b64_tr_b16 a[176:177], v3 offset:57344
  v_fmac_f32 v181, v18, v29
  v_mfma_f32_16x16x32_bf16 v[140:143], a[180:183], a[140:143], v[140:143]
  s_waitcnt lgkmcnt(6)
  buffer_load_dwordx4 a[84:87], v1, s[8:11], s75 offen offset:1024 sc1
  v_fmac_f32 v182, v18, v30
  v_mfma_f32_16x16x32_bf16 v[156:159], a[160:163], a[140:143], v[156:159]
  ds_read_b64_tr_b16 a[178:179], v3 offset:59392
  v_fmac_f32 v183, v18, v31
  v_mfma_f32_16x16x32_bf16 v[156:159], a[164:167], a[156:159], v[156:159]
  s_add_u32 s75, s75, 65536
  v_fmac_f32 v184, v20, v28
  v_fmac_f32 v185, v20, v29
  v_mfma_f32_16x16x32_bf16 v[152:155], a[164:167], a[152:155], v[152:155]
  ds_read_b64_tr_b16 a[180:181], v3 offset:61440
  v_fmac_f32 v186, v20, v30
  v_mfma_f32_16x16x32_bf16 v[152:155], a[160:163], a[136:139], v[152:155]
  buffer_load_dwordx4 a[72:75], v1, s[8:11], s75 offen offset:0 sc1
  v_fmac_f32 v187, v20, v31
  v_fmac_f32 v188, v22, v28
  v_mfma_f32_16x16x32_bf16 v[148:151], a[160:163], a[132:135], v[148:151]
  ds_read_b64_tr_b16 a[182:183], v3 offset:63488
  v_fmac_f32 v189, v22, v29
  v_mfma_f32_16x16x32_bf16 v[148:151], a[164:167], a[148:151], v[148:151]
  v_fmac_f32 v190, v22, v30
  v_fmac_f32 v191, v22, v31
  v_mfma_f32_16x16x32_bf16 v[144:147], a[164:167], a[144:147], v[144:147]
  ds_read_b64_tr_b16 a[164:165], v4 offset:49152
  v_mfma_f32_16x16x32_bf16 v[144:147], a[160:163], a[128:131], v[144:147]
  s_waitcnt lgkmcnt(5)
  ds_read_b128 v[28:31], v12 offset:192
  v_mfma_f32_16x16x32_bf16 v[160:163], a[168:171], a[128:131], v[160:163]
  ds_read_b64_tr_b16 a[166:167], v4 offset:51200
  s_waitcnt lgkmcnt(9)
  v_mfma_f32_16x16x32_bf16 v[160:163], a[172:175], a[144:147], v[160:163]
  buffer_load_dwordx4 a[88:91], v1, s[8:11], s75 offen offset:1024 sc1
  v_fmac_f32 v208, v16, v24
  v_fmac_f32 v209, v16, v25
  v_mfma_f32_16x16x32_bf16 v[164:167], a[172:175], a[148:151], v[164:167]
  ds_read_b64_tr_b16 a[160:161], v4 offset:53248
  v_fmac_f32 v210, v16, v26
  v_mfma_f32_16x16x32_bf16 v[164:167], a[168:171], a[132:135], v[164:167]
  s_add_u32 s75, s75, 65536
  v_fmac_f32 v211, v16, v27
  v_fmac_f32 v212, v18, v24
  v_mfma_f32_16x16x32_bf16 v[168:171], a[168:171], a[136:139], v[168:171]
  ds_read_b64_tr_b16 a[162:163], v4 offset:55296
  v_fmac_f32 v213, v18, v25
  v_mfma_f32_16x16x32_bf16 v[168:171], a[172:175], a[152:155], v[168:171]
  buffer_load_dwordx4 a[76:79], v1, s[8:11], s75 offen offset:0 sc1
  v_fmac_f32 v214, v18, v26
  v_fmac_f32 v215, v18, v27
  v_mfma_f32_16x16x32_bf16 v[172:175], a[172:175], a[156:159], v[172:175]
  ds_read_b64_tr_b16 a[172:173], v4 offset:57344
  v_fmac_f32 v216, v20, v24
HOP12:
  s_cbranch_execz HOP16
  v_mfma_f32_16x16x32_bf16 v[172:175], a[168:171], a[140:143], v[172:175]
  s_waitcnt lgkmcnt(6)
  v_fmac_f32 v217, v20, v25
  v_fmac_f32 v218, v20, v26
  v_mfma_f32_16x16x32_bf16 v[188:191], a[176:179], a[140:143], v[188:191]
  ds_read_b64_tr_b16 a[174:175], v4 offset:59392
  v_fmac_f32 v219, v20, v27
  v_mfma_f32_16x16x32_bf16 v[188:191], a[180:183], a[156:159], v[188:191]
  v_fmac_f32 v220, v22, v24
  v_fmac_f32 v221, v22, v25
  v_mfma_f32_16x16x32_bf16 v[184:187], a[180:183], a[152:155], v[184:187]
  ds_read_b64_tr_b16 a[168:169], v4 offset:61440
  v_fmac_f32 v222, v22, v26
  v_mfma_f32_16x16x32_bf16 v[184:187], a[176:179], a[136:139], v[184:187]
  buffer_load_dwordx4 a[92:95], v1, s[8:11], s75 offen offset:1024 sc1
  v_fmac_f32 v223, v22, v27
  v_mfma_f32_16x16x32_bf16 v[180:183], a[176:179], a[132:135], v[180:183]
  ds_read_b64_tr_b16 a[170:171], v4 offset:63488
  v_mfma_f32_16x16x32_bf16 v[180:183], a[180:183], a[148:151], v[180:183]
  s_mov_b32 s68, 5963776
  s_add_u32 s76, s24, 26624
  ds_read_b128 v[24:27], v12 offset:1600
  v_mfma_f32_16x16x32_bf16 v[176:179], a[180:183], a[144:147], v[176:179]
  ds_read_b64_tr_b16 a[180:181], v5 offset:49152
  s_waitcnt lgkmcnt(9)
  v_mfma_f32_16x16x32_bf16 v[176:179], a[176:179], a[128:131], v[176:179]
  s_waitcnt lgkmcnt(6)
  buffer_load_dwordx4 a[96:99], v1, s[8:11], s76 offen offset:0 sc1
  v_fmac_f32 v224, v16, v28
  v_mfma_f32_16x16x32_bf16 v[192:195], a[164:167], a[128:131], v[192:195]
  ds_read_b64_tr_b16 a[182:183], v5 offset:51200
  v_fmac_f32 v225, v16, v29
  v_mfma_f32_16x16x32_bf16 v[192:195], a[160:163], a[144:147], v[192:195]
  v_fmac_f32 v226, v16, v30
  v_fmac_f32 v227, v16, v31
  v_mfma_f32_16x16x32_bf16 v[196:199], a[160:163], a[148:151], v[196:199]
  ds_read_b64_tr_b16 a[176:177], v5 offset:53248
  v_fmac_f32 v228, v18, v28
  v_mfma_f32_16x16x32_bf16 v[196:199], a[164:167], a[132:135], v[196:199]
  v_fmac_f32 v229, v18, v29
  v_fmac_f32 v230, v18, v30
  v_mfma_f32_16x16x32_bf16 v[200:203], a[164:167], a[136:139], v[200:203]
  ds_read_b64_tr_b16 a[178:179], v5 offset:55296
  v_fmac_f32 v231, v18, v31
  v_mfma_f32_16x16x32_bf16 v[200:203], a[160:163], a[152:155], v[200:203]
  buffer_load_dwordx4 a[112:115], v1, s[8:11], s76 offen offset:1024 sc1
  v_fmac_f32 v232, v20, v28
  v_fmac_f32 v233, v20, v29
  v_mfma_f32_16x16x32_bf16 v[204:207], a[160:163], a[156:159], v[204:207]
  ds_read_b64_tr_b16 a[160:161], v5 offset:57344
  v_fmac_f32 v234, v20, v30
  v_mfma_f32_16x16x32_bf16 v[204:207], a[164:167], a[140:143], v[204:207]
  s_waitcnt lgkmcnt(6)
  s_add_u32 s76, s76, 65536
  v_fmac_f32 v235, v20, v31
  v_mfma_f32_16x16x32_bf16 v[220:223], a[172:175], a[140:143], v[220:223]
  ds_read_b64_tr_b16 a[162:163], v5 offset:59392
  v_fmac_f32 v236, v22, v28
  v_mfma_f32_16x16x32_bf16 v[220:223], a[168:171], a[156:159], v[220:223]
  buffer_load_dwordx4 a[100:103], v1, s[8:11], s76 offen offset:0 sc1
  v_fmac_f32 v237, v22, v29
  v_fmac_f32 v238, v22, v30
  v_mfma_f32_16x16x32_bf16 v[216:219], a[168:171], a[152:155], v[216:219]
  ds_read_b64_tr_b16 a[164:165], v5 offset:61440
  v_fmac_f32 v239, v22, v31
  v_mfma_f32_16x16x32_bf16 v[216:219], a[172:175], a[136:139], v[216:219]
  ds_read_b128 v[28:31], v12 offset:128
  s_waitcnt lgkmcnt(8)
  v_mfma_f32_16x16x32_bf16 v[212:215], a[172:175], a[132:135], v[212:215]
  ds_read_b64_tr_b16 a[166:167], v5 offset:63488
  v_fmac_f32 v176, v17, v24
  v_mfma_f32_16x16x32_bf16 v[212:215], a[168:171], a[148:151], v[212:215]
  s_waitcnt vmcnt(32)
  s_barrier
  v_mfma_f32_16x16x32_bf16 v[208:211], a[168:171], a[144:147], v[208:211]
  ds_read_b64_tr_b16 a[168:169], v6 offset:16384
  s_add_u32 s61, s91, 2048
  v_mfma_f32_16x16x32_bf16 v[208:211], a[172:175], a[128:131], v[208:211]
  s_waitcnt lgkmcnt(6)
  buffer_load_dword a253, v13, s[36:39], s61 offen
  v_fmac_f32 v177, v17, v25
  v_mfma_f32_16x16x32_bf16 v[224:227], a[180:183], a[128:131], v[224:227]
  ds_read_b64_tr_b16 a[170:171], v6 offset:18432
  v_fmac_f32 v178, v17, v26
  v_mfma_f32_16x16x32_bf16 v[224:227], a[176:179], a[144:147], v[224:227]
  v_fmac_f32 v179, v17, v27
  v_fmac_f32 v180, v19, v24
  v_mfma_f32_16x16x32_bf16 v[228:231], a[176:179], a[148:151], v[228:231]
  ds_read_b64_tr_b16 a[172:173], v6 offset:20480
  v_fmac_f32 v181, v19, v25
  v_mfma_f32_16x16x32_bf16 v[228:231], a[180:183], a[132:135], v[228:231]
  v_fmac_f32 v182, v19, v26
  v_fmac_f32 v183, v19, v27
  v_mfma_f32_16x16x32_bf16 v[232:235], a[180:183], a[136:139], v[232:235]
  ds_read_b64_tr_b16 a[174:175], v6 offset:22528
  v_fmac_f32 v184, v21, v24
  v_mfma_f32_16x16x32_bf16 v[232:235], a[176:179], a[152:155], v[232:235]
  v_fmac_f32 v185, v21, v25
  v_fmac_f32 v186, v21, v26
  v_mfma_f32_16x16x32_bf16 v[236:239], a[176:179], a[156:159], v[236:239]
  ds_read_b64_tr_b16 a[176:177], v6 offset:24576
  v_fmac_f32 v187, v21, v27
  v_mfma_f32_16x16x32_bf16 v[236:239], a[180:183], a[140:143], v[236:239]
  s_waitcnt lgkmcnt(5)
  s_add_u32 m0, s45, 114688
  v_fmac_f32 v188, v23, v24
  v_mfma_f32_16x16x32_bf16 v[252:255], a[160:163], a[140:143], v[252:255]
  ds_read_b64_tr_b16 a[178:179], v6 offset:26624
  v_fmac_f32 v189, v23, v25
  v_mfma_f32_16x16x32_bf16 v[252:255], a[164:167], a[156:159], v[252:255]
  buffer_load_dwordx4 v11, s[28:31], s68 offen lds
  v_fmac_f32 v190, v23, v26
  v_fmac_f32 v191, v23, v27
  v_mfma_f32_16x16x32_bf16 v[248:251], a[164:167], a[152:155], v[248:251]
  ds_read_b64_tr_b16 a[180:181], v6 offset:28672
  v_mfma_f32_16x16x32_bf16 v[248:251], a[160:163], a[136:139], v[248:251]
  s_add_u32 m0, s45, 122880
  ds_read_b128 v[24:27], v12 offset:1664
  v_mfma_f32_16x16x32_bf16 v[244:247], a[160:163], a[132:135], v[244:247]
  ds_read_b64_tr_b16 a[182:183], v6 offset:30720
  s_waitcnt lgkmcnt(10)
  v_mfma_f32_16x16x32_bf16 v[244:247], a[164:167], a[148:151], v[244:247]
  buffer_load_dwordx4 v11, s[32:35], s68 offen lds
  v_fmac_f32 v192, v16, v28
  v_fmac_f32 v193, v16, v29
  v_mfma_f32_16x16x32_bf16 v[240:243], a[164:167], a[144:147], v[240:243]
  ds_read_b64_tr_b16 a[164:165], v7 offset:16384
  v_fmac_f32 v194, v16, v30
  v_mfma_f32_16x16x32_bf16 v[240:243], a[160:163], a[128:131], v[240:243]
  s_waitcnt vmcnt(27) lgkmcnt(6)
  v_fmac_f32 v195, v16, v31
  v_fmac_f32 v196, v18, v28
  v_mfma_f32_16x16x32_bf16 v[64:67], a[168:171], a[0:3], v[64:67]
  ds_read_b64_tr_b16 a[166:167], v7 offset:18432
  v_fmac_f32 v197, v18, v29
  v_mfma_f32_16x16x32_bf16 v[64:67], a[172:175], a[16:19], v[64:67]
  s_add_u32 m0, s45, 118784
  s_add_u32 s60, s68, 229376
  v_fmac_f32 v198, v18, v30
  v_mfma_f32_16x16x32_bf16 v[68:71], a[172:175], a[20:23], v[68:71]
  ds_read_b64_tr_b16 a[160:161], v7 offset:20480
  v_fmac_f32 v199, v18, v31
  v_mfma_f32_16x16x32_bf16 v[68:71], a[168:171], a[4:7], v[68:71]
  buffer_load_dwordx4 v11, s[28:31], s60 offen lds
  v_fmac_f32 v200, v20, v28
  v_fmac_f32 v201, v20, v29
  v_mfma_f32_16x16x32_bf16 v[72:75], a[168:171], a[8:11], v[72:75]
  ds_read_b64_tr_b16 a[162:163], v7 offset:22528
  v_fmac_f32 v202, v20, v30
  v_mfma_f32_16x16x32_bf16 v[72:75], a[172:175], a[24:27], v[72:75]
  s_add_u32 m0, s45, 126976
  s_add_u32 s60, s68, 229376
  v_fmac_f32 v203, v20, v31
  v_mfma_f32_16x16x32_bf16 v[76:79], a[172:175], a[28:31], v[76:79]
  ds_read_b64_tr_b16 a[172:173], v7 offset:24576
  v_fmac_f32 v204, v22, v28
  v_mfma_f32_16x16x32_bf16 v[76:79], a[168:171], a[12:15], v[76:79]
  s_waitcnt lgkmcnt(5)
  buffer_load_dwordx4 v11, s[32:35], s60 offen lds
  v_fmac_f32 v205, v22, v29
  v_mfma_f32_16x16x32_bf16 v[92:95], a[176:179], a[12:15], v[92:95]
  ds_read_b64_tr_b16 a[174:175], v7 offset:26624
  v_fmac_f32 v206, v22, v30
  v_mfma_f32_16x16x32_bf16 v[92:95], a[180:183], a[28:31], v[92:95]
  v_fmac_f32 v207, v22, v31
  v_mfma_f32_16x16x32_bf16 v[88:91], a[180:183], a[24:27], v[88:91]
  ds_read_b64_tr_b16 a[168:169], v7 offset:28672
  v_mfma_f32_16x16x32_bf16 v[88:91], a[176:179], a[8:11], v[88:91]
  ds_read_b128 v[28:31], v12 offset:1216
  s_waitcnt lgkmcnt(9)
  v_mfma_f32_16x16x32_bf16 v[84:87], a[176:179], a[4:7], v[84:87]
  ds_read_b64_tr_b16 a[170:171], v7 offset:30720
  v_fmac_f32 v208, v17, v24
  v_mfma_f32_16x16x32_bf16 v[84:87], a[180:183], a[20:23], v[84:87]
  buffer_load_dwordx4 a[116:119], v1, s[8:11], s76 offen offset:1024 sc1
  v_fmac_f32 v209, v17, v25
  v_fmac_f32 v210, v17, v26
  v_mfma_f32_16x16x32_bf16 v[80:83], a[180:183], a[16:19], v[80:83]
  ds_read_b64_tr_b16 a[180:181], v8 offset:16384
  v_fmac_f32 v211, v17, v27
  v_mfma_f32_16x16x32_bf16 v[80:83], a[176:179], a[0:3], v[80:83]
  s_waitcnt lgkmcnt(6)
  s_add_u32 s76, s76, 65536
  v_fmac_f32 v212, v19, v24
  v_mfma_f32_16x16x32_bf16 v[96:99], a[164:167], a[0:3], v[96:99]
  ds_read_b64_tr_b16 a[182:183], v8 offset:18432
  v_fmac_f32 v213, v19, v25
  v_mfma_f32_16x16x32_bf16 v[96:99], a[160:163], a[16:19], v[96:99]
  buffer_load_dwordx4 a[104:107], v1, s[8:11], s76 offen offset:0 sc1
  v_fmac_f32 v214, v19, v26
  v_fmac_f32 v215, v19, v27
  v_mfma_f32_16x16x32_bf16 v[100:103], a[160:163], a[20:23], v[100:103]
  ds_read_b64_tr_b16 a[176:177], v8 offset:20480
  v_fmac_f32 v216, v21, v24
  v_mfma_f32_16x16x32_bf16 v[100:103], a[164:167], a[4:7], v[100:103]
  v_fmac_f32 v217, v21, v25
  v_fmac_f32 v218, v21, v26
  v_mfma_f32_16x16x32_bf16 v[104:107], a[164:167], a[8:11], v[104:107]
  ds_read_b64_tr_b16 a[178:179], v8 offset:22528
  v_fmac_f32 v219, v21, v27
  v_mfma_f32_16x16x32_bf16 v[104:107], a[160:163], a[24:27], v[104:107]
  v_fmac_f32 v220, v23, v24
  v_fmac_f32 v221, v23, v25
  v_mfma_f32_16x16x32_bf16 v[108:111], a[160:163], a[28:31], v[108:111]
  ds_read_b64_tr_b16 a[160:161], v8 offset:24576
  v_fmac_f32 v222, v23, v26
  v_mfma_f32_16x16x32_bf16 v[108:111], a[164:167], a[12:15], v[108:111]
  s_waitcnt lgkmcnt(5)
  buffer_load_dwordx4 a[120:123], v1, s[8:11], s76 offen offset:1024 sc1
  v_fmac_f32 v223, v23, v27
  v_mfma_f32_16x16x32_bf16 v[124:127], a[172:175], a[12:15], v[124:127]
  ds_read_b64_tr_b16 a[162:163], v8 offset:26624
  v_mfma_f32_16x16x32_bf16 v[124:127], a[168:171], a[28:31], v[124:127]
  s_add_u32 s76, s76, 65536
  ds_read_b128 v[24:27], v12 offset:1728
  v_mfma_f32_16x16x32_bf16 v[120:123], a[168:171], a[24:27], v[120:123]
  ds_read_b64_tr_b16 a[164:165], v8 offset:28672
  s_waitcnt lgkmcnt(9)
  v_mfma_f32_16x16x32_bf16 v[120:123], a[172:175], a[8:11], v[120:123]
  buffer_load_dwordx4 a[108:111], v1, s[8:11], s76 offen offset:0 sc1
  v_fmac_f32 v240, v16, v28
  v_fmac_f32 v241, v16, v29
  v_mfma_f32_16x16x32_bf16 v[116:119], a[172:175], a[4:7], v[116:119]
  ds_read_b64_tr_b16 a[166:167], v8 offset:30720
  v_fmac_f32 v242, v16, v30
  v_mfma_f32_16x16x32_bf16 v[116:119], a[168:171], a[20:23], v[116:119]
  v_fmac_f32 v243, v16, v31
  v_fmac_f32 v244, v18, v28
  v_mfma_f32_16x16x32_bf16 v[112:115], a[168:171], a[16:19], v[112:115]
  ds_read_b64_tr_b16 a[168:169], v6 offset:0
  v_fmac_f32 v245, v18, v29
  v_mfma_f32_16x16x32_bf16 v[112:115], a[172:175], a[0:3], v[112:115]
  s_waitcnt lgkmcnt(6)
  v_fmac_f32 v246, v18, v30
  v_fmac_f32 v247, v18, v31
  v_mfma_f32_16x16x32_bf16 v[32:35], a[180:183], a[0:3], v[32:35]
  ds_read_b64_tr_b16 a[170:171], v6 offset:2048
  v_fmac_f32 v248, v20, v28
  v_mfma_f32_16x16x32_bf16 v[32:35], a[176:179], a[16:19], v[32:35]
  buffer_load_dwordx4 a[124:127], v1, s[8:11], s76 offen offset:1024 sc1
  v_fmac_f32 v249, v20, v29
  v_fmac_f32 v250, v20, v30
  v_mfma_f32_16x16x32_bf16 v[36:39], a[176:179], a[20:23], v[36:39]
  ds_read_b64_tr_b16 a[172:173], v6 offset:4096
  v_fmac_f32 v251, v20, v31
  v_mfma_f32_16x16x32_bf16 v[36:39], a[180:183], a[4:7], v[36:39]
  s_mov_b32 s69, 6422528
  s_add_u32 s77, s24, 28672
  v_fmac_f32 v252, v22, v28
  v_fmac_f32 v253, v22, v29
  v_mfma_f32_16x16x32_bf16 v[40:43], a[180:183], a[8:11], v[40:43]
  ds_read_b64_tr_b16 a[174:175], v6 offset:6144
  v_fmac_f32 v254, v22, v30
  v_mfma_f32_16x16x32_bf16 v[40:43], a[176:179], a[24:27], v[40:43]
  buffer_load_dwordx4 a[128:131], v1, s[8:11], s77 offen offset:0 sc1
  v_fmac_f32 v255, v22, v31
  v_mfma_f32_16x16x32_bf16 v[44:47], a[176:179], a[28:31], v[44:47]
  ds_read_b64_tr_b16 a[176:177], v6 offset:8192
  s_waitcnt lgkmcnt(7)
  v_mfma_f32_16x16x32_bf16 v[44:47], a[180:183], a[12:15], v[44:47]
  s_waitcnt lgkmcnt(5)
  v_fmac_f32 v240, v17, v24
  v_fmac_f32 v241, v17, v25
  v_mfma_f32_16x16x32_bf16 v[60:63], a[160:163], a[12:15], v[60:63]
  ds_read_b64_tr_b16 a[178:179], v6 offset:10240
  v_fmac_f32 v242, v17, v26
  v_mfma_f32_16x16x32_bf16 v[60:63], a[164:167], a[28:31], v[60:63]
  v_fmac_f32 v243, v17, v27
  v_fmac_f32 v244, v19, v24
  v_mfma_f32_16x16x32_bf16 v[56:59], a[164:167], a[24:27], v[56:59]
  ds_read_b64_tr_b16 a[180:181], v6 offset:12288
  v_fmac_f32 v245, v19, v25
  v_mfma_f32_16x16x32_bf16 v[56:59], a[160:163], a[8:11], v[56:59]
  buffer_load_dwordx4 a[144:147], v1, s[8:11], s77 offen offset:1024 sc1
  v_fmac_f32 v246, v19, v26
  v_fmac_f32 v247, v19, v27
  v_mfma_f32_16x16x32_bf16 v[52:55], a[160:163], a[4:7], v[52:55]
  ds_read_b64_tr_b16 a[182:183], v6 offset:14336
  v_fmac_f32 v248, v21, v24
  v_mfma_f32_16x16x32_bf16 v[52:55], a[164:167], a[20:23], v[52:55]
  s_add_u32 s77, s77, 65536
  v_fmac_f32 v249, v21, v25
  v_fmac_f32 v250, v21, v26
  v_mfma_f32_16x16x32_bf16 v[48:51], a[164:167], a[16:19], v[48:51]
  ds_read_b64_tr_b16 a[164:165], v7 offset:0
  v_fmac_f32 v251, v21, v27
  v_mfma_f32_16x16x32_bf16 v[48:51], a[160:163], a[0:3], v[48:51]
  s_waitcnt vmcnt(28) lgkmcnt(5)
  buffer_load_dwordx4 a[132:135], v1, s[8:11], s77 offen offset:0 sc1
  v_fmac_f32 v252, v23, v24
  v_mfma_f32_16x16x32_bf16 v[64:67], a[168:171], a[32:35], v[64:67]
  ds_read_b64_tr_b16 a[166:167], v7 offset:2048
  v_fmac_f32 v253, v23, v25
  v_mfma_f32_16x16x32_bf16 v[64:67], a[172:175], a[48:51], v[64:67]
  v_fmac_f32 v254, v23, v26
  v_fmac_f32 v255, v23, v27
  v_mfma_f32_16x16x32_bf16 v[68:71], a[172:175], a[52:55], v[68:71]
  ds_read_b64_tr_b16 a[160:161], v7 offset:4096
  v_mfma_f32_16x16x32_bf16 v[68:71], a[168:171], a[36:39], v[68:71]
  s_add_u32 s61, s91, 4096
  ds_read_b128 v[28:31], v12 offset:896
  v_mfma_f32_16x16x32_bf16 v[72:75], a[168:171], a[40:43], v[72:75]
  ds_read_b64_tr_b16 a[162:163], v7 offset:6144
  v_mfma_f32_16x16x32_bf16 v[72:75], a[172:175], a[56:59], v[72:75]
  buffer_load_dword a253, v13, s[36:39], s61 offen
  v_rcp_f32 v16, v17
  v_mfma_f32_16x16x32_bf16 v[76:79], a[172:175], a[60:63], v[76:79]
  ds_read_b64_tr_b16 a[172:173], v7 offset:8192
  v_mfma_f32_16x16x32_bf16 v[76:79], a[168:171], a[44:47], v[76:79]
  s_waitcnt lgkmcnt(6)
  v_rcp_f32 v18, v19
  v_mfma_f32_16x16x32_bf16 v[92:95], a[176:179], a[44:47], v[92:95]
  ds_read_b64_tr_b16 a[174:175], v7 offset:10240
  v_mfma_f32_16x16x32_bf16 v[92:95], a[180:183], a[60:63], v[92:95]
  v_rcp_f32 v20, v21
  v_mfma_f32_16x16x32_bf16 v[88:91], a[180:183], a[56:59], v[88:91]
  ds_read_b64_tr_b16 a[168:169], v7 offset:12288
  v_mfma_f32_16x16x32_bf16 v[88:91], a[176:179], a[40:43], v[88:91]
  v_rcp_f32 v22, v23
  v_mfma_f32_16x16x32_bf16 v[84:87], a[176:179], a[36:39], v[84:87]
  ds_read_b64_tr_b16 a[170:171], v7 offset:14336
  v_mul_f32 v17, 0xbfb8aa3b, v17
  v_mfma_f32_16x16x32_bf16 v[84:87], a[180:183], a[52:55], v[84:87]
  v_mul_f32 v19, 0xbfb8aa3b, v19
  v_mul_f32 v21, 0xbfb8aa3b, v21
  v_mfma_f32_16x16x32_bf16 v[80:83], a[180:183], a[48:51], v[80:83]
  ds_read_b64_tr_b16 a[180:181], v8 offset:0
  v_mul_f32 v23, 0xbfb8aa3b, v23
  v_mfma_f32_16x16x32_bf16 v[80:83], a[176:179], a[32:35], v[80:83]
  s_waitcnt lgkmcnt(5)
  buffer_load_dwordx4 a[148:151], v1, s[8:11], s77 offen offset:1024 sc1
  v_mul_f32 v16, 0xbfb8aa3b, v16
  v_mfma_f32_16x16x32_bf16 v[96:99], a[164:167], a[32:35], v[96:99]
  ds_read_b64_tr_b16 a[182:183], v8 offset:2048
  v_mul_f32 v18, 0xbfb8aa3b, v18
  v_mfma_f32_16x16x32_bf16 v[96:99], a[160:163], a[48:51], v[96:99]
  s_add_u32 s77, s77, 65536
  v_mul_f32 v20, 0xbfb8aa3b, v20
  v_mul_f32 v22, 0xbfb8aa3b, v22
  v_mfma_f32_16x16x32_bf16 v[100:103], a[160:163], a[52:55], v[100:103]
  ds_read_b64_tr_b16 a[176:177], v8 offset:4096
  v_mfma_f32_16x16x32_bf16 v[100:103], a[164:167], a[36:39], v[100:103]
  buffer_load_dwordx4 a[136:139], v1, s[8:11], s77 offen offset:0 sc1
  v_mfma_f32_16x16x32_bf16 v[104:107], a[164:167], a[40:43], v[104:107]
  ds_read_b64_tr_b16 a[178:179], v8 offset:6144
  v_mfma_f32_16x16x32_bf16 v[104:107], a[160:163], a[56:59], v[104:107]
  v_mfma_f32_16x16x32_bf16 v[108:111], a[160:163], a[60:63], v[108:111]
  ds_read_b64_tr_b16 a[160:161], v8 offset:8192
  v_mfma_f32_16x16x32_bf16 v[108:111], a[164:167], a[44:47], v[108:111]
  s_waitcnt lgkmcnt(5)
  v_mfma_f32_16x16x32_bf16 v[124:127], a[172:175], a[44:47], v[124:127]
  ds_read_b64_tr_b16 a[162:163], v8 offset:10240
  v_mfma_f32_16x16x32_bf16 v[124:127], a[168:171], a[60:63], v[124:127]
  buffer_load_dwordx4 a[152:155], v1, s[8:11], s77 offen offset:1024 sc1
  v_mfma_f32_16x16x32_bf16 v[120:123], a[168:171], a[56:59], v[120:123]
  ds_read_b64_tr_b16 a[164:165], v8 offset:12288
  v_mfma_f32_16x16x32_bf16 v[120:123], a[172:175], a[40:43], v[120:123]
  s_add_u32 s77, s77, 65536
  v_mfma_f32_16x16x32_bf16 v[116:119], a[172:175], a[36:39], v[116:119]
  ds_read_b64_tr_b16 a[166:167], v8 offset:14336
  v_mfma_f32_16x16x32_bf16 v[116:119], a[168:171], a[52:55], v[116:119]
  buffer_load_dwordx4 a[140:143], v1, s[8:11], s77 offen offset:0 sc1
  v_mfma_f32_16x16x32_bf16 v[112:115], a[168:171], a[48:51], v[112:115]
  ds_read_b64_tr_b16 a[168:169], v2 offset:16384
  v_mfma_f32_16x16x32_bf16 v[112:115], a[172:175], a[32:35], v[112:115]
  s_waitcnt lgkmcnt(5)
  v_mfma_f32_16x16x32_bf16 v[32:35], a[180:183], a[32:35], v[32:35]
  ds_read_b64_tr_b16 a[170:171], v2 offset:18432
  v_mfma_f32_16x16x32_bf16 v[32:35], a[176:179], a[48:51], v[32:35]
  v_mfma_f32_16x16x32_bf16 v[36:39], a[176:179], a[52:55], v[36:39]
  ds_read_b64_tr_b16 a[172:173], v2 offset:20480
  v_mfma_f32_16x16x32_bf16 v[36:39], a[180:183], a[36:39], v[36:39]
  buffer_load_dwordx4 a[156:159], v1, s[8:11], s77 offen offset:1024 sc1
  v_mfma_f32_16x16x32_bf16 v[40:43], a[180:183], a[40:43], v[40:43]
  ds_read_b64_tr_b16 a[174:175], v2 offset:22528
  v_mfma_f32_16x16x32_bf16 v[40:43], a[176:179], a[56:59], v[40:43]
  s_mov_b32 s70, 6881280
  s_add_u32 s78, s24, 30720
  v_mfma_f32_16x16x32_bf16 v[44:47], a[176:179], a[60:63], v[44:47]
  ds_read_b64_tr_b16 a[176:177], v2 offset:24576
  v_mfma_f32_16x16x32_bf16 v[44:47], a[180:183], a[44:47], v[44:47]
  s_waitcnt lgkmcnt(5)
  buffer_load_dwordx4 a[188:191], v1, s[8:11], s78 offen offset:0 sc1
  v_mfma_f32_16x16x32_bf16 v[60:63], a[160:163], a[44:47], v[60:63]
  ds_read_b64_tr_b16 a[178:179], v2 offset:26624
  s_barrier
  v_mfma_f32_16x16x32_bf16 v[60:63], a[164:167], a[60:63], v[60:63]
  v_mfma_f32_16x16x32_bf16 v[56:59], a[164:167], a[56:59], v[56:59]
  ds_read_b64_tr_b16 a[180:181], v2 offset:28672
  v_mfma_f32_16x16x32_bf16 v[56:59], a[160:163], a[40:43], v[56:59]
  s_add_u32 m0, s45, 81920
  v_mfma_f32_16x16x32_bf16 v[52:55], a[160:163], a[36:39], v[52:55]
  ds_read_b64_tr_b16 a[182:183], v2 offset:30720
  v_mfma_f32_16x16x32_bf16 v[52:55], a[164:167], a[52:55], v[52:55]
  buffer_load_dwordx4 v11, s[28:31], s69 offen lds
  v_mfma_f32_16x16x32_bf16 v[48:51], a[164:167], a[48:51], v[48:51]
  ds_read_b64_tr_b16 a[164:165], v3 offset:16384
  v_mfma_f32_16x16x32_bf16 v[48:51], a[160:163], a[32:35], v[48:51]
  s_waitcnt lgkmcnt(5)
  s_add_u32 m0, s45, 90112
  v_mfma_f32_16x16x32_bf16 v[128:131], a[168:171], a[0:3], v[128:131]
  ds_read_b64_tr_b16 a[166:167], v3 offset:18432
  v_mfma_f32_16x16x32_bf16 v[128:131], a[172:175], a[16:19], v[128:131]
  buffer_load_dwordx4 v11, s[32:35], s69 offen lds
  v_mfma_f32_16x16x32_bf16 v[132:135], a[172:175], a[20:23], v[132:135]
  ds_read_b64_tr_b16 a[160:161], v3 offset:20480
  v_mfma_f32_16x16x32_bf16 v[132:135], a[168:171], a[4:7], v[132:135]
  v_mfma_f32_16x16x32_bf16 v[136:139], a[168:171], a[8:11], v[136:139]
  ds_read_b64_tr_b16 a[162:163], v3 offset:22528
  v_mfma_f32_16x16x32_bf16 v[136:139], a[172:175], a[24:27], v[136:139]
  s_add_u32 m0, s45, 86016
  s_add_u32 s60, s69, 229376
  v_mfma_f32_16x16x32_bf16 v[140:143], a[172:175], a[28:31], v[140:143]
  ds_read_b64_tr_b16 a[172:173], v3 offset:24576
  v_mfma_f32_16x16x32_bf16 v[140:143], a[168:171], a[12:15], v[140:143]
  s_waitcnt lgkmcnt(5)
  buffer_load_dwordx4 v11, s[28:31], s60 offen lds
  v_mfma_f32_16x16x32_bf16 v[156:159], a[176:179], a[12:15], v[156:159]
  ds_read_b64_tr_b16 a[174:175], v3 offset:26624
  v_mfma_f32_16x16x32_bf16 v[156:159], a[180:183], a[28:31], v[156:159]
  s_add_u32 m0, s45, 94208
  s_add_u32 s60, s69, 229376
  v_mfma_f32_16x16x32_bf16 v[152:155], a[180:183], a[24:27], v[152:155]
  ds_read_b64_tr_b16 a[168:169], v3 offset:28672
  v_mfma_f32_16x16x32_bf16 v[152:155], a[176:179], a[8:11], v[152:155]
  buffer_load_dwordx4 v11, s[32:35], s60 offen lds
  v_mfma_f32_16x16x32_bf16 v[148:151], a[176:179], a[4:7], v[148:151]
  ds_read_b64_tr_b16 a[170:171], v3 offset:30720
  v_mfma_f32_16x16x32_bf16 v[148:151], a[180:183], a[20:23], v[148:151]
  v_mfma_f32_16x16x32_bf16 v[144:147], a[180:183], a[16:19], v[144:147]
  ds_read_b64_tr_b16 a[180:181], v4 offset:16384
  v_mfma_f32_16x16x32_bf16 v[144:147], a[176:179], a[0:3], v[144:147]
  s_waitcnt lgkmcnt(5)
  s_add_u32 m0, s45, 65536
  v_mfma_f32_16x16x32_bf16 v[160:163], a[164:167], a[0:3], v[160:163]
  ds_read_b64_tr_b16 a[182:183], v4 offset:18432
  v_mfma_f32_16x16x32_bf16 v[160:163], a[160:163], a[16:19], v[160:163]
  buffer_load_dwordx4 v11, s[28:31], s70 offen lds
  v_mfma_f32_16x16x32_bf16 v[164:167], a[160:163], a[20:23], v[164:167]
  ds_read_b64_tr_b16 a[176:177], v4 offset:20480
  v_mfma_f32_16x16x32_bf16 v[164:167], a[164:167], a[4:7], v[164:167]
  s_add_u32 m0, s45, 73728
  v_mfma_f32_16x16x32_bf16 v[168:171], a[164:167], a[8:11], v[168:171]
  ds_read_b64_tr_b16 a[178:179], v4 offset:22528
  v_mfma_f32_16x16x32_bf16 v[168:171], a[160:163], a[24:27], v[168:171]
  buffer_load_dwordx4 v11, s[32:35], s70 offen lds
  v_mfma_f32_16x16x32_bf16 v[172:175], a[160:163], a[28:31], v[172:175]
  ds_read_b64_tr_b16 a[160:161], v4 offset:24576
  v_mfma_f32_16x16x32_bf16 v[172:175], a[164:167], a[12:15], v[172:175]
  s_waitcnt lgkmcnt(5)
  v_mfma_f32_16x16x32_bf16 v[188:191], a[172:175], a[12:15], v[188:191]
  ds_read_b64_tr_b16 a[162:163], v4 offset:26624
  v_mfma_f32_16x16x32_bf16 v[188:191], a[168:171], a[28:31], v[188:191]
  s_add_u32 m0, s45, 69632
  s_add_u32 s60, s70, 229376
  v_mfma_f32_16x16x32_bf16 v[184:187], a[168:171], a[24:27], v[184:187]
  ds_read_b64_tr_b16 a[164:165], v4 offset:28672
  v_mfma_f32_16x16x32_bf16 v[184:187], a[172:175], a[8:11], v[184:187]
  buffer_load_dwordx4 v11, s[28:31], s60 offen lds
  v_mfma_f32_16x16x32_bf16 v[180:183], a[172:175], a[4:7], v[180:183]
  ds_read_b64_tr_b16 a[166:167], v4 offset:30720
  v_mfma_f32_16x16x32_bf16 v[180:183], a[168:171], a[20:23], v[180:183]
  s_add_u32 m0, s45, 77824
  s_add_u32 s60, s70, 229376
  v_mfma_f32_16x16x32_bf16 v[176:179], a[168:171], a[16:19], v[176:179]
  ds_read_b64_tr_b16 a[168:169], v5 offset:16384
  v_mfma_f32_16x16x32_bf16 v[176:179], a[172:175], a[0:3], v[176:179]
  s_waitcnt lgkmcnt(5)
  buffer_load_dwordx4 v11, s[32:35], s60 offen lds
  v_mfma_f32_16x16x32_bf16 v[192:195], a[180:183], a[0:3], v[192:195]
  ds_read_b64_tr_b16 a[170:171], v5 offset:18432
  v_mfma_f32_16x16x32_bf16 v[192:195], a[176:179], a[16:19], v[192:195]
  v_mfma_f32_16x16x32_bf16 v[196:199], a[176:179], a[20:23], v[196:199]
  ds_read_b64_tr_b16 a[172:173], v5 offset:20480
  v_mfma_f32_16x16x32_bf16 v[196:199], a[180:183], a[4:7], v[196:199]
  s_add_u32 s61, s91, 6144
  v_mfma_f32_16x16x32_bf16 v[200:203], a[180:183], a[8:11], v[200:203]
  ds_read_b64_tr_b16 a[174:175], v5 offset:22528
  v_mfma_f32_16x16x32_bf16 v[200:203], a[176:179], a[24:27], v[200:203]
  buffer_load_dword a253, v13, s[36:39], s61 offen
  v_mfma_f32_16x16x32_bf16 v[204:207], a[176:179], a[28:31], v[204:207]
  ds_read_b64_tr_b16 a[176:177], v5 offset:24576
  v_mfma_f32_16x16x32_bf16 v[204:207], a[180:183], a[12:15], v[204:207]
  s_waitcnt lgkmcnt(5)
  v_mfma_f32_16x16x32_bf16 v[220:223], a[160:163], a[12:15], v[220:223]
  ds_read_b64_tr_b16 a[178:179], v5 offset:26624
  v_mfma_f32_16x16x32_bf16 v[220:223], a[164:167], a[28:31], v[220:223]
  v_mfma_f32_16x16x32_bf16 v[216:219], a[164:167], a[24:27], v[216:219]
  ds_read_b64_tr_b16 a[180:181], v5 offset:28672
  v_mfma_f32_16x16x32_bf16 v[216:219], a[160:163], a[8:11], v[216:219]
  v_mfma_f32_16x16x32_bf16 v[212:215], a[160:163], a[4:7], v[212:215]
  ds_read_b64_tr_b16 a[182:183], v5 offset:30720
  v_mfma_f32_16x16x32_bf16 v[212:215], a[164:167], a[20:23], v[212:215]
  s_waitcnt vmcnt(24)
  s_barrier
  v_mfma_f32_16x16x32_bf16 v[208:211], a[164:167], a[16:19], v[208:211]
  ds_read_b64_tr_b16 a[164:165], v8 offset:32768
  v_mfma_f32_16x16x32_bf16 v[208:211], a[160:163], a[0:3], v[208:211]
  s_waitcnt lgkmcnt(5)
  buffer_load_dwordx4 a[204:207], v1, s[8:11], s78 offen offset:1024 sc1
  v_mfma_f32_16x16x32_bf16 v[224:227], a[168:171], a[0:3], v[224:227]
  ds_read_b64_tr_b16 a[166:167], v8 offset:34816
  v_mfma_f32_16x16x32_bf16 v[224:227], a[172:175], a[16:19], v[224:227]
  s_add_u32 s78, s78, 65536
  v_mfma_f32_16x16x32_bf16 v[228:231], a[172:175], a[20:23], v[228:231]
  ds_read_b64_tr_b16 a[160:161], v8 offset:36864
  v_mfma_f32_16x16x32_bf16 v[228:231], a[168:171], a[4:7], v[228:231]
  buffer_load_dwordx4 a[192:195], v1, s[8:11], s78 offen offset:0 sc1
  v_mfma_f32_16x16x32_bf16 v[232:235], a[168:171], a[8:11], v[232:235]
  ds_read_b64_tr_b16 a[162:163], v8 offset:38912
  v_mfma_f32_16x16x32_bf16 v[232:235], a[172:175], a[24:27], v[232:235]
  v_mfma_f32_16x16x32_bf16 v[236:239], a[172:175], a[28:31], v[236:239]
  ds_read_b64_tr_b16 a[172:173], v8 offset:40960
  v_mfma_f32_16x16x32_bf16 v[236:239], a[168:171], a[12:15], v[236:239]
  s_waitcnt lgkmcnt(5)
  v_mfma_f32_16x16x32_bf16 v[252:255], a[176:179], a[12:15], v[252:255]
  ds_read_b64_tr_b16 a[174:175], v8 offset:43008
  v_mfma_f32_16x16x32_bf16 v[252:255], a[180:183], a[28:31], v[252:255]
  buffer_load_dwordx4 a[208:211], v1, s[8:11], s78 offen offset:1024 sc1
  v_mfma_f32_16x16x32_bf16 v[248:251], a[180:183], a[24:27], v[248:251]
  ds_read_b64_tr_b16 a[168:169], v8 offset:45056
  v_mfma_f32_16x16x32_bf16 v[248:251], a[176:179], a[8:11], v[248:251]
  s_add_u32 s78, s78, 65536
  v_mfma_f32_16x16x32_bf16 v[244:247], a[176:179], a[4:7], v[244:247]
  ds_read_b64_tr_b16 a[170:171], v8 offset:47104
  v_mfma_f32_16x16x32_bf16 v[244:247], a[180:183], a[20:23], v[244:247]
  buffer_load_dwordx4 a[196:199], v1, s[8:11], s78 offen offset:0 sc1
  v_mfma_f32_16x16x32_bf16 v[240:243], a[180:183], a[16:19], v[240:243]
  ds_read_b64_tr_b16 a[180:181], v8 offset:49152
  v_mfma_f32_16x16x32_bf16 v[240:243], a[176:179], a[0:3], v[240:243]
  s_waitcnt vmcnt(36) lgkmcnt(5)
  v_mfma_f32_16x16x32_bf16 v[32:35], a[164:167], a[64:67], v[32:35]
  ds_read_b64_tr_b16 a[182:183], v8 offset:51200
  v_mfma_f32_16x16x32_bf16 v[32:35], a[160:163], a[80:83], v[32:35]
  v_mfma_f32_16x16x32_bf16 v[36:39], a[160:163], a[84:87], v[36:39]
  ds_read_b64_tr_b16 a[176:177], v8 offset:53248
  v_mfma_f32_16x16x32_bf16 v[36:39], a[164:167], a[68:71], v[36:39]
  buffer_load_dwordx4 a[212:215], v1, s[8:11], s78 offen offset:1024 sc1
  v_mfma_f32_16x16x32_bf16 v[40:43], a[164:167], a[72:75], v[40:43]
  ds_read_b64_tr_b16 a[178:179], v8 offset:55296
  v_mfma_f32_16x16x32_bf16 v[40:43], a[160:163], a[88:91], v[40:43]
  s_add_u32 s78, s78, 65536
  v_mfma_f32_16x16x32_bf16 v[44:47], a[160:163], a[92:95], v[44:47]
  ds_read_b64_tr_b16 a[160:161], v8 offset:57344
  v_mfma_f32_16x16x32_bf16 v[44:47], a[164:167], a[76:79], v[44:47]
  s_waitcnt lgkmcnt(5)
  buffer_load_dwordx4 a[200:203], v1, s[8:11], s78 offen offset:0 sc1
  v_mfma_f32_16x16x32_bf16 v[60:63], a[172:175], a[76:79], v[60:63]
  ds_read_b64_tr_b16 a[162:163], v8 offset:59392
  v_mfma_f32_16x16x32_bf16 v[60:63], a[168:171], a[92:95], v[60:63]
  v_mfma_f32_16x16x32_bf16 v[56:59], a[168:171], a[88:91], v[56:59]
  ds_read_b64_tr_b16 a[164:165], v8 offset:61440
  v_mfma_f32_16x16x32_bf16 v[56:59], a[172:175], a[72:75], v[56:59]
  buffer_load_dwordx4 a[216:219], v1, s[8:11], s78 offen offset:1024 sc1
  v_mfma_f32_16x16x32_bf16 v[52:55], a[172:175], a[68:71], v[52:55]
  ds_read_b64_tr_b16 a[166:167], v8 offset:63488
  v_mfma_f32_16x16x32_bf16 v[52:55], a[168:171], a[84:87], v[52:55]
  s_waitcnt vmcnt(8)
  s_barrier
  v_mfma_f32_16x16x32_bf16 v[48:51], a[168:171], a[80:83], v[48:51]
  ds_read_b64_tr_b16 a[168:169], v8 offset:16384
  s_add_u32 m0, s45, 0
  v_mfma_f32_16x16x32_bf16 v[48:51], a[172:175], a[64:67], v[48:51]
  s_waitcnt vmcnt(26) lgkmcnt(5)
  buffer_load_dwordx4 v10, s[28:31], s66 offen lds
  v_mfma_f32_16x16x32_bf16 v[32:35], a[180:183], a[96:99], v[32:35]
  ds_read_b64_tr_b16 a[170:171], v8 offset:18432
  v_mfma_f32_16x16x32_bf16 v[32:35], a[176:179], a[112:115], v[32:35]
  s_add_u32 m0, s45, 8192
  v_mfma_f32_16x16x32_bf16 v[36:39], a[176:179], a[116:119], v[36:39]
  ds_read_b64_tr_b16 a[172:173], v8 offset:20480
  v_mfma_f32_16x16x32_bf16 v[36:39], a[180:183], a[100:103], v[36:39]
  buffer_load_dwordx4 v10, s[32:35], s66 offen lds
  v_mfma_f32_16x16x32_bf16 v[40:43], a[180:183], a[104:107], v[40:43]
  ds_read_b64_tr_b16 a[174:175], v8 offset:22528
  v_mfma_f32_16x16x32_bf16 v[40:43], a[176:179], a[120:123], v[40:43]
  s_add_u32 m0, s45, 4096
  s_add_u32 s60, s66, 229376
  v_mfma_f32_16x16x32_bf16 v[44:47], a[176:179], a[124:127], v[44:47]
  ds_read_b64_tr_b16 a[176:177], v8 offset:24576
  v_mfma_f32_16x16x32_bf16 v[44:47], a[180:183], a[108:111], v[44:47]
  s_waitcnt lgkmcnt(5)
  buffer_load_dwordx4 v10, s[28:31], s60 offen lds
  v_mfma_f32_16x16x32_bf16 v[60:63], a[160:163], a[108:111], v[60:63]
  ds_read_b64_tr_b16 a[178:179], v8 offset:26624
  v_mfma_f32_16x16x32_bf16 v[60:63], a[164:167], a[124:127], v[60:63]
  s_add_u32 m0, s45, 12288
HOP13:
  s_cbranch_execz HOP17
  s_add_u32 s60, s66, 229376
  v_mfma_f32_16x16x32_bf16 v[56:59], a[164:167], a[120:123], v[56:59]
  ds_read_b64_tr_b16 a[180:181], v8 offset:28672
  v_mfma_f32_16x16x32_bf16 v[56:59], a[160:163], a[104:107], v[56:59]
  buffer_load_dwordx4 v10, s[32:35], s60 offen lds
  v_mfma_f32_16x16x32_bf16 v[52:55], a[160:163], a[100:103], v[52:55]
  ds_read_b64_tr_b16 a[182:183], v8 offset:30720
  v_mfma_f32_16x16x32_bf16 v[52:55], a[164:167], a[116:119], v[52:55]
  s_add_u32 m0, s45, 32768
  v_mfma_f32_16x16x32_bf16 v[48:51], a[164:167], a[112:115], v[48:51]
  ds_read_b64_tr_b16 a[164:165], v8 offset:0
  v_mfma_f32_16x16x32_bf16 v[48:51], a[160:163], a[96:99], v[48:51]
  s_waitcnt vmcnt(21) lgkmcnt(5)
  buffer_load_dwordx4 v10, s[28:31], s67 offen lds
  v_mfma_f32_16x16x32_bf16 v[32:35], a[168:171], a[128:131], v[32:35]
  ds_read_b64_tr_b16 a[166:167], v8 offset:2048
  v_mfma_f32_16x16x32_bf16 v[32:35], a[172:175], a[144:147], v[32:35]
  s_add_u32 m0, s45, 40960
  v_mfma_f32_16x16x32_bf16 v[36:39], a[172:175], a[148:151], v[36:39]
  ds_read_b64_tr_b16 a[160:161], v8 offset:4096
  v_mfma_f32_16x16x32_bf16 v[36:39], a[168:171], a[132:135], v[36:39]
  buffer_load_dwordx4 v10, s[32:35], s67 offen lds
  v_mfma_f32_16x16x32_bf16 v[40:43], a[168:171], a[136:139], v[40:43]
  ds_read_b64_tr_b16 a[162:163], v8 offset:6144
  v_mfma_f32_16x16x32_bf16 v[40:43], a[172:175], a[152:155], v[40:43]
  s_add_u32 m0, s45, 36864
  s_add_u32 s60, s67, 229376
  v_mfma_f32_16x16x32_bf16 v[44:47], a[172:175], a[156:159], v[44:47]
  ds_read_b64_tr_b16 a[172:173], v8 offset:8192
  v_mfma_f32_16x16x32_bf16 v[44:47], a[168:171], a[140:143], v[44:47]
  s_waitcnt lgkmcnt(5)
  buffer_load_dwordx4 v10, s[28:31], s60 offen lds
  v_mfma_f32_16x16x32_bf16 v[60:63], a[176:179], a[140:143], v[60:63]
  ds_read_b64_tr_b16 a[174:175], v8 offset:10240
  v_mfma_f32_16x16x32_bf16 v[60:63], a[180:183], a[156:159], v[60:63]
  s_add_u32 m0, s45, 45056
  s_add_u32 s60, s67, 229376
  v_mfma_f32_16x16x32_bf16 v[56:59], a[180:183], a[152:155], v[56:59]
  ds_read_b64_tr_b16 a[168:169], v8 offset:12288
  v_mfma_f32_16x16x32_bf16 v[56:59], a[176:179], a[136:139], v[56:59]
  buffer_load_dwordx4 v10, s[32:35], s60 offen lds
  v_mfma_f32_16x16x32_bf16 v[52:55], a[176:179], a[132:135], v[52:55]
  ds_read_b64_tr_b16 a[170:171], v8 offset:14336
  v_mfma_f32_16x16x32_bf16 v[52:55], a[180:183], a[148:151], v[52:55]
  s_add_u32 s61, s91, 8192
  v_mfma_f32_16x16x32_bf16 v[48:51], a[180:183], a[144:147], v[48:51]
  ds_read_b64_tr_b16 a[180:181], v6 offset:32768
  v_mfma_f32_16x16x32_bf16 v[48:51], a[176:179], a[128:131], v[48:51]
  s_waitcnt vmcnt(8) lgkmcnt(5)
  buffer_load_dword a253, v13, s[36:39], s61 offen
  v_mfma_f32_16x16x32_bf16 v[32:35], a[164:167], a[188:191], v[32:35]
  ds_read_b64_tr_b16 a[182:183], v6 offset:34816
  v_mfma_f32_16x16x32_bf16 v[32:35], a[160:163], a[204:207], v[32:35]
  v_mfma_f32_16x16x32_bf16 v[36:39], a[160:163], a[208:211], v[36:39]
  ds_read_b64_tr_b16 a[176:177], v6 offset:36864
  v_mfma_f32_16x16x32_bf16 v[36:39], a[164:167], a[192:195], v[36:39]
  v_mfma_f32_16x16x32_bf16 v[40:43], a[164:167], a[196:199], v[40:43]
  ds_read_b64_tr_b16 a[178:179], v6 offset:38912
  v_mfma_f32_16x16x32_bf16 v[40:43], a[160:163], a[212:215], v[40:43]
  s_add_u32 m0, s45, 49152
  v_mfma_f32_16x16x32_bf16 v[44:47], a[160:163], a[216:219], v[44:47]
  ds_read_b64_tr_b16 a[160:161], v6 offset:40960
  v_mfma_f32_16x16x32_bf16 v[44:47], a[164:167], a[200:203], v[44:47]
  s_waitcnt lgkmcnt(5)
  buffer_load_dwordx4 v10, s[28:31], s68 offen lds
  v_mfma_f32_16x16x32_bf16 v[60:63], a[172:175], a[200:203], v[60:63]
  ds_read_b64_tr_b16 a[162:163], v6 offset:43008
  v_mfma_f32_16x16x32_bf16 v[60:63], a[168:171], a[216:219], v[60:63]
  s_add_u32 m0, s45, 57344
  v_mfma_f32_16x16x32_bf16 v[56:59], a[168:171], a[212:215], v[56:59]
  ds_read_b64_tr_b16 a[164:165], v6 offset:45056
  v_mfma_f32_16x16x32_bf16 v[56:59], a[172:175], a[196:199], v[56:59]
  buffer_load_dwordx4 v10, s[32:35], s68 offen lds
  v_mfma_f32_16x16x32_bf16 v[52:55], a[172:175], a[192:195], v[52:55]
  ds_read_b64_tr_b16 a[166:167], v6 offset:47104
  v_mfma_f32_16x16x32_bf16 v[52:55], a[168:171], a[208:211], v[52:55]
  s_add_u32 m0, s45, 53248
  s_add_u32 s60, s68, 229376
  v_mfma_f32_16x16x32_bf16 v[48:51], a[168:171], a[204:207], v[48:51]
  ds_read_b64_tr_b16 a[168:169], v6 offset:49152
  v_mfma_f32_16x16x32_bf16 v[48:51], a[172:175], a[188:191], v[48:51]
  s_waitcnt lgkmcnt(5)
  buffer_load_dwordx4 v10, s[28:31], s60 offen lds
  v_mfma_f32_16x16x32_bf16 v[64:67], a[180:183], a[64:67], v[64:67]
  ds_read_b64_tr_b16 a[170:171], v6 offset:51200
  v_mfma_f32_16x16x32_bf16 v[64:67], a[176:179], a[80:83], v[64:67]
  s_add_u32 m0, s45, 61440
  s_add_u32 s60, s68, 229376
  v_mfma_f32_16x16x32_bf16 v[68:71], a[176:179], a[84:87], v[68:71]
  ds_read_b64_tr_b16 a[172:173], v6 offset:53248
  s_waitcnt lgkmcnt(15)
  v_fma_f32 v32, v32, v16, v28
  v_mfma_f32_16x16x32_bf16 v[68:71], a[180:183], a[68:71], v[68:71]
  buffer_load_dwordx4 v10, s[32:35], s60 offen lds
  v_exp_f32 v24, v32
  v_fma_f32 v33, v33, v16, v29
  v_mfma_f32_16x16x32_bf16 v[72:75], a[180:183], a[72:75], v[72:75]
  ds_read_b64_tr_b16 a[174:175], v6 offset:55296
  v_exp_f32 v25, v33
  v_mfma_f32_16x16x32_bf16 v[72:75], a[176:179], a[88:91], v[72:75]
  s_add_u32 m0, s45, 16384
  v_fma_f32 v34, v34, v16, v30
  v_exp_f32 v26, v34
  v_mfma_f32_16x16x32_bf16 v[76:79], a[176:179], a[92:95], v[76:79]
  ds_read_b64_tr_b16 a[176:177], v6 offset:57344
  v_fma_f32 v35, v35, v16, v31
  v_mul_f32 v48, v32, v48
  v_mfma_f32_16x16x32_bf16 v[76:79], a[180:183], a[76:79], v[76:79]
  s_waitcnt lgkmcnt(5)
  buffer_load_dwordx4 v10, s[28:31], s69 offen lds
  v_exp_f32 v27, v35
  v_mfma_f32_16x16x32_bf16 v[92:95], a[160:163], a[76:79], v[92:95]
  ds_read_b64_tr_b16 a[178:179], v6 offset:59392
  v_mul_f32 v49, v33, v49
  v_mfma_f32_16x16x32_bf16 v[92:95], a[164:167], a[92:95], v[92:95]
  s_add_u32 m0, s45, 24576
  v_mul_f32 v50, v34, v50
  v_mul_f32 v51, v35, v51
  v_fma_f32 v24, v24, v17, v17
  v_mfma_f32_16x16x32_bf16 v[88:91], a[164:167], a[88:91], v[88:91]
  ds_read_b64_tr_b16 a[180:181], v6 offset:61440
  v_rcp_f32 v24, v24
  v_mfma_f32_16x16x32_bf16 v[88:91], a[160:163], a[72:75], v[88:91]
  buffer_load_dwordx4 v10, s[32:35], s69 offen lds
  v_fma_f32 v25, v25, v17, v17
  v_rcp_f32 v25, v25
  v_mfma_f32_16x16x32_bf16 v[84:87], a[160:163], a[68:71], v[84:87]
  ds_read_b64_tr_b16 a[182:183], v6 offset:63488
  v_fma_f32 v26, v26, v17, v17
  v_fma_f32 v27, v27, v17, v17
  v_mfma_f32_16x16x32_bf16 v[84:87], a[164:167], a[84:87], v[84:87]
  s_add_u32 m0, s45, 20480
  s_add_u32 s60, s69, 229376
  v_rcp_f32 v26, v26
  v_mfma_f32_16x16x32_bf16 v[80:83], a[164:167], a[80:83], v[80:83]
  ds_read_b64_tr_b16 a[164:165], v6 offset:16384
  v_rcp_f32 v27, v27
  v_mfma_f32_16x16x32_bf16 v[80:83], a[160:163], a[64:67], v[80:83]
  s_waitcnt lgkmcnt(5)
  buffer_load_dwordx4 v10, s[28:31], s60 offen lds
  v_mul_f32 v48, v48, v24
  v_mul_f32 v49, v49, v25
  v_mfma_f32_16x16x32_bf16 v[64:67], a[168:171], a[96:99], v[64:67]
  ds_read_b64_tr_b16 a[166:167], v6 offset:18432
  v_mul_f32 v50, v50, v26
  v_mfma_f32_16x16x32_bf16 v[64:67], a[172:175], a[112:115], v[64:67]
  s_add_u32 m0, s45, 28672
  s_add_u32 s60, s69, 229376
  v_mul_f32 v51, v51, v27
  v_cvt_pk_bf16_f32 v32, v48, v49
  v_mfma_f32_16x16x32_bf16 v[68:71], a[172:175], a[116:119], v[68:71]
  ds_read_b64_tr_b16 a[160:161], v6 offset:20480
  v_cvt_pk_bf16_f32 v33, v50, v51
  v_fma_f32 v36, v36, v18, v28
  v_mfma_f32_16x16x32_bf16 v[68:71], a[168:171], a[100:103], v[68:71]
  buffer_load_dwordx4 v10, s[32:35], s60 offen lds
  buffer_store_dwordx2 v[32:33], v1, s[8:11], s59 offen sc1
  v_mfma_f32_16x16x32_bf16 v[72:75], a[168:171], a[104:107], v[72:75]
  ds_read_b64_tr_b16 a[162:163], v6 offset:22528
  v_exp_f32 v24, v36
  v_mfma_f32_16x16x32_bf16 v[72:75], a[172:175], a[120:123], v[72:75]
  v_fma_f32 v37, v37, v18, v29
  v_exp_f32 v25, v37
  v_mfma_f32_16x16x32_bf16 v[76:79], a[172:175], a[124:127], v[76:79]
  ds_read_b64_tr_b16 a[172:173], v6 offset:24576
  v_fma_f32 v38, v38, v18, v30
  v_fma_f32 v39, v39, v18, v31
  v_mfma_f32_16x16x32_bf16 v[76:79], a[168:171], a[108:111], v[76:79]
  s_waitcnt lgkmcnt(5)
  v_exp_f32 v26, v38
  v_mul_f32 v52, v36, v52
  v_mfma_f32_16x16x32_bf16 v[92:95], a[176:179], a[108:111], v[92:95]
  ds_read_b64_tr_b16 a[174:175], v6 offset:26624
  v_mul_f32 v53, v37, v53
  v_mfma_f32_16x16x32_bf16 v[92:95], a[180:183], a[124:127], v[92:95]
  v_exp_f32 v27, v39
  v_mul_f32 v54, v38, v54
  v_mfma_f32_16x16x32_bf16 v[88:91], a[180:183], a[120:123], v[88:91]
  ds_read_b64_tr_b16 a[168:169], v6 offset:28672
  v_mul_f32 v55, v39, v55
  v_fma_f32 v24, v24, v19, v19
  v_mfma_f32_16x16x32_bf16 v[88:91], a[176:179], a[104:107], v[88:91]
  v_rcp_f32 v24, v24
  v_fma_f32 v25, v25, v19, v19
  v_mfma_f32_16x16x32_bf16 v[84:87], a[176:179], a[100:103], v[84:87]
  ds_read_b64_tr_b16 a[170:171], v6 offset:30720
  v_rcp_f32 v25, v25
  v_mfma_f32_16x16x32_bf16 v[84:87], a[180:183], a[116:119], v[84:87]
  v_fma_f32 v26, v26, v19, v19
  v_rcp_f32 v26, v26
  v_mfma_f32_16x16x32_bf16 v[80:83], a[180:183], a[112:115], v[80:83]
  ds_read_b64_tr_b16 a[180:181], v6 offset:0
  v_fma_f32 v27, v27, v19, v19
  v_mul_f32 v52, v52, v24
  v_mfma_f32_16x16x32_bf16 v[80:83], a[176:179], a[96:99], v[80:83]
  s_waitcnt lgkmcnt(5)
  v_rcp_f32 v27, v27
  v_mul_f32 v53, v53, v25
  v_mfma_f32_16x16x32_bf16 v[64:67], a[164:167], a[128:131], v[64:67]
  ds_read_b64_tr_b16 a[182:183], v6 offset:2048
  v_mul_f32 v54, v54, v26
  v_mfma_f32_16x16x32_bf16 v[64:67], a[160:163], a[144:147], v[64:67]
  v_mul_f32 v55, v55, v27
  v_cvt_pk_bf16_f32 v36, v52, v53
  v_cvt_pk_bf16_f32 v37, v54, v55
  v_mfma_f32_16x16x32_bf16 v[68:71], a[160:163], a[148:151], v[68:71]
  ds_read_b64_tr_b16 a[176:177], v6 offset:4096
  v_fma_f32 v40, v40, v20, v28
  v_fma_f32 v41, v41, v20, v29
  v_mfma_f32_16x16x32_bf16 v[68:71], a[164:167], a[132:135], v[68:71]
  s_add_u32 s55, s59, 262144
  buffer_store_dwordx2 v[36:37], v1, s[8:11], s55 offen sc1
  v_mfma_f32_16x16x32_bf16 v[72:75], a[164:167], a[136:139], v[72:75]
  ds_read_b64_tr_b16 a[178:179], v6 offset:6144
  s_add_u32 s61, s91, 10240
  v_fma_f32 v42, v42, v20, v30
  v_mfma_f32_16x16x32_bf16 v[72:75], a[160:163], a[152:155], v[72:75]
  buffer_load_dword a253, v13, s[36:39], s61 offen
  v_exp_f32 v24, v40
  v_fma_f32 v43, v43, v20, v31
  v_mfma_f32_16x16x32_bf16 v[76:79], a[160:163], a[156:159], v[76:79]
  ds_read_b64_tr_b16 a[160:161], v6 offset:8192
  v_exp_f32 v25, v41
  v_mfma_f32_16x16x32_bf16 v[76:79], a[164:167], a[140:143], v[76:79]
  s_waitcnt lgkmcnt(5)
  v_exp_f32 v26, v42
  v_mul_f32 v56, v40, v56
  v_mfma_f32_16x16x32_bf16 v[92:95], a[172:175], a[140:143], v[92:95]
  ds_read_b64_tr_b16 a[162:163], v6 offset:10240
  v_mul_f32 v57, v41, v57
  v_mfma_f32_16x16x32_bf16 v[92:95], a[168:171], a[156:159], v[92:95]
  v_exp_f32 v27, v43
  v_mul_f32 v58, v42, v58
  v_mfma_f32_16x16x32_bf16 v[88:91], a[168:171], a[152:155], v[88:91]
  ds_read_b64_tr_b16 a[164:165], v6 offset:12288
  v_mul_f32 v59, v43, v59
  v_fma_f32 v24, v24, v21, v21
  v_mfma_f32_16x16x32_bf16 v[88:91], a[172:175], a[136:139], v[88:91]
  v_rcp_f32 v24, v24
  v_fma_f32 v25, v25, v21, v21
  v_mfma_f32_16x16x32_bf16 v[84:87], a[172:175], a[132:135], v[84:87]
  ds_read_b64_tr_b16 a[166:167], v6 offset:14336
  v_rcp_f32 v25, v25
  v_mfma_f32_16x16x32_bf16 v[84:87], a[168:171], a[148:151], v[84:87]
  v_fma_f32 v26, v26, v21, v21
  v_rcp_f32 v26, v26
  v_mfma_f32_16x16x32_bf16 v[80:83], a[168:171], a[144:147], v[80:83]
  ds_read_b64_tr_b16 a[168:169], v7 offset:32768
  v_fma_f32 v27, v27, v21, v21
  v_mul_f32 v56, v56, v24
  v_mfma_f32_16x16x32_bf16 v[80:83], a[172:175], a[128:131], v[80:83]
  s_waitcnt lgkmcnt(5)
  v_rcp_f32 v27, v27
  v_mul_f32 v57, v57, v25
  v_mfma_f32_16x16x32_bf16 v[64:67], a[180:183], a[188:191], v[64:67]
  ds_read_b64_tr_b16 a[170:171], v7 offset:34816
  v_mul_f32 v58, v58, v26
  v_mfma_f32_16x16x32_bf16 v[64:67], a[176:179], a[204:207], v[64:67]
  v_mul_f32 v59, v59, v27
  v_cvt_pk_bf16_f32 v40, v56, v57
  v_cvt_pk_bf16_f32 v41, v58, v59
  v_mfma_f32_16x16x32_bf16 v[68:71], a[176:179], a[208:211], v[68:71]
  ds_read_b64_tr_b16 a[172:173], v7 offset:36864
  v_fma_f32 v44, v44, v22, v28
  v_fma_f32 v45, v45, v22, v29
  v_mfma_f32_16x16x32_bf16 v[68:71], a[180:183], a[192:195], v[68:71]
  s_add_u32 s55, s59, 524288
  buffer_store_dwordx2 v[40:41], v1, s[8:11], s55 offen sc1
  v_mfma_f32_16x16x32_bf16 v[72:75], a[180:183], a[196:199], v[72:75]
  ds_read_b64_tr_b16 a[174:175], v7 offset:38912
  v_exp_f32 v24, v44
  v_mfma_f32_16x16x32_bf16 v[72:75], a[176:179], a[212:215], v[72:75]
  v_exp_f32 v25, v45
  v_fma_f32 v46, v46, v22, v30
  v_mfma_f32_16x16x32_bf16 v[76:79], a[176:179], a[216:219], v[76:79]
  ds_read_b64_tr_b16 a[176:177], v7 offset:40960
  v_exp_f32 v26, v46
  v_mfma_f32_16x16x32_bf16 v[76:79], a[180:183], a[200:203], v[76:79]
  s_waitcnt lgkmcnt(5)
  v_fma_f32 v47, v47, v22, v31
  v_exp_f32 v27, v47
  v_mfma_f32_16x16x32_bf16 v[92:95], a[160:163], a[200:203], v[92:95]
  ds_read_b64_tr_b16 a[178:179], v7 offset:43008
  v_mul_f32 v60, v44, v60
  v_mfma_f32_16x16x32_bf16 v[92:95], a[164:167], a[216:219], v[92:95]
  v_mul_f32 v61, v45, v61
  v_mul_f32 v62, v46, v62
  v_mul_f32 v63, v47, v63
  v_mfma_f32_16x16x32_bf16 v[88:91], a[164:167], a[212:215], v[88:91]
  ds_read_b64_tr_b16 a[180:181], v7 offset:45056
  v_fma_f32 v24, v24, v23, v23
  v_fma_f32 v25, v25, v23, v23
  v_mfma_f32_16x16x32_bf16 v[88:91], a[160:163], a[196:199], v[88:91]
  v_rcp_f32 v24, v24
  v_fma_f32 v26, v26, v23, v23
  v_mfma_f32_16x16x32_bf16 v[84:87], a[160:163], a[192:195], v[84:87]
  ds_read_b64_tr_b16 a[182:183], v7 offset:47104
  v_rcp_f32 v25, v25
  v_mfma_f32_16x16x32_bf16 v[84:87], a[164:167], a[208:211], v[84:87]
  v_rcp_f32 v26, v26
  v_fma_f32 v27, v27, v23, v23
  v_mfma_f32_16x16x32_bf16 v[80:83], a[164:167], a[204:207], v[80:83]
  ds_read_b64_tr_b16 a[164:165], v7 offset:49152
  v_rcp_f32 v27, v27
  v_mfma_f32_16x16x32_bf16 v[80:83], a[160:163], a[188:191], v[80:83]
  s_waitcnt lgkmcnt(5)
  v_mul_f32 v60, v60, v24
  v_mul_f32 v61, v61, v25
  v_mul_f32 v62, v62, v26
  v_mfma_f32_16x16x32_bf16 v[96:99], a[168:171], a[64:67], v[96:99]
  ds_read_b64_tr_b16 a[166:167], v7 offset:51200
  v_mul_f32 v63, v63, v27
  v_mfma_f32_16x16x32_bf16 v[96:99], a[172:175], a[80:83], v[96:99]
  v_cvt_pk_bf16_f32 v44, v60, v61
  v_cvt_pk_bf16_f32 v45, v62, v63
  v_mfma_f32_16x16x32_bf16 v[100:103], a[172:175], a[84:87], v[100:103]
  ds_read_b64_tr_b16 a[160:161], v7 offset:53248
  ds_read_b128 v[60:63], v12 offset:768
  v_mfma_f32_16x16x32_bf16 v[100:103], a[168:171], a[68:71], v[100:103]
  s_add_u32 s55, s59, 786432
  buffer_store_dwordx2 v[44:45], v1, s[8:11], s55 offen sc1
  v_mfma_f32_16x16x32_bf16 v[104:107], a[168:171], a[72:75], v[104:107]
  ds_read_b64_tr_b16 a[162:163], v7 offset:55296
  v_mfma_f32_16x16x32_bf16 v[104:107], a[172:175], a[88:91], v[104:107]
  v_mfma_f32_16x16x32_bf16 v[108:111], a[172:175], a[92:95], v[108:111]
  ds_read_b64_tr_b16 a[172:173], v7 offset:57344
  v_mfma_f32_16x16x32_bf16 v[108:111], a[168:171], a[76:79], v[108:111]
  s_waitcnt lgkmcnt(6)
  v_mfma_f32_16x16x32_bf16 v[124:127], a[176:179], a[76:79], v[124:127]
  ds_read_b64_tr_b16 a[174:175], v7 offset:59392
  s_waitcnt lgkmcnt(3)
  v_fma_f32 v64, v64, v16, v60
  v_mfma_f32_16x16x32_bf16 v[124:127], a[180:183], a[92:95], v[124:127]
  v_exp_f32 v24, v64
  v_mfma_f32_16x16x32_bf16 v[120:123], a[180:183], a[88:91], v[120:123]
  ds_read_b64_tr_b16 a[168:169], v7 offset:61440
  v_fma_f32 v65, v65, v16, v61
  v_fma_f32 v66, v66, v16, v62
  v_mfma_f32_16x16x32_bf16 v[120:123], a[176:179], a[72:75], v[120:123]
  v_exp_f32 v25, v65
  v_mfma_f32_16x16x32_bf16 v[116:119], a[176:179], a[68:71], v[116:119]
  ds_read_b64_tr_b16 a[170:171], v7 offset:63488
  v_exp_f32 v26, v66
  v_mfma_f32_16x16x32_bf16 v[116:119], a[180:183], a[84:87], v[116:119]
  v_fma_f32 v67, v67, v16, v63
  v_fma_f32 v68, v68, v18, v60
  v_mfma_f32_16x16x32_bf16 v[112:115], a[180:183], a[80:83], v[112:115]
  ds_read_b64_tr_b16 a[180:181], v7 offset:16384
  v_exp_f32 v27, v67
  v_mfma_f32_16x16x32_bf16 v[112:115], a[176:179], a[64:67], v[112:115]
  s_waitcnt lgkmcnt(5)
  v_exp_f32 v28, v68
  v_fma_f32 v69, v69, v18, v61
  v_mfma_f32_16x16x32_bf16 v[96:99], a[164:167], a[96:99], v[96:99]
  ds_read_b64_tr_b16 a[182:183], v7 offset:18432
  v_fma_f32 v70, v70, v18, v62
  v_mfma_f32_16x16x32_bf16 v[96:99], a[160:163], a[112:115], v[96:99]
  v_exp_f32 v29, v69
  v_fma_f32 v71, v71, v18, v63
  v_mfma_f32_16x16x32_bf16 v[100:103], a[160:163], a[116:119], v[100:103]
  ds_read_b64_tr_b16 a[176:177], v7 offset:20480
  v_mul_f32 v80, v64, v80
  v_mfma_f32_16x16x32_bf16 v[100:103], a[164:167], a[100:103], v[100:103]
  v_mul_f32 v81, v65, v81
  v_mul_f32 v82, v66, v82
  v_mul_f32 v83, v67, v83
  v_mfma_f32_16x16x32_bf16 v[104:107], a[164:167], a[104:107], v[104:107]
  ds_read_b64_tr_b16 a[178:179], v7 offset:22528
  v_mul_f32 v84, v68, v84
  v_mfma_f32_16x16x32_bf16 v[104:107], a[160:163], a[120:123], v[104:107]
  v_lshrrev_b32 v48, 3, v0
  v_bfe_u32 v49, v48, 1, 2
  v_bfe_u32 v50, v0, 1, 2
  v_mfma_f32_16x16x32_bf16 v[108:111], a[160:163], a[124:127], v[108:111]
  ds_read_b64_tr_b16 a[160:161], v7 offset:24576
  v_xor_b32 v49, v49, v50
  v_mfma_f32_16x16x32_bf16 v[108:111], a[164:167], a[108:111], v[108:111]
  s_waitcnt lgkmcnt(5)
  v_lshlrev_b32 v49, 5, v49
  v_and_b32 v50, 1, v0
  v_lshl_add_u32 v49, v50, 4, v49
  v_mfma_f32_16x16x32_bf16 v[124:127], a[172:175], a[108:111], v[124:127]
  ds_read_b64_tr_b16 a[162:163], v7 offset:26624
  v_exp_f32 v30, v70
  v_mfma_f32_16x16x32_bf16 v[124:127], a[168:171], a[124:127], v[124:127]
  s_lshl_b32 s53, s44, 3
  v_exp_f32 v31, v71
  v_mfma_f32_16x16x32_bf16 v[120:123], a[168:171], a[120:123], v[120:123]
  ds_read_b64_tr_b16 a[164:165], v7 offset:28672
  v_add_u32 v48, s53, v48
  v_lshl_add_u32 v48, v48, 11, v49
  v_mfma_f32_16x16x32_bf16 v[120:123], a[172:175], a[104:107], v[120:123]
  s_mul_i32 s53, s52, 1835008
  s_lshl_b32 s54, s51, 7
  s_add_u32 s53, s53, s54
  v_mfma_f32_16x16x32_bf16 v[116:119], a[172:175], a[100:103], v[116:119]
  ds_read_b64_tr_b16 a[166:167], v7 offset:30720
  v_add_u32 v33, s53, v48
  v_xor_b32 v32, 128, v33
  v_mfma_f32_16x16x32_bf16 v[116:119], a[168:171], a[116:119], v[116:119]
  v_and_b32 v48, 3, v0
  v_bfe_u32 v49, v0, 2, 1
  v_mfma_f32_16x16x32_bf16 v[112:115], a[168:171], a[112:115], v[112:115]
  ds_read_b64_tr_b16 a[168:169], v7 offset:0
  v_lshl_add_u32 v48, v48, 3, v49
  v_lshlrev_b32 v37, 7, v48
  v_mfma_f32_16x16x32_bf16 v[112:115], a[172:175], a[96:99], v[112:115]
  s_waitcnt lgkmcnt(5)
  v_mul_f32 v85, v69, v85
  v_mul_f32 v86, v70, v86
  v_mul_f32 v87, v71, v87
  v_mfma_f32_16x16x32_bf16 v[96:99], a[180:183], a[128:131], v[96:99]
  ds_read_b64_tr_b16 a[170:171], v7 offset:2048
  v_fma_f32 v24, v24, v17, v17
  v_mfma_f32_16x16x32_bf16 v[96:99], a[176:179], a[144:147], v[96:99]
  v_rcp_f32 v24, v24
  v_fma_f32 v25, v25, v17, v17
  v_mfma_f32_16x16x32_bf16 v[100:103], a[176:179], a[148:151], v[100:103]
  ds_read_b64_tr_b16 a[172:173], v7 offset:4096
  v_fma_f32 v26, v26, v17, v17
  v_mfma_f32_16x16x32_bf16 v[100:103], a[180:183], a[132:135], v[100:103]
  v_rcp_f32 v25, v25
  v_fma_f32 v27, v27, v17, v17
  v_mfma_f32_16x16x32_bf16 v[104:107], a[180:183], a[136:139], v[104:107]
  ds_read_b64_tr_b16 a[174:175], v7 offset:6144
  v_fma_f32 v28, v28, v19, v19
  v_mfma_f32_16x16x32_bf16 v[104:107], a[176:179], a[152:155], v[104:107]
  v_rcp_f32 v26, v26
  v_fma_f32 v29, v29, v19, v19
  v_mfma_f32_16x16x32_bf16 v[108:111], a[176:179], a[156:159], v[108:111]
  ds_read_b64_tr_b16 a[176:177], v7 offset:8192
  v_fma_f32 v30, v30, v19, v19
  v_mfma_f32_16x16x32_bf16 v[108:111], a[180:183], a[140:143], v[108:111]
  s_waitcnt lgkmcnt(5)
  v_rcp_f32 v27, v27
  v_fma_f32 v31, v31, v19, v19
  v_mfma_f32_16x16x32_bf16 v[124:127], a[160:163], a[140:143], v[124:127]
  ds_read_b64_tr_b16 a[178:179], v7 offset:10240
  v_rcp_f32 v28, v28
  v_mfma_f32_16x16x32_bf16 v[124:127], a[164:167], a[156:159], v[124:127]
  v_rcp_f32 v29, v29
  v_mfma_f32_16x16x32_bf16 v[120:123], a[164:167], a[152:155], v[120:123]
  ds_read_b64_tr_b16 a[180:181], v7 offset:12288
  s_add_u32 s61, s91, 12288
  v_mul_f32 v80, v80, v24
  v_mfma_f32_16x16x32_bf16 v[120:123], a[160:163], a[136:139], v[120:123]
  buffer_load_dword a253, v13, s[36:39], s61 offen
  v_rcp_f32 v30, v30
  v_mfma_f32_16x16x32_bf16 v[116:119], a[160:163], a[132:135], v[116:119]
  ds_read_b64_tr_b16 a[182:183], v7 offset:14336
  v_rcp_f32 v31, v31
  v_mfma_f32_16x16x32_bf16 v[116:119], a[164:167], a[148:151], v[116:119]
  s_waitcnt vmcnt(19)
  s_barrier
  v_mfma_f32_16x16x32_bf16 v[112:115], a[164:167], a[144:147], v[112:115]
  ds_read_b64_tr_b16 a[164:165], v2 offset:0
  v_mul_f32 v81, v81, v25
  v_mul_f32 v82, v82, v26
  v_mfma_f32_16x16x32_bf16 v[112:115], a[160:163], a[128:131], v[112:115]
  s_waitcnt lgkmcnt(5)
  v_mul_f32 v83, v83, v27
  v_mul_f32 v84, v84, v28
  v_mul_f32 v85, v85, v29
  v_mfma_f32_16x16x32_bf16 v[96:99], a[168:171], a[188:191], v[96:99]
  ds_read_b64_tr_b16 a[166:167], v2 offset:2048
  v_mul_f32 v86, v86, v30
  v_mfma_f32_16x16x32_bf16 v[96:99], a[172:175], a[204:207], v[96:99]
  s_add_u32 m0, s45, 98304
  v_mul_f32 v87, v87, v31
  v_cvt_pk_bf16_f32 v64, v80, v81
  v_cvt_pk_bf16_f32 v65, v82, v83
  v_mfma_f32_16x16x32_bf16 v[100:103], a[172:175], a[208:211], v[100:103]
  ds_read_b64_tr_b16 a[160:161], v2 offset:4096
  v_cvt_pk_bf16_f32 v68, v84, v85
  v_mfma_f32_16x16x32_bf16 v[100:103], a[168:171], a[192:195], v[100:103]
  buffer_load_dwordx4 v10, s[28:31], s70 offen lds
  v_cvt_pk_bf16_f32 v69, v86, v87
  v_fma_f32 v72, v72, v20, v60
  v_fma_f32 v73, v73, v20, v61
  v_mfma_f32_16x16x32_bf16 v[104:107], a[168:171], a[196:199], v[104:107]
  ds_read_b64_tr_b16 a[162:163], v2 offset:6144
  v_fma_f32 v74, v74, v20, v62
  v_mfma_f32_16x16x32_bf16 v[104:107], a[172:175], a[212:215], v[104:107]
  s_add_u32 m0, s45, 106496
  v_exp_f32 v24, v72
  v_fma_f32 v75, v75, v20, v63
  v_mfma_f32_16x16x32_bf16 v[108:111], a[172:175], a[216:219], v[108:111]
  ds_read_b64_tr_b16 a[172:173], v2 offset:8192
  v_fma_f32 v76, v76, v22, v60
  v_mfma_f32_16x16x32_bf16 v[108:111], a[168:171], a[200:203], v[108:111]
  s_waitcnt lgkmcnt(5)
  buffer_load_dwordx4 v10, s[32:35], s70 offen lds
  v_exp_f32 v25, v73
  v_mfma_f32_16x16x32_bf16 v[124:127], a[176:179], a[200:203], v[124:127]
  ds_read_b64_tr_b16 a[174:175], v2 offset:10240
  s_waitcnt vmcnt(8)
  s_barrier
  v_mfma_f32_16x16x32_bf16 v[124:127], a[180:183], a[216:219], v[124:127]
  s_add_u32 m0, s45, 102400
  s_add_u32 s60, s70, 229376
  v_fma_f32 v77, v77, v22, v61
  v_mfma_f32_16x16x32_bf16 v[120:123], a[180:183], a[212:215], v[120:123]
  ds_read_b64_tr_b16 a[168:169], v2 offset:12288
  v_exp_f32 v26, v74
  v_mfma_f32_16x16x32_bf16 v[120:123], a[176:179], a[196:199], v[120:123]
  buffer_load_dwordx4 v10, s[28:31], s60 offen lds
  v_exp_f32 v27, v75
  v_mfma_f32_16x16x32_bf16 v[116:119], a[176:179], a[192:195], v[116:119]
  ds_read_b64_tr_b16 a[170:171], v2 offset:14336
  v_exp_f32 v28, v76
  v_mfma_f32_16x16x32_bf16 v[116:119], a[180:183], a[208:211], v[116:119]
  s_add_u32 m0, s45, 110592
  s_add_u32 s60, s70, 229376
  v_fma_f32 v78, v78, v22, v62
  v_mfma_f32_16x16x32_bf16 v[112:115], a[180:183], a[204:207], v[112:115]
  ds_read_b64_tr_b16 a[180:181], v3 offset:0
  v_exp_f32 v29, v77
  v_mfma_f32_16x16x32_bf16 v[112:115], a[176:179], a[188:191], v[112:115]
  s_waitcnt lgkmcnt(5)
  buffer_load_dwordx4 v10, s[32:35], s60 offen lds
  v_exp_f32 v30, v78
  v_mfma_f32_16x16x32_bf16 v[128:131], a[164:167], a[32:35], v[128:131]
  ds_read_b64_tr_b16 a[182:183], v3 offset:2048
  v_fma_f32 v79, v79, v22, v63
  v_mfma_f32_16x16x32_bf16 v[128:131], a[160:163], a[48:51], v[128:131]
  v_exp_f32 v31, v79
  v_mul_f32 v88, v72, v88
  v_mfma_f32_16x16x32_bf16 v[132:135], a[160:163], a[52:55], v[132:135]
  ds_read_b64_tr_b16 a[176:177], v3 offset:4096
  v_mul_f32 v89, v73, v89
  v_mfma_f32_16x16x32_bf16 v[132:135], a[164:167], a[36:39], v[132:135]
  ds_read_b128 v[60:63], v12 offset:832
  v_mul_f32 v90, v74, v90
  v_mul_f32 v91, v75, v91
  v_mfma_f32_16x16x32_bf16 v[136:139], a[164:167], a[40:43], v[136:139]
  ds_read_b64_tr_b16 a[178:179], v3 offset:6144
  v_mul_f32 v92, v76, v92
  v_mfma_f32_16x16x32_bf16 v[136:139], a[160:163], a[56:59], v[136:139]
  v_mul_f32 v93, v77, v93
  v_mul_f32 v94, v78, v94
  v_mul_f32 v95, v79, v95
  v_mfma_f32_16x16x32_bf16 v[140:143], a[160:163], a[60:63], v[140:143]
  ds_read_b64_tr_b16 a[160:161], v3 offset:8192
  v_fma_f32 v24, v24, v21, v21
  v_mfma_f32_16x16x32_bf16 v[140:143], a[164:167], a[44:47], v[140:143]
  s_waitcnt lgkmcnt(6)
  v_rcp_f32 v24, v24
  v_fma_f32 v25, v25, v21, v21
  v_mfma_f32_16x16x32_bf16 v[156:159], a[172:175], a[44:47], v[156:159]
  ds_read_b64_tr_b16 a[162:163], v3 offset:10240
  v_rcp_f32 v25, v25
  v_mfma_f32_16x16x32_bf16 v[156:159], a[168:171], a[60:63], v[156:159]
  v_fma_f32 v26, v26, v21, v21
  v_fma_f32 v27, v27, v21, v21
  v_mfma_f32_16x16x32_bf16 v[152:155], a[168:171], a[56:59], v[152:155]
  ds_read_b64_tr_b16 a[164:165], v3 offset:12288
  v_rcp_f32 v26, v26
  v_mfma_f32_16x16x32_bf16 v[152:155], a[172:175], a[40:43], v[152:155]
  v_rcp_f32 v27, v27
  v_mfma_f32_16x16x32_bf16 v[148:151], a[172:175], a[36:39], v[148:151]
  ds_read_b64_tr_b16 a[166:167], v3 offset:14336
  v_fma_f32 v28, v28, v23, v23
  v_fma_f32 v29, v29, v23, v23
  v_mfma_f32_16x16x32_bf16 v[148:151], a[168:171], a[52:55], v[148:151]
  v_rcp_f32 v28, v28
  v_mfma_f32_16x16x32_bf16 v[144:147], a[168:171], a[48:51], v[144:147]
  ds_read_b64_tr_b16 a[168:169], v4 offset:0
  v_rcp_f32 v29, v29
  v_mfma_f32_16x16x32_bf16 v[144:147], a[172:175], a[32:35], v[144:147]
  s_waitcnt lgkmcnt(5)
  v_fma_f32 v30, v30, v23, v23
  v_rcp_f32 v30, v30
  v_mfma_f32_16x16x32_bf16 v[160:163], a[180:183], a[32:35], v[160:163]
  ds_read_b64_tr_b16 a[170:171], v4 offset:2048
  v_fma_f32 v31, v31, v23, v23
  v_mfma_f32_16x16x32_bf16 v[160:163], a[176:179], a[48:51], v[160:163]
  v_rcp_f32 v31, v31
  v_mul_f32 v88, v88, v24
  v_mfma_f32_16x16x32_bf16 v[164:167], a[176:179], a[52:55], v[164:167]
  ds_read_b64_tr_b16 a[172:173], v4 offset:4096
  v_mul_f32 v89, v89, v25
  v_mfma_f32_16x16x32_bf16 v[164:167], a[180:183], a[36:39], v[164:167]
  v_mul_f32 v90, v90, v26
  v_mul_f32 v91, v91, v27
  v_mul_f32 v92, v92, v28
  v_mfma_f32_16x16x32_bf16 v[168:171], a[180:183], a[40:43], v[168:171]
  ds_read_b64_tr_b16 a[174:175], v4 offset:6144
  v_mul_f32 v93, v93, v29
  v_mfma_f32_16x16x32_bf16 v[168:171], a[176:179], a[56:59], v[168:171]
  v_mul_f32 v94, v94, v30
  v_mul_f32 v95, v95, v31
  v_cvt_pk_bf16_f32 v72, v88, v89
  v_mfma_f32_16x16x32_bf16 v[172:175], a[176:179], a[60:63], v[172:175]
  ds_read_b64_tr_b16 a[176:177], v4 offset:8192
  v_cvt_pk_bf16_f32 v73, v90, v91
HOP14:
  s_cbranch_execz HOP18
  v_mfma_f32_16x16x32_bf16 v[172:175], a[180:183], a[44:47], v[172:175]
  s_waitcnt lgkmcnt(5)
  v_cvt_pk_bf16_f32 v76, v92, v93
  v_cvt_pk_bf16_f32 v77, v94, v95
  v_mfma_f32_16x16x32_bf16 v[188:191], a[160:163], a[44:47], v[188:191]
  ds_read_b64_tr_b16 a[178:179], v4 offset:10240
  s_cmp_eq_u32 s90, 0
  s_cselect_b32 s71, 8, 1
  s_lshl_b32 s63, s71, 17
  s_lshl_b32 s71, s71, 11
  s_add_u32 s71, s71, s83
  s_add_u32 m0, s45, 114688
  s_waitcnt lgkmcnt(11)
  v_mfma_f32_16x16x32_bf16 v[188:191], a[164:167], a[60:63], v[188:191]
  buffer_load_dwordx4 v32, s[36:39], s63 offen lds
  v_fma_f32 v96, v96, v16, v60
  v_exp_f32 v24, v96
  v_mfma_f32_16x16x32_bf16 v[184:187], a[164:167], a[56:59], v[184:187]
  ds_read_b64_tr_b16 a[180:181], v4 offset:12288
  v_fma_f32 v97, v97, v16, v61
  v_fma_f32 v98, v98, v16, v62
  v_mfma_f32_16x16x32_bf16 v[184:187], a[160:163], a[40:43], v[184:187]
  s_add_u32 m0, s45, 118784
  s_add_u32 s60, s63, 65536
  v_exp_f32 v25, v97
  v_mfma_f32_16x16x32_bf16 v[180:183], a[160:163], a[36:39], v[180:183]
  ds_read_b64_tr_b16 a[182:183], v4 offset:14336
  v_exp_f32 v26, v98
  v_mfma_f32_16x16x32_bf16 v[180:183], a[164:167], a[52:55], v[180:183]
  buffer_load_dwordx4 v32, s[36:39], s60 offen lds
  v_fma_f32 v99, v99, v16, v63
  v_exp_f32 v27, v99
  v_mfma_f32_16x16x32_bf16 v[176:179], a[164:167], a[48:51], v[176:179]
  ds_read_b64_tr_b16 a[164:165], v5 offset:0
  v_fma_f32 v100, v100, v18, v60
  v_fma_f32 v101, v101, v18, v61
  v_mfma_f32_16x16x32_bf16 v[176:179], a[160:163], a[32:35], v[176:179]
  s_waitcnt lgkmcnt(5)
  s_add_u32 m0, s45, 122880
  v_exp_f32 v28, v100
  v_mfma_f32_16x16x32_bf16 v[192:195], a[168:171], a[32:35], v[192:195]
  ds_read_b64_tr_b16 a[166:167], v5 offset:2048
  v_fma_f32 v102, v102, v18, v62
  v_mfma_f32_16x16x32_bf16 v[192:195], a[172:175], a[48:51], v[192:195]
  buffer_load_dwordx4 v33, s[36:39], s63 offen lds
  v_exp_f32 v29, v101
  v_fma_f32 v103, v103, v18, v63
  v_mfma_f32_16x16x32_bf16 v[196:199], a[172:175], a[52:55], v[196:199]
  ds_read_b64_tr_b16 a[160:161], v5 offset:4096
  v_exp_f32 v30, v102
  v_mfma_f32_16x16x32_bf16 v[196:199], a[168:171], a[36:39], v[196:199]
  s_add_u32 m0, s45, 126976
  s_add_u32 s60, s63, 65536
  v_exp_f32 v31, v103
  v_mfma_f32_16x16x32_bf16 v[200:203], a[168:171], a[40:43], v[200:203]
  ds_read_b64_tr_b16 a[162:163], v5 offset:6144
  v_mul_f32 v112, v96, v112
  v_mul_f32 v113, v97, v113
  v_mfma_f32_16x16x32_bf16 v[200:203], a[172:175], a[56:59], v[200:203]
  buffer_load_dwordx4 v33, s[36:39], s60 offen lds
  v_mul_f32 v114, v98, v114
  v_mul_f32 v115, v99, v115
  v_mul_f32 v116, v100, v116
  v_mfma_f32_16x16x32_bf16 v[204:207], a[172:175], a[60:63], v[204:207]
  ds_read_b64_tr_b16 a[172:173], v5 offset:8192
  v_mul_f32 v117, v101, v117
  v_mul_f32 v118, v102, v118
  v_mfma_f32_16x16x32_bf16 v[204:207], a[168:171], a[44:47], v[204:207]
  s_waitcnt lgkmcnt(5)
  s_cmp_eq_u32 s90, 1
  s_cselect_b32 s72, 10, 3
  s_lshl_b32 s64, s72, 17
  s_lshl_b32 s72, s72, 11
  s_add_u32 s72, s72, s83
  s_add_u32 m0, s45, 81920
  v_mul_f32 v119, v103, v119
  v_fma_f32 v24, v24, v17, v17
  v_mfma_f32_16x16x32_bf16 v[220:223], a[176:179], a[44:47], v[220:223]
  ds_read_b64_tr_b16 a[174:175], v5 offset:10240
  v_rcp_f32 v24, v24
  v_mfma_f32_16x16x32_bf16 v[220:223], a[180:183], a[60:63], v[220:223]
  buffer_load_dwordx4 v32, s[36:39], s64 offen lds
  v_fma_f32 v25, v25, v17, v17
  v_rcp_f32 v25, v25
  v_mfma_f32_16x16x32_bf16 v[216:219], a[180:183], a[56:59], v[216:219]
  ds_read_b64_tr_b16 a[168:169], v5 offset:12288
  v_fma_f32 v26, v26, v17, v17
  v_fma_f32 v27, v27, v17, v17
  v_mfma_f32_16x16x32_bf16 v[216:219], a[176:179], a[40:43], v[216:219]
  s_add_u32 m0, s45, 86016
  s_add_u32 s60, s64, 65536
  v_rcp_f32 v26, v26
  v_mfma_f32_16x16x32_bf16 v[212:215], a[176:179], a[36:39], v[212:215]
  ds_read_b64_tr_b16 a[170:171], v5 offset:14336
  v_rcp_f32 v27, v27
  v_mfma_f32_16x16x32_bf16 v[212:215], a[180:183], a[52:55], v[212:215]
  buffer_load_dwordx4 v32, s[36:39], s60 offen lds
  v_fma_f32 v28, v28, v19, v19
  v_rcp_f32 v28, v28
  v_mfma_f32_16x16x32_bf16 v[208:211], a[180:183], a[48:51], v[208:211]
  ds_read_b64_tr_b16 a[180:181], v2 offset:32768
  v_fma_f32 v29, v29, v19, v19
  v_fma_f32 v30, v30, v19, v19
  v_mfma_f32_16x16x32_bf16 v[208:211], a[176:179], a[32:35], v[208:211]
  s_waitcnt lgkmcnt(5)
  s_add_u32 m0, s45, 90112
  v_rcp_f32 v29, v29
  v_mfma_f32_16x16x32_bf16 v[224:227], a[164:167], a[32:35], v[224:227]
  ds_read_b64_tr_b16 a[182:183], v2 offset:34816
  v_fma_f32 v31, v31, v19, v19
  v_mfma_f32_16x16x32_bf16 v[224:227], a[160:163], a[48:51], v[224:227]
  buffer_load_dwordx4 v33, s[36:39], s64 offen lds
  v_rcp_f32 v30, v30
  v_mul_f32 v112, v112, v24
  v_mfma_f32_16x16x32_bf16 v[228:231], a[160:163], a[52:55], v[228:231]
  ds_read_b64_tr_b16 a[176:177], v2 offset:36864
  v_rcp_f32 v31, v31
  v_mfma_f32_16x16x32_bf16 v[228:231], a[164:167], a[36:39], v[228:231]
  s_add_u32 m0, s45, 94208
  s_add_u32 s60, s64, 65536
  v_mul_f32 v113, v113, v25
  v_mul_f32 v114, v114, v26
  v_mfma_f32_16x16x32_bf16 v[232:235], a[164:167], a[40:43], v[232:235]
  ds_read_b64_tr_b16 a[178:179], v2 offset:38912
  v_mul_f32 v115, v115, v27
  v_mul_f32 v116, v116, v28
  v_mfma_f32_16x16x32_bf16 v[232:235], a[160:163], a[56:59], v[232:235]
  buffer_load_dwordx4 v33, s[36:39], s60 offen lds
  v_mul_f32 v117, v117, v29
  v_mul_f32 v118, v118, v30
  v_mul_f32 v119, v119, v31
  v_mfma_f32_16x16x32_bf16 v[236:239], a[160:163], a[60:63], v[236:239]
  ds_read_b64_tr_b16 a[160:161], v2 offset:40960
  v_cvt_pk_bf16_f32 v66, v112, v113
  v_cvt_pk_bf16_f32 v67, v114, v115
  v_mfma_f32_16x16x32_bf16 v[236:239], a[164:167], a[44:47], v[236:239]
  s_waitcnt lgkmcnt(5)
  s_cmp_eq_u32 s90, 2
  s_cselect_b32 s73, 12, 5
  s_lshl_b32 s65, s73, 17
  s_lshl_b32 s73, s73, 11
  s_add_u32 s73, s73, s83
  s_add_u32 m0, s45, 65536
  v_cvt_pk_bf16_f32 v70, v116, v117
  v_cvt_pk_bf16_f32 v71, v118, v119
  v_mfma_f32_16x16x32_bf16 v[252:255], a[172:175], a[44:47], v[252:255]
  ds_read_b64_tr_b16 a[162:163], v2 offset:43008
  v_fma_f32 v104, v104, v20, v60
  v_fma_f32 v105, v105, v20, v61
  v_mfma_f32_16x16x32_bf16 v[252:255], a[168:171], a[60:63], v[252:255]
  buffer_load_dwordx4 v32, s[36:39], s65 offen lds
  buffer_store_dwordx4 v[64:67], v1, s[8:11], s58 offen offset:0 sc1
  v_mfma_f32_16x16x32_bf16 v[248:251], a[168:171], a[56:59], v[248:251]
  ds_read_b64_tr_b16 a[164:165], v2 offset:45056
  v_exp_f32 v24, v104
  v_mfma_f32_16x16x32_bf16 v[248:251], a[172:175], a[40:43], v[248:251]
  s_add_u32 m0, s45, 69632
  s_add_u32 s60, s65, 65536
  v_exp_f32 v25, v105
  v_mfma_f32_16x16x32_bf16 v[244:247], a[172:175], a[36:39], v[244:247]
  ds_read_b64_tr_b16 a[166:167], v2 offset:47104
  s_add_u32 s55, s58, 262144
  buffer_store_dwordx4 v[68:71], v1, s[8:11], s55 offen offset:0 sc1
  v_mfma_f32_16x16x32_bf16 v[244:247], a[168:171], a[52:55], v[244:247]
  buffer_load_dwordx4 v32, s[36:39], s60 offen lds
  v_fma_f32 v106, v106, v20, v62
  v_exp_f32 v26, v106
  v_mfma_f32_16x16x32_bf16 v[240:243], a[168:171], a[48:51], v[240:243]
  ds_read_b64_tr_b16 a[168:169], v2 offset:49152
  v_fma_f32 v107, v107, v20, v63
  v_fma_f32 v108, v108, v22, v60
  v_mfma_f32_16x16x32_bf16 v[240:243], a[172:175], a[32:35], v[240:243]
  s_waitcnt lgkmcnt(5)
  s_add_u32 m0, s45, 73728
  v_exp_f32 v27, v107
  v_mfma_f32_16x16x32_bf16 v[128:131], a[180:183], a[64:67], v[128:131]
  ds_read_b64_tr_b16 a[170:171], v2 offset:51200
  v_fma_f32 v109, v109, v22, v61
  v_mfma_f32_16x16x32_bf16 v[128:131], a[176:179], a[80:83], v[128:131]
  buffer_load_dwordx4 v33, s[36:39], s65 offen lds
  v_exp_f32 v28, v108
  v_fma_f32 v110, v110, v22, v62
  v_mfma_f32_16x16x32_bf16 v[132:135], a[176:179], a[84:87], v[132:135]
  ds_read_b64_tr_b16 a[172:173], v2 offset:53248
  v_exp_f32 v29, v109
  v_mfma_f32_16x16x32_bf16 v[132:135], a[180:183], a[68:71], v[132:135]
  s_add_u32 m0, s45, 77824
  s_add_u32 s60, s65, 65536
  v_exp_f32 v30, v110
  v_mfma_f32_16x16x32_bf16 v[136:139], a[180:183], a[72:75], v[136:139]
  ds_read_b64_tr_b16 a[174:175], v2 offset:55296
  v_fma_f32 v111, v111, v22, v63
  v_mul_f32 v120, v104, v120
  v_mfma_f32_16x16x32_bf16 v[136:139], a[176:179], a[88:91], v[136:139]
  buffer_load_dwordx4 v33, s[36:39], s60 offen lds
  v_exp_f32 v31, v111
  v_mul_f32 v121, v105, v121
  v_mfma_f32_16x16x32_bf16 v[140:143], a[176:179], a[92:95], v[140:143]
  ds_read_b64_tr_b16 a[176:177], v2 offset:57344
  ds_read_b128 v[60:63], v12 offset:512
  v_mfma_f32_16x16x32_bf16 v[140:143], a[180:183], a[76:79], v[140:143]
  s_waitcnt lgkmcnt(6)
  v_mul_f32 v122, v106, v122
  v_mul_f32 v123, v107, v123
  v_mul_f32 v124, v108, v124
  v_mfma_f32_16x16x32_bf16 v[156:159], a[160:163], a[76:79], v[156:159]
  ds_read_b64_tr_b16 a[178:179], v2 offset:59392
  v_mul_f32 v125, v109, v125
  v_mul_f32 v126, v110, v126
  v_mfma_f32_16x16x32_bf16 v[156:159], a[164:167], a[92:95], v[156:159]
  v_mul_f32 v127, v111, v127
  v_fma_f32 v24, v24, v21, v21
  v_fma_f32 v25, v25, v21, v21
  v_mfma_f32_16x16x32_bf16 v[152:155], a[164:167], a[88:91], v[152:155]
  ds_read_b64_tr_b16 a[180:181], v2 offset:61440
  v_rcp_f32 v24, v24
  v_mfma_f32_16x16x32_bf16 v[152:155], a[160:163], a[72:75], v[152:155]
  v_rcp_f32 v25, v25
  v_fma_f32 v26, v26, v21, v21
  v_mfma_f32_16x16x32_bf16 v[148:151], a[160:163], a[68:71], v[148:151]
  ds_read_b64_tr_b16 a[182:183], v2 offset:63488
  v_rcp_f32 v26, v26
  v_mfma_f32_16x16x32_bf16 v[148:151], a[164:167], a[84:87], v[148:151]
  v_fma_f32 v27, v27, v21, v21
  v_rcp_f32 v27, v27
  v_mfma_f32_16x16x32_bf16 v[144:147], a[164:167], a[80:83], v[144:147]
  ds_read_b64_tr_b16 a[164:165], v2 offset:16384
  v_fma_f32 v28, v28, v23, v23
  v_fma_f32 v29, v29, v23, v23
  v_mfma_f32_16x16x32_bf16 v[144:147], a[160:163], a[64:67], v[144:147]
  s_waitcnt lgkmcnt(6)
  v_rcp_f32 v28, v28
  v_fma_f32 v30, v30, v23, v23
  v_mfma_f32_16x16x32_bf16 v[128:131], a[168:171], a[96:99], v[128:131]
  ds_read_b64_tr_b16 a[166:167], v2 offset:18432
  v_fma_f32 v31, v31, v23, v23
  v_mfma_f32_16x16x32_bf16 v[128:131], a[172:175], a[112:115], v[128:131]
  v_rcp_f32 v29, v29
  v_mul_f32 v120, v120, v24
  v_mfma_f32_16x16x32_bf16 v[132:135], a[172:175], a[116:119], v[132:135]
  ds_read_b64_tr_b16 a[160:161], v2 offset:20480
  v_rcp_f32 v30, v30
  v_mfma_f32_16x16x32_bf16 v[132:135], a[168:171], a[100:103], v[132:135]
  v_rcp_f32 v31, v31
  v_mul_f32 v121, v121, v25
  v_mfma_f32_16x16x32_bf16 v[136:139], a[168:171], a[104:107], v[136:139]
  ds_read_b64_tr_b16 a[162:163], v2 offset:22528
  v_mul_f32 v122, v122, v26
  v_mul_f32 v123, v123, v27
  v_mfma_f32_16x16x32_bf16 v[136:139], a[172:175], a[120:123], v[136:139]
  v_mul_f32 v124, v124, v28
  v_mul_f32 v125, v125, v29
  v_mul_f32 v126, v126, v30
  v_mfma_f32_16x16x32_bf16 v[140:143], a[172:175], a[124:127], v[140:143]
  ds_read_b64_tr_b16 a[172:173], v2 offset:24576
  v_mul_f32 v127, v127, v31
  v_cvt_pk_bf16_f32 v74, v120, v121
  v_mfma_f32_16x16x32_bf16 v[140:143], a[168:171], a[108:111], v[140:143]
  s_waitcnt lgkmcnt(5)
  v_cvt_pk_bf16_f32 v75, v122, v123
  v_cvt_pk_bf16_f32 v78, v124, v125
  v_cvt_pk_bf16_f32 v79, v126, v127
  v_mfma_f32_16x16x32_bf16 v[156:159], a[176:179], a[108:111], v[156:159]
  ds_read_b64_tr_b16 a[174:175], v2 offset:26624
  v_mfma_f32_16x16x32_bf16 v[156:159], a[180:183], a[124:127], v[156:159]
  s_add_u32 s55, s58, 524288
  buffer_store_dwordx4 v[72:75], v1, s[8:11], s55 offen offset:0 sc1
  v_mfma_f32_16x16x32_bf16 v[152:155], a[180:183], a[120:123], v[152:155]
  ds_read_b64_tr_b16 a[168:169], v2 offset:28672
  v_mfma_f32_16x16x32_bf16 v[152:155], a[176:179], a[104:107], v[152:155]
  s_add_u32 s55, s58, 786432
  buffer_store_dwordx4 v[76:79], v1, s[8:11], s55 offen offset:0 sc1
  v_mfma_f32_16x16x32_bf16 v[148:151], a[176:179], a[100:103], v[148:151]
  ds_read_b64_tr_b16 a[170:171], v2 offset:30720
  v_mfma_f32_16x16x32_bf16 v[148:151], a[180:183], a[116:119], v[148:151]
  s_waitcnt vmcnt(16)
  s_barrier
  v_mfma_f32_16x16x32_bf16 v[144:147], a[180:183], a[112:115], v[144:147]
  ds_read_b64_tr_b16 a[180:181], v6 offset:32768
  s_cmp_eq_u32 s90, 0
  s_cselect_b32 s74, 1, 8
  s_lshl_b32 s66, s74, 17
  s_lshl_b32 s74, s74, 11
  s_add_u32 s74, s74, s83
  s_add_u32 m0, s45, 0
  v_mfma_f32_16x16x32_bf16 v[144:147], a[176:179], a[96:99], v[144:147]
  s_waitcnt lgkmcnt(5)
  buffer_load_dwordx4 v32, s[36:39], s66 offen lds
  v_mfma_f32_16x16x32_bf16 v[128:131], a[164:167], a[128:131], v[128:131]
  ds_read_b64_tr_b16 a[182:183], v6 offset:34816
  v_mfma_f32_16x16x32_bf16 v[128:131], a[160:163], a[144:147], v[128:131]
  s_add_u32 m0, s45, 4096
  s_add_u32 s60, s66, 65536
  v_mfma_f32_16x16x32_bf16 v[132:135], a[160:163], a[148:151], v[132:135]
  ds_read_b64_tr_b16 a[176:177], v6 offset:36864
  v_mfma_f32_16x16x32_bf16 v[132:135], a[164:167], a[132:135], v[132:135]
  buffer_load_dwordx4 v32, s[36:39], s60 offen lds
  v_mfma_f32_16x16x32_bf16 v[136:139], a[164:167], a[136:139], v[136:139]
  ds_read_b64_tr_b16 a[178:179], v6 offset:38912
  v_mfma_f32_16x16x32_bf16 v[136:139], a[160:163], a[152:155], v[136:139]
  s_add_u32 m0, s45, 8192
  v_mfma_f32_16x16x32_bf16 v[140:143], a[160:163], a[156:159], v[140:143]
  ds_read_b64_tr_b16 a[160:161], v6 offset:40960
  v_mfma_f32_16x16x32_bf16 v[140:143], a[164:167], a[140:143], v[140:143]
  s_waitcnt lgkmcnt(5)
  buffer_load_dwordx4 v33, s[36:39], s66 offen lds
  v_mfma_f32_16x16x32_bf16 v[156:159], a[172:175], a[140:143], v[156:159]
  ds_read_b64_tr_b16 a[162:163], v6 offset:43008
  v_mfma_f32_16x16x32_bf16 v[156:159], a[168:171], a[156:159], v[156:159]
  s_add_u32 m0, s45, 12288
  s_add_u32 s60, s66, 65536
  v_mfma_f32_16x16x32_bf16 v[152:155], a[168:171], a[152:155], v[152:155]
  ds_read_b64_tr_b16 a[164:165], v6 offset:45056
  v_mfma_f32_16x16x32_bf16 v[152:155], a[172:175], a[136:139], v[152:155]
  buffer_load_dwordx4 v33, s[36:39], s60 offen lds
  v_mfma_f32_16x16x32_bf16 v[148:151], a[172:175], a[132:135], v[148:151]
  ds_read_b64_tr_b16 a[166:167], v6 offset:47104
  v_mfma_f32_16x16x32_bf16 v[148:151], a[168:171], a[148:151], v[148:151]
  v_mfma_f32_16x16x32_bf16 v[144:147], a[168:171], a[144:147], v[144:147]
  ds_read_b64_tr_b16 a[168:169], v3 offset:32768
  v_mfma_f32_16x16x32_bf16 v[144:147], a[172:175], a[128:131], v[144:147]
  s_waitcnt lgkmcnt(5)
  v_mfma_f32_16x16x32_bf16 v[128:131], a[180:183], a[188:191], v[128:131]
  ds_read_b64_tr_b16 a[170:171], v3 offset:34816
  v_mfma_f32_16x16x32_bf16 v[128:131], a[176:179], a[204:207], v[128:131]
  v_mfma_f32_16x16x32_bf16 v[132:135], a[176:179], a[208:211], v[132:135]
  ds_read_b64_tr_b16 a[172:173], v3 offset:36864
  v_mfma_f32_16x16x32_bf16 v[132:135], a[180:183], a[192:195], v[132:135]
  v_mfma_f32_16x16x32_bf16 v[136:139], a[180:183], a[196:199], v[136:139]
  ds_read_b64_tr_b16 a[174:175], v3 offset:38912
  v_mfma_f32_16x16x32_bf16 v[136:139], a[176:179], a[212:215], v[136:139]
  v_mfma_f32_16x16x32_bf16 v[140:143], a[176:179], a[216:219], v[140:143]
  ds_read_b64_tr_b16 a[176:177], v3 offset:40960
  v_mfma_f32_16x16x32_bf16 v[140:143], a[180:183], a[200:203], v[140:143]
  s_waitcnt lgkmcnt(5)
  v_mfma_f32_16x16x32_bf16 v[156:159], a[160:163], a[200:203], v[156:159]
  ds_read_b64_tr_b16 a[178:179], v3 offset:43008
  v_mfma_f32_16x16x32_bf16 v[156:159], a[164:167], a[216:219], v[156:159]
  v_mfma_f32_16x16x32_bf16 v[152:155], a[164:167], a[212:215], v[152:155]
  ds_read_b64_tr_b16 a[180:181], v3 offset:45056
  v_mfma_f32_16x16x32_bf16 v[152:155], a[160:163], a[196:199], v[152:155]
  v_mfma_f32_16x16x32_bf16 v[148:151], a[160:163], a[192:195], v[148:151]
  ds_read_b64_tr_b16 a[182:183], v3 offset:47104
  v_mfma_f32_16x16x32_bf16 v[148:151], a[164:167], a[208:211], v[148:151]
  v_mfma_f32_16x16x32_bf16 v[144:147], a[164:167], a[204:207], v[144:147]
  ds_read_b64_tr_b16 a[164:165], v3 offset:49152
  v_mfma_f32_16x16x32_bf16 v[144:147], a[160:163], a[188:191], v[144:147]
  s_waitcnt lgkmcnt(5)
  v_mfma_f32_16x16x32_bf16 v[160:163], a[168:171], a[64:67], v[160:163]
  ds_read_b64_tr_b16 a[166:167], v3 offset:51200
  v_mfma_f32_16x16x32_bf16 v[160:163], a[172:175], a[80:83], v[160:163]
  v_mfma_f32_16x16x32_bf16 v[164:167], a[172:175], a[84:87], v[164:167]
  ds_read_b64_tr_b16 a[160:161], v3 offset:53248
  s_waitcnt lgkmcnt(15)
  v_mfma_f32_16x16x32_bf16 v[164:167], a[168:171], a[68:71], v[164:167]
  v_fma_f32 v128, v128, v16, v60
  v_fma_f32 v129, v129, v16, v61
  v_mfma_f32_16x16x32_bf16 v[168:171], a[168:171], a[72:75], v[168:171]
  ds_read_b64_tr_b16 a[162:163], v3 offset:55296
  v_fma_f32 v130, v130, v16, v62
  v_mfma_f32_16x16x32_bf16 v[168:171], a[172:175], a[88:91], v[168:171]
  v_exp_f32 v24, v128
  v_mfma_f32_16x16x32_bf16 v[172:175], a[172:175], a[92:95], v[172:175]
  ds_read_b64_tr_b16 a[172:173], v3 offset:57344
  v_fma_f32 v131, v131, v16, v63
  v_mfma_f32_16x16x32_bf16 v[172:175], a[168:171], a[76:79], v[172:175]
  s_waitcnt lgkmcnt(5)
  v_exp_f32 v25, v129
  v_mfma_f32_16x16x32_bf16 v[188:191], a[176:179], a[76:79], v[188:191]
  ds_read_b64_tr_b16 a[174:175], v3 offset:59392
  v_fma_f32 v132, v132, v18, v60
  v_mfma_f32_16x16x32_bf16 v[188:191], a[180:183], a[92:95], v[188:191]
  v_exp_f32 v26, v130
  v_mfma_f32_16x16x32_bf16 v[184:187], a[180:183], a[88:91], v[184:187]
  ds_read_b64_tr_b16 a[168:169], v3 offset:61440
  v_fma_f32 v133, v133, v18, v61
  v_mfma_f32_16x16x32_bf16 v[184:187], a[176:179], a[72:75], v[184:187]
  v_exp_f32 v27, v131
  v_mfma_f32_16x16x32_bf16 v[180:183], a[176:179], a[68:71], v[180:183]
  ds_read_b64_tr_b16 a[170:171], v3 offset:63488
  v_fma_f32 v134, v134, v18, v62
  v_mfma_f32_16x16x32_bf16 v[180:183], a[180:183], a[84:87], v[180:183]
  v_exp_f32 v28, v132
  v_mfma_f32_16x16x32_bf16 v[176:179], a[180:183], a[80:83], v[176:179]
  ds_read_b64_tr_b16 a[180:181], v3 offset:16384
  v_fma_f32 v135, v135, v18, v63
  v_mfma_f32_16x16x32_bf16 v[176:179], a[176:179], a[64:67], v[176:179]
  s_waitcnt lgkmcnt(5)
  v_exp_f32 v29, v133
  v_mul_f32 v144, v128, v144
  v_mfma_f32_16x16x32_bf16 v[160:163], a[164:167], a[96:99], v[160:163]
  ds_read_b64_tr_b16 a[182:183], v3 offset:18432
  v_mul_f32 v145, v129, v145
  v_mfma_f32_16x16x32_bf16 v[160:163], a[160:163], a[112:115], v[160:163]
  v_exp_f32 v30, v134
  v_mfma_f32_16x16x32_bf16 v[164:167], a[160:163], a[116:119], v[164:167]
  ds_read_b64_tr_b16 a[176:177], v3 offset:20480
  v_mul_f32 v146, v130, v146
  v_mfma_f32_16x16x32_bf16 v[164:167], a[164:167], a[100:103], v[164:167]
  v_exp_f32 v31, v135
  v_mfma_f32_16x16x32_bf16 v[168:171], a[164:167], a[104:107], v[168:171]
  ds_read_b64_tr_b16 a[178:179], v3 offset:22528
  v_add_u32 v38, s46, v0
  s_waitcnt vmcnt(4)
  s_barrier
  s_mov_b64 exec, 1
  buffer_store_dword v38, v0, s[8:11], s79 offen offset:0 sc1
  s_mov_b64 exec, -1
  v_mfma_f32_16x16x32_bf16 v[168:171], a[160:163], a[120:123], v[168:171]
  v_mul_f32 v147, v131, v147
  v_mul_f32 v148, v132, v148
  v_mfma_f32_16x16x32_bf16 v[172:175], a[160:163], a[124:127], v[172:175]
  ds_read_b64_tr_b16 a[160:161], v3 offset:24576
  v_mul_f32 v149, v133, v149
  v_mfma_f32_16x16x32_bf16 v[172:175], a[164:167], a[108:111], v[172:175]
  s_waitcnt lgkmcnt(5)
  v_mul_f32 v150, v134, v150
  v_mul_f32 v151, v135, v151
  v_mfma_f32_16x16x32_bf16 v[188:191], a[172:175], a[108:111], v[188:191]
  ds_read_b64_tr_b16 a[162:163], v3 offset:26624
  v_fma_f32 v24, v24, v17, v17
  v_mfma_f32_16x16x32_bf16 v[188:191], a[168:171], a[124:127], v[188:191]
  v_rcp_f32 v24, v24
  v_mfma_f32_16x16x32_bf16 v[184:187], a[168:171], a[120:123], v[184:187]
  ds_read_b64_tr_b16 a[164:165], v3 offset:28672
  v_fma_f32 v25, v25, v17, v17
  v_mfma_f32_16x16x32_bf16 v[184:187], a[172:175], a[104:107], v[184:187]
  v_rcp_f32 v25, v25
  v_mfma_f32_16x16x32_bf16 v[180:183], a[172:175], a[100:103], v[180:183]
  ds_read_b64_tr_b16 a[166:167], v3 offset:30720
  v_fma_f32 v26, v26, v17, v17
  v_mfma_f32_16x16x32_bf16 v[180:183], a[168:171], a[116:119], v[180:183]
  v_rcp_f32 v26, v26
  v_mfma_f32_16x16x32_bf16 v[176:179], a[168:171], a[112:115], v[176:179]
  ds_read_b64_tr_b16 a[168:169], v7 offset:32768
  v_fma_f32 v27, v27, v17, v17
  v_mfma_f32_16x16x32_bf16 v[176:179], a[172:175], a[96:99], v[176:179]
  s_waitcnt lgkmcnt(5)
  v_rcp_f32 v27, v27
  v_fma_f32 v28, v28, v19, v19
  v_mfma_f32_16x16x32_bf16 v[160:163], a[180:183], a[128:131], v[160:163]
  ds_read_b64_tr_b16 a[170:171], v7 offset:34816
  v_fma_f32 v29, v29, v19, v19
  v_mfma_f32_16x16x32_bf16 v[160:163], a[176:179], a[144:147], v[160:163]
  v_rcp_f32 v28, v28
  v_mfma_f32_16x16x32_bf16 v[164:167], a[176:179], a[148:151], v[164:167]
  ds_read_b64_tr_b16 a[172:173], v7 offset:36864
  v_fma_f32 v30, v30, v19, v19
  v_mfma_f32_16x16x32_bf16 v[164:167], a[180:183], a[132:135], v[164:167]
  v_rcp_f32 v29, v29
  v_mfma_f32_16x16x32_bf16 v[168:171], a[180:183], a[136:139], v[168:171]
  ds_read_b64_tr_b16 a[174:175], v7 offset:38912
  v_fma_f32 v31, v31, v19, v19
  v_mfma_f32_16x16x32_bf16 v[168:171], a[176:179], a[152:155], v[168:171]
  v_rcp_f32 v30, v30
  v_mfma_f32_16x16x32_bf16 v[172:175], a[176:179], a[156:159], v[172:175]
  ds_read_b64_tr_b16 a[176:177], v7 offset:40960
  v_mul_f32 v144, v144, v24
  v_mfma_f32_16x16x32_bf16 v[172:175], a[180:183], a[140:143], v[172:175]
  s_waitcnt lgkmcnt(5)
  v_rcp_f32 v31, v31
  v_mfma_f32_16x16x32_bf16 v[188:191], a[160:163], a[140:143], v[188:191]
  ds_read_b64_tr_b16 a[178:179], v7 offset:43008
  v_mul_f32 v145, v145, v25
  v_mfma_f32_16x16x32_bf16 v[188:191], a[164:167], a[156:159], v[188:191]
  v_mul_f32 v146, v146, v26
  v_mul_f32 v147, v147, v27
  v_mfma_f32_16x16x32_bf16 v[184:187], a[164:167], a[152:155], v[184:187]
  ds_read_b64_tr_b16 a[180:181], v7 offset:45056
  v_mul_f32 v148, v148, v28
  v_mfma_f32_16x16x32_bf16 v[184:187], a[160:163], a[136:139], v[184:187]
  v_mul_f32 v149, v149, v29
  v_mul_f32 v150, v150, v30
  v_mfma_f32_16x16x32_bf16 v[180:183], a[160:163], a[132:135], v[180:183]
  ds_read_b64_tr_b16 a[182:183], v7 offset:47104
  v_mul_f32 v151, v151, v31
  v_mfma_f32_16x16x32_bf16 v[180:183], a[164:167], a[148:151], v[180:183]
  v_cvt_pk_bf16_f32 v128, v144, v145
  v_cvt_pk_bf16_f32 v129, v146, v147
  v_mfma_f32_16x16x32_bf16 v[176:179], a[164:167], a[144:147], v[176:179]
  ds_read_b64_tr_b16 a[164:165], v4 offset:32768
  v_cvt_pk_bf16_f32 v132, v148, v149
  v_mfma_f32_16x16x32_bf16 v[176:179], a[160:163], a[128:131], v[176:179]
  s_waitcnt lgkmcnt(5)
  v_cvt_pk_bf16_f32 v133, v150, v151
  v_fma_f32 v136, v136, v20, v60
  v_fma_f32 v137, v137, v20, v61
  v_mfma_f32_16x16x32_bf16 v[160:163], a[168:171], a[188:191], v[160:163]
  ds_read_b64_tr_b16 a[166:167], v4 offset:34816
  v_fma_f32 v138, v138, v20, v62
  v_mfma_f32_16x16x32_bf16 v[160:163], a[172:175], a[204:207], v[160:163]
  v_exp_f32 v24, v136
  v_mfma_f32_16x16x32_bf16 v[164:167], a[172:175], a[208:211], v[164:167]
  ds_read_b64_tr_b16 a[160:161], v4 offset:36864
  v_fma_f32 v139, v139, v20, v63
  v_mfma_f32_16x16x32_bf16 v[164:167], a[168:171], a[192:195], v[164:167]
  v_exp_f32 v25, v137
  v_mfma_f32_16x16x32_bf16 v[168:171], a[168:171], a[196:199], v[168:171]
  ds_read_b64_tr_b16 a[162:163], v4 offset:38912
  v_fma_f32 v140, v140, v22, v60
  v_mfma_f32_16x16x32_bf16 v[168:171], a[172:175], a[212:215], v[168:171]
  v_exp_f32 v26, v138
  v_mfma_f32_16x16x32_bf16 v[172:175], a[172:175], a[216:219], v[172:175]
  ds_read_b64_tr_b16 a[172:173], v4 offset:40960
  v_fma_f32 v141, v141, v22, v61
  v_mfma_f32_16x16x32_bf16 v[172:175], a[168:171], a[200:203], v[172:175]
  s_waitcnt lgkmcnt(5)
  v_exp_f32 v27, v139
  v_mfma_f32_16x16x32_bf16 v[188:191], a[176:179], a[200:203], v[188:191]
  ds_read_b64_tr_b16 a[174:175], v4 offset:43008
  v_fma_f32 v142, v142, v22, v62
  v_mfma_f32_16x16x32_bf16 v[188:191], a[180:183], a[216:219], v[188:191]
  v_exp_f32 v28, v140
  v_mfma_f32_16x16x32_bf16 v[184:187], a[180:183], a[212:215], v[184:187]
  ds_read_b64_tr_b16 a[168:169], v4 offset:45056
  v_fma_f32 v143, v143, v22, v63
  v_mfma_f32_16x16x32_bf16 v[184:187], a[176:179], a[196:199], v[184:187]
  v_exp_f32 v29, v141
  v_mfma_f32_16x16x32_bf16 v[180:183], a[176:179], a[192:195], v[180:183]
  ds_read_b64_tr_b16 a[170:171], v4 offset:47104
  v_mul_f32 v152, v136, v152
  v_mfma_f32_16x16x32_bf16 v[180:183], a[180:183], a[208:211], v[180:183]
  v_exp_f32 v30, v142
  v_mfma_f32_16x16x32_bf16 v[176:179], a[180:183], a[204:207], v[176:179]
  ds_read_b64_tr_b16 a[180:181], v4 offset:49152
  v_mul_f32 v153, v137, v153
  v_mfma_f32_16x16x32_bf16 v[176:179], a[176:179], a[188:191], v[176:179]
  s_waitcnt lgkmcnt(5)
  v_exp_f32 v31, v143
  v_mul_f32 v154, v138, v154
  v_mfma_f32_16x16x32_bf16 v[192:195], a[164:167], a[64:67], v[192:195]
  ds_read_b64_tr_b16 a[182:183], v4 offset:51200
  ds_read_b128 v[60:63], v12 offset:576
  v_mfma_f32_16x16x32_bf16 v[192:195], a[160:163], a[80:83], v[192:195]
  v_mul_f32 v155, v139, v155
  v_mul_f32 v156, v140, v156
  v_mfma_f32_16x16x32_bf16 v[196:199], a[160:163], a[84:87], v[196:199]
  ds_read_b64_tr_b16 a[176:177], v4 offset:53248
  v_mul_f32 v157, v141, v157
  v_mfma_f32_16x16x32_bf16 v[196:199], a[164:167], a[68:71], v[196:199]
  v_mul_f32 v158, v142, v158
  v_mul_f32 v159, v143, v159
  v_mfma_f32_16x16x32_bf16 v[200:203], a[164:167], a[72:75], v[200:203]
  ds_read_b64_tr_b16 a[178:179], v4 offset:55296
  v_fma_f32 v24, v24, v21, v21
  v_mfma_f32_16x16x32_bf16 v[200:203], a[160:163], a[88:91], v[200:203]
  v_rcp_f32 v24, v24
  v_mfma_f32_16x16x32_bf16 v[204:207], a[160:163], a[92:95], v[204:207]
  ds_read_b64_tr_b16 a[160:161], v4 offset:57344
  v_fma_f32 v25, v25, v21, v21
  v_mfma_f32_16x16x32_bf16 v[204:207], a[164:167], a[76:79], v[204:207]
  s_waitcnt lgkmcnt(6)
  v_rcp_f32 v25, v25
  v_mfma_f32_16x16x32_bf16 v[220:223], a[172:175], a[76:79], v[220:223]
  ds_read_b64_tr_b16 a[162:163], v4 offset:59392
  v_fma_f32 v26, v26, v21, v21
  v_mfma_f32_16x16x32_bf16 v[220:223], a[168:171], a[92:95], v[220:223]
  v_rcp_f32 v26, v26
  v_mfma_f32_16x16x32_bf16 v[216:219], a[168:171], a[88:91], v[216:219]
  ds_read_b64_tr_b16 a[164:165], v4 offset:61440
  v_fma_f32 v27, v27, v21, v21
  v_mfma_f32_16x16x32_bf16 v[216:219], a[172:175], a[72:75], v[216:219]
  v_rcp_f32 v27, v27
  v_mfma_f32_16x16x32_bf16 v[212:215], a[172:175], a[68:71], v[212:215]
  ds_read_b64_tr_b16 a[166:167], v4 offset:63488
  v_fma_f32 v28, v28, v23, v23
  v_mfma_f32_16x16x32_bf16 v[212:215], a[168:171], a[84:87], v[212:215]
  v_rcp_f32 v28, v28
  v_mfma_f32_16x16x32_bf16 v[208:211], a[168:171], a[80:83], v[208:211]
  ds_read_b64_tr_b16 a[168:169], v4 offset:16384
  v_fma_f32 v29, v29, v23, v23
  v_mfma_f32_16x16x32_bf16 v[208:211], a[172:175], a[64:67], v[208:211]
  s_waitcnt lgkmcnt(5)
  v_rcp_f32 v29, v29
  v_fma_f32 v30, v30, v23, v23
  v_mfma_f32_16x16x32_bf16 v[192:195], a[180:183], a[96:99], v[192:195]
  ds_read_b64_tr_b16 a[170:171], v4 offset:18432
  v_fma_f32 v31, v31, v23, v23
  v_mfma_f32_16x16x32_bf16 v[192:195], a[176:179], a[112:115], v[192:195]
  v_rcp_f32 v30, v30
  v_mfma_f32_16x16x32_bf16 v[196:199], a[176:179], a[116:119], v[196:199]
  ds_read_b64_tr_b16 a[172:173], v4 offset:20480
  v_mul_f32 v152, v152, v24
  v_mfma_f32_16x16x32_bf16 v[196:199], a[180:183], a[100:103], v[196:199]
  v_rcp_f32 v31, v31
  v_mfma_f32_16x16x32_bf16 v[200:203], a[180:183], a[104:107], v[200:203]
  ds_read_b64_tr_b16 a[174:175], v4 offset:22528
  v_mul_f32 v153, v153, v25
  v_mfma_f32_16x16x32_bf16 v[200:203], a[176:179], a[120:123], v[200:203]
  v_mul_f32 v154, v154, v26
  v_mul_f32 v155, v155, v27
  v_mfma_f32_16x16x32_bf16 v[204:207], a[176:179], a[124:127], v[204:207]
  ds_read_b64_tr_b16 a[176:177], v4 offset:24576
  v_mul_f32 v156, v156, v28
  v_mfma_f32_16x16x32_bf16 v[204:207], a[180:183], a[108:111], v[204:207]
  s_waitcnt lgkmcnt(5)
  v_mul_f32 v157, v157, v29
  v_mul_f32 v158, v158, v30
  v_mfma_f32_16x16x32_bf16 v[220:223], a[160:163], a[108:111], v[220:223]
  ds_read_b64_tr_b16 a[178:179], v4 offset:26624
  v_mul_f32 v159, v159, v31
  v_mfma_f32_16x16x32_bf16 v[220:223], a[164:167], a[124:127], v[220:223]
  v_cvt_pk_bf16_f32 v136, v152, v153
HOP15:
  s_cbranch_execz HOP19
  v_cvt_pk_bf16_f32 v137, v154, v155
  v_mfma_f32_16x16x32_bf16 v[216:219], a[164:167], a[120:123], v[216:219]
  ds_read_b64_tr_b16 a[180:181], v4 offset:28672
  v_cvt_pk_bf16_f32 v140, v156, v157
  v_mfma_f32_16x16x32_bf16 v[216:219], a[160:163], a[104:107], v[216:219]
  v_cvt_pk_bf16_f32 v141, v158, v159
  v_mfma_f32_16x16x32_bf16 v[212:215], a[160:163], a[100:103], v[212:215]
  ds_read_b64_tr_b16 a[182:183], v4 offset:30720
  s_lshl_b32 s82, s44, 28
  s_add_u32 s82, s82, s81
  buffer_load_dword v36, v37, s[8:11], s82 offen sc1
  v_mfma_f32_16x16x32_bf16 v[212:215], a[164:167], a[116:119], v[212:215]
  s_waitcnt lgkmcnt(14)
  v_fma_f32 v160, v160, v16, v60
  v_fma_f32 v161, v161, v16, v61
  v_mfma_f32_16x16x32_bf16 v[208:211], a[164:167], a[112:115], v[208:211]
  ds_read_b64_tr_b16 a[164:165], v8 offset:32768
  v_fma_f32 v162, v162, v16, v62
  v_mfma_f32_16x16x32_bf16 v[208:211], a[160:163], a[96:99], v[208:211]
  s_waitcnt lgkmcnt(5)
  v_exp_f32 v24, v160
  v_fma_f32 v163, v163, v16, v63
  v_mfma_f32_16x16x32_bf16 v[192:195], a[168:171], a[128:131], v[192:195]
  ds_read_b64_tr_b16 a[166:167], v8 offset:34816
  v_fma_f32 v164, v164, v18, v60
  v_mfma_f32_16x16x32_bf16 v[192:195], a[172:175], a[144:147], v[192:195]
  v_exp_f32 v25, v161
  v_mfma_f32_16x16x32_bf16 v[196:199], a[172:175], a[148:151], v[196:199]
  ds_read_b64_tr_b16 a[160:161], v8 offset:36864
  v_fma_f32 v165, v165, v18, v61
  v_mfma_f32_16x16x32_bf16 v[196:199], a[168:171], a[132:135], v[196:199]
  v_exp_f32 v26, v162
  v_fma_f32 v166, v166, v18, v62
  v_mfma_f32_16x16x32_bf16 v[200:203], a[168:171], a[136:139], v[200:203]
  ds_read_b64_tr_b16 a[162:163], v8 offset:38912
  v_fma_f32 v167, v167, v18, v63
  v_mfma_f32_16x16x32_bf16 v[200:203], a[172:175], a[152:155], v[200:203]
  v_exp_f32 v27, v163
  v_mfma_f32_16x16x32_bf16 v[204:207], a[172:175], a[156:159], v[204:207]
  ds_read_b64_tr_b16 a[172:173], v8 offset:40960
  v_mul_f32 v176, v160, v176
  v_mfma_f32_16x16x32_bf16 v[204:207], a[168:171], a[140:143], v[204:207]
  s_waitcnt lgkmcnt(5)
  v_exp_f32 v28, v164
  v_mul_f32 v177, v161, v177
  v_mfma_f32_16x16x32_bf16 v[220:223], a[176:179], a[140:143], v[220:223]
  ds_read_b64_tr_b16 a[174:175], v8 offset:43008
  v_mul_f32 v178, v162, v178
  v_mfma_f32_16x16x32_bf16 v[220:223], a[180:183], a[156:159], v[220:223]
  v_exp_f32 v29, v165
  v_mfma_f32_16x16x32_bf16 v[216:219], a[180:183], a[152:155], v[216:219]
  ds_read_b64_tr_b16 a[168:169], v8 offset:45056
  v_mul_f32 v179, v163, v179
  v_mfma_f32_16x16x32_bf16 v[216:219], a[176:179], a[136:139], v[216:219]
  v_exp_f32 v30, v166
  v_mul_f32 v180, v164, v180
  v_mfma_f32_16x16x32_bf16 v[212:215], a[176:179], a[132:135], v[212:215]
  ds_read_b64_tr_b16 a[170:171], v8 offset:47104
  v_mul_f32 v181, v165, v181
  v_mfma_f32_16x16x32_bf16 v[212:215], a[180:183], a[148:151], v[212:215]
  v_exp_f32 v31, v167
  v_mfma_f32_16x16x32_bf16 v[208:211], a[180:183], a[144:147], v[208:211]
  ds_read_b64_tr_b16 a[180:181], v5 offset:32768
  v_mul_f32 v182, v166, v182
  v_mfma_f32_16x16x32_bf16 v[208:211], a[176:179], a[128:131], v[208:211]
  s_waitcnt lgkmcnt(5)
  v_mul_f32 v183, v167, v183
  v_fma_f32 v24, v24, v17, v17
  v_fma_f32 v25, v25, v17, v17
  v_mfma_f32_16x16x32_bf16 v[192:195], a[164:167], a[188:191], v[192:195]
  ds_read_b64_tr_b16 a[182:183], v5 offset:34816
  v_fma_f32 v26, v26, v17, v17
  v_mfma_f32_16x16x32_bf16 v[192:195], a[160:163], a[204:207], v[192:195]
  v_rcp_f32 v24, v24
  v_mfma_f32_16x16x32_bf16 v[196:199], a[160:163], a[208:211], v[196:199]
  ds_read_b64_tr_b16 a[176:177], v5 offset:36864
  v_fma_f32 v27, v27, v17, v17
  v_mfma_f32_16x16x32_bf16 v[196:199], a[164:167], a[192:195], v[196:199]
  v_rcp_f32 v25, v25
  v_fma_f32 v28, v28, v19, v19
  v_mfma_f32_16x16x32_bf16 v[200:203], a[164:167], a[196:199], v[200:203]
  ds_read_b64_tr_b16 a[178:179], v5 offset:38912
  v_fma_f32 v29, v29, v19, v19
  v_mfma_f32_16x16x32_bf16 v[200:203], a[160:163], a[212:215], v[200:203]
  v_rcp_f32 v26, v26
  v_mfma_f32_16x16x32_bf16 v[204:207], a[160:163], a[216:219], v[204:207]
  ds_read_b64_tr_b16 a[160:161], v5 offset:40960
  v_fma_f32 v30, v30, v19, v19
  v_mfma_f32_16x16x32_bf16 v[204:207], a[164:167], a[200:203], v[204:207]
  s_waitcnt lgkmcnt(5)
  v_rcp_f32 v27, v27
  v_fma_f32 v31, v31, v19, v19
  v_mfma_f32_16x16x32_bf16 v[220:223], a[172:175], a[200:203], v[220:223]
  ds_read_b64_tr_b16 a[162:163], v5 offset:43008
  v_mul_f32 v176, v176, v24
  v_mfma_f32_16x16x32_bf16 v[220:223], a[168:171], a[216:219], v[220:223]
  v_rcp_f32 v28, v28
  v_mfma_f32_16x16x32_bf16 v[216:219], a[168:171], a[212:215], v[216:219]
  ds_read_b64_tr_b16 a[164:165], v5 offset:45056
  v_mul_f32 v177, v177, v25
  v_mfma_f32_16x16x32_bf16 v[216:219], a[172:175], a[196:199], v[216:219]
  v_rcp_f32 v29, v29
  v_mul_f32 v178, v178, v26
  v_mfma_f32_16x16x32_bf16 v[212:215], a[172:175], a[192:195], v[212:215]
  ds_read_b64_tr_b16 a[166:167], v5 offset:47104
  v_mul_f32 v179, v179, v27
  v_mfma_f32_16x16x32_bf16 v[212:215], a[168:171], a[208:211], v[212:215]
  v_rcp_f32 v30, v30
  v_mfma_f32_16x16x32_bf16 v[208:211], a[168:171], a[204:207], v[208:211]
  ds_read_b64_tr_b16 a[168:169], v5 offset:49152
  v_mul_f32 v180, v180, v28
  v_mfma_f32_16x16x32_bf16 v[208:211], a[172:175], a[188:191], v[208:211]
  s_waitcnt lgkmcnt(5)
  v_rcp_f32 v31, v31
  v_mul_f32 v181, v181, v29
  v_mfma_f32_16x16x32_bf16 v[224:227], a[180:183], a[64:67], v[224:227]
  ds_read_b64_tr_b16 a[170:171], v5 offset:51200
  v_mul_f32 v182, v182, v30
  v_mfma_f32_16x16x32_bf16 v[224:227], a[176:179], a[80:83], v[224:227]
  v_mul_f32 v183, v183, v31
  v_cvt_pk_bf16_f32 v130, v176, v177
  v_mfma_f32_16x16x32_bf16 v[228:231], a[176:179], a[84:87], v[228:231]
  ds_read_b64_tr_b16 a[172:173], v5 offset:53248
  v_cvt_pk_bf16_f32 v131, v178, v179
  v_mfma_f32_16x16x32_bf16 v[228:231], a[180:183], a[68:71], v[228:231]
  buffer_store_dwordx4 v[128:131], v1, s[8:11], s57 offen offset:0 sc1
  v_mfma_f32_16x16x32_bf16 v[232:235], a[180:183], a[72:75], v[232:235]
  ds_read_b64_tr_b16 a[174:175], v5 offset:55296
  s_waitcnt vmcnt(1)
  s_cmp_lg_u32 s44, 0
  s_cbranch_scc1 PL12_adaLN_cond__sliding_local_dilated__swiglu_ffn__prompt_kernelx
  v_cmp_ne_u32 vcc, s46, v36
  s_nop 4
  s_cbranch_vccz PL12_adaLN_cond__sliding_local_dilated__swiglu_ffn__prompt_kernelx
  s_mov_b32 s82, 60000
PL12_adaLN_cond__sliding_local_dilated__swiglu_ffn__prompt_kernel:
  buffer_load_dword v36, v37, s[8:11], s81 offen sc1
  s_sub_u32 s82, s82, 1
  s_cmp_eq_u32 s82, 0
  s_waitcnt vmcnt(0)
  s_cbranch_scc1 PL12_adaLN_cond__sliding_local_dilated__swiglu_ffn__prompt_kernelx
  v_cmp_ne_u32 vcc, s46, v36
  s_nop 4
  s_cbranch_vccnz PL12_adaLN_cond__sliding_local_dilated__swiglu_ffn__prompt_kernel
PL12_adaLN_cond__sliding_local_dilated__swiglu_ffn__prompt_kernelx:
  s_barrier
  v_mfma_f32_16x16x32_bf16 v[232:235], a[176:179], a[88:91], v[232:235]
  v_cvt_pk_bf16_f32 v134, v180, v181
  v_cvt_pk_bf16_f32 v135, v182, v183
  v_mfma_f32_16x16x32_bf16 v[236:239], a[176:179], a[92:95], v[236:239]
  ds_read_b64_tr_b16 a[176:177], v5 offset:57344
  v_fma_f32 v168, v168, v20, v60
  v_mfma_f32_16x16x32_bf16 v[236:239], a[180:183], a[76:79], v[236:239]
  s_waitcnt lgkmcnt(5)
  buffer_load_dwordx4 a[220:223], v1, s[8:11], s71 offen offset:0 sc1
  v_exp_f32 v24, v168
  v_mfma_f32_16x16x32_bf16 v[252:255], a[160:163], a[76:79], v[252:255]
  ds_read_b64_tr_b16 a[178:179], v5 offset:59392
  s_add_u32 s55, s57, 262144
  buffer_store_dwordx4 v[132:135], v1, s[8:11], s55 offen offset:0 sc1
  v_mfma_f32_16x16x32_bf16 v[252:255], a[164:167], a[92:95], v[252:255]
  v_fma_f32 v169, v169, v20, v61
  v_fma_f32 v170, v170, v20, v62
  v_mfma_f32_16x16x32_bf16 v[248:251], a[164:167], a[88:91], v[248:251]
  ds_read_b64_tr_b16 a[180:181], v5 offset:61440
  v_fma_f32 v171, v171, v20, v63
  v_mfma_f32_16x16x32_bf16 v[248:251], a[160:163], a[72:75], v[248:251]
  buffer_load_dwordx4 a[236:239], v1, s[8:11], s71 offen offset:1024 sc1
  v_exp_f32 v25, v169
  v_fma_f32 v172, v172, v22, v60
  v_mfma_f32_16x16x32_bf16 v[244:247], a[160:163], a[68:71], v[244:247]
  ds_read_b64_tr_b16 a[182:183], v5 offset:63488
  v_fma_f32 v173, v173, v22, v61
  v_mfma_f32_16x16x32_bf16 v[244:247], a[164:167], a[84:87], v[244:247]
  s_add_u32 s71, s71, 131072
  v_exp_f32 v26, v170
  v_mfma_f32_16x16x32_bf16 v[240:243], a[164:167], a[80:83], v[240:243]
  ds_read_b64_tr_b16 a[164:165], v5 offset:16384
  v_fma_f32 v174, v174, v22, v62
  v_mfma_f32_16x16x32_bf16 v[240:243], a[160:163], a[64:67], v[240:243]
  s_waitcnt lgkmcnt(5)
  buffer_load_dwordx4 a[224:227], v1, s[8:11], s71 offen offset:0 sc1
  v_exp_f32 v27, v171
  v_mfma_f32_16x16x32_bf16 v[224:227], a[168:171], a[96:99], v[224:227]
  ds_read_b64_tr_b16 a[166:167], v5 offset:18432
  v_fma_f32 v175, v175, v22, v63
  v_mfma_f32_16x16x32_bf16 v[224:227], a[172:175], a[112:115], v[224:227]
  v_exp_f32 v28, v172
  v_mfma_f32_16x16x32_bf16 v[228:231], a[172:175], a[116:119], v[228:231]
  ds_read_b64_tr_b16 a[160:161], v5 offset:20480
  v_mul_f32 v184, v168, v184
  v_mfma_f32_16x16x32_bf16 v[228:231], a[168:171], a[100:103], v[228:231]
  buffer_load_dwordx4 a[240:243], v1, s[8:11], s71 offen offset:1024 sc1
  v_exp_f32 v29, v173
  v_mul_f32 v185, v169, v185
  v_mfma_f32_16x16x32_bf16 v[232:235], a[168:171], a[104:107], v[232:235]
  ds_read_b64_tr_b16 a[162:163], v5 offset:22528
  v_mul_f32 v186, v170, v186
  v_mfma_f32_16x16x32_bf16 v[232:235], a[172:175], a[120:123], v[232:235]
  s_add_u32 s71, s71, s88
  v_exp_f32 v30, v174
  v_mfma_f32_16x16x32_bf16 v[236:239], a[172:175], a[124:127], v[236:239]
  ds_read_b64_tr_b16 a[172:173], v5 offset:24576
  ds_read_b128 v[60:63], v12 offset:640
  v_mfma_f32_16x16x32_bf16 v[236:239], a[168:171], a[108:111], v[236:239]
  s_waitcnt lgkmcnt(6)
  buffer_load_dwordx4 a[228:231], v1, s[8:11], s71 offen offset:0 sc1
  v_exp_f32 v31, v175
  v_mfma_f32_16x16x32_bf16 v[252:255], a[176:179], a[108:111], v[252:255]
  ds_read_b64_tr_b16 a[174:175], v5 offset:26624
  v_mul_f32 v187, v171, v187
  v_mfma_f32_16x16x32_bf16 v[252:255], a[180:183], a[124:127], v[252:255]
  v_mul_f32 v188, v172, v188
  v_mul_f32 v189, v173, v189
  v_mfma_f32_16x16x32_bf16 v[248:251], a[180:183], a[120:123], v[248:251]
  ds_read_b64_tr_b16 a[168:169], v5 offset:28672
  v_mul_f32 v190, v174, v190
  v_mfma_f32_16x16x32_bf16 v[248:251], a[176:179], a[104:107], v[248:251]
  buffer_load_dwordx4 a[244:247], v1, s[8:11], s71 offen offset:1024 sc1
  v_mul_f32 v191, v175, v191
  v_fma_f32 v24, v24, v21, v21
  v_fma_f32 v25, v25, v21, v21
  v_mfma_f32_16x16x32_bf16 v[244:247], a[176:179], a[100:103], v[244:247]
  ds_read_b64_tr_b16 a[170:171], v5 offset:30720
  v_fma_f32 v26, v26, v21, v21
  v_mfma_f32_16x16x32_bf16 v[244:247], a[180:183], a[116:119], v[244:247]
  s_add_u32 s71, s71, 131072
  v_rcp_f32 v24, v24
  v_mfma_f32_16x16x32_bf16 v[240:243], a[180:183], a[112:115], v[240:243]
  ds_read_b64_tr_b16 a[180:181], v9 offset:32768
  v_fma_f32 v27, v27, v21, v21
  v_mfma_f32_16x16x32_bf16 v[240:243], a[176:179], a[96:99], v[240:243]
  s_waitcnt lgkmcnt(6)
  buffer_load_dwordx4 a[232:235], v1, s[8:11], s71 offen offset:0 sc1
  v_rcp_f32 v25, v25
  v_mfma_f32_16x16x32_bf16 v[224:227], a[164:167], a[128:131], v[224:227]
  ds_read_b64_tr_b16 a[182:183], v9 offset:34816
  v_fma_f32 v28, v28, v23, v23
  v_mfma_f32_16x16x32_bf16 v[224:227], a[160:163], a[144:147], v[224:227]
  v_rcp_f32 v26, v26
  v_mfma_f32_16x16x32_bf16 v[228:231], a[160:163], a[148:151], v[228:231]
  ds_read_b64_tr_b16 a[176:177], v9 offset:36864
  v_fma_f32 v29, v29, v23, v23
  v_mfma_f32_16x16x32_bf16 v[228:231], a[164:167], a[132:135], v[228:231]
  buffer_load_dwordx4 a[248:251], v1, s[8:11], s71 offen offset:1024 sc1
  v_rcp_f32 v27, v27
  v_fma_f32 v30, v30, v23, v23
  v_mfma_f32_16x16x32_bf16 v[232:235], a[164:167], a[136:139], v[232:235]
  ds_read_b64_tr_b16 a[178:179], v9 offset:38912
  v_fma_f32 v31, v31, v23, v23
  v_mfma_f32_16x16x32_bf16 v[232:235], a[160:163], a[152:155], v[232:235]
  v_rcp_f32 v28, v28
  v_mfma_f32_16x16x32_bf16 v[236:239], a[160:163], a[156:159], v[236:239]
  ds_read_b64_tr_b16 a[160:161], v9 offset:40960
  v_mul_f32 v184, v184, v24
  v_mfma_f32_16x16x32_bf16 v[236:239], a[164:167], a[140:143], v[236:239]
  s_waitcnt lgkmcnt(5)
  buffer_load_dwordx4 a[0:3], v1, s[8:11], s72 offen offset:0 sc1
  v_rcp_f32 v29, v29
  v_mfma_f32_16x16x32_bf16 v[252:255], a[172:175], a[140:143], v[252:255]
  ds_read_b64_tr_b16 a[162:163], v9 offset:43008
  v_mul_f32 v185, v185, v25
  v_mfma_f32_16x16x32_bf16 v[252:255], a[168:171], a[156:159], v[252:255]
  v_rcp_f32 v30, v30
  v_mfma_f32_16x16x32_bf16 v[248:251], a[168:171], a[152:155], v[248:251]
  ds_read_b64_tr_b16 a[164:165], v9 offset:45056
  v_mul_f32 v186, v186, v26
  v_mfma_f32_16x16x32_bf16 v[248:251], a[172:175], a[136:139], v[248:251]
  buffer_load_dwordx4 a[16:19], v1, s[8:11], s72 offen offset:1024 sc1
  v_rcp_f32 v31, v31
  v_mul_f32 v187, v187, v27
  v_mfma_f32_16x16x32_bf16 v[244:247], a[172:175], a[132:135], v[244:247]
  ds_read_b64_tr_b16 a[166:167], v9 offset:47104
  v_mul_f32 v188, v188, v28
  v_mfma_f32_16x16x32_bf16 v[244:247], a[168:171], a[148:151], v[244:247]
  s_waitcnt vmcnt(32)
  s_barrier
  v_mfma_f32_16x16x32_bf16 v[240:243], a[168:171], a[144:147], v[240:243]
  ds_read_b64_tr_b16 a[168:169], v6 offset:49152
  s_add_u32 s72, s72, 131072
  v_mfma_f32_16x16x32_bf16 v[240:243], a[172:175], a[128:131], v[240:243]
  s_waitcnt lgkmcnt(5)
  buffer_load_dwordx4 a[4:7], v1, s[8:11], s72 offen offset:0 sc1
  v_mul_f32 v189, v189, v29
  v_mul_f32 v190, v190, v30
  v_mfma_f32_16x16x32_bf16 v[224:227], a[180:183], a[188:191], v[224:227]
  ds_read_b64_tr_b16 a[170:171], v6 offset:51200
  v_mul_f32 v191, v191, v31
  v_mfma_f32_16x16x32_bf16 v[224:227], a[176:179], a[204:207], v[224:227]
  v_cvt_pk_bf16_f32 v138, v184, v185
  v_cvt_pk_bf16_f32 v139, v186, v187
  v_mfma_f32_16x16x32_bf16 v[228:231], a[176:179], a[208:211], v[228:231]
  ds_read_b64_tr_b16 a[172:173], v6 offset:53248
  v_cvt_pk_bf16_f32 v142, v188, v189
  v_mfma_f32_16x16x32_bf16 v[228:231], a[180:183], a[192:195], v[228:231]
  buffer_load_dwordx4 a[20:23], v1, s[8:11], s72 offen offset:1024 sc1
  s_add_u32 s55, s57, 524288
  buffer_store_dwordx4 v[136:139], v1, s[8:11], s55 offen offset:0 sc1
  v_mfma_f32_16x16x32_bf16 v[232:235], a[180:183], a[196:199], v[232:235]
  ds_read_b64_tr_b16 a[174:175], v6 offset:55296
  v_cvt_pk_bf16_f32 v143, v190, v191
  v_mfma_f32_16x16x32_bf16 v[232:235], a[176:179], a[212:215], v[232:235]
  s_add_u32 s72, s72, s88
  s_add_u32 s55, s57, 786432
  buffer_store_dwordx4 v[140:143], v1, s[8:11], s55 offen offset:0 sc1
  v_mfma_f32_16x16x32_bf16 v[236:239], a[176:179], a[216:219], v[236:239]
  ds_read_b64_tr_b16 a[176:177], v7 offset:49152
  s_waitcnt lgkmcnt(15)
  v_mfma_f32_16x16x32_bf16 v[236:239], a[180:183], a[200:203], v[236:239]
  s_waitcnt lgkmcnt(5)
  buffer_load_dwordx4 a[8:11], v1, s[8:11], s72 offen offset:0 sc1
  v_fma_f32 v192, v192, v16, v60
  v_fma_f32 v193, v193, v16, v61
  v_mfma_f32_16x16x32_bf16 v[252:255], a[160:163], a[200:203], v[252:255]
  ds_read_b64_tr_b16 a[178:179], v7 offset:51200
  v_fma_f32 v194, v194, v16, v62
  v_mfma_f32_16x16x32_bf16 v[252:255], a[164:167], a[216:219], v[252:255]
  s_waitcnt vmcnt(31)
  s_barrier
  v_mfma_f32_16x16x32_bf16 v[248:251], a[164:167], a[212:215], v[248:251]
  ds_read_b64_tr_b16 a[180:181], v7 offset:53248
  v_exp_f32 v24, v192
  v_mfma_f32_16x16x32_bf16 v[248:251], a[160:163], a[196:199], v[248:251]
  buffer_load_dwordx4 a[24:27], v1, s[8:11], s72 offen offset:1024 sc1
  v_exp_f32 v25, v193
  v_mfma_f32_16x16x32_bf16 v[244:247], a[160:163], a[192:195], v[244:247]
  ds_read_b64_tr_b16 a[182:183], v7 offset:55296
  v_fma_f32 v195, v195, v16, v63
  v_mfma_f32_16x16x32_bf16 v[244:247], a[164:167], a[208:211], v[244:247]
  s_add_u32 s72, s72, 131072
  v_exp_f32 v26, v194
  v_fma_f32 v196, v196, v18, v60
  v_mfma_f32_16x16x32_bf16 v[240:243], a[164:167], a[204:207], v[240:243]
  ds_read_b64_tr_b16 a[164:165], v8 offset:49152
  v_fma_f32 v197, v197, v18, v61
  v_mfma_f32_16x16x32_bf16 v[240:243], a[160:163], a[188:191], v[240:243]
  s_waitcnt vmcnt(8) lgkmcnt(5)
  buffer_load_dwordx4 a[12:15], v1, s[8:11], s72 offen offset:0 sc1
  v_exp_f32 v27, v195
  v_mfma_f32_16x16x32_bf16 v[64:67], a[168:171], a[220:223], 0
  ds_read_b64_tr_b16 a[166:167], v8 offset:51200
  v_fma_f32 v198, v198, v18, v62
  v_mfma_f32_16x16x32_bf16 v[64:67], a[172:175], a[236:239], v[64:67]
  v_exp_f32 v28, v196
  v_mfma_f32_16x16x32_bf16 v[68:71], a[172:175], a[240:243], 0
  ds_read_b64_tr_b16 a[160:161], v8 offset:53248
  v_exp_f32 v29, v197
  v_mfma_f32_16x16x32_bf16 v[68:71], a[168:171], a[224:227], v[68:71]
  buffer_load_dwordx4 a[28:31], v1, s[8:11], s72 offen offset:1024 sc1
  v_exp_f32 v30, v198
  v_mfma_f32_16x16x32_bf16 v[72:75], a[168:171], a[228:231], 0
  ds_read_b64_tr_b16 a[162:163], v8 offset:55296
  v_fma_f32 v199, v199, v18, v63
  v_mfma_f32_16x16x32_bf16 v[72:75], a[172:175], a[244:247], v[72:75]
  v_exp_f32 v31, v199
  v_mul_f32 v208, v192, v208
  v_mfma_f32_16x16x32_bf16 v[76:79], a[172:175], a[248:251], 0
  ds_read_b64_tr_b16 a[172:173], v9 offset:49152
  v_mul_f32 v209, v193, v209
  v_mfma_f32_16x16x32_bf16 v[76:79], a[168:171], a[232:235], v[76:79]
  s_waitcnt lgkmcnt(5)
  buffer_load_dwordx4 a[32:35], v1, s[8:11], s73 offen offset:0 sc1
  v_mul_f32 v210, v194, v210
  v_mul_f32 v211, v195, v211
  v_mfma_f32_16x16x32_bf16 v[92:95], a[176:179], a[232:235], 0
  ds_read_b64_tr_b16 a[174:175], v9 offset:51200
  v_mul_f32 v212, v196, v212
  v_mfma_f32_16x16x32_bf16 v[92:95], a[180:183], a[248:251], v[92:95]
  v_mul_f32 v213, v197, v213
  v_mul_f32 v214, v198, v214
  v_mfma_f32_16x16x32_bf16 v[88:91], a[180:183], a[244:247], 0
  ds_read_b64_tr_b16 a[168:169], v9 offset:53248
  v_mul_f32 v215, v199, v215
  v_fma_f32 v24, v24, v17, v17
  v_mfma_f32_16x16x32_bf16 v[88:91], a[176:179], a[228:231], v[88:91]
  buffer_load_dwordx4 a[48:51], v1, s[8:11], s73 offen offset:1024 sc1
  v_rcp_f32 v24, v24
  v_mfma_f32_16x16x32_bf16 v[84:87], a[176:179], a[224:227], 0
  ds_read_b64_tr_b16 a[170:171], v9 offset:55296
  v_fma_f32 v25, v25, v17, v17
  v_mfma_f32_16x16x32_bf16 v[84:87], a[180:183], a[240:243], v[84:87]
  v_rcp_f32 v25, v25
  v_fma_f32 v26, v26, v17, v17
  v_mfma_f32_16x16x32_bf16 v[80:83], a[180:183], a[236:239], 0
  ds_read_b64_tr_b16 a[180:181], v6 offset:57344
  v_fma_f32 v27, v27, v17, v17
  v_mfma_f32_16x16x32_bf16 v[80:83], a[176:179], a[220:223], v[80:83]
  s_waitcnt lgkmcnt(5)
  s_add_u32 s73, s73, 131072
  v_rcp_f32 v26, v26
  v_mfma_f32_16x16x32_bf16 v[96:99], a[164:167], a[220:223], 0
  ds_read_b64_tr_b16 a[182:183], v6 offset:59392
  v_fma_f32 v28, v28, v19, v19
  v_mfma_f32_16x16x32_bf16 v[96:99], a[160:163], a[236:239], v[96:99]
  buffer_load_dwordx4 a[36:39], v1, s[8:11], s73 offen offset:0 sc1
  v_rcp_f32 v27, v27
  v_mfma_f32_16x16x32_bf16 v[100:103], a[160:163], a[240:243], 0
  ds_read_b64_tr_b16 a[176:177], v6 offset:61440
  v_rcp_f32 v28, v28
  v_mfma_f32_16x16x32_bf16 v[100:103], a[164:167], a[224:227], v[100:103]
  v_fma_f32 v29, v29, v19, v19
  v_fma_f32 v30, v30, v19, v19
  v_mfma_f32_16x16x32_bf16 v[104:107], a[164:167], a[228:231], 0
  ds_read_b64_tr_b16 a[178:179], v6 offset:63488
  v_fma_f32 v31, v31, v19, v19
  v_mfma_f32_16x16x32_bf16 v[104:107], a[160:163], a[244:247], v[104:107]
  buffer_load_dwordx4 a[52:55], v1, s[8:11], s73 offen offset:1024 sc1
  v_rcp_f32 v29, v29
  v_mul_f32 v208, v208, v24
  v_mfma_f32_16x16x32_bf16 v[108:111], a[160:163], a[248:251], 0
  ds_read_b64_tr_b16 a[160:161], v7 offset:57344
  v_mul_f32 v209, v209, v25
  v_mfma_f32_16x16x32_bf16 v[108:111], a[164:167], a[232:235], v[108:111]
  s_waitcnt lgkmcnt(5)
  s_add_u32 s73, s73, s88
  v_rcp_f32 v30, v30
  v_mfma_f32_16x16x32_bf16 v[124:127], a[172:175], a[232:235], 0
  ds_read_b64_tr_b16 a[162:163], v7 offset:59392
  v_mul_f32 v210, v210, v26
  v_mfma_f32_16x16x32_bf16 v[124:127], a[168:171], a[248:251], v[124:127]
  buffer_load_dwordx4 a[40:43], v1, s[8:11], s73 offen offset:0 sc1
  v_rcp_f32 v31, v31
  v_mfma_f32_16x16x32_bf16 v[120:123], a[168:171], a[244:247], 0
  ds_read_b64_tr_b16 a[164:165], v7 offset:61440
  v_mul_f32 v211, v211, v27
  v_mul_f32 v212, v212, v28
  v_mfma_f32_16x16x32_bf16 v[120:123], a[172:175], a[228:231], v[120:123]
  v_mul_f32 v213, v213, v29
  v_mul_f32 v214, v214, v30
  v_mfma_f32_16x16x32_bf16 v[116:119], a[172:175], a[224:227], 0
  ds_read_b64_tr_b16 a[166:167], v7 offset:63488
  v_mul_f32 v215, v215, v31
  v_mfma_f32_16x16x32_bf16 v[116:119], a[168:171], a[240:243], v[116:119]
  buffer_load_dwordx4 a[56:59], v1, s[8:11], s73 offen offset:1024 sc1
  v_cvt_pk_bf16_f32 v192, v208, v209
  v_cvt_pk_bf16_f32 v193, v210, v211
  v_cvt_pk_bf16_f32 v196, v212, v213
  v_mfma_f32_16x16x32_bf16 v[112:115], a[168:171], a[236:239], 0
  ds_read_b64_tr_b16 a[168:169], v8 offset:57344
  v_cvt_pk_bf16_f32 v197, v214, v215
  v_mfma_f32_16x16x32_bf16 v[112:115], a[172:175], a[220:223], v[112:115]
  s_waitcnt lgkmcnt(5)
  v_fma_f32 v200, v200, v20, v60
  v_exp_f32 v24, v200
  v_mfma_f32_16x16x32_bf16 v[128:131], a[180:183], a[220:223], 0
  ds_read_b64_tr_b16 a[170:171], v8 offset:59392
  v_fma_f32 v201, v201, v20, v61
  v_mfma_f32_16x16x32_bf16 v[128:131], a[176:179], a[236:239], v[128:131]
  s_add_u32 s73, s73, 131072
  v_exp_f32 v25, v201
  v_mfma_f32_16x16x32_bf16 v[132:135], a[176:179], a[240:243], 0
  ds_read_b64_tr_b16 a[172:173], v8 offset:61440
  v_fma_f32 v202, v202, v20, v62
  v_fma_f32 v203, v203, v20, v63
  v_mfma_f32_16x16x32_bf16 v[132:135], a[180:183], a[224:227], v[132:135]
  buffer_load_dwordx4 a[44:47], v1, s[8:11], s73 offen offset:0 sc1
  v_exp_f32 v26, v202
  v_mfma_f32_16x16x32_bf16 v[136:139], a[180:183], a[228:231], 0
  ds_read_b64_tr_b16 a[174:175], v8 offset:63488
  v_fma_f32 v204, v204, v22, v60
  v_mfma_f32_16x16x32_bf16 v[136:139], a[176:179], a[244:247], v[136:139]
  v_exp_f32 v27, v203
  v_fma_f32 v205, v205, v22, v61
  v_mfma_f32_16x16x32_bf16 v[140:143], a[176:179], a[248:251], 0
  ds_read_b64_tr_b16 a[176:177], v9 offset:57344
  v_fma_f32 v206, v206, v22, v62
  v_mfma_f32_16x16x32_bf16 v[140:143], a[180:183], a[232:235], v[140:143]
  s_waitcnt lgkmcnt(5)
  buffer_load_dwordx4 a[60:63], v1, s[8:11], s73 offen offset:1024 sc1
  v_exp_f32 v28, v204
  v_mfma_f32_16x16x32_bf16 v[156:159], a[160:163], a[232:235], 0
  ds_read_b64_tr_b16 a[178:179], v9 offset:59392
  v_fma_f32 v207, v207, v22, v63
  v_mfma_f32_16x16x32_bf16 v[156:159], a[164:167], a[248:251], v[156:159]
  v_exp_f32 v29, v205
  v_mfma_f32_16x16x32_bf16 v[152:155], a[164:167], a[244:247], 0
  ds_read_b64_tr_b16 a[180:181], v9 offset:61440
  v_exp_f32 v30, v206
  v_mfma_f32_16x16x32_bf16 v[152:155], a[160:163], a[228:231], v[152:155]
  buffer_load_dwordx4 a[64:67], v1, s[8:11], s74 offen offset:0 sc1
  v_exp_f32 v31, v207
  v_mfma_f32_16x16x32_bf16 v[148:151], a[160:163], a[224:227], 0
  ds_read_b64_tr_b16 a[182:183], v9 offset:63488
  v_mul_f32 v216, v200, v216
  v_mfma_f32_16x16x32_bf16 v[148:151], a[164:167], a[240:243], v[148:151]
  ds_read_b128 v[60:63], v12 offset:704
  v_mul_f32 v217, v201, v217
  v_mul_f32 v218, v202, v218
  v_mfma_f32_16x16x32_bf16 v[144:147], a[164:167], a[236:239], 0
  ds_read_b64_tr_b16 a[164:165], v6 offset:16384
  v_mul_f32 v219, v203, v219
  v_mfma_f32_16x16x32_bf16 v[144:147], a[160:163], a[220:223], v[144:147]
  s_waitcnt lgkmcnt(6)
  buffer_load_dwordx4 a[80:83], v1, s[8:11], s74 offen offset:1024 sc1
  v_mul_f32 v220, v204, v220
  v_mul_f32 v221, v205, v221
  v_mfma_f32_16x16x32_bf16 v[160:163], a[168:171], a[220:223], 0
  ds_read_b64_tr_b16 a[166:167], v6 offset:18432
  v_mul_f32 v222, v206, v222
  v_mfma_f32_16x16x32_bf16 v[160:163], a[172:175], a[236:239], v[160:163]
  v_mul_f32 v223, v207, v223
  v_fma_f32 v24, v24, v21, v21
  v_mfma_f32_16x16x32_bf16 v[164:167], a[172:175], a[240:243], 0
  ds_read_b64_tr_b16 a[160:161], v6 offset:20480
  v_rcp_f32 v24, v24
  v_mfma_f32_16x16x32_bf16 v[164:167], a[168:171], a[224:227], v[164:167]
  s_add_u32 s74, s74, 131072
  v_fma_f32 v25, v25, v21, v21
  v_fma_f32 v26, v26, v21, v21
  v_mfma_f32_16x16x32_bf16 v[168:171], a[168:171], a[228:231], 0
  ds_read_b64_tr_b16 a[162:163], v6 offset:22528
  v_fma_f32 v27, v27, v21, v21
  v_mfma_f32_16x16x32_bf16 v[168:171], a[172:175], a[244:247], v[168:171]
  buffer_load_dwordx4 a[68:71], v1, s[8:11], s74 offen offset:0 sc1
  v_rcp_f32 v25, v25
  v_fma_f32 v28, v28, v23, v23
  v_mfma_f32_16x16x32_bf16 v[172:175], a[172:175], a[248:251], 0
  ds_read_b64_tr_b16 a[172:173], v7 offset:16384
  v_fma_f32 v29, v29, v23, v23
  v_mfma_f32_16x16x32_bf16 v[172:175], a[168:171], a[232:235], v[172:175]
  s_waitcnt lgkmcnt(6)
  v_rcp_f32 v26, v26
  v_fma_f32 v30, v30, v23, v23
  v_mfma_f32_16x16x32_bf16 v[188:191], a[176:179], a[232:235], 0
  ds_read_b64_tr_b16 a[174:175], v7 offset:18432
  v_fma_f32 v31, v31, v23, v23
  v_mfma_f32_16x16x32_bf16 v[188:191], a[180:183], a[248:251], v[188:191]
  buffer_load_dwordx4 a[84:87], v1, s[8:11], s74 offen offset:1024 sc1
  v_rcp_f32 v27, v27
  v_mfma_f32_16x16x32_bf16 v[184:187], a[180:183], a[244:247], 0
  ds_read_b64_tr_b16 a[168:169], v7 offset:20480
  v_rcp_f32 v28, v28
  v_mfma_f32_16x16x32_bf16 v[184:187], a[176:179], a[228:231], v[184:187]
  s_add_u32 s74, s74, s88
  v_rcp_f32 v29, v29
  v_mfma_f32_16x16x32_bf16 v[180:183], a[176:179], a[224:227], 0
  ds_read_b64_tr_b16 a[170:171], v7 offset:22528
  v_mul_f32 v216, v216, v24
  v_mfma_f32_16x16x32_bf16 v[180:183], a[180:183], a[240:243], v[180:183]
  buffer_load_dwordx4 a[72:75], v1, s[8:11], s74 offen offset:0 sc1
  v_rcp_f32 v30, v30
  v_mul_f32 v217, v217, v25
  v_mfma_f32_16x16x32_bf16 v[176:179], a[180:183], a[236:239], 0
  ds_read_b64_tr_b16 a[180:181], v8 offset:16384
  v_mul_f32 v218, v218, v26
  v_mfma_f32_16x16x32_bf16 v[176:179], a[176:179], a[220:223], v[176:179]
  s_waitcnt vmcnt(13) lgkmcnt(5)
  v_rcp_f32 v31, v31
  v_mul_f32 v219, v219, v27
  v_mfma_f32_16x16x32_bf16 v[64:67], a[164:167], a[0:3], v[64:67]
  ds_read_b64_tr_b16 a[182:183], v8 offset:18432
  v_mul_f32 v220, v220, v28
  v_mfma_f32_16x16x32_bf16 v[64:67], a[160:163], a[16:19], v[64:67]
  buffer_load_dwordx4 a[88:91], v1, s[8:11], s74 offen offset:1024 sc1
  v_mul_f32 v221, v221, v29
  v_mul_f32 v222, v222, v30
  v_mfma_f32_16x16x32_bf16 v[68:71], a[160:163], a[20:23], v[68:71]
  ds_read_b64_tr_b16 a[176:177], v8 offset:20480
  v_mul_f32 v223, v223, v31
  v_cvt_pk_bf16_f32 v200, v216, v217
  v_mfma_f32_16x16x32_bf16 v[68:71], a[164:167], a[4:7], v[68:71]
  v_cvt_pk_bf16_f32 v201, v218, v219
  v_cvt_pk_bf16_f32 v204, v220, v221
  v_mfma_f32_16x16x32_bf16 v[72:75], a[164:167], a[8:11], v[72:75]
  ds_read_b64_tr_b16 a[178:179], v8 offset:22528
  v_cvt_pk_bf16_f32 v205, v222, v223
  v_mfma_f32_16x16x32_bf16 v[72:75], a[160:163], a[24:27], v[72:75]
  s_add_u32 s74, s74, 131072
  v_mfma_f32_16x16x32_bf16 v[76:79], a[160:163], a[28:31], v[76:79]
  ds_read_b64_tr_b16 a[160:161], v9 offset:16384
  s_waitcnt lgkmcnt(13)
  v_fma_f32 v224, v224, v16, v60
  v_mfma_f32_16x16x32_bf16 v[76:79], a[164:167], a[12:15], v[76:79]
  s_waitcnt lgkmcnt(5)
  buffer_load_dwordx4 a[76:79], v1, s[8:11], s74 offen offset:0 sc1
  v_exp_f32 v24, v224
  v_mfma_f32_16x16x32_bf16 v[92:95], a[172:175], a[12:15], v[92:95]
  ds_read_b64_tr_b16 a[162:163], v9 offset:18432
  v_fma_f32 v225, v225, v16, v61
  v_fma_f32 v226, v226, v16, v62
  v_mfma_f32_16x16x32_bf16 v[92:95], a[168:171], a[28:31], v[92:95]
  v_exp_f32 v25, v225
  v_fma_f32 v227, v227, v16, v63
  v_mfma_f32_16x16x32_bf16 v[88:91], a[168:171], a[24:27], v[88:91]
  ds_read_b64_tr_b16 a[164:165], v9 offset:20480
  v_fma_f32 v228, v228, v18, v60
  v_mfma_f32_16x16x32_bf16 v[88:91], a[172:175], a[8:11], v[88:91]
  buffer_load_dwordx4 a[92:95], v1, s[8:11], s74 offen offset:1024 sc1
  v_exp_f32 v26, v226
  v_fma_f32 v229, v229, v18, v61
  v_mfma_f32_16x16x32_bf16 v[84:87], a[172:175], a[4:7], v[84:87]
  ds_read_b64_tr_b16 a[166:167], v9 offset:22528
  v_exp_f32 v27, v227
  v_mfma_f32_16x16x32_bf16 v[84:87], a[168:171], a[20:23], v[84:87]
  s_cmp_eq_u32 s90, 1
  s_cselect_b32 s75, 3, 10
  s_lshl_b32 s67, s75, 17
  s_lshl_b32 s75, s75, 11
  s_add_u32 s75, s75, s83
  s_add_u32 m0, s45, 32768
  v_exp_f32 v28, v228
  v_fma_f32 v230, v230, v18, v62
  v_mfma_f32_16x16x32_bf16 v[80:83], a[168:171], a[16:19], v[80:83]
  ds_read_b64_tr_b16 a[168:169], v6 offset:24576
  v_exp_f32 v29, v229
  v_mfma_f32_16x16x32_bf16 v[80:83], a[172:175], a[0:3], v[80:83]
  s_waitcnt lgkmcnt(5)
  buffer_load_dwordx4 v32, s[36:39], s67 offen lds
HOP16:
  s_cbranch_execz WRET1
  v_exp_f32 v30, v230
  v_mfma_f32_16x16x32_bf16 v[96:99], a[180:183], a[0:3], v[96:99]
  ds_read_b64_tr_b16 a[170:171], v6 offset:26624
  v_fma_f32 v231, v231, v18, v63
  v_mfma_f32_16x16x32_bf16 v[96:99], a[176:179], a[16:19], v[96:99]
  s_add_u32 m0, s45, 36864
  s_add_u32 s60, s67, 65536
  v_exp_f32 v31, v231
  v_mfma_f32_16x16x32_bf16 v[100:103], a[176:179], a[20:23], v[100:103]
  ds_read_b64_tr_b16 a[172:173], v6 offset:28672
  v_mul_f32 v240, v224, v240
  v_mul_f32 v241, v225, v241
  v_mfma_f32_16x16x32_bf16 v[100:103], a[180:183], a[4:7], v[100:103]
  buffer_load_dwordx4 v32, s[36:39], s60 offen lds
  v_mul_f32 v242, v226, v242
  v_mul_f32 v243, v227, v243
  v_mul_f32 v244, v228, v244
  v_mfma_f32_16x16x32_bf16 v[104:107], a[180:183], a[8:11], v[104:107]
  ds_read_b64_tr_b16 a[174:175], v6 offset:30720
  v_mul_f32 v245, v229, v245
  v_mul_f32 v246, v230, v246
  v_mfma_f32_16x16x32_bf16 v[104:107], a[176:179], a[24:27], v[104:107]
  v_mul_f32 v247, v231, v247
  v_fma_f32 v24, v24, v17, v17
  v_mfma_f32_16x16x32_bf16 v[108:111], a[176:179], a[28:31], v[108:111]
  ds_read_b64_tr_b16 a[176:177], v7 offset:24576
  v_rcp_f32 v24, v24
  v_mfma_f32_16x16x32_bf16 v[108:111], a[180:183], a[12:15], v[108:111]
  s_waitcnt lgkmcnt(5)
  s_add_u32 m0, s45, 40960
  v_fma_f32 v25, v25, v17, v17
  v_fma_f32 v26, v26, v17, v17
  v_mfma_f32_16x16x32_bf16 v[124:127], a[160:163], a[12:15], v[124:127]
  ds_read_b64_tr_b16 a[178:179], v7 offset:26624
  v_rcp_f32 v25, v25
  v_mfma_f32_16x16x32_bf16 v[124:127], a[164:167], a[28:31], v[124:127]
  buffer_load_dwordx4 v33, s[36:39], s67 offen lds
  v_rcp_f32 v26, v26
  v_fma_f32 v27, v27, v17, v17
  v_mfma_f32_16x16x32_bf16 v[120:123], a[164:167], a[24:27], v[120:123]
  ds_read_b64_tr_b16 a[180:181], v7 offset:28672
  v_fma_f32 v28, v28, v19, v19
  v_mfma_f32_16x16x32_bf16 v[120:123], a[160:163], a[8:11], v[120:123]
  s_add_u32 m0, s45, 45056
  s_add_u32 s60, s67, 65536
  v_rcp_f32 v27, v27
  v_mfma_f32_16x16x32_bf16 v[116:119], a[160:163], a[4:7], v[116:119]
  ds_read_b64_tr_b16 a[182:183], v7 offset:30720
  v_rcp_f32 v28, v28
  v_mfma_f32_16x16x32_bf16 v[116:119], a[164:167], a[20:23], v[116:119]
  buffer_load_dwordx4 v33, s[36:39], s60 offen lds
  v_fma_f32 v29, v29, v19, v19
  v_rcp_f32 v29, v29
  v_mfma_f32_16x16x32_bf16 v[112:115], a[164:167], a[16:19], v[112:115]
  ds_read_b64_tr_b16 a[164:165], v8 offset:24576
  v_fma_f32 v30, v30, v19, v19
  v_fma_f32 v31, v31, v19, v19
  v_mfma_f32_16x16x32_bf16 v[112:115], a[160:163], a[0:3], v[112:115]
  s_waitcnt lgkmcnt(5)
  s_cmp_eq_u32 s90, 2
  s_cselect_b32 s76, 5, 12
  s_lshl_b32 s68, s76, 17
  s_lshl_b32 s76, s76, 11
  s_add_u32 s76, s76, s83
  s_add_u32 m0, s45, 49152
  v_rcp_f32 v30, v30
  v_mfma_f32_16x16x32_bf16 v[128:131], a[168:171], a[0:3], v[128:131]
  ds_read_b64_tr_b16 a[166:167], v8 offset:26624
  v_mul_f32 v240, v240, v24
  v_mfma_f32_16x16x32_bf16 v[128:131], a[172:175], a[16:19], v[128:131]
  buffer_load_dwordx4 v32, s[36:39], s68 offen lds
  v_rcp_f32 v31, v31
  v_mul_f32 v241, v241, v25
  v_mfma_f32_16x16x32_bf16 v[132:135], a[172:175], a[20:23], v[132:135]
  ds_read_b64_tr_b16 a[160:161], v8 offset:28672
  v_mul_f32 v242, v242, v26
  v_mul_f32 v243, v243, v27
  v_mfma_f32_16x16x32_bf16 v[132:135], a[168:171], a[4:7], v[132:135]
  s_add_u32 m0, s45, 53248
  s_add_u32 s60, s68, 65536
  v_mul_f32 v244, v244, v28
  v_mul_f32 v245, v245, v29
  v_mfma_f32_16x16x32_bf16 v[136:139], a[168:171], a[8:11], v[136:139]
  ds_read_b64_tr_b16 a[162:163], v8 offset:30720
  v_mul_f32 v246, v246, v30
  v_mul_f32 v247, v247, v31
  v_mfma_f32_16x16x32_bf16 v[136:139], a[172:175], a[24:27], v[136:139]
  buffer_load_dwordx4 v32, s[36:39], s60 offen lds
  v_cvt_pk_bf16_f32 v194, v240, v241
  v_cvt_pk_bf16_f32 v195, v242, v243
  v_mfma_f32_16x16x32_bf16 v[140:143], a[172:175], a[28:31], v[140:143]
  ds_read_b64_tr_b16 a[172:173], v9 offset:24576
  v_cvt_pk_bf16_f32 v198, v244, v245
  v_cvt_pk_bf16_f32 v199, v246, v247
  v_mfma_f32_16x16x32_bf16 v[140:143], a[168:171], a[12:15], v[140:143]
  s_waitcnt lgkmcnt(5)
  buffer_store_dwordx4 v[192:195], v1, s[8:11], s57 offen offset:1024 sc1
  v_mfma_f32_16x16x32_bf16 v[156:159], a[176:179], a[12:15], v[156:159]
  ds_read_b64_tr_b16 a[174:175], v9 offset:26624
  v_fma_f32 v232, v232, v20, v60
  v_fma_f32 v233, v233, v20, v61
  v_mfma_f32_16x16x32_bf16 v[156:159], a[180:183], a[28:31], v[156:159]
  s_add_u32 m0, s45, 57344
  s_add_u32 s55, s57, 262144
  buffer_store_dwordx4 v[196:199], v1, s[8:11], s55 offen offset:1024 sc1
  v_mfma_f32_16x16x32_bf16 v[152:155], a[180:183], a[24:27], v[152:155]
  ds_read_b64_tr_b16 a[168:169], v9 offset:28672
  v_fma_f32 v234, v234, v20, v62
  v_mfma_f32_16x16x32_bf16 v[152:155], a[176:179], a[8:11], v[152:155]
  buffer_load_dwordx4 v33, s[36:39], s68 offen lds
  v_exp_f32 v24, v232
  v_fma_f32 v235, v235, v20, v63
  v_mfma_f32_16x16x32_bf16 v[148:151], a[176:179], a[4:7], v[148:151]
  ds_read_b64_tr_b16 a[170:171], v9 offset:30720
  v_exp_f32 v25, v233
  v_mfma_f32_16x16x32_bf16 v[148:151], a[180:183], a[20:23], v[148:151]
  v_fma_f32 v236, v236, v22, v60
  s_waitcnt vmcnt(47)
  s_barrier
  v_mfma_f32_16x16x32_bf16 v[144:147], a[180:183], a[16:19], v[144:147]
  ds_read_b64_tr_b16 a[180:181], v6 offset:0
  s_add_u32 m0, s45, 61440
  s_add_u32 s60, s68, 65536
  v_mfma_f32_16x16x32_bf16 v[144:147], a[176:179], a[0:3], v[144:147]
  s_waitcnt lgkmcnt(5)
  buffer_load_dwordx4 v33, s[36:39], s60 offen lds
  v_exp_f32 v26, v234
  v_mfma_f32_16x16x32_bf16 v[160:163], a[164:167], a[0:3], v[160:163]
  ds_read_b64_tr_b16 a[182:183], v6 offset:2048
  v_fma_f32 v237, v237, v22, v61
  v_mfma_f32_16x16x32_bf16 v[160:163], a[160:163], a[16:19], v[160:163]
  v_exp_f32 v27, v235
  v_fma_f32 v238, v238, v22, v62
  v_mfma_f32_16x16x32_bf16 v[164:167], a[160:163], a[20:23], v[164:167]
  ds_read_b64_tr_b16 a[176:177], v6 offset:4096
  v_exp_f32 v28, v236
  v_mfma_f32_16x16x32_bf16 v[164:167], a[164:167], a[4:7], v[164:167]
  buffer_load_dwordx4 a[96:99], v1, s[8:11], s75 offen offset:0 sc1
  v_exp_f32 v29, v237
  v_fma_f32 v239, v239, v22, v63
  v_mfma_f32_16x16x32_bf16 v[168:171], a[164:167], a[8:11], v[168:171]
  ds_read_b64_tr_b16 a[178:179], v6 offset:6144
  v_exp_f32 v30, v238
  v_mfma_f32_16x16x32_bf16 v[168:171], a[160:163], a[24:27], v[168:171]
  v_exp_f32 v31, v239
  v_mfma_f32_16x16x32_bf16 v[172:175], a[160:163], a[28:31], v[172:175]
  ds_read_b64_tr_b16 a[160:161], v7 offset:0
  v_mul_f32 v248, v232, v248
  v_mul_f32 v249, v233, v249
  v_mfma_f32_16x16x32_bf16 v[172:175], a[164:167], a[12:15], v[172:175]
  s_waitcnt lgkmcnt(5)
  buffer_load_dwordx4 a[112:115], v1, s[8:11], s75 offen offset:1024 sc1
  v_mul_f32 v250, v234, v250
  v_mul_f32 v251, v235, v251
  v_mfma_f32_16x16x32_bf16 v[188:191], a[172:175], a[12:15], v[188:191]
  ds_read_b64_tr_b16 a[162:163], v7 offset:2048
  v_mul_f32 v252, v236, v252
  v_mul_f32 v253, v237, v253
  v_mfma_f32_16x16x32_bf16 v[188:191], a[168:171], a[28:31], v[188:191]
  v_mul_f32 v254, v238, v254
  v_mul_f32 v255, v239, v255
  v_fma_f32 v24, v24, v21, v21
  v_mfma_f32_16x16x32_bf16 v[184:187], a[168:171], a[24:27], v[184:187]
  ds_read_b64_tr_b16 a[164:165], v7 offset:4096
  v_fma_f32 v25, v25, v21, v21
  v_mfma_f32_16x16x32_bf16 v[184:187], a[172:175], a[8:11], v[184:187]
  s_add_u32 s75, s75, 131072
  v_rcp_f32 v24, v24
  v_fma_f32 v26, v26, v21, v21
  v_mfma_f32_16x16x32_bf16 v[180:183], a[172:175], a[4:7], v[180:183]
  ds_read_b64_tr_b16 a[166:167], v7 offset:6144
  v_rcp_f32 v25, v25
  v_mfma_f32_16x16x32_bf16 v[180:183], a[168:171], a[20:23], v[180:183]
  buffer_load_dwordx4 a[100:103], v1, s[8:11], s75 offen offset:0 sc1
  v_rcp_f32 v26, v26
  v_fma_f32 v27, v27, v21, v21
  v_mfma_f32_16x16x32_bf16 v[176:179], a[168:171], a[16:19], v[176:179]
  ds_read_b64_tr_b16 a[168:169], v8 offset:0
  v_rcp_f32 v27, v27
  v_mfma_f32_16x16x32_bf16 v[176:179], a[172:175], a[0:3], v[176:179]
  s_waitcnt vmcnt(21) lgkmcnt(5)
  v_fma_f32 v28, v28, v23, v23
  v_rcp_f32 v28, v28
  v_mfma_f32_16x16x32_bf16 v[64:67], a[180:183], a[32:35], v[64:67]
  ds_read_b64_tr_b16 a[170:171], v8 offset:2048
  v_fma_f32 v29, v29, v23, v23
  v_mfma_f32_16x16x32_bf16 v[64:67], a[176:179], a[48:51], v[64:67]
  buffer_load_dwordx4 a[116:119], v1, s[8:11], s75 offen offset:1024 sc1
  v_rcp_f32 v29, v29
  v_fma_f32 v30, v30, v23, v23
  v_mfma_f32_16x16x32_bf16 v[68:71], a[176:179], a[52:55], v[68:71]
  ds_read_b64_tr_b16 a[172:173], v8 offset:4096
  v_rcp_f32 v30, v30
  v_mfma_f32_16x16x32_bf16 v[68:71], a[180:183], a[36:39], v[68:71]
  s_add_u32 s75, s75, s88
  v_fma_f32 v31, v31, v23, v23
  v_rcp_f32 v31, v31
  v_mfma_f32_16x16x32_bf16 v[72:75], a[180:183], a[40:43], v[72:75]
  ds_read_b64_tr_b16 a[174:175], v8 offset:6144
  v_mul_f32 v248, v248, v24
  v_mul_f32 v249, v249, v25
  v_mfma_f32_16x16x32_bf16 v[72:75], a[176:179], a[56:59], v[72:75]
  buffer_load_dwordx4 a[104:107], v1, s[8:11], s75 offen offset:0 sc1
  v_mul_f32 v250, v250, v26
  v_mul_f32 v251, v251, v27
  v_mfma_f32_16x16x32_bf16 v[76:79], a[176:179], a[60:63], v[76:79]
  ds_read_b64_tr_b16 a[176:177], v9 offset:0
  v_mul_f32 v252, v252, v28
  v_mul_f32 v253, v253, v29
  v_mfma_f32_16x16x32_bf16 v[76:79], a[180:183], a[44:47], v[76:79]
  s_waitcnt lgkmcnt(5)
  v_mul_f32 v254, v254, v30
  v_mul_f32 v255, v255, v31
  v_cvt_pk_bf16_f32 v202, v248, v249
  v_mfma_f32_16x16x32_bf16 v[92:95], a[160:163], a[44:47], v[92:95]
  ds_read_b64_tr_b16 a[178:179], v9 offset:2048
  v_cvt_pk_bf16_f32 v203, v250, v251
  v_cvt_pk_bf16_f32 v206, v252, v253
  v_mfma_f32_16x16x32_bf16 v[92:95], a[164:167], a[60:63], v[92:95]
  buffer_load_dwordx4 a[120:123], v1, s[8:11], s75 offen offset:1024 sc1
  s_add_u32 s55, s57, 524288
  buffer_store_dwordx4 v[200:203], v1, s[8:11], s55 offen offset:1024 sc1
  v_mfma_f32_16x16x32_bf16 v[88:91], a[164:167], a[56:59], v[88:91]
  ds_read_b64_tr_b16 a[180:181], v9 offset:4096
  v_cvt_pk_bf16_f32 v207, v254, v255
  v_mfma_f32_16x16x32_bf16 v[88:91], a[160:163], a[40:43], v[88:91]
  s_add_u32 s55, s57, 786432
  buffer_store_dwordx4 v[204:207], v1, s[8:11], s55 offen offset:1024 sc1
  v_mfma_f32_16x16x32_bf16 v[84:87], a[160:163], a[36:39], v[84:87]
  ds_read_b64_tr_b16 a[182:183], v9 offset:6144
  s_sub_u32 s79, s79, 491520
  v_mfma_f32_16x16x32_bf16 v[84:87], a[164:167], a[52:55], v[84:87]
  s_add_u32 s75, s75, 131072
  v_mfma_f32_16x16x32_bf16 v[80:83], a[164:167], a[48:51], v[80:83]
  ds_read_b64_tr_b16 a[164:165], v6 offset:8192
  v_mfma_f32_16x16x32_bf16 v[80:83], a[160:163], a[32:35], v[80:83]
  s_waitcnt lgkmcnt(5)
  buffer_load_dwordx4 a[108:111], v1, s[8:11], s75 offen offset:0 sc1
  v_mfma_f32_16x16x32_bf16 v[96:99], a[168:171], a[32:35], v[96:99]
  ds_read_b64_tr_b16 a[166:167], v6 offset:10240
  v_mfma_f32_16x16x32_bf16 v[96:99], a[172:175], a[48:51], v[96:99]
  v_mfma_f32_16x16x32_bf16 v[100:103], a[172:175], a[52:55], v[100:103]
  ds_read_b64_tr_b16 a[160:161], v6 offset:12288
  v_mfma_f32_16x16x32_bf16 v[100:103], a[168:171], a[36:39], v[100:103]
  buffer_load_dwordx4 a[124:127], v1, s[8:11], s75 offen offset:1024 sc1
  v_mfma_f32_16x16x32_bf16 v[104:107], a[168:171], a[40:43], v[104:107]
  ds_read_b64_tr_b16 a[162:163], v6 offset:14336
  v_mfma_f32_16x16x32_bf16 v[104:107], a[172:175], a[56:59], v[104:107]
  v_mfma_f32_16x16x32_bf16 v[108:111], a[172:175], a[60:63], v[108:111]
  ds_read_b64_tr_b16 a[172:173], v7 offset:8192
  v_mfma_f32_16x16x32_bf16 v[108:111], a[168:171], a[44:47], v[108:111]
  s_waitcnt lgkmcnt(5)
  buffer_load_dwordx4 a[128:131], v1, s[8:11], s76 offen offset:0 sc1
  v_mfma_f32_16x16x32_bf16 v[124:127], a[176:179], a[44:47], v[124:127]
  ds_read_b64_tr_b16 a[174:175], v7 offset:10240
  v_mfma_f32_16x16x32_bf16 v[124:127], a[180:183], a[60:63], v[124:127]
  v_mfma_f32_16x16x32_bf16 v[120:123], a[180:183], a[56:59], v[120:123]
  ds_read_b64_tr_b16 a[168:169], v7 offset:12288
  v_mfma_f32_16x16x32_bf16 v[120:123], a[176:179], a[40:43], v[120:123]
  buffer_load_dwordx4 a[144:147], v1, s[8:11], s76 offen offset:1024 sc1
  v_mfma_f32_16x16x32_bf16 v[116:119], a[176:179], a[36:39], v[116:119]
  ds_read_b64_tr_b16 a[170:171], v7 offset:14336
  v_mfma_f32_16x16x32_bf16 v[116:119], a[180:183], a[52:55], v[116:119]
  v_mfma_f32_16x16x32_bf16 v[112:115], a[180:183], a[48:51], v[112:115]
  ds_read_b64_tr_b16 a[180:181], v8 offset:8192
  v_mfma_f32_16x16x32_bf16 v[112:115], a[176:179], a[32:35], v[112:115]
  s_waitcnt lgkmcnt(5)
  s_add_u32 s76, s76, 131072
  v_mfma_f32_16x16x32_bf16 v[128:131], a[164:167], a[32:35], v[128:131]
  ds_read_b64_tr_b16 a[182:183], v8 offset:10240
  v_mfma_f32_16x16x32_bf16 v[128:131], a[160:163], a[48:51], v[128:131]
  buffer_load_dwordx4 a[132:135], v1, s[8:11], s76 offen offset:0 sc1
  v_mfma_f32_16x16x32_bf16 v[132:135], a[160:163], a[52:55], v[132:135]
  ds_read_b64_tr_b16 a[176:177], v8 offset:12288
  v_mfma_f32_16x16x32_bf16 v[132:135], a[164:167], a[36:39], v[132:135]
  v_mfma_f32_16x16x32_bf16 v[136:139], a[164:167], a[40:43], v[136:139]
  ds_read_b64_tr_b16 a[178:179], v8 offset:14336
  v_mfma_f32_16x16x32_bf16 v[136:139], a[160:163], a[56:59], v[136:139]
  buffer_load_dwordx4 a[148:151], v1, s[8:11], s76 offen offset:1024 sc1
  v_mfma_f32_16x16x32_bf16 v[140:143], a[160:163], a[60:63], v[140:143]
  ds_read_b64_tr_b16 a[160:161], v9 offset:8192
  v_mfma_f32_16x16x32_bf16 v[140:143], a[164:167], a[44:47], v[140:143]
  s_waitcnt lgkmcnt(5)
  s_add_u32 s76, s76, s88
  v_mfma_f32_16x16x32_bf16 v[156:159], a[172:175], a[44:47], v[156:159]
  ds_read_b64_tr_b16 a[162:163], v9 offset:10240
  v_mfma_f32_16x16x32_bf16 v[156:159], a[168:171], a[60:63], v[156:159]
  buffer_load_dwordx4 a[136:139], v1, s[8:11], s76 offen offset:0 sc1
  v_mfma_f32_16x16x32_bf16 v[152:155], a[168:171], a[56:59], v[152:155]
  ds_read_b64_tr_b16 a[164:165], v9 offset:12288
  v_mfma_f32_16x16x32_bf16 v[152:155], a[172:175], a[40:43], v[152:155]
  v_mfma_f32_16x16x32_bf16 v[148:151], a[172:175], a[36:39], v[148:151]
  ds_read_b64_tr_b16 a[166:167], v9 offset:14336
  v_mfma_f32_16x16x32_bf16 v[148:151], a[168:171], a[52:55], v[148:151]
  buffer_load_dwordx4 a[152:155], v1, s[8:11], s76 offen offset:1024 sc1
  v_mfma_f32_16x16x32_bf16 v[144:147], a[168:171], a[48:51], v[144:147]
  ds_read_b64_tr_b16 a[168:169], v2 offset:0
  v_mfma_f32_16x16x32_bf16 v[144:147], a[172:175], a[32:35], v[144:147]
  s_waitcnt lgkmcnt(5)
  v_mfma_f32_16x16x32_bf16 v[160:163], a[180:183], a[32:35], v[160:163]
  ds_read_b64_tr_b16 a[170:171], v2 offset:2048
  v_mfma_f32_16x16x32_bf16 v[160:163], a[176:179], a[48:51], v[160:163]
  s_add_u32 s76, s76, 131072
  v_mfma_f32_16x16x32_bf16 v[164:167], a[176:179], a[52:55], v[164:167]
  ds_read_b64_tr_b16 a[172:173], v2 offset:4096
  v_mfma_f32_16x16x32_bf16 v[164:167], a[180:183], a[36:39], v[164:167]
  buffer_load_dwordx4 a[140:143], v1, s[8:11], s76 offen offset:0 sc1
  v_mfma_f32_16x16x32_bf16 v[168:171], a[180:183], a[40:43], v[168:171]
  ds_read_b64_tr_b16 a[174:175], v2 offset:6144
  v_mfma_f32_16x16x32_bf16 v[168:171], a[176:179], a[56:59], v[168:171]
  v_mfma_f32_16x16x32_bf16 v[172:175], a[176:179], a[60:63], v[172:175]
  ds_read_b64_tr_b16 a[176:177], v3 offset:0
  v_mfma_f32_16x16x32_bf16 v[172:175], a[180:183], a[44:47], v[172:175]
  s_waitcnt lgkmcnt(5)
  buffer_load_dwordx4 a[156:159], v1, s[8:11], s76 offen offset:1024 sc1
  v_mfma_f32_16x16x32_bf16 v[188:191], a[160:163], a[44:47], v[188:191]
  ds_read_b64_tr_b16 a[178:179], v3 offset:2048
  v_mfma_f32_16x16x32_bf16 v[188:191], a[164:167], a[60:63], v[188:191]
  s_cmp_eq_u32 s90, 0
  s_cselect_b32 s77, 7, 0
  s_lshl_b32 s69, s77, 17
  s_lshl_b32 s77, s77, 11
  s_add_u32 s77, s77, s83
  s_add_u32 m0, s45, 16384
  v_mfma_f32_16x16x32_bf16 v[184:187], a[164:167], a[56:59], v[184:187]
  ds_read_b64_tr_b16 a[180:181], v3 offset:4096
  v_mfma_f32_16x16x32_bf16 v[184:187], a[160:163], a[40:43], v[184:187]
  buffer_load_dwordx4 v32, s[36:39], s69 offen lds
  v_mfma_f32_16x16x32_bf16 v[180:183], a[160:163], a[36:39], v[180:183]
  ds_read_b64_tr_b16 a[182:183], v3 offset:6144
  v_mfma_f32_16x16x32_bf16 v[180:183], a[164:167], a[52:55], v[180:183]
  s_add_u32 m0, s45, 20480
  s_add_u32 s60, s69, 65536
  v_mfma_f32_16x16x32_bf16 v[176:179], a[164:167], a[48:51], v[176:179]
  ds_read_b64_tr_b16 a[164:165], v4 offset:0
  v_mfma_f32_16x16x32_bf16 v[176:179], a[160:163], a[32:35], v[176:179]
  s_waitcnt vmcnt(29) lgkmcnt(5)
  buffer_load_dwordx4 v32, s[36:39], s60 offen lds
  v_mfma_f32_16x16x32_bf16 v[64:67], a[168:171], a[64:67], v[64:67]
  ds_read_b64_tr_b16 a[166:167], v4 offset:2048
  v_mfma_f32_16x16x32_bf16 v[64:67], a[172:175], a[80:83], v[64:67]
  v_mfma_f32_16x16x32_bf16 v[68:71], a[172:175], a[84:87], v[68:71]
  ds_read_b64_tr_b16 a[160:161], v4 offset:4096
  v_mfma_f32_16x16x32_bf16 v[68:71], a[168:171], a[68:71], v[68:71]
  s_add_u32 m0, s45, 24576
  v_mfma_f32_16x16x32_bf16 v[72:75], a[168:171], a[72:75], v[72:75]
  ds_read_b64_tr_b16 a[162:163], v4 offset:6144
  v_mfma_f32_16x16x32_bf16 v[72:75], a[172:175], a[88:91], v[72:75]
  buffer_load_dwordx4 v33, s[36:39], s69 offen lds
  v_mfma_f32_16x16x32_bf16 v[76:79], a[172:175], a[92:95], v[76:79]
  ds_read_b64_tr_b16 a[172:173], v5 offset:0
  v_mfma_f32_16x16x32_bf16 v[76:79], a[168:171], a[76:79], v[76:79]
  s_waitcnt lgkmcnt(5)
  s_add_u32 m0, s45, 28672
  s_add_u32 s60, s69, 65536
  v_mfma_f32_16x16x32_bf16 v[92:95], a[176:179], a[76:79], v[92:95]
  ds_read_b64_tr_b16 a[174:175], v5 offset:2048
  v_mfma_f32_16x16x32_bf16 v[92:95], a[180:183], a[92:95], v[92:95]
  buffer_load_dwordx4 v33, s[36:39], s60 offen lds
  v_add_u32 v38, s46, v0
  s_waitcnt vmcnt(14)
  s_barrier
  s_mov_b64 exec, 1
  buffer_store_dword v38, v0, s[8:11], s79 offen offset:0 sc1
  s_mov_b64 exec, -1
  v_mfma_f32_16x16x32_bf16 v[88:91], a[180:183], a[88:91], v[88:91]
  ds_read_b64_tr_b16 a[168:169], v5 offset:4096
  s_lshl_b32 s53, s44, 8
  v_mfma_f32_16x16x32_bf16 v[88:91], a[176:179], a[72:75], v[88:91]
  s_cmp_eq_u32 s90, 1
  s_cselect_b32 s78, 9, 2
  s_lshl_b32 s70, s78, 17
  s_lshl_b32 s78, s78, 11
  s_add_u32 s78, s78, s83
  s_add_u32 m0, s45, 98304
  s_add_u32 s53, s53, 133120
  v_lshrrev_b32 v49, 4, v0
  v_mfma_f32_16x16x32_bf16 v[84:87], a[176:179], a[68:71], v[84:87]
  ds_read_b64_tr_b16 a[170:171], v5 offset:6144
  v_lshl_add_u32 v46, v49, 4, s53
  v_mfma_f32_16x16x32_bf16 v[84:87], a[180:183], a[84:87], v[84:87]
  buffer_load_dwordx4 v32, s[36:39], s70 offen lds
  v_lshlrev_b32 v47, 2, v0
  v_add_u32 v45, s53, v47
  v_mfma_f32_16x16x32_bf16 v[80:83], a[180:183], a[80:83], v[80:83]
  ds_read_b64_tr_b16 a[180:181], v2 offset:8192
  v_lshrrev_b32 v48, 3, v0
  v_mfma_f32_16x16x32_bf16 v[80:83], a[176:179], a[64:67], v[80:83]
  s_waitcnt lgkmcnt(5)
  s_add_u32 m0, s45, 102400
  s_add_u32 s60, s70, 65536
  v_mfma_f32_16x16x32_bf16 v[96:99], a[164:167], a[64:67], v[96:99]
  ds_read_b64_tr_b16 a[182:183], v2 offset:10240
  v_and_b32 v50, 7, v0
  v_mfma_f32_16x16x32_bf16 v[96:99], a[160:163], a[80:83], v[96:99]
  buffer_load_dwordx4 v32, s[36:39], s60 offen lds
  v_xor_b32 v51, v50, v48
  v_lshlrev_b32 v51, 4, v51
  v_mfma_f32_16x16x32_bf16 v[100:103], a[160:163], a[84:87], v[100:103]
  ds_read_b64_tr_b16 a[176:177], v2 offset:12288
  v_lshl_add_u32 v40, v48, 11, v51
  v_mfma_f32_16x16x32_bf16 v[100:103], a[164:167], a[68:71], v[100:103]
  v_bfe_u32 v48, v0, 4, 1
  v_lshrrev_b32 v51, 5, v0
  v_mfma_f32_16x16x32_bf16 v[104:107], a[164:167], a[72:75], v[104:107]
  ds_read_b64_tr_b16 a[178:179], v2 offset:14336
  v_lshl_add_u32 v48, v48, 1, v51
  v_mfma_f32_16x16x32_bf16 v[104:107], a[160:163], a[88:91], v[104:107]
  s_cmp_eq_u32 s90, 2
  s_cselect_b32 s71, 11, 4
  s_lshl_b32 s63, s71, 17
  s_lshl_b32 s71, s71, 11
  s_add_u32 s71, s71, s83
  s_add_u32 m0, s45, 114688
  v_xor_b32 v48, v48, v50
  v_lshlrev_b32 v48, 4, v48
  v_mfma_f32_16x16x32_bf16 v[108:111], a[160:163], a[92:95], v[108:111]
  ds_read_b64_tr_b16 a[160:161], v3 offset:8192
  v_and_b32 v50, 15, v0
  v_mfma_f32_16x16x32_bf16 v[108:111], a[164:167], a[76:79], v[108:111]
  s_waitcnt lgkmcnt(5)
  buffer_load_dwordx4 v32, s[36:39], s63 offen lds
  v_lshl_add_u32 v48, v50, 7, v48
  v_mfma_f32_16x16x32_bf16 v[124:127], a[172:175], a[76:79], v[124:127]
  ds_read_b64_tr_b16 a[162:163], v3 offset:10240
  v_add_u32 v42, s89, v48
  v_mfma_f32_16x16x32_bf16 v[124:127], a[168:171], a[92:95], v[124:127]
  s_add_u32 m0, s45, 118784
  s_add_u32 s60, s63, 65536
  v_xor_b32 v43, 64, v42
  v_mfma_f32_16x16x32_bf16 v[120:123], a[168:171], a[88:91], v[120:123]
  ds_read_b64_tr_b16 a[164:165], v3 offset:12288
  v_add_u32 v44, s89, v1
  v_mfma_f32_16x16x32_bf16 v[120:123], a[172:175], a[72:75], v[120:123]
  buffer_load_dwordx4 v32, s[36:39], s60 offen lds
  v_bfe_u32 v48, v0, 2, 2
  v_lshrrev_b32 v49, 4, v0
  v_mfma_f32_16x16x32_bf16 v[116:119], a[172:175], a[68:71], v[116:119]
  ds_read_b64_tr_b16 a[166:167], v3 offset:14336
  v_and_b32 v50, 1, v0
  v_mfma_f32_16x16x32_bf16 v[116:119], a[168:171], a[84:87], v[116:119]
  s_cmp_eq_u32 s90, 3
  s_cselect_b32 s72, 13, 6
  s_lshl_b32 s64, s72, 17
  s_lshl_b32 s72, s72, 11
  s_add_u32 s72, s72, s83
  s_add_u32 m0, s45, 81920
  v_lshlrev_b32 v50, 4, v50
  v_mov_b32 v51, 0xffff
  v_mfma_f32_16x16x32_bf16 v[112:115], a[168:171], a[80:83], v[112:115]
  ds_read_b64_tr_b16 a[168:169], v4 offset:8192
  v_lshlrev_b32 v50, v50, v51
  v_mfma_f32_16x16x32_bf16 v[112:115], a[172:175], a[64:67], v[112:115]
  s_waitcnt lgkmcnt(5)
  buffer_load_dwordx4 v32, s[36:39], s64 offen lds
  v_cmp_eq_u32 vcc, v48, v49
  v_mov_b32 v60, 0
  v_mov_b32 v61, 0
  v_cndmask_b32 v48, 0, v50, vcc
  v_mfma_f32_16x16x32_bf16 v[128:131], a[180:183], a[64:67], v[128:131]
  ds_read_b64_tr_b16 a[170:171], v4 offset:10240
  v_and_b32 v49, 2, v0
  v_mfma_f32_16x16x32_bf16 v[128:131], a[176:179], a[80:83], v[128:131]
  s_add_u32 m0, s45, 86016
  s_add_u32 s60, s64, 65536
  v_cmp_eq_u32 vcc, 0, v49
  v_mov_b32 v54, 0
  v_mov_b32 v55, 0
  v_cndmask_b32 v50, 0, v48, vcc
  v_mfma_f32_16x16x32_bf16 v[132:135], a[176:179], a[84:87], v[132:135]
  ds_read_b64_tr_b16 a[172:173], v4 offset:12288
  v_sub_u32 v51, v48, v50
  v_mfma_f32_16x16x32_bf16 v[132:135], a[180:183], a[68:71], v[132:135]
  buffer_load_dwordx4 v32, s[36:39], s60 offen lds
  v_mfma_f32_16x16x32_bf16 v[136:139], a[180:183], a[72:75], v[136:139]
  ds_read_b64_tr_b16 a[174:175], v4 offset:14336
  v_mfma_f32_16x16x32_bf16 v[136:139], a[176:179], a[88:91], v[136:139]
  v_mfma_f32_16x16x32_bf16 v[140:143], a[176:179], a[92:95], v[140:143]
  ds_read_b64_tr_b16 a[176:177], v5 offset:8192
  v_mfma_f32_16x16x32_bf16 v[140:143], a[180:183], a[76:79], v[140:143]
  s_waitcnt lgkmcnt(5)
  s_add_u32 m0, s45, 106496
  v_mfma_f32_16x16x32_bf16 v[156:159], a[160:163], a[76:79], v[156:159]
  ds_read_b64_tr_b16 a[178:179], v5 offset:10240
  v_mfma_f32_16x16x32_bf16 v[156:159], a[164:167], a[92:95], v[156:159]
  buffer_load_dwordx4 v33, s[36:39], s70 offen lds
  v_mfma_f32_16x16x32_bf16 v[152:155], a[164:167], a[88:91], v[152:155]
  ds_read_b64_tr_b16 a[180:181], v5 offset:12288
  v_mfma_f32_16x16x32_bf16 v[152:155], a[160:163], a[72:75], v[152:155]
  s_add_u32 m0, s45, 110592
  s_add_u32 s60, s70, 65536
  v_mfma_f32_16x16x32_bf16 v[148:151], a[160:163], a[68:71], v[148:151]
  ds_read_b64_tr_b16 a[182:183], v5 offset:14336
  buffer_load_dwordx4 v33, s[36:39], s60 offen lds
  v_mfma_f32_16x16x32_bf16 v[148:151], a[164:167], a[84:87], v[148:151]
  s_waitcnt vmcnt(31)
  s_barrier
  v_mfma_f32_16x16x32_bf16 v[144:147], a[164:167], a[80:83], v[144:147]
  ds_read_b64_tr_b16 a[164:165], v2 offset:32768
  v_mfma_f32_16x16x32_bf16 v[144:147], a[160:163], a[64:67], v[144:147]
  s_waitcnt lgkmcnt(5)
  s_cmp_eq_u32 s90, 0
  s_cselect_b32 s73, 0, 7
  s_lshl_b32 s65, s73, 17
  s_lshl_b32 s73, s73, 11
  s_add_u32 s73, s73, s83
  s_add_u32 m0, s45, 65536
  v_mfma_f32_16x16x32_bf16 v[160:163], a[168:171], a[64:67], v[160:163]
  ds_read_b64_tr_b16 a[166:167], v2 offset:34816
  v_mfma_f32_16x16x32_bf16 v[160:163], a[172:175], a[80:83], v[160:163]
  buffer_load_dwordx4 v32, s[36:39], s65 offen lds
  v_mfma_f32_16x16x32_bf16 v[164:167], a[172:175], a[84:87], v[164:167]
  ds_read_b64_tr_b16 a[160:161], v2 offset:36864
  v_mfma_f32_16x16x32_bf16 v[164:167], a[168:171], a[68:71], v[164:167]
  s_add_u32 m0, s45, 69632
  s_add_u32 s60, s65, 65536
  v_mfma_f32_16x16x32_bf16 v[168:171], a[168:171], a[72:75], v[168:171]
  ds_read_b64_tr_b16 a[162:163], v2 offset:38912
  v_mfma_f32_16x16x32_bf16 v[168:171], a[172:175], a[88:91], v[168:171]
  buffer_load_dwordx4 v32, s[36:39], s60 offen lds
  v_mfma_f32_16x16x32_bf16 v[172:175], a[172:175], a[92:95], v[172:175]
  ds_read_b64_tr_b16 a[172:173], v3 offset:32768
  v_mfma_f32_16x16x32_bf16 v[172:175], a[168:171], a[76:79], v[172:175]
  s_waitcnt lgkmcnt(5)
  v_mfma_f32_16x16x32_bf16 v[188:191], a[176:179], a[76:79], v[188:191]
  ds_read_b64_tr_b16 a[174:175], v3 offset:34816
  v_mfma_f32_16x16x32_bf16 v[188:191], a[180:183], a[92:95], v[188:191]
  s_add_u32 s61, s87, 0
  v_mfma_f32_16x16x32_bf16 v[184:187], a[180:183], a[88:91], v[184:187]
  ds_read_b64_tr_b16 a[168:169], v3 offset:36864
  v_mfma_f32_16x16x32_bf16 v[184:187], a[176:179], a[72:75], v[184:187]
  buffer_load_dword v240, v47, s[8:11], s61 offen sc1
  v_mfma_f32_16x16x32_bf16 v[180:183], a[176:179], a[68:71], v[180:183]
  ds_read_b64_tr_b16 a[170:171], v3 offset:38912
  v_mfma_f32_16x16x32_bf16 v[180:183], a[180:183], a[84:87], v[180:183]
  s_add_u32 s61, s87, 24576
  v_mfma_f32_16x16x32_bf16 v[176:179], a[180:183], a[80:83], v[176:179]
  ds_read_b64_tr_b16 a[180:181], v4 offset:32768
  v_mfma_f32_16x16x32_bf16 v[176:179], a[176:179], a[64:67], v[176:179]
  s_waitcnt vmcnt(24) lgkmcnt(5)
  buffer_load_dword v241, v47, s[8:11], s61 offen sc1
  v_mfma_f32_16x16x32_bf16 v[64:67], a[164:167], a[96:99], v[64:67]
  ds_read_b64_tr_b16 a[182:183], v4 offset:34816
  v_mfma_f32_16x16x32_bf16 v[64:67], a[160:163], a[112:115], v[64:67]
  s_add_u32 s61, s87, 49152
  v_mfma_f32_16x16x32_bf16 v[68:71], a[160:163], a[116:119], v[68:71]
  ds_read_b64_tr_b16 a[176:177], v4 offset:36864
  v_mfma_f32_16x16x32_bf16 v[68:71], a[164:167], a[100:103], v[68:71]
  buffer_load_dword v242, v47, s[8:11], s61 offen sc1
  v_mfma_f32_16x16x32_bf16 v[72:75], a[164:167], a[104:107], v[72:75]
  ds_read_b64_tr_b16 a[178:179], v4 offset:38912
  v_mfma_f32_16x16x32_bf16 v[72:75], a[160:163], a[120:123], v[72:75]
  s_add_u32 s61, s87, 73728
  v_mfma_f32_16x16x32_bf16 v[76:79], a[160:163], a[124:127], v[76:79]
  ds_read_b64_tr_b16 a[160:161], v5 offset:32768
  v_mfma_f32_16x16x32_bf16 v[76:79], a[164:167], a[108:111], v[76:79]
  s_waitcnt lgkmcnt(5)
  buffer_load_dword v243, v47, s[8:11], s61 offen sc1
  v_mfma_f32_16x16x32_bf16 v[92:95], a[172:175], a[108:111], v[92:95]
  ds_read_b64_tr_b16 a[162:163], v5 offset:34816
  v_mfma_f32_16x16x32_bf16 v[92:95], a[168:171], a[124:127], v[92:95]
  v_mfma_f32_16x16x32_bf16 v[88:91], a[168:171], a[120:123], v[88:91]
  ds_read_b64_tr_b16 a[164:165], v5 offset:36864
  v_mfma_f32_16x16x32_bf16 v[88:91], a[172:175], a[104:107], v[88:91]
  s_cmp_eq_u32 s90, 1
  s_cselect_b32 s74, 2, 9
  s_lshl_b32 s66, s74, 17
  s_lshl_b32 s74, s74, 11
  s_add_u32 s74, s74, s83
  s_add_u32 m0, s45, 0
  v_mfma_f32_16x16x32_bf16 v[84:87], a[172:175], a[100:103], v[84:87]
  ds_read_b64_tr_b16 a[166:167], v5 offset:38912
  v_mfma_f32_16x16x32_bf16 v[84:87], a[168:171], a[116:119], v[84:87]
  buffer_load_dwordx4 v32, s[36:39], s66 offen lds
  v_mfma_f32_16x16x32_bf16 v[80:83], a[168:171], a[112:115], v[80:83]
  ds_read_b64_tr_b16 a[168:169], v2 offset:40960
  v_mfma_f32_16x16x32_bf16 v[80:83], a[172:175], a[96:99], v[80:83]
  s_waitcnt lgkmcnt(5)
  s_add_u32 m0, s45, 4096
  s_add_u32 s60, s66, 65536
  v_mfma_f32_16x16x32_bf16 v[96:99], a[180:183], a[96:99], v[96:99]
  ds_read_b64_tr_b16 a[170:171], v2 offset:43008
  v_mfma_f32_16x16x32_bf16 v[96:99], a[176:179], a[112:115], v[96:99]
  s_sub_u32 s81, s81, 491520
  buffer_load_dwordx4 v32, s[36:39], s60 offen lds
  v_mfma_f32_16x16x32_bf16 v[100:103], a[176:179], a[116:119], v[100:103]
  ds_read_b64_tr_b16 a[172:173], v2 offset:45056
  s_lshl_b32 s82, s44, 28
  s_add_u32 s82, s82, s81
  buffer_load_dword v36, v37, s[8:11], s82 offen sc1
  v_mfma_f32_16x16x32_bf16 v[100:103], a[180:183], a[100:103], v[100:103]
  s_add_u32 m0, s45, 122880
HOP17:
  s_cbranch_execz WRET1
  v_mfma_f32_16x16x32_bf16 v[104:107], a[180:183], a[104:107], v[104:107]
  ds_read_b64_tr_b16 a[174:175], v2 offset:47104
  v_mfma_f32_16x16x32_bf16 v[104:107], a[176:179], a[120:123], v[104:107]
  buffer_load_dwordx4 v33, s[36:39], s63 offen lds
  v_mfma_f32_16x16x32_bf16 v[108:111], a[176:179], a[124:127], v[108:111]
  ds_read_b64_tr_b16 a[176:177], v3 offset:40960
  v_mfma_f32_16x16x32_bf16 v[108:111], a[180:183], a[108:111], v[108:111]
  s_waitcnt lgkmcnt(5)
  s_add_u32 m0, s45, 126976
  s_add_u32 s60, s63, 65536
  v_mfma_f32_16x16x32_bf16 v[124:127], a[160:163], a[108:111], v[124:127]
  ds_read_b64_tr_b16 a[178:179], v3 offset:43008
  v_mfma_f32_16x16x32_bf16 v[124:127], a[164:167], a[124:127], v[124:127]
  buffer_load_dwordx4 v33, s[36:39], s60 offen lds
  v_mfma_f32_16x16x32_bf16 v[120:123], a[164:167], a[120:123], v[120:123]
  ds_read_b64_tr_b16 a[180:181], v3 offset:45056
  v_mfma_f32_16x16x32_bf16 v[120:123], a[160:163], a[104:107], v[120:123]
  v_mfma_f32_16x16x32_bf16 v[116:119], a[160:163], a[100:103], v[116:119]
  ds_read_b64_tr_b16 a[182:183], v3 offset:47104
  v_mfma_f32_16x16x32_bf16 v[116:119], a[164:167], a[116:119], v[116:119]
  s_add_u32 m0, s45, 90112
  v_mfma_f32_16x16x32_bf16 v[112:115], a[164:167], a[112:115], v[112:115]
  ds_read_b64_tr_b16 a[164:165], v4 offset:40960
  v_mfma_f32_16x16x32_bf16 v[112:115], a[160:163], a[96:99], v[112:115]
  s_waitcnt lgkmcnt(5)
  buffer_load_dwordx4 v33, s[36:39], s64 offen lds
  v_mfma_f32_16x16x32_bf16 v[128:131], a[168:171], a[96:99], v[128:131]
  ds_read_b64_tr_b16 a[166:167], v4 offset:43008
  v_mfma_f32_16x16x32_bf16 v[128:131], a[172:175], a[112:115], v[128:131]
  s_add_u32 m0, s45, 94208
  s_add_u32 s60, s64, 65536
  v_mfma_f32_16x16x32_bf16 v[132:135], a[172:175], a[116:119], v[132:135]
  ds_read_b64_tr_b16 a[160:161], v4 offset:45056
  v_mfma_f32_16x16x32_bf16 v[132:135], a[168:171], a[100:103], v[132:135]
  buffer_load_dwordx4 v33, s[36:39], s60 offen lds
  v_mfma_f32_16x16x32_bf16 v[136:139], a[168:171], a[104:107], v[136:139]
  ds_read_b64_tr_b16 a[162:163], v4 offset:47104
  v_mfma_f32_16x16x32_bf16 v[136:139], a[172:175], a[120:123], v[136:139]
  s_add_u32 m0, s45, 73728
  v_mfma_f32_16x16x32_bf16 v[140:143], a[172:175], a[124:127], v[140:143]
  ds_read_b64_tr_b16 a[172:173], v5 offset:40960
  v_mfma_f32_16x16x32_bf16 v[140:143], a[168:171], a[108:111], v[140:143]
  s_waitcnt lgkmcnt(5)
  buffer_load_dwordx4 v33, s[36:39], s65 offen lds
  v_mfma_f32_16x16x32_bf16 v[156:159], a[176:179], a[108:111], v[156:159]
  ds_read_b64_tr_b16 a[174:175], v5 offset:43008
  v_mfma_f32_16x16x32_bf16 v[156:159], a[180:183], a[124:127], v[156:159]
  s_add_u32 m0, s45, 77824
  s_add_u32 s60, s65, 65536
  v_mfma_f32_16x16x32_bf16 v[152:155], a[180:183], a[120:123], v[152:155]
  ds_read_b64_tr_b16 a[168:169], v5 offset:45056
  v_mfma_f32_16x16x32_bf16 v[152:155], a[176:179], a[104:107], v[152:155]
  buffer_load_dwordx4 v33, s[36:39], s60 offen lds
  v_mfma_f32_16x16x32_bf16 v[148:151], a[176:179], a[100:103], v[148:151]
  ds_read_b64_tr_b16 a[170:171], v5 offset:47104
  v_mfma_f32_16x16x32_bf16 v[148:151], a[180:183], a[116:119], v[148:151]
  v_mfma_f32_16x16x32_bf16 v[144:147], a[180:183], a[112:115], v[144:147]
  ds_read_b64_tr_b16 a[180:181], v2 offset:49152
  v_mfma_f32_16x16x32_bf16 v[144:147], a[176:179], a[96:99], v[144:147]
  s_waitcnt lgkmcnt(5)
  v_mfma_f32_16x16x32_bf16 v[160:163], a[164:167], a[96:99], v[160:163]
  ds_read_b64_tr_b16 a[182:183], v2 offset:51200
  v_mfma_f32_16x16x32_bf16 v[160:163], a[160:163], a[112:115], v[160:163]
  v_mfma_f32_16x16x32_bf16 v[164:167], a[160:163], a[116:119], v[164:167]
  ds_read_b64_tr_b16 a[176:177], v2 offset:53248
  v_mfma_f32_16x16x32_bf16 v[164:167], a[164:167], a[100:103], v[164:167]
  v_mfma_f32_16x16x32_bf16 v[168:171], a[164:167], a[104:107], v[168:171]
  ds_read_b64_tr_b16 a[178:179], v2 offset:55296
  v_mfma_f32_16x16x32_bf16 v[168:171], a[160:163], a[120:123], v[168:171]
  v_mfma_f32_16x16x32_bf16 v[172:175], a[160:163], a[124:127], v[172:175]
  ds_read_b64_tr_b16 a[160:161], v3 offset:49152
  v_mfma_f32_16x16x32_bf16 v[172:175], a[164:167], a[108:111], v[172:175]
  s_waitcnt lgkmcnt(5)
  v_mfma_f32_16x16x32_bf16 v[188:191], a[172:175], a[108:111], v[188:191]
  ds_read_b64_tr_b16 a[162:163], v3 offset:51200
  v_mfma_f32_16x16x32_bf16 v[188:191], a[168:171], a[124:127], v[188:191]
  v_mfma_f32_16x16x32_bf16 v[184:187], a[168:171], a[120:123], v[184:187]
  ds_read_b64_tr_b16 a[164:165], v3 offset:53248
  s_waitcnt vmcnt(6)
  s_cmp_lg_u32 s44, 0
  s_cbranch_scc1 PL13_adaLN_cond__sliding_local_dilated__swiglu_ffn__prompt_kernelx
  v_cmp_ne_u32 vcc, s46, v36
  s_nop 4
  s_cbranch_vccz PL13_adaLN_cond__sliding_local_dilated__swiglu_ffn__prompt_kernelx
  s_mov_b32 s82, 60000
PL13_adaLN_cond__sliding_local_dilated__swiglu_ffn__prompt_kernel:
  buffer_load_dword v36, v37, s[8:11], s81 offen sc1
  s_sub_u32 s82, s82, 1
  s_cmp_eq_u32 s82, 0
  s_waitcnt vmcnt(0)
  s_cbranch_scc1 PL13_adaLN_cond__sliding_local_dilated__swiglu_ffn__prompt_kernelx
  v_cmp_ne_u32 vcc, s46, v36
  s_nop 4
  s_cbranch_vccnz PL13_adaLN_cond__sliding_local_dilated__swiglu_ffn__prompt_kernel
PL13_adaLN_cond__sliding_local_dilated__swiglu_ffn__prompt_kernelx:
  s_barrier
  v_mfma_f32_16x16x32_bf16 v[184:187], a[172:175], a[104:107], v[184:187]
  v_mfma_f32_16x16x32_bf16 v[180:183], a[172:175], a[100:103], v[180:183]
  ds_read_b64_tr_b16 a[166:167], v3 offset:55296
  v_mfma_f32_16x16x32_bf16 v[180:183], a[168:171], a[116:119], v[180:183]
  buffer_load_dwordx4 a[188:191], v1, s[8:11], s77 offen offset:0 sc1
  v_mfma_f32_16x16x32_bf16 v[176:179], a[168:171], a[112:115], v[176:179]
  ds_read_b64_tr_b16 a[168:169], v4 offset:49152
  v_mfma_f32_16x16x32_bf16 v[176:179], a[172:175], a[96:99], v[176:179]
  s_waitcnt vmcnt(29) lgkmcnt(5)
  v_mfma_f32_16x16x32_bf16 v[64:67], a[180:183], a[128:131], v[64:67]
  ds_read_b64_tr_b16 a[170:171], v4 offset:51200
  v_mfma_f32_16x16x32_bf16 v[64:67], a[176:179], a[144:147], v[64:67]
  buffer_load_dwordx4 a[204:207], v1, s[8:11], s77 offen offset:1024 sc1
  v_mfma_f32_16x16x32_bf16 v[68:71], a[176:179], a[148:151], v[68:71]
  ds_read_b64_tr_b16 a[172:173], v4 offset:53248
  v_mfma_f32_16x16x32_bf16 v[68:71], a[180:183], a[132:135], v[68:71]
  s_add_u32 s77, s77, 131072
  v_mfma_f32_16x16x32_bf16 v[72:75], a[180:183], a[136:139], v[72:75]
  ds_read_b64_tr_b16 a[174:175], v4 offset:55296
  v_mfma_f32_16x16x32_bf16 v[72:75], a[176:179], a[152:155], v[72:75]
  buffer_load_dwordx4 a[192:195], v1, s[8:11], s77 offen offset:0 sc1
  v_mfma_f32_16x16x32_bf16 v[76:79], a[176:179], a[156:159], v[76:79]
  ds_read_b64_tr_b16 a[176:177], v5 offset:49152
  v_mfma_f32_16x16x32_bf16 v[76:79], a[180:183], a[140:143], v[76:79]
  s_waitcnt lgkmcnt(5)
  v_mfma_f32_16x16x32_bf16 v[92:95], a[160:163], a[140:143], v[92:95]
  ds_read_b64_tr_b16 a[178:179], v5 offset:51200
  v_mfma_f32_16x16x32_bf16 v[92:95], a[164:167], a[156:159], v[92:95]
  v_mfma_f32_16x16x32_bf16 v[88:91], a[164:167], a[152:155], v[88:91]
  ds_read_b64_tr_b16 a[180:181], v5 offset:53248
  v_mfma_f32_16x16x32_bf16 v[88:91], a[160:163], a[136:139], v[88:91]
  buffer_load_dwordx4 a[208:211], v1, s[8:11], s77 offen offset:1024 sc1
  v_mfma_f32_16x16x32_bf16 v[84:87], a[160:163], a[132:135], v[84:87]
  ds_read_b64_tr_b16 a[182:183], v5 offset:55296
  v_mfma_f32_16x16x32_bf16 v[84:87], a[164:167], a[148:151], v[84:87]
  s_add_u32 s77, s77, s88
  v_mfma_f32_16x16x32_bf16 v[80:83], a[164:167], a[144:147], v[80:83]
  ds_read_b64_tr_b16 a[164:165], v2 offset:57344
  v_mfma_f32_16x16x32_bf16 v[80:83], a[160:163], a[128:131], v[80:83]
  s_waitcnt lgkmcnt(5)
  buffer_load_dwordx4 a[196:199], v1, s[8:11], s77 offen offset:0 sc1
  v_mfma_f32_16x16x32_bf16 v[96:99], a[168:171], a[128:131], v[96:99]
  ds_read_b64_tr_b16 a[166:167], v2 offset:59392
  v_mfma_f32_16x16x32_bf16 v[96:99], a[172:175], a[144:147], v[96:99]
  v_mfma_f32_16x16x32_bf16 v[100:103], a[172:175], a[148:151], v[100:103]
  ds_read_b64_tr_b16 a[160:161], v2 offset:61440
  v_mfma_f32_16x16x32_bf16 v[100:103], a[168:171], a[132:135], v[100:103]
  buffer_load_dwordx4 a[212:215], v1, s[8:11], s77 offen offset:1024 sc1
  v_mfma_f32_16x16x32_bf16 v[104:107], a[168:171], a[136:139], v[104:107]
  ds_read_b64_tr_b16 a[162:163], v2 offset:63488
  v_mfma_f32_16x16x32_bf16 v[104:107], a[172:175], a[152:155], v[104:107]
  s_add_u32 s77, s77, 131072
  v_mfma_f32_16x16x32_bf16 v[108:111], a[172:175], a[156:159], v[108:111]
  ds_read_b64_tr_b16 a[172:173], v3 offset:57344
  v_mfma_f32_16x16x32_bf16 v[108:111], a[168:171], a[140:143], v[108:111]
  s_waitcnt lgkmcnt(5)
  buffer_load_dwordx4 a[200:203], v1, s[8:11], s77 offen offset:0 sc1
  v_mfma_f32_16x16x32_bf16 v[124:127], a[176:179], a[140:143], v[124:127]
  ds_read_b64_tr_b16 a[174:175], v3 offset:59392
  v_mfma_f32_16x16x32_bf16 v[124:127], a[180:183], a[156:159], v[124:127]
  v_mfma_f32_16x16x32_bf16 v[120:123], a[180:183], a[152:155], v[120:123]
  ds_read_b64_tr_b16 a[168:169], v3 offset:61440
  v_mfma_f32_16x16x32_bf16 v[120:123], a[176:179], a[136:139], v[120:123]
  v_mfma_f32_16x16x32_bf16 v[116:119], a[176:179], a[132:135], v[116:119]
  ds_read_b64_tr_b16 a[170:171], v3 offset:63488
  v_mfma_f32_16x16x32_bf16 v[116:119], a[180:183], a[148:151], v[116:119]
  buffer_load_dwordx4 a[216:219], v1, s[8:11], s77 offen offset:1024 sc1
  v_mfma_f32_16x16x32_bf16 v[112:115], a[180:183], a[144:147], v[112:115]
  ds_read_b64_tr_b16 a[180:181], v4 offset:57344
  v_mfma_f32_16x16x32_bf16 v[112:115], a[176:179], a[128:131], v[112:115]
  s_waitcnt lgkmcnt(5)
  v_mfma_f32_16x16x32_bf16 v[128:131], a[164:167], a[128:131], v[128:131]
  ds_read_b64_tr_b16 a[182:183], v4 offset:59392
  v_mfma_f32_16x16x32_bf16 v[128:131], a[160:163], a[144:147], v[128:131]
  buffer_load_dwordx4 a[220:223], v1, s[8:11], s78 offen offset:0 sc1
  v_mfma_f32_16x16x32_bf16 v[132:135], a[160:163], a[148:151], v[132:135]
  ds_read_b64_tr_b16 a[176:177], v4 offset:61440
  v_mfma_f32_16x16x32_bf16 v[132:135], a[164:167], a[132:135], v[132:135]
  v_mfma_f32_16x16x32_bf16 v[136:139], a[164:167], a[136:139], v[136:139]
  ds_read_b64_tr_b16 a[178:179], v4 offset:63488
  v_mfma_f32_16x16x32_bf16 v[136:139], a[160:163], a[152:155], v[136:139]
  buffer_load_dwordx4 a[236:239], v1, s[8:11], s78 offen offset:1024 sc1
  v_mfma_f32_16x16x32_bf16 v[140:143], a[160:163], a[156:159], v[140:143]
  ds_read_b64_tr_b16 a[160:161], v5 offset:57344
  v_mfma_f32_16x16x32_bf16 v[140:143], a[164:167], a[140:143], v[140:143]
  s_waitcnt lgkmcnt(5)
  s_add_u32 s78, s78, 131072
  v_mfma_f32_16x16x32_bf16 v[156:159], a[172:175], a[140:143], v[156:159]
  ds_read_b64_tr_b16 a[162:163], v5 offset:59392
  v_mfma_f32_16x16x32_bf16 v[156:159], a[168:171], a[156:159], v[156:159]
  buffer_load_dwordx4 a[224:227], v1, s[8:11], s78 offen offset:0 sc1
  ds_read_b128 v[192:195], v44 offset:0
  v_mfma_f32_16x16x32_bf16 v[152:155], a[168:171], a[152:155], v[152:155]
  ds_read_b64_tr_b16 a[164:165], v5 offset:61440
  v_mfma_f32_16x16x32_bf16 v[152:155], a[172:175], a[136:139], v[152:155]
  ds_read_b128 v[196:199], v44 offset:1024
  v_mfma_f32_16x16x32_bf16 v[148:151], a[172:175], a[132:135], v[148:151]
  ds_read_b64_tr_b16 a[166:167], v5 offset:63488
  v_mfma_f32_16x16x32_bf16 v[148:151], a[168:171], a[148:151], v[148:151]
  s_waitcnt vmcnt(35)
  s_barrier
  v_mfma_f32_16x16x32_bf16 v[144:147], a[168:171], a[144:147], v[144:147]
  ds_read_b64_tr_b16 a[168:169], v2 offset:16384
  v_mfma_f32_16x16x32_bf16 v[144:147], a[172:175], a[128:131], v[144:147]
  s_waitcnt lgkmcnt(7)
  buffer_load_dwordx4 a[240:243], v1, s[8:11], s78 offen offset:1024 sc1
  v_mfma_f32_16x16x32_bf16 v[160:163], a[180:183], a[128:131], v[160:163]
  ds_read_b64_tr_b16 a[170:171], v2 offset:18432
  ds_read_b128 v[200:203], v44 offset:2048
  v_mfma_f32_16x16x32_bf16 v[160:163], a[176:179], a[144:147], v[160:163]
  s_add_u32 s78, s78, s88
  ds_read_b128 v[204:207], v44 offset:3072
  v_mfma_f32_16x16x32_bf16 v[164:167], a[176:179], a[148:151], v[164:167]
  ds_read_b64_tr_b16 a[172:173], v2 offset:20480
  s_waitcnt vmcnt(21)
  v_mfma_f32_16x16x32_bf16 v[164:167], a[180:183], a[132:135], v[164:167]
  buffer_load_dwordx4 a[228:231], v1, s[8:11], s78 offen offset:0 sc1
  v_add_f32 v240, v240, v241
  v_add_f32 v242, v242, v243
  v_mfma_f32_16x16x32_bf16 v[168:171], a[180:183], a[136:139], v[168:171]
  ds_read_b64_tr_b16 a[174:175], v2 offset:22528
  v_add_f32 v240, v240, v242
  v_mfma_f32_16x16x32_bf16 v[168:171], a[176:179], a[152:155], v[168:171]
  v_cvt_pk_bf16_f32 v240, v240, v240
  v_lshlrev_b32 v240, 16, v240
  v_mfma_f32_16x16x32_bf16 v[172:175], a[176:179], a[156:159], v[172:175]
  ds_read_b64_tr_b16 a[176:177], v3 offset:16384
  v_mfma_f32_16x16x32_bf16 v[172:175], a[180:183], a[140:143], v[172:175]
  s_waitcnt lgkmcnt(7)
  buffer_load_dwordx4 a[244:247], v1, s[8:11], s78 offen offset:1024 sc1
  v_mfma_f32_16x16x32_bf16 v[188:191], a[160:163], a[140:143], v[188:191]
  ds_read_b64_tr_b16 a[178:179], v3 offset:18432
  v_mfma_f32_16x16x32_bf16 v[188:191], a[164:167], a[156:159], v[188:191]
  s_add_u32 s78, s78, 131072
  ds_write_b32 v45, v240
  v_mfma_f32_16x16x32_bf16 v[184:187], a[164:167], a[152:155], v[184:187]
  ds_read_b64_tr_b16 a[180:181], v3 offset:20480
  v_mfma_f32_16x16x32_bf16 v[184:187], a[160:163], a[136:139], v[184:187]
  buffer_load_dwordx4 a[232:235], v1, s[8:11], s78 offen offset:0 sc1
  ds_read_b128 v[240:243], v46 offset:0
  v_mfma_f32_16x16x32_bf16 v[180:183], a[160:163], a[132:135], v[180:183]
  ds_read_b64_tr_b16 a[182:183], v3 offset:22528
  v_mfma_f32_16x16x32_bf16 v[180:183], a[164:167], a[148:151], v[180:183]
  ds_read_b128 v[244:247], v46 offset:64
  v_mfma_f32_16x16x32_bf16 v[176:179], a[164:167], a[144:147], v[176:179]
  ds_read_b64_tr_b16 a[164:165], v4 offset:16384
  v_mfma_f32_16x16x32_bf16 v[176:179], a[160:163], a[128:131], v[176:179]
  s_waitcnt vmcnt(7) lgkmcnt(8)
  ds_read_b128 v[248:251], v46 offset:128
  v_mfma_f32_16x16x32_bf16 v[64:67], a[168:171], a[188:191], v[64:67]
  ds_read_b64_tr_b16 a[166:167], v4 offset:18432
  v_mfma_f32_16x16x32_bf16 v[64:67], a[172:175], a[204:207], v[64:67]
  buffer_load_dwordx4 a[248:251], v1, s[8:11], s78 offen offset:1024 sc1
  ds_read_b128 v[252:255], v46 offset:192
  v_mfma_f32_16x16x32_bf16 v[68:71], a[172:175], a[208:211], v[68:71]
  ds_read_b64_tr_b16 a[160:161], v4 offset:20480
  s_waitcnt lgkmcnt(14)
  v_mfma_f32_16x16x32_bf16 v[68:71], a[168:171], a[192:195], v[68:71]
  v_lshlrev_b32 v208, 16, v192
  v_and_b32 v209, 0xffff0000, v192
  v_mfma_f32_16x16x32_bf16 v[72:75], a[168:171], a[196:199], v[72:75]
  ds_read_b64_tr_b16 a[162:163], v4 offset:22528
  v_lshlrev_b32 v210, 16, v193
  v_mfma_f32_16x16x32_bf16 v[72:75], a[172:175], a[212:215], v[72:75]
  buffer_load_dwordx4 a[0:3], v1, s[8:11], s71 offen offset:0 sc1
  v_and_b32 v211, 0xffff0000, v193
  v_lshlrev_b32 v212, 16, v194
  v_mfma_f32_16x16x32_bf16 v[76:79], a[172:175], a[216:219], v[76:79]
  ds_read_b64_tr_b16 a[172:173], v5 offset:16384
  v_and_b32 v213, 0xffff0000, v194
  v_mfma_f32_16x16x32_bf16 v[76:79], a[168:171], a[200:203], v[76:79]
  s_waitcnt lgkmcnt(8)
  v_lshlrev_b32 v214, 16, v195
  v_and_b32 v215, 0xffff0000, v195
  v_mfma_f32_16x16x32_bf16 v[92:95], a[176:179], a[200:203], v[92:95]
  ds_read_b64_tr_b16 a[174:175], v5 offset:18432
  v_lshlrev_b32 v216, 16, v196
  v_mfma_f32_16x16x32_bf16 v[92:95], a[180:183], a[216:219], v[92:95]
  buffer_load_dwordx4 a[16:19], v1, s[8:11], s71 offen offset:1024 sc1
  v_and_b32 v217, 0xffff0000, v196
  v_lshlrev_b32 v218, 16, v197
  v_mfma_f32_16x16x32_bf16 v[88:91], a[180:183], a[212:215], v[88:91]
  ds_read_b64_tr_b16 a[168:169], v5 offset:20480
  v_and_b32 v219, 0xffff0000, v197
  v_mfma_f32_16x16x32_bf16 v[88:91], a[176:179], a[196:199], v[88:91]
  s_add_u32 s71, s71, 131072
  v_lshlrev_b32 v220, 16, v198
  v_and_b32 v221, 0xffff0000, v198
  v_mfma_f32_16x16x32_bf16 v[84:87], a[176:179], a[192:195], v[84:87]
  ds_read_b64_tr_b16 a[170:171], v5 offset:22528
  v_lshlrev_b32 v222, 16, v199
  v_mfma_f32_16x16x32_bf16 v[84:87], a[180:183], a[208:211], v[84:87]
  buffer_load_dwordx4 a[4:7], v1, s[8:11], s71 offen offset:0 sc1
  v_and_b32 v223, 0xffff0000, v199
  v_lshlrev_b32 v224, 16, v200
  v_mfma_f32_16x16x32_bf16 v[80:83], a[180:183], a[204:207], v[80:83]
  ds_read_b64_tr_b16 a[180:181], v2 offset:24576
  v_and_b32 v225, 0xffff0000, v200
  v_mfma_f32_16x16x32_bf16 v[80:83], a[176:179], a[188:191], v[80:83]
  s_waitcnt lgkmcnt(5)
  v_lshlrev_b32 v226, 16, v201
  v_and_b32 v227, 0xffff0000, v201
  v_mfma_f32_16x16x32_bf16 v[96:99], a[164:167], a[188:191], v[96:99]
  ds_read_b64_tr_b16 a[182:183], v2 offset:26624
  v_lshlrev_b32 v228, 16, v202
  v_mfma_f32_16x16x32_bf16 v[96:99], a[160:163], a[204:207], v[96:99]
  v_and_b32 v229, 0xffff0000, v202
  v_lshlrev_b32 v230, 16, v203
  v_mfma_f32_16x16x32_bf16 v[100:103], a[160:163], a[208:211], v[100:103]
  ds_read_b64_tr_b16 a[176:177], v2 offset:28672
  v_and_b32 v231, 0xffff0000, v203
  v_mfma_f32_16x16x32_bf16 v[100:103], a[164:167], a[192:195], v[100:103]
  buffer_load_dwordx4 a[20:23], v1, s[8:11], s71 offen offset:1024 sc1
  v_lshlrev_b32 v232, 16, v204
  v_and_b32 v233, 0xffff0000, v204
  v_mfma_f32_16x16x32_bf16 v[104:107], a[164:167], a[196:199], v[104:107]
  ds_read_b64_tr_b16 a[178:179], v2 offset:30720
  v_lshlrev_b32 v234, 16, v205
  v_mfma_f32_16x16x32_bf16 v[104:107], a[160:163], a[212:215], v[104:107]
  s_add_u32 s71, s71, s88
  v_and_b32 v235, 0xffff0000, v205
  v_lshlrev_b32 v236, 16, v206
  v_mfma_f32_16x16x32_bf16 v[108:111], a[160:163], a[216:219], v[108:111]
  ds_read_b64_tr_b16 a[160:161], v3 offset:24576
  v_and_b32 v237, 0xffff0000, v206
  v_mfma_f32_16x16x32_bf16 v[108:111], a[164:167], a[200:203], v[108:111]
  s_waitcnt lgkmcnt(5)
  buffer_load_dwordx4 a[8:11], v1, s[8:11], s71 offen offset:0 sc1
  v_lshlrev_b32 v238, 16, v207
  v_mfma_f32_16x16x32_bf16 v[124:127], a[172:175], a[200:203], v[124:127]
  ds_read_b64_tr_b16 a[162:163], v3 offset:26624
  v_and_b32 v239, 0xffff0000, v207
  v_mfma_f32_16x16x32_bf16 v[124:127], a[168:171], a[216:219], v[124:127]
  v_mov_b32 v37, 0
  s_waitcnt lgkmcnt(12)
  v_mfma_f32_16x16x32_bf16 v[120:123], a[168:171], a[212:215], v[120:123]
  ds_read_b64_tr_b16 a[164:165], v3 offset:28672
  v_cvt_pk_bf16_f32 v52, v240, v241
  v_mfma_f32_16x16x32_bf16 v[120:123], a[172:175], a[196:199], v[120:123]
  buffer_load_dwordx4 a[24:27], v1, s[8:11], s71 offen offset:1024 sc1
  v_and_b32 v52, v52, v50
  v_cvt_pk_bf16_f32 v53, v242, v243
  v_mfma_f32_16x16x32_bf16 v[116:119], a[172:175], a[192:195], v[116:119]
  ds_read_b64_tr_b16 a[166:167], v3 offset:30720
  v_and_b32 v53, v53, v51
  v_mfma_f32_16x16x32_bf16 v[116:119], a[168:171], a[208:211], v[116:119]
  s_add_u32 s71, s71, 131072
  v_cvt_pk_bf16_f32 v56, v244, v245
  v_and_b32 v56, v56, v50
  v_mfma_f32_16x16x32_bf16 v[112:115], a[168:171], a[204:207], v[112:115]
  ds_read_b64_tr_b16 a[168:169], v4 offset:24576
  v_cvt_pk_bf16_f32 v57, v246, v247
  v_mfma_f32_16x16x32_bf16 v[112:115], a[172:175], a[188:191], v[112:115]
  s_waitcnt lgkmcnt(5)
  buffer_load_dwordx4 a[12:15], v1, s[8:11], s71 offen offset:0 sc1
  v_and_b32 v57, v57, v51
  v_mfma_f32_16x16x32_bf16 v[128:131], a[180:183], a[188:191], v[128:131]
  ds_read_b64_tr_b16 a[170:171], v4 offset:26624
  v_cvt_pk_bf16_f32 v58, v248, v249
  v_mfma_f32_16x16x32_bf16 v[128:131], a[176:179], a[204:207], v[128:131]
  v_and_b32 v58, v58, v50
  v_cvt_pk_bf16_f32 v59, v250, v251
  v_mfma_f32_16x16x32_bf16 v[132:135], a[176:179], a[208:211], v[132:135]
  ds_read_b64_tr_b16 a[172:173], v4 offset:28672
  v_and_b32 v59, v59, v51
  v_mfma_f32_16x16x32_bf16 v[132:135], a[180:183], a[192:195], v[132:135]
  v_cvt_pk_bf16_f32 v62, v252, v253
  v_and_b32 v62, v62, v50
  v_mfma_f32_16x16x32_bf16 v[136:139], a[180:183], a[196:199], v[136:139]
  ds_read_b64_tr_b16 a[174:175], v4 offset:30720
  v_cvt_pk_bf16_f32 v63, v254, v255
  v_mfma_f32_16x16x32_bf16 v[136:139], a[176:179], a[212:215], v[136:139]
  buffer_load_dwordx4 a[28:31], v1, s[8:11], s71 offen offset:1024 sc1
  v_and_b32 v63, v63, v51
  v_mfma_f32_16x16x32_bf16 v[140:143], a[176:179], a[216:219], v[140:143]
  ds_read_b64_tr_b16 a[176:177], v5 offset:24576
  v_mfma_f32_16x16x32_bf16 v[140:143], a[180:183], a[200:203], v[140:143]
  s_waitcnt lgkmcnt(5)
  s_cmp_eq_u32 s90, 2
  s_cselect_b32 s75, 4, 11
  s_lshl_b32 s67, s75, 17
  s_lshl_b32 s75, s75, 11
  s_add_u32 s75, s75, s83
  s_add_u32 m0, s45, 32768
  v_mfma_f32_16x16x32_bf16 v[156:159], a[160:163], a[200:203], v[156:159]
  ds_read_b64_tr_b16 a[178:179], v5 offset:26624
  v_mfma_f32_16x16x32_bf16 v[156:159], a[164:167], a[216:219], v[156:159]
  buffer_load_dwordx4 v32, s[36:39], s67 offen lds
  v_mfma_f32_16x16x32_bf16 v[152:155], a[164:167], a[212:215], v[152:155]
  ds_read_b64_tr_b16 a[180:181], v5 offset:28672
  v_mfma_f32_16x16x32_bf16 v[152:155], a[160:163], a[196:199], v[152:155]
  s_add_u32 m0, s45, 36864
  s_add_u32 s60, s67, 65536
  v_mfma_f32_16x16x32_bf16 v[148:151], a[160:163], a[192:195], v[148:151]
  ds_read_b64_tr_b16 a[182:183], v5 offset:30720
  v_mfma_f32_16x16x32_bf16 v[148:151], a[164:167], a[208:211], v[148:151]
  buffer_load_dwordx4 v32, s[36:39], s60 offen lds
  s_waitcnt vmcnt(45)
  s_barrier
  v_mfma_f32_16x16x32_bf16 v[144:147], a[164:167], a[204:207], v[144:147]
  ds_read_b64_tr_b16 a[164:165], v6 offset:32768
  v_mfma_f32_16x16x32_bf16 v[144:147], a[160:163], a[188:191], v[144:147]
  s_waitcnt lgkmcnt(5)
  s_cmp_eq_u32 s90, 3
  s_cselect_b32 s76, 6, 13
  s_lshl_b32 s68, s76, 17
  s_lshl_b32 s76, s76, 11
  s_add_u32 s76, s76, s83
  s_add_u32 m0, s45, 49152
  v_mfma_f32_16x16x32_bf16 v[160:163], a[168:171], a[188:191], v[160:163]
  ds_read_b64_tr_b16 a[166:167], v6 offset:34816
  v_mfma_f32_16x16x32_bf16 v[160:163], a[172:175], a[204:207], v[160:163]
  buffer_load_dwordx4 v32, s[36:39], s68 offen lds
  v_mfma_f32_16x16x32_bf16 v[164:167], a[172:175], a[208:211], v[164:167]
  ds_read_b64_tr_b16 a[160:161], v6 offset:36864
  v_mfma_f32_16x16x32_bf16 v[164:167], a[168:171], a[192:195], v[164:167]
  v_mfma_f32_16x16x32_bf16 v[168:171], a[168:171], a[196:199], v[168:171]
  ds_read_b64_tr_b16 a[162:163], v6 offset:38912
  v_mfma_f32_16x16x32_bf16 v[168:171], a[172:175], a[212:215], v[168:171]
  s_add_u32 m0, s45, 53248
  s_add_u32 s60, s68, 65536
  v_mfma_f32_16x16x32_bf16 v[172:175], a[172:175], a[216:219], v[172:175]
  ds_read_b64_tr_b16 a[172:173], v7 offset:32768
  v_mfma_f32_16x16x32_bf16 v[172:175], a[168:171], a[200:203], v[172:175]
  s_waitcnt lgkmcnt(5)
  buffer_load_dwordx4 v32, s[36:39], s60 offen lds
  v_mfma_f32_16x16x32_bf16 v[188:191], a[176:179], a[200:203], v[188:191]
  ds_read_b64_tr_b16 a[174:175], v7 offset:34816
  v_mfma_f32_16x16x32_bf16 v[188:191], a[180:183], a[216:219], v[188:191]
  v_mfma_f32_16x16x32_bf16 v[184:187], a[180:183], a[212:215], v[184:187]
  ds_read_b64_tr_b16 a[168:169], v7 offset:36864
  v_mfma_f32_16x16x32_bf16 v[184:187], a[176:179], a[196:199], v[184:187]
  buffer_load_dwordx4 a[32:35], v1, s[8:11], s72 offen offset:0 sc1
  v_mfma_f32_16x16x32_bf16 v[180:183], a[176:179], a[192:195], v[180:183]
  ds_read_b64_tr_b16 a[170:171], v7 offset:38912
  v_mfma_f32_16x16x32_bf16 v[180:183], a[180:183], a[208:211], v[180:183]
  v_mfma_f32_16x16x32_bf16 v[176:179], a[180:183], a[204:207], v[176:179]
  ds_read_b64_tr_b16 a[180:181], v8 offset:32768
  v_mfma_f32_16x16x32_bf16 v[176:179], a[176:179], a[188:191], v[176:179]
  s_waitcnt vmcnt(13) lgkmcnt(5)
  buffer_load_dwordx4 a[48:51], v1, s[8:11], s72 offen offset:1024 sc1
  v_mfma_f32_16x16x32_bf16 v[64:67], a[164:167], a[220:223], v[64:67]
  ds_read_b64_tr_b16 a[182:183], v8 offset:34816
  v_mfma_f32_16x16x32_bf16 v[64:67], a[160:163], a[236:239], v[64:67]
  s_add_u32 s72, s72, 131072
  v_mfma_f32_16x16x32_bf16 v[68:71], a[160:163], a[240:243], v[68:71]
  ds_read_b64_tr_b16 a[176:177], v8 offset:36864
  v_mfma_f32_16x16x32_bf16 v[68:71], a[164:167], a[224:227], v[68:71]
  buffer_load_dwordx4 a[36:39], v1, s[8:11], s72 offen offset:0 sc1
  v_mfma_f32_16x16x32_bf16 v[72:75], a[164:167], a[228:231], v[72:75]
  ds_read_b64_tr_b16 a[178:179], v8 offset:38912
  v_mfma_f32_16x16x32_bf16 v[72:75], a[160:163], a[244:247], v[72:75]
  v_mfma_f32_16x16x32_bf16 v[76:79], a[160:163], a[248:251], v[76:79]
  ds_read_b64_tr_b16 a[160:161], v9 offset:32768
  v_mfma_f32_16x16x32_bf16 v[76:79], a[164:167], a[232:235], v[76:79]
  s_waitcnt lgkmcnt(5)
  v_mfma_f32_16x16x32_bf16 v[92:95], a[172:175], a[232:235], v[92:95]
  ds_read_b64_tr_b16 a[162:163], v9 offset:34816
  v_mfma_f32_16x16x32_bf16 v[92:95], a[168:171], a[248:251], v[92:95]
  buffer_load_dwordx4 a[52:55], v1, s[8:11], s72 offen offset:1024 sc1
  v_mfma_f32_16x16x32_bf16 v[88:91], a[168:171], a[244:247], v[88:91]
  ds_read_b64_tr_b16 a[164:165], v9 offset:36864
  v_mfma_f32_16x16x32_bf16 v[88:91], a[172:175], a[228:231], v[88:91]
  s_add_u32 s72, s72, s88
  v_mfma_f32_16x16x32_bf16 v[84:87], a[172:175], a[224:227], v[84:87]
  ds_read_b64_tr_b16 a[166:167], v9 offset:38912
  v_mfma_f32_16x16x32_bf16 v[84:87], a[168:171], a[240:243], v[84:87]
  buffer_load_dwordx4 a[40:43], v1, s[8:11], s72 offen offset:0 sc1
  v_mfma_f32_16x16x32_bf16 v[80:83], a[168:171], a[236:239], v[80:83]
  ds_read_b64_tr_b16 a[168:169], v6 offset:49152
  v_mfma_f32_16x16x32_bf16 v[80:83], a[172:175], a[220:223], v[80:83]
  s_waitcnt lgkmcnt(5)
  v_mfma_f32_16x16x32_bf16 v[96:99], a[180:183], a[220:223], v[96:99]
  ds_read_b64_tr_b16 a[170:171], v6 offset:51200
  v_mfma_f32_16x16x32_bf16 v[96:99], a[176:179], a[236:239], v[96:99]
  buffer_load_dwordx4 a[56:59], v1, s[8:11], s72 offen offset:1024 sc1
  v_mfma_f32_16x16x32_bf16 v[100:103], a[176:179], a[240:243], v[100:103]
  ds_read_b64_tr_b16 a[172:173], v6 offset:53248
  v_mfma_f32_16x16x32_bf16 v[100:103], a[180:183], a[224:227], v[100:103]
  s_add_u32 s72, s72, 131072
  v_mfma_f32_16x16x32_bf16 v[104:107], a[180:183], a[228:231], v[104:107]
  ds_read_b64_tr_b16 a[174:175], v6 offset:55296
  v_mfma_f32_16x16x32_bf16 v[104:107], a[176:179], a[244:247], v[104:107]
  buffer_load_dwordx4 a[44:47], v1, s[8:11], s72 offen offset:0 sc1
  v_mfma_f32_16x16x32_bf16 v[108:111], a[176:179], a[248:251], v[108:111]
  ds_read_b64_tr_b16 a[176:177], v7 offset:49152
  v_mfma_f32_16x16x32_bf16 v[108:111], a[180:183], a[232:235], v[108:111]
  s_waitcnt lgkmcnt(5)
  v_mfma_f32_16x16x32_bf16 v[124:127], a[160:163], a[232:235], v[124:127]
  ds_read_b64_tr_b16 a[178:179], v7 offset:51200
  v_mfma_f32_16x16x32_bf16 v[124:127], a[164:167], a[248:251], v[124:127]
  v_mfma_f32_16x16x32_bf16 v[120:123], a[164:167], a[244:247], v[120:123]
  ds_read_b64_tr_b16 a[180:181], v7 offset:53248
  v_mfma_f32_16x16x32_bf16 v[120:123], a[160:163], a[228:231], v[120:123]
  buffer_load_dwordx4 a[60:63], v1, s[8:11], s72 offen offset:1024 sc1
  v_mfma_f32_16x16x32_bf16 v[116:119], a[160:163], a[224:227], v[116:119]
  ds_read_b64_tr_b16 a[182:183], v7 offset:55296
  v_mfma_f32_16x16x32_bf16 v[116:119], a[164:167], a[240:243], v[116:119]
  v_mfma_f32_16x16x32_bf16 v[112:115], a[164:167], a[236:239], v[112:115]
  ds_read_b64_tr_b16 a[164:165], v8 offset:49152
  v_mfma_f32_16x16x32_bf16 v[112:115], a[160:163], a[220:223], v[112:115]
  s_waitcnt vmcnt(12) lgkmcnt(5)
  buffer_load_dwordx4 a[64:67], v1, s[8:11], s73 offen offset:0 sc1
  v_mfma_f32_16x16x32_bf16 v[64:67], a[168:171], a[0:3], v[64:67]
  ds_read_b64_tr_b16 a[166:167], v8 offset:51200
  v_mfma_f32_16x16x32_bf16 v[64:67], a[172:175], a[16:19], v[64:67]
  v_mfma_f32_16x16x32_bf16 v[68:71], a[172:175], a[20:23], v[68:71]
  ds_read_b64_tr_b16 a[160:161], v8 offset:53248
  v_mfma_f32_16x16x32_bf16 v[68:71], a[168:171], a[4:7], v[68:71]
  buffer_load_dwordx4 a[80:83], v1, s[8:11], s73 offen offset:1024 sc1
  v_mfma_f32_16x16x32_bf16 v[72:75], a[168:171], a[8:11], v[72:75]
  ds_read_b64_tr_b16 a[162:163], v8 offset:55296
  v_mfma_f32_16x16x32_bf16 v[72:75], a[172:175], a[24:27], v[72:75]
  s_add_u32 s73, s73, 131072
  v_mfma_f32_16x16x32_bf16 v[76:79], a[172:175], a[28:31], v[76:79]
  ds_read_b64_tr_b16 a[172:173], v9 offset:49152
  v_mfma_f32_16x16x32_bf16 v[76:79], a[168:171], a[12:15], v[76:79]
  s_waitcnt lgkmcnt(5)
  buffer_load_dwordx4 a[68:71], v1, s[8:11], s73 offen offset:0 sc1
  v_mfma_f32_16x16x32_bf16 v[92:95], a[176:179], a[12:15], v[92:95]
  ds_read_b64_tr_b16 a[174:175], v9 offset:51200
  v_mfma_f32_16x16x32_bf16 v[92:95], a[180:183], a[28:31], v[92:95]
  v_mfma_f32_16x16x32_bf16 v[88:91], a[180:183], a[24:27], v[88:91]
  ds_read_b64_tr_b16 a[168:169], v9 offset:53248
  v_mfma_f32_16x16x32_bf16 v[88:91], a[176:179], a[8:11], v[88:91]
  v_mfma_f32_16x16x32_bf16 v[84:87], a[176:179], a[4:7], v[84:87]
  ds_read_b64_tr_b16 a[170:171], v9 offset:55296
  buffer_load_dwordx4 a[84:87], v1, s[8:11], s73 offen offset:1024 sc1
  v_mfma_f32_16x16x32_bf16 v[84:87], a[180:183], a[20:23], v[84:87]
  s_waitcnt vmcnt(12)
  s_barrier
  v_mfma_f32_16x16x32_bf16 v[80:83], a[180:183], a[16:19], v[80:83]
  ds_read_b64_tr_b16 a[180:181], v6 offset:16384
  v_mfma_f32_16x16x32_bf16 v[80:83], a[176:179], a[0:3], v[80:83]
  s_waitcnt lgkmcnt(5)
  s_add_u32 s73, s73, s88
  v_mfma_f32_16x16x32_bf16 v[96:99], a[164:167], a[0:3], v[96:99]
  ds_read_b64_tr_b16 a[182:183], v6 offset:18432
  v_mfma_f32_16x16x32_bf16 v[96:99], a[160:163], a[16:19], v[96:99]
  buffer_load_dwordx4 a[72:75], v1, s[8:11], s73 offen offset:0 sc1
  v_mfma_f32_16x16x32_bf16 v[100:103], a[160:163], a[20:23], v[100:103]
  ds_read_b64_tr_b16 a[176:177], v6 offset:20480
  v_mfma_f32_16x16x32_bf16 v[100:103], a[164:167], a[4:7], v[100:103]
  v_mfma_f32_16x16x32_bf16 v[104:107], a[164:167], a[8:11], v[104:107]
  ds_read_b64_tr_b16 a[178:179], v6 offset:22528
  v_mfma_f32_16x16x32_bf16 v[104:107], a[160:163], a[24:27], v[104:107]
  buffer_load_dwordx4 a[88:91], v1, s[8:11], s73 offen offset:1024 sc1
  v_mfma_f32_16x16x32_bf16 v[108:111], a[160:163], a[28:31], v[108:111]
  ds_read_b64_tr_b16 a[160:161], v7 offset:16384
  v_mfma_f32_16x16x32_bf16 v[108:111], a[164:167], a[12:15], v[108:111]
  s_waitcnt lgkmcnt(5)
  s_add_u32 s73, s73, 131072
  v_mfma_f32_16x16x32_bf16 v[124:127], a[172:175], a[12:15], v[124:127]
  ds_read_b64_tr_b16 a[162:163], v7 offset:18432
  v_mfma_f32_16x16x32_bf16 v[124:127], a[168:171], a[28:31], v[124:127]
  buffer_load_dwordx4 a[76:79], v1, s[8:11], s73 offen offset:0 sc1
  v_mfma_f32_16x16x32_bf16 v[120:123], a[168:171], a[24:27], v[120:123]
  ds_read_b64_tr_b16 a[164:165], v7 offset:20480
  v_mfma_f32_16x16x32_bf16 v[120:123], a[172:175], a[8:11], v[120:123]
  v_mfma_f32_16x16x32_bf16 v[116:119], a[172:175], a[4:7], v[116:119]
  ds_read_b64_tr_b16 a[166:167], v7 offset:22528
  v_mfma_f32_16x16x32_bf16 v[116:119], a[168:171], a[20:23], v[116:119]
  v_mfma_f32_16x16x32_bf16 v[112:115], a[168:171], a[16:19], v[112:115]
  ds_read_b64_tr_b16 a[168:169], v8 offset:16384
  v_mfma_f32_16x16x32_bf16 v[112:115], a[172:175], a[0:3], v[112:115]
  s_waitcnt vmcnt(7) lgkmcnt(5)
HOP18:
  s_cbranch_execz WRET1
  buffer_load_dwordx4 a[92:95], v1, s[8:11], s73 offen offset:1024 sc1
  v_mfma_f32_16x16x32_bf16 v[64:67], a[180:183], a[32:35], v[64:67]
  ds_read_b64_tr_b16 a[170:171], v8 offset:18432
  v_mfma_f32_16x16x32_bf16 v[64:67], a[176:179], a[48:51], v[64:67]
  v_mfma_f32_16x16x32_bf16 v[68:71], a[176:179], a[52:55], v[68:71]
  ds_read_b64_tr_b16 a[172:173], v8 offset:20480
  v_mfma_f32_16x16x32_bf16 v[68:71], a[180:183], a[36:39], v[68:71]
  buffer_load_dwordx4 a[96:99], v1, s[8:11], s74 offen offset:0 sc1
  v_mfma_f32_16x16x32_bf16 v[72:75], a[180:183], a[40:43], v[72:75]
  ds_read_b64_tr_b16 a[174:175], v8 offset:22528
  v_mfma_f32_16x16x32_bf16 v[72:75], a[176:179], a[56:59], v[72:75]
  v_mfma_f32_16x16x32_bf16 v[76:79], a[176:179], a[60:63], v[76:79]
  ds_read_b64_tr_b16 a[176:177], v9 offset:16384
  v_mfma_f32_16x16x32_bf16 v[76:79], a[180:183], a[44:47], v[76:79]
  s_waitcnt lgkmcnt(5)
  buffer_load_dwordx4 a[112:115], v1, s[8:11], s74 offen offset:1024 sc1
  v_mfma_f32_16x16x32_bf16 v[92:95], a[160:163], a[44:47], v[92:95]
  ds_read_b64_tr_b16 a[178:179], v9 offset:18432
  v_mfma_f32_16x16x32_bf16 v[92:95], a[164:167], a[60:63], v[92:95]
  s_add_u32 s74, s74, 131072
  v_mfma_f32_16x16x32_bf16 v[88:91], a[164:167], a[56:59], v[88:91]
  ds_read_b64_tr_b16 a[180:181], v9 offset:20480
  v_mfma_f32_16x16x32_bf16 v[88:91], a[160:163], a[40:43], v[88:91]
  buffer_load_dwordx4 a[100:103], v1, s[8:11], s74 offen offset:0 sc1
  v_mfma_f32_16x16x32_bf16 v[84:87], a[160:163], a[36:39], v[84:87]
  ds_read_b64_tr_b16 a[182:183], v9 offset:22528
  v_mfma_f32_16x16x32_bf16 v[84:87], a[164:167], a[52:55], v[84:87]
  v_mfma_f32_16x16x32_bf16 v[80:83], a[164:167], a[48:51], v[80:83]
  ds_read_b64_tr_b16 a[164:165], v6 offset:0
  v_mfma_f32_16x16x32_bf16 v[80:83], a[160:163], a[32:35], v[80:83]
  s_waitcnt lgkmcnt(5)
  v_mfma_f32_16x16x32_bf16 v[96:99], a[168:171], a[32:35], v[96:99]
  ds_read_b64_tr_b16 a[166:167], v6 offset:2048
  v_mfma_f32_16x16x32_bf16 v[96:99], a[172:175], a[48:51], v[96:99]
  buffer_load_dwordx4 a[116:119], v1, s[8:11], s74 offen offset:1024 sc1
  v_mfma_f32_16x16x32_bf16 v[100:103], a[172:175], a[52:55], v[100:103]
  ds_read_b64_tr_b16 a[160:161], v6 offset:4096
  v_mfma_f32_16x16x32_bf16 v[100:103], a[168:171], a[36:39], v[100:103]
  s_add_u32 s74, s74, s88
  v_mfma_f32_16x16x32_bf16 v[104:107], a[168:171], a[40:43], v[104:107]
  ds_read_b64_tr_b16 a[162:163], v6 offset:6144
  v_mfma_f32_16x16x32_bf16 v[104:107], a[172:175], a[56:59], v[104:107]
  buffer_load_dwordx4 a[104:107], v1, s[8:11], s74 offen offset:0 sc1
  v_mfma_f32_16x16x32_bf16 v[108:111], a[172:175], a[60:63], v[108:111]
  ds_read_b64_tr_b16 a[172:173], v7 offset:0
  v_mfma_f32_16x16x32_bf16 v[108:111], a[168:171], a[44:47], v[108:111]
  s_waitcnt lgkmcnt(5)
  v_mfma_f32_16x16x32_bf16 v[124:127], a[176:179], a[44:47], v[124:127]
  ds_read_b64_tr_b16 a[174:175], v7 offset:2048
  v_mfma_f32_16x16x32_bf16 v[124:127], a[180:183], a[60:63], v[124:127]
  buffer_load_dwordx4 a[120:123], v1, s[8:11], s74 offen offset:1024 sc1
  v_mfma_f32_16x16x32_bf16 v[120:123], a[180:183], a[56:59], v[120:123]
  ds_read_b64_tr_b16 a[168:169], v7 offset:4096
  v_mfma_f32_16x16x32_bf16 v[120:123], a[176:179], a[40:43], v[120:123]
  s_add_u32 s74, s74, 131072
  v_mfma_f32_16x16x32_bf16 v[116:119], a[176:179], a[36:39], v[116:119]
  ds_read_b64_tr_b16 a[170:171], v7 offset:6144
  v_mfma_f32_16x16x32_bf16 v[116:119], a[180:183], a[52:55], v[116:119]
  buffer_load_dwordx4 a[108:111], v1, s[8:11], s74 offen offset:0 sc1
  v_mfma_f32_16x16x32_bf16 v[112:115], a[180:183], a[48:51], v[112:115]
  ds_read_b64_tr_b16 a[180:181], v8 offset:0
  v_mfma_f32_16x16x32_bf16 v[112:115], a[176:179], a[32:35], v[112:115]
  s_waitcnt vmcnt(7) lgkmcnt(5)
  v_mfma_f32_16x16x32_bf16 v[64:67], a[164:167], a[64:67], v[64:67]
  ds_read_b64_tr_b16 a[182:183], v8 offset:2048
  v_mfma_f32_16x16x32_bf16 v[64:67], a[160:163], a[80:83], v[64:67]
  v_mfma_f32_16x16x32_bf16 v[68:71], a[160:163], a[84:87], v[68:71]
  ds_read_b64_tr_b16 a[176:177], v8 offset:4096
  v_mfma_f32_16x16x32_bf16 v[68:71], a[164:167], a[68:71], v[68:71]
  buffer_load_dwordx4 a[124:127], v1, s[8:11], s74 offen offset:1024 sc1
  v_mfma_f32_16x16x32_bf16 v[72:75], a[164:167], a[72:75], v[72:75]
  ds_read_b64_tr_b16 a[178:179], v8 offset:6144
  v_mfma_f32_16x16x32_bf16 v[72:75], a[160:163], a[88:91], v[72:75]
  v_mfma_f32_16x16x32_bf16 v[76:79], a[160:163], a[92:95], v[76:79]
  ds_read_b64_tr_b16 a[160:161], v9 offset:0
  v_mfma_f32_16x16x32_bf16 v[76:79], a[164:167], a[76:79], v[76:79]
  s_waitcnt lgkmcnt(5)
  buffer_load_dwordx4 a[128:131], v1, s[8:11], s75 offen offset:0 sc1
  v_mfma_f32_16x16x32_bf16 v[92:95], a[172:175], a[76:79], v[92:95]
  ds_read_b64_tr_b16 a[162:163], v9 offset:2048
  v_mfma_f32_16x16x32_bf16 v[92:95], a[168:171], a[92:95], v[92:95]
  v_mfma_f32_16x16x32_bf16 v[88:91], a[168:171], a[88:91], v[88:91]
  ds_read_b64_tr_b16 a[164:165], v9 offset:4096
  v_mfma_f32_16x16x32_bf16 v[88:91], a[172:175], a[72:75], v[88:91]
  buffer_load_dwordx4 a[144:147], v1, s[8:11], s75 offen offset:1024 sc1
  v_mfma_f32_16x16x32_bf16 v[84:87], a[172:175], a[68:71], v[84:87]
  ds_read_b64_tr_b16 a[166:167], v9 offset:6144
  v_mfma_f32_16x16x32_bf16 v[84:87], a[168:171], a[84:87], v[84:87]
  s_add_u32 s75, s75, 131072
  v_mfma_f32_16x16x32_bf16 v[80:83], a[168:171], a[80:83], v[80:83]
  ds_read_b64_tr_b16 a[168:169], v2 offset:0
  v_mfma_f32_16x16x32_bf16 v[80:83], a[172:175], a[64:67], v[80:83]
  s_waitcnt lgkmcnt(5)
  buffer_load_dwordx4 a[132:135], v1, s[8:11], s75 offen offset:0 sc1
  v_mfma_f32_16x16x32_bf16 v[96:99], a[180:183], a[64:67], v[96:99]
  ds_read_b64_tr_b16 a[170:171], v2 offset:2048
  v_mfma_f32_16x16x32_bf16 v[96:99], a[176:179], a[80:83], v[96:99]
  v_mfma_f32_16x16x32_bf16 v[100:103], a[176:179], a[84:87], v[100:103]
  ds_read_b64_tr_b16 a[172:173], v2 offset:4096
  v_mfma_f32_16x16x32_bf16 v[100:103], a[180:183], a[68:71], v[100:103]
  v_mfma_f32_16x16x32_bf16 v[104:107], a[180:183], a[72:75], v[104:107]
  ds_read_b64_tr_b16 a[174:175], v2 offset:6144
  v_mfma_f32_16x16x32_bf16 v[104:107], a[176:179], a[88:91], v[104:107]
  buffer_load_dwordx4 a[148:151], v1, s[8:11], s75 offen offset:1024 sc1
  v_mfma_f32_16x16x32_bf16 v[108:111], a[176:179], a[92:95], v[108:111]
  ds_read_b64_tr_b16 a[176:177], v3 offset:0
  v_mfma_f32_16x16x32_bf16 v[108:111], a[180:183], a[76:79], v[108:111]
  s_waitcnt lgkmcnt(5)
  s_add_u32 s75, s75, s88
  v_mfma_f32_16x16x32_bf16 v[124:127], a[160:163], a[76:79], v[124:127]
  ds_read_b64_tr_b16 a[178:179], v3 offset:2048
  v_mfma_f32_16x16x32_bf16 v[124:127], a[164:167], a[92:95], v[124:127]
  buffer_load_dwordx4 a[136:139], v1, s[8:11], s75 offen offset:0 sc1
  v_mfma_f32_16x16x32_bf16 v[120:123], a[164:167], a[88:91], v[120:123]
  ds_read_b64_tr_b16 a[180:181], v3 offset:4096
  v_mfma_f32_16x16x32_bf16 v[120:123], a[160:163], a[72:75], v[120:123]
  v_mfma_f32_16x16x32_bf16 v[116:119], a[160:163], a[68:71], v[116:119]
  ds_read_b64_tr_b16 a[182:183], v3 offset:6144
  v_mfma_f32_16x16x32_bf16 v[116:119], a[164:167], a[84:87], v[116:119]
  buffer_load_dwordx4 a[152:155], v1, s[8:11], s75 offen offset:1024 sc1
  v_mfma_f32_16x16x32_bf16 v[112:115], a[164:167], a[80:83], v[112:115]
  ds_read_b64_tr_b16 a[164:165], v4 offset:0
  v_mfma_f32_16x16x32_bf16 v[112:115], a[160:163], a[64:67], v[112:115]
  s_waitcnt vmcnt(6) lgkmcnt(5)
  s_add_u32 s75, s75, 131072
  v_mfma_f32_16x16x32_bf16 v[64:67], a[168:171], a[96:99], v[64:67]
  ds_read_b64_tr_b16 a[166:167], v4 offset:2048
  v_mfma_f32_16x16x32_bf16 v[64:67], a[172:175], a[112:115], v[64:67]
  buffer_load_dwordx4 a[140:143], v1, s[8:11], s75 offen offset:0 sc1
  v_mfma_f32_16x16x32_bf16 v[68:71], a[172:175], a[116:119], v[68:71]
  ds_read_b64_tr_b16 a[160:161], v4 offset:4096
  v_mfma_f32_16x16x32_bf16 v[68:71], a[168:171], a[100:103], v[68:71]
  v_mfma_f32_16x16x32_bf16 v[72:75], a[168:171], a[104:107], v[72:75]
  ds_read_b64_tr_b16 a[162:163], v4 offset:6144
  v_mfma_f32_16x16x32_bf16 v[72:75], a[172:175], a[120:123], v[72:75]
  v_mfma_f32_16x16x32_bf16 v[76:79], a[172:175], a[124:127], v[76:79]
  ds_read_b64_tr_b16 a[172:173], v5 offset:0
  v_mfma_f32_16x16x32_bf16 v[76:79], a[168:171], a[108:111], v[76:79]
  s_waitcnt lgkmcnt(5)
  buffer_load_dwordx4 a[156:159], v1, s[8:11], s75 offen offset:1024 sc1
  v_mfma_f32_16x16x32_bf16 v[92:95], a[176:179], a[108:111], v[92:95]
  ds_read_b64_tr_b16 a[174:175], v5 offset:2048
  v_mfma_f32_16x16x32_bf16 v[92:95], a[180:183], a[124:127], v[92:95]
  v_mfma_f32_16x16x32_bf16 v[88:91], a[180:183], a[120:123], v[88:91]
  ds_read_b64_tr_b16 a[168:169], v5 offset:4096
  v_mfma_f32_16x16x32_bf16 v[88:91], a[176:179], a[104:107], v[88:91]
  buffer_load_dwordx4 a[188:191], v1, s[8:11], s76 offen offset:0 sc1
  v_mfma_f32_16x16x32_bf16 v[84:87], a[176:179], a[100:103], v[84:87]
  ds_read_b64_tr_b16 a[170:171], v5 offset:6144
  v_mfma_f32_16x16x32_bf16 v[84:87], a[180:183], a[116:119], v[84:87]
  v_mfma_f32_16x16x32_bf16 v[80:83], a[180:183], a[112:115], v[80:83]
  ds_read_b64_tr_b16 a[180:181], v2 offset:32768
  v_mfma_f32_16x16x32_bf16 v[80:83], a[176:179], a[96:99], v[80:83]
  s_waitcnt lgkmcnt(5)
  buffer_load_dwordx4 a[204:207], v1, s[8:11], s76 offen offset:1024 sc1
  v_mfma_f32_16x16x32_bf16 v[96:99], a[164:167], a[96:99], v[96:99]
  ds_read_b64_tr_b16 a[182:183], v2 offset:34816
  v_mfma_f32_16x16x32_bf16 v[96:99], a[160:163], a[112:115], v[96:99]
  s_add_u32 s76, s76, 131072
  v_mfma_f32_16x16x32_bf16 v[100:103], a[160:163], a[116:119], v[100:103]
  ds_read_b64_tr_b16 a[176:177], v2 offset:36864
  v_mfma_f32_16x16x32_bf16 v[100:103], a[164:167], a[100:103], v[100:103]
  buffer_load_dwordx4 a[192:195], v1, s[8:11], s76 offen offset:0 sc1
  v_mfma_f32_16x16x32_bf16 v[104:107], a[164:167], a[104:107], v[104:107]
  ds_read_b64_tr_b16 a[178:179], v2 offset:38912
  v_mfma_f32_16x16x32_bf16 v[104:107], a[160:163], a[120:123], v[104:107]
  v_mfma_f32_16x16x32_bf16 v[108:111], a[160:163], a[124:127], v[108:111]
  ds_read_b64_tr_b16 a[160:161], v3 offset:32768
  v_mfma_f32_16x16x32_bf16 v[108:111], a[164:167], a[108:111], v[108:111]
  s_waitcnt lgkmcnt(5)
  v_mfma_f32_16x16x32_bf16 v[124:127], a[172:175], a[108:111], v[124:127]
  ds_read_b64_tr_b16 a[162:163], v3 offset:34816
  v_mfma_f32_16x16x32_bf16 v[124:127], a[168:171], a[124:127], v[124:127]
  buffer_load_dwordx4 a[208:211], v1, s[8:11], s76 offen offset:1024 sc1
  v_mfma_f32_16x16x32_bf16 v[120:123], a[168:171], a[120:123], v[120:123]
  ds_read_b64_tr_b16 a[164:165], v3 offset:36864
  v_mfma_f32_16x16x32_bf16 v[120:123], a[172:175], a[104:107], v[120:123]
  s_add_u32 s76, s76, s88
  v_mfma_f32_16x16x32_bf16 v[116:119], a[172:175], a[100:103], v[116:119]
  ds_read_b64_tr_b16 a[166:167], v3 offset:38912
  v_mfma_f32_16x16x32_bf16 v[116:119], a[168:171], a[116:119], v[116:119]
  buffer_load_dwordx4 a[196:199], v1, s[8:11], s76 offen offset:0 sc1
  v_mfma_f32_16x16x32_bf16 v[112:115], a[168:171], a[112:115], v[112:115]
  ds_read_b64_tr_b16 a[168:169], v4 offset:32768
  v_mfma_f32_16x16x32_bf16 v[112:115], a[172:175], a[96:99], v[112:115]
  s_waitcnt vmcnt(5) lgkmcnt(5)
  v_mfma_f32_16x16x32_bf16 v[64:67], a[180:183], a[128:131], v[64:67]
  ds_read_b64_tr_b16 a[170:171], v4 offset:34816
  v_mfma_f32_16x16x32_bf16 v[64:67], a[176:179], a[144:147], v[64:67]
  buffer_load_dwordx4 a[212:215], v1, s[8:11], s76 offen offset:1024 sc1
  v_mfma_f32_16x16x32_bf16 v[68:71], a[176:179], a[148:151], v[68:71]
  ds_read_b64_tr_b16 a[172:173], v4 offset:36864
  v_mfma_f32_16x16x32_bf16 v[68:71], a[180:183], a[132:135], v[68:71]
  s_add_u32 s76, s76, 131072
  v_mfma_f32_16x16x32_bf16 v[72:75], a[180:183], a[136:139], v[72:75]
  ds_read_b64_tr_b16 a[174:175], v4 offset:38912
  v_mfma_f32_16x16x32_bf16 v[72:75], a[176:179], a[152:155], v[72:75]
  buffer_load_dwordx4 a[200:203], v1, s[8:11], s76 offen offset:0 sc1
  v_mfma_f32_16x16x32_bf16 v[76:79], a[176:179], a[156:159], v[76:79]
  ds_read_b64_tr_b16 a[176:177], v5 offset:32768
  v_mfma_f32_16x16x32_bf16 v[76:79], a[180:183], a[140:143], v[76:79]
  s_waitcnt lgkmcnt(5)
  v_mfma_f32_16x16x32_bf16 v[92:95], a[160:163], a[140:143], v[92:95]
  ds_read_b64_tr_b16 a[178:179], v5 offset:34816
  v_mfma_f32_16x16x32_bf16 v[92:95], a[164:167], a[156:159], v[92:95]
  v_mfma_f32_16x16x32_bf16 v[88:91], a[164:167], a[152:155], v[88:91]
  ds_read_b64_tr_b16 a[180:181], v5 offset:36864
  v_mfma_f32_16x16x32_bf16 v[88:91], a[160:163], a[136:139], v[88:91]
  buffer_load_dwordx4 a[216:219], v1, s[8:11], s76 offen offset:1024 sc1
  v_mfma_f32_16x16x32_bf16 v[84:87], a[160:163], a[132:135], v[84:87]
  ds_read_b64_tr_b16 a[182:183], v5 offset:38912
  v_mfma_f32_16x16x32_bf16 v[84:87], a[164:167], a[148:151], v[84:87]
  s_add_u32 m0, s45, 8192
  v_mfma_f32_16x16x32_bf16 v[80:83], a[164:167], a[144:147], v[80:83]
  ds_read_b64_tr_b16 a[164:165], v2 offset:49152
  v_mfma_f32_16x16x32_bf16 v[80:83], a[160:163], a[128:131], v[80:83]
  s_waitcnt lgkmcnt(5)
  buffer_load_dwordx4 v33, s[36:39], s66 offen lds
  v_mfma_f32_16x16x32_bf16 v[96:99], a[168:171], a[128:131], v[96:99]
  ds_read_b64_tr_b16 a[166:167], v2 offset:51200
  v_mfma_f32_16x16x32_bf16 v[96:99], a[172:175], a[144:147], v[96:99]
  s_add_u32 m0, s45, 12288
  s_add_u32 s60, s66, 65536
  v_mfma_f32_16x16x32_bf16 v[100:103], a[172:175], a[148:151], v[100:103]
  ds_read_b64_tr_b16 a[160:161], v2 offset:53248
  v_mfma_f32_16x16x32_bf16 v[100:103], a[168:171], a[132:135], v[100:103]
  buffer_load_dwordx4 v33, s[36:39], s60 offen lds
  v_mfma_f32_16x16x32_bf16 v[104:107], a[168:171], a[136:139], v[104:107]
  ds_read_b64_tr_b16 a[162:163], v2 offset:55296
  v_mfma_f32_16x16x32_bf16 v[104:107], a[172:175], a[152:155], v[104:107]
  s_add_u32 m0, s45, 40960
  v_mfma_f32_16x16x32_bf16 v[108:111], a[172:175], a[156:159], v[108:111]
  ds_read_b64_tr_b16 a[172:173], v3 offset:49152
  v_mfma_f32_16x16x32_bf16 v[108:111], a[168:171], a[140:143], v[108:111]
  s_waitcnt lgkmcnt(5)
  buffer_load_dwordx4 v33, s[36:39], s67 offen lds
  v_mfma_f32_16x16x32_bf16 v[124:127], a[176:179], a[140:143], v[124:127]
  ds_read_b64_tr_b16 a[174:175], v3 offset:51200
  v_mfma_f32_16x16x32_bf16 v[124:127], a[180:183], a[156:159], v[124:127]
  v_mfma_f32_16x16x32_bf16 v[120:123], a[180:183], a[152:155], v[120:123]
  ds_read_b64_tr_b16 a[168:169], v3 offset:53248
  v_mfma_f32_16x16x32_bf16 v[120:123], a[176:179], a[136:139], v[120:123]
  s_add_u32 m0, s45, 45056
  s_add_u32 s60, s67, 65536
  v_mfma_f32_16x16x32_bf16 v[116:119], a[176:179], a[132:135], v[116:119]
  ds_read_b64_tr_b16 a[170:171], v3 offset:55296
  v_mfma_f32_16x16x32_bf16 v[116:119], a[180:183], a[148:151], v[116:119]
  buffer_load_dwordx4 v33, s[36:39], s60 offen lds
  v_mfma_f32_16x16x32_bf16 v[112:115], a[180:183], a[144:147], v[112:115]
  ds_read_b64_tr_b16 a[180:181], v4 offset:49152
  v_mfma_f32_16x16x32_bf16 v[112:115], a[176:179], a[128:131], v[112:115]
  s_waitcnt vmcnt(4) lgkmcnt(5)
  s_add_u32 m0, s45, 57344
  v_mfma_f32_16x16x32_bf16 v[64:67], a[164:167], a[188:191], v[64:67]
  ds_read_b64_tr_b16 a[182:183], v4 offset:51200
  v_mfma_f32_16x16x32_bf16 v[64:67], a[160:163], a[204:207], v[64:67]
  buffer_load_dwordx4 v33, s[36:39], s68 offen lds
  v_mfma_f32_16x16x32_bf16 v[68:71], a[160:163], a[208:211], v[68:71]
  ds_read_b64_tr_b16 a[176:177], v4 offset:53248
  v_mfma_f32_16x16x32_bf16 v[68:71], a[164:167], a[192:195], v[68:71]
  s_add_u32 m0, s45, 61440
  s_add_u32 s60, s68, 65536
  v_mfma_f32_16x16x32_bf16 v[72:75], a[164:167], a[196:199], v[72:75]
  ds_read_b64_tr_b16 a[178:179], v4 offset:55296
  v_mfma_f32_16x16x32_bf16 v[72:75], a[160:163], a[212:215], v[72:75]
  buffer_load_dwordx4 v33, s[36:39], s60 offen lds
  v_mfma_f32_16x16x32_bf16 v[76:79], a[160:163], a[216:219], v[76:79]
  ds_read_b64_tr_b16 a[160:161], v5 offset:49152
  v_mfma_f32_16x16x32_bf16 v[76:79], a[164:167], a[200:203], v[76:79]
  s_waitcnt lgkmcnt(5)
  v_mfma_f32_16x16x32_bf16 v[92:95], a[172:175], a[200:203], v[92:95]
  ds_read_b64_tr_b16 a[162:163], v5 offset:51200
  v_mfma_f32_16x16x32_bf16 v[92:95], a[168:171], a[216:219], v[92:95]
  v_mfma_f32_16x16x32_bf16 v[88:91], a[168:171], a[212:215], v[88:91]
  ds_read_b64_tr_b16 a[164:165], v5 offset:53248
  v_cvt_pk_bf16_f32 v72, v72, v73
  v_mfma_f32_16x16x32_bf16 v[88:91], a[172:175], a[196:199], v[88:91]
  v_cvt_pk_bf16_f32 v73, v74, v75
  v_cvt_pk_bf16_f32 v76, v76, v77
  v_mfma_f32_16x16x32_bf16 v[84:87], a[172:175], a[192:195], v[84:87]
  ds_read_b64_tr_b16 a[166:167], v5 offset:55296
  v_cvt_pk_bf16_f32 v77, v78, v79
  v_mfma_f32_16x16x32_bf16 v[84:87], a[168:171], a[208:211], v[84:87]
  v_cvt_pk_bf16_f32 v64, v64, v65
  v_cvt_pk_bf16_f32 v65, v66, v67
  v_mfma_f32_16x16x32_bf16 v[80:83], a[168:171], a[204:207], v[80:83]
  v_cvt_pk_bf16_f32 v68, v68, v69
  v_cvt_pk_bf16_f32 v69, v70, v71
  v_mfma_f32_16x16x32_bf16 v[80:83], a[172:175], a[188:191], v[80:83]
  s_waitcnt lgkmcnt(4)
  s_waitcnt vmcnt(0)
  s_barrier
  v_mfma_f32_16x16x32_bf16 v[96:99], a[180:183], a[188:191], v[96:99]
  ds_read_b64_tr_b16 v[16:17], v6 offset:40960
  v_mfma_f32_16x16x32_bf16 v[96:99], a[176:179], a[204:207], v[96:99]
  ds_read_b64_tr_b16 v[18:19], v6 offset:43008
  v_mfma_f32_16x16x32_bf16 v[100:103], a[176:179], a[208:211], v[100:103]
  ds_read_b64_tr_b16 v[20:21], v6 offset:45056
  v_cvt_pk_bf16_f32 v74, v88, v89
  v_mfma_f32_16x16x32_bf16 v[100:103], a[180:183], a[192:195], v[100:103]
  ds_read_b64_tr_b16 v[22:23], v6 offset:47104
  v_cvt_pk_bf16_f32 v75, v90, v91
  v_mfma_f32_16x16x32_bf16 v[104:107], a[180:183], a[196:199], v[104:107]
  ds_read_b64_tr_b16 v[24:25], v7 offset:40960
  v_mfma_f32_16x16x32_bf16 v[104:107], a[176:179], a[212:215], v[104:107]
  ds_read_b64_tr_b16 v[26:27], v7 offset:43008
  v_mfma_f32_16x16x32_bf16 v[108:111], a[176:179], a[216:219], v[108:111]
  ds_read_b64_tr_b16 v[28:29], v7 offset:45056
  s_add_u32 s86, s85, 0
  buffer_store_dwordx4 v[72:75], v1, s[8:11], s86 offen offset:0 sc1
  v_mfma_f32_16x16x32_bf16 v[108:111], a[180:183], a[200:203], v[108:111]
  s_waitcnt lgkmcnt(7)
  ds_read_b64_tr_b16 v[30:31], v7 offset:47104
  v_mfma_f32_16x16x32_bf16 v[124:127], a[160:163], a[200:203], v[124:127]
  ds_read_b64_tr_b16 a[168:169], v8 offset:40960
  v_cvt_pk_bf16_f32 v78, v92, v93
  v_mfma_f32_16x16x32_bf16 v[124:127], a[164:167], a[216:219], v[124:127]
  ds_read_b64_tr_b16 a[170:171], v8 offset:43008
  v_cvt_pk_bf16_f32 v79, v94, v95
  v_mfma_f32_16x16x32_bf16 v[120:123], a[164:167], a[212:215], v[120:123]
  ds_read_b64_tr_b16 a[172:173], v8 offset:45056
  v_mfma_f32_16x16x32_bf16 v[120:123], a[160:163], a[196:199], v[120:123]
  ds_read_b64_tr_b16 a[174:175], v8 offset:47104
  v_mfma_f32_16x16x32_bf16 v[116:119], a[160:163], a[192:195], v[116:119]
  ds_read_b64_tr_b16 a[176:177], v9 offset:40960
  s_add_u32 s86, s85, 0
  buffer_store_dwordx4 v[76:79], v1, s[8:11], s86 offen offset:2048 sc1
  v_mfma_f32_16x16x32_bf16 v[116:119], a[164:167], a[208:211], v[116:119]
  ds_read_b64_tr_b16 a[178:179], v9 offset:43008
  v_mfma_f32_16x16x32_bf16 v[112:115], a[164:167], a[204:207], v[112:115]
  ds_read_b64_tr_b16 a[180:181], v9 offset:45056
  v_cvt_pk_bf16_f32 v66, v80, v81
  v_mfma_f32_16x16x32_bf16 v[112:115], a[160:163], a[188:191], v[112:115]
  s_waitcnt lgkmcnt(7)
  ds_read_b64_tr_b16 a[182:183], v9 offset:47104
  v_mfma_f32_16x16x32_bf16 v[136:139], v[16:19], a[228:231], v[136:139]
  ds_read_b64_tr_b16 a[164:165], v6 offset:57344
  v_cvt_pk_bf16_f32 v67, v82, v83
  v_mfma_f32_16x16x32_bf16 v[136:139], v[20:23], a[244:247], v[136:139]
  ds_read_b64_tr_b16 a[166:167], v6 offset:59392
  v_mfma_f32_16x16x32_bf16 v[140:143], v[20:23], a[248:251], v[140:143]
  ds_read_b64_tr_b16 a[160:161], v6 offset:61440
  v_mfma_f32_16x16x32_bf16 v[140:143], v[16:19], a[232:235], v[140:143]
  ds_read_b64_tr_b16 a[162:163], v6 offset:63488
  s_add_u32 s86, s85, 4096
  buffer_store_dwordx4 v[64:67], v1, s[8:11], s86 offen offset:0 sc1
  v_mfma_f32_16x16x32_bf16 v[156:159], v[24:27], a[232:235], v[156:159]
  ds_read_b64_tr_b16 v[20:21], v7 offset:57344
  v_mfma_f32_16x16x32_bf16 v[156:159], v[28:31], a[248:251], v[156:159]
  ds_read_b64_tr_b16 v[22:23], v7 offset:59392
  v_cvt_pk_bf16_f32 v70, v84, v85
  v_mfma_f32_16x16x32_bf16 v[152:155], v[28:31], a[244:247], v[152:155]
  ds_read_b64_tr_b16 v[16:17], v7 offset:61440
  v_cvt_pk_bf16_f32 v71, v86, v87
  v_mfma_f32_16x16x32_bf16 v[152:155], v[24:27], a[228:231], v[152:155]
  s_waitcnt lgkmcnt(7)
  ds_read_b64_tr_b16 v[18:19], v7 offset:63488
  v_mfma_f32_16x16x32_bf16 v[168:171], a[168:171], a[228:231], v[168:171]
  ds_read_b64_tr_b16 v[28:29], v8 offset:57344
  v_mfma_f32_16x16x32_bf16 v[168:171], a[172:175], a[244:247], v[168:171]
  ds_read_b64_tr_b16 v[30:31], v8 offset:59392
  s_add_u32 s86, s85, 4096
  buffer_store_dwordx4 v[68:71], v1, s[8:11], s86 offen offset:2048 sc1
  v_mfma_f32_16x16x32_bf16 v[172:175], a[172:175], a[248:251], v[172:175]
  ds_read_b64_tr_b16 v[24:25], v8 offset:61440
  v_mfma_f32_16x16x32_bf16 v[172:175], a[168:171], a[232:235], v[172:175]
  ds_read_b64_tr_b16 v[26:27], v8 offset:63488
  v_cvt_pk_bf16_f32 v104, v104, v105
  v_mfma_f32_16x16x32_bf16 v[188:191], a[176:179], a[232:235], v[188:191]
  ds_read_b64_tr_b16 a[172:173], v9 offset:57344
  v_cvt_pk_bf16_f32 v105, v106, v107
  v_mfma_f32_16x16x32_bf16 v[188:191], a[180:183], a[248:251], v[188:191]
  ds_read_b64_tr_b16 a[174:175], v9 offset:59392
  v_cvt_pk_bf16_f32 v108, v108, v109
  v_mfma_f32_16x16x32_bf16 v[184:187], a[180:183], a[244:247], v[184:187]
  ds_read_b64_tr_b16 a[168:169], v9 offset:61440
  v_cvt_pk_bf16_f32 v109, v110, v111
  v_mfma_f32_16x16x32_bf16 v[184:187], a[176:179], a[228:231], v[184:187]
  s_waitcnt lgkmcnt(7)
  ds_read_b64_tr_b16 a[170:171], v9 offset:63488
  v_mfma_f32_16x16x32_bf16 v[136:139], a[164:167], a[8:11], v[136:139]
  ds_read_b64_tr_b16 a[180:181], v6 offset:24576
  v_cvt_pk_bf16_f32 v96, v96, v97
  v_mfma_f32_16x16x32_bf16 v[136:139], a[160:163], a[24:27], v[136:139]
  ds_read_b64_tr_b16 a[182:183], v6 offset:26624
  v_cvt_pk_bf16_f32 v97, v98, v99
  v_mfma_f32_16x16x32_bf16 v[140:143], a[160:163], a[28:31], v[140:143]
  ds_read_b64_tr_b16 a[176:177], v6 offset:28672
  v_cvt_pk_bf16_f32 v100, v100, v101
  v_mfma_f32_16x16x32_bf16 v[140:143], a[164:167], a[12:15], v[140:143]
  ds_read_b64_tr_b16 a[178:179], v6 offset:30720
  v_cvt_pk_bf16_f32 v101, v102, v103
  v_mfma_f32_16x16x32_bf16 v[156:159], v[20:23], a[12:15], v[156:159]
  ds_read_b64_tr_b16 a[160:161], v7 offset:24576
  v_cvt_pk_bf16_f32 v106, v120, v121
  v_mfma_f32_16x16x32_bf16 v[156:159], v[16:19], a[28:31], v[156:159]
  ds_read_b64_tr_b16 a[162:163], v7 offset:26624
  v_cvt_pk_bf16_f32 v107, v122, v123
  v_mfma_f32_16x16x32_bf16 v[152:155], v[16:19], a[24:27], v[152:155]
  ds_read_b64_tr_b16 a[164:165], v7 offset:28672
  v_mfma_f32_16x16x32_bf16 v[152:155], v[20:23], a[8:11], v[152:155]
  s_waitcnt lgkmcnt(7)
  ds_read_b64_tr_b16 a[166:167], v7 offset:30720
  v_mfma_f32_16x16x32_bf16 v[168:171], v[28:31], a[8:11], v[168:171]
  ds_read_b64_tr_b16 v[16:17], v8 offset:24576
  s_add_u32 s86, s85, 0
  buffer_store_dwordx4 v[104:107], v1, s[8:11], s86 offen offset:1024 sc1
  v_mfma_f32_16x16x32_bf16 v[168:171], v[24:27], a[24:27], v[168:171]
  ds_read_b64_tr_b16 v[18:19], v8 offset:26624
  v_mfma_f32_16x16x32_bf16 v[172:175], v[24:27], a[28:31], v[172:175]
  ds_read_b64_tr_b16 v[20:21], v8 offset:28672
  v_cvt_pk_bf16_f32 v110, v124, v125
  v_mfma_f32_16x16x32_bf16 v[172:175], v[28:31], a[12:15], v[172:175]
  ds_read_b64_tr_b16 v[22:23], v8 offset:30720
  v_cvt_pk_bf16_f32 v111, v126, v127
  v_mfma_f32_16x16x32_bf16 v[188:191], a[172:175], a[12:15], v[188:191]
  ds_read_b64_tr_b16 v[24:25], v9 offset:24576
  v_mfma_f32_16x16x32_bf16 v[188:191], a[168:171], a[28:31], v[188:191]
  ds_read_b64_tr_b16 v[26:27], v9 offset:26624
  v_mfma_f32_16x16x32_bf16 v[184:187], a[168:171], a[24:27], v[184:187]
  ds_read_b64_tr_b16 v[28:29], v9 offset:28672
  s_add_u32 s86, s85, 0
  buffer_store_dwordx4 v[108:111], v1, s[8:11], s86 offen offset:3072 sc1
  v_mfma_f32_16x16x32_bf16 v[184:187], a[172:175], a[8:11], v[184:187]
  s_waitcnt lgkmcnt(7)
  ds_read_b64_tr_b16 v[30:31], v9 offset:30720
  v_mfma_f32_16x16x32_bf16 v[136:139], a[180:183], a[40:43], v[136:139]
  ds_read_b64_tr_b16 a[168:169], v6 offset:8192
  v_cvt_pk_bf16_f32 v98, v112, v113
  v_mfma_f32_16x16x32_bf16 v[136:139], a[176:179], a[56:59], v[136:139]
  ds_read_b64_tr_b16 a[170:171], v6 offset:10240
  v_cvt_pk_bf16_f32 v99, v114, v115
  v_mfma_f32_16x16x32_bf16 v[140:143], a[176:179], a[60:63], v[140:143]
  ds_read_b64_tr_b16 a[172:173], v6 offset:12288
  v_mfma_f32_16x16x32_bf16 v[140:143], a[180:183], a[44:47], v[140:143]
  ds_read_b64_tr_b16 a[174:175], v6 offset:14336
  v_mfma_f32_16x16x32_bf16 v[156:159], a[160:163], a[44:47], v[156:159]
  ds_read_b64_tr_b16 a[176:177], v7 offset:8192
  s_add_u32 s86, s85, 4096
  buffer_store_dwordx4 v[96:99], v1, s[8:11], s86 offen offset:1024 sc1
  v_mfma_f32_16x16x32_bf16 v[156:159], a[164:167], a[60:63], v[156:159]
  ds_read_b64_tr_b16 a[178:179], v7 offset:10240
  v_mfma_f32_16x16x32_bf16 v[152:155], a[164:167], a[56:59], v[152:155]
  ds_read_b64_tr_b16 a[180:181], v7 offset:12288
  v_cvt_pk_bf16_f32 v102, v116, v117
  v_mfma_f32_16x16x32_bf16 v[152:155], a[160:163], a[40:43], v[152:155]
  s_waitcnt lgkmcnt(7)
  ds_read_b64_tr_b16 a[182:183], v7 offset:14336
  v_mfma_f32_16x16x32_bf16 v[168:171], v[16:19], a[40:43], v[168:171]
  ds_read_b64_tr_b16 a[164:165], v8 offset:8192
  v_cvt_pk_bf16_f32 v103, v118, v119
  v_mfma_f32_16x16x32_bf16 v[168:171], v[20:23], a[56:59], v[168:171]
  ds_read_b64_tr_b16 a[166:167], v8 offset:10240
  v_mfma_f32_16x16x32_bf16 v[172:175], v[20:23], a[60:63], v[172:175]
  ds_read_b64_tr_b16 a[160:161], v8 offset:12288
  v_mfma_f32_16x16x32_bf16 v[172:175], v[16:19], a[44:47], v[172:175]
  ds_read_b64_tr_b16 a[162:163], v8 offset:14336
  s_add_u32 s86, s85, 4096
  buffer_store_dwordx4 v[100:103], v1, s[8:11], s86 offen offset:3072 sc1
  v_mfma_f32_16x16x32_bf16 v[188:191], v[24:27], a[44:47], v[188:191]
  ds_read_b64_tr_b16 v[20:21], v9 offset:8192
  v_mfma_f32_16x16x32_bf16 v[188:191], v[28:31], a[60:63], v[188:191]
  ds_read_b64_tr_b16 v[22:23], v9 offset:10240
  v_mfma_f32_16x16x32_bf16 v[184:187], v[28:31], a[56:59], v[184:187]
  ds_read_b64_tr_b16 v[16:17], v9 offset:12288
  v_mfma_f32_16x16x32_bf16 v[184:187], v[24:27], a[40:43], v[184:187]
  s_waitcnt lgkmcnt(7)
  ds_read_b64_tr_b16 v[18:19], v9 offset:14336
  v_mfma_f32_16x16x32_bf16 v[136:139], a[168:171], a[72:75], v[136:139]
  ds_read_b64_tr_b16 v[28:29], v2 offset:8192
  v_mfma_f32_16x16x32_bf16 v[136:139], a[172:175], a[88:91], v[136:139]
  ds_read_b64_tr_b16 v[30:31], v2 offset:10240
  v_mfma_f32_16x16x32_bf16 v[140:143], a[172:175], a[92:95], v[140:143]
  ds_read_b64_tr_b16 v[24:25], v2 offset:12288
  v_mfma_f32_16x16x32_bf16 v[140:143], a[168:171], a[76:79], v[140:143]
  ds_read_b64_tr_b16 v[26:27], v2 offset:14336
  v_mfma_f32_16x16x32_bf16 v[156:159], a[176:179], a[76:79], v[156:159]
  ds_read_b64_tr_b16 a[172:173], v3 offset:8192
  v_mfma_f32_16x16x32_bf16 v[156:159], a[180:183], a[92:95], v[156:159]
  ds_read_b64_tr_b16 a[174:175], v3 offset:10240
  v_mfma_f32_16x16x32_bf16 v[152:155], a[180:183], a[88:91], v[152:155]
  ds_read_b64_tr_b16 a[168:169], v3 offset:12288
  v_mfma_f32_16x16x32_bf16 v[152:155], a[176:179], a[72:75], v[152:155]
  s_waitcnt lgkmcnt(7)
  ds_read_b64_tr_b16 a[170:171], v3 offset:14336
  v_mfma_f32_16x16x32_bf16 v[168:171], a[164:167], a[72:75], v[168:171]
  ds_read_b64_tr_b16 a[180:181], v4 offset:8192
  v_mfma_f32_16x16x32_bf16 v[168:171], a[160:163], a[88:91], v[168:171]
  ds_read_b64_tr_b16 a[182:183], v4 offset:10240
  v_mfma_f32_16x16x32_bf16 v[172:175], a[160:163], a[92:95], v[172:175]
  ds_read_b64_tr_b16 a[176:177], v4 offset:12288
  v_mfma_f32_16x16x32_bf16 v[172:175], a[164:167], a[76:79], v[172:175]
  ds_read_b64_tr_b16 a[178:179], v4 offset:14336
  v_mfma_f32_16x16x32_bf16 v[188:191], v[20:23], a[76:79], v[188:191]
  ds_read_b64_tr_b16 a[160:161], v5 offset:8192
  v_mfma_f32_16x16x32_bf16 v[188:191], v[16:19], a[92:95], v[188:191]
  ds_read_b64_tr_b16 a[162:163], v5 offset:10240
  v_mfma_f32_16x16x32_bf16 v[184:187], v[16:19], a[88:91], v[184:187]
  ds_read_b64_tr_b16 a[164:165], v5 offset:12288
  v_mfma_f32_16x16x32_bf16 v[184:187], v[20:23], a[72:75], v[184:187]
  s_waitcnt lgkmcnt(7)
  ds_read_b64_tr_b16 a[166:167], v5 offset:14336
  v_mfma_f32_16x16x32_bf16 v[136:139], v[28:31], a[104:107], v[136:139]
  ds_read_b64_tr_b16 v[16:17], v2 offset:40960
  v_mfma_f32_16x16x32_bf16 v[136:139], v[24:27], a[120:123], v[136:139]
  ds_read_b64_tr_b16 v[18:19], v2 offset:43008
  v_mfma_f32_16x16x32_bf16 v[140:143], v[24:27], a[124:127], v[140:143]
  ds_read_b64_tr_b16 v[20:21], v2 offset:45056
  v_mfma_f32_16x16x32_bf16 v[140:143], v[28:31], a[108:111], v[140:143]
  ds_read_b64_tr_b16 v[22:23], v2 offset:47104
  v_mfma_f32_16x16x32_bf16 v[156:159], a[172:175], a[108:111], v[156:159]
  ds_read_b64_tr_b16 v[24:25], v3 offset:40960
  v_mfma_f32_16x16x32_bf16 v[156:159], a[168:171], a[124:127], v[156:159]
  ds_read_b64_tr_b16 v[26:27], v3 offset:43008
  v_mfma_f32_16x16x32_bf16 v[152:155], a[168:171], a[120:123], v[152:155]
  ds_read_b64_tr_b16 v[28:29], v3 offset:45056
  v_mfma_f32_16x16x32_bf16 v[152:155], a[172:175], a[104:107], v[152:155]
  s_waitcnt lgkmcnt(7)
  ds_read_b64_tr_b16 v[30:31], v3 offset:47104
  v_mfma_f32_16x16x32_bf16 v[168:171], a[180:183], a[104:107], v[168:171]
  ds_read_b64_tr_b16 a[168:169], v4 offset:40960
  v_mfma_f32_16x16x32_bf16 v[168:171], a[176:179], a[120:123], v[168:171]
  ds_read_b64_tr_b16 a[170:171], v4 offset:43008
  v_mfma_f32_16x16x32_bf16 v[172:175], a[176:179], a[124:127], v[172:175]
  ds_read_b64_tr_b16 a[172:173], v4 offset:45056
  v_mfma_f32_16x16x32_bf16 v[172:175], a[180:183], a[108:111], v[172:175]
  ds_read_b64_tr_b16 a[174:175], v4 offset:47104
  v_mfma_f32_16x16x32_bf16 v[188:191], a[160:163], a[108:111], v[188:191]
  ds_read_b64_tr_b16 a[176:177], v5 offset:40960
  v_mfma_f32_16x16x32_bf16 v[188:191], a[164:167], a[124:127], v[188:191]
  ds_read_b64_tr_b16 a[178:179], v5 offset:43008
HOP19:
  s_cbranch_execz WRET1
  v_mfma_f32_16x16x32_bf16 v[184:187], a[164:167], a[120:123], v[184:187]
  ds_read_b64_tr_b16 a[180:181], v5 offset:45056
  v_mfma_f32_16x16x32_bf16 v[184:187], a[160:163], a[104:107], v[184:187]
  s_waitcnt lgkmcnt(7)
  ds_read_b64_tr_b16 a[182:183], v5 offset:47104
  v_mfma_f32_16x16x32_bf16 v[136:139], v[16:19], a[136:139], v[136:139]
  ds_read_b64_tr_b16 a[164:165], v2 offset:57344
  v_mfma_f32_16x16x32_bf16 v[136:139], v[20:23], a[152:155], v[136:139]
  ds_read_b64_tr_b16 a[166:167], v2 offset:59392
  v_mfma_f32_16x16x32_bf16 v[140:143], v[20:23], a[156:159], v[140:143]
  ds_read_b64_tr_b16 a[160:161], v2 offset:61440
  v_mfma_f32_16x16x32_bf16 v[140:143], v[16:19], a[140:143], v[140:143]
  ds_read_b64_tr_b16 a[162:163], v2 offset:63488
  v_mfma_f32_16x16x32_bf16 v[156:159], v[24:27], a[140:143], v[156:159]
  ds_read_b64_tr_b16 v[20:21], v3 offset:57344
  v_add_u32 v38, s46, v0
  s_waitcnt vmcnt(0)
  s_mov_b64 exec, 1
  buffer_store_dword v38, v0, s[8:11], s80 offen offset:0 sc1
  s_mov_b64 exec, -1
  v_mfma_f32_16x16x32_bf16 v[156:159], v[28:31], a[156:159], v[156:159]
  ds_read_b64_tr_b16 v[22:23], v3 offset:59392
  v_mfma_f32_16x16x32_bf16 v[152:155], v[28:31], a[152:155], v[152:155]
  ds_read_b64_tr_b16 v[16:17], v3 offset:61440
  v_mfma_f32_16x16x32_bf16 v[152:155], v[24:27], a[136:139], v[152:155]
  s_waitcnt lgkmcnt(7)
  ds_read_b64_tr_b16 v[18:19], v3 offset:63488
  v_mfma_f32_16x16x32_bf16 v[168:171], a[168:171], a[136:139], v[168:171]
  ds_read_b64_tr_b16 v[28:29], v4 offset:57344
  v_mfma_f32_16x16x32_bf16 v[168:171], a[172:175], a[152:155], v[168:171]
  ds_read_b64_tr_b16 v[30:31], v4 offset:59392
  v_mfma_f32_16x16x32_bf16 v[172:175], a[172:175], a[156:159], v[172:175]
  ds_read_b64_tr_b16 v[24:25], v4 offset:61440
  v_mfma_f32_16x16x32_bf16 v[172:175], a[168:171], a[140:143], v[172:175]
  ds_read_b64_tr_b16 v[26:27], v4 offset:63488
  v_mfma_f32_16x16x32_bf16 v[188:191], a[176:179], a[140:143], v[188:191]
  ds_read_b64_tr_b16 a[172:173], v5 offset:57344
  v_mfma_f32_16x16x32_bf16 v[188:191], a[180:183], a[156:159], v[188:191]
  ds_read_b64_tr_b16 a[174:175], v5 offset:59392
  v_mfma_f32_16x16x32_bf16 v[184:187], a[180:183], a[152:155], v[184:187]
  ds_read_b64_tr_b16 a[168:169], v5 offset:61440
  v_mfma_f32_16x16x32_bf16 v[184:187], a[176:179], a[136:139], v[184:187]
  s_waitcnt lgkmcnt(7)
  ds_read_b64_tr_b16 a[170:171], v5 offset:63488
  v_mfma_f32_16x16x32_bf16 v[136:139], a[164:167], a[196:199], v[136:139]
  ds_read_b64_tr_b16 a[180:181], v6 offset:40960
  v_mfma_f32_16x16x32_bf16 v[136:139], a[160:163], a[212:215], v[136:139]
  ds_read_b64_tr_b16 a[182:183], v6 offset:43008
  v_mfma_f32_16x16x32_bf16 v[140:143], a[160:163], a[216:219], v[140:143]
  ds_read_b64_tr_b16 a[176:177], v6 offset:45056
  v_mfma_f32_16x16x32_bf16 v[140:143], a[164:167], a[200:203], v[140:143]
  ds_read_b64_tr_b16 a[178:179], v6 offset:47104
  v_mfma_f32_16x16x32_bf16 v[156:159], v[20:23], a[200:203], v[156:159]
  ds_read_b64_tr_b16 a[160:161], v7 offset:40960
  v_mfma_f32_16x16x32_bf16 v[156:159], v[16:19], a[216:219], v[156:159]
  ds_read_b64_tr_b16 a[162:163], v7 offset:43008
  v_mfma_f32_16x16x32_bf16 v[152:155], v[16:19], a[212:215], v[152:155]
  ds_read_b64_tr_b16 a[164:165], v7 offset:45056
  v_cvt_pk_bf16_f32 v136, v136, v137
  v_cvt_pk_bf16_f32 v137, v138, v139
  v_cvt_pk_bf16_f32 v140, v140, v141
  v_cvt_pk_bf16_f32 v141, v142, v143
  v_mfma_f32_16x16x32_bf16 v[152:155], v[20:23], a[196:199], v[152:155]
  s_waitcnt lgkmcnt(7)
  ds_read_b64_tr_b16 a[166:167], v7 offset:47104
  v_mfma_f32_16x16x32_bf16 v[168:171], v[28:31], a[196:199], v[168:171]
  ds_read_b64_tr_b16 v[16:17], v8 offset:40960
  v_mfma_f32_16x16x32_bf16 v[168:171], v[24:27], a[212:215], v[168:171]
  ds_read_b64_tr_b16 v[18:19], v8 offset:43008
  v_mfma_f32_16x16x32_bf16 v[172:175], v[24:27], a[216:219], v[172:175]
  ds_read_b64_tr_b16 v[20:21], v8 offset:45056
  v_cvt_pk_bf16_f32 v138, v152, v153
  v_cvt_pk_bf16_f32 v139, v154, v155
  v_mfma_f32_16x16x32_bf16 v[172:175], v[28:31], a[200:203], v[172:175]
  ds_read_b64_tr_b16 v[22:23], v8 offset:47104
  v_mfma_f32_16x16x32_bf16 v[188:191], a[172:175], a[200:203], v[188:191]
  ds_read_b64_tr_b16 v[24:25], v9 offset:40960
  v_mfma_f32_16x16x32_bf16 v[188:191], a[168:171], a[216:219], v[188:191]
  ds_read_b64_tr_b16 v[26:27], v9 offset:43008
  s_add_u32 s86, s85, 8192
  buffer_store_dwordx4 v[136:139], v1, s[8:11], s86 offen offset:0 sc1
  v_mfma_f32_16x16x32_bf16 v[184:187], a[168:171], a[212:215], v[184:187]
  ds_read_b64_tr_b16 v[28:29], v9 offset:45056
  v_cvt_pk_bf16_f32 v142, v156, v157
  v_cvt_pk_bf16_f32 v143, v158, v159
  v_mfma_f32_16x16x32_bf16 v[184:187], a[172:175], a[196:199], v[184:187]
  s_waitcnt lgkmcnt(7)
  ds_read_b64_tr_b16 v[30:31], v9 offset:47104
  v_mfma_f32_16x16x32_bf16 v[128:131], a[180:183], a[220:223], v[128:131]
  ds_read_b64_tr_b16 a[168:169], v6 offset:57344
  v_mfma_f32_16x16x32_bf16 v[128:131], a[176:179], a[236:239], v[128:131]
  ds_read_b64_tr_b16 a[170:171], v6 offset:59392
  s_add_u32 s86, s85, 8192
  buffer_store_dwordx4 v[140:143], v1, s[8:11], s86 offen offset:2048 sc1
  v_mfma_f32_16x16x32_bf16 v[132:135], a[176:179], a[240:243], v[132:135]
  ds_read_b64_tr_b16 a[172:173], v6 offset:61440
  v_cvt_pk_bf16_f32 v168, v168, v169
  v_cvt_pk_bf16_f32 v169, v170, v171
  v_cvt_pk_bf16_f32 v172, v172, v173
  v_cvt_pk_bf16_f32 v173, v174, v175
  v_mfma_f32_16x16x32_bf16 v[132:135], a[180:183], a[224:227], v[132:135]
  ds_read_b64_tr_b16 a[174:175], v6 offset:63488
  v_cvt_pk_bf16_f32 v170, v184, v185
  v_cvt_pk_bf16_f32 v171, v186, v187
  v_mfma_f32_16x16x32_bf16 v[148:151], a[160:163], a[224:227], v[148:151]
  ds_read_b64_tr_b16 a[176:177], v7 offset:57344
  v_mfma_f32_16x16x32_bf16 v[148:151], a[164:167], a[240:243], v[148:151]
  ds_read_b64_tr_b16 a[178:179], v7 offset:59392
  v_mfma_f32_16x16x32_bf16 v[144:147], a[164:167], a[236:239], v[144:147]
  ds_read_b64_tr_b16 a[180:181], v7 offset:61440
  s_add_u32 s86, s85, 8192
  buffer_store_dwordx4 v[168:171], v1, s[8:11], s86 offen offset:1024 sc1
  v_mfma_f32_16x16x32_bf16 v[144:147], a[160:163], a[220:223], v[144:147]
  s_waitcnt lgkmcnt(7)
  ds_read_b64_tr_b16 a[182:183], v7 offset:63488
  v_cvt_pk_bf16_f32 v174, v188, v189
  v_cvt_pk_bf16_f32 v175, v190, v191
  v_mfma_f32_16x16x32_bf16 v[160:163], v[16:19], a[220:223], v[160:163]
  ds_read_b64_tr_b16 a[164:165], v8 offset:57344
  v_mfma_f32_16x16x32_bf16 v[160:163], v[20:23], a[236:239], v[160:163]
  ds_read_b64_tr_b16 a[166:167], v8 offset:59392
  v_mfma_f32_16x16x32_bf16 v[164:167], v[20:23], a[240:243], v[164:167]
  ds_read_b64_tr_b16 a[160:161], v8 offset:61440
  s_add_u32 s86, s85, 8192
  buffer_store_dwordx4 v[172:175], v1, s[8:11], s86 offen offset:3072 sc1
  v_mfma_f32_16x16x32_bf16 v[164:167], v[16:19], a[224:227], v[164:167]
  ds_read_b64_tr_b16 a[162:163], v8 offset:63488
  v_mfma_f32_16x16x32_bf16 v[180:183], v[24:27], a[224:227], v[180:183]
  ds_read_b64_tr_b16 v[20:21], v9 offset:57344
  v_mfma_f32_16x16x32_bf16 v[180:183], v[28:31], a[240:243], v[180:183]
  ds_read_b64_tr_b16 v[22:23], v9 offset:59392
  v_mfma_f32_16x16x32_bf16 v[176:179], v[28:31], a[236:239], v[176:179]
  ds_read_b64_tr_b16 v[16:17], v9 offset:61440
  v_mfma_f32_16x16x32_bf16 v[176:179], v[24:27], a[220:223], v[176:179]
  s_waitcnt lgkmcnt(7)
  ds_read_b64_tr_b16 v[18:19], v9 offset:63488
  v_mfma_f32_16x16x32_bf16 v[128:131], a[168:171], a[0:3], v[128:131]
  ds_read_b64_tr_b16 v[28:29], v6 offset:24576
  v_mfma_f32_16x16x32_bf16 v[128:131], a[172:175], a[16:19], v[128:131]
  ds_read_b64_tr_b16 v[30:31], v6 offset:26624
  v_mfma_f32_16x16x32_bf16 v[132:135], a[172:175], a[20:23], v[132:135]
  ds_read_b64_tr_b16 v[24:25], v6 offset:28672
  v_mfma_f32_16x16x32_bf16 v[132:135], a[168:171], a[4:7], v[132:135]
  ds_read_b64_tr_b16 v[26:27], v6 offset:30720
  v_mfma_f32_16x16x32_bf16 v[148:151], a[176:179], a[4:7], v[148:151]
  ds_read_b64_tr_b16 a[172:173], v7 offset:24576
  v_mfma_f32_16x16x32_bf16 v[148:151], a[180:183], a[20:23], v[148:151]
  ds_read_b64_tr_b16 a[174:175], v7 offset:26624
  v_mfma_f32_16x16x32_bf16 v[144:147], a[180:183], a[16:19], v[144:147]
  ds_read_b64_tr_b16 a[168:169], v7 offset:28672
  v_mfma_f32_16x16x32_bf16 v[144:147], a[176:179], a[0:3], v[144:147]
  s_waitcnt lgkmcnt(7)
  ds_read_b64_tr_b16 a[170:171], v7 offset:30720
  v_mfma_f32_16x16x32_bf16 v[160:163], a[164:167], a[0:3], v[160:163]
  ds_read_b64_tr_b16 a[180:181], v8 offset:24576
  v_mfma_f32_16x16x32_bf16 v[160:163], a[160:163], a[16:19], v[160:163]
  ds_read_b64_tr_b16 a[182:183], v8 offset:26624
  v_mfma_f32_16x16x32_bf16 v[164:167], a[160:163], a[20:23], v[164:167]
  ds_read_b64_tr_b16 a[176:177], v8 offset:28672
  v_mfma_f32_16x16x32_bf16 v[164:167], a[164:167], a[4:7], v[164:167]
  ds_read_b64_tr_b16 a[178:179], v8 offset:30720
  v_mfma_f32_16x16x32_bf16 v[180:183], v[20:23], a[4:7], v[180:183]
  ds_read_b64_tr_b16 a[160:161], v9 offset:24576
  v_mfma_f32_16x16x32_bf16 v[180:183], v[16:19], a[20:23], v[180:183]
  ds_read_b64_tr_b16 a[162:163], v9 offset:26624
  v_mfma_f32_16x16x32_bf16 v[176:179], v[16:19], a[16:19], v[176:179]
  ds_read_b64_tr_b16 a[164:165], v9 offset:28672
  v_mfma_f32_16x16x32_bf16 v[176:179], v[20:23], a[0:3], v[176:179]
  s_waitcnt lgkmcnt(7)
  ds_read_b64_tr_b16 a[166:167], v9 offset:30720
  v_mfma_f32_16x16x32_bf16 v[128:131], v[28:31], a[32:35], v[128:131]
  ds_read_b64_tr_b16 v[16:17], v6 offset:8192
  v_mfma_f32_16x16x32_bf16 v[128:131], v[24:27], a[48:51], v[128:131]
  ds_read_b64_tr_b16 v[18:19], v6 offset:10240
  v_mfma_f32_16x16x32_bf16 v[132:135], v[24:27], a[52:55], v[132:135]
  ds_read_b64_tr_b16 v[20:21], v6 offset:12288
  v_mfma_f32_16x16x32_bf16 v[132:135], v[28:31], a[36:39], v[132:135]
  ds_read_b64_tr_b16 v[22:23], v6 offset:14336
  v_mfma_f32_16x16x32_bf16 v[148:151], a[172:175], a[36:39], v[148:151]
  ds_read_b64_tr_b16 v[24:25], v7 offset:8192
  v_mfma_f32_16x16x32_bf16 v[148:151], a[168:171], a[52:55], v[148:151]
  ds_read_b64_tr_b16 v[26:27], v7 offset:10240
  s_xor_b32 s83, s80, 1536
  s_add_u32 s83, s83, 0
  buffer_load_dword v34, v37, s[8:11], s83 offen sc1
  v_mfma_f32_16x16x32_bf16 v[144:147], a[168:171], a[48:51], v[144:147]
  ds_read_b64_tr_b16 v[28:29], v7 offset:12288
  s_xor_b32 s90, s80, 512
  s_add_u32 s90, s90, 0
  buffer_load_dword v39, v37, s[8:11], s90 offen sc1
  v_mfma_f32_16x16x32_bf16 v[144:147], a[172:175], a[32:35], v[144:147]
  s_waitcnt lgkmcnt(7)
  ds_read_b64_tr_b16 v[30:31], v7 offset:14336
  v_mfma_f32_16x16x32_bf16 v[160:163], a[180:183], a[32:35], v[160:163]
  ds_read_b64_tr_b16 a[168:169], v8 offset:8192
  v_mfma_f32_16x16x32_bf16 v[160:163], a[176:179], a[48:51], v[160:163]
  ds_read_b64_tr_b16 a[170:171], v8 offset:10240
  v_mfma_f32_16x16x32_bf16 v[164:167], a[176:179], a[52:55], v[164:167]
  ds_read_b64_tr_b16 a[172:173], v8 offset:12288
  v_mfma_f32_16x16x32_bf16 v[164:167], a[180:183], a[36:39], v[164:167]
  ds_read_b64_tr_b16 a[174:175], v8 offset:14336
  v_mfma_f32_16x16x32_bf16 v[180:183], a[160:163], a[36:39], v[180:183]
  ds_read_b64_tr_b16 a[176:177], v9 offset:8192
  v_mfma_f32_16x16x32_bf16 v[180:183], a[164:167], a[52:55], v[180:183]
  ds_read_b64_tr_b16 a[178:179], v9 offset:10240
  v_mfma_f32_16x16x32_bf16 v[176:179], a[164:167], a[48:51], v[176:179]
  ds_read_b64_tr_b16 a[180:181], v9 offset:12288
  v_mfma_f32_16x16x32_bf16 v[176:179], a[160:163], a[32:35], v[176:179]
  s_waitcnt lgkmcnt(7)
  ds_read_b64_tr_b16 a[182:183], v9 offset:14336
  v_add_u32 v38, s46, v0
  s_waitcnt vmcnt(2)
  s_mov_b64 exec, 1
  buffer_store_dword v38, v0, s[8:11], s80 offen offset:16 sc1
  s_mov_b64 exec, -1
  v_mfma_f32_16x16x32_bf16 v[128:131], v[16:19], a[64:67], v[128:131]
  ds_read_b64_tr_b16 a[164:165], v2 offset:8192
  v_mfma_f32_16x16x32_bf16 v[128:131], v[20:23], a[80:83], v[128:131]
  ds_read_b64_tr_b16 a[166:167], v2 offset:10240
  v_mfma_f32_16x16x32_bf16 v[132:135], v[20:23], a[84:87], v[132:135]
  ds_read_b64_tr_b16 a[160:161], v2 offset:12288
  v_mfma_f32_16x16x32_bf16 v[132:135], v[16:19], a[68:71], v[132:135]
  ds_read_b64_tr_b16 a[162:163], v2 offset:14336
  s_xor_b32 s81, s80, 1024
  s_add_u32 s81, s81, 16
  buffer_load_dword v36, v37, s[8:11], s81 offen sc1
  v_mfma_f32_16x16x32_bf16 v[148:151], v[24:27], a[68:71], v[148:151]
  ds_read_b64_tr_b16 v[20:21], v3 offset:8192
  v_mfma_f32_16x16x32_bf16 v[148:151], v[28:31], a[84:87], v[148:151]
  ds_read_b64_tr_b16 v[22:23], v3 offset:10240
  v_mfma_f32_16x16x32_bf16 v[144:147], v[28:31], a[80:83], v[144:147]
  ds_read_b64_tr_b16 v[16:17], v3 offset:12288
  v_mfma_f32_16x16x32_bf16 v[144:147], v[24:27], a[64:67], v[144:147]
  s_waitcnt lgkmcnt(7)
  ds_read_b64_tr_b16 v[18:19], v3 offset:14336
  v_mfma_f32_16x16x32_bf16 v[160:163], a[168:171], a[64:67], v[160:163]
  ds_read_b64_tr_b16 v[28:29], v4 offset:8192
  v_mfma_f32_16x16x32_bf16 v[160:163], a[172:175], a[80:83], v[160:163]
  ds_read_b64_tr_b16 v[30:31], v4 offset:10240
  v_mfma_f32_16x16x32_bf16 v[164:167], a[172:175], a[84:87], v[164:167]
  ds_read_b64_tr_b16 v[24:25], v4 offset:12288
  v_mfma_f32_16x16x32_bf16 v[164:167], a[168:171], a[68:71], v[164:167]
  ds_read_b64_tr_b16 v[26:27], v4 offset:14336
  v_mfma_f32_16x16x32_bf16 v[180:183], a[176:179], a[68:71], v[180:183]
  ds_read_b64_tr_b16 a[172:173], v5 offset:8192
  v_mfma_f32_16x16x32_bf16 v[180:183], a[180:183], a[84:87], v[180:183]
  ds_read_b64_tr_b16 a[174:175], v5 offset:10240
  v_mfma_f32_16x16x32_bf16 v[176:179], a[180:183], a[80:83], v[176:179]
  ds_read_b64_tr_b16 a[168:169], v5 offset:12288
  v_mfma_f32_16x16x32_bf16 v[176:179], a[176:179], a[64:67], v[176:179]
  s_waitcnt lgkmcnt(7)
  ds_read_b64_tr_b16 a[170:171], v5 offset:14336
  v_mfma_f32_16x16x32_bf16 v[128:131], a[164:167], a[96:99], v[128:131]
  ds_read_b64_tr_b16 a[180:181], v2 offset:40960
  v_mfma_f32_16x16x32_bf16 v[128:131], a[160:163], a[112:115], v[128:131]
  ds_read_b64_tr_b16 a[182:183], v2 offset:43008
  s_waitcnt vmcnt(3)
  v_cmp_ne_u32 vcc, s46, v34
  s_nop 4
  s_cbranch_vccz PL14_adaLN_cond__sliding_local_dilated__swiglu_ffn__prompt_kernelx
  s_mov_b32 s82, 60000
PL14_adaLN_cond__sliding_local_dilated__swiglu_ffn__prompt_kernel:
  buffer_load_dword v34, v37, s[8:11], s83 offen sc1
  s_sub_u32 s82, s82, 1
  s_cmp_eq_u32 s82, 0
  s_waitcnt vmcnt(0)
  s_cbranch_scc1 PL14_adaLN_cond__sliding_local_dilated__swiglu_ffn__prompt_kernelx
  v_cmp_ne_u32 vcc, s46, v34
  s_nop 4
  s_cbranch_vccnz PL14_adaLN_cond__sliding_local_dilated__swiglu_ffn__prompt_kernel
PL14_adaLN_cond__sliding_local_dilated__swiglu_ffn__prompt_kernelx:
  v_mfma_f32_16x16x32_bf16 v[132:135], a[160:163], a[116:119], v[132:135]
  ds_read_b64_tr_b16 a[176:177], v2 offset:45056
  s_xor_b32 s55, s85, 196608
  s_add_u32 s55, s55, 0
  buffer_load_dwordx4 v[88:91], v1, s[8:11], s55 offen offset:0 sc1
  v_mfma_f32_16x16x32_bf16 v[132:135], a[164:167], a[100:103], v[132:135]
  ds_read_b64_tr_b16 a[178:179], v2 offset:47104
  s_xor_b32 s55, s85, 196608
  s_add_u32 s55, s55, 0
  buffer_load_dwordx4 v[120:123], v1, s[8:11], s55 offen offset:1024 sc1
  v_mfma_f32_16x16x32_bf16 v[148:151], v[20:23], a[100:103], v[148:151]
  ds_read_b64_tr_b16 a[160:161], v3 offset:40960
  s_xor_b32 s55, s85, 196608
  s_add_u32 s55, s55, 0
  buffer_load_dwordx4 v[92:95], v1, s[8:11], s55 offen offset:2048 sc1
  v_mfma_f32_16x16x32_bf16 v[148:151], v[16:19], a[116:119], v[148:151]
  ds_read_b64_tr_b16 a[162:163], v3 offset:43008
  s_xor_b32 s55, s85, 196608
  s_add_u32 s55, s55, 0
  buffer_load_dwordx4 v[124:127], v1, s[8:11], s55 offen offset:3072 sc1
  v_mfma_f32_16x16x32_bf16 v[144:147], v[16:19], a[112:115], v[144:147]
  ds_read_b64_tr_b16 a[164:165], v3 offset:45056
  s_waitcnt vmcnt(6)
  v_cmp_ne_u32 vcc, s46, v39
  s_nop 4
  s_cbranch_vccz PL15_adaLN_cond__sliding_local_dilated__swiglu_ffn__prompt_kernelx
  s_mov_b32 s82, 60000
PL15_adaLN_cond__sliding_local_dilated__swiglu_ffn__prompt_kernel:
  buffer_load_dword v39, v37, s[8:11], s90 offen sc1
  s_sub_u32 s82, s82, 1
  s_cmp_eq_u32 s82, 0
  s_waitcnt vmcnt(0)
  s_cbranch_scc1 PL15_adaLN_cond__sliding_local_dilated__swiglu_ffn__prompt_kernelx
  v_cmp_ne_u32 vcc, s46, v39
  s_nop 4
  s_cbranch_vccnz PL15_adaLN_cond__sliding_local_dilated__swiglu_ffn__prompt_kernel
PL15_adaLN_cond__sliding_local_dilated__swiglu_ffn__prompt_kernelx:
  v_mfma_f32_16x16x32_bf16 v[144:147], v[20:23], a[96:99], v[144:147]
  s_waitcnt lgkmcnt(7)
  ds_read_b64_tr_b16 a[166:167], v3 offset:47104
  s_xor_b32 s55, s85, 65536
  s_add_u32 s55, s55, 4096
  buffer_load_dwordx4 v[80:83], v1, s[8:11], s55 offen offset:0 sc1
  v_mfma_f32_16x16x32_bf16 v[160:163], v[28:31], a[96:99], v[160:163]
  ds_read_b64_tr_b16 v[16:17], v4 offset:40960
  s_xor_b32 s55, s85, 65536
  s_add_u32 s55, s55, 4096
  buffer_load_dwordx4 v[112:115], v1, s[8:11], s55 offen offset:1024 sc1
  v_mfma_f32_16x16x32_bf16 v[160:163], v[24:27], a[112:115], v[160:163]
  ds_read_b64_tr_b16 v[18:19], v4 offset:43008
  s_xor_b32 s55, s85, 65536
  s_add_u32 s55, s55, 4096
  buffer_load_dwordx4 v[84:87], v1, s[8:11], s55 offen offset:2048 sc1
  v_mfma_f32_16x16x32_bf16 v[164:167], v[24:27], a[116:119], v[164:167]
  ds_read_b64_tr_b16 v[20:21], v4 offset:45056
  s_xor_b32 s55, s85, 65536
  s_add_u32 s55, s55, 4096
  buffer_load_dwordx4 v[116:119], v1, s[8:11], s55 offen offset:3072 sc1
  v_mfma_f32_16x16x32_bf16 v[164:167], v[28:31], a[100:103], v[164:167]
  ds_read_b64_tr_b16 v[22:23], v4 offset:47104
  v_mfma_f32_16x16x32_bf16 v[180:183], a[172:175], a[100:103], v[180:183]
  ds_read_b64_tr_b16 v[24:25], v5 offset:40960
  v_mfma_f32_16x16x32_bf16 v[180:183], a[168:171], a[116:119], v[180:183]
  ds_read_b64_tr_b16 v[26:27], v5 offset:43008
  s_waitcnt vmcnt(8)
  v_cmp_ne_u32 vcc, s46, v36
  s_mov_b32 s86, 0
  s_nop 3
  s_cbranch_vccnz XL16_adaLN_cond__sliding_local_dilated__swiglu_ffn__prompt_kernel
  s_xor_b32 s55, s85, 131072
  s_add_u32 s55, s55, 8192
  buffer_load_dwordx4 v[152:155], v1, s[8:11], s55 offen offset:0 sc1
  buffer_load_dwordx4 v[184:187], v1, s[8:11], s55 offen offset:1024 sc1
  buffer_load_dwordx4 v[156:159], v1, s[8:11], s55 offen offset:2048 sc1
  buffer_load_dwordx4 v[188:191], v1, s[8:11], s55 offen offset:3072 sc1
  s_mov_b32 s86, 1
XL16_adaLN_cond__sliding_local_dilated__swiglu_ffn__prompt_kernel:
  v_mfma_f32_16x16x32_bf16 v[176:179], a[168:171], a[112:115], v[176:179]
  ds_read_b64_tr_b16 v[28:29], v5 offset:45056
  v_mfma_f32_16x16x32_bf16 v[176:179], a[172:175], a[96:99], v[176:179]
  s_waitcnt lgkmcnt(7)
  ds_read_b64_tr_b16 v[30:31], v5 offset:47104
  v_mfma_f32_16x16x32_bf16 v[128:131], a[180:183], a[128:131], v[128:131]
  ds_read_b64_tr_b16 a[168:169], v2 offset:57344
  v_mfma_f32_16x16x32_bf16 v[128:131], a[176:179], a[144:147], v[128:131]
  ds_read_b64_tr_b16 a[170:171], v2 offset:59392
  v_mfma_f32_16x16x32_bf16 v[132:135], a[176:179], a[148:151], v[132:135]
  ds_read_b64_tr_b16 a[172:173], v2 offset:61440
  v_mfma_f32_16x16x32_bf16 v[132:135], a[180:183], a[132:135], v[132:135]
  ds_read_b64_tr_b16 a[174:175], v2 offset:63488
  v_mfma_f32_16x16x32_bf16 v[148:151], a[160:163], a[132:135], v[148:151]
  ds_read_b64_tr_b16 a[176:177], v3 offset:57344
  v_mfma_f32_16x16x32_bf16 v[148:151], a[164:167], a[148:151], v[148:151]
  ds_read_b64_tr_b16 a[178:179], v3 offset:59392
  v_mfma_f32_16x16x32_bf16 v[144:147], a[164:167], a[144:147], v[144:147]
  ds_read_b64_tr_b16 a[180:181], v3 offset:61440
  v_mfma_f32_16x16x32_bf16 v[144:147], a[160:163], a[128:131], v[144:147]
  s_waitcnt lgkmcnt(7)
  ds_read_b64_tr_b16 a[182:183], v3 offset:63488
  v_mfma_f32_16x16x32_bf16 v[160:163], v[16:19], a[128:131], v[160:163]
  ds_read_b64_tr_b16 a[164:165], v4 offset:57344
  v_mfma_f32_16x16x32_bf16 v[160:163], v[20:23], a[144:147], v[160:163]
  ds_read_b64_tr_b16 a[166:167], v4 offset:59392
  v_mfma_f32_16x16x32_bf16 v[164:167], v[20:23], a[148:151], v[164:167]
  ds_read_b64_tr_b16 a[160:161], v4 offset:61440
  v_mfma_f32_16x16x32_bf16 v[164:167], v[16:19], a[132:135], v[164:167]
  ds_read_b64_tr_b16 a[162:163], v4 offset:63488
  v_mfma_f32_16x16x32_bf16 v[180:183], v[24:27], a[132:135], v[180:183]
  ds_read_b64_tr_b16 v[20:21], v5 offset:57344
  v_mfma_f32_16x16x32_bf16 v[180:183], v[28:31], a[148:151], v[180:183]
  ds_read_b64_tr_b16 v[22:23], v5 offset:59392
  v_mfma_f32_16x16x32_bf16 v[176:179], v[28:31], a[144:147], v[176:179]
  ds_read_b64_tr_b16 v[16:17], v5 offset:61440
  v_mfma_f32_16x16x32_bf16 v[176:179], v[24:27], a[128:131], v[176:179]
  s_waitcnt lgkmcnt(7)
  ds_read_b64_tr_b16 v[18:19], v5 offset:63488
  v_mfma_f32_16x16x32_bf16 v[128:131], a[168:171], a[188:191], v[128:131]
  v_mfma_f32_16x16x32_bf16 v[128:131], a[172:175], a[204:207], v[128:131]
  v_mfma_f32_16x16x32_bf16 v[132:135], a[172:175], a[208:211], v[132:135]
  v_mfma_f32_16x16x32_bf16 v[132:135], a[168:171], a[192:195], v[132:135]
  v_mfma_f32_16x16x32_bf16 v[148:151], a[176:179], a[192:195], v[148:151]
  v_mfma_f32_16x16x32_bf16 v[148:151], a[180:183], a[208:211], v[148:151]
  v_mfma_f32_16x16x32_bf16 v[144:147], a[180:183], a[204:207], v[144:147]
  v_mfma_f32_16x16x32_bf16 v[144:147], a[176:179], a[188:191], v[144:147]
  s_waitcnt lgkmcnt(0)
  v_mfma_f32_16x16x32_bf16 v[160:163], a[164:167], a[188:191], v[160:163]
  v_mfma_f32_16x16x32_bf16 v[160:163], a[160:163], a[204:207], v[160:163]
  v_mfma_f32_16x16x32_bf16 v[164:167], a[160:163], a[208:211], v[164:167]
  v_mfma_f32_16x16x32_bf16 v[164:167], a[164:167], a[192:195], v[164:167]
  v_mfma_f32_16x16x32_bf16 v[180:183], v[20:23], a[192:195], v[180:183]
  v_mfma_f32_16x16x32_bf16 v[180:183], v[16:19], a[208:211], v[180:183]
  v_mfma_f32_16x16x32_bf16 v[176:179], v[16:19], a[204:207], v[176:179]
  v_mfma_f32_16x16x32_bf16 v[176:179], v[20:23], a[188:191], v[176:179]
  s_waitcnt vmcnt(0)
  v_mfma_f32_16x16x32_bf16 v[208:211], v[52:55], v[88:91], v[208:211]
  v_mfma_f32_16x16x32_bf16 v[212:215], v[54:57], v[88:91], v[212:215]
  v_mfma_f32_16x16x32_bf16 v[216:219], v[58:61], v[120:123], v[216:219]
  v_mfma_f32_16x16x32_bf16 v[220:223], v[60:63], v[120:123], v[220:223]
  v_mfma_f32_16x16x32_bf16 v[224:227], v[52:55], v[92:95], v[224:227]
  v_mfma_f32_16x16x32_bf16 v[228:231], v[54:57], v[92:95], v[228:231]
  v_mfma_f32_16x16x32_bf16 v[232:235], v[58:61], v[124:127], v[232:235]
  v_mfma_f32_16x16x32_bf16 v[236:239], v[60:63], v[124:127], v[236:239]
  v_mfma_f32_16x16x32_bf16 v[208:211], v[52:55], v[80:83], v[208:211]
  v_mfma_f32_16x16x32_bf16 v[212:215], v[54:57], v[80:83], v[212:215]
  v_mfma_f32_16x16x32_bf16 v[216:219], v[58:61], v[112:115], v[216:219]
  v_mfma_f32_16x16x32_bf16 v[220:223], v[60:63], v[112:115], v[220:223]
  v_mfma_f32_16x16x32_bf16 v[224:227], v[52:55], v[84:87], v[224:227]
  v_mfma_f32_16x16x32_bf16 v[228:231], v[54:57], v[84:87], v[228:231]
  v_mfma_f32_16x16x32_bf16 v[232:235], v[58:61], v[116:119], v[232:235]
  v_mfma_f32_16x16x32_bf16 v[236:239], v[60:63], v[116:119], v[236:239]
  s_nop 0
  v_fmac_f32 v208, v240, v128
  v_fmac_f32 v209, v241, v129
  v_fmac_f32 v210, v242, v130
  v_fmac_f32 v211, v243, v131
  v_fmac_f32 v212, v244, v144
  v_fmac_f32 v213, v245, v145
  v_fmac_f32 v214, v246, v146
  v_fmac_f32 v215, v247, v147
  v_fmac_f32 v224, v240, v132
  v_fmac_f32 v225, v241, v133
  v_fmac_f32 v226, v242, v134
  v_fmac_f32 v227, v243, v135
  v_fmac_f32 v228, v244, v148
  v_fmac_f32 v229, v245, v149
  v_fmac_f32 v230, v246, v150
  v_fmac_f32 v231, v247, v151
  v_fmac_f32 v216, v248, v160
  v_fmac_f32 v217, v249, v161
  v_fmac_f32 v218, v250, v162
  v_fmac_f32 v219, v251, v163
  v_fmac_f32 v220, v252, v176
  v_fmac_f32 v221, v253, v177
  v_fmac_f32 v222, v254, v178
  v_fmac_f32 v223, v255, v179
  v_fmac_f32 v232, v248, v164
  v_fmac_f32 v233, v249, v165
  v_fmac_f32 v234, v250, v166
  v_fmac_f32 v235, v251, v167
  v_fmac_f32 v236, v252, v180
  v_fmac_f32 v237, v253, v181
  v_fmac_f32 v238, v254, v182
  v_fmac_f32 v239, v255, v183
  s_cmp_eq_u32 s86, 1
  s_cbranch_scc1 XA17_adaLN_cond__sliding_local_dilated__swiglu_ffn__prompt_kernelx
  s_mov_b32 s82, 60000
XA17_adaLN_cond__sliding_local_dilated__swiglu_ffn__prompt_kernel:
  buffer_load_dword v36, v37, s[8:11], s81 offen sc1
  s_sub_u32 s82, s82, 1
  s_cmp_eq_u32 s82, 0
  s_waitcnt vmcnt(0)
  s_cbranch_scc1 XA17_adaLN_cond__sliding_local_dilated__swiglu_ffn__prompt_kernely
  v_cmp_ne_u32 vcc, s46, v36
  s_nop 4
  s_cbranch_vccnz XA17_adaLN_cond__sliding_local_dilated__swiglu_ffn__prompt_kernel
XA17_adaLN_cond__sliding_local_dilated__swiglu_ffn__prompt_kernely:
  s_xor_b32 s55, s85, 131072
  s_add_u32 s55, s55, 8192
  buffer_load_dwordx4 v[152:155], v1, s[8:11], s55 offen offset:0 sc1
  buffer_load_dwordx4 v[184:187], v1, s[8:11], s55 offen offset:1024 sc1
  buffer_load_dwordx4 v[156:159], v1, s[8:11], s55 offen offset:2048 sc1
  buffer_load_dwordx4 v[188:191], v1, s[8:11], s55 offen offset:3072 sc1
XA17_adaLN_cond__sliding_local_dilated__swiglu_ffn__prompt_kernelx:
  s_waitcnt vmcnt(3)
  v_mfma_f32_16x16x32_bf16 v[208:211], v[52:55], v[152:155], v[208:211]
  v_mfma_f32_16x16x32_bf16 v[212:215], v[54:57], v[152:155], v[212:215]
  s_waitcnt vmcnt(2)
  v_mfma_f32_16x16x32_bf16 v[216:219], v[58:61], v[184:187], v[216:219]
  v_mfma_f32_16x16x32_bf16 v[220:223], v[60:63], v[184:187], v[220:223]
  s_waitcnt vmcnt(1)
  v_mfma_f32_16x16x32_bf16 v[224:227], v[52:55], v[156:159], v[224:227]
  v_mfma_f32_16x16x32_bf16 v[228:231], v[54:57], v[156:159], v[228:231]
  s_waitcnt vmcnt(0)
  v_mfma_f32_16x16x32_bf16 v[232:235], v[58:61], v[188:191], v[232:235]
  v_mfma_f32_16x16x32_bf16 v[236:239], v[60:63], v[188:191], v[236:239]
  v_cvt_pk_bf16_f32 v192, v208, v209
  v_cvt_pk_bf16_f32 v193, v210, v211
  v_cvt_pk_bf16_f32 v194, v212, v213
  v_cvt_pk_bf16_f32 v195, v214, v215
  s_nop 0
  v_permlane16_swap_b32 v192, v194
  v_permlane16_swap_b32 v193, v195
  ds_write_b128 v42, v[192:195] offset:0
  v_cvt_pk_bf16_f32 v196, v216, v217
  v_cvt_pk_bf16_f32 v197, v218, v219
  v_cvt_pk_bf16_f32 v198, v220, v221
  v_cvt_pk_bf16_f32 v199, v222, v223
  s_nop 0
  v_permlane16_swap_b32 v196, v198
  v_permlane16_swap_b32 v197, v199
  ds_write_b128 v43, v[196:199] offset:0
  ds_read_b128 v[208:211], v44 offset:0
  ds_read_b128 v[212:215], v44 offset:1024
  v_cvt_pk_bf16_f32 v200, v224, v225
  v_cvt_pk_bf16_f32 v201, v226, v227
  v_cvt_pk_bf16_f32 v202, v228, v229
  v_cvt_pk_bf16_f32 v203, v230, v231
  s_nop 0
  v_permlane16_swap_b32 v200, v202
  v_permlane16_swap_b32 v201, v203
  ds_write_b128 v42, v[200:203] offset:2048
  v_cvt_pk_bf16_f32 v204, v232, v233
  v_cvt_pk_bf16_f32 v205, v234, v235
  v_cvt_pk_bf16_f32 v206, v236, v237
  v_cvt_pk_bf16_f32 v207, v238, v239
  s_nop 0
  v_permlane16_swap_b32 v204, v206
  v_permlane16_swap_b32 v205, v207
  ds_write_b128 v43, v[204:207] offset:2048
  ds_read_b128 v[224:227], v44 offset:2048
  ds_read_b128 v[228:231], v44 offset:3072
  s_waitcnt lgkmcnt(5)
  buffer_store_dwordx4 v[208:211], v40, s[40:43], s84 offen sc1
  s_add_u32 s84, s84, 16384
  s_waitcnt lgkmcnt(4)
  buffer_store_dwordx4 v[212:215], v40, s[40:43], s84 offen sc1
  s_add_u32 s84, s84, 16384
  s_waitcnt lgkmcnt(1)
  buffer_store_dwordx4 v[224:227], v40, s[40:43], s84 offen sc1
  s_add_u32 s84, s84, 16384
  s_waitcnt lgkmcnt(0)
  buffer_store_dwordx4 v[228:231], v40, s[40:43], s84 offen sc1
E_adaLN_cond__sliding_local_dilated__swiglu_ffn__prompt_kernel:
X_adaLN_cond__sliding_local_dilated__swiglu_ffn__prompt_kernel:
  s_endpgm
code_end:
.fill 2048, 4, 0xBF800000
.section .rodata,"a"
.p2align 6
.amdhsa_kernel adaLN_cond__sliding_local_dilated__swiglu_ffn__prompt_kernel
  .amdhsa_next_free_vgpr 512
  .amdhsa_next_free_sgpr 102
  .amdhsa_accum_offset 256
  .amdhsa_group_segment_fixed_size 0
  .amdhsa_kernarg_size 96
  .amdhsa_user_sgpr_count 2
  .amdhsa_user_sgpr_kernarg_segment_ptr 1
  .amdhsa_system_sgpr_workgroup_id_x 1
  .amdhsa_float_denorm_mode_32 3
.end_amdhsa_kernel
```

```asm
; @launch grid=(256,1,1) block=(256,1,1) lds=163840
.amdgcn_target "amdgcn-amd-amdhsa--gfx950"
.text
.globl adaLN_cond__sliding_local_dilated__swiglu_ffn__prompt_kernel
.type adaLN_cond__sliding_local_dilated__swiglu_ffn__prompt_kernel,@function
.p2align 8
adaLN_cond__sliding_local_dilated__swiglu_ffn__prompt_kernel:
  s_cmp_ge_u32 s2, 256
  s_cbranch_scc1 X_adaLN_cond__sliding_local_dilated__swiglu_ffn__prompt_kernel
  s_load_dwordx2 s[4:5], s[0:1], 0
  s_load_dwordx2 s[8:9], s[0:1], 88
  s_load_dwordx2 s[12:13], s[0:1], 8
  s_load_dwordx2 s[16:17], s[0:1], 16
  s_load_dwordx2 s[20:21], s[0:1], 64
  s_load_dwordx2 s[24:25], s[0:1], 56
  s_load_dwordx2 s[28:29], s[0:1], 32
  s_load_dwordx2 s[32:33], s[0:1], 40
  s_load_dwordx2 s[36:37], s[0:1], 48
  s_load_dwordx2 s[40:41], s[0:1], 72
  v_lshrrev_b32 v21, 6, v0
  v_and_b32 v0, 63, v0
  v_readfirstlane_b32 s44, v21
  v_lshrrev_b32 v22, 3, v0
  v_lshlrev_b32 v1, 4, v0
  s_lshr_b32 s83, s2, 3
  s_lshl_b32 s83, s83, 2
  s_add_u32 s83, s83, s44
  s_lshl_b32 s83, s83, 10
  s_getpc_b64 s[80:81]
CT1_adaLN_cond__sliding_local_dilated__swiglu_ffn__prompt_kernel:
  s_min_u32 s82, s83, code_end-CB0
  s_add_u32 s82, s82, CB0-CT1_adaLN_cond__sliding_local_dilated__swiglu_ffn__prompt_kernel
  s_add_u32 s80, s80, s82
  s_addc_u32 s81, s81, 0
  v_and_b32 v24, 0x70, v1
  v_lshlrev_b32 v24, 3, v24
  global_load_dword a253, v24, s[80:81]
  v_bfe_u32 v11, v22, 1, 2
  v_bfe_u32 v23, v0, 1, 2
  v_xor_b32 v11, v11, v23
  v_lshlrev_b32 v11, 5, v11
  v_and_b32 v23, 1, v0
  v_lshl_add_u32 v11, v23, 4, v11
  s_lshl_b32 s45, s44, 10
  s_lshl_b32 s52, s44, 3
  v_add_u32 v10, s52, v22
  s_and_b32 s52, s2, 7
  s_lshl_b32 s52, s52, 7
  v_add_u32 v35, s52, v10
  v_mul_u32_u24 v35, 12288, v35
  s_lshr_b32 s53, s2, 3
  s_lshl_b32 s53, s53, 7
  v_add3_u32 v35, v35, v11, s53
  s_and_b32 s53, s44, 1
  s_lshl_b32 s53, s53, 6
  s_add_u32 s52, s52, s53
  v_add_lshl_u32 v16, s52, v0, 1
  s_and_b32 s52, s2, 7
  s_lshr_b32 s53, s2, 3
  s_and_b32 s51, s52, 3
  s_lshl_b32 s51, s51, 2
  s_and_b32 s50, s53, 3
  s_add_u32 s51, s51, s50
  s_lshr_b32 s50, s52, 2
  s_lshl_b32 s50, s50, 3
  s_lshr_b32 s53, s53, 2
  s_add_u32 s50, s50, s53
  s_lshl_b32 s54, s50, 4
  s_add_u32 s54, s54, s51
  v_and_b32 v21, 7, v0
  v_lshlrev_b32 v28, 11, v21
  v_lshl_add_u32 v28, v22, 4, v28
  v_mov_b32 v29, 851968
  s_lshr_b32 s38, s54, 1
  s_lshl_b32 s38, s38, 15
  s_and_b32 s53, s54, 1
  s_lshl_b32 s53, s53, 2
  s_add_u32 s53, s53, s44
  s_lshl_b32 s52, s53, 8
  s_add_u32 s30, s38, s52
  s_mov_b32 s6, 4194304
  s_mov_b32 s7, 0x20000
  s_mov_b32 s10, 134217728
  s_mov_b32 s11, 0x20000
  s_mov_b32 s14, 6291456
  s_mov_b32 s15, 0x20000
  s_mov_b32 s18, 2097152
  s_mov_b32 s19, 0x20000
  s_mov_b32 s22, 12582912
  s_mov_b32 s23, 0x20000
  s_mov_b32 s26, 2048
  s_mov_b32 s27, 0x20000
  s_waitcnt lgkmcnt(0)
  buffer_load_ushort v15, v16, s[24:27], 0 offen
  s_add_u32 m0, s45, 131072
  s_mov_b32 s68, 0
  buffer_load_dwordx4 v35, s[20:23], s68 offen nt lds
  s_add_u32 m0, s45, 135168
  s_add_u32 s68, s68, 393216
  buffer_load_dwordx4 v35, s[20:23], s68 offen nt lds
  s_add_u32 m0, s45, 139264
  s_add_u32 s68, s68, 393216
  buffer_load_dwordx4 v35, s[20:23], s68 offen nt lds
  s_add_u32 m0, s45, 143360
  s_add_u32 s68, s68, 393216
  buffer_load_dwordx4 v35, s[20:23], s68 offen nt lds
  buffer_load_dword v36, v29, s[8:11], 0 offen sc1
  s_and_b32 s52, s2, 3
  s_lshl_b32 s52, s52, 2
  s_add_u32 s52, s52, s44
  s_lshl_b32 s52, s52, 7
  v_lshlrev_b32 v23, 1, v0
  buffer_load_ushort v23, v23, s[24:27], s52 offen
  s_add_u32 s52, s30, 0
  buffer_load_dwordx4 v[44:47], v28, s[4:7], s52 offen offset:0
  buffer_load_dwordx4 v[48:51], v28, s[4:7], s52 offen offset:128
  s_add_u32 s52, s30, 16384
  buffer_load_dwordx4 v[52:55], v28, s[4:7], s52 offen offset:0
  buffer_load_dwordx4 v[56:59], v28, s[4:7], s52 offen offset:128
  s_branch BODY0
.p2align 12
BODY0:
CB0:
  v_lshlrev_b32 v1, 4, v0
  v_add_u32 v2, 65536, v1
  v_add_u32 v13, 131072, v1
  s_and_b32 s66, s51, 0
  v_mul_u32_u24 v9, 6144, v10
  s_lshl_b32 s52, s51, 7
  v_add3_u32 v9, v9, v11, s52
  s_lshl_b32 s52, s53, 12
  s_add_u32 s38, s38, s52
  s_add_u32 s39, s38, 41943040
  s_add_u32 s38, s38, 1048576
  s_lshl_b32 s34, s53, 9
  s_add_u32 s34, s34, 131072
  s_lshl_b32 s35, s53, 11
  s_add_u32 s35, s35, 819200
  s_xor_b32 s30, s30, 1024
  s_add_u32 s52, s30, 0
  buffer_load_dwordx4 v[92:95], v28, s[4:7], s52 offen offset:0
  buffer_load_dwordx4 v[96:99], v28, s[4:7], s52 offen offset:128
  s_add_u32 s52, s30, 16384
  buffer_load_dwordx4 v[100:103], v28, s[4:7], s52 offen offset:0
  buffer_load_dwordx4 v[104:107], v28, s[4:7], s52 offen offset:128
  s_lshr_b32 s52, s2, 3
  s_mul_i32 s52, s52, 98304
  s_lshl_b32 s53, s44, 11
  s_add_u32 s52, s52, s53
  s_and_b32 s53, s2, 3
  s_lshl_b32 s53, s53, 9
  s_add_u32 s52, s52, s53
  s_add_u32 s52, s52, 0
  s_cmp_lt_u32 s44, 3
  s_cselect_b32 s52, s52, 1073741824
  v_lshrrev_b32 v43, 2, v0
  v_mul_u32_u24 v43, 5632, v43
  v_lshl_add_u32 v43, v0, 7, v43
  buffer_load_dword a252, v43, s[12:15], s52 offen
  v_lshrrev_b32 v41, 2, v0
  v_bfe_u32 v40, v41, 1, 2
  v_lshlrev_b32 v40, 5, v40
  v_lshl_add_u32 v40, v41, 7, v40
  v_and_b32 v41, 3, v0
  v_lshl_add_u32 v40, v41, 3, v40
  s_lshl_b32 s52, s44, 5
  v_xor_b32 v3, s52, v40
  s_and_b32 s52, s52, 64
  s_and_b32 s53, s44, 1
  s_lshl_b32 s53, s53, 14
  s_add_u32 s52, s52, s53
  v_xor_b32 v4, s52, v40
  v_xor_b32 v5, 32, v4
  v_add_u32 v6, 65536, v3
  v_add_u32 v7, 65536, v4
  v_add_u32 v8, 65536, v5
  v_add_u32 v35, 131072, v3
  v_lshrrev_b32 v30, 5, v0
  v_lshlrev_b32 v30, 6, v30
  v_bfe_u32 v40, v0, 2, 2
  v_lshl_add_u32 v30, v40, 4, v30
  v_bfe_u32 v40, v0, 4, 1
  v_lshl_add_u32 v30, v40, 3, v30
  v_lshl_add_u32 v30, v41, 1, v30
  s_lshl_b32 s52, s44, 7
  s_add_u32 s52, s52, 160768
  v_add_u32 v30, s52, v30
  v_lshrrev_b32 v32, 4, v0
  v_lshlrev_b32 v32, 4, v32
  v_add_u32 v31, 160768, v32
  v_and_b32 v40, 15, v0
  v_lshl_add_u32 v32, v40, 27, v32
  s_and_b32 s52, s2, 7
  s_lshl_b32 s52, s52, 13
  s_lshr_b32 s53, s2, 3
  s_lshl_b32 s53, s53, 8
  s_add_u32 s52, s52, s53
  s_lshl_b32 s53, s44, 6
  s_add_u32 s52, s52, s53
  s_add_u32 s42, s52, 131072
  s_lshl_b32 s53, s44, 28
  s_lshl_b32 s31, s2, 7
  s_add_u32 s31, s31, s53
  s_add_u32 s31, s31, 819200
  s_lshl_b32 s74, s54, 7
  s_add_u32 s74, s74, s53
  s_add_u32 s75, s74, 786432
  s_add_u32 s74, s74, 655360
  s_lshl_b32 s52, s50, 18
  s_add_u32 s52, s52, 1015808
  s_max_u32 s72, s52, 1048576
  s_lshr_b32 s53, s44, 1
  s_lshl_b32 s70, s53, 15
  s_add_u32 s52, s52, s70
  v_add_u32 v12, s52, v1
  s_lshl_b32 s53, s53, 11
  s_add_u32 s72, s72, s53
  s_lshl_b32 s70, s44, 12
  s_and_b32 s52, s70, 4096
  s_add_u32 s71, s52, s53
  s_and_b32 s52, s44, 1
  s_add_u32 s52, s52, s66
  s_add_u32 s58, s52, 0
  s_and_b32 s58, s58, 7
  s_lshl_b32 s58, s58, 12
  s_add_u32 s59, s52, 2
  s_and_b32 s59, s59, 7
  s_lshl_b32 s59, s59, 12
  s_add_u32 s60, s52, 4
  s_and_b32 s60, s60, 7
  s_lshl_b32 s60, s60, 12
  s_add_u32 s61, s52, 6
  s_and_b32 s61, s61, 7
  s_lshl_b32 s61, s61, 12
  s_lshl_b32 s52, s50, 4
  s_sub_u32 s52, s52, 2
  v_min_u32 v14, 17, v0
  v_add_u32 v14, s52, v14
  v_max_i32 v14, 0, v14
  v_lshlrev_b32 v14, 7, v14
  v_add_u32 v14, 786432, v14
  s_and_b32 s52, s2, 3
  s_lshl_b32 s52, s52, 8
  v_add_u32 v40, s52, v10
  v_mul_u32_u24 v40, 12288, v40
  s_lshr_b32 s53, s2, 2
  s_add_u32 s53, s53, 32
  s_lshl_b32 s53, s53, 7
  v_lshl_add_u32 v10, v10, 11, v11
  v_add3_u32 v11, v40, v11, s53
  s_and_b32 s52, s44, 1
  s_lshl_b32 s53, s50, 3
  s_add_u32 s53, s53, s52
  s_lshl_b32 s73, s53, 15
  s_lshl_b32 s53, s51, 1
  s_lshr_b32 s57, s44, 1
  s_add_u32 s53, s53, s57
  s_lshl_b32 s53, s53, 10
  s_add_u32 s73, s73, s53
  s_add_u32 s73, s73, 7340032
  s_mul_i32 s57, s57, 3072
  s_add_u32 s57, s57, 131072
  v_add_u32 v19, s57, v1
  s_lshl_b32 s53, s52, 3
  v_add_u32 v18, s53, v19
  s_lshl_b32 s53, s52, 10
  v_add_u32 v17, s53, v19
  v_lshrrev_b32 v40, 2, v0
  v_and_b32 v20, 3, v0
  v_lshl_add_u32 v40, v20, 4, v40
  v_lshl_add_u32 v20, v40, 4, s57
  s_mov_b32 s80, 0xfff0ffff
  s_mov_b32 s81, 0xf000ff00
  s_mov_b32 s82, 0xffe0fffe
  s_mov_b32 s83, 0xe000fe00
  s_mov_b32 s84, 0xffc0fffc
  s_mov_b32 s85, 0xc000fc00
  s_mov_b32 s86, 0xff80fff8
  s_mov_b32 s87, 0x8000f800
  s_mov_b32 s88, 0xaaaaaaaa
  s_mov_b32 s89, 0xaaaaaaaa
  s_mov_b32 s90, 0x000f0000
  s_mov_b32 s91, 0x0fff00ff
  s_mov_b32 s92, 0x003f0003
  s_mov_b32 s93, 0x3fff03ff
  v_mov_b32 v41, 0xffff
  v_mov_b32 v24, 0xffff0000
  v_cndmask_b32 v41, v41, v24, s[88:89]
  v_cndmask_b32 v24, 0, v41, s[90:91]
  v_cndmask_b32 v25, 0, v41, s[92:93]
  v_xor_b32 v26, v24, v41
  v_xor_b32 v27, v25, v41
  s_or_b32 s52, s52, s50
  s_cmp_eq_u32 s52, 0
  s_cselect_b64 s[90:91], s[90:91], 0
  s_cselect_b64 s[92:93], s[92:93], 0
  s_waitcnt vmcnt(15)
  v_lshlrev_b32 v15, 16, v15
  v_mul_f32 v16, 0xbfb8aa3b, v15
  v_exp_f32 v16, v16
  s_nop 0
  v_add_f32 v16, 1.0, v16
  v_rcp_f32 v16, v16
  s_nop 0
  v_mul_f32 v15, v15, v16
  v_cvt_pk_bf16_f32 v15, v15, v15
  ds_write_b16 v30, v15
  s_waitcnt vmcnt(11) lgkmcnt(0)
  s_barrier
  ds_read_b64_tr_b16 v[60:61], v35 offset:0
  ds_read_b64_tr_b16 v[62:63], v35 offset:2048
  ds_read_b128 v[76:79], v31 offset:0
  ds_read_b64_tr_b16 v[64:65], v35 offset:4096
  ds_read_b64_tr_b16 v[66:67], v35 offset:6144
  ds_read_b128 v[80:83], v31 offset:64
  ds_read_b64_tr_b16 v[68:69], v35 offset:8192
  ds_read_b64_tr_b16 v[70:71], v35 offset:10240
  ds_read_b128 v[84:87], v31 offset:128
  ds_read_b64_tr_b16 v[72:73], v35 offset:12288
  ds_read_b64_tr_b16 v[74:75], v35 offset:14336
  ds_read_b128 v[88:91], v31 offset:192
  s_waitcnt vmcnt(10)
  v_readfirstlane_b32 s46, v36
  s_nop 0
  s_add_u32 s46, s46, 8
  s_mul_i32 s52, s46, 0x13c6ef37
  v_mov_b32 v36, 0xff
  s_bfe_u32 s55, s52, 0x80000
  s_bfe_u32 s56, s52, 0x80008
  s_bfe_u32 s69, s52, 0x80010
  s_bfe_u32 s54, s52, 0x80018
  s_waitcnt lgkmcnt(9)
  v_mfma_f32_16x16x32_bf16 v[40:43], v[60:63], v[76:79], 0
  s_waitcnt lgkmcnt(6)
  v_mfma_f32_16x16x32_bf16 v[40:43], v[64:67], v[80:83], v[40:43]
  s_waitcnt lgkmcnt(3)
  v_mfma_f32_16x16x32_bf16 v[40:43], v[68:71], v[84:87], v[40:43]
  s_waitcnt lgkmcnt(0)
  v_mfma_f32_16x16x32_bf16 v[40:43], v[72:75], v[88:91], v[40:43]
  s_nop 7
  v_bfi_b32 v40, v36, s55, v40
  v_bfi_b32 v41, v36, s56, v41
  v_bfi_b32 v42, v36, s69, v42
  v_bfi_b32 v43, v36, s54, v43
  buffer_store_dwordx4 v[40:43], v32, s[8:11], s42 offen sc1
  s_lshr_b32 s52, s2, 3
  s_mul_i32 s52, s52, 98304
  s_lshl_b32 s53, s44, 11
  s_add_u32 s52, s52, s53
  s_and_b32 s53, s2, 3
  s_lshl_b32 s53, s53, 9
  s_add_u32 s52, s52, s53
  s_add_u32 s52, s52, 3145728
  s_cmp_lt_u32 s44, 3
  s_cselect_b32 s52, s52, 1073741824
  v_lshrrev_b32 v43, 2, v0
  v_mul_u32_u24 v43, 5632, v43
  v_lshl_add_u32 v43, v0, 7, v43
  buffer_load_dword a252, v43, s[12:15], s52 offen
  s_mov_b64 exec, 0
  s_cmp_eq_u32 s44, 0
  s_cbranch_scc1 HOP0
  s_cmp_eq_u32 s44, 1
  s_cbranch_scc1 HOP1
  s_cmp_eq_u32 s44, 2
  s_cbranch_scc1 HOP2
  s_cmp_eq_u32 s44, 3
  s_cbranch_scc1 HOP3
WRET0:
  s_mov_b64 exec, -1
  s_lshl_b32 s53, s44, 5
  v_lshlrev_b32 v31, 7, v21
  v_add_u32 v31, 159744, v31
  v_and_b32 v30, 8, v0
  v_lshl_add_u32 v30, v30, 1, v31
  v_add_u32 v30, s53, v30
  v_mov_b32 v108, 0x3f803f80
  v_mov_b32 v109, 0x3f803f80
  v_mov_b32 v110, 0x3f803f80
  v_mov_b32 v111, 0x3f803f80
  s_mov_b32 vcc_lo, 0xaaaaaaaa
  s_mov_b32 vcc_hi, 0xaaaaaaaa
  s_waitcnt vmcnt(7)
  v_mfma_f32_16x16x32_bf16 v[60:63], v[108:111], v[44:47], 0
  v_mfma_f32_16x16x32_bf16 v[64:67], v[44:47], v[44:47], 0
  v_mfma_f32_16x16x32_bf16 v[68:71], v[108:111], v[52:55], 0
  v_mfma_f32_16x16x32_bf16 v[72:75], v[52:55], v[52:55], 0
  v_mfma_f32_16x16x32_bf16 v[60:63], v[108:111], v[48:51], v[60:63]
  v_mfma_f32_16x16x32_bf16 v[64:67], v[48:51], v[48:51], v[64:67]
  v_mfma_f32_16x16x32_bf16 v[68:71], v[108:111], v[56:59], v[68:71]
  v_mfma_f32_16x16x32_bf16 v[72:75], v[56:59], v[56:59], v[72:75]
  s_waitcnt vmcnt(3)
  v_mfma_f32_16x16x32_bf16 v[60:63], v[108:111], v[92:95], v[60:63]
  v_mfma_f32_16x16x32_bf16 v[64:67], v[92:95], v[92:95], v[64:67]
  v_mfma_f32_16x16x32_bf16 v[68:71], v[108:111], v[100:103], v[68:71]
  v_mfma_f32_16x16x32_bf16 v[72:75], v[100:103], v[100:103], v[72:75]
  v_mfma_f32_16x16x32_bf16 v[60:63], v[108:111], v[96:99], v[60:63]
  v_mfma_f32_16x16x32_bf16 v[64:67], v[96:99], v[96:99], v[64:67]
  v_mfma_f32_16x16x32_bf16 v[68:71], v[108:111], v[104:107], v[68:71]
  v_mfma_f32_16x16x32_bf16 v[72:75], v[104:107], v[104:107], v[72:75]
  s_nop 4
  v_mov_b32 v36, v60
  v_cndmask_b32 v64, v64, v65, vcc
  v_cndmask_b32 v66, v66, v67, vcc
  v_mov_b32 v38, v68
  v_cndmask_b32 v72, v72, v73, vcc
  v_cndmask_b32 v74, v74, v75, vcc
  s_mov_b32 vcc_lo, 0xcccccccc
  s_mov_b32 vcc_hi, 0xcccccccc
  v_cndmask_b32 v37, v64, v66, vcc
  v_cndmask_b32 v39, v72, v74, vcc
  s_mov_b32 exec_lo, 0x00f0000f
  s_mov_b32 exec_hi, 0xf0000f00
  ds_write_b128 v30, v[36:39]
  s_mov_b64 exec, -1
  s_add_u32 m0, s45, 0
  s_add_u32 s68, s66, 0
  s_and_b32 s68, s68, 7
  s_mul_i32 s68, s68, 786432
  buffer_load_dwordx4 v9, s[12:15], s68 offen lds
  v_lshlrev_b32 v60, 16, v44
  v_and_b32 v61, 0xffff0000, v44
  v_lshlrev_b32 v62, 16, v45
  v_and_b32 v63, 0xffff0000, v45
  v_lshlrev_b32 v64, 16, v46
  v_and_b32 v65, 0xffff0000, v46
  v_lshlrev_b32 v66, 16, v47
  v_and_b32 v67, 0xffff0000, v47
  v_lshlrev_b32 v68, 16, v48
  v_and_b32 v69, 0xffff0000, v48
  v_lshlrev_b32 v70, 16, v49
  v_and_b32 v71, 0xffff0000, v49
  v_lshlrev_b32 v72, 16, v50
  s_add_u32 m0, s45, 4096
  s_add_u32 s68, s68, 196608
  buffer_load_dwordx4 v9, s[12:15], s68 offen lds
  v_and_b32 v73, 0xffff0000, v50
  v_lshlrev_b32 v74, 16, v51
  v_and_b32 v75, 0xffff0000, v51
  v_lshlrev_b32 v76, 16, v52
  v_and_b32 v77, 0xffff0000, v52
  v_lshlrev_b32 v78, 16, v53
  v_and_b32 v79, 0xffff0000, v53
  v_lshlrev_b32 v80, 16, v54
  v_and_b32 v81, 0xffff0000, v54
  v_lshlrev_b32 v82, 16, v55
  v_and_b32 v83, 0xffff0000, v55
  v_lshlrev_b32 v84, 16, v56
  s_add_u32 m0, s45, 8192
  s_add_u32 s68, s68, 196608
  buffer_load_dwordx4 v9, s[12:15], s68 offen lds
  v_and_b32 v85, 0xffff0000, v56
  v_lshlrev_b32 v86, 16, v57
  v_and_b32 v87, 0xffff0000, v57
  v_lshlrev_b32 v88, 16, v58
  v_and_b32 v89, 0xffff0000, v58
  v_lshlrev_b32 v90, 16, v59
  v_and_b32 v91, 0xffff0000, v59
  s_waitcnt lgkmcnt(0)
  s_barrier
  ds_read_b128 v[92:95], v31 offset:0
  ds_read_b128 v[96:99], v31 offset:16
  ds_read_b128 v[100:103], v31 offset:32
  s_add_u32 m0, s45, 12288
  s_add_u32 s68, s68, 196608
  buffer_load_dwordx4 v9, s[12:15], s68 offen lds
  ds_read_b128 v[104:107], v31 offset:48
  ds_read_b128 v[108:111], v31 offset:64
  ds_read_b128 v[112:115], v31 offset:80
  ds_read_b128 v[116:119], v31 offset:96
  ds_read_b128 v[120:123], v31 offset:112
  v_permlane16_swap_b32 v44, v46
  v_permlane16_swap_b32 v45, v47
  v_permlane16_swap_b32 v48, v50
  v_permlane16_swap_b32 v49, v51
  v_permlane16_swap_b32 v52, v54
  v_permlane16_swap_b32 v53, v55
  v_permlane16_swap_b32 v56, v58
  s_add_u32 m0, s45, 16384
  s_add_u32 s68, s66, 1
  s_and_b32 s68, s68, 7
  s_mul_i32 s68, s68, 786432
  buffer_load_dwordx4 v9, s[12:15], s68 offen lds
  v_permlane16_swap_b32 v57, v59
  v_bfe_u32 v36, v0, 3, 1
  v_lshlrev_b32 v28, 9, v36
  v_bfe_u32 v36, v0, 4, 1
  v_lshl_add_u32 v28, v36, 8, v28
  v_lshrrev_b32 v34, 5, v0
  v_lshl_add_u32 v28, v34, 10, v28
  v_lshl_add_u32 v28, v21, 4, v28
  v_and_b32 v29, 31, v0
  v_lshlrev_b32 v29, 4, v29
  v_lshl_add_u32 v29, v34, 12, v29
  v_cvt_f32_u32 v34, v34
  s_add_u32 m0, s45, 20480
  s_add_u32 s68, s68, 196608
  buffer_load_dwordx4 v9, s[12:15], s68 offen lds
  s_add_u32 s53, s45, 151552
  v_add_u32 v32, s53, v1
  v_lshl_add_u32 v33, v22, 5, s53
  v_lshlrev_b32 v36, 14, v36
  v_and_b32 v35, 15, v0
  v_lshl_add_u32 v35, v35, 7, v36
  s_waitcnt lgkmcnt(0)
  v_pk_add_f32 v[92:93], v[92:93], v[108:109]
  v_pk_add_f32 v[94:95], v[94:95], v[110:111]
  v_pk_add_f32 v[96:97], v[96:97], v[112:113]
  v_pk_add_f32 v[98:99], v[98:99], v[114:115]
  v_pk_add_f32 v[100:101], v[100:101], v[116:117]
  s_add_u32 m0, s45, 24576
  s_add_u32 s68, s68, 196608
  buffer_load_dwordx4 v9, s[12:15], s68 offen lds
  v_pk_add_f32 v[102:103], v[102:103], v[118:119]
  v_pk_add_f32 v[104:105], v[104:105], v[120:121]
  v_pk_add_f32 v[106:107], v[106:107], v[122:123]
  v_pk_add_f32 v[92:93], v[92:93], v[100:101]
  v_pk_add_f32 v[94:95], v[94:95], v[102:103]
  v_pk_add_f32 v[96:97], v[96:97], v[104:105]
  v_pk_add_f32 v[98:99], v[98:99], v[106:107]
  v_pk_add_f32 v[92:93], v[92:93], v[96:97]
  v_pk_add_f32 v[94:95], v[94:95], v[98:99]
  v_mul_f32 v92, 0x3a800000, v92
  v_mul_f32 v94, 0x3a800000, v94
  v_mul_f32 v93, 0x3a800000, v93
  v_mul_f32 v95, 0x3a800000, v95
  s_add_u32 m0, s45, 28672
  s_add_u32 s68, s68, 196608
  buffer_load_dwordx4 v9, s[12:15], s68 offen lds
  v_fma_f32 v93, -v92, v92, v93
  v_fma_f32 v95, -v94, v94, v95
  v_max_f32 v93, 0, v93
  v_max_f32 v95, 0, v95
  v_cvt_pk_bf16_f32 v93, v93, v93
  v_cvt_pk_bf16_f32 v95, v95, v95
  v_lshlrev_b32 v93, 16, v93
  v_lshlrev_b32 v95, 16, v95
  v_add_f32 v93, 0x3727c5ac, v93
  v_add_f32 v95, 0x3727c5ac, v95
  v_cvt_pk_bf16_f32 v93, v93, v93
  v_cvt_pk_bf16_f32 v95, v95, v95
  s_add_u32 m0, s45, 32768
  s_add_u32 s68, s66, 0
  s_and_b32 s68, s68, 7
  s_mul_i32 s68, s68, 786432
  s_add_u32 s68, s68, 2048
  buffer_load_dwordx4 v9, s[12:15], s68 offen lds
  v_lshlrev_b32 v93, 16, v93
  v_lshlrev_b32 v95, 16, v95
  v_sqrt_f32 v93, v93
  v_sqrt_f32 v95, v95
  v_cvt_pk_bf16_f32 v92, v92, v92
  v_cvt_pk_bf16_f32 v94, v94, v94
  v_lshlrev_b32 v92, 16, v92
  v_lshlrev_b32 v94, 16, v94
  v_cvt_pk_bf16_f32 v93, v93, v93
  v_cvt_pk_bf16_f32 v95, v95, v95
  v_lshlrev_b32 v93, 16, v93
  v_lshlrev_b32 v95, 16, v95
  s_add_u32 m0, s45, 36864
  s_add_u32 s68, s68, 196608
  buffer_load_dwordx4 v9, s[12:15], s68 offen lds
  v_rcp_f32 v93, v93
  v_rcp_f32 v95, v95
  v_mul_f32 v92, v92, v93
  v_mul_f32 v94, v94, v95
  v_fma_f32 v60, v60, v93, -v92
  v_fma_f32 v61, v61, v93, -v92
  v_fma_f32 v62, v62, v93, -v92
  v_fma_f32 v63, v63, v93, -v92
  v_fma_f32 v64, v64, v93, -v92
  v_fma_f32 v65, v65, v93, -v92
  v_fma_f32 v66, v66, v93, -v92
  v_fma_f32 v67, v67, v93, -v92
  s_add_u32 m0, s45, 40960
  s_add_u32 s68, s68, 196608
  buffer_load_dwordx4 v9, s[12:15], s68 offen lds
  v_fma_f32 v68, v68, v93, -v92
  v_fma_f32 v69, v69, v93, -v92
  v_fma_f32 v70, v70, v93, -v92
  v_fma_f32 v71, v71, v93, -v92
  v_fma_f32 v72, v72, v93, -v92
  v_fma_f32 v73, v73, v93, -v92
  v_fma_f32 v74, v74, v93, -v92
  v_fma_f32 v75, v75, v93, -v92
  v_fma_f32 v76, v76, v95, -v94
  v_fma_f32 v77, v77, v95, -v94
  v_fma_f32 v78, v78, v95, -v94
  v_fma_f32 v79, v79, v95, -v94
  s_add_u32 m0, s45, 45056
  s_add_u32 s68, s68, 196608
  buffer_load_dwordx4 v9, s[12:15], s68 offen lds
  v_fma_f32 v80, v80, v95, -v94
  v_fma_f32 v81, v81, v95, -v94
  v_fma_f32 v82, v82, v95, -v94
  v_fma_f32 v83, v83, v95, -v94
  v_fma_f32 v84, v84, v95, -v94
  v_fma_f32 v85, v85, v95, -v94
  v_fma_f32 v86, v86, v95, -v94
  v_fma_f32 v87, v87, v95, -v94
  v_fma_f32 v88, v88, v95, -v94
  v_fma_f32 v89, v89, v95, -v94
  v_fma_f32 v90, v90, v95, -v94
  v_fma_f32 v91, v91, v95, -v94
  s_add_u32 s52, s34, 0
  buffer_load_dwordx4 v[92:95], v29, s[8:11], s52 offen sc1
  s_add_u32 s52, s34, 8192
  buffer_load_dwordx4 v[96:99], v29, s[8:11], s52 offen sc1
  s_add_u32 s52, s34, 16384
  buffer_load_dwordx4 v[100:103], v29, s[8:11], s52 offen sc1
  s_add_u32 s52, s34, 24576
  buffer_load_dwordx4 v[104:107], v29, s[8:11], s52 offen sc1
  s_add_u32 s52, s34, 32768
  buffer_load_dwordx4 v[108:111], v29, s[8:11], s52 offen sc1
  s_add_u32 s52, s34, 40960
  buffer_load_dwordx4 v[112:115], v29, s[8:11], s52 offen sc1
  s_add_u32 s52, s34, 49152
  buffer_load_dwordx4 v[116:119], v29, s[8:11], s52 offen sc1
  s_add_u32 s52, s34, 57344
  buffer_load_dwordx4 v[120:123], v29, s[8:11], s52 offen sc1
  s_add_u32 m0, s45, 49152
  s_add_u32 s68, s66, 0
  s_and_b32 s68, s68, 7
  s_mul_i32 s68, s68, 786432
  s_add_u32 s68, s68, 4096
  buffer_load_dwordx4 v9, s[12:15], s68 offen lds
  s_bfe_u32 s53, s2, 0x30003
  s_lshl_b32 s43, s53, 1
  s_and_b32 s52, s2, 1
  s_add_u32 s43, s43, s52
  s_and_b32 s79, s2, 4
  s_lshr_b32 s52, s2, 6
  s_add_u32 s79, s79, s52
  s_add_u32 m0, s45, 53248
  s_add_u32 s68, s68, 196608
  buffer_load_dwordx4 v9, s[12:15], s68 offen lds
  s_lshl_b32 s79, s79, 1
  s_add_u32 s67, s79, s53
  s_bfe_u32 s52, s2, 0x10001
  s_add_u32 s79, s79, s52
  s_and_b32 s52, s44, 1
  s_add_u32 s52, s52, s67
  s_add_u32 s62, s52, 0
  s_add_u32 m0, s45, 57344
  s_add_u32 s68, s68, 196608
  buffer_load_dwordx4 v9, s[12:15], s68 offen lds
  s_and_b32 s62, s62, 7
  s_lshl_b32 s62, s62, 12
  s_add_u32 s63, s52, 2
  s_and_b32 s63, s63, 7
  s_lshl_b32 s63, s63, 12
  s_add_u32 s64, s52, 4
  s_and_b32 s64, s64, 7
  s_add_u32 m0, s45, 61440
  s_add_u32 s68, s68, 196608
  buffer_load_dwordx4 v9, s[12:15], s68 offen lds
  s_lshl_b32 s64, s64, 12
  s_add_u32 s65, s52, 6
  s_and_b32 s65, s65, 7
  s_lshl_b32 s65, s65, 12
  s_lshl_b32 s52, s43, 7
  v_add_u32 v10, s52, v10
  s_lshl_b32 s52, s79, 18
  s_add_u32 m0, s45, 65536
  s_add_u32 s68, s66, 1
  s_and_b32 s68, s68, 7
  s_mul_i32 s68, s68, 786432
  s_add_u32 s68, s68, 2048
  buffer_load_dwordx4 v9, s[12:15], s68 offen lds
  s_lshr_b32 s53, s44, 1
  s_lshl_b32 s53, s53, 15
  s_add_u32 s53, s52, s53
  s_add_u32 s78, s53, 7340032
  s_and_b32 s53, s44, 1
  s_lshl_b32 s53, s53, 15
  s_add_u32 s52, s52, s53
  s_add_u32 m0, s45, 69632
  s_add_u32 s68, s68, 196608
  buffer_load_dwordx4 v9, s[12:15], s68 offen lds
  s_lshl_b32 s53, s43, 1
  s_lshr_b32 s57, s44, 1
  s_add_u32 s53, s53, s57
  s_lshl_b32 s76, s53, 7
  s_lshl_b32 s53, s53, 10
  s_add_u32 s47, s52, s53
  s_lshr_b32 s53, s53, 1
  s_add_u32 m0, s45, 73728
  s_add_u32 s68, s68, 196608
  buffer_load_dwordx4 v9, s[12:15], s68 offen lds
  s_lshl_b32 s52, s79, 1
  s_and_b32 s57, s44, 1
  s_add_u32 s52, s52, s57
  s_lshl_b32 s52, s52, 14
  s_add_u32 s52, s52, s53
  s_add_u32 s48, s52, 6291456
  s_lshl_b32 s52, s79, 11
  s_add_u32 m0, s45, 77824
  s_add_u32 s68, s68, 196608
  buffer_load_dwordx4 v9, s[12:15], s68 offen lds
  s_lshl_b32 s53, s43, 7
  s_add_u32 s53, s53, s52
  s_lshl_b32 s57, s44, 28
  s_add_u32 s53, s53, s57
  s_add_u32 s49, s53, 753664
  s_add_u32 s77, s52, 655360
  s_mov_b32 s57, 20000
  s_branch MT2_adaLN_cond__sliding_local_dilated__swiglu_ffn__prompt_kernelt
MT2_adaLN_cond__sliding_local_dilated__swiglu_ffn__prompt_kernel:
  s_add_u32 s52, s34, 0
  buffer_load_dwordx4 v[92:95], v29, s[8:11], s52 offen sc1
  s_add_u32 s52, s34, 8192
  buffer_load_dwordx4 v[96:99], v29, s[8:11], s52 offen sc1
  s_add_u32 s52, s34, 16384
  buffer_load_dwordx4 v[100:103], v29, s[8:11], s52 offen sc1
  s_add_u32 s52, s34, 24576
  buffer_load_dwordx4 v[104:107], v29, s[8:11], s52 offen sc1
  s_add_u32 s52, s34, 32768
  buffer_load_dwordx4 v[108:111], v29, s[8:11], s52 offen sc1
  s_add_u32 s52, s34, 40960
  buffer_load_dwordx4 v[112:115], v29, s[8:11], s52 offen sc1
  s_add_u32 s52, s34, 49152
  buffer_load_dwordx4 v[116:119], v29, s[8:11], s52 offen sc1
  s_add_u32 s52, s34, 57344
  buffer_load_dwordx4 v[120:123], v29, s[8:11], s52 offen sc1
  s_waitcnt vmcnt(0)
MT2_adaLN_cond__sliding_local_dilated__swiglu_ffn__prompt_kernelt:
  s_waitcnt vmcnt(15)
  v_xor_b32 v92, s55, v92
  v_xor_b32 v93, s56, v93
  v_xor_b32 v94, s69, v94
  v_xor_b32 v95, s54, v95
  v_or3_b32 v36, v92, v93, 0
  v_or3_b32 v36, v94, v95, v36
  s_waitcnt vmcnt(14)
  v_xor_b32 v96, s55, v96
  v_xor_b32 v97, s56, v97
  v_xor_b32 v98, s69, v98
  v_xor_b32 v99, s54, v99
  v_or3_b32 v36, v96, v97, v36
  v_or3_b32 v36, v98, v99, v36
  s_waitcnt vmcnt(13)
  v_xor_b32 v100, s55, v100
  v_xor_b32 v101, s56, v101
  v_xor_b32 v102, s69, v102
  v_xor_b32 v103, s54, v103
  v_or3_b32 v36, v100, v101, v36
  v_or3_b32 v36, v102, v103, v36
  s_waitcnt vmcnt(12)
  v_xor_b32 v104, s55, v104
  v_xor_b32 v105, s56, v105
  v_xor_b32 v106, s69, v106
  v_xor_b32 v107, s54, v107
  v_or3_b32 v36, v104, v105, v36
  v_or3_b32 v36, v106, v107, v36
  s_waitcnt vmcnt(11)
  v_xor_b32 v108, s55, v108
  v_xor_b32 v109, s56, v109
  v_xor_b32 v110, s69, v110
  v_xor_b32 v111, s54, v111
  v_or3_b32 v36, v108, v109, v36
  v_or3_b32 v36, v110, v111, v36
  s_waitcnt vmcnt(10)
  v_xor_b32 v112, s55, v112
  v_xor_b32 v113, s56, v113
  v_xor_b32 v114, s69, v114
  v_xor_b32 v115, s54, v115
  v_or3_b32 v36, v112, v113, v36
  v_or3_b32 v36, v114, v115, v36
  s_waitcnt vmcnt(9)
  v_xor_b32 v116, s55, v116
  v_xor_b32 v117, s56, v117
  v_xor_b32 v118, s69, v118
  v_xor_b32 v119, s54, v119
  v_or3_b32 v36, v116, v117, v36
  v_or3_b32 v36, v118, v119, v36
  s_waitcnt vmcnt(8)
  v_xor_b32 v120, s55, v120
  v_xor_b32 v121, s56, v121
  v_xor_b32 v122, s69, v122
  v_xor_b32 v123, s54, v123
  v_or3_b32 v36, v120, v121, v36
  v_or3_b32 v36, v122, v123, v36
  v_and_b32 v36, 0xff, v36
  v_cmp_ne_u32 vcc, 0, v36
  s_sub_u32 s57, s57, 1
  s_cmp_eq_u32 s57, 0
  s_cbranch_scc1 MT2_adaLN_cond__sliding_local_dilated__swiglu_ffn__prompt_kernelx
  s_nop 1
  s_cbranch_vccnz MT2_adaLN_cond__sliding_local_dilated__swiglu_ffn__prompt_kernel
MT2_adaLN_cond__sliding_local_dilated__swiglu_ffn__prompt_kernelx:
  s_waitcnt vmcnt(14)
  v_pk_add_f32 v[92:93], v[92:93], v[96:97]
  v_pk_add_f32 v[94:95], v[94:95], v[98:99]
  s_waitcnt vmcnt(13)
  v_pk_add_f32 v[92:93], v[92:93], v[100:101]
  v_pk_add_f32 v[94:95], v[94:95], v[102:103]
  s_waitcnt vmcnt(12)
  v_pk_add_f32 v[92:93], v[92:93], v[104:105]
  v_pk_add_f32 v[94:95], v[94:95], v[106:107]
  s_waitcnt vmcnt(11)
  v_pk_add_f32 v[92:93], v[92:93], v[108:109]
HOP0:
  s_cbranch_execz HOP4
  v_pk_add_f32 v[94:95], v[94:95], v[110:111]
  s_waitcnt vmcnt(10)
  v_pk_add_f32 v[92:93], v[92:93], v[112:113]
  v_pk_add_f32 v[94:95], v[94:95], v[114:115]
  s_waitcnt vmcnt(9)
  v_pk_add_f32 v[92:93], v[92:93], v[116:117]
  v_pk_add_f32 v[94:95], v[94:95], v[118:119]
  s_waitcnt vmcnt(8)
  v_pk_add_f32 v[92:93], v[92:93], v[120:121]
  v_pk_add_f32 v[94:95], v[94:95], v[122:123]
  v_cvt_pk_bf16_f32 v96, v92, v93
  v_cvt_pk_bf16_f32 v97, v94, v95
  v_lshlrev_b32 v92, 16, v96
  v_and_b32 v93, 0xffff0000, v96
  v_lshlrev_b32 v94, 16, v97
  v_and_b32 v95, 0xffff0000, v97
  v_add_f32 v92, v34, v92
  v_add_f32 v93, v34, v93
  v_add_f32 v94, v34, v94
  v_add_f32 v95, v34, v95
  v_cvt_pk_bf16_f32 v96, v92, v93
  v_cvt_pk_bf16_f32 v97, v94, v95
  v_lshlrev_b32 v92, 16, v96
  v_and_b32 v93, 0xffff0000, v96
  v_lshlrev_b32 v94, 16, v97
  v_and_b32 v95, 0xffff0000, v97
  ds_write_b128 v32, v[92:95]
  ds_read_b128 v[92:95], v33 offset:512
  ds_read_b128 v[108:111], v33 offset:0
  ds_read_b128 v[96:99], v33 offset:528
  ds_read_b128 v[112:115], v33 offset:16
  ds_read_b128 v[100:103], v33 offset:768
  ds_read_b128 v[116:119], v33 offset:256
  ds_read_b128 v[104:107], v33 offset:784
  ds_read_b128 v[120:123], v33 offset:272
  s_waitcnt lgkmcnt(4)
  v_pk_fma_f32 v[60:61], v[60:61], v[92:93], v[108:109]
  v_pk_fma_f32 v[62:63], v[62:63], v[94:95], v[110:111]
  v_pk_fma_f32 v[64:65], v[64:65], v[96:97], v[112:113]
  v_pk_fma_f32 v[66:67], v[66:67], v[98:99], v[114:115]
  v_pk_fma_f32 v[76:77], v[76:77], v[92:93], v[108:109]
  v_pk_fma_f32 v[78:79], v[78:79], v[94:95], v[110:111]
  v_pk_fma_f32 v[80:81], v[80:81], v[96:97], v[112:113]
  v_pk_fma_f32 v[82:83], v[82:83], v[98:99], v[114:115]
  v_cvt_pk_bf16_f32 v60, v60, v61
  v_cvt_pk_bf16_f32 v61, v62, v63
  v_cvt_pk_bf16_f32 v62, v64, v65
  v_cvt_pk_bf16_f32 v63, v66, v67
  v_cvt_pk_bf16_f32 v76, v76, v77
  v_cvt_pk_bf16_f32 v77, v78, v79
  v_cvt_pk_bf16_f32 v78, v80, v81
  v_cvt_pk_bf16_f32 v79, v82, v83
  v_permlane16_swap_b32 v60, v62
  v_permlane16_swap_b32 v61, v63
  buffer_store_dwordx4 v[60:63], v28, s[8:11], s38 offen offset:0 sc1
  v_permlane16_swap_b32 v76, v78
  v_permlane16_swap_b32 v77, v79
  buffer_store_dwordx4 v[76:79], v28, s[8:11], s38 offen offset:128 sc1
  s_waitcnt lgkmcnt(0)
  v_pk_fma_f32 v[68:69], v[68:69], v[100:101], v[116:117]
  v_pk_fma_f32 v[70:71], v[70:71], v[102:103], v[118:119]
  v_pk_fma_f32 v[72:73], v[72:73], v[104:105], v[120:121]
  v_pk_fma_f32 v[74:75], v[74:75], v[106:107], v[122:123]
  v_pk_fma_f32 v[84:85], v[84:85], v[100:101], v[116:117]
  v_pk_fma_f32 v[86:87], v[86:87], v[102:103], v[118:119]
  v_pk_fma_f32 v[88:89], v[88:89], v[104:105], v[120:121]
  v_pk_fma_f32 v[90:91], v[90:91], v[106:107], v[122:123]
  v_cvt_pk_bf16_f32 v68, v68, v69
  v_cvt_pk_bf16_f32 v69, v70, v71
  v_cvt_pk_bf16_f32 v70, v72, v73
  v_cvt_pk_bf16_f32 v71, v74, v75
  v_cvt_pk_bf16_f32 v84, v84, v85
  v_cvt_pk_bf16_f32 v85, v86, v87
  v_cvt_pk_bf16_f32 v86, v88, v89
  v_cvt_pk_bf16_f32 v87, v90, v91
  v_permlane16_swap_b32 v68, v70
  v_permlane16_swap_b32 v69, v71
  buffer_store_dwordx4 v[68:71], v28, s[8:11], s38 offen offset:2048 sc1
  v_permlane16_swap_b32 v84, v86
  v_permlane16_swap_b32 v85, v87
  buffer_store_dwordx4 v[84:87], v28, s[8:11], s38 offen offset:2176 sc1
  buffer_store_dwordx4 v[44:47], v28, s[8:11], s39 offen offset:0 sc1
  buffer_store_dwordx4 v[48:51], v28, s[8:11], s39 offen offset:2048 sc1
  buffer_store_dwordx4 v[52:55], v28, s[8:11], s39 offen offset:128 sc1
  buffer_store_dwordx4 v[56:59], v28, s[8:11], s39 offen offset:2176 sc1
  s_add_u32 m0, s45, 81920
  s_add_u32 s68, s66, 1
  s_and_b32 s68, s68, 7
  s_mul_i32 s68, s68, 786432
  s_add_u32 s68, s68, 4096
  buffer_load_dwordx4 v9, s[12:15], s68 offen lds
  s_waitcnt vmcnt(48)
  v_lshlrev_b32 v15, 16, v23
  v_mul_f32 v16, 0xbfb8aa3b, v15
  v_exp_f32 v16, v16
  v_lshrrev_b32 v21, 5, v0
  s_add_u32 m0, s45, 86016
  s_add_u32 s68, s68, 196608
  buffer_load_dwordx4 v9, s[12:15], s68 offen lds
  v_add_f32 v16, 1.0, v16
  v_rcp_f32 v16, v16
  v_lshlrev_b32 v21, 6, v21
  v_mul_f32 v15, v15, v16
  v_cvt_pk_bf16_f32 v16, v15, v15
  s_add_u32 m0, s45, 90112
  s_add_u32 s68, s68, 196608
  buffer_load_dwordx4 v9, s[12:15], s68 offen lds
  v_bfe_u32 v15, v0, 2, 2
  v_lshl_add_u32 v21, v15, 4, v21
  v_bfe_u32 v15, v0, 4, 1
  v_lshl_add_u32 v21, v15, 3, v21
  v_and_b32 v15, 3, v0
  s_add_u32 m0, s45, 94208
  s_add_u32 s68, s68, 196608
  buffer_load_dwordx4 v9, s[12:15], s68 offen lds
  v_lshl_add_u32 v21, v15, 1, v21
  s_lshl_b32 s53, s44, 7
  s_add_u32 s53, s53, 160768
  v_add_u32 v21, s53, v21
  v_add_u32 v15, s46, v0
  s_waitcnt vmcnt(8)
  s_barrier
  s_mov_b64 exec, 1
  buffer_store_dword v15, v0, s[8:11], s75 offen offset:0 sc1
  s_mov_b64 exec, -1
  s_waitcnt vmcnt(33) lgkmcnt(0)
  s_barrier
  s_add_u32 m0, s45, 98304
  s_add_u32 s68, s66, 2
  s_and_b32 s68, s68, 7
  s_mul_i32 s68, s68, 786432
  buffer_load_dwordx4 v9, s[12:15], s68 offen lds
  ds_read_b64_tr_b16 a[0:1], v3 offset:0
  ds_read_b64_tr_b16 a[2:3], v3 offset:2048
  s_add_u32 m0, s45, 102400
  s_add_u32 s68, s68, 196608
  buffer_load_dwordx4 v9, s[12:15], s68 offen lds
  ds_read_b64_tr_b16 a[12:13], v3 offset:4096
  ds_read_b64_tr_b16 a[14:15], v3 offset:6144
  s_add_u32 m0, s45, 106496
  s_add_u32 s68, s68, 196608
  buffer_load_dwordx4 v9, s[12:15], s68 offen lds
  ds_read_b64_tr_b16 a[24:25], v3 offset:8192
  ds_read_b64_tr_b16 a[26:27], v3 offset:10240
  s_add_u32 m0, s45, 110592
  s_add_u32 s68, s68, 196608
  buffer_load_dwordx4 v9, s[12:15], s68 offen lds
  ds_read_b64_tr_b16 a[36:37], v3 offset:12288
  ds_read_b64_tr_b16 a[38:39], v3 offset:14336
  s_add_u32 m0, s45, 114688
  s_add_u32 s68, s66, 3
  s_and_b32 s68, s68, 7
  s_mul_i32 s68, s68, 786432
  buffer_load_dwordx4 v9, s[12:15], s68 offen lds
  ds_read_b64_tr_b16 a[48:49], v3 offset:16384
  ds_read_b64_tr_b16 a[50:51], v3 offset:18432
  s_add_u32 m0, s45, 118784
  s_add_u32 s68, s68, 196608
  buffer_load_dwordx4 v9, s[12:15], s68 offen lds
  ds_read_b64_tr_b16 a[60:61], v3 offset:20480
  ds_read_b64_tr_b16 a[62:63], v3 offset:22528
  s_add_u32 m0, s45, 122880
  s_add_u32 s68, s68, 196608
  buffer_load_dwordx4 v9, s[12:15], s68 offen lds
  ds_read_b64_tr_b16 a[72:73], v3 offset:24576
  ds_read_b64_tr_b16 a[74:75], v3 offset:26624
  s_add_u32 m0, s45, 126976
  s_add_u32 s68, s68, 196608
  buffer_load_dwordx4 v9, s[12:15], s68 offen lds
  ds_read_b64_tr_b16 a[84:85], v3 offset:28672
  ds_read_b64_tr_b16 a[86:87], v3 offset:30720
  s_waitcnt vmcnt(25) lgkmcnt(0)
  s_barrier
  s_add_u32 m0, s45, 0
  s_add_u32 s68, s66, 2
  s_and_b32 s68, s68, 7
  s_mul_i32 s68, s68, 786432
  s_add_u32 s68, s68, 2048
  buffer_load_dwordx4 v9, s[12:15], s68 offen lds
  ds_read_b64_tr_b16 a[4:5], v4 offset:32768
  ds_read_b64_tr_b16 a[6:7], v4 offset:34816
  s_add_u32 m0, s45, 4096
  s_add_u32 s68, s68, 196608
  buffer_load_dwordx4 v9, s[12:15], s68 offen lds
  ds_read_b64_tr_b16 a[8:9], v5 offset:32768
  ds_read_b64_tr_b16 a[10:11], v5 offset:34816
  s_add_u32 m0, s45, 8192
  s_add_u32 s68, s68, 196608
  buffer_load_dwordx4 v9, s[12:15], s68 offen lds
  ds_read_b64_tr_b16 a[16:17], v4 offset:36864
  ds_read_b64_tr_b16 a[18:19], v4 offset:38912
  s_add_u32 m0, s45, 12288
  s_add_u32 s68, s68, 196608
  buffer_load_dwordx4 v9, s[12:15], s68 offen lds
  ds_read_b64_tr_b16 a[20:21], v5 offset:36864
  ds_read_b64_tr_b16 a[22:23], v5 offset:38912
  s_add_u32 m0, s45, 16384
  s_add_u32 s68, s66, 2
  s_and_b32 s68, s68, 7
  s_mul_i32 s68, s68, 786432
  s_add_u32 s68, s68, 4096
  buffer_load_dwordx4 v9, s[12:15], s68 offen lds
  ds_read_b64_tr_b16 a[28:29], v4 offset:40960
  ds_read_b64_tr_b16 a[30:31], v4 offset:43008
  s_add_u32 m0, s45, 20480
  s_add_u32 s68, s68, 196608
  buffer_load_dwordx4 v9, s[12:15], s68 offen lds
  ds_read_b64_tr_b16 a[32:33], v5 offset:40960
  ds_read_b64_tr_b16 a[34:35], v5 offset:43008
  s_add_u32 m0, s45, 24576
  s_add_u32 s68, s68, 196608
  buffer_load_dwordx4 v9, s[12:15], s68 offen lds
  ds_read_b64_tr_b16 a[40:41], v4 offset:45056
  ds_read_b64_tr_b16 a[42:43], v4 offset:47104
  s_add_u32 m0, s45, 28672
  s_add_u32 s68, s68, 196608
  buffer_load_dwordx4 v9, s[12:15], s68 offen lds
  ds_read_b64_tr_b16 a[44:45], v5 offset:45056
  ds_read_b64_tr_b16 a[46:47], v5 offset:47104
  s_waitcnt vmcnt(17) lgkmcnt(0)
  s_barrier
  s_add_u32 m0, s45, 32768
  s_add_u32 s68, s66, 3
  s_and_b32 s68, s68, 7
  s_mul_i32 s68, s68, 786432
  s_add_u32 s68, s68, 2048
  buffer_load_dwordx4 v9, s[12:15], s68 offen lds
  ds_read_b64_tr_b16 a[52:53], v7 offset:0
  ds_read_b64_tr_b16 a[54:55], v7 offset:2048
  s_add_u32 m0, s45, 36864
  s_add_u32 s68, s68, 196608
  buffer_load_dwordx4 v9, s[12:15], s68 offen lds
  ds_read_b64_tr_b16 a[56:57], v8 offset:0
  ds_read_b64_tr_b16 a[58:59], v8 offset:2048
  s_add_u32 m0, s45, 40960
  s_add_u32 s68, s68, 196608
  buffer_load_dwordx4 v9, s[12:15], s68 offen lds
  ds_read_b64_tr_b16 a[64:65], v7 offset:4096
  ds_read_b64_tr_b16 a[66:67], v7 offset:6144
  s_add_u32 m0, s45, 45056
  s_add_u32 s68, s68, 196608
  buffer_load_dwordx4 v9, s[12:15], s68 offen lds
  ds_read_b64_tr_b16 a[68:69], v8 offset:4096
  ds_read_b64_tr_b16 a[70:71], v8 offset:6144
  s_add_u32 m0, s45, 49152
  s_add_u32 s68, s66, 3
  s_and_b32 s68, s68, 7
  s_mul_i32 s68, s68, 786432
  s_add_u32 s68, s68, 4096
  buffer_load_dwordx4 v9, s[12:15], s68 offen lds
  ds_read_b64_tr_b16 a[76:77], v7 offset:8192
  ds_read_b64_tr_b16 a[78:79], v7 offset:10240
  s_add_u32 m0, s45, 53248
  s_add_u32 s68, s68, 196608
  buffer_load_dwordx4 v9, s[12:15], s68 offen lds
  ds_read_b64_tr_b16 a[80:81], v8 offset:8192
  ds_read_b64_tr_b16 a[82:83], v8 offset:10240
  s_add_u32 m0, s45, 57344
  s_add_u32 s68, s68, 196608
  buffer_load_dwordx4 v9, s[12:15], s68 offen lds
  ds_read_b64_tr_b16 a[88:89], v7 offset:12288
  ds_read_b64_tr_b16 a[90:91], v7 offset:14336
  s_add_u32 m0, s45, 61440
  s_add_u32 s68, s68, 196608
  buffer_load_dwordx4 v9, s[12:15], s68 offen lds
  ds_read_b64_tr_b16 a[92:93], v8 offset:12288
  ds_read_b64_tr_b16 a[94:95], v8 offset:14336
  s_lshl_b32 s57, s44, 28
  buffer_load_dword v36, v14, s[8:11], s57 offen sc1
  s_waitcnt vmcnt(17) lgkmcnt(0)
  s_barrier
  s_add_u32 m0, s45, 65536
  s_add_u32 s68, s66, 4
  s_and_b32 s68, s68, 7
  s_mul_i32 s68, s68, 786432
  buffer_load_dwordx4 v9, s[12:15], s68 offen lds
  ds_read_b64_tr_b16 a[96:97], v6 offset:32768
  ds_read_b64_tr_b16 a[98:99], v6 offset:34816
  s_add_u32 m0, s45, 69632
  s_add_u32 s68, s68, 196608
  buffer_load_dwordx4 v9, s[12:15], s68 offen lds
  ds_read_b64_tr_b16 a[108:109], v6 offset:36864
  ds_read_b64_tr_b16 a[110:111], v6 offset:38912
  s_add_u32 m0, s45, 73728
  s_add_u32 s68, s68, 196608
  buffer_load_dwordx4 v9, s[12:15], s68 offen lds
  ds_read_b64_tr_b16 a[120:121], v6 offset:40960
  ds_read_b64_tr_b16 a[122:123], v6 offset:43008
  s_add_u32 m0, s45, 77824
  s_add_u32 s68, s68, 196608
  buffer_load_dwordx4 v9, s[12:15], s68 offen lds
  ds_read_b64_tr_b16 a[132:133], v6 offset:45056
  ds_read_b64_tr_b16 a[134:135], v6 offset:47104
  s_add_u32 m0, s45, 81920
  s_add_u32 s68, s66, 5
  s_and_b32 s68, s68, 7
  s_mul_i32 s68, s68, 786432
  buffer_load_dwordx4 v9, s[12:15], s68 offen lds
  ds_read_b64_tr_b16 a[144:145], v6 offset:49152
  ds_read_b64_tr_b16 a[146:147], v6 offset:51200
  s_add_u32 m0, s45, 86016
  s_add_u32 s68, s68, 196608
  buffer_load_dwordx4 v9, s[12:15], s68 offen lds
  ds_read_b64_tr_b16 a[156:157], v6 offset:53248
  ds_read_b64_tr_b16 a[158:159], v6 offset:55296
  s_add_u32 m0, s45, 90112
  s_add_u32 s68, s68, 196608
  buffer_load_dwordx4 v9, s[12:15], s68 offen lds
  ds_read_b64_tr_b16 a[168:169], v6 offset:57344
  ds_read_b64_tr_b16 a[170:171], v6 offset:59392
  s_add_u32 m0, s45, 94208
  s_add_u32 s68, s68, 196608
  buffer_load_dwordx4 v9, s[12:15], s68 offen lds
  ds_read_b64_tr_b16 a[180:181], v6 offset:61440
  ds_read_b64_tr_b16 a[182:183], v6 offset:63488
  s_waitcnt vmcnt(17) lgkmcnt(0)
  s_barrier
  ds_read_b64_tr_b16 a[100:101], v4 offset:0
  ds_read_b64_tr_b16 a[102:103], v4 offset:2048
  ds_read_b64_tr_b16 a[104:105], v5 offset:0
  ds_read_b64_tr_b16 a[106:107], v5 offset:2048
  ds_read_b64_tr_b16 a[112:113], v4 offset:4096
  ds_read_b64_tr_b16 a[114:115], v4 offset:6144
  ds_read_b64_tr_b16 a[116:117], v5 offset:4096
  ds_read_b64_tr_b16 a[118:119], v5 offset:6144
  ds_read_b64_tr_b16 a[124:125], v4 offset:8192
  ds_read_b64_tr_b16 a[126:127], v4 offset:10240
  ds_read_b64_tr_b16 a[128:129], v5 offset:8192
  ds_read_b64_tr_b16 a[130:131], v5 offset:10240
  ds_read_b64_tr_b16 a[136:137], v4 offset:12288
  ds_read_b64_tr_b16 a[138:139], v4 offset:14336
  ds_read_b64_tr_b16 a[140:141], v5 offset:12288
  ds_read_b64_tr_b16 a[142:143], v5 offset:14336
  s_waitcnt vmcnt(8)
  s_cmp_lg_u32 s44, 0
  s_cbranch_scc1 PL3_adaLN_cond__sliding_local_dilated__swiglu_ffn__prompt_kernelx
  v_cmp_ne_u32 vcc, s46, v36
  s_nop 4
  s_cbranch_vccz PL3_adaLN_cond__sliding_local_dilated__swiglu_ffn__prompt_kernelx
  s_mov_b32 s57, 60000
PL3_adaLN_cond__sliding_local_dilated__swiglu_ffn__prompt_kernel:
  buffer_load_dword v36, v14, s[8:11], 0 offen sc1
  s_sub_u32 s57, s57, 1
  s_cmp_eq_u32 s57, 0
  s_waitcnt vmcnt(0)
  s_cbranch_scc1 PL3_adaLN_cond__sliding_local_dilated__swiglu_ffn__prompt_kernelx
  v_cmp_ne_u32 vcc, s46, v36
  s_nop 4
  s_cbranch_vccnz PL3_adaLN_cond__sliding_local_dilated__swiglu_ffn__prompt_kernel
PL3_adaLN_cond__sliding_local_dilated__swiglu_ffn__prompt_kernelx:
  s_barrier
  s_add_u32 m0, s70, 98304
  s_add_u32 s69, s58, 32768
  buffer_load_dwordx4 v12, s[8:11], s69 offen offset:0 sc1 lds
  buffer_load_dwordx4 v12, s[8:11], s69 offen offset:1024 sc1 lds
  buffer_load_dwordx4 v12, s[8:11], s69 offen offset:2048 sc1 lds
  buffer_load_dwordx4 v12, s[8:11], s69 offen offset:3072 sc1 lds
  s_add_u32 m0, s71, 131072
  s_add_u32 s69, s58, s72
  buffer_load_dwordx4 v1, s[8:11], s69 offen offset:0 sc1 lds
  buffer_load_dwordx4 v1, s[8:11], s69 offen offset:1024 sc1 lds
  s_add_u32 m0, s70, 114688
  s_add_u32 s69, s59, 32768
  buffer_load_dwordx4 v12, s[8:11], s69 offen offset:0 sc1 lds
  buffer_load_dwordx4 v12, s[8:11], s69 offen offset:1024 sc1 lds
  buffer_load_dwordx4 v12, s[8:11], s69 offen offset:2048 sc1 lds
  buffer_load_dwordx4 v12, s[8:11], s69 offen offset:3072 sc1 lds
  s_add_u32 m0, s71, 139264
  s_add_u32 s69, s59, s72
  buffer_load_dwordx4 v1, s[8:11], s69 offen offset:0 sc1 lds
  buffer_load_dwordx4 v1, s[8:11], s69 offen offset:1024 sc1 lds
  s_waitcnt vmcnt(21) lgkmcnt(0)
  s_barrier
  s_add_u32 m0, s45, 0
  s_add_u32 s68, s66, 4
  s_and_b32 s68, s68, 7
  s_mul_i32 s68, s68, 786432
  s_add_u32 s68, s68, 2048
  buffer_load_dwordx4 v9, s[12:15], s68 offen lds
  ds_read_b64_tr_b16 a[148:149], v4 offset:32768
  ds_read_b64_tr_b16 a[150:151], v4 offset:34816
  s_add_u32 m0, s45, 4096
  s_add_u32 s68, s68, 196608
  buffer_load_dwordx4 v9, s[12:15], s68 offen lds
  ds_read_b64_tr_b16 a[152:153], v5 offset:32768
  ds_read_b64_tr_b16 a[154:155], v5 offset:34816
  s_add_u32 m0, s45, 8192
  s_add_u32 s68, s68, 196608
  buffer_load_dwordx4 v9, s[12:15], s68 offen lds
  ds_read_b64_tr_b16 a[160:161], v4 offset:36864
  ds_read_b64_tr_b16 a[162:163], v4 offset:38912
  s_add_u32 m0, s45, 12288
  s_add_u32 s68, s68, 196608
  buffer_load_dwordx4 v9, s[12:15], s68 offen lds
  ds_read_b64_tr_b16 a[164:165], v5 offset:36864
  ds_read_b64_tr_b16 a[166:167], v5 offset:38912
  s_add_u32 m0, s45, 16384
  s_add_u32 s68, s66, 4
  s_and_b32 s68, s68, 7
  s_mul_i32 s68, s68, 786432
  s_add_u32 s68, s68, 4096
  buffer_load_dwordx4 v9, s[12:15], s68 offen lds
  ds_read_b64_tr_b16 a[172:173], v4 offset:40960
  ds_read_b64_tr_b16 a[174:175], v4 offset:43008
  s_add_u32 m0, s45, 20480
  s_add_u32 s68, s68, 196608
  buffer_load_dwordx4 v9, s[12:15], s68 offen lds
  ds_read_b64_tr_b16 a[176:177], v5 offset:40960
  ds_read_b64_tr_b16 a[178:179], v5 offset:43008
  s_add_u32 m0, s45, 24576
  s_add_u32 s68, s68, 196608
  buffer_load_dwordx4 v9, s[12:15], s68 offen lds
  ds_read_b64_tr_b16 a[184:185], v4 offset:45056
  ds_read_b64_tr_b16 a[186:187], v4 offset:47104
  s_add_u32 m0, s45, 28672
  s_add_u32 s68, s68, 196608
  buffer_load_dwordx4 v9, s[12:15], s68 offen lds
  ds_read_b64_tr_b16 a[188:189], v5 offset:45056
  ds_read_b64_tr_b16 a[190:191], v5 offset:47104
  s_waitcnt vmcnt(14) lgkmcnt(0)
  s_barrier
  ds_read_b128 v[76:79], v2 offset:32768
  ds_read_b128 v[80:83], v2 offset:33792
  ds_read_b128 v[84:87], v2 offset:40960
  ds_read_b128 v[88:91], v2 offset:41984
  ds_read_b128 v[92:95], v13 offset:0
  ds_read_b128 v[96:99], v13 offset:1024
  ds_read_b128 v[100:103], v2 offset:34816
  ds_read_b128 v[104:107], v2 offset:35840
  s_waitcnt lgkmcnt(2)
  v_mfma_f32_16x16x32_bf16 v[28:31], a[0:3], v[76:79], 0
  ds_read_b64_tr_b16 a[192:193], v6 offset:0
  s_add_u32 m0, s45, 32768
  s_add_u32 s68, s66, 5
  s_and_b32 s68, s68, 7
  s_mul_i32 s68, s68, 786432
  s_add_u32 s68, s68, 2048
  v_mfma_f32_16x16x32_bf16 v[28:31], a[12:15], v[80:83], v[28:31]
  ds_read_b128 v[108:111], v2 offset:43008
  buffer_load_dwordx4 v9, s[12:15], s68 offen lds
  v_mfma_f32_16x16x32_bf16 v[32:35], a[12:15], v[88:91], 0
  ds_read_b64_tr_b16 a[194:195], v6 offset:2048
  v_mfma_f32_16x16x32_bf16 v[32:35], a[0:3], v[84:87], v[32:35]
  ds_read_b64_tr_b16 a[204:205], v6 offset:4096
  v_mfma_f32_16x16x32_bf16 v[40:43], a[4:7], v[84:87], 0
  ds_read_b128 v[112:115], v2 offset:44032
  s_add_u32 m0, s45, 36864
  s_add_u32 s68, s68, 196608
  v_mfma_f32_16x16x32_bf16 v[40:43], a[16:19], v[88:91], v[40:43]
  ds_read_b64_tr_b16 a[206:207], v6 offset:6144
  buffer_load_dwordx4 v9, s[12:15], s68 offen lds
  v_mfma_f32_16x16x32_bf16 v[36:39], a[16:19], v[80:83], 0
  ds_read_b128 v[116:119], v13 offset:2048
  v_mfma_f32_16x16x32_bf16 v[36:39], a[4:7], v[76:79], v[36:39]
  ds_read_b64_tr_b16 a[216:217], v6 offset:8192
  v_mfma_f32_16x16x32_bf16 v[44:47], a[8:11], v[76:79], 0
  ds_read_b64_tr_b16 a[218:219], v6 offset:10240
  s_add_u32 m0, s45, 40960
  s_add_u32 s68, s68, 196608
  v_mfma_f32_16x16x32_bf16 v[44:47], a[20:23], v[80:83], v[44:47]
  ds_read_b128 v[120:123], v13 offset:3072
  buffer_load_dwordx4 v9, s[12:15], s68 offen lds
  v_mfma_f32_16x16x32_bf16 v[48:51], a[20:23], v[88:91], 0
  ds_read_b64_tr_b16 a[228:229], v6 offset:12288
  v_mfma_f32_16x16x32_bf16 v[48:51], a[8:11], v[84:87], v[48:51]
  ds_read_b64_tr_b16 a[230:231], v6 offset:14336
  v_mfma_f32_16x16x32_bf16 v[68:71], a[8:11], v[92:95], 0
  ds_read_b128 v[76:79], v2 offset:36864
  s_add_u32 m0, s45, 45056
  s_add_u32 s68, s68, 196608
  v_mfma_f32_16x16x32_bf16 v[68:71], a[20:23], v[96:99], v[68:71]
  ds_read_b64_tr_b16 a[240:241], v6 offset:16384
  buffer_load_dwordx4 v9, s[12:15], s68 offen lds
  v_mfma_f32_16x16x32_bf16 v[60:63], a[16:19], v[96:99], 0
  ds_read_b128 v[80:83], v2 offset:37888
  v_mfma_f32_16x16x32_bf16 v[60:63], a[4:7], v[92:95], v[60:63]
  s_waitcnt lgkmcnt(5)
  ds_read_b64_tr_b16 a[242:243], v6 offset:18432
  v_mfma_f32_16x16x32_bf16 v[28:31], a[24:27], v[100:103], v[28:31]
  ds_read_b64_tr_b16 v[124:125], v6 offset:20480
  s_add_u32 m0, s45, 49152
  s_add_u32 s68, s66, 5
  s_and_b32 s68, s68, 7
  s_mul_i32 s68, s68, 786432
  s_add_u32 s68, s68, 4096
  v_mfma_f32_16x16x32_bf16 v[28:31], a[36:39], v[104:107], v[28:31]
  ds_read_b128 v[88:91], v2 offset:45056
  buffer_load_dwordx4 v9, s[12:15], s68 offen lds
  v_mfma_f32_16x16x32_bf16 v[32:35], a[36:39], v[112:115], v[32:35]
  ds_read_b64_tr_b16 v[126:127], v6 offset:22528
  v_mfma_f32_16x16x32_bf16 v[32:35], a[24:27], v[108:111], v[32:35]
  ds_read_b64_tr_b16 v[136:137], v6 offset:24576
  v_mfma_f32_16x16x32_bf16 v[40:43], a[28:31], v[108:111], v[40:43]
  ds_read_b128 v[84:87], v2 offset:46080
  s_add_u32 m0, s45, 53248
  s_add_u32 s68, s68, 196608
  v_mfma_f32_16x16x32_bf16 v[40:43], a[40:43], v[112:115], v[40:43]
  ds_read_b64_tr_b16 v[138:139], v6 offset:26624
  buffer_load_dwordx4 v9, s[12:15], s68 offen lds
  v_mfma_f32_16x16x32_bf16 v[36:39], a[40:43], v[104:107], v[36:39]
  ds_read_b128 v[96:99], v13 offset:4096
  v_mfma_f32_16x16x32_bf16 v[36:39], a[28:31], v[100:103], v[36:39]
  ds_read_b64_tr_b16 v[148:149], v6 offset:28672
  v_mfma_f32_16x16x32_bf16 v[44:47], a[32:35], v[100:103], v[44:47]
  ds_read_b64_tr_b16 v[150:151], v6 offset:30720
  v_mfma_f32_16x16x32_bf16 v[44:47], a[44:47], v[104:107], v[44:47]
  ds_read_b128 v[92:95], v13 offset:5120
  s_add_u32 m0, s45, 57344
  s_add_u32 s68, s68, 196608
  v_mfma_f32_16x16x32_bf16 v[48:51], a[44:47], v[112:115], v[48:51]
  buffer_load_dwordx4 v9, s[12:15], s68 offen lds
  v_mfma_f32_16x16x32_bf16 v[48:51], a[32:35], v[108:111], v[48:51]
  s_add_u32 m0, s45, 61440
  s_add_u32 s68, s68, 196608
  v_mfma_f32_16x16x32_bf16 v[68:71], a[32:35], v[116:119], v[68:71]
  ds_read_b128 v[100:103], v2 offset:38912
  v_mfma_f32_16x16x32_bf16 v[68:71], a[44:47], v[120:123], v[68:71]
  buffer_load_dwordx4 v9, s[12:15], s68 offen lds
  v_mfma_f32_16x16x32_bf16 v[60:63], a[40:43], v[120:123], v[60:63]
  ds_read_b128 v[104:107], v2 offset:39936
  v_mfma_f32_16x16x32_bf16 v[60:63], a[28:31], v[116:119], v[60:63]
  s_waitcnt lgkmcnt(2)
  v_mfma_f32_16x16x32_bf16 v[28:31], a[48:51], v[76:79], v[28:31]
  s_add_u32 m0, s71, 147456
  s_add_u32 s69, s60, s72
  v_mfma_f32_16x16x32_bf16 v[28:31], a[60:63], v[80:83], v[28:31]
  ds_read_b128 v[112:115], v2 offset:47104
  v_mfma_f32_16x16x32_bf16 v[32:35], a[60:63], v[84:87], v[32:35]
  buffer_load_dwordx4 v1, s[8:11], s69 offen offset:0 sc1 lds
  v_mfma_f32_16x16x32_bf16 v[32:35], a[48:51], v[88:91], v[32:35]
  v_mfma_f32_16x16x32_bf16 v[40:43], a[52:55], v[88:91], v[40:43]
  ds_read_b128 v[108:111], v2 offset:48128
  v_mfma_f32_16x16x32_bf16 v[40:43], a[64:67], v[84:87], v[40:43]
  buffer_load_dwordx4 v1, s[8:11], s69 offen offset:1024 sc1 lds
  v_mfma_f32_16x16x32_bf16 v[36:39], a[64:67], v[80:83], v[36:39]
  ds_read_b128 v[120:123], v13 offset:6144
  v_mfma_f32_16x16x32_bf16 v[36:39], a[52:55], v[76:79], v[36:39]
  v_mfma_f32_16x16x32_bf16 v[44:47], a[56:59], v[76:79], v[44:47]
  s_add_u32 m0, s71, 155648
  s_add_u32 s69, s61, s72
  v_mfma_f32_16x16x32_bf16 v[44:47], a[68:71], v[80:83], v[44:47]
  ds_read_b128 v[116:119], v13 offset:7168
  v_mfma_f32_16x16x32_bf16 v[48:51], a[68:71], v[84:87], v[48:51]
  buffer_load_dwordx4 v1, s[8:11], s69 offen offset:0 sc1 lds
  v_mfma_f32_16x16x32_bf16 v[48:51], a[56:59], v[88:91], v[48:51]
  s_waitcnt vmcnt(11) lgkmcnt(7)
  s_barrier
  v_mfma_f32_16x16x32_bf16 v[68:71], a[56:59], v[96:99], v[68:71]
  ds_read_b128 v[76:79], v2 offset:49152
  v_mfma_f32_16x16x32_bf16 v[68:71], a[68:71], v[92:95], v[68:71]
  ds_read_b64_tr_b16 a[196:197], v4 offset:0
  buffer_load_dwordx4 v1, s[8:11], s69 offen offset:1024 sc1 lds
  v_mfma_f32_16x16x32_bf16 v[60:63], a[64:67], v[92:95], v[60:63]
  ds_read_b128 v[80:83], v2 offset:50176
  v_mfma_f32_16x16x32_bf16 v[60:63], a[52:55], v[96:99], v[60:63]
  s_waitcnt lgkmcnt(3)
  ds_read_b64_tr_b16 a[198:199], v4 offset:2048
  v_mfma_f32_16x16x32_bf16 v[28:31], a[72:75], v[100:103], v[28:31]
  ds_read_b64_tr_b16 a[200:201], v5 offset:0
  s_add_u32 m0, s70, 65536
  s_add_u32 s69, s60, 32768
  v_mfma_f32_16x16x32_bf16 v[28:31], a[84:87], v[104:107], v[28:31]
  ds_read_b128 v[84:87], v2 offset:57344
  buffer_load_dwordx4 v12, s[8:11], s69 offen offset:0 sc1 lds
  v_mfma_f32_16x16x32_bf16 v[32:35], a[84:87], v[108:111], v[32:35]
  ds_read_b64_tr_b16 a[202:203], v5 offset:2048
HOP1:
  s_cbranch_execz HOP5
  v_mfma_f32_16x16x32_bf16 v[32:35], a[72:75], v[112:115], v[32:35]
  ds_read_b64_tr_b16 a[208:209], v4 offset:4096
  v_mfma_f32_16x16x32_bf16 v[40:43], a[76:79], v[112:115], v[40:43]
  ds_read_b128 v[88:91], v2 offset:58368
  v_mfma_f32_16x16x32_bf16 v[40:43], a[88:91], v[108:111], v[40:43]
  ds_read_b64_tr_b16 a[210:211], v4 offset:6144
  buffer_load_dwordx4 v12, s[8:11], s69 offen offset:1024 sc1 lds
  v_mfma_f32_16x16x32_bf16 v[36:39], a[88:91], v[104:107], v[36:39]
  ds_read_b128 v[92:95], v13 offset:8192
  v_mfma_f32_16x16x32_bf16 v[36:39], a[76:79], v[100:103], v[36:39]
  ds_read_b64_tr_b16 a[212:213], v5 offset:4096
  v_mfma_f32_16x16x32_bf16 v[44:47], a[80:83], v[100:103], v[44:47]
  ds_read_b64_tr_b16 a[214:215], v5 offset:6144
  v_mfma_f32_16x16x32_bf16 v[44:47], a[92:95], v[104:107], v[44:47]
  ds_read_b128 v[96:99], v13 offset:9216
  buffer_load_dwordx4 v12, s[8:11], s69 offen offset:2048 sc1 lds
  v_mfma_f32_16x16x32_bf16 v[48:51], a[92:95], v[108:111], v[48:51]
  ds_read_b64_tr_b16 a[220:221], v4 offset:8192
  v_mfma_f32_16x16x32_bf16 v[48:51], a[80:83], v[112:115], v[48:51]
  ds_read_b64_tr_b16 a[222:223], v4 offset:10240
  v_mfma_f32_16x16x32_bf16 v[68:71], a[80:83], v[120:123], v[68:71]
  ds_read_b128 v[100:103], v2 offset:51200
  v_mfma_f32_16x16x32_bf16 v[68:71], a[92:95], v[116:119], v[68:71]
  ds_read_b64_tr_b16 a[224:225], v5 offset:8192
  buffer_load_dwordx4 v12, s[8:11], s69 offen offset:3072 sc1 lds
  v_mfma_f32_16x16x32_bf16 v[60:63], a[88:91], v[116:119], v[60:63]
  ds_read_b128 v[104:107], v2 offset:52224
  v_mfma_f32_16x16x32_bf16 v[60:63], a[76:79], v[120:123], v[60:63]
  s_waitcnt lgkmcnt(5)
  ds_read_b64_tr_b16 a[226:227], v5 offset:10240
  v_mfma_f32_16x16x32_bf16 v[28:31], a[96:99], v[76:79], v[28:31]
  ds_read_b64_tr_b16 a[232:233], v4 offset:12288
  s_add_u32 m0, s45, 81920
  s_add_u32 s68, s66, 6
  s_and_b32 s68, s68, 7
  s_mul_i32 s68, s68, 786432
  v_mfma_f32_16x16x32_bf16 v[28:31], a[108:111], v[80:83], v[28:31]
  ds_read_b128 v[108:111], v2 offset:59392
  buffer_load_dwordx4 v9, s[12:15], s68 offen lds
  v_mfma_f32_16x16x32_bf16 v[32:35], a[108:111], v[88:91], v[32:35]
  ds_read_b64_tr_b16 a[234:235], v4 offset:14336
  v_mfma_f32_16x16x32_bf16 v[32:35], a[96:99], v[84:87], v[32:35]
  ds_read_b64_tr_b16 a[236:237], v5 offset:12288
  v_mfma_f32_16x16x32_bf16 v[40:43], a[100:103], v[84:87], v[40:43]
  ds_read_b128 v[112:115], v2 offset:60416
  s_add_u32 m0, s45, 86016
  s_add_u32 s68, s68, 196608
  v_mfma_f32_16x16x32_bf16 v[40:43], a[112:115], v[88:91], v[40:43]
  ds_read_b64_tr_b16 a[238:239], v5 offset:14336
  buffer_load_dwordx4 v9, s[12:15], s68 offen lds
  v_mfma_f32_16x16x32_bf16 v[36:39], a[112:115], v[80:83], v[36:39]
  ds_read_b128 v[116:119], v13 offset:10240
  v_mfma_f32_16x16x32_bf16 v[36:39], a[100:103], v[76:79], v[36:39]
  v_mfma_f32_16x16x32_bf16 v[44:47], a[104:107], v[76:79], v[44:47]
  s_add_u32 m0, s45, 90112
  s_add_u32 s68, s68, 196608
  v_mfma_f32_16x16x32_bf16 v[44:47], a[116:119], v[80:83], v[44:47]
  ds_read_b128 v[120:123], v13 offset:11264
  v_mfma_f32_16x16x32_bf16 v[48:51], a[116:119], v[88:91], v[48:51]
  buffer_load_dwordx4 v9, s[12:15], s68 offen lds
  v_mfma_f32_16x16x32_bf16 v[48:51], a[104:107], v[84:87], v[48:51]
  s_waitcnt vmcnt(11) lgkmcnt(2)
  s_barrier
  v_mfma_f32_16x16x32_bf16 v[68:71], a[104:107], v[92:95], v[68:71]
  ds_read_b128 v[76:79], v2 offset:53248
  s_add_u32 m0, s45, 94208
  s_add_u32 s68, s68, 196608
  v_mfma_f32_16x16x32_bf16 v[68:71], a[116:119], v[96:99], v[68:71]
  ds_read_b64_tr_b16 a[244:245], v4 offset:32768
  buffer_load_dwordx4 v9, s[12:15], s68 offen lds
  v_mfma_f32_16x16x32_bf16 v[60:63], a[112:115], v[96:99], v[60:63]
  ds_read_b128 v[80:83], v2 offset:54272
  v_mfma_f32_16x16x32_bf16 v[60:63], a[100:103], v[92:95], v[60:63]
  s_waitcnt lgkmcnt(3)
  ds_read_b64_tr_b16 a[246:247], v4 offset:34816
  v_mfma_f32_16x16x32_bf16 v[28:31], a[120:123], v[100:103], v[28:31]
  ds_read_b64_tr_b16 a[248:249], v5 offset:32768
  s_add_u32 m0, s45, 98304
  s_add_u32 s68, s66, 7
  s_and_b32 s68, s68, 7
  s_mul_i32 s68, s68, 786432
  v_mfma_f32_16x16x32_bf16 v[28:31], a[132:135], v[104:107], v[28:31]
  ds_read_b128 v[88:91], v2 offset:61440
  buffer_load_dwordx4 v9, s[12:15], s68 offen lds
  v_mfma_f32_16x16x32_bf16 v[32:35], a[132:135], v[112:115], v[32:35]
  ds_read_b64_tr_b16 a[250:251], v5 offset:34816
  v_mfma_f32_16x16x32_bf16 v[32:35], a[120:123], v[108:111], v[32:35]
  ds_read_b64_tr_b16 v[128:129], v4 offset:36864
  v_mfma_f32_16x16x32_bf16 v[40:43], a[124:127], v[108:111], v[40:43]
  ds_read_b128 v[84:87], v2 offset:62464
  s_add_u32 m0, s45, 102400
  s_add_u32 s68, s68, 196608
  v_mfma_f32_16x16x32_bf16 v[40:43], a[136:139], v[112:115], v[40:43]
  ds_read_b64_tr_b16 v[130:131], v4 offset:38912
  buffer_load_dwordx4 v9, s[12:15], s68 offen lds
  v_mfma_f32_16x16x32_bf16 v[36:39], a[136:139], v[104:107], v[36:39]
  ds_read_b128 v[96:99], v13 offset:12288
  v_mfma_f32_16x16x32_bf16 v[36:39], a[124:127], v[100:103], v[36:39]
  ds_read_b64_tr_b16 v[132:133], v5 offset:36864
  v_mfma_f32_16x16x32_bf16 v[44:47], a[128:131], v[100:103], v[44:47]
  ds_read_b64_tr_b16 v[134:135], v5 offset:38912
  s_add_u32 m0, s45, 106496
  s_add_u32 s68, s68, 196608
  v_mfma_f32_16x16x32_bf16 v[44:47], a[140:143], v[104:107], v[44:47]
  ds_read_b128 v[92:95], v13 offset:13312
  buffer_load_dwordx4 v9, s[12:15], s68 offen lds
  v_mfma_f32_16x16x32_bf16 v[48:51], a[140:143], v[112:115], v[48:51]
  ds_read_b64_tr_b16 v[140:141], v4 offset:40960
  v_mfma_f32_16x16x32_bf16 v[48:51], a[128:131], v[108:111], v[48:51]
  ds_read_b64_tr_b16 v[142:143], v4 offset:43008
  v_mfma_f32_16x16x32_bf16 v[68:71], a[128:131], v[116:119], v[68:71]
  ds_read_b128 v[100:103], v2 offset:55296
  s_add_u32 m0, s45, 110592
  s_add_u32 s68, s68, 196608
  v_mfma_f32_16x16x32_bf16 v[68:71], a[140:143], v[120:123], v[68:71]
  ds_read_b64_tr_b16 v[144:145], v5 offset:40960
  buffer_load_dwordx4 v9, s[12:15], s68 offen lds
  v_mfma_f32_16x16x32_bf16 v[60:63], a[136:139], v[120:123], v[60:63]
  ds_read_b128 v[104:107], v2 offset:56320
  v_mfma_f32_16x16x32_bf16 v[60:63], a[124:127], v[116:119], v[60:63]
  s_waitcnt lgkmcnt(5)
  ds_read_b64_tr_b16 v[146:147], v5 offset:43008
  v_mfma_f32_16x16x32_bf16 v[28:31], a[144:147], v[76:79], v[28:31]
  ds_read_b64_tr_b16 v[152:153], v4 offset:45056
  s_add_u32 m0, s45, 0
  s_add_u32 s68, s66, 6
  s_and_b32 s68, s68, 7
  s_mul_i32 s68, s68, 786432
  s_add_u32 s68, s68, 2048
  v_mfma_f32_16x16x32_bf16 v[28:31], a[156:159], v[80:83], v[28:31]
  ds_read_b128 v[112:115], v2 offset:63488
  buffer_load_dwordx4 v9, s[12:15], s68 offen lds
  v_mfma_f32_16x16x32_bf16 v[32:35], a[156:159], v[84:87], v[32:35]
  ds_read_b64_tr_b16 v[154:155], v4 offset:47104
  v_mfma_f32_16x16x32_bf16 v[32:35], a[144:147], v[88:91], v[32:35]
  ds_read_b64_tr_b16 v[156:157], v5 offset:45056
  v_mfma_f32_16x16x32_bf16 v[40:43], a[148:151], v[88:91], v[40:43]
  ds_read_b128 v[108:111], v2 offset:64512
  s_add_u32 m0, s45, 4096
  s_add_u32 s68, s68, 196608
  v_mfma_f32_16x16x32_bf16 v[40:43], a[160:163], v[84:87], v[40:43]
  ds_read_b64_tr_b16 v[158:159], v5 offset:47104
  buffer_load_dwordx4 v9, s[12:15], s68 offen lds
  v_mfma_f32_16x16x32_bf16 v[36:39], a[160:163], v[80:83], v[36:39]
  ds_read_b128 v[120:123], v13 offset:14336
  v_mfma_f32_16x16x32_bf16 v[36:39], a[148:151], v[76:79], v[36:39]
  v_mfma_f32_16x16x32_bf16 v[44:47], a[152:155], v[76:79], v[44:47]
  s_add_u32 m0, s45, 8192
  s_add_u32 s68, s68, 196608
  v_mfma_f32_16x16x32_bf16 v[44:47], a[164:167], v[80:83], v[44:47]
  ds_read_b128 v[116:119], v13 offset:15360
  v_mfma_f32_16x16x32_bf16 v[48:51], a[164:167], v[84:87], v[48:51]
  buffer_load_dwordx4 v9, s[12:15], s68 offen lds
  v_mfma_f32_16x16x32_bf16 v[48:51], a[152:155], v[88:91], v[48:51]
  s_waitcnt vmcnt(3) lgkmcnt(2)
  s_barrier
  v_mfma_f32_16x16x32_bf16 v[68:71], a[152:155], v[96:99], v[68:71]
  ds_read_b128 v[76:79], v2 offset:0
  s_add_u32 m0, s45, 12288
  s_add_u32 s68, s68, 196608
  v_mfma_f32_16x16x32_bf16 v[68:71], a[164:167], v[92:95], v[68:71]
  ds_read_b64_tr_b16 v[160:161], v6 offset:16384
  buffer_load_dwordx4 v9, s[12:15], s68 offen lds
  v_mfma_f32_16x16x32_bf16 v[60:63], a[160:163], v[92:95], v[60:63]
  ds_read_b128 v[80:83], v2 offset:1024
  v_mfma_f32_16x16x32_bf16 v[60:63], a[148:151], v[96:99], v[60:63]
  s_waitcnt lgkmcnt(3)
  ds_read_b64_tr_b16 v[162:163], v6 offset:18432
  v_mfma_f32_16x16x32_bf16 v[28:31], a[168:171], v[100:103], v[28:31]
  ds_read_b64_tr_b16 v[172:173], v6 offset:20480
  s_add_u32 m0, s45, 16384
  s_add_u32 s68, s66, 6
  s_and_b32 s68, s68, 7
  s_mul_i32 s68, s68, 786432
  s_add_u32 s68, s68, 4096
  v_mfma_f32_16x16x32_bf16 v[28:31], a[180:183], v[104:107], v[28:31]
  ds_read_b128 v[84:87], v2 offset:8192
  buffer_load_dwordx4 v9, s[12:15], s68 offen lds
  v_mfma_f32_16x16x32_bf16 v[32:35], a[180:183], v[108:111], v[32:35]
  ds_read_b64_tr_b16 v[174:175], v6 offset:22528
  v_mfma_f32_16x16x32_bf16 v[32:35], a[168:171], v[112:115], v[32:35]
  ds_read_b64_tr_b16 v[184:185], v6 offset:24576
  v_mfma_f32_16x16x32_bf16 v[40:43], a[172:175], v[112:115], v[40:43]
  ds_read_b128 v[88:91], v2 offset:9216
  s_add_u32 m0, s45, 20480
  s_add_u32 s68, s68, 196608
  v_mfma_f32_16x16x32_bf16 v[40:43], a[184:187], v[108:111], v[40:43]
  ds_read_b64_tr_b16 v[186:187], v6 offset:26624
  buffer_load_dwordx4 v9, s[12:15], s68 offen lds
  v_mfma_f32_16x16x32_bf16 v[36:39], a[184:187], v[104:107], v[36:39]
  ds_read_b128 v[92:95], v13 offset:16384
  v_mfma_f32_16x16x32_bf16 v[36:39], a[172:175], v[100:103], v[36:39]
  ds_read_b64_tr_b16 v[196:197], v6 offset:28672
  v_mfma_f32_16x16x32_bf16 v[44:47], a[176:179], v[100:103], v[44:47]
  ds_read_b64_tr_b16 v[198:199], v6 offset:30720
  s_add_u32 m0, s45, 24576
  s_add_u32 s68, s68, 196608
  v_mfma_f32_16x16x32_bf16 v[44:47], a[188:191], v[104:107], v[44:47]
  ds_read_b128 v[96:99], v13 offset:17408
  buffer_load_dwordx4 v9, s[12:15], s68 offen lds
  v_mfma_f32_16x16x32_bf16 v[48:51], a[188:191], v[108:111], v[48:51]
  ds_read_b64_tr_b16 v[208:209], v6 offset:32768
  v_mfma_f32_16x16x32_bf16 v[48:51], a[176:179], v[112:115], v[48:51]
  ds_read_b64_tr_b16 v[210:211], v6 offset:34816
  v_mfma_f32_16x16x32_bf16 v[68:71], a[176:179], v[120:123], v[68:71]
  ds_read_b128 v[100:103], v2 offset:2048
  s_add_u32 m0, s45, 28672
  s_add_u32 s68, s68, 196608
  v_mfma_f32_16x16x32_bf16 v[68:71], a[188:191], v[116:119], v[68:71]
  ds_read_b64_tr_b16 v[220:221], v6 offset:36864
  buffer_load_dwordx4 v9, s[12:15], s68 offen lds
  v_mfma_f32_16x16x32_bf16 v[60:63], a[184:187], v[116:119], v[60:63]
  ds_read_b128 v[104:107], v2 offset:3072
  v_mfma_f32_16x16x32_bf16 v[60:63], a[172:175], v[120:123], v[60:63]
  s_waitcnt lgkmcnt(5)
  ds_read_b64_tr_b16 v[222:223], v6 offset:38912
  v_mfma_f32_16x16x32_bf16 v[28:31], a[192:195], v[76:79], v[28:31]
  ds_read_b64_tr_b16 v[232:233], v6 offset:40960
  s_add_u32 m0, s70, 32768
  s_add_u32 s69, s61, 32768
  v_mfma_f32_16x16x32_bf16 v[28:31], a[204:207], v[80:83], v[28:31]
  ds_read_b128 v[108:111], v2 offset:10240
  buffer_load_dwordx4 v12, s[8:11], s69 offen offset:0 sc1 lds
  v_mfma_f32_16x16x32_bf16 v[32:35], a[204:207], v[88:91], v[32:35]
  ds_read_b64_tr_b16 v[234:235], v6 offset:43008
  v_mfma_f32_16x16x32_bf16 v[32:35], a[192:195], v[84:87], v[32:35]
  ds_read_b64_tr_b16 v[244:245], v6 offset:45056
  v_mfma_f32_16x16x32_bf16 v[40:43], a[196:199], v[84:87], v[40:43]
  ds_read_b128 v[112:115], v2 offset:11264
  v_mfma_f32_16x16x32_bf16 v[40:43], a[208:211], v[88:91], v[40:43]
  ds_read_b64_tr_b16 v[246:247], v6 offset:47104
  buffer_load_dwordx4 v12, s[8:11], s69 offen offset:1024 sc1 lds
  v_mfma_f32_16x16x32_bf16 v[36:39], a[208:211], v[80:83], v[36:39]
  ds_read_b128 v[116:119], v13 offset:18432
  v_mfma_f32_16x16x32_bf16 v[36:39], a[196:199], v[76:79], v[36:39]
  v_mfma_f32_16x16x32_bf16 v[44:47], a[200:203], v[76:79], v[44:47]
  v_mfma_f32_16x16x32_bf16 v[44:47], a[212:215], v[80:83], v[44:47]
  ds_read_b128 v[120:123], v13 offset:19456
  v_mfma_f32_16x16x32_bf16 v[48:51], a[212:215], v[88:91], v[48:51]
  buffer_load_dwordx4 v12, s[8:11], s69 offen offset:2048 sc1 lds
  v_mfma_f32_16x16x32_bf16 v[48:51], a[200:203], v[84:87], v[48:51]
  s_waitcnt vmcnt(3) lgkmcnt(2)
  s_barrier
  v_mfma_f32_16x16x32_bf16 v[68:71], a[200:203], v[92:95], v[68:71]
  ds_read_b128 v[76:79], v2 offset:4096
  v_mfma_f32_16x16x32_bf16 v[68:71], a[212:215], v[96:99], v[68:71]
  ds_read_b64_tr_b16 v[164:165], v4 offset:0
  buffer_load_dwordx4 v12, s[8:11], s69 offen offset:3072 sc1 lds
  v_mfma_f32_16x16x32_bf16 v[60:63], a[208:211], v[96:99], v[60:63]
  ds_read_b128 v[80:83], v2 offset:5120
  v_mfma_f32_16x16x32_bf16 v[60:63], a[196:199], v[92:95], v[60:63]
  s_waitcnt lgkmcnt(3)
  ds_read_b64_tr_b16 v[166:167], v4 offset:2048
  v_mfma_f32_16x16x32_bf16 v[28:31], a[216:219], v[100:103], v[28:31]
  ds_read_b64_tr_b16 v[168:169], v5 offset:0
  s_add_u32 m0, s45, 81920
  s_add_u32 s68, s66, 7
  s_and_b32 s68, s68, 7
  s_mul_i32 s68, s68, 786432
  s_add_u32 s68, s68, 2048
  v_mfma_f32_16x16x32_bf16 v[28:31], a[228:231], v[104:107], v[28:31]
  ds_read_b128 v[88:91], v2 offset:12288
  buffer_load_dwordx4 v9, s[12:15], s68 offen lds
  v_mfma_f32_16x16x32_bf16 v[32:35], a[228:231], v[112:115], v[32:35]
  ds_read_b64_tr_b16 v[170:171], v5 offset:2048
  v_mfma_f32_16x16x32_bf16 v[32:35], a[216:219], v[108:111], v[32:35]
  ds_read_b64_tr_b16 v[176:177], v4 offset:4096
  v_mfma_f32_16x16x32_bf16 v[40:43], a[220:223], v[108:111], v[40:43]
  ds_read_b128 v[84:87], v2 offset:13312
  s_add_u32 m0, s45, 86016
  s_add_u32 s68, s68, 196608
  v_mfma_f32_16x16x32_bf16 v[40:43], a[232:235], v[112:115], v[40:43]
  ds_read_b64_tr_b16 v[178:179], v4 offset:6144
  buffer_load_dwordx4 v9, s[12:15], s68 offen lds
  v_mfma_f32_16x16x32_bf16 v[36:39], a[232:235], v[104:107], v[36:39]
  ds_read_b128 v[96:99], v13 offset:20480
  v_mfma_f32_16x16x32_bf16 v[36:39], a[220:223], v[100:103], v[36:39]
  ds_read_b64_tr_b16 v[180:181], v5 offset:4096
  v_mfma_f32_16x16x32_bf16 v[44:47], a[224:227], v[100:103], v[44:47]
  ds_read_b64_tr_b16 v[182:183], v5 offset:6144
  s_add_u32 m0, s45, 90112
  s_add_u32 s68, s68, 196608
  v_mfma_f32_16x16x32_bf16 v[44:47], a[236:239], v[104:107], v[44:47]
  ds_read_b128 v[92:95], v13 offset:21504
  buffer_load_dwordx4 v9, s[12:15], s68 offen lds
  v_mfma_f32_16x16x32_bf16 v[48:51], a[236:239], v[112:115], v[48:51]
  ds_read_b64_tr_b16 v[188:189], v4 offset:8192
  v_mfma_f32_16x16x32_bf16 v[48:51], a[224:227], v[108:111], v[48:51]
  ds_read_b64_tr_b16 v[190:191], v4 offset:10240
  v_mfma_f32_16x16x32_bf16 v[68:71], a[224:227], v[116:119], v[68:71]
  ds_read_b128 v[100:103], v2 offset:6144
  s_add_u32 m0, s45, 94208
  s_add_u32 s68, s68, 196608
  v_mfma_f32_16x16x32_bf16 v[68:71], a[236:239], v[120:123], v[68:71]
  ds_read_b64_tr_b16 v[192:193], v5 offset:8192
  buffer_load_dwordx4 v9, s[12:15], s68 offen lds
  v_mfma_f32_16x16x32_bf16 v[60:63], a[232:235], v[120:123], v[60:63]
  ds_read_b128 v[104:107], v2 offset:7168
  v_mfma_f32_16x16x32_bf16 v[60:63], a[220:223], v[116:119], v[60:63]
  s_waitcnt lgkmcnt(5)
  ds_read_b64_tr_b16 v[194:195], v5 offset:10240
  v_mfma_f32_16x16x32_bf16 v[28:31], a[240:243], v[76:79], v[28:31]
  ds_read_b64_tr_b16 v[200:201], v4 offset:12288
  s_add_u32 m0, s45, 98304
  s_add_u32 s68, s66, 7
  s_and_b32 s68, s68, 7
  s_mul_i32 s68, s68, 786432
  s_add_u32 s68, s68, 4096
  v_mfma_f32_16x16x32_bf16 v[28:31], v[124:127], v[80:83], v[28:31]
  ds_read_b128 v[112:115], v2 offset:14336
  buffer_load_dwordx4 v9, s[12:15], s68 offen lds
  v_mfma_f32_16x16x32_bf16 v[32:35], v[124:127], v[84:87], v[32:35]
  ds_read_b64_tr_b16 v[202:203], v4 offset:14336
  v_mfma_f32_16x16x32_bf16 v[32:35], a[240:243], v[88:91], v[32:35]
  ds_read_b64_tr_b16 v[204:205], v5 offset:12288
  v_mfma_f32_16x16x32_bf16 v[40:43], a[244:247], v[88:91], v[40:43]
  ds_read_b128 v[108:111], v2 offset:15360
  s_add_u32 m0, s45, 102400
  s_add_u32 s68, s68, 196608
  v_mfma_f32_16x16x32_bf16 v[40:43], v[128:131], v[84:87], v[40:43]
  ds_read_b64_tr_b16 v[206:207], v5 offset:14336
  buffer_load_dwordx4 v9, s[12:15], s68 offen lds
  v_mfma_f32_16x16x32_bf16 v[36:39], v[128:131], v[80:83], v[36:39]
  ds_read_b128 v[120:123], v13 offset:22528
  v_mfma_f32_16x16x32_bf16 v[36:39], a[244:247], v[76:79], v[36:39]
  v_mfma_f32_16x16x32_bf16 v[44:47], a[248:251], v[76:79], v[44:47]
  s_add_u32 m0, s45, 106496
  s_add_u32 s68, s68, 196608
  v_mfma_f32_16x16x32_bf16 v[44:47], v[132:135], v[80:83], v[44:47]
  ds_read_b128 v[116:119], v13 offset:23552
  v_mfma_f32_16x16x32_bf16 v[48:51], v[132:135], v[84:87], v[48:51]
  buffer_load_dwordx4 v9, s[12:15], s68 offen lds
  v_mfma_f32_16x16x32_bf16 v[48:51], a[248:251], v[88:91], v[48:51]
  s_waitcnt vmcnt(7) lgkmcnt(2)
  s_barrier
  v_mfma_f32_16x16x32_bf16 v[68:71], a[248:251], v[96:99], v[68:71]
  ds_read_b128 v[76:79], v1 offset:32768
  s_add_u32 m0, s45, 110592
  s_add_u32 s68, s68, 196608
  v_mfma_f32_16x16x32_bf16 v[68:71], v[132:135], v[92:95], v[68:71]
  buffer_load_dwordx4 v9, s[12:15], s68 offen lds
  v_mfma_f32_16x16x32_bf16 v[60:63], v[128:131], v[92:95], v[60:63]
  ds_read_b128 v[80:83], v1 offset:33792
  v_mfma_f32_16x16x32_bf16 v[60:63], a[244:247], v[96:99], v[60:63]
  s_waitcnt lgkmcnt(2)
  v_mfma_f32_16x16x32_bf16 v[28:31], v[136:139], v[100:103], v[28:31]
  s_add_u32 m0, s70, 49152
  s_add_u32 s69, s58, 98304
  v_mfma_f32_16x16x32_bf16 v[28:31], v[148:151], v[104:107], v[28:31]
  ds_read_b128 v[84:87], v1 offset:40960
  v_mfma_f32_16x16x32_bf16 v[32:35], v[148:151], v[108:111], v[32:35]
  buffer_load_dwordx4 v12, s[8:11], s69 offen offset:0 sc1 lds
  v_mfma_f32_16x16x32_bf16 v[32:35], v[136:139], v[112:115], v[32:35]
  v_mfma_f32_16x16x32_bf16 v[40:43], v[140:143], v[112:115], v[40:43]
  ds_read_b128 v[88:91], v1 offset:41984
  v_mfma_f32_16x16x32_bf16 v[40:43], v[152:155], v[108:111], v[40:43]
  buffer_load_dwordx4 v12, s[8:11], s69 offen offset:1024 sc1 lds
  v_mfma_f32_16x16x32_bf16 v[36:39], v[152:155], v[104:107], v[36:39]
  ds_read_b128 v[92:95], v13 offset:24576
  v_mfma_f32_16x16x32_bf16 v[36:39], v[140:143], v[100:103], v[36:39]
  v_mfma_f32_16x16x32_bf16 v[44:47], v[144:147], v[100:103], v[44:47]
  v_mfma_f32_16x16x32_bf16 v[44:47], v[156:159], v[104:107], v[44:47]
  ds_read_b128 v[96:99], v13 offset:25600
  v_mfma_f32_16x16x32_bf16 v[48:51], v[156:159], v[108:111], v[48:51]
  buffer_load_dwordx4 v12, s[8:11], s69 offen offset:2048 sc1 lds
  v_mfma_f32_16x16x32_bf16 v[48:51], v[144:147], v[112:115], v[48:51]
  s_waitcnt vmcnt(3)
  s_barrier
  v_mfma_f32_16x16x32_bf16 v[68:71], v[144:147], v[120:123], v[68:71]
  ds_read_b128 v[100:103], v1 offset:34816
  v_mfma_f32_16x16x32_bf16 v[68:71], v[156:159], v[116:119], v[68:71]
  ds_read_b64_tr_b16 v[212:213], v7 offset:16384
  buffer_load_dwordx4 v12, s[8:11], s69 offen offset:3072 sc1 lds
  v_mfma_f32_16x16x32_bf16 v[60:63], v[152:155], v[116:119], v[60:63]
  ds_read_b128 v[104:107], v1 offset:35840
  v_mfma_f32_16x16x32_bf16 v[60:63], v[140:143], v[120:123], v[60:63]
  s_waitcnt lgkmcnt(3)
  ds_read_b64_tr_b16 v[214:215], v7 offset:18432
  v_mfma_f32_16x16x32_bf16 v[28:31], v[160:163], v[76:79], v[28:31]
  ds_read_b64_tr_b16 v[216:217], v8 offset:16384
  s_add_u32 m0, s70, 114688
  s_add_u32 s69, s59, 98304
  v_mfma_f32_16x16x32_bf16 v[28:31], v[172:175], v[80:83], v[28:31]
  ds_read_b128 v[108:111], v1 offset:43008
  buffer_load_dwordx4 v12, s[8:11], s69 offen offset:0 sc1 lds
  v_mfma_f32_16x16x32_bf16 v[32:35], v[172:175], v[88:91], v[32:35]
  ds_read_b64_tr_b16 v[218:219], v8 offset:18432
  v_mfma_f32_16x16x32_bf16 v[32:35], v[160:163], v[84:87], v[32:35]
  ds_read_b64_tr_b16 v[224:225], v7 offset:20480
  v_mfma_f32_16x16x32_bf16 v[40:43], v[164:167], v[84:87], v[40:43]
  ds_read_b128 v[112:115], v1 offset:44032
  v_mfma_f32_16x16x32_bf16 v[40:43], v[176:179], v[88:91], v[40:43]
  ds_read_b64_tr_b16 v[226:227], v7 offset:22528
  buffer_load_dwordx4 v12, s[8:11], s69 offen offset:1024 sc1 lds
  v_mfma_f32_16x16x32_bf16 v[36:39], v[176:179], v[80:83], v[36:39]
  ds_read_b128 v[116:119], v13 offset:26624
  v_mfma_f32_16x16x32_bf16 v[36:39], v[164:167], v[76:79], v[36:39]
  ds_read_b64_tr_b16 v[228:229], v8 offset:20480
  v_mfma_f32_16x16x32_bf16 v[44:47], v[168:171], v[76:79], v[44:47]
  ds_read_b64_tr_b16 v[230:231], v8 offset:22528
  v_mfma_f32_16x16x32_bf16 v[44:47], v[180:183], v[80:83], v[44:47]
  ds_read_b128 v[120:123], v13 offset:27648
  buffer_load_dwordx4 v12, s[8:11], s69 offen offset:2048 sc1 lds
  v_mfma_f32_16x16x32_bf16 v[48:51], v[180:183], v[88:91], v[48:51]
  ds_read_b64_tr_b16 v[236:237], v7 offset:24576
  v_mfma_f32_16x16x32_bf16 v[48:51], v[168:171], v[84:87], v[48:51]
  ds_read_b64_tr_b16 v[238:239], v7 offset:26624
  v_mfma_f32_16x16x32_bf16 v[68:71], v[168:171], v[92:95], v[68:71]
  ds_read_b128 v[76:79], v1 offset:36864
  v_mfma_f32_16x16x32_bf16 v[68:71], v[180:183], v[96:99], v[68:71]
  ds_read_b64_tr_b16 v[240:241], v8 offset:24576
  buffer_load_dwordx4 v12, s[8:11], s69 offen offset:3072 sc1 lds
  v_mfma_f32_16x16x32_bf16 v[60:63], v[176:179], v[96:99], v[60:63]
  ds_read_b128 v[80:83], v1 offset:37888
  v_mfma_f32_16x16x32_bf16 v[60:63], v[164:167], v[92:95], v[60:63]
  s_waitcnt lgkmcnt(5)
  ds_read_b64_tr_b16 v[242:243], v8 offset:26624
  v_mfma_f32_16x16x32_bf16 v[28:31], v[184:187], v[100:103], v[28:31]
  ds_read_b64_tr_b16 v[248:249], v7 offset:28672
  s_add_u32 m0, s70, 0
  s_add_u32 s69, s60, 98304
  v_mfma_f32_16x16x32_bf16 v[28:31], v[196:199], v[104:107], v[28:31]
  ds_read_b128 v[88:91], v1 offset:45056
  buffer_load_dwordx4 v12, s[8:11], s69 offen offset:0 sc1 lds
  v_mfma_f32_16x16x32_bf16 v[32:35], v[196:199], v[112:115], v[32:35]
  ds_read_b64_tr_b16 v[250:251], v7 offset:30720
  v_mfma_f32_16x16x32_bf16 v[32:35], v[184:187], v[108:111], v[32:35]
  ds_read_b64_tr_b16 v[252:253], v8 offset:28672
  v_mfma_f32_16x16x32_bf16 v[40:43], v[188:191], v[108:111], v[40:43]
  ds_read_b128 v[84:87], v1 offset:46080
  v_mfma_f32_16x16x32_bf16 v[40:43], v[200:203], v[112:115], v[40:43]
  ds_read_b64_tr_b16 v[254:255], v8 offset:30720
  buffer_load_dwordx4 v12, s[8:11], s69 offen offset:1024 sc1 lds
  v_mfma_f32_16x16x32_bf16 v[36:39], v[200:203], v[104:107], v[36:39]
  ds_read_b128 v[96:99], v13 offset:28672
  v_mfma_f32_16x16x32_bf16 v[36:39], v[188:191], v[100:103], v[36:39]
  v_mfma_f32_16x16x32_bf16 v[44:47], v[192:195], v[100:103], v[44:47]
  v_mfma_f32_16x16x32_bf16 v[44:47], v[204:207], v[104:107], v[44:47]
  ds_read_b128 v[92:95], v13 offset:29696
  v_mfma_f32_16x16x32_bf16 v[48:51], v[204:207], v[112:115], v[48:51]
  buffer_load_dwordx4 v12, s[8:11], s69 offen offset:2048 sc1 lds
  v_mfma_f32_16x16x32_bf16 v[48:51], v[192:195], v[108:111], v[48:51]
  v_mfma_f32_16x16x32_bf16 v[68:71], v[192:195], v[116:119], v[68:71]
  ds_read_b128 v[100:103], v1 offset:38912
  v_mfma_f32_16x16x32_bf16 v[68:71], v[204:207], v[120:123], v[68:71]
  buffer_load_dwordx4 v12, s[8:11], s69 offen offset:3072 sc1 lds
  v_mfma_f32_16x16x32_bf16 v[60:63], v[200:203], v[120:123], v[60:63]
  ds_read_b128 v[104:107], v1 offset:39936
  s_mov_b32 s30, 7340032
  v_mfma_f32_16x16x32_bf16 v[60:63], v[188:191], v[116:119], v[60:63]
  s_waitcnt lgkmcnt(2)
  s_mov_b32 s31, 131072
  s_mov_b32 s34, 7340032
  v_mfma_f32_16x16x32_bf16 v[28:31], v[208:211], v[76:79], v[28:31]
  s_add_u32 m0, s45, 16384
  s_mov_b32 s68, 0
  v_mfma_f32_16x16x32_bf16 v[28:31], v[220:223], v[80:83], v[28:31]
  ds_read_b128 v[112:115], v1 offset:47104
  s_mov_b32 s35, 131072
  v_mfma_f32_16x16x32_bf16 v[32:35], v[220:223], v[84:87], v[32:35]
  buffer_load_dwordx4 v11, s[20:23], s68 offen nt lds
  s_mov_b32 s38, 7340032
  s_mov_b32 s39, 131072
  v_mfma_f32_16x16x32_bf16 v[32:35], v[208:211], v[88:91], v[32:35]
  s_add_u32 m0, s45, 20480
  s_add_u32 s68, s68, 393216
  s_mov_b32 s42, 4194304
  v_mfma_f32_16x16x32_bf16 v[40:43], v[212:215], v[88:91], v[40:43]
  ds_read_b128 v[108:111], v1 offset:48128
  s_mov_b32 s43, 131072
  v_mfma_f32_16x16x32_bf16 v[40:43], v[224:227], v[84:87], v[40:43]
  buffer_load_dwordx4 v11, s[20:23], s68 offen nt lds
  v_add_u32 v9, s78, v1
  v_and_b32 v4, 0xffffbfff, v4
  v_mfma_f32_16x16x32_bf16 v[36:39], v[224:227], v[80:83], v[36:39]
  ds_read_b128 v[120:123], v13 offset:30720
  v_and_b32 v5, 0xffffbfff, v5
  v_mfma_f32_16x16x32_bf16 v[36:39], v[212:215], v[76:79], v[36:39]
  v_and_b32 v7, 0xffffbfff, v7
  v_and_b32 v8, 0xffffbfff, v8
  v_mfma_f32_16x16x32_bf16 v[44:47], v[216:219], v[76:79], v[44:47]
  s_add_u32 m0, s45, 24576
  s_add_u32 s68, s68, 393216
  s_lshl_b32 s52, s44, 13
  v_mfma_f32_16x16x32_bf16 v[44:47], v[228:231], v[80:83], v[44:47]
  ds_read_b128 v[116:119], v13 offset:31744
  s_and_b32 s52, s52, 8192
  v_mfma_f32_16x16x32_bf16 v[48:51], v[228:231], v[84:87], v[48:51]
  buffer_load_dwordx4 v11, s[20:23], s68 offen nt lds
  v_add_u32 v22, s52, v1
  v_add_u32 v23, s52, v2
  v_mfma_f32_16x16x32_bf16 v[48:51], v[216:219], v[88:91], v[48:51]
  s_waitcnt vmcnt(11) lgkmcnt(8)
  s_barrier
  v_mfma_f32_16x16x32_bf16 v[68:71], v[216:219], v[96:99], v[68:71]
  ds_read_b128 v[76:79], v1 offset:49152
  s_add_u32 m0, s45, 28672
  s_add_u32 s68, s68, 393216
  v_mfma_f32_16x16x32_bf16 v[68:71], v[228:231], v[92:95], v[68:71]
  buffer_load_dwordx4 v11, s[20:23], s68 offen nt lds
  v_and_b32 v14, 15, v0
  v_lshlrev_b32 v14, 7, v14
  v_mfma_f32_16x16x32_bf16 v[60:63], v[224:227], v[92:95], v[60:63]
  v_mfma_f32_16x16x32_bf16 v[60:63], v[212:215], v[96:99], v[60:63]
  s_waitcnt lgkmcnt(1)
  ds_read_b128 v[80:83], v1 offset:50176
  v_mfma_f32_16x16x32_bf16 v[28:31], v[232:235], v[100:103], v[28:31]
  v_mfma_f32_16x16x32_bf16 v[28:31], v[244:247], v[104:107], v[28:31]
  v_mfma_f32_16x16x32_bf16 v[32:35], v[244:247], v[108:111], v[32:35]
  ds_read_b128 v[84:87], v1 offset:57344
  v_mfma_f32_16x16x32_bf16 v[32:35], v[232:235], v[112:115], v[32:35]
  v_mfma_f32_16x16x32_bf16 v[40:43], v[236:239], v[112:115], v[40:43]
  v_mfma_f32_16x16x32_bf16 v[40:43], v[248:251], v[108:111], v[40:43]
  ds_read_b128 v[88:91], v1 offset:58368
  v_mfma_f32_16x16x32_bf16 v[36:39], v[248:251], v[104:107], v[36:39]
  v_mfma_f32_16x16x32_bf16 v[36:39], v[236:239], v[100:103], v[36:39]
  v_mfma_f32_16x16x32_bf16 v[44:47], v[240:243], v[100:103], v[44:47]
  ds_read_b128 v[92:95], v1 offset:51200
  v_mfma_f32_16x16x32_bf16 v[44:47], v[252:255], v[104:107], v[44:47]
  v_mfma_f32_16x16x32_bf16 v[48:51], v[252:255], v[108:111], v[48:51]
  v_mfma_f32_16x16x32_bf16 v[48:51], v[240:243], v[112:115], v[48:51]
  ds_read_b128 v[96:99], v1 offset:52224
  v_mfma_f32_16x16x32_bf16 v[68:71], v[240:243], v[120:123], v[68:71]
  v_mfma_f32_16x16x32_bf16 v[68:71], v[252:255], v[116:119], v[68:71]
  v_mfma_f32_16x16x32_bf16 v[60:63], v[248:251], v[116:119], v[60:63]
  ds_read_b128 v[100:103], v1 offset:59392
  v_mfma_f32_16x16x32_bf16 v[60:63], v[236:239], v[120:123], v[60:63]
  s_waitcnt lgkmcnt(3)
  v_mfma_f32_16x16x32_bf16 v[52:55], a[0:3], v[76:79], 0
  v_mfma_f32_16x16x32_bf16 v[52:55], a[12:15], v[80:83], v[52:55]
  ds_read_b128 v[104:107], v1 offset:60416
  v_mfma_f32_16x16x32_bf16 v[56:59], a[12:15], v[88:91], 0
  s_nop 2
  v_cvt_pk_bf16_f32 v60, v60, v61
  v_cvt_pk_bf16_f32 v61, v62, v63
HOP2:
  s_cbranch_execz HOP6
  v_cvt_pk_bf16_f32 v62, v68, v69
  v_cvt_pk_bf16_f32 v63, v70, v71
  ds_write_b128 v17, v[60:63] offset:1024
  v_mfma_f32_16x16x32_bf16 v[56:59], a[0:3], v[84:87], v[56:59]
  v_cvt_pk_bf16_f32 v28, v28, v29
  v_cvt_pk_bf16_f32 v29, v30, v31
  v_mfma_f32_16x16x32_bf16 v[64:67], a[4:7], v[84:87], 0
  ds_read_b128 v[108:111], v1 offset:53248
  v_mfma_f32_16x16x32_bf16 v[64:67], a[16:19], v[88:91], v[64:67]
  ds_write_b64 v18, v[28:29] offset:6144
  v_mfma_f32_16x16x32_bf16 v[60:63], a[16:19], v[80:83], 0
  v_cvt_pk_bf16_f32 v36, v36, v37
  v_cvt_pk_bf16_f32 v37, v38, v39
  v_mfma_f32_16x16x32_bf16 v[60:63], a[4:7], v[76:79], v[60:63]
  ds_read_b128 v[112:115], v1 offset:54272
  v_cvt_pk_bf16_f32 v38, v44, v45
  v_mfma_f32_16x16x32_bf16 v[68:71], a[8:11], v[76:79], 0
  v_cvt_pk_bf16_f32 v39, v46, v47
  v_mfma_f32_16x16x32_bf16 v[68:71], a[20:23], v[80:83], v[68:71]
  ds_write_b128 v17, v[36:39] offset:7168
  v_mfma_f32_16x16x32_bf16 v[72:75], a[20:23], v[88:91], 0
  ds_read_b128 v[76:79], v1 offset:61440
  v_cvt_pk_bf16_f32 v32, v32, v33
  v_mfma_f32_16x16x32_bf16 v[72:75], a[8:11], v[84:87], v[72:75]
  s_waitcnt lgkmcnt(6)
  v_cvt_pk_bf16_f32 v33, v34, v35
  v_mfma_f32_16x16x32_bf16 v[52:55], a[24:27], v[92:95], v[52:55]
  s_add_u32 m0, s70, 65536
  s_add_u32 s69, s61, 98304
  v_mfma_f32_16x16x32_bf16 v[52:55], a[36:39], v[96:99], v[52:55]
  ds_read_b128 v[80:83], v1 offset:62464
  v_mfma_f32_16x16x32_bf16 v[56:59], a[36:39], v[104:107], v[56:59]
  buffer_load_dwordx4 v12, s[8:11], s69 offen offset:0 sc1 lds
  ds_write_b64 v18, v[32:33] offset:12288
  v_mfma_f32_16x16x32_bf16 v[56:59], a[24:27], v[100:103], v[56:59]
  v_cvt_pk_bf16_f32 v40, v40, v41
  v_cvt_pk_bf16_f32 v41, v42, v43
  v_mfma_f32_16x16x32_bf16 v[64:67], a[28:31], v[100:103], v[64:67]
  ds_read_b128 v[88:91], v1 offset:55296
  v_cvt_pk_bf16_f32 v42, v48, v49
  v_mfma_f32_16x16x32_bf16 v[64:67], a[40:43], v[104:107], v[64:67]
  v_cvt_pk_bf16_f32 v43, v50, v51
  v_mfma_f32_16x16x32_bf16 v[60:63], a[40:43], v[96:99], v[60:63]
  buffer_load_dwordx4 v12, s[8:11], s69 offen offset:1024 sc1 lds
  ds_write_b128 v17, v[40:43] offset:13312
  v_mfma_f32_16x16x32_bf16 v[60:63], a[28:31], v[92:95], v[60:63]
  ds_read_b128 v[84:87], v1 offset:56320
  v_mfma_f32_16x16x32_bf16 v[68:71], a[32:35], v[92:95], v[68:71]
  s_bitcmp1_b32 s44, 0
  s_mov_b32 s52, 6144
  s_cselect_b32 s52, 12288, s52
  s_mov_b32 s53, 0
  s_cselect_b32 s53, 6144, s53
  v_mfma_f32_16x16x32_bf16 v[68:71], a[44:47], v[96:99], v[68:71]
  v_add_u32 v116, s52, v19
  v_add_u32 v117, s53, v19
  v_mfma_f32_16x16x32_bf16 v[72:75], a[44:47], v[104:107], v[72:75]
  ds_read_b128 v[92:95], v1 offset:63488
  v_add_u32 v118, s52, v20
  v_mfma_f32_16x16x32_bf16 v[72:75], a[32:35], v[100:103], v[72:75]
  s_waitcnt lgkmcnt(5)
  buffer_load_dwordx4 v12, s[8:11], s69 offen offset:2048 sc1 lds
  v_add_u32 v119, s53, v20
  v_mfma_f32_16x16x32_bf16 v[52:55], a[48:51], v[108:111], v[52:55]
  s_waitcnt vmcnt(11) lgkmcnt(2)
  s_barrier
  v_mfma_f32_16x16x32_bf16 v[52:55], a[60:63], v[112:115], v[52:55]
  ds_read_b128 v[96:99], v1 offset:64512
  ds_write_b16 v21, v16
  v_mfma_f32_16x16x32_bf16 v[56:59], a[60:63], v[80:83], v[56:59]
  ds_read_b128 v[28:31], v116
  v_mfma_f32_16x16x32_bf16 v[56:59], a[48:51], v[76:79], v[56:59]
  ds_read_b128 v[32:35], v117 offset:1024
  v_mfma_f32_16x16x32_bf16 v[64:67], a[52:55], v[76:79], v[64:67]
  ds_read_b128 v[104:107], v2 offset:49152
  v_mfma_f32_16x16x32_bf16 v[64:67], a[64:67], v[80:83], v[64:67]
  buffer_load_dwordx4 v12, s[8:11], s69 offen offset:3072 sc1 lds
  ds_read_b128 v[36:39], v116 offset:1024
  v_mfma_f32_16x16x32_bf16 v[60:63], a[64:67], v[112:115], v[60:63]
  ds_read_b64_tr_b16 v[40:41], v119 offset:2048
  v_mfma_f32_16x16x32_bf16 v[60:63], a[52:55], v[108:111], v[60:63]
  ds_read_b128 v[100:103], v2 offset:50176
  v_mfma_f32_16x16x32_bf16 v[68:71], a[56:59], v[108:111], v[68:71]
  s_add_u32 m0, s70, 98304
  s_add_u32 s69, s58, 163840
  v_mfma_f32_16x16x32_bf16 v[68:71], a[68:71], v[112:115], v[68:71]
  buffer_load_dwordx4 v12, s[8:11], s69 offen offset:0 sc1 lds
  ds_read_b64_tr_b16 v[42:43], v118 offset:2048
  v_mfma_f32_16x16x32_bf16 v[72:75], a[68:71], v[80:83], v[72:75]
  ds_read_b128 v[108:111], v2 offset:57344
  v_mfma_f32_16x16x32_bf16 v[72:75], a[56:59], v[76:79], v[72:75]
  s_waitcnt lgkmcnt(9)
  ds_read_b64_tr_b16 v[44:45], v119 offset:2056
  v_mfma_f32_16x16x32_bf16 v[52:55], a[72:75], v[88:91], v[52:55]
  ds_read_b64_tr_b16 v[46:47], v118 offset:2056
  v_mfma_f32_16x16x32_bf16 v[52:55], a[84:87], v[84:87], v[52:55]
  ds_read_b128 v[112:115], v2 offset:58368
  v_mfma_f32_16x16x32_bf16 v[56:59], a[84:87], v[96:99], v[56:59]
  buffer_load_dwordx4 v12, s[8:11], s69 offen offset:1024 sc1 lds
  v_mfma_f32_16x16x32_bf16 v[56:59], a[72:75], v[92:95], v[56:59]
  v_mfma_f32_16x16x32_bf16 v[64:67], a[76:79], v[92:95], v[64:67]
  ds_read_b128 v[80:83], v2 offset:51200
  v_mfma_f32_16x16x32_bf16 v[64:67], a[88:91], v[96:99], v[64:67]
  s_waitcnt lgkmcnt(2)
  v_mfma_f32_16x16x32_bf16 v[116:119], v[32:35], v[28:31], 0
  v_mfma_f32_16x16x32_bf16 v[120:123], v[36:39], v[28:31], 0
  v_mfma_f32_16x16x32_bf16 v[60:63], a[88:91], v[84:87], v[60:63]
  v_mfma_f32_16x16x32_bf16 v[60:63], a[76:79], v[88:91], v[60:63]
  ds_read_b128 v[76:79], v2 offset:52224
  v_mfma_f32_16x16x32_bf16 v[68:71], a[80:83], v[88:91], v[68:71]
  buffer_load_dwordx4 v12, s[8:11], s69 offen offset:2048 sc1 lds
  v_mfma_f32_16x16x32_bf16 v[68:71], a[92:95], v[84:87], v[68:71]
  s_nop 1
  v_cndmask_b32 v48, v116, v120, s[80:81]
  v_cndmask_b32 v49, v117, v121, s[82:83]
  v_mfma_f32_16x16x32_bf16 v[72:75], a[92:95], v[96:99], v[72:75]
  ds_read_b128 v[88:91], v2 offset:59392
  v_cndmask_b32 v50, v118, v122, s[84:85]
  v_mfma_f32_16x16x32_bf16 v[72:75], a[80:83], v[92:95], v[72:75]
  s_waitcnt lgkmcnt(3)
  v_cndmask_b32 v51, v119, v123, s[86:87]
  v_cndmask_b32 v48, v48, v49, s[88:89]
  v_mfma_f32_16x16x32_bf16 v[52:55], a[96:99], v[104:107], v[52:55]
  buffer_load_dwordx4 v12, s[8:11], s69 offen offset:3072 sc1 lds
  v_cndmask_b32 v49, v50, v51, s[88:89]
  v_mul_f32 v48, 0x3e8293ee, v48
  v_mfma_f32_16x16x32_bf16 v[52:55], a[108:111], v[100:103], v[52:55]
  ds_read_b128 v[84:87], v2 offset:60416
  v_mul_f32 v49, 0x3e8293ee, v49
  v_mfma_f32_16x16x32_bf16 v[56:59], a[108:111], v[112:115], v[56:59]
  v_mov_b32 v50, 0xce6e6b28
  v_cndmask_b32 v48, v48, v50, s[90:91]
  v_mfma_f32_16x16x32_bf16 v[56:59], a[96:99], v[108:111], v[56:59]
  s_add_u32 m0, s45, 81920
  s_mov_b32 s68, 1572864
  v_mfma_f32_16x16x32_bf16 v[64:67], a[100:103], v[108:111], v[64:67]
  ds_read_b128 v[96:99], v2 offset:53248
  v_cndmask_b32 v49, v49, v50, s[92:93]
  v_mfma_f32_16x16x32_bf16 v[64:67], a[112:115], v[112:115], v[64:67]
  buffer_load_dwordx4 v11, s[20:23], s68 offen nt lds
  v_max_f32 v50, v48, v49
  v_mov_b32 v51, v50
  v_mfma_f32_16x16x32_bf16 v[60:63], a[112:115], v[100:103], v[60:63]
  s_nop 0
  v_permlane16_swap_b32 v50, v51
  v_mfma_f32_16x16x32_bf16 v[60:63], a[100:103], v[104:107], v[60:63]
  ds_read_b128 v[92:95], v2 offset:54272
  v_max_f32 v50, v50, v51
  v_mfma_f32_16x16x32_bf16 v[68:71], a[104:107], v[104:107], v[68:71]
  v_mov_b32 v51, v50
  v_mfma_f32_16x16x32_bf16 v[68:71], a[116:119], v[100:103], v[68:71]
  s_add_u32 m0, s45, 86016
  s_add_u32 s68, s68, 393216
  v_mfma_f32_16x16x32_bf16 v[72:75], a[116:119], v[112:115], v[72:75]
  ds_read_b128 v[104:107], v2 offset:61440
  v_mfma_f32_16x16x32_bf16 v[72:75], a[104:107], v[108:111], v[72:75]
  s_waitcnt lgkmcnt(3)
  buffer_load_dwordx4 v11, s[20:23], s68 offen nt lds
  v_mfma_f32_16x16x32_bf16 v[52:55], a[120:123], v[80:83], v[52:55]
  v_permlane32_swap_b32 v50, v51
  v_mfma_f32_16x16x32_bf16 v[52:55], a[132:135], v[76:79], v[52:55]
  ds_read_b128 v[100:103], v2 offset:62464
  v_max_f32 v50, v50, v51
  v_mfma_f32_16x16x32_bf16 v[56:59], a[132:135], v[84:87], v[56:59]
  s_add_u32 m0, s45, 90112
  s_add_u32 s68, s68, 393216
  v_sub_f32 v48, v48, v50
  v_mfma_f32_16x16x32_bf16 v[56:59], a[120:123], v[88:91], v[56:59]
  buffer_load_dwordx4 v11, s[20:23], s68 offen nt lds
  v_sub_f32 v49, v49, v50
  v_mfma_f32_16x16x32_bf16 v[64:67], a[124:127], v[88:91], v[64:67]
  ds_read_b128 v[112:115], v2 offset:55296
  v_mfma_f32_16x16x32_bf16 v[64:67], a[136:139], v[84:87], v[64:67]
  v_exp_f32 v48, v48
  v_mfma_f32_16x16x32_bf16 v[60:63], a[136:139], v[76:79], v[60:63]
  s_add_u32 m0, s45, 94208
  s_add_u32 s68, s68, 393216
  v_mfma_f32_16x16x32_bf16 v[60:63], a[124:127], v[80:83], v[60:63]
  ds_read_b128 v[108:111], v2 offset:56320
  v_mfma_f32_16x16x32_bf16 v[68:71], a[128:131], v[80:83], v[68:71]
  buffer_load_dwordx4 v11, s[20:23], s68 offen nt lds
  v_exp_f32 v49, v49
  v_mfma_f32_16x16x32_bf16 v[68:71], a[140:143], v[76:79], v[68:71]
  v_add_f32 v50, v48, v49
  v_mov_b32 v51, v50
  v_mfma_f32_16x16x32_bf16 v[72:75], a[140:143], v[84:87], v[72:75]
  ds_read_b128 v[80:83], v2 offset:63488
  v_mfma_f32_16x16x32_bf16 v[72:75], a[128:131], v[88:91], v[72:75]
  s_waitcnt lgkmcnt(3)
  v_permlane16_swap_b32 v50, v51
  v_mfma_f32_16x16x32_bf16 v[52:55], a[144:147], v[96:99], v[52:55]
  v_add_f32 v50, v50, v51
  v_mov_b32 v51, v50
  v_mfma_f32_16x16x32_bf16 v[52:55], a[156:159], v[92:95], v[52:55]
  ds_read_b128 v[76:79], v2 offset:64512
  v_mfma_f32_16x16x32_bf16 v[56:59], a[156:159], v[100:103], v[56:59]
  v_permlane32_swap_b32 v50, v51
  v_mfma_f32_16x16x32_bf16 v[56:59], a[144:147], v[104:107], v[56:59]
  s_waitcnt vmcnt(8) lgkmcnt(15)
  s_barrier
  v_mfma_f32_16x16x32_bf16 v[64:67], a[148:151], v[104:107], v[64:67]
  ds_read_b128 v[84:87], v1 offset:0
  v_add_f32 v50, v50, v51
  v_mfma_f32_16x16x32_bf16 v[64:67], a[160:163], v[100:103], v[64:67]
  v_rcp_f32 v50, v50
  v_mfma_f32_16x16x32_bf16 v[60:63], a[160:163], v[92:95], v[60:63]
  v_mul_f32 v48, v48, v50
  v_mul_f32 v49, v49, v50
  v_mfma_f32_16x16x32_bf16 v[60:63], a[148:151], v[96:99], v[60:63]
  ds_read_b128 v[88:91], v1 offset:1024
  v_cvt_pk_bf16_f32 v48, v48, v48
  v_mfma_f32_16x16x32_bf16 v[68:71], a[152:155], v[96:99], v[68:71]
  v_cvt_pk_bf16_f32 v49, v49, v49
  v_and_b32 v28, v24, v48
  v_mfma_f32_16x16x32_bf16 v[68:71], a[164:167], v[92:95], v[68:71]
  v_and_b32 v29, v25, v49
  v_and_b32 v30, v26, v48
  v_mfma_f32_16x16x32_bf16 v[72:75], a[164:167], v[100:103], v[72:75]
  ds_read_b128 v[96:99], v1 offset:8192
  v_and_b32 v31, v27, v49
  v_mfma_f32_16x16x32_bf16 v[72:75], a[152:155], v[104:107], v[72:75]
  s_waitcnt lgkmcnt(3)
  v_mfma_f32_16x16x32_bf16 v[32:35], v[40:43], v[28:31], 0
  v_mfma_f32_16x16x32_bf16 v[36:39], v[44:47], v[28:31], 0
  v_mfma_f32_16x16x32_bf16 v[52:55], a[168:171], v[112:115], v[52:55]
  v_mfma_f32_16x16x32_bf16 v[52:55], a[180:183], v[108:111], v[52:55]
  ds_read_b128 v[92:95], v1 offset:9216
  v_mfma_f32_16x16x32_bf16 v[56:59], a[180:183], v[76:79], v[56:59]
  v_mfma_f32_16x16x32_bf16 v[56:59], a[168:171], v[80:83], v[56:59]
  s_nop 1
  v_cvt_pk_bf16_f32 v116, v32, v33
  v_cvt_pk_bf16_f32 v117, v34, v35
  v_mfma_f32_16x16x32_bf16 v[64:67], a[172:175], v[80:83], v[64:67]
  ds_read_b128 v[100:103], v1 offset:2048
  v_cvt_pk_bf16_f32 v118, v36, v37
  v_mfma_f32_16x16x32_bf16 v[64:67], a[184:187], v[76:79], v[64:67]
  v_cvt_pk_bf16_f32 v119, v38, v39
  v_mfma_f32_16x16x32_bf16 v[60:63], a[184:187], v[108:111], v[60:63]
  buffer_store_dwordx4 v[116:119], v1, s[8:11], s73 offen sc1
  v_mfma_f32_16x16x32_bf16 v[60:63], a[172:175], v[112:115], v[60:63]
  ds_read_b128 v[104:107], v1 offset:3072
  s_add_u32 s73, s73, 65536
  v_mfma_f32_16x16x32_bf16 v[68:71], a[176:179], v[112:115], v[68:71]
  v_mfma_f32_16x16x32_bf16 v[68:71], a[188:191], v[108:111], v[68:71]
  v_mfma_f32_16x16x32_bf16 v[72:75], a[188:191], v[76:79], v[72:75]
  ds_read_b128 v[112:115], v1 offset:10240
  v_mfma_f32_16x16x32_bf16 v[72:75], a[176:179], v[80:83], v[72:75]
  s_waitcnt lgkmcnt(3)
  v_mfma_f32_16x16x32_bf16 v[52:55], a[192:195], v[84:87], v[52:55]
  v_mfma_f32_16x16x32_bf16 v[52:55], a[204:207], v[88:91], v[52:55]
  ds_read_b128 v[108:111], v1 offset:11264
  v_mfma_f32_16x16x32_bf16 v[56:59], a[204:207], v[92:95], v[56:59]
  v_mfma_f32_16x16x32_bf16 v[56:59], a[192:195], v[96:99], v[56:59]
  v_mfma_f32_16x16x32_bf16 v[64:67], a[196:199], v[96:99], v[64:67]
  ds_read_b128 v[76:79], v1 offset:4096
  v_lshrrev_b32 v40, 4, v0
  v_lshlrev_b32 v40, 4, v40
  v_mfma_f32_16x16x32_bf16 v[64:67], a[208:211], v[92:95], v[64:67]
  v_add_u32 v41, 160768, v40
  v_mfma_f32_16x16x32_bf16 v[60:63], a[208:211], v[88:91], v[60:63]
  ds_read_b64_tr_b16 v[116:117], v3 offset:16384
  v_mfma_f32_16x16x32_bf16 v[60:63], a[196:199], v[84:87], v[60:63]
  ds_read_b128 v[80:83], v1 offset:5120
  ds_read_b64_tr_b16 v[118:119], v3 offset:18432
  v_mfma_f32_16x16x32_bf16 v[68:71], a[200:203], v[84:87], v[68:71]
  ds_read_b128 v[28:31], v41 offset:0
  v_mfma_f32_16x16x32_bf16 v[68:71], a[212:215], v[88:91], v[68:71]
  v_mfma_f32_16x16x32_bf16 v[72:75], a[212:215], v[92:95], v[72:75]
  ds_read_b128 v[84:87], v1 offset:12288
  v_mfma_f32_16x16x32_bf16 v[72:75], a[200:203], v[96:99], v[72:75]
  s_waitcnt lgkmcnt(6)
  s_add_u32 m0, s70, 32768
  s_add_u32 s69, s59, 163840
  v_mfma_f32_16x16x32_bf16 v[52:55], a[216:219], v[100:103], v[52:55]
  buffer_load_dwordx4 v12, s[8:11], s69 offen offset:0 sc1 lds
  v_mfma_f32_16x16x32_bf16 v[52:55], a[228:231], v[104:107], v[52:55]
  ds_read_b128 v[88:91], v1 offset:13312
  v_mfma_f32_16x16x32_bf16 v[56:59], a[228:231], v[108:111], v[56:59]
  v_mfma_f32_16x16x32_bf16 v[56:59], a[216:219], v[112:115], v[56:59]
  v_mfma_f32_16x16x32_bf16 v[64:67], a[220:223], v[112:115], v[64:67]
  ds_read_b128 v[92:95], v1 offset:6144
  ds_read_b64_tr_b16 v[120:121], v3 offset:20480
  v_mfma_f32_16x16x32_bf16 v[64:67], a[232:235], v[108:111], v[64:67]
  ds_read_b64_tr_b16 v[122:123], v3 offset:22528
  s_waitcnt lgkmcnt(5)
  v_mfma_f32_16x16x32_bf16 v[36:39], v[116:119], v[28:31], 0
  v_mfma_f32_16x16x32_bf16 v[60:63], a[232:235], v[104:107], v[60:63]
  buffer_load_dwordx4 v12, s[8:11], s69 offen offset:1024 sc1 lds
  ds_read_b128 v[32:35], v41 offset:64
  v_mfma_f32_16x16x32_bf16 v[60:63], a[220:223], v[100:103], v[60:63]
  ds_read_b128 v[96:99], v1 offset:7168
  v_mfma_f32_16x16x32_bf16 v[68:71], a[224:227], v[100:103], v[68:71]
  v_mfma_f32_16x16x32_bf16 v[68:71], a[236:239], v[104:107], v[68:71]
  v_mfma_f32_16x16x32_bf16 v[72:75], a[236:239], v[108:111], v[72:75]
  ds_read_b128 v[100:103], v1 offset:14336
  v_mfma_f32_16x16x32_bf16 v[72:75], a[224:227], v[112:115], v[72:75]
  s_waitcnt lgkmcnt(6)
  buffer_load_dwordx4 v12, s[8:11], s69 offen offset:2048 sc1 lds
  v_mfma_f32_16x16x32_bf16 v[52:55], a[240:243], v[76:79], v[52:55]
  v_mfma_f32_16x16x32_bf16 v[52:55], v[124:127], v[80:83], v[52:55]
  ds_read_b128 v[104:107], v1 offset:15360
  v_mfma_f32_16x16x32_bf16 v[56:59], v[124:127], v[88:91], v[56:59]
  ds_read_b64_tr_b16 v[116:117], v3 offset:24576
  v_and_b32 v42, 15, v0
  v_mfma_f32_16x16x32_bf16 v[56:59], a[240:243], v[84:87], v[56:59]
  ds_read_b64_tr_b16 v[118:119], v3 offset:26624
  buffer_load_dwordx4 v12, s[8:11], s69 offen offset:3072 sc1 lds
  s_waitcnt lgkmcnt(5)
  v_mfma_f32_16x16x32_bf16 v[36:39], v[120:123], v[32:35], v[36:39]
  v_lshl_add_u32 v40, v42, 27, v40
  s_lshr_b32 s52, s2, 2
  v_mfma_f32_16x16x32_bf16 v[64:67], a[244:247], v[84:87], v[64:67]
  ds_read_b128 v[108:111], v2 offset:0
  ds_read_b128 v[28:31], v41 offset:128
  v_mfma_f32_16x16x32_bf16 v[64:67], v[128:131], v[88:91], v[64:67]
  s_lshl_b32 s54, s52, 7
  s_lshl_b32 s52, s52, 8
  s_and_b32 s53, s2, 3
  v_mfma_f32_16x16x32_bf16 v[60:63], v[128:131], v[80:83], v[60:63]
  s_add_u32 m0, s70, 49152
  s_add_u32 s69, s60, 163840
  s_mul_i32 s79, s53, 24576
  v_mfma_f32_16x16x32_bf16 v[60:63], a[244:247], v[76:79], v[60:63]
  ds_read_b128 v[112:115], v2 offset:1024
  s_add_u32 s52, s52, s79
  v_mfma_f32_16x16x32_bf16 v[68:71], a[248:251], v[76:79], v[68:71]
  buffer_load_dwordx4 v12, s[8:11], s69 offen offset:0 sc1 lds
  s_lshl_b32 s79, s44, 6
  s_add_u32 s52, s52, s79
  v_mfma_f32_16x16x32_bf16 v[68:71], v[132:135], v[80:83], v[68:71]
  s_add_u32 s52, s52, 8192
  s_lshl_b32 s53, s53, 2
  s_add_u32 s54, s54, s53
  v_mfma_f32_16x16x32_bf16 v[72:75], v[132:135], v[88:91], v[72:75]
  ds_read_b128 v[76:79], v2 offset:8192
  s_add_u32 s54, s54, 720896
  v_mfma_f32_16x16x32_bf16 v[72:75], a[248:251], v[84:87], v[72:75]
  s_waitcnt lgkmcnt(6)
  s_cmp_eq_u32 s44, 0
  s_cselect_b32 s79, s54, 1073741824
  v_mfma_f32_16x16x32_bf16 v[52:55], v[136:139], v[92:95], v[52:55]
  ds_read_b64_tr_b16 v[120:121], v3 offset:28672
  v_mfma_f32_16x16x32_bf16 v[52:55], v[148:151], v[96:99], v[52:55]
  ds_read_b128 v[80:83], v2 offset:9216
  ds_read_b64_tr_b16 v[122:123], v3 offset:30720
  s_waitcnt lgkmcnt(5)
  v_mfma_f32_16x16x32_bf16 v[36:39], v[116:119], v[28:31], v[36:39]
  v_mfma_f32_16x16x32_bf16 v[56:59], v[148:151], v[104:107], v[56:59]
  buffer_load_dwordx4 v12, s[8:11], s69 offen offset:1024 sc1 lds
  ds_read_b128 v[32:35], v41 offset:192
  v_mfma_f32_16x16x32_bf16 v[56:59], v[136:139], v[100:103], v[56:59]
  v_mfma_f32_16x16x32_bf16 v[64:67], v[140:143], v[100:103], v[64:67]
  ds_read_b128 v[88:91], v2 offset:2048
  v_mfma_f32_16x16x32_bf16 v[64:67], v[152:155], v[104:107], v[64:67]
  v_mfma_f32_16x16x32_bf16 v[60:63], v[152:155], v[96:99], v[60:63]
  buffer_load_dwordx4 v12, s[8:11], s69 offen offset:2048 sc1 lds
  v_mfma_f32_16x16x32_bf16 v[60:63], v[140:143], v[92:95], v[60:63]
  ds_read_b128 v[84:87], v2 offset:3072
  v_mfma_f32_16x16x32_bf16 v[68:71], v[144:147], v[92:95], v[68:71]
  v_mfma_f32_16x16x32_bf16 v[68:71], v[156:159], v[96:99], v[68:71]
  s_waitcnt vmcnt(8)
  s_barrier
  v_mfma_f32_16x16x32_bf16 v[72:75], v[156:159], v[104:107], v[72:75]
  ds_read_b128 v[92:95], v2 offset:10240
  ds_read_b64_tr_b16 v[116:117], v6 offset:16384
  v_mfma_f32_16x16x32_bf16 v[72:75], v[144:147], v[100:103], v[72:75]
  s_waitcnt lgkmcnt(6)
  ds_read_b64_tr_b16 v[118:119], v6 offset:18432
  s_waitcnt lgkmcnt(5)
  v_mfma_f32_16x16x32_bf16 v[36:39], v[120:123], v[32:35], v[36:39]
  v_mfma_f32_16x16x32_bf16 v[52:55], v[160:163], v[108:111], v[52:55]
  buffer_load_dwordx4 v12, s[8:11], s69 offen offset:3072 sc1 lds
  ds_read_b128 v[28:31], v41 offset:256
  v_mfma_f32_16x16x32_bf16 v[52:55], v[172:175], v[112:115], v[52:55]
  ds_read_b128 v[96:99], v2 offset:11264
  v_mfma_f32_16x16x32_bf16 v[56:59], v[172:175], v[80:83], v[56:59]
  v_mfma_f32_16x16x32_bf16 v[56:59], v[160:163], v[76:79], v[56:59]
  s_add_u32 m0, s70, 114688
  s_add_u32 s69, s61, 163840
  v_mfma_f32_16x16x32_bf16 v[64:67], v[164:167], v[76:79], v[64:67]
  ds_read_b128 v[104:107], v2 offset:4096
  v_mfma_f32_16x16x32_bf16 v[64:67], v[176:179], v[80:83], v[64:67]
  buffer_load_dwordx4 v12, s[8:11], s69 offen offset:0 sc1 lds
  v_mfma_f32_16x16x32_bf16 v[60:63], v[176:179], v[112:115], v[60:63]
  v_mfma_f32_16x16x32_bf16 v[60:63], v[164:167], v[108:111], v[60:63]
  ds_read_b128 v[100:103], v2 offset:5120
  v_mfma_f32_16x16x32_bf16 v[68:71], v[168:171], v[108:111], v[68:71]
  ds_read_b64_tr_b16 v[120:121], v6 offset:20480
  v_mfma_f32_16x16x32_bf16 v[68:71], v[180:183], v[112:115], v[68:71]
  ds_read_b64_tr_b16 v[122:123], v6 offset:22528
  buffer_load_dwordx4 v12, s[8:11], s69 offen offset:1024 sc1 lds
  s_waitcnt lgkmcnt(5)
  v_mfma_f32_16x16x32_bf16 v[36:39], v[116:119], v[28:31], v[36:39]
  v_mfma_f32_16x16x32_bf16 v[72:75], v[180:183], v[80:83], v[72:75]
  ds_read_b128 v[108:111], v2 offset:12288
  ds_read_b128 v[32:35], v41 offset:320
  v_mfma_f32_16x16x32_bf16 v[72:75], v[168:171], v[76:79], v[72:75]
  s_waitcnt lgkmcnt(6)
  v_mfma_f32_16x16x32_bf16 v[52:55], v[184:187], v[88:91], v[52:55]
  v_mfma_f32_16x16x32_bf16 v[52:55], v[196:199], v[84:87], v[52:55]
  ds_read_b128 v[112:115], v2 offset:13312
  v_mfma_f32_16x16x32_bf16 v[56:59], v[196:199], v[96:99], v[56:59]
  buffer_load_dwordx4 v12, s[8:11], s69 offen offset:2048 sc1 lds
  v_mfma_f32_16x16x32_bf16 v[56:59], v[184:187], v[92:95], v[56:59]
  v_mfma_f32_16x16x32_bf16 v[64:67], v[188:191], v[92:95], v[64:67]
  ds_read_b128 v[80:83], v2 offset:6144
  v_mfma_f32_16x16x32_bf16 v[64:67], v[200:203], v[96:99], v[64:67]
  v_mfma_f32_16x16x32_bf16 v[60:63], v[200:203], v[84:87], v[60:63]
  ds_read_b64_tr_b16 v[116:117], v6 offset:24576
  v_mfma_f32_16x16x32_bf16 v[60:63], v[188:191], v[88:91], v[60:63]
  ds_read_b128 v[76:79], v2 offset:7168
  ds_read_b64_tr_b16 v[118:119], v6 offset:26624
  s_waitcnt lgkmcnt(5)
  v_mfma_f32_16x16x32_bf16 v[36:39], v[120:123], v[32:35], v[36:39]
  v_mfma_f32_16x16x32_bf16 v[68:71], v[192:195], v[88:91], v[68:71]
  buffer_load_dwordx4 v12, s[8:11], s69 offen offset:3072 sc1 lds
  ds_read_b128 v[28:31], v41 offset:384
  v_mfma_f32_16x16x32_bf16 v[68:71], v[204:207], v[84:87], v[68:71]
  v_mfma_f32_16x16x32_bf16 v[72:75], v[204:207], v[96:99], v[72:75]
  ds_read_b128 v[88:91], v2 offset:14336
  v_mfma_f32_16x16x32_bf16 v[72:75], v[192:195], v[92:95], v[72:75]
  s_waitcnt lgkmcnt(6)
  s_add_u32 m0, s70, 0
  s_add_u32 s69, s58, 229376
  v_mfma_f32_16x16x32_bf16 v[52:55], v[208:211], v[104:107], v[52:55]
  buffer_load_dwordx4 v12, s[8:11], s69 offen offset:0 sc1 lds
  v_mfma_f32_16x16x32_bf16 v[52:55], v[220:223], v[100:103], v[52:55]
  ds_read_b128 v[84:87], v2 offset:15360
  v_mfma_f32_16x16x32_bf16 v[56:59], v[220:223], v[112:115], v[56:59]
  v_mfma_f32_16x16x32_bf16 v[56:59], v[208:211], v[108:111], v[56:59]
  v_mfma_f32_16x16x32_bf16 v[64:67], v[212:215], v[108:111], v[64:67]
  ds_read_b128 v[96:99], v2 offset:32768
  ds_read_b64_tr_b16 v[120:121], v6 offset:28672
  v_mfma_f32_16x16x32_bf16 v[64:67], v[224:227], v[112:115], v[64:67]
  ds_read_b64_tr_b16 v[122:123], v6 offset:30720
  s_waitcnt lgkmcnt(5)
  v_mfma_f32_16x16x32_bf16 v[36:39], v[116:119], v[28:31], v[36:39]
  v_mfma_f32_16x16x32_bf16 v[60:63], v[224:227], v[100:103], v[60:63]
  buffer_load_dwordx4 v12, s[8:11], s69 offen offset:1024 sc1 lds
  ds_read_b128 v[32:35], v41 offset:448
  v_mfma_f32_16x16x32_bf16 v[60:63], v[212:215], v[104:107], v[60:63]
  ds_read_b128 v[92:95], v2 offset:33792
  v_mfma_f32_16x16x32_bf16 v[68:71], v[216:219], v[104:107], v[68:71]
  v_mfma_f32_16x16x32_bf16 v[68:71], v[228:231], v[100:103], v[68:71]
  v_mfma_f32_16x16x32_bf16 v[72:75], v[228:231], v[112:115], v[72:75]
  ds_read_b128 v[104:107], v2 offset:40960
  v_mfma_f32_16x16x32_bf16 v[72:75], v[216:219], v[108:111], v[72:75]
  s_waitcnt lgkmcnt(6)
  buffer_load_dwordx4 v12, s[8:11], s69 offen offset:2048 sc1 lds
  v_mfma_f32_16x16x32_bf16 v[52:55], v[232:235], v[80:83], v[52:55]
  v_mfma_f32_16x16x32_bf16 v[52:55], v[244:247], v[76:79], v[52:55]
  ds_read_b128 v[100:103], v2 offset:41984
  v_mfma_f32_16x16x32_bf16 v[56:59], v[244:247], v[84:87], v[56:59]
  v_mfma_f32_16x16x32_bf16 v[56:59], v[232:235], v[88:91], v[56:59]
  buffer_load_dwordx4 v12, s[8:11], s69 offen offset:3072 sc1 lds
  s_waitcnt lgkmcnt(3)
  v_mfma_f32_16x16x32_bf16 v[36:39], v[120:123], v[32:35], v[36:39]
  v_mfma_f32_16x16x32_bf16 v[64:67], v[236:239], v[88:91], v[64:67]
  ds_read_b128 v[112:115], v2 offset:34816
  v_mfma_f32_16x16x32_bf16 v[64:67], v[248:251], v[84:87], v[64:67]
  v_mfma_f32_16x16x32_bf16 v[60:63], v[248:251], v[76:79], v[60:63]
  v_mfma_f32_16x16x32_bf16 v[60:63], v[236:239], v[80:83], v[60:63]
  ds_read_b128 v[108:111], v2 offset:35840
  v_mfma_f32_16x16x32_bf16 v[68:71], v[240:243], v[80:83], v[68:71]
  s_nop 0
  buffer_store_dwordx4 v[36:39], v40, s[8:11], s52 offen sc1
  v_mfma_f32_16x16x32_bf16 v[68:71], v[252:255], v[76:79], v[68:71]
  v_mfma_f32_16x16x32_bf16 v[72:75], v[252:255], v[84:87], v[72:75]
  ds_read_b128 v[80:83], v2 offset:43008
  v_mfma_f32_16x16x32_bf16 v[72:75], v[240:243], v[88:91], v[72:75]
  s_waitcnt lgkmcnt(3)
  v_mfma_f32_16x16x32_bf16 v[28:31], a[0:3], v[96:99], 0
  v_mfma_f32_16x16x32_bf16 v[28:31], a[12:15], v[92:95], v[28:31]
  ds_read_b128 v[76:79], v2 offset:44032
  v_mfma_f32_16x16x32_bf16 v[32:35], a[12:15], v[100:103], 0
  v_mfma_f32_16x16x32_bf16 v[32:35], a[0:3], v[104:107], v[32:35]
  v_cvt_pk_bf16_f32 v52, v52, v53
  v_cvt_pk_bf16_f32 v53, v54, v55
  v_mfma_f32_16x16x32_bf16 v[40:43], a[4:7], v[104:107], 0
  ds_read_b128 v[84:87], v2 offset:36864
  v_mfma_f32_16x16x32_bf16 v[40:43], a[16:19], v[100:103], v[40:43]
  ds_write_b64 v18, v[52:53] offset:0
  v_mfma_f32_16x16x32_bf16 v[36:39], a[16:19], v[92:95], 0
  v_cvt_pk_bf16_f32 v60, v60, v61
  v_cvt_pk_bf16_f32 v61, v62, v63
  v_mfma_f32_16x16x32_bf16 v[36:39], a[4:7], v[96:99], v[36:39]
  ds_read_b128 v[88:91], v2 offset:37888
  v_cvt_pk_bf16_f32 v62, v68, v69
  v_cvt_pk_bf16_f32 v63, v70, v71
  v_mfma_f32_16x16x32_bf16 v[44:47], a[8:11], v[96:99], 0
  ds_write_b128 v17, v[60:63] offset:1024
  v_mfma_f32_16x16x32_bf16 v[44:47], a[20:23], v[92:95], v[44:47]
  v_cvt_pk_bf16_f32 v56, v56, v57
  v_cvt_pk_bf16_f32 v57, v58, v59
  v_mfma_f32_16x16x32_bf16 v[48:51], a[20:23], v[100:103], 0
  ds_read_b128 v[96:99], v2 offset:45056
  v_mfma_f32_16x16x32_bf16 v[48:51], a[8:11], v[104:107], v[48:51]
  s_waitcnt lgkmcnt(5)
  ds_write_b64 v18, v[56:57] offset:6144
  v_mfma_f32_16x16x32_bf16 v[28:31], a[24:27], v[112:115], v[28:31]
  v_cvt_pk_bf16_f32 v64, v64, v65
  v_cvt_pk_bf16_f32 v65, v66, v67
  v_mfma_f32_16x16x32_bf16 v[28:31], a[36:39], v[108:111], v[28:31]
  ds_read_b128 v[92:95], v2 offset:46080
  v_cvt_pk_bf16_f32 v66, v72, v73
  v_mfma_f32_16x16x32_bf16 v[32:35], a[36:39], v[76:79], v[32:35]
  v_cvt_pk_bf16_f32 v67, v74, v75
  v_mfma_f32_16x16x32_bf16 v[32:35], a[24:27], v[80:83], v[32:35]
  ds_write_b128 v17, v[64:67] offset:7168
  v_mfma_f32_16x16x32_bf16 v[40:43], a[28:31], v[80:83], v[40:43]
  ds_read_b128 v[100:103], v2 offset:38912
  v_mfma_f32_16x16x32_bf16 v[40:43], a[40:43], v[76:79], v[40:43]
  s_bitcmp1_b32 s44, 0
  s_mov_b32 s52, 0
  s_cselect_b32 s52, 6144, s52
  s_mov_b32 s53, 12288
  s_cselect_b32 s53, 0, s53
  v_mfma_f32_16x16x32_bf16 v[36:39], a[40:43], v[108:111], v[36:39]
  v_add_u32 v116, s52, v19
  v_add_u32 v117, s53, v19
  v_mfma_f32_16x16x32_bf16 v[36:39], a[28:31], v[112:115], v[36:39]
  ds_read_b128 v[104:107], v2 offset:39936
  v_add_u32 v118, s52, v20
  v_mfma_f32_16x16x32_bf16 v[44:47], a[32:35], v[112:115], v[44:47]
  v_add_u32 v119, s53, v20
  v_mfma_f32_16x16x32_bf16 v[44:47], a[44:47], v[108:111], v[44:47]
  s_waitcnt vmcnt(13) lgkmcnt(2)
  s_barrier
  v_mfma_f32_16x16x32_bf16 v[48:51], a[44:47], v[76:79], v[48:51]
  ds_read_b128 v[112:115], v2 offset:47104
  v_mfma_f32_16x16x32_bf16 v[48:51], a[32:35], v[80:83], v[48:51]
  s_waitcnt lgkmcnt(4)
  s_add_u32 m0, s45, 16384
  s_add_u32 s68, s67, 0
  s_and_b32 s68, s68, 7
  s_mul_i32 s68, s68, 262144
  v_mfma_f32_16x16x32_bf16 v[28:31], a[48:51], v[84:87], v[28:31]
  buffer_load_dwordx4 v10, s[16:19], s68 offen lds
  ds_read_b128 v[52:55], v116
  v_mfma_f32_16x16x32_bf16 v[28:31], a[60:63], v[88:91], v[28:31]
  ds_read_b128 v[108:111], v2 offset:48128
  v_mfma_f32_16x16x32_bf16 v[32:35], a[60:63], v[92:95], v[32:35]
  ds_read_b128 v[56:59], v117 offset:1024
  v_mfma_f32_16x16x32_bf16 v[32:35], a[48:51], v[96:99], v[32:35]
  s_add_u32 m0, s45, 20480
  s_add_u32 s68, s68, 65536
  v_mfma_f32_16x16x32_bf16 v[40:43], a[52:55], v[96:99], v[40:43]
  ds_read_b128 v[76:79], v1 offset:32768
  v_mfma_f32_16x16x32_bf16 v[40:43], a[64:67], v[92:95], v[40:43]
  buffer_load_dwordx4 v10, s[16:19], s68 offen lds
  ds_read_b128 v[60:63], v116 offset:1024
  v_mfma_f32_16x16x32_bf16 v[36:39], a[64:67], v[88:91], v[36:39]
  ds_read_b64_tr_b16 v[64:65], v119 offset:2048
  v_mfma_f32_16x16x32_bf16 v[36:39], a[52:55], v[84:87], v[36:39]
  ds_read_b128 v[80:83], v1 offset:33792
  v_mfma_f32_16x16x32_bf16 v[44:47], a[56:59], v[84:87], v[44:47]
  s_add_u32 m0, s45, 24576
  s_add_u32 s68, s68, 65536
HOP3:
  s_cbranch_execz HOP7
  v_mfma_f32_16x16x32_bf16 v[44:47], a[68:71], v[88:91], v[44:47]
  buffer_load_dwordx4 v10, s[16:19], s68 offen lds
  ds_read_b64_tr_b16 v[66:67], v118 offset:2048
  v_mfma_f32_16x16x32_bf16 v[48:51], a[68:71], v[92:95], v[48:51]
  ds_read_b128 v[84:87], v1 offset:40960
  v_mfma_f32_16x16x32_bf16 v[48:51], a[56:59], v[96:99], v[48:51]
  s_waitcnt lgkmcnt(7)
  ds_read_b64_tr_b16 v[68:69], v119 offset:2056
  v_mfma_f32_16x16x32_bf16 v[28:31], a[72:75], v[100:103], v[28:31]
  s_add_u32 m0, s45, 28672
  s_add_u32 s68, s68, 65536
  v_mfma_f32_16x16x32_bf16 v[28:31], a[84:87], v[104:107], v[28:31]
  ds_read_b128 v[88:91], v1 offset:41984
  v_mfma_f32_16x16x32_bf16 v[32:35], a[84:87], v[108:111], v[32:35]
  buffer_load_dwordx4 v10, s[16:19], s68 offen lds
  ds_read_b64_tr_b16 v[70:71], v118 offset:2056
  v_mfma_f32_16x16x32_bf16 v[32:35], a[72:75], v[112:115], v[32:35]
  v_mfma_f32_16x16x32_bf16 v[40:43], a[76:79], v[112:115], v[40:43]
  ds_read_b128 v[92:95], v1 offset:34816
  v_mfma_f32_16x16x32_bf16 v[40:43], a[88:91], v[108:111], v[40:43]
  v_mfma_f32_16x16x32_bf16 v[36:39], a[88:91], v[104:107], v[36:39]
  s_add_u32 m0, s70, 65536
  s_add_u32 s69, s59, 229376
  v_mfma_f32_16x16x32_bf16 v[36:39], a[76:79], v[100:103], v[36:39]
  ds_read_b128 v[96:99], v1 offset:35840
  s_waitcnt lgkmcnt(2)
  v_mfma_f32_16x16x32_bf16 v[116:119], v[56:59], v[52:55], 0
  v_mfma_f32_16x16x32_bf16 v[120:123], v[60:63], v[52:55], 0
  v_mfma_f32_16x16x32_bf16 v[44:47], a[80:83], v[100:103], v[44:47]
  buffer_load_dwordx4 v12, s[8:11], s69 offen offset:0 sc1 lds
  v_mfma_f32_16x16x32_bf16 v[44:47], a[92:95], v[104:107], v[44:47]
  v_mfma_f32_16x16x32_bf16 v[48:51], a[92:95], v[108:111], v[48:51]
  ds_read_b128 v[100:103], v1 offset:43008
  v_mfma_f32_16x16x32_bf16 v[48:51], a[80:83], v[112:115], v[48:51]
  s_waitcnt lgkmcnt(4)
  s_nop 0
  v_cndmask_b32 v72, v116, v120, s[80:81]
  v_cndmask_b32 v73, v117, v121, s[82:83]
  v_mfma_f32_16x16x32_bf16 v[28:31], a[96:99], v[76:79], v[28:31]
  buffer_load_dwordx4 v12, s[8:11], s69 offen offset:1024 sc1 lds
  v_cndmask_b32 v74, v118, v122, s[84:85]
  v_cndmask_b32 v75, v119, v123, s[86:87]
  v_mfma_f32_16x16x32_bf16 v[28:31], a[108:111], v[80:83], v[28:31]
  ds_read_b128 v[104:107], v1 offset:44032
  v_cndmask_b32 v72, v72, v73, s[88:89]
  v_mfma_f32_16x16x32_bf16 v[32:35], a[108:111], v[88:91], v[32:35]
  v_cndmask_b32 v73, v74, v75, s[88:89]
  v_mul_f32 v72, 0x3e8293ee, v72
  v_mfma_f32_16x16x32_bf16 v[32:35], a[96:99], v[84:87], v[32:35]
  v_mul_f32 v73, 0x3e8293ee, v73
  v_max_f32 v74, v72, v73
  v_mfma_f32_16x16x32_bf16 v[40:43], a[100:103], v[84:87], v[40:43]
  ds_read_b128 v[108:111], v1 offset:36864
  v_mov_b32 v75, v74
  v_mfma_f32_16x16x32_bf16 v[40:43], a[112:115], v[88:91], v[40:43]
  buffer_load_dwordx4 v12, s[8:11], s69 offen offset:2048 sc1 lds
  v_permlane16_swap_b32 v74, v75
  v_mfma_f32_16x16x32_bf16 v[36:39], a[112:115], v[80:83], v[36:39]
  v_max_f32 v74, v74, v75
  v_mov_b32 v75, v74
  v_mfma_f32_16x16x32_bf16 v[36:39], a[100:103], v[76:79], v[36:39]
  ds_read_b128 v[112:115], v1 offset:37888
  v_mfma_f32_16x16x32_bf16 v[44:47], a[104:107], v[76:79], v[44:47]
  v_permlane32_swap_b32 v74, v75
  v_mfma_f32_16x16x32_bf16 v[44:47], a[116:119], v[80:83], v[44:47]
  v_max_f32 v74, v74, v75
  v_sub_f32 v72, v72, v74
  v_mfma_f32_16x16x32_bf16 v[48:51], a[116:119], v[88:91], v[48:51]
  ds_read_b128 v[76:79], v1 offset:45056
  v_sub_f32 v73, v73, v74
  v_mfma_f32_16x16x32_bf16 v[48:51], a[104:107], v[84:87], v[48:51]
  s_waitcnt lgkmcnt(3)
  buffer_load_dwordx4 v12, s[8:11], s69 offen offset:3072 sc1 lds
  v_mfma_f32_16x16x32_bf16 v[28:31], a[120:123], v[92:95], v[28:31]
  v_exp_f32 v72, v72
  v_mfma_f32_16x16x32_bf16 v[28:31], a[132:135], v[96:99], v[28:31]
  ds_read_b128 v[80:83], v1 offset:46080
  v_mfma_f32_16x16x32_bf16 v[32:35], a[132:135], v[104:107], v[32:35]
  s_add_u32 m0, s45, 81920
  s_add_u32 s68, s67, 1
  s_and_b32 s68, s68, 7
  s_mul_i32 s68, s68, 262144
  v_mfma_f32_16x16x32_bf16 v[32:35], a[120:123], v[100:103], v[32:35]
  buffer_load_dwordx4 v10, s[16:19], s68 offen lds
  v_exp_f32 v73, v73
  v_mfma_f32_16x16x32_bf16 v[40:43], a[124:127], v[100:103], v[40:43]
  ds_read_b128 v[88:91], v1 offset:38912
  v_add_f32 v74, v72, v73
  v_mfma_f32_16x16x32_bf16 v[40:43], a[136:139], v[104:107], v[40:43]
  v_mov_b32 v75, v74
  v_mfma_f32_16x16x32_bf16 v[36:39], a[136:139], v[96:99], v[36:39]
  s_add_u32 m0, s45, 86016
  s_add_u32 s68, s68, 65536
  v_mfma_f32_16x16x32_bf16 v[36:39], a[124:127], v[92:95], v[36:39]
  ds_read_b128 v[84:87], v1 offset:39936
  v_mfma_f32_16x16x32_bf16 v[44:47], a[128:131], v[92:95], v[44:47]
  buffer_load_dwordx4 v10, s[16:19], s68 offen lds
  v_permlane16_swap_b32 v74, v75
  v_mfma_f32_16x16x32_bf16 v[44:47], a[140:143], v[96:99], v[44:47]
  v_add_f32 v74, v74, v75
  v_mov_b32 v75, v74
  v_mfma_f32_16x16x32_bf16 v[48:51], a[140:143], v[104:107], v[48:51]
  ds_read_b128 v[92:95], v1 offset:47104
  v_mfma_f32_16x16x32_bf16 v[48:51], a[128:131], v[100:103], v[48:51]
  s_waitcnt lgkmcnt(3)
  v_permlane32_swap_b32 v74, v75
  v_mfma_f32_16x16x32_bf16 v[28:31], a[144:147], v[108:111], v[28:31]
  s_add_u32 m0, s45, 90112
  s_add_u32 s68, s68, 65536
  v_add_f32 v74, v74, v75
  v_mfma_f32_16x16x32_bf16 v[28:31], a[156:159], v[112:115], v[28:31]
  ds_read_b128 v[96:99], v1 offset:48128
  v_mfma_f32_16x16x32_bf16 v[32:35], a[156:159], v[80:83], v[32:35]
  buffer_load_dwordx4 v10, s[16:19], s68 offen lds
  v_rcp_f32 v74, v74
  v_mfma_f32_16x16x32_bf16 v[32:35], a[144:147], v[76:79], v[32:35]
  s_waitcnt vmcnt(11)
  s_barrier
  v_mfma_f32_16x16x32_bf16 v[40:43], a[148:151], v[76:79], v[40:43]
  ds_read_b128 v[104:107], v1 offset:49152
  v_mul_f32 v72, v72, v74
  v_add_u32 v15, s46, v0
  s_mov_b64 exec, 1
  buffer_store_dword v15, v0, s[8:11], s79 offen offset:0 sc1
  s_mov_b64 exec, -1
  v_mfma_f32_16x16x32_bf16 v[40:43], a[160:163], v[80:83], v[40:43]
  s_add_u32 m0, s45, 94208
  s_add_u32 s68, s68, 65536
  v_mul_f32 v73, v73, v74
  v_mfma_f32_16x16x32_bf16 v[36:39], a[160:163], v[112:115], v[36:39]
  buffer_load_dwordx4 v10, s[16:19], s68 offen lds
  v_cvt_pk_bf16_f32 v72, v72, v72
  v_cvt_pk_bf16_f32 v73, v73, v73
  v_mfma_f32_16x16x32_bf16 v[36:39], a[148:151], v[108:111], v[36:39]
  ds_read_b128 v[100:103], v1 offset:50176
  v_and_b32 v52, v24, v72
  v_mfma_f32_16x16x32_bf16 v[44:47], a[152:155], v[108:111], v[44:47]
  v_and_b32 v53, v25, v73
  v_and_b32 v54, v26, v72
  v_mfma_f32_16x16x32_bf16 v[44:47], a[164:167], v[112:115], v[44:47]
  v_and_b32 v55, v27, v73
  v_mfma_f32_16x16x32_bf16 v[48:51], a[164:167], v[80:83], v[48:51]
  ds_read_b128 v[108:111], v1 offset:57344
  v_mfma_f32_16x16x32_bf16 v[56:59], v[64:67], v[52:55], 0
  v_mfma_f32_16x16x32_bf16 v[60:63], v[68:71], v[52:55], 0
  v_mfma_f32_16x16x32_bf16 v[48:51], a[152:155], v[76:79], v[48:51]
  s_waitcnt lgkmcnt(3)
  s_add_u32 m0, s70, 98304
  s_add_u32 s69, s60, 229376
  v_mfma_f32_16x16x32_bf16 v[28:31], a[168:171], v[88:91], v[28:31]
  buffer_load_dwordx4 v12, s[8:11], s69 offen offset:0 sc1 lds
  v_mfma_f32_16x16x32_bf16 v[28:31], a[180:183], v[84:87], v[28:31]
  ds_read_b128 v[112:115], v1 offset:58368
  v_mfma_f32_16x16x32_bf16 v[32:35], a[180:183], v[96:99], v[32:35]
  v_cvt_pk_bf16_f32 v116, v56, v57
  v_cvt_pk_bf16_f32 v117, v58, v59
  v_mfma_f32_16x16x32_bf16 v[32:35], a[168:171], v[92:95], v[32:35]
  v_cvt_pk_bf16_f32 v118, v60, v61
  v_cvt_pk_bf16_f32 v119, v62, v63
  v_mfma_f32_16x16x32_bf16 v[40:43], a[172:175], v[92:95], v[40:43]
  ds_read_b128 v[80:83], v1 offset:51200
  v_mfma_f32_16x16x32_bf16 v[40:43], a[184:187], v[96:99], v[40:43]
  buffer_load_dwordx4 v12, s[8:11], s69 offen offset:1024 sc1 lds
  buffer_store_dwordx4 v[116:119], v1, s[8:11], s73 offen sc1
  v_mfma_f32_16x16x32_bf16 v[36:39], a[184:187], v[84:87], v[36:39]
  s_add_u32 s73, s73, 65536
  v_mfma_f32_16x16x32_bf16 v[36:39], a[172:175], v[88:91], v[36:39]
  ds_read_b128 v[76:79], v1 offset:52224
  v_mfma_f32_16x16x32_bf16 v[44:47], a[176:179], v[88:91], v[44:47]
  v_mfma_f32_16x16x32_bf16 v[44:47], a[188:191], v[84:87], v[44:47]
  buffer_load_dwordx4 v12, s[8:11], s69 offen offset:2048 sc1 lds
  v_mfma_f32_16x16x32_bf16 v[48:51], a[188:191], v[96:99], v[48:51]
  ds_read_b128 v[88:91], v1 offset:59392
  v_mfma_f32_16x16x32_bf16 v[48:51], a[176:179], v[92:95], v[48:51]
  s_waitcnt lgkmcnt(3)
  v_mfma_f32_16x16x32_bf16 v[28:31], a[192:195], v[104:107], v[28:31]
  v_mfma_f32_16x16x32_bf16 v[28:31], a[204:207], v[100:103], v[28:31]
  ds_read_b128 v[84:87], v1 offset:60416
  v_mfma_f32_16x16x32_bf16 v[32:35], a[204:207], v[112:115], v[32:35]
  buffer_load_dwordx4 v12, s[8:11], s69 offen offset:3072 sc1 lds
  v_mfma_f32_16x16x32_bf16 v[32:35], a[192:195], v[108:111], v[32:35]
  v_mfma_f32_16x16x32_bf16 v[40:43], a[196:199], v[108:111], v[40:43]
  ds_read_b128 v[96:99], v1 offset:53248
  v_mfma_f32_16x16x32_bf16 v[40:43], a[208:211], v[112:115], v[40:43]
  v_mfma_f32_16x16x32_bf16 v[36:39], a[208:211], v[100:103], v[36:39]
  v_lshrrev_b32 v116, 3, v0
  v_bfe_u32 v117, v116, 1, 2
  v_mfma_f32_16x16x32_bf16 v[36:39], a[196:199], v[104:107], v[36:39]
  ds_read_b128 v[92:95], v1 offset:54272
  v_bfe_u32 v118, v0, 1, 2
  v_mfma_f32_16x16x32_bf16 v[44:47], a[200:203], v[104:107], v[44:47]
  v_xor_b32 v117, v117, v118
  s_lshl_b32 s52, s44, 3
  v_mfma_f32_16x16x32_bf16 v[44:47], a[212:215], v[100:103], v[44:47]
  v_add_u32 v116, s52, v116
  v_mul_u32_u24 v116, 7168, v116
  v_mfma_f32_16x16x32_bf16 v[48:51], a[212:215], v[112:115], v[48:51]
  ds_read_b128 v[104:107], v1 offset:61440
  v_and_b32 v118, 1, v0
  v_mfma_f32_16x16x32_bf16 v[48:51], a[200:203], v[108:111], v[48:51]
  s_waitcnt lgkmcnt(3)
  v_lshl_add_u32 v116, v118, 4, v116
  s_and_b32 s52, s2, 7
  v_mfma_f32_16x16x32_bf16 v[28:31], a[216:219], v[80:83], v[28:31]
  s_mul_i32 s52, s52, 896
  v_add_u32 v116, s52, v116
  v_lshlrev_b32 v118, 5, v117
  v_mfma_f32_16x16x32_bf16 v[28:31], a[228:231], v[76:79], v[28:31]
  ds_read_b128 v[100:103], v1 offset:62464
  s_and_b32 s53, s2, 24
  v_mfma_f32_16x16x32_bf16 v[32:35], a[228:231], v[84:87], v[32:35]
  s_lshl_b32 s52, s53, 5
  v_add3_u32 v16, v116, v118, s52
  s_lshr_b32 s52, 0x0b070602, s53
  v_mfma_f32_16x16x32_bf16 v[32:35], a[216:219], v[88:91], v[32:35]
  s_and_b32 s52, s52, 15
  s_lshl_b32 s52, s52, 6
  v_add_u32 v118, s52, v118
  v_mfma_f32_16x16x32_bf16 v[40:43], a[220:223], v[88:91], v[40:43]
  ds_read_b128 v[112:115], v1 offset:55296
  s_lshr_b32 s52, 0x15140706, s53
  v_mfma_f32_16x16x32_bf16 v[40:43], a[232:235], v[84:87], v[40:43]
  s_and_b32 s52, s52, 31
  s_lshl_b32 s52, s52, 5
  v_mov_b32 v119, s52
  v_mfma_f32_16x16x32_bf16 v[36:39], a[232:235], v[76:79], v[36:39]
  v_cmp_gt_u32 vcc, 2, v117
  s_nop 1
  v_cndmask_b32 v118, v119, v118, vcc
  v_mfma_f32_16x16x32_bf16 v[36:39], a[220:223], v[80:83], v[36:39]
  ds_read_b128 v[108:111], v1 offset:56320
  v_add_u32 v11, v116, v118
  v_mfma_f32_16x16x32_bf16 v[44:47], a[224:227], v[80:83], v[44:47]
  v_add_u32 v117, 1, v117
  v_lshrrev_b32 v117, 2, v117
  v_mfma_f32_16x16x32_bf16 v[44:47], a[236:239], v[76:79], v[44:47]
  v_lshl_add_u32 v11, v117, 30, v11
  v_mfma_f32_16x16x32_bf16 v[48:51], a[236:239], v[84:87], v[48:51]
  ds_read_b128 v[80:83], v1 offset:63488
  v_mfma_f32_16x16x32_bf16 v[48:51], a[224:227], v[88:91], v[48:51]
  s_waitcnt lgkmcnt(3)
  v_mfma_f32_16x16x32_bf16 v[28:31], a[240:243], v[96:99], v[28:31]
  v_mfma_f32_16x16x32_bf16 v[28:31], v[124:127], v[92:95], v[28:31]
  ds_read_b128 v[76:79], v1 offset:64512
  v_mfma_f32_16x16x32_bf16 v[32:35], v[124:127], v[100:103], v[32:35]
  v_mfma_f32_16x16x32_bf16 v[32:35], a[240:243], v[104:107], v[32:35]
  s_waitcnt vmcnt(23)
  s_barrier
  v_mfma_f32_16x16x32_bf16 v[40:43], a[244:247], v[104:107], v[40:43]
  ds_read_b128 v[84:87], v2 offset:49152
  s_add_u32 m0, s45, 32768
  s_add_u32 s68, s67, 2
  s_and_b32 s68, s68, 7
  s_mul_i32 s68, s68, 262144
  v_mfma_f32_16x16x32_bf16 v[40:43], v[128:131], v[100:103], v[40:43]
  buffer_load_dwordx4 v10, s[16:19], s68 offen lds
  v_mfma_f32_16x16x32_bf16 v[36:39], v[128:131], v[92:95], v[36:39]
  v_mfma_f32_16x16x32_bf16 v[36:39], a[244:247], v[96:99], v[36:39]
  ds_read_b128 v[88:91], v2 offset:50176
  v_mfma_f32_16x16x32_bf16 v[44:47], a[248:251], v[96:99], v[44:47]
  v_mfma_f32_16x16x32_bf16 v[44:47], v[132:135], v[92:95], v[44:47]
  s_add_u32 m0, s45, 36864
  s_add_u32 s68, s68, 65536
  v_mfma_f32_16x16x32_bf16 v[48:51], v[132:135], v[100:103], v[48:51]
  ds_read_b128 v[96:99], v2 offset:57344
  v_mfma_f32_16x16x32_bf16 v[48:51], a[248:251], v[104:107], v[48:51]
  s_waitcnt lgkmcnt(3)
  buffer_load_dwordx4 v10, s[16:19], s68 offen lds
  v_mfma_f32_16x16x32_bf16 v[28:31], v[136:139], v[112:115], v[28:31]
  v_mfma_f32_16x16x32_bf16 v[28:31], v[148:151], v[108:111], v[28:31]
  ds_read_b128 v[92:95], v2 offset:58368
  v_mfma_f32_16x16x32_bf16 v[32:35], v[148:151], v[76:79], v[32:35]
  s_add_u32 m0, s45, 40960
  s_add_u32 s68, s68, 65536
  v_mfma_f32_16x16x32_bf16 v[32:35], v[136:139], v[80:83], v[32:35]
  buffer_load_dwordx4 v10, s[16:19], s68 offen lds
  v_mfma_f32_16x16x32_bf16 v[40:43], v[140:143], v[80:83], v[40:43]
  ds_read_b128 v[100:103], v2 offset:51200
  v_mfma_f32_16x16x32_bf16 v[40:43], v[152:155], v[76:79], v[40:43]
  s_add_u32 m0, s45, 45056
  s_add_u32 s68, s68, 65536
  v_mfma_f32_16x16x32_bf16 v[36:39], v[152:155], v[108:111], v[36:39]
  buffer_load_dwordx4 v10, s[16:19], s68 offen lds
  v_mfma_f32_16x16x32_bf16 v[36:39], v[140:143], v[112:115], v[36:39]
  ds_read_b128 v[104:107], v2 offset:52224
  v_mfma_f32_16x16x32_bf16 v[44:47], v[144:147], v[112:115], v[44:47]
  v_mfma_f32_16x16x32_bf16 v[44:47], v[156:159], v[108:111], v[44:47]
  v_mfma_f32_16x16x32_bf16 v[48:51], v[156:159], v[76:79], v[48:51]
  ds_read_b128 v[112:115], v2 offset:59392
  s_cmp_gt_u32 s44, 1
  s_cbranch_scc1 TH4_adaLN_cond__sliding_local_dilated__swiglu_ffn__prompt_kernel
  s_cmp_eq_u32 s44, 0
  s_cselect_b64 s[4:5], s[28:29], s[32:33]
  s_lshr_b32 s57, s2, 3
  s_mul_i32 s57, s57, 57344
  s_and_b32 vcc_lo, s2, 7
  s_mul_i32 vcc_lo, vcc_lo, 896
  s_add_u32 s57, s57, vcc_lo
  v_lshrrev_b32 v15, 3, v0
  v_mul_u32_u24 v15, 6144, v15
  v_lshl_add_u32 v15, v0, 7, v15
  s_mov_b32 exec_lo, 0x7f7f7f7f
  s_mov_b32 exec_hi, 0x7f7f7f7f
  buffer_load_dword a253, v15, s[4:7], s57 offen
  s_mov_b64 exec, -1
TH4_adaLN_cond__sliding_local_dilated__swiglu_ffn__prompt_kernel:
  v_mfma_f32_16x16x32_bf16 v[48:51], v[144:147], v[80:83], v[48:51]
  s_waitcnt lgkmcnt(3)
  v_mfma_f32_16x16x32_bf16 v[28:31], v[160:163], v[84:87], v[28:31]
  v_mfma_f32_16x16x32_bf16 v[28:31], v[172:175], v[88:91], v[28:31]
  ds_read_b128 v[108:111], v2 offset:60416
  v_mfma_f32_16x16x32_bf16 v[32:35], v[172:175], v[92:95], v[32:35]
  v_mfma_f32_16x16x32_bf16 v[32:35], v[160:163], v[96:99], v[32:35]
  v_mfma_f32_16x16x32_bf16 v[40:43], v[164:167], v[96:99], v[40:43]
  ds_read_b128 v[76:79], v2 offset:53248
  v_mfma_f32_16x16x32_bf16 v[40:43], v[176:179], v[92:95], v[40:43]
  v_mfma_f32_16x16x32_bf16 v[36:39], v[176:179], v[88:91], v[36:39]
  v_mfma_f32_16x16x32_bf16 v[36:39], v[164:167], v[84:87], v[36:39]
  ds_read_b128 v[80:83], v2 offset:54272
  v_mfma_f32_16x16x32_bf16 v[44:47], v[168:171], v[84:87], v[44:47]
  v_mfma_f32_16x16x32_bf16 v[44:47], v[180:183], v[88:91], v[44:47]
  v_mfma_f32_16x16x32_bf16 v[48:51], v[180:183], v[92:95], v[48:51]
  ds_read_b128 v[84:87], v2 offset:61440
  v_mfma_f32_16x16x32_bf16 v[48:51], v[168:171], v[96:99], v[48:51]
  s_waitcnt lgkmcnt(3)
  v_mfma_f32_16x16x32_bf16 v[28:31], v[184:187], v[100:103], v[28:31]
  v_mfma_f32_16x16x32_bf16 v[28:31], v[196:199], v[104:107], v[28:31]
  ds_read_b128 v[88:91], v2 offset:62464
  v_mfma_f32_16x16x32_bf16 v[32:35], v[196:199], v[108:111], v[32:35]
  v_mfma_f32_16x16x32_bf16 v[32:35], v[184:187], v[112:115], v[32:35]
  v_mfma_f32_16x16x32_bf16 v[40:43], v[188:191], v[112:115], v[40:43]
  ds_read_b128 v[92:95], v2 offset:55296
  v_mfma_f32_16x16x32_bf16 v[40:43], v[200:203], v[108:111], v[40:43]
  v_mfma_f32_16x16x32_bf16 v[36:39], v[200:203], v[104:107], v[36:39]
  v_mfma_f32_16x16x32_bf16 v[36:39], v[188:191], v[100:103], v[36:39]
  ds_read_b128 v[96:99], v2 offset:56320
  v_mfma_f32_16x16x32_bf16 v[44:47], v[192:195], v[100:103], v[44:47]
  v_mfma_f32_16x16x32_bf16 v[44:47], v[204:207], v[104:107], v[44:47]
  v_mfma_f32_16x16x32_bf16 v[48:51], v[204:207], v[108:111], v[48:51]
  ds_read_b128 v[100:103], v2 offset:63488
  v_mfma_f32_16x16x32_bf16 v[48:51], v[192:195], v[112:115], v[48:51]
  s_waitcnt lgkmcnt(3)
  v_mfma_f32_16x16x32_bf16 v[28:31], v[208:211], v[76:79], v[28:31]
  v_mfma_f32_16x16x32_bf16 v[28:31], v[220:223], v[80:83], v[28:31]
  ds_read_b128 v[104:107], v2 offset:64512
  v_mfma_f32_16x16x32_bf16 v[32:35], v[220:223], v[88:91], v[32:35]
  v_mfma_f32_16x16x32_bf16 v[32:35], v[208:211], v[84:87], v[32:35]
  s_waitcnt vmcnt(6)
  s_barrier
  v_add_u32 v15, s46, v0
  v_add_u32 v15, 1, v15
  s_mov_b64 exec, 1
  buffer_store_dword v15, v0, s[8:11], s74 offen offset:0 sc1
  s_mov_b64 exec, -1
  v_mfma_f32_16x16x32_bf16 v[40:43], v[212:215], v[84:87], v[40:43]
  ds_read_b128 v[108:111], v1 offset:0
  s_add_u32 m0, s45, 49152
  s_add_u32 s68, s67, 3
  s_and_b32 s68, s68, 7
  s_mul_i32 s68, s68, 262144
  v_mfma_f32_16x16x32_bf16 v[40:43], v[224:227], v[88:91], v[40:43]
  buffer_load_dwordx4 v10, s[16:19], s68 offen lds
  v_mfma_f32_16x16x32_bf16 v[36:39], v[224:227], v[80:83], v[36:39]
  s_add_u32 m0, s45, 53248
  s_add_u32 s68, s68, 65536
  v_mfma_f32_16x16x32_bf16 v[36:39], v[212:215], v[76:79], v[36:39]
  ds_read_b128 v[112:115], v1 offset:1024
  v_mfma_f32_16x16x32_bf16 v[44:47], v[216:219], v[76:79], v[44:47]
  buffer_load_dwordx4 v10, s[16:19], s68 offen lds
  v_mfma_f32_16x16x32_bf16 v[44:47], v[228:231], v[80:83], v[44:47]
  v_mfma_f32_16x16x32_bf16 v[48:51], v[228:231], v[88:91], v[48:51]
  ds_read_b128 v[76:79], v1 offset:8192
  v_mfma_f32_16x16x32_bf16 v[48:51], v[216:219], v[84:87], v[48:51]
  s_waitcnt lgkmcnt(3)
  s_add_u32 m0, s45, 57344
  s_add_u32 s68, s68, 65536
  v_mfma_f32_16x16x32_bf16 v[28:31], v[232:235], v[92:95], v[28:31]
  buffer_load_dwordx4 v10, s[16:19], s68 offen lds
  s_add_u32 m0, s45, 61440
  s_add_u32 s68, s68, 65536
  v_mfma_f32_16x16x32_bf16 v[28:31], v[244:247], v[96:99], v[28:31]
  ds_read_b128 v[80:83], v1 offset:9216
  v_mfma_f32_16x16x32_bf16 v[32:35], v[244:247], v[104:107], v[32:35]
  buffer_load_dwordx4 v10, s[16:19], s68 offen lds
  v_mfma_f32_16x16x32_bf16 v[32:35], v[232:235], v[100:103], v[32:35]
  v_mfma_f32_16x16x32_bf16 v[40:43], v[236:239], v[100:103], v[40:43]
  ds_read_b128 v[88:91], v1 offset:2048
  v_mfma_f32_16x16x32_bf16 v[40:43], v[248:251], v[104:107], v[40:43]
  v_mfma_f32_16x16x32_bf16 v[36:39], v[248:251], v[96:99], v[36:39]
  v_mfma_f32_16x16x32_bf16 v[36:39], v[236:239], v[92:95], v[36:39]
  ds_read_b128 v[84:87], v1 offset:3072
  v_mfma_f32_16x16x32_bf16 v[44:47], v[240:243], v[92:95], v[44:47]
  v_mfma_f32_16x16x32_bf16 v[44:47], v[252:255], v[96:99], v[44:47]
  v_mfma_f32_16x16x32_bf16 v[48:51], v[252:255], v[104:107], v[48:51]
  ds_read_b128 v[92:95], v1 offset:10240
  v_mfma_f32_16x16x32_bf16 v[48:51], v[240:243], v[100:103], v[48:51]
  s_waitcnt lgkmcnt(3)
  v_mfma_f32_16x16x32_bf16 v[52:55], a[0:3], v[108:111], 0
  v_mfma_f32_16x16x32_bf16 v[52:55], a[12:15], v[112:115], v[52:55]
  ds_read_b128 v[96:99], v1 offset:11264
  v_mfma_f32_16x16x32_bf16 v[56:59], a[12:15], v[80:83], 0
  v_mfma_f32_16x16x32_bf16 v[56:59], a[0:3], v[76:79], v[56:59]
  v_cvt_pk_bf16_f32 v28, v28, v29
  v_cvt_pk_bf16_f32 v29, v30, v31
  v_mfma_f32_16x16x32_bf16 v[64:67], a[4:7], v[76:79], 0
  ds_read_b128 v[104:107], v1 offset:4096
  v_mfma_f32_16x16x32_bf16 v[64:67], a[16:19], v[80:83], v[64:67]
  ds_write_b64 v18, v[28:29] offset:12288
  v_mfma_f32_16x16x32_bf16 v[60:63], a[16:19], v[112:115], 0
  v_cvt_pk_bf16_f32 v36, v36, v37
  v_cvt_pk_bf16_f32 v37, v38, v39
  v_mfma_f32_16x16x32_bf16 v[60:63], a[4:7], v[108:111], v[60:63]
  ds_read_b128 v[100:103], v1 offset:5120
  v_cvt_pk_bf16_f32 v38, v44, v45
  v_cvt_pk_bf16_f32 v39, v46, v47
  v_mfma_f32_16x16x32_bf16 v[68:71], a[8:11], v[108:111], 0
  ds_write_b128 v17, v[36:39] offset:13312
  v_mfma_f32_16x16x32_bf16 v[68:71], a[20:23], v[112:115], v[68:71]
  v_cvt_pk_bf16_f32 v32, v32, v33
  v_cvt_pk_bf16_f32 v33, v34, v35
  v_mfma_f32_16x16x32_bf16 v[72:75], a[20:23], v[80:83], 0
  ds_read_b128 v[108:111], v1 offset:12288
  v_mfma_f32_16x16x32_bf16 v[72:75], a[8:11], v[76:79], v[72:75]
  s_waitcnt lgkmcnt(5)
  ds_write_b64 v18, v[32:33] offset:0
  v_mfma_f32_16x16x32_bf16 v[52:55], a[24:27], v[88:91], v[52:55]
  v_cvt_pk_bf16_f32 v40, v40, v41
  v_cvt_pk_bf16_f32 v41, v42, v43
  v_mfma_f32_16x16x32_bf16 v[52:55], a[36:39], v[84:87], v[52:55]
  ds_read_b128 v[112:115], v1 offset:13312
  v_cvt_pk_bf16_f32 v42, v48, v49
  v_mfma_f32_16x16x32_bf16 v[56:59], a[36:39], v[96:99], v[56:59]
  v_cvt_pk_bf16_f32 v43, v50, v51
  v_mfma_f32_16x16x32_bf16 v[56:59], a[24:27], v[92:95], v[56:59]
  ds_write_b128 v17, v[40:43] offset:1024
  v_mfma_f32_16x16x32_bf16 v[64:67], a[28:31], v[92:95], v[64:67]
  ds_read_b128 v[80:83], v1 offset:6144
  v_mfma_f32_16x16x32_bf16 v[64:67], a[40:43], v[96:99], v[64:67]
  s_bitcmp1_b32 s44, 0
  s_mov_b32 s52, 12288
  s_cselect_b32 s52, 0, s52
  s_mov_b32 s53, 6144
  s_cselect_b32 s53, 12288, s53
  v_mfma_f32_16x16x32_bf16 v[60:63], a[40:43], v[84:87], v[60:63]
  v_add_u32 v116, s52, v19
  v_add_u32 v117, s53, v19
  v_mfma_f32_16x16x32_bf16 v[60:63], a[28:31], v[88:91], v[60:63]
  ds_read_b128 v[76:79], v1 offset:7168
  v_add_u32 v118, s52, v20
  v_mfma_f32_16x16x32_bf16 v[68:71], a[32:35], v[88:91], v[68:71]
  v_add_u32 v119, s53, v20
  v_mfma_f32_16x16x32_bf16 v[68:71], a[44:47], v[84:87], v[68:71]
  s_waitcnt vmcnt(19) lgkmcnt(2)
  s_barrier
  v_mfma_f32_16x16x32_bf16 v[72:75], a[44:47], v[96:99], v[72:75]
  ds_read_b128 v[88:91], v1 offset:14336
  s_add_u32 m0, s45, 114688
  s_add_u32 s68, s67, 4
  s_and_b32 s68, s68, 7
  s_mul_i32 s68, s68, 262144
  v_mfma_f32_16x16x32_bf16 v[72:75], a[32:35], v[92:95], v[72:75]
  s_waitcnt lgkmcnt(4)
  buffer_load_dwordx4 v10, s[16:19], s68 offen lds
  ds_read_b128 v[28:31], v116
  v_mfma_f32_16x16x32_bf16 v[52:55], a[48:51], v[104:107], v[52:55]
  ds_read_b64_tr_b16 a[0:1], v4 offset:16384
  ds_read_b128 v[32:35], v117 offset:1024
  v_mfma_f32_16x16x32_bf16 v[52:55], a[60:63], v[100:103], v[52:55]
  ds_read_b128 v[84:87], v1 offset:15360
  s_add_u32 m0, s45, 118784
  s_add_u32 s68, s68, 65536
  v_mfma_f32_16x16x32_bf16 v[56:59], a[60:63], v[112:115], v[56:59]
  ds_read_b64_tr_b16 a[2:3], v4 offset:18432
  buffer_load_dwordx4 v10, s[16:19], s68 offen lds
  v_mfma_f32_16x16x32_bf16 v[56:59], a[48:51], v[108:111], v[56:59]
  ds_read_b64_tr_b16 a[4:5], v5 offset:16384
  ds_read_b128 v[36:39], v116 offset:1024
  v_mfma_f32_16x16x32_bf16 v[64:67], a[52:55], v[108:111], v[64:67]
  ds_read_b128 v[96:99], v2 offset:0
  s_add_u32 m0, s45, 122880
  s_add_u32 s68, s68, 65536
  v_mfma_f32_16x16x32_bf16 v[64:67], a[64:67], v[112:115], v[64:67]
  ds_read_b64_tr_b16 a[6:7], v5 offset:18432
  buffer_load_dwordx4 v10, s[16:19], s68 offen lds
  v_mfma_f32_16x16x32_bf16 v[60:63], a[64:67], v[100:103], v[60:63]
  ds_read_b64_tr_b16 a[8:9], v4 offset:20480
  ds_read_b64_tr_b16 v[40:41], v119 offset:2048
  v_mfma_f32_16x16x32_bf16 v[60:63], a[52:55], v[104:107], v[60:63]
  ds_read_b128 v[92:95], v2 offset:1024
  s_add_u32 m0, s45, 126976
  s_add_u32 s68, s68, 65536
  v_mfma_f32_16x16x32_bf16 v[68:71], a[56:59], v[104:107], v[68:71]
  ds_read_b64_tr_b16 a[10:11], v4 offset:22528
  buffer_load_dwordx4 v10, s[16:19], s68 offen lds
  v_mfma_f32_16x16x32_bf16 v[68:71], a[68:71], v[100:103], v[68:71]
  ds_read_b64_tr_b16 a[12:13], v5 offset:20480
  ds_read_b64_tr_b16 v[42:43], v118 offset:2048
  v_mfma_f32_16x16x32_bf16 v[72:75], a[68:71], v[112:115], v[72:75]
  ds_read_b128 v[104:107], v2 offset:8192
  ds_read_b64_tr_b16 v[44:45], v119 offset:2056
  v_mfma_f32_16x16x32_bf16 v[72:75], a[56:59], v[108:111], v[72:75]
  s_waitcnt lgkmcnt(13)
  ds_read_b64_tr_b16 a[14:15], v5 offset:22528
  v_mfma_f32_16x16x32_bf16 v[52:55], a[72:75], v[80:83], v[52:55]
  ds_read_b64_tr_b16 a[16:17], v4 offset:24576
  ds_read_b64_tr_b16 v[46:47], v118 offset:2056
  v_mfma_f32_16x16x32_bf16 v[52:55], a[84:87], v[76:79], v[52:55]
  ds_read_b128 v[100:103], v2 offset:9216
  v_mfma_f32_16x16x32_bf16 v[56:59], a[84:87], v[84:87], v[56:59]
  ds_read_b64_tr_b16 a[18:19], v4 offset:26624
  v_mfma_f32_16x16x32_bf16 v[56:59], a[72:75], v[88:91], v[56:59]
  ds_read_b64_tr_b16 a[20:21], v5 offset:24576
  v_mfma_f32_16x16x32_bf16 v[64:67], a[76:79], v[88:91], v[64:67]
  ds_read_b128 v[112:115], v2 offset:2048
  v_mfma_f32_16x16x32_bf16 v[64:67], a[88:91], v[84:87], v[64:67]
  ds_read_b64_tr_b16 a[22:23], v5 offset:26624
  s_waitcnt lgkmcnt(5)
  v_mfma_f32_16x16x32_bf16 v[116:119], v[32:35], v[28:31], 0
  v_mfma_f32_16x16x32_bf16 v[120:123], v[36:39], v[28:31], 0
  v_mfma_f32_16x16x32_bf16 v[60:63], a[88:91], v[76:79], v[60:63]
  ds_read_b64_tr_b16 a[24:25], v4 offset:28672
  v_mfma_f32_16x16x32_bf16 v[60:63], a[76:79], v[80:83], v[60:63]
  ds_read_b128 v[108:111], v2 offset:3072
  v_mfma_f32_16x16x32_bf16 v[68:71], a[80:83], v[80:83], v[68:71]
  ds_read_b64_tr_b16 a[26:27], v4 offset:30720
  v_mfma_f32_16x16x32_bf16 v[68:71], a[92:95], v[76:79], v[68:71]
  ds_read_b64_tr_b16 a[28:29], v5 offset:28672
  v_cndmask_b32 v48, v116, v120, s[80:81]
  v_cndmask_b32 v49, v117, v121, s[82:83]
  v_mfma_f32_16x16x32_bf16 v[72:75], a[92:95], v[84:87], v[72:75]
  ds_read_b128 v[80:83], v2 offset:10240
  v_cndmask_b32 v50, v118, v122, s[84:85]
  v_cndmask_b32 v51, v119, v123, s[86:87]
  v_mfma_f32_16x16x32_bf16 v[72:75], a[80:83], v[88:91], v[72:75]
  s_waitcnt lgkmcnt(9)
  ds_read_b64_tr_b16 a[30:31], v5 offset:30720
  v_cndmask_b32 v48, v48, v49, s[88:89]
  v_mfma_f32_16x16x32_bf16 v[52:55], a[96:99], v[96:99], v[52:55]
  s_lshl_b32 s57, s44, 28
  s_add_u32 s57, s57, s77
  buffer_load_dword v13, v14, s[8:11], s57 offen sc1
  v_cndmask_b32 v49, v50, v51, s[88:89]
  v_mfma_f32_16x16x32_bf16 v[52:55], a[108:111], v[92:95], v[52:55]
  ds_read_b128 v[76:79], v2 offset:11264
  v_mul_f32 v48, 0x3e8293ee, v48
  v_mul_f32 v49, 0x3e8293ee, v49
  v_mfma_f32_16x16x32_bf16 v[56:59], a[108:111], v[100:103], v[56:59]
  v_max_f32 v50, v48, v49
  v_mov_b32 v51, v50
  v_mfma_f32_16x16x32_bf16 v[56:59], a[96:99], v[104:107], v[56:59]
  s_nop 0
  v_permlane16_swap_b32 v50, v51
  v_max_f32 v50, v50, v51
  v_mfma_f32_16x16x32_bf16 v[64:67], a[100:103], v[104:107], v[64:67]
  ds_read_b128 v[84:87], v2 offset:4096
  s_waitcnt vmcnt(14)
  s_barrier
  v_mfma_f32_16x16x32_bf16 v[64:67], a[112:115], v[100:103], v[64:67]
  ds_read_b64_tr_b16 a[32:33], v7 offset:16384
  s_add_u32 m0, s70, 0
  s_add_u32 s69, s61, 229376
  v_mfma_f32_16x16x32_bf16 v[60:63], a[112:115], v[92:95], v[60:63]
  ds_read_b64_tr_b16 a[34:35], v7 offset:18432
  buffer_load_dwordx4 v12, s[8:11], s69 offen offset:0 sc1 lds
  v_mov_b32 v51, v50
  v_mfma_f32_16x16x32_bf16 v[60:63], a[100:103], v[96:99], v[60:63]
  ds_read_b128 v[88:91], v2 offset:5120
  v_permlane32_swap_b32 v50, v51
  v_mfma_f32_16x16x32_bf16 v[68:71], a[104:107], v[96:99], v[68:71]
  ds_read_b64_tr_b16 a[36:37], v8 offset:16384
  v_max_f32 v50, v50, v51
  v_sub_f32 v48, v48, v50
  v_mfma_f32_16x16x32_bf16 v[68:71], a[116:119], v[92:95], v[68:71]
HOP4:
  s_cbranch_execz HOP8
  ds_read_b64_tr_b16 a[38:39], v8 offset:18432
  buffer_load_dwordx4 v12, s[8:11], s69 offen offset:1024 sc1 lds
  v_sub_f32 v49, v49, v50
  v_mfma_f32_16x16x32_bf16 v[72:75], a[116:119], v[100:103], v[72:75]
  ds_read_b128 v[96:99], v2 offset:12288
  v_exp_f32 v48, v48
  v_mfma_f32_16x16x32_bf16 v[72:75], a[104:107], v[104:107], v[72:75]
  s_waitcnt lgkmcnt(7)
  ds_read_b64_tr_b16 a[40:41], v7 offset:20480
  v_mfma_f32_16x16x32_bf16 v[52:55], a[120:123], v[112:115], v[52:55]
  ds_read_b64_tr_b16 a[42:43], v7 offset:22528
  buffer_load_dwordx4 v12, s[8:11], s69 offen offset:2048 sc1 lds
  v_mfma_f32_16x16x32_bf16 v[52:55], a[132:135], v[108:111], v[52:55]
  ds_read_b128 v[92:95], v2 offset:13312
  v_exp_f32 v49, v49
  v_mfma_f32_16x16x32_bf16 v[56:59], a[132:135], v[76:79], v[56:59]
  ds_read_b64_tr_b16 a[44:45], v8 offset:20480
  v_add_f32 v50, v48, v49
  v_mov_b32 v51, v50
  v_mfma_f32_16x16x32_bf16 v[56:59], a[120:123], v[80:83], v[56:59]
  ds_read_b64_tr_b16 a[46:47], v8 offset:22528
  buffer_load_dwordx4 v12, s[8:11], s69 offen offset:3072 sc1 lds
  v_mfma_f32_16x16x32_bf16 v[64:67], a[124:127], v[80:83], v[64:67]
  ds_read_b128 v[100:103], v2 offset:6144
  v_permlane16_swap_b32 v50, v51
  v_mfma_f32_16x16x32_bf16 v[64:67], a[136:139], v[76:79], v[64:67]
  ds_read_b64_tr_b16 a[48:49], v7 offset:24576
  v_add_f32 v50, v50, v51
  v_mov_b32 v51, v50
  v_mfma_f32_16x16x32_bf16 v[60:63], a[136:139], v[108:111], v[60:63]
  ds_read_b64_tr_b16 a[50:51], v7 offset:26624
  v_permlane32_swap_b32 v50, v51
  v_mfma_f32_16x16x32_bf16 v[60:63], a[124:127], v[112:115], v[60:63]
  ds_read_b128 v[104:107], v2 offset:7168
  v_add_f32 v50, v50, v51
  v_mfma_f32_16x16x32_bf16 v[68:71], a[128:131], v[112:115], v[68:71]
  ds_read_b64_tr_b16 a[52:53], v8 offset:24576
  v_rcp_f32 v50, v50
  v_mfma_f32_16x16x32_bf16 v[68:71], a[140:143], v[108:111], v[68:71]
  ds_read_b64_tr_b16 a[54:55], v8 offset:26624
  v_mul_f32 v48, v48, v50
  v_mul_f32 v49, v49, v50
  v_mfma_f32_16x16x32_bf16 v[72:75], a[140:143], v[76:79], v[72:75]
  ds_read_b128 v[112:115], v2 offset:14336
  v_cvt_pk_bf16_f32 v48, v48, v48
  v_cvt_pk_bf16_f32 v49, v49, v49
  v_mfma_f32_16x16x32_bf16 v[72:75], a[128:131], v[80:83], v[72:75]
  s_waitcnt lgkmcnt(9)
  ds_read_b64_tr_b16 a[56:57], v7 offset:28672
  v_and_b32 v28, v24, v48
  v_mfma_f32_16x16x32_bf16 v[52:55], a[144:147], v[84:87], v[52:55]
  ds_read_b64_tr_b16 a[58:59], v7 offset:30720
  v_and_b32 v29, v25, v49
  v_and_b32 v30, v26, v48
  v_mfma_f32_16x16x32_bf16 v[52:55], a[156:159], v[88:91], v[52:55]
  ds_read_b128 v[108:111], v2 offset:15360
  v_and_b32 v31, v27, v49
  v_mfma_f32_16x16x32_bf16 v[56:59], a[156:159], v[92:95], v[56:59]
  ds_read_b64_tr_b16 a[60:61], v8 offset:28672
  v_mfma_f32_16x16x32_bf16 v[32:35], v[40:43], v[28:31], 0
  v_mfma_f32_16x16x32_bf16 v[36:39], v[44:47], v[28:31], 0
  v_mfma_f32_16x16x32_bf16 v[56:59], a[144:147], v[96:99], v[56:59]
  ds_read_b64_tr_b16 a[62:63], v8 offset:30720
  v_mfma_f32_16x16x32_bf16 v[64:67], a[148:151], v[96:99], v[64:67]
  ds_read_b128 v[76:79], v2 offset:32768
  v_mfma_f32_16x16x32_bf16 v[64:67], a[160:163], v[92:95], v[64:67]
  v_mfma_f32_16x16x32_bf16 v[60:63], a[160:163], v[88:91], v[60:63]
  s_nop 0
  v_cvt_pk_bf16_f32 v116, v32, v33
  v_cvt_pk_bf16_f32 v117, v34, v35
  v_cvt_pk_bf16_f32 v118, v36, v37
  v_mfma_f32_16x16x32_bf16 v[60:63], a[148:151], v[84:87], v[60:63]
  ds_read_b128 v[80:83], v2 offset:33792
  v_cvt_pk_bf16_f32 v119, v38, v39
  v_mfma_f32_16x16x32_bf16 v[68:71], a[152:155], v[84:87], v[68:71]
  buffer_store_dwordx4 v[116:119], v1, s[8:11], s73 offen sc1
  v_mfma_f32_16x16x32_bf16 v[68:71], a[164:167], v[88:91], v[68:71]
  s_add_u32 s73, s73, 65536
  v_mfma_f32_16x16x32_bf16 v[72:75], a[164:167], v[92:95], v[72:75]
  ds_read_b128 v[84:87], v2 offset:40960
  v_mfma_f32_16x16x32_bf16 v[72:75], a[152:155], v[96:99], v[72:75]
  s_waitcnt lgkmcnt(5)
  s_waitcnt vmcnt(5)
  s_cmp_lg_u32 s44, 0
  s_cbranch_scc1 PL5_adaLN_cond__sliding_local_dilated__swiglu_ffn__prompt_kernelx
  v_subrev_u32 v13, s46, v13
  v_subrev_u32 v13, 1, v13
  v_cmp_lt_u32 vcc, 3, v13
  s_nop 4
  s_cbranch_vccz PL5_adaLN_cond__sliding_local_dilated__swiglu_ffn__prompt_kernelx
  s_mov_b32 s57, 60000
PL5_adaLN_cond__sliding_local_dilated__swiglu_ffn__prompt_kernel:
  buffer_load_dword v13, v14, s[8:11], s77 offen sc1
  s_sub_u32 s57, s57, 1
  s_cmp_eq_u32 s57, 0
  s_waitcnt vmcnt(0)
  s_cbranch_scc1 PL5_adaLN_cond__sliding_local_dilated__swiglu_ffn__prompt_kernelx
  v_subrev_u32 v13, s46, v13
  v_subrev_u32 v13, 1, v13
  v_cmp_lt_u32 vcc, 3, v13
  s_nop 4
  s_cbranch_vccnz PL5_adaLN_cond__sliding_local_dilated__swiglu_ffn__prompt_kernel
PL5_adaLN_cond__sliding_local_dilated__swiglu_ffn__prompt_kernelx:
  s_waitcnt vmcnt(10) lgkmcnt(3)
  s_barrier
  v_mfma_f32_16x16x32_bf16 v[52:55], a[168:171], v[100:103], v[52:55]
  ds_read_b64_tr_b16 a[64:65], v4 offset:32768
  s_add_u32 m0, s45, 16384
  s_add_u32 s68, s67, 5
  s_and_b32 s68, s68, 7
  s_mul_i32 s68, s68, 262144
  v_mfma_f32_16x16x32_bf16 v[52:55], a[180:183], v[104:107], v[52:55]
  ds_read_b128 v[88:91], v2 offset:41984
  ds_read_b64_tr_b16 a[66:67], v4 offset:34816
  v_mfma_f32_16x16x32_bf16 v[56:59], a[180:183], v[108:111], v[56:59]
  ds_read_b64_tr_b16 a[68:69], v5 offset:32768
  buffer_load_dwordx4 v10, s[16:19], s68 offen lds
  v_mfma_f32_16x16x32_bf16 v[56:59], a[168:171], v[112:115], v[56:59]
  ds_read_b64_tr_b16 a[70:71], v5 offset:34816
  ds_read_b64_tr_b16 a[72:73], v4 offset:36864
  v_mfma_f32_16x16x32_bf16 v[64:67], a[172:175], v[112:115], v[64:67]
  ds_read_b128 v[92:95], v2 offset:34816
  ds_read_b64_tr_b16 a[74:75], v4 offset:38912
  s_add_u32 m0, s45, 20480
  s_add_u32 s68, s68, 65536
  v_mfma_f32_16x16x32_bf16 v[64:67], a[184:187], v[108:111], v[64:67]
  ds_read_b64_tr_b16 a[76:77], v5 offset:36864
  buffer_load_dwordx4 v10, s[16:19], s68 offen lds
  v_mfma_f32_16x16x32_bf16 v[60:63], a[184:187], v[104:107], v[60:63]
  ds_read_b64_tr_b16 a[78:79], v5 offset:38912
  ds_read_b64_tr_b16 a[80:81], v4 offset:40960
  v_mfma_f32_16x16x32_bf16 v[60:63], a[172:175], v[100:103], v[60:63]
  ds_read_b128 v[96:99], v2 offset:35840
  ds_read_b64_tr_b16 a[82:83], v4 offset:43008
  s_add_u32 m0, s45, 24576
  s_add_u32 s68, s68, 65536
  v_mfma_f32_16x16x32_bf16 v[68:71], a[176:179], v[100:103], v[68:71]
  ds_read_b64_tr_b16 a[84:85], v5 offset:40960
  buffer_load_dwordx4 v10, s[16:19], s68 offen lds
  v_mfma_f32_16x16x32_bf16 v[68:71], a[188:191], v[104:107], v[68:71]
  ds_read_b64_tr_b16 a[86:87], v5 offset:43008
  ds_read_b64_tr_b16 a[88:89], v4 offset:45056
  v_mfma_f32_16x16x32_bf16 v[72:75], a[188:191], v[108:111], v[72:75]
  ds_read_b128 v[100:103], v2 offset:43008
  ds_read_b64_tr_b16 a[90:91], v4 offset:47104
  s_add_u32 m0, s45, 28672
  s_add_u32 s68, s68, 65536
  v_mfma_f32_16x16x32_bf16 v[72:75], a[176:179], v[112:115], v[72:75]
  s_waitcnt lgkmcnt(15)
  ds_read_b64_tr_b16 a[92:93], v5 offset:45056
  buffer_load_dwordx4 v10, s[16:19], s68 offen lds
  v_mfma_f32_16x16x32_bf16 v[52:55], a[192:195], v[76:79], v[52:55]
  ds_read_b64_tr_b16 a[94:95], v5 offset:47104
  ds_read_b64_tr_b16 a[96:97], v4 offset:49152
  v_mfma_f32_16x16x32_bf16 v[52:55], a[204:207], v[80:83], v[52:55]
  ds_read_b128 v[104:107], v2 offset:44032
  ds_read_b64_tr_b16 a[98:99], v4 offset:51200
  s_add_u32 m0, s45, 81920
  s_add_u32 s68, s67, 6
  s_and_b32 s68, s68, 7
  s_mul_i32 s68, s68, 262144
  v_mfma_f32_16x16x32_bf16 v[56:59], a[204:207], v[88:91], v[56:59]
  ds_read_b64_tr_b16 a[100:101], v5 offset:49152
  buffer_load_dwordx4 v10, s[16:19], s68 offen lds
  v_mfma_f32_16x16x32_bf16 v[56:59], a[192:195], v[84:87], v[56:59]
  ds_read_b64_tr_b16 a[102:103], v5 offset:51200
  ds_read_b64_tr_b16 a[104:105], v4 offset:53248
  v_mfma_f32_16x16x32_bf16 v[64:67], a[196:199], v[84:87], v[64:67]
  ds_read_b128 v[108:111], v2 offset:36864
  ds_read_b64_tr_b16 a[106:107], v4 offset:55296
  s_add_u32 m0, s45, 86016
  s_add_u32 s68, s68, 65536
  v_mfma_f32_16x16x32_bf16 v[64:67], a[208:211], v[88:91], v[64:67]
  ds_read_b64_tr_b16 a[108:109], v5 offset:53248
  buffer_load_dwordx4 v10, s[16:19], s68 offen lds
  v_mfma_f32_16x16x32_bf16 v[60:63], a[208:211], v[80:83], v[60:63]
  ds_read_b64_tr_b16 a[110:111], v5 offset:55296
  ds_read_b64_tr_b16 a[112:113], v4 offset:57344
  v_mfma_f32_16x16x32_bf16 v[60:63], a[196:199], v[76:79], v[60:63]
  ds_read_b128 v[112:115], v2 offset:37888
  ds_read_b64_tr_b16 a[114:115], v4 offset:59392
  s_add_u32 m0, s45, 90112
  s_add_u32 s68, s68, 65536
  v_mfma_f32_16x16x32_bf16 v[68:71], a[200:203], v[76:79], v[68:71]
  ds_read_b64_tr_b16 a[116:117], v5 offset:57344
  buffer_load_dwordx4 v10, s[16:19], s68 offen lds
  v_mfma_f32_16x16x32_bf16 v[68:71], a[212:215], v[80:83], v[68:71]
  ds_read_b64_tr_b16 a[118:119], v5 offset:59392
  ds_read_b64_tr_b16 a[120:121], v4 offset:61440
  v_mfma_f32_16x16x32_bf16 v[72:75], a[212:215], v[88:91], v[72:75]
  ds_read_b128 v[76:79], v2 offset:45056
  ds_read_b64_tr_b16 a[122:123], v4 offset:63488
  s_add_u32 m0, s45, 94208
  s_add_u32 s68, s68, 65536
  v_mfma_f32_16x16x32_bf16 v[72:75], a[200:203], v[84:87], v[72:75]
  s_waitcnt lgkmcnt(15)
  ds_read_b64_tr_b16 a[124:125], v5 offset:61440
  buffer_load_dwordx4 v10, s[16:19], s68 offen lds
  v_mfma_f32_16x16x32_bf16 v[52:55], a[216:219], v[92:95], v[52:55]
  ds_read_b64_tr_b16 a[126:127], v5 offset:63488
  v_mfma_f32_16x16x32_bf16 v[52:55], a[228:231], v[96:99], v[52:55]
  ds_read_b128 v[80:83], v2 offset:46080
  v_mfma_f32_16x16x32_bf16 v[56:59], a[228:231], v[104:107], v[56:59]
  v_mfma_f32_16x16x32_bf16 v[56:59], a[216:219], v[100:103], v[56:59]
  v_mfma_f32_16x16x32_bf16 v[64:67], a[220:223], v[100:103], v[64:67]
  ds_read_b128 v[88:91], v2 offset:38912
  v_mfma_f32_16x16x32_bf16 v[64:67], a[232:235], v[104:107], v[64:67]
  v_lshlrev_b32 v21, 7, v0
  v_add_u32 v21, 720896, v21
  v_mfma_f32_16x16x32_bf16 v[60:63], a[232:235], v[96:99], v[60:63]
  s_waitcnt vmcnt(4) lgkmcnt(2)
  s_barrier
  v_add_u32 v15, s46, v0
  v_add_u32 v15, 2, v15
  s_mov_b64 exec, 1
  buffer_store_dword v15, v0, s[8:11], s74 offen offset:0 sc1
  s_mov_b64 exec, -1
  v_mfma_f32_16x16x32_bf16 v[60:63], a[220:223], v[92:95], v[60:63]
  ds_read_b128 v[84:87], v2 offset:39936
  ds_read_b64_tr_b16 a[128:129], v7 offset:49152
  s_add_u32 m0, s45, 65536
  s_add_u32 s68, s67, 7
  s_and_b32 s68, s68, 7
  s_mul_i32 s68, s68, 262144
  v_mfma_f32_16x16x32_bf16 v[68:71], a[224:227], v[92:95], v[68:71]
  ds_read_b64_tr_b16 a[130:131], v7 offset:51200
  buffer_load_dwordx4 v10, s[16:19], s68 offen lds
  v_mfma_f32_16x16x32_bf16 v[68:71], a[236:239], v[96:99], v[68:71]
  ds_read_b64_tr_b16 a[132:133], v8 offset:49152
  v_mfma_f32_16x16x32_bf16 v[72:75], a[236:239], v[104:107], v[72:75]
  ds_read_b128 v[92:95], v2 offset:47104
  ds_read_b64_tr_b16 a[134:135], v8 offset:51200
  ds_read_b64_tr_b16 a[136:137], v7 offset:53248
  v_mfma_f32_16x16x32_bf16 v[72:75], a[224:227], v[100:103], v[72:75]
  s_waitcnt lgkmcnt(8)
  ds_read_b64_tr_b16 a[138:139], v7 offset:55296
  s_add_u32 m0, s45, 69632
  s_add_u32 s68, s68, 65536
  v_mfma_f32_16x16x32_bf16 v[52:55], a[240:243], v[108:111], v[52:55]
  ds_read_b64_tr_b16 a[140:141], v8 offset:53248
  buffer_load_dwordx4 v10, s[16:19], s68 offen lds
  s_add_u32 m0, s45, 73728
  s_add_u32 s68, s68, 65536
  v_mfma_f32_16x16x32_bf16 v[52:55], v[124:127], v[112:115], v[52:55]
  ds_read_b128 v[96:99], v2 offset:48128
  ds_read_b64_tr_b16 a[142:143], v8 offset:55296
  ds_read_b64_tr_b16 a[144:145], v7 offset:57344
  v_mfma_f32_16x16x32_bf16 v[56:59], v[124:127], v[80:83], v[56:59]
  ds_read_b64_tr_b16 a[146:147], v7 offset:59392
  buffer_load_dwordx4 v10, s[16:19], s68 offen lds
  v_mfma_f32_16x16x32_bf16 v[56:59], a[240:243], v[76:79], v[56:59]
  ds_read_b64_tr_b16 a[148:149], v8 offset:57344
  s_add_u32 m0, s45, 77824
  s_add_u32 s68, s68, 65536
  v_mfma_f32_16x16x32_bf16 v[64:67], a[244:247], v[76:79], v[64:67]
  ds_read_b128 v[104:107], v1 offset:0
  ds_read_b64_tr_b16 a[150:151], v8 offset:59392
  ds_read_b64_tr_b16 a[152:153], v7 offset:61440
  v_mfma_f32_16x16x32_bf16 v[64:67], v[128:131], v[80:83], v[64:67]
  ds_read_b64_tr_b16 a[154:155], v7 offset:63488
  buffer_load_dwordx4 v10, s[16:19], s68 offen lds
  v_mfma_f32_16x16x32_bf16 v[60:63], v[128:131], v[112:115], v[60:63]
  ds_read_b64_tr_b16 a[156:157], v8 offset:61440
  s_add_u32 m0, s70, 32768
  s_add_u32 s69, s62, 0
  v_mfma_f32_16x16x32_bf16 v[60:63], a[244:247], v[108:111], v[60:63]
  ds_read_b128 v[100:103], v1 offset:1024
  ds_read_b64_tr_b16 a[158:159], v8 offset:63488
  ds_read_b64_tr_b16 a[160:161], v4 offset:16384
  v_mfma_f32_16x16x32_bf16 v[68:71], a[248:251], v[108:111], v[68:71]
  ds_read_b64_tr_b16 a[162:163], v4 offset:18432
  buffer_load_dwordx4 v9, s[8:11], s69 offen offset:0 sc1 lds
  v_mfma_f32_16x16x32_bf16 v[68:71], v[132:135], v[112:115], v[68:71]
  ds_read_b64_tr_b16 a[164:165], v5 offset:16384
  v_mfma_f32_16x16x32_bf16 v[72:75], v[132:135], v[80:83], v[72:75]
  ds_read_b128 v[108:111], v1 offset:8192
  ds_read_b64_tr_b16 a[166:167], v5 offset:18432
  ds_read_b64_tr_b16 a[168:169], v4 offset:20480
  s_lshl_b32 s57, s44, 28
  buffer_load_dwordx4 v[116:119], v21, s[8:11], s57 offen sc1
  v_mfma_f32_16x16x32_bf16 v[72:75], a[248:251], v[76:79], v[72:75]
  s_waitcnt lgkmcnt(15)
  ds_read_b64_tr_b16 a[170:171], v4 offset:22528
  v_mfma_f32_16x16x32_bf16 v[52:55], v[136:139], v[88:91], v[52:55]
  ds_read_b64_tr_b16 a[172:173], v5 offset:20480
  buffer_load_dwordx4 v9, s[8:11], s69 offen offset:1024 sc1 lds
  v_mfma_f32_16x16x32_bf16 v[52:55], v[148:151], v[84:87], v[52:55]
  ds_read_b128 v[112:115], v1 offset:9216
  ds_read_b64_tr_b16 a[174:175], v5 offset:22528
  ds_read_b64_tr_b16 a[176:177], v4 offset:24576
  v_mfma_f32_16x16x32_bf16 v[56:59], v[148:151], v[96:99], v[56:59]
  ds_read_b64_tr_b16 a[178:179], v4 offset:26624
  buffer_load_dwordx4 v9, s[8:11], s69 offen offset:2048 sc1 lds
  v_mfma_f32_16x16x32_bf16 v[56:59], v[136:139], v[92:95], v[56:59]
  ds_read_b64_tr_b16 a[180:181], v5 offset:24576
  v_mfma_f32_16x16x32_bf16 v[64:67], v[140:143], v[92:95], v[64:67]
  ds_read_b128 v[80:83], v1 offset:2048
  ds_read_b64_tr_b16 a[182:183], v5 offset:26624
  ds_read_b64_tr_b16 a[184:185], v4 offset:28672
  v_mfma_f32_16x16x32_bf16 v[64:67], v[152:155], v[96:99], v[64:67]
  ds_read_b64_tr_b16 a[186:187], v4 offset:30720
  buffer_load_dwordx4 v9, s[8:11], s69 offen offset:3072 sc1 lds
  v_mfma_f32_16x16x32_bf16 v[60:63], v[152:155], v[84:87], v[60:63]
  ds_read_b64_tr_b16 a[188:189], v5 offset:28672
  s_add_u32 m0, s70, 49152
  s_add_u32 s69, s63, 0
  v_mfma_f32_16x16x32_bf16 v[60:63], v[140:143], v[88:91], v[60:63]
  ds_read_b128 v[76:79], v1 offset:3072
  ds_read_b64_tr_b16 a[190:191], v5 offset:30720
  v_mfma_f32_16x16x32_bf16 v[68:71], v[144:147], v[88:91], v[68:71]
  buffer_load_dwordx4 v9, s[8:11], s69 offen offset:0 sc1 lds
  v_mfma_f32_16x16x32_bf16 v[68:71], v[156:159], v[84:87], v[68:71]
  v_mfma_f32_16x16x32_bf16 v[72:75], v[156:159], v[96:99], v[72:75]
  ds_read_b128 v[88:91], v1 offset:10240
  v_mfma_f32_16x16x32_bf16 v[72:75], v[144:147], v[92:95], v[72:75]
  s_waitcnt lgkmcnt(12)
  buffer_load_dwordx4 v9, s[8:11], s69 offen offset:1024 sc1 lds
  v_mfma_f32_16x16x32_bf16 v[52:55], v[160:163], v[104:107], v[52:55]
  s_waitcnt vmcnt(7) lgkmcnt(15)
  s_barrier
  v_mfma_f32_16x16x32_bf16 v[52:55], v[172:175], v[100:103], v[52:55]
  ds_read_b128 v[84:87], v1 offset:11264
  ds_read_b64_tr_b16 a[192:193], v7 offset:16384
  v_mfma_f32_16x16x32_bf16 v[56:59], v[172:175], v[112:115], v[56:59]
  ds_read_b64_tr_b16 a[194:195], v7 offset:18432
  buffer_load_dwordx4 v9, s[8:11], s69 offen offset:2048 sc1 lds
  v_mfma_f32_16x16x32_bf16 v[56:59], v[160:163], v[108:111], v[56:59]
  ds_read_b64_tr_b16 a[196:197], v8 offset:16384
  v_mfma_f32_16x16x32_bf16 v[64:67], v[164:167], v[108:111], v[64:67]
  ds_read_b128 v[96:99], v1 offset:4096
  ds_read_b64_tr_b16 a[198:199], v8 offset:18432
  ds_read_b64_tr_b16 a[200:201], v7 offset:20480
  v_mfma_f32_16x16x32_bf16 v[64:67], v[176:179], v[112:115], v[64:67]
  ds_read_b64_tr_b16 a[202:203], v7 offset:22528
  buffer_load_dwordx4 v9, s[8:11], s69 offen offset:3072 sc1 lds
  v_mfma_f32_16x16x32_bf16 v[60:63], v[176:179], v[100:103], v[60:63]
  ds_read_b64_tr_b16 a[204:205], v8 offset:20480
  s_add_u32 m0, s70, 98304
  s_add_u32 s69, s64, 0
  v_mfma_f32_16x16x32_bf16 v[60:63], v[164:167], v[104:107], v[60:63]
  ds_read_b128 v[92:95], v1 offset:5120
  ds_read_b64_tr_b16 a[206:207], v8 offset:22528
  ds_read_b64_tr_b16 a[208:209], v7 offset:24576
  v_mfma_f32_16x16x32_bf16 v[68:71], v[168:171], v[104:107], v[68:71]
  ds_read_b64_tr_b16 a[210:211], v7 offset:26624
  buffer_load_dwordx4 v9, s[8:11], s69 offen offset:0 sc1 lds
  v_mfma_f32_16x16x32_bf16 v[68:71], v[180:183], v[100:103], v[68:71]
  ds_read_b64_tr_b16 a[212:213], v8 offset:24576
  v_mfma_f32_16x16x32_bf16 v[72:75], v[180:183], v[112:115], v[72:75]
  ds_read_b128 v[104:107], v1 offset:12288
  ds_read_b64_tr_b16 a[214:215], v8 offset:26624
  ds_read_b64_tr_b16 a[216:217], v7 offset:28672
  v_mfma_f32_16x16x32_bf16 v[72:75], v[168:171], v[108:111], v[72:75]
  s_waitcnt lgkmcnt(15)
  ds_read_b64_tr_b16 a[218:219], v7 offset:30720
  v_mfma_f32_16x16x32_bf16 v[52:55], v[184:187], v[80:83], v[52:55]
  ds_read_b64_tr_b16 a[220:221], v8 offset:28672
  buffer_load_dwordx4 v9, s[8:11], s69 offen offset:1024 sc1 lds
  v_mfma_f32_16x16x32_bf16 v[52:55], v[196:199], v[76:79], v[52:55]
  ds_read_b128 v[100:103], v1 offset:13312
  ds_read_b64_tr_b16 a[222:223], v8 offset:30720
  ds_read_b64_tr_b16 a[224:225], v7 offset:0
  v_mfma_f32_16x16x32_bf16 v[56:59], v[196:199], v[84:87], v[56:59]
  ds_read_b64_tr_b16 a[226:227], v7 offset:2048
  buffer_load_dwordx4 v9, s[8:11], s69 offen offset:2048 sc1 lds
  v_mfma_f32_16x16x32_bf16 v[56:59], v[184:187], v[88:91], v[56:59]
  ds_read_b64_tr_b16 a[228:229], v8 offset:0
  v_mfma_f32_16x16x32_bf16 v[64:67], v[188:191], v[88:91], v[64:67]
  ds_read_b128 v[112:115], v1 offset:6144
  ds_read_b64_tr_b16 a[230:231], v8 offset:2048
  ds_read_b64_tr_b16 a[232:233], v7 offset:4096
  v_mfma_f32_16x16x32_bf16 v[64:67], v[200:203], v[84:87], v[64:67]
  ds_read_b64_tr_b16 a[234:235], v7 offset:6144
  buffer_load_dwordx4 v9, s[8:11], s69 offen offset:3072 sc1 lds
  v_mfma_f32_16x16x32_bf16 v[60:63], v[200:203], v[76:79], v[60:63]
  ds_read_b64_tr_b16 a[236:237], v8 offset:4096
  s_add_u32 m0, s70, 114688
  s_add_u32 s69, s65, 0
  v_mfma_f32_16x16x32_bf16 v[60:63], v[188:191], v[80:83], v[60:63]
  ds_read_b128 v[108:111], v1 offset:7168
  ds_read_b64_tr_b16 a[238:239], v8 offset:6144
  ds_read_b64_tr_b16 a[240:241], v7 offset:8192
  v_mfma_f32_16x16x32_bf16 v[68:71], v[192:195], v[80:83], v[68:71]
  ds_read_b64_tr_b16 a[242:243], v7 offset:10240
  buffer_load_dwordx4 v9, s[8:11], s69 offen offset:0 sc1 lds
  v_mfma_f32_16x16x32_bf16 v[68:71], v[204:207], v[76:79], v[68:71]
  ds_read_b64_tr_b16 a[244:245], v8 offset:8192
  v_mfma_f32_16x16x32_bf16 v[72:75], v[204:207], v[84:87], v[72:75]
  ds_read_b128 v[80:83], v1 offset:14336
  ds_read_b64_tr_b16 a[246:247], v8 offset:10240
  ds_read_b64_tr_b16 a[248:249], v7 offset:12288
  v_mfma_f32_16x16x32_bf16 v[72:75], v[192:195], v[88:91], v[72:75]
  s_waitcnt lgkmcnt(15)
  ds_read_b64_tr_b16 a[250:251], v7 offset:14336
  v_mfma_f32_16x16x32_bf16 v[52:55], v[208:211], v[96:99], v[52:55]
  ds_read_b64_tr_b16 v[124:125], v8 offset:12288
  buffer_load_dwordx4 v9, s[8:11], s69 offen offset:1024 sc1 lds
  v_mfma_f32_16x16x32_bf16 v[52:55], v[220:223], v[92:95], v[52:55]
  ds_read_b128 v[76:79], v1 offset:15360
  ds_read_b64_tr_b16 v[126:127], v8 offset:14336
  v_mfma_f32_16x16x32_bf16 v[56:59], v[220:223], v[100:103], v[56:59]
  buffer_load_dwordx4 v9, s[8:11], s69 offen offset:2048 sc1 lds
  v_mfma_f32_16x16x32_bf16 v[56:59], v[208:211], v[104:107], v[56:59]
  v_mfma_f32_16x16x32_bf16 v[64:67], v[212:215], v[104:107], v[64:67]
  v_mfma_f32_16x16x32_bf16 v[64:67], v[224:227], v[100:103], v[64:67]
  buffer_load_dwordx4 v9, s[8:11], s69 offen offset:3072 sc1 lds
  v_mfma_f32_16x16x32_bf16 v[60:63], v[224:227], v[92:95], v[60:63]
  v_mfma_f32_16x16x32_bf16 v[60:63], v[212:215], v[96:99], v[60:63]
  s_waitcnt vmcnt(15)
  s_cmp_lg_u32 s44, 0
  s_cbranch_scc1 PL6_adaLN_cond__sliding_local_dilated__swiglu_ffn__prompt_kernelx
  v_bitop3_b32 v116, v116, v117, s46 bitop3:0x7e
  v_bitop3_b32 v118, v118, v119, s46 bitop3:0x7e
  v_or_b32 v116, v116, v118
  v_cmp_ne_u32 vcc, 0, v116
  s_nop 4
  s_cbranch_vccz PL6_adaLN_cond__sliding_local_dilated__swiglu_ffn__prompt_kernelx
  s_mov_b32 s57, 60000
PL6_adaLN_cond__sliding_local_dilated__swiglu_ffn__prompt_kernel:
  buffer_load_dwordx4 v[116:119], v21, s[8:11], 0 offen sc1
  s_sub_u32 s57, s57, 1
  s_cmp_eq_u32 s57, 0
  s_waitcnt vmcnt(0)
  s_cbranch_scc1 PL6_adaLN_cond__sliding_local_dilated__swiglu_ffn__prompt_kernelx
  v_bitop3_b32 v116, v116, v117, s46 bitop3:0x7e
  v_bitop3_b32 v118, v118, v119, s46 bitop3:0x7e
  v_or_b32 v116, v116, v118
  v_cmp_ne_u32 vcc, 0, v116
  s_nop 4
  s_cbranch_vccnz PL6_adaLN_cond__sliding_local_dilated__swiglu_ffn__prompt_kernel
PL6_adaLN_cond__sliding_local_dilated__swiglu_ffn__prompt_kernelx:
  s_waitcnt vmcnt(8) lgkmcnt(0)
  s_barrier
  v_mfma_f32_16x16x32_bf16 v[68:71], v[216:219], v[96:99], v[68:71]
  ds_read_b128 v[84:87], v22 offset:32768
  s_add_u32 m0, s70, 16384
  s_add_u32 s69, s62, 65536
  v_mfma_f32_16x16x32_bf16 v[68:71], v[228:231], v[92:95], v[68:71]
  v_and_b32 v21, 31, v0
  v_lshlrev_b32 v21, 2, v21
  v_lshrrev_b32 v181, 5, v0
  v_lshl_add_u32 v21, v181, 13, v21
  v_mfma_f32_16x16x32_bf16 v[72:75], v[228:231], v[100:103], v[72:75]
  ds_read_b128 v[88:91], v22 offset:33792
  buffer_load_dwordx4 v9, s[8:11], s69 offen offset:0 sc1 lds
  v_mfma_f32_16x16x32_bf16 v[72:75], v[216:219], v[104:107], v[72:75]
  s_waitcnt lgkmcnt(3)
  v_mfma_f32_16x16x32_bf16 v[52:55], v[232:235], v[112:115], v[52:55]
  ds_read_b128 v[96:99], v22 offset:34816
  v_mfma_f32_16x16x32_bf16 v[52:55], v[244:247], v[108:111], v[52:55]
  buffer_load_dwordx4 v9, s[8:11], s69 offen offset:1024 sc1 lds
  v_mfma_f32_16x16x32_bf16 v[56:59], v[244:247], v[76:79], v[56:59]
  ds_read_b128 v[92:95], v22 offset:35840
  v_mfma_f32_16x16x32_bf16 v[56:59], v[232:235], v[80:83], v[56:59]
  buffer_load_dwordx4 v9, s[8:11], s69 offen offset:2048 sc1 lds
  v_mfma_f32_16x16x32_bf16 v[64:67], v[236:239], v[80:83], v[64:67]
  ds_read_b128 v[100:103], v22 offset:36864
  v_mfma_f32_16x16x32_bf16 v[64:67], v[248:251], v[76:79], v[64:67]
  v_mfma_f32_16x16x32_bf16 v[60:63], v[248:251], v[108:111], v[60:63]
  ds_read_b128 v[104:107], v22 offset:37888
  v_mfma_f32_16x16x32_bf16 v[60:63], v[236:239], v[112:115], v[60:63]
  buffer_load_dwordx4 v9, s[8:11], s69 offen offset:3072 sc1 lds
  s_add_u32 s56, s76, 8192
  v_mfma_f32_16x16x32_bf16 v[68:71], v[240:243], v[112:115], v[68:71]
  ds_read_b128 v[112:115], v22 offset:38912
  v_mfma_f32_16x16x32_bf16 v[68:71], v[252:255], v[108:111], v[68:71]
  buffer_load_dword v160, v21, s[8:11], s56 offen sc1
  s_add_u32 s56, s76, 32768
  v_mfma_f32_16x16x32_bf16 v[72:75], v[252:255], v[76:79], v[72:75]
  ds_read_b128 v[108:111], v22 offset:39936
  v_mfma_f32_16x16x32_bf16 v[72:75], v[240:243], v[80:83], v[72:75]
  s_waitcnt lgkmcnt(4)
  buffer_load_dword v161, v21, s[8:11], s56 offen sc1
  s_add_u32 s56, s76, 57344
  v_mfma_f32_16x16x32_bf16 v[128:131], a[0:3], v[84:87], 0
  ds_read_b128 v[76:79], v22 offset:49152
  buffer_load_dword v162, v21, s[8:11], s56 offen sc1
  v_mfma_f32_16x16x32_bf16 v[128:131], a[8:11], v[88:91], v[128:131]
  s_add_u32 s56, s76, 81920
  v_mfma_f32_16x16x32_bf16 v[132:135], a[12:15], v[88:91], 0
  ds_read_b128 v[80:83], v22 offset:50176
  s_lshr_b32 s79, s2, 6
  s_lshl_b32 s79, s79, 2
  s_add_u32 s79, s79, s44
  s_lshl_b32 s79, s79, 8
  buffer_load_dword v163, v21, s[8:11], s56 offen sc1
  s_add_u32 s56, s47, 41943040
  v_mfma_f32_16x16x32_bf16 v[132:135], a[4:7], v[84:87], v[132:135]
  buffer_load_dwordx4 v[144:147], v1, s[8:11], s56 offen sc1
  s_add_u32 s56, s47, 42008576
  v_cvt_pk_bf16_f32 v52, v52, v53
  v_cvt_pk_bf16_f32 v53, v54, v55
  ds_write_b64 v18, v[52:53] offset:6144
  v_cvt_pk_bf16_f32 v60, v60, v61
  v_cvt_pk_bf16_f32 v61, v62, v63
  v_mfma_f32_16x16x32_bf16 v[128:131], a[16:19], v[96:99], v[128:131]
  ds_read_b128 v[88:91], v22 offset:51200
  v_cvt_pk_bf16_f32 v62, v68, v69
  v_cvt_pk_bf16_f32 v63, v70, v71
  ds_write_b128 v17, v[60:63] offset:7168
  v_mfma_f32_16x16x32_bf16 v[128:131], a[24:27], v[92:95], v[128:131]
  buffer_load_dwordx4 v[148:151], v1, s[8:11], s56 offen sc1
  s_add_u32 s56, s47, 42074112
  v_cvt_pk_bf16_f32 v56, v56, v57
  v_cvt_pk_bf16_f32 v57, v58, v59
  ds_write_b64 v18, v[56:57] offset:12288
  v_cvt_pk_bf16_f32 v64, v64, v65
  v_cvt_pk_bf16_f32 v65, v66, v67
  v_mfma_f32_16x16x32_bf16 v[132:135], a[28:31], v[92:95], v[132:135]
  ds_read_b128 v[84:87], v22 offset:52224
  v_cvt_pk_bf16_f32 v66, v72, v73
  v_cvt_pk_bf16_f32 v67, v74, v75
  ds_write_b128 v17, v[64:67] offset:13312
  v_mfma_f32_16x16x32_bf16 v[132:135], a[20:23], v[96:99], v[132:135]
  s_waitcnt lgkmcnt(8)
  buffer_load_dwordx4 v[152:155], v1, s[8:11], s56 offen sc1
  s_add_u32 s56, s47, 42139648
  s_bitcmp1_b32 s44, 0
  s_mov_b32 s52, 6144
  s_cselect_b32 s52, 12288, s52
  s_mov_b32 s53, 0
  s_cselect_b32 s53, 6144, s53
  v_add_u32 v116, s52, v19
  v_add_u32 v117, s53, v19
  v_mfma_f32_16x16x32_bf16 v[128:131], a[32:35], v[100:103], v[128:131]
  ds_read_b128 v[92:95], v22 offset:53248
  v_add_u32 v118, s52, v20
  v_add_u32 v119, s53, v20
  s_waitcnt vmcnt(11) lgkmcnt(1)
  s_barrier
  v_mfma_f32_16x16x32_bf16 v[128:131], a[40:43], v[104:107], v[128:131]
  buffer_load_dwordx4 v[156:159], v1, s[8:11], s56 offen sc1
  s_add_u32 m0, s70, 81920
  s_add_u32 s69, s63, 65536
  ds_read_b128 v[52:55], v116
  ds_read_b128 v[56:59], v117 offset:1024
  v_mfma_f32_16x16x32_bf16 v[132:135], a[44:47], v[104:107], v[132:135]
  ds_read_b128 v[96:99], v22 offset:54272
  ds_read_b128 v[60:63], v116 offset:1024
  ds_read_b64_tr_b16 v[64:65], v119 offset:2048
  ds_read_b64_tr_b16 v[66:67], v118 offset:2048
  v_mfma_f32_16x16x32_bf16 v[132:135], a[36:39], v[100:103], v[132:135]
  buffer_load_dwordx4 v9, s[8:11], s69 offen offset:0 sc1 lds
  ds_read_b64_tr_b16 v[68:69], v119 offset:2056
  ds_read_b64_tr_b16 v[70:71], v118 offset:2056
  v_mfma_f32_16x16x32_bf16 v[128:131], a[48:51], v[112:115], v[128:131]
  ds_read_b128 v[104:107], v22 offset:55296
  s_lshl_b32 s57, s44, 28
  s_add_u32 s57, s57, s77
  buffer_load_dword v13, v14, s[8:11], s57 offen sc1
  v_mfma_f32_16x16x32_bf16 v[128:131], a[56:59], v[108:111], v[128:131]
  v_mfma_f32_16x16x32_bf16 v[132:135], a[60:63], v[108:111], v[132:135]
  ds_read_b128 v[100:103], v22 offset:56320
  v_mfma_f32_16x16x32_bf16 v[132:135], a[52:55], v[112:115], v[132:135]
  s_waitcnt lgkmcnt(12)
  buffer_load_dwordx4 v9, s[8:11], s69 offen offset:1024 sc1 lds
  v_mfma_f32_16x16x32_bf16 v[128:131], a[64:67], v[76:79], v[128:131]
  ds_read_b128 v[108:111], v23 offset:32768
  s_waitcnt lgkmcnt(3)
  v_mfma_f32_16x16x32_bf16 v[116:119], v[56:59], v[52:55], 0
  v_mfma_f32_16x16x32_bf16 v[120:123], v[60:63], v[52:55], 0
  v_mfma_f32_16x16x32_bf16 v[128:131], a[72:75], v[80:83], v[128:131]
  buffer_load_dwordx4 v9, s[8:11], s69 offen offset:2048 sc1 lds
  v_mfma_f32_16x16x32_bf16 v[132:135], a[76:79], v[80:83], v[132:135]
  ds_read_b128 v[112:115], v23 offset:33792
  v_mfma_f32_16x16x32_bf16 v[132:135], a[68:71], v[76:79], v[132:135]
  v_mfma_f32_16x16x32_bf16 v[128:131], a[80:83], v[88:91], v[128:131]
  ds_read_b128 v[80:83], v23 offset:34816
HOP5:
  s_cbranch_execz HOP9
  s_nop 0
  v_cndmask_b32 v72, v116, v120, s[80:81]
  v_cndmask_b32 v73, v117, v121, s[82:83]
  v_cndmask_b32 v74, v118, v122, s[84:85]
  v_cndmask_b32 v75, v119, v123, s[86:87]
  v_cndmask_b32 v72, v72, v73, s[88:89]
  v_cndmask_b32 v73, v74, v75, s[88:89]
  v_mfma_f32_16x16x32_bf16 v[128:131], a[88:91], v[84:87], v[128:131]
  buffer_load_dwordx4 v9, s[8:11], s69 offen offset:3072 sc1 lds
  s_add_u32 m0, s70, 65536
  s_add_u32 s69, s64, 65536
  v_mul_f32 v72, 0x3e8293ee, v72
  v_mul_f32 v73, 0x3e8293ee, v73
  v_max_f32 v74, v72, v73
  v_mov_b32 v75, v74
  v_mfma_f32_16x16x32_bf16 v[132:135], a[92:95], v[84:87], v[132:135]
  ds_read_b128 v[76:79], v23 offset:35840
  v_permlane16_swap_b32 v74, v75
  v_max_f32 v74, v74, v75
  v_mov_b32 v75, v74
  v_mfma_f32_16x16x32_bf16 v[132:135], a[84:87], v[88:91], v[132:135]
  s_waitcnt lgkmcnt(4)
  buffer_load_dwordx4 v9, s[8:11], s69 offen offset:0 sc1 lds
  v_permlane32_swap_b32 v74, v75
  v_max_f32 v74, v74, v75
  v_sub_f32 v72, v72, v74
  v_sub_f32 v73, v73, v74
  v_mfma_f32_16x16x32_bf16 v[128:131], a[96:99], v[92:95], v[128:131]
  ds_read_b128 v[84:87], v23 offset:36864
  v_exp_f32 v72, v72
  v_exp_f32 v73, v73
  v_mfma_f32_16x16x32_bf16 v[128:131], a[104:107], v[96:99], v[128:131]
  v_add_f32 v74, v72, v73
  v_mov_b32 v75, v74
  v_mfma_f32_16x16x32_bf16 v[132:135], a[108:111], v[96:99], v[132:135]
  ds_read_b128 v[88:91], v23 offset:37888
  v_permlane16_swap_b32 v74, v75
  v_add_f32 v74, v74, v75
  v_mov_b32 v75, v74
  v_mfma_f32_16x16x32_bf16 v[132:135], a[100:103], v[92:95], v[132:135]
  buffer_load_dwordx4 v9, s[8:11], s69 offen offset:1024 sc1 lds
  v_permlane32_swap_b32 v74, v75
  v_add_f32 v74, v74, v75
  v_rcp_f32 v74, v74
  v_mfma_f32_16x16x32_bf16 v[128:131], a[112:115], v[104:107], v[128:131]
  ds_read_b128 v[96:99], v23 offset:38912
  v_mul_f32 v72, v72, v74
  v_mul_f32 v73, v73, v74
  v_cvt_pk_bf16_f32 v72, v72, v72
  v_cvt_pk_bf16_f32 v73, v73, v73
  v_and_b32 v52, v24, v72
  v_and_b32 v53, v25, v73
  v_mfma_f32_16x16x32_bf16 v[128:131], a[120:123], v[100:103], v[128:131]
  buffer_load_dwordx4 v9, s[8:11], s69 offen offset:2048 sc1 lds
  v_and_b32 v54, v26, v72
  v_and_b32 v55, v27, v73
  v_mfma_f32_16x16x32_bf16 v[132:135], a[124:127], v[100:103], v[132:135]
  ds_read_b128 v[92:95], v23 offset:39936
  v_mfma_f32_16x16x32_bf16 v[56:59], v[64:67], v[52:55], 0
  v_mfma_f32_16x16x32_bf16 v[60:63], v[68:71], v[52:55], 0
  v_mfma_f32_16x16x32_bf16 v[132:135], a[116:119], v[104:107], v[132:135]
  s_waitcnt lgkmcnt(4)
  v_mfma_f32_16x16x32_bf16 v[128:131], a[128:131], v[108:111], v[128:131]
  ds_read_b128 v[100:103], v23 offset:49152
  v_mfma_f32_16x16x32_bf16 v[128:131], a[136:139], v[112:115], v[128:131]
  buffer_load_dwordx4 v9, s[8:11], s69 offen offset:3072 sc1 lds
  s_add_u32 m0, s70, 0
  s_add_u32 s69, s65, 65536
  v_mfma_f32_16x16x32_bf16 v[132:135], a[140:143], v[112:115], v[132:135]
  ds_read_b128 v[104:107], v23 offset:50176
  v_cvt_pk_bf16_f32 v116, v56, v57
  v_cvt_pk_bf16_f32 v117, v58, v59
  v_cvt_pk_bf16_f32 v118, v60, v61
  v_cvt_pk_bf16_f32 v119, v62, v63
  v_mfma_f32_16x16x32_bf16 v[132:135], a[132:135], v[108:111], v[132:135]
  buffer_load_dwordx4 v9, s[8:11], s69 offen offset:0 sc1 lds
  buffer_store_dwordx4 v[116:119], v1, s[8:11], s73 offen sc1
  s_add_u32 s73, s73, 65536
  v_mfma_f32_16x16x32_bf16 v[128:131], a[144:147], v[80:83], v[128:131]
  ds_read_b128 v[112:115], v23 offset:51200
  v_mfma_f32_16x16x32_bf16 v[128:131], a[152:155], v[76:79], v[128:131]
  v_mfma_f32_16x16x32_bf16 v[132:135], a[156:159], v[76:79], v[132:135]
  ds_read_b128 v[108:111], v23 offset:52224
  v_mfma_f32_16x16x32_bf16 v[132:135], a[148:151], v[80:83], v[132:135]
  s_waitcnt lgkmcnt(4)
  buffer_load_dwordx4 v9, s[8:11], s69 offen offset:1024 sc1 lds
  v_mfma_f32_16x16x32_bf16 v[128:131], a[160:163], v[84:87], v[128:131]
  ds_read_b128 v[76:79], v23 offset:53248
  s_waitcnt vmcnt(16)
  v_add_f32 v160, v160, v161
  v_mfma_f32_16x16x32_bf16 v[128:131], a[168:171], v[88:91], v[128:131]
  buffer_load_dwordx4 v9, s[8:11], s69 offen offset:2048 sc1 lds
  v_add_f32 v162, v162, v163
  v_add_f32 v160, v160, v162
  v_cvt_pk_bf16_f32 v160, v160, v160
  v_mfma_f32_16x16x32_bf16 v[132:135], a[172:175], v[88:91], v[132:135]
  ds_read_b128 v[80:83], v23 offset:54272
  v_lshlrev_b32 v160, 16, v160
  v_cvt_f32_u32 v181, v181
  v_mfma_f32_16x16x32_bf16 v[132:135], a[164:167], v[84:87], v[132:135]
  v_add_f32 v160, v160, v181
  v_cvt_pk_bf16_f32 v160, v160, v160
  v_lshlrev_b32 v160, 16, v160
  v_mfma_f32_16x16x32_bf16 v[128:131], a[176:179], v[96:99], v[128:131]
  ds_read_b128 v[88:91], v23 offset:55296
  s_lshl_b32 s54, s44, 8
  s_add_u32 s54, s54, 161792
  v_mfma_f32_16x16x32_bf16 v[128:131], a[184:187], v[92:95], v[128:131]
  buffer_load_dwordx4 v9, s[8:11], s69 offen offset:3072 sc1 lds
  v_lshl_add_u32 v180, v0, 2, s54
  v_lshrrev_b32 v161, 4, v0
  v_lshl_add_u32 v181, v161, 4, s54
  v_mfma_f32_16x16x32_bf16 v[132:135], a[188:191], v[92:95], v[132:135]
  ds_read_b128 v[84:87], v23 offset:56320
  ds_write_b32 v180, v160
  v_mfma_f32_16x16x32_bf16 v[132:135], a[180:183], v[96:99], v[132:135]
  s_waitcnt lgkmcnt(5)
  s_waitcnt vmcnt(12)
  s_cmp_lg_u32 s44, 0
  s_cbranch_scc1 PL7_adaLN_cond__sliding_local_dilated__swiglu_ffn__prompt_kernelx
  v_subrev_u32 v13, s46, v13
  v_subrev_u32 v13, 2, v13
  v_cmp_lt_u32 vcc, 3, v13
  s_nop 4
  s_cbranch_vccz PL7_adaLN_cond__sliding_local_dilated__swiglu_ffn__prompt_kernelx
  s_mov_b32 s57, 60000
PL7_adaLN_cond__sliding_local_dilated__swiglu_ffn__prompt_kernel:
  buffer_load_dword v13, v14, s[8:11], s77 offen sc1
  s_sub_u32 s57, s57, 1
  s_cmp_eq_u32 s57, 0
  s_waitcnt vmcnt(0)
  s_cbranch_scc1 PL7_adaLN_cond__sliding_local_dilated__swiglu_ffn__prompt_kernelx
  v_subrev_u32 v13, s46, v13
  v_subrev_u32 v13, 2, v13
  v_cmp_lt_u32 vcc, 3, v13
  s_nop 4
  s_cbranch_vccnz PL7_adaLN_cond__sliding_local_dilated__swiglu_ffn__prompt_kernel
PL7_adaLN_cond__sliding_local_dilated__swiglu_ffn__prompt_kernelx:
  s_waitcnt vmcnt(9)
  s_barrier
  v_mfma_f32_16x16x32_bf16 v[128:131], a[192:195], v[100:103], v[128:131]
  ds_read_b128 v[92:95], v22 offset:16384
  s_add_u32 m0, s70, 32768
  s_add_u32 s69, s62, 131072
  v_mfma_f32_16x16x32_bf16 v[128:131], a[200:203], v[104:107], v[128:131]
  buffer_load_dwordx4 v9, s[8:11], s69 offen offset:0 sc1 lds
  v_bfe_u32 v180, v0, 2, 2
  v_xor_b32 v180, v180, v161
  v_lshlrev_b32 v180, 27, v180
  v_mfma_f32_16x16x32_bf16 v[132:135], a[204:207], v[104:107], v[132:135]
  ds_read_b128 v[96:99], v22 offset:17408
  v_and_b32 v162, 15, v0
  v_lshl_add_u32 v180, v162, 4, v180
  v_mfma_f32_16x16x32_bf16 v[132:135], a[196:199], v[100:103], v[132:135]
  s_and_b32 s54, s44, 1
  s_lshl_b32 s54, s54, 11
  v_add_u32 v182, s54, v1
  s_and_b32 s54, s44, 2
  v_mfma_f32_16x16x32_bf16 v[128:131], a[208:211], v[112:115], v[128:131]
  ds_read_b128 v[104:107], v22 offset:18432
  s_lshl_b32 s54, s54, 9
  s_add_u32 s54, s54, 135168
  v_mfma_f32_16x16x32_bf16 v[128:131], a[216:219], v[108:111], v[128:131]
  buffer_load_dwordx4 v9, s[8:11], s69 offen offset:1024 sc1 lds
  v_add_u32 v182, s54, v182
  ds_read_b128 v[160:163], v181 offset:0
  v_mfma_f32_16x16x32_bf16 v[132:135], a[220:223], v[108:111], v[132:135]
  ds_read_b128 v[100:103], v22 offset:19456
  ds_read_b128 v[164:167], v181 offset:64
  v_mfma_f32_16x16x32_bf16 v[132:135], a[212:215], v[112:115], v[132:135]
  s_waitcnt lgkmcnt(7)
  buffer_load_dwordx4 v9, s[8:11], s69 offen offset:2048 sc1 lds
  ds_read_b128 v[168:171], v181 offset:128
  v_mfma_f32_16x16x32_bf16 v[128:131], a[224:227], v[76:79], v[128:131]
  ds_read_b128 v[108:111], v22 offset:20480
  ds_read_b128 v[172:175], v181 offset:192
  v_mfma_f32_16x16x32_bf16 v[128:131], a[232:235], v[80:83], v[128:131]
  v_mov_b32 v176, 0x3f803f80
  v_mov_b32 v177, 0x3f803f80
  v_mov_b32 v178, 0x3f803f80
  v_mfma_f32_16x16x32_bf16 v[132:135], a[236:239], v[80:83], v[132:135]
  ds_read_b128 v[112:115], v22 offset:21504
  v_mov_b32 v179, 0x3f803f80
  s_mov_b32 s90, 0xcccccccc
  v_mfma_f32_16x16x32_bf16 v[132:135], a[228:231], v[76:79], v[132:135]
  buffer_load_dwordx4 v9, s[8:11], s69 offen offset:3072 sc1 lds
  s_add_u32 m0, s70, 49152
  s_add_u32 s69, s63, 131072
  s_mov_b32 s91, 0xcccccccc
  v_mfma_f32_16x16x32_bf16 v[128:131], a[240:243], v[88:91], v[128:131]
  ds_read_b128 v[80:83], v22 offset:22528
  v_lshrrev_b32 v220, 5, v0
  v_xor_b32 v220, 1, v220
  v_lshlrev_b32 v220, 12, v220
  v_mfma_f32_16x16x32_bf16 v[128:131], a[248:251], v[84:87], v[128:131]
  buffer_load_dwordx4 v9, s[8:11], s69 offen offset:0 sc1 lds
  s_waitcnt vmcnt(22) lgkmcnt(2)
  v_lshlrev_b32 v184, 16, v144
  v_and_b32 v185, 0xffff0000, v144
  v_mfma_f32_16x16x32_bf16 v[132:135], v[124:127], v[84:87], v[132:135]
  ds_read_b128 v[76:79], v22 offset:23552
  v_and_b32 v221, 31, v0
  v_lshl_add_u32 v220, v221, 3, v220
  v_mfma_f32_16x16x32_bf16 v[132:135], a[244:247], v[88:91], v[132:135]
  s_waitcnt lgkmcnt(7)
  v_add_u32 v15, s46, v0
  v_add_u32 v15, 3, v15
  s_waitcnt vmcnt(8)
  s_barrier
  s_mov_b64 exec, 1
  buffer_store_dword v15, v0, s[8:11], s74 offen offset:0 sc1
  s_mov_b64 exec, -1
  v_mfma_f32_16x16x32_bf16 v[136:139], a[0:3], v[92:95], 0
  ds_read_b128 v[84:87], v23 offset:16384
  v_lshlrev_b32 v186, 16, v145
  v_and_b32 v187, 0xffff0000, v145
  v_mfma_f32_16x16x32_bf16 v[136:139], a[8:11], v[96:99], v[136:139]
  buffer_load_dwordx4 v9, s[8:11], s69 offen offset:1024 sc1 lds
  v_lshlrev_b32 v188, 16, v146
  v_and_b32 v189, 0xffff0000, v146
  v_lshlrev_b32 v190, 16, v147
  v_mfma_f32_16x16x32_bf16 v[140:143], a[12:15], v[96:99], 0
  ds_read_b128 v[88:91], v23 offset:17408
  v_and_b32 v191, 0xffff0000, v147
  v_fmac_f32 v184, v160, v128
  v_mfma_f32_16x16x32_bf16 v[140:143], a[4:7], v[92:95], v[140:143]
  buffer_load_dwordx4 v9, s[8:11], s69 offen offset:2048 sc1 lds
  v_fmac_f32 v185, v161, v129
  v_fmac_f32 v186, v162, v130
  v_fmac_f32 v187, v163, v131
  v_mfma_f32_16x16x32_bf16 v[136:139], a[16:19], v[104:107], v[136:139]
  ds_read_b128 v[96:99], v23 offset:18432
  v_fmac_f32 v188, v164, v132
  v_fmac_f32 v189, v165, v133
  v_mfma_f32_16x16x32_bf16 v[136:139], a[24:27], v[100:103], v[136:139]
  v_fmac_f32 v190, v166, v134
  v_fmac_f32 v191, v167, v135
  v_mul_f32 v128, v184, v168
  v_mfma_f32_16x16x32_bf16 v[140:143], a[28:31], v[100:103], v[140:143]
  ds_read_b128 v[92:95], v23 offset:19456
  v_mul_f32 v129, v185, v169
  v_mul_f32 v130, v186, v170
  v_mfma_f32_16x16x32_bf16 v[140:143], a[20:23], v[104:107], v[140:143]
  s_waitcnt lgkmcnt(4)
  buffer_load_dwordx4 v9, s[8:11], s69 offen offset:3072 sc1 lds
  v_mul_f32 v131, v187, v171
  v_mul_f32 v132, v188, v172
  v_mfma_f32_16x16x32_bf16 v[136:139], a[32:35], v[108:111], v[136:139]
  ds_read_b128 v[100:103], v23 offset:20480
  s_add_u32 m0, s70, 98304
  s_add_u32 s69, s64, 131072
  v_mfma_f32_16x16x32_bf16 v[136:139], a[40:43], v[112:115], v[136:139]
  buffer_load_dwordx4 v9, s[8:11], s69 offen offset:0 sc1 lds
  v_mul_f32 v133, v189, v173
  v_mul_f32 v134, v190, v174
  v_mul_f32 v135, v191, v175
  v_mfma_f32_16x16x32_bf16 v[140:143], a[44:47], v[112:115], v[140:143]
  ds_read_b128 v[104:107], v23 offset:21504
  v_cvt_pk_bf16_f32 v196, v128, v129
  v_cvt_pk_bf16_f32 v197, v130, v131
  v_mfma_f32_16x16x32_bf16 v[140:143], a[36:39], v[108:111], v[140:143]
  v_cvt_pk_bf16_f32 v198, v132, v133
  v_cvt_pk_bf16_f32 v199, v134, v135
  v_mfma_f32_16x16x32_bf16 v[136:139], a[48:51], v[80:83], v[136:139]
  ds_read_b128 v[112:115], v23 offset:22528
  v_mfma_f32_16x16x32_bf16 v[136:139], a[56:59], v[76:79], v[136:139]
  buffer_load_dwordx4 v9, s[8:11], s69 offen offset:1024 sc1 lds
  s_add_u32 s54, s47, 36700160
  buffer_store_dwordx4 v[196:199], v1, s[8:11], s54 offen sc1
  v_mfma_f32_16x16x32_bf16 v[140:143], a[60:63], v[76:79], v[140:143]
  ds_read_b128 v[108:111], v23 offset:23552
  v_cvt_pk_bf16_f32 v144, v184, v185
  v_cvt_pk_bf16_f32 v145, v186, v187
  v_mfma_f32_16x16x32_bf16 v[140:143], a[52:55], v[80:83], v[140:143]
  s_waitcnt lgkmcnt(4)
  v_cvt_pk_bf16_f32 v146, v188, v189
  s_waitcnt vmcnt(12)
  s_barrier
  v_mfma_f32_16x16x32_bf16 v[136:139], a[64:67], v[84:87], v[136:139]
  ds_read_b128 v[76:79], v23 offset:0
  buffer_load_dwordx4 v9, s[8:11], s69 offen offset:2048 sc1 lds
  v_cvt_pk_bf16_f32 v147, v190, v191
  v_mfma_f32_16x16x32_bf16 v[136:139], a[72:75], v[88:91], v[136:139]
  s_nop 0
  v_mfma_f32_16x16x32_bf16 v[224:227], v[176:179], v[144:147], 0
  v_mfma_f32_16x16x32_bf16 v[192:195], v[144:147], v[144:147], 0
  v_mfma_f32_16x16x32_bf16 v[140:143], a[76:79], v[88:91], v[140:143]
  ds_read_b128 v[80:83], v23 offset:1024
  v_mfma_f32_16x16x32_bf16 v[140:143], a[68:71], v[84:87], v[140:143]
  buffer_load_dwordx4 v9, s[8:11], s69 offen offset:3072 sc1 lds
  s_add_u32 m0, s70, 114688
  s_add_u32 s69, s65, 131072
  v_mfma_f32_16x16x32_bf16 v[136:139], a[80:83], v[96:99], v[136:139]
  ds_read_b128 v[88:91], v23 offset:2048
  v_cndmask_b32 v192, v192, v193, s[88:89]
  v_cndmask_b32 v194, v194, v195, s[88:89]
  v_mfma_f32_16x16x32_bf16 v[136:139], a[88:91], v[92:95], v[136:139]
  buffer_load_dwordx4 v9, s[8:11], s69 offen offset:0 sc1 lds
  v_cndmask_b32 v225, v192, v194, s[90:91]
  v_mfma_f32_16x16x32_bf16 v[140:143], a[92:95], v[92:95], v[140:143]
  ds_read_b128 v[84:87], v23 offset:3072
  v_mfma_f32_16x16x32_bf16 v[140:143], a[84:87], v[96:99], v[140:143]
  s_waitcnt lgkmcnt(4)
  ds_write_b128 v182, v[144:147] offset:0
  v_mfma_f32_16x16x32_bf16 v[136:139], a[96:99], v[100:103], v[136:139]
  ds_read_b128 v[92:95], v23 offset:4096
  v_mfma_f32_16x16x32_bf16 v[136:139], a[104:107], v[104:107], v[136:139]
  buffer_load_dwordx4 v9, s[8:11], s69 offen offset:1024 sc1 lds
  v_mfma_f32_16x16x32_bf16 v[140:143], a[108:111], v[104:107], v[140:143]
  ds_read_b128 v[96:99], v23 offset:5120
  v_mfma_f32_16x16x32_bf16 v[140:143], a[100:103], v[100:103], v[140:143]
  buffer_load_dwordx4 v9, s[8:11], s69 offen offset:2048 sc1 lds
  v_mfma_f32_16x16x32_bf16 v[136:139], a[112:115], v[112:115], v[136:139]
  ds_read_b128 v[104:107], v23 offset:6144
  v_lshrrev_b32 v29, 2, v0
  v_mfma_f32_16x16x32_bf16 v[136:139], a[120:123], v[108:111], v[136:139]
  v_bfe_u32 v28, v29, 1, 2
  v_lshlrev_b32 v28, 5, v28
  v_mfma_f32_16x16x32_bf16 v[140:143], a[124:127], v[108:111], v[140:143]
  ds_read_b128 v[100:103], v23 offset:7168
  v_lshl_add_u32 v28, v29, 7, v28
  v_mfma_f32_16x16x32_bf16 v[140:143], a[116:119], v[112:115], v[140:143]
  s_waitcnt lgkmcnt(5)
  buffer_load_dwordx4 v9, s[8:11], s69 offen offset:3072 sc1 lds
  v_and_b32 v29, 3, v0
  v_mfma_f32_16x16x32_bf16 v[136:139], a[128:131], v[76:79], v[136:139]
  ds_read_b128 v[108:111], v22 offset:0
  v_lshl_add_u32 v2, v29, 3, v28
  v_mfma_f32_16x16x32_bf16 v[136:139], a[136:139], v[80:83], v[136:139]
  v_xor_b32 v3, 32, v2
  v_xor_b32 v4, 64, v2
  v_mfma_f32_16x16x32_bf16 v[140:143], a[140:143], v[80:83], v[140:143]
  ds_read_b128 v[112:115], v22 offset:1024
  v_xor_b32 v5, 96, v2
  v_mfma_f32_16x16x32_bf16 v[140:143], a[132:135], v[76:79], v[140:143]
  v_add_u32 v6, 65536, v2
  v_add_u32 v7, 65536, v3
  v_mfma_f32_16x16x32_bf16 v[136:139], a[144:147], v[88:91], v[136:139]
  ds_read_b128 v[80:83], v22 offset:2048
  v_add_u32 v8, 65536, v4
  v_mfma_f32_16x16x32_bf16 v[136:139], a[152:155], v[84:87], v[136:139]
  s_lshr_b32 s52, s2, 5
  s_lshl_b32 s52, s52, 19
  s_lshr_b32 s53, s44, 1
  v_mfma_f32_16x16x32_bf16 v[140:143], a[156:159], v[84:87], v[140:143]
  ds_read_b128 v[76:79], v22 offset:3072
  s_lshl_b32 s53, s53, 18
  v_mfma_f32_16x16x32_bf16 v[140:143], a[148:151], v[88:91], v[140:143]
  s_waitcnt lgkmcnt(4)
  s_add_u32 s52, s52, s53
  s_and_b32 s53, s44, 1
  v_mfma_f32_16x16x32_bf16 v[136:139], a[160:163], v[92:95], v[136:139]
  ds_read_b128 v[84:87], v22 offset:4096
  s_lshl_b32 s53, s53, 15
  v_mfma_f32_16x16x32_bf16 v[136:139], a[168:171], v[96:99], v[136:139]
  s_or_b32 s57, s2, s44
  s_mov_b32 s57, 851968
  s_cselect_b32 s57, 1073741824, s57
  v_add_u32 v15, s46, v0
  s_mov_b64 exec, 1
  buffer_store_dword v15, v0, s[8:11], s57 offen offset:0 sc1
  s_mov_b64 exec, -1
  s_add_u32 s56, s79, 12288
  v_mfma_f32_16x16x32_bf16 v[140:143], a[172:175], v[96:99], v[140:143]
  ds_read_b128 v[88:91], v22 offset:5120
  buffer_load_dwordx2 v[212:213], v220, s[8:11], s56 offen sc1
  v_mfma_f32_16x16x32_bf16 v[140:143], a[164:167], v[92:95], v[140:143]
  s_add_u32 s56, s79, 36864
  s_add_u32 s52, s52, s53
  s_add_u32 s24, s52, 36700160
  v_mfma_f32_16x16x32_bf16 v[136:139], a[176:179], v[104:107], v[136:139]
  ds_read_b128 v[96:99], v22 offset:6144
  s_lshl_b32 s57, s44, 28
  s_add_u32 s57, s57, s77
  buffer_load_dword v13, v14, s[8:11], s57 offen sc1
  buffer_load_dwordx2 v[214:215], v220, s[8:11], s56 offen sc1
  s_add_u32 s56, s79, 61440
  v_mfma_f32_16x16x32_bf16 v[136:139], a[184:187], v[100:103], v[136:139]
  buffer_load_dwordx2 v[216:217], v220, s[8:11], s56 offen sc1
  s_add_u32 s56, s79, 86016
  v_mfma_f32_16x16x32_bf16 v[140:143], a[188:191], v[100:103], v[140:143]
  ds_read_b128 v[92:95], v22 offset:7168
  v_mfma_f32_16x16x32_bf16 v[140:143], a[180:183], v[104:107], v[140:143]
  s_waitcnt lgkmcnt(4)
  buffer_load_dwordx2 v[218:219], v220, s[8:11], s56 offen sc1
  s_waitcnt vmcnt(15)
  s_barrier
  v_mfma_f32_16x16x32_bf16 v[136:139], a[192:195], v[108:111], v[136:139]
  ds_read_b128 v[100:103], v22 offset:32768
  s_bitcmp1_b32 s2, 3
  s_cselect_b64 s[12:13], s[32:33], s[28:29]
  v_mfma_f32_16x16x32_bf16 v[136:139], a[200:203], v[112:115], v[136:139]
  s_mov_b32 s14, 7340032
  s_mov_b32 s16, 0x03030303
  s_mov_b32 s17, 0x03030303
  v_mfma_f32_16x16x32_bf16 v[140:143], a[204:207], v[112:115], v[140:143]
  ds_read_b128 v[104:107], v22 offset:33792
  s_mov_b32 s18, 0x0c0c0c0c
  v_mfma_f32_16x16x32_bf16 v[140:143], a[196:199], v[108:111], v[140:143]
  s_mov_b32 s19, 0x0c0c0c0c
  s_mov_b32 s20, 0x30303030
  s_mov_b32 s21, 0x30303030
  v_mfma_f32_16x16x32_bf16 v[136:139], a[208:211], v[80:83], v[136:139]
  ds_read_b128 v[112:115], v22 offset:34816
  s_waitcnt vmcnt(40) lgkmcnt(15)
  v_lshlrev_b32 v184, 16, v148
  v_and_b32 v185, 0xffff0000, v148
  v_lshlrev_b32 v186, 16, v149
  v_mfma_f32_16x16x32_bf16 v[136:139], a[216:219], v[76:79], v[136:139]
  v_and_b32 v187, 0xffff0000, v149
  v_lshlrev_b32 v188, 16, v150
  v_and_b32 v189, 0xffff0000, v150
  v_lshlrev_b32 v190, 16, v151
  v_and_b32 v191, 0xffff0000, v151
  v_mfma_f32_16x16x32_bf16 v[140:143], a[220:223], v[76:79], v[140:143]
  ds_read_b128 v[108:111], v22 offset:35840
  s_mov_b32 s22, 0xc0c0c0c0
  v_mfma_f32_16x16x32_bf16 v[140:143], a[212:215], v[80:83], v[140:143]
  s_waitcnt lgkmcnt(4)
  s_mov_b32 s23, 0xc0c0c0c0
  v_mfma_f32_16x16x32_bf16 v[136:139], a[224:227], v[84:87], v[136:139]
  ds_read_b128 v[76:79], v22 offset:36864
  v_mfma_f32_16x16x32_bf16 v[136:139], a[232:235], v[88:91], v[136:139]
  v_mfma_f32_16x16x32_bf16 v[140:143], a[236:239], v[88:91], v[140:143]
  ds_read_b128 v[80:83], v22 offset:37888
  v_mfma_f32_16x16x32_bf16 v[140:143], a[228:231], v[84:87], v[140:143]
  v_mfma_f32_16x16x32_bf16 v[136:139], a[240:243], v[96:99], v[136:139]
  ds_read_b128 v[88:91], v22 offset:38912
  v_mfma_f32_16x16x32_bf16 v[136:139], a[248:251], v[92:95], v[136:139]
  v_mfma_f32_16x16x32_bf16 v[140:143], v[124:127], v[92:95], v[140:143]
  ds_read_b128 v[84:87], v22 offset:39936
  v_mfma_f32_16x16x32_bf16 v[140:143], a[244:247], v[96:99], v[140:143]
  s_waitcnt lgkmcnt(4)
  v_mfma_f32_16x16x32_bf16 v[128:131], a[0:3], v[100:103], 0
  ds_read_b128 v[92:95], v22 offset:49152
  v_mfma_f32_16x16x32_bf16 v[128:131], a[8:11], v[104:107], v[128:131]
  v_mfma_f32_16x16x32_bf16 v[132:135], a[12:15], v[104:107], 0
  ds_read_b128 v[96:99], v22 offset:50176
  v_fmac_f32 v184, v160, v136
  v_fmac_f32 v185, v161, v137
  v_fmac_f32 v186, v162, v138
  v_fmac_f32 v187, v163, v139
  v_mfma_f32_16x16x32_bf16 v[132:135], a[4:7], v[100:103], v[132:135]
  v_fmac_f32 v188, v164, v140
  v_fmac_f32 v189, v165, v141
  v_fmac_f32 v190, v166, v142
  v_fmac_f32 v191, v167, v143
  v_mul_f32 v136, v184, v168
  v_mfma_f32_16x16x32_bf16 v[128:131], a[16:19], v[112:115], v[128:131]
  ds_read_b128 v[104:107], v22 offset:51200
  v_mul_f32 v137, v185, v169
  v_mul_f32 v138, v186, v170
  v_mul_f32 v139, v187, v171
  v_mul_f32 v140, v188, v172
  v_mfma_f32_16x16x32_bf16 v[128:131], a[24:27], v[108:111], v[128:131]
  v_mul_f32 v141, v189, v173
  v_mul_f32 v142, v190, v174
  v_mul_f32 v143, v191, v175
  v_cvt_pk_bf16_f32 v200, v136, v137
  v_cvt_pk_bf16_f32 v201, v138, v139
  v_mfma_f32_16x16x32_bf16 v[132:135], a[28:31], v[108:111], v[132:135]
  ds_read_b128 v[100:103], v22 offset:52224
  v_cvt_pk_bf16_f32 v202, v140, v141
  v_cvt_pk_bf16_f32 v203, v142, v143
  v_mfma_f32_16x16x32_bf16 v[132:135], a[20:23], v[112:115], v[132:135]
  s_waitcnt lgkmcnt(4)
  s_add_u32 s54, s47, 36765696
  buffer_store_dwordx4 v[200:203], v1, s[8:11], s54 offen sc1
  v_mfma_f32_16x16x32_bf16 v[128:131], a[32:35], v[76:79], v[128:131]
  ds_read_b128 v[108:111], v22 offset:53248
  v_cvt_pk_bf16_f32 v148, v184, v185
  v_cvt_pk_bf16_f32 v149, v186, v187
  v_cvt_pk_bf16_f32 v150, v188, v189
  v_cvt_pk_bf16_f32 v151, v190, v191
  v_mfma_f32_16x16x32_bf16 v[128:131], a[40:43], v[80:83], v[128:131]
  s_nop 0
  v_mfma_f32_16x16x32_bf16 v[226:229], v[176:179], v[148:151], 0
  v_mfma_f32_16x16x32_bf16 v[192:195], v[148:151], v[148:151], 0
  v_mfma_f32_16x16x32_bf16 v[132:135], a[44:47], v[80:83], v[132:135]
  ds_read_b128 v[112:115], v22 offset:54272
  v_mfma_f32_16x16x32_bf16 v[132:135], a[36:39], v[76:79], v[132:135]
  v_mfma_f32_16x16x32_bf16 v[128:131], a[48:51], v[88:91], v[128:131]
  ds_read_b128 v[80:83], v22 offset:55296
  s_nop 2
  v_cndmask_b32 v192, v192, v193, s[88:89]
  v_cndmask_b32 v194, v194, v195, s[88:89]
  v_cndmask_b32 v227, v192, v194, s[90:91]
  v_mfma_f32_16x16x32_bf16 v[128:131], a[56:59], v[84:87], v[128:131]
  buffer_store_dwordx4 v[224:227], v180, s[8:11], s48 offen offset:0 sc1
  v_mfma_f32_16x16x32_bf16 v[132:135], a[60:63], v[84:87], v[132:135]
  ds_read_b128 v[76:79], v22 offset:56320
  v_mfma_f32_16x16x32_bf16 v[132:135], a[52:55], v[88:91], v[132:135]
  s_waitcnt lgkmcnt(4)
  s_waitcnt vmcnt(5)
  s_cmp_lg_u32 s44, 0
  s_cbranch_scc1 PL8_adaLN_cond__sliding_local_dilated__swiglu_ffn__prompt_kernelx
  v_subrev_u32 v13, s46, v13
  v_subrev_u32 v13, 3, v13
  v_cmp_lt_u32 vcc, 3, v13
  s_nop 4
  s_cbranch_vccz PL8_adaLN_cond__sliding_local_dilated__swiglu_ffn__prompt_kernelx
  s_mov_b32 s57, 60000
PL8_adaLN_cond__sliding_local_dilated__swiglu_ffn__prompt_kernel:
  buffer_load_dword v13, v14, s[8:11], s77 offen sc1
  s_sub_u32 s57, s57, 1
  s_cmp_eq_u32 s57, 0
  s_waitcnt vmcnt(0)
  s_cbranch_scc1 PL8_adaLN_cond__sliding_local_dilated__swiglu_ffn__prompt_kernelx
  v_subrev_u32 v13, s46, v13
  v_subrev_u32 v13, 3, v13
  v_cmp_lt_u32 vcc, 3, v13
  s_nop 4
  s_cbranch_vccnz PL8_adaLN_cond__sliding_local_dilated__swiglu_ffn__prompt_kernel
PL8_adaLN_cond__sliding_local_dilated__swiglu_ffn__prompt_kernelx:
  s_waitcnt vmcnt(8)
  s_barrier
  v_mfma_f32_16x16x32_bf16 v[128:131], a[64:67], v[92:95], v[128:131]
  ds_read_b128 v[84:87], v23 offset:32768
  s_add_u32 m0, s70, 16384
  s_add_u32 s69, s62, 196608
  ds_write_b128 v182, v[148:151] offset:4096
  v_mfma_f32_16x16x32_bf16 v[128:131], a[72:75], v[96:99], v[128:131]
  buffer_load_dwordx4 v9, s[8:11], s69 offen offset:0 sc1 lds
  v_mfma_f32_16x16x32_bf16 v[132:135], a[76:79], v[96:99], v[132:135]
  ds_read_b128 v[88:91], v23 offset:33792
  v_mfma_f32_16x16x32_bf16 v[132:135], a[68:71], v[92:95], v[132:135]
  buffer_load_dwordx4 v9, s[8:11], s69 offen offset:1024 sc1 lds
  v_mfma_f32_16x16x32_bf16 v[128:131], a[80:83], v[104:107], v[128:131]
  ds_read_b128 v[96:99], v23 offset:34816
  buffer_load_dwordx4 v9, s[8:11], s69 offen offset:2048 sc1 lds
  v_mfma_f32_16x16x32_bf16 v[128:131], a[88:91], v[100:103], v[128:131]
  v_mfma_f32_16x16x32_bf16 v[132:135], a[92:95], v[100:103], v[132:135]
  ds_read_b128 v[92:95], v23 offset:35840
  buffer_load_dwordx4 v9, s[8:11], s69 offen offset:3072 sc1 lds
  s_add_u32 m0, s70, 81920
  s_add_u32 s69, s63, 196608
  v_mfma_f32_16x16x32_bf16 v[132:135], a[84:87], v[104:107], v[132:135]
  s_waitcnt lgkmcnt(5)
  buffer_load_dwordx4 v9, s[8:11], s69 offen offset:0 sc1 lds
  v_mfma_f32_16x16x32_bf16 v[128:131], a[96:99], v[108:111], v[128:131]
  ds_read_b128 v[100:103], v23 offset:36864
  v_mfma_f32_16x16x32_bf16 v[128:131], a[104:107], v[112:115], v[128:131]
  buffer_load_dwordx4 v9, s[8:11], s69 offen offset:1024 sc1 lds
  v_mfma_f32_16x16x32_bf16 v[132:135], a[108:111], v[112:115], v[132:135]
  ds_read_b128 v[104:107], v23 offset:37888
  buffer_load_dwordx4 v9, s[8:11], s69 offen offset:2048 sc1 lds
  v_mfma_f32_16x16x32_bf16 v[132:135], a[100:103], v[108:111], v[132:135]
  v_mfma_f32_16x16x32_bf16 v[128:131], a[112:115], v[80:83], v[128:131]
  ds_read_b128 v[112:115], v23 offset:38912
  buffer_load_dwordx4 v9, s[8:11], s69 offen offset:3072 sc1 lds
  s_add_u32 m0, s70, 65536
  s_add_u32 s69, s64, 196608
  v_mfma_f32_16x16x32_bf16 v[128:131], a[120:123], v[76:79], v[128:131]
  buffer_load_dwordx4 v9, s[8:11], s69 offen offset:0 sc1 lds
  v_mfma_f32_16x16x32_bf16 v[132:135], a[124:127], v[76:79], v[132:135]
  ds_read_b128 v[108:111], v23 offset:39936
  v_mfma_f32_16x16x32_bf16 v[132:135], a[116:119], v[80:83], v[132:135]
  s_waitcnt lgkmcnt(4)
  buffer_load_dwordx4 v9, s[8:11], s69 offen offset:1024 sc1 lds
  v_mfma_f32_16x16x32_bf16 v[128:131], a[128:131], v[84:87], v[128:131]
  ds_read_b128 v[76:79], v23 offset:49152
  buffer_load_dwordx4 v9, s[8:11], s69 offen offset:2048 sc1 lds
  v_mfma_f32_16x16x32_bf16 v[128:131], a[136:139], v[88:91], v[128:131]
  v_mfma_f32_16x16x32_bf16 v[132:135], a[140:143], v[88:91], v[132:135]
  ds_read_b128 v[80:83], v23 offset:50176
  buffer_load_dwordx4 v9, s[8:11], s69 offen offset:3072 sc1 lds
  s_add_u32 m0, s70, 0
  s_add_u32 s69, s65, 196608
  v_mfma_f32_16x16x32_bf16 v[132:135], a[132:135], v[84:87], v[132:135]
  buffer_load_dwordx4 v9, s[8:11], s69 offen offset:0 sc1 lds
  v_mfma_f32_16x16x32_bf16 v[128:131], a[144:147], v[96:99], v[128:131]
  ds_read_b128 v[88:91], v23 offset:51200
  v_mfma_f32_16x16x32_bf16 v[128:131], a[152:155], v[92:95], v[128:131]
  buffer_load_dwordx4 v9, s[8:11], s69 offen offset:1024 sc1 lds
  v_mfma_f32_16x16x32_bf16 v[132:135], a[156:159], v[92:95], v[132:135]
  ds_read_b128 v[84:87], v23 offset:52224
  buffer_load_dwordx4 v9, s[8:11], s69 offen offset:2048 sc1 lds
  v_mfma_f32_16x16x32_bf16 v[132:135], a[148:151], v[96:99], v[132:135]
  s_waitcnt lgkmcnt(4)
  v_mfma_f32_16x16x32_bf16 v[128:131], a[160:163], v[100:103], v[128:131]
  ds_read_b128 v[92:95], v23 offset:53248
  v_mfma_f32_16x16x32_bf16 v[128:131], a[168:171], v[104:107], v[128:131]
  buffer_load_dwordx4 v9, s[8:11], s69 offen offset:3072 sc1 lds
  v_mfma_f32_16x16x32_bf16 v[132:135], a[172:175], v[104:107], v[132:135]
  ds_read_b128 v[96:99], v23 offset:54272
  v_mfma_f32_16x16x32_bf16 v[132:135], a[164:167], v[100:103], v[132:135]
  v_mfma_f32_16x16x32_bf16 v[128:131], a[176:179], v[112:115], v[128:131]
  ds_read_b128 v[104:107], v23 offset:55296
  s_waitcnt vmcnt(18)
  v_mfma_f32_16x16x32_bf16 v[128:131], a[184:187], v[108:111], v[128:131]
  s_mov_b32 s55, 0
  s_add_u32 m0, s45, 32768
  v_add_f32 v212, v212, v214
  s_sub_u32 s73, s49, 524288
  v_mfma_f32_16x16x32_bf16 v[132:135], a[188:191], v[108:111], v[132:135]
  ds_read_b128 v[100:103], v23 offset:56320
  buffer_load_dwordx4 v16, s[28:31], s55 offen lds
  v_mfma_f32_16x16x32_bf16 v[132:135], a[180:183], v[112:115], v[132:135]
  s_waitcnt lgkmcnt(4)
  s_waitcnt vmcnt(9)
  s_barrier
  v_add_u32 v15, s46, v0
  s_mov_b64 exec, 1
  buffer_store_dword v15, v0, s[8:11], s73 offen offset:0 sc1
  s_mov_b64 exec, -1
  v_mfma_f32_16x16x32_bf16 v[128:131], a[192:195], v[76:79], v[128:131]
  ds_read_b128 v[108:111], v22 offset:16384
  v_add_f32 v216, v216, v218
  v_mfma_f32_16x16x32_bf16 v[128:131], a[200:203], v[80:83], v[128:131]
  v_add_f32 v212, v212, v216
  v_add_f32 v213, v213, v215
  v_mfma_f32_16x16x32_bf16 v[132:135], a[204:207], v[80:83], v[132:135]
  ds_read_b128 v[112:115], v22 offset:17408
  v_add_f32 v217, v217, v219
  v_mfma_f32_16x16x32_bf16 v[132:135], a[196:199], v[76:79], v[132:135]
HOP6:
  s_cbranch_execz HOP10
  s_mov_b32 s55, 0
  s_add_u32 m0, s45, 40960
  v_add_f32 v213, v213, v217
  v_mfma_f32_16x16x32_bf16 v[128:131], a[208:211], v[88:91], v[128:131]
  ds_read_b128 v[80:83], v22 offset:18432
  s_waitcnt vmcnt(59) lgkmcnt(15)
  v_lshlrev_b32 v184, 16, v152
  v_mfma_f32_16x16x32_bf16 v[128:131], a[216:219], v[84:87], v[128:131]
  buffer_load_dwordx4 v16, s[32:35], s55 offen lds
  v_and_b32 v185, 0xffff0000, v152
  v_lshlrev_b32 v186, 16, v153
  v_and_b32 v187, 0xffff0000, v153
  v_mfma_f32_16x16x32_bf16 v[132:135], a[220:223], v[84:87], v[132:135]
  ds_read_b128 v[76:79], v22 offset:19456
  v_lshlrev_b32 v188, 16, v154
  v_and_b32 v189, 0xffff0000, v154
  v_mfma_f32_16x16x32_bf16 v[132:135], a[212:215], v[88:91], v[132:135]
  s_waitcnt lgkmcnt(4)
  v_lshlrev_b32 v190, 16, v155
  v_and_b32 v191, 0xffff0000, v155
  v_mfma_f32_16x16x32_bf16 v[128:131], a[224:227], v[92:95], v[128:131]
  ds_read_b128 v[84:87], v22 offset:20480
  v_lshrrev_b32 v28, 5, v0
  v_mfma_f32_16x16x32_bf16 v[128:131], a[232:235], v[96:99], v[128:131]
  s_mov_b32 s55, 229376
  s_add_u32 m0, s45, 36864
  v_xor_b32 v29, 1, v28
  v_mfma_f32_16x16x32_bf16 v[132:135], a[236:239], v[96:99], v[132:135]
  ds_read_b128 v[88:91], v22 offset:21504
  v_cvt_f32_u32 v29, v29
  v_mfma_f32_16x16x32_bf16 v[132:135], a[228:231], v[92:95], v[132:135]
  buffer_load_dwordx4 v16, s[28:31], s55 offen lds
  v_cvt_pk_bf16_f32 v214, v212, v213
  v_lshlrev_b32 v212, 16, v214
  v_mfma_f32_16x16x32_bf16 v[128:131], a[240:243], v[104:107], v[128:131]
  ds_read_b128 v[96:99], v22 offset:22528
  v_and_b32 v213, 0xffff0000, v214
  v_mfma_f32_16x16x32_bf16 v[128:131], a[248:251], v[100:103], v[128:131]
  v_add_f32 v212, v212, v29
  v_add_f32 v213, v213, v29
  v_mfma_f32_16x16x32_bf16 v[132:135], v[124:127], v[100:103], v[132:135]
  ds_read_b128 v[92:95], v22 offset:23552
  v_cvt_pk_bf16_f32 v214, v212, v213
  v_mfma_f32_16x16x32_bf16 v[132:135], a[244:247], v[104:107], v[132:135]
  s_waitcnt lgkmcnt(4)
  s_mov_b32 s55, 229376
  s_add_u32 m0, s45, 45056
  v_mfma_f32_16x16x32_bf16 v[136:139], a[0:3], v[108:111], 0
  ds_read_b128 v[100:103], v23 offset:16384
  v_lshlrev_b32 v212, 16, v214
  v_mfma_f32_16x16x32_bf16 v[136:139], a[8:11], v[112:115], v[136:139]
  buffer_load_dwordx4 v16, s[32:35], s55 offen lds
  v_and_b32 v213, 0xffff0000, v214
  v_lshrrev_b32 v215, 16, v214
  v_mfma_f32_16x16x32_bf16 v[140:143], a[12:15], v[112:115], 0
  ds_read_b128 v[104:107], v23 offset:17408
  v_fmac_f32 v184, v160, v128
  v_fmac_f32 v185, v161, v129
  v_mfma_f32_16x16x32_bf16 v[140:143], a[4:7], v[108:111], v[140:143]
  v_fmac_f32 v186, v162, v130
  v_fmac_f32 v187, v163, v131
  v_fmac_f32 v188, v164, v132
  v_mfma_f32_16x16x32_bf16 v[136:139], a[16:19], v[80:83], v[136:139]
  ds_read_b128 v[112:115], v23 offset:18432
  v_fmac_f32 v189, v165, v133
  v_fmac_f32 v190, v166, v134
  v_mfma_f32_16x16x32_bf16 v[136:139], a[24:27], v[76:79], v[136:139]
  s_mov_b32 s55, 0
  s_add_u32 m0, s45, 98304
  v_fmac_f32 v191, v167, v135
  v_mul_f32 v128, v184, v168
  v_mfma_f32_16x16x32_bf16 v[140:143], a[28:31], v[76:79], v[140:143]
  ds_read_b128 v[108:111], v23 offset:19456
  v_mul_f32 v129, v185, v169
  v_mul_f32 v130, v186, v170
  v_mfma_f32_16x16x32_bf16 v[140:143], a[20:23], v[80:83], v[140:143]
  s_waitcnt lgkmcnt(4)
  buffer_load_dwordx4 v11, s[28:31], s55 offen lds
  v_mul_f32 v131, v187, v171
  v_mul_f32 v132, v188, v172
  v_mfma_f32_16x16x32_bf16 v[136:139], a[32:35], v[84:87], v[136:139]
  ds_read_b128 v[76:79], v23 offset:20480
  v_mul_f32 v133, v189, v173
  v_mul_f32 v134, v190, v174
  v_mfma_f32_16x16x32_bf16 v[136:139], a[40:43], v[88:91], v[136:139]
  v_mul_f32 v135, v191, v175
  v_cvt_pk_bf16_f32 v204, v128, v129
  v_cvt_pk_bf16_f32 v205, v130, v131
  v_and_b32 v214, 0xffff, v214
  v_mfma_f32_16x16x32_bf16 v[140:143], a[44:47], v[88:91], v[140:143]
  ds_read_b128 v[80:83], v23 offset:21504
  v_cvt_pk_bf16_f32 v206, v132, v133
  v_cvt_pk_bf16_f32 v207, v134, v135
  v_mfma_f32_16x16x32_bf16 v[140:143], a[36:39], v[84:87], v[140:143]
  s_mov_b32 s55, 0
  s_add_u32 m0, s45, 106496
  s_add_u32 s52, s45, 151552
  v_mfma_f32_16x16x32_bf16 v[136:139], a[48:51], v[96:99], v[136:139]
  ds_read_b128 v[88:91], v23 offset:22528
  v_lshlrev_b32 v28, 8, v28
  v_mfma_f32_16x16x32_bf16 v[136:139], a[56:59], v[92:95], v[136:139]
  buffer_load_dwordx4 v11, s[32:35], s55 offen lds
  s_add_u32 s54, s47, 36831232
  buffer_store_dwordx4 v[204:207], v1, s[8:11], s54 offen sc1
  v_mfma_f32_16x16x32_bf16 v[140:143], a[60:63], v[92:95], v[140:143]
  ds_read_b128 v[84:87], v23 offset:23552
  v_cvt_pk_bf16_f32 v152, v184, v185
  v_cvt_pk_bf16_f32 v153, v186, v187
  v_mfma_f32_16x16x32_bf16 v[140:143], a[52:55], v[96:99], v[140:143]
  s_waitcnt lgkmcnt(4)
  v_cvt_pk_bf16_f32 v154, v188, v189
  s_waitcnt vmcnt(8)
  s_barrier
  v_mfma_f32_16x16x32_bf16 v[136:139], a[64:67], v[100:103], v[136:139]
  ds_read_b128 v[92:95], v23 offset:0
  v_cvt_pk_bf16_f32 v155, v190, v191
  v_mfma_f32_16x16x32_bf16 v[136:139], a[72:75], v[104:107], v[136:139]
  s_mov_b32 s55, 229376
  s_add_u32 m0, s45, 102400
  v_mfma_f32_16x16x32_bf16 v[228:231], v[176:179], v[152:155], 0
  v_mfma_f32_16x16x32_bf16 v[192:195], v[152:155], v[152:155], 0
  v_lshl_add_u32 v28, v0, 3, v28
  v_add_u32 v28, s52, v28
  v_mfma_f32_16x16x32_bf16 v[140:143], a[76:79], v[104:107], v[140:143]
  ds_read_b128 v[96:99], v23 offset:1024
  v_mfma_f32_16x16x32_bf16 v[140:143], a[68:71], v[100:103], v[140:143]
  buffer_load_dwordx4 v11, s[28:31], s55 offen lds
  ds_write_b64 v28, v[214:215]
  v_mfma_f32_16x16x32_bf16 v[136:139], a[80:83], v[112:115], v[136:139]
  ds_read_b128 v[104:107], v23 offset:2048
  v_cndmask_b32 v192, v192, v193, s[88:89]
  v_cndmask_b32 v194, v194, v195, s[88:89]
  v_mfma_f32_16x16x32_bf16 v[136:139], a[88:91], v[108:111], v[136:139]
  ds_write_b64 v28, v[212:213] offset:256
  v_cndmask_b32 v229, v192, v194, s[90:91]
  v_mfma_f32_16x16x32_bf16 v[140:143], a[92:95], v[108:111], v[140:143]
  ds_read_b128 v[100:103], v23 offset:3072
  v_mfma_f32_16x16x32_bf16 v[140:143], a[84:87], v[112:115], v[140:143]
  s_waitcnt lgkmcnt(6)
  s_mov_b32 s55, 229376
  s_add_u32 m0, s45, 110592
  v_mfma_f32_16x16x32_bf16 v[136:139], a[96:99], v[76:79], v[136:139]
  ds_read_b128 v[108:111], v23 offset:4096
  ds_write_b128 v182, v[152:155] offset:8192
  v_mfma_f32_16x16x32_bf16 v[136:139], a[104:107], v[80:83], v[136:139]
  buffer_load_dwordx4 v11, s[32:35], s55 offen lds
  v_mfma_f32_16x16x32_bf16 v[140:143], a[108:111], v[80:83], v[140:143]
  ds_read_b128 v[112:115], v23 offset:5120
  v_mfma_f32_16x16x32_bf16 v[140:143], a[100:103], v[76:79], v[140:143]
  v_mfma_f32_16x16x32_bf16 v[136:139], a[112:115], v[88:91], v[136:139]
  ds_read_b128 v[80:83], v23 offset:6144
  v_mfma_f32_16x16x32_bf16 v[136:139], a[120:123], v[84:87], v[136:139]
  s_mov_b32 s55, 458752
  s_add_u32 m0, s45, 114688
  v_mfma_f32_16x16x32_bf16 v[140:143], a[124:127], v[84:87], v[140:143]
  ds_read_b128 v[76:79], v23 offset:7168
  v_mfma_f32_16x16x32_bf16 v[140:143], a[116:119], v[88:91], v[140:143]
  s_waitcnt lgkmcnt(5)
  buffer_load_dwordx4 v11, s[28:31], s55 offen lds
  v_mfma_f32_16x16x32_bf16 v[136:139], a[128:131], v[92:95], v[136:139]
  ds_read_b128 v[84:87], v22 offset:0
  v_mfma_f32_16x16x32_bf16 v[136:139], a[136:139], v[96:99], v[136:139]
  v_mfma_f32_16x16x32_bf16 v[140:143], a[140:143], v[96:99], v[140:143]
  ds_read_b128 v[88:91], v22 offset:1024
  v_mfma_f32_16x16x32_bf16 v[140:143], a[132:135], v[92:95], v[140:143]
  s_mov_b32 s55, 458752
  s_add_u32 m0, s45, 122880
  v_mfma_f32_16x16x32_bf16 v[136:139], a[144:147], v[104:107], v[136:139]
  ds_read_b128 v[96:99], v22 offset:2048
  v_mfma_f32_16x16x32_bf16 v[136:139], a[152:155], v[100:103], v[136:139]
  buffer_load_dwordx4 v11, s[32:35], s55 offen lds
  v_mfma_f32_16x16x32_bf16 v[140:143], a[156:159], v[100:103], v[140:143]
  ds_read_b128 v[92:95], v22 offset:3072
  v_mfma_f32_16x16x32_bf16 v[140:143], a[148:151], v[104:107], v[140:143]
  s_waitcnt lgkmcnt(4)
  v_mfma_f32_16x16x32_bf16 v[136:139], a[160:163], v[108:111], v[136:139]
  ds_read_b128 v[100:103], v22 offset:4096
  v_mfma_f32_16x16x32_bf16 v[136:139], a[168:171], v[112:115], v[136:139]
  s_mov_b32 s55, 688128
  s_add_u32 m0, s45, 118784
  v_mfma_f32_16x16x32_bf16 v[140:143], a[172:175], v[112:115], v[140:143]
  ds_read_b128 v[104:107], v22 offset:5120
  v_mfma_f32_16x16x32_bf16 v[140:143], a[164:167], v[108:111], v[140:143]
  buffer_load_dwordx4 v11, s[28:31], s55 offen lds
  v_mfma_f32_16x16x32_bf16 v[136:139], a[176:179], v[80:83], v[136:139]
  ds_read_b128 v[112:115], v22 offset:6144
  s_waitcnt vmcnt(63) lgkmcnt(15)
  v_mfma_f32_16x16x32_bf16 v[136:139], a[184:187], v[76:79], v[136:139]
  s_lshr_b32 s77, s2, 5
  s_lshl_b32 s77, s77, 12
  s_add_u32 s77, s77, 229376
  v_mfma_f32_16x16x32_bf16 v[140:143], a[188:191], v[76:79], v[140:143]
  ds_read_b128 v[108:111], v22 offset:7168
  s_mov_b32 s55, 688128
  s_add_u32 m0, s45, 126976
  v_mfma_f32_16x16x32_bf16 v[140:143], a[180:183], v[80:83], v[140:143]
  s_waitcnt lgkmcnt(4)
  v_and_b32 v14, 31, v0
  v_lshlrev_b32 v14, 7, v14
  v_mfma_f32_16x16x32_bf16 v[136:139], a[192:195], v[84:87], v[136:139]
  buffer_load_dwordx4 v11, s[32:35], s55 offen lds
  v_lshlrev_b32 v184, 16, v156
  v_and_b32 v185, 0xffff0000, v156
  v_mfma_f32_16x16x32_bf16 v[136:139], a[200:203], v[88:91], v[136:139]
  s_lshl_b32 s57, s44, 28
  s_add_u32 s57, s57, s77
  buffer_load_dword v13, v14, s[8:11], s57 offen sc1
  v_mfma_f32_16x16x32_bf16 v[140:143], a[204:207], v[88:91], v[140:143]
  v_lshlrev_b32 v186, 16, v157
  v_and_b32 v187, 0xffff0000, v157
  v_mfma_f32_16x16x32_bf16 v[140:143], a[196:199], v[84:87], v[140:143]
  v_lshlrev_b32 v188, 16, v158
  v_and_b32 v189, 0xffff0000, v158
  v_mfma_f32_16x16x32_bf16 v[136:139], a[208:211], v[96:99], v[136:139]
  v_lshlrev_b32 v190, 16, v159
  v_and_b32 v191, 0xffff0000, v159
  v_mfma_f32_16x16x32_bf16 v[136:139], a[216:219], v[92:95], v[136:139]
  s_mov_b32 s55, 458752
  s_add_u32 m0, s45, 49152
  v_mfma_f32_16x16x32_bf16 v[140:143], a[220:223], v[92:95], v[140:143]
  buffer_load_dwordx4 v16, s[28:31], s55 offen lds
  v_mfma_f32_16x16x32_bf16 v[140:143], a[212:215], v[96:99], v[140:143]
  s_waitcnt lgkmcnt(0)
  v_mfma_f32_16x16x32_bf16 v[136:139], a[224:227], v[100:103], v[136:139]
  v_mfma_f32_16x16x32_bf16 v[136:139], a[232:235], v[104:107], v[136:139]
  v_mfma_f32_16x16x32_bf16 v[140:143], a[236:239], v[104:107], v[140:143]
  v_mfma_f32_16x16x32_bf16 v[140:143], a[228:231], v[100:103], v[140:143]
  s_mov_b32 s55, 458752
  s_add_u32 m0, s45, 57344
  v_mfma_f32_16x16x32_bf16 v[136:139], a[240:243], v[112:115], v[136:139]
  buffer_load_dwordx4 v16, s[32:35], s55 offen lds
  v_mfma_f32_16x16x32_bf16 v[136:139], a[248:251], v[108:111], v[136:139]
  v_mfma_f32_16x16x32_bf16 v[140:143], v[124:127], v[108:111], v[140:143]
  v_mfma_f32_16x16x32_bf16 v[140:143], a[244:247], v[112:115], v[140:143]
  s_nop 5
  v_fmac_f32 v184, v160, v136
  v_fmac_f32 v185, v161, v137
  v_fmac_f32 v186, v162, v138
  v_fmac_f32 v187, v163, v139
  v_fmac_f32 v188, v164, v140
  v_fmac_f32 v189, v165, v141
  v_fmac_f32 v190, v166, v142
  v_fmac_f32 v191, v167, v143
  v_mul_f32 v136, v184, v168
  v_mul_f32 v137, v185, v169
  v_mul_f32 v138, v186, v170
  v_mul_f32 v139, v187, v171
  v_mul_f32 v140, v188, v172
  v_mul_f32 v141, v189, v173
  v_mul_f32 v142, v190, v174
  v_mul_f32 v143, v191, v175
  v_cvt_pk_bf16_f32 v208, v136, v137
  v_cvt_pk_bf16_f32 v209, v138, v139
  v_cvt_pk_bf16_f32 v210, v140, v141
  v_cvt_pk_bf16_f32 v211, v142, v143
  s_add_u32 s54, s47, 36896768
  buffer_store_dwordx4 v[208:211], v1, s[8:11], s54 offen sc1
  v_cvt_pk_bf16_f32 v156, v184, v185
  v_cvt_pk_bf16_f32 v157, v186, v187
  v_cvt_pk_bf16_f32 v158, v188, v189
  v_cvt_pk_bf16_f32 v159, v190, v191
  s_nop 1
  v_mfma_f32_16x16x32_bf16 v[230:233], v[176:179], v[156:159], 0
  v_mfma_f32_16x16x32_bf16 v[192:195], v[156:159], v[156:159], 0
  s_nop 7
  v_cndmask_b32 v192, v192, v193, s[88:89]
  v_cndmask_b32 v194, v194, v195, s[88:89]
  v_cndmask_b32 v231, v192, v194, s[90:91]
  buffer_store_dwordx4 v[228:231], v180, s[8:11], s48 offen offset:256 sc1
  ds_write_b128 v182, v[156:159] offset:12288
  s_mov_b64 exec, 0
  s_cmp_eq_u32 s44, 0
  s_cbranch_scc1 HOP12
  s_cmp_eq_u32 s44, 1
  s_cbranch_scc1 HOP13
  s_cmp_eq_u32 s44, 2
  s_cbranch_scc1 HOP14
  s_cmp_eq_u32 s44, 3
  s_cbranch_scc1 HOP15
WRET1:
  s_mov_b64 exec, -1
  s_waitcnt vmcnt(9) lgkmcnt(0)
  s_waitcnt vmcnt(4)
  s_cmp_lg_u32 s44, 0
  s_cbranch_scc1 PL9_adaLN_cond__sliding_local_dilated__swiglu_ffn__prompt_kernelx
  v_cmp_ne_u32 vcc, s46, v13
  s_nop 4
  s_cbranch_vccz PL9_adaLN_cond__sliding_local_dilated__swiglu_ffn__prompt_kernelx
  s_mov_b32 s57, 60000
PL9_adaLN_cond__sliding_local_dilated__swiglu_ffn__prompt_kernel:
  buffer_load_dword v13, v14, s[8:11], s77 offen sc1
  s_sub_u32 s57, s57, 1
  s_cmp_eq_u32 s57, 0
  s_waitcnt vmcnt(0)
  s_cbranch_scc1 PL9_adaLN_cond__sliding_local_dilated__swiglu_ffn__prompt_kernelx
  v_cmp_ne_u32 vcc, s46, v13
  s_nop 4
  s_cbranch_vccnz PL9_adaLN_cond__sliding_local_dilated__swiglu_ffn__prompt_kernel
PL9_adaLN_cond__sliding_local_dilated__swiglu_ffn__prompt_kernelx:
  s_barrier
  s_mov_b32 s63, 0
  s_add_u32 s71, s24, 0
  buffer_load_dwordx4 a[0:3], v1, s[8:11], s71 offen offset:0 sc1
  buffer_load_dwordx4 a[16:19], v1, s[8:11], s71 offen offset:1024 sc1
  s_add_u32 s71, s71, 65536
  buffer_load_dwordx4 a[4:7], v1, s[8:11], s71 offen offset:0 sc1
  buffer_load_dwordx4 a[20:23], v1, s[8:11], s71 offen offset:1024 sc1
  s_mov_b32 s64, 458752
  s_add_u32 s72, s24, 2048
  buffer_load_dwordx4 a[32:35], v1, s[8:11], s72 offen offset:0 sc1
  buffer_load_dwordx4 a[48:51], v1, s[8:11], s72 offen offset:1024 sc1
  s_add_u32 s72, s72, 65536
  buffer_load_dwordx4 a[36:39], v1, s[8:11], s72 offen offset:0 sc1
  buffer_load_dwordx4 a[52:55], v1, s[8:11], s72 offen offset:1024 sc1
  s_waitcnt vmcnt(17) lgkmcnt(0)
  v_add_u32 v9, s46, v0
  s_waitcnt vmcnt(8)
  s_barrier
  s_mov_b64 exec, 1
  buffer_store_dword v9, v0, s[8:11], s49 offen offset:0 sc1
  s_mov_b64 exec, -1
  s_mov_b32 s55, 688128
  s_add_u32 m0, s45, 53248
  s_nop 0
  buffer_load_dwordx4 v16, s[28:31], s55 offen lds
  s_mov_b32 s55, 688128
  s_add_u32 m0, s45, 61440
  s_nop 0
  buffer_load_dwordx4 v16, s[32:35], s55 offen lds
  v_mov_b32 v10, v16
  ds_read_b64_tr_b16 a[160:161], v6 offset:32768
  ds_read_b64_tr_b16 a[162:163], v6 offset:34816
  ds_read_b64_tr_b16 a[164:165], v6 offset:36864
  ds_read_b64_tr_b16 a[166:167], v6 offset:38912
  ds_read_b64_tr_b16 a[168:169], v6 offset:40960
  ds_read_b64_tr_b16 a[170:171], v6 offset:43008
  ds_read_b64_tr_b16 a[172:173], v6 offset:45056
  ds_read_b64_tr_b16 a[174:175], v6 offset:47104
  ds_read_b64_tr_b16 a[176:177], v7 offset:32768
  ds_read_b64_tr_b16 a[178:179], v7 offset:34816
  ds_read_b64_tr_b16 a[180:181], v7 offset:36864
  ds_read_b64_tr_b16 a[182:183], v7 offset:38912
  ds_read_b64_tr_b16 a[188:189], v7 offset:40960
  ds_read_b64_tr_b16 a[190:191], v7 offset:43008
  ds_read_b64_tr_b16 a[192:193], v7 offset:45056
  ds_read_b64_tr_b16 a[194:195], v7 offset:47104
  s_waitcnt vmcnt(7) lgkmcnt(8)
  v_mfma_f32_16x16x32_bf16 v[64:67], a[160:163], a[0:3], 0
  ds_read_b64_tr_b16 a[196:197], v8 offset:32768
  s_mov_b32 s65, 917504
  s_add_u32 s73, s24, 4096
  s_add_u32 m0, s45, 81920
  v_mfma_f32_16x16x32_bf16 v[64:67], a[164:167], a[16:19], v[64:67]
  ds_read_b64_tr_b16 a[198:199], v8 offset:34816
  buffer_load_dwordx4 v11, s[28:31], s65 offen lds
  v_mfma_f32_16x16x32_bf16 v[68:71], a[164:167], a[20:23], 0
  ds_read_b64_tr_b16 a[200:201], v8 offset:36864
  s_lshr_b32 s53, s2, 5
  v_mfma_f32_16x16x32_bf16 v[68:71], a[160:163], a[4:7], v[68:71]
  ds_read_b64_tr_b16 a[202:203], v8 offset:38912
  s_lshl_b32 s53, s53, 12
  v_mfma_f32_16x16x32_bf16 v[84:87], a[168:171], a[4:7], 0
  ds_read_b64_tr_b16 a[204:205], v8 offset:40960
  s_add_u32 m0, s45, 90112
  v_mfma_f32_16x16x32_bf16 v[84:87], a[172:175], a[20:23], v[84:87]
  ds_read_b64_tr_b16 a[206:207], v8 offset:43008
  buffer_load_dwordx4 v11, s[32:35], s65 offen lds
  v_mfma_f32_16x16x32_bf16 v[80:83], a[172:175], a[16:19], 0
  ds_read_b64_tr_b16 a[208:209], v8 offset:45056
  s_add_u32 s81, s53, 753664
  v_mfma_f32_16x16x32_bf16 v[80:83], a[168:171], a[0:3], v[80:83]
  s_waitcnt lgkmcnt(7)
  ds_read_b64_tr_b16 a[210:211], v8 offset:47104
  v_mfma_f32_16x16x32_bf16 v[96:99], a[176:179], a[0:3], 0
  ds_read_b64_tr_b16 a[164:165], v2 offset:32768
  s_add_u32 m0, s45, 86016
  s_add_u32 s60, s65, 229376
  v_mfma_f32_16x16x32_bf16 v[96:99], a[180:183], a[16:19], v[96:99]
  ds_read_b64_tr_b16 a[166:167], v2 offset:34816
  buffer_load_dwordx4 v11, s[28:31], s60 offen lds
  v_mfma_f32_16x16x32_bf16 v[100:103], a[180:183], a[20:23], 0
  ds_read_b64_tr_b16 a[160:161], v2 offset:36864
  v_and_b32 v15, 31, v0
  v_mfma_f32_16x16x32_bf16 v[100:103], a[176:179], a[4:7], v[100:103]
  ds_read_b64_tr_b16 a[162:163], v2 offset:38912
  v_lshlrev_b32 v15, 7, v15
  v_mfma_f32_16x16x32_bf16 v[116:119], a[188:191], a[4:7], 0
  ds_read_b64_tr_b16 a[172:173], v2 offset:40960
  s_add_u32 m0, s45, 94208
  s_add_u32 s60, s65, 229376
  v_mfma_f32_16x16x32_bf16 v[116:119], a[192:195], a[20:23], v[116:119]
  ds_read_b64_tr_b16 a[174:175], v2 offset:43008
  buffer_load_dwordx4 v11, s[32:35], s60 offen lds
  v_mfma_f32_16x16x32_bf16 v[112:115], a[192:195], a[16:19], 0
  ds_read_b64_tr_b16 a[168:169], v2 offset:45056
  s_and_b32 s52, s2, 7
  v_mfma_f32_16x16x32_bf16 v[112:115], a[188:191], a[0:3], v[112:115]
  s_waitcnt lgkmcnt(7)
  ds_read_b64_tr_b16 a[170:171], v2 offset:47104
  v_mfma_f32_16x16x32_bf16 v[32:35], a[196:199], a[0:3], 0
  ds_read_b64_tr_b16 a[180:181], v3 offset:32768
  s_add_u32 m0, s45, 16384
  v_mfma_f32_16x16x32_bf16 v[32:35], a[200:203], a[16:19], v[32:35]
  ds_read_b64_tr_b16 a[182:183], v3 offset:34816
  buffer_load_dwordx4 v10, s[28:31], s65 offen lds
  v_mfma_f32_16x16x32_bf16 v[36:39], a[200:203], a[20:23], 0
  ds_read_b64_tr_b16 a[176:177], v3 offset:36864
  s_bfe_u32 s51, s2, 0x20003
  v_mfma_f32_16x16x32_bf16 v[36:39], a[196:199], a[4:7], v[36:39]
  ds_read_b64_tr_b16 a[178:179], v3 offset:38912
  s_lshr_b32 s50, s2, 5
  v_mfma_f32_16x16x32_bf16 v[52:55], a[204:207], a[4:7], 0
  ds_read_b64_tr_b16 a[192:193], v3 offset:40960
  s_add_u32 m0, s45, 24576
  v_mfma_f32_16x16x32_bf16 v[52:55], a[208:211], a[20:23], v[52:55]
  ds_read_b64_tr_b16 a[194:195], v3 offset:43008
  buffer_load_dwordx4 v10, s[32:35], s65 offen lds
  v_mfma_f32_16x16x32_bf16 v[48:51], a[208:211], a[16:19], 0
  ds_read_b64_tr_b16 a[188:189], v3 offset:45056
  s_add_u32 s56, s51, s50
  v_mfma_f32_16x16x32_bf16 v[48:51], a[204:207], a[0:3], v[48:51]
  s_waitcnt lgkmcnt(7)
  ds_read_b64_tr_b16 a[190:191], v3 offset:47104
  v_mfma_f32_16x16x32_bf16 v[128:131], a[164:167], a[0:3], 0
  ds_read_b64_tr_b16 a[200:201], v4 offset:32768
  s_add_u32 m0, s45, 20480
  s_add_u32 s60, s65, 229376
  v_mfma_f32_16x16x32_bf16 v[128:131], a[160:163], a[16:19], v[128:131]
  ds_read_b64_tr_b16 a[202:203], v4 offset:34816
  buffer_load_dwordx4 v10, s[28:31], s60 offen lds
  v_mfma_f32_16x16x32_bf16 v[132:135], a[160:163], a[20:23], 0
  ds_read_b64_tr_b16 a[196:197], v4 offset:36864
  s_and_b32 s56, s56, 3
  v_mfma_f32_16x16x32_bf16 v[132:135], a[164:167], a[4:7], v[132:135]
  ds_read_b64_tr_b16 a[198:199], v4 offset:38912
  s_lshl_b32 s53, s50, 1
  v_mfma_f32_16x16x32_bf16 v[148:151], a[172:175], a[4:7], 0
  ds_read_b64_tr_b16 a[208:209], v4 offset:40960
  s_add_u32 m0, s45, 28672
  s_add_u32 s60, s65, 229376
  v_mfma_f32_16x16x32_bf16 v[148:151], a[168:171], a[20:23], v[148:151]
  ds_read_b64_tr_b16 a[210:211], v4 offset:43008
  buffer_load_dwordx4 v10, s[32:35], s60 offen lds
  v_mfma_f32_16x16x32_bf16 v[144:147], a[168:171], a[16:19], 0
  ds_read_b64_tr_b16 a[204:205], v4 offset:45056
  s_lshr_b32 s54, s44, 1
  v_mfma_f32_16x16x32_bf16 v[144:147], a[172:175], a[0:3], v[144:147]
  s_waitcnt lgkmcnt(7)
  ds_read_b64_tr_b16 a[206:207], v4 offset:47104
  v_mfma_f32_16x16x32_bf16 v[160:163], a[180:183], a[0:3], 0
  ds_read_b64_tr_b16 a[160:161], v5 offset:32768
  v_mfma_f32_16x16x32_bf16 v[160:163], a[176:179], a[16:19], v[160:163]
  ds_read_b64_tr_b16 a[162:163], v5 offset:34816
  buffer_load_dwordx4 a[64:67], v1, s[8:11], s73 offen offset:0 sc1
  v_mfma_f32_16x16x32_bf16 v[164:167], a[176:179], a[20:23], 0
  ds_read_b64_tr_b16 a[164:165], v5 offset:36864
  s_add_u32 s53, s53, s54
  v_mfma_f32_16x16x32_bf16 v[164:167], a[180:183], a[4:7], v[164:167]
  ds_read_b64_tr_b16 a[166:167], v5 offset:38912
  s_lshl_b32 s62, s53, 3
  v_mfma_f32_16x16x32_bf16 v[180:183], a[192:195], a[4:7], 0
  ds_read_b64_tr_b16 a[168:169], v5 offset:40960
  s_and_b32 s55, s44, 1
  v_mfma_f32_16x16x32_bf16 v[180:183], a[188:191], a[20:23], v[180:183]
  ds_read_b64_tr_b16 a[170:171], v5 offset:43008
  buffer_load_dwordx4 a[80:83], v1, s[8:11], s73 offen offset:1024 sc1
  v_mfma_f32_16x16x32_bf16 v[176:179], a[188:191], a[16:19], 0
  ds_read_b64_tr_b16 a[172:173], v5 offset:45056
  s_add_u32 s62, s62, s55
  v_mfma_f32_16x16x32_bf16 v[176:179], a[192:195], a[0:3], v[176:179]
  s_waitcnt lgkmcnt(7)
  ds_read_b64_tr_b16 a[174:175], v5 offset:47104
  s_waitcnt vmcnt(10)
  s_barrier
  v_mfma_f32_16x16x32_bf16 v[192:195], a[200:203], a[0:3], 0
  ds_read_b64_tr_b16 a[176:177], v6 offset:49152
  s_lshl_b32 s82, s44, 28
  s_add_u32 s82, s82, s81
  buffer_load_dword v9, v15, s[8:11], s82 offen sc1
  s_add_u32 s73, s73, 65536
  v_mfma_f32_16x16x32_bf16 v[192:195], a[196:199], a[16:19], v[192:195]
  ds_read_b64_tr_b16 a[178:179], v6 offset:51200
  buffer_load_dwordx4 a[68:71], v1, s[8:11], s73 offen offset:0 sc1
  v_mfma_f32_16x16x32_bf16 v[196:199], a[196:199], a[20:23], 0
  ds_read_b64_tr_b16 a[180:181], v6 offset:53248
  s_lshl_b32 s79, s2, 7
  v_mfma_f32_16x16x32_bf16 v[196:199], a[200:203], a[4:7], v[196:199]
  ds_read_b64_tr_b16 a[182:183], v6 offset:55296
  s_lshl_b32 s53, s44, 28
  v_mfma_f32_16x16x32_bf16 v[212:215], a[208:211], a[4:7], 0
  ds_read_b64_tr_b16 a[188:189], v6 offset:57344
  s_add_u32 s79, s79, s53
  v_mfma_f32_16x16x32_bf16 v[212:215], a[204:207], a[20:23], v[212:215]
  ds_read_b64_tr_b16 a[190:191], v6 offset:59392
  buffer_load_dwordx4 a[84:87], v1, s[8:11], s73 offen offset:1024 sc1
  v_mfma_f32_16x16x32_bf16 v[208:211], a[204:207], a[16:19], 0
  ds_read_b64_tr_b16 a[192:193], v6 offset:61440
  s_add_u32 s79, s79, 884736
  v_mfma_f32_16x16x32_bf16 v[208:211], a[208:211], a[0:3], v[208:211]
  s_waitcnt lgkmcnt(7)
  ds_read_b64_tr_b16 a[194:195], v6 offset:63488
  v_mfma_f32_16x16x32_bf16 v[224:227], a[160:163], a[0:3], 0
  ds_read_b64_tr_b16 a[196:197], v7 offset:49152
  s_mov_b32 s66, 1376256
  s_add_u32 s74, s24, 6144
  s_add_u32 m0, s45, 65536
  v_mfma_f32_16x16x32_bf16 v[224:227], a[164:167], a[16:19], v[224:227]
  ds_read_b64_tr_b16 a[198:199], v7 offset:51200
  buffer_load_dwordx4 v11, s[28:31], s66 offen lds
  v_mfma_f32_16x16x32_bf16 v[228:231], a[164:167], a[20:23], 0
  ds_read_b64_tr_b16 a[200:201], v7 offset:53248
  s_lshl_b32 s53, s2, 2
  v_mfma_f32_16x16x32_bf16 v[228:231], a[160:163], a[4:7], v[228:231]
  ds_read_b64_tr_b16 a[202:203], v7 offset:55296
  s_add_u32 s53, s53, s44
  v_mfma_f32_16x16x32_bf16 v[244:247], a[168:171], a[4:7], 0
  ds_read_b64_tr_b16 a[204:205], v7 offset:57344
  s_add_u32 m0, s45, 73728
  v_mfma_f32_16x16x32_bf16 v[244:247], a[172:175], a[20:23], v[244:247]
  ds_read_b64_tr_b16 a[206:207], v7 offset:59392
  buffer_load_dwordx4 v11, s[32:35], s66 offen lds
  v_mfma_f32_16x16x32_bf16 v[240:243], a[172:175], a[16:19], 0
  ds_read_b64_tr_b16 a[208:209], v7 offset:61440
  s_lshl_b32 s53, s53, 7
  v_mfma_f32_16x16x32_bf16 v[240:243], a[168:171], a[0:3], v[240:243]
  s_waitcnt vmcnt(18) lgkmcnt(7)
  ds_read_b64_tr_b16 a[210:211], v7 offset:63488
  v_mfma_f32_16x16x32_bf16 v[64:67], a[176:179], a[32:35], v[64:67]
  ds_read_b64_tr_b16 a[164:165], v8 offset:49152
  s_add_u32 m0, s45, 69632
  s_add_u32 s60, s66, 229376
  v_mfma_f32_16x16x32_bf16 v[64:67], a[180:183], a[48:51], v[64:67]
  ds_read_b64_tr_b16 a[166:167], v8 offset:51200
  buffer_load_dwordx4 v11, s[28:31], s60 offen lds
  v_mfma_f32_16x16x32_bf16 v[68:71], a[180:183], a[52:55], v[68:71]
  ds_read_b64_tr_b16 a[160:161], v8 offset:53248
  s_add_u32 s80, s53, 917504
  v_mfma_f32_16x16x32_bf16 v[68:71], a[176:179], a[36:39], v[68:71]
  ds_read_b64_tr_b16 a[162:163], v8 offset:55296
  s_add_u32 s53, s45, 151552
  v_mfma_f32_16x16x32_bf16 v[84:87], a[188:191], a[36:39], v[84:87]
  ds_read_b64_tr_b16 a[172:173], v8 offset:57344
  s_add_u32 m0, s45, 77824
  s_add_u32 s60, s66, 229376
  v_mfma_f32_16x16x32_bf16 v[84:87], a[192:195], a[52:55], v[84:87]
  ds_read_b64_tr_b16 a[174:175], v8 offset:59392
  buffer_load_dwordx4 v11, s[32:35], s60 offen lds
  v_mfma_f32_16x16x32_bf16 v[80:83], a[192:195], a[48:51], v[80:83]
  ds_read_b64_tr_b16 a[168:169], v8 offset:61440
  v_bfe_u32 v24, v0, 3, 1
  v_mfma_f32_16x16x32_bf16 v[80:83], a[188:191], a[32:35], v[80:83]
  s_waitcnt lgkmcnt(7)
  ds_read_b64_tr_b16 a[170:171], v8 offset:63488
  v_mfma_f32_16x16x32_bf16 v[96:99], a[196:199], a[32:35], v[96:99]
  ds_read_b64_tr_b16 a[180:181], v2 offset:49152
  s_add_u32 m0, s45, 0
  v_mfma_f32_16x16x32_bf16 v[96:99], a[200:203], a[48:51], v[96:99]
  ds_read_b64_tr_b16 a[182:183], v2 offset:51200
  buffer_load_dwordx4 v10, s[28:31], s66 offen lds
  v_mfma_f32_16x16x32_bf16 v[100:103], a[200:203], a[52:55], v[100:103]
  ds_read_b64_tr_b16 a[176:177], v2 offset:53248
  v_lshlrev_b32 v24, 9, v24
  v_mfma_f32_16x16x32_bf16 v[100:103], a[196:199], a[36:39], v[100:103]
  ds_read_b64_tr_b16 a[178:179], v2 offset:55296
  v_and_b32 v25, 1, v0
  v_mfma_f32_16x16x32_bf16 v[116:119], a[204:207], a[36:39], v[116:119]
  ds_read_b64_tr_b16 a[192:193], v2 offset:57344
  s_add_u32 m0, s45, 8192
  v_mfma_f32_16x16x32_bf16 v[116:119], a[208:211], a[52:55], v[116:119]
  ds_read_b64_tr_b16 a[194:195], v2 offset:59392
  buffer_load_dwordx4 v10, s[32:35], s66 offen lds
  v_mfma_f32_16x16x32_bf16 v[112:115], a[208:211], a[48:51], v[112:115]
  ds_read_b64_tr_b16 a[188:189], v2 offset:61440
  v_lshl_add_u32 v24, v25, 8, v24
  v_mfma_f32_16x16x32_bf16 v[112:115], a[204:207], a[32:35], v[112:115]
  s_waitcnt lgkmcnt(7)
  ds_read_b64_tr_b16 a[190:191], v2 offset:63488
  v_mfma_f32_16x16x32_bf16 v[32:35], a[164:167], a[32:35], v[32:35]
  ds_read_b64_tr_b16 a[200:201], v3 offset:49152
  s_add_u32 m0, s45, 4096
  s_add_u32 s60, s66, 229376
  v_mfma_f32_16x16x32_bf16 v[32:35], a[160:163], a[48:51], v[32:35]
  ds_read_b64_tr_b16 a[202:203], v3 offset:51200
  buffer_load_dwordx4 v10, s[28:31], s60 offen lds
  v_mfma_f32_16x16x32_bf16 v[36:39], a[160:163], a[52:55], v[36:39]
  ds_read_b64_tr_b16 a[196:197], v3 offset:53248
  v_lshrrev_b32 v25, 4, v0
  v_mfma_f32_16x16x32_bf16 v[36:39], a[164:167], a[36:39], v[36:39]
  ds_read_b64_tr_b16 a[198:199], v3 offset:55296
HOP7:
  s_cbranch_execz HOP11
  v_lshl_add_u32 v24, v25, 6, v24
  v_mfma_f32_16x16x32_bf16 v[52:55], a[172:175], a[36:39], v[52:55]
  ds_read_b64_tr_b16 a[208:209], v3 offset:57344
  s_add_u32 m0, s45, 12288
  s_add_u32 s60, s66, 229376
  v_mfma_f32_16x16x32_bf16 v[52:55], a[168:171], a[52:55], v[52:55]
  ds_read_b64_tr_b16 a[210:211], v3 offset:59392
  buffer_load_dwordx4 v10, s[32:35], s60 offen lds
  v_mfma_f32_16x16x32_bf16 v[48:51], a[168:171], a[48:51], v[48:51]
  ds_read_b64_tr_b16 a[204:205], v3 offset:61440
  v_add_u32 v14, s53, v24
  v_mfma_f32_16x16x32_bf16 v[48:51], a[172:175], a[32:35], v[48:51]
  s_waitcnt lgkmcnt(7)
  ds_read_b64_tr_b16 a[206:207], v3 offset:63488
  v_mfma_f32_16x16x32_bf16 v[128:131], a[180:183], a[32:35], v[128:131]
  ds_read_b64_tr_b16 a[160:161], v4 offset:49152
  s_waitcnt vmcnt(10)
  s_cmp_lg_u32 s44, 0
  s_cbranch_scc1 PL10_adaLN_cond__sliding_local_dilated__swiglu_ffn__prompt_kernelx
  v_cmp_ne_u32 vcc, s46, v9
  s_nop 4
  s_cbranch_vccz PL10_adaLN_cond__sliding_local_dilated__swiglu_ffn__prompt_kernelx
  s_mov_b32 s82, 60000
PL10_adaLN_cond__sliding_local_dilated__swiglu_ffn__prompt_kernel:
  buffer_load_dword v9, v15, s[8:11], s81 offen sc1
  s_sub_u32 s82, s82, 1
  s_cmp_eq_u32 s82, 0
  s_waitcnt vmcnt(0)
  s_cbranch_scc1 PL10_adaLN_cond__sliding_local_dilated__swiglu_ffn__prompt_kernelx
  v_cmp_ne_u32 vcc, s46, v9
  s_nop 4
  s_cbranch_vccnz PL10_adaLN_cond__sliding_local_dilated__swiglu_ffn__prompt_kernel
PL10_adaLN_cond__sliding_local_dilated__swiglu_ffn__prompt_kernelx:
  s_barrier
  v_mfma_f32_16x16x32_bf16 v[128:131], a[176:179], a[48:51], v[128:131]
  ds_read_b64_tr_b16 a[162:163], v4 offset:51200
  buffer_load_dwordx4 a[96:99], v1, s[8:11], s74 offen offset:0 sc1
  v_mfma_f32_16x16x32_bf16 v[132:135], a[176:179], a[52:55], v[132:135]
  ds_read_b64_tr_b16 a[164:165], v4 offset:53248
  s_bfe_u32 s53, s2, 0x20004
  v_mfma_f32_16x16x32_bf16 v[132:135], a[180:183], a[36:39], v[132:135]
  ds_read_b64_tr_b16 a[166:167], v4 offset:55296
  s_lshl_b32 s53, s53, 8
  v_mfma_f32_16x16x32_bf16 v[148:151], a[192:195], a[36:39], v[148:151]
  ds_read_b64_tr_b16 a[168:169], v4 offset:57344
  s_add_u32 s71, s71, 65536
  v_mfma_f32_16x16x32_bf16 v[148:151], a[188:191], a[52:55], v[148:151]
  ds_read_b64_tr_b16 a[170:171], v4 offset:59392
  buffer_load_dwordx4 a[8:11], v1, s[8:11], s71 offen offset:0 sc1
  v_mfma_f32_16x16x32_bf16 v[144:147], a[188:191], a[48:51], v[144:147]
  ds_read_b64_tr_b16 a[172:173], v4 offset:61440
  v_and_b32 v24, 15, v0
  v_mfma_f32_16x16x32_bf16 v[144:147], a[192:195], a[32:35], v[144:147]
  s_waitcnt lgkmcnt(7)
  ds_read_b64_tr_b16 a[174:175], v4 offset:63488
  buffer_load_dwordx4 a[24:27], v1, s[8:11], s71 offen offset:1024 sc1
  v_mfma_f32_16x16x32_bf16 v[160:163], a[200:203], a[32:35], v[160:163]
  ds_read_b64_tr_b16 a[176:177], v5 offset:49152
  s_add_u32 s71, s71, 65536
  v_mfma_f32_16x16x32_bf16 v[160:163], a[196:199], a[48:51], v[160:163]
  ds_read_b64_tr_b16 a[178:179], v5 offset:51200
  buffer_load_dwordx4 a[12:15], v1, s[8:11], s71 offen offset:0 sc1
  v_mfma_f32_16x16x32_bf16 v[164:167], a[196:199], a[52:55], v[164:167]
  ds_read_b64_tr_b16 a[180:181], v5 offset:53248
  v_lshl_add_u32 v24, v24, 4, s53
  v_mfma_f32_16x16x32_bf16 v[164:167], a[200:203], a[36:39], v[164:167]
  ds_read_b64_tr_b16 a[182:183], v5 offset:55296
  buffer_load_dwordx4 a[28:31], v1, s[8:11], s71 offen offset:1024 sc1
  v_mfma_f32_16x16x32_bf16 v[180:183], a[208:211], a[36:39], v[180:183]
  ds_read_b64_tr_b16 a[188:189], v5 offset:57344
  s_add_u32 s72, s72, 65536
  v_mfma_f32_16x16x32_bf16 v[180:183], a[204:207], a[52:55], v[180:183]
  ds_read_b64_tr_b16 a[190:191], v5 offset:59392
  buffer_load_dwordx4 a[40:43], v1, s[8:11], s72 offen offset:0 sc1
  v_cmp_gt_u32 vcc, 896, v24
  v_mov_b32 v26, 1073741824
  v_mul_u32_u24 v25, 114688, v25
  v_cndmask_b32 v24, v26, v24, vcc
  v_mfma_f32_16x16x32_bf16 v[176:179], a[204:207], a[48:51], v[176:179]
  ds_read_b64_tr_b16 a[192:193], v5 offset:61440
  s_lshr_b32 s53, s2, 6
  v_mfma_f32_16x16x32_bf16 v[176:179], a[208:211], a[32:35], v[176:179]
  s_waitcnt lgkmcnt(7)
  ds_read_b64_tr_b16 a[194:195], v5 offset:63488
  buffer_load_dwordx4 a[56:59], v1, s[8:11], s72 offen offset:1024 sc1
  v_mfma_f32_16x16x32_bf16 v[192:195], a[160:163], a[32:35], v[192:195]
  ds_read_b64_tr_b16 a[196:197], v6 offset:32768
  s_add_u32 s72, s72, 65536
  v_mfma_f32_16x16x32_bf16 v[192:195], a[164:167], a[48:51], v[192:195]
  ds_read_b64_tr_b16 a[198:199], v6 offset:34816
  buffer_load_dwordx4 a[44:47], v1, s[8:11], s72 offen offset:0 sc1
  v_mfma_f32_16x16x32_bf16 v[196:199], a[164:167], a[52:55], v[196:199]
  ds_read_b64_tr_b16 a[200:201], v6 offset:36864
  s_lshl_b32 s53, s53, 2
  v_mfma_f32_16x16x32_bf16 v[196:199], a[160:163], a[36:39], v[196:199]
  ds_read_b64_tr_b16 a[202:203], v6 offset:38912
  buffer_load_dwordx4 a[60:63], v1, s[8:11], s72 offen offset:1024 sc1
  v_mfma_f32_16x16x32_bf16 v[212:215], a[168:171], a[36:39], v[212:215]
  ds_read_b64_tr_b16 a[204:205], v6 offset:40960
  s_add_u32 s73, s73, 65536
  v_mfma_f32_16x16x32_bf16 v[212:215], a[172:175], a[52:55], v[212:215]
  ds_read_b64_tr_b16 a[206:207], v6 offset:43008
  buffer_load_dwordx4 a[72:75], v1, s[8:11], s73 offen offset:0 sc1
  v_mfma_f32_16x16x32_bf16 v[208:211], a[172:175], a[48:51], v[208:211]
  ds_read_b64_tr_b16 a[208:209], v6 offset:45056
  s_add_u32 s53, s53, s44
  v_mfma_f32_16x16x32_bf16 v[208:211], a[168:171], a[32:35], v[208:211]
  s_waitcnt lgkmcnt(7)
  ds_read_b64_tr_b16 a[210:211], v6 offset:47104
  v_mfma_f32_16x16x32_bf16 v[224:227], a[176:179], a[32:35], v[224:227]
  ds_read_b64_tr_b16 a[164:165], v7 offset:32768
  s_mul_i32 s53, s53, 458752
  v_mfma_f32_16x16x32_bf16 v[224:227], a[180:183], a[48:51], v[224:227]
  ds_read_b64_tr_b16 a[166:167], v7 offset:34816
  buffer_load_dwordx4 a[88:91], v1, s[8:11], s73 offen offset:1024 sc1
  v_mfma_f32_16x16x32_bf16 v[228:231], a[180:183], a[52:55], v[228:231]
  ds_read_b64_tr_b16 a[160:161], v7 offset:36864
  s_mul_i32 s54, s52, 896
  v_mfma_f32_16x16x32_bf16 v[228:231], a[176:179], a[36:39], v[228:231]
  ds_read_b64_tr_b16 a[162:163], v7 offset:38912
  s_add_u32 s53, s53, s54
  v_mfma_f32_16x16x32_bf16 v[244:247], a[188:191], a[36:39], v[244:247]
  ds_read_b64_tr_b16 a[172:173], v7 offset:40960
  s_add_u32 s73, s73, 65536
  v_mfma_f32_16x16x32_bf16 v[244:247], a[192:195], a[52:55], v[244:247]
  ds_read_b64_tr_b16 a[174:175], v7 offset:43008
  buffer_load_dwordx4 a[76:79], v1, s[8:11], s73 offen offset:0 sc1
  v_mfma_f32_16x16x32_bf16 v[240:243], a[192:195], a[48:51], v[240:243]
  ds_read_b64_tr_b16 a[168:169], v7 offset:45056
  v_add3_u32 v13, v24, v25, s53
  v_mfma_f32_16x16x32_bf16 v[240:243], a[188:191], a[32:35], v[240:243]
  s_waitcnt vmcnt(7) lgkmcnt(7)
  ds_read_b64_tr_b16 a[170:171], v7 offset:47104
  v_mfma_f32_16x16x32_bf16 v[72:75], a[196:199], a[8:11], 0
  ds_read_b64_tr_b16 a[180:181], v8 offset:32768
  s_lshl_b32 s57, s51, 12
  v_mfma_f32_16x16x32_bf16 v[72:75], a[200:203], a[24:27], v[72:75]
  ds_read_b64_tr_b16 a[182:183], v8 offset:34816
  buffer_load_dwordx4 a[92:95], v1, s[8:11], s73 offen offset:1024 sc1
  v_mfma_f32_16x16x32_bf16 v[76:79], a[200:203], a[28:31], 0
  ds_read_b64_tr_b16 a[176:177], v8 offset:36864
  s_lshl_b32 s54, s51, 3
  v_mfma_f32_16x16x32_bf16 v[76:79], a[196:199], a[12:15], v[76:79]
  ds_read_b64_tr_b16 a[178:179], v8 offset:38912
  s_lshr_b32 s53, 0x0b070602, s54
  v_mfma_f32_16x16x32_bf16 v[92:95], a[204:207], a[12:15], 0
  ds_read_b64_tr_b16 a[192:193], v8 offset:40960
  s_and_b32 s53, s53, 15
  v_mfma_f32_16x16x32_bf16 v[92:95], a[208:211], a[28:31], v[92:95]
  ds_read_b64_tr_b16 a[194:195], v8 offset:43008
  s_lshl_b32 s58, s53, 10
  v_mfma_f32_16x16x32_bf16 v[88:91], a[208:211], a[24:27], 0
  ds_read_b64_tr_b16 a[188:189], v8 offset:45056
  buffer_load_dwordx4 a[112:115], v1, s[8:11], s74 offen offset:1024 sc1
  v_mfma_f32_16x16x32_bf16 v[88:91], a[204:207], a[8:11], v[88:91]
  s_waitcnt lgkmcnt(7)
  ds_read_b64_tr_b16 a[190:191], v8 offset:47104
  v_mfma_f32_16x16x32_bf16 v[104:107], a[164:167], a[8:11], 0
  ds_read_b64_tr_b16 a[200:201], v2 offset:32768
  s_lshr_b32 s53, s51, 1
  v_mfma_f32_16x16x32_bf16 v[104:107], a[160:163], a[24:27], v[104:107]
  ds_read_b64_tr_b16 a[202:203], v2 offset:34816
  s_mul_i32 s53, s53, 7168
  v_mfma_f32_16x16x32_bf16 v[108:111], a[160:163], a[28:31], 0
  ds_read_b64_tr_b16 a[196:197], v2 offset:36864
  s_mov_b32 s61, 0
  v_mfma_f32_16x16x32_bf16 v[108:111], a[164:167], a[12:15], v[108:111]
  ds_read_b64_tr_b16 a[198:199], v2 offset:38912
  buffer_load_dwordx4 a[220:223], v13, s[12:15], s61 offen
  v_mfma_f32_16x16x32_bf16 v[124:127], a[172:175], a[12:15], 0
  ds_read_b64_tr_b16 a[208:209], v2 offset:40960
  s_mov_b32 s61, 7168
  v_mfma_f32_16x16x32_bf16 v[124:127], a[168:171], a[28:31], v[124:127]
  ds_read_b64_tr_b16 a[210:211], v2 offset:43008
  buffer_load_dwordx4 a[224:227], v13, s[12:15], s61 offen
  v_mfma_f32_16x16x32_bf16 v[120:123], a[168:171], a[24:27], 0
  ds_read_b64_tr_b16 a[204:205], v2 offset:45056
  s_mov_b32 s61, 14336
  s_and_b32 s54, s54, 8
  v_mfma_f32_16x16x32_bf16 v[120:123], a[172:175], a[8:11], v[120:123]
  s_waitcnt lgkmcnt(7)
  ds_read_b64_tr_b16 a[206:207], v2 offset:47104
  buffer_load_dwordx4 a[228:231], v13, s[12:15], s61 offen
  v_mfma_f32_16x16x32_bf16 v[40:43], a[180:183], a[8:11], 0
  ds_read_b64_tr_b16 a[160:161], v3 offset:32768
  s_mov_b32 s61, 21504
  v_mfma_f32_16x16x32_bf16 v[40:43], a[176:179], a[24:27], v[40:43]
  ds_read_b64_tr_b16 a[162:163], v3 offset:34816
  buffer_load_dwordx4 a[232:235], v13, s[12:15], s61 offen
  v_mfma_f32_16x16x32_bf16 v[44:47], a[176:179], a[28:31], 0
  ds_read_b64_tr_b16 a[164:165], v3 offset:36864
  s_add_u32 s53, s53, s54
  v_mfma_f32_16x16x32_bf16 v[44:47], a[180:183], a[12:15], v[44:47]
  ds_read_b64_tr_b16 a[166:167], v3 offset:38912
  s_add_u32 s59, s53, 3072
  v_mfma_f32_16x16x32_bf16 v[60:63], a[192:195], a[12:15], 0
  ds_read_b64_tr_b16 a[168:169], v3 offset:40960
  s_mul_i32 s53, s52, 14336
  v_mfma_f32_16x16x32_bf16 v[60:63], a[188:191], a[28:31], v[60:63]
  ds_read_b64_tr_b16 a[170:171], v3 offset:43008
  s_mul_i32 s54, s62, 131072
  v_mfma_f32_16x16x32_bf16 v[56:59], a[188:191], a[24:27], 0
  ds_read_b64_tr_b16 a[172:173], v3 offset:45056
  s_add_u32 s53, s53, s54
  v_mfma_f32_16x16x32_bf16 v[56:59], a[192:195], a[8:11], v[56:59]
  s_waitcnt lgkmcnt(7)
  ds_read_b64_tr_b16 a[174:175], v3 offset:47104
  v_mfma_f32_16x16x32_bf16 v[136:139], a[200:203], a[8:11], 0
  ds_read_b64_tr_b16 a[176:177], v4 offset:32768
  s_add_u32 s53, s53, 19922944
  v_mfma_f32_16x16x32_bf16 v[136:139], a[196:199], a[24:27], v[136:139]
  ds_read_b64_tr_b16 a[178:179], v4 offset:34816
  s_add_u32 s57, s57, s53
  v_mfma_f32_16x16x32_bf16 v[140:143], a[196:199], a[28:31], 0
  ds_read_b64_tr_b16 a[180:181], v4 offset:36864
  s_add_u32 s58, s58, s53
  v_mfma_f32_16x16x32_bf16 v[140:143], a[200:203], a[12:15], v[140:143]
  ds_read_b64_tr_b16 a[182:183], v4 offset:38912
  s_add_u32 s59, s59, s53
  v_mfma_f32_16x16x32_bf16 v[156:159], a[208:211], a[12:15], 0
  ds_read_b64_tr_b16 a[188:189], v4 offset:40960
  s_lshl_b32 s62, s50, 2
  v_mfma_f32_16x16x32_bf16 v[156:159], a[204:207], a[28:31], v[156:159]
  ds_read_b64_tr_b16 a[190:191], v4 offset:43008
  s_add_u32 s62, s62, s44
  v_mfma_f32_16x16x32_bf16 v[152:155], a[204:207], a[24:27], 0
  ds_read_b64_tr_b16 a[192:193], v4 offset:45056
  s_lshl_b32 s62, s62, 14
  v_mfma_f32_16x16x32_bf16 v[152:155], a[208:211], a[8:11], v[152:155]
  s_waitcnt lgkmcnt(7)
  ds_read_b64_tr_b16 a[194:195], v4 offset:47104
  v_mfma_f32_16x16x32_bf16 v[168:171], a[160:163], a[8:11], 0
  ds_read_b64_tr_b16 a[196:197], v5 offset:32768
  s_add_u32 s62, s62, 6291456
  v_mfma_f32_16x16x32_bf16 v[168:171], a[164:167], a[24:27], v[168:171]
  ds_read_b64_tr_b16 a[198:199], v5 offset:34816
  v_and_b32 v12, 0x300, v1
  v_mfma_f32_16x16x32_bf16 v[172:175], a[164:167], a[28:31], 0
  ds_read_b64_tr_b16 a[200:201], v5 offset:36864
  v_add_u32 v12, v12, v1
  v_mfma_f32_16x16x32_bf16 v[172:175], a[160:163], a[12:15], v[172:175]
  ds_read_b64_tr_b16 a[202:203], v5 offset:38912
  v_mfma_f32_16x16x32_bf16 v[188:191], a[168:171], a[12:15], 0
  ds_read_b64_tr_b16 a[204:205], v5 offset:40960
  v_mfma_f32_16x16x32_bf16 v[188:191], a[172:175], a[28:31], v[188:191]
  ds_read_b64_tr_b16 a[206:207], v5 offset:43008
  v_mfma_f32_16x16x32_bf16 v[184:187], a[172:175], a[24:27], 0
  ds_read_b64_tr_b16 a[208:209], v5 offset:45056
  v_mfma_f32_16x16x32_bf16 v[184:187], a[168:171], a[8:11], v[184:187]
  s_waitcnt lgkmcnt(7)
  ds_read_b64_tr_b16 a[210:211], v5 offset:47104
  v_mfma_f32_16x16x32_bf16 v[200:203], a[176:179], a[8:11], 0
  ds_read_b64_tr_b16 a[164:165], v6 offset:49152
  v_mfma_f32_16x16x32_bf16 v[200:203], a[180:183], a[24:27], v[200:203]
  ds_read_b64_tr_b16 a[166:167], v6 offset:51200
  v_mfma_f32_16x16x32_bf16 v[204:207], a[180:183], a[28:31], 0
  ds_read_b64_tr_b16 a[160:161], v6 offset:53248
  v_mfma_f32_16x16x32_bf16 v[204:207], a[176:179], a[12:15], v[204:207]
  ds_read_b64_tr_b16 a[162:163], v6 offset:55296
  v_mfma_f32_16x16x32_bf16 v[220:223], a[188:191], a[12:15], 0
  ds_read_b64_tr_b16 a[172:173], v6 offset:57344
  v_mfma_f32_16x16x32_bf16 v[220:223], a[192:195], a[28:31], v[220:223]
  ds_read_b64_tr_b16 a[174:175], v6 offset:59392
  v_mfma_f32_16x16x32_bf16 v[216:219], a[192:195], a[24:27], 0
  ds_read_b64_tr_b16 a[168:169], v6 offset:61440
  s_add_u32 s74, s74, 65536
  v_mfma_f32_16x16x32_bf16 v[216:219], a[188:191], a[8:11], v[216:219]
  s_waitcnt lgkmcnt(7)
  ds_read_b64_tr_b16 a[170:171], v6 offset:63488
  v_mfma_f32_16x16x32_bf16 v[232:235], a[196:199], a[8:11], 0
  ds_read_b64_tr_b16 a[180:181], v7 offset:49152
  buffer_load_dwordx4 a[100:103], v1, s[8:11], s74 offen offset:0 sc1
  v_mfma_f32_16x16x32_bf16 v[232:235], a[200:203], a[24:27], v[232:235]
  ds_read_b64_tr_b16 a[182:183], v7 offset:51200
  v_mfma_f32_16x16x32_bf16 v[236:239], a[200:203], a[28:31], 0
  ds_read_b64_tr_b16 a[176:177], v7 offset:53248
  v_mfma_f32_16x16x32_bf16 v[236:239], a[196:199], a[12:15], v[236:239]
  ds_read_b64_tr_b16 a[178:179], v7 offset:55296
  v_mfma_f32_16x16x32_bf16 v[252:255], a[204:207], a[12:15], 0
  ds_read_b64_tr_b16 a[192:193], v7 offset:57344
  s_barrier
  v_mfma_f32_16x16x32_bf16 v[252:255], a[208:211], a[28:31], v[252:255]
  ds_read_b64_tr_b16 a[194:195], v7 offset:59392
  buffer_load_dwordx4 a[116:119], v1, s[8:11], s74 offen offset:1024 sc1
  v_mfma_f32_16x16x32_bf16 v[248:251], a[208:211], a[24:27], 0
  ds_read_b64_tr_b16 a[188:189], v7 offset:61440
  v_mfma_f32_16x16x32_bf16 v[248:251], a[204:207], a[8:11], v[248:251]
  s_waitcnt vmcnt(11) lgkmcnt(7)
  ds_read_b64_tr_b16 a[190:191], v7 offset:63488
  v_mfma_f32_16x16x32_bf16 v[72:75], a[164:167], a[40:43], v[72:75]
  ds_read_b64_tr_b16 a[200:201], v8 offset:49152
  s_add_u32 s74, s74, 65536
  v_mfma_f32_16x16x32_bf16 v[72:75], a[160:163], a[56:59], v[72:75]
  ds_read_b64_tr_b16 a[202:203], v8 offset:51200
  buffer_load_dwordx4 a[104:107], v1, s[8:11], s74 offen offset:0 sc1
  v_mfma_f32_16x16x32_bf16 v[76:79], a[160:163], a[60:63], v[76:79]
  ds_read_b64_tr_b16 a[196:197], v8 offset:53248
  v_mfma_f32_16x16x32_bf16 v[76:79], a[164:167], a[44:47], v[76:79]
  ds_read_b64_tr_b16 a[198:199], v8 offset:55296
  v_mfma_f32_16x16x32_bf16 v[92:95], a[172:175], a[44:47], v[92:95]
  ds_read_b64_tr_b16 a[208:209], v8 offset:57344
  v_mfma_f32_16x16x32_bf16 v[92:95], a[168:171], a[60:63], v[92:95]
  ds_read_b64_tr_b16 a[210:211], v8 offset:59392
  v_mfma_f32_16x16x32_bf16 v[88:91], a[168:171], a[56:59], v[88:91]
  ds_read_b64_tr_b16 a[204:205], v8 offset:61440
  buffer_load_dwordx4 a[120:123], v1, s[8:11], s74 offen offset:1024 sc1
  v_mfma_f32_16x16x32_bf16 v[88:91], a[172:175], a[40:43], v[88:91]
  s_waitcnt lgkmcnt(7)
  ds_read_b64_tr_b16 a[206:207], v8 offset:63488
  v_mfma_f32_16x16x32_bf16 v[104:107], a[180:183], a[40:43], v[104:107]
  ds_read_b64_tr_b16 a[160:161], v2 offset:49152
  v_mfma_f32_16x16x32_bf16 v[104:107], a[176:179], a[56:59], v[104:107]
  ds_read_b64_tr_b16 a[162:163], v2 offset:51200
  v_mfma_f32_16x16x32_bf16 v[108:111], a[176:179], a[60:63], v[108:111]
  ds_read_b64_tr_b16 a[164:165], v2 offset:53248
  s_add_u32 s74, s74, 65536
  v_mfma_f32_16x16x32_bf16 v[108:111], a[180:183], a[44:47], v[108:111]
  ds_read_b64_tr_b16 a[166:167], v2 offset:55296
  buffer_load_dwordx4 a[108:111], v1, s[8:11], s74 offen offset:0 sc1
  v_mfma_f32_16x16x32_bf16 v[124:127], a[192:195], a[44:47], v[124:127]
  ds_read_b64_tr_b16 a[168:169], v2 offset:57344
  v_mfma_f32_16x16x32_bf16 v[124:127], a[188:191], a[60:63], v[124:127]
  ds_read_b64_tr_b16 a[170:171], v2 offset:59392
  v_mfma_f32_16x16x32_bf16 v[120:123], a[188:191], a[56:59], v[120:123]
  ds_read_b64_tr_b16 a[172:173], v2 offset:61440
  v_mfma_f32_16x16x32_bf16 v[120:123], a[192:195], a[40:43], v[120:123]
  s_waitcnt lgkmcnt(7)
  ds_read_b64_tr_b16 a[174:175], v2 offset:63488
  v_mfma_f32_16x16x32_bf16 v[40:43], a[200:203], a[40:43], v[40:43]
  ds_read_b64_tr_b16 a[176:177], v3 offset:49152
  buffer_load_dwordx4 a[124:127], v1, s[8:11], s74 offen offset:1024 sc1
  v_mfma_f32_16x16x32_bf16 v[40:43], a[196:199], a[56:59], v[40:43]
  ds_read_b64_tr_b16 a[178:179], v3 offset:51200
  v_mfma_f32_16x16x32_bf16 v[44:47], a[196:199], a[60:63], v[44:47]
  ds_read_b64_tr_b16 a[180:181], v3 offset:53248
  v_mfma_f32_16x16x32_bf16 v[44:47], a[200:203], a[44:47], v[44:47]
  ds_read_b64_tr_b16 a[182:183], v3 offset:55296
  v_mfma_f32_16x16x32_bf16 v[60:63], a[208:211], a[44:47], v[60:63]
  ds_read_b64_tr_b16 a[188:189], v3 offset:57344
  s_mov_b32 s61, 28672
  v_mfma_f32_16x16x32_bf16 v[60:63], a[204:207], a[60:63], v[60:63]
  ds_read_b64_tr_b16 a[190:191], v3 offset:59392
  buffer_load_dwordx4 a[236:239], v13, s[12:15], s61 offen
  v_mfma_f32_16x16x32_bf16 v[56:59], a[204:207], a[56:59], v[56:59]
  ds_read_b64_tr_b16 a[192:193], v3 offset:61440
  s_mov_b32 s61, 35840
  v_mfma_f32_16x16x32_bf16 v[56:59], a[208:211], a[40:43], v[56:59]
  s_waitcnt lgkmcnt(7)
  ds_read_b64_tr_b16 a[194:195], v3 offset:63488
  buffer_load_dwordx4 a[240:243], v13, s[12:15], s61 offen
  v_mfma_f32_16x16x32_bf16 v[136:139], a[160:163], a[40:43], v[136:139]
  ds_read_b64_tr_b16 a[196:197], v4 offset:49152
  s_mov_b32 s61, 43008
  v_mfma_f32_16x16x32_bf16 v[136:139], a[164:167], a[56:59], v[136:139]
  ds_read_b64_tr_b16 a[198:199], v4 offset:51200
  buffer_load_dwordx4 a[244:247], v13, s[12:15], s61 offen
  v_mfma_f32_16x16x32_bf16 v[140:143], a[164:167], a[60:63], v[140:143]
  ds_read_b64_tr_b16 a[200:201], v4 offset:53248
  s_mov_b32 s61, 50176
  v_mfma_f32_16x16x32_bf16 v[140:143], a[160:163], a[44:47], v[140:143]
  ds_read_b64_tr_b16 a[202:203], v4 offset:55296
  buffer_load_dwordx4 a[248:251], v13, s[12:15], s61 offen
  v_mfma_f32_16x16x32_bf16 v[156:159], a[168:171], a[44:47], v[156:159]
  ds_read_b64_tr_b16 a[204:205], v4 offset:57344
  v_mfma_f32_16x16x32_bf16 v[156:159], a[172:175], a[60:63], v[156:159]
  ds_read_b64_tr_b16 a[206:207], v4 offset:59392
  v_mfma_f32_16x16x32_bf16 v[152:155], a[172:175], a[56:59], v[152:155]
  ds_read_b64_tr_b16 a[208:209], v4 offset:61440
  v_mfma_f32_16x16x32_bf16 v[152:155], a[168:171], a[40:43], v[152:155]
  s_waitcnt lgkmcnt(7)
  ds_read_b64_tr_b16 a[210:211], v4 offset:63488
  v_mfma_f32_16x16x32_bf16 v[168:171], a[176:179], a[40:43], v[168:171]
  ds_read_b64_tr_b16 a[164:165], v5 offset:49152
  v_mfma_f32_16x16x32_bf16 v[168:171], a[180:183], a[56:59], v[168:171]
  ds_read_b64_tr_b16 a[166:167], v5 offset:51200
  v_mfma_f32_16x16x32_bf16 v[172:175], a[180:183], a[60:63], v[172:175]
  ds_read_b64_tr_b16 a[160:161], v5 offset:53248
  v_mfma_f32_16x16x32_bf16 v[172:175], a[176:179], a[44:47], v[172:175]
  ds_read_b64_tr_b16 a[162:163], v5 offset:55296
  v_mfma_f32_16x16x32_bf16 v[188:191], a[188:191], a[44:47], v[188:191]
  ds_read_b64_tr_b16 a[172:173], v5 offset:57344
  v_mfma_f32_16x16x32_bf16 v[188:191], a[192:195], a[60:63], v[188:191]
  ds_read_b64_tr_b16 a[174:175], v5 offset:59392
  s_waitcnt vmcnt(41)
  s_barrier
  v_mfma_f32_16x16x32_bf16 v[184:187], a[192:195], a[56:59], v[184:187]
  ds_read_b64_tr_b16 a[168:169], v5 offset:61440
  ds_read_b64_tr_b16 a[180:181], v6 offset:16384
  v_mfma_f32_16x16x32_bf16 v[184:187], a[188:191], a[40:43], v[184:187]
  s_waitcnt lgkmcnt(8)
  ds_read_b64_tr_b16 a[170:171], v5 offset:63488
  v_mfma_f32_16x16x32_bf16 v[200:203], a[196:199], a[40:43], v[200:203]
  ds_read_b64_tr_b16 a[182:183], v6 offset:18432
  v_mfma_f32_16x16x32_bf16 v[200:203], a[200:203], a[56:59], v[200:203]
  v_mfma_f32_16x16x32_bf16 v[204:207], a[200:203], a[60:63], v[204:207]
  ds_read_b64_tr_b16 a[176:177], v6 offset:20480
  v_mfma_f32_16x16x32_bf16 v[204:207], a[196:199], a[44:47], v[204:207]
  v_mfma_f32_16x16x32_bf16 v[220:223], a[204:207], a[44:47], v[220:223]
  ds_read_b64_tr_b16 a[178:179], v6 offset:22528
  v_mfma_f32_16x16x32_bf16 v[220:223], a[208:211], a[60:63], v[220:223]
  ds_read_b128 v[24:27], v14 offset:0
  v_mfma_f32_16x16x32_bf16 v[216:219], a[208:211], a[56:59], v[216:219]
  ds_read_b64_tr_b16 a[192:193], v6 offset:24576
  v_mfma_f32_16x16x32_bf16 v[216:219], a[204:207], a[40:43], v[216:219]
  s_waitcnt lgkmcnt(5)
  v_mfma_f32_16x16x32_bf16 v[232:235], a[164:167], a[40:43], v[232:235]
  ds_read_b64_tr_b16 a[194:195], v6 offset:26624
  v_mfma_f32_16x16x32_bf16 v[232:235], a[160:163], a[56:59], v[232:235]
  v_mfma_f32_16x16x32_bf16 v[236:239], a[160:163], a[60:63], v[236:239]
  ds_read_b64_tr_b16 a[188:189], v6 offset:28672
  v_mfma_f32_16x16x32_bf16 v[236:239], a[164:167], a[44:47], v[236:239]
  s_waitcnt vmcnt(10) lgkmcnt(3)
  v_cndmask_b32 v28, 0, v24, s[16:17]
  v_cndmask_b32 v29, 0, v24, s[18:19]
  v_mfma_f32_16x16x32_bf16 v[252:255], a[172:175], a[44:47], v[252:255]
  ds_read_b64_tr_b16 a[190:191], v6 offset:30720
  v_cndmask_b32 v30, 0, v24, s[20:21]
  v_mfma_f32_16x16x32_bf16 v[252:255], a[168:171], a[60:63], v[252:255]
  v_cndmask_b32 v31, 0, v24, s[22:23]
  v_mfma_f32_16x16x32_bf16 v[248:251], a[168:171], a[56:59], v[248:251]
  ds_read_b64_tr_b16 a[200:201], v7 offset:16384
  v_mfma_f32_16x16x32_bf16 a[184:187], v[28:31], a[220:223], 0
  v_cndmask_b32 v28, 0, v25, s[16:17]
  v_cndmask_b32 v29, 0, v25, s[18:19]
  v_mfma_f32_16x16x32_bf16 v[248:251], a[172:175], a[40:43], v[248:251]
  s_waitcnt vmcnt(15) lgkmcnt(6)
  s_mov_b32 s67, 1835008
  s_add_u32 s75, s24, 8192
  s_add_u32 m0, s45, 98304
  v_cndmask_b32 v30, 0, v25, s[20:21]
  v_mfma_f32_16x16x32_bf16 v[64:67], a[180:183], a[64:67], v[64:67]
  ds_read_b64_tr_b16 a[202:203], v7 offset:18432
  v_cndmask_b32 v31, 0, v25, s[22:23]
  v_mfma_f32_16x16x32_bf16 v[64:67], a[176:179], a[80:83], v[64:67]
  buffer_load_dwordx4 v11, s[28:31], s67 offen lds
  v_mfma_f32_16x16x32_bf16 a[184:187], v[28:31], a[224:227], a[184:187]
  v_cndmask_b32 v28, 0, v26, s[16:17]
  v_cndmask_b32 v29, 0, v26, s[18:19]
  v_mfma_f32_16x16x32_bf16 v[68:71], a[176:179], a[84:87], v[68:71]
  ds_read_b64_tr_b16 a[196:197], v7 offset:20480
  v_cndmask_b32 v30, 0, v26, s[20:21]
  v_mfma_f32_16x16x32_bf16 v[68:71], a[180:183], a[68:71], v[68:71]
  v_cndmask_b32 v31, 0, v26, s[22:23]
  v_mfma_f32_16x16x32_bf16 v[72:75], a[180:183], a[72:75], v[72:75]
  ds_read_b64_tr_b16 a[198:199], v7 offset:22528
  v_mfma_f32_16x16x32_bf16 a[184:187], v[28:31], a[228:231], a[184:187]
  v_cndmask_b32 v28, 0, v27, s[16:17]
  v_cndmask_b32 v29, 0, v27, s[18:19]
  v_mfma_f32_16x16x32_bf16 v[72:75], a[176:179], a[88:91], v[72:75]
  s_add_u32 m0, s45, 106496
  v_cndmask_b32 v30, 0, v27, s[20:21]
  v_cndmask_b32 v31, 0, v27, s[22:23]
  v_mfma_f32_16x16x32_bf16 v[76:79], a[176:179], a[92:95], v[76:79]
  ds_read_b64_tr_b16 a[160:161], v7 offset:24576
  v_mfma_f32_16x16x32_bf16 a[184:187], v[28:31], a[232:235], a[184:187]
  v_mfma_f32_16x16x32_bf16 v[76:79], a[180:183], a[76:79], v[76:79]
  s_waitcnt lgkmcnt(5)
  buffer_load_dwordx4 v11, s[32:35], s67 offen lds
  v_mfma_f32_16x16x32_bf16 v[92:95], a[192:195], a[76:79], v[92:95]
  ds_read_b64_tr_b16 a[162:163], v7 offset:26624
  v_mfma_f32_16x16x32_bf16 v[92:95], a[188:191], a[92:95], v[92:95]
  s_add_u32 m0, s45, 102400
  s_add_u32 s60, s67, 229376
  v_mfma_f32_16x16x32_bf16 v[88:91], a[188:191], a[88:91], v[88:91]
  ds_read_b64_tr_b16 a[164:165], v7 offset:28672
  v_mfma_f32_16x16x32_bf16 v[88:91], a[192:195], a[72:75], v[88:91]
  buffer_load_dwordx4 v11, s[28:31], s60 offen lds
  v_mfma_f32_16x16x32_bf16 v[84:87], a[192:195], a[68:71], v[84:87]
  ds_read_b64_tr_b16 a[166:167], v7 offset:30720
  v_mfma_f32_16x16x32_bf16 v[84:87], a[188:191], a[84:87], v[84:87]
  v_mfma_f32_16x16x32_bf16 v[80:83], a[188:191], a[80:83], v[80:83]
  ds_read_b64_tr_b16 a[168:169], v8 offset:16384
  v_mfma_f32_16x16x32_bf16 v[80:83], a[192:195], a[64:67], v[80:83]
  s_waitcnt lgkmcnt(5)
  s_add_u32 m0, s45, 110592
  s_add_u32 s60, s67, 229376
  v_mfma_f32_16x16x32_bf16 v[96:99], a[200:203], a[64:67], v[96:99]
  ds_read_b64_tr_b16 a[170:171], v8 offset:18432
  v_mfma_f32_16x16x32_bf16 v[96:99], a[196:199], a[80:83], v[96:99]
  buffer_load_dwordx4 v11, s[32:35], s60 offen lds
  v_mfma_f32_16x16x32_bf16 v[100:103], a[196:199], a[84:87], v[100:103]
  ds_read_b64_tr_b16 a[172:173], v8 offset:20480
  v_mfma_f32_16x16x32_bf16 v[100:103], a[200:203], a[68:71], v[100:103]
  s_add_u32 m0, s45, 32768
  v_mfma_f32_16x16x32_bf16 v[104:107], a[200:203], a[72:75], v[104:107]
  ds_read_b64_tr_b16 a[174:175], v8 offset:22528
  v_mfma_f32_16x16x32_bf16 v[104:107], a[196:199], a[88:91], v[104:107]
  buffer_load_dwordx4 v10, s[28:31], s67 offen lds
  v_mfma_f32_16x16x32_bf16 v[108:111], a[196:199], a[92:95], v[108:111]
  ds_read_b64_tr_b16 a[176:177], v8 offset:24576
  v_mfma_f32_16x16x32_bf16 v[108:111], a[200:203], a[76:79], v[108:111]
  s_waitcnt lgkmcnt(5)
  v_mfma_f32_16x16x32_bf16 v[124:127], a[160:163], a[76:79], v[124:127]
  ds_read_b64_tr_b16 a[178:179], v8 offset:26624
  v_mfma_f32_16x16x32_bf16 v[124:127], a[164:167], a[92:95], v[124:127]
  s_add_u32 m0, s45, 40960
  v_mfma_f32_16x16x32_bf16 v[120:123], a[164:167], a[88:91], v[120:123]
  ds_read_b64_tr_b16 a[180:181], v8 offset:28672
  v_mfma_f32_16x16x32_bf16 v[120:123], a[160:163], a[72:75], v[120:123]
  buffer_load_dwordx4 v10, s[32:35], s67 offen lds
  v_mfma_f32_16x16x32_bf16 v[116:119], a[160:163], a[68:71], v[116:119]
  ds_read_b64_tr_b16 a[182:183], v8 offset:30720
  v_mfma_f32_16x16x32_bf16 v[116:119], a[164:167], a[84:87], v[116:119]
  s_add_u32 m0, s45, 36864
  s_add_u32 s60, s67, 229376
  v_mfma_f32_16x16x32_bf16 v[112:115], a[164:167], a[80:83], v[112:115]
  ds_read_b64_tr_b16 a[164:165], v2 offset:16384
  v_mfma_f32_16x16x32_bf16 v[112:115], a[160:163], a[64:67], v[112:115]
  s_waitcnt lgkmcnt(5)
  buffer_load_dwordx4 v10, s[28:31], s60 offen lds
  v_mfma_f32_16x16x32_bf16 v[32:35], a[168:171], a[64:67], v[32:35]
  ds_read_b64_tr_b16 a[166:167], v2 offset:18432
  v_mfma_f32_16x16x32_bf16 v[32:35], a[172:175], a[80:83], v[32:35]
  v_mfma_f32_16x16x32_bf16 v[36:39], a[172:175], a[84:87], v[36:39]
  ds_read_b64_tr_b16 a[160:161], v2 offset:20480
  v_mfma_f32_16x16x32_bf16 v[36:39], a[168:171], a[68:71], v[36:39]
  s_add_u32 m0, s45, 45056
  s_add_u32 s60, s67, 229376
  v_mfma_f32_16x16x32_bf16 v[40:43], a[168:171], a[72:75], v[40:43]
  ds_read_b64_tr_b16 a[162:163], v2 offset:22528
  v_mfma_f32_16x16x32_bf16 v[40:43], a[172:175], a[88:91], v[40:43]
  buffer_load_dwordx4 v10, s[32:35], s60 offen lds
  v_mfma_f32_16x16x32_bf16 v[44:47], a[172:175], a[92:95], v[44:47]
  ds_read_b64_tr_b16 a[172:173], v2 offset:24576
  v_mfma_f32_16x16x32_bf16 v[44:47], a[168:171], a[76:79], v[44:47]
  s_waitcnt lgkmcnt(5)
  s_mov_b32 s61, 57344
  v_mfma_f32_16x16x32_bf16 v[60:63], a[176:179], a[76:79], v[60:63]
  ds_read_b64_tr_b16 a[174:175], v2 offset:26624
  v_mfma_f32_16x16x32_bf16 v[60:63], a[180:183], a[92:95], v[60:63]
  buffer_load_dwordx4 a[220:223], v13, s[12:15], s61 offen
  s_mov_b32 s61, 64512
  v_mfma_f32_16x16x32_bf16 v[56:59], a[180:183], a[88:91], v[56:59]
  ds_read_b64_tr_b16 a[168:169], v2 offset:28672
  v_mfma_f32_16x16x32_bf16 v[56:59], a[176:179], a[72:75], v[56:59]
  buffer_load_dwordx4 a[224:227], v13, s[12:15], s61 offen
  s_mov_b32 s61, 71680
  v_mfma_f32_16x16x32_bf16 v[52:55], a[176:179], a[68:71], v[52:55]
  ds_read_b64_tr_b16 a[170:171], v2 offset:30720
  v_mfma_f32_16x16x32_bf16 v[52:55], a[180:183], a[84:87], v[52:55]
  buffer_load_dwordx4 a[228:231], v13, s[12:15], s61 offen
  s_mov_b32 s61, 78848
  v_mfma_f32_16x16x32_bf16 v[48:51], a[180:183], a[80:83], v[48:51]
  ds_read_b64_tr_b16 a[180:181], v3 offset:16384
  v_mfma_f32_16x16x32_bf16 v[48:51], a[176:179], a[64:67], v[48:51]
  s_waitcnt lgkmcnt(5)
  buffer_load_dwordx4 a[232:235], v13, s[12:15], s61 offen
  v_mfma_f32_16x16x32_bf16 v[128:131], a[164:167], a[64:67], v[128:131]
HOP8:
  s_cbranch_execz WRET0
  ds_read_b64_tr_b16 a[182:183], v3 offset:18432
  v_mfma_f32_16x16x32_bf16 v[128:131], a[160:163], a[80:83], v[128:131]
  v_mfma_f32_16x16x32_bf16 v[132:135], a[160:163], a[84:87], v[132:135]
  ds_read_b64_tr_b16 a[176:177], v3 offset:20480
  v_mfma_f32_16x16x32_bf16 v[132:135], a[164:167], a[68:71], v[132:135]
  v_mfma_f32_16x16x32_bf16 v[136:139], a[164:167], a[72:75], v[136:139]
  ds_read_b64_tr_b16 a[178:179], v3 offset:22528
  v_mfma_f32_16x16x32_bf16 v[136:139], a[160:163], a[88:91], v[136:139]
  v_mfma_f32_16x16x32_bf16 v[140:143], a[160:163], a[92:95], v[140:143]
  ds_read_b64_tr_b16 a[160:161], v3 offset:24576
  v_mfma_f32_16x16x32_bf16 v[140:143], a[164:167], a[76:79], v[140:143]
  s_waitcnt lgkmcnt(5)
  v_mfma_f32_16x16x32_bf16 v[156:159], a[172:175], a[76:79], v[156:159]
  ds_read_b64_tr_b16 a[162:163], v3 offset:26624
  v_mfma_f32_16x16x32_bf16 v[156:159], a[168:171], a[92:95], v[156:159]
  ds_read_b128 v[24:27], v14 offset:16
  v_mfma_f32_16x16x32_bf16 v[152:155], a[168:171], a[88:91], v[152:155]
  ds_read_b64_tr_b16 a[164:165], v3 offset:28672
  v_mfma_f32_16x16x32_bf16 v[152:155], a[172:175], a[72:75], v[152:155]
  v_mfma_f32_16x16x32_bf16 v[148:151], a[172:175], a[68:71], v[148:151]
  ds_read_b64_tr_b16 a[166:167], v3 offset:30720
  v_mfma_f32_16x16x32_bf16 v[148:151], a[168:171], a[84:87], v[148:151]
  v_mfma_f32_16x16x32_bf16 v[144:147], a[168:171], a[80:83], v[144:147]
  ds_read_b64_tr_b16 a[168:169], v4 offset:16384
  v_mfma_f32_16x16x32_bf16 v[144:147], a[172:175], a[64:67], v[144:147]
  s_waitcnt lgkmcnt(6)
  s_waitcnt vmcnt(12) lgkmcnt(3)
  v_cndmask_b32 v28, 0, v24, s[16:17]
  v_mfma_f32_16x16x32_bf16 v[160:163], a[180:183], a[64:67], v[160:163]
  ds_read_b64_tr_b16 a[170:171], v4 offset:18432
  v_cndmask_b32 v29, 0, v24, s[18:19]
  v_mfma_f32_16x16x32_bf16 v[160:163], a[176:179], a[80:83], v[160:163]
  v_cndmask_b32 v30, 0, v24, s[20:21]
  v_cndmask_b32 v31, 0, v24, s[22:23]
  v_mfma_f32_16x16x32_bf16 v[164:167], a[176:179], a[84:87], v[164:167]
  ds_read_b64_tr_b16 a[172:173], v4 offset:20480
  v_mfma_f32_16x16x32_bf16 a[184:187], v[28:31], a[236:239], a[184:187]
  v_cndmask_b32 v28, 0, v25, s[16:17]
  v_cndmask_b32 v29, 0, v25, s[18:19]
  v_mfma_f32_16x16x32_bf16 v[164:167], a[180:183], a[68:71], v[164:167]
  v_cndmask_b32 v30, 0, v25, s[20:21]
  v_cndmask_b32 v31, 0, v25, s[22:23]
  v_mfma_f32_16x16x32_bf16 v[168:171], a[180:183], a[72:75], v[168:171]
  ds_read_b64_tr_b16 a[174:175], v4 offset:22528
  v_mfma_f32_16x16x32_bf16 a[184:187], v[28:31], a[240:243], a[184:187]
  v_cndmask_b32 v28, 0, v26, s[16:17]
  v_cndmask_b32 v29, 0, v26, s[18:19]
  v_mfma_f32_16x16x32_bf16 v[168:171], a[176:179], a[88:91], v[168:171]
  v_cndmask_b32 v30, 0, v26, s[20:21]
  v_cndmask_b32 v31, 0, v26, s[22:23]
  v_mfma_f32_16x16x32_bf16 v[172:175], a[176:179], a[92:95], v[172:175]
  ds_read_b64_tr_b16 a[176:177], v4 offset:24576
  v_mfma_f32_16x16x32_bf16 a[184:187], v[28:31], a[244:247], a[184:187]
  v_cndmask_b32 v28, 0, v27, s[16:17]
  v_cndmask_b32 v29, 0, v27, s[18:19]
  v_mfma_f32_16x16x32_bf16 v[172:175], a[180:183], a[76:79], v[172:175]
  s_waitcnt lgkmcnt(5)
  v_cndmask_b32 v30, 0, v27, s[20:21]
  v_cndmask_b32 v31, 0, v27, s[22:23]
  v_mfma_f32_16x16x32_bf16 v[188:191], a[160:163], a[76:79], v[188:191]
  ds_read_b64_tr_b16 a[178:179], v4 offset:26624
  v_mfma_f32_16x16x32_bf16 a[184:187], v[28:31], a[248:251], a[184:187]
  v_mfma_f32_16x16x32_bf16 v[188:191], a[164:167], a[92:95], v[188:191]
  v_mfma_f32_16x16x32_bf16 v[184:187], a[164:167], a[88:91], v[184:187]
  ds_read_b64_tr_b16 a[180:181], v4 offset:28672
  v_mfma_f32_16x16x32_bf16 v[184:187], a[160:163], a[72:75], v[184:187]
  v_mfma_f32_16x16x32_bf16 v[180:183], a[160:163], a[68:71], v[180:183]
  ds_read_b64_tr_b16 a[182:183], v4 offset:30720
  s_add_u32 s61, s62, 0
  v_mfma_f32_16x16x32_bf16 v[180:183], a[164:167], a[84:87], v[180:183]
  buffer_load_dwordx4 a[188:191], v12, s[8:11], s61 offen offset:0 sc1
  v_mfma_f32_16x16x32_bf16 v[176:179], a[164:167], a[80:83], v[176:179]
  ds_read_b64_tr_b16 a[164:165], v5 offset:16384
  v_mfma_f32_16x16x32_bf16 v[176:179], a[160:163], a[64:67], v[176:179]
  s_waitcnt lgkmcnt(5)
  v_mfma_f32_16x16x32_bf16 v[192:195], a[168:171], a[64:67], v[192:195]
  ds_read_b64_tr_b16 a[166:167], v5 offset:18432
  v_mfma_f32_16x16x32_bf16 v[192:195], a[172:175], a[80:83], v[192:195]
  s_add_u32 s61, s62, 0
  v_mfma_f32_16x16x32_bf16 v[196:199], a[172:175], a[84:87], v[196:199]
  ds_read_b64_tr_b16 a[160:161], v5 offset:20480
  v_mfma_f32_16x16x32_bf16 v[196:199], a[168:171], a[68:71], v[196:199]
  buffer_load_dwordx4 a[192:195], v12, s[8:11], s61 offen offset:256 sc1
  v_mfma_f32_16x16x32_bf16 v[200:203], a[168:171], a[72:75], v[200:203]
  ds_read_b64_tr_b16 a[162:163], v5 offset:22528
  v_mfma_f32_16x16x32_bf16 v[200:203], a[172:175], a[88:91], v[200:203]
  s_add_u32 s61, s62, 2048
  v_mfma_f32_16x16x32_bf16 v[204:207], a[172:175], a[92:95], v[204:207]
  ds_read_b64_tr_b16 a[172:173], v5 offset:24576
  v_mfma_f32_16x16x32_bf16 v[204:207], a[168:171], a[76:79], v[204:207]
  s_waitcnt lgkmcnt(5)
  buffer_load_dwordx4 a[196:199], v12, s[8:11], s61 offen offset:0 sc1
  v_mfma_f32_16x16x32_bf16 v[220:223], a[176:179], a[76:79], v[220:223]
  ds_read_b64_tr_b16 a[174:175], v5 offset:26624
  v_mfma_f32_16x16x32_bf16 v[220:223], a[180:183], a[92:95], v[220:223]
  v_mfma_f32_16x16x32_bf16 v[216:219], a[180:183], a[88:91], v[216:219]
  ds_read_b64_tr_b16 a[168:169], v5 offset:28672
  v_mfma_f32_16x16x32_bf16 v[216:219], a[176:179], a[72:75], v[216:219]
  s_add_u32 s61, s62, 2048
  v_mfma_f32_16x16x32_bf16 v[212:215], a[176:179], a[68:71], v[212:215]
  ds_read_b64_tr_b16 a[170:171], v5 offset:30720
  buffer_load_dwordx4 a[200:203], v12, s[8:11], s61 offen offset:256 sc1
  v_mfma_f32_16x16x32_bf16 v[212:215], a[180:183], a[84:87], v[212:215]
  s_waitcnt vmcnt(44)
  s_barrier
  v_mfma_f32_16x16x32_bf16 v[208:211], a[180:183], a[80:83], v[208:211]
  ds_read_b64_tr_b16 a[180:181], v6 offset:0
  v_mfma_f32_16x16x32_bf16 v[208:211], a[176:179], a[64:67], v[208:211]
  s_waitcnt lgkmcnt(5)
  s_add_u32 s61, s62, 4096
  v_mfma_f32_16x16x32_bf16 v[224:227], a[164:167], a[64:67], v[224:227]
  ds_read_b64_tr_b16 a[182:183], v6 offset:2048
  v_mfma_f32_16x16x32_bf16 v[224:227], a[160:163], a[80:83], v[224:227]
  buffer_load_dwordx4 a[204:207], v12, s[8:11], s61 offen offset:0 sc1
  v_mfma_f32_16x16x32_bf16 v[228:231], a[160:163], a[84:87], v[228:231]
  ds_read_b64_tr_b16 a[176:177], v6 offset:4096
  v_mfma_f32_16x16x32_bf16 v[228:231], a[164:167], a[68:71], v[228:231]
  v_mfma_f32_16x16x32_bf16 v[232:235], a[164:167], a[72:75], v[232:235]
  ds_read_b64_tr_b16 a[178:179], v6 offset:6144
  v_mfma_f32_16x16x32_bf16 v[232:235], a[160:163], a[88:91], v[232:235]
  s_add_u32 s61, s62, 4096
  v_mfma_f32_16x16x32_bf16 v[236:239], a[160:163], a[92:95], v[236:239]
  ds_read_b64_tr_b16 a[160:161], v6 offset:8192
  v_mfma_f32_16x16x32_bf16 v[236:239], a[164:167], a[76:79], v[236:239]
  s_waitcnt lgkmcnt(5)
  buffer_load_dwordx4 a[208:211], v12, s[8:11], s61 offen offset:256 sc1
  v_mfma_f32_16x16x32_bf16 v[252:255], a[172:175], a[76:79], v[252:255]
  ds_read_b64_tr_b16 a[162:163], v6 offset:10240
  v_mfma_f32_16x16x32_bf16 v[252:255], a[168:171], a[92:95], v[252:255]
  s_add_u32 s61, s62, 6144
  v_mfma_f32_16x16x32_bf16 v[248:251], a[168:171], a[88:91], v[248:251]
  ds_read_b64_tr_b16 a[164:165], v6 offset:12288
  v_mfma_f32_16x16x32_bf16 v[248:251], a[172:175], a[72:75], v[248:251]
  buffer_load_dwordx4 a[212:215], v12, s[8:11], s61 offen offset:0 sc1
  v_mfma_f32_16x16x32_bf16 v[244:247], a[172:175], a[68:71], v[244:247]
  ds_read_b64_tr_b16 a[166:167], v6 offset:14336
  v_mfma_f32_16x16x32_bf16 v[244:247], a[168:171], a[84:87], v[244:247]
  v_mfma_f32_16x16x32_bf16 v[240:243], a[168:171], a[80:83], v[240:243]
  ds_read_b64_tr_b16 a[168:169], v7 offset:0
  v_mfma_f32_16x16x32_bf16 v[240:243], a[172:175], a[64:67], v[240:243]
  s_waitcnt vmcnt(23) lgkmcnt(5)
  s_add_u32 s61, s62, 6144
  v_mfma_f32_16x16x32_bf16 v[64:67], a[180:183], a[96:99], v[64:67]
  ds_read_b64_tr_b16 a[170:171], v7 offset:2048
  v_mfma_f32_16x16x32_bf16 v[64:67], a[176:179], a[112:115], v[64:67]
  buffer_load_dwordx4 a[216:219], v12, s[8:11], s61 offen offset:256 sc1
  v_mfma_f32_16x16x32_bf16 v[68:71], a[176:179], a[116:119], v[68:71]
  ds_read_b64_tr_b16 a[172:173], v7 offset:4096
  v_mfma_f32_16x16x32_bf16 v[68:71], a[180:183], a[100:103], v[68:71]
  v_mfma_f32_16x16x32_bf16 v[72:75], a[180:183], a[104:107], v[72:75]
  ds_read_b64_tr_b16 a[174:175], v7 offset:6144
  v_mfma_f32_16x16x32_bf16 v[72:75], a[176:179], a[120:123], v[72:75]
  buffer_load_dwordx4 a[128:131], v1, s[8:11], s75 offen offset:0 sc1
  v_mfma_f32_16x16x32_bf16 v[76:79], a[176:179], a[124:127], v[76:79]
  ds_read_b64_tr_b16 a[176:177], v7 offset:8192
  v_mfma_f32_16x16x32_bf16 v[76:79], a[180:183], a[108:111], v[76:79]
  s_waitcnt lgkmcnt(5)
  v_mfma_f32_16x16x32_bf16 v[92:95], a[160:163], a[108:111], v[92:95]
  ds_read_b64_tr_b16 a[178:179], v7 offset:10240
  v_mfma_f32_16x16x32_bf16 v[92:95], a[164:167], a[124:127], v[92:95]
  v_mfma_f32_16x16x32_bf16 v[88:91], a[164:167], a[120:123], v[88:91]
  ds_read_b64_tr_b16 a[180:181], v7 offset:12288
  v_mfma_f32_16x16x32_bf16 v[88:91], a[160:163], a[104:107], v[88:91]
  buffer_load_dwordx4 a[144:147], v1, s[8:11], s75 offen offset:1024 sc1
  v_mfma_f32_16x16x32_bf16 v[84:87], a[160:163], a[100:103], v[84:87]
  ds_read_b64_tr_b16 a[182:183], v7 offset:14336
  v_mfma_f32_16x16x32_bf16 v[84:87], a[164:167], a[116:119], v[84:87]
  v_mfma_f32_16x16x32_bf16 v[80:83], a[164:167], a[112:115], v[80:83]
  ds_read_b64_tr_b16 a[164:165], v8 offset:0
  s_mov_b32 s61, 86016
  v_mfma_f32_16x16x32_bf16 v[80:83], a[160:163], a[96:99], v[80:83]
  s_waitcnt lgkmcnt(5)
  buffer_load_dwordx4 a[236:239], v13, s[12:15], s61 offen
  v_mfma_f32_16x16x32_bf16 v[96:99], a[168:171], a[96:99], v[96:99]
  ds_read_b64_tr_b16 a[166:167], v8 offset:2048
  s_mov_b32 s61, 93184
  v_mfma_f32_16x16x32_bf16 v[96:99], a[172:175], a[112:115], v[96:99]
  buffer_load_dwordx4 a[240:243], v13, s[12:15], s61 offen
  s_mov_b32 s61, 100352
  v_mfma_f32_16x16x32_bf16 v[100:103], a[172:175], a[116:119], v[100:103]
  ds_read_b64_tr_b16 a[160:161], v8 offset:4096
  v_mfma_f32_16x16x32_bf16 v[100:103], a[168:171], a[100:103], v[100:103]
  buffer_load_dwordx4 a[244:247], v13, s[12:15], s61 offen
  s_mov_b32 s61, 107520
  v_mfma_f32_16x16x32_bf16 v[104:107], a[168:171], a[104:107], v[104:107]
  ds_read_b64_tr_b16 a[162:163], v8 offset:6144
  v_mfma_f32_16x16x32_bf16 v[104:107], a[172:175], a[120:123], v[104:107]
  buffer_load_dwordx4 a[248:251], v13, s[12:15], s61 offen
  ds_read_b128 v[24:27], v14 offset:32
  v_mfma_f32_16x16x32_bf16 v[108:111], a[172:175], a[124:127], v[108:111]
  ds_read_b64_tr_b16 a[172:173], v8 offset:8192
  v_mfma_f32_16x16x32_bf16 v[108:111], a[168:171], a[108:111], v[108:111]
  s_waitcnt lgkmcnt(6)
  v_mfma_f32_16x16x32_bf16 v[124:127], a[176:179], a[108:111], v[124:127]
  ds_read_b64_tr_b16 a[174:175], v8 offset:10240
  v_mfma_f32_16x16x32_bf16 v[124:127], a[180:183], a[124:127], v[124:127]
  v_mfma_f32_16x16x32_bf16 v[120:123], a[180:183], a[120:123], v[120:123]
  ds_read_b64_tr_b16 a[168:169], v8 offset:12288
  v_mfma_f32_16x16x32_bf16 v[120:123], a[176:179], a[104:107], v[120:123]
  s_waitcnt vmcnt(14) lgkmcnt(3)
  v_cndmask_b32 v28, 0, v24, s[16:17]
  v_cndmask_b32 v29, 0, v24, s[18:19]
  v_mfma_f32_16x16x32_bf16 v[116:119], a[176:179], a[100:103], v[116:119]
  ds_read_b64_tr_b16 a[170:171], v8 offset:14336
  v_cndmask_b32 v30, 0, v24, s[20:21]
  v_mfma_f32_16x16x32_bf16 v[116:119], a[180:183], a[116:119], v[116:119]
  v_cndmask_b32 v31, 0, v24, s[22:23]
  v_mfma_f32_16x16x32_bf16 v[112:115], a[180:183], a[112:115], v[112:115]
  ds_read_b64_tr_b16 a[180:181], v2 offset:0
  v_mfma_f32_16x16x32_bf16 a[184:187], v[28:31], a[220:223], a[184:187]
  v_cndmask_b32 v28, 0, v25, s[16:17]
  v_cndmask_b32 v29, 0, v25, s[18:19]
  v_mfma_f32_16x16x32_bf16 v[112:115], a[176:179], a[96:99], v[112:115]
  s_waitcnt lgkmcnt(6)
  v_cndmask_b32 v30, 0, v25, s[20:21]
  v_cndmask_b32 v31, 0, v25, s[22:23]
  v_mfma_f32_16x16x32_bf16 v[32:35], a[164:167], a[96:99], v[32:35]
  ds_read_b64_tr_b16 a[182:183], v2 offset:2048
  v_mfma_f32_16x16x32_bf16 a[184:187], v[28:31], a[224:227], a[184:187]
  v_cndmask_b32 v28, 0, v26, s[16:17]
  v_cndmask_b32 v29, 0, v26, s[18:19]
  v_mfma_f32_16x16x32_bf16 v[32:35], a[160:163], a[112:115], v[32:35]
  v_cndmask_b32 v30, 0, v26, s[20:21]
  v_cndmask_b32 v31, 0, v26, s[22:23]
  v_mfma_f32_16x16x32_bf16 v[36:39], a[160:163], a[116:119], v[36:39]
  ds_read_b64_tr_b16 a[176:177], v2 offset:4096
  v_mfma_f32_16x16x32_bf16 a[184:187], v[28:31], a[228:231], a[184:187]
  v_cndmask_b32 v28, 0, v27, s[16:17]
  v_cndmask_b32 v29, 0, v27, s[18:19]
  v_mfma_f32_16x16x32_bf16 v[36:39], a[164:167], a[100:103], v[36:39]
  v_cndmask_b32 v30, 0, v27, s[20:21]
  v_cndmask_b32 v31, 0, v27, s[22:23]
  v_mfma_f32_16x16x32_bf16 v[40:43], a[164:167], a[104:107], v[40:43]
  ds_read_b64_tr_b16 a[178:179], v2 offset:6144
  v_mfma_f32_16x16x32_bf16 a[184:187], v[28:31], a[232:235], a[184:187]
  v_mfma_f32_16x16x32_bf16 v[40:43], a[160:163], a[120:123], v[40:43]
  v_mfma_f32_16x16x32_bf16 v[44:47], a[160:163], a[124:127], v[44:47]
  ds_read_b64_tr_b16 a[160:161], v2 offset:8192
  v_mfma_f32_16x16x32_bf16 v[44:47], a[164:167], a[108:111], v[44:47]
  s_waitcnt lgkmcnt(5)
  v_mfma_f32_16x16x32_bf16 v[60:63], a[172:175], a[108:111], v[60:63]
  ds_read_b64_tr_b16 a[162:163], v2 offset:10240
  v_mfma_f32_16x16x32_bf16 v[60:63], a[168:171], a[124:127], v[60:63]
  v_mfma_f32_16x16x32_bf16 v[56:59], a[168:171], a[120:123], v[56:59]
  ds_read_b64_tr_b16 a[164:165], v2 offset:12288
  v_mfma_f32_16x16x32_bf16 v[56:59], a[172:175], a[104:107], v[56:59]
  v_mfma_f32_16x16x32_bf16 v[52:55], a[172:175], a[100:103], v[52:55]
  ds_read_b64_tr_b16 a[166:167], v2 offset:14336
  v_mfma_f32_16x16x32_bf16 v[52:55], a[168:171], a[116:119], v[52:55]
  v_mfma_f32_16x16x32_bf16 v[48:51], a[168:171], a[112:115], v[48:51]
  ds_read_b64_tr_b16 a[168:169], v3 offset:0
  v_mfma_f32_16x16x32_bf16 v[48:51], a[172:175], a[96:99], v[48:51]
  s_waitcnt lgkmcnt(5)
  v_mfma_f32_16x16x32_bf16 v[128:131], a[180:183], a[96:99], v[128:131]
  ds_read_b64_tr_b16 a[170:171], v3 offset:2048
  v_mfma_f32_16x16x32_bf16 v[128:131], a[176:179], a[112:115], v[128:131]
  s_add_u32 s75, s75, 65536
  v_mfma_f32_16x16x32_bf16 v[132:135], a[176:179], a[116:119], v[132:135]
  ds_read_b64_tr_b16 a[172:173], v3 offset:4096
  v_mfma_f32_16x16x32_bf16 v[132:135], a[180:183], a[100:103], v[132:135]
  buffer_load_dwordx4 a[132:135], v1, s[8:11], s75 offen offset:0 sc1
  v_mfma_f32_16x16x32_bf16 v[136:139], a[180:183], a[104:107], v[136:139]
  ds_read_b64_tr_b16 a[174:175], v3 offset:6144
  v_mfma_f32_16x16x32_bf16 v[136:139], a[176:179], a[120:123], v[136:139]
  v_mfma_f32_16x16x32_bf16 v[140:143], a[176:179], a[124:127], v[140:143]
  ds_read_b64_tr_b16 a[176:177], v3 offset:8192
  v_mfma_f32_16x16x32_bf16 v[140:143], a[180:183], a[108:111], v[140:143]
  s_waitcnt lgkmcnt(5)
  v_mfma_f32_16x16x32_bf16 v[156:159], a[160:163], a[108:111], v[156:159]
  ds_read_b64_tr_b16 a[178:179], v3 offset:10240
  v_mfma_f32_16x16x32_bf16 v[156:159], a[164:167], a[124:127], v[156:159]
  buffer_load_dwordx4 a[148:151], v1, s[8:11], s75 offen offset:1024 sc1
  v_mfma_f32_16x16x32_bf16 v[152:155], a[164:167], a[120:123], v[152:155]
  ds_read_b64_tr_b16 a[180:181], v3 offset:12288
  v_mfma_f32_16x16x32_bf16 v[152:155], a[160:163], a[104:107], v[152:155]
  s_add_u32 s75, s75, 65536
  v_mfma_f32_16x16x32_bf16 v[148:151], a[160:163], a[100:103], v[148:151]
  ds_read_b64_tr_b16 a[182:183], v3 offset:14336
  v_mfma_f32_16x16x32_bf16 v[148:151], a[164:167], a[116:119], v[148:151]
  buffer_load_dwordx4 a[136:139], v1, s[8:11], s75 offen offset:0 sc1
  v_mfma_f32_16x16x32_bf16 v[144:147], a[164:167], a[112:115], v[144:147]
  ds_read_b64_tr_b16 a[164:165], v4 offset:0
  v_mfma_f32_16x16x32_bf16 v[144:147], a[160:163], a[96:99], v[144:147]
  s_waitcnt lgkmcnt(5)
  v_mfma_f32_16x16x32_bf16 v[160:163], a[168:171], a[96:99], v[160:163]
  ds_read_b64_tr_b16 a[166:167], v4 offset:2048
  s_waitcnt vmcnt(9)
  v_mfma_f32_16x16x32_bf16 v[160:163], a[172:175], a[112:115], v[160:163]
  v_accvgpr_read_b32 v16, a188
  v_accvgpr_read_b32 v17, a189
  v_mfma_f32_16x16x32_bf16 v[164:167], a[172:175], a[116:119], v[164:167]
  ds_read_b64_tr_b16 a[160:161], v4 offset:4096
  v_accvgpr_read_b32 v18, a190
  v_mfma_f32_16x16x32_bf16 v[164:167], a[168:171], a[100:103], v[164:167]
  buffer_load_dwordx4 a[152:155], v1, s[8:11], s75 offen offset:1024 sc1
  v_accvgpr_read_b32 v19, a191
  v_accvgpr_read_b32 v20, a192
  v_mfma_f32_16x16x32_bf16 v[168:171], a[168:171], a[104:107], v[168:171]
  ds_read_b64_tr_b16 a[162:163], v4 offset:6144
  v_accvgpr_read_b32 v21, a193
  v_mfma_f32_16x16x32_bf16 v[168:171], a[172:175], a[120:123], v[168:171]
  s_add_u32 s75, s75, 65536
  v_accvgpr_read_b32 v22, a194
  v_accvgpr_read_b32 v23, a195
  v_mfma_f32_16x16x32_bf16 v[172:175], a[172:175], a[124:127], v[172:175]
  ds_read_b64_tr_b16 a[172:173], v4 offset:8192
  v_accvgpr_read_b32 v24, a196
  v_mfma_f32_16x16x32_bf16 v[172:175], a[168:171], a[108:111], v[172:175]
  s_waitcnt lgkmcnt(5)
  buffer_load_dwordx4 a[140:143], v1, s[8:11], s75 offen offset:0 sc1
  v_accvgpr_read_b32 v25, a197
  v_mfma_f32_16x16x32_bf16 v[188:191], a[176:179], a[108:111], v[188:191]
  ds_read_b64_tr_b16 a[174:175], v4 offset:10240
  v_accvgpr_read_b32 v26, a198
  v_mfma_f32_16x16x32_bf16 v[188:191], a[180:183], a[124:127], v[188:191]
  v_accvgpr_read_b32 v27, a199
  v_accvgpr_read_b32 v28, a200
  v_mfma_f32_16x16x32_bf16 v[184:187], a[180:183], a[120:123], v[184:187]
  ds_read_b64_tr_b16 a[168:169], v4 offset:12288
  v_accvgpr_read_b32 v29, a201
  v_mfma_f32_16x16x32_bf16 v[184:187], a[176:179], a[104:107], v[184:187]
  v_accvgpr_read_b32 v30, a202
  v_accvgpr_read_b32 v31, a203
  v_mfma_f32_16x16x32_bf16 v[180:183], a[176:179], a[100:103], v[180:183]
  ds_read_b64_tr_b16 a[170:171], v4 offset:14336
  v_add_f32 v16, v16, v24
  v_mfma_f32_16x16x32_bf16 v[180:183], a[180:183], a[116:119], v[180:183]
  buffer_load_dwordx4 a[156:159], v1, s[8:11], s75 offen offset:1024 sc1
  v_add_f32 v17, v17, v25
  v_add_f32 v18, v18, v26
  v_mfma_f32_16x16x32_bf16 v[176:179], a[180:183], a[112:115], v[176:179]
  ds_read_b64_tr_b16 a[180:181], v5 offset:0
  v_add_f32 v19, v19, v27
  v_mfma_f32_16x16x32_bf16 v[176:179], a[176:179], a[96:99], v[176:179]
  s_waitcnt lgkmcnt(5)
  s_mov_b32 s68, 2293760
  s_add_u32 s76, s24, 10240
  s_add_u32 m0, s45, 114688
  v_add_f32 v20, v20, v28
  v_mfma_f32_16x16x32_bf16 v[192:195], a[164:167], a[96:99], v[192:195]
  ds_read_b64_tr_b16 a[182:183], v5 offset:2048
  v_add_f32 v21, v21, v29
  v_mfma_f32_16x16x32_bf16 v[192:195], a[160:163], a[112:115], v[192:195]
  buffer_load_dwordx4 v11, s[28:31], s68 offen lds
  v_add_f32 v22, v22, v30
  v_add_f32 v23, v23, v31
  v_mfma_f32_16x16x32_bf16 v[196:199], a[160:163], a[116:119], v[196:199]
  ds_read_b64_tr_b16 a[176:177], v5 offset:4096
  v_accvgpr_read_b32 v24, a204
  v_mfma_f32_16x16x32_bf16 v[196:199], a[164:167], a[100:103], v[196:199]
  v_accvgpr_read_b32 v25, a205
  v_accvgpr_read_b32 v26, a206
  v_mfma_f32_16x16x32_bf16 v[200:203], a[164:167], a[104:107], v[200:203]
  ds_read_b64_tr_b16 a[178:179], v5 offset:6144
  v_accvgpr_read_b32 v27, a207
  v_mfma_f32_16x16x32_bf16 v[200:203], a[160:163], a[120:123], v[200:203]
  s_add_u32 m0, s45, 122880
  v_accvgpr_read_b32 v28, a208
  v_accvgpr_read_b32 v29, a209
  v_mfma_f32_16x16x32_bf16 v[204:207], a[160:163], a[124:127], v[204:207]
  ds_read_b64_tr_b16 a[160:161], v5 offset:8192
  v_accvgpr_read_b32 v30, a210
  v_mfma_f32_16x16x32_bf16 v[204:207], a[164:167], a[108:111], v[204:207]
  s_waitcnt lgkmcnt(5)
  buffer_load_dwordx4 v11, s[32:35], s68 offen lds
  v_accvgpr_read_b32 v31, a211
  v_mfma_f32_16x16x32_bf16 v[220:223], a[172:175], a[108:111], v[220:223]
  ds_read_b64_tr_b16 a[162:163], v5 offset:10240
  v_add_f32 v16, v16, v24
  v_mfma_f32_16x16x32_bf16 v[220:223], a[168:171], a[124:127], v[220:223]
  s_add_u32 m0, s45, 118784
  s_add_u32 s60, s68, 229376
  v_add_f32 v17, v17, v25
  v_mfma_f32_16x16x32_bf16 v[216:219], a[168:171], a[120:123], v[216:219]
  ds_read_b64_tr_b16 a[164:165], v5 offset:12288
  v_add_f32 v18, v18, v26
  v_mfma_f32_16x16x32_bf16 v[216:219], a[172:175], a[104:107], v[216:219]
  buffer_load_dwordx4 v11, s[28:31], s60 offen lds
  v_add_f32 v19, v19, v27
  v_add_f32 v20, v20, v28
  v_mfma_f32_16x16x32_bf16 v[212:215], a[172:175], a[100:103], v[212:215]
  ds_read_b64_tr_b16 a[166:167], v5 offset:14336
  v_add_f32 v21, v21, v29
  v_mfma_f32_16x16x32_bf16 v[212:215], a[168:171], a[116:119], v[212:215]
  s_waitcnt vmcnt(27)
  s_barrier
  v_mfma_f32_16x16x32_bf16 v[208:211], a[168:171], a[112:115], v[208:211]
  ds_read_b64_tr_b16 a[168:169], v6 offset:32768
  v_add_f32 v22, v22, v30
  v_mfma_f32_16x16x32_bf16 v[208:211], a[172:175], a[96:99], v[208:211]
  s_waitcnt lgkmcnt(5)
  s_add_u32 m0, s45, 126976
  s_add_u32 s60, s68, 229376
  v_mfma_f32_16x16x32_bf16 v[224:227], a[180:183], a[96:99], v[224:227]
  ds_read_b64_tr_b16 a[170:171], v6 offset:34816
  v_add_f32 v23, v23, v31
  v_mfma_f32_16x16x32_bf16 v[224:227], a[176:179], a[112:115], v[224:227]
  buffer_load_dwordx4 v11, s[32:35], s60 offen lds
  v_accvgpr_read_b32 v24, a212
  v_accvgpr_read_b32 v25, a213
  v_mfma_f32_16x16x32_bf16 v[228:231], a[176:179], a[116:119], v[228:231]
  ds_read_b64_tr_b16 a[172:173], v6 offset:36864
  v_accvgpr_read_b32 v26, a214
  v_mfma_f32_16x16x32_bf16 v[228:231], a[180:183], a[100:103], v[228:231]
  s_add_u32 m0, s45, 49152
  v_accvgpr_read_b32 v27, a215
  v_accvgpr_read_b32 v28, a216
  v_mfma_f32_16x16x32_bf16 v[232:235], a[180:183], a[104:107], v[232:235]
  ds_read_b64_tr_b16 a[174:175], v6 offset:38912
  v_accvgpr_read_b32 v29, a217
  v_mfma_f32_16x16x32_bf16 v[232:235], a[176:179], a[120:123], v[232:235]
  buffer_load_dwordx4 v10, s[28:31], s68 offen lds
  v_accvgpr_read_b32 v30, a218
  v_accvgpr_read_b32 v31, a219
  v_mfma_f32_16x16x32_bf16 v[236:239], a[176:179], a[124:127], v[236:239]
  ds_read_b64_tr_b16 a[176:177], v6 offset:40960
  v_add_f32 v16, v16, v24
  v_mfma_f32_16x16x32_bf16 v[236:239], a[180:183], a[108:111], v[236:239]
  s_waitcnt lgkmcnt(5)
  v_add_f32 v17, v17, v25
  v_add_f32 v18, v18, v26
  v_mfma_f32_16x16x32_bf16 v[252:255], a[160:163], a[108:111], v[252:255]
  ds_read_b64_tr_b16 a[178:179], v6 offset:43008
  v_add_f32 v19, v19, v27
  v_mfma_f32_16x16x32_bf16 v[252:255], a[164:167], a[124:127], v[252:255]
  s_add_u32 m0, s45, 57344
  v_add_f32 v20, v20, v28
  v_add_f32 v21, v21, v29
  v_mfma_f32_16x16x32_bf16 v[248:251], a[164:167], a[120:123], v[248:251]
  ds_read_b64_tr_b16 a[180:181], v6 offset:45056
  v_add_f32 v22, v22, v30
  v_mfma_f32_16x16x32_bf16 v[248:251], a[160:163], a[104:107], v[248:251]
  buffer_load_dwordx4 v10, s[32:35], s68 offen lds
  v_add_f32 v23, v23, v31
  v_mfma_f32_16x16x32_bf16 v[244:247], a[160:163], a[100:103], v[244:247]
  ds_read_b64_tr_b16 a[182:183], v6 offset:47104
  v_mfma_f32_16x16x32_bf16 v[244:247], a[164:167], a[116:119], v[244:247]
  s_add_u32 m0, s45, 53248
  s_add_u32 s60, s68, 229376
  v_mfma_f32_16x16x32_bf16 v[240:243], a[164:167], a[112:115], v[240:243]
  ds_read_b64_tr_b16 a[164:165], v7 offset:32768
  v_mfma_f32_16x16x32_bf16 v[240:243], a[160:163], a[96:99], v[240:243]
  s_waitcnt vmcnt(6) lgkmcnt(5)
  buffer_load_dwordx4 v10, s[28:31], s60 offen lds
  v_mfma_f32_16x16x32_bf16 v[64:67], a[168:171], a[128:131], v[64:67]
  ds_read_b64_tr_b16 a[166:167], v7 offset:34816
  v_mfma_f32_16x16x32_bf16 v[64:67], a[172:175], a[144:147], v[64:67]
  ds_read_b128 v[24:27], v14 offset:48
  v_mfma_f32_16x16x32_bf16 v[68:71], a[172:175], a[148:151], v[68:71]
  ds_read_b64_tr_b16 a[160:161], v7 offset:36864
  v_mfma_f32_16x16x32_bf16 v[68:71], a[168:171], a[132:135], v[68:71]
  s_add_u32 m0, s45, 61440
  s_add_u32 s60, s68, 229376
  v_mfma_f32_16x16x32_bf16 v[72:75], a[168:171], a[136:139], v[72:75]
  ds_read_b64_tr_b16 a[162:163], v7 offset:38912
  v_mfma_f32_16x16x32_bf16 v[72:75], a[172:175], a[152:155], v[72:75]
  buffer_load_dwordx4 v10, s[32:35], s60 offen lds
  v_mfma_f32_16x16x32_bf16 v[76:79], a[172:175], a[156:159], v[76:79]
  ds_read_b64_tr_b16 a[172:173], v7 offset:40960
  v_mfma_f32_16x16x32_bf16 v[76:79], a[168:171], a[140:143], v[76:79]
  s_waitcnt lgkmcnt(6)
  s_waitcnt vmcnt(14) lgkmcnt(3)
  v_mfma_f32_16x16x32_bf16 v[92:95], a[176:179], a[140:143], v[92:95]
  ds_read_b64_tr_b16 a[174:175], v7 offset:43008
  v_cndmask_b32 v28, 0, v24, s[16:17]
  v_mfma_f32_16x16x32_bf16 v[92:95], a[180:183], a[156:159], v[92:95]
  buffer_load_dwordx4 a[0:3], v1, s[8:11], s76 offen offset:0 sc1
  v_cndmask_b32 v29, 0, v24, s[18:19]
  v_cndmask_b32 v30, 0, v24, s[20:21]
  v_mfma_f32_16x16x32_bf16 v[88:91], a[180:183], a[152:155], v[88:91]
  ds_read_b64_tr_b16 a[168:169], v7 offset:45056
  v_cndmask_b32 v31, 0, v24, s[22:23]
  v_mfma_f32_16x16x32_bf16 v[88:91], a[176:179], a[136:139], v[88:91]
  s_nop 0
  v_mfma_f32_16x16x32_bf16 a[184:187], v[28:31], a[236:239], a[184:187]
  v_cndmask_b32 v28, 0, v25, s[16:17]
  v_cndmask_b32 v29, 0, v25, s[18:19]
  v_mfma_f32_16x16x32_bf16 v[84:87], a[176:179], a[132:135], v[84:87]
  ds_read_b64_tr_b16 a[170:171], v7 offset:47104
  v_cndmask_b32 v30, 0, v25, s[20:21]
  v_mfma_f32_16x16x32_bf16 v[84:87], a[180:183], a[148:151], v[84:87]
  v_cndmask_b32 v31, 0, v25, s[22:23]
  v_mfma_f32_16x16x32_bf16 v[80:83], a[180:183], a[144:147], v[80:83]
  ds_read_b64_tr_b16 a[180:181], v8 offset:32768
  v_mfma_f32_16x16x32_bf16 a[184:187], v[28:31], a[240:243], a[184:187]
  v_cndmask_b32 v28, 0, v26, s[16:17]
  v_cndmask_b32 v29, 0, v26, s[18:19]
  v_mfma_f32_16x16x32_bf16 v[80:83], a[176:179], a[128:131], v[80:83]
  s_waitcnt lgkmcnt(5)
  buffer_load_dwordx4 a[16:19], v1, s[8:11], s76 offen offset:1024 sc1
  v_cndmask_b32 v30, 0, v26, s[20:21]
  v_mfma_f32_16x16x32_bf16 v[96:99], a[164:167], a[128:131], v[96:99]
  ds_read_b64_tr_b16 a[182:183], v8 offset:34816
  v_cndmask_b32 v31, 0, v26, s[22:23]
  v_mfma_f32_16x16x32_bf16 v[96:99], a[160:163], a[144:147], v[96:99]
  s_add_u32 s76, s76, 65536
  v_mfma_f32_16x16x32_bf16 a[184:187], v[28:31], a[244:247], a[184:187]
  v_cndmask_b32 v28, 0, v27, s[16:17]
  v_cndmask_b32 v29, 0, v27, s[18:19]
  v_mfma_f32_16x16x32_bf16 v[100:103], a[160:163], a[148:151], v[100:103]
  ds_read_b64_tr_b16 a[176:177], v8 offset:36864
  v_cndmask_b32 v30, 0, v27, s[20:21]
  v_mfma_f32_16x16x32_bf16 v[100:103], a[164:167], a[132:135], v[100:103]
  buffer_load_dwordx4 a[4:7], v1, s[8:11], s76 offen offset:0 sc1
  v_cndmask_b32 v31, 0, v27, s[22:23]
  v_mfma_f32_16x16x32_bf16 v[104:107], a[164:167], a[136:139], v[104:107]
  ds_read_b64_tr_b16 a[178:179], v8 offset:38912
  v_mfma_f32_16x16x32_bf16 a[184:187], v[28:31], a[248:251], a[184:187]
  v_mfma_f32_16x16x32_bf16 v[104:107], a[160:163], a[152:155], v[104:107]
  v_mfma_f32_16x16x32_bf16 v[108:111], a[160:163], a[156:159], v[108:111]
  ds_read_b64_tr_b16 a[160:161], v8 offset:40960
  v_mfma_f32_16x16x32_bf16 v[108:111], a[164:167], a[140:143], v[108:111]
  s_waitcnt lgkmcnt(5)
  s_add_u32 s61, s62, 8192
  v_mfma_f32_16x16x32_bf16 v[124:127], a[172:175], a[140:143], v[124:127]
  ds_read_b64_tr_b16 a[162:163], v8 offset:43008
  s_bfe_u32 s53, s2, 0x20004
  v_mfma_f32_16x16x32_bf16 v[124:127], a[168:171], a[156:159], v[124:127]
  buffer_load_dwordx4 a[188:191], v12, s[8:11], s61 offen offset:0 sc1
  s_lshl_b32 s53, s53, 9
  v_and_b32 v14, 15, v0
  v_mfma_f32_16x16x32_bf16 v[120:123], a[168:171], a[152:155], v[120:123]
  ds_read_b64_tr_b16 a[164:165], v8 offset:45056
  v_lshl_add_u32 v14, v14, 5, s53
  v_mfma_f32_16x16x32_bf16 v[120:123], a[172:175], a[136:139], v[120:123]
  s_add_u32 s61, s62, 8192
  v_cmp_gt_u32 vcc, 1792, v14
  v_mov_b32 v15, 134217728
  v_bfe_u32 v13, v0, 4, 1
  v_cndmask_b32 v14, v15, v14, vcc
  v_mfma_f32_16x16x32_bf16 v[116:119], a[172:175], a[132:135], v[116:119]
  ds_read_b64_tr_b16 a[166:167], v8 offset:47104
  v_lshl_add_u32 v14, v13, 4, v14
  v_mfma_f32_16x16x32_bf16 v[116:119], a[168:171], a[148:151], v[116:119]
  buffer_load_dwordx4 a[192:195], v12, s[8:11], s61 offen offset:256 sc1
  v_lshrrev_b32 v13, 5, v0
  v_mul_u32_u24 v13, 14336, v13
  v_mfma_f32_16x16x32_bf16 v[112:115], a[168:171], a[144:147], v[112:115]
  ds_read_b64_tr_b16 a[168:169], v2 offset:32768
  v_add_u32 v14, v14, v13
  v_mfma_f32_16x16x32_bf16 v[112:115], a[172:175], a[128:131], v[112:115]
  s_waitcnt lgkmcnt(5)
  s_lshr_b32 s53, s2, 6
  s_lshl_b32 s53, s53, 2
  v_mfma_f32_16x16x32_bf16 v[32:35], a[180:183], a[128:131], v[32:35]
HOP9:
  s_cbranch_execz WRET0
  ds_read_b64_tr_b16 a[170:171], v2 offset:34816
  s_add_u32 s53, s53, s44
  v_mfma_f32_16x16x32_bf16 v[32:35], a[176:179], a[144:147], v[32:35]
  s_add_u32 s61, s62, 10240
  s_lshl_b32 s53, s53, 1
  s_bfe_u32 s54, s2, 0x10003
  v_mfma_f32_16x16x32_bf16 v[36:39], a[176:179], a[148:151], v[36:39]
  ds_read_b64_tr_b16 a[172:173], v2 offset:36864
  s_add_u32 s53, s53, s54
  v_mfma_f32_16x16x32_bf16 v[36:39], a[180:183], a[132:135], v[36:39]
  buffer_load_dwordx4 a[196:199], v12, s[8:11], s61 offen offset:0 sc1
  s_mul_i32 s53, s53, 28672
  s_mul_i32 s54, s52, 1792
  v_mfma_f32_16x16x32_bf16 v[40:43], a[180:183], a[136:139], v[40:43]
  ds_read_b64_tr_b16 a[174:175], v2 offset:38912
  s_add_u32 s53, s53, s54
  v_mfma_f32_16x16x32_bf16 v[40:43], a[176:179], a[152:155], v[40:43]
  s_add_u32 s61, s62, 10240
  s_add_u32 s53, s53, 46137344
  v_mfma_f32_16x16x32_bf16 v[44:47], a[176:179], a[156:159], v[44:47]
  ds_read_b64_tr_b16 a[176:177], v2 offset:40960
  v_mfma_f32_16x16x32_bf16 v[44:47], a[180:183], a[140:143], v[44:47]
  s_waitcnt lgkmcnt(5)
  buffer_load_dwordx4 a[200:203], v12, s[8:11], s61 offen offset:256 sc1
  v_mfma_f32_16x16x32_bf16 v[60:63], a[160:163], a[140:143], v[60:63]
  ds_read_b64_tr_b16 a[178:179], v2 offset:43008
  buffer_store_dwordx4 a[184:187], v14, s[8:11], s53 offen sc1
  v_mfma_f32_16x16x32_bf16 v[60:63], a[164:167], a[156:159], v[60:63]
  s_lshl_b32 s53, s52, 7
  s_add_u32 s53, s53, 884736
  v_and_b32 v13, 31, v0
  v_mfma_f32_16x16x32_bf16 v[56:59], a[164:167], a[152:155], v[56:59]
  ds_read_b64_tr_b16 a[180:181], v2 offset:45056
  v_min_u32 v15, 27, v13
  v_mfma_f32_16x16x32_bf16 v[56:59], a[160:163], a[136:139], v[56:59]
  s_add_u32 s61, s62, 12288
  v_lshl_add_u32 v13, v13, 10, s53
  v_lshlrev_b32 v15, 4, v15
  v_mfma_f32_16x16x32_bf16 v[52:55], a[160:163], a[132:135], v[52:55]
  ds_read_b64_tr_b16 a[182:183], v2 offset:47104
  s_lshl_b32 s53, s51, 9
  v_mfma_f32_16x16x32_bf16 v[52:55], a[164:167], a[148:151], v[52:55]
  buffer_load_dwordx4 a[204:207], v12, s[8:11], s61 offen offset:0 sc1
  v_mov_b32 v14, s53
  s_lshl_b32 s55, s51, 3
  v_mfma_f32_16x16x32_bf16 v[48:51], a[164:167], a[144:147], v[48:51]
  ds_read_b64_tr_b16 a[164:165], v3 offset:32768
  s_lshr_b32 s53, 0x0b070602, s55
  v_mfma_f32_16x16x32_bf16 v[48:51], a[160:163], a[128:131], v[48:51]
  s_waitcnt lgkmcnt(5)
  s_add_u32 s61, s62, 12288
  s_and_b32 s53, s53, 15
  v_mfma_f32_16x16x32_bf16 v[128:131], a[168:171], a[128:131], v[128:131]
  ds_read_b64_tr_b16 a[166:167], v3 offset:34816
  s_lshl_b32 s53, s53, 7
  v_mfma_f32_16x16x32_bf16 v[128:131], a[172:175], a[144:147], v[128:131]
  buffer_load_dwordx4 a[208:211], v12, s[8:11], s61 offen offset:256 sc1
  s_sub_u32 s53, s53, 256
  v_mov_b32 v24, s53
  v_mfma_f32_16x16x32_bf16 v[132:135], a[172:175], a[148:151], v[132:135]
  ds_read_b64_tr_b16 a[160:161], v3 offset:36864
  v_mfma_f32_16x16x32_bf16 v[132:135], a[168:171], a[132:135], v[132:135]
  v_cmp_gt_u32 vcc, 256, v15
  s_nop 1
  v_cndmask_b32 v14, v24, v14, vcc
  v_mfma_f32_16x16x32_bf16 v[136:139], a[168:171], a[136:139], v[136:139]
  ds_read_b64_tr_b16 a[162:163], v3 offset:38912
  s_lshr_b32 s53, 0x15140706, s55
  v_mfma_f32_16x16x32_bf16 v[136:139], a[172:175], a[152:155], v[136:139]
  s_add_u32 s61, s62, 14336
  s_and_b32 s53, s53, 31
  s_lshl_b32 s53, s53, 6
  v_mfma_f32_16x16x32_bf16 v[140:143], a[172:175], a[156:159], v[140:143]
  ds_read_b64_tr_b16 a[172:173], v3 offset:40960
  s_sub_u32 s53, s53, 384
  v_mfma_f32_16x16x32_bf16 v[140:143], a[168:171], a[140:143], v[140:143]
  s_waitcnt lgkmcnt(5)
  buffer_load_dwordx4 a[212:215], v12, s[8:11], s61 offen offset:0 sc1
  v_mov_b32 v24, s53
  v_mfma_f32_16x16x32_bf16 v[156:159], a[176:179], a[140:143], v[156:159]
  ds_read_b64_tr_b16 a[174:175], v3 offset:43008
  v_mfma_f32_16x16x32_bf16 v[156:159], a[180:183], a[156:159], v[156:159]
  s_add_u32 s61, s62, 14336
  v_cmp_gt_u32 vcc, 384, v15
  s_nop 1
  v_cndmask_b32 v14, v24, v14, vcc
  v_mfma_f32_16x16x32_bf16 v[152:155], a[180:183], a[152:155], v[152:155]
  ds_read_b64_tr_b16 a[168:169], v3 offset:45056
  v_lshrrev_b32 v24, 5, v0
  v_mfma_f32_16x16x32_bf16 v[152:155], a[176:179], a[136:139], v[152:155]
  buffer_load_dwordx4 a[216:219], v12, s[8:11], s61 offen offset:256 sc1
  v_mul_u32_u24 v24, 57344, v24
  v_add3_u32 v14, v14, v15, v24
  v_mfma_f32_16x16x32_bf16 v[148:151], a[176:179], a[132:135], v[148:151]
  ds_read_b64_tr_b16 a[170:171], v3 offset:47104
  s_mul_i32 s53, s44, 14336
  v_mfma_f32_16x16x32_bf16 v[148:151], a[180:183], a[148:151], v[148:151]
  s_add_u32 s53, s53, s54
  s_add_u32 s53, s53, 46137344
  v_add_u32 v14, s53, v14
  v_mfma_f32_16x16x32_bf16 v[144:147], a[180:183], a[144:147], v[144:147]
  ds_read_b64_tr_b16 a[180:181], v4 offset:32768
  s_lshl_b32 s53, s44, 9
  v_mfma_f32_16x16x32_bf16 v[144:147], a[176:179], a[128:131], v[144:147]
  s_waitcnt lgkmcnt(5)
  s_add_u32 s53, s53, 131072
  v_add_u32 v15, s53, v15
  v_mfma_f32_16x16x32_bf16 v[160:163], a[164:167], a[128:131], v[160:163]
  ds_read_b64_tr_b16 a[182:183], v4 offset:34816
  s_and_b32 s50, s2, 4
  v_mfma_f32_16x16x32_bf16 v[160:163], a[160:163], a[144:147], v[160:163]
  buffer_load_dwordx4 a[20:23], v1, s[8:11], s76 offen offset:1024 sc1
  s_lshr_b32 s53, s2, 6
  s_add_u32 s50, s50, s53
  v_mfma_f32_16x16x32_bf16 v[164:167], a[160:163], a[148:151], v[164:167]
  ds_read_b64_tr_b16 a[176:177], v4 offset:36864
  s_bfe_u32 s51, s2, 0x30003
  v_mfma_f32_16x16x32_bf16 v[164:167], a[164:167], a[132:135], v[164:167]
  s_add_u32 s76, s76, 65536
  s_and_b32 s52, s2, 3
  s_add_u32 s90, s50, s51
  v_mfma_f32_16x16x32_bf16 v[168:171], a[164:167], a[136:139], v[168:171]
  ds_read_b64_tr_b16 a[178:179], v4 offset:38912
  s_and_b32 s90, s90, 3
  v_mfma_f32_16x16x32_bf16 v[168:171], a[160:163], a[152:155], v[168:171]
  buffer_load_dwordx4 a[8:11], v1, s[8:11], s76 offen offset:0 sc1
  s_lshl_b32 s53, s50, 4
  s_and_b32 s54, s52, 2
  v_mfma_f32_16x16x32_bf16 v[172:175], a[160:163], a[156:159], v[172:175]
  ds_read_b64_tr_b16 a[160:161], v4 offset:40960
  s_mul_i32 s88, s54, 4293918720
  v_mfma_f32_16x16x32_bf16 v[172:175], a[164:167], a[140:143], v[172:175]
  s_waitcnt lgkmcnt(5)
  s_add_u32 s88, s88, 917504
  s_lshl_b32 s54, s54, 2
  v_mfma_f32_16x16x32_bf16 v[188:191], a[172:175], a[140:143], v[188:191]
  ds_read_b64_tr_b16 a[162:163], v4 offset:43008
  s_add_u32 s53, s53, s54
  v_mfma_f32_16x16x32_bf16 v[188:191], a[168:171], a[156:159], v[188:191]
  s_lshl_b32 s54, s44, 1
  s_add_u32 s53, s53, s54
  s_mul_i32 s83, s53, 131072
  v_mfma_f32_16x16x32_bf16 v[184:187], a[168:171], a[152:155], v[184:187]
  ds_read_b64_tr_b16 a[164:165], v4 offset:45056
  s_mul_i32 s54, s52, 28672
  v_mfma_f32_16x16x32_bf16 v[184:187], a[172:175], a[136:139], v[184:187]
  buffer_load_dwordx4 a[24:27], v1, s[8:11], s76 offen offset:1024 sc1
  s_add_u32 s83, s83, s54
  s_add_u32 s83, s83, 19922944
  v_mfma_f32_16x16x32_bf16 v[180:183], a[172:175], a[132:135], v[180:183]
  ds_read_b64_tr_b16 a[166:167], v4 offset:47104
  s_lshl_b32 s84, s53, 15
  v_mfma_f32_16x16x32_bf16 v[180:183], a[168:171], a[148:151], v[180:183]
  s_add_u32 s76, s76, 65536
  s_lshl_b32 s51, s51, 1
  s_and_b32 s54, s52, 1
  v_mfma_f32_16x16x32_bf16 v[176:179], a[168:171], a[144:147], v[176:179]
  ds_read_b64_tr_b16 a[168:169], v5 offset:32768
  s_add_u32 s51, s51, s54
  v_mfma_f32_16x16x32_bf16 v[176:179], a[172:175], a[128:131], v[176:179]
  s_waitcnt lgkmcnt(5)
  buffer_load_dwordx4 a[12:15], v1, s[8:11], s76 offen offset:0 sc1
  s_lshl_b32 s53, s51, 7
  v_mfma_f32_16x16x32_bf16 v[192:195], a[180:183], a[128:131], v[192:195]
  ds_read_b64_tr_b16 a[170:171], v5 offset:34816
  s_add_u32 s84, s84, s53
  v_mfma_f32_16x16x32_bf16 v[192:195], a[176:179], a[144:147], v[192:195]
  s_lshl_b32 s87, s51, 8
  s_add_u32 s87, s87, 20480
  s_lshl_b32 s53, s50, 12
  v_mfma_f32_16x16x32_bf16 v[196:199], a[176:179], a[148:151], v[196:199]
  ds_read_b64_tr_b16 a[172:173], v5 offset:36864
  s_lshl_b32 s54, s52, 8
  v_mfma_f32_16x16x32_bf16 v[196:199], a[180:183], a[132:135], v[196:199]
  s_add_u32 s53, s53, s54
  s_add_u32 s81, s53, 688128
  s_lshl_b32 s89, s44, 12
  v_mfma_f32_16x16x32_bf16 v[200:203], a[180:183], a[136:139], v[200:203]
  ds_read_b64_tr_b16 a[174:175], v5 offset:38912
  s_add_u32 s89, s89, 135168
  v_mfma_f32_16x16x32_bf16 v[200:203], a[176:179], a[152:155], v[200:203]
  buffer_load_dwordx4 a[28:31], v1, s[8:11], s76 offen offset:1024 sc1
  s_lshl_b32 s85, s2, 16
  s_lshl_b32 s53, s44, 14
  v_mfma_f32_16x16x32_bf16 v[204:207], a[176:179], a[156:159], v[204:207]
  ds_read_b64_tr_b16 a[176:177], v5 offset:40960
  s_add_u32 s85, s85, s53
  v_mfma_f32_16x16x32_bf16 v[204:207], a[180:183], a[140:143], v[204:207]
  s_waitcnt lgkmcnt(5)
  s_mov_b32 s69, 2752512
  s_add_u32 s77, s24, 12288
  s_add_u32 m0, s45, 81920
  s_add_u32 s85, s85, 67108864
  v_mfma_f32_16x16x32_bf16 v[220:223], a[160:163], a[140:143], v[220:223]
  ds_read_b64_tr_b16 a[178:179], v5 offset:43008
  s_lshr_b32 s53, s2, 3
  v_mfma_f32_16x16x32_bf16 v[220:223], a[164:167], a[156:159], v[220:223]
  buffer_load_dwordx4 v11, s[28:31], s69 offen lds
  s_lshl_b32 s53, s53, 2
  s_add_u32 s53, s53, s44
  v_mfma_f32_16x16x32_bf16 v[216:219], a[164:167], a[152:155], v[216:219]
  ds_read_b64_tr_b16 a[180:181], v5 offset:45056
  s_mul_i32 s91, s53, 1024
  v_mfma_f32_16x16x32_bf16 v[216:219], a[160:163], a[136:139], v[216:219]
  s_mul_i32 s53, s52, 1835008
  s_add_u32 s91, s91, s53
  s_nop 0
  v_mfma_f32_16x16x32_bf16 v[212:215], a[160:163], a[132:135], v[212:215]
  ds_read_b64_tr_b16 a[182:183], v5 offset:47104
  v_mfma_f32_16x16x32_bf16 v[212:215], a[164:167], a[148:151], v[212:215]
  s_waitcnt vmcnt(18)
  s_barrier
  v_mfma_f32_16x16x32_bf16 v[208:211], a[164:167], a[144:147], v[208:211]
  ds_read_b64_tr_b16 a[164:165], v6 offset:49152
  s_add_u32 m0, s45, 90112
  v_mfma_f32_16x16x32_bf16 v[208:211], a[160:163], a[128:131], v[208:211]
  s_waitcnt lgkmcnt(5)
  buffer_load_dwordx4 v11, s[32:35], s69 offen lds
  v_mfma_f32_16x16x32_bf16 v[224:227], a[168:171], a[128:131], v[224:227]
  ds_read_b64_tr_b16 a[166:167], v6 offset:51200
  v_mfma_f32_16x16x32_bf16 v[224:227], a[172:175], a[144:147], v[224:227]
  s_add_u32 m0, s45, 86016
  s_add_u32 s60, s69, 229376
  v_mfma_f32_16x16x32_bf16 v[228:231], a[172:175], a[148:151], v[228:231]
  ds_read_b64_tr_b16 a[160:161], v6 offset:53248
  v_mfma_f32_16x16x32_bf16 v[228:231], a[168:171], a[132:135], v[228:231]
  buffer_load_dwordx4 v11, s[28:31], s60 offen lds
  v_mfma_f32_16x16x32_bf16 v[232:235], a[168:171], a[136:139], v[232:235]
  ds_read_b64_tr_b16 a[162:163], v6 offset:55296
  v_add_u32 v9, s46, v0
  s_waitcnt vmcnt(12)
  s_barrier
  s_mov_b64 exec, 1
  buffer_store_dword v9, v0, s[8:11], s79 offen offset:0 sc1
  s_mov_b64 exec, -1
  s_sub_u32 s79, s79, 196608
  v_mfma_f32_16x16x32_bf16 v[232:235], a[172:175], a[152:155], v[232:235]
  v_mfma_f32_16x16x32_bf16 v[236:239], a[172:175], a[156:159], v[236:239]
  ds_read_b64_tr_b16 a[172:173], v6 offset:57344
  v_mfma_f32_16x16x32_bf16 v[236:239], a[168:171], a[140:143], v[236:239]
  s_waitcnt lgkmcnt(5)
  s_add_u32 m0, s45, 94208
  s_add_u32 s60, s69, 229376
  v_mfma_f32_16x16x32_bf16 v[252:255], a[176:179], a[140:143], v[252:255]
  ds_read_b64_tr_b16 a[174:175], v6 offset:59392
  v_mfma_f32_16x16x32_bf16 v[252:255], a[180:183], a[156:159], v[252:255]
  buffer_load_dwordx4 v11, s[32:35], s60 offen lds
  v_mfma_f32_16x16x32_bf16 v[248:251], a[180:183], a[152:155], v[248:251]
  ds_read_b64_tr_b16 a[168:169], v6 offset:61440
  v_mfma_f32_16x16x32_bf16 v[248:251], a[176:179], a[136:139], v[248:251]
  s_add_u32 m0, s45, 16384
  v_mfma_f32_16x16x32_bf16 v[244:247], a[176:179], a[132:135], v[244:247]
  ds_read_b64_tr_b16 a[170:171], v6 offset:63488
  v_mfma_f32_16x16x32_bf16 v[244:247], a[180:183], a[148:151], v[244:247]
  buffer_load_dwordx4 v10, s[28:31], s69 offen lds
  v_mfma_f32_16x16x32_bf16 v[240:243], a[180:183], a[144:147], v[240:243]
  ds_read_b64_tr_b16 a[180:181], v7 offset:49152
  v_mfma_f32_16x16x32_bf16 v[240:243], a[176:179], a[128:131], v[240:243]
  s_waitcnt vmcnt(6) lgkmcnt(5)
  v_mfma_f32_16x16x32_bf16 v[64:67], a[164:167], a[0:3], v[64:67]
  ds_read_b64_tr_b16 a[182:183], v7 offset:51200
  v_mfma_f32_16x16x32_bf16 v[64:67], a[160:163], a[16:19], v[64:67]
  s_add_u32 m0, s45, 24576
  v_mfma_f32_16x16x32_bf16 v[68:71], a[160:163], a[20:23], v[68:71]
  ds_read_b64_tr_b16 a[176:177], v7 offset:53248
  v_mfma_f32_16x16x32_bf16 v[68:71], a[164:167], a[4:7], v[68:71]
  buffer_load_dwordx4 v10, s[32:35], s69 offen lds
  v_mfma_f32_16x16x32_bf16 v[72:75], a[164:167], a[8:11], v[72:75]
  ds_read_b64_tr_b16 a[178:179], v7 offset:55296
  v_mfma_f32_16x16x32_bf16 v[72:75], a[160:163], a[24:27], v[72:75]
  s_add_u32 m0, s45, 20480
  s_add_u32 s60, s69, 229376
  v_mfma_f32_16x16x32_bf16 v[76:79], a[160:163], a[28:31], v[76:79]
  ds_read_b64_tr_b16 a[160:161], v7 offset:57344
  v_mfma_f32_16x16x32_bf16 v[76:79], a[164:167], a[12:15], v[76:79]
  s_waitcnt lgkmcnt(5)
  buffer_load_dwordx4 v10, s[28:31], s60 offen lds
  v_mfma_f32_16x16x32_bf16 v[92:95], a[172:175], a[12:15], v[92:95]
  ds_read_b64_tr_b16 a[162:163], v7 offset:59392
  v_mfma_f32_16x16x32_bf16 v[92:95], a[168:171], a[28:31], v[92:95]
  v_mfma_f32_16x16x32_bf16 v[88:91], a[168:171], a[24:27], v[88:91]
  ds_read_b64_tr_b16 a[164:165], v7 offset:61440
  s_waitcnt vmcnt(13)
  v_mfma_f32_16x16x32_bf16 v[88:91], a[172:175], a[8:11], v[88:91]
  s_add_u32 m0, s45, 28672
  s_add_u32 s60, s69, 229376
  v_accvgpr_read_b32 v24, a188
  v_mfma_f32_16x16x32_bf16 v[84:87], a[172:175], a[4:7], v[84:87]
  ds_read_b64_tr_b16 a[166:167], v7 offset:63488
  v_accvgpr_read_b32 v25, a189
  v_mfma_f32_16x16x32_bf16 v[84:87], a[168:171], a[20:23], v[84:87]
  buffer_load_dwordx4 v10, s[32:35], s60 offen lds
  v_accvgpr_read_b32 v26, a190
  v_accvgpr_read_b32 v27, a191
  v_mfma_f32_16x16x32_bf16 v[80:83], a[168:171], a[16:19], v[80:83]
  ds_read_b64_tr_b16 a[168:169], v8 offset:49152
  v_accvgpr_read_b32 v28, a192
  v_mfma_f32_16x16x32_bf16 v[80:83], a[172:175], a[0:3], v[80:83]
  s_waitcnt lgkmcnt(5)
  v_accvgpr_read_b32 v29, a193
  v_mfma_f32_16x16x32_bf16 v[96:99], a[180:183], a[0:3], v[96:99]
  ds_read_b64_tr_b16 a[170:171], v8 offset:51200
  v_accvgpr_read_b32 v30, a194
  v_mfma_f32_16x16x32_bf16 v[96:99], a[176:179], a[16:19], v[96:99]
  buffer_load_dwordx4 a[32:35], v1, s[8:11], s77 offen offset:0 sc1
  v_accvgpr_read_b32 v31, a195
  v_add_f32 v16, v16, v24
  v_mfma_f32_16x16x32_bf16 v[100:103], a[176:179], a[20:23], v[100:103]
  ds_read_b64_tr_b16 a[172:173], v8 offset:53248
  v_add_f32 v17, v17, v25
  v_mfma_f32_16x16x32_bf16 v[100:103], a[180:183], a[4:7], v[100:103]
  v_add_f32 v18, v18, v26
  v_add_f32 v19, v19, v27
  v_mfma_f32_16x16x32_bf16 v[104:107], a[180:183], a[8:11], v[104:107]
  ds_read_b64_tr_b16 a[174:175], v8 offset:55296
  v_add_f32 v20, v20, v28
  v_mfma_f32_16x16x32_bf16 v[104:107], a[176:179], a[24:27], v[104:107]
  v_add_f32 v21, v21, v29
  v_add_f32 v22, v22, v30
  v_mfma_f32_16x16x32_bf16 v[108:111], a[176:179], a[28:31], v[108:111]
  ds_read_b64_tr_b16 a[176:177], v8 offset:57344
  v_add_f32 v23, v23, v31
  v_mfma_f32_16x16x32_bf16 v[108:111], a[180:183], a[12:15], v[108:111]
  s_waitcnt lgkmcnt(5)
  buffer_load_dwordx4 a[48:51], v1, s[8:11], s77 offen offset:1024 sc1
  v_accvgpr_read_b32 v24, a196
  v_mfma_f32_16x16x32_bf16 v[124:127], a[160:163], a[12:15], v[124:127]
  ds_read_b64_tr_b16 a[178:179], v8 offset:59392
  v_accvgpr_read_b32 v25, a197
  v_mfma_f32_16x16x32_bf16 v[124:127], a[164:167], a[28:31], v[124:127]
  s_add_u32 s77, s77, 65536
  v_accvgpr_read_b32 v26, a198
  v_accvgpr_read_b32 v27, a199
  v_mfma_f32_16x16x32_bf16 v[120:123], a[164:167], a[24:27], v[120:123]
  ds_read_b64_tr_b16 a[180:181], v8 offset:61440
  v_accvgpr_read_b32 v28, a200
  v_mfma_f32_16x16x32_bf16 v[120:123], a[160:163], a[8:11], v[120:123]
  buffer_load_dwordx4 a[36:39], v1, s[8:11], s77 offen offset:0 sc1
  v_accvgpr_read_b32 v29, a201
  v_accvgpr_read_b32 v30, a202
  v_mfma_f32_16x16x32_bf16 v[116:119], a[160:163], a[4:7], v[116:119]
  ds_read_b64_tr_b16 a[182:183], v8 offset:63488
  v_accvgpr_read_b32 v31, a203
  v_mfma_f32_16x16x32_bf16 v[116:119], a[164:167], a[20:23], v[116:119]
  v_add_f32 v16, v16, v24
  v_add_f32 v17, v17, v25
  v_mfma_f32_16x16x32_bf16 v[112:115], a[164:167], a[16:19], v[112:115]
  ds_read_b64_tr_b16 a[164:165], v2 offset:49152
  v_add_f32 v18, v18, v26
  v_mfma_f32_16x16x32_bf16 v[112:115], a[160:163], a[0:3], v[112:115]
  s_waitcnt lgkmcnt(5)
  v_add_f32 v19, v19, v27
  v_add_f32 v20, v20, v28
  v_mfma_f32_16x16x32_bf16 v[32:35], a[168:171], a[0:3], v[32:35]
  ds_read_b64_tr_b16 a[166:167], v2 offset:51200
  v_add_f32 v21, v21, v29
  v_mfma_f32_16x16x32_bf16 v[32:35], a[172:175], a[16:19], v[32:35]
  buffer_load_dwordx4 a[52:55], v1, s[8:11], s77 offen offset:1024 sc1
  v_add_f32 v22, v22, v30
  v_add_f32 v23, v23, v31
  v_mfma_f32_16x16x32_bf16 v[36:39], a[172:175], a[20:23], v[36:39]
  ds_read_b64_tr_b16 a[160:161], v2 offset:53248
  v_accvgpr_read_b32 v24, a204
  v_mfma_f32_16x16x32_bf16 v[36:39], a[168:171], a[4:7], v[36:39]
  s_add_u32 s77, s77, 65536
  v_accvgpr_read_b32 v25, a205
  v_accvgpr_read_b32 v26, a206
  v_mfma_f32_16x16x32_bf16 v[40:43], a[168:171], a[8:11], v[40:43]
  ds_read_b64_tr_b16 a[162:163], v2 offset:55296
  v_accvgpr_read_b32 v27, a207
  v_mfma_f32_16x16x32_bf16 v[40:43], a[172:175], a[24:27], v[40:43]
  buffer_load_dwordx4 a[40:43], v1, s[8:11], s77 offen offset:0 sc1
  v_accvgpr_read_b32 v28, a208
  v_accvgpr_read_b32 v29, a209
  v_mfma_f32_16x16x32_bf16 v[44:47], a[172:175], a[28:31], v[44:47]
  ds_read_b64_tr_b16 a[172:173], v2 offset:57344
  v_accvgpr_read_b32 v30, a210
  v_mfma_f32_16x16x32_bf16 v[44:47], a[168:171], a[12:15], v[44:47]
  s_waitcnt lgkmcnt(5)
  v_accvgpr_read_b32 v31, a211
  v_add_f32 v16, v16, v24
  v_mfma_f32_16x16x32_bf16 v[60:63], a[176:179], a[12:15], v[60:63]
  ds_read_b64_tr_b16 a[174:175], v2 offset:59392
  v_add_f32 v17, v17, v25
  v_mfma_f32_16x16x32_bf16 v[60:63], a[180:183], a[28:31], v[60:63]
  v_add_f32 v18, v18, v26
  v_add_f32 v19, v19, v27
  v_mfma_f32_16x16x32_bf16 v[56:59], a[180:183], a[24:27], v[56:59]
  ds_read_b64_tr_b16 a[168:169], v2 offset:61440
  v_add_f32 v20, v20, v28
  v_mfma_f32_16x16x32_bf16 v[56:59], a[176:179], a[8:11], v[56:59]
  buffer_load_dwordx4 a[56:59], v1, s[8:11], s77 offen offset:1024 sc1
  v_add_f32 v21, v21, v29
  v_add_f32 v22, v22, v30
  v_mfma_f32_16x16x32_bf16 v[52:55], a[176:179], a[4:7], v[52:55]
  ds_read_b64_tr_b16 a[170:171], v2 offset:63488
  v_add_f32 v23, v23, v31
  v_mfma_f32_16x16x32_bf16 v[52:55], a[180:183], a[20:23], v[52:55]
  s_add_u32 s77, s77, 65536
  v_accvgpr_read_b32 v24, a212
  v_accvgpr_read_b32 v25, a213
  v_mfma_f32_16x16x32_bf16 v[48:51], a[180:183], a[16:19], v[48:51]
  ds_read_b64_tr_b16 a[180:181], v3 offset:49152
  v_accvgpr_read_b32 v26, a214
  v_mfma_f32_16x16x32_bf16 v[48:51], a[176:179], a[0:3], v[48:51]
  s_waitcnt lgkmcnt(5)
  buffer_load_dwordx4 a[44:47], v1, s[8:11], s77 offen offset:0 sc1
  v_accvgpr_read_b32 v27, a215
  v_mfma_f32_16x16x32_bf16 v[128:131], a[164:167], a[0:3], v[128:131]
  ds_read_b64_tr_b16 a[182:183], v3 offset:51200
  v_accvgpr_read_b32 v28, a216
  v_mfma_f32_16x16x32_bf16 v[128:131], a[160:163], a[16:19], v[128:131]
  v_accvgpr_read_b32 v29, a217
  v_accvgpr_read_b32 v30, a218
  v_mfma_f32_16x16x32_bf16 v[132:135], a[160:163], a[20:23], v[132:135]
  ds_read_b64_tr_b16 a[176:177], v3 offset:53248
  v_accvgpr_read_b32 v31, a219
  v_mfma_f32_16x16x32_bf16 v[132:135], a[164:167], a[4:7], v[132:135]
  v_add_f32 v16, v16, v24
  v_add_f32 v17, v17, v25
  v_mfma_f32_16x16x32_bf16 v[136:139], a[164:167], a[8:11], v[136:139]
  ds_read_b64_tr_b16 a[178:179], v3 offset:55296
  v_add_f32 v18, v18, v26
  v_mfma_f32_16x16x32_bf16 v[136:139], a[160:163], a[24:27], v[136:139]
  buffer_load_dwordx4 a[60:63], v1, s[8:11], s77 offen offset:1024 sc1
  v_add_f32 v19, v19, v27
  v_add_f32 v20, v20, v28
  v_mfma_f32_16x16x32_bf16 v[140:143], a[160:163], a[28:31], v[140:143]
  ds_read_b64_tr_b16 a[160:161], v3 offset:57344
  v_add_f32 v21, v21, v29
  v_mfma_f32_16x16x32_bf16 v[140:143], a[164:167], a[12:15], v[140:143]
  s_waitcnt lgkmcnt(5)
  s_mov_b32 s70, 3211264
  s_add_u32 s78, s24, 14336
  s_add_u32 m0, s45, 65536
  v_add_f32 v22, v22, v30
  v_mfma_f32_16x16x32_bf16 v[156:159], a[172:175], a[12:15], v[156:159]
  ds_read_b64_tr_b16 a[162:163], v3 offset:59392
  v_add_f32 v23, v23, v31
  v_mfma_f32_16x16x32_bf16 v[156:159], a[168:171], a[28:31], v[156:159]
  buffer_load_dwordx4 v11, s[28:31], s70 offen lds
  v_permlane32_swap_b32 v16, v20
  v_mfma_f32_16x16x32_bf16 v[152:155], a[168:171], a[24:27], v[152:155]
  ds_read_b64_tr_b16 a[164:165], v3 offset:61440
  v_mfma_f32_16x16x32_bf16 v[152:155], a[172:175], a[8:11], v[152:155]
  v_permlane32_swap_b32 v17, v21
  v_mfma_f32_16x16x32_bf16 v[148:151], a[172:175], a[4:7], v[148:151]
  ds_read_b64_tr_b16 a[166:167], v3 offset:63488
  v_mfma_f32_16x16x32_bf16 v[148:151], a[168:171], a[20:23], v[148:151]
  s_add_u32 m0, s45, 73728
  v_permlane32_swap_b32 v18, v22
  v_mfma_f32_16x16x32_bf16 v[144:147], a[168:171], a[16:19], v[144:147]
  ds_read_b64_tr_b16 a[168:169], v4 offset:49152
  v_mfma_f32_16x16x32_bf16 v[144:147], a[172:175], a[0:3], v[144:147]
  s_waitcnt lgkmcnt(5)
  buffer_load_dwordx4 v11, s[32:35], s70 offen lds
  v_mfma_f32_16x16x32_bf16 v[160:163], a[180:183], a[0:3], v[160:163]
  ds_read_b64_tr_b16 a[170:171], v4 offset:51200
  v_mfma_f32_16x16x32_bf16 v[160:163], a[176:179], a[16:19], v[160:163]
  s_add_u32 m0, s45, 69632
  s_add_u32 s60, s70, 229376
  v_mfma_f32_16x16x32_bf16 v[164:167], a[176:179], a[20:23], v[164:167]
  ds_read_b64_tr_b16 a[172:173], v4 offset:53248
  v_permlane32_swap_b32 v19, v23
  v_mfma_f32_16x16x32_bf16 v[164:167], a[180:183], a[4:7], v[164:167]
  buffer_load_dwordx4 v11, s[28:31], s60 offen lds
  v_add_f32 v16, v16, v20
  v_add_f32 v17, v17, v21
  v_mfma_f32_16x16x32_bf16 v[168:171], a[180:183], a[8:11], v[168:171]
  ds_read_b64_tr_b16 a[174:175], v4 offset:55296
  v_add_f32 v18, v18, v22
  v_mfma_f32_16x16x32_bf16 v[168:171], a[176:179], a[24:27], v[168:171]
  v_add_f32 v19, v19, v23
  v_mfma_f32_16x16x32_bf16 v[172:175], a[176:179], a[28:31], v[172:175]
  ds_read_b64_tr_b16 a[176:177], v4 offset:57344
  v_mfma_f32_16x16x32_bf16 v[172:175], a[180:183], a[12:15], v[172:175]
  s_waitcnt lgkmcnt(5)
  s_add_u32 m0, s45, 77824
  s_add_u32 s60, s70, 229376
  v_mfma_f32_16x16x32_bf16 v[188:191], a[160:163], a[12:15], v[188:191]
  ds_read_b64_tr_b16 a[178:179], v4 offset:59392
  v_mfma_f32_16x16x32_bf16 v[188:191], a[164:167], a[28:31], v[188:191]
  buffer_load_dwordx4 v11, s[32:35], s60 offen lds
  v_permlane16_swap_b32 v16, v18
  v_mfma_f32_16x16x32_bf16 v[184:187], a[164:167], a[24:27], v[184:187]
  ds_read_b64_tr_b16 a[180:181], v4 offset:61440
  v_mfma_f32_16x16x32_bf16 v[184:187], a[160:163], a[8:11], v[184:187]
  s_add_u32 m0, s45, 0
  v_permlane16_swap_b32 v17, v19
  v_mfma_f32_16x16x32_bf16 v[180:183], a[160:163], a[4:7], v[180:183]
  ds_read_b64_tr_b16 a[182:183], v4 offset:63488
  v_add_f32 v16, v16, v18
  v_mfma_f32_16x16x32_bf16 v[180:183], a[164:167], a[20:23], v[180:183]
  buffer_load_dwordx4 v10, s[28:31], s70 offen lds
  v_add_f32 v17, v17, v19
  v_mul_f32 v16, 0x3a800000, v16
  v_mfma_f32_16x16x32_bf16 v[176:179], a[164:167], a[16:19], v[176:179]
  ds_read_b64_tr_b16 a[164:165], v5 offset:49152
  v_mul_f32 v17, 0x3a800000, v17
  v_mfma_f32_16x16x32_bf16 v[176:179], a[160:163], a[0:3], v[176:179]
  s_waitcnt lgkmcnt(5)
  v_fma_f32 v17, -v16, v16, v17
  v_max_f32 v17, 0, v17
  v_mfma_f32_16x16x32_bf16 v[192:195], a[168:171], a[0:3], v[192:195]
  ds_read_b64_tr_b16 a[166:167], v5 offset:51200
  v_cvt_pk_bf16_f32 v17, v17, v17
  v_mfma_f32_16x16x32_bf16 v[192:195], a[172:175], a[16:19], v[192:195]
  s_add_u32 m0, s45, 8192
  v_lshlrev_b32 v17, 16, v17
  v_add_f32 v17, 0x3727c5ac, v17
  v_mfma_f32_16x16x32_bf16 v[196:199], a[172:175], a[20:23], v[196:199]
  ds_read_b64_tr_b16 a[160:161], v5 offset:53248
  v_cvt_pk_bf16_f32 v17, v17, v17
  v_mfma_f32_16x16x32_bf16 v[196:199], a[168:171], a[4:7], v[196:199]
  buffer_load_dwordx4 v10, s[32:35], s70 offen lds
  v_lshlrev_b32 v17, 16, v17
  v_mfma_f32_16x16x32_bf16 v[200:203], a[168:171], a[8:11], v[200:203]
  ds_read_b64_tr_b16 a[162:163], v5 offset:55296
  v_mfma_f32_16x16x32_bf16 v[200:203], a[172:175], a[24:27], v[200:203]
  s_add_u32 m0, s45, 4096
  s_add_u32 s60, s70, 229376
  v_mfma_f32_16x16x32_bf16 v[204:207], a[172:175], a[28:31], v[204:207]
  ds_read_b64_tr_b16 a[172:173], v5 offset:57344
  v_mfma_f32_16x16x32_bf16 v[204:207], a[168:171], a[12:15], v[204:207]
  s_waitcnt lgkmcnt(5)
  buffer_load_dwordx4 v10, s[28:31], s60 offen lds
  v_mfma_f32_16x16x32_bf16 v[220:223], a[176:179], a[12:15], v[220:223]
  ds_read_b64_tr_b16 a[174:175], v5 offset:59392
  v_sqrt_f32 v17, v17
  v_mfma_f32_16x16x32_bf16 v[220:223], a[180:183], a[28:31], v[220:223]
  v_cvt_pk_bf16_f32 v16, v16, v16
  v_lshlrev_b32 v16, 16, v16
  v_mfma_f32_16x16x32_bf16 v[216:219], a[180:183], a[24:27], v[216:219]
  ds_read_b64_tr_b16 a[168:169], v5 offset:61440
  v_cvt_pk_bf16_f32 v17, v17, v17
  v_mfma_f32_16x16x32_bf16 v[216:219], a[176:179], a[8:11], v[216:219]
  s_add_u32 m0, s45, 12288
  s_add_u32 s60, s70, 229376
  v_lshlrev_b32 v17, 16, v17
  v_mfma_f32_16x16x32_bf16 v[212:215], a[176:179], a[4:7], v[212:215]
  ds_read_b64_tr_b16 a[170:171], v5 offset:63488
  buffer_load_dwordx4 v10, s[32:35], s60 offen lds
  v_mfma_f32_16x16x32_bf16 v[212:215], a[180:183], a[20:23], v[212:215]
  s_waitcnt vmcnt(16)
  s_barrier
  v_mfma_f32_16x16x32_bf16 v[208:211], a[180:183], a[16:19], v[208:211]
  ds_read_b64_tr_b16 a[180:181], v6 offset:16384
  v_sub_f32 v16, 0, v16
  v_mfma_f32_16x16x32_bf16 v[208:211], a[176:179], a[0:3], v[208:211]
  s_waitcnt lgkmcnt(5)
  v_mov_b32 v18, v16
  v_mfma_f32_16x16x32_bf16 v[224:227], a[164:167], a[0:3], v[224:227]
  ds_read_b64_tr_b16 a[182:183], v6 offset:18432
  v_mov_b32 v19, v17
  v_mfma_f32_16x16x32_bf16 v[224:227], a[160:163], a[16:19], v[224:227]
  buffer_load_dwordx4 a[64:67], v1, s[8:11], s78 offen offset:0 sc1
  v_permlane16_swap_b32 v16, v18
  v_mfma_f32_16x16x32_bf16 v[228:231], a[160:163], a[20:23], v[228:231]
  ds_read_b64_tr_b16 a[176:177], v6 offset:20480
  v_mfma_f32_16x16x32_bf16 v[228:231], a[164:167], a[4:7], v[228:231]
  v_permlane16_swap_b32 v17, v19
  v_mfma_f32_16x16x32_bf16 v[232:235], a[164:167], a[8:11], v[232:235]
  ds_read_b64_tr_b16 a[178:179], v6 offset:22528
  v_mov_b32 v20, v16
  v_mfma_f32_16x16x32_bf16 v[232:235], a[160:163], a[24:27], v[232:235]
  v_mov_b32 v21, v17
  v_mov_b32 v22, v18
  v_mfma_f32_16x16x32_bf16 v[236:239], a[160:163], a[28:31], v[236:239]
  ds_read_b64_tr_b16 a[160:161], v6 offset:24576
  v_mov_b32 v23, v19
  v_mfma_f32_16x16x32_bf16 v[236:239], a[164:167], a[12:15], v[236:239]
  s_waitcnt lgkmcnt(5)
  buffer_load_dwordx4 a[80:83], v1, s[8:11], s78 offen offset:1024 sc1
  v_mfma_f32_16x16x32_bf16 v[252:255], a[172:175], a[12:15], v[252:255]
  ds_read_b64_tr_b16 a[162:163], v6 offset:26624
  v_mfma_f32_16x16x32_bf16 v[252:255], a[168:171], a[28:31], v[252:255]
  s_add_u32 s78, s78, 65536
  v_permlane32_swap_b32 v16, v20
  v_mfma_f32_16x16x32_bf16 v[248:251], a[168:171], a[24:27], v[248:251]
  ds_read_b64_tr_b16 a[164:165], v6 offset:28672
  v_mfma_f32_16x16x32_bf16 v[248:251], a[172:175], a[8:11], v[248:251]
  buffer_load_dwordx4 a[68:71], v1, s[8:11], s78 offen offset:0 sc1
  v_permlane32_swap_b32 v17, v21
  v_mfma_f32_16x16x32_bf16 v[244:247], a[172:175], a[4:7], v[244:247]
  ds_read_b64_tr_b16 a[166:167], v6 offset:30720
  v_mfma_f32_16x16x32_bf16 v[244:247], a[168:171], a[20:23], v[244:247]
  v_permlane32_swap_b32 v18, v22
  v_mfma_f32_16x16x32_bf16 v[240:243], a[168:171], a[16:19], v[240:243]
  ds_read_b64_tr_b16 a[168:169], v7 offset:16384
HOP10:
  s_cbranch_execz WRET0
  v_mfma_f32_16x16x32_bf16 v[240:243], a[172:175], a[0:3], v[240:243]
  s_waitcnt vmcnt(11) lgkmcnt(5)
  v_permlane32_swap_b32 v19, v23
  v_mfma_f32_16x16x32_bf16 v[64:67], a[180:183], a[32:35], v[64:67]
  ds_read_b64_tr_b16 a[170:171], v7 offset:18432
  v_lshrrev_b32 v12, 8, v1
  v_mfma_f32_16x16x32_bf16 v[64:67], a[176:179], a[48:51], v[64:67]
  buffer_load_dwordx4 a[84:87], v1, s[8:11], s78 offen offset:1024 sc1
  v_lshlrev_b32 v12, 4, v12
  v_add_u32 v12, 131072, v12
  v_mfma_f32_16x16x32_bf16 v[68:71], a[176:179], a[52:55], v[68:71]
  ds_read_b64_tr_b16 a[172:173], v7 offset:20480
  v_mfma_f32_16x16x32_bf16 v[68:71], a[180:183], a[36:39], v[68:71]
  s_add_u32 s78, s78, 65536
  v_mfma_f32_16x16x32_bf16 v[72:75], a[180:183], a[40:43], v[72:75]
  ds_read_b64_tr_b16 a[174:175], v7 offset:22528
  v_mfma_f32_16x16x32_bf16 v[72:75], a[176:179], a[56:59], v[72:75]
  buffer_load_dwordx4 a[72:75], v1, s[8:11], s78 offen offset:0 sc1
  v_mfma_f32_16x16x32_bf16 v[76:79], a[176:179], a[60:63], v[76:79]
  ds_read_b64_tr_b16 a[176:177], v7 offset:24576
  v_mfma_f32_16x16x32_bf16 v[76:79], a[180:183], a[44:47], v[76:79]
  s_waitcnt lgkmcnt(5)
  v_mfma_f32_16x16x32_bf16 v[92:95], a[160:163], a[44:47], v[92:95]
  ds_read_b64_tr_b16 a[178:179], v7 offset:26624
  v_mfma_f32_16x16x32_bf16 v[92:95], a[164:167], a[60:63], v[92:95]
  v_mfma_f32_16x16x32_bf16 v[88:91], a[164:167], a[56:59], v[88:91]
  ds_read_b64_tr_b16 a[180:181], v7 offset:28672
  v_mfma_f32_16x16x32_bf16 v[88:91], a[160:163], a[40:43], v[88:91]
  buffer_load_dwordx4 a[88:91], v1, s[8:11], s78 offen offset:1024 sc1
  v_mfma_f32_16x16x32_bf16 v[84:87], a[160:163], a[36:39], v[84:87]
  ds_read_b64_tr_b16 a[182:183], v7 offset:30720
  v_mfma_f32_16x16x32_bf16 v[84:87], a[164:167], a[52:55], v[84:87]
  s_lshl_b32 s82, s44, 28
  buffer_load_dword v9, v13, s[8:11], s82 offen sc1
  v_mfma_f32_16x16x32_bf16 v[80:83], a[164:167], a[48:51], v[80:83]
  ds_read_b64_tr_b16 a[164:165], v8 offset:16384
  s_add_u32 s78, s78, 65536
  v_mfma_f32_16x16x32_bf16 v[80:83], a[160:163], a[32:35], v[80:83]
  s_waitcnt lgkmcnt(5)
  buffer_load_dwordx4 a[76:79], v1, s[8:11], s78 offen offset:0 sc1
  v_mfma_f32_16x16x32_bf16 v[96:99], a[168:171], a[32:35], v[96:99]
  ds_read_b64_tr_b16 a[166:167], v8 offset:18432
  v_mfma_f32_16x16x32_bf16 v[96:99], a[172:175], a[48:51], v[96:99]
  v_mfma_f32_16x16x32_bf16 v[100:103], a[172:175], a[52:55], v[100:103]
  ds_read_b64_tr_b16 a[160:161], v8 offset:20480
  v_mfma_f32_16x16x32_bf16 v[100:103], a[168:171], a[36:39], v[100:103]
  v_mfma_f32_16x16x32_bf16 v[104:107], a[168:171], a[40:43], v[104:107]
  ds_read_b64_tr_b16 a[162:163], v8 offset:22528
  v_mfma_f32_16x16x32_bf16 v[104:107], a[172:175], a[56:59], v[104:107]
  buffer_load_dwordx4 a[92:95], v1, s[8:11], s78 offen offset:1024 sc1
  v_mfma_f32_16x16x32_bf16 v[108:111], a[172:175], a[60:63], v[108:111]
  ds_read_b64_tr_b16 a[172:173], v8 offset:24576
  v_mfma_f32_16x16x32_bf16 v[108:111], a[168:171], a[44:47], v[108:111]
  s_waitcnt lgkmcnt(5)
  s_mov_b32 s63, 3670016
  s_add_u32 s71, s24, 16384
  s_add_u32 m0, s45, 98304
  v_mfma_f32_16x16x32_bf16 v[124:127], a[176:179], a[44:47], v[124:127]
  ds_read_b64_tr_b16 a[174:175], v8 offset:26624
  v_mfma_f32_16x16x32_bf16 v[124:127], a[180:183], a[60:63], v[124:127]
  buffer_load_dwordx4 v11, s[28:31], s63 offen lds
  v_mfma_f32_16x16x32_bf16 v[120:123], a[180:183], a[56:59], v[120:123]
  ds_read_b64_tr_b16 a[168:169], v8 offset:28672
  v_mfma_f32_16x16x32_bf16 v[120:123], a[176:179], a[40:43], v[120:123]
  v_mfma_f32_16x16x32_bf16 v[116:119], a[176:179], a[36:39], v[116:119]
  ds_read_b64_tr_b16 a[170:171], v8 offset:30720
  v_mfma_f32_16x16x32_bf16 v[116:119], a[180:183], a[52:55], v[116:119]
  s_add_u32 m0, s45, 106496
  v_mfma_f32_16x16x32_bf16 v[112:115], a[180:183], a[48:51], v[112:115]
  ds_read_b64_tr_b16 a[180:181], v2 offset:16384
  v_mfma_f32_16x16x32_bf16 v[112:115], a[176:179], a[32:35], v[112:115]
  s_waitcnt lgkmcnt(5)
  buffer_load_dwordx4 v11, s[32:35], s63 offen lds
  v_mfma_f32_16x16x32_bf16 v[32:35], a[164:167], a[32:35], v[32:35]
  ds_read_b64_tr_b16 a[182:183], v2 offset:18432
  v_mfma_f32_16x16x32_bf16 v[32:35], a[160:163], a[48:51], v[32:35]
  s_add_u32 m0, s45, 102400
  s_add_u32 s60, s63, 229376
  v_mfma_f32_16x16x32_bf16 v[36:39], a[160:163], a[52:55], v[36:39]
  ds_read_b64_tr_b16 a[176:177], v2 offset:20480
  v_mfma_f32_16x16x32_bf16 v[36:39], a[164:167], a[36:39], v[36:39]
  buffer_load_dwordx4 v11, s[28:31], s60 offen lds
  v_mfma_f32_16x16x32_bf16 v[40:43], a[164:167], a[40:43], v[40:43]
  ds_read_b64_tr_b16 a[178:179], v2 offset:22528
  v_mfma_f32_16x16x32_bf16 v[40:43], a[160:163], a[56:59], v[40:43]
  v_mfma_f32_16x16x32_bf16 v[44:47], a[160:163], a[60:63], v[44:47]
  ds_read_b64_tr_b16 a[160:161], v2 offset:24576
  v_mfma_f32_16x16x32_bf16 v[44:47], a[164:167], a[44:47], v[44:47]
  s_waitcnt lgkmcnt(5)
  s_add_u32 m0, s45, 110592
  s_add_u32 s60, s63, 229376
  v_mfma_f32_16x16x32_bf16 v[60:63], a[172:175], a[44:47], v[60:63]
  ds_read_b64_tr_b16 a[162:163], v2 offset:26624
  v_mfma_f32_16x16x32_bf16 v[60:63], a[168:171], a[60:63], v[60:63]
  buffer_load_dwordx4 v11, s[32:35], s60 offen lds
  v_mfma_f32_16x16x32_bf16 v[56:59], a[168:171], a[56:59], v[56:59]
  ds_read_b64_tr_b16 a[164:165], v2 offset:28672
  v_mfma_f32_16x16x32_bf16 v[56:59], a[172:175], a[40:43], v[56:59]
  s_add_u32 m0, s45, 32768
  v_mfma_f32_16x16x32_bf16 v[52:55], a[172:175], a[36:39], v[52:55]
  ds_read_b64_tr_b16 a[166:167], v2 offset:30720
  v_mfma_f32_16x16x32_bf16 v[52:55], a[168:171], a[52:55], v[52:55]
  buffer_load_dwordx4 v10, s[28:31], s63 offen lds
  v_mfma_f32_16x16x32_bf16 v[48:51], a[168:171], a[48:51], v[48:51]
  ds_read_b64_tr_b16 a[168:169], v3 offset:16384
  v_mfma_f32_16x16x32_bf16 v[48:51], a[172:175], a[32:35], v[48:51]
  s_waitcnt lgkmcnt(5)
  v_mfma_f32_16x16x32_bf16 v[128:131], a[180:183], a[32:35], v[128:131]
  ds_read_b64_tr_b16 a[170:171], v3 offset:18432
  v_mfma_f32_16x16x32_bf16 v[128:131], a[176:179], a[48:51], v[128:131]
  s_add_u32 m0, s45, 40960
  v_mfma_f32_16x16x32_bf16 v[132:135], a[176:179], a[52:55], v[132:135]
  ds_read_b64_tr_b16 a[172:173], v3 offset:20480
  v_mfma_f32_16x16x32_bf16 v[132:135], a[180:183], a[36:39], v[132:135]
  buffer_load_dwordx4 v10, s[32:35], s63 offen lds
  v_mfma_f32_16x16x32_bf16 v[136:139], a[180:183], a[40:43], v[136:139]
  ds_read_b64_tr_b16 a[174:175], v3 offset:22528
  v_mfma_f32_16x16x32_bf16 v[136:139], a[176:179], a[56:59], v[136:139]
  s_waitcnt vmcnt(8)
  s_cmp_lg_u32 s44, 0
  s_cbranch_scc1 PL11_adaLN_cond__sliding_local_dilated__swiglu_ffn__prompt_kernelx
  v_cmp_ne_u32 vcc, s46, v9
  s_nop 4
  s_cbranch_vccz PL11_adaLN_cond__sliding_local_dilated__swiglu_ffn__prompt_kernelx
  s_mov_b32 s82, 60000
PL11_adaLN_cond__sliding_local_dilated__swiglu_ffn__prompt_kernel:
  buffer_load_dword v9, v13, s[8:11], 0 offen sc1
  s_sub_u32 s82, s82, 1
  s_cmp_eq_u32 s82, 0
  s_waitcnt vmcnt(0)
  s_cbranch_scc1 PL11_adaLN_cond__sliding_local_dilated__swiglu_ffn__prompt_kernelx
  v_cmp_ne_u32 vcc, s46, v9
  s_nop 4
  s_cbranch_vccnz PL11_adaLN_cond__sliding_local_dilated__swiglu_ffn__prompt_kernel
PL11_adaLN_cond__sliding_local_dilated__swiglu_ffn__prompt_kernelx:
  s_barrier
  v_mfma_f32_16x16x32_bf16 v[140:143], a[176:179], a[60:63], v[140:143]
  ds_read_b64_tr_b16 a[176:177], v3 offset:24576
  s_add_u32 m0, s45, 36864
  s_add_u32 s60, s63, 229376
  v_mfma_f32_16x16x32_bf16 v[140:143], a[180:183], a[44:47], v[140:143]
  s_waitcnt lgkmcnt(5)
  buffer_load_dwordx4 v10, s[28:31], s60 offen lds
  v_mfma_f32_16x16x32_bf16 v[156:159], a[160:163], a[44:47], v[156:159]
  ds_read_b64_tr_b16 a[178:179], v3 offset:26624
  v_mfma_f32_16x16x32_bf16 v[156:159], a[164:167], a[60:63], v[156:159]
  v_mfma_f32_16x16x32_bf16 v[152:155], a[164:167], a[56:59], v[152:155]
  ds_read_b64_tr_b16 a[180:181], v3 offset:28672
  v_mfma_f32_16x16x32_bf16 v[152:155], a[160:163], a[40:43], v[152:155]
  s_add_u32 m0, s45, 45056
  s_add_u32 s60, s63, 229376
  v_mfma_f32_16x16x32_bf16 v[148:151], a[160:163], a[36:39], v[148:151]
  ds_read_b64_tr_b16 a[182:183], v3 offset:30720
  v_mfma_f32_16x16x32_bf16 v[148:151], a[164:167], a[52:55], v[148:151]
  buffer_load_dwordx4 v10, s[32:35], s60 offen lds
  v_mfma_f32_16x16x32_bf16 v[144:147], a[164:167], a[48:51], v[144:147]
  ds_read_b64_tr_b16 a[164:165], v4 offset:16384
  v_mfma_f32_16x16x32_bf16 v[144:147], a[160:163], a[32:35], v[144:147]
  s_waitcnt lgkmcnt(5)
  s_mov_b32 s61, 0
  v_mfma_f32_16x16x32_bf16 v[160:163], a[168:171], a[32:35], v[160:163]
  ds_read_b64_tr_b16 a[166:167], v4 offset:18432
  v_mfma_f32_16x16x32_bf16 v[160:163], a[172:175], a[48:51], v[160:163]
  buffer_load_dwordx4 a[220:223], v14, s[8:11], s61 offen sc1
  v_mfma_f32_16x16x32_bf16 v[164:167], a[172:175], a[52:55], v[164:167]
  ds_read_b64_tr_b16 a[160:161], v4 offset:20480
  v_mfma_f32_16x16x32_bf16 v[164:167], a[168:171], a[36:39], v[164:167]
  s_mov_b32 s61, 114688
  v_mfma_f32_16x16x32_bf16 v[168:171], a[168:171], a[40:43], v[168:171]
  ds_read_b64_tr_b16 a[162:163], v4 offset:22528
  buffer_load_dwordx4 a[224:227], v14, s[8:11], s61 offen sc1
  v_mfma_f32_16x16x32_bf16 v[168:171], a[172:175], a[56:59], v[168:171]
  s_mov_b32 s61, 229376
  v_mfma_f32_16x16x32_bf16 v[172:175], a[172:175], a[60:63], v[172:175]
  ds_read_b64_tr_b16 a[172:173], v4 offset:24576
  buffer_load_dwordx4 a[228:231], v14, s[8:11], s61 offen sc1
  v_mfma_f32_16x16x32_bf16 v[172:175], a[168:171], a[44:47], v[172:175]
  s_waitcnt lgkmcnt(5)
  s_mov_b32 s61, 344064
  v_mfma_f32_16x16x32_bf16 v[188:191], a[176:179], a[44:47], v[188:191]
  ds_read_b64_tr_b16 a[174:175], v4 offset:26624
  v_mfma_f32_16x16x32_bf16 v[188:191], a[180:183], a[60:63], v[188:191]
  buffer_load_dwordx4 a[232:235], v14, s[8:11], s61 offen sc1
  s_mov_b32 s61, 458752
  v_mfma_f32_16x16x32_bf16 v[184:187], a[180:183], a[56:59], v[184:187]
  ds_read_b64_tr_b16 a[168:169], v4 offset:28672
  v_mfma_f32_16x16x32_bf16 v[184:187], a[176:179], a[40:43], v[184:187]
  buffer_load_dwordx4 a[236:239], v14, s[8:11], s61 offen sc1
  v_mfma_f32_16x16x32_bf16 v[180:183], a[176:179], a[36:39], v[180:183]
  ds_read_b64_tr_b16 a[170:171], v4 offset:30720
  v_mfma_f32_16x16x32_bf16 v[180:183], a[180:183], a[52:55], v[180:183]
  s_mov_b32 s61, 573440
  v_mfma_f32_16x16x32_bf16 v[176:179], a[180:183], a[48:51], v[176:179]
  ds_read_b64_tr_b16 a[180:181], v5 offset:16384
  buffer_load_dwordx4 a[240:243], v14, s[8:11], s61 offen sc1
  v_mfma_f32_16x16x32_bf16 v[176:179], a[176:179], a[32:35], v[176:179]
  s_waitcnt lgkmcnt(5)
  s_mov_b32 s61, 688128
  v_mfma_f32_16x16x32_bf16 v[192:195], a[164:167], a[32:35], v[192:195]
  ds_read_b64_tr_b16 a[182:183], v5 offset:18432
  buffer_load_dwordx4 a[244:247], v14, s[8:11], s61 offen sc1
  v_mfma_f32_16x16x32_bf16 v[192:195], a[160:163], a[48:51], v[192:195]
  s_mov_b32 s61, 802816
  v_mfma_f32_16x16x32_bf16 v[196:199], a[160:163], a[52:55], v[196:199]
  ds_read_b64_tr_b16 a[176:177], v5 offset:20480
  v_mfma_f32_16x16x32_bf16 v[196:199], a[164:167], a[36:39], v[196:199]
  buffer_load_dwordx4 a[248:251], v14, s[8:11], s61 offen sc1
  v_mfma_f32_16x16x32_bf16 v[200:203], a[164:167], a[40:43], v[200:203]
  ds_read_b64_tr_b16 a[178:179], v5 offset:22528
  v_mfma_f32_16x16x32_bf16 v[200:203], a[160:163], a[56:59], v[200:203]
  buffer_load_dwordx4 a[96:99], v1, s[8:11], s71 offen offset:0 sc1
  v_mfma_f32_16x16x32_bf16 v[204:207], a[160:163], a[60:63], v[204:207]
  ds_read_b64_tr_b16 a[160:161], v5 offset:24576
  v_mfma_f32_16x16x32_bf16 v[204:207], a[164:167], a[44:47], v[204:207]
  s_waitcnt lgkmcnt(5)
  v_mfma_f32_16x16x32_bf16 v[220:223], a[172:175], a[44:47], v[220:223]
  ds_read_b64_tr_b16 a[162:163], v5 offset:26624
  v_mfma_f32_16x16x32_bf16 v[220:223], a[168:171], a[60:63], v[220:223]
  v_mfma_f32_16x16x32_bf16 v[216:219], a[168:171], a[56:59], v[216:219]
  ds_read_b64_tr_b16 a[164:165], v5 offset:28672
  v_mfma_f32_16x16x32_bf16 v[216:219], a[172:175], a[40:43], v[216:219]
  buffer_load_dwordx4 a[112:115], v1, s[8:11], s71 offen offset:1024 sc1
  v_mfma_f32_16x16x32_bf16 v[212:215], a[172:175], a[36:39], v[212:215]
  ds_read_b64_tr_b16 a[166:167], v5 offset:30720
  v_mfma_f32_16x16x32_bf16 v[212:215], a[168:171], a[52:55], v[212:215]
  s_waitcnt vmcnt(27)
  s_barrier
  v_mfma_f32_16x16x32_bf16 v[208:211], a[168:171], a[48:51], v[208:211]
  ds_read_b64_tr_b16 a[168:169], v6 offset:0
  s_add_u32 s71, s71, 65536
  v_mfma_f32_16x16x32_bf16 v[208:211], a[172:175], a[32:35], v[208:211]
  s_waitcnt lgkmcnt(5)
  buffer_load_dwordx4 a[100:103], v1, s[8:11], s71 offen offset:0 sc1
  v_mfma_f32_16x16x32_bf16 v[224:227], a[180:183], a[32:35], v[224:227]
  ds_read_b64_tr_b16 a[170:171], v6 offset:2048
  v_mfma_f32_16x16x32_bf16 v[224:227], a[176:179], a[48:51], v[224:227]
  v_mfma_f32_16x16x32_bf16 v[228:231], a[176:179], a[52:55], v[228:231]
  ds_read_b64_tr_b16 a[172:173], v6 offset:4096
  v_mfma_f32_16x16x32_bf16 v[228:231], a[180:183], a[36:39], v[228:231]
  v_mfma_f32_16x16x32_bf16 v[232:235], a[180:183], a[40:43], v[232:235]
  ds_read_b64_tr_b16 a[174:175], v6 offset:6144
  v_mfma_f32_16x16x32_bf16 v[232:235], a[176:179], a[56:59], v[232:235]
  buffer_load_dwordx4 a[116:119], v1, s[8:11], s71 offen offset:1024 sc1
  v_mfma_f32_16x16x32_bf16 v[236:239], a[176:179], a[60:63], v[236:239]
  ds_read_b64_tr_b16 a[176:177], v6 offset:8192
  v_mfma_f32_16x16x32_bf16 v[236:239], a[180:183], a[44:47], v[236:239]
  s_waitcnt lgkmcnt(5)
  s_add_u32 s71, s71, 65536
  v_mfma_f32_16x16x32_bf16 v[252:255], a[160:163], a[44:47], v[252:255]
  ds_read_b64_tr_b16 a[178:179], v6 offset:10240
  v_mfma_f32_16x16x32_bf16 v[252:255], a[164:167], a[60:63], v[252:255]
  buffer_load_dwordx4 a[104:107], v1, s[8:11], s71 offen offset:0 sc1
  v_mfma_f32_16x16x32_bf16 v[248:251], a[164:167], a[56:59], v[248:251]
  ds_read_b64_tr_b16 a[180:181], v6 offset:12288
  v_mfma_f32_16x16x32_bf16 v[248:251], a[160:163], a[40:43], v[248:251]
  v_mfma_f32_16x16x32_bf16 v[244:247], a[160:163], a[36:39], v[244:247]
  ds_read_b64_tr_b16 a[182:183], v6 offset:14336
  v_mfma_f32_16x16x32_bf16 v[244:247], a[164:167], a[52:55], v[244:247]
  v_mfma_f32_16x16x32_bf16 v[240:243], a[164:167], a[48:51], v[240:243]
  ds_read_b64_tr_b16 a[164:165], v7 offset:0
  v_mfma_f32_16x16x32_bf16 v[240:243], a[160:163], a[32:35], v[240:243]
  s_waitcnt vmcnt(21) lgkmcnt(5)
  buffer_load_dwordx4 a[120:123], v1, s[8:11], s71 offen offset:1024 sc1
  v_mfma_f32_16x16x32_bf16 v[64:67], a[168:171], a[64:67], v[64:67]
  ds_read_b64_tr_b16 a[166:167], v7 offset:2048
  v_mfma_f32_16x16x32_bf16 v[64:67], a[172:175], a[80:83], v[64:67]
  s_add_u32 s71, s71, 65536
  v_mfma_f32_16x16x32_bf16 v[68:71], a[172:175], a[84:87], v[68:71]
  ds_read_b64_tr_b16 a[160:161], v7 offset:4096
  v_mfma_f32_16x16x32_bf16 v[68:71], a[168:171], a[68:71], v[68:71]
  buffer_load_dwordx4 a[108:111], v1, s[8:11], s71 offen offset:0 sc1
  v_mfma_f32_16x16x32_bf16 v[72:75], a[168:171], a[72:75], v[72:75]
  ds_read_b64_tr_b16 a[162:163], v7 offset:6144
  v_mfma_f32_16x16x32_bf16 v[72:75], a[172:175], a[88:91], v[72:75]
  v_mfma_f32_16x16x32_bf16 v[76:79], a[172:175], a[92:95], v[76:79]
  ds_read_b64_tr_b16 a[172:173], v7 offset:8192
  s_waitcnt vmcnt(7)
  v_mfma_f32_16x16x32_bf16 v[76:79], a[168:171], a[76:79], v[76:79]
  s_waitcnt lgkmcnt(5)
  v_accvgpr_read_b32 v24, a220
  v_accvgpr_read_b32 v25, a221
  v_accvgpr_read_b32 v26, a222
  v_mfma_f32_16x16x32_bf16 v[92:95], a[176:179], a[76:79], v[92:95]
  ds_read_b64_tr_b16 a[174:175], v7 offset:10240
  v_accvgpr_read_b32 v27, a223
  v_mfma_f32_16x16x32_bf16 v[92:95], a[180:183], a[92:95], v[92:95]
  buffer_load_dwordx4 a[124:127], v1, s[8:11], s71 offen offset:1024 sc1
  v_accvgpr_read_b32 v28, a224
  v_accvgpr_read_b32 v29, a225
  v_mfma_f32_16x16x32_bf16 v[88:91], a[180:183], a[88:91], v[88:91]
  ds_read_b64_tr_b16 a[168:169], v7 offset:12288
  v_accvgpr_read_b32 v30, a226
  v_mfma_f32_16x16x32_bf16 v[88:91], a[176:179], a[72:75], v[88:91]
  s_mov_b32 s64, 4128768
  s_add_u32 s72, s24, 18432
  s_add_u32 m0, s45, 114688
  v_accvgpr_read_b32 v31, a227
  v_add_f32 v24, v24, v28
  v_add_f32 v25, v25, v29
  v_mfma_f32_16x16x32_bf16 v[84:87], a[176:179], a[68:71], v[84:87]
  ds_read_b64_tr_b16 a[170:171], v7 offset:14336
  v_add_f32 v26, v26, v30
  v_mfma_f32_16x16x32_bf16 v[84:87], a[180:183], a[84:87], v[84:87]
  buffer_load_dwordx4 v11, s[28:31], s64 offen lds
  v_add_f32 v27, v27, v31
  v_accvgpr_read_b32 v28, a228
  v_mfma_f32_16x16x32_bf16 v[80:83], a[180:183], a[80:83], v[80:83]
  ds_read_b64_tr_b16 a[180:181], v8 offset:0
  v_accvgpr_read_b32 v29, a229
  v_mfma_f32_16x16x32_bf16 v[80:83], a[176:179], a[64:67], v[80:83]
  s_waitcnt lgkmcnt(5)
  v_accvgpr_read_b32 v30, a230
  v_accvgpr_read_b32 v31, a231
  v_add_f32 v24, v24, v28
  v_mfma_f32_16x16x32_bf16 v[96:99], a[164:167], a[64:67], v[96:99]
  ds_read_b64_tr_b16 a[182:183], v8 offset:2048
  v_add_f32 v25, v25, v29
  v_mfma_f32_16x16x32_bf16 v[96:99], a[160:163], a[80:83], v[96:99]
  s_add_u32 m0, s45, 122880
  v_add_f32 v26, v26, v30
  v_add_f32 v27, v27, v31
  v_mfma_f32_16x16x32_bf16 v[100:103], a[160:163], a[84:87], v[100:103]
  ds_read_b64_tr_b16 a[176:177], v8 offset:4096
  v_accvgpr_read_b32 v28, a232
  v_mfma_f32_16x16x32_bf16 v[100:103], a[164:167], a[68:71], v[100:103]
  buffer_load_dwordx4 v11, s[32:35], s64 offen lds
  v_accvgpr_read_b32 v29, a233
  v_accvgpr_read_b32 v30, a234
  v_accvgpr_read_b32 v31, a235
  v_mfma_f32_16x16x32_bf16 v[104:107], a[164:167], a[72:75], v[104:107]
  ds_read_b64_tr_b16 a[178:179], v8 offset:6144
  v_add_f32 v24, v24, v28
  v_mfma_f32_16x16x32_bf16 v[104:107], a[160:163], a[88:91], v[104:107]
  s_add_u32 m0, s45, 118784
  s_add_u32 s60, s64, 229376
  v_add_f32 v25, v25, v29
  v_mfma_f32_16x16x32_bf16 v[108:111], a[160:163], a[92:95], v[108:111]
  ds_read_b64_tr_b16 a[160:161], v8 offset:8192
  v_add_f32 v26, v26, v30
  v_mfma_f32_16x16x32_bf16 v[108:111], a[164:167], a[76:79], v[108:111]
  s_waitcnt lgkmcnt(5)
  buffer_load_dwordx4 v11, s[28:31], s60 offen lds
  v_add_f32 v27, v27, v31
  v_accvgpr_read_b32 v28, a236
  v_mfma_f32_16x16x32_bf16 v[124:127], a[172:175], a[76:79], v[124:127]
  ds_read_b64_tr_b16 a[162:163], v8 offset:10240
  v_accvgpr_read_b32 v29, a237
  v_mfma_f32_16x16x32_bf16 v[124:127], a[168:171], a[92:95], v[124:127]
  v_accvgpr_read_b32 v30, a238
  v_accvgpr_read_b32 v31, a239
  v_mfma_f32_16x16x32_bf16 v[120:123], a[168:171], a[88:91], v[120:123]
  ds_read_b64_tr_b16 a[164:165], v8 offset:12288
  v_add_f32 v24, v24, v28
  v_mfma_f32_16x16x32_bf16 v[120:123], a[172:175], a[72:75], v[120:123]
  s_add_u32 m0, s45, 126976
  s_add_u32 s60, s64, 229376
  v_add_f32 v25, v25, v29
  v_add_f32 v26, v26, v30
  v_mfma_f32_16x16x32_bf16 v[116:119], a[172:175], a[68:71], v[116:119]
  ds_read_b64_tr_b16 a[166:167], v8 offset:14336
  v_add_f32 v27, v27, v31
  v_mfma_f32_16x16x32_bf16 v[116:119], a[168:171], a[84:87], v[116:119]
  buffer_load_dwordx4 v11, s[32:35], s60 offen lds
  v_accvgpr_read_b32 v28, a240
  v_accvgpr_read_b32 v29, a241
  v_mfma_f32_16x16x32_bf16 v[112:115], a[168:171], a[80:83], v[112:115]
  ds_read_b64_tr_b16 a[168:169], v2 offset:0
  v_accvgpr_read_b32 v30, a242
  v_mfma_f32_16x16x32_bf16 v[112:115], a[172:175], a[64:67], v[112:115]
  s_waitcnt lgkmcnt(5)
  s_add_u32 m0, s45, 49152
  v_accvgpr_read_b32 v31, a243
  v_add_f32 v24, v24, v28
  v_mfma_f32_16x16x32_bf16 v[32:35], a[180:183], a[64:67], v[32:35]
  ds_read_b64_tr_b16 a[170:171], v2 offset:2048
  v_add_f32 v25, v25, v29
  v_mfma_f32_16x16x32_bf16 v[32:35], a[176:179], a[80:83], v[32:35]
  buffer_load_dwordx4 v10, s[28:31], s64 offen lds
  v_add_f32 v26, v26, v30
  v_add_f32 v27, v27, v31
  v_mfma_f32_16x16x32_bf16 v[36:39], a[176:179], a[84:87], v[36:39]
  ds_read_b64_tr_b16 a[172:173], v2 offset:4096
  v_accvgpr_read_b32 v28, a244
  v_mfma_f32_16x16x32_bf16 v[36:39], a[180:183], a[68:71], v[36:39]
  v_accvgpr_read_b32 v29, a245
  v_accvgpr_read_b32 v30, a246
  v_accvgpr_read_b32 v31, a247
  v_mfma_f32_16x16x32_bf16 v[40:43], a[180:183], a[72:75], v[40:43]
  ds_read_b64_tr_b16 a[174:175], v2 offset:6144
  v_add_f32 v24, v24, v28
  v_mfma_f32_16x16x32_bf16 v[40:43], a[176:179], a[88:91], v[40:43]
  s_add_u32 m0, s45, 57344
  v_add_f32 v25, v25, v29
  v_add_f32 v26, v26, v30
  v_mfma_f32_16x16x32_bf16 v[44:47], a[176:179], a[92:95], v[44:47]
  ds_read_b64_tr_b16 a[176:177], v2 offset:8192
  v_add_f32 v27, v27, v31
  v_mfma_f32_16x16x32_bf16 v[44:47], a[180:183], a[76:79], v[44:47]
  s_waitcnt lgkmcnt(5)
  buffer_load_dwordx4 v10, s[32:35], s64 offen lds
  v_accvgpr_read_b32 v28, a248
  v_accvgpr_read_b32 v29, a249
  v_mfma_f32_16x16x32_bf16 v[60:63], a[160:163], a[76:79], v[60:63]
  ds_read_b64_tr_b16 a[178:179], v2 offset:10240
  v_accvgpr_read_b32 v30, a250
  v_mfma_f32_16x16x32_bf16 v[60:63], a[164:167], a[92:95], v[60:63]
  s_add_u32 m0, s45, 53248
  s_add_u32 s60, s64, 229376
  v_accvgpr_read_b32 v31, a251
  v_mfma_f32_16x16x32_bf16 v[56:59], a[164:167], a[88:91], v[56:59]
  ds_read_b64_tr_b16 a[180:181], v2 offset:12288
  v_add_f32 v24, v24, v28
  v_mfma_f32_16x16x32_bf16 v[56:59], a[160:163], a[72:75], v[56:59]
  buffer_load_dwordx4 v10, s[28:31], s60 offen lds
  v_add_f32 v25, v25, v29
  v_add_f32 v26, v26, v30
  v_add_f32 v27, v27, v31
  v_mfma_f32_16x16x32_bf16 v[52:55], a[160:163], a[68:71], v[52:55]
  ds_read_b64_tr_b16 a[182:183], v2 offset:14336
  v_mov_b32 v28, v24
  v_mfma_f32_16x16x32_bf16 v[52:55], a[164:167], a[84:87], v[52:55]
  v_mov_b32 v29, v25
  v_mov_b32 v30, v26
  v_mfma_f32_16x16x32_bf16 v[48:51], a[164:167], a[80:83], v[48:51]
  ds_read_b64_tr_b16 a[164:165], v3 offset:0
  v_mov_b32 v31, v27
  v_mfma_f32_16x16x32_bf16 v[48:51], a[160:163], a[64:67], v[48:51]
  s_waitcnt lgkmcnt(5)
  s_add_u32 m0, s45, 61440
  s_add_u32 s60, s64, 229376
  v_mfma_f32_16x16x32_bf16 v[128:131], a[168:171], a[64:67], v[128:131]
  ds_read_b64_tr_b16 a[166:167], v3 offset:2048
  v_mfma_f32_16x16x32_bf16 v[128:131], a[172:175], a[80:83], v[128:131]
  buffer_load_dwordx4 v10, s[32:35], s60 offen lds
  v_permlane32_swap_b32 v24, v28
  v_mfma_f32_16x16x32_bf16 v[132:135], a[172:175], a[84:87], v[132:135]
  ds_read_b64_tr_b16 a[160:161], v3 offset:4096
  v_mfma_f32_16x16x32_bf16 v[132:135], a[168:171], a[68:71], v[132:135]
  v_permlane32_swap_b32 v25, v29
  v_mfma_f32_16x16x32_bf16 v[136:139], a[168:171], a[72:75], v[136:139]
  ds_read_b64_tr_b16 a[162:163], v3 offset:6144
  v_mfma_f32_16x16x32_bf16 v[136:139], a[172:175], a[88:91], v[136:139]
  buffer_load_dwordx4 a[128:131], v1, s[8:11], s72 offen offset:0 sc1
  v_permlane32_swap_b32 v26, v30
  v_mfma_f32_16x16x32_bf16 v[140:143], a[172:175], a[92:95], v[140:143]
  ds_read_b64_tr_b16 a[172:173], v3 offset:8192
  v_mfma_f32_16x16x32_bf16 v[140:143], a[168:171], a[76:79], v[140:143]
  s_waitcnt lgkmcnt(5)
  v_permlane32_swap_b32 v27, v31
  v_add_f32 v24, v24, v28
  v_mfma_f32_16x16x32_bf16 v[156:159], a[176:179], a[76:79], v[156:159]
  ds_read_b64_tr_b16 a[174:175], v3 offset:10240
  v_add_f32 v25, v25, v29
  v_mfma_f32_16x16x32_bf16 v[156:159], a[180:183], a[92:95], v[156:159]
  v_add_f32 v26, v26, v30
  v_add_f32 v27, v27, v31
  v_mfma_f32_16x16x32_bf16 v[152:155], a[180:183], a[88:91], v[152:155]
  ds_read_b64_tr_b16 a[168:169], v3 offset:12288
  v_mfma_f32_16x16x32_bf16 v[152:155], a[176:179], a[72:75], v[152:155]
  buffer_load_dwordx4 a[144:147], v1, s[8:11], s72 offen offset:1024 sc1
  s_cmp_eq_u32 s44, 1
  s_cselect_b32 s55, 0xbfb8aa3b, 1.0
  v_mul_f32 v24, s55, v24
  v_mfma_f32_16x16x32_bf16 v[148:151], a[176:179], a[68:71], v[148:151]
  ds_read_b64_tr_b16 a[170:171], v3 offset:14336
  v_xor_b32 v9, 96, v6
  v_mfma_f32_16x16x32_bf16 v[148:151], a[180:183], a[84:87], v[148:151]
  s_add_u32 s72, s72, 65536
  v_mul_f32 v25, s55, v25
  v_mul_f32 v26, s55, v26
  v_mfma_f32_16x16x32_bf16 v[144:147], a[180:183], a[80:83], v[144:147]
  ds_read_b64_tr_b16 a[180:181], v4 offset:0
  v_mul_f32 v27, s55, v27
  v_mfma_f32_16x16x32_bf16 v[144:147], a[176:179], a[64:67], v[144:147]
  s_waitcnt lgkmcnt(5)
  buffer_load_dwordx4 a[132:135], v1, s[8:11], s72 offen offset:0 sc1
  v_mfma_f32_16x16x32_bf16 v[160:163], a[164:167], a[64:67], v[160:163]
  ds_read_b64_tr_b16 a[182:183], v4 offset:2048
  v_mfma_f32_16x16x32_bf16 v[160:163], a[160:163], a[80:83], v[160:163]
  ds_write_b128 v15, v[24:27]
  v_mfma_f32_16x16x32_bf16 v[164:167], a[160:163], a[84:87], v[164:167]
  ds_read_b64_tr_b16 a[176:177], v4 offset:4096
  v_mfma_f32_16x16x32_bf16 v[164:167], a[164:167], a[68:71], v[164:167]
  v_mfma_f32_16x16x32_bf16 v[168:171], a[164:167], a[72:75], v[168:171]
  ds_read_b64_tr_b16 a[178:179], v4 offset:6144
  buffer_load_dwordx4 a[148:151], v1, s[8:11], s72 offen offset:1024 sc1
  s_waitcnt lgkmcnt(2)
  s_barrier
  v_mfma_f32_16x16x32_bf16 v[168:171], a[160:163], a[88:91], v[168:171]
  v_lshrrev_b32 v15, 3, v0
  v_and_b32 v13, 7, v0
  v_lshlrev_b32 v13, 7, v13
  v_mfma_f32_16x16x32_bf16 v[172:175], a[160:163], a[92:95], v[172:175]
  ds_read_b64_tr_b16 a[160:161], v4 offset:8192
  v_lshl_add_u32 v13, v15, 18, v13
  v_lshrrev_b32 v14, 2, v15
  v_mfma_f32_16x16x32_bf16 v[172:175], a[164:167], a[76:79], v[172:175]
  s_waitcnt lgkmcnt(6)
  v_lshlrev_b32 v14, 17, v14
  v_sub_u32 v14, v13, v14
  v_add_u32 v15, 5, v15
  v_mfma_f32_16x16x32_bf16 v[188:191], a[172:175], a[76:79], v[188:191]
  ds_read_b64_tr_b16 a[162:163], v4 offset:10240
  s_add_u32 s72, s72, 65536
  v_lshrrev_b32 v15, 3, v15
  v_add_u32 v15, 1, v15
  v_mfma_f32_16x16x32_bf16 v[188:191], a[168:171], a[92:95], v[188:191]
  buffer_load_dwordx4 a[136:139], v1, s[8:11], s72 offen offset:0 sc1
  v_lshl_add_u32 v13, v15, 17, v13
  v_mfma_f32_16x16x32_bf16 v[184:187], a[168:171], a[88:91], v[184:187]
  ds_read_b64_tr_b16 a[164:165], v4 offset:12288
  ds_read_b128 v[24:27], v12 offset:384
  v_mfma_f32_16x16x32_bf16 v[184:187], a[172:175], a[72:75], v[184:187]
  v_mfma_f32_16x16x32_bf16 v[180:183], a[172:175], a[68:71], v[180:183]
  ds_read_b64_tr_b16 a[166:167], v4 offset:14336
  v_mfma_f32_16x16x32_bf16 v[180:183], a[168:171], a[84:87], v[180:183]
  ds_read_b128 v[28:31], v12 offset:1408
  s_waitcnt lgkmcnt(2)
  v_mfma_f32_16x16x32_bf16 v[176:179], a[168:171], a[80:83], v[176:179]
  ds_read_b64_tr_b16 a[168:169], v5 offset:0
  v_fmac_f32 v32, v16, v24
  v_mfma_f32_16x16x32_bf16 v[176:179], a[172:175], a[64:67], v[176:179]
  s_waitcnt lgkmcnt(7)
  buffer_load_dwordx4 a[152:155], v1, s[8:11], s72 offen offset:1024 sc1
  v_fmac_f32 v33, v16, v25
  v_mfma_f32_16x16x32_bf16 v[192:195], a[180:183], a[64:67], v[192:195]
  ds_read_b64_tr_b16 a[170:171], v5 offset:2048
  v_fmac_f32 v34, v16, v26
  v_mfma_f32_16x16x32_bf16 v[192:195], a[176:179], a[80:83], v[192:195]
  s_add_u32 s72, s72, 65536
  v_fmac_f32 v35, v16, v27
  v_fmac_f32 v36, v18, v24
  v_mfma_f32_16x16x32_bf16 v[196:199], a[176:179], a[84:87], v[196:199]
  ds_read_b64_tr_b16 a[172:173], v5 offset:4096
  v_fmac_f32 v37, v18, v25
  v_mfma_f32_16x16x32_bf16 v[196:199], a[180:183], a[68:71], v[196:199]
  buffer_load_dwordx4 a[140:143], v1, s[8:11], s72 offen offset:0 sc1
  v_fmac_f32 v38, v18, v26
  v_fmac_f32 v39, v18, v27
  v_mfma_f32_16x16x32_bf16 v[200:203], a[180:183], a[72:75], v[200:203]
  ds_read_b64_tr_b16 a[174:175], v5 offset:6144
  v_fmac_f32 v40, v20, v24
  v_mfma_f32_16x16x32_bf16 v[200:203], a[176:179], a[88:91], v[200:203]
  v_fmac_f32 v41, v20, v25
  v_fmac_f32 v42, v20, v26
  v_mfma_f32_16x16x32_bf16 v[204:207], a[176:179], a[92:95], v[204:207]
  ds_read_b64_tr_b16 a[176:177], v5 offset:8192
  v_fmac_f32 v43, v20, v27
  v_mfma_f32_16x16x32_bf16 v[204:207], a[180:183], a[76:79], v[204:207]
  s_waitcnt lgkmcnt(6)
  v_fmac_f32 v44, v22, v24
  v_fmac_f32 v45, v22, v25
  v_mfma_f32_16x16x32_bf16 v[220:223], a[160:163], a[76:79], v[220:223]
  ds_read_b64_tr_b16 a[178:179], v5 offset:10240
  v_fmac_f32 v46, v22, v26
  v_mfma_f32_16x16x32_bf16 v[220:223], a[164:167], a[92:95], v[220:223]
  buffer_load_dwordx4 a[156:159], v1, s[8:11], s72 offen offset:1024 sc1
  v_fmac_f32 v47, v22, v27
  v_mfma_f32_16x16x32_bf16 v[216:219], a[164:167], a[88:91], v[216:219]
  ds_read_b64_tr_b16 a[180:181], v5 offset:12288
  v_mfma_f32_16x16x32_bf16 v[216:219], a[160:163], a[72:75], v[216:219]
  s_mov_b32 s65, 4587520
  s_add_u32 s73, s24, 20480
  s_add_u32 m0, s45, 81920
  ds_read_b128 v[24:27], v12 offset:1920
  v_mfma_f32_16x16x32_bf16 v[212:215], a[160:163], a[68:71], v[212:215]
  ds_read_b64_tr_b16 a[182:183], v5 offset:14336
  s_waitcnt lgkmcnt(9)
  v_mfma_f32_16x16x32_bf16 v[212:215], a[164:167], a[84:87], v[212:215]
  buffer_load_dwordx4 v11, s[28:31], s65 offen lds
  s_waitcnt vmcnt(33)
  s_barrier
  v_mfma_f32_16x16x32_bf16 v[208:211], a[164:167], a[80:83], v[208:211]
  ds_read_b64_tr_b16 a[164:165], v6 offset:32768
  v_fmac_f32 v48, v16, v28
  v_mfma_f32_16x16x32_bf16 v[208:211], a[160:163], a[64:67], v[208:211]
HOP11:
  s_cbranch_execz WRET0
  s_waitcnt lgkmcnt(6)
  v_fmac_f32 v49, v16, v29
  v_fmac_f32 v50, v16, v30
  v_mfma_f32_16x16x32_bf16 v[224:227], a[168:171], a[64:67], v[224:227]
  ds_read_b64_tr_b16 a[166:167], v6 offset:34816
  v_fmac_f32 v51, v16, v31
  v_mfma_f32_16x16x32_bf16 v[224:227], a[172:175], a[80:83], v[224:227]
  s_add_u32 m0, s45, 90112
  v_fmac_f32 v52, v18, v28
  v_fmac_f32 v53, v18, v29
  v_mfma_f32_16x16x32_bf16 v[228:231], a[172:175], a[84:87], v[228:231]
  ds_read_b64_tr_b16 a[160:161], v6 offset:36864
  v_fmac_f32 v54, v18, v30
  v_mfma_f32_16x16x32_bf16 v[228:231], a[168:171], a[68:71], v[228:231]
  buffer_load_dwordx4 v11, s[32:35], s65 offen lds
  v_fmac_f32 v55, v18, v31
  v_fmac_f32 v56, v20, v28
  v_mfma_f32_16x16x32_bf16 v[232:235], a[168:171], a[72:75], v[232:235]
  ds_read_b64_tr_b16 a[162:163], v6 offset:38912
  v_fmac_f32 v57, v20, v29
  v_mfma_f32_16x16x32_bf16 v[232:235], a[172:175], a[88:91], v[232:235]
  s_add_u32 m0, s45, 86016
  s_add_u32 s60, s65, 229376
  v_fmac_f32 v58, v20, v30
  v_mfma_f32_16x16x32_bf16 v[236:239], a[172:175], a[92:95], v[236:239]
  ds_read_b64_tr_b16 a[172:173], v6 offset:40960
  v_fmac_f32 v59, v20, v31
  v_mfma_f32_16x16x32_bf16 v[236:239], a[168:171], a[76:79], v[236:239]
  s_waitcnt lgkmcnt(5)
  buffer_load_dwordx4 v11, s[28:31], s60 offen lds
  v_fmac_f32 v60, v22, v28
  v_mfma_f32_16x16x32_bf16 v[252:255], a[176:179], a[76:79], v[252:255]
  ds_read_b64_tr_b16 a[174:175], v6 offset:43008
  v_fmac_f32 v61, v22, v29
  v_mfma_f32_16x16x32_bf16 v[252:255], a[180:183], a[92:95], v[252:255]
  v_fmac_f32 v62, v22, v30
  v_fmac_f32 v63, v22, v31
  v_mfma_f32_16x16x32_bf16 v[248:251], a[180:183], a[88:91], v[248:251]
  ds_read_b64_tr_b16 a[168:169], v6 offset:45056
  v_mfma_f32_16x16x32_bf16 v[248:251], a[176:179], a[72:75], v[248:251]
  s_add_u32 m0, s45, 94208
  s_add_u32 s60, s65, 229376
  v_mfma_f32_16x16x32_bf16 v[244:247], a[176:179], a[68:71], v[244:247]
  ds_read_b64_tr_b16 a[170:171], v6 offset:47104
  v_mfma_f32_16x16x32_bf16 v[244:247], a[180:183], a[84:87], v[244:247]
  buffer_load_dwordx4 v11, s[32:35], s60 offen lds
  ds_read_b128 v[28:31], v12 offset:0
  v_mfma_f32_16x16x32_bf16 v[240:243], a[180:183], a[80:83], v[240:243]
  ds_read_b64_tr_b16 a[180:181], v7 offset:32768
  s_waitcnt lgkmcnt(11)
  v_mfma_f32_16x16x32_bf16 v[240:243], a[176:179], a[64:67], v[240:243]
  s_waitcnt vmcnt(20) lgkmcnt(6)
  s_mov_b32 s66, 5046272
  s_add_u32 s74, s24, 22528
  s_add_u32 m0, s45, 65536
  v_fmac_f32 v48, v17, v24
  v_mfma_f32_16x16x32_bf16 v[64:67], a[164:167], a[96:99], v[64:67]
  ds_read_b64_tr_b16 a[182:183], v7 offset:34816
  v_fmac_f32 v49, v17, v25
  v_mfma_f32_16x16x32_bf16 v[64:67], a[160:163], a[112:115], v[64:67]
  buffer_load_dwordx4 v11, s[28:31], s66 offen lds
  v_fmac_f32 v50, v17, v26
  v_fmac_f32 v51, v17, v27
  v_mfma_f32_16x16x32_bf16 v[68:71], a[160:163], a[116:119], v[68:71]
  ds_read_b64_tr_b16 a[176:177], v7 offset:36864
  v_fmac_f32 v52, v19, v24
  v_mfma_f32_16x16x32_bf16 v[68:71], a[164:167], a[100:103], v[68:71]
  v_fmac_f32 v53, v19, v25
  v_fmac_f32 v54, v19, v26
  v_mfma_f32_16x16x32_bf16 v[72:75], a[164:167], a[104:107], v[72:75]
  ds_read_b64_tr_b16 a[178:179], v7 offset:38912
  v_fmac_f32 v55, v19, v27
  v_mfma_f32_16x16x32_bf16 v[72:75], a[160:163], a[120:123], v[72:75]
  s_add_u32 m0, s45, 73728
  v_fmac_f32 v56, v21, v24
  v_fmac_f32 v57, v21, v25
  v_mfma_f32_16x16x32_bf16 v[76:79], a[160:163], a[124:127], v[76:79]
  ds_read_b64_tr_b16 a[160:161], v7 offset:40960
  v_fmac_f32 v58, v21, v26
  v_mfma_f32_16x16x32_bf16 v[76:79], a[164:167], a[108:111], v[76:79]
  s_waitcnt lgkmcnt(6)
  buffer_load_dwordx4 v11, s[32:35], s66 offen lds
  v_fmac_f32 v59, v21, v27
  v_mfma_f32_16x16x32_bf16 v[92:95], a[172:175], a[108:111], v[92:95]
  ds_read_b64_tr_b16 a[162:163], v7 offset:43008
  v_fmac_f32 v60, v23, v24
  v_mfma_f32_16x16x32_bf16 v[92:95], a[168:171], a[124:127], v[92:95]
  s_add_u32 m0, s45, 69632
  s_add_u32 s60, s66, 229376
  v_fmac_f32 v61, v23, v25
  v_mfma_f32_16x16x32_bf16 v[88:91], a[168:171], a[120:123], v[88:91]
  ds_read_b64_tr_b16 a[164:165], v7 offset:45056
  v_fmac_f32 v62, v23, v26
  v_mfma_f32_16x16x32_bf16 v[88:91], a[172:175], a[104:107], v[88:91]
  buffer_load_dwordx4 v11, s[28:31], s60 offen lds
  v_fmac_f32 v63, v23, v27
  v_mfma_f32_16x16x32_bf16 v[84:87], a[172:175], a[100:103], v[84:87]
  ds_read_b64_tr_b16 a[166:167], v7 offset:47104
  v_mfma_f32_16x16x32_bf16 v[84:87], a[168:171], a[116:119], v[84:87]
  ds_read_b128 v[24:27], v12 offset:256
  s_waitcnt lgkmcnt(9)
  v_mfma_f32_16x16x32_bf16 v[80:83], a[168:171], a[112:115], v[80:83]
  ds_read_b64_tr_b16 a[168:169], v8 offset:32768
  v_fmac_f32 v128, v16, v28
  v_mfma_f32_16x16x32_bf16 v[80:83], a[172:175], a[96:99], v[80:83]
  s_waitcnt lgkmcnt(6)
  s_add_u32 m0, s45, 77824
  s_add_u32 s60, s66, 229376
  v_mfma_f32_16x16x32_bf16 v[96:99], a[180:183], a[96:99], v[96:99]
  ds_read_b64_tr_b16 a[170:171], v8 offset:34816
  v_fmac_f32 v129, v16, v29
  v_mfma_f32_16x16x32_bf16 v[96:99], a[176:179], a[112:115], v[96:99]
  buffer_load_dwordx4 v11, s[32:35], s60 offen lds
  v_fmac_f32 v130, v16, v30
  v_fmac_f32 v131, v16, v31
  v_mfma_f32_16x16x32_bf16 v[100:103], a[176:179], a[116:119], v[100:103]
  ds_read_b64_tr_b16 a[172:173], v8 offset:36864
  v_fmac_f32 v132, v18, v28
  v_mfma_f32_16x16x32_bf16 v[100:103], a[180:183], a[100:103], v[100:103]
  s_add_u32 m0, s45, 16384
  v_fmac_f32 v133, v18, v29
  v_fmac_f32 v134, v18, v30
  v_mfma_f32_16x16x32_bf16 v[104:107], a[180:183], a[104:107], v[104:107]
  ds_read_b64_tr_b16 a[174:175], v8 offset:38912
  v_fmac_f32 v135, v18, v31
  v_mfma_f32_16x16x32_bf16 v[104:107], a[176:179], a[120:123], v[104:107]
  buffer_load_dwordx4 v10, s[28:31], s65 offen lds
  v_fmac_f32 v136, v20, v28
  v_fmac_f32 v137, v20, v29
  v_mfma_f32_16x16x32_bf16 v[108:111], a[176:179], a[124:127], v[108:111]
  ds_read_b64_tr_b16 a[176:177], v8 offset:40960
  v_fmac_f32 v138, v20, v30
  v_mfma_f32_16x16x32_bf16 v[108:111], a[180:183], a[108:111], v[108:111]
  s_waitcnt lgkmcnt(6)
  v_fmac_f32 v139, v20, v31
  v_fmac_f32 v140, v22, v28
  v_mfma_f32_16x16x32_bf16 v[124:127], a[160:163], a[108:111], v[124:127]
  ds_read_b64_tr_b16 a[178:179], v8 offset:43008
  v_fmac_f32 v141, v22, v29
  v_mfma_f32_16x16x32_bf16 v[124:127], a[164:167], a[124:127], v[124:127]
  s_add_u32 m0, s45, 24576
  v_fmac_f32 v142, v22, v30
  v_fmac_f32 v143, v22, v31
  v_mfma_f32_16x16x32_bf16 v[120:123], a[164:167], a[120:123], v[120:123]
  ds_read_b64_tr_b16 a[180:181], v8 offset:45056
  v_mfma_f32_16x16x32_bf16 v[120:123], a[160:163], a[104:107], v[120:123]
  buffer_load_dwordx4 v10, s[32:35], s65 offen lds
  ds_read_b128 v[28:31], v12 offset:1280
  v_mfma_f32_16x16x32_bf16 v[116:119], a[160:163], a[100:103], v[116:119]
  ds_read_b64_tr_b16 a[182:183], v8 offset:47104
  s_waitcnt lgkmcnt(9)
  v_mfma_f32_16x16x32_bf16 v[116:119], a[164:167], a[116:119], v[116:119]
  s_add_u32 m0, s45, 20480
  s_add_u32 s60, s65, 229376
  v_fmac_f32 v64, v16, v24
  v_mfma_f32_16x16x32_bf16 v[112:115], a[164:167], a[112:115], v[112:115]
  ds_read_b64_tr_b16 a[164:165], v2 offset:32768
  v_fmac_f32 v65, v16, v25
  v_mfma_f32_16x16x32_bf16 v[112:115], a[160:163], a[96:99], v[112:115]
  s_waitcnt lgkmcnt(6)
  buffer_load_dwordx4 v10, s[28:31], s60 offen lds
  v_fmac_f32 v66, v16, v26
  v_mfma_f32_16x16x32_bf16 v[32:35], a[168:171], a[96:99], v[32:35]
  ds_read_b64_tr_b16 a[166:167], v2 offset:34816
  v_fmac_f32 v67, v16, v27
  v_mfma_f32_16x16x32_bf16 v[32:35], a[172:175], a[112:115], v[32:35]
  v_fmac_f32 v68, v18, v24
  v_fmac_f32 v69, v18, v25
  v_mfma_f32_16x16x32_bf16 v[36:39], a[172:175], a[116:119], v[36:39]
  ds_read_b64_tr_b16 a[160:161], v2 offset:36864
  v_fmac_f32 v70, v18, v26
  v_mfma_f32_16x16x32_bf16 v[36:39], a[168:171], a[100:103], v[36:39]
  s_add_u32 m0, s45, 28672
  s_add_u32 s60, s65, 229376
  v_fmac_f32 v71, v18, v27
  v_mfma_f32_16x16x32_bf16 v[40:43], a[168:171], a[104:107], v[40:43]
  ds_read_b64_tr_b16 a[162:163], v2 offset:38912
  v_fmac_f32 v72, v20, v24
  v_mfma_f32_16x16x32_bf16 v[40:43], a[172:175], a[120:123], v[40:43]
  buffer_load_dwordx4 v10, s[32:35], s60 offen lds
  v_fmac_f32 v73, v20, v25
  v_fmac_f32 v74, v20, v26
  v_mfma_f32_16x16x32_bf16 v[44:47], a[172:175], a[124:127], v[44:47]
  ds_read_b64_tr_b16 a[172:173], v2 offset:40960
  v_fmac_f32 v75, v20, v27
  v_mfma_f32_16x16x32_bf16 v[44:47], a[168:171], a[108:111], v[44:47]
  s_waitcnt lgkmcnt(5)
  v_fmac_f32 v76, v22, v24
  v_mfma_f32_16x16x32_bf16 v[60:63], a[176:179], a[108:111], v[60:63]
  ds_read_b64_tr_b16 a[174:175], v2 offset:43008
  v_fmac_f32 v77, v22, v25
  v_mfma_f32_16x16x32_bf16 v[60:63], a[180:183], a[124:127], v[60:63]
  buffer_load_dwordx4 a[0:3], v1, s[8:11], s73 offen offset:0 sc1
  v_fmac_f32 v78, v22, v26
  v_fmac_f32 v79, v22, v27
  v_mfma_f32_16x16x32_bf16 v[56:59], a[180:183], a[120:123], v[56:59]
  ds_read_b64_tr_b16 a[168:169], v2 offset:45056
  v_mfma_f32_16x16x32_bf16 v[56:59], a[176:179], a[104:107], v[56:59]
  ds_read_b128 v[24:27], v12 offset:1792
  s_waitcnt lgkmcnt(9)
  v_mfma_f32_16x16x32_bf16 v[52:55], a[176:179], a[100:103], v[52:55]
  ds_read_b64_tr_b16 a[170:171], v2 offset:47104
  v_fmac_f32 v80, v16, v28
  v_mfma_f32_16x16x32_bf16 v[52:55], a[180:183], a[116:119], v[52:55]
  v_fmac_f32 v81, v16, v29
  v_fmac_f32 v82, v16, v30
  v_mfma_f32_16x16x32_bf16 v[48:51], a[180:183], a[112:115], v[48:51]
  ds_read_b64_tr_b16 a[180:181], v3 offset:32768
  v_fmac_f32 v83, v16, v31
  v_mfma_f32_16x16x32_bf16 v[48:51], a[176:179], a[96:99], v[48:51]
  s_waitcnt lgkmcnt(6)
  buffer_load_dwordx4 a[16:19], v1, s[8:11], s73 offen offset:1024 sc1
  v_fmac_f32 v84, v18, v28
  v_mfma_f32_16x16x32_bf16 v[128:131], a[164:167], a[96:99], v[128:131]
  ds_read_b64_tr_b16 a[182:183], v3 offset:34816
  v_fmac_f32 v85, v18, v29
  v_mfma_f32_16x16x32_bf16 v[128:131], a[160:163], a[112:115], v[128:131]
  s_add_u32 s73, s73, 65536
  v_fmac_f32 v86, v18, v30
  v_fmac_f32 v87, v18, v31
  v_mfma_f32_16x16x32_bf16 v[132:135], a[160:163], a[116:119], v[132:135]
  ds_read_b64_tr_b16 a[176:177], v3 offset:36864
  v_fmac_f32 v88, v20, v28
  v_mfma_f32_16x16x32_bf16 v[132:135], a[164:167], a[100:103], v[132:135]
  buffer_load_dwordx4 a[4:7], v1, s[8:11], s73 offen offset:0 sc1
  v_fmac_f32 v89, v20, v29
  v_fmac_f32 v90, v20, v30
  v_mfma_f32_16x16x32_bf16 v[136:139], a[164:167], a[104:107], v[136:139]
  ds_read_b64_tr_b16 a[178:179], v3 offset:38912
  v_fmac_f32 v91, v20, v31
  v_mfma_f32_16x16x32_bf16 v[136:139], a[160:163], a[120:123], v[136:139]
  v_fmac_f32 v92, v22, v28
  v_fmac_f32 v93, v22, v29
  v_mfma_f32_16x16x32_bf16 v[140:143], a[160:163], a[124:127], v[140:143]
  ds_read_b64_tr_b16 a[160:161], v3 offset:40960
  v_fmac_f32 v94, v22, v30
  v_mfma_f32_16x16x32_bf16 v[140:143], a[164:167], a[108:111], v[140:143]
  s_waitcnt lgkmcnt(5)
  v_fmac_f32 v95, v22, v31
  v_mfma_f32_16x16x32_bf16 v[156:159], a[172:175], a[108:111], v[156:159]
  ds_read_b64_tr_b16 a[162:163], v3 offset:43008
  v_mfma_f32_16x16x32_bf16 v[156:159], a[168:171], a[124:127], v[156:159]
  buffer_load_dwordx4 a[20:23], v1, s[8:11], s73 offen offset:1024 sc1
  ds_read_b128 v[28:31], v12 offset:320
  v_mfma_f32_16x16x32_bf16 v[152:155], a[168:171], a[120:123], v[152:155]
  ds_read_b64_tr_b16 a[164:165], v3 offset:45056
  s_waitcnt lgkmcnt(9)
  v_mfma_f32_16x16x32_bf16 v[152:155], a[172:175], a[104:107], v[152:155]
  s_add_u32 s73, s73, 65536
  v_fmac_f32 v80, v17, v24
  v_fmac_f32 v81, v17, v25
  v_mfma_f32_16x16x32_bf16 v[148:151], a[172:175], a[100:103], v[148:151]
  ds_read_b64_tr_b16 a[166:167], v3 offset:47104
  v_fmac_f32 v82, v17, v26
  v_mfma_f32_16x16x32_bf16 v[148:151], a[168:171], a[116:119], v[148:151]
  buffer_load_dwordx4 a[8:11], v1, s[8:11], s73 offen offset:0 sc1
  v_fmac_f32 v83, v17, v27
  v_fmac_f32 v84, v19, v24
  v_mfma_f32_16x16x32_bf16 v[144:147], a[168:171], a[112:115], v[144:147]
  ds_read_b64_tr_b16 a[168:169], v4 offset:32768
  v_fmac_f32 v85, v19, v25
  v_mfma_f32_16x16x32_bf16 v[144:147], a[172:175], a[96:99], v[144:147]
  s_waitcnt lgkmcnt(6)
  v_fmac_f32 v86, v19, v26
  v_fmac_f32 v87, v19, v27
  v_mfma_f32_16x16x32_bf16 v[160:163], a[180:183], a[96:99], v[160:163]
  ds_read_b64_tr_b16 a[170:171], v4 offset:34816
  v_fmac_f32 v88, v21, v24
  v_mfma_f32_16x16x32_bf16 v[160:163], a[176:179], a[112:115], v[160:163]
  v_fmac_f32 v89, v21, v25
  v_fmac_f32 v90, v21, v26
  v_mfma_f32_16x16x32_bf16 v[164:167], a[176:179], a[116:119], v[164:167]
  ds_read_b64_tr_b16 a[172:173], v4 offset:36864
  v_fmac_f32 v91, v21, v27
  v_mfma_f32_16x16x32_bf16 v[164:167], a[180:183], a[100:103], v[164:167]
  buffer_load_dwordx4 a[24:27], v1, s[8:11], s73 offen offset:1024 sc1
  v_fmac_f32 v92, v23, v24
  v_fmac_f32 v93, v23, v25
  v_mfma_f32_16x16x32_bf16 v[168:171], a[180:183], a[104:107], v[168:171]
  ds_read_b64_tr_b16 a[174:175], v4 offset:38912
  v_fmac_f32 v94, v23, v26
  v_mfma_f32_16x16x32_bf16 v[168:171], a[176:179], a[120:123], v[168:171]
  s_add_u32 s73, s73, 65536
  v_fmac_f32 v95, v23, v27
  v_mfma_f32_16x16x32_bf16 v[172:175], a[176:179], a[124:127], v[172:175]
  ds_read_b64_tr_b16 a[176:177], v4 offset:40960
  v_mfma_f32_16x16x32_bf16 v[172:175], a[180:183], a[108:111], v[172:175]
  s_waitcnt lgkmcnt(5)
  buffer_load_dwordx4 a[12:15], v1, s[8:11], s73 offen offset:0 sc1
  v_mfma_f32_16x16x32_bf16 v[188:191], a[160:163], a[108:111], v[188:191]
  ds_read_b64_tr_b16 a[178:179], v4 offset:43008
  v_mfma_f32_16x16x32_bf16 v[188:191], a[164:167], a[124:127], v[188:191]
  ds_read_b128 v[24:27], v12 offset:1344
  s_waitcnt lgkmcnt(9)
  v_mfma_f32_16x16x32_bf16 v[184:187], a[164:167], a[120:123], v[184:187]
  ds_read_b64_tr_b16 a[180:181], v4 offset:45056
  v_fmac_f32 v96, v16, v28
  v_mfma_f32_16x16x32_bf16 v[184:187], a[160:163], a[104:107], v[184:187]
  v_fmac_f32 v97, v16, v29
  v_fmac_f32 v98, v16, v30
  v_mfma_f32_16x16x32_bf16 v[180:183], a[160:163], a[100:103], v[180:183]
  ds_read_b64_tr_b16 a[182:183], v4 offset:47104
  v_fmac_f32 v99, v16, v31
  v_mfma_f32_16x16x32_bf16 v[180:183], a[164:167], a[116:119], v[180:183]
  buffer_load_dwordx4 a[28:31], v1, s[8:11], s73 offen offset:1024 sc1
  v_fmac_f32 v100, v18, v28
  v_fmac_f32 v101, v18, v29
  v_mfma_f32_16x16x32_bf16 v[176:179], a[164:167], a[112:115], v[176:179]
  ds_read_b64_tr_b16 a[164:165], v5 offset:32768
  v_fmac_f32 v102, v18, v30
  v_mfma_f32_16x16x32_bf16 v[176:179], a[160:163], a[96:99], v[176:179]
  s_waitcnt lgkmcnt(6)
  v_fmac_f32 v103, v18, v31
  v_mfma_f32_16x16x32_bf16 v[192:195], a[168:171], a[96:99], v[192:195]
  ds_read_b64_tr_b16 a[166:167], v5 offset:34816
  v_fmac_f32 v104, v20, v28
  v_mfma_f32_16x16x32_bf16 v[192:195], a[172:175], a[112:115], v[192:195]
  buffer_load_dwordx4 a[32:35], v1, s[8:11], s74 offen offset:0 sc1
  v_fmac_f32 v105, v20, v29
  v_fmac_f32 v106, v20, v30
  v_mfma_f32_16x16x32_bf16 v[196:199], a[172:175], a[116:119], v[196:199]
  ds_read_b64_tr_b16 a[160:161], v5 offset:36864
  v_fmac_f32 v107, v20, v31
  v_mfma_f32_16x16x32_bf16 v[196:199], a[168:171], a[100:103], v[196:199]
  v_fmac_f32 v108, v22, v28
  v_fmac_f32 v109, v22, v29
  v_mfma_f32_16x16x32_bf16 v[200:203], a[168:171], a[104:107], v[200:203]
  ds_read_b64_tr_b16 a[162:163], v5 offset:38912
  v_fmac_f32 v110, v22, v30
  v_mfma_f32_16x16x32_bf16 v[200:203], a[172:175], a[120:123], v[200:203]
  v_fmac_f32 v111, v22, v31
  v_mfma_f32_16x16x32_bf16 v[204:207], a[172:175], a[124:127], v[204:207]
  ds_read_b64_tr_b16 a[172:173], v5 offset:40960
  v_mfma_f32_16x16x32_bf16 v[204:207], a[168:171], a[108:111], v[204:207]
  s_waitcnt lgkmcnt(5)
  buffer_load_dwordx4 a[48:51], v1, s[8:11], s74 offen offset:1024 sc1
  v_mfma_f32_16x16x32_bf16 v[220:223], a[176:179], a[108:111], v[220:223]
  ds_read_b64_tr_b16 a[174:175], v5 offset:43008
  v_mfma_f32_16x16x32_bf16 v[220:223], a[180:183], a[124:127], v[220:223]
  s_add_u32 s74, s74, 65536
  ds_read_b128 v[28:31], v12 offset:1856
  v_mfma_f32_16x16x32_bf16 v[216:219], a[180:183], a[120:123], v[216:219]
  ds_read_b64_tr_b16 a[168:169], v5 offset:45056
  s_waitcnt lgkmcnt(10)
  v_mfma_f32_16x16x32_bf16 v[216:219], a[176:179], a[104:107], v[216:219]
  buffer_load_dwordx4 a[36:39], v1, s[8:11], s74 offen offset:0 sc1
  v_fmac_f32 v112, v16, v24
  v_fmac_f32 v113, v16, v25
  v_mfma_f32_16x16x32_bf16 v[212:215], a[176:179], a[100:103], v[212:215]
  ds_read_b64_tr_b16 a[170:171], v5 offset:47104
  v_fmac_f32 v114, v16, v26
  v_mfma_f32_16x16x32_bf16 v[212:215], a[180:183], a[116:119], v[212:215]
  s_waitcnt vmcnt(31)
  s_barrier
  v_mfma_f32_16x16x32_bf16 v[208:211], a[180:183], a[112:115], v[208:211]
  ds_read_b64_tr_b16 a[180:181], v6 offset:49152
  v_fmac_f32 v115, v16, v27
  v_mfma_f32_16x16x32_bf16 v[208:211], a[176:179], a[96:99], v[208:211]
  s_waitcnt lgkmcnt(6)
  v_fmac_f32 v116, v18, v24
  v_fmac_f32 v117, v18, v25
  v_mfma_f32_16x16x32_bf16 v[224:227], a[164:167], a[96:99], v[224:227]
  ds_read_b64_tr_b16 a[182:183], v6 offset:51200
  v_fmac_f32 v118, v18, v26
  v_mfma_f32_16x16x32_bf16 v[224:227], a[160:163], a[112:115], v[224:227]
  buffer_load_dwordx4 a[52:55], v1, s[8:11], s74 offen offset:1024 sc1
  v_fmac_f32 v119, v18, v27
  v_fmac_f32 v120, v20, v24
  v_mfma_f32_16x16x32_bf16 v[228:231], a[160:163], a[116:119], v[228:231]
  ds_read_b64_tr_b16 a[176:177], v6 offset:53248
  v_fmac_f32 v121, v20, v25
  v_mfma_f32_16x16x32_bf16 v[228:231], a[164:167], a[100:103], v[228:231]
  s_add_u32 s74, s74, 65536
  v_fmac_f32 v122, v20, v26
  v_fmac_f32 v123, v20, v27
  v_mfma_f32_16x16x32_bf16 v[232:235], a[164:167], a[104:107], v[232:235]
  ds_read_b64_tr_b16 a[178:179], v6 offset:55296
  v_fmac_f32 v124, v22, v24
  v_mfma_f32_16x16x32_bf16 v[232:235], a[160:163], a[120:123], v[232:235]
  buffer_load_dwordx4 a[40:43], v1, s[8:11], s74 offen offset:0 sc1
  v_fmac_f32 v125, v22, v25
  v_fmac_f32 v126, v22, v26
  v_mfma_f32_16x16x32_bf16 v[236:239], a[160:163], a[124:127], v[236:239]
  ds_read_b64_tr_b16 a[160:161], v6 offset:57344
  v_fmac_f32 v127, v22, v27
  v_mfma_f32_16x16x32_bf16 v[236:239], a[164:167], a[108:111], v[236:239]
  s_waitcnt lgkmcnt(5)
  ds_read_b128 v[24:27], v12 offset:1024
  v_mfma_f32_16x16x32_bf16 v[252:255], a[172:175], a[108:111], v[252:255]
  ds_read_b64_tr_b16 a[162:163], v6 offset:59392
  s_waitcnt lgkmcnt(9)
  v_mfma_f32_16x16x32_bf16 v[252:255], a[168:171], a[124:127], v[252:255]
  v_fmac_f32 v112, v17, v28
  v_fmac_f32 v113, v17, v29
  v_mfma_f32_16x16x32_bf16 v[248:251], a[168:171], a[120:123], v[248:251]
  ds_read_b64_tr_b16 a[164:165], v6 offset:61440
  v_fmac_f32 v114, v17, v30
  v_mfma_f32_16x16x32_bf16 v[248:251], a[172:175], a[104:107], v[248:251]
  buffer_load_dwordx4 a[56:59], v1, s[8:11], s74 offen offset:1024 sc1
  v_fmac_f32 v115, v17, v31
  v_fmac_f32 v116, v19, v28
  v_mfma_f32_16x16x32_bf16 v[244:247], a[172:175], a[100:103], v[244:247]
  ds_read_b64_tr_b16 a[166:167], v6 offset:63488
  v_fmac_f32 v117, v19, v29
  v_mfma_f32_16x16x32_bf16 v[244:247], a[168:171], a[116:119], v[244:247]
  s_add_u32 s74, s74, 65536
  v_fmac_f32 v118, v19, v30
  v_fmac_f32 v119, v19, v31
  v_mfma_f32_16x16x32_bf16 v[240:243], a[168:171], a[112:115], v[240:243]
  ds_read_b64_tr_b16 a[168:169], v7 offset:49152
  v_fmac_f32 v120, v21, v28
  v_mfma_f32_16x16x32_bf16 v[240:243], a[172:175], a[96:99], v[240:243]
  s_waitcnt vmcnt(26) lgkmcnt(6)
  buffer_load_dwordx4 a[44:47], v1, s[8:11], s74 offen offset:0 sc1
  v_fmac_f32 v121, v21, v29
  v_mfma_f32_16x16x32_bf16 v[64:67], a[180:183], a[128:131], v[64:67]
  ds_read_b64_tr_b16 a[170:171], v7 offset:51200
  v_fmac_f32 v122, v21, v30
  v_mfma_f32_16x16x32_bf16 v[64:67], a[176:179], a[144:147], v[64:67]
  v_fmac_f32 v123, v21, v31
  v_fmac_f32 v124, v23, v28
  v_mfma_f32_16x16x32_bf16 v[68:71], a[176:179], a[148:151], v[68:71]
  ds_read_b64_tr_b16 a[172:173], v7 offset:53248
  v_fmac_f32 v125, v23, v29
  v_mfma_f32_16x16x32_bf16 v[68:71], a[180:183], a[132:135], v[68:71]
  v_fmac_f32 v126, v23, v30
  v_fmac_f32 v127, v23, v31
  v_mfma_f32_16x16x32_bf16 v[72:75], a[180:183], a[136:139], v[72:75]
  ds_read_b64_tr_b16 a[174:175], v7 offset:55296
  v_mfma_f32_16x16x32_bf16 v[72:75], a[176:179], a[152:155], v[72:75]
  buffer_load_dwordx4 a[60:63], v1, s[8:11], s74 offen offset:1024 sc1
  ds_read_b128 v[28:31], v12 offset:1536
  v_mfma_f32_16x16x32_bf16 v[76:79], a[176:179], a[156:159], v[76:79]
  ds_read_b64_tr_b16 a[176:177], v7 offset:57344
  s_waitcnt lgkmcnt(9)
  v_mfma_f32_16x16x32_bf16 v[76:79], a[180:183], a[140:143], v[76:79]
  s_waitcnt lgkmcnt(6)
  s_mov_b32 s67, 5505024
  s_add_u32 s75, s24, 24576
  s_add_u32 m0, s45, 98304
  v_fmac_f32 v144, v16, v24
  v_mfma_f32_16x16x32_bf16 v[92:95], a[160:163], a[140:143], v[92:95]
  ds_read_b64_tr_b16 a[178:179], v7 offset:59392
  v_fmac_f32 v145, v16, v25
  v_mfma_f32_16x16x32_bf16 v[92:95], a[164:167], a[156:159], v[92:95]
  buffer_load_dwordx4 v11, s[28:31], s67 offen lds
  v_fmac_f32 v146, v16, v26
  v_fmac_f32 v147, v16, v27
  v_mfma_f32_16x16x32_bf16 v[88:91], a[164:167], a[152:155], v[88:91]
  ds_read_b64_tr_b16 a[180:181], v7 offset:61440
  v_fmac_f32 v148, v18, v24
  v_mfma_f32_16x16x32_bf16 v[88:91], a[160:163], a[136:139], v[88:91]
  v_fmac_f32 v149, v18, v25
  v_fmac_f32 v150, v18, v26
  v_mfma_f32_16x16x32_bf16 v[84:87], a[160:163], a[132:135], v[84:87]
  ds_read_b64_tr_b16 a[182:183], v7 offset:63488
  v_fmac_f32 v151, v18, v27
  v_mfma_f32_16x16x32_bf16 v[84:87], a[164:167], a[148:151], v[84:87]
  s_add_u32 m0, s45, 106496
  v_fmac_f32 v152, v20, v24
  v_fmac_f32 v153, v20, v25
  v_mfma_f32_16x16x32_bf16 v[80:83], a[164:167], a[144:147], v[80:83]
  ds_read_b64_tr_b16 a[164:165], v8 offset:49152
  v_fmac_f32 v154, v20, v26
  v_mfma_f32_16x16x32_bf16 v[80:83], a[160:163], a[128:131], v[80:83]
  s_waitcnt lgkmcnt(6)
  buffer_load_dwordx4 v11, s[32:35], s67 offen lds
  v_fmac_f32 v155, v20, v27
  v_mfma_f32_16x16x32_bf16 v[96:99], a[168:171], a[128:131], v[96:99]
  ds_read_b64_tr_b16 a[166:167], v8 offset:51200
  v_fmac_f32 v156, v22, v24
  v_mfma_f32_16x16x32_bf16 v[96:99], a[172:175], a[144:147], v[96:99]
  s_add_u32 m0, s45, 102400
  s_add_u32 s60, s67, 229376
  v_fmac_f32 v157, v22, v25
  v_mfma_f32_16x16x32_bf16 v[100:103], a[172:175], a[148:151], v[100:103]
  ds_read_b64_tr_b16 a[160:161], v8 offset:53248
  v_fmac_f32 v158, v22, v26
  v_mfma_f32_16x16x32_bf16 v[100:103], a[168:171], a[132:135], v[100:103]
  buffer_load_dwordx4 v11, s[28:31], s60 offen lds
  v_fmac_f32 v159, v22, v27
  v_mfma_f32_16x16x32_bf16 v[104:107], a[168:171], a[136:139], v[104:107]
  ds_read_b64_tr_b16 a[162:163], v8 offset:55296
  v_mfma_f32_16x16x32_bf16 v[104:107], a[172:175], a[152:155], v[104:107]
  ds_read_b128 v[24:27], v12 offset:64
  s_waitcnt lgkmcnt(9)
  v_mfma_f32_16x16x32_bf16 v[108:111], a[172:175], a[156:159], v[108:111]
  ds_read_b64_tr_b16 a[172:173], v8 offset:57344
  v_fmac_f32 v144, v17, v28
  v_mfma_f32_16x16x32_bf16 v[108:111], a[168:171], a[140:143], v[108:111]
  s_waitcnt lgkmcnt(6)
  s_add_u32 m0, s45, 110592
  s_add_u32 s60, s67, 229376
  v_mfma_f32_16x16x32_bf16 v[124:127], a[176:179], a[140:143], v[124:127]
  ds_read_b64_tr_b16 a[174:175], v8 offset:59392
  v_fmac_f32 v145, v17, v29
  v_mfma_f32_16x16x32_bf16 v[124:127], a[180:183], a[156:159], v[124:127]
  buffer_load_dwordx4 v11, s[32:35], s60 offen lds
  v_fmac_f32 v146, v17, v30
  v_fmac_f32 v147, v17, v31
  v_mfma_f32_16x16x32_bf16 v[120:123], a[180:183], a[152:155], v[120:123]
  ds_read_b64_tr_b16 a[168:169], v8 offset:61440
  v_fmac_f32 v148, v19, v28
  v_mfma_f32_16x16x32_bf16 v[120:123], a[176:179], a[136:139], v[120:123]
  v_fmac_f32 v149, v19, v29
  v_fmac_f32 v150, v19, v30
  v_mfma_f32_16x16x32_bf16 v[116:119], a[176:179], a[132:135], v[116:119]
  ds_read_b64_tr_b16 a[170:171], v8 offset:63488
  v_fmac_f32 v151, v19, v31
  v_mfma_f32_16x16x32_bf16 v[116:119], a[180:183], a[148:151], v[116:119]
  buffer_load_dwordx4 a[64:67], v1, s[8:11], s75 offen offset:0 sc1
  v_fmac_f32 v152, v21, v28
  v_fmac_f32 v153, v21, v29
  v_mfma_f32_16x16x32_bf16 v[112:115], a[180:183], a[144:147], v[112:115]
  ds_read_b64_tr_b16 a[180:181], v2 offset:49152
  v_fmac_f32 v154, v21, v30
  v_mfma_f32_16x16x32_bf16 v[112:115], a[176:179], a[128:131], v[112:115]
  s_waitcnt lgkmcnt(6)
  v_fmac_f32 v155, v21, v31
  v_fmac_f32 v156, v23, v28
  v_mfma_f32_16x16x32_bf16 v[32:35], a[164:167], a[128:131], v[32:35]
  ds_read_b64_tr_b16 a[182:183], v2 offset:51200
  v_fmac_f32 v157, v23, v29
  v_mfma_f32_16x16x32_bf16 v[32:35], a[160:163], a[144:147], v[32:35]
  v_fmac_f32 v158, v23, v30
  v_fmac_f32 v159, v23, v31
  v_mfma_f32_16x16x32_bf16 v[36:39], a[160:163], a[148:151], v[36:39]
  ds_read_b64_tr_b16 a[176:177], v2 offset:53248
  v_mfma_f32_16x16x32_bf16 v[36:39], a[164:167], a[132:135], v[36:39]
  buffer_load_dwordx4 a[80:83], v1, s[8:11], s75 offen offset:1024 sc1
  ds_read_b128 v[28:31], v12 offset:1088
  v_mfma_f32_16x16x32_bf16 v[40:43], a[164:167], a[136:139], v[40:43]
  ds_read_b64_tr_b16 a[178:179], v2 offset:55296
  s_waitcnt lgkmcnt(9)
  v_mfma_f32_16x16x32_bf16 v[40:43], a[160:163], a[152:155], v[40:43]
  s_add_u32 s75, s75, 65536
  v_fmac_f32 v160, v16, v24
  v_fmac_f32 v161, v16, v25
  v_mfma_f32_16x16x32_bf16 v[44:47], a[160:163], a[156:159], v[44:47]
  ds_read_b64_tr_b16 a[160:161], v2 offset:57344
  v_fmac_f32 v162, v16, v26
  v_mfma_f32_16x16x32_bf16 v[44:47], a[164:167], a[140:143], v[44:47]
  s_waitcnt lgkmcnt(6)
  buffer_load_dwordx4 a[68:71], v1, s[8:11], s75 offen offset:0 sc1
  v_fmac_f32 v163, v16, v27
  v_mfma_f32_16x16x32_bf16 v[60:63], a[172:175], a[140:143], v[60:63]
  ds_read_b64_tr_b16 a[162:163], v2 offset:59392
  v_fmac_f32 v164, v18, v24
  v_mfma_f32_16x16x32_bf16 v[60:63], a[168:171], a[156:159], v[60:63]
  v_fmac_f32 v165, v18, v25
  v_fmac_f32 v166, v18, v26
  v_mfma_f32_16x16x32_bf16 v[56:59], a[168:171], a[152:155], v[56:59]
  ds_read_b64_tr_b16 a[164:165], v2 offset:61440
  v_fmac_f32 v167, v18, v27
  v_mfma_f32_16x16x32_bf16 v[56:59], a[172:175], a[136:139], v[56:59]
  v_fmac_f32 v168, v20, v24
  v_fmac_f32 v169, v20, v25
  v_mfma_f32_16x16x32_bf16 v[52:55], a[172:175], a[132:135], v[52:55]
  ds_read_b64_tr_b16 a[166:167], v2 offset:63488
  v_fmac_f32 v170, v20, v26
  v_mfma_f32_16x16x32_bf16 v[52:55], a[168:171], a[148:151], v[52:55]
  buffer_load_dwordx4 a[84:87], v1, s[8:11], s75 offen offset:1024 sc1
  v_fmac_f32 v171, v20, v27
  v_fmac_f32 v172, v22, v24
  v_mfma_f32_16x16x32_bf16 v[48:51], a[168:171], a[144:147], v[48:51]
  ds_read_b64_tr_b16 a[168:169], v3 offset:49152
  v_fmac_f32 v173, v22, v25
  v_mfma_f32_16x16x32_bf16 v[48:51], a[172:175], a[128:131], v[48:51]
  s_waitcnt lgkmcnt(5)
  s_add_u32 s75, s75, 65536
  v_fmac_f32 v174, v22, v26
  v_mfma_f32_16x16x32_bf16 v[128:131], a[180:183], a[128:131], v[128:131]
  ds_read_b64_tr_b16 a[170:171], v3 offset:51200
  v_fmac_f32 v175, v22, v27
  v_mfma_f32_16x16x32_bf16 v[128:131], a[176:179], a[144:147], v[128:131]
  buffer_load_dwordx4 a[72:75], v1, s[8:11], s75 offen offset:0 sc1
  ds_read_b128 v[24:27], v12 offset:1152
  v_mfma_f32_16x16x32_bf16 v[132:135], a[176:179], a[148:151], v[132:135]
  ds_read_b64_tr_b16 a[172:173], v3 offset:53248
  s_waitcnt lgkmcnt(9)
  v_mfma_f32_16x16x32_bf16 v[132:135], a[180:183], a[132:135], v[132:135]
  v_fmac_f32 v176, v16, v28
  v_fmac_f32 v177, v16, v29
  v_mfma_f32_16x16x32_bf16 v[136:139], a[180:183], a[136:139], v[136:139]
  ds_read_b64_tr_b16 a[174:175], v3 offset:55296
  v_fmac_f32 v178, v16, v30
  v_mfma_f32_16x16x32_bf16 v[136:139], a[176:179], a[152:155], v[136:139]
  v_fmac_f32 v179, v16, v31
  v_fmac_f32 v180, v18, v28
  v_mfma_f32_16x16x32_bf16 v[140:143], a[176:179], a[156:159], v[140:143]
  ds_read_b64_tr_b16 a[176:177], v3 offset:57344
  v_fmac_f32 v181, v18, v29
  v_mfma_f32_16x16x32_bf16 v[140:143], a[180:183], a[140:143], v[140:143]
  s_waitcnt lgkmcnt(6)
  buffer_load_dwordx4 a[88:91], v1, s[8:11], s75 offen offset:1024 sc1
  v_fmac_f32 v182, v18, v30
  v_mfma_f32_16x16x32_bf16 v[156:159], a[160:163], a[140:143], v[156:159]
  ds_read_b64_tr_b16 a[178:179], v3 offset:59392
  v_fmac_f32 v183, v18, v31
  v_mfma_f32_16x16x32_bf16 v[156:159], a[164:167], a[156:159], v[156:159]
  s_add_u32 s75, s75, 65536
  v_fmac_f32 v184, v20, v28
  v_fmac_f32 v185, v20, v29
  v_mfma_f32_16x16x32_bf16 v[152:155], a[164:167], a[152:155], v[152:155]
  ds_read_b64_tr_b16 a[180:181], v3 offset:61440
  v_fmac_f32 v186, v20, v30
  v_mfma_f32_16x16x32_bf16 v[152:155], a[160:163], a[136:139], v[152:155]
  buffer_load_dwordx4 a[76:79], v1, s[8:11], s75 offen offset:0 sc1
  v_fmac_f32 v187, v20, v31
  v_fmac_f32 v188, v22, v28
  v_mfma_f32_16x16x32_bf16 v[148:151], a[160:163], a[132:135], v[148:151]
  ds_read_b64_tr_b16 a[182:183], v3 offset:63488
  v_fmac_f32 v189, v22, v29
  v_mfma_f32_16x16x32_bf16 v[148:151], a[164:167], a[148:151], v[148:151]
  v_fmac_f32 v190, v22, v30
  v_fmac_f32 v191, v22, v31
  v_mfma_f32_16x16x32_bf16 v[144:147], a[164:167], a[144:147], v[144:147]
  ds_read_b64_tr_b16 a[164:165], v4 offset:49152
  v_mfma_f32_16x16x32_bf16 v[144:147], a[160:163], a[128:131], v[144:147]
  s_waitcnt lgkmcnt(5)
  ds_read_b128 v[28:31], v12 offset:192
  v_mfma_f32_16x16x32_bf16 v[160:163], a[168:171], a[128:131], v[160:163]
  ds_read_b64_tr_b16 a[166:167], v4 offset:51200
  s_waitcnt lgkmcnt(9)
  v_mfma_f32_16x16x32_bf16 v[160:163], a[172:175], a[144:147], v[160:163]
  buffer_load_dwordx4 a[92:95], v1, s[8:11], s75 offen offset:1024 sc1
  v_fmac_f32 v208, v16, v24
  v_fmac_f32 v209, v16, v25
  v_mfma_f32_16x16x32_bf16 v[164:167], a[172:175], a[148:151], v[164:167]
  ds_read_b64_tr_b16 a[160:161], v4 offset:53248
  v_fmac_f32 v210, v16, v26
  v_mfma_f32_16x16x32_bf16 v[164:167], a[168:171], a[132:135], v[164:167]
  s_mov_b32 s68, 5963776
  s_add_u32 s76, s24, 26624
  v_fmac_f32 v211, v16, v27
  v_fmac_f32 v212, v18, v24
  v_mfma_f32_16x16x32_bf16 v[168:171], a[168:171], a[136:139], v[168:171]
HOP12:
  s_cbranch_execz HOP16
  ds_read_b64_tr_b16 a[162:163], v4 offset:55296
  v_fmac_f32 v213, v18, v25
  v_mfma_f32_16x16x32_bf16 v[168:171], a[172:175], a[152:155], v[168:171]
  buffer_load_dwordx4 a[96:99], v1, s[8:11], s76 offen offset:0 sc1
  v_fmac_f32 v214, v18, v26
  v_fmac_f32 v215, v18, v27
  v_mfma_f32_16x16x32_bf16 v[172:175], a[172:175], a[156:159], v[172:175]
  ds_read_b64_tr_b16 a[172:173], v4 offset:57344
  v_fmac_f32 v216, v20, v24
  v_mfma_f32_16x16x32_bf16 v[172:175], a[168:171], a[140:143], v[172:175]
  s_waitcnt lgkmcnt(6)
  v_fmac_f32 v217, v20, v25
  v_fmac_f32 v218, v20, v26
  v_mfma_f32_16x16x32_bf16 v[188:191], a[176:179], a[140:143], v[188:191]
  ds_read_b64_tr_b16 a[174:175], v4 offset:59392
  v_fmac_f32 v219, v20, v27
  v_mfma_f32_16x16x32_bf16 v[188:191], a[180:183], a[156:159], v[188:191]
  v_fmac_f32 v220, v22, v24
  v_fmac_f32 v221, v22, v25
  v_mfma_f32_16x16x32_bf16 v[184:187], a[180:183], a[152:155], v[184:187]
  ds_read_b64_tr_b16 a[168:169], v4 offset:61440
  v_fmac_f32 v222, v22, v26
  v_mfma_f32_16x16x32_bf16 v[184:187], a[176:179], a[136:139], v[184:187]
  buffer_load_dwordx4 a[112:115], v1, s[8:11], s76 offen offset:1024 sc1
  v_fmac_f32 v223, v22, v27
  v_mfma_f32_16x16x32_bf16 v[180:183], a[176:179], a[132:135], v[180:183]
  ds_read_b64_tr_b16 a[170:171], v4 offset:63488
  v_mfma_f32_16x16x32_bf16 v[180:183], a[180:183], a[148:151], v[180:183]
  s_add_u32 s76, s76, 65536
  ds_read_b128 v[24:27], v12 offset:1600
  v_mfma_f32_16x16x32_bf16 v[176:179], a[180:183], a[144:147], v[176:179]
  ds_read_b64_tr_b16 a[180:181], v5 offset:49152
  s_waitcnt lgkmcnt(9)
  v_mfma_f32_16x16x32_bf16 v[176:179], a[176:179], a[128:131], v[176:179]
  s_waitcnt lgkmcnt(6)
  buffer_load_dwordx4 a[100:103], v1, s[8:11], s76 offen offset:0 sc1
  v_fmac_f32 v224, v16, v28
  v_mfma_f32_16x16x32_bf16 v[192:195], a[164:167], a[128:131], v[192:195]
  ds_read_b64_tr_b16 a[182:183], v5 offset:51200
  v_fmac_f32 v225, v16, v29
  v_mfma_f32_16x16x32_bf16 v[192:195], a[160:163], a[144:147], v[192:195]
  v_fmac_f32 v226, v16, v30
  v_fmac_f32 v227, v16, v31
  v_mfma_f32_16x16x32_bf16 v[196:199], a[160:163], a[148:151], v[196:199]
  ds_read_b64_tr_b16 a[176:177], v5 offset:53248
  v_fmac_f32 v228, v18, v28
  v_mfma_f32_16x16x32_bf16 v[196:199], a[164:167], a[132:135], v[196:199]
  v_fmac_f32 v229, v18, v29
  v_fmac_f32 v230, v18, v30
  v_mfma_f32_16x16x32_bf16 v[200:203], a[164:167], a[136:139], v[200:203]
  ds_read_b64_tr_b16 a[178:179], v5 offset:55296
  v_fmac_f32 v231, v18, v31
  v_mfma_f32_16x16x32_bf16 v[200:203], a[160:163], a[152:155], v[200:203]
  buffer_load_dwordx4 a[116:119], v1, s[8:11], s76 offen offset:1024 sc1
  v_fmac_f32 v232, v20, v28
  v_fmac_f32 v233, v20, v29
  v_mfma_f32_16x16x32_bf16 v[204:207], a[160:163], a[156:159], v[204:207]
  ds_read_b64_tr_b16 a[160:161], v5 offset:57344
  v_fmac_f32 v234, v20, v30
  v_mfma_f32_16x16x32_bf16 v[204:207], a[164:167], a[140:143], v[204:207]
  s_waitcnt lgkmcnt(6)
  s_add_u32 s76, s76, 65536
  v_fmac_f32 v235, v20, v31
  v_mfma_f32_16x16x32_bf16 v[220:223], a[172:175], a[140:143], v[220:223]
  ds_read_b64_tr_b16 a[162:163], v5 offset:59392
  v_fmac_f32 v236, v22, v28
  v_mfma_f32_16x16x32_bf16 v[220:223], a[168:171], a[156:159], v[220:223]
  buffer_load_dwordx4 a[104:107], v1, s[8:11], s76 offen offset:0 sc1
  v_fmac_f32 v237, v22, v29
  v_fmac_f32 v238, v22, v30
  v_mfma_f32_16x16x32_bf16 v[216:219], a[168:171], a[152:155], v[216:219]
  ds_read_b64_tr_b16 a[164:165], v5 offset:61440
  v_fmac_f32 v239, v22, v31
  v_mfma_f32_16x16x32_bf16 v[216:219], a[172:175], a[136:139], v[216:219]
  ds_read_b128 v[28:31], v12 offset:128
  s_waitcnt lgkmcnt(8)
  v_mfma_f32_16x16x32_bf16 v[212:215], a[172:175], a[132:135], v[212:215]
  ds_read_b64_tr_b16 a[166:167], v5 offset:63488
  v_fmac_f32 v176, v17, v24
  v_mfma_f32_16x16x32_bf16 v[212:215], a[168:171], a[148:151], v[212:215]
  s_waitcnt vmcnt(33)
  s_barrier
  v_mfma_f32_16x16x32_bf16 v[208:211], a[168:171], a[144:147], v[208:211]
  ds_read_b64_tr_b16 a[168:169], v6 offset:16384
  v_fmac_f32 v177, v17, v25
  v_mfma_f32_16x16x32_bf16 v[208:211], a[172:175], a[128:131], v[208:211]
  s_waitcnt lgkmcnt(6)
  buffer_load_dwordx4 a[120:123], v1, s[8:11], s76 offen offset:1024 sc1
  v_fmac_f32 v178, v17, v26
  v_mfma_f32_16x16x32_bf16 v[224:227], a[180:183], a[128:131], v[224:227]
  ds_read_b64_tr_b16 a[170:171], v6 offset:18432
  v_fmac_f32 v179, v17, v27
  v_mfma_f32_16x16x32_bf16 v[224:227], a[176:179], a[144:147], v[224:227]
  s_add_u32 m0, s45, 114688
  v_fmac_f32 v180, v19, v24
  v_fmac_f32 v181, v19, v25
  v_mfma_f32_16x16x32_bf16 v[228:231], a[176:179], a[148:151], v[228:231]
  ds_read_b64_tr_b16 a[172:173], v6 offset:20480
  v_fmac_f32 v182, v19, v26
  v_mfma_f32_16x16x32_bf16 v[228:231], a[180:183], a[132:135], v[228:231]
  buffer_load_dwordx4 v11, s[28:31], s68 offen lds
  v_fmac_f32 v183, v19, v27
  v_fmac_f32 v184, v21, v24
  v_mfma_f32_16x16x32_bf16 v[232:235], a[180:183], a[136:139], v[232:235]
  ds_read_b64_tr_b16 a[174:175], v6 offset:22528
  v_fmac_f32 v185, v21, v25
  v_mfma_f32_16x16x32_bf16 v[232:235], a[176:179], a[152:155], v[232:235]
  v_fmac_f32 v186, v21, v26
  v_fmac_f32 v187, v21, v27
  v_mfma_f32_16x16x32_bf16 v[236:239], a[176:179], a[156:159], v[236:239]
  ds_read_b64_tr_b16 a[176:177], v6 offset:24576
  v_fmac_f32 v188, v23, v24
  v_mfma_f32_16x16x32_bf16 v[236:239], a[180:183], a[140:143], v[236:239]
  s_waitcnt lgkmcnt(5)
  s_add_u32 m0, s45, 122880
  v_fmac_f32 v189, v23, v25
  v_mfma_f32_16x16x32_bf16 v[252:255], a[160:163], a[140:143], v[252:255]
  ds_read_b64_tr_b16 a[178:179], v6 offset:26624
  v_fmac_f32 v190, v23, v26
  v_mfma_f32_16x16x32_bf16 v[252:255], a[164:167], a[156:159], v[252:255]
  buffer_load_dwordx4 v11, s[32:35], s68 offen lds
  v_fmac_f32 v191, v23, v27
  v_mfma_f32_16x16x32_bf16 v[248:251], a[164:167], a[152:155], v[248:251]
  ds_read_b64_tr_b16 a[180:181], v6 offset:28672
  v_mfma_f32_16x16x32_bf16 v[248:251], a[160:163], a[136:139], v[248:251]
  s_add_u32 m0, s45, 118784
  s_add_u32 s60, s68, 229376
  v_mfma_f32_16x16x32_bf16 v[244:247], a[160:163], a[132:135], v[244:247]
  ds_read_b64_tr_b16 a[182:183], v6 offset:30720
  v_mfma_f32_16x16x32_bf16 v[244:247], a[164:167], a[148:151], v[244:247]
  buffer_load_dwordx4 v11, s[28:31], s60 offen lds
  ds_read_b128 v[24:27], v12 offset:1664
  v_mfma_f32_16x16x32_bf16 v[240:243], a[164:167], a[144:147], v[240:243]
  ds_read_b64_tr_b16 a[164:165], v7 offset:16384
  s_waitcnt lgkmcnt(11)
  v_mfma_f32_16x16x32_bf16 v[240:243], a[160:163], a[128:131], v[240:243]
  s_waitcnt vmcnt(29) lgkmcnt(6)
  v_fmac_f32 v192, v16, v28
  v_fmac_f32 v193, v16, v29
  v_mfma_f32_16x16x32_bf16 v[64:67], a[168:171], a[0:3], v[64:67]
  ds_read_b64_tr_b16 a[166:167], v7 offset:18432
  v_fmac_f32 v194, v16, v30
  v_mfma_f32_16x16x32_bf16 v[64:67], a[172:175], a[16:19], v[64:67]
  s_add_u32 m0, s45, 126976
  s_add_u32 s60, s68, 229376
  v_fmac_f32 v195, v16, v31
  v_mfma_f32_16x16x32_bf16 v[68:71], a[172:175], a[20:23], v[68:71]
  ds_read_b64_tr_b16 a[160:161], v7 offset:20480
  v_fmac_f32 v196, v18, v28
  v_mfma_f32_16x16x32_bf16 v[68:71], a[168:171], a[4:7], v[68:71]
  buffer_load_dwordx4 v11, s[32:35], s60 offen lds
  v_fmac_f32 v197, v18, v29
  v_fmac_f32 v198, v18, v30
  v_mfma_f32_16x16x32_bf16 v[72:75], a[168:171], a[8:11], v[72:75]
  ds_read_b64_tr_b16 a[162:163], v7 offset:22528
  v_fmac_f32 v199, v18, v31
  v_mfma_f32_16x16x32_bf16 v[72:75], a[172:175], a[24:27], v[72:75]
  s_add_u32 s76, s76, 65536
  v_fmac_f32 v200, v20, v28
  v_fmac_f32 v201, v20, v29
  v_mfma_f32_16x16x32_bf16 v[76:79], a[172:175], a[28:31], v[76:79]
  ds_read_b64_tr_b16 a[172:173], v7 offset:24576
  v_fmac_f32 v202, v20, v30
  v_mfma_f32_16x16x32_bf16 v[76:79], a[168:171], a[12:15], v[76:79]
  s_waitcnt lgkmcnt(6)
  buffer_load_dwordx4 a[108:111], v1, s[8:11], s76 offen offset:0 sc1
  v_fmac_f32 v203, v20, v31
  v_mfma_f32_16x16x32_bf16 v[92:95], a[176:179], a[12:15], v[92:95]
  ds_read_b64_tr_b16 a[174:175], v7 offset:26624
  v_fmac_f32 v204, v22, v28
  v_mfma_f32_16x16x32_bf16 v[92:95], a[180:183], a[28:31], v[92:95]
  v_fmac_f32 v205, v22, v29
  v_fmac_f32 v206, v22, v30
  v_mfma_f32_16x16x32_bf16 v[88:91], a[180:183], a[24:27], v[88:91]
  ds_read_b64_tr_b16 a[168:169], v7 offset:28672
  v_fmac_f32 v207, v22, v31
  v_mfma_f32_16x16x32_bf16 v[88:91], a[176:179], a[8:11], v[88:91]
  ds_read_b128 v[28:31], v12 offset:1216
  s_waitcnt lgkmcnt(8)
  v_mfma_f32_16x16x32_bf16 v[84:87], a[176:179], a[4:7], v[84:87]
  ds_read_b64_tr_b16 a[170:171], v7 offset:30720
  v_fmac_f32 v208, v17, v24
  v_mfma_f32_16x16x32_bf16 v[84:87], a[180:183], a[20:23], v[84:87]
  buffer_load_dwordx4 a[124:127], v1, s[8:11], s76 offen offset:1024 sc1
  v_fmac_f32 v209, v17, v25
  v_fmac_f32 v210, v17, v26
  v_mfma_f32_16x16x32_bf16 v[80:83], a[180:183], a[16:19], v[80:83]
  ds_read_b64_tr_b16 a[180:181], v8 offset:16384
  v_fmac_f32 v211, v17, v27
  v_mfma_f32_16x16x32_bf16 v[80:83], a[176:179], a[0:3], v[80:83]
  s_waitcnt lgkmcnt(6)
  s_mov_b32 s69, 6422528
  s_add_u32 s77, s24, 28672
  v_fmac_f32 v212, v19, v24
  v_mfma_f32_16x16x32_bf16 v[96:99], a[164:167], a[0:3], v[96:99]
  ds_read_b64_tr_b16 a[182:183], v8 offset:18432
  v_fmac_f32 v213, v19, v25
  v_mfma_f32_16x16x32_bf16 v[96:99], a[160:163], a[16:19], v[96:99]
  buffer_load_dwordx4 a[128:131], v1, s[8:11], s77 offen offset:0 sc1
  v_fmac_f32 v214, v19, v26
  v_fmac_f32 v215, v19, v27
  v_mfma_f32_16x16x32_bf16 v[100:103], a[160:163], a[20:23], v[100:103]
  ds_read_b64_tr_b16 a[176:177], v8 offset:20480
  v_fmac_f32 v216, v21, v24
  v_mfma_f32_16x16x32_bf16 v[100:103], a[164:167], a[4:7], v[100:103]
  v_fmac_f32 v217, v21, v25
  v_fmac_f32 v218, v21, v26
  v_mfma_f32_16x16x32_bf16 v[104:107], a[164:167], a[8:11], v[104:107]
  ds_read_b64_tr_b16 a[178:179], v8 offset:22528
  v_fmac_f32 v219, v21, v27
  v_mfma_f32_16x16x32_bf16 v[104:107], a[160:163], a[24:27], v[104:107]
  v_fmac_f32 v220, v23, v24
  v_fmac_f32 v221, v23, v25
  v_mfma_f32_16x16x32_bf16 v[108:111], a[160:163], a[28:31], v[108:111]
  ds_read_b64_tr_b16 a[160:161], v8 offset:24576
  v_fmac_f32 v222, v23, v26
  v_mfma_f32_16x16x32_bf16 v[108:111], a[164:167], a[12:15], v[108:111]
  s_waitcnt lgkmcnt(5)
  buffer_load_dwordx4 a[144:147], v1, s[8:11], s77 offen offset:1024 sc1
  v_fmac_f32 v223, v23, v27
  v_mfma_f32_16x16x32_bf16 v[124:127], a[172:175], a[12:15], v[124:127]
  ds_read_b64_tr_b16 a[162:163], v8 offset:26624
  v_mfma_f32_16x16x32_bf16 v[124:127], a[168:171], a[28:31], v[124:127]
  s_add_u32 s77, s77, 65536
  ds_read_b128 v[24:27], v12 offset:1728
  v_mfma_f32_16x16x32_bf16 v[120:123], a[168:171], a[24:27], v[120:123]
  ds_read_b64_tr_b16 a[164:165], v8 offset:28672
  s_waitcnt lgkmcnt(9)
  v_mfma_f32_16x16x32_bf16 v[120:123], a[172:175], a[8:11], v[120:123]
  buffer_load_dwordx4 a[132:135], v1, s[8:11], s77 offen offset:0 sc1
  v_fmac_f32 v240, v16, v28
  v_fmac_f32 v241, v16, v29
  v_mfma_f32_16x16x32_bf16 v[116:119], a[172:175], a[4:7], v[116:119]
  ds_read_b64_tr_b16 a[166:167], v8 offset:30720
  v_fmac_f32 v242, v16, v30
  v_mfma_f32_16x16x32_bf16 v[116:119], a[168:171], a[20:23], v[116:119]
  v_fmac_f32 v243, v16, v31
  v_fmac_f32 v244, v18, v28
  v_mfma_f32_16x16x32_bf16 v[112:115], a[168:171], a[16:19], v[112:115]
  ds_read_b64_tr_b16 a[168:169], v6 offset:0
  v_fmac_f32 v245, v18, v29
  v_mfma_f32_16x16x32_bf16 v[112:115], a[172:175], a[0:3], v[112:115]
  s_waitcnt lgkmcnt(6)
  v_fmac_f32 v246, v18, v30
  v_fmac_f32 v247, v18, v31
  v_mfma_f32_16x16x32_bf16 v[32:35], a[180:183], a[0:3], v[32:35]
  ds_read_b64_tr_b16 a[170:171], v6 offset:2048
  v_fmac_f32 v248, v20, v28
  v_mfma_f32_16x16x32_bf16 v[32:35], a[176:179], a[16:19], v[32:35]
  buffer_load_dwordx4 a[148:151], v1, s[8:11], s77 offen offset:1024 sc1
  v_fmac_f32 v249, v20, v29
  v_fmac_f32 v250, v20, v30
  v_mfma_f32_16x16x32_bf16 v[36:39], a[176:179], a[20:23], v[36:39]
  ds_read_b64_tr_b16 a[172:173], v6 offset:4096
  v_fmac_f32 v251, v20, v31
  v_mfma_f32_16x16x32_bf16 v[36:39], a[180:183], a[4:7], v[36:39]
  s_add_u32 s77, s77, 65536
  v_fmac_f32 v252, v22, v28
  v_fmac_f32 v253, v22, v29
  v_mfma_f32_16x16x32_bf16 v[40:43], a[180:183], a[8:11], v[40:43]
  ds_read_b64_tr_b16 a[174:175], v6 offset:6144
  v_fmac_f32 v254, v22, v30
  v_mfma_f32_16x16x32_bf16 v[40:43], a[176:179], a[24:27], v[40:43]
  buffer_load_dwordx4 a[136:139], v1, s[8:11], s77 offen offset:0 sc1
  v_fmac_f32 v255, v22, v31
  v_mfma_f32_16x16x32_bf16 v[44:47], a[176:179], a[28:31], v[44:47]
  ds_read_b64_tr_b16 a[176:177], v6 offset:8192
  s_waitcnt lgkmcnt(7)
  v_mfma_f32_16x16x32_bf16 v[44:47], a[180:183], a[12:15], v[44:47]
  s_waitcnt lgkmcnt(5)
  v_fmac_f32 v240, v17, v24
  v_fmac_f32 v241, v17, v25
  v_mfma_f32_16x16x32_bf16 v[60:63], a[160:163], a[12:15], v[60:63]
  ds_read_b64_tr_b16 a[178:179], v6 offset:10240
  v_fmac_f32 v242, v17, v26
  v_mfma_f32_16x16x32_bf16 v[60:63], a[164:167], a[28:31], v[60:63]
  v_fmac_f32 v243, v17, v27
  v_fmac_f32 v244, v19, v24
  v_mfma_f32_16x16x32_bf16 v[56:59], a[164:167], a[24:27], v[56:59]
  ds_read_b64_tr_b16 a[180:181], v6 offset:12288
  v_fmac_f32 v245, v19, v25
  v_mfma_f32_16x16x32_bf16 v[56:59], a[160:163], a[8:11], v[56:59]
  buffer_load_dwordx4 a[152:155], v1, s[8:11], s77 offen offset:1024 sc1
  v_fmac_f32 v246, v19, v26
  v_fmac_f32 v247, v19, v27
  v_mfma_f32_16x16x32_bf16 v[52:55], a[160:163], a[4:7], v[52:55]
  ds_read_b64_tr_b16 a[182:183], v6 offset:14336
  v_fmac_f32 v248, v21, v24
  v_mfma_f32_16x16x32_bf16 v[52:55], a[164:167], a[20:23], v[52:55]
  s_add_u32 s77, s77, 65536
  v_fmac_f32 v249, v21, v25
  v_fmac_f32 v250, v21, v26
  v_mfma_f32_16x16x32_bf16 v[48:51], a[164:167], a[16:19], v[48:51]
  ds_read_b64_tr_b16 a[164:165], v7 offset:0
  v_fmac_f32 v251, v21, v27
  v_mfma_f32_16x16x32_bf16 v[48:51], a[160:163], a[0:3], v[48:51]
  s_waitcnt vmcnt(30) lgkmcnt(5)
  buffer_load_dwordx4 a[140:143], v1, s[8:11], s77 offen offset:0 sc1
  v_fmac_f32 v252, v23, v24
  v_mfma_f32_16x16x32_bf16 v[64:67], a[168:171], a[32:35], v[64:67]
  ds_read_b64_tr_b16 a[166:167], v7 offset:2048
  v_fmac_f32 v253, v23, v25
  v_mfma_f32_16x16x32_bf16 v[64:67], a[172:175], a[48:51], v[64:67]
  v_fmac_f32 v254, v23, v26
  v_fmac_f32 v255, v23, v27
  v_mfma_f32_16x16x32_bf16 v[68:71], a[172:175], a[52:55], v[68:71]
  ds_read_b64_tr_b16 a[160:161], v7 offset:4096
  v_mfma_f32_16x16x32_bf16 v[68:71], a[168:171], a[36:39], v[68:71]
  ds_read_b128 v[28:31], v12 offset:896
  v_mfma_f32_16x16x32_bf16 v[72:75], a[168:171], a[40:43], v[72:75]
  ds_read_b64_tr_b16 a[162:163], v7 offset:6144
  v_mfma_f32_16x16x32_bf16 v[72:75], a[172:175], a[56:59], v[72:75]
  buffer_load_dwordx4 a[156:159], v1, s[8:11], s77 offen offset:1024 sc1
  v_rcp_f32 v16, v17
  v_mfma_f32_16x16x32_bf16 v[76:79], a[172:175], a[60:63], v[76:79]
  ds_read_b64_tr_b16 a[172:173], v7 offset:8192
  v_mfma_f32_16x16x32_bf16 v[76:79], a[168:171], a[44:47], v[76:79]
  s_waitcnt lgkmcnt(6)
  s_mov_b32 s70, 6881280
  s_add_u32 s78, s24, 30720
  v_mfma_f32_16x16x32_bf16 v[92:95], a[176:179], a[44:47], v[92:95]
  ds_read_b64_tr_b16 a[174:175], v7 offset:10240
  v_mfma_f32_16x16x32_bf16 v[92:95], a[180:183], a[60:63], v[92:95]
  buffer_load_dwordx4 a[188:191], v1, s[8:11], s78 offen offset:0 sc1
  v_rcp_f32 v18, v19
  v_mfma_f32_16x16x32_bf16 v[88:91], a[180:183], a[56:59], v[88:91]
  ds_read_b64_tr_b16 a[168:169], v7 offset:12288
  v_mfma_f32_16x16x32_bf16 v[88:91], a[176:179], a[40:43], v[88:91]
  v_rcp_f32 v20, v21
  v_mfma_f32_16x16x32_bf16 v[84:87], a[176:179], a[36:39], v[84:87]
  ds_read_b64_tr_b16 a[170:171], v7 offset:14336
  v_mfma_f32_16x16x32_bf16 v[84:87], a[180:183], a[52:55], v[84:87]
  v_rcp_f32 v22, v23
  v_mfma_f32_16x16x32_bf16 v[80:83], a[180:183], a[48:51], v[80:83]
  ds_read_b64_tr_b16 a[180:181], v8 offset:0
  v_mul_f32 v17, 0xbfb8aa3b, v17
  v_mfma_f32_16x16x32_bf16 v[80:83], a[176:179], a[32:35], v[80:83]
  s_waitcnt lgkmcnt(5)
  buffer_load_dwordx4 a[204:207], v1, s[8:11], s78 offen offset:1024 sc1
  v_mul_f32 v19, 0xbfb8aa3b, v19
  v_mfma_f32_16x16x32_bf16 v[96:99], a[164:167], a[32:35], v[96:99]
  ds_read_b64_tr_b16 a[182:183], v8 offset:2048
  v_mul_f32 v21, 0xbfb8aa3b, v21
  v_mfma_f32_16x16x32_bf16 v[96:99], a[160:163], a[48:51], v[96:99]
  s_add_u32 s78, s78, 65536
  v_mul_f32 v23, 0xbfb8aa3b, v23
  v_mul_f32 v16, 0xbfb8aa3b, v16
  v_mfma_f32_16x16x32_bf16 v[100:103], a[160:163], a[52:55], v[100:103]
  ds_read_b64_tr_b16 a[176:177], v8 offset:4096
  v_mul_f32 v18, 0xbfb8aa3b, v18
  v_mfma_f32_16x16x32_bf16 v[100:103], a[164:167], a[36:39], v[100:103]
  buffer_load_dwordx4 a[192:195], v1, s[8:11], s78 offen offset:0 sc1
  v_mul_f32 v20, 0xbfb8aa3b, v20
  v_mul_f32 v22, 0xbfb8aa3b, v22
  v_mfma_f32_16x16x32_bf16 v[104:107], a[164:167], a[40:43], v[104:107]
  ds_read_b64_tr_b16 a[178:179], v8 offset:6144
  v_mfma_f32_16x16x32_bf16 v[104:107], a[160:163], a[56:59], v[104:107]
  v_mfma_f32_16x16x32_bf16 v[108:111], a[160:163], a[60:63], v[108:111]
  ds_read_b64_tr_b16 a[160:161], v8 offset:8192
  v_mfma_f32_16x16x32_bf16 v[108:111], a[164:167], a[44:47], v[108:111]
  s_waitcnt lgkmcnt(5)
  v_mfma_f32_16x16x32_bf16 v[124:127], a[172:175], a[44:47], v[124:127]
  ds_read_b64_tr_b16 a[162:163], v8 offset:10240
  v_mfma_f32_16x16x32_bf16 v[124:127], a[168:171], a[60:63], v[124:127]
  buffer_load_dwordx4 a[208:211], v1, s[8:11], s78 offen offset:1024 sc1
  v_mfma_f32_16x16x32_bf16 v[120:123], a[168:171], a[56:59], v[120:123]
  ds_read_b64_tr_b16 a[164:165], v8 offset:12288
  v_mfma_f32_16x16x32_bf16 v[120:123], a[172:175], a[40:43], v[120:123]
  s_add_u32 s78, s78, 65536
  v_mfma_f32_16x16x32_bf16 v[116:119], a[172:175], a[36:39], v[116:119]
  ds_read_b64_tr_b16 a[166:167], v8 offset:14336
  v_mfma_f32_16x16x32_bf16 v[116:119], a[168:171], a[52:55], v[116:119]
  buffer_load_dwordx4 a[196:199], v1, s[8:11], s78 offen offset:0 sc1
  v_mfma_f32_16x16x32_bf16 v[112:115], a[168:171], a[48:51], v[112:115]
  ds_read_b64_tr_b16 a[168:169], v2 offset:16384
  v_mfma_f32_16x16x32_bf16 v[112:115], a[172:175], a[32:35], v[112:115]
  s_waitcnt lgkmcnt(5)
  v_mfma_f32_16x16x32_bf16 v[32:35], a[180:183], a[32:35], v[32:35]
  ds_read_b64_tr_b16 a[170:171], v2 offset:18432
  v_mfma_f32_16x16x32_bf16 v[32:35], a[176:179], a[48:51], v[32:35]
  v_mfma_f32_16x16x32_bf16 v[36:39], a[176:179], a[52:55], v[36:39]
  ds_read_b64_tr_b16 a[172:173], v2 offset:20480
  v_mfma_f32_16x16x32_bf16 v[36:39], a[180:183], a[36:39], v[36:39]
  buffer_load_dwordx4 a[212:215], v1, s[8:11], s78 offen offset:1024 sc1
  v_mfma_f32_16x16x32_bf16 v[40:43], a[180:183], a[40:43], v[40:43]
  ds_read_b64_tr_b16 a[174:175], v2 offset:22528
  v_mfma_f32_16x16x32_bf16 v[40:43], a[176:179], a[56:59], v[40:43]
  s_add_u32 s78, s78, 65536
  v_mfma_f32_16x16x32_bf16 v[44:47], a[176:179], a[60:63], v[44:47]
  ds_read_b64_tr_b16 a[176:177], v2 offset:24576
  v_mfma_f32_16x16x32_bf16 v[44:47], a[180:183], a[44:47], v[44:47]
  s_waitcnt lgkmcnt(5)
  buffer_load_dwordx4 a[200:203], v1, s[8:11], s78 offen offset:0 sc1
  v_mfma_f32_16x16x32_bf16 v[60:63], a[160:163], a[44:47], v[60:63]
  ds_read_b64_tr_b16 a[178:179], v2 offset:26624
  s_barrier
  v_mfma_f32_16x16x32_bf16 v[60:63], a[164:167], a[60:63], v[60:63]
  v_mfma_f32_16x16x32_bf16 v[56:59], a[164:167], a[56:59], v[56:59]
  ds_read_b64_tr_b16 a[180:181], v2 offset:28672
  v_mfma_f32_16x16x32_bf16 v[56:59], a[160:163], a[40:43], v[56:59]
  s_add_u32 m0, s45, 81920
  v_mfma_f32_16x16x32_bf16 v[52:55], a[160:163], a[36:39], v[52:55]
  ds_read_b64_tr_b16 a[182:183], v2 offset:30720
  v_mfma_f32_16x16x32_bf16 v[52:55], a[164:167], a[52:55], v[52:55]
  buffer_load_dwordx4 v11, s[28:31], s69 offen lds
  v_mfma_f32_16x16x32_bf16 v[48:51], a[164:167], a[48:51], v[48:51]
  ds_read_b64_tr_b16 a[164:165], v3 offset:16384
  v_mfma_f32_16x16x32_bf16 v[48:51], a[160:163], a[32:35], v[48:51]
  s_waitcnt lgkmcnt(5)
  s_add_u32 m0, s45, 90112
  v_mfma_f32_16x16x32_bf16 v[128:131], a[168:171], a[0:3], v[128:131]
  ds_read_b64_tr_b16 a[166:167], v3 offset:18432
  v_mfma_f32_16x16x32_bf16 v[128:131], a[172:175], a[16:19], v[128:131]
  buffer_load_dwordx4 v11, s[32:35], s69 offen lds
  v_mfma_f32_16x16x32_bf16 v[132:135], a[172:175], a[20:23], v[132:135]
  ds_read_b64_tr_b16 a[160:161], v3 offset:20480
  v_mfma_f32_16x16x32_bf16 v[132:135], a[168:171], a[4:7], v[132:135]
  v_mfma_f32_16x16x32_bf16 v[136:139], a[168:171], a[8:11], v[136:139]
  ds_read_b64_tr_b16 a[162:163], v3 offset:22528
  v_mfma_f32_16x16x32_bf16 v[136:139], a[172:175], a[24:27], v[136:139]
  s_add_u32 m0, s45, 86016
  s_add_u32 s60, s69, 229376
  v_mfma_f32_16x16x32_bf16 v[140:143], a[172:175], a[28:31], v[140:143]
  ds_read_b64_tr_b16 a[172:173], v3 offset:24576
  v_mfma_f32_16x16x32_bf16 v[140:143], a[168:171], a[12:15], v[140:143]
  s_waitcnt lgkmcnt(5)
  buffer_load_dwordx4 v11, s[28:31], s60 offen lds
  v_mfma_f32_16x16x32_bf16 v[156:159], a[176:179], a[12:15], v[156:159]
  ds_read_b64_tr_b16 a[174:175], v3 offset:26624
  v_mfma_f32_16x16x32_bf16 v[156:159], a[180:183], a[28:31], v[156:159]
  s_add_u32 m0, s45, 94208
  s_add_u32 s60, s69, 229376
  v_mfma_f32_16x16x32_bf16 v[152:155], a[180:183], a[24:27], v[152:155]
  ds_read_b64_tr_b16 a[168:169], v3 offset:28672
  v_mfma_f32_16x16x32_bf16 v[152:155], a[176:179], a[8:11], v[152:155]
  buffer_load_dwordx4 v11, s[32:35], s60 offen lds
  v_mfma_f32_16x16x32_bf16 v[148:151], a[176:179], a[4:7], v[148:151]
  ds_read_b64_tr_b16 a[170:171], v3 offset:30720
  v_mfma_f32_16x16x32_bf16 v[148:151], a[180:183], a[20:23], v[148:151]
  v_mfma_f32_16x16x32_bf16 v[144:147], a[180:183], a[16:19], v[144:147]
  ds_read_b64_tr_b16 a[180:181], v4 offset:16384
  v_mfma_f32_16x16x32_bf16 v[144:147], a[176:179], a[0:3], v[144:147]
  s_waitcnt lgkmcnt(5)
  s_add_u32 m0, s45, 65536
  v_mfma_f32_16x16x32_bf16 v[160:163], a[164:167], a[0:3], v[160:163]
  ds_read_b64_tr_b16 a[182:183], v4 offset:18432
  v_mfma_f32_16x16x32_bf16 v[160:163], a[160:163], a[16:19], v[160:163]
  buffer_load_dwordx4 v11, s[28:31], s70 offen lds
  v_mfma_f32_16x16x32_bf16 v[164:167], a[160:163], a[20:23], v[164:167]
  ds_read_b64_tr_b16 a[176:177], v4 offset:20480
  v_mfma_f32_16x16x32_bf16 v[164:167], a[164:167], a[4:7], v[164:167]
  s_add_u32 m0, s45, 73728
  v_mfma_f32_16x16x32_bf16 v[168:171], a[164:167], a[8:11], v[168:171]
  ds_read_b64_tr_b16 a[178:179], v4 offset:22528
  v_mfma_f32_16x16x32_bf16 v[168:171], a[160:163], a[24:27], v[168:171]
  buffer_load_dwordx4 v11, s[32:35], s70 offen lds
  v_mfma_f32_16x16x32_bf16 v[172:175], a[160:163], a[28:31], v[172:175]
  ds_read_b64_tr_b16 a[160:161], v4 offset:24576
  v_mfma_f32_16x16x32_bf16 v[172:175], a[164:167], a[12:15], v[172:175]
  s_waitcnt lgkmcnt(5)
  v_mfma_f32_16x16x32_bf16 v[188:191], a[172:175], a[12:15], v[188:191]
  ds_read_b64_tr_b16 a[162:163], v4 offset:26624
  v_mfma_f32_16x16x32_bf16 v[188:191], a[168:171], a[28:31], v[188:191]
  s_add_u32 m0, s45, 69632
  s_add_u32 s60, s70, 229376
  v_mfma_f32_16x16x32_bf16 v[184:187], a[168:171], a[24:27], v[184:187]
  ds_read_b64_tr_b16 a[164:165], v4 offset:28672
  v_mfma_f32_16x16x32_bf16 v[184:187], a[172:175], a[8:11], v[184:187]
  buffer_load_dwordx4 v11, s[28:31], s60 offen lds
  v_mfma_f32_16x16x32_bf16 v[180:183], a[172:175], a[4:7], v[180:183]
  ds_read_b64_tr_b16 a[166:167], v4 offset:30720
  v_mfma_f32_16x16x32_bf16 v[180:183], a[168:171], a[20:23], v[180:183]
  s_add_u32 m0, s45, 77824
  s_add_u32 s60, s70, 229376
  v_mfma_f32_16x16x32_bf16 v[176:179], a[168:171], a[16:19], v[176:179]
  ds_read_b64_tr_b16 a[168:169], v5 offset:16384
  v_mfma_f32_16x16x32_bf16 v[176:179], a[172:175], a[0:3], v[176:179]
  s_waitcnt lgkmcnt(5)
  buffer_load_dwordx4 v11, s[32:35], s60 offen lds
  v_mfma_f32_16x16x32_bf16 v[192:195], a[180:183], a[0:3], v[192:195]
  ds_read_b64_tr_b16 a[170:171], v5 offset:18432
  v_mfma_f32_16x16x32_bf16 v[192:195], a[176:179], a[16:19], v[192:195]
  v_mfma_f32_16x16x32_bf16 v[196:199], a[176:179], a[20:23], v[196:199]
  ds_read_b64_tr_b16 a[172:173], v5 offset:20480
  v_mfma_f32_16x16x32_bf16 v[196:199], a[180:183], a[4:7], v[196:199]
  v_mfma_f32_16x16x32_bf16 v[200:203], a[180:183], a[8:11], v[200:203]
  ds_read_b64_tr_b16 a[174:175], v5 offset:22528
  v_mfma_f32_16x16x32_bf16 v[200:203], a[176:179], a[24:27], v[200:203]
  buffer_load_dwordx4 a[216:219], v1, s[8:11], s78 offen offset:1024 sc1
  v_mfma_f32_16x16x32_bf16 v[204:207], a[176:179], a[28:31], v[204:207]
  ds_read_b64_tr_b16 a[176:177], v5 offset:24576
  v_mfma_f32_16x16x32_bf16 v[204:207], a[180:183], a[12:15], v[204:207]
  s_waitcnt lgkmcnt(5)
  s_add_u32 m0, s45, 0
  v_mfma_f32_16x16x32_bf16 v[220:223], a[160:163], a[12:15], v[220:223]
  ds_read_b64_tr_b16 a[178:179], v5 offset:26624
  v_mfma_f32_16x16x32_bf16 v[220:223], a[164:167], a[28:31], v[220:223]
  buffer_load_dwordx4 v10, s[28:31], s66 offen lds
  v_mfma_f32_16x16x32_bf16 v[216:219], a[164:167], a[24:27], v[216:219]
  ds_read_b64_tr_b16 a[180:181], v5 offset:28672
  v_mfma_f32_16x16x32_bf16 v[216:219], a[160:163], a[8:11], v[216:219]
  v_mfma_f32_16x16x32_bf16 v[212:215], a[160:163], a[4:7], v[212:215]
  ds_read_b64_tr_b16 a[182:183], v5 offset:30720
  v_mfma_f32_16x16x32_bf16 v[212:215], a[164:167], a[20:23], v[212:215]
  s_waitcnt vmcnt(27)
  s_barrier
  v_mfma_f32_16x16x32_bf16 v[208:211], a[164:167], a[16:19], v[208:211]
  ds_read_b64_tr_b16 a[164:165], v8 offset:32768
  s_add_u32 m0, s45, 8192
  v_mfma_f32_16x16x32_bf16 v[208:211], a[160:163], a[0:3], v[208:211]
  s_waitcnt lgkmcnt(5)
  buffer_load_dwordx4 v10, s[32:35], s66 offen lds
  v_mfma_f32_16x16x32_bf16 v[224:227], a[168:171], a[0:3], v[224:227]
  ds_read_b64_tr_b16 a[166:167], v8 offset:34816
  v_mfma_f32_16x16x32_bf16 v[224:227], a[172:175], a[16:19], v[224:227]
  s_add_u32 m0, s45, 4096
  s_add_u32 s60, s66, 229376
  v_mfma_f32_16x16x32_bf16 v[228:231], a[172:175], a[20:23], v[228:231]
  ds_read_b64_tr_b16 a[160:161], v8 offset:36864
  v_mfma_f32_16x16x32_bf16 v[228:231], a[168:171], a[4:7], v[228:231]
  buffer_load_dwordx4 v10, s[28:31], s60 offen lds
  v_mfma_f32_16x16x32_bf16 v[232:235], a[168:171], a[8:11], v[232:235]
  ds_read_b64_tr_b16 a[162:163], v8 offset:38912
  v_mfma_f32_16x16x32_bf16 v[232:235], a[172:175], a[24:27], v[232:235]
  v_mfma_f32_16x16x32_bf16 v[236:239], a[172:175], a[28:31], v[236:239]
  ds_read_b64_tr_b16 a[172:173], v8 offset:40960
  v_mfma_f32_16x16x32_bf16 v[236:239], a[168:171], a[12:15], v[236:239]
  s_waitcnt lgkmcnt(5)
  s_add_u32 m0, s45, 12288
  s_add_u32 s60, s66, 229376
  v_mfma_f32_16x16x32_bf16 v[252:255], a[176:179], a[12:15], v[252:255]
  ds_read_b64_tr_b16 a[174:175], v8 offset:43008
  v_mfma_f32_16x16x32_bf16 v[252:255], a[180:183], a[28:31], v[252:255]
  buffer_load_dwordx4 v10, s[32:35], s60 offen lds
  v_mfma_f32_16x16x32_bf16 v[248:251], a[180:183], a[24:27], v[248:251]
  ds_read_b64_tr_b16 a[168:169], v8 offset:45056
  v_mfma_f32_16x16x32_bf16 v[248:251], a[176:179], a[8:11], v[248:251]
  s_add_u32 m0, s45, 32768
  v_mfma_f32_16x16x32_bf16 v[244:247], a[176:179], a[4:7], v[244:247]
  ds_read_b64_tr_b16 a[170:171], v8 offset:47104
  v_mfma_f32_16x16x32_bf16 v[244:247], a[180:183], a[20:23], v[244:247]
  buffer_load_dwordx4 v10, s[28:31], s67 offen lds
  v_mfma_f32_16x16x32_bf16 v[240:243], a[180:183], a[16:19], v[240:243]
  ds_read_b64_tr_b16 a[180:181], v8 offset:49152
  v_mfma_f32_16x16x32_bf16 v[240:243], a[176:179], a[0:3], v[240:243]
  s_waitcnt vmcnt(41) lgkmcnt(5)
  v_mfma_f32_16x16x32_bf16 v[32:35], a[164:167], a[64:67], v[32:35]
  ds_read_b64_tr_b16 a[182:183], v8 offset:51200
  v_mfma_f32_16x16x32_bf16 v[32:35], a[160:163], a[80:83], v[32:35]
  s_add_u32 m0, s45, 40960
  v_mfma_f32_16x16x32_bf16 v[36:39], a[160:163], a[84:87], v[36:39]
  ds_read_b64_tr_b16 a[176:177], v8 offset:53248
  v_mfma_f32_16x16x32_bf16 v[36:39], a[164:167], a[68:71], v[36:39]
  buffer_load_dwordx4 v10, s[32:35], s67 offen lds
  v_mfma_f32_16x16x32_bf16 v[40:43], a[164:167], a[72:75], v[40:43]
  ds_read_b64_tr_b16 a[178:179], v8 offset:55296
  v_mfma_f32_16x16x32_bf16 v[40:43], a[160:163], a[88:91], v[40:43]
  s_add_u32 m0, s45, 36864
  s_add_u32 s60, s67, 229376
  v_mfma_f32_16x16x32_bf16 v[44:47], a[160:163], a[92:95], v[44:47]
  ds_read_b64_tr_b16 a[160:161], v8 offset:57344
  v_mfma_f32_16x16x32_bf16 v[44:47], a[164:167], a[76:79], v[44:47]
  s_waitcnt lgkmcnt(5)
  buffer_load_dwordx4 v10, s[28:31], s60 offen lds
  v_mfma_f32_16x16x32_bf16 v[60:63], a[172:175], a[76:79], v[60:63]
  ds_read_b64_tr_b16 a[162:163], v8 offset:59392
  v_mfma_f32_16x16x32_bf16 v[60:63], a[168:171], a[92:95], v[60:63]
  s_add_u32 m0, s45, 45056
  s_add_u32 s60, s67, 229376
  v_mfma_f32_16x16x32_bf16 v[56:59], a[168:171], a[88:91], v[56:59]
  ds_read_b64_tr_b16 a[164:165], v8 offset:61440
  v_mfma_f32_16x16x32_bf16 v[56:59], a[172:175], a[72:75], v[56:59]
  buffer_load_dwordx4 v10, s[32:35], s60 offen lds
  v_mfma_f32_16x16x32_bf16 v[52:55], a[172:175], a[68:71], v[52:55]
  ds_read_b64_tr_b16 a[166:167], v8 offset:63488
  v_mfma_f32_16x16x32_bf16 v[52:55], a[168:171], a[84:87], v[52:55]
  s_waitcnt vmcnt(9)
  s_barrier
  v_mfma_f32_16x16x32_bf16 v[48:51], a[168:171], a[80:83], v[48:51]
  ds_read_b64_tr_b16 a[168:169], v8 offset:16384
  s_add_u32 m0, s45, 49152
  v_mfma_f32_16x16x32_bf16 v[48:51], a[172:175], a[64:67], v[48:51]
  s_waitcnt vmcnt(32) lgkmcnt(5)
  buffer_load_dwordx4 v10, s[28:31], s68 offen lds
  v_mfma_f32_16x16x32_bf16 v[32:35], a[180:183], a[96:99], v[32:35]
  ds_read_b64_tr_b16 a[170:171], v8 offset:18432
  v_mfma_f32_16x16x32_bf16 v[32:35], a[176:179], a[112:115], v[32:35]
  s_add_u32 m0, s45, 57344
HOP13:
  s_cbranch_execz HOP17
  v_mfma_f32_16x16x32_bf16 v[36:39], a[176:179], a[116:119], v[36:39]
  ds_read_b64_tr_b16 a[172:173], v8 offset:20480
  v_mfma_f32_16x16x32_bf16 v[36:39], a[180:183], a[100:103], v[36:39]
  buffer_load_dwordx4 v10, s[32:35], s68 offen lds
  v_mfma_f32_16x16x32_bf16 v[40:43], a[180:183], a[104:107], v[40:43]
  ds_read_b64_tr_b16 a[174:175], v8 offset:22528
  v_mfma_f32_16x16x32_bf16 v[40:43], a[176:179], a[120:123], v[40:43]
  s_add_u32 m0, s45, 53248
  s_add_u32 s60, s68, 229376
  v_mfma_f32_16x16x32_bf16 v[44:47], a[176:179], a[124:127], v[44:47]
  ds_read_b64_tr_b16 a[176:177], v8 offset:24576
  v_mfma_f32_16x16x32_bf16 v[44:47], a[180:183], a[108:111], v[44:47]
  s_waitcnt lgkmcnt(5)
  buffer_load_dwordx4 v10, s[28:31], s60 offen lds
  v_mfma_f32_16x16x32_bf16 v[60:63], a[160:163], a[108:111], v[60:63]
  ds_read_b64_tr_b16 a[178:179], v8 offset:26624
  v_mfma_f32_16x16x32_bf16 v[60:63], a[164:167], a[124:127], v[60:63]
  s_add_u32 m0, s45, 61440
  s_add_u32 s60, s68, 229376
  v_mfma_f32_16x16x32_bf16 v[56:59], a[164:167], a[120:123], v[56:59]
  ds_read_b64_tr_b16 a[180:181], v8 offset:28672
  v_mfma_f32_16x16x32_bf16 v[56:59], a[160:163], a[104:107], v[56:59]
  buffer_load_dwordx4 v10, s[32:35], s60 offen lds
  v_mfma_f32_16x16x32_bf16 v[52:55], a[160:163], a[100:103], v[52:55]
  ds_read_b64_tr_b16 a[182:183], v8 offset:30720
  v_mfma_f32_16x16x32_bf16 v[52:55], a[164:167], a[116:119], v[52:55]
  s_add_u32 m0, s45, 16384
  v_mfma_f32_16x16x32_bf16 v[48:51], a[164:167], a[112:115], v[48:51]
  ds_read_b64_tr_b16 a[164:165], v8 offset:0
  v_mfma_f32_16x16x32_bf16 v[48:51], a[160:163], a[96:99], v[48:51]
  s_waitcnt vmcnt(28) lgkmcnt(5)
  buffer_load_dwordx4 v10, s[28:31], s69 offen lds
  v_mfma_f32_16x16x32_bf16 v[32:35], a[168:171], a[128:131], v[32:35]
  ds_read_b64_tr_b16 a[166:167], v8 offset:2048
  v_mfma_f32_16x16x32_bf16 v[32:35], a[172:175], a[144:147], v[32:35]
  s_add_u32 m0, s45, 24576
  v_mfma_f32_16x16x32_bf16 v[36:39], a[172:175], a[148:151], v[36:39]
  ds_read_b64_tr_b16 a[160:161], v8 offset:4096
  v_mfma_f32_16x16x32_bf16 v[36:39], a[168:171], a[132:135], v[36:39]
  buffer_load_dwordx4 v10, s[32:35], s69 offen lds
  v_mfma_f32_16x16x32_bf16 v[40:43], a[168:171], a[136:139], v[40:43]
  ds_read_b64_tr_b16 a[162:163], v8 offset:6144
  v_mfma_f32_16x16x32_bf16 v[40:43], a[172:175], a[152:155], v[40:43]
  s_add_u32 m0, s45, 20480
  s_add_u32 s60, s69, 229376
  v_mfma_f32_16x16x32_bf16 v[44:47], a[172:175], a[156:159], v[44:47]
  ds_read_b64_tr_b16 a[172:173], v8 offset:8192
  v_mfma_f32_16x16x32_bf16 v[44:47], a[168:171], a[140:143], v[44:47]
  s_waitcnt lgkmcnt(5)
  buffer_load_dwordx4 v10, s[28:31], s60 offen lds
  v_mfma_f32_16x16x32_bf16 v[60:63], a[176:179], a[140:143], v[60:63]
  ds_read_b64_tr_b16 a[174:175], v8 offset:10240
  v_mfma_f32_16x16x32_bf16 v[60:63], a[180:183], a[156:159], v[60:63]
  s_add_u32 m0, s45, 28672
  s_add_u32 s60, s69, 229376
  v_mfma_f32_16x16x32_bf16 v[56:59], a[180:183], a[152:155], v[56:59]
  ds_read_b64_tr_b16 a[168:169], v8 offset:12288
  v_mfma_f32_16x16x32_bf16 v[56:59], a[176:179], a[136:139], v[56:59]
  buffer_load_dwordx4 v10, s[32:35], s60 offen lds
  v_mfma_f32_16x16x32_bf16 v[52:55], a[176:179], a[132:135], v[52:55]
  ds_read_b64_tr_b16 a[170:171], v8 offset:14336
  v_mfma_f32_16x16x32_bf16 v[52:55], a[180:183], a[148:151], v[52:55]
  v_mfma_f32_16x16x32_bf16 v[48:51], a[180:183], a[144:147], v[48:51]
  ds_read_b64_tr_b16 a[180:181], v6 offset:32768
  v_mfma_f32_16x16x32_bf16 v[48:51], a[176:179], a[128:131], v[48:51]
  s_waitcnt vmcnt(16) lgkmcnt(5)
  v_mfma_f32_16x16x32_bf16 v[32:35], a[164:167], a[188:191], v[32:35]
  ds_read_b64_tr_b16 a[182:183], v6 offset:34816
  v_mfma_f32_16x16x32_bf16 v[32:35], a[160:163], a[204:207], v[32:35]
  v_mfma_f32_16x16x32_bf16 v[36:39], a[160:163], a[208:211], v[36:39]
  ds_read_b64_tr_b16 a[176:177], v6 offset:36864
  v_mfma_f32_16x16x32_bf16 v[36:39], a[164:167], a[192:195], v[36:39]
  v_mfma_f32_16x16x32_bf16 v[40:43], a[164:167], a[196:199], v[40:43]
  ds_read_b64_tr_b16 a[178:179], v6 offset:38912
  v_mfma_f32_16x16x32_bf16 v[40:43], a[160:163], a[212:215], v[40:43]
  v_mfma_f32_16x16x32_bf16 v[44:47], a[160:163], a[216:219], v[44:47]
  ds_read_b64_tr_b16 a[160:161], v6 offset:40960
  v_mfma_f32_16x16x32_bf16 v[44:47], a[164:167], a[200:203], v[44:47]
  s_waitcnt lgkmcnt(5)
  v_mfma_f32_16x16x32_bf16 v[60:63], a[172:175], a[200:203], v[60:63]
  ds_read_b64_tr_b16 a[162:163], v6 offset:43008
  v_mfma_f32_16x16x32_bf16 v[60:63], a[168:171], a[216:219], v[60:63]
  v_mfma_f32_16x16x32_bf16 v[56:59], a[168:171], a[212:215], v[56:59]
  ds_read_b64_tr_b16 a[164:165], v6 offset:45056
  v_mfma_f32_16x16x32_bf16 v[56:59], a[172:175], a[196:199], v[56:59]
  v_mfma_f32_16x16x32_bf16 v[52:55], a[172:175], a[192:195], v[52:55]
  ds_read_b64_tr_b16 a[166:167], v6 offset:47104
  v_mfma_f32_16x16x32_bf16 v[52:55], a[168:171], a[208:211], v[52:55]
  v_mfma_f32_16x16x32_bf16 v[48:51], a[168:171], a[204:207], v[48:51]
  ds_read_b64_tr_b16 a[168:169], v6 offset:49152
  v_mfma_f32_16x16x32_bf16 v[48:51], a[172:175], a[188:191], v[48:51]
  s_waitcnt lgkmcnt(5)
  v_mfma_f32_16x16x32_bf16 v[64:67], a[180:183], a[64:67], v[64:67]
  ds_read_b64_tr_b16 a[170:171], v6 offset:51200
  v_mfma_f32_16x16x32_bf16 v[64:67], a[176:179], a[80:83], v[64:67]
  v_mfma_f32_16x16x32_bf16 v[68:71], a[176:179], a[84:87], v[68:71]
  ds_read_b64_tr_b16 a[172:173], v6 offset:53248
  s_waitcnt lgkmcnt(15)
  v_fma_f32 v32, v32, v16, v28
  v_mfma_f32_16x16x32_bf16 v[68:71], a[180:183], a[68:71], v[68:71]
  v_exp_f32 v24, v32
  v_fma_f32 v33, v33, v16, v29
  v_mfma_f32_16x16x32_bf16 v[72:75], a[180:183], a[72:75], v[72:75]
  ds_read_b64_tr_b16 a[174:175], v6 offset:55296
  v_exp_f32 v25, v33
  v_mfma_f32_16x16x32_bf16 v[72:75], a[176:179], a[88:91], v[72:75]
  v_fma_f32 v34, v34, v16, v30
  v_fma_f32 v35, v35, v16, v31
  v_mfma_f32_16x16x32_bf16 v[76:79], a[176:179], a[92:95], v[76:79]
  ds_read_b64_tr_b16 a[176:177], v6 offset:57344
  v_exp_f32 v26, v34
  v_mfma_f32_16x16x32_bf16 v[76:79], a[180:183], a[76:79], v[76:79]
  s_waitcnt lgkmcnt(5)
  v_exp_f32 v27, v35
  v_mul_f32 v48, v32, v48
  v_mfma_f32_16x16x32_bf16 v[92:95], a[160:163], a[76:79], v[92:95]
  ds_read_b64_tr_b16 a[178:179], v6 offset:59392
  v_mul_f32 v49, v33, v49
  v_mul_f32 v50, v34, v50
  v_mfma_f32_16x16x32_bf16 v[92:95], a[164:167], a[92:95], v[92:95]
  v_mul_f32 v51, v35, v51
  v_fma_f32 v24, v24, v17, v17
  v_fma_f32 v25, v25, v17, v17
  v_mfma_f32_16x16x32_bf16 v[88:91], a[164:167], a[88:91], v[88:91]
  ds_read_b64_tr_b16 a[180:181], v6 offset:61440
  v_fma_f32 v26, v26, v17, v17
  v_mfma_f32_16x16x32_bf16 v[88:91], a[160:163], a[72:75], v[88:91]
  v_rcp_f32 v24, v24
  v_fma_f32 v27, v27, v17, v17
  v_mfma_f32_16x16x32_bf16 v[84:87], a[160:163], a[68:71], v[84:87]
  ds_read_b64_tr_b16 a[182:183], v6 offset:63488
  v_rcp_f32 v25, v25
  v_mfma_f32_16x16x32_bf16 v[84:87], a[164:167], a[84:87], v[84:87]
  v_rcp_f32 v26, v26
  v_mul_f32 v48, v48, v24
  v_mfma_f32_16x16x32_bf16 v[80:83], a[164:167], a[80:83], v[80:83]
  ds_read_b64_tr_b16 a[164:165], v6 offset:16384
  v_rcp_f32 v27, v27
  v_mfma_f32_16x16x32_bf16 v[80:83], a[160:163], a[64:67], v[80:83]
  s_waitcnt lgkmcnt(5)
  v_mul_f32 v49, v49, v25
  v_mul_f32 v50, v50, v26
  v_mul_f32 v51, v51, v27
  v_mfma_f32_16x16x32_bf16 v[64:67], a[168:171], a[96:99], v[64:67]
  ds_read_b64_tr_b16 a[166:167], v6 offset:18432
  v_cvt_pk_bf16_f32 v32, v48, v49
  v_mfma_f32_16x16x32_bf16 v[64:67], a[172:175], a[112:115], v[64:67]
  v_cvt_pk_bf16_f32 v33, v50, v51
  v_fma_f32 v36, v36, v18, v28
  v_fma_f32 v37, v37, v18, v29
  v_mfma_f32_16x16x32_bf16 v[68:71], a[172:175], a[116:119], v[68:71]
  ds_read_b64_tr_b16 a[160:161], v6 offset:20480
  v_exp_f32 v24, v36
  v_mfma_f32_16x16x32_bf16 v[68:71], a[168:171], a[100:103], v[68:71]
  buffer_store_dwordx2 v[32:33], v1, s[8:11], s59 offen sc1
  v_mfma_f32_16x16x32_bf16 v[72:75], a[168:171], a[104:107], v[72:75]
  ds_read_b64_tr_b16 a[162:163], v6 offset:22528
  v_exp_f32 v25, v37
  v_mfma_f32_16x16x32_bf16 v[72:75], a[172:175], a[120:123], v[72:75]
  v_fma_f32 v38, v38, v18, v30
  v_fma_f32 v39, v39, v18, v31
  v_mfma_f32_16x16x32_bf16 v[76:79], a[172:175], a[124:127], v[76:79]
  ds_read_b64_tr_b16 a[172:173], v6 offset:24576
  s_bfm_b64 exec, 48, 0
  buffer_load_dword a253, v13, s[36:39], s91 offen
  s_mov_b64 exec, -1
  v_mfma_f32_16x16x32_bf16 v[76:79], a[168:171], a[108:111], v[76:79]
  s_waitcnt lgkmcnt(5)
  v_exp_f32 v26, v38
  v_mul_f32 v52, v36, v52
  v_mfma_f32_16x16x32_bf16 v[92:95], a[176:179], a[108:111], v[92:95]
  ds_read_b64_tr_b16 a[174:175], v6 offset:26624
  v_exp_f32 v27, v39
  v_mfma_f32_16x16x32_bf16 v[92:95], a[180:183], a[124:127], v[92:95]
  v_mul_f32 v53, v37, v53
  v_mul_f32 v54, v38, v54
  v_mul_f32 v55, v39, v55
  v_mfma_f32_16x16x32_bf16 v[88:91], a[180:183], a[120:123], v[88:91]
  ds_read_b64_tr_b16 a[168:169], v6 offset:28672
  v_fma_f32 v24, v24, v19, v19
  v_mfma_f32_16x16x32_bf16 v[88:91], a[176:179], a[104:107], v[88:91]
  v_rcp_f32 v24, v24
  v_fma_f32 v25, v25, v19, v19
  v_mfma_f32_16x16x32_bf16 v[84:87], a[176:179], a[100:103], v[84:87]
  ds_read_b64_tr_b16 a[170:171], v6 offset:30720
  v_rcp_f32 v25, v25
  v_mfma_f32_16x16x32_bf16 v[84:87], a[180:183], a[116:119], v[84:87]
  v_fma_f32 v26, v26, v19, v19
  v_rcp_f32 v26, v26
  v_mfma_f32_16x16x32_bf16 v[80:83], a[180:183], a[112:115], v[80:83]
  ds_read_b64_tr_b16 a[180:181], v6 offset:0
  v_fma_f32 v27, v27, v19, v19
  v_mul_f32 v52, v52, v24
  v_mfma_f32_16x16x32_bf16 v[80:83], a[176:179], a[96:99], v[80:83]
  s_waitcnt lgkmcnt(5)
  v_rcp_f32 v27, v27
  v_mul_f32 v53, v53, v25
  v_mfma_f32_16x16x32_bf16 v[64:67], a[164:167], a[128:131], v[64:67]
  ds_read_b64_tr_b16 a[182:183], v6 offset:2048
  v_mul_f32 v54, v54, v26
  v_mfma_f32_16x16x32_bf16 v[64:67], a[160:163], a[144:147], v[64:67]
  v_mul_f32 v55, v55, v27
  v_cvt_pk_bf16_f32 v36, v52, v53
  v_cvt_pk_bf16_f32 v37, v54, v55
  v_mfma_f32_16x16x32_bf16 v[68:71], a[160:163], a[148:151], v[68:71]
  ds_read_b64_tr_b16 a[176:177], v6 offset:4096
  v_fma_f32 v40, v40, v20, v28
  v_fma_f32 v41, v41, v20, v29
  v_mfma_f32_16x16x32_bf16 v[68:71], a[164:167], a[132:135], v[68:71]
  s_add_u32 s55, s59, 262144
  buffer_store_dwordx2 v[36:37], v1, s[8:11], s55 offen sc1
  v_mfma_f32_16x16x32_bf16 v[72:75], a[164:167], a[136:139], v[72:75]
  ds_read_b64_tr_b16 a[178:179], v6 offset:6144
  v_exp_f32 v24, v40
  v_mfma_f32_16x16x32_bf16 v[72:75], a[160:163], a[152:155], v[72:75]
  v_exp_f32 v25, v41
  v_mfma_f32_16x16x32_bf16 v[76:79], a[160:163], a[156:159], v[76:79]
  ds_read_b64_tr_b16 a[160:161], v6 offset:8192
  v_fma_f32 v42, v42, v20, v30
  v_fma_f32 v43, v43, v20, v31
  v_mfma_f32_16x16x32_bf16 v[76:79], a[164:167], a[140:143], v[76:79]
  s_waitcnt lgkmcnt(5)
  v_exp_f32 v26, v42
  v_mul_f32 v56, v40, v56
  v_mfma_f32_16x16x32_bf16 v[92:95], a[172:175], a[140:143], v[92:95]
  ds_read_b64_tr_b16 a[162:163], v6 offset:10240
  v_exp_f32 v27, v43
  v_mfma_f32_16x16x32_bf16 v[92:95], a[168:171], a[156:159], v[92:95]
  v_mul_f32 v57, v41, v57
  v_mul_f32 v58, v42, v58
  v_mul_f32 v59, v43, v59
  v_mfma_f32_16x16x32_bf16 v[88:91], a[168:171], a[152:155], v[88:91]
  ds_read_b64_tr_b16 a[164:165], v6 offset:12288
  v_fma_f32 v24, v24, v21, v21
  v_mfma_f32_16x16x32_bf16 v[88:91], a[172:175], a[136:139], v[88:91]
  v_rcp_f32 v24, v24
  v_fma_f32 v25, v25, v21, v21
  v_mfma_f32_16x16x32_bf16 v[84:87], a[172:175], a[132:135], v[84:87]
  ds_read_b64_tr_b16 a[166:167], v6 offset:14336
  v_rcp_f32 v25, v25
  v_mfma_f32_16x16x32_bf16 v[84:87], a[168:171], a[148:151], v[84:87]
  v_fma_f32 v26, v26, v21, v21
  v_rcp_f32 v26, v26
  v_mfma_f32_16x16x32_bf16 v[80:83], a[168:171], a[144:147], v[80:83]
  ds_read_b64_tr_b16 a[168:169], v7 offset:32768
  v_fma_f32 v27, v27, v21, v21
  v_mul_f32 v56, v56, v24
  v_mfma_f32_16x16x32_bf16 v[80:83], a[172:175], a[128:131], v[80:83]
  s_waitcnt lgkmcnt(5)
  v_rcp_f32 v27, v27
  v_mul_f32 v57, v57, v25
  v_mfma_f32_16x16x32_bf16 v[64:67], a[180:183], a[188:191], v[64:67]
  ds_read_b64_tr_b16 a[170:171], v7 offset:34816
  v_mul_f32 v58, v58, v26
  v_mfma_f32_16x16x32_bf16 v[64:67], a[176:179], a[204:207], v[64:67]
  v_mul_f32 v59, v59, v27
  v_cvt_pk_bf16_f32 v40, v56, v57
  v_cvt_pk_bf16_f32 v41, v58, v59
  v_mfma_f32_16x16x32_bf16 v[68:71], a[176:179], a[208:211], v[68:71]
  ds_read_b64_tr_b16 a[172:173], v7 offset:36864
  v_fma_f32 v44, v44, v22, v28
  v_fma_f32 v45, v45, v22, v29
  v_mfma_f32_16x16x32_bf16 v[68:71], a[180:183], a[192:195], v[68:71]
  s_add_u32 s55, s59, 524288
  buffer_store_dwordx2 v[40:41], v1, s[8:11], s55 offen sc1
  v_mfma_f32_16x16x32_bf16 v[72:75], a[180:183], a[196:199], v[72:75]
  ds_read_b64_tr_b16 a[174:175], v7 offset:38912
  v_exp_f32 v24, v44
  v_mfma_f32_16x16x32_bf16 v[72:75], a[176:179], a[212:215], v[72:75]
  v_exp_f32 v25, v45
  v_mfma_f32_16x16x32_bf16 v[76:79], a[176:179], a[216:219], v[76:79]
  ds_read_b64_tr_b16 a[176:177], v7 offset:40960
  v_fma_f32 v46, v46, v22, v30
  v_fma_f32 v47, v47, v22, v31
  v_mfma_f32_16x16x32_bf16 v[76:79], a[180:183], a[200:203], v[76:79]
  s_waitcnt lgkmcnt(5)
  v_exp_f32 v26, v46
  v_mul_f32 v60, v44, v60
  v_mfma_f32_16x16x32_bf16 v[92:95], a[160:163], a[200:203], v[92:95]
  ds_read_b64_tr_b16 a[178:179], v7 offset:43008
  v_exp_f32 v27, v47
  v_mfma_f32_16x16x32_bf16 v[92:95], a[164:167], a[216:219], v[92:95]
  v_mul_f32 v61, v45, v61
  v_mul_f32 v62, v46, v62
  v_mul_f32 v63, v47, v63
  v_mfma_f32_16x16x32_bf16 v[88:91], a[164:167], a[212:215], v[88:91]
  ds_read_b64_tr_b16 a[180:181], v7 offset:45056
  v_fma_f32 v24, v24, v23, v23
  v_mfma_f32_16x16x32_bf16 v[88:91], a[160:163], a[196:199], v[88:91]
  v_rcp_f32 v24, v24
  v_fma_f32 v25, v25, v23, v23
  v_mfma_f32_16x16x32_bf16 v[84:87], a[160:163], a[192:195], v[84:87]
  ds_read_b64_tr_b16 a[182:183], v7 offset:47104
  v_rcp_f32 v25, v25
  v_mfma_f32_16x16x32_bf16 v[84:87], a[164:167], a[208:211], v[84:87]
  v_fma_f32 v26, v26, v23, v23
  v_rcp_f32 v26, v26
  v_mfma_f32_16x16x32_bf16 v[80:83], a[164:167], a[204:207], v[80:83]
  ds_read_b64_tr_b16 a[164:165], v7 offset:49152
  v_fma_f32 v27, v27, v23, v23
  v_mul_f32 v60, v60, v24
  v_mfma_f32_16x16x32_bf16 v[80:83], a[160:163], a[188:191], v[80:83]
  s_waitcnt lgkmcnt(5)
  v_rcp_f32 v27, v27
  v_mul_f32 v61, v61, v25
  v_mfma_f32_16x16x32_bf16 v[96:99], a[168:171], a[64:67], v[96:99]
  ds_read_b64_tr_b16 a[166:167], v7 offset:51200
  v_mul_f32 v62, v62, v26
  v_mfma_f32_16x16x32_bf16 v[96:99], a[172:175], a[80:83], v[96:99]
  v_mul_f32 v63, v63, v27
  v_cvt_pk_bf16_f32 v44, v60, v61
  v_cvt_pk_bf16_f32 v45, v62, v63
  v_mfma_f32_16x16x32_bf16 v[100:103], a[172:175], a[84:87], v[100:103]
  ds_read_b64_tr_b16 a[160:161], v7 offset:53248
  ds_read_b128 v[60:63], v12 offset:768
  v_mfma_f32_16x16x32_bf16 v[100:103], a[168:171], a[68:71], v[100:103]
  s_add_u32 s55, s59, 786432
  buffer_store_dwordx2 v[44:45], v1, s[8:11], s55 offen sc1
  v_mfma_f32_16x16x32_bf16 v[104:107], a[168:171], a[72:75], v[104:107]
  ds_read_b64_tr_b16 a[162:163], v7 offset:55296
  v_mfma_f32_16x16x32_bf16 v[104:107], a[172:175], a[88:91], v[104:107]
  v_mfma_f32_16x16x32_bf16 v[108:111], a[172:175], a[92:95], v[108:111]
  ds_read_b64_tr_b16 a[172:173], v7 offset:57344
  v_mfma_f32_16x16x32_bf16 v[108:111], a[168:171], a[76:79], v[108:111]
  s_waitcnt lgkmcnt(6)
  v_mfma_f32_16x16x32_bf16 v[124:127], a[176:179], a[76:79], v[124:127]
  ds_read_b64_tr_b16 a[174:175], v7 offset:59392
  s_waitcnt lgkmcnt(3)
  v_fma_f32 v64, v64, v16, v60
  v_mfma_f32_16x16x32_bf16 v[124:127], a[180:183], a[92:95], v[124:127]
  v_exp_f32 v24, v64
  v_mfma_f32_16x16x32_bf16 v[120:123], a[180:183], a[88:91], v[120:123]
  ds_read_b64_tr_b16 a[168:169], v7 offset:61440
  v_fma_f32 v65, v65, v16, v61
  v_fma_f32 v66, v66, v16, v62
  v_mfma_f32_16x16x32_bf16 v[120:123], a[176:179], a[72:75], v[120:123]
  v_exp_f32 v25, v65
  v_mfma_f32_16x16x32_bf16 v[116:119], a[176:179], a[68:71], v[116:119]
  ds_read_b64_tr_b16 a[170:171], v7 offset:63488
  v_exp_f32 v26, v66
  v_mfma_f32_16x16x32_bf16 v[116:119], a[180:183], a[84:87], v[116:119]
  v_fma_f32 v67, v67, v16, v63
  v_fma_f32 v68, v68, v18, v60
  v_mfma_f32_16x16x32_bf16 v[112:115], a[180:183], a[80:83], v[112:115]
  ds_read_b64_tr_b16 a[180:181], v7 offset:16384
  v_exp_f32 v27, v67
  v_mfma_f32_16x16x32_bf16 v[112:115], a[176:179], a[64:67], v[112:115]
  s_waitcnt lgkmcnt(5)
  v_exp_f32 v28, v68
  v_fma_f32 v69, v69, v18, v61
  v_mfma_f32_16x16x32_bf16 v[96:99], a[164:167], a[96:99], v[96:99]
  ds_read_b64_tr_b16 a[182:183], v7 offset:18432
  v_fma_f32 v70, v70, v18, v62
  v_mfma_f32_16x16x32_bf16 v[96:99], a[160:163], a[112:115], v[96:99]
  v_exp_f32 v29, v69
  v_fma_f32 v71, v71, v18, v63
  v_mfma_f32_16x16x32_bf16 v[100:103], a[160:163], a[116:119], v[100:103]
  ds_read_b64_tr_b16 a[176:177], v7 offset:20480
  v_mul_f32 v80, v64, v80
  v_mfma_f32_16x16x32_bf16 v[100:103], a[164:167], a[100:103], v[100:103]
  v_mul_f32 v81, v65, v81
  v_mul_f32 v82, v66, v82
  v_mul_f32 v83, v67, v83
  v_mfma_f32_16x16x32_bf16 v[104:107], a[164:167], a[104:107], v[104:107]
  ds_read_b64_tr_b16 a[178:179], v7 offset:22528
  v_mul_f32 v84, v68, v84
  v_mfma_f32_16x16x32_bf16 v[104:107], a[160:163], a[120:123], v[104:107]
  v_lshrrev_b32 v48, 3, v0
  v_bfe_u32 v49, v48, 1, 2
  v_bfe_u32 v50, v0, 1, 2
  v_mfma_f32_16x16x32_bf16 v[108:111], a[160:163], a[124:127], v[108:111]
  ds_read_b64_tr_b16 a[160:161], v7 offset:24576
  v_xor_b32 v49, v49, v50
  v_mfma_f32_16x16x32_bf16 v[108:111], a[164:167], a[108:111], v[108:111]
  s_waitcnt lgkmcnt(5)
  v_lshlrev_b32 v49, 5, v49
  v_and_b32 v50, 1, v0
  v_lshl_add_u32 v49, v50, 4, v49
  v_mfma_f32_16x16x32_bf16 v[124:127], a[172:175], a[108:111], v[124:127]
  ds_read_b64_tr_b16 a[162:163], v7 offset:26624
  v_exp_f32 v30, v70
  v_mfma_f32_16x16x32_bf16 v[124:127], a[168:171], a[124:127], v[124:127]
  s_lshl_b32 s53, s44, 3
  v_exp_f32 v31, v71
  v_mfma_f32_16x16x32_bf16 v[120:123], a[168:171], a[120:123], v[120:123]
  ds_read_b64_tr_b16 a[164:165], v7 offset:28672
  v_add_u32 v48, s53, v48
  v_lshl_add_u32 v48, v48, 11, v49
  v_mfma_f32_16x16x32_bf16 v[120:123], a[172:175], a[104:107], v[120:123]
  s_mul_i32 s53, s52, 1835008
  s_lshl_b32 s54, s51, 7
  s_add_u32 s53, s53, s54
  v_mfma_f32_16x16x32_bf16 v[116:119], a[172:175], a[100:103], v[116:119]
  ds_read_b64_tr_b16 a[166:167], v7 offset:30720
  v_add_u32 v33, s53, v48
  v_xor_b32 v32, 128, v33
  v_mfma_f32_16x16x32_bf16 v[116:119], a[168:171], a[116:119], v[116:119]
  v_and_b32 v48, 3, v0
  v_bfe_u32 v49, v0, 2, 1
  v_mfma_f32_16x16x32_bf16 v[112:115], a[168:171], a[112:115], v[112:115]
  ds_read_b64_tr_b16 a[168:169], v7 offset:0
  v_lshl_add_u32 v48, v48, 3, v49
  v_lshlrev_b32 v37, 7, v48
  v_mfma_f32_16x16x32_bf16 v[112:115], a[172:175], a[96:99], v[112:115]
  s_waitcnt lgkmcnt(5)
  v_mul_f32 v85, v69, v85
  v_mul_f32 v86, v70, v86
  v_mul_f32 v87, v71, v87
  v_mfma_f32_16x16x32_bf16 v[96:99], a[180:183], a[128:131], v[96:99]
  ds_read_b64_tr_b16 a[170:171], v7 offset:2048
  v_fma_f32 v24, v24, v17, v17
  v_mfma_f32_16x16x32_bf16 v[96:99], a[176:179], a[144:147], v[96:99]
  v_rcp_f32 v24, v24
  v_fma_f32 v25, v25, v17, v17
  v_mfma_f32_16x16x32_bf16 v[100:103], a[176:179], a[148:151], v[100:103]
  ds_read_b64_tr_b16 a[172:173], v7 offset:4096
  v_fma_f32 v26, v26, v17, v17
  v_mfma_f32_16x16x32_bf16 v[100:103], a[180:183], a[132:135], v[100:103]
  v_rcp_f32 v25, v25
  v_fma_f32 v27, v27, v17, v17
  v_mfma_f32_16x16x32_bf16 v[104:107], a[180:183], a[136:139], v[104:107]
  ds_read_b64_tr_b16 a[174:175], v7 offset:6144
  v_fma_f32 v28, v28, v19, v19
  v_mfma_f32_16x16x32_bf16 v[104:107], a[176:179], a[152:155], v[104:107]
  v_rcp_f32 v26, v26
  v_fma_f32 v29, v29, v19, v19
  v_mfma_f32_16x16x32_bf16 v[108:111], a[176:179], a[156:159], v[108:111]
  ds_read_b64_tr_b16 a[176:177], v7 offset:8192
  v_fma_f32 v30, v30, v19, v19
  v_mfma_f32_16x16x32_bf16 v[108:111], a[180:183], a[140:143], v[108:111]
  s_waitcnt lgkmcnt(5)
  v_rcp_f32 v27, v27
  v_fma_f32 v31, v31, v19, v19
  v_mfma_f32_16x16x32_bf16 v[124:127], a[160:163], a[140:143], v[124:127]
  ds_read_b64_tr_b16 a[178:179], v7 offset:10240
  v_rcp_f32 v28, v28
  v_mfma_f32_16x16x32_bf16 v[124:127], a[164:167], a[156:159], v[124:127]
  v_rcp_f32 v29, v29
  v_mfma_f32_16x16x32_bf16 v[120:123], a[164:167], a[152:155], v[120:123]
  ds_read_b64_tr_b16 a[180:181], v7 offset:12288
  v_rcp_f32 v30, v30
  v_mfma_f32_16x16x32_bf16 v[120:123], a[160:163], a[136:139], v[120:123]
  v_rcp_f32 v31, v31
  v_mfma_f32_16x16x32_bf16 v[116:119], a[160:163], a[132:135], v[116:119]
  ds_read_b64_tr_b16 a[182:183], v7 offset:14336
  v_mul_f32 v80, v80, v24
  v_mul_f32 v81, v81, v25
  v_mfma_f32_16x16x32_bf16 v[116:119], a[164:167], a[148:151], v[116:119]
  s_waitcnt vmcnt(17)
  s_barrier
  v_mfma_f32_16x16x32_bf16 v[112:115], a[164:167], a[144:147], v[112:115]
  ds_read_b64_tr_b16 a[164:165], v2 offset:0
  s_add_u32 m0, s45, 98304
  v_mul_f32 v82, v82, v26
  v_mfma_f32_16x16x32_bf16 v[112:115], a[160:163], a[128:131], v[112:115]
  s_waitcnt lgkmcnt(5)
  buffer_load_dwordx4 v10, s[28:31], s70 offen lds
  v_mul_f32 v83, v83, v27
  v_mul_f32 v84, v84, v28
  v_mfma_f32_16x16x32_bf16 v[96:99], a[168:171], a[188:191], v[96:99]
  ds_read_b64_tr_b16 a[166:167], v2 offset:2048
  v_mul_f32 v85, v85, v29
  v_mfma_f32_16x16x32_bf16 v[96:99], a[172:175], a[204:207], v[96:99]
  s_add_u32 m0, s45, 106496
  v_mul_f32 v86, v86, v30
  v_mul_f32 v87, v87, v31
  v_cvt_pk_bf16_f32 v64, v80, v81
  v_mfma_f32_16x16x32_bf16 v[100:103], a[172:175], a[208:211], v[100:103]
  ds_read_b64_tr_b16 a[160:161], v2 offset:4096
  v_cvt_pk_bf16_f32 v65, v82, v83
  v_mfma_f32_16x16x32_bf16 v[100:103], a[168:171], a[192:195], v[100:103]
  buffer_load_dwordx4 v10, s[32:35], s70 offen lds
  v_cvt_pk_bf16_f32 v68, v84, v85
  v_cvt_pk_bf16_f32 v69, v86, v87
  v_fma_f32 v72, v72, v20, v60
  v_mfma_f32_16x16x32_bf16 v[104:107], a[168:171], a[196:199], v[104:107]
  ds_read_b64_tr_b16 a[162:163], v2 offset:6144
  v_fma_f32 v73, v73, v20, v61
  v_mfma_f32_16x16x32_bf16 v[104:107], a[172:175], a[212:215], v[104:107]
  s_add_u32 m0, s45, 102400
  s_add_u32 s60, s70, 229376
  v_exp_f32 v24, v72
  v_mfma_f32_16x16x32_bf16 v[108:111], a[172:175], a[216:219], v[108:111]
  ds_read_b64_tr_b16 a[172:173], v2 offset:8192
  v_fma_f32 v74, v74, v20, v62
  v_mfma_f32_16x16x32_bf16 v[108:111], a[168:171], a[200:203], v[108:111]
  s_waitcnt lgkmcnt(5)
  buffer_load_dwordx4 v10, s[28:31], s60 offen lds
  v_exp_f32 v25, v73
  v_mfma_f32_16x16x32_bf16 v[124:127], a[176:179], a[200:203], v[124:127]
  ds_read_b64_tr_b16 a[174:175], v2 offset:10240
  s_waitcnt vmcnt(8)
  s_barrier
  v_mfma_f32_16x16x32_bf16 v[124:127], a[180:183], a[216:219], v[124:127]
  s_add_u32 m0, s45, 110592
  s_add_u32 s60, s70, 229376
  v_fma_f32 v75, v75, v20, v63
  v_mfma_f32_16x16x32_bf16 v[120:123], a[180:183], a[212:215], v[120:123]
  ds_read_b64_tr_b16 a[168:169], v2 offset:12288
  v_exp_f32 v26, v74
  v_mfma_f32_16x16x32_bf16 v[120:123], a[176:179], a[196:199], v[120:123]
  buffer_load_dwordx4 v10, s[32:35], s60 offen lds
  v_exp_f32 v27, v75
  v_mfma_f32_16x16x32_bf16 v[116:119], a[176:179], a[192:195], v[116:119]
  ds_read_b64_tr_b16 a[170:171], v2 offset:14336
  v_fma_f32 v76, v76, v22, v60
  v_fma_f32 v77, v77, v22, v61
  v_mfma_f32_16x16x32_bf16 v[116:119], a[180:183], a[208:211], v[116:119]
  v_exp_f32 v28, v76
  v_mfma_f32_16x16x32_bf16 v[112:115], a[180:183], a[204:207], v[112:115]
  ds_read_b64_tr_b16 a[180:181], v3 offset:0
  v_exp_f32 v29, v77
  v_mfma_f32_16x16x32_bf16 v[112:115], a[176:179], a[188:191], v[112:115]
  s_waitcnt lgkmcnt(5)
  v_fma_f32 v78, v78, v22, v62
  v_exp_f32 v30, v78
  v_mfma_f32_16x16x32_bf16 v[128:131], a[164:167], a[32:35], v[128:131]
  ds_read_b64_tr_b16 a[182:183], v3 offset:2048
  v_fma_f32 v79, v79, v22, v63
  v_mfma_f32_16x16x32_bf16 v[128:131], a[160:163], a[48:51], v[128:131]
  v_exp_f32 v31, v79
  v_mul_f32 v88, v72, v88
  v_mfma_f32_16x16x32_bf16 v[132:135], a[160:163], a[52:55], v[132:135]
  ds_read_b64_tr_b16 a[176:177], v3 offset:4096
  v_mul_f32 v89, v73, v89
  v_mfma_f32_16x16x32_bf16 v[132:135], a[164:167], a[36:39], v[132:135]
  ds_read_b128 v[60:63], v12 offset:832
  v_mul_f32 v90, v74, v90
  v_mul_f32 v91, v75, v91
  v_mfma_f32_16x16x32_bf16 v[136:139], a[164:167], a[40:43], v[136:139]
  ds_read_b64_tr_b16 a[178:179], v3 offset:6144
  v_mul_f32 v92, v76, v92
  v_mfma_f32_16x16x32_bf16 v[136:139], a[160:163], a[56:59], v[136:139]
  v_mul_f32 v93, v77, v93
  v_mul_f32 v94, v78, v94
  v_mul_f32 v95, v79, v95
  v_mfma_f32_16x16x32_bf16 v[140:143], a[160:163], a[60:63], v[140:143]
  ds_read_b64_tr_b16 a[160:161], v3 offset:8192
  v_fma_f32 v24, v24, v21, v21
  v_mfma_f32_16x16x32_bf16 v[140:143], a[164:167], a[44:47], v[140:143]
  s_waitcnt lgkmcnt(6)
  v_rcp_f32 v24, v24
  v_fma_f32 v25, v25, v21, v21
  v_mfma_f32_16x16x32_bf16 v[156:159], a[172:175], a[44:47], v[156:159]
  ds_read_b64_tr_b16 a[162:163], v3 offset:10240
  v_rcp_f32 v25, v25
  v_mfma_f32_16x16x32_bf16 v[156:159], a[168:171], a[60:63], v[156:159]
  v_fma_f32 v26, v26, v21, v21
  v_fma_f32 v27, v27, v21, v21
  v_mfma_f32_16x16x32_bf16 v[152:155], a[168:171], a[56:59], v[152:155]
  ds_read_b64_tr_b16 a[164:165], v3 offset:12288
  v_rcp_f32 v26, v26
  v_mfma_f32_16x16x32_bf16 v[152:155], a[172:175], a[40:43], v[152:155]
  v_rcp_f32 v27, v27
  v_mfma_f32_16x16x32_bf16 v[148:151], a[172:175], a[36:39], v[148:151]
  ds_read_b64_tr_b16 a[166:167], v3 offset:14336
  v_fma_f32 v28, v28, v23, v23
  v_fma_f32 v29, v29, v23, v23
  v_mfma_f32_16x16x32_bf16 v[148:151], a[168:171], a[52:55], v[148:151]
  v_rcp_f32 v28, v28
  v_mfma_f32_16x16x32_bf16 v[144:147], a[168:171], a[48:51], v[144:147]
  ds_read_b64_tr_b16 a[168:169], v4 offset:0
  v_rcp_f32 v29, v29
  v_mfma_f32_16x16x32_bf16 v[144:147], a[172:175], a[32:35], v[144:147]
  s_waitcnt lgkmcnt(5)
  v_fma_f32 v30, v30, v23, v23
  v_rcp_f32 v30, v30
  v_mfma_f32_16x16x32_bf16 v[160:163], a[180:183], a[32:35], v[160:163]
  ds_read_b64_tr_b16 a[170:171], v4 offset:2048
  v_fma_f32 v31, v31, v23, v23
  v_mfma_f32_16x16x32_bf16 v[160:163], a[176:179], a[48:51], v[160:163]
  v_rcp_f32 v31, v31
  v_mul_f32 v88, v88, v24
  v_mfma_f32_16x16x32_bf16 v[164:167], a[176:179], a[52:55], v[164:167]
  ds_read_b64_tr_b16 a[172:173], v4 offset:4096
  v_mul_f32 v89, v89, v25
  v_mfma_f32_16x16x32_bf16 v[164:167], a[180:183], a[36:39], v[164:167]
  v_mul_f32 v90, v90, v26
  v_mul_f32 v91, v91, v27
  v_mul_f32 v92, v92, v28
  v_mfma_f32_16x16x32_bf16 v[168:171], a[180:183], a[40:43], v[168:171]
  ds_read_b64_tr_b16 a[174:175], v4 offset:6144
  v_mul_f32 v93, v93, v29
  v_mfma_f32_16x16x32_bf16 v[168:171], a[176:179], a[56:59], v[168:171]
  v_mul_f32 v94, v94, v30
  v_mul_f32 v95, v95, v31
  v_cvt_pk_bf16_f32 v72, v88, v89
  v_mfma_f32_16x16x32_bf16 v[172:175], a[176:179], a[60:63], v[172:175]
  ds_read_b64_tr_b16 a[176:177], v4 offset:8192
  v_cvt_pk_bf16_f32 v73, v90, v91
  v_mfma_f32_16x16x32_bf16 v[172:175], a[180:183], a[44:47], v[172:175]
  s_waitcnt lgkmcnt(5)
  v_cvt_pk_bf16_f32 v76, v92, v93
  v_cvt_pk_bf16_f32 v77, v94, v95
  v_mfma_f32_16x16x32_bf16 v[188:191], a[160:163], a[44:47], v[188:191]
  ds_read_b64_tr_b16 a[178:179], v4 offset:10240
  s_cmp_eq_u32 s90, 0
  s_cselect_b32 s71, 8, 1
  s_lshl_b32 s63, s71, 17
HOP14:
  s_cbranch_execz HOP18
  s_lshl_b32 s71, s71, 11
  s_add_u32 s71, s71, s83
  s_add_u32 m0, s45, 114688
  s_waitcnt lgkmcnt(11)
  v_mfma_f32_16x16x32_bf16 v[188:191], a[164:167], a[60:63], v[188:191]
  buffer_load_dwordx4 v32, s[36:39], s63 offen lds
  v_fma_f32 v96, v96, v16, v60
  v_exp_f32 v24, v96
  v_mfma_f32_16x16x32_bf16 v[184:187], a[164:167], a[56:59], v[184:187]
  ds_read_b64_tr_b16 a[180:181], v4 offset:12288
  v_fma_f32 v97, v97, v16, v61
  v_fma_f32 v98, v98, v16, v62
  v_mfma_f32_16x16x32_bf16 v[184:187], a[160:163], a[40:43], v[184:187]
  s_add_u32 m0, s45, 118784
  s_add_u32 s60, s63, 65536
  v_exp_f32 v25, v97
  v_mfma_f32_16x16x32_bf16 v[180:183], a[160:163], a[36:39], v[180:183]
  ds_read_b64_tr_b16 a[182:183], v4 offset:14336
  v_exp_f32 v26, v98
  v_mfma_f32_16x16x32_bf16 v[180:183], a[164:167], a[52:55], v[180:183]
  buffer_load_dwordx4 v32, s[36:39], s60 offen lds
  v_fma_f32 v99, v99, v16, v63
  v_exp_f32 v27, v99
  v_mfma_f32_16x16x32_bf16 v[176:179], a[164:167], a[48:51], v[176:179]
  ds_read_b64_tr_b16 a[164:165], v5 offset:0
  v_fma_f32 v100, v100, v18, v60
  v_fma_f32 v101, v101, v18, v61
  v_mfma_f32_16x16x32_bf16 v[176:179], a[160:163], a[32:35], v[176:179]
  s_waitcnt lgkmcnt(5)
  s_add_u32 m0, s45, 122880
  v_exp_f32 v28, v100
  v_mfma_f32_16x16x32_bf16 v[192:195], a[168:171], a[32:35], v[192:195]
  ds_read_b64_tr_b16 a[166:167], v5 offset:2048
  v_fma_f32 v102, v102, v18, v62
  v_mfma_f32_16x16x32_bf16 v[192:195], a[172:175], a[48:51], v[192:195]
  buffer_load_dwordx4 v33, s[36:39], s63 offen lds
  v_exp_f32 v29, v101
  v_fma_f32 v103, v103, v18, v63
  v_mfma_f32_16x16x32_bf16 v[196:199], a[172:175], a[52:55], v[196:199]
  ds_read_b64_tr_b16 a[160:161], v5 offset:4096
  v_exp_f32 v30, v102
  v_mfma_f32_16x16x32_bf16 v[196:199], a[168:171], a[36:39], v[196:199]
  s_add_u32 m0, s45, 126976
  s_add_u32 s60, s63, 65536
  v_exp_f32 v31, v103
  v_mfma_f32_16x16x32_bf16 v[200:203], a[168:171], a[40:43], v[200:203]
  ds_read_b64_tr_b16 a[162:163], v5 offset:6144
  v_mul_f32 v112, v96, v112
  v_mul_f32 v113, v97, v113
  v_mfma_f32_16x16x32_bf16 v[200:203], a[172:175], a[56:59], v[200:203]
  buffer_load_dwordx4 v33, s[36:39], s60 offen lds
  v_mul_f32 v114, v98, v114
  v_mul_f32 v115, v99, v115
  v_mul_f32 v116, v100, v116
  v_mfma_f32_16x16x32_bf16 v[204:207], a[172:175], a[60:63], v[204:207]
  ds_read_b64_tr_b16 a[172:173], v5 offset:8192
  v_mul_f32 v117, v101, v117
  v_mul_f32 v118, v102, v118
  v_mfma_f32_16x16x32_bf16 v[204:207], a[168:171], a[44:47], v[204:207]
  s_waitcnt lgkmcnt(5)
  s_cmp_eq_u32 s90, 1
  s_cselect_b32 s72, 10, 3
  s_lshl_b32 s64, s72, 17
  s_lshl_b32 s72, s72, 11
  s_add_u32 s72, s72, s83
  s_add_u32 m0, s45, 81920
  v_mul_f32 v119, v103, v119
  v_fma_f32 v24, v24, v17, v17
  v_mfma_f32_16x16x32_bf16 v[220:223], a[176:179], a[44:47], v[220:223]
  ds_read_b64_tr_b16 a[174:175], v5 offset:10240
  v_rcp_f32 v24, v24
  v_mfma_f32_16x16x32_bf16 v[220:223], a[180:183], a[60:63], v[220:223]
  buffer_load_dwordx4 v32, s[36:39], s64 offen lds
  v_fma_f32 v25, v25, v17, v17
  v_rcp_f32 v25, v25
  v_mfma_f32_16x16x32_bf16 v[216:219], a[180:183], a[56:59], v[216:219]
  ds_read_b64_tr_b16 a[168:169], v5 offset:12288
  v_fma_f32 v26, v26, v17, v17
  v_fma_f32 v27, v27, v17, v17
  v_mfma_f32_16x16x32_bf16 v[216:219], a[176:179], a[40:43], v[216:219]
  s_add_u32 m0, s45, 86016
  s_add_u32 s60, s64, 65536
  v_rcp_f32 v26, v26
  v_mfma_f32_16x16x32_bf16 v[212:215], a[176:179], a[36:39], v[212:215]
  ds_read_b64_tr_b16 a[170:171], v5 offset:14336
  v_rcp_f32 v27, v27
  v_mfma_f32_16x16x32_bf16 v[212:215], a[180:183], a[52:55], v[212:215]
  buffer_load_dwordx4 v32, s[36:39], s60 offen lds
  v_fma_f32 v28, v28, v19, v19
  v_rcp_f32 v28, v28
  v_mfma_f32_16x16x32_bf16 v[208:211], a[180:183], a[48:51], v[208:211]
  ds_read_b64_tr_b16 a[180:181], v2 offset:32768
  v_fma_f32 v29, v29, v19, v19
  v_fma_f32 v30, v30, v19, v19
  v_mfma_f32_16x16x32_bf16 v[208:211], a[176:179], a[32:35], v[208:211]
  s_waitcnt lgkmcnt(5)
  s_add_u32 m0, s45, 90112
  v_rcp_f32 v29, v29
  v_mfma_f32_16x16x32_bf16 v[224:227], a[164:167], a[32:35], v[224:227]
  ds_read_b64_tr_b16 a[182:183], v2 offset:34816
  v_fma_f32 v31, v31, v19, v19
  v_mfma_f32_16x16x32_bf16 v[224:227], a[160:163], a[48:51], v[224:227]
  buffer_load_dwordx4 v33, s[36:39], s64 offen lds
  v_rcp_f32 v30, v30
  v_mul_f32 v112, v112, v24
  v_mfma_f32_16x16x32_bf16 v[228:231], a[160:163], a[52:55], v[228:231]
  ds_read_b64_tr_b16 a[176:177], v2 offset:36864
  v_rcp_f32 v31, v31
  v_mfma_f32_16x16x32_bf16 v[228:231], a[164:167], a[36:39], v[228:231]
  s_add_u32 m0, s45, 94208
  s_add_u32 s60, s64, 65536
  v_mul_f32 v113, v113, v25
  v_mul_f32 v114, v114, v26
  v_mfma_f32_16x16x32_bf16 v[232:235], a[164:167], a[40:43], v[232:235]
  ds_read_b64_tr_b16 a[178:179], v2 offset:38912
  v_mul_f32 v115, v115, v27
  v_mul_f32 v116, v116, v28
  v_mfma_f32_16x16x32_bf16 v[232:235], a[160:163], a[56:59], v[232:235]
  buffer_load_dwordx4 v33, s[36:39], s60 offen lds
  v_mul_f32 v117, v117, v29
  v_mul_f32 v118, v118, v30
  v_mul_f32 v119, v119, v31
  v_mfma_f32_16x16x32_bf16 v[236:239], a[160:163], a[60:63], v[236:239]
  ds_read_b64_tr_b16 a[160:161], v2 offset:40960
  v_cvt_pk_bf16_f32 v66, v112, v113
  v_cvt_pk_bf16_f32 v67, v114, v115
  v_mfma_f32_16x16x32_bf16 v[236:239], a[164:167], a[44:47], v[236:239]
  s_waitcnt lgkmcnt(5)
  s_cmp_eq_u32 s90, 2
  s_cselect_b32 s73, 12, 5
  s_lshl_b32 s65, s73, 17
  s_lshl_b32 s73, s73, 11
  s_add_u32 s73, s73, s83
  s_add_u32 m0, s45, 65536
  v_cvt_pk_bf16_f32 v70, v116, v117
  v_cvt_pk_bf16_f32 v71, v118, v119
  v_mfma_f32_16x16x32_bf16 v[252:255], a[172:175], a[44:47], v[252:255]
  ds_read_b64_tr_b16 a[162:163], v2 offset:43008
  v_fma_f32 v104, v104, v20, v60
  v_fma_f32 v105, v105, v20, v61
  v_mfma_f32_16x16x32_bf16 v[252:255], a[168:171], a[60:63], v[252:255]
  buffer_load_dwordx4 v32, s[36:39], s65 offen lds
  buffer_store_dwordx4 v[64:67], v1, s[8:11], s58 offen offset:0 sc1
  v_mfma_f32_16x16x32_bf16 v[248:251], a[168:171], a[56:59], v[248:251]
  ds_read_b64_tr_b16 a[164:165], v2 offset:45056
  v_exp_f32 v24, v104
  v_mfma_f32_16x16x32_bf16 v[248:251], a[172:175], a[40:43], v[248:251]
  s_add_u32 m0, s45, 69632
  s_add_u32 s60, s65, 65536
  v_exp_f32 v25, v105
  v_mfma_f32_16x16x32_bf16 v[244:247], a[172:175], a[36:39], v[244:247]
  ds_read_b64_tr_b16 a[166:167], v2 offset:47104
  s_add_u32 s55, s58, 262144
  buffer_store_dwordx4 v[68:71], v1, s[8:11], s55 offen offset:0 sc1
  v_mfma_f32_16x16x32_bf16 v[244:247], a[168:171], a[52:55], v[244:247]
  buffer_load_dwordx4 v32, s[36:39], s60 offen lds
  v_fma_f32 v106, v106, v20, v62
  v_exp_f32 v26, v106
  v_mfma_f32_16x16x32_bf16 v[240:243], a[168:171], a[48:51], v[240:243]
  ds_read_b64_tr_b16 a[168:169], v2 offset:49152
  v_fma_f32 v107, v107, v20, v63
  v_fma_f32 v108, v108, v22, v60
  v_mfma_f32_16x16x32_bf16 v[240:243], a[172:175], a[32:35], v[240:243]
  s_waitcnt lgkmcnt(5)
  s_add_u32 m0, s45, 73728
  v_exp_f32 v27, v107
  v_mfma_f32_16x16x32_bf16 v[128:131], a[180:183], a[64:67], v[128:131]
  ds_read_b64_tr_b16 a[170:171], v2 offset:51200
  v_fma_f32 v109, v109, v22, v61
  v_mfma_f32_16x16x32_bf16 v[128:131], a[176:179], a[80:83], v[128:131]
  buffer_load_dwordx4 v33, s[36:39], s65 offen lds
  v_exp_f32 v28, v108
  v_fma_f32 v110, v110, v22, v62
  v_mfma_f32_16x16x32_bf16 v[132:135], a[176:179], a[84:87], v[132:135]
  ds_read_b64_tr_b16 a[172:173], v2 offset:53248
  v_exp_f32 v29, v109
  v_mfma_f32_16x16x32_bf16 v[132:135], a[180:183], a[68:71], v[132:135]
  s_add_u32 m0, s45, 77824
  s_add_u32 s60, s65, 65536
  v_exp_f32 v30, v110
  v_mfma_f32_16x16x32_bf16 v[136:139], a[180:183], a[72:75], v[136:139]
  ds_read_b64_tr_b16 a[174:175], v2 offset:55296
  v_fma_f32 v111, v111, v22, v63
  v_mul_f32 v120, v104, v120
  v_mfma_f32_16x16x32_bf16 v[136:139], a[176:179], a[88:91], v[136:139]
  buffer_load_dwordx4 v33, s[36:39], s60 offen lds
  v_exp_f32 v31, v111
  v_mul_f32 v121, v105, v121
  v_mfma_f32_16x16x32_bf16 v[140:143], a[176:179], a[92:95], v[140:143]
  ds_read_b64_tr_b16 a[176:177], v2 offset:57344
  ds_read_b128 v[60:63], v12 offset:512
  v_mfma_f32_16x16x32_bf16 v[140:143], a[180:183], a[76:79], v[140:143]
  s_waitcnt lgkmcnt(6)
  v_mul_f32 v122, v106, v122
  v_mul_f32 v123, v107, v123
  v_mul_f32 v124, v108, v124
  v_mfma_f32_16x16x32_bf16 v[156:159], a[160:163], a[76:79], v[156:159]
  ds_read_b64_tr_b16 a[178:179], v2 offset:59392
  v_mul_f32 v125, v109, v125
  v_mul_f32 v126, v110, v126
  v_mfma_f32_16x16x32_bf16 v[156:159], a[164:167], a[92:95], v[156:159]
  v_mul_f32 v127, v111, v127
  v_fma_f32 v24, v24, v21, v21
  v_fma_f32 v25, v25, v21, v21
  v_mfma_f32_16x16x32_bf16 v[152:155], a[164:167], a[88:91], v[152:155]
  ds_read_b64_tr_b16 a[180:181], v2 offset:61440
  v_rcp_f32 v24, v24
  v_mfma_f32_16x16x32_bf16 v[152:155], a[160:163], a[72:75], v[152:155]
  v_rcp_f32 v25, v25
  v_fma_f32 v26, v26, v21, v21
  v_mfma_f32_16x16x32_bf16 v[148:151], a[160:163], a[68:71], v[148:151]
  ds_read_b64_tr_b16 a[182:183], v2 offset:63488
  v_rcp_f32 v26, v26
  v_mfma_f32_16x16x32_bf16 v[148:151], a[164:167], a[84:87], v[148:151]
  v_fma_f32 v27, v27, v21, v21
  v_rcp_f32 v27, v27
  v_mfma_f32_16x16x32_bf16 v[144:147], a[164:167], a[80:83], v[144:147]
  ds_read_b64_tr_b16 a[164:165], v2 offset:16384
  v_fma_f32 v28, v28, v23, v23
  v_fma_f32 v29, v29, v23, v23
  v_mfma_f32_16x16x32_bf16 v[144:147], a[160:163], a[64:67], v[144:147]
  s_waitcnt lgkmcnt(6)
  v_rcp_f32 v28, v28
  v_fma_f32 v30, v30, v23, v23
  v_mfma_f32_16x16x32_bf16 v[128:131], a[168:171], a[96:99], v[128:131]
  ds_read_b64_tr_b16 a[166:167], v2 offset:18432
  v_fma_f32 v31, v31, v23, v23
  v_mfma_f32_16x16x32_bf16 v[128:131], a[172:175], a[112:115], v[128:131]
  v_rcp_f32 v29, v29
  v_mul_f32 v120, v120, v24
  v_mfma_f32_16x16x32_bf16 v[132:135], a[172:175], a[116:119], v[132:135]
  ds_read_b64_tr_b16 a[160:161], v2 offset:20480
  v_rcp_f32 v30, v30
  v_mfma_f32_16x16x32_bf16 v[132:135], a[168:171], a[100:103], v[132:135]
  v_rcp_f32 v31, v31
  v_mul_f32 v121, v121, v25
  v_mfma_f32_16x16x32_bf16 v[136:139], a[168:171], a[104:107], v[136:139]
  ds_read_b64_tr_b16 a[162:163], v2 offset:22528
  v_mul_f32 v122, v122, v26
  v_mul_f32 v123, v123, v27
  v_mfma_f32_16x16x32_bf16 v[136:139], a[172:175], a[120:123], v[136:139]
  v_mul_f32 v124, v124, v28
  v_mul_f32 v125, v125, v29
  v_mul_f32 v126, v126, v30
  v_mfma_f32_16x16x32_bf16 v[140:143], a[172:175], a[124:127], v[140:143]
  ds_read_b64_tr_b16 a[172:173], v2 offset:24576
  v_mul_f32 v127, v127, v31
  v_cvt_pk_bf16_f32 v74, v120, v121
  v_mfma_f32_16x16x32_bf16 v[140:143], a[168:171], a[108:111], v[140:143]
  s_waitcnt lgkmcnt(5)
  v_cvt_pk_bf16_f32 v75, v122, v123
  v_cvt_pk_bf16_f32 v78, v124, v125
  v_cvt_pk_bf16_f32 v79, v126, v127
  v_mfma_f32_16x16x32_bf16 v[156:159], a[176:179], a[108:111], v[156:159]
  ds_read_b64_tr_b16 a[174:175], v2 offset:26624
  v_mfma_f32_16x16x32_bf16 v[156:159], a[180:183], a[124:127], v[156:159]
  s_add_u32 s55, s58, 524288
  buffer_store_dwordx4 v[72:75], v1, s[8:11], s55 offen offset:0 sc1
  v_mfma_f32_16x16x32_bf16 v[152:155], a[180:183], a[120:123], v[152:155]
  ds_read_b64_tr_b16 a[168:169], v2 offset:28672
  v_mfma_f32_16x16x32_bf16 v[152:155], a[176:179], a[104:107], v[152:155]
  s_add_u32 s55, s58, 786432
  buffer_store_dwordx4 v[76:79], v1, s[8:11], s55 offen offset:0 sc1
  v_mfma_f32_16x16x32_bf16 v[148:151], a[176:179], a[100:103], v[148:151]
  ds_read_b64_tr_b16 a[170:171], v2 offset:30720
  v_mfma_f32_16x16x32_bf16 v[148:151], a[180:183], a[116:119], v[148:151]
  s_waitcnt vmcnt(16)
  s_barrier
  v_mfma_f32_16x16x32_bf16 v[144:147], a[180:183], a[112:115], v[144:147]
  ds_read_b64_tr_b16 a[180:181], v6 offset:32768
  s_cmp_eq_u32 s90, 0
  s_cselect_b32 s74, 1, 8
  s_lshl_b32 s66, s74, 17
  s_lshl_b32 s74, s74, 11
  s_add_u32 s74, s74, s83
  s_add_u32 m0, s45, 0
  v_mfma_f32_16x16x32_bf16 v[144:147], a[176:179], a[96:99], v[144:147]
  s_waitcnt lgkmcnt(5)
  buffer_load_dwordx4 v32, s[36:39], s66 offen lds
  v_mfma_f32_16x16x32_bf16 v[128:131], a[164:167], a[128:131], v[128:131]
  ds_read_b64_tr_b16 a[182:183], v6 offset:34816
  v_mfma_f32_16x16x32_bf16 v[128:131], a[160:163], a[144:147], v[128:131]
  s_add_u32 m0, s45, 4096
  s_add_u32 s60, s66, 65536
  v_mfma_f32_16x16x32_bf16 v[132:135], a[160:163], a[148:151], v[132:135]
  ds_read_b64_tr_b16 a[176:177], v6 offset:36864
  v_mfma_f32_16x16x32_bf16 v[132:135], a[164:167], a[132:135], v[132:135]
  buffer_load_dwordx4 v32, s[36:39], s60 offen lds
  v_mfma_f32_16x16x32_bf16 v[136:139], a[164:167], a[136:139], v[136:139]
  ds_read_b64_tr_b16 a[178:179], v6 offset:38912
  v_mfma_f32_16x16x32_bf16 v[136:139], a[160:163], a[152:155], v[136:139]
  s_add_u32 m0, s45, 8192
  v_mfma_f32_16x16x32_bf16 v[140:143], a[160:163], a[156:159], v[140:143]
  ds_read_b64_tr_b16 a[160:161], v6 offset:40960
  v_mfma_f32_16x16x32_bf16 v[140:143], a[164:167], a[140:143], v[140:143]
  s_waitcnt lgkmcnt(5)
  buffer_load_dwordx4 v33, s[36:39], s66 offen lds
  v_mfma_f32_16x16x32_bf16 v[156:159], a[172:175], a[140:143], v[156:159]
  ds_read_b64_tr_b16 a[162:163], v6 offset:43008
  v_mfma_f32_16x16x32_bf16 v[156:159], a[168:171], a[156:159], v[156:159]
  s_add_u32 m0, s45, 12288
  s_add_u32 s60, s66, 65536
  v_mfma_f32_16x16x32_bf16 v[152:155], a[168:171], a[152:155], v[152:155]
  ds_read_b64_tr_b16 a[164:165], v6 offset:45056
  v_mfma_f32_16x16x32_bf16 v[152:155], a[172:175], a[136:139], v[152:155]
  buffer_load_dwordx4 v33, s[36:39], s60 offen lds
  v_mfma_f32_16x16x32_bf16 v[148:151], a[172:175], a[132:135], v[148:151]
  ds_read_b64_tr_b16 a[166:167], v6 offset:47104
  v_mfma_f32_16x16x32_bf16 v[148:151], a[168:171], a[148:151], v[148:151]
  v_mfma_f32_16x16x32_bf16 v[144:147], a[168:171], a[144:147], v[144:147]
  ds_read_b64_tr_b16 a[168:169], v3 offset:32768
  buffer_load_dword a253, v14, s[36:39], s91 offen
  v_mfma_f32_16x16x32_bf16 v[144:147], a[172:175], a[128:131], v[144:147]
  s_waitcnt lgkmcnt(5)
  v_mfma_f32_16x16x32_bf16 v[128:131], a[180:183], a[188:191], v[128:131]
  ds_read_b64_tr_b16 a[170:171], v3 offset:34816
  v_mfma_f32_16x16x32_bf16 v[128:131], a[176:179], a[204:207], v[128:131]
  v_mfma_f32_16x16x32_bf16 v[132:135], a[176:179], a[208:211], v[132:135]
  ds_read_b64_tr_b16 a[172:173], v3 offset:36864
  v_mfma_f32_16x16x32_bf16 v[132:135], a[180:183], a[192:195], v[132:135]
  v_mfma_f32_16x16x32_bf16 v[136:139], a[180:183], a[196:199], v[136:139]
  ds_read_b64_tr_b16 a[174:175], v3 offset:38912
  v_mfma_f32_16x16x32_bf16 v[136:139], a[176:179], a[212:215], v[136:139]
  v_mfma_f32_16x16x32_bf16 v[140:143], a[176:179], a[216:219], v[140:143]
  ds_read_b64_tr_b16 a[176:177], v3 offset:40960
  v_mfma_f32_16x16x32_bf16 v[140:143], a[180:183], a[200:203], v[140:143]
  s_waitcnt lgkmcnt(5)
  v_mfma_f32_16x16x32_bf16 v[156:159], a[160:163], a[200:203], v[156:159]
  ds_read_b64_tr_b16 a[178:179], v3 offset:43008
  v_mfma_f32_16x16x32_bf16 v[156:159], a[164:167], a[216:219], v[156:159]
  v_mfma_f32_16x16x32_bf16 v[152:155], a[164:167], a[212:215], v[152:155]
  ds_read_b64_tr_b16 a[180:181], v3 offset:45056
  v_mfma_f32_16x16x32_bf16 v[152:155], a[160:163], a[196:199], v[152:155]
  v_mfma_f32_16x16x32_bf16 v[148:151], a[160:163], a[192:195], v[148:151]
  ds_read_b64_tr_b16 a[182:183], v3 offset:47104
  v_mfma_f32_16x16x32_bf16 v[148:151], a[164:167], a[208:211], v[148:151]
  v_mfma_f32_16x16x32_bf16 v[144:147], a[164:167], a[204:207], v[144:147]
  ds_read_b64_tr_b16 a[164:165], v3 offset:49152
  v_mfma_f32_16x16x32_bf16 v[144:147], a[160:163], a[188:191], v[144:147]
  s_waitcnt lgkmcnt(5)
  v_mfma_f32_16x16x32_bf16 v[160:163], a[168:171], a[64:67], v[160:163]
  ds_read_b64_tr_b16 a[166:167], v3 offset:51200
  v_mfma_f32_16x16x32_bf16 v[160:163], a[172:175], a[80:83], v[160:163]
  v_mfma_f32_16x16x32_bf16 v[164:167], a[172:175], a[84:87], v[164:167]
  ds_read_b64_tr_b16 a[160:161], v3 offset:53248
  s_waitcnt lgkmcnt(15)
  v_mfma_f32_16x16x32_bf16 v[164:167], a[168:171], a[68:71], v[164:167]
  v_fma_f32 v128, v128, v16, v60
  v_fma_f32 v129, v129, v16, v61
  v_mfma_f32_16x16x32_bf16 v[168:171], a[168:171], a[72:75], v[168:171]
  ds_read_b64_tr_b16 a[162:163], v3 offset:55296
  v_fma_f32 v130, v130, v16, v62
  v_mfma_f32_16x16x32_bf16 v[168:171], a[172:175], a[88:91], v[168:171]
  v_exp_f32 v24, v128
  v_mfma_f32_16x16x32_bf16 v[172:175], a[172:175], a[92:95], v[172:175]
  ds_read_b64_tr_b16 a[172:173], v3 offset:57344
  v_fma_f32 v131, v131, v16, v63
  v_mfma_f32_16x16x32_bf16 v[172:175], a[168:171], a[76:79], v[172:175]
  s_waitcnt lgkmcnt(5)
  v_exp_f32 v25, v129
  v_mfma_f32_16x16x32_bf16 v[188:191], a[176:179], a[76:79], v[188:191]
  ds_read_b64_tr_b16 a[174:175], v3 offset:59392
  v_fma_f32 v132, v132, v18, v60
  v_mfma_f32_16x16x32_bf16 v[188:191], a[180:183], a[92:95], v[188:191]
  v_exp_f32 v26, v130
  v_mfma_f32_16x16x32_bf16 v[184:187], a[180:183], a[88:91], v[184:187]
  ds_read_b64_tr_b16 a[168:169], v3 offset:61440
  v_fma_f32 v133, v133, v18, v61
  v_mfma_f32_16x16x32_bf16 v[184:187], a[176:179], a[72:75], v[184:187]
  v_exp_f32 v27, v131
  v_mfma_f32_16x16x32_bf16 v[180:183], a[176:179], a[68:71], v[180:183]
  ds_read_b64_tr_b16 a[170:171], v3 offset:63488
  v_fma_f32 v134, v134, v18, v62
  v_mfma_f32_16x16x32_bf16 v[180:183], a[180:183], a[84:87], v[180:183]
  v_exp_f32 v28, v132
  v_mfma_f32_16x16x32_bf16 v[176:179], a[180:183], a[80:83], v[176:179]
  ds_read_b64_tr_b16 a[180:181], v3 offset:16384
  v_fma_f32 v135, v135, v18, v63
  v_mfma_f32_16x16x32_bf16 v[176:179], a[176:179], a[64:67], v[176:179]
  s_waitcnt lgkmcnt(5)
  v_exp_f32 v29, v133
  v_mul_f32 v144, v128, v144
  v_mfma_f32_16x16x32_bf16 v[160:163], a[164:167], a[96:99], v[160:163]
  ds_read_b64_tr_b16 a[182:183], v3 offset:18432
  v_mul_f32 v145, v129, v145
  v_mfma_f32_16x16x32_bf16 v[160:163], a[160:163], a[112:115], v[160:163]
  v_exp_f32 v30, v134
  v_mfma_f32_16x16x32_bf16 v[164:167], a[160:163], a[116:119], v[164:167]
  ds_read_b64_tr_b16 a[176:177], v3 offset:20480
  v_mul_f32 v146, v130, v146
  v_mfma_f32_16x16x32_bf16 v[164:167], a[164:167], a[100:103], v[164:167]
  v_exp_f32 v31, v135
  v_mfma_f32_16x16x32_bf16 v[168:171], a[164:167], a[104:107], v[168:171]
  ds_read_b64_tr_b16 a[178:179], v3 offset:22528
  v_add_u32 v38, s46, v0
  s_waitcnt vmcnt(5)
  s_barrier
  s_mov_b64 exec, 1
  buffer_store_dword v38, v0, s[8:11], s79 offen offset:0 sc1
  s_mov_b64 exec, -1
  v_mfma_f32_16x16x32_bf16 v[168:171], a[160:163], a[120:123], v[168:171]
  v_mul_f32 v147, v131, v147
  v_mul_f32 v148, v132, v148
  v_mfma_f32_16x16x32_bf16 v[172:175], a[160:163], a[124:127], v[172:175]
  ds_read_b64_tr_b16 a[160:161], v3 offset:24576
  v_mul_f32 v149, v133, v149
  v_mfma_f32_16x16x32_bf16 v[172:175], a[164:167], a[108:111], v[172:175]
  s_waitcnt lgkmcnt(5)
  v_mul_f32 v150, v134, v150
  v_mul_f32 v151, v135, v151
  v_mfma_f32_16x16x32_bf16 v[188:191], a[172:175], a[108:111], v[188:191]
  ds_read_b64_tr_b16 a[162:163], v3 offset:26624
  v_fma_f32 v24, v24, v17, v17
  v_mfma_f32_16x16x32_bf16 v[188:191], a[168:171], a[124:127], v[188:191]
  v_rcp_f32 v24, v24
  v_mfma_f32_16x16x32_bf16 v[184:187], a[168:171], a[120:123], v[184:187]
  ds_read_b64_tr_b16 a[164:165], v3 offset:28672
  v_fma_f32 v25, v25, v17, v17
  v_mfma_f32_16x16x32_bf16 v[184:187], a[172:175], a[104:107], v[184:187]
  v_rcp_f32 v25, v25
  v_mfma_f32_16x16x32_bf16 v[180:183], a[172:175], a[100:103], v[180:183]
  ds_read_b64_tr_b16 a[166:167], v3 offset:30720
  v_fma_f32 v26, v26, v17, v17
  v_mfma_f32_16x16x32_bf16 v[180:183], a[168:171], a[116:119], v[180:183]
  v_rcp_f32 v26, v26
  v_mfma_f32_16x16x32_bf16 v[176:179], a[168:171], a[112:115], v[176:179]
  ds_read_b64_tr_b16 a[168:169], v7 offset:32768
  v_fma_f32 v27, v27, v17, v17
  v_mfma_f32_16x16x32_bf16 v[176:179], a[172:175], a[96:99], v[176:179]
  s_waitcnt lgkmcnt(5)
  v_rcp_f32 v27, v27
  v_fma_f32 v28, v28, v19, v19
  v_mfma_f32_16x16x32_bf16 v[160:163], a[180:183], a[128:131], v[160:163]
  ds_read_b64_tr_b16 a[170:171], v7 offset:34816
  v_fma_f32 v29, v29, v19, v19
  v_mfma_f32_16x16x32_bf16 v[160:163], a[176:179], a[144:147], v[160:163]
  v_rcp_f32 v28, v28
  v_mfma_f32_16x16x32_bf16 v[164:167], a[176:179], a[148:151], v[164:167]
  ds_read_b64_tr_b16 a[172:173], v7 offset:36864
  v_fma_f32 v30, v30, v19, v19
  v_mfma_f32_16x16x32_bf16 v[164:167], a[180:183], a[132:135], v[164:167]
  v_rcp_f32 v29, v29
  v_mfma_f32_16x16x32_bf16 v[168:171], a[180:183], a[136:139], v[168:171]
  ds_read_b64_tr_b16 a[174:175], v7 offset:38912
  v_fma_f32 v31, v31, v19, v19
  v_mfma_f32_16x16x32_bf16 v[168:171], a[176:179], a[152:155], v[168:171]
  v_rcp_f32 v30, v30
  v_mfma_f32_16x16x32_bf16 v[172:175], a[176:179], a[156:159], v[172:175]
  ds_read_b64_tr_b16 a[176:177], v7 offset:40960
  v_mul_f32 v144, v144, v24
  v_mfma_f32_16x16x32_bf16 v[172:175], a[180:183], a[140:143], v[172:175]
  s_waitcnt lgkmcnt(5)
  v_rcp_f32 v31, v31
  v_mfma_f32_16x16x32_bf16 v[188:191], a[160:163], a[140:143], v[188:191]
  ds_read_b64_tr_b16 a[178:179], v7 offset:43008
  v_mul_f32 v145, v145, v25
  v_mfma_f32_16x16x32_bf16 v[188:191], a[164:167], a[156:159], v[188:191]
  v_mul_f32 v146, v146, v26
  v_mul_f32 v147, v147, v27
  v_mfma_f32_16x16x32_bf16 v[184:187], a[164:167], a[152:155], v[184:187]
  ds_read_b64_tr_b16 a[180:181], v7 offset:45056
  v_mul_f32 v148, v148, v28
  v_mfma_f32_16x16x32_bf16 v[184:187], a[160:163], a[136:139], v[184:187]
  v_mul_f32 v149, v149, v29
  v_mul_f32 v150, v150, v30
  v_mfma_f32_16x16x32_bf16 v[180:183], a[160:163], a[132:135], v[180:183]
  ds_read_b64_tr_b16 a[182:183], v7 offset:47104
  v_mul_f32 v151, v151, v31
  v_mfma_f32_16x16x32_bf16 v[180:183], a[164:167], a[148:151], v[180:183]
  v_cvt_pk_bf16_f32 v128, v144, v145
  v_cvt_pk_bf16_f32 v129, v146, v147
  v_mfma_f32_16x16x32_bf16 v[176:179], a[164:167], a[144:147], v[176:179]
  ds_read_b64_tr_b16 a[164:165], v4 offset:32768
  v_cvt_pk_bf16_f32 v132, v148, v149
  v_mfma_f32_16x16x32_bf16 v[176:179], a[160:163], a[128:131], v[176:179]
  s_waitcnt lgkmcnt(5)
  v_cvt_pk_bf16_f32 v133, v150, v151
  v_fma_f32 v136, v136, v20, v60
  v_fma_f32 v137, v137, v20, v61
  v_mfma_f32_16x16x32_bf16 v[160:163], a[168:171], a[188:191], v[160:163]
  ds_read_b64_tr_b16 a[166:167], v4 offset:34816
  v_fma_f32 v138, v138, v20, v62
  v_mfma_f32_16x16x32_bf16 v[160:163], a[172:175], a[204:207], v[160:163]
  v_exp_f32 v24, v136
  v_mfma_f32_16x16x32_bf16 v[164:167], a[172:175], a[208:211], v[164:167]
  ds_read_b64_tr_b16 a[160:161], v4 offset:36864
  v_fma_f32 v139, v139, v20, v63
  v_mfma_f32_16x16x32_bf16 v[164:167], a[168:171], a[192:195], v[164:167]
  v_exp_f32 v25, v137
  v_mfma_f32_16x16x32_bf16 v[168:171], a[168:171], a[196:199], v[168:171]
  ds_read_b64_tr_b16 a[162:163], v4 offset:38912
  v_fma_f32 v140, v140, v22, v60
  v_mfma_f32_16x16x32_bf16 v[168:171], a[172:175], a[212:215], v[168:171]
  v_exp_f32 v26, v138
  v_mfma_f32_16x16x32_bf16 v[172:175], a[172:175], a[216:219], v[172:175]
  ds_read_b64_tr_b16 a[172:173], v4 offset:40960
  v_fma_f32 v141, v141, v22, v61
  v_mfma_f32_16x16x32_bf16 v[172:175], a[168:171], a[200:203], v[172:175]
  s_waitcnt lgkmcnt(5)
  v_exp_f32 v27, v139
  v_mfma_f32_16x16x32_bf16 v[188:191], a[176:179], a[200:203], v[188:191]
  ds_read_b64_tr_b16 a[174:175], v4 offset:43008
  v_fma_f32 v142, v142, v22, v62
  v_mfma_f32_16x16x32_bf16 v[188:191], a[180:183], a[216:219], v[188:191]
  v_exp_f32 v28, v140
  v_mfma_f32_16x16x32_bf16 v[184:187], a[180:183], a[212:215], v[184:187]
  ds_read_b64_tr_b16 a[168:169], v4 offset:45056
  v_fma_f32 v143, v143, v22, v63
  v_mfma_f32_16x16x32_bf16 v[184:187], a[176:179], a[196:199], v[184:187]
  v_exp_f32 v29, v141
  v_mfma_f32_16x16x32_bf16 v[180:183], a[176:179], a[192:195], v[180:183]
  ds_read_b64_tr_b16 a[170:171], v4 offset:47104
  v_mul_f32 v152, v136, v152
  v_mfma_f32_16x16x32_bf16 v[180:183], a[180:183], a[208:211], v[180:183]
  v_exp_f32 v30, v142
  v_mfma_f32_16x16x32_bf16 v[176:179], a[180:183], a[204:207], v[176:179]
  ds_read_b64_tr_b16 a[180:181], v4 offset:49152
  v_mul_f32 v153, v137, v153
  v_mfma_f32_16x16x32_bf16 v[176:179], a[176:179], a[188:191], v[176:179]
  s_waitcnt lgkmcnt(5)
  v_exp_f32 v31, v143
  v_mul_f32 v154, v138, v154
  v_mfma_f32_16x16x32_bf16 v[192:195], a[164:167], a[64:67], v[192:195]
  ds_read_b64_tr_b16 a[182:183], v4 offset:51200
  ds_read_b128 v[60:63], v12 offset:576
  v_mfma_f32_16x16x32_bf16 v[192:195], a[160:163], a[80:83], v[192:195]
  v_mul_f32 v155, v139, v155
  v_mul_f32 v156, v140, v156
  v_mfma_f32_16x16x32_bf16 v[196:199], a[160:163], a[84:87], v[196:199]
  ds_read_b64_tr_b16 a[176:177], v4 offset:53248
  v_mul_f32 v157, v141, v157
  v_mfma_f32_16x16x32_bf16 v[196:199], a[164:167], a[68:71], v[196:199]
  v_mul_f32 v158, v142, v158
  v_mul_f32 v159, v143, v159
  v_mfma_f32_16x16x32_bf16 v[200:203], a[164:167], a[72:75], v[200:203]
  ds_read_b64_tr_b16 a[178:179], v4 offset:55296
  v_fma_f32 v24, v24, v21, v21
  v_mfma_f32_16x16x32_bf16 v[200:203], a[160:163], a[88:91], v[200:203]
  v_rcp_f32 v24, v24
  v_mfma_f32_16x16x32_bf16 v[204:207], a[160:163], a[92:95], v[204:207]
  ds_read_b64_tr_b16 a[160:161], v4 offset:57344
  v_fma_f32 v25, v25, v21, v21
  v_mfma_f32_16x16x32_bf16 v[204:207], a[164:167], a[76:79], v[204:207]
  s_waitcnt lgkmcnt(6)
  v_rcp_f32 v25, v25
  v_mfma_f32_16x16x32_bf16 v[220:223], a[172:175], a[76:79], v[220:223]
  ds_read_b64_tr_b16 a[162:163], v4 offset:59392
  v_fma_f32 v26, v26, v21, v21
  v_mfma_f32_16x16x32_bf16 v[220:223], a[168:171], a[92:95], v[220:223]
  v_rcp_f32 v26, v26
  v_mfma_f32_16x16x32_bf16 v[216:219], a[168:171], a[88:91], v[216:219]
  ds_read_b64_tr_b16 a[164:165], v4 offset:61440
  v_fma_f32 v27, v27, v21, v21
  v_mfma_f32_16x16x32_bf16 v[216:219], a[172:175], a[72:75], v[216:219]
  v_rcp_f32 v27, v27
  v_mfma_f32_16x16x32_bf16 v[212:215], a[172:175], a[68:71], v[212:215]
  ds_read_b64_tr_b16 a[166:167], v4 offset:63488
  v_fma_f32 v28, v28, v23, v23
  v_mfma_f32_16x16x32_bf16 v[212:215], a[168:171], a[84:87], v[212:215]
  v_rcp_f32 v28, v28
  v_mfma_f32_16x16x32_bf16 v[208:211], a[168:171], a[80:83], v[208:211]
  ds_read_b64_tr_b16 a[168:169], v4 offset:16384
  v_fma_f32 v29, v29, v23, v23
  v_mfma_f32_16x16x32_bf16 v[208:211], a[172:175], a[64:67], v[208:211]
  s_waitcnt lgkmcnt(5)
  v_rcp_f32 v29, v29
  v_fma_f32 v30, v30, v23, v23
  v_mfma_f32_16x16x32_bf16 v[192:195], a[180:183], a[96:99], v[192:195]
  ds_read_b64_tr_b16 a[170:171], v4 offset:18432
  v_fma_f32 v31, v31, v23, v23
  v_mfma_f32_16x16x32_bf16 v[192:195], a[176:179], a[112:115], v[192:195]
  v_rcp_f32 v30, v30
  v_mfma_f32_16x16x32_bf16 v[196:199], a[176:179], a[116:119], v[196:199]
  ds_read_b64_tr_b16 a[172:173], v4 offset:20480
  v_mul_f32 v152, v152, v24
  v_mfma_f32_16x16x32_bf16 v[196:199], a[180:183], a[100:103], v[196:199]
  v_rcp_f32 v31, v31
  v_mfma_f32_16x16x32_bf16 v[200:203], a[180:183], a[104:107], v[200:203]
  ds_read_b64_tr_b16 a[174:175], v4 offset:22528
  v_mul_f32 v153, v153, v25
  v_mfma_f32_16x16x32_bf16 v[200:203], a[176:179], a[120:123], v[200:203]
  v_mul_f32 v154, v154, v26
  v_mul_f32 v155, v155, v27
  v_mfma_f32_16x16x32_bf16 v[204:207], a[176:179], a[124:127], v[204:207]
  ds_read_b64_tr_b16 a[176:177], v4 offset:24576
  v_mul_f32 v156, v156, v28
  v_mfma_f32_16x16x32_bf16 v[204:207], a[180:183], a[108:111], v[204:207]
  s_waitcnt lgkmcnt(5)
  v_mul_f32 v157, v157, v29
  v_mul_f32 v158, v158, v30
  v_mfma_f32_16x16x32_bf16 v[220:223], a[160:163], a[108:111], v[220:223]
  ds_read_b64_tr_b16 a[178:179], v4 offset:26624
  v_mul_f32 v159, v159, v31
  v_mfma_f32_16x16x32_bf16 v[220:223], a[164:167], a[124:127], v[220:223]
  v_cvt_pk_bf16_f32 v136, v152, v153
  v_cvt_pk_bf16_f32 v137, v154, v155
  v_mfma_f32_16x16x32_bf16 v[216:219], a[164:167], a[120:123], v[216:219]
  ds_read_b64_tr_b16 a[180:181], v4 offset:28672
  v_cvt_pk_bf16_f32 v140, v156, v157
  v_mfma_f32_16x16x32_bf16 v[216:219], a[160:163], a[104:107], v[216:219]
  v_cvt_pk_bf16_f32 v141, v158, v159
HOP15:
  s_cbranch_execz HOP19
  v_mfma_f32_16x16x32_bf16 v[212:215], a[160:163], a[100:103], v[212:215]
  ds_read_b64_tr_b16 a[182:183], v4 offset:30720
  s_lshl_b32 s82, s44, 28
  s_add_u32 s82, s82, s81
  buffer_load_dword v36, v37, s[8:11], s82 offen sc1
  v_mfma_f32_16x16x32_bf16 v[212:215], a[164:167], a[116:119], v[212:215]
  s_waitcnt lgkmcnt(14)
  v_fma_f32 v160, v160, v16, v60
  v_fma_f32 v161, v161, v16, v61
  v_mfma_f32_16x16x32_bf16 v[208:211], a[164:167], a[112:115], v[208:211]
  ds_read_b64_tr_b16 a[164:165], v8 offset:32768
  v_fma_f32 v162, v162, v16, v62
  v_mfma_f32_16x16x32_bf16 v[208:211], a[160:163], a[96:99], v[208:211]
  s_waitcnt lgkmcnt(5)
  v_exp_f32 v24, v160
  v_fma_f32 v163, v163, v16, v63
  v_mfma_f32_16x16x32_bf16 v[192:195], a[168:171], a[128:131], v[192:195]
  ds_read_b64_tr_b16 a[166:167], v8 offset:34816
  v_fma_f32 v164, v164, v18, v60
  v_mfma_f32_16x16x32_bf16 v[192:195], a[172:175], a[144:147], v[192:195]
  v_exp_f32 v25, v161
  v_mfma_f32_16x16x32_bf16 v[196:199], a[172:175], a[148:151], v[196:199]
  ds_read_b64_tr_b16 a[160:161], v8 offset:36864
  v_fma_f32 v165, v165, v18, v61
  v_mfma_f32_16x16x32_bf16 v[196:199], a[168:171], a[132:135], v[196:199]
  v_exp_f32 v26, v162
  v_fma_f32 v166, v166, v18, v62
  v_mfma_f32_16x16x32_bf16 v[200:203], a[168:171], a[136:139], v[200:203]
  ds_read_b64_tr_b16 a[162:163], v8 offset:38912
  v_fma_f32 v167, v167, v18, v63
  v_mfma_f32_16x16x32_bf16 v[200:203], a[172:175], a[152:155], v[200:203]
  v_exp_f32 v27, v163
  v_mfma_f32_16x16x32_bf16 v[204:207], a[172:175], a[156:159], v[204:207]
  ds_read_b64_tr_b16 a[172:173], v8 offset:40960
  v_mul_f32 v176, v160, v176
  v_mfma_f32_16x16x32_bf16 v[204:207], a[168:171], a[140:143], v[204:207]
  s_waitcnt lgkmcnt(5)
  v_exp_f32 v28, v164
  v_mul_f32 v177, v161, v177
  v_mfma_f32_16x16x32_bf16 v[220:223], a[176:179], a[140:143], v[220:223]
  ds_read_b64_tr_b16 a[174:175], v8 offset:43008
  v_mul_f32 v178, v162, v178
  v_mfma_f32_16x16x32_bf16 v[220:223], a[180:183], a[156:159], v[220:223]
  v_exp_f32 v29, v165
  v_mfma_f32_16x16x32_bf16 v[216:219], a[180:183], a[152:155], v[216:219]
  ds_read_b64_tr_b16 a[168:169], v8 offset:45056
  v_mul_f32 v179, v163, v179
  v_mfma_f32_16x16x32_bf16 v[216:219], a[176:179], a[136:139], v[216:219]
  v_exp_f32 v30, v166
  v_mul_f32 v180, v164, v180
  v_mfma_f32_16x16x32_bf16 v[212:215], a[176:179], a[132:135], v[212:215]
  ds_read_b64_tr_b16 a[170:171], v8 offset:47104
  v_mul_f32 v181, v165, v181
  v_mfma_f32_16x16x32_bf16 v[212:215], a[180:183], a[148:151], v[212:215]
  v_exp_f32 v31, v167
  v_mfma_f32_16x16x32_bf16 v[208:211], a[180:183], a[144:147], v[208:211]
  ds_read_b64_tr_b16 a[180:181], v5 offset:32768
  v_mul_f32 v182, v166, v182
  v_mfma_f32_16x16x32_bf16 v[208:211], a[176:179], a[128:131], v[208:211]
  s_waitcnt lgkmcnt(5)
  v_mul_f32 v183, v167, v183
  v_fma_f32 v24, v24, v17, v17
  v_fma_f32 v25, v25, v17, v17
  v_mfma_f32_16x16x32_bf16 v[192:195], a[164:167], a[188:191], v[192:195]
  ds_read_b64_tr_b16 a[182:183], v5 offset:34816
  v_fma_f32 v26, v26, v17, v17
  v_mfma_f32_16x16x32_bf16 v[192:195], a[160:163], a[204:207], v[192:195]
  v_rcp_f32 v24, v24
  v_mfma_f32_16x16x32_bf16 v[196:199], a[160:163], a[208:211], v[196:199]
  ds_read_b64_tr_b16 a[176:177], v5 offset:36864
  v_fma_f32 v27, v27, v17, v17
  v_mfma_f32_16x16x32_bf16 v[196:199], a[164:167], a[192:195], v[196:199]
  v_rcp_f32 v25, v25
  v_fma_f32 v28, v28, v19, v19
  v_mfma_f32_16x16x32_bf16 v[200:203], a[164:167], a[196:199], v[200:203]
  ds_read_b64_tr_b16 a[178:179], v5 offset:38912
  v_fma_f32 v29, v29, v19, v19
  v_mfma_f32_16x16x32_bf16 v[200:203], a[160:163], a[212:215], v[200:203]
  v_rcp_f32 v26, v26
  v_mfma_f32_16x16x32_bf16 v[204:207], a[160:163], a[216:219], v[204:207]
  ds_read_b64_tr_b16 a[160:161], v5 offset:40960
  v_fma_f32 v30, v30, v19, v19
  v_mfma_f32_16x16x32_bf16 v[204:207], a[164:167], a[200:203], v[204:207]
  s_waitcnt lgkmcnt(5)
  v_rcp_f32 v27, v27
  v_fma_f32 v31, v31, v19, v19
  v_mfma_f32_16x16x32_bf16 v[220:223], a[172:175], a[200:203], v[220:223]
  ds_read_b64_tr_b16 a[162:163], v5 offset:43008
  v_mul_f32 v176, v176, v24
  v_mfma_f32_16x16x32_bf16 v[220:223], a[168:171], a[216:219], v[220:223]
  v_rcp_f32 v28, v28
  v_mfma_f32_16x16x32_bf16 v[216:219], a[168:171], a[212:215], v[216:219]
  ds_read_b64_tr_b16 a[164:165], v5 offset:45056
  v_mul_f32 v177, v177, v25
  v_mfma_f32_16x16x32_bf16 v[216:219], a[172:175], a[196:199], v[216:219]
  v_rcp_f32 v29, v29
  v_mul_f32 v178, v178, v26
  v_mfma_f32_16x16x32_bf16 v[212:215], a[172:175], a[192:195], v[212:215]
  ds_read_b64_tr_b16 a[166:167], v5 offset:47104
  v_mul_f32 v179, v179, v27
  v_mfma_f32_16x16x32_bf16 v[212:215], a[168:171], a[208:211], v[212:215]
  v_rcp_f32 v30, v30
  v_mfma_f32_16x16x32_bf16 v[208:211], a[168:171], a[204:207], v[208:211]
  ds_read_b64_tr_b16 a[168:169], v5 offset:49152
  v_mul_f32 v180, v180, v28
  v_mfma_f32_16x16x32_bf16 v[208:211], a[172:175], a[188:191], v[208:211]
  s_waitcnt lgkmcnt(5)
  v_rcp_f32 v31, v31
  v_mul_f32 v181, v181, v29
  v_mfma_f32_16x16x32_bf16 v[224:227], a[180:183], a[64:67], v[224:227]
  ds_read_b64_tr_b16 a[170:171], v5 offset:51200
  v_mul_f32 v182, v182, v30
  v_mfma_f32_16x16x32_bf16 v[224:227], a[176:179], a[80:83], v[224:227]
  v_mul_f32 v183, v183, v31
  v_cvt_pk_bf16_f32 v130, v176, v177
  v_mfma_f32_16x16x32_bf16 v[228:231], a[176:179], a[84:87], v[228:231]
  ds_read_b64_tr_b16 a[172:173], v5 offset:53248
  v_cvt_pk_bf16_f32 v131, v178, v179
  v_mfma_f32_16x16x32_bf16 v[228:231], a[180:183], a[68:71], v[228:231]
  buffer_store_dwordx4 v[128:131], v1, s[8:11], s57 offen offset:0 sc1
  v_mfma_f32_16x16x32_bf16 v[232:235], a[180:183], a[72:75], v[232:235]
  ds_read_b64_tr_b16 a[174:175], v5 offset:55296
  s_waitcnt vmcnt(1)
  s_cmp_lg_u32 s44, 0
  s_cbranch_scc1 PL12_adaLN_cond__sliding_local_dilated__swiglu_ffn__prompt_kernelx
  v_cmp_ne_u32 vcc, s46, v36
  s_nop 4
  s_cbranch_vccz PL12_adaLN_cond__sliding_local_dilated__swiglu_ffn__prompt_kernelx
  s_mov_b32 s82, 60000
PL12_adaLN_cond__sliding_local_dilated__swiglu_ffn__prompt_kernel:
  buffer_load_dword v36, v37, s[8:11], s81 offen sc1
  s_sub_u32 s82, s82, 1
  s_cmp_eq_u32 s82, 0
  s_waitcnt vmcnt(0)
  s_cbranch_scc1 PL12_adaLN_cond__sliding_local_dilated__swiglu_ffn__prompt_kernelx
  v_cmp_ne_u32 vcc, s46, v36
  s_nop 4
  s_cbranch_vccnz PL12_adaLN_cond__sliding_local_dilated__swiglu_ffn__prompt_kernel
PL12_adaLN_cond__sliding_local_dilated__swiglu_ffn__prompt_kernelx:
  s_barrier
  v_mfma_f32_16x16x32_bf16 v[232:235], a[176:179], a[88:91], v[232:235]
  v_cvt_pk_bf16_f32 v134, v180, v181
  v_cvt_pk_bf16_f32 v135, v182, v183
  v_mfma_f32_16x16x32_bf16 v[236:239], a[176:179], a[92:95], v[236:239]
  ds_read_b64_tr_b16 a[176:177], v5 offset:57344
  v_fma_f32 v168, v168, v20, v60
  v_mfma_f32_16x16x32_bf16 v[236:239], a[180:183], a[76:79], v[236:239]
  s_waitcnt lgkmcnt(5)
  buffer_load_dwordx4 a[220:223], v1, s[8:11], s71 offen offset:0 sc1
  v_exp_f32 v24, v168
  v_mfma_f32_16x16x32_bf16 v[252:255], a[160:163], a[76:79], v[252:255]
  ds_read_b64_tr_b16 a[178:179], v5 offset:59392
  s_add_u32 s55, s57, 262144
  buffer_store_dwordx4 v[132:135], v1, s[8:11], s55 offen offset:0 sc1
  v_mfma_f32_16x16x32_bf16 v[252:255], a[164:167], a[92:95], v[252:255]
  v_fma_f32 v169, v169, v20, v61
  v_fma_f32 v170, v170, v20, v62
  v_mfma_f32_16x16x32_bf16 v[248:251], a[164:167], a[88:91], v[248:251]
  ds_read_b64_tr_b16 a[180:181], v5 offset:61440
  v_fma_f32 v171, v171, v20, v63
  v_mfma_f32_16x16x32_bf16 v[248:251], a[160:163], a[72:75], v[248:251]
  buffer_load_dwordx4 a[236:239], v1, s[8:11], s71 offen offset:1024 sc1
  v_exp_f32 v25, v169
  v_fma_f32 v172, v172, v22, v60
  v_mfma_f32_16x16x32_bf16 v[244:247], a[160:163], a[68:71], v[244:247]
  ds_read_b64_tr_b16 a[182:183], v5 offset:63488
  v_fma_f32 v173, v173, v22, v61
  v_mfma_f32_16x16x32_bf16 v[244:247], a[164:167], a[84:87], v[244:247]
  s_add_u32 s71, s71, 131072
  v_exp_f32 v26, v170
  v_mfma_f32_16x16x32_bf16 v[240:243], a[164:167], a[80:83], v[240:243]
  ds_read_b64_tr_b16 a[164:165], v5 offset:16384
  v_fma_f32 v174, v174, v22, v62
  v_mfma_f32_16x16x32_bf16 v[240:243], a[160:163], a[64:67], v[240:243]
  s_waitcnt lgkmcnt(5)
  buffer_load_dwordx4 a[224:227], v1, s[8:11], s71 offen offset:0 sc1
  v_exp_f32 v27, v171
  v_mfma_f32_16x16x32_bf16 v[224:227], a[168:171], a[96:99], v[224:227]
  ds_read_b64_tr_b16 a[166:167], v5 offset:18432
  v_fma_f32 v175, v175, v22, v63
  v_mfma_f32_16x16x32_bf16 v[224:227], a[172:175], a[112:115], v[224:227]
  v_exp_f32 v28, v172
  v_mfma_f32_16x16x32_bf16 v[228:231], a[172:175], a[116:119], v[228:231]
  ds_read_b64_tr_b16 a[160:161], v5 offset:20480
  v_mul_f32 v184, v168, v184
  v_mfma_f32_16x16x32_bf16 v[228:231], a[168:171], a[100:103], v[228:231]
  buffer_load_dwordx4 a[240:243], v1, s[8:11], s71 offen offset:1024 sc1
  v_exp_f32 v29, v173
  v_mul_f32 v185, v169, v185
  v_mfma_f32_16x16x32_bf16 v[232:235], a[168:171], a[104:107], v[232:235]
  ds_read_b64_tr_b16 a[162:163], v5 offset:22528
  v_mul_f32 v186, v170, v186
  v_mfma_f32_16x16x32_bf16 v[232:235], a[172:175], a[120:123], v[232:235]
  s_add_u32 s71, s71, s88
  v_exp_f32 v30, v174
  v_mfma_f32_16x16x32_bf16 v[236:239], a[172:175], a[124:127], v[236:239]
  ds_read_b64_tr_b16 a[172:173], v5 offset:24576
  ds_read_b128 v[60:63], v12 offset:640
  v_mfma_f32_16x16x32_bf16 v[236:239], a[168:171], a[108:111], v[236:239]
  s_waitcnt lgkmcnt(6)
  buffer_load_dwordx4 a[228:231], v1, s[8:11], s71 offen offset:0 sc1
  v_exp_f32 v31, v175
  v_mfma_f32_16x16x32_bf16 v[252:255], a[176:179], a[108:111], v[252:255]
  ds_read_b64_tr_b16 a[174:175], v5 offset:26624
  v_mul_f32 v187, v171, v187
  v_mfma_f32_16x16x32_bf16 v[252:255], a[180:183], a[124:127], v[252:255]
  v_mul_f32 v188, v172, v188
  v_mul_f32 v189, v173, v189
  v_mfma_f32_16x16x32_bf16 v[248:251], a[180:183], a[120:123], v[248:251]
  ds_read_b64_tr_b16 a[168:169], v5 offset:28672
  v_mul_f32 v190, v174, v190
  v_mfma_f32_16x16x32_bf16 v[248:251], a[176:179], a[104:107], v[248:251]
  buffer_load_dwordx4 a[244:247], v1, s[8:11], s71 offen offset:1024 sc1
  v_mul_f32 v191, v175, v191
  v_fma_f32 v24, v24, v21, v21
  v_fma_f32 v25, v25, v21, v21
  v_mfma_f32_16x16x32_bf16 v[244:247], a[176:179], a[100:103], v[244:247]
  ds_read_b64_tr_b16 a[170:171], v5 offset:30720
  v_fma_f32 v26, v26, v21, v21
  v_mfma_f32_16x16x32_bf16 v[244:247], a[180:183], a[116:119], v[244:247]
  s_add_u32 s71, s71, 131072
  v_rcp_f32 v24, v24
  v_mfma_f32_16x16x32_bf16 v[240:243], a[180:183], a[112:115], v[240:243]
  ds_read_b64_tr_b16 a[180:181], v9 offset:32768
  v_fma_f32 v27, v27, v21, v21
  v_mfma_f32_16x16x32_bf16 v[240:243], a[176:179], a[96:99], v[240:243]
  s_waitcnt lgkmcnt(6)
  buffer_load_dwordx4 a[232:235], v1, s[8:11], s71 offen offset:0 sc1
  v_rcp_f32 v25, v25
  v_mfma_f32_16x16x32_bf16 v[224:227], a[164:167], a[128:131], v[224:227]
  ds_read_b64_tr_b16 a[182:183], v9 offset:34816
  v_fma_f32 v28, v28, v23, v23
  v_mfma_f32_16x16x32_bf16 v[224:227], a[160:163], a[144:147], v[224:227]
  v_rcp_f32 v26, v26
  v_mfma_f32_16x16x32_bf16 v[228:231], a[160:163], a[148:151], v[228:231]
  ds_read_b64_tr_b16 a[176:177], v9 offset:36864
  v_fma_f32 v29, v29, v23, v23
  v_mfma_f32_16x16x32_bf16 v[228:231], a[164:167], a[132:135], v[228:231]
  buffer_load_dwordx4 a[248:251], v1, s[8:11], s71 offen offset:1024 sc1
  v_rcp_f32 v27, v27
  v_fma_f32 v30, v30, v23, v23
  v_mfma_f32_16x16x32_bf16 v[232:235], a[164:167], a[136:139], v[232:235]
  ds_read_b64_tr_b16 a[178:179], v9 offset:38912
  v_fma_f32 v31, v31, v23, v23
  v_mfma_f32_16x16x32_bf16 v[232:235], a[160:163], a[152:155], v[232:235]
  v_rcp_f32 v28, v28
  v_mfma_f32_16x16x32_bf16 v[236:239], a[160:163], a[156:159], v[236:239]
  ds_read_b64_tr_b16 a[160:161], v9 offset:40960
  v_mul_f32 v184, v184, v24
  v_mfma_f32_16x16x32_bf16 v[236:239], a[164:167], a[140:143], v[236:239]
  s_waitcnt lgkmcnt(5)
  buffer_load_dwordx4 a[0:3], v1, s[8:11], s72 offen offset:0 sc1
  v_rcp_f32 v29, v29
  v_mfma_f32_16x16x32_bf16 v[252:255], a[172:175], a[140:143], v[252:255]
  ds_read_b64_tr_b16 a[162:163], v9 offset:43008
  v_mul_f32 v185, v185, v25
  v_mfma_f32_16x16x32_bf16 v[252:255], a[168:171], a[156:159], v[252:255]
  v_rcp_f32 v30, v30
  v_mfma_f32_16x16x32_bf16 v[248:251], a[168:171], a[152:155], v[248:251]
  ds_read_b64_tr_b16 a[164:165], v9 offset:45056
  v_mul_f32 v186, v186, v26
  v_mfma_f32_16x16x32_bf16 v[248:251], a[172:175], a[136:139], v[248:251]
  buffer_load_dwordx4 a[16:19], v1, s[8:11], s72 offen offset:1024 sc1
  v_rcp_f32 v31, v31
  v_mul_f32 v187, v187, v27
  v_mfma_f32_16x16x32_bf16 v[244:247], a[172:175], a[132:135], v[244:247]
  ds_read_b64_tr_b16 a[166:167], v9 offset:47104
  v_mul_f32 v188, v188, v28
  v_mfma_f32_16x16x32_bf16 v[244:247], a[168:171], a[148:151], v[244:247]
  s_waitcnt vmcnt(33)
  s_barrier
  v_mfma_f32_16x16x32_bf16 v[240:243], a[168:171], a[144:147], v[240:243]
  ds_read_b64_tr_b16 a[168:169], v6 offset:49152
  s_add_u32 s72, s72, 131072
  v_mfma_f32_16x16x32_bf16 v[240:243], a[172:175], a[128:131], v[240:243]
  s_waitcnt lgkmcnt(5)
  buffer_load_dwordx4 a[4:7], v1, s[8:11], s72 offen offset:0 sc1
  v_mul_f32 v189, v189, v29
  v_mul_f32 v190, v190, v30
  v_mfma_f32_16x16x32_bf16 v[224:227], a[180:183], a[188:191], v[224:227]
  ds_read_b64_tr_b16 a[170:171], v6 offset:51200
  v_mul_f32 v191, v191, v31
  v_mfma_f32_16x16x32_bf16 v[224:227], a[176:179], a[204:207], v[224:227]
  v_cvt_pk_bf16_f32 v138, v184, v185
  v_cvt_pk_bf16_f32 v139, v186, v187
  v_mfma_f32_16x16x32_bf16 v[228:231], a[176:179], a[208:211], v[228:231]
  ds_read_b64_tr_b16 a[172:173], v6 offset:53248
  v_cvt_pk_bf16_f32 v142, v188, v189
  v_mfma_f32_16x16x32_bf16 v[228:231], a[180:183], a[192:195], v[228:231]
  buffer_load_dwordx4 a[20:23], v1, s[8:11], s72 offen offset:1024 sc1
  s_add_u32 s55, s57, 524288
  buffer_store_dwordx4 v[136:139], v1, s[8:11], s55 offen offset:0 sc1
  v_mfma_f32_16x16x32_bf16 v[232:235], a[180:183], a[196:199], v[232:235]
  ds_read_b64_tr_b16 a[174:175], v6 offset:55296
  v_cvt_pk_bf16_f32 v143, v190, v191
  v_mfma_f32_16x16x32_bf16 v[232:235], a[176:179], a[212:215], v[232:235]
  s_add_u32 s72, s72, s88
  s_add_u32 s55, s57, 786432
  buffer_store_dwordx4 v[140:143], v1, s[8:11], s55 offen offset:0 sc1
  v_mfma_f32_16x16x32_bf16 v[236:239], a[176:179], a[216:219], v[236:239]
  ds_read_b64_tr_b16 a[176:177], v7 offset:49152
  s_waitcnt lgkmcnt(15)
  v_mfma_f32_16x16x32_bf16 v[236:239], a[180:183], a[200:203], v[236:239]
  s_waitcnt lgkmcnt(5)
  buffer_load_dwordx4 a[8:11], v1, s[8:11], s72 offen offset:0 sc1
  v_fma_f32 v192, v192, v16, v60
  v_fma_f32 v193, v193, v16, v61
  v_mfma_f32_16x16x32_bf16 v[252:255], a[160:163], a[200:203], v[252:255]
  ds_read_b64_tr_b16 a[178:179], v7 offset:51200
  v_fma_f32 v194, v194, v16, v62
  v_mfma_f32_16x16x32_bf16 v[252:255], a[164:167], a[216:219], v[252:255]
  s_waitcnt vmcnt(32)
  s_barrier
  v_mfma_f32_16x16x32_bf16 v[248:251], a[164:167], a[212:215], v[248:251]
  ds_read_b64_tr_b16 a[180:181], v7 offset:53248
  v_exp_f32 v24, v192
  v_mfma_f32_16x16x32_bf16 v[248:251], a[160:163], a[196:199], v[248:251]
  buffer_load_dwordx4 a[24:27], v1, s[8:11], s72 offen offset:1024 sc1
  v_exp_f32 v25, v193
  v_mfma_f32_16x16x32_bf16 v[244:247], a[160:163], a[192:195], v[244:247]
  ds_read_b64_tr_b16 a[182:183], v7 offset:55296
  v_fma_f32 v195, v195, v16, v63
  v_mfma_f32_16x16x32_bf16 v[244:247], a[164:167], a[208:211], v[244:247]
  s_add_u32 s72, s72, 131072
  v_exp_f32 v26, v194
  v_fma_f32 v196, v196, v18, v60
  v_mfma_f32_16x16x32_bf16 v[240:243], a[164:167], a[204:207], v[240:243]
  ds_read_b64_tr_b16 a[164:165], v8 offset:49152
  v_fma_f32 v197, v197, v18, v61
  v_mfma_f32_16x16x32_bf16 v[240:243], a[160:163], a[188:191], v[240:243]
  s_waitcnt vmcnt(8) lgkmcnt(5)
  buffer_load_dwordx4 a[12:15], v1, s[8:11], s72 offen offset:0 sc1
  v_exp_f32 v27, v195
  v_mfma_f32_16x16x32_bf16 v[64:67], a[168:171], a[220:223], 0
  ds_read_b64_tr_b16 a[166:167], v8 offset:51200
  v_fma_f32 v198, v198, v18, v62
  v_mfma_f32_16x16x32_bf16 v[64:67], a[172:175], a[236:239], v[64:67]
  v_exp_f32 v28, v196
  v_mfma_f32_16x16x32_bf16 v[68:71], a[172:175], a[240:243], 0
  ds_read_b64_tr_b16 a[160:161], v8 offset:53248
  v_exp_f32 v29, v197
  v_mfma_f32_16x16x32_bf16 v[68:71], a[168:171], a[224:227], v[68:71]
  buffer_load_dwordx4 a[28:31], v1, s[8:11], s72 offen offset:1024 sc1
  v_exp_f32 v30, v198
  v_mfma_f32_16x16x32_bf16 v[72:75], a[168:171], a[228:231], 0
  ds_read_b64_tr_b16 a[162:163], v8 offset:55296
  v_fma_f32 v199, v199, v18, v63
  v_mfma_f32_16x16x32_bf16 v[72:75], a[172:175], a[244:247], v[72:75]
  v_exp_f32 v31, v199
  v_mul_f32 v208, v192, v208
  v_mfma_f32_16x16x32_bf16 v[76:79], a[172:175], a[248:251], 0
  ds_read_b64_tr_b16 a[172:173], v9 offset:49152
  v_mul_f32 v209, v193, v209
  v_mfma_f32_16x16x32_bf16 v[76:79], a[168:171], a[232:235], v[76:79]
  s_waitcnt lgkmcnt(5)
  buffer_load_dwordx4 a[32:35], v1, s[8:11], s73 offen offset:0 sc1
  v_mul_f32 v210, v194, v210
  v_mul_f32 v211, v195, v211
  v_mfma_f32_16x16x32_bf16 v[92:95], a[176:179], a[232:235], 0
  ds_read_b64_tr_b16 a[174:175], v9 offset:51200
  v_mul_f32 v212, v196, v212
  v_mfma_f32_16x16x32_bf16 v[92:95], a[180:183], a[248:251], v[92:95]
  v_mul_f32 v213, v197, v213
  v_mul_f32 v214, v198, v214
  v_mfma_f32_16x16x32_bf16 v[88:91], a[180:183], a[244:247], 0
  ds_read_b64_tr_b16 a[168:169], v9 offset:53248
  v_mul_f32 v215, v199, v215
  v_fma_f32 v24, v24, v17, v17
  v_mfma_f32_16x16x32_bf16 v[88:91], a[176:179], a[228:231], v[88:91]
  buffer_load_dwordx4 a[48:51], v1, s[8:11], s73 offen offset:1024 sc1
  v_rcp_f32 v24, v24
  v_mfma_f32_16x16x32_bf16 v[84:87], a[176:179], a[224:227], 0
  ds_read_b64_tr_b16 a[170:171], v9 offset:55296
  v_fma_f32 v25, v25, v17, v17
  v_mfma_f32_16x16x32_bf16 v[84:87], a[180:183], a[240:243], v[84:87]
  v_rcp_f32 v25, v25
  v_fma_f32 v26, v26, v17, v17
  v_mfma_f32_16x16x32_bf16 v[80:83], a[180:183], a[236:239], 0
  ds_read_b64_tr_b16 a[180:181], v6 offset:57344
  v_fma_f32 v27, v27, v17, v17
  v_mfma_f32_16x16x32_bf16 v[80:83], a[176:179], a[220:223], v[80:83]
  s_waitcnt lgkmcnt(5)
  s_add_u32 s73, s73, 131072
  v_rcp_f32 v26, v26
  v_mfma_f32_16x16x32_bf16 v[96:99], a[164:167], a[220:223], 0
  ds_read_b64_tr_b16 a[182:183], v6 offset:59392
  v_fma_f32 v28, v28, v19, v19
  v_mfma_f32_16x16x32_bf16 v[96:99], a[160:163], a[236:239], v[96:99]
  buffer_load_dwordx4 a[36:39], v1, s[8:11], s73 offen offset:0 sc1
  v_rcp_f32 v27, v27
  v_mfma_f32_16x16x32_bf16 v[100:103], a[160:163], a[240:243], 0
  ds_read_b64_tr_b16 a[176:177], v6 offset:61440
  v_rcp_f32 v28, v28
  v_mfma_f32_16x16x32_bf16 v[100:103], a[164:167], a[224:227], v[100:103]
  v_fma_f32 v29, v29, v19, v19
  v_fma_f32 v30, v30, v19, v19
  v_mfma_f32_16x16x32_bf16 v[104:107], a[164:167], a[228:231], 0
  ds_read_b64_tr_b16 a[178:179], v6 offset:63488
  v_fma_f32 v31, v31, v19, v19
  v_mfma_f32_16x16x32_bf16 v[104:107], a[160:163], a[244:247], v[104:107]
  buffer_load_dwordx4 a[52:55], v1, s[8:11], s73 offen offset:1024 sc1
  v_rcp_f32 v29, v29
  v_mul_f32 v208, v208, v24
  v_mfma_f32_16x16x32_bf16 v[108:111], a[160:163], a[248:251], 0
  ds_read_b64_tr_b16 a[160:161], v7 offset:57344
  v_mul_f32 v209, v209, v25
  v_mfma_f32_16x16x32_bf16 v[108:111], a[164:167], a[232:235], v[108:111]
  s_waitcnt lgkmcnt(5)
  s_add_u32 s73, s73, s88
  v_rcp_f32 v30, v30
  v_mfma_f32_16x16x32_bf16 v[124:127], a[172:175], a[232:235], 0
  ds_read_b64_tr_b16 a[162:163], v7 offset:59392
  v_mul_f32 v210, v210, v26
  v_mfma_f32_16x16x32_bf16 v[124:127], a[168:171], a[248:251], v[124:127]
  buffer_load_dwordx4 a[40:43], v1, s[8:11], s73 offen offset:0 sc1
  v_rcp_f32 v31, v31
  v_mfma_f32_16x16x32_bf16 v[120:123], a[168:171], a[244:247], 0
  ds_read_b64_tr_b16 a[164:165], v7 offset:61440
  v_mul_f32 v211, v211, v27
  v_mul_f32 v212, v212, v28
  v_mfma_f32_16x16x32_bf16 v[120:123], a[172:175], a[228:231], v[120:123]
  v_mul_f32 v213, v213, v29
  v_mul_f32 v214, v214, v30
  v_mfma_f32_16x16x32_bf16 v[116:119], a[172:175], a[224:227], 0
  ds_read_b64_tr_b16 a[166:167], v7 offset:63488
  v_mul_f32 v215, v215, v31
  v_mfma_f32_16x16x32_bf16 v[116:119], a[168:171], a[240:243], v[116:119]
  buffer_load_dwordx4 a[56:59], v1, s[8:11], s73 offen offset:1024 sc1
  v_cvt_pk_bf16_f32 v192, v208, v209
  v_cvt_pk_bf16_f32 v193, v210, v211
  v_cvt_pk_bf16_f32 v196, v212, v213
  v_mfma_f32_16x16x32_bf16 v[112:115], a[168:171], a[236:239], 0
  ds_read_b64_tr_b16 a[168:169], v8 offset:57344
  v_cvt_pk_bf16_f32 v197, v214, v215
  v_mfma_f32_16x16x32_bf16 v[112:115], a[172:175], a[220:223], v[112:115]
  s_waitcnt lgkmcnt(5)
  v_fma_f32 v200, v200, v20, v60
  v_exp_f32 v24, v200
  v_mfma_f32_16x16x32_bf16 v[128:131], a[180:183], a[220:223], 0
  ds_read_b64_tr_b16 a[170:171], v8 offset:59392
  v_fma_f32 v201, v201, v20, v61
  v_mfma_f32_16x16x32_bf16 v[128:131], a[176:179], a[236:239], v[128:131]
  s_add_u32 s73, s73, 131072
  v_exp_f32 v25, v201
  v_mfma_f32_16x16x32_bf16 v[132:135], a[176:179], a[240:243], 0
  ds_read_b64_tr_b16 a[172:173], v8 offset:61440
  v_fma_f32 v202, v202, v20, v62
  v_fma_f32 v203, v203, v20, v63
  v_mfma_f32_16x16x32_bf16 v[132:135], a[180:183], a[224:227], v[132:135]
  buffer_load_dwordx4 a[44:47], v1, s[8:11], s73 offen offset:0 sc1
  v_exp_f32 v26, v202
  v_mfma_f32_16x16x32_bf16 v[136:139], a[180:183], a[228:231], 0
  ds_read_b64_tr_b16 a[174:175], v8 offset:63488
  v_fma_f32 v204, v204, v22, v60
  v_mfma_f32_16x16x32_bf16 v[136:139], a[176:179], a[244:247], v[136:139]
  v_exp_f32 v27, v203
  v_fma_f32 v205, v205, v22, v61
  v_mfma_f32_16x16x32_bf16 v[140:143], a[176:179], a[248:251], 0
  ds_read_b64_tr_b16 a[176:177], v9 offset:57344
  v_fma_f32 v206, v206, v22, v62
  v_mfma_f32_16x16x32_bf16 v[140:143], a[180:183], a[232:235], v[140:143]
  s_waitcnt lgkmcnt(5)
  buffer_load_dwordx4 a[60:63], v1, s[8:11], s73 offen offset:1024 sc1
  v_exp_f32 v28, v204
  v_mfma_f32_16x16x32_bf16 v[156:159], a[160:163], a[232:235], 0
  ds_read_b64_tr_b16 a[178:179], v9 offset:59392
  v_fma_f32 v207, v207, v22, v63
  v_mfma_f32_16x16x32_bf16 v[156:159], a[164:167], a[248:251], v[156:159]
  v_exp_f32 v29, v205
  v_mfma_f32_16x16x32_bf16 v[152:155], a[164:167], a[244:247], 0
  ds_read_b64_tr_b16 a[180:181], v9 offset:61440
  v_exp_f32 v30, v206
  v_mfma_f32_16x16x32_bf16 v[152:155], a[160:163], a[228:231], v[152:155]
  buffer_load_dwordx4 a[64:67], v1, s[8:11], s74 offen offset:0 sc1
  v_exp_f32 v31, v207
  v_mfma_f32_16x16x32_bf16 v[148:151], a[160:163], a[224:227], 0
  ds_read_b64_tr_b16 a[182:183], v9 offset:63488
  v_mul_f32 v216, v200, v216
  v_mfma_f32_16x16x32_bf16 v[148:151], a[164:167], a[240:243], v[148:151]
  ds_read_b128 v[60:63], v12 offset:704
  v_mul_f32 v217, v201, v217
  v_mul_f32 v218, v202, v218
  v_mfma_f32_16x16x32_bf16 v[144:147], a[164:167], a[236:239], 0
  ds_read_b64_tr_b16 a[164:165], v6 offset:16384
  v_mul_f32 v219, v203, v219
  v_mfma_f32_16x16x32_bf16 v[144:147], a[160:163], a[220:223], v[144:147]
  s_waitcnt lgkmcnt(6)
  buffer_load_dwordx4 a[80:83], v1, s[8:11], s74 offen offset:1024 sc1
  v_mul_f32 v220, v204, v220
  v_mul_f32 v221, v205, v221
  v_mfma_f32_16x16x32_bf16 v[160:163], a[168:171], a[220:223], 0
  ds_read_b64_tr_b16 a[166:167], v6 offset:18432
  v_mul_f32 v222, v206, v222
  v_mfma_f32_16x16x32_bf16 v[160:163], a[172:175], a[236:239], v[160:163]
  v_mul_f32 v223, v207, v223
  v_fma_f32 v24, v24, v21, v21
  v_mfma_f32_16x16x32_bf16 v[164:167], a[172:175], a[240:243], 0
  ds_read_b64_tr_b16 a[160:161], v6 offset:20480
  v_rcp_f32 v24, v24
  v_mfma_f32_16x16x32_bf16 v[164:167], a[168:171], a[224:227], v[164:167]
  s_add_u32 s74, s74, 131072
  v_fma_f32 v25, v25, v21, v21
  v_fma_f32 v26, v26, v21, v21
  v_mfma_f32_16x16x32_bf16 v[168:171], a[168:171], a[228:231], 0
  ds_read_b64_tr_b16 a[162:163], v6 offset:22528
  v_fma_f32 v27, v27, v21, v21
  v_mfma_f32_16x16x32_bf16 v[168:171], a[172:175], a[244:247], v[168:171]
  buffer_load_dwordx4 a[68:71], v1, s[8:11], s74 offen offset:0 sc1
  v_rcp_f32 v25, v25
  v_fma_f32 v28, v28, v23, v23
  v_mfma_f32_16x16x32_bf16 v[172:175], a[172:175], a[248:251], 0
  ds_read_b64_tr_b16 a[172:173], v7 offset:16384
  v_fma_f32 v29, v29, v23, v23
  v_mfma_f32_16x16x32_bf16 v[172:175], a[168:171], a[232:235], v[172:175]
  s_waitcnt lgkmcnt(6)
  v_rcp_f32 v26, v26
  v_fma_f32 v30, v30, v23, v23
  v_mfma_f32_16x16x32_bf16 v[188:191], a[176:179], a[232:235], 0
  ds_read_b64_tr_b16 a[174:175], v7 offset:18432
  v_fma_f32 v31, v31, v23, v23
  v_mfma_f32_16x16x32_bf16 v[188:191], a[180:183], a[248:251], v[188:191]
  buffer_load_dwordx4 a[84:87], v1, s[8:11], s74 offen offset:1024 sc1
  v_rcp_f32 v27, v27
  v_mfma_f32_16x16x32_bf16 v[184:187], a[180:183], a[244:247], 0
  ds_read_b64_tr_b16 a[168:169], v7 offset:20480
  v_rcp_f32 v28, v28
  v_mfma_f32_16x16x32_bf16 v[184:187], a[176:179], a[228:231], v[184:187]
  s_add_u32 s74, s74, s88
  v_rcp_f32 v29, v29
  v_mfma_f32_16x16x32_bf16 v[180:183], a[176:179], a[224:227], 0
  ds_read_b64_tr_b16 a[170:171], v7 offset:22528
  v_mul_f32 v216, v216, v24
  v_mfma_f32_16x16x32_bf16 v[180:183], a[180:183], a[240:243], v[180:183]
  buffer_load_dwordx4 a[72:75], v1, s[8:11], s74 offen offset:0 sc1
  v_rcp_f32 v30, v30
  v_mul_f32 v217, v217, v25
  v_mfma_f32_16x16x32_bf16 v[176:179], a[180:183], a[236:239], 0
  ds_read_b64_tr_b16 a[180:181], v8 offset:16384
  v_mul_f32 v218, v218, v26
  v_mfma_f32_16x16x32_bf16 v[176:179], a[176:179], a[220:223], v[176:179]
  s_waitcnt vmcnt(13) lgkmcnt(5)
  v_rcp_f32 v31, v31
  v_mul_f32 v219, v219, v27
  v_mfma_f32_16x16x32_bf16 v[64:67], a[164:167], a[0:3], v[64:67]
  ds_read_b64_tr_b16 a[182:183], v8 offset:18432
  v_mul_f32 v220, v220, v28
  v_mfma_f32_16x16x32_bf16 v[64:67], a[160:163], a[16:19], v[64:67]
  buffer_load_dwordx4 a[88:91], v1, s[8:11], s74 offen offset:1024 sc1
  v_mul_f32 v221, v221, v29
  v_mul_f32 v222, v222, v30
  v_mfma_f32_16x16x32_bf16 v[68:71], a[160:163], a[20:23], v[68:71]
  ds_read_b64_tr_b16 a[176:177], v8 offset:20480
  v_mul_f32 v223, v223, v31
  v_cvt_pk_bf16_f32 v200, v216, v217
  v_mfma_f32_16x16x32_bf16 v[68:71], a[164:167], a[4:7], v[68:71]
  v_cvt_pk_bf16_f32 v201, v218, v219
  v_cvt_pk_bf16_f32 v204, v220, v221
  v_mfma_f32_16x16x32_bf16 v[72:75], a[164:167], a[8:11], v[72:75]
  ds_read_b64_tr_b16 a[178:179], v8 offset:22528
  v_cvt_pk_bf16_f32 v205, v222, v223
  v_mfma_f32_16x16x32_bf16 v[72:75], a[160:163], a[24:27], v[72:75]
  s_add_u32 s74, s74, 131072
  v_mfma_f32_16x16x32_bf16 v[76:79], a[160:163], a[28:31], v[76:79]
  ds_read_b64_tr_b16 a[160:161], v9 offset:16384
  s_waitcnt lgkmcnt(13)
  v_fma_f32 v224, v224, v16, v60
  v_mfma_f32_16x16x32_bf16 v[76:79], a[164:167], a[12:15], v[76:79]
  s_waitcnt lgkmcnt(5)
  buffer_load_dwordx4 a[76:79], v1, s[8:11], s74 offen offset:0 sc1
  v_exp_f32 v24, v224
  v_mfma_f32_16x16x32_bf16 v[92:95], a[172:175], a[12:15], v[92:95]
  ds_read_b64_tr_b16 a[162:163], v9 offset:18432
  v_fma_f32 v225, v225, v16, v61
  v_fma_f32 v226, v226, v16, v62
  v_mfma_f32_16x16x32_bf16 v[92:95], a[168:171], a[28:31], v[92:95]
  v_exp_f32 v25, v225
  v_fma_f32 v227, v227, v16, v63
  v_mfma_f32_16x16x32_bf16 v[88:91], a[168:171], a[24:27], v[88:91]
  ds_read_b64_tr_b16 a[164:165], v9 offset:20480
  v_fma_f32 v228, v228, v18, v60
  v_mfma_f32_16x16x32_bf16 v[88:91], a[172:175], a[8:11], v[88:91]
  buffer_load_dwordx4 a[92:95], v1, s[8:11], s74 offen offset:1024 sc1
  v_exp_f32 v26, v226
  v_fma_f32 v229, v229, v18, v61
  v_mfma_f32_16x16x32_bf16 v[84:87], a[172:175], a[4:7], v[84:87]
  ds_read_b64_tr_b16 a[166:167], v9 offset:22528
  v_exp_f32 v27, v227
  v_mfma_f32_16x16x32_bf16 v[84:87], a[168:171], a[20:23], v[84:87]
  s_cmp_eq_u32 s90, 1
  s_cselect_b32 s75, 3, 10
  s_lshl_b32 s67, s75, 17
  s_lshl_b32 s75, s75, 11
  s_add_u32 s75, s75, s83
  s_add_u32 m0, s45, 32768
  v_exp_f32 v28, v228
  v_fma_f32 v230, v230, v18, v62
  v_mfma_f32_16x16x32_bf16 v[80:83], a[168:171], a[16:19], v[80:83]
  ds_read_b64_tr_b16 a[168:169], v6 offset:24576
  v_exp_f32 v29, v229
  v_mfma_f32_16x16x32_bf16 v[80:83], a[172:175], a[0:3], v[80:83]
  s_waitcnt lgkmcnt(5)
  buffer_load_dwordx4 v32, s[36:39], s67 offen lds
  v_exp_f32 v30, v230
  v_mfma_f32_16x16x32_bf16 v[96:99], a[180:183], a[0:3], v[96:99]
  ds_read_b64_tr_b16 a[170:171], v6 offset:26624
  v_fma_f32 v231, v231, v18, v63
  v_mfma_f32_16x16x32_bf16 v[96:99], a[176:179], a[16:19], v[96:99]
  s_add_u32 m0, s45, 36864
  s_add_u32 s60, s67, 65536
HOP16:
  s_cbranch_execz WRET1
  v_exp_f32 v31, v231
  v_mfma_f32_16x16x32_bf16 v[100:103], a[176:179], a[20:23], v[100:103]
  ds_read_b64_tr_b16 a[172:173], v6 offset:28672
  v_mul_f32 v240, v224, v240
  v_mul_f32 v241, v225, v241
  v_mfma_f32_16x16x32_bf16 v[100:103], a[180:183], a[4:7], v[100:103]
  buffer_load_dwordx4 v32, s[36:39], s60 offen lds
  v_mul_f32 v242, v226, v242
  v_mul_f32 v243, v227, v243
  v_mul_f32 v244, v228, v244
  v_mfma_f32_16x16x32_bf16 v[104:107], a[180:183], a[8:11], v[104:107]
  ds_read_b64_tr_b16 a[174:175], v6 offset:30720
  v_mul_f32 v245, v229, v245
  v_mul_f32 v246, v230, v246
  v_mfma_f32_16x16x32_bf16 v[104:107], a[176:179], a[24:27], v[104:107]
  v_mul_f32 v247, v231, v247
  v_fma_f32 v24, v24, v17, v17
  v_mfma_f32_16x16x32_bf16 v[108:111], a[176:179], a[28:31], v[108:111]
  ds_read_b64_tr_b16 a[176:177], v7 offset:24576
  v_rcp_f32 v24, v24
  v_mfma_f32_16x16x32_bf16 v[108:111], a[180:183], a[12:15], v[108:111]
  s_waitcnt lgkmcnt(5)
  s_add_u32 m0, s45, 40960
  v_fma_f32 v25, v25, v17, v17
  v_fma_f32 v26, v26, v17, v17
  v_mfma_f32_16x16x32_bf16 v[124:127], a[160:163], a[12:15], v[124:127]
  ds_read_b64_tr_b16 a[178:179], v7 offset:26624
  v_rcp_f32 v25, v25
  v_mfma_f32_16x16x32_bf16 v[124:127], a[164:167], a[28:31], v[124:127]
  buffer_load_dwordx4 v33, s[36:39], s67 offen lds
  v_rcp_f32 v26, v26
  v_fma_f32 v27, v27, v17, v17
  v_mfma_f32_16x16x32_bf16 v[120:123], a[164:167], a[24:27], v[120:123]
  ds_read_b64_tr_b16 a[180:181], v7 offset:28672
  v_fma_f32 v28, v28, v19, v19
  v_mfma_f32_16x16x32_bf16 v[120:123], a[160:163], a[8:11], v[120:123]
  s_add_u32 m0, s45, 45056
  s_add_u32 s60, s67, 65536
  v_rcp_f32 v27, v27
  v_mfma_f32_16x16x32_bf16 v[116:119], a[160:163], a[4:7], v[116:119]
  ds_read_b64_tr_b16 a[182:183], v7 offset:30720
  v_rcp_f32 v28, v28
  v_mfma_f32_16x16x32_bf16 v[116:119], a[164:167], a[20:23], v[116:119]
  buffer_load_dwordx4 v33, s[36:39], s60 offen lds
  v_fma_f32 v29, v29, v19, v19
  v_rcp_f32 v29, v29
  v_mfma_f32_16x16x32_bf16 v[112:115], a[164:167], a[16:19], v[112:115]
  ds_read_b64_tr_b16 a[164:165], v8 offset:24576
  v_fma_f32 v30, v30, v19, v19
  v_fma_f32 v31, v31, v19, v19
  v_mfma_f32_16x16x32_bf16 v[112:115], a[160:163], a[0:3], v[112:115]
  s_waitcnt lgkmcnt(5)
  s_cmp_eq_u32 s90, 2
  s_cselect_b32 s76, 5, 12
  s_lshl_b32 s68, s76, 17
  s_lshl_b32 s76, s76, 11
  s_add_u32 s76, s76, s83
  s_add_u32 m0, s45, 49152
  v_rcp_f32 v30, v30
  v_mfma_f32_16x16x32_bf16 v[128:131], a[168:171], a[0:3], v[128:131]
  ds_read_b64_tr_b16 a[166:167], v8 offset:26624
  v_mul_f32 v240, v240, v24
  v_mfma_f32_16x16x32_bf16 v[128:131], a[172:175], a[16:19], v[128:131]
  buffer_load_dwordx4 v32, s[36:39], s68 offen lds
  v_rcp_f32 v31, v31
  v_mul_f32 v241, v241, v25
  v_mfma_f32_16x16x32_bf16 v[132:135], a[172:175], a[20:23], v[132:135]
  ds_read_b64_tr_b16 a[160:161], v8 offset:28672
  v_mul_f32 v242, v242, v26
  v_mul_f32 v243, v243, v27
  v_mfma_f32_16x16x32_bf16 v[132:135], a[168:171], a[4:7], v[132:135]
  s_add_u32 m0, s45, 53248
  s_add_u32 s60, s68, 65536
  v_mul_f32 v244, v244, v28
  v_mul_f32 v245, v245, v29
  v_mfma_f32_16x16x32_bf16 v[136:139], a[168:171], a[8:11], v[136:139]
  ds_read_b64_tr_b16 a[162:163], v8 offset:30720
  v_mul_f32 v246, v246, v30
  v_mul_f32 v247, v247, v31
  v_mfma_f32_16x16x32_bf16 v[136:139], a[172:175], a[24:27], v[136:139]
  buffer_load_dwordx4 v32, s[36:39], s60 offen lds
  v_cvt_pk_bf16_f32 v194, v240, v241
  v_cvt_pk_bf16_f32 v195, v242, v243
  v_mfma_f32_16x16x32_bf16 v[140:143], a[172:175], a[28:31], v[140:143]
  ds_read_b64_tr_b16 a[172:173], v9 offset:24576
  v_cvt_pk_bf16_f32 v198, v244, v245
  v_cvt_pk_bf16_f32 v199, v246, v247
  v_mfma_f32_16x16x32_bf16 v[140:143], a[168:171], a[12:15], v[140:143]
  s_waitcnt lgkmcnt(5)
  buffer_store_dwordx4 v[192:195], v1, s[8:11], s57 offen offset:1024 sc1
  v_mfma_f32_16x16x32_bf16 v[156:159], a[176:179], a[12:15], v[156:159]
  ds_read_b64_tr_b16 a[174:175], v9 offset:26624
  v_fma_f32 v232, v232, v20, v60
  v_fma_f32 v233, v233, v20, v61
  v_mfma_f32_16x16x32_bf16 v[156:159], a[180:183], a[28:31], v[156:159]
  s_add_u32 m0, s45, 57344
  s_add_u32 s55, s57, 262144
  buffer_store_dwordx4 v[196:199], v1, s[8:11], s55 offen offset:1024 sc1
  v_mfma_f32_16x16x32_bf16 v[152:155], a[180:183], a[24:27], v[152:155]
  ds_read_b64_tr_b16 a[168:169], v9 offset:28672
  v_fma_f32 v234, v234, v20, v62
  v_mfma_f32_16x16x32_bf16 v[152:155], a[176:179], a[8:11], v[152:155]
  buffer_load_dwordx4 v33, s[36:39], s68 offen lds
  v_exp_f32 v24, v232
  v_fma_f32 v235, v235, v20, v63
  v_mfma_f32_16x16x32_bf16 v[148:151], a[176:179], a[4:7], v[148:151]
  ds_read_b64_tr_b16 a[170:171], v9 offset:30720
  v_exp_f32 v25, v233
  v_mfma_f32_16x16x32_bf16 v[148:151], a[180:183], a[20:23], v[148:151]
  v_fma_f32 v236, v236, v22, v60
  s_waitcnt vmcnt(48)
  s_barrier
  v_mfma_f32_16x16x32_bf16 v[144:147], a[180:183], a[16:19], v[144:147]
  ds_read_b64_tr_b16 a[180:181], v6 offset:0
  s_add_u32 m0, s45, 61440
  s_add_u32 s60, s68, 65536
  v_mfma_f32_16x16x32_bf16 v[144:147], a[176:179], a[0:3], v[144:147]
  s_waitcnt lgkmcnt(5)
  buffer_load_dwordx4 v33, s[36:39], s60 offen lds
  v_exp_f32 v26, v234
  v_mfma_f32_16x16x32_bf16 v[160:163], a[164:167], a[0:3], v[160:163]
  ds_read_b64_tr_b16 a[182:183], v6 offset:2048
  v_fma_f32 v237, v237, v22, v61
  v_mfma_f32_16x16x32_bf16 v[160:163], a[160:163], a[16:19], v[160:163]
  v_exp_f32 v27, v235
  v_fma_f32 v238, v238, v22, v62
  v_mfma_f32_16x16x32_bf16 v[164:167], a[160:163], a[20:23], v[164:167]
  ds_read_b64_tr_b16 a[176:177], v6 offset:4096
  v_exp_f32 v28, v236
  v_mfma_f32_16x16x32_bf16 v[164:167], a[164:167], a[4:7], v[164:167]
  buffer_load_dwordx4 a[96:99], v1, s[8:11], s75 offen offset:0 sc1
  v_exp_f32 v29, v237
  v_fma_f32 v239, v239, v22, v63
  v_mfma_f32_16x16x32_bf16 v[168:171], a[164:167], a[8:11], v[168:171]
  ds_read_b64_tr_b16 a[178:179], v6 offset:6144
  v_exp_f32 v30, v238
  v_mfma_f32_16x16x32_bf16 v[168:171], a[160:163], a[24:27], v[168:171]
  v_exp_f32 v31, v239
  v_mfma_f32_16x16x32_bf16 v[172:175], a[160:163], a[28:31], v[172:175]
  ds_read_b64_tr_b16 a[160:161], v7 offset:0
  v_mul_f32 v248, v232, v248
  v_mul_f32 v249, v233, v249
  v_mfma_f32_16x16x32_bf16 v[172:175], a[164:167], a[12:15], v[172:175]
  s_waitcnt lgkmcnt(5)
  buffer_load_dwordx4 a[112:115], v1, s[8:11], s75 offen offset:1024 sc1
  v_mul_f32 v250, v234, v250
  v_mul_f32 v251, v235, v251
  v_mfma_f32_16x16x32_bf16 v[188:191], a[172:175], a[12:15], v[188:191]
  ds_read_b64_tr_b16 a[162:163], v7 offset:2048
  v_mul_f32 v252, v236, v252
  v_mul_f32 v253, v237, v253
  v_mfma_f32_16x16x32_bf16 v[188:191], a[168:171], a[28:31], v[188:191]
  v_mul_f32 v254, v238, v254
  v_mul_f32 v255, v239, v255
  v_fma_f32 v24, v24, v21, v21
  v_mfma_f32_16x16x32_bf16 v[184:187], a[168:171], a[24:27], v[184:187]
  ds_read_b64_tr_b16 a[164:165], v7 offset:4096
  v_fma_f32 v25, v25, v21, v21
  v_mfma_f32_16x16x32_bf16 v[184:187], a[172:175], a[8:11], v[184:187]
  s_add_u32 s75, s75, 131072
  v_rcp_f32 v24, v24
  v_fma_f32 v26, v26, v21, v21
  v_mfma_f32_16x16x32_bf16 v[180:183], a[172:175], a[4:7], v[180:183]
  ds_read_b64_tr_b16 a[166:167], v7 offset:6144
  v_rcp_f32 v25, v25
  v_mfma_f32_16x16x32_bf16 v[180:183], a[168:171], a[20:23], v[180:183]
  buffer_load_dwordx4 a[100:103], v1, s[8:11], s75 offen offset:0 sc1
  v_rcp_f32 v26, v26
  v_fma_f32 v27, v27, v21, v21
  v_mfma_f32_16x16x32_bf16 v[176:179], a[168:171], a[16:19], v[176:179]
  ds_read_b64_tr_b16 a[168:169], v8 offset:0
  v_rcp_f32 v27, v27
  v_mfma_f32_16x16x32_bf16 v[176:179], a[172:175], a[0:3], v[176:179]
  s_waitcnt vmcnt(21) lgkmcnt(5)
  v_fma_f32 v28, v28, v23, v23
  v_rcp_f32 v28, v28
  v_mfma_f32_16x16x32_bf16 v[64:67], a[180:183], a[32:35], v[64:67]
  ds_read_b64_tr_b16 a[170:171], v8 offset:2048
  v_fma_f32 v29, v29, v23, v23
  v_mfma_f32_16x16x32_bf16 v[64:67], a[176:179], a[48:51], v[64:67]
  buffer_load_dwordx4 a[116:119], v1, s[8:11], s75 offen offset:1024 sc1
  v_rcp_f32 v29, v29
  v_fma_f32 v30, v30, v23, v23
  v_mfma_f32_16x16x32_bf16 v[68:71], a[176:179], a[52:55], v[68:71]
  ds_read_b64_tr_b16 a[172:173], v8 offset:4096
  v_rcp_f32 v30, v30
  v_mfma_f32_16x16x32_bf16 v[68:71], a[180:183], a[36:39], v[68:71]
  s_add_u32 s75, s75, s88
  v_fma_f32 v31, v31, v23, v23
  v_rcp_f32 v31, v31
  v_mfma_f32_16x16x32_bf16 v[72:75], a[180:183], a[40:43], v[72:75]
  ds_read_b64_tr_b16 a[174:175], v8 offset:6144
  v_mul_f32 v248, v248, v24
  v_mul_f32 v249, v249, v25
  v_mfma_f32_16x16x32_bf16 v[72:75], a[176:179], a[56:59], v[72:75]
  buffer_load_dwordx4 a[104:107], v1, s[8:11], s75 offen offset:0 sc1
  v_mul_f32 v250, v250, v26
  v_mul_f32 v251, v251, v27
  v_mfma_f32_16x16x32_bf16 v[76:79], a[176:179], a[60:63], v[76:79]
  ds_read_b64_tr_b16 a[176:177], v9 offset:0
  v_mul_f32 v252, v252, v28
  v_mul_f32 v253, v253, v29
  v_mfma_f32_16x16x32_bf16 v[76:79], a[180:183], a[44:47], v[76:79]
  s_waitcnt lgkmcnt(5)
  v_mul_f32 v254, v254, v30
  v_mul_f32 v255, v255, v31
  v_cvt_pk_bf16_f32 v202, v248, v249
  v_mfma_f32_16x16x32_bf16 v[92:95], a[160:163], a[44:47], v[92:95]
  ds_read_b64_tr_b16 a[178:179], v9 offset:2048
  v_cvt_pk_bf16_f32 v203, v250, v251
  v_cvt_pk_bf16_f32 v206, v252, v253
  v_mfma_f32_16x16x32_bf16 v[92:95], a[164:167], a[60:63], v[92:95]
  buffer_load_dwordx4 a[120:123], v1, s[8:11], s75 offen offset:1024 sc1
  s_add_u32 s55, s57, 524288
  buffer_store_dwordx4 v[200:203], v1, s[8:11], s55 offen offset:1024 sc1
  v_mfma_f32_16x16x32_bf16 v[88:91], a[164:167], a[56:59], v[88:91]
  ds_read_b64_tr_b16 a[180:181], v9 offset:4096
  v_cvt_pk_bf16_f32 v207, v254, v255
  v_mfma_f32_16x16x32_bf16 v[88:91], a[160:163], a[40:43], v[88:91]
  s_add_u32 s55, s57, 786432
  buffer_store_dwordx4 v[204:207], v1, s[8:11], s55 offen offset:1024 sc1
  v_mfma_f32_16x16x32_bf16 v[84:87], a[160:163], a[36:39], v[84:87]
  ds_read_b64_tr_b16 a[182:183], v9 offset:6144
  s_sub_u32 s79, s79, 491520
  v_mfma_f32_16x16x32_bf16 v[84:87], a[164:167], a[52:55], v[84:87]
  s_add_u32 s75, s75, 131072
  v_mfma_f32_16x16x32_bf16 v[80:83], a[164:167], a[48:51], v[80:83]
  ds_read_b64_tr_b16 a[164:165], v6 offset:8192
  v_mfma_f32_16x16x32_bf16 v[80:83], a[160:163], a[32:35], v[80:83]
  s_waitcnt lgkmcnt(5)
  buffer_load_dwordx4 a[108:111], v1, s[8:11], s75 offen offset:0 sc1
  v_mfma_f32_16x16x32_bf16 v[96:99], a[168:171], a[32:35], v[96:99]
  ds_read_b64_tr_b16 a[166:167], v6 offset:10240
  v_mfma_f32_16x16x32_bf16 v[96:99], a[172:175], a[48:51], v[96:99]
  v_mfma_f32_16x16x32_bf16 v[100:103], a[172:175], a[52:55], v[100:103]
  ds_read_b64_tr_b16 a[160:161], v6 offset:12288
  v_mfma_f32_16x16x32_bf16 v[100:103], a[168:171], a[36:39], v[100:103]
  buffer_load_dwordx4 a[124:127], v1, s[8:11], s75 offen offset:1024 sc1
  v_mfma_f32_16x16x32_bf16 v[104:107], a[168:171], a[40:43], v[104:107]
  ds_read_b64_tr_b16 a[162:163], v6 offset:14336
  v_mfma_f32_16x16x32_bf16 v[104:107], a[172:175], a[56:59], v[104:107]
  v_mfma_f32_16x16x32_bf16 v[108:111], a[172:175], a[60:63], v[108:111]
  ds_read_b64_tr_b16 a[172:173], v7 offset:8192
  v_mfma_f32_16x16x32_bf16 v[108:111], a[168:171], a[44:47], v[108:111]
  s_waitcnt lgkmcnt(5)
  buffer_load_dwordx4 a[128:131], v1, s[8:11], s76 offen offset:0 sc1
  v_mfma_f32_16x16x32_bf16 v[124:127], a[176:179], a[44:47], v[124:127]
  ds_read_b64_tr_b16 a[174:175], v7 offset:10240
  v_mfma_f32_16x16x32_bf16 v[124:127], a[180:183], a[60:63], v[124:127]
  v_mfma_f32_16x16x32_bf16 v[120:123], a[180:183], a[56:59], v[120:123]
  ds_read_b64_tr_b16 a[168:169], v7 offset:12288
  v_mfma_f32_16x16x32_bf16 v[120:123], a[176:179], a[40:43], v[120:123]
  buffer_load_dwordx4 a[144:147], v1, s[8:11], s76 offen offset:1024 sc1
  v_mfma_f32_16x16x32_bf16 v[116:119], a[176:179], a[36:39], v[116:119]
  ds_read_b64_tr_b16 a[170:171], v7 offset:14336
  v_mfma_f32_16x16x32_bf16 v[116:119], a[180:183], a[52:55], v[116:119]
  v_mfma_f32_16x16x32_bf16 v[112:115], a[180:183], a[48:51], v[112:115]
  ds_read_b64_tr_b16 a[180:181], v8 offset:8192
  v_mfma_f32_16x16x32_bf16 v[112:115], a[176:179], a[32:35], v[112:115]
  s_waitcnt lgkmcnt(5)
  s_add_u32 s76, s76, 131072
  v_mfma_f32_16x16x32_bf16 v[128:131], a[164:167], a[32:35], v[128:131]
  ds_read_b64_tr_b16 a[182:183], v8 offset:10240
  v_mfma_f32_16x16x32_bf16 v[128:131], a[160:163], a[48:51], v[128:131]
  buffer_load_dwordx4 a[132:135], v1, s[8:11], s76 offen offset:0 sc1
  v_mfma_f32_16x16x32_bf16 v[132:135], a[160:163], a[52:55], v[132:135]
  ds_read_b64_tr_b16 a[176:177], v8 offset:12288
  v_mfma_f32_16x16x32_bf16 v[132:135], a[164:167], a[36:39], v[132:135]
  v_mfma_f32_16x16x32_bf16 v[136:139], a[164:167], a[40:43], v[136:139]
  ds_read_b64_tr_b16 a[178:179], v8 offset:14336
  v_mfma_f32_16x16x32_bf16 v[136:139], a[160:163], a[56:59], v[136:139]
  buffer_load_dwordx4 a[148:151], v1, s[8:11], s76 offen offset:1024 sc1
  v_mfma_f32_16x16x32_bf16 v[140:143], a[160:163], a[60:63], v[140:143]
  ds_read_b64_tr_b16 a[160:161], v9 offset:8192
  v_mfma_f32_16x16x32_bf16 v[140:143], a[164:167], a[44:47], v[140:143]
  s_waitcnt lgkmcnt(5)
  s_add_u32 s76, s76, s88
  v_mfma_f32_16x16x32_bf16 v[156:159], a[172:175], a[44:47], v[156:159]
  ds_read_b64_tr_b16 a[162:163], v9 offset:10240
  v_mfma_f32_16x16x32_bf16 v[156:159], a[168:171], a[60:63], v[156:159]
  buffer_load_dwordx4 a[136:139], v1, s[8:11], s76 offen offset:0 sc1
  v_mfma_f32_16x16x32_bf16 v[152:155], a[168:171], a[56:59], v[152:155]
  ds_read_b64_tr_b16 a[164:165], v9 offset:12288
  v_mfma_f32_16x16x32_bf16 v[152:155], a[172:175], a[40:43], v[152:155]
  v_mfma_f32_16x16x32_bf16 v[148:151], a[172:175], a[36:39], v[148:151]
  ds_read_b64_tr_b16 a[166:167], v9 offset:14336
  v_mfma_f32_16x16x32_bf16 v[148:151], a[168:171], a[52:55], v[148:151]
  buffer_load_dwordx4 a[152:155], v1, s[8:11], s76 offen offset:1024 sc1
  v_mfma_f32_16x16x32_bf16 v[144:147], a[168:171], a[48:51], v[144:147]
  ds_read_b64_tr_b16 a[168:169], v2 offset:0
  v_mfma_f32_16x16x32_bf16 v[144:147], a[172:175], a[32:35], v[144:147]
  s_waitcnt lgkmcnt(5)
  v_mfma_f32_16x16x32_bf16 v[160:163], a[180:183], a[32:35], v[160:163]
  ds_read_b64_tr_b16 a[170:171], v2 offset:2048
  v_mfma_f32_16x16x32_bf16 v[160:163], a[176:179], a[48:51], v[160:163]
  s_add_u32 s76, s76, 131072
  v_mfma_f32_16x16x32_bf16 v[164:167], a[176:179], a[52:55], v[164:167]
  ds_read_b64_tr_b16 a[172:173], v2 offset:4096
  v_mfma_f32_16x16x32_bf16 v[164:167], a[180:183], a[36:39], v[164:167]
  buffer_load_dwordx4 a[140:143], v1, s[8:11], s76 offen offset:0 sc1
  v_mfma_f32_16x16x32_bf16 v[168:171], a[180:183], a[40:43], v[168:171]
  ds_read_b64_tr_b16 a[174:175], v2 offset:6144
  v_mfma_f32_16x16x32_bf16 v[168:171], a[176:179], a[56:59], v[168:171]
  v_mfma_f32_16x16x32_bf16 v[172:175], a[176:179], a[60:63], v[172:175]
  ds_read_b64_tr_b16 a[176:177], v3 offset:0
  v_mfma_f32_16x16x32_bf16 v[172:175], a[180:183], a[44:47], v[172:175]
  s_waitcnt lgkmcnt(5)
  buffer_load_dwordx4 a[156:159], v1, s[8:11], s76 offen offset:1024 sc1
  v_mfma_f32_16x16x32_bf16 v[188:191], a[160:163], a[44:47], v[188:191]
  ds_read_b64_tr_b16 a[178:179], v3 offset:2048
  v_mfma_f32_16x16x32_bf16 v[188:191], a[164:167], a[60:63], v[188:191]
  s_cmp_eq_u32 s90, 0
  s_cselect_b32 s77, 7, 0
  s_lshl_b32 s69, s77, 17
  s_lshl_b32 s77, s77, 11
  s_add_u32 s77, s77, s83
  s_add_u32 m0, s45, 16384
  v_mfma_f32_16x16x32_bf16 v[184:187], a[164:167], a[56:59], v[184:187]
  ds_read_b64_tr_b16 a[180:181], v3 offset:4096
  v_mfma_f32_16x16x32_bf16 v[184:187], a[160:163], a[40:43], v[184:187]
  buffer_load_dwordx4 v32, s[36:39], s69 offen lds
  v_mfma_f32_16x16x32_bf16 v[180:183], a[160:163], a[36:39], v[180:183]
  ds_read_b64_tr_b16 a[182:183], v3 offset:6144
  v_mfma_f32_16x16x32_bf16 v[180:183], a[164:167], a[52:55], v[180:183]
  s_add_u32 m0, s45, 20480
  s_add_u32 s60, s69, 65536
  v_mfma_f32_16x16x32_bf16 v[176:179], a[164:167], a[48:51], v[176:179]
  ds_read_b64_tr_b16 a[164:165], v4 offset:0
  v_mfma_f32_16x16x32_bf16 v[176:179], a[160:163], a[32:35], v[176:179]
  s_waitcnt vmcnt(29) lgkmcnt(5)
  buffer_load_dwordx4 v32, s[36:39], s60 offen lds
  v_mfma_f32_16x16x32_bf16 v[64:67], a[168:171], a[64:67], v[64:67]
  ds_read_b64_tr_b16 a[166:167], v4 offset:2048
  v_mfma_f32_16x16x32_bf16 v[64:67], a[172:175], a[80:83], v[64:67]
  v_mfma_f32_16x16x32_bf16 v[68:71], a[172:175], a[84:87], v[68:71]
  ds_read_b64_tr_b16 a[160:161], v4 offset:4096
  v_mfma_f32_16x16x32_bf16 v[68:71], a[168:171], a[68:71], v[68:71]
  s_add_u32 m0, s45, 24576
  v_mfma_f32_16x16x32_bf16 v[72:75], a[168:171], a[72:75], v[72:75]
  ds_read_b64_tr_b16 a[162:163], v4 offset:6144
  v_mfma_f32_16x16x32_bf16 v[72:75], a[172:175], a[88:91], v[72:75]
  buffer_load_dwordx4 v33, s[36:39], s69 offen lds
  v_mfma_f32_16x16x32_bf16 v[76:79], a[172:175], a[92:95], v[76:79]
  ds_read_b64_tr_b16 a[172:173], v5 offset:0
  v_mfma_f32_16x16x32_bf16 v[76:79], a[168:171], a[76:79], v[76:79]
  s_waitcnt lgkmcnt(5)
  s_add_u32 m0, s45, 28672
  s_add_u32 s60, s69, 65536
  v_mfma_f32_16x16x32_bf16 v[92:95], a[176:179], a[76:79], v[92:95]
  ds_read_b64_tr_b16 a[174:175], v5 offset:2048
  v_mfma_f32_16x16x32_bf16 v[92:95], a[180:183], a[92:95], v[92:95]
  buffer_load_dwordx4 v33, s[36:39], s60 offen lds
  v_add_u32 v38, s46, v0
  s_waitcnt vmcnt(14)
  s_barrier
  s_mov_b64 exec, 1
  buffer_store_dword v38, v0, s[8:11], s79 offen offset:0 sc1
  s_mov_b64 exec, -1
  v_mfma_f32_16x16x32_bf16 v[88:91], a[180:183], a[88:91], v[88:91]
  ds_read_b64_tr_b16 a[168:169], v5 offset:4096
  s_lshl_b32 s53, s44, 8
  v_mfma_f32_16x16x32_bf16 v[88:91], a[176:179], a[72:75], v[88:91]
  s_cmp_eq_u32 s90, 1
  s_cselect_b32 s78, 9, 2
  s_lshl_b32 s70, s78, 17
  s_lshl_b32 s78, s78, 11
  s_add_u32 s78, s78, s83
  s_add_u32 m0, s45, 98304
  s_add_u32 s53, s53, 133120
  v_lshrrev_b32 v49, 4, v0
  v_mfma_f32_16x16x32_bf16 v[84:87], a[176:179], a[68:71], v[84:87]
  ds_read_b64_tr_b16 a[170:171], v5 offset:6144
  v_lshl_add_u32 v46, v49, 4, s53
  v_mfma_f32_16x16x32_bf16 v[84:87], a[180:183], a[84:87], v[84:87]
  buffer_load_dwordx4 v32, s[36:39], s70 offen lds
  v_lshlrev_b32 v47, 2, v0
  v_add_u32 v45, s53, v47
  v_mfma_f32_16x16x32_bf16 v[80:83], a[180:183], a[80:83], v[80:83]
  ds_read_b64_tr_b16 a[180:181], v2 offset:8192
  v_lshrrev_b32 v48, 3, v0
  v_mfma_f32_16x16x32_bf16 v[80:83], a[176:179], a[64:67], v[80:83]
  s_waitcnt lgkmcnt(5)
  s_add_u32 m0, s45, 102400
  s_add_u32 s60, s70, 65536
  v_mfma_f32_16x16x32_bf16 v[96:99], a[164:167], a[64:67], v[96:99]
  ds_read_b64_tr_b16 a[182:183], v2 offset:10240
  v_and_b32 v50, 7, v0
  v_mfma_f32_16x16x32_bf16 v[96:99], a[160:163], a[80:83], v[96:99]
  buffer_load_dwordx4 v32, s[36:39], s60 offen lds
  v_xor_b32 v51, v50, v48
  v_lshlrev_b32 v51, 4, v51
  v_mfma_f32_16x16x32_bf16 v[100:103], a[160:163], a[84:87], v[100:103]
  ds_read_b64_tr_b16 a[176:177], v2 offset:12288
  v_lshl_add_u32 v40, v48, 11, v51
  v_mfma_f32_16x16x32_bf16 v[100:103], a[164:167], a[68:71], v[100:103]
  v_bfe_u32 v48, v0, 4, 1
  v_lshrrev_b32 v51, 5, v0
  v_mfma_f32_16x16x32_bf16 v[104:107], a[164:167], a[72:75], v[104:107]
  ds_read_b64_tr_b16 a[178:179], v2 offset:14336
  v_lshl_add_u32 v48, v48, 1, v51
  v_mfma_f32_16x16x32_bf16 v[104:107], a[160:163], a[88:91], v[104:107]
  s_cmp_eq_u32 s90, 2
  s_cselect_b32 s71, 11, 4
  s_lshl_b32 s63, s71, 17
  s_lshl_b32 s71, s71, 11
  s_add_u32 s71, s71, s83
  s_add_u32 m0, s45, 114688
  v_xor_b32 v48, v48, v50
  v_lshlrev_b32 v48, 4, v48
  v_mfma_f32_16x16x32_bf16 v[108:111], a[160:163], a[92:95], v[108:111]
  ds_read_b64_tr_b16 a[160:161], v3 offset:8192
  v_and_b32 v50, 15, v0
  v_mfma_f32_16x16x32_bf16 v[108:111], a[164:167], a[76:79], v[108:111]
  s_waitcnt lgkmcnt(5)
  buffer_load_dwordx4 v32, s[36:39], s63 offen lds
  v_lshl_add_u32 v48, v50, 7, v48
  v_mfma_f32_16x16x32_bf16 v[124:127], a[172:175], a[76:79], v[124:127]
  ds_read_b64_tr_b16 a[162:163], v3 offset:10240
  v_add_u32 v42, s89, v48
  v_mfma_f32_16x16x32_bf16 v[124:127], a[168:171], a[92:95], v[124:127]
  s_add_u32 m0, s45, 118784
  s_add_u32 s60, s63, 65536
  v_xor_b32 v43, 64, v42
  v_mfma_f32_16x16x32_bf16 v[120:123], a[168:171], a[88:91], v[120:123]
  ds_read_b64_tr_b16 a[164:165], v3 offset:12288
  v_add_u32 v44, s89, v1
  v_mfma_f32_16x16x32_bf16 v[120:123], a[172:175], a[72:75], v[120:123]
  buffer_load_dwordx4 v32, s[36:39], s60 offen lds
  v_bfe_u32 v48, v0, 2, 2
  v_lshrrev_b32 v49, 4, v0
  v_mfma_f32_16x16x32_bf16 v[116:119], a[172:175], a[68:71], v[116:119]
  ds_read_b64_tr_b16 a[166:167], v3 offset:14336
  v_and_b32 v50, 1, v0
  v_mfma_f32_16x16x32_bf16 v[116:119], a[168:171], a[84:87], v[116:119]
  s_cmp_eq_u32 s90, 3
  s_cselect_b32 s72, 13, 6
  s_lshl_b32 s64, s72, 17
  s_lshl_b32 s72, s72, 11
  s_add_u32 s72, s72, s83
  s_add_u32 m0, s45, 81920
  v_lshlrev_b32 v50, 4, v50
  v_mov_b32 v51, 0xffff
  v_mfma_f32_16x16x32_bf16 v[112:115], a[168:171], a[80:83], v[112:115]
  ds_read_b64_tr_b16 a[168:169], v4 offset:8192
  v_lshlrev_b32 v50, v50, v51
  v_mfma_f32_16x16x32_bf16 v[112:115], a[172:175], a[64:67], v[112:115]
  s_waitcnt lgkmcnt(5)
  buffer_load_dwordx4 v32, s[36:39], s64 offen lds
  v_cmp_eq_u32 vcc, v48, v49
  v_mov_b32 v60, 0
  v_mov_b32 v61, 0
  v_cndmask_b32 v48, 0, v50, vcc
  v_mfma_f32_16x16x32_bf16 v[128:131], a[180:183], a[64:67], v[128:131]
  ds_read_b64_tr_b16 a[170:171], v4 offset:10240
  v_and_b32 v49, 2, v0
  v_mfma_f32_16x16x32_bf16 v[128:131], a[176:179], a[80:83], v[128:131]
  s_add_u32 m0, s45, 86016
  s_add_u32 s60, s64, 65536
  v_cmp_eq_u32 vcc, 0, v49
  v_mov_b32 v54, 0
  v_mov_b32 v55, 0
  v_cndmask_b32 v50, 0, v48, vcc
  v_mfma_f32_16x16x32_bf16 v[132:135], a[176:179], a[84:87], v[132:135]
  ds_read_b64_tr_b16 a[172:173], v4 offset:12288
  v_sub_u32 v51, v48, v50
  v_mfma_f32_16x16x32_bf16 v[132:135], a[180:183], a[68:71], v[132:135]
  buffer_load_dwordx4 v32, s[36:39], s60 offen lds
  v_mfma_f32_16x16x32_bf16 v[136:139], a[180:183], a[72:75], v[136:139]
  ds_read_b64_tr_b16 a[174:175], v4 offset:14336
  v_mfma_f32_16x16x32_bf16 v[136:139], a[176:179], a[88:91], v[136:139]
  v_mfma_f32_16x16x32_bf16 v[140:143], a[176:179], a[92:95], v[140:143]
  ds_read_b64_tr_b16 a[176:177], v5 offset:8192
  v_mfma_f32_16x16x32_bf16 v[140:143], a[180:183], a[76:79], v[140:143]
  s_waitcnt lgkmcnt(5)
  s_add_u32 m0, s45, 106496
  v_mfma_f32_16x16x32_bf16 v[156:159], a[160:163], a[76:79], v[156:159]
  ds_read_b64_tr_b16 a[178:179], v5 offset:10240
  v_mfma_f32_16x16x32_bf16 v[156:159], a[164:167], a[92:95], v[156:159]
  buffer_load_dwordx4 v33, s[36:39], s70 offen lds
  v_mfma_f32_16x16x32_bf16 v[152:155], a[164:167], a[88:91], v[152:155]
  ds_read_b64_tr_b16 a[180:181], v5 offset:12288
  v_mfma_f32_16x16x32_bf16 v[152:155], a[160:163], a[72:75], v[152:155]
  s_add_u32 m0, s45, 110592
  s_add_u32 s60, s70, 65536
  v_mfma_f32_16x16x32_bf16 v[148:151], a[160:163], a[68:71], v[148:151]
  ds_read_b64_tr_b16 a[182:183], v5 offset:14336
  buffer_load_dwordx4 v33, s[36:39], s60 offen lds
  v_mfma_f32_16x16x32_bf16 v[148:151], a[164:167], a[84:87], v[148:151]
  s_waitcnt vmcnt(31)
  s_barrier
  v_mfma_f32_16x16x32_bf16 v[144:147], a[164:167], a[80:83], v[144:147]
  ds_read_b64_tr_b16 a[164:165], v2 offset:32768
  v_mfma_f32_16x16x32_bf16 v[144:147], a[160:163], a[64:67], v[144:147]
  s_waitcnt lgkmcnt(5)
  s_cmp_eq_u32 s90, 0
  s_cselect_b32 s73, 0, 7
  s_lshl_b32 s65, s73, 17
  s_lshl_b32 s73, s73, 11
  s_add_u32 s73, s73, s83
  s_add_u32 m0, s45, 65536
  v_mfma_f32_16x16x32_bf16 v[160:163], a[168:171], a[64:67], v[160:163]
  ds_read_b64_tr_b16 a[166:167], v2 offset:34816
  v_mfma_f32_16x16x32_bf16 v[160:163], a[172:175], a[80:83], v[160:163]
  buffer_load_dwordx4 v32, s[36:39], s65 offen lds
  v_mfma_f32_16x16x32_bf16 v[164:167], a[172:175], a[84:87], v[164:167]
  ds_read_b64_tr_b16 a[160:161], v2 offset:36864
  v_mfma_f32_16x16x32_bf16 v[164:167], a[168:171], a[68:71], v[164:167]
  s_add_u32 m0, s45, 69632
  s_add_u32 s60, s65, 65536
  v_mfma_f32_16x16x32_bf16 v[168:171], a[168:171], a[72:75], v[168:171]
  ds_read_b64_tr_b16 a[162:163], v2 offset:38912
  v_mfma_f32_16x16x32_bf16 v[168:171], a[172:175], a[88:91], v[168:171]
  buffer_load_dwordx4 v32, s[36:39], s60 offen lds
  v_mfma_f32_16x16x32_bf16 v[172:175], a[172:175], a[92:95], v[172:175]
  ds_read_b64_tr_b16 a[172:173], v3 offset:32768
  v_mfma_f32_16x16x32_bf16 v[172:175], a[168:171], a[76:79], v[172:175]
  s_waitcnt lgkmcnt(5)
  v_mfma_f32_16x16x32_bf16 v[188:191], a[176:179], a[76:79], v[188:191]
  ds_read_b64_tr_b16 a[174:175], v3 offset:34816
  v_mfma_f32_16x16x32_bf16 v[188:191], a[180:183], a[92:95], v[188:191]
  s_add_u32 s61, s87, 0
  v_mfma_f32_16x16x32_bf16 v[184:187], a[180:183], a[88:91], v[184:187]
  ds_read_b64_tr_b16 a[168:169], v3 offset:36864
  v_mfma_f32_16x16x32_bf16 v[184:187], a[176:179], a[72:75], v[184:187]
  buffer_load_dword v240, v47, s[8:11], s61 offen sc1
  v_mfma_f32_16x16x32_bf16 v[180:183], a[176:179], a[68:71], v[180:183]
  ds_read_b64_tr_b16 a[170:171], v3 offset:38912
  v_mfma_f32_16x16x32_bf16 v[180:183], a[180:183], a[84:87], v[180:183]
  s_add_u32 s61, s87, 24576
  v_mfma_f32_16x16x32_bf16 v[176:179], a[180:183], a[80:83], v[176:179]
  ds_read_b64_tr_b16 a[180:181], v4 offset:32768
  v_mfma_f32_16x16x32_bf16 v[176:179], a[176:179], a[64:67], v[176:179]
  s_waitcnt vmcnt(24) lgkmcnt(5)
  buffer_load_dword v241, v47, s[8:11], s61 offen sc1
  v_mfma_f32_16x16x32_bf16 v[64:67], a[164:167], a[96:99], v[64:67]
  ds_read_b64_tr_b16 a[182:183], v4 offset:34816
  v_mfma_f32_16x16x32_bf16 v[64:67], a[160:163], a[112:115], v[64:67]
  s_add_u32 s61, s87, 49152
  v_mfma_f32_16x16x32_bf16 v[68:71], a[160:163], a[116:119], v[68:71]
  ds_read_b64_tr_b16 a[176:177], v4 offset:36864
  v_mfma_f32_16x16x32_bf16 v[68:71], a[164:167], a[100:103], v[68:71]
  buffer_load_dword v242, v47, s[8:11], s61 offen sc1
  v_mfma_f32_16x16x32_bf16 v[72:75], a[164:167], a[104:107], v[72:75]
  ds_read_b64_tr_b16 a[178:179], v4 offset:38912
  v_mfma_f32_16x16x32_bf16 v[72:75], a[160:163], a[120:123], v[72:75]
  s_add_u32 s61, s87, 73728
  v_mfma_f32_16x16x32_bf16 v[76:79], a[160:163], a[124:127], v[76:79]
  ds_read_b64_tr_b16 a[160:161], v5 offset:32768
  v_mfma_f32_16x16x32_bf16 v[76:79], a[164:167], a[108:111], v[76:79]
  s_waitcnt lgkmcnt(5)
  buffer_load_dword v243, v47, s[8:11], s61 offen sc1
  v_mfma_f32_16x16x32_bf16 v[92:95], a[172:175], a[108:111], v[92:95]
  ds_read_b64_tr_b16 a[162:163], v5 offset:34816
  v_mfma_f32_16x16x32_bf16 v[92:95], a[168:171], a[124:127], v[92:95]
  v_mfma_f32_16x16x32_bf16 v[88:91], a[168:171], a[120:123], v[88:91]
  ds_read_b64_tr_b16 a[164:165], v5 offset:36864
  v_mfma_f32_16x16x32_bf16 v[88:91], a[172:175], a[104:107], v[88:91]
  s_cmp_eq_u32 s90, 1
  s_cselect_b32 s74, 2, 9
  s_lshl_b32 s66, s74, 17
  s_lshl_b32 s74, s74, 11
  s_add_u32 s74, s74, s83
  s_add_u32 m0, s45, 0
  v_mfma_f32_16x16x32_bf16 v[84:87], a[172:175], a[100:103], v[84:87]
  ds_read_b64_tr_b16 a[166:167], v5 offset:38912
  v_mfma_f32_16x16x32_bf16 v[84:87], a[168:171], a[116:119], v[84:87]
  buffer_load_dwordx4 v32, s[36:39], s66 offen lds
  v_mfma_f32_16x16x32_bf16 v[80:83], a[168:171], a[112:115], v[80:83]
  ds_read_b64_tr_b16 a[168:169], v2 offset:40960
  v_mfma_f32_16x16x32_bf16 v[80:83], a[172:175], a[96:99], v[80:83]
  s_waitcnt lgkmcnt(5)
  s_add_u32 m0, s45, 4096
  s_add_u32 s60, s66, 65536
  v_mfma_f32_16x16x32_bf16 v[96:99], a[180:183], a[96:99], v[96:99]
  ds_read_b64_tr_b16 a[170:171], v2 offset:43008
  v_mfma_f32_16x16x32_bf16 v[96:99], a[176:179], a[112:115], v[96:99]
  s_sub_u32 s81, s81, 491520
  buffer_load_dwordx4 v32, s[36:39], s60 offen lds
  v_mfma_f32_16x16x32_bf16 v[100:103], a[176:179], a[116:119], v[100:103]
  ds_read_b64_tr_b16 a[172:173], v2 offset:45056
  s_lshl_b32 s82, s44, 28
  s_add_u32 s82, s82, s81
  buffer_load_dword v36, v37, s[8:11], s82 offen sc1
  v_mfma_f32_16x16x32_bf16 v[100:103], a[180:183], a[100:103], v[100:103]
  s_add_u32 m0, s45, 122880
  v_mfma_f32_16x16x32_bf16 v[104:107], a[180:183], a[104:107], v[104:107]
  ds_read_b64_tr_b16 a[174:175], v2 offset:47104
  v_mfma_f32_16x16x32_bf16 v[104:107], a[176:179], a[120:123], v[104:107]
  buffer_load_dwordx4 v33, s[36:39], s63 offen lds
  v_mfma_f32_16x16x32_bf16 v[108:111], a[176:179], a[124:127], v[108:111]
  ds_read_b64_tr_b16 a[176:177], v3 offset:40960
HOP17:
  s_cbranch_execz WRET1
  v_mfma_f32_16x16x32_bf16 v[108:111], a[180:183], a[108:111], v[108:111]
  s_waitcnt lgkmcnt(5)
  s_add_u32 m0, s45, 126976
  s_add_u32 s60, s63, 65536
  v_mfma_f32_16x16x32_bf16 v[124:127], a[160:163], a[108:111], v[124:127]
  ds_read_b64_tr_b16 a[178:179], v3 offset:43008
  v_mfma_f32_16x16x32_bf16 v[124:127], a[164:167], a[124:127], v[124:127]
  buffer_load_dwordx4 v33, s[36:39], s60 offen lds
  v_mfma_f32_16x16x32_bf16 v[120:123], a[164:167], a[120:123], v[120:123]
  ds_read_b64_tr_b16 a[180:181], v3 offset:45056
  v_mfma_f32_16x16x32_bf16 v[120:123], a[160:163], a[104:107], v[120:123]
  v_mfma_f32_16x16x32_bf16 v[116:119], a[160:163], a[100:103], v[116:119]
  ds_read_b64_tr_b16 a[182:183], v3 offset:47104
  v_mfma_f32_16x16x32_bf16 v[116:119], a[164:167], a[116:119], v[116:119]
  s_add_u32 m0, s45, 90112
  v_mfma_f32_16x16x32_bf16 v[112:115], a[164:167], a[112:115], v[112:115]
  ds_read_b64_tr_b16 a[164:165], v4 offset:40960
  v_mfma_f32_16x16x32_bf16 v[112:115], a[160:163], a[96:99], v[112:115]
  s_waitcnt lgkmcnt(5)
  buffer_load_dwordx4 v33, s[36:39], s64 offen lds
  v_mfma_f32_16x16x32_bf16 v[128:131], a[168:171], a[96:99], v[128:131]
  ds_read_b64_tr_b16 a[166:167], v4 offset:43008
  v_mfma_f32_16x16x32_bf16 v[128:131], a[172:175], a[112:115], v[128:131]
  s_add_u32 m0, s45, 94208
  s_add_u32 s60, s64, 65536
  v_mfma_f32_16x16x32_bf16 v[132:135], a[172:175], a[116:119], v[132:135]
  ds_read_b64_tr_b16 a[160:161], v4 offset:45056
  v_mfma_f32_16x16x32_bf16 v[132:135], a[168:171], a[100:103], v[132:135]
  buffer_load_dwordx4 v33, s[36:39], s60 offen lds
  v_mfma_f32_16x16x32_bf16 v[136:139], a[168:171], a[104:107], v[136:139]
  ds_read_b64_tr_b16 a[162:163], v4 offset:47104
  v_mfma_f32_16x16x32_bf16 v[136:139], a[172:175], a[120:123], v[136:139]
  s_add_u32 m0, s45, 73728
  v_mfma_f32_16x16x32_bf16 v[140:143], a[172:175], a[124:127], v[140:143]
  ds_read_b64_tr_b16 a[172:173], v5 offset:40960
  v_mfma_f32_16x16x32_bf16 v[140:143], a[168:171], a[108:111], v[140:143]
  s_waitcnt lgkmcnt(5)
  buffer_load_dwordx4 v33, s[36:39], s65 offen lds
  v_mfma_f32_16x16x32_bf16 v[156:159], a[176:179], a[108:111], v[156:159]
  ds_read_b64_tr_b16 a[174:175], v5 offset:43008
  v_mfma_f32_16x16x32_bf16 v[156:159], a[180:183], a[124:127], v[156:159]
  s_add_u32 m0, s45, 77824
  s_add_u32 s60, s65, 65536
  v_mfma_f32_16x16x32_bf16 v[152:155], a[180:183], a[120:123], v[152:155]
  ds_read_b64_tr_b16 a[168:169], v5 offset:45056
  v_mfma_f32_16x16x32_bf16 v[152:155], a[176:179], a[104:107], v[152:155]
  buffer_load_dwordx4 v33, s[36:39], s60 offen lds
  v_mfma_f32_16x16x32_bf16 v[148:151], a[176:179], a[100:103], v[148:151]
  ds_read_b64_tr_b16 a[170:171], v5 offset:47104
  v_mfma_f32_16x16x32_bf16 v[148:151], a[180:183], a[116:119], v[148:151]
  v_mfma_f32_16x16x32_bf16 v[144:147], a[180:183], a[112:115], v[144:147]
  ds_read_b64_tr_b16 a[180:181], v2 offset:49152
  v_mfma_f32_16x16x32_bf16 v[144:147], a[176:179], a[96:99], v[144:147]
  s_waitcnt lgkmcnt(5)
  v_mfma_f32_16x16x32_bf16 v[160:163], a[164:167], a[96:99], v[160:163]
  ds_read_b64_tr_b16 a[182:183], v2 offset:51200
  v_mfma_f32_16x16x32_bf16 v[160:163], a[160:163], a[112:115], v[160:163]
  v_mfma_f32_16x16x32_bf16 v[164:167], a[160:163], a[116:119], v[164:167]
  ds_read_b64_tr_b16 a[176:177], v2 offset:53248
  v_mfma_f32_16x16x32_bf16 v[164:167], a[164:167], a[100:103], v[164:167]
  v_mfma_f32_16x16x32_bf16 v[168:171], a[164:167], a[104:107], v[168:171]
  ds_read_b64_tr_b16 a[178:179], v2 offset:55296
  v_mfma_f32_16x16x32_bf16 v[168:171], a[160:163], a[120:123], v[168:171]
  v_mfma_f32_16x16x32_bf16 v[172:175], a[160:163], a[124:127], v[172:175]
  ds_read_b64_tr_b16 a[160:161], v3 offset:49152
  v_mfma_f32_16x16x32_bf16 v[172:175], a[164:167], a[108:111], v[172:175]
  s_waitcnt lgkmcnt(5)
  v_mfma_f32_16x16x32_bf16 v[188:191], a[172:175], a[108:111], v[188:191]
  ds_read_b64_tr_b16 a[162:163], v3 offset:51200
  v_mfma_f32_16x16x32_bf16 v[188:191], a[168:171], a[124:127], v[188:191]
  v_mfma_f32_16x16x32_bf16 v[184:187], a[168:171], a[120:123], v[184:187]
  ds_read_b64_tr_b16 a[164:165], v3 offset:53248
  s_waitcnt vmcnt(6)
  s_cmp_lg_u32 s44, 0
  s_cbranch_scc1 PL13_adaLN_cond__sliding_local_dilated__swiglu_ffn__prompt_kernelx
  v_cmp_ne_u32 vcc, s46, v36
  s_nop 4
  s_cbranch_vccz PL13_adaLN_cond__sliding_local_dilated__swiglu_ffn__prompt_kernelx
  s_mov_b32 s82, 60000
PL13_adaLN_cond__sliding_local_dilated__swiglu_ffn__prompt_kernel:
  buffer_load_dword v36, v37, s[8:11], s81 offen sc1
  s_sub_u32 s82, s82, 1
  s_cmp_eq_u32 s82, 0
  s_waitcnt vmcnt(0)
  s_cbranch_scc1 PL13_adaLN_cond__sliding_local_dilated__swiglu_ffn__prompt_kernelx
  v_cmp_ne_u32 vcc, s46, v36
  s_nop 4
  s_cbranch_vccnz PL13_adaLN_cond__sliding_local_dilated__swiglu_ffn__prompt_kernel
PL13_adaLN_cond__sliding_local_dilated__swiglu_ffn__prompt_kernelx:
  s_barrier
  v_mfma_f32_16x16x32_bf16 v[184:187], a[172:175], a[104:107], v[184:187]
  v_mfma_f32_16x16x32_bf16 v[180:183], a[172:175], a[100:103], v[180:183]
  ds_read_b64_tr_b16 a[166:167], v3 offset:55296
  v_mfma_f32_16x16x32_bf16 v[180:183], a[168:171], a[116:119], v[180:183]
  buffer_load_dwordx4 a[188:191], v1, s[8:11], s77 offen offset:0 sc1
  v_mfma_f32_16x16x32_bf16 v[176:179], a[168:171], a[112:115], v[176:179]
  ds_read_b64_tr_b16 a[168:169], v4 offset:49152
  v_mfma_f32_16x16x32_bf16 v[176:179], a[172:175], a[96:99], v[176:179]
  s_waitcnt vmcnt(29) lgkmcnt(5)
  v_mfma_f32_16x16x32_bf16 v[64:67], a[180:183], a[128:131], v[64:67]
  ds_read_b64_tr_b16 a[170:171], v4 offset:51200
  v_mfma_f32_16x16x32_bf16 v[64:67], a[176:179], a[144:147], v[64:67]
  buffer_load_dwordx4 a[204:207], v1, s[8:11], s77 offen offset:1024 sc1
  v_mfma_f32_16x16x32_bf16 v[68:71], a[176:179], a[148:151], v[68:71]
  ds_read_b64_tr_b16 a[172:173], v4 offset:53248
  v_mfma_f32_16x16x32_bf16 v[68:71], a[180:183], a[132:135], v[68:71]
  s_add_u32 s77, s77, 131072
  v_mfma_f32_16x16x32_bf16 v[72:75], a[180:183], a[136:139], v[72:75]
  ds_read_b64_tr_b16 a[174:175], v4 offset:55296
  v_mfma_f32_16x16x32_bf16 v[72:75], a[176:179], a[152:155], v[72:75]
  buffer_load_dwordx4 a[192:195], v1, s[8:11], s77 offen offset:0 sc1
  v_mfma_f32_16x16x32_bf16 v[76:79], a[176:179], a[156:159], v[76:79]
  ds_read_b64_tr_b16 a[176:177], v5 offset:49152
  v_mfma_f32_16x16x32_bf16 v[76:79], a[180:183], a[140:143], v[76:79]
  s_waitcnt lgkmcnt(5)
  v_mfma_f32_16x16x32_bf16 v[92:95], a[160:163], a[140:143], v[92:95]
  ds_read_b64_tr_b16 a[178:179], v5 offset:51200
  v_mfma_f32_16x16x32_bf16 v[92:95], a[164:167], a[156:159], v[92:95]
  v_mfma_f32_16x16x32_bf16 v[88:91], a[164:167], a[152:155], v[88:91]
  ds_read_b64_tr_b16 a[180:181], v5 offset:53248
  v_mfma_f32_16x16x32_bf16 v[88:91], a[160:163], a[136:139], v[88:91]
  buffer_load_dwordx4 a[208:211], v1, s[8:11], s77 offen offset:1024 sc1
  v_mfma_f32_16x16x32_bf16 v[84:87], a[160:163], a[132:135], v[84:87]
  ds_read_b64_tr_b16 a[182:183], v5 offset:55296
  v_mfma_f32_16x16x32_bf16 v[84:87], a[164:167], a[148:151], v[84:87]
  s_add_u32 s77, s77, s88
  v_mfma_f32_16x16x32_bf16 v[80:83], a[164:167], a[144:147], v[80:83]
  ds_read_b64_tr_b16 a[164:165], v2 offset:57344
  v_mfma_f32_16x16x32_bf16 v[80:83], a[160:163], a[128:131], v[80:83]
  s_waitcnt lgkmcnt(5)
  buffer_load_dwordx4 a[196:199], v1, s[8:11], s77 offen offset:0 sc1
  v_mfma_f32_16x16x32_bf16 v[96:99], a[168:171], a[128:131], v[96:99]
  ds_read_b64_tr_b16 a[166:167], v2 offset:59392
  v_mfma_f32_16x16x32_bf16 v[96:99], a[172:175], a[144:147], v[96:99]
  v_mfma_f32_16x16x32_bf16 v[100:103], a[172:175], a[148:151], v[100:103]
  ds_read_b64_tr_b16 a[160:161], v2 offset:61440
  v_mfma_f32_16x16x32_bf16 v[100:103], a[168:171], a[132:135], v[100:103]
  buffer_load_dwordx4 a[212:215], v1, s[8:11], s77 offen offset:1024 sc1
  v_mfma_f32_16x16x32_bf16 v[104:107], a[168:171], a[136:139], v[104:107]
  ds_read_b64_tr_b16 a[162:163], v2 offset:63488
  v_mfma_f32_16x16x32_bf16 v[104:107], a[172:175], a[152:155], v[104:107]
  s_add_u32 s77, s77, 131072
  v_mfma_f32_16x16x32_bf16 v[108:111], a[172:175], a[156:159], v[108:111]
  ds_read_b64_tr_b16 a[172:173], v3 offset:57344
  v_mfma_f32_16x16x32_bf16 v[108:111], a[168:171], a[140:143], v[108:111]
  s_waitcnt lgkmcnt(5)
  buffer_load_dwordx4 a[200:203], v1, s[8:11], s77 offen offset:0 sc1
  v_mfma_f32_16x16x32_bf16 v[124:127], a[176:179], a[140:143], v[124:127]
  ds_read_b64_tr_b16 a[174:175], v3 offset:59392
  v_mfma_f32_16x16x32_bf16 v[124:127], a[180:183], a[156:159], v[124:127]
  v_mfma_f32_16x16x32_bf16 v[120:123], a[180:183], a[152:155], v[120:123]
  ds_read_b64_tr_b16 a[168:169], v3 offset:61440
  v_mfma_f32_16x16x32_bf16 v[120:123], a[176:179], a[136:139], v[120:123]
  v_mfma_f32_16x16x32_bf16 v[116:119], a[176:179], a[132:135], v[116:119]
  ds_read_b64_tr_b16 a[170:171], v3 offset:63488
  v_mfma_f32_16x16x32_bf16 v[116:119], a[180:183], a[148:151], v[116:119]
  buffer_load_dwordx4 a[216:219], v1, s[8:11], s77 offen offset:1024 sc1
  v_mfma_f32_16x16x32_bf16 v[112:115], a[180:183], a[144:147], v[112:115]
  ds_read_b64_tr_b16 a[180:181], v4 offset:57344
  v_mfma_f32_16x16x32_bf16 v[112:115], a[176:179], a[128:131], v[112:115]
  s_waitcnt lgkmcnt(5)
  v_mfma_f32_16x16x32_bf16 v[128:131], a[164:167], a[128:131], v[128:131]
  ds_read_b64_tr_b16 a[182:183], v4 offset:59392
  v_mfma_f32_16x16x32_bf16 v[128:131], a[160:163], a[144:147], v[128:131]
  buffer_load_dwordx4 a[220:223], v1, s[8:11], s78 offen offset:0 sc1
  v_mfma_f32_16x16x32_bf16 v[132:135], a[160:163], a[148:151], v[132:135]
  ds_read_b64_tr_b16 a[176:177], v4 offset:61440
  v_mfma_f32_16x16x32_bf16 v[132:135], a[164:167], a[132:135], v[132:135]
  v_mfma_f32_16x16x32_bf16 v[136:139], a[164:167], a[136:139], v[136:139]
  ds_read_b64_tr_b16 a[178:179], v4 offset:63488
  v_mfma_f32_16x16x32_bf16 v[136:139], a[160:163], a[152:155], v[136:139]
  buffer_load_dwordx4 a[236:239], v1, s[8:11], s78 offen offset:1024 sc1
  v_mfma_f32_16x16x32_bf16 v[140:143], a[160:163], a[156:159], v[140:143]
  ds_read_b64_tr_b16 a[160:161], v5 offset:57344
  v_mfma_f32_16x16x32_bf16 v[140:143], a[164:167], a[140:143], v[140:143]
  s_waitcnt lgkmcnt(5)
  s_add_u32 s78, s78, 131072
  v_mfma_f32_16x16x32_bf16 v[156:159], a[172:175], a[140:143], v[156:159]
  ds_read_b64_tr_b16 a[162:163], v5 offset:59392
  v_mfma_f32_16x16x32_bf16 v[156:159], a[168:171], a[156:159], v[156:159]
  buffer_load_dwordx4 a[224:227], v1, s[8:11], s78 offen offset:0 sc1
  ds_read_b128 v[192:195], v44 offset:0
  v_mfma_f32_16x16x32_bf16 v[152:155], a[168:171], a[152:155], v[152:155]
  ds_read_b64_tr_b16 a[164:165], v5 offset:61440
  v_mfma_f32_16x16x32_bf16 v[152:155], a[172:175], a[136:139], v[152:155]
  ds_read_b128 v[196:199], v44 offset:1024
  v_mfma_f32_16x16x32_bf16 v[148:151], a[172:175], a[132:135], v[148:151]
  ds_read_b64_tr_b16 a[166:167], v5 offset:63488
  v_mfma_f32_16x16x32_bf16 v[148:151], a[168:171], a[148:151], v[148:151]
  s_waitcnt vmcnt(35)
  s_barrier
  v_mfma_f32_16x16x32_bf16 v[144:147], a[168:171], a[144:147], v[144:147]
  ds_read_b64_tr_b16 a[168:169], v2 offset:16384
  v_mfma_f32_16x16x32_bf16 v[144:147], a[172:175], a[128:131], v[144:147]
  s_waitcnt lgkmcnt(7)
  buffer_load_dwordx4 a[240:243], v1, s[8:11], s78 offen offset:1024 sc1
  v_mfma_f32_16x16x32_bf16 v[160:163], a[180:183], a[128:131], v[160:163]
  ds_read_b64_tr_b16 a[170:171], v2 offset:18432
  ds_read_b128 v[200:203], v44 offset:2048
  v_mfma_f32_16x16x32_bf16 v[160:163], a[176:179], a[144:147], v[160:163]
  s_add_u32 s78, s78, s88
  ds_read_b128 v[204:207], v44 offset:3072
  v_mfma_f32_16x16x32_bf16 v[164:167], a[176:179], a[148:151], v[164:167]
  ds_read_b64_tr_b16 a[172:173], v2 offset:20480
  s_waitcnt vmcnt(21)
  v_mfma_f32_16x16x32_bf16 v[164:167], a[180:183], a[132:135], v[164:167]
  buffer_load_dwordx4 a[228:231], v1, s[8:11], s78 offen offset:0 sc1
  v_add_f32 v240, v240, v241
  v_add_f32 v242, v242, v243
  v_mfma_f32_16x16x32_bf16 v[168:171], a[180:183], a[136:139], v[168:171]
  ds_read_b64_tr_b16 a[174:175], v2 offset:22528
  v_add_f32 v240, v240, v242
  v_mfma_f32_16x16x32_bf16 v[168:171], a[176:179], a[152:155], v[168:171]
  v_cvt_pk_bf16_f32 v240, v240, v240
  v_lshlrev_b32 v240, 16, v240
  v_mfma_f32_16x16x32_bf16 v[172:175], a[176:179], a[156:159], v[172:175]
  ds_read_b64_tr_b16 a[176:177], v3 offset:16384
  v_mfma_f32_16x16x32_bf16 v[172:175], a[180:183], a[140:143], v[172:175]
  s_waitcnt lgkmcnt(7)
  buffer_load_dwordx4 a[244:247], v1, s[8:11], s78 offen offset:1024 sc1
  v_mfma_f32_16x16x32_bf16 v[188:191], a[160:163], a[140:143], v[188:191]
  ds_read_b64_tr_b16 a[178:179], v3 offset:18432
  v_mfma_f32_16x16x32_bf16 v[188:191], a[164:167], a[156:159], v[188:191]
  s_add_u32 s78, s78, 131072
  ds_write_b32 v45, v240
  v_mfma_f32_16x16x32_bf16 v[184:187], a[164:167], a[152:155], v[184:187]
  ds_read_b64_tr_b16 a[180:181], v3 offset:20480
  v_mfma_f32_16x16x32_bf16 v[184:187], a[160:163], a[136:139], v[184:187]
  buffer_load_dwordx4 a[232:235], v1, s[8:11], s78 offen offset:0 sc1
  ds_read_b128 v[240:243], v46 offset:0
  v_mfma_f32_16x16x32_bf16 v[180:183], a[160:163], a[132:135], v[180:183]
  ds_read_b64_tr_b16 a[182:183], v3 offset:22528
  v_mfma_f32_16x16x32_bf16 v[180:183], a[164:167], a[148:151], v[180:183]
  ds_read_b128 v[244:247], v46 offset:64
  v_mfma_f32_16x16x32_bf16 v[176:179], a[164:167], a[144:147], v[176:179]
  ds_read_b64_tr_b16 a[164:165], v4 offset:16384
  v_mfma_f32_16x16x32_bf16 v[176:179], a[160:163], a[128:131], v[176:179]
  s_waitcnt vmcnt(7) lgkmcnt(8)
  ds_read_b128 v[248:251], v46 offset:128
  v_mfma_f32_16x16x32_bf16 v[64:67], a[168:171], a[188:191], v[64:67]
  ds_read_b64_tr_b16 a[166:167], v4 offset:18432
  v_mfma_f32_16x16x32_bf16 v[64:67], a[172:175], a[204:207], v[64:67]
  buffer_load_dwordx4 a[248:251], v1, s[8:11], s78 offen offset:1024 sc1
  ds_read_b128 v[252:255], v46 offset:192
  v_mfma_f32_16x16x32_bf16 v[68:71], a[172:175], a[208:211], v[68:71]
  ds_read_b64_tr_b16 a[160:161], v4 offset:20480
  s_waitcnt lgkmcnt(14)
  v_mfma_f32_16x16x32_bf16 v[68:71], a[168:171], a[192:195], v[68:71]
  v_lshlrev_b32 v208, 16, v192
  v_and_b32 v209, 0xffff0000, v192
  v_mfma_f32_16x16x32_bf16 v[72:75], a[168:171], a[196:199], v[72:75]
  ds_read_b64_tr_b16 a[162:163], v4 offset:22528
  v_lshlrev_b32 v210, 16, v193
  v_mfma_f32_16x16x32_bf16 v[72:75], a[172:175], a[212:215], v[72:75]
  buffer_load_dwordx4 a[0:3], v1, s[8:11], s71 offen offset:0 sc1
  v_and_b32 v211, 0xffff0000, v193
  v_lshlrev_b32 v212, 16, v194
  v_mfma_f32_16x16x32_bf16 v[76:79], a[172:175], a[216:219], v[76:79]
  ds_read_b64_tr_b16 a[172:173], v5 offset:16384
  v_and_b32 v213, 0xffff0000, v194
  v_mfma_f32_16x16x32_bf16 v[76:79], a[168:171], a[200:203], v[76:79]
  s_waitcnt lgkmcnt(8)
  v_lshlrev_b32 v214, 16, v195
  v_and_b32 v215, 0xffff0000, v195
  v_mfma_f32_16x16x32_bf16 v[92:95], a[176:179], a[200:203], v[92:95]
  ds_read_b64_tr_b16 a[174:175], v5 offset:18432
  v_lshlrev_b32 v216, 16, v196
  v_mfma_f32_16x16x32_bf16 v[92:95], a[180:183], a[216:219], v[92:95]
  buffer_load_dwordx4 a[16:19], v1, s[8:11], s71 offen offset:1024 sc1
  v_and_b32 v217, 0xffff0000, v196
  v_lshlrev_b32 v218, 16, v197
  v_mfma_f32_16x16x32_bf16 v[88:91], a[180:183], a[212:215], v[88:91]
  ds_read_b64_tr_b16 a[168:169], v5 offset:20480
  v_and_b32 v219, 0xffff0000, v197
  v_mfma_f32_16x16x32_bf16 v[88:91], a[176:179], a[196:199], v[88:91]
  s_add_u32 s71, s71, 131072
  v_lshlrev_b32 v220, 16, v198
  v_and_b32 v221, 0xffff0000, v198
  v_mfma_f32_16x16x32_bf16 v[84:87], a[176:179], a[192:195], v[84:87]
  ds_read_b64_tr_b16 a[170:171], v5 offset:22528
  v_lshlrev_b32 v222, 16, v199
  v_mfma_f32_16x16x32_bf16 v[84:87], a[180:183], a[208:211], v[84:87]
  buffer_load_dwordx4 a[4:7], v1, s[8:11], s71 offen offset:0 sc1
  v_and_b32 v223, 0xffff0000, v199
  v_lshlrev_b32 v224, 16, v200
  v_mfma_f32_16x16x32_bf16 v[80:83], a[180:183], a[204:207], v[80:83]
  ds_read_b64_tr_b16 a[180:181], v2 offset:24576
  v_and_b32 v225, 0xffff0000, v200
  v_mfma_f32_16x16x32_bf16 v[80:83], a[176:179], a[188:191], v[80:83]
  s_waitcnt lgkmcnt(5)
  v_lshlrev_b32 v226, 16, v201
  v_and_b32 v227, 0xffff0000, v201
  v_mfma_f32_16x16x32_bf16 v[96:99], a[164:167], a[188:191], v[96:99]
  ds_read_b64_tr_b16 a[182:183], v2 offset:26624
  v_lshlrev_b32 v228, 16, v202
  v_mfma_f32_16x16x32_bf16 v[96:99], a[160:163], a[204:207], v[96:99]
  v_and_b32 v229, 0xffff0000, v202
  v_lshlrev_b32 v230, 16, v203
  v_mfma_f32_16x16x32_bf16 v[100:103], a[160:163], a[208:211], v[100:103]
  ds_read_b64_tr_b16 a[176:177], v2 offset:28672
  v_and_b32 v231, 0xffff0000, v203
  v_mfma_f32_16x16x32_bf16 v[100:103], a[164:167], a[192:195], v[100:103]
  buffer_load_dwordx4 a[20:23], v1, s[8:11], s71 offen offset:1024 sc1
  v_lshlrev_b32 v232, 16, v204
  v_and_b32 v233, 0xffff0000, v204
  v_mfma_f32_16x16x32_bf16 v[104:107], a[164:167], a[196:199], v[104:107]
  ds_read_b64_tr_b16 a[178:179], v2 offset:30720
  v_lshlrev_b32 v234, 16, v205
  v_mfma_f32_16x16x32_bf16 v[104:107], a[160:163], a[212:215], v[104:107]
  s_add_u32 s71, s71, s88
  v_and_b32 v235, 0xffff0000, v205
  v_lshlrev_b32 v236, 16, v206
  v_mfma_f32_16x16x32_bf16 v[108:111], a[160:163], a[216:219], v[108:111]
  ds_read_b64_tr_b16 a[160:161], v3 offset:24576
  v_and_b32 v237, 0xffff0000, v206
  v_mfma_f32_16x16x32_bf16 v[108:111], a[164:167], a[200:203], v[108:111]
  s_waitcnt lgkmcnt(5)
  buffer_load_dwordx4 a[8:11], v1, s[8:11], s71 offen offset:0 sc1
  v_lshlrev_b32 v238, 16, v207
  v_mfma_f32_16x16x32_bf16 v[124:127], a[172:175], a[200:203], v[124:127]
  ds_read_b64_tr_b16 a[162:163], v3 offset:26624
  v_and_b32 v239, 0xffff0000, v207
  v_mfma_f32_16x16x32_bf16 v[124:127], a[168:171], a[216:219], v[124:127]
  v_mov_b32 v37, 0
  s_waitcnt lgkmcnt(12)
  v_mfma_f32_16x16x32_bf16 v[120:123], a[168:171], a[212:215], v[120:123]
  ds_read_b64_tr_b16 a[164:165], v3 offset:28672
  v_cvt_pk_bf16_f32 v52, v240, v241
  v_mfma_f32_16x16x32_bf16 v[120:123], a[172:175], a[196:199], v[120:123]
  buffer_load_dwordx4 a[24:27], v1, s[8:11], s71 offen offset:1024 sc1
  v_and_b32 v52, v52, v50
  v_cvt_pk_bf16_f32 v53, v242, v243
  v_mfma_f32_16x16x32_bf16 v[116:119], a[172:175], a[192:195], v[116:119]
  ds_read_b64_tr_b16 a[166:167], v3 offset:30720
  v_and_b32 v53, v53, v51
  v_mfma_f32_16x16x32_bf16 v[116:119], a[168:171], a[208:211], v[116:119]
  s_add_u32 s71, s71, 131072
  v_cvt_pk_bf16_f32 v56, v244, v245
  v_and_b32 v56, v56, v50
  v_mfma_f32_16x16x32_bf16 v[112:115], a[168:171], a[204:207], v[112:115]
  ds_read_b64_tr_b16 a[168:169], v4 offset:24576
  v_cvt_pk_bf16_f32 v57, v246, v247
  v_mfma_f32_16x16x32_bf16 v[112:115], a[172:175], a[188:191], v[112:115]
  s_waitcnt lgkmcnt(5)
  buffer_load_dwordx4 a[12:15], v1, s[8:11], s71 offen offset:0 sc1
  v_and_b32 v57, v57, v51
  v_mfma_f32_16x16x32_bf16 v[128:131], a[180:183], a[188:191], v[128:131]
  ds_read_b64_tr_b16 a[170:171], v4 offset:26624
  v_cvt_pk_bf16_f32 v58, v248, v249
  v_mfma_f32_16x16x32_bf16 v[128:131], a[176:179], a[204:207], v[128:131]
  v_and_b32 v58, v58, v50
  v_cvt_pk_bf16_f32 v59, v250, v251
  v_mfma_f32_16x16x32_bf16 v[132:135], a[176:179], a[208:211], v[132:135]
  ds_read_b64_tr_b16 a[172:173], v4 offset:28672
  v_and_b32 v59, v59, v51
  v_mfma_f32_16x16x32_bf16 v[132:135], a[180:183], a[192:195], v[132:135]
  v_cvt_pk_bf16_f32 v62, v252, v253
  v_and_b32 v62, v62, v50
  v_mfma_f32_16x16x32_bf16 v[136:139], a[180:183], a[196:199], v[136:139]
  ds_read_b64_tr_b16 a[174:175], v4 offset:30720
  v_cvt_pk_bf16_f32 v63, v254, v255
  v_mfma_f32_16x16x32_bf16 v[136:139], a[176:179], a[212:215], v[136:139]
  buffer_load_dwordx4 a[28:31], v1, s[8:11], s71 offen offset:1024 sc1
  v_and_b32 v63, v63, v51
  v_mfma_f32_16x16x32_bf16 v[140:143], a[176:179], a[216:219], v[140:143]
  ds_read_b64_tr_b16 a[176:177], v5 offset:24576
  v_mfma_f32_16x16x32_bf16 v[140:143], a[180:183], a[200:203], v[140:143]
  s_waitcnt lgkmcnt(5)
  s_cmp_eq_u32 s90, 2
  s_cselect_b32 s75, 4, 11
  s_lshl_b32 s67, s75, 17
  s_lshl_b32 s75, s75, 11
  s_add_u32 s75, s75, s83
  s_add_u32 m0, s45, 32768
  v_mfma_f32_16x16x32_bf16 v[156:159], a[160:163], a[200:203], v[156:159]
  ds_read_b64_tr_b16 a[178:179], v5 offset:26624
  v_mfma_f32_16x16x32_bf16 v[156:159], a[164:167], a[216:219], v[156:159]
  buffer_load_dwordx4 v32, s[36:39], s67 offen lds
  v_mfma_f32_16x16x32_bf16 v[152:155], a[164:167], a[212:215], v[152:155]
  ds_read_b64_tr_b16 a[180:181], v5 offset:28672
  v_mfma_f32_16x16x32_bf16 v[152:155], a[160:163], a[196:199], v[152:155]
  s_add_u32 m0, s45, 36864
  s_add_u32 s60, s67, 65536
  v_mfma_f32_16x16x32_bf16 v[148:151], a[160:163], a[192:195], v[148:151]
  ds_read_b64_tr_b16 a[182:183], v5 offset:30720
  v_mfma_f32_16x16x32_bf16 v[148:151], a[164:167], a[208:211], v[148:151]
  buffer_load_dwordx4 v32, s[36:39], s60 offen lds
  s_waitcnt vmcnt(45)
  s_barrier
  v_mfma_f32_16x16x32_bf16 v[144:147], a[164:167], a[204:207], v[144:147]
  ds_read_b64_tr_b16 a[164:165], v6 offset:32768
  v_mfma_f32_16x16x32_bf16 v[144:147], a[160:163], a[188:191], v[144:147]
  s_waitcnt lgkmcnt(5)
  s_cmp_eq_u32 s90, 3
  s_cselect_b32 s76, 6, 13
  s_lshl_b32 s68, s76, 17
  s_lshl_b32 s76, s76, 11
  s_add_u32 s76, s76, s83
  s_add_u32 m0, s45, 49152
  v_mfma_f32_16x16x32_bf16 v[160:163], a[168:171], a[188:191], v[160:163]
  ds_read_b64_tr_b16 a[166:167], v6 offset:34816
  v_mfma_f32_16x16x32_bf16 v[160:163], a[172:175], a[204:207], v[160:163]
  buffer_load_dwordx4 v32, s[36:39], s68 offen lds
  v_mfma_f32_16x16x32_bf16 v[164:167], a[172:175], a[208:211], v[164:167]
  ds_read_b64_tr_b16 a[160:161], v6 offset:36864
  v_mfma_f32_16x16x32_bf16 v[164:167], a[168:171], a[192:195], v[164:167]
  v_mfma_f32_16x16x32_bf16 v[168:171], a[168:171], a[196:199], v[168:171]
  ds_read_b64_tr_b16 a[162:163], v6 offset:38912
  v_mfma_f32_16x16x32_bf16 v[168:171], a[172:175], a[212:215], v[168:171]
  s_add_u32 m0, s45, 53248
  s_add_u32 s60, s68, 65536
  v_mfma_f32_16x16x32_bf16 v[172:175], a[172:175], a[216:219], v[172:175]
  ds_read_b64_tr_b16 a[172:173], v7 offset:32768
  v_mfma_f32_16x16x32_bf16 v[172:175], a[168:171], a[200:203], v[172:175]
  s_waitcnt lgkmcnt(5)
  buffer_load_dwordx4 v32, s[36:39], s60 offen lds
  v_mfma_f32_16x16x32_bf16 v[188:191], a[176:179], a[200:203], v[188:191]
  ds_read_b64_tr_b16 a[174:175], v7 offset:34816
  v_mfma_f32_16x16x32_bf16 v[188:191], a[180:183], a[216:219], v[188:191]
  v_mfma_f32_16x16x32_bf16 v[184:187], a[180:183], a[212:215], v[184:187]
  ds_read_b64_tr_b16 a[168:169], v7 offset:36864
  v_mfma_f32_16x16x32_bf16 v[184:187], a[176:179], a[196:199], v[184:187]
  buffer_load_dwordx4 a[32:35], v1, s[8:11], s72 offen offset:0 sc1
  v_mfma_f32_16x16x32_bf16 v[180:183], a[176:179], a[192:195], v[180:183]
  ds_read_b64_tr_b16 a[170:171], v7 offset:38912
  v_mfma_f32_16x16x32_bf16 v[180:183], a[180:183], a[208:211], v[180:183]
  v_mfma_f32_16x16x32_bf16 v[176:179], a[180:183], a[204:207], v[176:179]
  ds_read_b64_tr_b16 a[180:181], v8 offset:32768
  v_mfma_f32_16x16x32_bf16 v[176:179], a[176:179], a[188:191], v[176:179]
  s_waitcnt vmcnt(13) lgkmcnt(5)
  buffer_load_dwordx4 a[48:51], v1, s[8:11], s72 offen offset:1024 sc1
  v_mfma_f32_16x16x32_bf16 v[64:67], a[164:167], a[220:223], v[64:67]
  ds_read_b64_tr_b16 a[182:183], v8 offset:34816
  v_mfma_f32_16x16x32_bf16 v[64:67], a[160:163], a[236:239], v[64:67]
  s_add_u32 s72, s72, 131072
  v_mfma_f32_16x16x32_bf16 v[68:71], a[160:163], a[240:243], v[68:71]
  ds_read_b64_tr_b16 a[176:177], v8 offset:36864
  v_mfma_f32_16x16x32_bf16 v[68:71], a[164:167], a[224:227], v[68:71]
  buffer_load_dwordx4 a[36:39], v1, s[8:11], s72 offen offset:0 sc1
  v_mfma_f32_16x16x32_bf16 v[72:75], a[164:167], a[228:231], v[72:75]
  ds_read_b64_tr_b16 a[178:179], v8 offset:38912
  v_mfma_f32_16x16x32_bf16 v[72:75], a[160:163], a[244:247], v[72:75]
  v_mfma_f32_16x16x32_bf16 v[76:79], a[160:163], a[248:251], v[76:79]
  ds_read_b64_tr_b16 a[160:161], v9 offset:32768
  v_mfma_f32_16x16x32_bf16 v[76:79], a[164:167], a[232:235], v[76:79]
  s_waitcnt lgkmcnt(5)
  v_mfma_f32_16x16x32_bf16 v[92:95], a[172:175], a[232:235], v[92:95]
  ds_read_b64_tr_b16 a[162:163], v9 offset:34816
  v_mfma_f32_16x16x32_bf16 v[92:95], a[168:171], a[248:251], v[92:95]
  buffer_load_dwordx4 a[52:55], v1, s[8:11], s72 offen offset:1024 sc1
  v_mfma_f32_16x16x32_bf16 v[88:91], a[168:171], a[244:247], v[88:91]
  ds_read_b64_tr_b16 a[164:165], v9 offset:36864
  v_mfma_f32_16x16x32_bf16 v[88:91], a[172:175], a[228:231], v[88:91]
  s_add_u32 s72, s72, s88
  v_mfma_f32_16x16x32_bf16 v[84:87], a[172:175], a[224:227], v[84:87]
  ds_read_b64_tr_b16 a[166:167], v9 offset:38912
  v_mfma_f32_16x16x32_bf16 v[84:87], a[168:171], a[240:243], v[84:87]
  buffer_load_dwordx4 a[40:43], v1, s[8:11], s72 offen offset:0 sc1
  v_mfma_f32_16x16x32_bf16 v[80:83], a[168:171], a[236:239], v[80:83]
  ds_read_b64_tr_b16 a[168:169], v6 offset:49152
  v_mfma_f32_16x16x32_bf16 v[80:83], a[172:175], a[220:223], v[80:83]
  s_waitcnt lgkmcnt(5)
  v_mfma_f32_16x16x32_bf16 v[96:99], a[180:183], a[220:223], v[96:99]
  ds_read_b64_tr_b16 a[170:171], v6 offset:51200
  v_mfma_f32_16x16x32_bf16 v[96:99], a[176:179], a[236:239], v[96:99]
  buffer_load_dwordx4 a[56:59], v1, s[8:11], s72 offen offset:1024 sc1
  v_mfma_f32_16x16x32_bf16 v[100:103], a[176:179], a[240:243], v[100:103]
  ds_read_b64_tr_b16 a[172:173], v6 offset:53248
  v_mfma_f32_16x16x32_bf16 v[100:103], a[180:183], a[224:227], v[100:103]
  s_add_u32 s72, s72, 131072
  v_mfma_f32_16x16x32_bf16 v[104:107], a[180:183], a[228:231], v[104:107]
  ds_read_b64_tr_b16 a[174:175], v6 offset:55296
  v_mfma_f32_16x16x32_bf16 v[104:107], a[176:179], a[244:247], v[104:107]
  buffer_load_dwordx4 a[44:47], v1, s[8:11], s72 offen offset:0 sc1
  v_mfma_f32_16x16x32_bf16 v[108:111], a[176:179], a[248:251], v[108:111]
  ds_read_b64_tr_b16 a[176:177], v7 offset:49152
  v_mfma_f32_16x16x32_bf16 v[108:111], a[180:183], a[232:235], v[108:111]
  s_waitcnt lgkmcnt(5)
  v_mfma_f32_16x16x32_bf16 v[124:127], a[160:163], a[232:235], v[124:127]
  ds_read_b64_tr_b16 a[178:179], v7 offset:51200
  v_mfma_f32_16x16x32_bf16 v[124:127], a[164:167], a[248:251], v[124:127]
  v_mfma_f32_16x16x32_bf16 v[120:123], a[164:167], a[244:247], v[120:123]
  ds_read_b64_tr_b16 a[180:181], v7 offset:53248
  v_mfma_f32_16x16x32_bf16 v[120:123], a[160:163], a[228:231], v[120:123]
  buffer_load_dwordx4 a[60:63], v1, s[8:11], s72 offen offset:1024 sc1
  v_mfma_f32_16x16x32_bf16 v[116:119], a[160:163], a[224:227], v[116:119]
  ds_read_b64_tr_b16 a[182:183], v7 offset:55296
  v_mfma_f32_16x16x32_bf16 v[116:119], a[164:167], a[240:243], v[116:119]
  v_mfma_f32_16x16x32_bf16 v[112:115], a[164:167], a[236:239], v[112:115]
  ds_read_b64_tr_b16 a[164:165], v8 offset:49152
  v_mfma_f32_16x16x32_bf16 v[112:115], a[160:163], a[220:223], v[112:115]
  s_waitcnt vmcnt(12) lgkmcnt(5)
  buffer_load_dwordx4 a[64:67], v1, s[8:11], s73 offen offset:0 sc1
  v_mfma_f32_16x16x32_bf16 v[64:67], a[168:171], a[0:3], v[64:67]
  ds_read_b64_tr_b16 a[166:167], v8 offset:51200
  v_mfma_f32_16x16x32_bf16 v[64:67], a[172:175], a[16:19], v[64:67]
  v_mfma_f32_16x16x32_bf16 v[68:71], a[172:175], a[20:23], v[68:71]
  ds_read_b64_tr_b16 a[160:161], v8 offset:53248
  v_mfma_f32_16x16x32_bf16 v[68:71], a[168:171], a[4:7], v[68:71]
  buffer_load_dwordx4 a[80:83], v1, s[8:11], s73 offen offset:1024 sc1
  v_mfma_f32_16x16x32_bf16 v[72:75], a[168:171], a[8:11], v[72:75]
  ds_read_b64_tr_b16 a[162:163], v8 offset:55296
  v_mfma_f32_16x16x32_bf16 v[72:75], a[172:175], a[24:27], v[72:75]
  s_add_u32 s73, s73, 131072
  v_mfma_f32_16x16x32_bf16 v[76:79], a[172:175], a[28:31], v[76:79]
  ds_read_b64_tr_b16 a[172:173], v9 offset:49152
  v_mfma_f32_16x16x32_bf16 v[76:79], a[168:171], a[12:15], v[76:79]
  s_waitcnt lgkmcnt(5)
  buffer_load_dwordx4 a[68:71], v1, s[8:11], s73 offen offset:0 sc1
  v_mfma_f32_16x16x32_bf16 v[92:95], a[176:179], a[12:15], v[92:95]
  ds_read_b64_tr_b16 a[174:175], v9 offset:51200
  v_mfma_f32_16x16x32_bf16 v[92:95], a[180:183], a[28:31], v[92:95]
  v_mfma_f32_16x16x32_bf16 v[88:91], a[180:183], a[24:27], v[88:91]
  ds_read_b64_tr_b16 a[168:169], v9 offset:53248
  v_mfma_f32_16x16x32_bf16 v[88:91], a[176:179], a[8:11], v[88:91]
  v_mfma_f32_16x16x32_bf16 v[84:87], a[176:179], a[4:7], v[84:87]
  ds_read_b64_tr_b16 a[170:171], v9 offset:55296
  buffer_load_dwordx4 a[84:87], v1, s[8:11], s73 offen offset:1024 sc1
  v_mfma_f32_16x16x32_bf16 v[84:87], a[180:183], a[20:23], v[84:87]
  s_waitcnt vmcnt(12)
  s_barrier
  v_mfma_f32_16x16x32_bf16 v[80:83], a[180:183], a[16:19], v[80:83]
  ds_read_b64_tr_b16 a[180:181], v6 offset:16384
  v_mfma_f32_16x16x32_bf16 v[80:83], a[176:179], a[0:3], v[80:83]
  s_waitcnt lgkmcnt(5)
  s_add_u32 s73, s73, s88
  v_mfma_f32_16x16x32_bf16 v[96:99], a[164:167], a[0:3], v[96:99]
  ds_read_b64_tr_b16 a[182:183], v6 offset:18432
  v_mfma_f32_16x16x32_bf16 v[96:99], a[160:163], a[16:19], v[96:99]
  buffer_load_dwordx4 a[72:75], v1, s[8:11], s73 offen offset:0 sc1
  v_mfma_f32_16x16x32_bf16 v[100:103], a[160:163], a[20:23], v[100:103]
  ds_read_b64_tr_b16 a[176:177], v6 offset:20480
  v_mfma_f32_16x16x32_bf16 v[100:103], a[164:167], a[4:7], v[100:103]
  v_mfma_f32_16x16x32_bf16 v[104:107], a[164:167], a[8:11], v[104:107]
  ds_read_b64_tr_b16 a[178:179], v6 offset:22528
  v_mfma_f32_16x16x32_bf16 v[104:107], a[160:163], a[24:27], v[104:107]
  buffer_load_dwordx4 a[88:91], v1, s[8:11], s73 offen offset:1024 sc1
  v_mfma_f32_16x16x32_bf16 v[108:111], a[160:163], a[28:31], v[108:111]
  ds_read_b64_tr_b16 a[160:161], v7 offset:16384
  v_mfma_f32_16x16x32_bf16 v[108:111], a[164:167], a[12:15], v[108:111]
  s_waitcnt lgkmcnt(5)
  s_add_u32 s73, s73, 131072
  v_mfma_f32_16x16x32_bf16 v[124:127], a[172:175], a[12:15], v[124:127]
  ds_read_b64_tr_b16 a[162:163], v7 offset:18432
  v_mfma_f32_16x16x32_bf16 v[124:127], a[168:171], a[28:31], v[124:127]
  buffer_load_dwordx4 a[76:79], v1, s[8:11], s73 offen offset:0 sc1
  v_mfma_f32_16x16x32_bf16 v[120:123], a[168:171], a[24:27], v[120:123]
  ds_read_b64_tr_b16 a[164:165], v7 offset:20480
  v_mfma_f32_16x16x32_bf16 v[120:123], a[172:175], a[8:11], v[120:123]
  v_mfma_f32_16x16x32_bf16 v[116:119], a[172:175], a[4:7], v[116:119]
  ds_read_b64_tr_b16 a[166:167], v7 offset:22528
  v_mfma_f32_16x16x32_bf16 v[116:119], a[168:171], a[20:23], v[116:119]
  v_mfma_f32_16x16x32_bf16 v[112:115], a[168:171], a[16:19], v[112:115]
  ds_read_b64_tr_b16 a[168:169], v8 offset:16384
  v_mfma_f32_16x16x32_bf16 v[112:115], a[172:175], a[0:3], v[112:115]
  s_waitcnt vmcnt(7) lgkmcnt(5)
  buffer_load_dwordx4 a[92:95], v1, s[8:11], s73 offen offset:1024 sc1
  v_mfma_f32_16x16x32_bf16 v[64:67], a[180:183], a[32:35], v[64:67]
  ds_read_b64_tr_b16 a[170:171], v8 offset:18432
  v_mfma_f32_16x16x32_bf16 v[64:67], a[176:179], a[48:51], v[64:67]
  v_mfma_f32_16x16x32_bf16 v[68:71], a[176:179], a[52:55], v[68:71]
  ds_read_b64_tr_b16 a[172:173], v8 offset:20480
HOP18:
  s_cbranch_execz WRET1
  v_mfma_f32_16x16x32_bf16 v[68:71], a[180:183], a[36:39], v[68:71]
  buffer_load_dwordx4 a[96:99], v1, s[8:11], s74 offen offset:0 sc1
  v_mfma_f32_16x16x32_bf16 v[72:75], a[180:183], a[40:43], v[72:75]
  ds_read_b64_tr_b16 a[174:175], v8 offset:22528
  v_mfma_f32_16x16x32_bf16 v[72:75], a[176:179], a[56:59], v[72:75]
  v_mfma_f32_16x16x32_bf16 v[76:79], a[176:179], a[60:63], v[76:79]
  ds_read_b64_tr_b16 a[176:177], v9 offset:16384
  v_mfma_f32_16x16x32_bf16 v[76:79], a[180:183], a[44:47], v[76:79]
  s_waitcnt lgkmcnt(5)
  buffer_load_dwordx4 a[112:115], v1, s[8:11], s74 offen offset:1024 sc1
  v_mfma_f32_16x16x32_bf16 v[92:95], a[160:163], a[44:47], v[92:95]
  ds_read_b64_tr_b16 a[178:179], v9 offset:18432
  v_mfma_f32_16x16x32_bf16 v[92:95], a[164:167], a[60:63], v[92:95]
  s_add_u32 s74, s74, 131072
  v_mfma_f32_16x16x32_bf16 v[88:91], a[164:167], a[56:59], v[88:91]
  ds_read_b64_tr_b16 a[180:181], v9 offset:20480
  v_mfma_f32_16x16x32_bf16 v[88:91], a[160:163], a[40:43], v[88:91]
  buffer_load_dwordx4 a[100:103], v1, s[8:11], s74 offen offset:0 sc1
  v_mfma_f32_16x16x32_bf16 v[84:87], a[160:163], a[36:39], v[84:87]
  ds_read_b64_tr_b16 a[182:183], v9 offset:22528
  v_mfma_f32_16x16x32_bf16 v[84:87], a[164:167], a[52:55], v[84:87]
  v_mfma_f32_16x16x32_bf16 v[80:83], a[164:167], a[48:51], v[80:83]
  ds_read_b64_tr_b16 a[164:165], v6 offset:0
  v_mfma_f32_16x16x32_bf16 v[80:83], a[160:163], a[32:35], v[80:83]
  s_waitcnt lgkmcnt(5)
  v_mfma_f32_16x16x32_bf16 v[96:99], a[168:171], a[32:35], v[96:99]
  ds_read_b64_tr_b16 a[166:167], v6 offset:2048
  v_mfma_f32_16x16x32_bf16 v[96:99], a[172:175], a[48:51], v[96:99]
  buffer_load_dwordx4 a[116:119], v1, s[8:11], s74 offen offset:1024 sc1
  v_mfma_f32_16x16x32_bf16 v[100:103], a[172:175], a[52:55], v[100:103]
  ds_read_b64_tr_b16 a[160:161], v6 offset:4096
  v_mfma_f32_16x16x32_bf16 v[100:103], a[168:171], a[36:39], v[100:103]
  s_add_u32 s74, s74, s88
  v_mfma_f32_16x16x32_bf16 v[104:107], a[168:171], a[40:43], v[104:107]
  ds_read_b64_tr_b16 a[162:163], v6 offset:6144
  v_mfma_f32_16x16x32_bf16 v[104:107], a[172:175], a[56:59], v[104:107]
  buffer_load_dwordx4 a[104:107], v1, s[8:11], s74 offen offset:0 sc1
  v_mfma_f32_16x16x32_bf16 v[108:111], a[172:175], a[60:63], v[108:111]
  ds_read_b64_tr_b16 a[172:173], v7 offset:0
  v_mfma_f32_16x16x32_bf16 v[108:111], a[168:171], a[44:47], v[108:111]
  s_waitcnt lgkmcnt(5)
  v_mfma_f32_16x16x32_bf16 v[124:127], a[176:179], a[44:47], v[124:127]
  ds_read_b64_tr_b16 a[174:175], v7 offset:2048
  v_mfma_f32_16x16x32_bf16 v[124:127], a[180:183], a[60:63], v[124:127]
  buffer_load_dwordx4 a[120:123], v1, s[8:11], s74 offen offset:1024 sc1
  v_mfma_f32_16x16x32_bf16 v[120:123], a[180:183], a[56:59], v[120:123]
  ds_read_b64_tr_b16 a[168:169], v7 offset:4096
  v_mfma_f32_16x16x32_bf16 v[120:123], a[176:179], a[40:43], v[120:123]
  s_add_u32 s74, s74, 131072
  v_mfma_f32_16x16x32_bf16 v[116:119], a[176:179], a[36:39], v[116:119]
  ds_read_b64_tr_b16 a[170:171], v7 offset:6144
  v_mfma_f32_16x16x32_bf16 v[116:119], a[180:183], a[52:55], v[116:119]
  buffer_load_dwordx4 a[108:111], v1, s[8:11], s74 offen offset:0 sc1
  v_mfma_f32_16x16x32_bf16 v[112:115], a[180:183], a[48:51], v[112:115]
  ds_read_b64_tr_b16 a[180:181], v8 offset:0
  v_mfma_f32_16x16x32_bf16 v[112:115], a[176:179], a[32:35], v[112:115]
  s_waitcnt vmcnt(7) lgkmcnt(5)
  v_mfma_f32_16x16x32_bf16 v[64:67], a[164:167], a[64:67], v[64:67]
  ds_read_b64_tr_b16 a[182:183], v8 offset:2048
  v_mfma_f32_16x16x32_bf16 v[64:67], a[160:163], a[80:83], v[64:67]
  v_mfma_f32_16x16x32_bf16 v[68:71], a[160:163], a[84:87], v[68:71]
  ds_read_b64_tr_b16 a[176:177], v8 offset:4096
  v_mfma_f32_16x16x32_bf16 v[68:71], a[164:167], a[68:71], v[68:71]
  buffer_load_dwordx4 a[124:127], v1, s[8:11], s74 offen offset:1024 sc1
  v_mfma_f32_16x16x32_bf16 v[72:75], a[164:167], a[72:75], v[72:75]
  ds_read_b64_tr_b16 a[178:179], v8 offset:6144
  v_mfma_f32_16x16x32_bf16 v[72:75], a[160:163], a[88:91], v[72:75]
  v_mfma_f32_16x16x32_bf16 v[76:79], a[160:163], a[92:95], v[76:79]
  ds_read_b64_tr_b16 a[160:161], v9 offset:0
  v_mfma_f32_16x16x32_bf16 v[76:79], a[164:167], a[76:79], v[76:79]
  s_waitcnt lgkmcnt(5)
  buffer_load_dwordx4 a[128:131], v1, s[8:11], s75 offen offset:0 sc1
  v_mfma_f32_16x16x32_bf16 v[92:95], a[172:175], a[76:79], v[92:95]
  ds_read_b64_tr_b16 a[162:163], v9 offset:2048
  v_mfma_f32_16x16x32_bf16 v[92:95], a[168:171], a[92:95], v[92:95]
  v_mfma_f32_16x16x32_bf16 v[88:91], a[168:171], a[88:91], v[88:91]
  ds_read_b64_tr_b16 a[164:165], v9 offset:4096
  v_mfma_f32_16x16x32_bf16 v[88:91], a[172:175], a[72:75], v[88:91]
  buffer_load_dwordx4 a[144:147], v1, s[8:11], s75 offen offset:1024 sc1
  v_mfma_f32_16x16x32_bf16 v[84:87], a[172:175], a[68:71], v[84:87]
  ds_read_b64_tr_b16 a[166:167], v9 offset:6144
  v_mfma_f32_16x16x32_bf16 v[84:87], a[168:171], a[84:87], v[84:87]
  s_add_u32 s75, s75, 131072
  v_mfma_f32_16x16x32_bf16 v[80:83], a[168:171], a[80:83], v[80:83]
  ds_read_b64_tr_b16 a[168:169], v2 offset:0
  v_mfma_f32_16x16x32_bf16 v[80:83], a[172:175], a[64:67], v[80:83]
  s_waitcnt lgkmcnt(5)
  buffer_load_dwordx4 a[132:135], v1, s[8:11], s75 offen offset:0 sc1
  v_mfma_f32_16x16x32_bf16 v[96:99], a[180:183], a[64:67], v[96:99]
  ds_read_b64_tr_b16 a[170:171], v2 offset:2048
  v_mfma_f32_16x16x32_bf16 v[96:99], a[176:179], a[80:83], v[96:99]
  v_mfma_f32_16x16x32_bf16 v[100:103], a[176:179], a[84:87], v[100:103]
  ds_read_b64_tr_b16 a[172:173], v2 offset:4096
  v_mfma_f32_16x16x32_bf16 v[100:103], a[180:183], a[68:71], v[100:103]
  v_mfma_f32_16x16x32_bf16 v[104:107], a[180:183], a[72:75], v[104:107]
  ds_read_b64_tr_b16 a[174:175], v2 offset:6144
  v_mfma_f32_16x16x32_bf16 v[104:107], a[176:179], a[88:91], v[104:107]
  buffer_load_dwordx4 a[148:151], v1, s[8:11], s75 offen offset:1024 sc1
  v_mfma_f32_16x16x32_bf16 v[108:111], a[176:179], a[92:95], v[108:111]
  ds_read_b64_tr_b16 a[176:177], v3 offset:0
  v_mfma_f32_16x16x32_bf16 v[108:111], a[180:183], a[76:79], v[108:111]
  s_waitcnt lgkmcnt(5)
  s_add_u32 s75, s75, s88
  v_mfma_f32_16x16x32_bf16 v[124:127], a[160:163], a[76:79], v[124:127]
  ds_read_b64_tr_b16 a[178:179], v3 offset:2048
  v_mfma_f32_16x16x32_bf16 v[124:127], a[164:167], a[92:95], v[124:127]
  buffer_load_dwordx4 a[136:139], v1, s[8:11], s75 offen offset:0 sc1
  v_mfma_f32_16x16x32_bf16 v[120:123], a[164:167], a[88:91], v[120:123]
  ds_read_b64_tr_b16 a[180:181], v3 offset:4096
  v_mfma_f32_16x16x32_bf16 v[120:123], a[160:163], a[72:75], v[120:123]
  v_mfma_f32_16x16x32_bf16 v[116:119], a[160:163], a[68:71], v[116:119]
  ds_read_b64_tr_b16 a[182:183], v3 offset:6144
  v_mfma_f32_16x16x32_bf16 v[116:119], a[164:167], a[84:87], v[116:119]
  buffer_load_dwordx4 a[152:155], v1, s[8:11], s75 offen offset:1024 sc1
  v_mfma_f32_16x16x32_bf16 v[112:115], a[164:167], a[80:83], v[112:115]
  ds_read_b64_tr_b16 a[164:165], v4 offset:0
  v_mfma_f32_16x16x32_bf16 v[112:115], a[160:163], a[64:67], v[112:115]
  s_waitcnt vmcnt(6) lgkmcnt(5)
  s_add_u32 s75, s75, 131072
  v_mfma_f32_16x16x32_bf16 v[64:67], a[168:171], a[96:99], v[64:67]
  ds_read_b64_tr_b16 a[166:167], v4 offset:2048
  v_mfma_f32_16x16x32_bf16 v[64:67], a[172:175], a[112:115], v[64:67]
  buffer_load_dwordx4 a[140:143], v1, s[8:11], s75 offen offset:0 sc1
  v_mfma_f32_16x16x32_bf16 v[68:71], a[172:175], a[116:119], v[68:71]
  ds_read_b64_tr_b16 a[160:161], v4 offset:4096
  v_mfma_f32_16x16x32_bf16 v[68:71], a[168:171], a[100:103], v[68:71]
  v_mfma_f32_16x16x32_bf16 v[72:75], a[168:171], a[104:107], v[72:75]
  ds_read_b64_tr_b16 a[162:163], v4 offset:6144
  v_mfma_f32_16x16x32_bf16 v[72:75], a[172:175], a[120:123], v[72:75]
  v_mfma_f32_16x16x32_bf16 v[76:79], a[172:175], a[124:127], v[76:79]
  ds_read_b64_tr_b16 a[172:173], v5 offset:0
  v_mfma_f32_16x16x32_bf16 v[76:79], a[168:171], a[108:111], v[76:79]
  s_waitcnt lgkmcnt(5)
  buffer_load_dwordx4 a[156:159], v1, s[8:11], s75 offen offset:1024 sc1
  v_mfma_f32_16x16x32_bf16 v[92:95], a[176:179], a[108:111], v[92:95]
  ds_read_b64_tr_b16 a[174:175], v5 offset:2048
  v_mfma_f32_16x16x32_bf16 v[92:95], a[180:183], a[124:127], v[92:95]
  v_mfma_f32_16x16x32_bf16 v[88:91], a[180:183], a[120:123], v[88:91]
  ds_read_b64_tr_b16 a[168:169], v5 offset:4096
  v_mfma_f32_16x16x32_bf16 v[88:91], a[176:179], a[104:107], v[88:91]
  buffer_load_dwordx4 a[188:191], v1, s[8:11], s76 offen offset:0 sc1
  v_mfma_f32_16x16x32_bf16 v[84:87], a[176:179], a[100:103], v[84:87]
  ds_read_b64_tr_b16 a[170:171], v5 offset:6144
  v_mfma_f32_16x16x32_bf16 v[84:87], a[180:183], a[116:119], v[84:87]
  v_mfma_f32_16x16x32_bf16 v[80:83], a[180:183], a[112:115], v[80:83]
  ds_read_b64_tr_b16 a[180:181], v2 offset:32768
  v_mfma_f32_16x16x32_bf16 v[80:83], a[176:179], a[96:99], v[80:83]
  s_waitcnt lgkmcnt(5)
  buffer_load_dwordx4 a[204:207], v1, s[8:11], s76 offen offset:1024 sc1
  v_mfma_f32_16x16x32_bf16 v[96:99], a[164:167], a[96:99], v[96:99]
  ds_read_b64_tr_b16 a[182:183], v2 offset:34816
  v_mfma_f32_16x16x32_bf16 v[96:99], a[160:163], a[112:115], v[96:99]
  s_add_u32 s76, s76, 131072
  v_mfma_f32_16x16x32_bf16 v[100:103], a[160:163], a[116:119], v[100:103]
  ds_read_b64_tr_b16 a[176:177], v2 offset:36864
  v_mfma_f32_16x16x32_bf16 v[100:103], a[164:167], a[100:103], v[100:103]
  buffer_load_dwordx4 a[192:195], v1, s[8:11], s76 offen offset:0 sc1
  v_mfma_f32_16x16x32_bf16 v[104:107], a[164:167], a[104:107], v[104:107]
  ds_read_b64_tr_b16 a[178:179], v2 offset:38912
  v_mfma_f32_16x16x32_bf16 v[104:107], a[160:163], a[120:123], v[104:107]
  v_mfma_f32_16x16x32_bf16 v[108:111], a[160:163], a[124:127], v[108:111]
  ds_read_b64_tr_b16 a[160:161], v3 offset:32768
  v_mfma_f32_16x16x32_bf16 v[108:111], a[164:167], a[108:111], v[108:111]
  s_waitcnt lgkmcnt(5)
  v_mfma_f32_16x16x32_bf16 v[124:127], a[172:175], a[108:111], v[124:127]
  ds_read_b64_tr_b16 a[162:163], v3 offset:34816
  v_mfma_f32_16x16x32_bf16 v[124:127], a[168:171], a[124:127], v[124:127]
  buffer_load_dwordx4 a[208:211], v1, s[8:11], s76 offen offset:1024 sc1
  v_mfma_f32_16x16x32_bf16 v[120:123], a[168:171], a[120:123], v[120:123]
  ds_read_b64_tr_b16 a[164:165], v3 offset:36864
  v_mfma_f32_16x16x32_bf16 v[120:123], a[172:175], a[104:107], v[120:123]
  s_add_u32 s76, s76, s88
  v_mfma_f32_16x16x32_bf16 v[116:119], a[172:175], a[100:103], v[116:119]
  ds_read_b64_tr_b16 a[166:167], v3 offset:38912
  v_mfma_f32_16x16x32_bf16 v[116:119], a[168:171], a[116:119], v[116:119]
  buffer_load_dwordx4 a[196:199], v1, s[8:11], s76 offen offset:0 sc1
  v_mfma_f32_16x16x32_bf16 v[112:115], a[168:171], a[112:115], v[112:115]
  ds_read_b64_tr_b16 a[168:169], v4 offset:32768
  v_mfma_f32_16x16x32_bf16 v[112:115], a[172:175], a[96:99], v[112:115]
  s_waitcnt vmcnt(5) lgkmcnt(5)
  v_mfma_f32_16x16x32_bf16 v[64:67], a[180:183], a[128:131], v[64:67]
  ds_read_b64_tr_b16 a[170:171], v4 offset:34816
  v_mfma_f32_16x16x32_bf16 v[64:67], a[176:179], a[144:147], v[64:67]
  buffer_load_dwordx4 a[212:215], v1, s[8:11], s76 offen offset:1024 sc1
  v_mfma_f32_16x16x32_bf16 v[68:71], a[176:179], a[148:151], v[68:71]
  ds_read_b64_tr_b16 a[172:173], v4 offset:36864
  v_mfma_f32_16x16x32_bf16 v[68:71], a[180:183], a[132:135], v[68:71]
  s_add_u32 s76, s76, 131072
  v_mfma_f32_16x16x32_bf16 v[72:75], a[180:183], a[136:139], v[72:75]
  ds_read_b64_tr_b16 a[174:175], v4 offset:38912
  v_mfma_f32_16x16x32_bf16 v[72:75], a[176:179], a[152:155], v[72:75]
  buffer_load_dwordx4 a[200:203], v1, s[8:11], s76 offen offset:0 sc1
  v_mfma_f32_16x16x32_bf16 v[76:79], a[176:179], a[156:159], v[76:79]
  ds_read_b64_tr_b16 a[176:177], v5 offset:32768
  v_mfma_f32_16x16x32_bf16 v[76:79], a[180:183], a[140:143], v[76:79]
  s_waitcnt lgkmcnt(5)
  v_mfma_f32_16x16x32_bf16 v[92:95], a[160:163], a[140:143], v[92:95]
  ds_read_b64_tr_b16 a[178:179], v5 offset:34816
  v_mfma_f32_16x16x32_bf16 v[92:95], a[164:167], a[156:159], v[92:95]
  v_mfma_f32_16x16x32_bf16 v[88:91], a[164:167], a[152:155], v[88:91]
  ds_read_b64_tr_b16 a[180:181], v5 offset:36864
  v_mfma_f32_16x16x32_bf16 v[88:91], a[160:163], a[136:139], v[88:91]
  buffer_load_dwordx4 a[216:219], v1, s[8:11], s76 offen offset:1024 sc1
  v_mfma_f32_16x16x32_bf16 v[84:87], a[160:163], a[132:135], v[84:87]
  ds_read_b64_tr_b16 a[182:183], v5 offset:38912
  v_mfma_f32_16x16x32_bf16 v[84:87], a[164:167], a[148:151], v[84:87]
  s_add_u32 m0, s45, 8192
  v_mfma_f32_16x16x32_bf16 v[80:83], a[164:167], a[144:147], v[80:83]
  ds_read_b64_tr_b16 a[164:165], v2 offset:49152
  v_mfma_f32_16x16x32_bf16 v[80:83], a[160:163], a[128:131], v[80:83]
  s_waitcnt lgkmcnt(5)
  buffer_load_dwordx4 v33, s[36:39], s66 offen lds
  v_mfma_f32_16x16x32_bf16 v[96:99], a[168:171], a[128:131], v[96:99]
  ds_read_b64_tr_b16 a[166:167], v2 offset:51200
  v_mfma_f32_16x16x32_bf16 v[96:99], a[172:175], a[144:147], v[96:99]
  s_add_u32 m0, s45, 12288
  s_add_u32 s60, s66, 65536
  v_mfma_f32_16x16x32_bf16 v[100:103], a[172:175], a[148:151], v[100:103]
  ds_read_b64_tr_b16 a[160:161], v2 offset:53248
  v_mfma_f32_16x16x32_bf16 v[100:103], a[168:171], a[132:135], v[100:103]
  buffer_load_dwordx4 v33, s[36:39], s60 offen lds
  v_mfma_f32_16x16x32_bf16 v[104:107], a[168:171], a[136:139], v[104:107]
  ds_read_b64_tr_b16 a[162:163], v2 offset:55296
  v_mfma_f32_16x16x32_bf16 v[104:107], a[172:175], a[152:155], v[104:107]
  s_add_u32 m0, s45, 40960
  v_mfma_f32_16x16x32_bf16 v[108:111], a[172:175], a[156:159], v[108:111]
  ds_read_b64_tr_b16 a[172:173], v3 offset:49152
  v_mfma_f32_16x16x32_bf16 v[108:111], a[168:171], a[140:143], v[108:111]
  s_waitcnt lgkmcnt(5)
  buffer_load_dwordx4 v33, s[36:39], s67 offen lds
  v_mfma_f32_16x16x32_bf16 v[124:127], a[176:179], a[140:143], v[124:127]
  ds_read_b64_tr_b16 a[174:175], v3 offset:51200
  v_mfma_f32_16x16x32_bf16 v[124:127], a[180:183], a[156:159], v[124:127]
  v_mfma_f32_16x16x32_bf16 v[120:123], a[180:183], a[152:155], v[120:123]
  ds_read_b64_tr_b16 a[168:169], v3 offset:53248
  v_mfma_f32_16x16x32_bf16 v[120:123], a[176:179], a[136:139], v[120:123]
  s_add_u32 m0, s45, 45056
  s_add_u32 s60, s67, 65536
  v_mfma_f32_16x16x32_bf16 v[116:119], a[176:179], a[132:135], v[116:119]
  ds_read_b64_tr_b16 a[170:171], v3 offset:55296
  v_mfma_f32_16x16x32_bf16 v[116:119], a[180:183], a[148:151], v[116:119]
  buffer_load_dwordx4 v33, s[36:39], s60 offen lds
  v_mfma_f32_16x16x32_bf16 v[112:115], a[180:183], a[144:147], v[112:115]
  ds_read_b64_tr_b16 a[180:181], v4 offset:49152
  v_mfma_f32_16x16x32_bf16 v[112:115], a[176:179], a[128:131], v[112:115]
  s_waitcnt vmcnt(4) lgkmcnt(5)
  s_add_u32 m0, s45, 57344
  v_mfma_f32_16x16x32_bf16 v[64:67], a[164:167], a[188:191], v[64:67]
  ds_read_b64_tr_b16 a[182:183], v4 offset:51200
  v_mfma_f32_16x16x32_bf16 v[64:67], a[160:163], a[204:207], v[64:67]
  buffer_load_dwordx4 v33, s[36:39], s68 offen lds
  v_mfma_f32_16x16x32_bf16 v[68:71], a[160:163], a[208:211], v[68:71]
  ds_read_b64_tr_b16 a[176:177], v4 offset:53248
  v_mfma_f32_16x16x32_bf16 v[68:71], a[164:167], a[192:195], v[68:71]
  s_add_u32 m0, s45, 61440
  s_add_u32 s60, s68, 65536
  v_mfma_f32_16x16x32_bf16 v[72:75], a[164:167], a[196:199], v[72:75]
  ds_read_b64_tr_b16 a[178:179], v4 offset:55296
  v_mfma_f32_16x16x32_bf16 v[72:75], a[160:163], a[212:215], v[72:75]
  buffer_load_dwordx4 v33, s[36:39], s60 offen lds
  v_mfma_f32_16x16x32_bf16 v[76:79], a[160:163], a[216:219], v[76:79]
  ds_read_b64_tr_b16 a[160:161], v5 offset:49152
  v_mfma_f32_16x16x32_bf16 v[76:79], a[164:167], a[200:203], v[76:79]
  s_waitcnt lgkmcnt(5)
  v_mfma_f32_16x16x32_bf16 v[92:95], a[172:175], a[200:203], v[92:95]
  ds_read_b64_tr_b16 a[162:163], v5 offset:51200
  v_mfma_f32_16x16x32_bf16 v[92:95], a[168:171], a[216:219], v[92:95]
  v_mfma_f32_16x16x32_bf16 v[88:91], a[168:171], a[212:215], v[88:91]
  ds_read_b64_tr_b16 a[164:165], v5 offset:53248
  v_cvt_pk_bf16_f32 v72, v72, v73
  v_mfma_f32_16x16x32_bf16 v[88:91], a[172:175], a[196:199], v[88:91]
  v_cvt_pk_bf16_f32 v73, v74, v75
  v_cvt_pk_bf16_f32 v76, v76, v77
  v_mfma_f32_16x16x32_bf16 v[84:87], a[172:175], a[192:195], v[84:87]
  ds_read_b64_tr_b16 a[166:167], v5 offset:55296
  v_cvt_pk_bf16_f32 v77, v78, v79
  v_mfma_f32_16x16x32_bf16 v[84:87], a[168:171], a[208:211], v[84:87]
  v_cvt_pk_bf16_f32 v64, v64, v65
  v_cvt_pk_bf16_f32 v65, v66, v67
  v_mfma_f32_16x16x32_bf16 v[80:83], a[168:171], a[204:207], v[80:83]
  v_cvt_pk_bf16_f32 v68, v68, v69
  v_cvt_pk_bf16_f32 v69, v70, v71
  v_mfma_f32_16x16x32_bf16 v[80:83], a[172:175], a[188:191], v[80:83]
  s_waitcnt lgkmcnt(4)
  s_waitcnt vmcnt(0)
  s_barrier
  v_mfma_f32_16x16x32_bf16 v[96:99], a[180:183], a[188:191], v[96:99]
  ds_read_b64_tr_b16 v[16:17], v6 offset:40960
  v_mfma_f32_16x16x32_bf16 v[96:99], a[176:179], a[204:207], v[96:99]
  ds_read_b64_tr_b16 v[18:19], v6 offset:43008
  v_mfma_f32_16x16x32_bf16 v[100:103], a[176:179], a[208:211], v[100:103]
  ds_read_b64_tr_b16 v[20:21], v6 offset:45056
  v_cvt_pk_bf16_f32 v74, v88, v89
  v_mfma_f32_16x16x32_bf16 v[100:103], a[180:183], a[192:195], v[100:103]
  ds_read_b64_tr_b16 v[22:23], v6 offset:47104
  v_cvt_pk_bf16_f32 v75, v90, v91
  v_mfma_f32_16x16x32_bf16 v[104:107], a[180:183], a[196:199], v[104:107]
  ds_read_b64_tr_b16 v[24:25], v7 offset:40960
  v_mfma_f32_16x16x32_bf16 v[104:107], a[176:179], a[212:215], v[104:107]
  ds_read_b64_tr_b16 v[26:27], v7 offset:43008
  v_mfma_f32_16x16x32_bf16 v[108:111], a[176:179], a[216:219], v[108:111]
  ds_read_b64_tr_b16 v[28:29], v7 offset:45056
  s_add_u32 s86, s85, 0
  buffer_store_dwordx4 v[72:75], v1, s[8:11], s86 offen offset:0 sc1
  v_mfma_f32_16x16x32_bf16 v[108:111], a[180:183], a[200:203], v[108:111]
  s_waitcnt lgkmcnt(7)
  ds_read_b64_tr_b16 v[30:31], v7 offset:47104
  v_mfma_f32_16x16x32_bf16 v[124:127], a[160:163], a[200:203], v[124:127]
  ds_read_b64_tr_b16 a[168:169], v8 offset:40960
  v_cvt_pk_bf16_f32 v78, v92, v93
  v_mfma_f32_16x16x32_bf16 v[124:127], a[164:167], a[216:219], v[124:127]
  ds_read_b64_tr_b16 a[170:171], v8 offset:43008
  v_cvt_pk_bf16_f32 v79, v94, v95
  v_mfma_f32_16x16x32_bf16 v[120:123], a[164:167], a[212:215], v[120:123]
  ds_read_b64_tr_b16 a[172:173], v8 offset:45056
  v_mfma_f32_16x16x32_bf16 v[120:123], a[160:163], a[196:199], v[120:123]
  ds_read_b64_tr_b16 a[174:175], v8 offset:47104
  v_mfma_f32_16x16x32_bf16 v[116:119], a[160:163], a[192:195], v[116:119]
  ds_read_b64_tr_b16 a[176:177], v9 offset:40960
  s_add_u32 s86, s85, 0
  buffer_store_dwordx4 v[76:79], v1, s[8:11], s86 offen offset:2048 sc1
  v_mfma_f32_16x16x32_bf16 v[116:119], a[164:167], a[208:211], v[116:119]
  ds_read_b64_tr_b16 a[178:179], v9 offset:43008
  v_mfma_f32_16x16x32_bf16 v[112:115], a[164:167], a[204:207], v[112:115]
  ds_read_b64_tr_b16 a[180:181], v9 offset:45056
  v_cvt_pk_bf16_f32 v66, v80, v81
  v_mfma_f32_16x16x32_bf16 v[112:115], a[160:163], a[188:191], v[112:115]
  s_waitcnt lgkmcnt(7)
  ds_read_b64_tr_b16 a[182:183], v9 offset:47104
  v_mfma_f32_16x16x32_bf16 v[136:139], v[16:19], a[228:231], v[136:139]
  ds_read_b64_tr_b16 a[164:165], v6 offset:57344
  v_cvt_pk_bf16_f32 v67, v82, v83
  v_mfma_f32_16x16x32_bf16 v[136:139], v[20:23], a[244:247], v[136:139]
  ds_read_b64_tr_b16 a[166:167], v6 offset:59392
  v_mfma_f32_16x16x32_bf16 v[140:143], v[20:23], a[248:251], v[140:143]
  ds_read_b64_tr_b16 a[160:161], v6 offset:61440
  v_mfma_f32_16x16x32_bf16 v[140:143], v[16:19], a[232:235], v[140:143]
  ds_read_b64_tr_b16 a[162:163], v6 offset:63488
  s_add_u32 s86, s85, 4096
  buffer_store_dwordx4 v[64:67], v1, s[8:11], s86 offen offset:0 sc1
  v_mfma_f32_16x16x32_bf16 v[156:159], v[24:27], a[232:235], v[156:159]
  ds_read_b64_tr_b16 v[20:21], v7 offset:57344
  v_mfma_f32_16x16x32_bf16 v[156:159], v[28:31], a[248:251], v[156:159]
  ds_read_b64_tr_b16 v[22:23], v7 offset:59392
  v_cvt_pk_bf16_f32 v70, v84, v85
  v_mfma_f32_16x16x32_bf16 v[152:155], v[28:31], a[244:247], v[152:155]
  ds_read_b64_tr_b16 v[16:17], v7 offset:61440
  v_cvt_pk_bf16_f32 v71, v86, v87
  v_mfma_f32_16x16x32_bf16 v[152:155], v[24:27], a[228:231], v[152:155]
  s_waitcnt lgkmcnt(7)
  ds_read_b64_tr_b16 v[18:19], v7 offset:63488
  v_mfma_f32_16x16x32_bf16 v[168:171], a[168:171], a[228:231], v[168:171]
  ds_read_b64_tr_b16 v[28:29], v8 offset:57344
  v_mfma_f32_16x16x32_bf16 v[168:171], a[172:175], a[244:247], v[168:171]
  ds_read_b64_tr_b16 v[30:31], v8 offset:59392
  s_add_u32 s86, s85, 4096
  buffer_store_dwordx4 v[68:71], v1, s[8:11], s86 offen offset:2048 sc1
  v_mfma_f32_16x16x32_bf16 v[172:175], a[172:175], a[248:251], v[172:175]
  ds_read_b64_tr_b16 v[24:25], v8 offset:61440
  v_mfma_f32_16x16x32_bf16 v[172:175], a[168:171], a[232:235], v[172:175]
  ds_read_b64_tr_b16 v[26:27], v8 offset:63488
  v_cvt_pk_bf16_f32 v104, v104, v105
  v_mfma_f32_16x16x32_bf16 v[188:191], a[176:179], a[232:235], v[188:191]
  ds_read_b64_tr_b16 a[172:173], v9 offset:57344
  v_cvt_pk_bf16_f32 v105, v106, v107
  v_mfma_f32_16x16x32_bf16 v[188:191], a[180:183], a[248:251], v[188:191]
  ds_read_b64_tr_b16 a[174:175], v9 offset:59392
  v_cvt_pk_bf16_f32 v108, v108, v109
  v_mfma_f32_16x16x32_bf16 v[184:187], a[180:183], a[244:247], v[184:187]
  ds_read_b64_tr_b16 a[168:169], v9 offset:61440
  v_cvt_pk_bf16_f32 v109, v110, v111
  v_mfma_f32_16x16x32_bf16 v[184:187], a[176:179], a[228:231], v[184:187]
  s_waitcnt lgkmcnt(7)
  ds_read_b64_tr_b16 a[170:171], v9 offset:63488
  v_mfma_f32_16x16x32_bf16 v[136:139], a[164:167], a[8:11], v[136:139]
  ds_read_b64_tr_b16 a[180:181], v6 offset:24576
  v_cvt_pk_bf16_f32 v96, v96, v97
  v_mfma_f32_16x16x32_bf16 v[136:139], a[160:163], a[24:27], v[136:139]
  ds_read_b64_tr_b16 a[182:183], v6 offset:26624
  v_cvt_pk_bf16_f32 v97, v98, v99
  v_mfma_f32_16x16x32_bf16 v[140:143], a[160:163], a[28:31], v[140:143]
  ds_read_b64_tr_b16 a[176:177], v6 offset:28672
  v_cvt_pk_bf16_f32 v100, v100, v101
  v_mfma_f32_16x16x32_bf16 v[140:143], a[164:167], a[12:15], v[140:143]
  ds_read_b64_tr_b16 a[178:179], v6 offset:30720
  v_cvt_pk_bf16_f32 v101, v102, v103
  v_mfma_f32_16x16x32_bf16 v[156:159], v[20:23], a[12:15], v[156:159]
  ds_read_b64_tr_b16 a[160:161], v7 offset:24576
  v_cvt_pk_bf16_f32 v106, v120, v121
  v_mfma_f32_16x16x32_bf16 v[156:159], v[16:19], a[28:31], v[156:159]
  ds_read_b64_tr_b16 a[162:163], v7 offset:26624
  v_cvt_pk_bf16_f32 v107, v122, v123
  v_mfma_f32_16x16x32_bf16 v[152:155], v[16:19], a[24:27], v[152:155]
  ds_read_b64_tr_b16 a[164:165], v7 offset:28672
  v_mfma_f32_16x16x32_bf16 v[152:155], v[20:23], a[8:11], v[152:155]
  s_waitcnt lgkmcnt(7)
  ds_read_b64_tr_b16 a[166:167], v7 offset:30720
  v_mfma_f32_16x16x32_bf16 v[168:171], v[28:31], a[8:11], v[168:171]
  ds_read_b64_tr_b16 v[16:17], v8 offset:24576
  s_add_u32 s86, s85, 0
  buffer_store_dwordx4 v[104:107], v1, s[8:11], s86 offen offset:1024 sc1
  v_mfma_f32_16x16x32_bf16 v[168:171], v[24:27], a[24:27], v[168:171]
  ds_read_b64_tr_b16 v[18:19], v8 offset:26624
  v_mfma_f32_16x16x32_bf16 v[172:175], v[24:27], a[28:31], v[172:175]
  ds_read_b64_tr_b16 v[20:21], v8 offset:28672
  v_cvt_pk_bf16_f32 v110, v124, v125
  v_mfma_f32_16x16x32_bf16 v[172:175], v[28:31], a[12:15], v[172:175]
  ds_read_b64_tr_b16 v[22:23], v8 offset:30720
  v_cvt_pk_bf16_f32 v111, v126, v127
  v_mfma_f32_16x16x32_bf16 v[188:191], a[172:175], a[12:15], v[188:191]
  ds_read_b64_tr_b16 v[24:25], v9 offset:24576
  v_mfma_f32_16x16x32_bf16 v[188:191], a[168:171], a[28:31], v[188:191]
  ds_read_b64_tr_b16 v[26:27], v9 offset:26624
  v_mfma_f32_16x16x32_bf16 v[184:187], a[168:171], a[24:27], v[184:187]
  ds_read_b64_tr_b16 v[28:29], v9 offset:28672
  s_add_u32 s86, s85, 0
  buffer_store_dwordx4 v[108:111], v1, s[8:11], s86 offen offset:3072 sc1
  v_mfma_f32_16x16x32_bf16 v[184:187], a[172:175], a[8:11], v[184:187]
  s_waitcnt lgkmcnt(7)
  ds_read_b64_tr_b16 v[30:31], v9 offset:30720
  v_mfma_f32_16x16x32_bf16 v[136:139], a[180:183], a[40:43], v[136:139]
  ds_read_b64_tr_b16 a[168:169], v6 offset:8192
  v_cvt_pk_bf16_f32 v98, v112, v113
  v_mfma_f32_16x16x32_bf16 v[136:139], a[176:179], a[56:59], v[136:139]
  ds_read_b64_tr_b16 a[170:171], v6 offset:10240
  v_cvt_pk_bf16_f32 v99, v114, v115
  v_mfma_f32_16x16x32_bf16 v[140:143], a[176:179], a[60:63], v[140:143]
  ds_read_b64_tr_b16 a[172:173], v6 offset:12288
  v_mfma_f32_16x16x32_bf16 v[140:143], a[180:183], a[44:47], v[140:143]
  ds_read_b64_tr_b16 a[174:175], v6 offset:14336
  v_mfma_f32_16x16x32_bf16 v[156:159], a[160:163], a[44:47], v[156:159]
  ds_read_b64_tr_b16 a[176:177], v7 offset:8192
  s_add_u32 s86, s85, 4096
  buffer_store_dwordx4 v[96:99], v1, s[8:11], s86 offen offset:1024 sc1
  v_mfma_f32_16x16x32_bf16 v[156:159], a[164:167], a[60:63], v[156:159]
  ds_read_b64_tr_b16 a[178:179], v7 offset:10240
  v_mfma_f32_16x16x32_bf16 v[152:155], a[164:167], a[56:59], v[152:155]
  ds_read_b64_tr_b16 a[180:181], v7 offset:12288
  v_cvt_pk_bf16_f32 v102, v116, v117
  v_mfma_f32_16x16x32_bf16 v[152:155], a[160:163], a[40:43], v[152:155]
  s_waitcnt lgkmcnt(7)
  ds_read_b64_tr_b16 a[182:183], v7 offset:14336
  v_mfma_f32_16x16x32_bf16 v[168:171], v[16:19], a[40:43], v[168:171]
  ds_read_b64_tr_b16 a[164:165], v8 offset:8192
  v_cvt_pk_bf16_f32 v103, v118, v119
  v_mfma_f32_16x16x32_bf16 v[168:171], v[20:23], a[56:59], v[168:171]
  ds_read_b64_tr_b16 a[166:167], v8 offset:10240
  v_mfma_f32_16x16x32_bf16 v[172:175], v[20:23], a[60:63], v[172:175]
  ds_read_b64_tr_b16 a[160:161], v8 offset:12288
  v_mfma_f32_16x16x32_bf16 v[172:175], v[16:19], a[44:47], v[172:175]
  ds_read_b64_tr_b16 a[162:163], v8 offset:14336
  s_add_u32 s86, s85, 4096
  buffer_store_dwordx4 v[100:103], v1, s[8:11], s86 offen offset:3072 sc1
  v_mfma_f32_16x16x32_bf16 v[188:191], v[24:27], a[44:47], v[188:191]
  ds_read_b64_tr_b16 v[20:21], v9 offset:8192
  v_mfma_f32_16x16x32_bf16 v[188:191], v[28:31], a[60:63], v[188:191]
  ds_read_b64_tr_b16 v[22:23], v9 offset:10240
  v_mfma_f32_16x16x32_bf16 v[184:187], v[28:31], a[56:59], v[184:187]
  ds_read_b64_tr_b16 v[16:17], v9 offset:12288
  v_mfma_f32_16x16x32_bf16 v[184:187], v[24:27], a[40:43], v[184:187]
  s_waitcnt lgkmcnt(7)
  ds_read_b64_tr_b16 v[18:19], v9 offset:14336
  v_mfma_f32_16x16x32_bf16 v[136:139], a[168:171], a[72:75], v[136:139]
  ds_read_b64_tr_b16 v[28:29], v2 offset:8192
  v_mfma_f32_16x16x32_bf16 v[136:139], a[172:175], a[88:91], v[136:139]
  ds_read_b64_tr_b16 v[30:31], v2 offset:10240
  v_mfma_f32_16x16x32_bf16 v[140:143], a[172:175], a[92:95], v[140:143]
  ds_read_b64_tr_b16 v[24:25], v2 offset:12288
  v_mfma_f32_16x16x32_bf16 v[140:143], a[168:171], a[76:79], v[140:143]
  ds_read_b64_tr_b16 v[26:27], v2 offset:14336
  v_mfma_f32_16x16x32_bf16 v[156:159], a[176:179], a[76:79], v[156:159]
  ds_read_b64_tr_b16 a[172:173], v3 offset:8192
  v_mfma_f32_16x16x32_bf16 v[156:159], a[180:183], a[92:95], v[156:159]
  ds_read_b64_tr_b16 a[174:175], v3 offset:10240
  v_mfma_f32_16x16x32_bf16 v[152:155], a[180:183], a[88:91], v[152:155]
  ds_read_b64_tr_b16 a[168:169], v3 offset:12288
  v_mfma_f32_16x16x32_bf16 v[152:155], a[176:179], a[72:75], v[152:155]
  s_waitcnt lgkmcnt(7)
  ds_read_b64_tr_b16 a[170:171], v3 offset:14336
  v_mfma_f32_16x16x32_bf16 v[168:171], a[164:167], a[72:75], v[168:171]
  ds_read_b64_tr_b16 a[180:181], v4 offset:8192
  v_mfma_f32_16x16x32_bf16 v[168:171], a[160:163], a[88:91], v[168:171]
  ds_read_b64_tr_b16 a[182:183], v4 offset:10240
  v_mfma_f32_16x16x32_bf16 v[172:175], a[160:163], a[92:95], v[172:175]
  ds_read_b64_tr_b16 a[176:177], v4 offset:12288
  v_mfma_f32_16x16x32_bf16 v[172:175], a[164:167], a[76:79], v[172:175]
  ds_read_b64_tr_b16 a[178:179], v4 offset:14336
  v_mfma_f32_16x16x32_bf16 v[188:191], v[20:23], a[76:79], v[188:191]
  ds_read_b64_tr_b16 a[160:161], v5 offset:8192
  v_mfma_f32_16x16x32_bf16 v[188:191], v[16:19], a[92:95], v[188:191]
  ds_read_b64_tr_b16 a[162:163], v5 offset:10240
  v_mfma_f32_16x16x32_bf16 v[184:187], v[16:19], a[88:91], v[184:187]
  ds_read_b64_tr_b16 a[164:165], v5 offset:12288
  v_mfma_f32_16x16x32_bf16 v[184:187], v[20:23], a[72:75], v[184:187]
  s_waitcnt lgkmcnt(7)
  ds_read_b64_tr_b16 a[166:167], v5 offset:14336
  v_mfma_f32_16x16x32_bf16 v[136:139], v[28:31], a[104:107], v[136:139]
  ds_read_b64_tr_b16 v[16:17], v2 offset:40960
  v_mfma_f32_16x16x32_bf16 v[136:139], v[24:27], a[120:123], v[136:139]
  ds_read_b64_tr_b16 v[18:19], v2 offset:43008
  v_mfma_f32_16x16x32_bf16 v[140:143], v[24:27], a[124:127], v[140:143]
  ds_read_b64_tr_b16 v[20:21], v2 offset:45056
  v_mfma_f32_16x16x32_bf16 v[140:143], v[28:31], a[108:111], v[140:143]
  ds_read_b64_tr_b16 v[22:23], v2 offset:47104
  v_mfma_f32_16x16x32_bf16 v[156:159], a[172:175], a[108:111], v[156:159]
  ds_read_b64_tr_b16 v[24:25], v3 offset:40960
  v_mfma_f32_16x16x32_bf16 v[156:159], a[168:171], a[124:127], v[156:159]
  ds_read_b64_tr_b16 v[26:27], v3 offset:43008
  v_mfma_f32_16x16x32_bf16 v[152:155], a[168:171], a[120:123], v[152:155]
  ds_read_b64_tr_b16 v[28:29], v3 offset:45056
  v_mfma_f32_16x16x32_bf16 v[152:155], a[172:175], a[104:107], v[152:155]
  s_waitcnt lgkmcnt(7)
  ds_read_b64_tr_b16 v[30:31], v3 offset:47104
  v_mfma_f32_16x16x32_bf16 v[168:171], a[180:183], a[104:107], v[168:171]
  ds_read_b64_tr_b16 a[168:169], v4 offset:40960
  v_mfma_f32_16x16x32_bf16 v[168:171], a[176:179], a[120:123], v[168:171]
  ds_read_b64_tr_b16 a[170:171], v4 offset:43008
  v_mfma_f32_16x16x32_bf16 v[172:175], a[176:179], a[124:127], v[172:175]
  ds_read_b64_tr_b16 a[172:173], v4 offset:45056
  v_mfma_f32_16x16x32_bf16 v[172:175], a[180:183], a[108:111], v[172:175]
  ds_read_b64_tr_b16 a[174:175], v4 offset:47104
  v_mfma_f32_16x16x32_bf16 v[188:191], a[160:163], a[108:111], v[188:191]
  ds_read_b64_tr_b16 a[176:177], v5 offset:40960
  v_mfma_f32_16x16x32_bf16 v[188:191], a[164:167], a[124:127], v[188:191]
  ds_read_b64_tr_b16 a[178:179], v5 offset:43008
  v_mfma_f32_16x16x32_bf16 v[184:187], a[164:167], a[120:123], v[184:187]
  ds_read_b64_tr_b16 a[180:181], v5 offset:45056
  v_mfma_f32_16x16x32_bf16 v[184:187], a[160:163], a[104:107], v[184:187]
  s_waitcnt lgkmcnt(7)
  ds_read_b64_tr_b16 a[182:183], v5 offset:47104
  v_mfma_f32_16x16x32_bf16 v[136:139], v[16:19], a[136:139], v[136:139]
HOP19:
  s_cbranch_execz WRET1
  ds_read_b64_tr_b16 a[164:165], v2 offset:57344
  v_mfma_f32_16x16x32_bf16 v[136:139], v[20:23], a[152:155], v[136:139]
  ds_read_b64_tr_b16 a[166:167], v2 offset:59392
  v_mfma_f32_16x16x32_bf16 v[140:143], v[20:23], a[156:159], v[140:143]
  ds_read_b64_tr_b16 a[160:161], v2 offset:61440
  v_mfma_f32_16x16x32_bf16 v[140:143], v[16:19], a[140:143], v[140:143]
  ds_read_b64_tr_b16 a[162:163], v2 offset:63488
  v_mfma_f32_16x16x32_bf16 v[156:159], v[24:27], a[140:143], v[156:159]
  ds_read_b64_tr_b16 v[20:21], v3 offset:57344
  v_add_u32 v38, s46, v0
  s_waitcnt vmcnt(0)
  s_mov_b64 exec, 1
  buffer_store_dword v38, v0, s[8:11], s80 offen offset:0 sc1
  s_mov_b64 exec, -1
  v_mfma_f32_16x16x32_bf16 v[156:159], v[28:31], a[156:159], v[156:159]
  ds_read_b64_tr_b16 v[22:23], v3 offset:59392
  v_mfma_f32_16x16x32_bf16 v[152:155], v[28:31], a[152:155], v[152:155]
  ds_read_b64_tr_b16 v[16:17], v3 offset:61440
  v_mfma_f32_16x16x32_bf16 v[152:155], v[24:27], a[136:139], v[152:155]
  s_waitcnt lgkmcnt(7)
  ds_read_b64_tr_b16 v[18:19], v3 offset:63488
  v_mfma_f32_16x16x32_bf16 v[168:171], a[168:171], a[136:139], v[168:171]
  ds_read_b64_tr_b16 v[28:29], v4 offset:57344
  v_mfma_f32_16x16x32_bf16 v[168:171], a[172:175], a[152:155], v[168:171]
  ds_read_b64_tr_b16 v[30:31], v4 offset:59392
  v_mfma_f32_16x16x32_bf16 v[172:175], a[172:175], a[156:159], v[172:175]
  ds_read_b64_tr_b16 v[24:25], v4 offset:61440
  v_mfma_f32_16x16x32_bf16 v[172:175], a[168:171], a[140:143], v[172:175]
  ds_read_b64_tr_b16 v[26:27], v4 offset:63488
  v_mfma_f32_16x16x32_bf16 v[188:191], a[176:179], a[140:143], v[188:191]
  ds_read_b64_tr_b16 a[172:173], v5 offset:57344
  v_mfma_f32_16x16x32_bf16 v[188:191], a[180:183], a[156:159], v[188:191]
  ds_read_b64_tr_b16 a[174:175], v5 offset:59392
  v_mfma_f32_16x16x32_bf16 v[184:187], a[180:183], a[152:155], v[184:187]
  ds_read_b64_tr_b16 a[168:169], v5 offset:61440
  v_mfma_f32_16x16x32_bf16 v[184:187], a[176:179], a[136:139], v[184:187]
  s_waitcnt lgkmcnt(7)
  ds_read_b64_tr_b16 a[170:171], v5 offset:63488
  v_mfma_f32_16x16x32_bf16 v[136:139], a[164:167], a[196:199], v[136:139]
  ds_read_b64_tr_b16 a[180:181], v6 offset:40960
  v_mfma_f32_16x16x32_bf16 v[136:139], a[160:163], a[212:215], v[136:139]
  ds_read_b64_tr_b16 a[182:183], v6 offset:43008
  v_mfma_f32_16x16x32_bf16 v[140:143], a[160:163], a[216:219], v[140:143]
  ds_read_b64_tr_b16 a[176:177], v6 offset:45056
  v_mfma_f32_16x16x32_bf16 v[140:143], a[164:167], a[200:203], v[140:143]
  ds_read_b64_tr_b16 a[178:179], v6 offset:47104
  v_mfma_f32_16x16x32_bf16 v[156:159], v[20:23], a[200:203], v[156:159]
  ds_read_b64_tr_b16 a[160:161], v7 offset:40960
  v_mfma_f32_16x16x32_bf16 v[156:159], v[16:19], a[216:219], v[156:159]
  ds_read_b64_tr_b16 a[162:163], v7 offset:43008
  v_mfma_f32_16x16x32_bf16 v[152:155], v[16:19], a[212:215], v[152:155]
  ds_read_b64_tr_b16 a[164:165], v7 offset:45056
  v_cvt_pk_bf16_f32 v136, v136, v137
  v_cvt_pk_bf16_f32 v137, v138, v139
  v_cvt_pk_bf16_f32 v140, v140, v141
  v_cvt_pk_bf16_f32 v141, v142, v143
  v_mfma_f32_16x16x32_bf16 v[152:155], v[20:23], a[196:199], v[152:155]
  s_waitcnt lgkmcnt(7)
  ds_read_b64_tr_b16 a[166:167], v7 offset:47104
  v_mfma_f32_16x16x32_bf16 v[168:171], v[28:31], a[196:199], v[168:171]
  ds_read_b64_tr_b16 v[16:17], v8 offset:40960
  v_mfma_f32_16x16x32_bf16 v[168:171], v[24:27], a[212:215], v[168:171]
  ds_read_b64_tr_b16 v[18:19], v8 offset:43008
  v_mfma_f32_16x16x32_bf16 v[172:175], v[24:27], a[216:219], v[172:175]
  ds_read_b64_tr_b16 v[20:21], v8 offset:45056
  v_cvt_pk_bf16_f32 v138, v152, v153
  v_cvt_pk_bf16_f32 v139, v154, v155
  v_mfma_f32_16x16x32_bf16 v[172:175], v[28:31], a[200:203], v[172:175]
  ds_read_b64_tr_b16 v[22:23], v8 offset:47104
  v_mfma_f32_16x16x32_bf16 v[188:191], a[172:175], a[200:203], v[188:191]
  ds_read_b64_tr_b16 v[24:25], v9 offset:40960
  v_mfma_f32_16x16x32_bf16 v[188:191], a[168:171], a[216:219], v[188:191]
  ds_read_b64_tr_b16 v[26:27], v9 offset:43008
  s_add_u32 s86, s85, 8192
  buffer_store_dwordx4 v[136:139], v1, s[8:11], s86 offen offset:0 sc1
  v_mfma_f32_16x16x32_bf16 v[184:187], a[168:171], a[212:215], v[184:187]
  ds_read_b64_tr_b16 v[28:29], v9 offset:45056
  v_cvt_pk_bf16_f32 v142, v156, v157
  v_cvt_pk_bf16_f32 v143, v158, v159
  v_mfma_f32_16x16x32_bf16 v[184:187], a[172:175], a[196:199], v[184:187]
  s_waitcnt lgkmcnt(7)
  ds_read_b64_tr_b16 v[30:31], v9 offset:47104
  v_mfma_f32_16x16x32_bf16 v[128:131], a[180:183], a[220:223], v[128:131]
  ds_read_b64_tr_b16 a[168:169], v6 offset:57344
  v_mfma_f32_16x16x32_bf16 v[128:131], a[176:179], a[236:239], v[128:131]
  ds_read_b64_tr_b16 a[170:171], v6 offset:59392
  s_add_u32 s86, s85, 8192
  buffer_store_dwordx4 v[140:143], v1, s[8:11], s86 offen offset:2048 sc1
  v_mfma_f32_16x16x32_bf16 v[132:135], a[176:179], a[240:243], v[132:135]
  ds_read_b64_tr_b16 a[172:173], v6 offset:61440
  v_cvt_pk_bf16_f32 v168, v168, v169
  v_cvt_pk_bf16_f32 v169, v170, v171
  v_cvt_pk_bf16_f32 v172, v172, v173
  v_cvt_pk_bf16_f32 v173, v174, v175
  v_mfma_f32_16x16x32_bf16 v[132:135], a[180:183], a[224:227], v[132:135]
  ds_read_b64_tr_b16 a[174:175], v6 offset:63488
  v_cvt_pk_bf16_f32 v170, v184, v185
  v_cvt_pk_bf16_f32 v171, v186, v187
  v_mfma_f32_16x16x32_bf16 v[148:151], a[160:163], a[224:227], v[148:151]
  ds_read_b64_tr_b16 a[176:177], v7 offset:57344
  v_mfma_f32_16x16x32_bf16 v[148:151], a[164:167], a[240:243], v[148:151]
  ds_read_b64_tr_b16 a[178:179], v7 offset:59392
  v_mfma_f32_16x16x32_bf16 v[144:147], a[164:167], a[236:239], v[144:147]
  ds_read_b64_tr_b16 a[180:181], v7 offset:61440
  s_add_u32 s86, s85, 8192
  buffer_store_dwordx4 v[168:171], v1, s[8:11], s86 offen offset:1024 sc1
  v_mfma_f32_16x16x32_bf16 v[144:147], a[160:163], a[220:223], v[144:147]
  s_waitcnt lgkmcnt(7)
  ds_read_b64_tr_b16 a[182:183], v7 offset:63488
  v_cvt_pk_bf16_f32 v174, v188, v189
  v_cvt_pk_bf16_f32 v175, v190, v191
  v_mfma_f32_16x16x32_bf16 v[160:163], v[16:19], a[220:223], v[160:163]
  ds_read_b64_tr_b16 a[164:165], v8 offset:57344
  v_mfma_f32_16x16x32_bf16 v[160:163], v[20:23], a[236:239], v[160:163]
  ds_read_b64_tr_b16 a[166:167], v8 offset:59392
  v_mfma_f32_16x16x32_bf16 v[164:167], v[20:23], a[240:243], v[164:167]
  ds_read_b64_tr_b16 a[160:161], v8 offset:61440
  s_add_u32 s86, s85, 8192
  buffer_store_dwordx4 v[172:175], v1, s[8:11], s86 offen offset:3072 sc1
  v_mfma_f32_16x16x32_bf16 v[164:167], v[16:19], a[224:227], v[164:167]
  ds_read_b64_tr_b16 a[162:163], v8 offset:63488
  v_mfma_f32_16x16x32_bf16 v[180:183], v[24:27], a[224:227], v[180:183]
  ds_read_b64_tr_b16 v[20:21], v9 offset:57344
  v_mfma_f32_16x16x32_bf16 v[180:183], v[28:31], a[240:243], v[180:183]
  ds_read_b64_tr_b16 v[22:23], v9 offset:59392
  v_mfma_f32_16x16x32_bf16 v[176:179], v[28:31], a[236:239], v[176:179]
  ds_read_b64_tr_b16 v[16:17], v9 offset:61440
  v_mfma_f32_16x16x32_bf16 v[176:179], v[24:27], a[220:223], v[176:179]
  s_waitcnt lgkmcnt(7)
  ds_read_b64_tr_b16 v[18:19], v9 offset:63488
  v_mfma_f32_16x16x32_bf16 v[128:131], a[168:171], a[0:3], v[128:131]
  ds_read_b64_tr_b16 v[28:29], v6 offset:24576
  v_mfma_f32_16x16x32_bf16 v[128:131], a[172:175], a[16:19], v[128:131]
  ds_read_b64_tr_b16 v[30:31], v6 offset:26624
  v_mfma_f32_16x16x32_bf16 v[132:135], a[172:175], a[20:23], v[132:135]
  ds_read_b64_tr_b16 v[24:25], v6 offset:28672
  v_mfma_f32_16x16x32_bf16 v[132:135], a[168:171], a[4:7], v[132:135]
  ds_read_b64_tr_b16 v[26:27], v6 offset:30720
  v_mfma_f32_16x16x32_bf16 v[148:151], a[176:179], a[4:7], v[148:151]
  ds_read_b64_tr_b16 a[172:173], v7 offset:24576
  v_mfma_f32_16x16x32_bf16 v[148:151], a[180:183], a[20:23], v[148:151]
  ds_read_b64_tr_b16 a[174:175], v7 offset:26624
  v_mfma_f32_16x16x32_bf16 v[144:147], a[180:183], a[16:19], v[144:147]
  ds_read_b64_tr_b16 a[168:169], v7 offset:28672
  v_mfma_f32_16x16x32_bf16 v[144:147], a[176:179], a[0:3], v[144:147]
  s_waitcnt lgkmcnt(7)
  ds_read_b64_tr_b16 a[170:171], v7 offset:30720
  v_mfma_f32_16x16x32_bf16 v[160:163], a[164:167], a[0:3], v[160:163]
  ds_read_b64_tr_b16 a[180:181], v8 offset:24576
  v_mfma_f32_16x16x32_bf16 v[160:163], a[160:163], a[16:19], v[160:163]
  ds_read_b64_tr_b16 a[182:183], v8 offset:26624
  v_mfma_f32_16x16x32_bf16 v[164:167], a[160:163], a[20:23], v[164:167]
  ds_read_b64_tr_b16 a[176:177], v8 offset:28672
  v_mfma_f32_16x16x32_bf16 v[164:167], a[164:167], a[4:7], v[164:167]
  ds_read_b64_tr_b16 a[178:179], v8 offset:30720
  v_mfma_f32_16x16x32_bf16 v[180:183], v[20:23], a[4:7], v[180:183]
  ds_read_b64_tr_b16 a[160:161], v9 offset:24576
  v_mfma_f32_16x16x32_bf16 v[180:183], v[16:19], a[20:23], v[180:183]
  ds_read_b64_tr_b16 a[162:163], v9 offset:26624
  v_mfma_f32_16x16x32_bf16 v[176:179], v[16:19], a[16:19], v[176:179]
  ds_read_b64_tr_b16 a[164:165], v9 offset:28672
  v_mfma_f32_16x16x32_bf16 v[176:179], v[20:23], a[0:3], v[176:179]
  s_waitcnt lgkmcnt(7)
  ds_read_b64_tr_b16 a[166:167], v9 offset:30720
  v_mfma_f32_16x16x32_bf16 v[128:131], v[28:31], a[32:35], v[128:131]
  ds_read_b64_tr_b16 v[16:17], v6 offset:8192
  v_mfma_f32_16x16x32_bf16 v[128:131], v[24:27], a[48:51], v[128:131]
  ds_read_b64_tr_b16 v[18:19], v6 offset:10240
  v_mfma_f32_16x16x32_bf16 v[132:135], v[24:27], a[52:55], v[132:135]
  ds_read_b64_tr_b16 v[20:21], v6 offset:12288
  v_mfma_f32_16x16x32_bf16 v[132:135], v[28:31], a[36:39], v[132:135]
  ds_read_b64_tr_b16 v[22:23], v6 offset:14336
  v_mfma_f32_16x16x32_bf16 v[148:151], a[172:175], a[36:39], v[148:151]
  ds_read_b64_tr_b16 v[24:25], v7 offset:8192
  v_mfma_f32_16x16x32_bf16 v[148:151], a[168:171], a[52:55], v[148:151]
  ds_read_b64_tr_b16 v[26:27], v7 offset:10240
  s_xor_b32 s83, s80, 1536
  s_add_u32 s83, s83, 0
  buffer_load_dword v34, v37, s[8:11], s83 offen sc1
  v_mfma_f32_16x16x32_bf16 v[144:147], a[168:171], a[48:51], v[144:147]
  ds_read_b64_tr_b16 v[28:29], v7 offset:12288
  s_xor_b32 s90, s80, 512
  s_add_u32 s90, s90, 0
  buffer_load_dword v39, v37, s[8:11], s90 offen sc1
  v_mfma_f32_16x16x32_bf16 v[144:147], a[172:175], a[32:35], v[144:147]
  s_waitcnt lgkmcnt(7)
  ds_read_b64_tr_b16 v[30:31], v7 offset:14336
  v_mfma_f32_16x16x32_bf16 v[160:163], a[180:183], a[32:35], v[160:163]
  ds_read_b64_tr_b16 a[168:169], v8 offset:8192
  v_mfma_f32_16x16x32_bf16 v[160:163], a[176:179], a[48:51], v[160:163]
  ds_read_b64_tr_b16 a[170:171], v8 offset:10240
  v_mfma_f32_16x16x32_bf16 v[164:167], a[176:179], a[52:55], v[164:167]
  ds_read_b64_tr_b16 a[172:173], v8 offset:12288
  v_mfma_f32_16x16x32_bf16 v[164:167], a[180:183], a[36:39], v[164:167]
  ds_read_b64_tr_b16 a[174:175], v8 offset:14336
  v_mfma_f32_16x16x32_bf16 v[180:183], a[160:163], a[36:39], v[180:183]
  ds_read_b64_tr_b16 a[176:177], v9 offset:8192
  v_mfma_f32_16x16x32_bf16 v[180:183], a[164:167], a[52:55], v[180:183]
  ds_read_b64_tr_b16 a[178:179], v9 offset:10240
  v_mfma_f32_16x16x32_bf16 v[176:179], a[164:167], a[48:51], v[176:179]
  ds_read_b64_tr_b16 a[180:181], v9 offset:12288
  v_mfma_f32_16x16x32_bf16 v[176:179], a[160:163], a[32:35], v[176:179]
  s_waitcnt lgkmcnt(7)
  ds_read_b64_tr_b16 a[182:183], v9 offset:14336
  v_add_u32 v38, s46, v0
  s_waitcnt vmcnt(2)
  s_mov_b64 exec, 1
  buffer_store_dword v38, v0, s[8:11], s80 offen offset:16 sc1
  s_mov_b64 exec, -1
  v_mfma_f32_16x16x32_bf16 v[128:131], v[16:19], a[64:67], v[128:131]
  ds_read_b64_tr_b16 a[164:165], v2 offset:8192
  v_mfma_f32_16x16x32_bf16 v[128:131], v[20:23], a[80:83], v[128:131]
  ds_read_b64_tr_b16 a[166:167], v2 offset:10240
  v_mfma_f32_16x16x32_bf16 v[132:135], v[20:23], a[84:87], v[132:135]
  ds_read_b64_tr_b16 a[160:161], v2 offset:12288
  v_mfma_f32_16x16x32_bf16 v[132:135], v[16:19], a[68:71], v[132:135]
  ds_read_b64_tr_b16 a[162:163], v2 offset:14336
  s_xor_b32 s81, s80, 1024
  s_add_u32 s81, s81, 16
  buffer_load_dword v36, v37, s[8:11], s81 offen sc1
  v_mfma_f32_16x16x32_bf16 v[148:151], v[24:27], a[68:71], v[148:151]
  ds_read_b64_tr_b16 v[20:21], v3 offset:8192
  v_mfma_f32_16x16x32_bf16 v[148:151], v[28:31], a[84:87], v[148:151]
  ds_read_b64_tr_b16 v[22:23], v3 offset:10240
  v_mfma_f32_16x16x32_bf16 v[144:147], v[28:31], a[80:83], v[144:147]
  ds_read_b64_tr_b16 v[16:17], v3 offset:12288
  v_mfma_f32_16x16x32_bf16 v[144:147], v[24:27], a[64:67], v[144:147]
  s_waitcnt lgkmcnt(7)
  ds_read_b64_tr_b16 v[18:19], v3 offset:14336
  v_mfma_f32_16x16x32_bf16 v[160:163], a[168:171], a[64:67], v[160:163]
  ds_read_b64_tr_b16 v[28:29], v4 offset:8192
  v_mfma_f32_16x16x32_bf16 v[160:163], a[172:175], a[80:83], v[160:163]
  ds_read_b64_tr_b16 v[30:31], v4 offset:10240
  v_mfma_f32_16x16x32_bf16 v[164:167], a[172:175], a[84:87], v[164:167]
  ds_read_b64_tr_b16 v[24:25], v4 offset:12288
  v_mfma_f32_16x16x32_bf16 v[164:167], a[168:171], a[68:71], v[164:167]
  ds_read_b64_tr_b16 v[26:27], v4 offset:14336
  v_mfma_f32_16x16x32_bf16 v[180:183], a[176:179], a[68:71], v[180:183]
  ds_read_b64_tr_b16 a[172:173], v5 offset:8192
  v_mfma_f32_16x16x32_bf16 v[180:183], a[180:183], a[84:87], v[180:183]
  ds_read_b64_tr_b16 a[174:175], v5 offset:10240
  v_mfma_f32_16x16x32_bf16 v[176:179], a[180:183], a[80:83], v[176:179]
  ds_read_b64_tr_b16 a[168:169], v5 offset:12288
  v_mfma_f32_16x16x32_bf16 v[176:179], a[176:179], a[64:67], v[176:179]
  s_waitcnt lgkmcnt(7)
  ds_read_b64_tr_b16 a[170:171], v5 offset:14336
  v_mfma_f32_16x16x32_bf16 v[128:131], a[164:167], a[96:99], v[128:131]
  ds_read_b64_tr_b16 a[180:181], v2 offset:40960
  v_mfma_f32_16x16x32_bf16 v[128:131], a[160:163], a[112:115], v[128:131]
  ds_read_b64_tr_b16 a[182:183], v2 offset:43008
  s_waitcnt vmcnt(3)
  v_cmp_ne_u32 vcc, s46, v34
  s_nop 4
  s_cbranch_vccz PL14_adaLN_cond__sliding_local_dilated__swiglu_ffn__prompt_kernelx
  s_mov_b32 s82, 60000
PL14_adaLN_cond__sliding_local_dilated__swiglu_ffn__prompt_kernel:
  buffer_load_dword v34, v37, s[8:11], s83 offen sc1
  s_sub_u32 s82, s82, 1
  s_cmp_eq_u32 s82, 0
  s_waitcnt vmcnt(0)
  s_cbranch_scc1 PL14_adaLN_cond__sliding_local_dilated__swiglu_ffn__prompt_kernelx
  v_cmp_ne_u32 vcc, s46, v34
  s_nop 4
  s_cbranch_vccnz PL14_adaLN_cond__sliding_local_dilated__swiglu_ffn__prompt_kernel
PL14_adaLN_cond__sliding_local_dilated__swiglu_ffn__prompt_kernelx:
  v_mfma_f32_16x16x32_bf16 v[132:135], a[160:163], a[116:119], v[132:135]
  ds_read_b64_tr_b16 a[176:177], v2 offset:45056
  s_xor_b32 s55, s85, 196608
  s_add_u32 s55, s55, 0
  buffer_load_dwordx4 v[88:91], v1, s[8:11], s55 offen offset:0 sc1
  v_mfma_f32_16x16x32_bf16 v[132:135], a[164:167], a[100:103], v[132:135]
  ds_read_b64_tr_b16 a[178:179], v2 offset:47104
  s_xor_b32 s55, s85, 196608
  s_add_u32 s55, s55, 0
  buffer_load_dwordx4 v[120:123], v1, s[8:11], s55 offen offset:1024 sc1
  v_mfma_f32_16x16x32_bf16 v[148:151], v[20:23], a[100:103], v[148:151]
  ds_read_b64_tr_b16 a[160:161], v3 offset:40960
  s_xor_b32 s55, s85, 196608
  s_add_u32 s55, s55, 0
  buffer_load_dwordx4 v[92:95], v1, s[8:11], s55 offen offset:2048 sc1
  v_mfma_f32_16x16x32_bf16 v[148:151], v[16:19], a[116:119], v[148:151]
  ds_read_b64_tr_b16 a[162:163], v3 offset:43008
  s_xor_b32 s55, s85, 196608
  s_add_u32 s55, s55, 0
  buffer_load_dwordx4 v[124:127], v1, s[8:11], s55 offen offset:3072 sc1
  v_mfma_f32_16x16x32_bf16 v[144:147], v[16:19], a[112:115], v[144:147]
  ds_read_b64_tr_b16 a[164:165], v3 offset:45056
  s_waitcnt vmcnt(6)
  v_cmp_ne_u32 vcc, s46, v39
  s_nop 4
  s_cbranch_vccz PL15_adaLN_cond__sliding_local_dilated__swiglu_ffn__prompt_kernelx
  s_mov_b32 s82, 60000
PL15_adaLN_cond__sliding_local_dilated__swiglu_ffn__prompt_kernel:
  buffer_load_dword v39, v37, s[8:11], s90 offen sc1
  s_sub_u32 s82, s82, 1
  s_cmp_eq_u32 s82, 0
  s_waitcnt vmcnt(0)
  s_cbranch_scc1 PL15_adaLN_cond__sliding_local_dilated__swiglu_ffn__prompt_kernelx
  v_cmp_ne_u32 vcc, s46, v39
  s_nop 4
  s_cbranch_vccnz PL15_adaLN_cond__sliding_local_dilated__swiglu_ffn__prompt_kernel
PL15_adaLN_cond__sliding_local_dilated__swiglu_ffn__prompt_kernelx:
  v_mfma_f32_16x16x32_bf16 v[144:147], v[20:23], a[96:99], v[144:147]
  s_waitcnt lgkmcnt(7)
  ds_read_b64_tr_b16 a[166:167], v3 offset:47104
  s_xor_b32 s55, s85, 65536
  s_add_u32 s55, s55, 4096
  buffer_load_dwordx4 v[80:83], v1, s[8:11], s55 offen offset:0 sc1
  v_mfma_f32_16x16x32_bf16 v[160:163], v[28:31], a[96:99], v[160:163]
  ds_read_b64_tr_b16 v[16:17], v4 offset:40960
  s_xor_b32 s55, s85, 65536
  s_add_u32 s55, s55, 4096
  buffer_load_dwordx4 v[112:115], v1, s[8:11], s55 offen offset:1024 sc1
  v_mfma_f32_16x16x32_bf16 v[160:163], v[24:27], a[112:115], v[160:163]
  ds_read_b64_tr_b16 v[18:19], v4 offset:43008
  s_xor_b32 s55, s85, 65536
  s_add_u32 s55, s55, 4096
  buffer_load_dwordx4 v[84:87], v1, s[8:11], s55 offen offset:2048 sc1
  v_mfma_f32_16x16x32_bf16 v[164:167], v[24:27], a[116:119], v[164:167]
  ds_read_b64_tr_b16 v[20:21], v4 offset:45056
  s_xor_b32 s55, s85, 65536
  s_add_u32 s55, s55, 4096
  buffer_load_dwordx4 v[116:119], v1, s[8:11], s55 offen offset:3072 sc1
  v_mfma_f32_16x16x32_bf16 v[164:167], v[28:31], a[100:103], v[164:167]
  ds_read_b64_tr_b16 v[22:23], v4 offset:47104
  v_mfma_f32_16x16x32_bf16 v[180:183], a[172:175], a[100:103], v[180:183]
  ds_read_b64_tr_b16 v[24:25], v5 offset:40960
  v_mfma_f32_16x16x32_bf16 v[180:183], a[168:171], a[116:119], v[180:183]
  ds_read_b64_tr_b16 v[26:27], v5 offset:43008
  s_waitcnt vmcnt(8)
  v_cmp_ne_u32 vcc, s46, v36
  s_mov_b32 s86, 0
  s_nop 3
  s_cbranch_vccnz XL16_adaLN_cond__sliding_local_dilated__swiglu_ffn__prompt_kernel
  s_xor_b32 s55, s85, 131072
  s_add_u32 s55, s55, 8192
  buffer_load_dwordx4 v[152:155], v1, s[8:11], s55 offen offset:0 sc1
  buffer_load_dwordx4 v[184:187], v1, s[8:11], s55 offen offset:1024 sc1
  buffer_load_dwordx4 v[156:159], v1, s[8:11], s55 offen offset:2048 sc1
  buffer_load_dwordx4 v[188:191], v1, s[8:11], s55 offen offset:3072 sc1
  s_mov_b32 s86, 1
XL16_adaLN_cond__sliding_local_dilated__swiglu_ffn__prompt_kernel:
  v_mfma_f32_16x16x32_bf16 v[176:179], a[168:171], a[112:115], v[176:179]
  ds_read_b64_tr_b16 v[28:29], v5 offset:45056
  v_mfma_f32_16x16x32_bf16 v[176:179], a[172:175], a[96:99], v[176:179]
  s_waitcnt lgkmcnt(7)
  ds_read_b64_tr_b16 v[30:31], v5 offset:47104
  v_mfma_f32_16x16x32_bf16 v[128:131], a[180:183], a[128:131], v[128:131]
  ds_read_b64_tr_b16 a[168:169], v2 offset:57344
  v_mfma_f32_16x16x32_bf16 v[128:131], a[176:179], a[144:147], v[128:131]
  ds_read_b64_tr_b16 a[170:171], v2 offset:59392
  v_mfma_f32_16x16x32_bf16 v[132:135], a[176:179], a[148:151], v[132:135]
  ds_read_b64_tr_b16 a[172:173], v2 offset:61440
  v_mfma_f32_16x16x32_bf16 v[132:135], a[180:183], a[132:135], v[132:135]
  ds_read_b64_tr_b16 a[174:175], v2 offset:63488
  v_mfma_f32_16x16x32_bf16 v[148:151], a[160:163], a[132:135], v[148:151]
  ds_read_b64_tr_b16 a[176:177], v3 offset:57344
  v_mfma_f32_16x16x32_bf16 v[148:151], a[164:167], a[148:151], v[148:151]
  ds_read_b64_tr_b16 a[178:179], v3 offset:59392
  v_mfma_f32_16x16x32_bf16 v[144:147], a[164:167], a[144:147], v[144:147]
  ds_read_b64_tr_b16 a[180:181], v3 offset:61440
  v_mfma_f32_16x16x32_bf16 v[144:147], a[160:163], a[128:131], v[144:147]
  s_waitcnt lgkmcnt(7)
  ds_read_b64_tr_b16 a[182:183], v3 offset:63488
  v_mfma_f32_16x16x32_bf16 v[160:163], v[16:19], a[128:131], v[160:163]
  ds_read_b64_tr_b16 a[164:165], v4 offset:57344
  v_mfma_f32_16x16x32_bf16 v[160:163], v[20:23], a[144:147], v[160:163]
  ds_read_b64_tr_b16 a[166:167], v4 offset:59392
  v_mfma_f32_16x16x32_bf16 v[164:167], v[20:23], a[148:151], v[164:167]
  ds_read_b64_tr_b16 a[160:161], v4 offset:61440
  v_mfma_f32_16x16x32_bf16 v[164:167], v[16:19], a[132:135], v[164:167]
  ds_read_b64_tr_b16 a[162:163], v4 offset:63488
  v_mfma_f32_16x16x32_bf16 v[180:183], v[24:27], a[132:135], v[180:183]
  ds_read_b64_tr_b16 v[20:21], v5 offset:57344
  v_mfma_f32_16x16x32_bf16 v[180:183], v[28:31], a[148:151], v[180:183]
  ds_read_b64_tr_b16 v[22:23], v5 offset:59392
  v_mfma_f32_16x16x32_bf16 v[176:179], v[28:31], a[144:147], v[176:179]
  ds_read_b64_tr_b16 v[16:17], v5 offset:61440
  v_mfma_f32_16x16x32_bf16 v[176:179], v[24:27], a[128:131], v[176:179]
  s_waitcnt lgkmcnt(7)
  ds_read_b64_tr_b16 v[18:19], v5 offset:63488
  v_mfma_f32_16x16x32_bf16 v[128:131], a[168:171], a[188:191], v[128:131]
  v_mfma_f32_16x16x32_bf16 v[128:131], a[172:175], a[204:207], v[128:131]
  v_mfma_f32_16x16x32_bf16 v[132:135], a[172:175], a[208:211], v[132:135]
  v_mfma_f32_16x16x32_bf16 v[132:135], a[168:171], a[192:195], v[132:135]
  v_mfma_f32_16x16x32_bf16 v[148:151], a[176:179], a[192:195], v[148:151]
  v_mfma_f32_16x16x32_bf16 v[148:151], a[180:183], a[208:211], v[148:151]
  v_mfma_f32_16x16x32_bf16 v[144:147], a[180:183], a[204:207], v[144:147]
  v_mfma_f32_16x16x32_bf16 v[144:147], a[176:179], a[188:191], v[144:147]
  s_waitcnt lgkmcnt(0)
  v_mfma_f32_16x16x32_bf16 v[160:163], a[164:167], a[188:191], v[160:163]
  v_mfma_f32_16x16x32_bf16 v[160:163], a[160:163], a[204:207], v[160:163]
  v_mfma_f32_16x16x32_bf16 v[164:167], a[160:163], a[208:211], v[164:167]
  v_mfma_f32_16x16x32_bf16 v[164:167], a[164:167], a[192:195], v[164:167]
  v_mfma_f32_16x16x32_bf16 v[180:183], v[20:23], a[192:195], v[180:183]
  v_mfma_f32_16x16x32_bf16 v[180:183], v[16:19], a[208:211], v[180:183]
  v_mfma_f32_16x16x32_bf16 v[176:179], v[16:19], a[204:207], v[176:179]
  v_mfma_f32_16x16x32_bf16 v[176:179], v[20:23], a[188:191], v[176:179]
  s_waitcnt vmcnt(0)
  v_mfma_f32_16x16x32_bf16 v[208:211], v[52:55], v[88:91], v[208:211]
  v_mfma_f32_16x16x32_bf16 v[212:215], v[54:57], v[88:91], v[212:215]
  v_mfma_f32_16x16x32_bf16 v[216:219], v[58:61], v[120:123], v[216:219]
  v_mfma_f32_16x16x32_bf16 v[220:223], v[60:63], v[120:123], v[220:223]
  v_mfma_f32_16x16x32_bf16 v[224:227], v[52:55], v[92:95], v[224:227]
  v_mfma_f32_16x16x32_bf16 v[228:231], v[54:57], v[92:95], v[228:231]
  v_mfma_f32_16x16x32_bf16 v[232:235], v[58:61], v[124:127], v[232:235]
  v_mfma_f32_16x16x32_bf16 v[236:239], v[60:63], v[124:127], v[236:239]
  v_mfma_f32_16x16x32_bf16 v[208:211], v[52:55], v[80:83], v[208:211]
  v_mfma_f32_16x16x32_bf16 v[212:215], v[54:57], v[80:83], v[212:215]
  v_mfma_f32_16x16x32_bf16 v[216:219], v[58:61], v[112:115], v[216:219]
  v_mfma_f32_16x16x32_bf16 v[220:223], v[60:63], v[112:115], v[220:223]
  v_mfma_f32_16x16x32_bf16 v[224:227], v[52:55], v[84:87], v[224:227]
  v_mfma_f32_16x16x32_bf16 v[228:231], v[54:57], v[84:87], v[228:231]
  v_mfma_f32_16x16x32_bf16 v[232:235], v[58:61], v[116:119], v[232:235]
  v_mfma_f32_16x16x32_bf16 v[236:239], v[60:63], v[116:119], v[236:239]
  s_nop 0
  v_fmac_f32 v208, v240, v128
  v_fmac_f32 v209, v241, v129
  v_fmac_f32 v210, v242, v130
  v_fmac_f32 v211, v243, v131
  v_fmac_f32 v212, v244, v144
  v_fmac_f32 v213, v245, v145
  v_fmac_f32 v214, v246, v146
  v_fmac_f32 v215, v247, v147
  v_fmac_f32 v224, v240, v132
  v_fmac_f32 v225, v241, v133
  v_fmac_f32 v226, v242, v134
  v_fmac_f32 v227, v243, v135
  v_fmac_f32 v228, v244, v148
  v_fmac_f32 v229, v245, v149
  v_fmac_f32 v230, v246, v150
  v_fmac_f32 v231, v247, v151
  v_fmac_f32 v216, v248, v160
  v_fmac_f32 v217, v249, v161
  v_fmac_f32 v218, v250, v162
  v_fmac_f32 v219, v251, v163
  v_fmac_f32 v220, v252, v176
  v_fmac_f32 v221, v253, v177
  v_fmac_f32 v222, v254, v178
  v_fmac_f32 v223, v255, v179
  v_fmac_f32 v232, v248, v164
  v_fmac_f32 v233, v249, v165
  v_fmac_f32 v234, v250, v166
  v_fmac_f32 v235, v251, v167
  v_fmac_f32 v236, v252, v180
  v_fmac_f32 v237, v253, v181
  v_fmac_f32 v238, v254, v182
  v_fmac_f32 v239, v255, v183
  s_cmp_eq_u32 s86, 1
  s_cbranch_scc1 XA17_adaLN_cond__sliding_local_dilated__swiglu_ffn__prompt_kernelx
  s_mov_b32 s82, 60000
XA17_adaLN_cond__sliding_local_dilated__swiglu_ffn__prompt_kernel:
  buffer_load_dword v36, v37, s[8:11], s81 offen sc1
  s_sub_u32 s82, s82, 1
  s_cmp_eq_u32 s82, 0
  s_waitcnt vmcnt(0)
  s_cbranch_scc1 XA17_adaLN_cond__sliding_local_dilated__swiglu_ffn__prompt_kernely
  v_cmp_ne_u32 vcc, s46, v36
  s_nop 4
  s_cbranch_vccnz XA17_adaLN_cond__sliding_local_dilated__swiglu_ffn__prompt_kernel
XA17_adaLN_cond__sliding_local_dilated__swiglu_ffn__prompt_kernely:
  s_xor_b32 s55, s85, 131072
  s_add_u32 s55, s55, 8192
  buffer_load_dwordx4 v[152:155], v1, s[8:11], s55 offen offset:0 sc1
  buffer_load_dwordx4 v[184:187], v1, s[8:11], s55 offen offset:1024 sc1
  buffer_load_dwordx4 v[156:159], v1, s[8:11], s55 offen offset:2048 sc1
  buffer_load_dwordx4 v[188:191], v1, s[8:11], s55 offen offset:3072 sc1
XA17_adaLN_cond__sliding_local_dilated__swiglu_ffn__prompt_kernelx:
  s_waitcnt vmcnt(3)
  v_mfma_f32_16x16x32_bf16 v[208:211], v[52:55], v[152:155], v[208:211]
  v_mfma_f32_16x16x32_bf16 v[212:215], v[54:57], v[152:155], v[212:215]
  s_waitcnt vmcnt(2)
  v_mfma_f32_16x16x32_bf16 v[216:219], v[58:61], v[184:187], v[216:219]
  v_mfma_f32_16x16x32_bf16 v[220:223], v[60:63], v[184:187], v[220:223]
  s_waitcnt vmcnt(1)
  v_mfma_f32_16x16x32_bf16 v[224:227], v[52:55], v[156:159], v[224:227]
  v_mfma_f32_16x16x32_bf16 v[228:231], v[54:57], v[156:159], v[228:231]
  s_waitcnt vmcnt(0)
  v_mfma_f32_16x16x32_bf16 v[232:235], v[58:61], v[188:191], v[232:235]
  v_mfma_f32_16x16x32_bf16 v[236:239], v[60:63], v[188:191], v[236:239]
  v_cvt_pk_bf16_f32 v192, v208, v209
  v_cvt_pk_bf16_f32 v193, v210, v211
  v_cvt_pk_bf16_f32 v194, v212, v213
  v_cvt_pk_bf16_f32 v195, v214, v215
  s_nop 0
  v_permlane16_swap_b32 v192, v194
  v_permlane16_swap_b32 v193, v195
  ds_write_b128 v42, v[192:195] offset:0
  v_cvt_pk_bf16_f32 v196, v216, v217
  v_cvt_pk_bf16_f32 v197, v218, v219
  v_cvt_pk_bf16_f32 v198, v220, v221
  v_cvt_pk_bf16_f32 v199, v222, v223
  s_nop 0
  v_permlane16_swap_b32 v196, v198
  v_permlane16_swap_b32 v197, v199
  ds_write_b128 v43, v[196:199] offset:0
  ds_read_b128 v[208:211], v44 offset:0
  ds_read_b128 v[212:215], v44 offset:1024
  v_cvt_pk_bf16_f32 v200, v224, v225
  v_cvt_pk_bf16_f32 v201, v226, v227
  v_cvt_pk_bf16_f32 v202, v228, v229
  v_cvt_pk_bf16_f32 v203, v230, v231
  s_nop 0
  v_permlane16_swap_b32 v200, v202
  v_permlane16_swap_b32 v201, v203
  ds_write_b128 v42, v[200:203] offset:2048
  v_cvt_pk_bf16_f32 v204, v232, v233
  v_cvt_pk_bf16_f32 v205, v234, v235
  v_cvt_pk_bf16_f32 v206, v236, v237
  v_cvt_pk_bf16_f32 v207, v238, v239
  s_nop 0
  v_permlane16_swap_b32 v204, v206
  v_permlane16_swap_b32 v205, v207
  ds_write_b128 v43, v[204:207] offset:2048
  ds_read_b128 v[224:227], v44 offset:2048
  ds_read_b128 v[228:231], v44 offset:3072
  s_waitcnt lgkmcnt(5)
  buffer_store_dwordx4 v[208:211], v40, s[40:43], s84 offen sc1
  s_add_u32 s84, s84, 16384
  s_waitcnt lgkmcnt(4)
  buffer_store_dwordx4 v[212:215], v40, s[40:43], s84 offen sc1
  s_add_u32 s84, s84, 16384
  s_waitcnt lgkmcnt(1)
  buffer_store_dwordx4 v[224:227], v40, s[40:43], s84 offen sc1
  s_add_u32 s84, s84, 16384
  s_waitcnt lgkmcnt(0)
  buffer_store_dwordx4 v[228:231], v40, s[40:43], s84 offen sc1
E_adaLN_cond__sliding_local_dilated__swiglu_ffn__prompt_kernel:
X_adaLN_cond__sliding_local_dilated__swiglu_ffn__prompt_kernel:
  s_endpgm
code_end:
.fill 2048, 4, 0xBF800000
.section .rodata,"a"
.p2align 6
.amdhsa_kernel adaLN_cond__sliding_local_dilated__swiglu_ffn__prompt_kernel
  .amdhsa_next_free_vgpr 512
  .amdhsa_next_free_sgpr 102
  .amdhsa_accum_offset 256
  .amdhsa_group_segment_fixed_size 0
  .amdhsa_kernarg_size 96
  .amdhsa_user_sgpr_count 2
  .amdhsa_user_sgpr_kernarg_segment_ptr 1
  .amdhsa_system_sgpr_workgroup_id_x 1
  .amdhsa_float_denorm_mode_32 3
.end_amdhsa_kernel
```

```asm
; @launch grid=(256,1,1) block=(256,1,1) lds=163840
.amdgcn_target "amdgcn-amd-amdhsa--gfx950"
.text
.globl adaLN_cond__sliding_local_dilated__swiglu_ffn__prompt_kernel
.type adaLN_cond__sliding_local_dilated__swiglu_ffn__prompt_kernel,@function
.p2align 8
adaLN_cond__sliding_local_dilated__swiglu_ffn__prompt_kernel:
  s_cmp_ge_u32 s2, 256
  s_cbranch_scc1 X_adaLN_cond__sliding_local_dilated__swiglu_ffn__prompt_kernel
  s_load_dwordx2 s[4:5], s[0:1], 0
  s_load_dwordx2 s[8:9], s[0:1], 88
  s_load_dwordx2 s[12:13], s[0:1], 8
  s_load_dwordx2 s[16:17], s[0:1], 16
  s_load_dwordx2 s[20:21], s[0:1], 64
  s_load_dwordx2 s[24:25], s[0:1], 56
  s_load_dwordx2 s[28:29], s[0:1], 32
  s_load_dwordx2 s[32:33], s[0:1], 40
  s_load_dwordx2 s[36:37], s[0:1], 48
  s_load_dwordx2 s[40:41], s[0:1], 72
  v_lshrrev_b32 v21, 6, v0
  v_and_b32 v0, 63, v0
  v_readfirstlane_b32 s44, v21
  v_lshrrev_b32 v22, 3, v0
  v_lshlrev_b32 v1, 4, v0
  s_lshr_b32 s83, s2, 3
  s_lshl_b32 s83, s83, 2
  s_add_u32 s83, s83, s44
  s_lshl_b32 s83, s83, 10
  s_getpc_b64 s[80:81]
CT1_adaLN_cond__sliding_local_dilated__swiglu_ffn__prompt_kernel:
  s_min_u32 s82, s83, code_end-CB0
  s_add_u32 s82, s82, CB0-CT1_adaLN_cond__sliding_local_dilated__swiglu_ffn__prompt_kernel
  s_add_u32 s80, s80, s82
  s_addc_u32 s81, s81, 0
  v_and_b32 v24, 0x70, v1
  v_lshlrev_b32 v24, 3, v24
  global_load_dword a253, v24, s[80:81]
  v_bfe_u32 v11, v22, 1, 2
  v_bfe_u32 v23, v0, 1, 2
  v_xor_b32 v11, v11, v23
  v_lshlrev_b32 v11, 5, v11
  v_and_b32 v23, 1, v0
  v_lshl_add_u32 v11, v23, 4, v11
  s_lshl_b32 s45, s44, 10
  s_lshl_b32 s52, s44, 3
  v_add_u32 v10, s52, v22
  s_and_b32 s52, s2, 7
  s_lshl_b32 s52, s52, 7
  v_add_u32 v35, s52, v10
  v_mul_u32_u24 v35, 12288, v35
  s_lshr_b32 s53, s2, 3
  s_lshl_b32 s53, s53, 7
  v_add3_u32 v35, v35, v11, s53
  s_and_b32 s53, s44, 1
  s_lshl_b32 s53, s53, 6
  s_add_u32 s52, s52, s53
  v_add_lshl_u32 v16, s52, v0, 1
  s_and_b32 s52, s2, 7
  s_lshr_b32 s53, s2, 3
  s_and_b32 s51, s52, 3
  s_lshl_b32 s51, s51, 2
  s_and_b32 s50, s53, 3
  s_add_u32 s51, s51, s50
  s_lshr_b32 s50, s52, 2
  s_lshl_b32 s50, s50, 3
  s_lshr_b32 s53, s53, 2
  s_add_u32 s50, s50, s53
  s_lshl_b32 s54, s50, 4
  s_add_u32 s54, s54, s51
  v_and_b32 v21, 7, v0
  v_lshlrev_b32 v28, 11, v21
  v_lshl_add_u32 v28, v22, 4, v28
  v_mov_b32 v29, 851968
  s_lshr_b32 s38, s54, 1
  s_lshl_b32 s38, s38, 15
  s_and_b32 s53, s54, 1
  s_lshl_b32 s53, s53, 2
  s_add_u32 s53, s53, s44
  s_lshl_b32 s52, s53, 8
  s_add_u32 s30, s38, s52
  s_mov_b32 s6, 4194304
  s_mov_b32 s7, 0x20000
  s_mov_b32 s10, 134217728
  s_mov_b32 s11, 0x20000
  s_mov_b32 s14, 6291456
  s_mov_b32 s15, 0x20000
  s_mov_b32 s18, 2097152
  s_mov_b32 s19, 0x20000
  s_mov_b32 s22, 12582912
  s_mov_b32 s23, 0x20000
  s_mov_b32 s26, 2048
  s_mov_b32 s27, 0x20000
  s_waitcnt lgkmcnt(0)
  buffer_load_ushort v15, v16, s[24:27], 0 offen
  s_add_u32 m0, s45, 131072
  s_mov_b32 s68, 0
  buffer_load_dwordx4 v35, s[20:23], s68 offen nt lds
  s_add_u32 m0, s45, 135168
  s_add_u32 s68, s68, 393216
  buffer_load_dwordx4 v35, s[20:23], s68 offen nt lds
  s_add_u32 m0, s45, 139264
  s_add_u32 s68, s68, 393216
  buffer_load_dwordx4 v35, s[20:23], s68 offen nt lds
  s_add_u32 m0, s45, 143360
  s_add_u32 s68, s68, 393216
  buffer_load_dwordx4 v35, s[20:23], s68 offen nt lds
  buffer_load_dword v36, v29, s[8:11], 0 offen sc1
  s_and_b32 s52, s2, 3
  s_lshl_b32 s52, s52, 2
  s_add_u32 s52, s52, s44
  s_lshl_b32 s52, s52, 7
  v_lshlrev_b32 v23, 1, v0
  buffer_load_ushort v23, v23, s[24:27], s52 offen
  s_add_u32 s52, s30, 0
  buffer_load_dwordx4 v[44:47], v28, s[4:7], s52 offen offset:0
  buffer_load_dwordx4 v[48:51], v28, s[4:7], s52 offen offset:128
  s_add_u32 s52, s30, 16384
  buffer_load_dwordx4 v[52:55], v28, s[4:7], s52 offen offset:0
  buffer_load_dwordx4 v[56:59], v28, s[4:7], s52 offen offset:128
  s_branch BODY0
.p2align 12
BODY0:
CB0:
  v_lshlrev_b32 v1, 4, v0
  v_add_u32 v2, 65536, v1
  v_add_u32 v13, 131072, v1
  s_and_b32 s66, s51, 0
  v_mul_u32_u24 v9, 6144, v10
  s_lshl_b32 s52, s51, 7
  v_add3_u32 v9, v9, v11, s52
  s_lshl_b32 s52, s53, 12
  s_add_u32 s38, s38, s52
  s_add_u32 s39, s38, 41943040
  s_add_u32 s38, s38, 1048576
  s_lshl_b32 s34, s53, 9
  s_add_u32 s34, s34, 131072
  s_lshl_b32 s35, s53, 11
  s_add_u32 s35, s35, 819200
  s_xor_b32 s30, s30, 1024
  s_add_u32 s52, s30, 0
  buffer_load_dwordx4 v[92:95], v28, s[4:7], s52 offen offset:0
  buffer_load_dwordx4 v[96:99], v28, s[4:7], s52 offen offset:128
  s_add_u32 s52, s30, 16384
  buffer_load_dwordx4 v[100:103], v28, s[4:7], s52 offen offset:0
  buffer_load_dwordx4 v[104:107], v28, s[4:7], s52 offen offset:128
  s_lshr_b32 s52, s2, 3
  s_mul_i32 s52, s52, 98304
  s_lshl_b32 s53, s44, 11
  s_add_u32 s52, s52, s53
  s_and_b32 s53, s2, 3
  s_lshl_b32 s53, s53, 9
  s_add_u32 s52, s52, s53
  s_add_u32 s52, s52, 0
  s_cmp_lt_u32 s44, 3
  s_cselect_b32 s52, s52, 1073741824
  v_lshrrev_b32 v43, 2, v0
  v_mul_u32_u24 v43, 5632, v43
  v_lshl_add_u32 v43, v0, 7, v43
  buffer_load_dword a252, v43, s[12:15], s52 offen
  v_lshrrev_b32 v41, 2, v0
  v_bfe_u32 v40, v41, 1, 2
  v_lshlrev_b32 v40, 5, v40
  v_lshl_add_u32 v40, v41, 7, v40
  v_and_b32 v41, 3, v0
  v_lshl_add_u32 v40, v41, 3, v40
  s_lshl_b32 s52, s44, 5
  v_xor_b32 v3, s52, v40
  s_and_b32 s52, s52, 64
  s_and_b32 s53, s44, 1
  s_lshl_b32 s53, s53, 14
  s_add_u32 s52, s52, s53
  v_xor_b32 v4, s52, v40
  v_xor_b32 v5, 32, v4
  v_add_u32 v6, 65536, v3
  v_add_u32 v7, 65536, v4
  v_add_u32 v8, 65536, v5
  v_add_u32 v35, 131072, v3
  v_lshrrev_b32 v30, 5, v0
  v_lshlrev_b32 v30, 6, v30
  v_bfe_u32 v40, v0, 2, 2
  v_lshl_add_u32 v30, v40, 4, v30
  v_bfe_u32 v40, v0, 4, 1
  v_lshl_add_u32 v30, v40, 3, v30
  v_lshl_add_u32 v30, v41, 1, v30
  s_lshl_b32 s52, s44, 7
  s_add_u32 s52, s52, 160768
  v_add_u32 v30, s52, v30
  v_lshrrev_b32 v32, 4, v0
  v_lshlrev_b32 v32, 4, v32
  v_add_u32 v31, 160768, v32
  v_and_b32 v40, 15, v0
  v_lshl_add_u32 v32, v40, 27, v32
  s_and_b32 s52, s2, 7
  s_lshl_b32 s52, s52, 13
  s_lshr_b32 s53, s2, 3
  s_lshl_b32 s53, s53, 8
  s_add_u32 s52, s52, s53
  s_lshl_b32 s53, s44, 6
  s_add_u32 s52, s52, s53
  s_add_u32 s42, s52, 131072
  s_lshl_b32 s53, s44, 28
  s_lshl_b32 s31, s2, 7
  s_add_u32 s31, s31, s53
  s_add_u32 s31, s31, 819200
  s_lshl_b32 s74, s54, 7
  s_add_u32 s74, s74, s53
  s_add_u32 s75, s74, 786432
  s_add_u32 s74, s74, 655360
  s_lshl_b32 s52, s50, 18
  s_add_u32 s52, s52, 1015808
  s_cmp_eq_u32 s50, 0
  s_cselect_b32 s72, 5210112, s52
  s_lshr_b32 s53, s44, 1
  s_lshl_b32 s70, s53, 15
  s_add_u32 s52, s52, s70
  v_add_u32 v12, s52, v1
  s_lshl_b32 s53, s53, 11
  s_add_u32 s72, s72, s53
  s_lshl_b32 s70, s44, 12
  s_and_b32 s52, s70, 4096
  s_add_u32 s71, s52, s53
  s_and_b32 s52, s44, 1
  s_add_u32 s52, s52, s66
  s_add_u32 s58, s52, 0
  s_and_b32 s58, s58, 7
  s_lshl_b32 s58, s58, 12
  s_add_u32 s59, s52, 2
  s_and_b32 s59, s59, 7
  s_lshl_b32 s59, s59, 12
  s_add_u32 s60, s52, 4
  s_and_b32 s60, s60, 7
  s_lshl_b32 s60, s60, 12
  s_add_u32 s61, s52, 6
  s_and_b32 s61, s61, 7
  s_lshl_b32 s61, s61, 12
  s_lshl_b32 s52, s50, 4
  s_sub_u32 s52, s52, 2
  v_min_u32 v14, 17, v0
  v_add_u32 v14, s52, v14
  v_and_b32 v14, 255, v14
  v_lshlrev_b32 v14, 7, v14
  v_add_u32 v14, 786432, v14
  s_and_b32 s52, s2, 3
  s_lshl_b32 s52, s52, 8
  v_add_u32 v40, s52, v10
  v_mul_u32_u24 v40, 12288, v40
  s_lshr_b32 s53, s2, 2
  s_add_u32 s53, s53, 32
  s_lshl_b32 s53, s53, 7
  v_lshl_add_u32 v10, v10, 11, v11
  v_add3_u32 v11, v40, v11, s53
  s_and_b32 s52, s44, 1
  s_lshl_b32 s53, s50, 3
  s_add_u32 s53, s53, s52
  s_lshl_b32 s73, s53, 15
  s_lshl_b32 s53, s51, 1
  s_lshr_b32 s57, s44, 1
  s_add_u32 s53, s53, s57
  s_lshl_b32 s53, s53, 10
  s_add_u32 s73, s73, s53
  s_add_u32 s73, s73, 7340032
  s_mul_i32 s57, s57, 3072
  s_add_u32 s57, s57, 131072
  v_add_u32 v19, s57, v1
  s_lshl_b32 s53, s52, 3
  v_add_u32 v18, s53, v19
  s_lshl_b32 s53, s52, 10
  v_add_u32 v17, s53, v19
  v_lshrrev_b32 v40, 2, v0
  v_and_b32 v20, 3, v0
  v_lshl_add_u32 v40, v20, 4, v40
  v_lshl_add_u32 v20, v40, 4, s57
  s_mov_b32 s80, 0xfff0ffff
  s_mov_b32 s81, 0xf000ff00
  s_mov_b32 s82, 0xffe0fffe
  s_mov_b32 s83, 0xe000fe00
  s_mov_b32 s84, 0xffc0fffc
  s_mov_b32 s85, 0xc000fc00
  s_mov_b32 s86, 0xff80fff8
  s_mov_b32 s87, 0x8000f800
  s_mov_b32 s88, 0xaaaaaaaa
  s_mov_b32 s89, 0xaaaaaaaa
  s_mov_b32 s90, 0x000f0000
  s_mov_b32 s91, 0x0fff00ff
  s_mov_b32 s92, 0x003f0003
  s_mov_b32 s93, 0x3fff03ff
  v_mov_b32 v41, 0xffff
  v_mov_b32 v24, 0xffff0000
  v_cndmask_b32 v41, v41, v24, s[88:89]
  v_cndmask_b32 v24, 0, v41, s[90:91]
  v_cndmask_b32 v25, 0, v41, s[92:93]
  v_xor_b32 v26, v24, v41
  v_xor_b32 v27, v25, v41
  s_or_b32 s52, s52, s50
  s_cmp_eq_u32 s52, 0
  s_cselect_b64 s[90:91], s[90:91], 0
  s_cselect_b64 s[92:93], s[92:93], 0
  s_waitcnt vmcnt(15)
  v_lshlrev_b32 v15, 16, v15
  v_mul_f32 v16, 0xbfb8aa3b, v15
  v_exp_f32 v16, v16
  s_nop 0
  v_add_f32 v16, 1.0, v16
  v_rcp_f32 v16, v16
  s_nop 0
  v_mul_f32 v15, v15, v16
  v_cvt_pk_bf16_f32 v15, v15, v15
  ds_write_b16 v30, v15
  s_waitcnt vmcnt(11) lgkmcnt(0)
  s_barrier
  ds_read_b64_tr_b16 v[60:61], v35 offset:0
  ds_read_b64_tr_b16 v[62:63], v35 offset:2048
  ds_read_b128 v[76:79], v31 offset:0
  ds_read_b64_tr_b16 v[64:65], v35 offset:4096
  ds_read_b64_tr_b16 v[66:67], v35 offset:6144
  ds_read_b128 v[80:83], v31 offset:64
  ds_read_b64_tr_b16 v[68:69], v35 offset:8192
  ds_read_b64_tr_b16 v[70:71], v35 offset:10240
  ds_read_b128 v[84:87], v31 offset:128
  ds_read_b64_tr_b16 v[72:73], v35 offset:12288
  ds_read_b64_tr_b16 v[74:75], v35 offset:14336
  ds_read_b128 v[88:91], v31 offset:192
  s_waitcnt vmcnt(10)
  v_readfirstlane_b32 s46, v36
  s_nop 0
  s_add_u32 s46, s46, 8
  s_mul_i32 s52, s46, 0x13c6ef37
  v_mov_b32 v36, 0xff
  s_bfe_u32 s55, s52, 0x80000
  s_bfe_u32 s56, s52, 0x80008
  s_bfe_u32 s69, s52, 0x80010
  s_bfe_u32 s54, s52, 0x80018
  s_waitcnt lgkmcnt(9)
  v_mfma_f32_16x16x32_bf16 v[40:43], v[60:63], v[76:79], 0
  s_waitcnt lgkmcnt(6)
  v_mfma_f32_16x16x32_bf16 v[40:43], v[64:67], v[80:83], v[40:43]
  s_waitcnt lgkmcnt(3)
  v_mfma_f32_16x16x32_bf16 v[40:43], v[68:71], v[84:87], v[40:43]
  s_waitcnt lgkmcnt(0)
  v_mfma_f32_16x16x32_bf16 v[40:43], v[72:75], v[88:91], v[40:43]
  s_nop 7
  v_bfi_b32 v40, v36, s55, v40
  v_bfi_b32 v41, v36, s56, v41
  v_bfi_b32 v42, v36, s69, v42
  v_bfi_b32 v43, v36, s54, v43
  buffer_store_dwordx4 v[40:43], v32, s[8:11], s42 offen sc1
  s_lshr_b32 s52, s2, 3
  s_mul_i32 s52, s52, 98304
  s_lshl_b32 s53, s44, 11
  s_add_u32 s52, s52, s53
  s_and_b32 s53, s2, 3
  s_lshl_b32 s53, s53, 9
  s_add_u32 s52, s52, s53
  s_add_u32 s52, s52, 3145728
  s_cmp_lt_u32 s44, 3
  s_cselect_b32 s52, s52, 1073741824
  v_lshrrev_b32 v43, 2, v0
  v_mul_u32_u24 v43, 5632, v43
  v_lshl_add_u32 v43, v0, 7, v43
  buffer_load_dword a252, v43, s[12:15], s52 offen
  s_mov_b64 exec, 0
  s_cmp_eq_u32 s44, 0
  s_cbranch_scc1 HOP0
  s_cmp_eq_u32 s44, 1
  s_cbranch_scc1 HOP1
  s_cmp_eq_u32 s44, 2
  s_cbranch_scc1 HOP2
  s_cmp_eq_u32 s44, 3
  s_cbranch_scc1 HOP3
WRET0:
  s_mov_b64 exec, -1
  s_lshl_b32 s53, s44, 5
  v_lshlrev_b32 v31, 7, v21
  v_add_u32 v31, 159744, v31
  v_and_b32 v30, 8, v0
  v_lshl_add_u32 v30, v30, 1, v31
  v_add_u32 v30, s53, v30
  v_mov_b32 v108, 0x3f803f80
  v_mov_b32 v109, 0x3f803f80
  v_mov_b32 v110, 0x3f803f80
  v_mov_b32 v111, 0x3f803f80
  s_mov_b32 vcc_lo, 0xaaaaaaaa
  s_mov_b32 vcc_hi, 0xaaaaaaaa
  s_waitcnt vmcnt(7)
  v_mfma_f32_16x16x32_bf16 v[60:63], v[108:111], v[44:47], 0
  v_mfma_f32_16x16x32_bf16 v[64:67], v[44:47], v[44:47], 0
  v_mfma_f32_16x16x32_bf16 v[68:71], v[108:111], v[52:55], 0
  v_mfma_f32_16x16x32_bf16 v[72:75], v[52:55], v[52:55], 0
  v_mfma_f32_16x16x32_bf16 v[60:63], v[108:111], v[48:51], v[60:63]
  v_mfma_f32_16x16x32_bf16 v[64:67], v[48:51], v[48:51], v[64:67]
  v_mfma_f32_16x16x32_bf16 v[68:71], v[108:111], v[56:59], v[68:71]
  v_mfma_f32_16x16x32_bf16 v[72:75], v[56:59], v[56:59], v[72:75]
  s_waitcnt vmcnt(3)
  v_mfma_f32_16x16x32_bf16 v[60:63], v[108:111], v[92:95], v[60:63]
  v_mfma_f32_16x16x32_bf16 v[64:67], v[92:95], v[92:95], v[64:67]
  v_mfma_f32_16x16x32_bf16 v[68:71], v[108:111], v[100:103], v[68:71]
  v_mfma_f32_16x16x32_bf16 v[72:75], v[100:103], v[100:103], v[72:75]
  v_mfma_f32_16x16x32_bf16 v[60:63], v[108:111], v[96:99], v[60:63]
  v_mfma_f32_16x16x32_bf16 v[64:67], v[96:99], v[96:99], v[64:67]
  v_mfma_f32_16x16x32_bf16 v[68:71], v[108:111], v[104:107], v[68:71]
  v_mfma_f32_16x16x32_bf16 v[72:75], v[104:107], v[104:107], v[72:75]
  s_nop 4
  v_mov_b32 v36, v60
  v_cndmask_b32 v64, v64, v65, vcc
  v_cndmask_b32 v66, v66, v67, vcc
  v_mov_b32 v38, v68
  v_cndmask_b32 v72, v72, v73, vcc
  v_cndmask_b32 v74, v74, v75, vcc
  s_mov_b32 vcc_lo, 0xcccccccc
  s_mov_b32 vcc_hi, 0xcccccccc
  v_cndmask_b32 v37, v64, v66, vcc
  v_cndmask_b32 v39, v72, v74, vcc
  s_mov_b32 exec_lo, 0x00f0000f
  s_mov_b32 exec_hi, 0xf0000f00
  ds_write_b128 v30, v[36:39]
  s_mov_b64 exec, -1
  s_add_u32 m0, s45, 0
  s_add_u32 s68, s66, 0
  s_and_b32 s68, s68, 7
  s_mul_i32 s68, s68, 786432
  buffer_load_dwordx4 v9, s[12:15], s68 offen lds
  v_lshlrev_b32 v60, 16, v44
  v_and_b32 v61, 0xffff0000, v44
  v_lshlrev_b32 v62, 16, v45
  v_and_b32 v63, 0xffff0000, v45
  v_lshlrev_b32 v64, 16, v46
  v_and_b32 v65, 0xffff0000, v46
  v_lshlrev_b32 v66, 16, v47
  v_and_b32 v67, 0xffff0000, v47
  v_lshlrev_b32 v68, 16, v48
  v_and_b32 v69, 0xffff0000, v48
  v_lshlrev_b32 v70, 16, v49
  v_and_b32 v71, 0xffff0000, v49
  v_lshlrev_b32 v72, 16, v50
  s_add_u32 m0, s45, 4096
  s_add_u32 s68, s68, 196608
  buffer_load_dwordx4 v9, s[12:15], s68 offen lds
  v_and_b32 v73, 0xffff0000, v50
  v_lshlrev_b32 v74, 16, v51
  v_and_b32 v75, 0xffff0000, v51
  v_lshlrev_b32 v76, 16, v52
  v_and_b32 v77, 0xffff0000, v52
  v_lshlrev_b32 v78, 16, v53
  v_and_b32 v79, 0xffff0000, v53
  v_lshlrev_b32 v80, 16, v54
  v_and_b32 v81, 0xffff0000, v54
  v_lshlrev_b32 v82, 16, v55
  v_and_b32 v83, 0xffff0000, v55
  v_lshlrev_b32 v84, 16, v56
  s_add_u32 m0, s45, 8192
  s_add_u32 s68, s68, 196608
  buffer_load_dwordx4 v9, s[12:15], s68 offen lds
  v_and_b32 v85, 0xffff0000, v56
  v_lshlrev_b32 v86, 16, v57
  v_and_b32 v87, 0xffff0000, v57
  v_lshlrev_b32 v88, 16, v58
  v_and_b32 v89, 0xffff0000, v58
  v_lshlrev_b32 v90, 16, v59
  v_and_b32 v91, 0xffff0000, v59
  s_waitcnt lgkmcnt(0)
  s_barrier
  ds_read_b128 v[92:95], v31 offset:0
  ds_read_b128 v[96:99], v31 offset:16
  ds_read_b128 v[100:103], v31 offset:32
  s_add_u32 m0, s45, 12288
  s_add_u32 s68, s68, 196608
  buffer_load_dwordx4 v9, s[12:15], s68 offen lds
  ds_read_b128 v[104:107], v31 offset:48
  ds_read_b128 v[108:111], v31 offset:64
  ds_read_b128 v[112:115], v31 offset:80
  ds_read_b128 v[116:119], v31 offset:96
  ds_read_b128 v[120:123], v31 offset:112
  v_permlane16_swap_b32 v44, v46
  v_permlane16_swap_b32 v45, v47
  v_permlane16_swap_b32 v48, v50
  v_permlane16_swap_b32 v49, v51
  v_permlane16_swap_b32 v52, v54
  v_permlane16_swap_b32 v53, v55
  v_permlane16_swap_b32 v56, v58
  s_add_u32 m0, s45, 16384
  s_add_u32 s68, s66, 1
  s_and_b32 s68, s68, 7
  s_mul_i32 s68, s68, 786432
  buffer_load_dwordx4 v9, s[12:15], s68 offen lds
  v_permlane16_swap_b32 v57, v59
  v_bfe_u32 v36, v0, 3, 1
  v_lshlrev_b32 v28, 9, v36
  v_bfe_u32 v36, v0, 4, 1
  v_lshl_add_u32 v28, v36, 8, v28
  v_lshrrev_b32 v34, 5, v0
  v_lshl_add_u32 v28, v34, 10, v28
  v_lshl_add_u32 v28, v21, 4, v28
  v_and_b32 v29, 31, v0
  v_lshlrev_b32 v29, 4, v29
  v_lshl_add_u32 v29, v34, 12, v29
  v_cvt_f32_u32 v34, v34
  s_add_u32 m0, s45, 20480
  s_add_u32 s68, s68, 196608
  buffer_load_dwordx4 v9, s[12:15], s68 offen lds
  s_add_u32 s53, s45, 151552
  v_add_u32 v32, s53, v1
  v_lshl_add_u32 v33, v22, 5, s53
  v_lshlrev_b32 v36, 14, v36
  v_and_b32 v35, 15, v0
  v_lshl_add_u32 v35, v35, 7, v36
  s_waitcnt lgkmcnt(0)
  v_pk_add_f32 v[92:93], v[92:93], v[108:109]
  v_pk_add_f32 v[94:95], v[94:95], v[110:111]
  v_pk_add_f32 v[96:97], v[96:97], v[112:113]
  v_pk_add_f32 v[98:99], v[98:99], v[114:115]
  v_pk_add_f32 v[100:101], v[100:101], v[116:117]
  s_add_u32 m0, s45, 24576
  s_add_u32 s68, s68, 196608
  buffer_load_dwordx4 v9, s[12:15], s68 offen lds
  v_pk_add_f32 v[102:103], v[102:103], v[118:119]
  v_pk_add_f32 v[104:105], v[104:105], v[120:121]
  v_pk_add_f32 v[106:107], v[106:107], v[122:123]
  v_pk_add_f32 v[92:93], v[92:93], v[100:101]
  v_pk_add_f32 v[94:95], v[94:95], v[102:103]
  v_pk_add_f32 v[96:97], v[96:97], v[104:105]
  v_pk_add_f32 v[98:99], v[98:99], v[106:107]
  v_pk_add_f32 v[92:93], v[92:93], v[96:97]
  v_pk_add_f32 v[94:95], v[94:95], v[98:99]
  v_mul_f32 v92, 0x3a800000, v92
  v_mul_f32 v94, 0x3a800000, v94
  v_mul_f32 v93, 0x3a800000, v93
  v_mul_f32 v95, 0x3a800000, v95
  s_add_u32 m0, s45, 28672
  s_add_u32 s68, s68, 196608
  buffer_load_dwordx4 v9, s[12:15], s68 offen lds
  v_fma_f32 v93, -v92, v92, v93
  v_fma_f32 v95, -v94, v94, v95
  v_max_f32 v93, 0, v93
  v_max_f32 v95, 0, v95
  v_cvt_pk_bf16_f32 v93, v93, v93
  v_cvt_pk_bf16_f32 v95, v95, v95
  v_lshlrev_b32 v93, 16, v93
  v_lshlrev_b32 v95, 16, v95
  v_add_f32 v93, 0x3727c5ac, v93
  v_add_f32 v95, 0x3727c5ac, v95
  v_cvt_pk_bf16_f32 v93, v93, v93
  v_cvt_pk_bf16_f32 v95, v95, v95
  s_add_u32 m0, s45, 32768
  s_add_u32 s68, s66, 0
  s_and_b32 s68, s68, 7
  s_mul_i32 s68, s68, 786432
  s_add_u32 s68, s68, 2048
  buffer_load_dwordx4 v9, s[12:15], s68 offen lds
  v_lshlrev_b32 v93, 16, v93
  v_lshlrev_b32 v95, 16, v95
  v_sqrt_f32 v93, v93
  v_sqrt_f32 v95, v95
  v_cvt_pk_bf16_f32 v92, v92, v92
  v_cvt_pk_bf16_f32 v94, v94, v94
  v_lshlrev_b32 v92, 16, v92
  v_lshlrev_b32 v94, 16, v94
  v_cvt_pk_bf16_f32 v93, v93, v93
  v_cvt_pk_bf16_f32 v95, v95, v95
  v_lshlrev_b32 v93, 16, v93
  v_lshlrev_b32 v95, 16, v95
  s_add_u32 m0, s45, 36864
  s_add_u32 s68, s68, 196608
  buffer_load_dwordx4 v9, s[12:15], s68 offen lds
  v_rcp_f32 v93, v93
  v_rcp_f32 v95, v95
  v_mul_f32 v92, v92, v93
  v_mul_f32 v94, v94, v95
  v_fma_f32 v60, v60, v93, -v92
  v_fma_f32 v61, v61, v93, -v92
  v_fma_f32 v62, v62, v93, -v92
  v_fma_f32 v63, v63, v93, -v92
  v_fma_f32 v64, v64, v93, -v92
  v_fma_f32 v65, v65, v93, -v92
  v_fma_f32 v66, v66, v93, -v92
  v_fma_f32 v67, v67, v93, -v92
  s_add_u32 m0, s45, 40960
  s_add_u32 s68, s68, 196608
  buffer_load_dwordx4 v9, s[12:15], s68 offen lds
  v_fma_f32 v68, v68, v93, -v92
  v_fma_f32 v69, v69, v93, -v92
  v_fma_f32 v70, v70, v93, -v92
  v_fma_f32 v71, v71, v93, -v92
  v_fma_f32 v72, v72, v93, -v92
  v_fma_f32 v73, v73, v93, -v92
  v_fma_f32 v74, v74, v93, -v92
  v_fma_f32 v75, v75, v93, -v92
  v_fma_f32 v76, v76, v95, -v94
  v_fma_f32 v77, v77, v95, -v94
  v_fma_f32 v78, v78, v95, -v94
  v_fma_f32 v79, v79, v95, -v94
  s_add_u32 m0, s45, 45056
  s_add_u32 s68, s68, 196608
  buffer_load_dwordx4 v9, s[12:15], s68 offen lds
  v_fma_f32 v80, v80, v95, -v94
  v_fma_f32 v81, v81, v95, -v94
  v_fma_f32 v82, v82, v95, -v94
  v_fma_f32 v83, v83, v95, -v94
  v_fma_f32 v84, v84, v95, -v94
  v_fma_f32 v85, v85, v95, -v94
  v_fma_f32 v86, v86, v95, -v94
  v_fma_f32 v87, v87, v95, -v94
  v_fma_f32 v88, v88, v95, -v94
  v_fma_f32 v89, v89, v95, -v94
  v_fma_f32 v90, v90, v95, -v94
  v_fma_f32 v91, v91, v95, -v94
  s_add_u32 s52, s34, 0
  buffer_load_dwordx4 v[92:95], v29, s[8:11], s52 offen sc1
  s_add_u32 s52, s34, 8192
  buffer_load_dwordx4 v[96:99], v29, s[8:11], s52 offen sc1
  s_add_u32 s52, s34, 16384
  buffer_load_dwordx4 v[100:103], v29, s[8:11], s52 offen sc1
  s_add_u32 s52, s34, 24576
  buffer_load_dwordx4 v[104:107], v29, s[8:11], s52 offen sc1
  s_add_u32 s52, s34, 32768
  buffer_load_dwordx4 v[108:111], v29, s[8:11], s52 offen sc1
  s_add_u32 s52, s34, 40960
  buffer_load_dwordx4 v[112:115], v29, s[8:11], s52 offen sc1
  s_add_u32 s52, s34, 49152
  buffer_load_dwordx4 v[116:119], v29, s[8:11], s52 offen sc1
  s_add_u32 s52, s34, 57344
  buffer_load_dwordx4 v[120:123], v29, s[8:11], s52 offen sc1
  s_add_u32 m0, s45, 49152
  s_add_u32 s68, s66, 0
  s_and_b32 s68, s68, 7
  s_mul_i32 s68, s68, 786432
  s_add_u32 s68, s68, 4096
  buffer_load_dwordx4 v9, s[12:15], s68 offen lds
  s_bfe_u32 s53, s2, 0x30003
  s_lshl_b32 s43, s53, 1
  s_and_b32 s52, s2, 1
  s_add_u32 s43, s43, s52
  s_and_b32 s79, s2, 4
  s_lshr_b32 s52, s2, 6
  s_add_u32 s79, s79, s52
  s_add_u32 m0, s45, 53248
  s_add_u32 s68, s68, 196608
  buffer_load_dwordx4 v9, s[12:15], s68 offen lds
  s_lshl_b32 s79, s79, 1
  s_add_u32 s67, s79, s53
  s_bfe_u32 s52, s2, 0x10001
  s_add_u32 s79, s79, s52
  s_and_b32 s52, s44, 1
  s_add_u32 s52, s52, s67
  s_add_u32 s62, s52, 0
  s_add_u32 m0, s45, 57344
  s_add_u32 s68, s68, 196608
  buffer_load_dwordx4 v9, s[12:15], s68 offen lds
  s_and_b32 s62, s62, 7
  s_lshl_b32 s62, s62, 12
  s_add_u32 s63, s52, 2
  s_and_b32 s63, s63, 7
  s_lshl_b32 s63, s63, 12
  s_add_u32 s64, s52, 4
  s_and_b32 s64, s64, 7
  s_add_u32 m0, s45, 61440
  s_add_u32 s68, s68, 196608
  buffer_load_dwordx4 v9, s[12:15], s68 offen lds
  s_lshl_b32 s64, s64, 12
  s_add_u32 s65, s52, 6
  s_and_b32 s65, s65, 7
  s_lshl_b32 s65, s65, 12
  s_lshl_b32 s52, s43, 7
  v_add_u32 v10, s52, v10
  s_lshl_b32 s52, s79, 18
  s_add_u32 m0, s45, 65536
  s_add_u32 s68, s66, 1
  s_and_b32 s68, s68, 7
  s_mul_i32 s68, s68, 786432
  s_add_u32 s68, s68, 2048
  buffer_load_dwordx4 v9, s[12:15], s68 offen lds
  s_lshr_b32 s53, s44, 1
  s_lshl_b32 s53, s53, 15
  s_add_u32 s53, s52, s53
  s_add_u32 s78, s53, 7340032
  s_and_b32 s53, s44, 1
  s_lshl_b32 s53, s53, 15
  s_add_u32 s52, s52, s53
  s_add_u32 m0, s45, 69632
  s_add_u32 s68, s68, 196608
  buffer_load_dwordx4 v9, s[12:15], s68 offen lds
  s_lshl_b32 s53, s43, 1
  s_lshr_b32 s57, s44, 1
  s_add_u32 s53, s53, s57
  s_lshl_b32 s76, s53, 7
  s_lshl_b32 s53, s53, 10
  s_add_u32 s47, s52, s53
  s_lshr_b32 s53, s53, 1
  s_add_u32 m0, s45, 73728
  s_add_u32 s68, s68, 196608
  buffer_load_dwordx4 v9, s[12:15], s68 offen lds
  s_lshl_b32 s52, s79, 1
  s_and_b32 s57, s44, 1
  s_add_u32 s52, s52, s57
  s_lshl_b32 s52, s52, 14
  s_add_u32 s52, s52, s53
  s_add_u32 s48, s52, 6291456
  s_lshl_b32 s52, s79, 11
  s_add_u32 m0, s45, 77824
  s_add_u32 s68, s68, 196608
  buffer_load_dwordx4 v9, s[12:15], s68 offen lds
  s_lshl_b32 s53, s43, 7
  s_add_u32 s53, s53, s52
  s_lshl_b32 s57, s44, 28
  s_add_u32 s53, s53, s57
  s_add_u32 s49, s53, 753664
  s_add_u32 s77, s52, 655360
  s_mov_b32 s57, 20000
  s_branch MT2_adaLN_cond__sliding_local_dilated__swiglu_ffn__prompt_kernelt
MT2_adaLN_cond__sliding_local_dilated__swiglu_ffn__prompt_kernel:
  s_add_u32 s52, s34, 0
  buffer_load_dwordx4 v[92:95], v29, s[8:11], s52 offen sc1
  s_add_u32 s52, s34, 8192
  buffer_load_dwordx4 v[96:99], v29, s[8:11], s52 offen sc1
  s_add_u32 s52, s34, 16384
  buffer_load_dwordx4 v[100:103], v29, s[8:11], s52 offen sc1
  s_add_u32 s52, s34, 24576
  buffer_load_dwordx4 v[104:107], v29, s[8:11], s52 offen sc1
  s_add_u32 s52, s34, 32768
  buffer_load_dwordx4 v[108:111], v29, s[8:11], s52 offen sc1
  s_add_u32 s52, s34, 40960
  buffer_load_dwordx4 v[112:115], v29, s[8:11], s52 offen sc1
  s_add_u32 s52, s34, 49152
  buffer_load_dwordx4 v[116:119], v29, s[8:11], s52 offen sc1
  s_add_u32 s52, s34, 57344
  buffer_load_dwordx4 v[120:123], v29, s[8:11], s52 offen sc1
  s_waitcnt vmcnt(0)
MT2_adaLN_cond__sliding_local_dilated__swiglu_ffn__prompt_kernelt:
  s_waitcnt vmcnt(15)
  v_xor_b32 v92, s55, v92
  v_xor_b32 v93, s56, v93
  v_xor_b32 v94, s69, v94
  v_xor_b32 v95, s54, v95
  v_or3_b32 v36, v92, v93, 0
  v_or3_b32 v36, v94, v95, v36
  s_waitcnt vmcnt(14)
  v_xor_b32 v96, s55, v96
  v_xor_b32 v97, s56, v97
  v_xor_b32 v98, s69, v98
  v_xor_b32 v99, s54, v99
  v_or3_b32 v36, v96, v97, v36
  v_or3_b32 v36, v98, v99, v36
  s_waitcnt vmcnt(13)
  v_xor_b32 v100, s55, v100
  v_xor_b32 v101, s56, v101
  v_xor_b32 v102, s69, v102
  v_xor_b32 v103, s54, v103
  v_or3_b32 v36, v100, v101, v36
  v_or3_b32 v36, v102, v103, v36
  s_waitcnt vmcnt(12)
  v_xor_b32 v104, s55, v104
  v_xor_b32 v105, s56, v105
  v_xor_b32 v106, s69, v106
  v_xor_b32 v107, s54, v107
  v_or3_b32 v36, v104, v105, v36
  v_or3_b32 v36, v106, v107, v36
  s_waitcnt vmcnt(11)
  v_xor_b32 v108, s55, v108
  v_xor_b32 v109, s56, v109
  v_xor_b32 v110, s69, v110
  v_xor_b32 v111, s54, v111
  v_or3_b32 v36, v108, v109, v36
  v_or3_b32 v36, v110, v111, v36
  s_waitcnt vmcnt(10)
  v_xor_b32 v112, s55, v112
  v_xor_b32 v113, s56, v113
  v_xor_b32 v114, s69, v114
  v_xor_b32 v115, s54, v115
  v_or3_b32 v36, v112, v113, v36
  v_or3_b32 v36, v114, v115, v36
  s_waitcnt vmcnt(9)
  v_xor_b32 v116, s55, v116
  v_xor_b32 v117, s56, v117
  v_xor_b32 v118, s69, v118
  v_xor_b32 v119, s54, v119
  v_or3_b32 v36, v116, v117, v36
  v_or3_b32 v36, v118, v119, v36
  s_waitcnt vmcnt(8)
  v_xor_b32 v120, s55, v120
  v_xor_b32 v121, s56, v121
  v_xor_b32 v122, s69, v122
  v_xor_b32 v123, s54, v123
  v_or3_b32 v36, v120, v121, v36
  v_or3_b32 v36, v122, v123, v36
  v_and_b32 v36, 0xff, v36
  v_cmp_ne_u32 vcc, 0, v36
  s_sub_u32 s57, s57, 1
  s_cmp_eq_u32 s57, 0
  s_cbranch_scc1 MT2_adaLN_cond__sliding_local_dilated__swiglu_ffn__prompt_kernelx
  s_nop 1
  s_cbranch_vccnz MT2_adaLN_cond__sliding_local_dilated__swiglu_ffn__prompt_kernel
MT2_adaLN_cond__sliding_local_dilated__swiglu_ffn__prompt_kernelx:
  s_waitcnt vmcnt(14)
  v_pk_add_f32 v[92:93], v[92:93], v[96:97]
  v_pk_add_f32 v[94:95], v[94:95], v[98:99]
  s_waitcnt vmcnt(13)
  v_pk_add_f32 v[92:93], v[92:93], v[100:101]
  v_pk_add_f32 v[94:95], v[94:95], v[102:103]
  s_waitcnt vmcnt(12)
  v_pk_add_f32 v[92:93], v[92:93], v[104:105]
  v_pk_add_f32 v[94:95], v[94:95], v[106:107]
  s_waitcnt vmcnt(11)
HOP0:
  s_cbranch_execz HOP4
  v_pk_add_f32 v[92:93], v[92:93], v[108:109]
  v_pk_add_f32 v[94:95], v[94:95], v[110:111]
  s_waitcnt vmcnt(10)
  v_pk_add_f32 v[92:93], v[92:93], v[112:113]
  v_pk_add_f32 v[94:95], v[94:95], v[114:115]
  s_waitcnt vmcnt(9)
  v_pk_add_f32 v[92:93], v[92:93], v[116:117]
  v_pk_add_f32 v[94:95], v[94:95], v[118:119]
  s_waitcnt vmcnt(8)
  v_pk_add_f32 v[92:93], v[92:93], v[120:121]
  v_pk_add_f32 v[94:95], v[94:95], v[122:123]
  v_cvt_pk_bf16_f32 v96, v92, v93
  v_cvt_pk_bf16_f32 v97, v94, v95
  v_lshlrev_b32 v92, 16, v96
  v_and_b32 v93, 0xffff0000, v96
  v_lshlrev_b32 v94, 16, v97
  v_and_b32 v95, 0xffff0000, v97
  v_add_f32 v92, v34, v92
  v_add_f32 v93, v34, v93
  v_add_f32 v94, v34, v94
  v_add_f32 v95, v34, v95
  v_cvt_pk_bf16_f32 v96, v92, v93
  v_cvt_pk_bf16_f32 v97, v94, v95
  v_lshlrev_b32 v92, 16, v96
  v_and_b32 v93, 0xffff0000, v96
  v_lshlrev_b32 v94, 16, v97
  v_and_b32 v95, 0xffff0000, v97
  ds_write_b128 v32, v[92:95]
  ds_read_b128 v[92:95], v33 offset:512
  ds_read_b128 v[108:111], v33 offset:0
  ds_read_b128 v[96:99], v33 offset:528
  ds_read_b128 v[112:115], v33 offset:16
  ds_read_b128 v[100:103], v33 offset:768
  ds_read_b128 v[116:119], v33 offset:256
  ds_read_b128 v[104:107], v33 offset:784
  ds_read_b128 v[120:123], v33 offset:272
  s_waitcnt lgkmcnt(4)
  v_pk_fma_f32 v[60:61], v[60:61], v[92:93], v[108:109]
  v_pk_fma_f32 v[62:63], v[62:63], v[94:95], v[110:111]
  v_pk_fma_f32 v[64:65], v[64:65], v[96:97], v[112:113]
  v_pk_fma_f32 v[66:67], v[66:67], v[98:99], v[114:115]
  v_pk_fma_f32 v[76:77], v[76:77], v[92:93], v[108:109]
  v_pk_fma_f32 v[78:79], v[78:79], v[94:95], v[110:111]
  v_pk_fma_f32 v[80:81], v[80:81], v[96:97], v[112:113]
  v_pk_fma_f32 v[82:83], v[82:83], v[98:99], v[114:115]
  v_cvt_pk_bf16_f32 v60, v60, v61
  v_cvt_pk_bf16_f32 v61, v62, v63
  v_cvt_pk_bf16_f32 v62, v64, v65
  v_cvt_pk_bf16_f32 v63, v66, v67
  v_cvt_pk_bf16_f32 v76, v76, v77
  v_cvt_pk_bf16_f32 v77, v78, v79
  v_cvt_pk_bf16_f32 v78, v80, v81
  v_cvt_pk_bf16_f32 v79, v82, v83
  v_permlane16_swap_b32 v60, v62
  v_permlane16_swap_b32 v61, v63
  buffer_store_dwordx4 v[60:63], v28, s[8:11], s38 offen offset:0 sc1
  v_permlane16_swap_b32 v76, v78
  v_permlane16_swap_b32 v77, v79
  buffer_store_dwordx4 v[76:79], v28, s[8:11], s38 offen offset:128 sc1
  s_waitcnt lgkmcnt(0)
  v_pk_fma_f32 v[68:69], v[68:69], v[100:101], v[116:117]
  v_pk_fma_f32 v[70:71], v[70:71], v[102:103], v[118:119]
  v_pk_fma_f32 v[72:73], v[72:73], v[104:105], v[120:121]
  v_pk_fma_f32 v[74:75], v[74:75], v[106:107], v[122:123]
  v_pk_fma_f32 v[84:85], v[84:85], v[100:101], v[116:117]
  v_pk_fma_f32 v[86:87], v[86:87], v[102:103], v[118:119]
  v_pk_fma_f32 v[88:89], v[88:89], v[104:105], v[120:121]
  v_pk_fma_f32 v[90:91], v[90:91], v[106:107], v[122:123]
  v_cvt_pk_bf16_f32 v68, v68, v69
  v_cvt_pk_bf16_f32 v69, v70, v71
  v_cvt_pk_bf16_f32 v70, v72, v73
  v_cvt_pk_bf16_f32 v71, v74, v75
  v_cvt_pk_bf16_f32 v84, v84, v85
  v_cvt_pk_bf16_f32 v85, v86, v87
  v_cvt_pk_bf16_f32 v86, v88, v89
  v_cvt_pk_bf16_f32 v87, v90, v91
  v_permlane16_swap_b32 v68, v70
  v_permlane16_swap_b32 v69, v71
  buffer_store_dwordx4 v[68:71], v28, s[8:11], s38 offen offset:2048 sc1
  v_permlane16_swap_b32 v84, v86
  v_permlane16_swap_b32 v85, v87
  buffer_store_dwordx4 v[84:87], v28, s[8:11], s38 offen offset:2176 sc1
  buffer_store_dwordx4 v[44:47], v28, s[8:11], s39 offen offset:0 sc1
  buffer_store_dwordx4 v[48:51], v28, s[8:11], s39 offen offset:2048 sc1
  buffer_store_dwordx4 v[52:55], v28, s[8:11], s39 offen offset:128 sc1
  buffer_store_dwordx4 v[56:59], v28, s[8:11], s39 offen offset:2176 sc1
  s_add_u32 m0, s45, 81920
  s_add_u32 s68, s66, 1
  s_and_b32 s68, s68, 7
  s_mul_i32 s68, s68, 786432
  s_add_u32 s68, s68, 4096
  buffer_load_dwordx4 v9, s[12:15], s68 offen lds
  s_waitcnt vmcnt(48)
  v_lshlrev_b32 v15, 16, v23
  v_mul_f32 v16, 0xbfb8aa3b, v15
  v_exp_f32 v16, v16
  v_lshrrev_b32 v21, 5, v0
  s_add_u32 m0, s45, 86016
  s_add_u32 s68, s68, 196608
  buffer_load_dwordx4 v9, s[12:15], s68 offen lds
  v_add_f32 v16, 1.0, v16
  v_rcp_f32 v16, v16
  v_lshlrev_b32 v21, 6, v21
  v_mul_f32 v15, v15, v16
  v_cvt_pk_bf16_f32 v16, v15, v15
  s_add_u32 m0, s45, 90112
  s_add_u32 s68, s68, 196608
  buffer_load_dwordx4 v9, s[12:15], s68 offen lds
  v_bfe_u32 v15, v0, 2, 2
  v_lshl_add_u32 v21, v15, 4, v21
  v_bfe_u32 v15, v0, 4, 1
  v_lshl_add_u32 v21, v15, 3, v21
  v_and_b32 v15, 3, v0
  s_add_u32 m0, s45, 94208
  s_add_u32 s68, s68, 196608
  buffer_load_dwordx4 v9, s[12:15], s68 offen lds
  v_lshl_add_u32 v21, v15, 1, v21
  s_lshl_b32 s53, s44, 7
  s_add_u32 s53, s53, 160768
  v_add_u32 v21, s53, v21
  v_add_u32 v15, s46, v0
  s_waitcnt vmcnt(8)
  s_barrier
  s_mov_b64 exec, 1
  buffer_store_dword v15, v0, s[8:11], s75 offen offset:0 sc1
  s_mov_b64 exec, -1
  s_waitcnt vmcnt(33) lgkmcnt(0)
  s_barrier
  s_add_u32 m0, s45, 98304
  s_add_u32 s68, s66, 2
  s_and_b32 s68, s68, 7
  s_mul_i32 s68, s68, 786432
  buffer_load_dwordx4 v9, s[12:15], s68 offen lds
  ds_read_b64_tr_b16 a[0:1], v3 offset:0
  ds_read_b64_tr_b16 a[2:3], v3 offset:2048
  s_add_u32 m0, s45, 102400
  s_add_u32 s68, s68, 196608
  buffer_load_dwordx4 v9, s[12:15], s68 offen lds
  ds_read_b64_tr_b16 a[12:13], v3 offset:4096
  ds_read_b64_tr_b16 a[14:15], v3 offset:6144
  s_add_u32 m0, s45, 106496
  s_add_u32 s68, s68, 196608
  buffer_load_dwordx4 v9, s[12:15], s68 offen lds
  ds_read_b64_tr_b16 a[24:25], v3 offset:8192
  ds_read_b64_tr_b16 a[26:27], v3 offset:10240
  s_add_u32 m0, s45, 110592
  s_add_u32 s68, s68, 196608
  buffer_load_dwordx4 v9, s[12:15], s68 offen lds
  ds_read_b64_tr_b16 a[36:37], v3 offset:12288
  ds_read_b64_tr_b16 a[38:39], v3 offset:14336
  s_add_u32 m0, s45, 114688
  s_add_u32 s68, s66, 3
  s_and_b32 s68, s68, 7
  s_mul_i32 s68, s68, 786432
  buffer_load_dwordx4 v9, s[12:15], s68 offen lds
  ds_read_b64_tr_b16 a[48:49], v3 offset:16384
  ds_read_b64_tr_b16 a[50:51], v3 offset:18432
  s_add_u32 m0, s45, 118784
  s_add_u32 s68, s68, 196608
  buffer_load_dwordx4 v9, s[12:15], s68 offen lds
  ds_read_b64_tr_b16 a[60:61], v3 offset:20480
  ds_read_b64_tr_b16 a[62:63], v3 offset:22528
  s_add_u32 m0, s45, 122880
  s_add_u32 s68, s68, 196608
  buffer_load_dwordx4 v9, s[12:15], s68 offen lds
  ds_read_b64_tr_b16 a[72:73], v3 offset:24576
  ds_read_b64_tr_b16 a[74:75], v3 offset:26624
  s_add_u32 m0, s45, 126976
  s_add_u32 s68, s68, 196608
  buffer_load_dwordx4 v9, s[12:15], s68 offen lds
  ds_read_b64_tr_b16 a[84:85], v3 offset:28672
  ds_read_b64_tr_b16 a[86:87], v3 offset:30720
  s_waitcnt vmcnt(25) lgkmcnt(0)
  s_barrier
  s_add_u32 m0, s45, 0
  s_add_u32 s68, s66, 2
  s_and_b32 s68, s68, 7
  s_mul_i32 s68, s68, 786432
  s_add_u32 s68, s68, 2048
  buffer_load_dwordx4 v9, s[12:15], s68 offen lds
  ds_read_b64_tr_b16 a[4:5], v4 offset:32768
  ds_read_b64_tr_b16 a[6:7], v4 offset:34816
  s_add_u32 m0, s45, 4096
  s_add_u32 s68, s68, 196608
  buffer_load_dwordx4 v9, s[12:15], s68 offen lds
  ds_read_b64_tr_b16 a[8:9], v5 offset:32768
  ds_read_b64_tr_b16 a[10:11], v5 offset:34816
  s_add_u32 m0, s45, 8192
  s_add_u32 s68, s68, 196608
  buffer_load_dwordx4 v9, s[12:15], s68 offen lds
  ds_read_b64_tr_b16 a[16:17], v4 offset:36864
  ds_read_b64_tr_b16 a[18:19], v4 offset:38912
  s_add_u32 m0, s45, 12288
  s_add_u32 s68, s68, 196608
  buffer_load_dwordx4 v9, s[12:15], s68 offen lds
  ds_read_b64_tr_b16 a[20:21], v5 offset:36864
  ds_read_b64_tr_b16 a[22:23], v5 offset:38912
  s_add_u32 m0, s45, 16384
  s_add_u32 s68, s66, 2
  s_and_b32 s68, s68, 7
  s_mul_i32 s68, s68, 786432
  s_add_u32 s68, s68, 4096
  buffer_load_dwordx4 v9, s[12:15], s68 offen lds
  ds_read_b64_tr_b16 a[28:29], v4 offset:40960
  ds_read_b64_tr_b16 a[30:31], v4 offset:43008
  s_add_u32 m0, s45, 20480
  s_add_u32 s68, s68, 196608
  buffer_load_dwordx4 v9, s[12:15], s68 offen lds
  ds_read_b64_tr_b16 a[32:33], v5 offset:40960
  ds_read_b64_tr_b16 a[34:35], v5 offset:43008
  s_add_u32 m0, s45, 24576
  s_add_u32 s68, s68, 196608
  buffer_load_dwordx4 v9, s[12:15], s68 offen lds
  ds_read_b64_tr_b16 a[40:41], v4 offset:45056
  ds_read_b64_tr_b16 a[42:43], v4 offset:47104
  s_add_u32 m0, s45, 28672
  s_add_u32 s68, s68, 196608
  buffer_load_dwordx4 v9, s[12:15], s68 offen lds
  ds_read_b64_tr_b16 a[44:45], v5 offset:45056
  ds_read_b64_tr_b16 a[46:47], v5 offset:47104
  s_waitcnt vmcnt(17) lgkmcnt(0)
  s_barrier
  s_add_u32 m0, s45, 32768
  s_add_u32 s68, s66, 3
  s_and_b32 s68, s68, 7
  s_mul_i32 s68, s68, 786432
  s_add_u32 s68, s68, 2048
  buffer_load_dwordx4 v9, s[12:15], s68 offen lds
  ds_read_b64_tr_b16 a[52:53], v7 offset:0
  ds_read_b64_tr_b16 a[54:55], v7 offset:2048
  s_add_u32 m0, s45, 36864
  s_add_u32 s68, s68, 196608
  buffer_load_dwordx4 v9, s[12:15], s68 offen lds
  ds_read_b64_tr_b16 a[56:57], v8 offset:0
  ds_read_b64_tr_b16 a[58:59], v8 offset:2048
  s_add_u32 m0, s45, 40960
  s_add_u32 s68, s68, 196608
  buffer_load_dwordx4 v9, s[12:15], s68 offen lds
  ds_read_b64_tr_b16 a[64:65], v7 offset:4096
  ds_read_b64_tr_b16 a[66:67], v7 offset:6144
  s_add_u32 m0, s45, 45056
  s_add_u32 s68, s68, 196608
  buffer_load_dwordx4 v9, s[12:15], s68 offen lds
  ds_read_b64_tr_b16 a[68:69], v8 offset:4096
  ds_read_b64_tr_b16 a[70:71], v8 offset:6144
  s_add_u32 m0, s45, 49152
  s_add_u32 s68, s66, 3
  s_and_b32 s68, s68, 7
  s_mul_i32 s68, s68, 786432
  s_add_u32 s68, s68, 4096
  buffer_load_dwordx4 v9, s[12:15], s68 offen lds
  ds_read_b64_tr_b16 a[76:77], v7 offset:8192
  ds_read_b64_tr_b16 a[78:79], v7 offset:10240
  s_add_u32 m0, s45, 53248
  s_add_u32 s68, s68, 196608
  buffer_load_dwordx4 v9, s[12:15], s68 offen lds
  ds_read_b64_tr_b16 a[80:81], v8 offset:8192
  ds_read_b64_tr_b16 a[82:83], v8 offset:10240
  s_add_u32 m0, s45, 57344
  s_add_u32 s68, s68, 196608
  buffer_load_dwordx4 v9, s[12:15], s68 offen lds
  ds_read_b64_tr_b16 a[88:89], v7 offset:12288
  ds_read_b64_tr_b16 a[90:91], v7 offset:14336
  s_add_u32 m0, s45, 61440
  s_add_u32 s68, s68, 196608
  buffer_load_dwordx4 v9, s[12:15], s68 offen lds
  ds_read_b64_tr_b16 a[92:93], v8 offset:12288
  ds_read_b64_tr_b16 a[94:95], v8 offset:14336
  s_lshl_b32 s57, s44, 28
  buffer_load_dword v36, v14, s[8:11], s57 offen sc1
  s_waitcnt vmcnt(17) lgkmcnt(0)
  s_barrier
  s_add_u32 m0, s45, 65536
  s_add_u32 s68, s66, 4
  s_and_b32 s68, s68, 7
  s_mul_i32 s68, s68, 786432
  buffer_load_dwordx4 v9, s[12:15], s68 offen lds
  ds_read_b64_tr_b16 a[96:97], v6 offset:32768
  ds_read_b64_tr_b16 a[98:99], v6 offset:34816
  s_add_u32 m0, s45, 69632
  s_add_u32 s68, s68, 196608
  buffer_load_dwordx4 v9, s[12:15], s68 offen lds
  ds_read_b64_tr_b16 a[108:109], v6 offset:36864
  ds_read_b64_tr_b16 a[110:111], v6 offset:38912
  s_add_u32 m0, s45, 73728
  s_add_u32 s68, s68, 196608
  buffer_load_dwordx4 v9, s[12:15], s68 offen lds
  ds_read_b64_tr_b16 a[120:121], v6 offset:40960
  ds_read_b64_tr_b16 a[122:123], v6 offset:43008
  s_add_u32 m0, s45, 77824
  s_add_u32 s68, s68, 196608
  buffer_load_dwordx4 v9, s[12:15], s68 offen lds
  ds_read_b64_tr_b16 a[132:133], v6 offset:45056
  ds_read_b64_tr_b16 a[134:135], v6 offset:47104
  s_add_u32 m0, s45, 81920
  s_add_u32 s68, s66, 5
  s_and_b32 s68, s68, 7
  s_mul_i32 s68, s68, 786432
  buffer_load_dwordx4 v9, s[12:15], s68 offen lds
  ds_read_b64_tr_b16 a[144:145], v6 offset:49152
  ds_read_b64_tr_b16 a[146:147], v6 offset:51200
  s_add_u32 m0, s45, 86016
  s_add_u32 s68, s68, 196608
  buffer_load_dwordx4 v9, s[12:15], s68 offen lds
  ds_read_b64_tr_b16 a[156:157], v6 offset:53248
  ds_read_b64_tr_b16 a[158:159], v6 offset:55296
  s_add_u32 m0, s45, 90112
  s_add_u32 s68, s68, 196608
  buffer_load_dwordx4 v9, s[12:15], s68 offen lds
  ds_read_b64_tr_b16 a[168:169], v6 offset:57344
  ds_read_b64_tr_b16 a[170:171], v6 offset:59392
  s_add_u32 m0, s45, 94208
  s_add_u32 s68, s68, 196608
  buffer_load_dwordx4 v9, s[12:15], s68 offen lds
  ds_read_b64_tr_b16 a[180:181], v6 offset:61440
  ds_read_b64_tr_b16 a[182:183], v6 offset:63488
  s_waitcnt vmcnt(17) lgkmcnt(0)
  s_barrier
  ds_read_b64_tr_b16 a[100:101], v4 offset:0
  ds_read_b64_tr_b16 a[102:103], v4 offset:2048
  ds_read_b64_tr_b16 a[104:105], v5 offset:0
  ds_read_b64_tr_b16 a[106:107], v5 offset:2048
  ds_read_b64_tr_b16 a[112:113], v4 offset:4096
  ds_read_b64_tr_b16 a[114:115], v4 offset:6144
  ds_read_b64_tr_b16 a[116:117], v5 offset:4096
  ds_read_b64_tr_b16 a[118:119], v5 offset:6144
  ds_read_b64_tr_b16 a[124:125], v4 offset:8192
  ds_read_b64_tr_b16 a[126:127], v4 offset:10240
  ds_read_b64_tr_b16 a[128:129], v5 offset:8192
  ds_read_b64_tr_b16 a[130:131], v5 offset:10240
  ds_read_b64_tr_b16 a[136:137], v4 offset:12288
  ds_read_b64_tr_b16 a[138:139], v4 offset:14336
  ds_read_b64_tr_b16 a[140:141], v5 offset:12288
  ds_read_b64_tr_b16 a[142:143], v5 offset:14336
  s_waitcnt vmcnt(8)
  s_cmp_lg_u32 s44, 0
  s_cbranch_scc1 PL3_adaLN_cond__sliding_local_dilated__swiglu_ffn__prompt_kernelx
  v_cmp_ne_u32 vcc, s46, v36
  s_nop 4
  s_cbranch_vccz PL3_adaLN_cond__sliding_local_dilated__swiglu_ffn__prompt_kernelx
  s_mov_b32 s57, 60000
PL3_adaLN_cond__sliding_local_dilated__swiglu_ffn__prompt_kernel:
  buffer_load_dword v36, v14, s[8:11], 0 offen sc1
  s_sub_u32 s57, s57, 1
  s_cmp_eq_u32 s57, 0
  s_waitcnt vmcnt(0)
  s_cbranch_scc1 PL3_adaLN_cond__sliding_local_dilated__swiglu_ffn__prompt_kernelx
  v_cmp_ne_u32 vcc, s46, v36
  s_nop 4
  s_cbranch_vccnz PL3_adaLN_cond__sliding_local_dilated__swiglu_ffn__prompt_kernel
PL3_adaLN_cond__sliding_local_dilated__swiglu_ffn__prompt_kernelx:
  s_barrier
  s_add_u32 m0, s70, 98304
  s_add_u32 s69, s58, 32768
  buffer_load_dwordx4 v12, s[8:11], s69 offen offset:0 sc1 lds
  buffer_load_dwordx4 v12, s[8:11], s69 offen offset:1024 sc1 lds
  buffer_load_dwordx4 v12, s[8:11], s69 offen offset:2048 sc1 lds
  buffer_load_dwordx4 v12, s[8:11], s69 offen offset:3072 sc1 lds
  s_add_u32 m0, s71, 131072
  s_add_u32 s69, s58, s72
  buffer_load_dwordx4 v1, s[8:11], s69 offen offset:0 sc1 lds
  buffer_load_dwordx4 v1, s[8:11], s69 offen offset:1024 sc1 lds
  s_add_u32 m0, s70, 114688
  s_add_u32 s69, s59, 32768
  buffer_load_dwordx4 v12, s[8:11], s69 offen offset:0 sc1 lds
  buffer_load_dwordx4 v12, s[8:11], s69 offen offset:1024 sc1 lds
  buffer_load_dwordx4 v12, s[8:11], s69 offen offset:2048 sc1 lds
  buffer_load_dwordx4 v12, s[8:11], s69 offen offset:3072 sc1 lds
  s_add_u32 m0, s71, 139264
  s_add_u32 s69, s59, s72
  buffer_load_dwordx4 v1, s[8:11], s69 offen offset:0 sc1 lds
  buffer_load_dwordx4 v1, s[8:11], s69 offen offset:1024 sc1 lds
  s_waitcnt vmcnt(21) lgkmcnt(0)
  s_barrier
  s_add_u32 m0, s45, 0
  s_add_u32 s68, s66, 4
  s_and_b32 s68, s68, 7
  s_mul_i32 s68, s68, 786432
  s_add_u32 s68, s68, 2048
  buffer_load_dwordx4 v9, s[12:15], s68 offen lds
  ds_read_b64_tr_b16 a[148:149], v4 offset:32768
  ds_read_b64_tr_b16 a[150:151], v4 offset:34816
  s_add_u32 m0, s45, 4096
  s_add_u32 s68, s68, 196608
  buffer_load_dwordx4 v9, s[12:15], s68 offen lds
  ds_read_b64_tr_b16 a[152:153], v5 offset:32768
  ds_read_b64_tr_b16 a[154:155], v5 offset:34816
  s_add_u32 m0, s45, 8192
  s_add_u32 s68, s68, 196608
  buffer_load_dwordx4 v9, s[12:15], s68 offen lds
  ds_read_b64_tr_b16 a[160:161], v4 offset:36864
  ds_read_b64_tr_b16 a[162:163], v4 offset:38912
  s_add_u32 m0, s45, 12288
  s_add_u32 s68, s68, 196608
  buffer_load_dwordx4 v9, s[12:15], s68 offen lds
  ds_read_b64_tr_b16 a[164:165], v5 offset:36864
  ds_read_b64_tr_b16 a[166:167], v5 offset:38912
  s_add_u32 m0, s45, 16384
  s_add_u32 s68, s66, 4
  s_and_b32 s68, s68, 7
  s_mul_i32 s68, s68, 786432
  s_add_u32 s68, s68, 4096
  buffer_load_dwordx4 v9, s[12:15], s68 offen lds
  ds_read_b64_tr_b16 a[172:173], v4 offset:40960
  ds_read_b64_tr_b16 a[174:175], v4 offset:43008
  s_add_u32 m0, s45, 20480
  s_add_u32 s68, s68, 196608
  buffer_load_dwordx4 v9, s[12:15], s68 offen lds
  ds_read_b64_tr_b16 a[176:177], v5 offset:40960
  ds_read_b64_tr_b16 a[178:179], v5 offset:43008
  s_add_u32 m0, s45, 24576
  s_add_u32 s68, s68, 196608
  buffer_load_dwordx4 v9, s[12:15], s68 offen lds
  ds_read_b64_tr_b16 a[184:185], v4 offset:45056
  ds_read_b64_tr_b16 a[186:187], v4 offset:47104
  s_add_u32 m0, s45, 28672
  s_add_u32 s68, s68, 196608
  buffer_load_dwordx4 v9, s[12:15], s68 offen lds
  ds_read_b64_tr_b16 a[188:189], v5 offset:45056
  ds_read_b64_tr_b16 a[190:191], v5 offset:47104
  s_waitcnt vmcnt(14) lgkmcnt(0)
  s_barrier
  ds_read_b128 v[76:79], v2 offset:32768
  ds_read_b128 v[80:83], v2 offset:33792
  ds_read_b128 v[84:87], v2 offset:40960
  ds_read_b128 v[88:91], v2 offset:41984
  ds_read_b128 v[92:95], v13 offset:0
  ds_read_b128 v[96:99], v13 offset:1024
  ds_read_b128 v[100:103], v2 offset:34816
  ds_read_b128 v[104:107], v2 offset:35840
  s_waitcnt lgkmcnt(2)
  v_mfma_f32_16x16x32_bf16 v[28:31], a[0:3], v[76:79], 0
  ds_read_b64_tr_b16 a[192:193], v6 offset:0
  s_add_u32 m0, s45, 32768
  s_add_u32 s68, s66, 5
  s_and_b32 s68, s68, 7
  s_mul_i32 s68, s68, 786432
  s_add_u32 s68, s68, 2048
  v_mfma_f32_16x16x32_bf16 v[28:31], a[12:15], v[80:83], v[28:31]
  ds_read_b128 v[108:111], v2 offset:43008
  buffer_load_dwordx4 v9, s[12:15], s68 offen lds
  v_mfma_f32_16x16x32_bf16 v[32:35], a[12:15], v[88:91], 0
  ds_read_b64_tr_b16 a[194:195], v6 offset:2048
  v_mfma_f32_16x16x32_bf16 v[32:35], a[0:3], v[84:87], v[32:35]
  ds_read_b64_tr_b16 a[204:205], v6 offset:4096
  v_mfma_f32_16x16x32_bf16 v[40:43], a[4:7], v[84:87], 0
  ds_read_b128 v[112:115], v2 offset:44032
  s_add_u32 m0, s45, 36864
  s_add_u32 s68, s68, 196608
  v_mfma_f32_16x16x32_bf16 v[40:43], a[16:19], v[88:91], v[40:43]
  ds_read_b64_tr_b16 a[206:207], v6 offset:6144
  buffer_load_dwordx4 v9, s[12:15], s68 offen lds
  v_mfma_f32_16x16x32_bf16 v[36:39], a[16:19], v[80:83], 0
  ds_read_b128 v[116:119], v13 offset:2048
  v_mfma_f32_16x16x32_bf16 v[36:39], a[4:7], v[76:79], v[36:39]
  ds_read_b64_tr_b16 a[216:217], v6 offset:8192
  v_mfma_f32_16x16x32_bf16 v[44:47], a[8:11], v[76:79], 0
  ds_read_b64_tr_b16 a[218:219], v6 offset:10240
  s_add_u32 m0, s45, 40960
  s_add_u32 s68, s68, 196608
  v_mfma_f32_16x16x32_bf16 v[44:47], a[20:23], v[80:83], v[44:47]
  ds_read_b128 v[120:123], v13 offset:3072
  buffer_load_dwordx4 v9, s[12:15], s68 offen lds
  v_mfma_f32_16x16x32_bf16 v[48:51], a[20:23], v[88:91], 0
  ds_read_b64_tr_b16 a[228:229], v6 offset:12288
  v_mfma_f32_16x16x32_bf16 v[48:51], a[8:11], v[84:87], v[48:51]
  ds_read_b64_tr_b16 a[230:231], v6 offset:14336
  v_mfma_f32_16x16x32_bf16 v[68:71], a[8:11], v[92:95], 0
  ds_read_b128 v[76:79], v2 offset:36864
  s_add_u32 m0, s45, 45056
  s_add_u32 s68, s68, 196608
  v_mfma_f32_16x16x32_bf16 v[68:71], a[20:23], v[96:99], v[68:71]
  ds_read_b64_tr_b16 a[240:241], v6 offset:16384
  buffer_load_dwordx4 v9, s[12:15], s68 offen lds
  v_mfma_f32_16x16x32_bf16 v[60:63], a[16:19], v[96:99], 0
  ds_read_b128 v[80:83], v2 offset:37888
  v_mfma_f32_16x16x32_bf16 v[60:63], a[4:7], v[92:95], v[60:63]
  s_waitcnt lgkmcnt(5)
  ds_read_b64_tr_b16 a[242:243], v6 offset:18432
  v_mfma_f32_16x16x32_bf16 v[28:31], a[24:27], v[100:103], v[28:31]
  ds_read_b64_tr_b16 v[124:125], v6 offset:20480
  s_add_u32 m0, s45, 49152
  s_add_u32 s68, s66, 5
  s_and_b32 s68, s68, 7
  s_mul_i32 s68, s68, 786432
  s_add_u32 s68, s68, 4096
  v_mfma_f32_16x16x32_bf16 v[28:31], a[36:39], v[104:107], v[28:31]
  ds_read_b128 v[88:91], v2 offset:45056
  buffer_load_dwordx4 v9, s[12:15], s68 offen lds
  v_mfma_f32_16x16x32_bf16 v[32:35], a[36:39], v[112:115], v[32:35]
  ds_read_b64_tr_b16 v[126:127], v6 offset:22528
  v_mfma_f32_16x16x32_bf16 v[32:35], a[24:27], v[108:111], v[32:35]
  ds_read_b64_tr_b16 v[136:137], v6 offset:24576
  v_mfma_f32_16x16x32_bf16 v[40:43], a[28:31], v[108:111], v[40:43]
  ds_read_b128 v[84:87], v2 offset:46080
  s_add_u32 m0, s45, 53248
  s_add_u32 s68, s68, 196608
  v_mfma_f32_16x16x32_bf16 v[40:43], a[40:43], v[112:115], v[40:43]
  ds_read_b64_tr_b16 v[138:139], v6 offset:26624
  buffer_load_dwordx4 v9, s[12:15], s68 offen lds
  v_mfma_f32_16x16x32_bf16 v[36:39], a[40:43], v[104:107], v[36:39]
  ds_read_b128 v[96:99], v13 offset:4096
  v_mfma_f32_16x16x32_bf16 v[36:39], a[28:31], v[100:103], v[36:39]
  ds_read_b64_tr_b16 v[148:149], v6 offset:28672
  v_mfma_f32_16x16x32_bf16 v[44:47], a[32:35], v[100:103], v[44:47]
  ds_read_b64_tr_b16 v[150:151], v6 offset:30720
  v_mfma_f32_16x16x32_bf16 v[44:47], a[44:47], v[104:107], v[44:47]
  ds_read_b128 v[92:95], v13 offset:5120
  s_add_u32 m0, s45, 57344
  s_add_u32 s68, s68, 196608
  v_mfma_f32_16x16x32_bf16 v[48:51], a[44:47], v[112:115], v[48:51]
  buffer_load_dwordx4 v9, s[12:15], s68 offen lds
  v_mfma_f32_16x16x32_bf16 v[48:51], a[32:35], v[108:111], v[48:51]
  s_add_u32 m0, s45, 61440
  s_add_u32 s68, s68, 196608
  v_mfma_f32_16x16x32_bf16 v[68:71], a[32:35], v[116:119], v[68:71]
  ds_read_b128 v[100:103], v2 offset:38912
  v_mfma_f32_16x16x32_bf16 v[68:71], a[44:47], v[120:123], v[68:71]
  buffer_load_dwordx4 v9, s[12:15], s68 offen lds
  v_mfma_f32_16x16x32_bf16 v[60:63], a[40:43], v[120:123], v[60:63]
  ds_read_b128 v[104:107], v2 offset:39936
  v_mfma_f32_16x16x32_bf16 v[60:63], a[28:31], v[116:119], v[60:63]
  s_waitcnt lgkmcnt(2)
  v_mfma_f32_16x16x32_bf16 v[28:31], a[48:51], v[76:79], v[28:31]
  s_add_u32 m0, s71, 147456
  s_add_u32 s69, s60, s72
  v_mfma_f32_16x16x32_bf16 v[28:31], a[60:63], v[80:83], v[28:31]
  ds_read_b128 v[112:115], v2 offset:47104
  v_mfma_f32_16x16x32_bf16 v[32:35], a[60:63], v[84:87], v[32:35]
  buffer_load_dwordx4 v1, s[8:11], s69 offen offset:0 sc1 lds
  v_mfma_f32_16x16x32_bf16 v[32:35], a[48:51], v[88:91], v[32:35]
  v_mfma_f32_16x16x32_bf16 v[40:43], a[52:55], v[88:91], v[40:43]
  ds_read_b128 v[108:111], v2 offset:48128
  v_mfma_f32_16x16x32_bf16 v[40:43], a[64:67], v[84:87], v[40:43]
  buffer_load_dwordx4 v1, s[8:11], s69 offen offset:1024 sc1 lds
  v_mfma_f32_16x16x32_bf16 v[36:39], a[64:67], v[80:83], v[36:39]
  ds_read_b128 v[120:123], v13 offset:6144
  v_mfma_f32_16x16x32_bf16 v[36:39], a[52:55], v[76:79], v[36:39]
  v_mfma_f32_16x16x32_bf16 v[44:47], a[56:59], v[76:79], v[44:47]
  s_add_u32 m0, s71, 155648
  s_add_u32 s69, s61, s72
  v_mfma_f32_16x16x32_bf16 v[44:47], a[68:71], v[80:83], v[44:47]
  ds_read_b128 v[116:119], v13 offset:7168
  v_mfma_f32_16x16x32_bf16 v[48:51], a[68:71], v[84:87], v[48:51]
  buffer_load_dwordx4 v1, s[8:11], s69 offen offset:0 sc1 lds
  v_mfma_f32_16x16x32_bf16 v[48:51], a[56:59], v[88:91], v[48:51]
  s_waitcnt vmcnt(11) lgkmcnt(7)
  s_barrier
  v_mfma_f32_16x16x32_bf16 v[68:71], a[56:59], v[96:99], v[68:71]
  ds_read_b128 v[76:79], v2 offset:49152
  v_mfma_f32_16x16x32_bf16 v[68:71], a[68:71], v[92:95], v[68:71]
  ds_read_b64_tr_b16 a[196:197], v4 offset:0
  buffer_load_dwordx4 v1, s[8:11], s69 offen offset:1024 sc1 lds
  v_mfma_f32_16x16x32_bf16 v[60:63], a[64:67], v[92:95], v[60:63]
  ds_read_b128 v[80:83], v2 offset:50176
  v_mfma_f32_16x16x32_bf16 v[60:63], a[52:55], v[96:99], v[60:63]
  s_waitcnt lgkmcnt(3)
  ds_read_b64_tr_b16 a[198:199], v4 offset:2048
  v_mfma_f32_16x16x32_bf16 v[28:31], a[72:75], v[100:103], v[28:31]
  ds_read_b64_tr_b16 a[200:201], v5 offset:0
  s_add_u32 m0, s70, 65536
  s_add_u32 s69, s60, 32768
  v_mfma_f32_16x16x32_bf16 v[28:31], a[84:87], v[104:107], v[28:31]
  ds_read_b128 v[84:87], v2 offset:57344
  buffer_load_dwordx4 v12, s[8:11], s69 offen offset:0 sc1 lds
  v_mfma_f32_16x16x32_bf16 v[32:35], a[84:87], v[108:111], v[32:35]
HOP1:
  s_cbranch_execz HOP5
  ds_read_b64_tr_b16 a[202:203], v5 offset:2048
  v_mfma_f32_16x16x32_bf16 v[32:35], a[72:75], v[112:115], v[32:35]
  ds_read_b64_tr_b16 a[208:209], v4 offset:4096
  v_mfma_f32_16x16x32_bf16 v[40:43], a[76:79], v[112:115], v[40:43]
  ds_read_b128 v[88:91], v2 offset:58368
  v_mfma_f32_16x16x32_bf16 v[40:43], a[88:91], v[108:111], v[40:43]
  ds_read_b64_tr_b16 a[210:211], v4 offset:6144
  buffer_load_dwordx4 v12, s[8:11], s69 offen offset:1024 sc1 lds
  v_mfma_f32_16x16x32_bf16 v[36:39], a[88:91], v[104:107], v[36:39]
  ds_read_b128 v[92:95], v13 offset:8192
  v_mfma_f32_16x16x32_bf16 v[36:39], a[76:79], v[100:103], v[36:39]
  ds_read_b64_tr_b16 a[212:213], v5 offset:4096
  v_mfma_f32_16x16x32_bf16 v[44:47], a[80:83], v[100:103], v[44:47]
  ds_read_b64_tr_b16 a[214:215], v5 offset:6144
  v_mfma_f32_16x16x32_bf16 v[44:47], a[92:95], v[104:107], v[44:47]
  ds_read_b128 v[96:99], v13 offset:9216
  buffer_load_dwordx4 v12, s[8:11], s69 offen offset:2048 sc1 lds
  v_mfma_f32_16x16x32_bf16 v[48:51], a[92:95], v[108:111], v[48:51]
  ds_read_b64_tr_b16 a[220:221], v4 offset:8192
  v_mfma_f32_16x16x32_bf16 v[48:51], a[80:83], v[112:115], v[48:51]
  ds_read_b64_tr_b16 a[222:223], v4 offset:10240
  v_mfma_f32_16x16x32_bf16 v[68:71], a[80:83], v[120:123], v[68:71]
  ds_read_b128 v[100:103], v2 offset:51200
  v_mfma_f32_16x16x32_bf16 v[68:71], a[92:95], v[116:119], v[68:71]
  ds_read_b64_tr_b16 a[224:225], v5 offset:8192
  buffer_load_dwordx4 v12, s[8:11], s69 offen offset:3072 sc1 lds
  v_mfma_f32_16x16x32_bf16 v[60:63], a[88:91], v[116:119], v[60:63]
  ds_read_b128 v[104:107], v2 offset:52224
  v_mfma_f32_16x16x32_bf16 v[60:63], a[76:79], v[120:123], v[60:63]
  s_waitcnt lgkmcnt(5)
  ds_read_b64_tr_b16 a[226:227], v5 offset:10240
  v_mfma_f32_16x16x32_bf16 v[28:31], a[96:99], v[76:79], v[28:31]
  ds_read_b64_tr_b16 a[232:233], v4 offset:12288
  s_add_u32 m0, s45, 81920
  s_add_u32 s68, s66, 6
  s_and_b32 s68, s68, 7
  s_mul_i32 s68, s68, 786432
  v_mfma_f32_16x16x32_bf16 v[28:31], a[108:111], v[80:83], v[28:31]
  ds_read_b128 v[108:111], v2 offset:59392
  buffer_load_dwordx4 v9, s[12:15], s68 offen lds
  v_mfma_f32_16x16x32_bf16 v[32:35], a[108:111], v[88:91], v[32:35]
  ds_read_b64_tr_b16 a[234:235], v4 offset:14336
  v_mfma_f32_16x16x32_bf16 v[32:35], a[96:99], v[84:87], v[32:35]
  ds_read_b64_tr_b16 a[236:237], v5 offset:12288
  v_mfma_f32_16x16x32_bf16 v[40:43], a[100:103], v[84:87], v[40:43]
  ds_read_b128 v[112:115], v2 offset:60416
  s_add_u32 m0, s45, 86016
  s_add_u32 s68, s68, 196608
  v_mfma_f32_16x16x32_bf16 v[40:43], a[112:115], v[88:91], v[40:43]
  ds_read_b64_tr_b16 a[238:239], v5 offset:14336
  buffer_load_dwordx4 v9, s[12:15], s68 offen lds
  v_mfma_f32_16x16x32_bf16 v[36:39], a[112:115], v[80:83], v[36:39]
  ds_read_b128 v[116:119], v13 offset:10240
  v_mfma_f32_16x16x32_bf16 v[36:39], a[100:103], v[76:79], v[36:39]
  v_mfma_f32_16x16x32_bf16 v[44:47], a[104:107], v[76:79], v[44:47]
  s_add_u32 m0, s45, 90112
  s_add_u32 s68, s68, 196608
  v_mfma_f32_16x16x32_bf16 v[44:47], a[116:119], v[80:83], v[44:47]
  ds_read_b128 v[120:123], v13 offset:11264
  v_mfma_f32_16x16x32_bf16 v[48:51], a[116:119], v[88:91], v[48:51]
  buffer_load_dwordx4 v9, s[12:15], s68 offen lds
  v_mfma_f32_16x16x32_bf16 v[48:51], a[104:107], v[84:87], v[48:51]
  s_waitcnt vmcnt(11) lgkmcnt(2)
  s_barrier
  v_mfma_f32_16x16x32_bf16 v[68:71], a[104:107], v[92:95], v[68:71]
  ds_read_b128 v[76:79], v2 offset:53248
  s_add_u32 m0, s45, 94208
  s_add_u32 s68, s68, 196608
  v_mfma_f32_16x16x32_bf16 v[68:71], a[116:119], v[96:99], v[68:71]
  ds_read_b64_tr_b16 a[244:245], v4 offset:32768
  buffer_load_dwordx4 v9, s[12:15], s68 offen lds
  v_mfma_f32_16x16x32_bf16 v[60:63], a[112:115], v[96:99], v[60:63]
  ds_read_b128 v[80:83], v2 offset:54272
  v_mfma_f32_16x16x32_bf16 v[60:63], a[100:103], v[92:95], v[60:63]
  s_waitcnt lgkmcnt(3)
  ds_read_b64_tr_b16 a[246:247], v4 offset:34816
  v_mfma_f32_16x16x32_bf16 v[28:31], a[120:123], v[100:103], v[28:31]
  ds_read_b64_tr_b16 a[248:249], v5 offset:32768
  s_add_u32 m0, s45, 98304
  s_add_u32 s68, s66, 7
  s_and_b32 s68, s68, 7
  s_mul_i32 s68, s68, 786432
  v_mfma_f32_16x16x32_bf16 v[28:31], a[132:135], v[104:107], v[28:31]
  ds_read_b128 v[88:91], v2 offset:61440
  buffer_load_dwordx4 v9, s[12:15], s68 offen lds
  v_mfma_f32_16x16x32_bf16 v[32:35], a[132:135], v[112:115], v[32:35]
  ds_read_b64_tr_b16 a[250:251], v5 offset:34816
  v_mfma_f32_16x16x32_bf16 v[32:35], a[120:123], v[108:111], v[32:35]
  ds_read_b64_tr_b16 v[128:129], v4 offset:36864
  v_mfma_f32_16x16x32_bf16 v[40:43], a[124:127], v[108:111], v[40:43]
  ds_read_b128 v[84:87], v2 offset:62464
  s_add_u32 m0, s45, 102400
  s_add_u32 s68, s68, 196608
  v_mfma_f32_16x16x32_bf16 v[40:43], a[136:139], v[112:115], v[40:43]
  ds_read_b64_tr_b16 v[130:131], v4 offset:38912
  buffer_load_dwordx4 v9, s[12:15], s68 offen lds
  v_mfma_f32_16x16x32_bf16 v[36:39], a[136:139], v[104:107], v[36:39]
  ds_read_b128 v[96:99], v13 offset:12288
  v_mfma_f32_16x16x32_bf16 v[36:39], a[124:127], v[100:103], v[36:39]
  ds_read_b64_tr_b16 v[132:133], v5 offset:36864
  v_mfma_f32_16x16x32_bf16 v[44:47], a[128:131], v[100:103], v[44:47]
  ds_read_b64_tr_b16 v[134:135], v5 offset:38912
  s_add_u32 m0, s45, 106496
  s_add_u32 s68, s68, 196608
  v_mfma_f32_16x16x32_bf16 v[44:47], a[140:143], v[104:107], v[44:47]
  ds_read_b128 v[92:95], v13 offset:13312
  buffer_load_dwordx4 v9, s[12:15], s68 offen lds
  v_mfma_f32_16x16x32_bf16 v[48:51], a[140:143], v[112:115], v[48:51]
  ds_read_b64_tr_b16 v[140:141], v4 offset:40960
  v_mfma_f32_16x16x32_bf16 v[48:51], a[128:131], v[108:111], v[48:51]
  ds_read_b64_tr_b16 v[142:143], v4 offset:43008
  v_mfma_f32_16x16x32_bf16 v[68:71], a[128:131], v[116:119], v[68:71]
  ds_read_b128 v[100:103], v2 offset:55296
  s_add_u32 m0, s45, 110592
  s_add_u32 s68, s68, 196608
  v_mfma_f32_16x16x32_bf16 v[68:71], a[140:143], v[120:123], v[68:71]
  ds_read_b64_tr_b16 v[144:145], v5 offset:40960
  buffer_load_dwordx4 v9, s[12:15], s68 offen lds
  v_mfma_f32_16x16x32_bf16 v[60:63], a[136:139], v[120:123], v[60:63]
  ds_read_b128 v[104:107], v2 offset:56320
  v_mfma_f32_16x16x32_bf16 v[60:63], a[124:127], v[116:119], v[60:63]
  s_waitcnt lgkmcnt(5)
  ds_read_b64_tr_b16 v[146:147], v5 offset:43008
  v_mfma_f32_16x16x32_bf16 v[28:31], a[144:147], v[76:79], v[28:31]
  ds_read_b64_tr_b16 v[152:153], v4 offset:45056
  s_add_u32 m0, s45, 0
  s_add_u32 s68, s66, 6
  s_and_b32 s68, s68, 7
  s_mul_i32 s68, s68, 786432
  s_add_u32 s68, s68, 2048
  v_mfma_f32_16x16x32_bf16 v[28:31], a[156:159], v[80:83], v[28:31]
  ds_read_b128 v[112:115], v2 offset:63488
  buffer_load_dwordx4 v9, s[12:15], s68 offen lds
  v_mfma_f32_16x16x32_bf16 v[32:35], a[156:159], v[84:87], v[32:35]
  ds_read_b64_tr_b16 v[154:155], v4 offset:47104
  v_mfma_f32_16x16x32_bf16 v[32:35], a[144:147], v[88:91], v[32:35]
  ds_read_b64_tr_b16 v[156:157], v5 offset:45056
  v_mfma_f32_16x16x32_bf16 v[40:43], a[148:151], v[88:91], v[40:43]
  ds_read_b128 v[108:111], v2 offset:64512
  s_add_u32 m0, s45, 4096
  s_add_u32 s68, s68, 196608
  v_mfma_f32_16x16x32_bf16 v[40:43], a[160:163], v[84:87], v[40:43]
  ds_read_b64_tr_b16 v[158:159], v5 offset:47104
  buffer_load_dwordx4 v9, s[12:15], s68 offen lds
  v_mfma_f32_16x16x32_bf16 v[36:39], a[160:163], v[80:83], v[36:39]
  ds_read_b128 v[120:123], v13 offset:14336
  v_mfma_f32_16x16x32_bf16 v[36:39], a[148:151], v[76:79], v[36:39]
  v_mfma_f32_16x16x32_bf16 v[44:47], a[152:155], v[76:79], v[44:47]
  s_add_u32 m0, s45, 8192
  s_add_u32 s68, s68, 196608
  v_mfma_f32_16x16x32_bf16 v[44:47], a[164:167], v[80:83], v[44:47]
  ds_read_b128 v[116:119], v13 offset:15360
  v_mfma_f32_16x16x32_bf16 v[48:51], a[164:167], v[84:87], v[48:51]
  buffer_load_dwordx4 v9, s[12:15], s68 offen lds
  v_mfma_f32_16x16x32_bf16 v[48:51], a[152:155], v[88:91], v[48:51]
  s_waitcnt vmcnt(3) lgkmcnt(2)
  s_barrier
  v_mfma_f32_16x16x32_bf16 v[68:71], a[152:155], v[96:99], v[68:71]
  ds_read_b128 v[76:79], v2 offset:0
  s_add_u32 m0, s45, 12288
  s_add_u32 s68, s68, 196608
  v_mfma_f32_16x16x32_bf16 v[68:71], a[164:167], v[92:95], v[68:71]
  ds_read_b64_tr_b16 v[160:161], v6 offset:16384
  buffer_load_dwordx4 v9, s[12:15], s68 offen lds
  v_mfma_f32_16x16x32_bf16 v[60:63], a[160:163], v[92:95], v[60:63]
  ds_read_b128 v[80:83], v2 offset:1024
  v_mfma_f32_16x16x32_bf16 v[60:63], a[148:151], v[96:99], v[60:63]
  s_waitcnt lgkmcnt(3)
  ds_read_b64_tr_b16 v[162:163], v6 offset:18432
  v_mfma_f32_16x16x32_bf16 v[28:31], a[168:171], v[100:103], v[28:31]
  ds_read_b64_tr_b16 v[172:173], v6 offset:20480
  s_add_u32 m0, s45, 16384
  s_add_u32 s68, s66, 6
  s_and_b32 s68, s68, 7
  s_mul_i32 s68, s68, 786432
  s_add_u32 s68, s68, 4096
  v_mfma_f32_16x16x32_bf16 v[28:31], a[180:183], v[104:107], v[28:31]
  ds_read_b128 v[84:87], v2 offset:8192
  buffer_load_dwordx4 v9, s[12:15], s68 offen lds
  v_mfma_f32_16x16x32_bf16 v[32:35], a[180:183], v[108:111], v[32:35]
  ds_read_b64_tr_b16 v[174:175], v6 offset:22528
  v_mfma_f32_16x16x32_bf16 v[32:35], a[168:171], v[112:115], v[32:35]
  ds_read_b64_tr_b16 v[184:185], v6 offset:24576
  v_mfma_f32_16x16x32_bf16 v[40:43], a[172:175], v[112:115], v[40:43]
  ds_read_b128 v[88:91], v2 offset:9216
  s_add_u32 m0, s45, 20480
  s_add_u32 s68, s68, 196608
  v_mfma_f32_16x16x32_bf16 v[40:43], a[184:187], v[108:111], v[40:43]
  ds_read_b64_tr_b16 v[186:187], v6 offset:26624
  buffer_load_dwordx4 v9, s[12:15], s68 offen lds
  v_mfma_f32_16x16x32_bf16 v[36:39], a[184:187], v[104:107], v[36:39]
  ds_read_b128 v[92:95], v13 offset:16384
  v_mfma_f32_16x16x32_bf16 v[36:39], a[172:175], v[100:103], v[36:39]
  ds_read_b64_tr_b16 v[196:197], v6 offset:28672
  v_mfma_f32_16x16x32_bf16 v[44:47], a[176:179], v[100:103], v[44:47]
  ds_read_b64_tr_b16 v[198:199], v6 offset:30720
  s_add_u32 m0, s45, 24576
  s_add_u32 s68, s68, 196608
  v_mfma_f32_16x16x32_bf16 v[44:47], a[188:191], v[104:107], v[44:47]
  ds_read_b128 v[96:99], v13 offset:17408
  buffer_load_dwordx4 v9, s[12:15], s68 offen lds
  v_mfma_f32_16x16x32_bf16 v[48:51], a[188:191], v[108:111], v[48:51]
  ds_read_b64_tr_b16 v[208:209], v6 offset:32768
  v_mfma_f32_16x16x32_bf16 v[48:51], a[176:179], v[112:115], v[48:51]
  ds_read_b64_tr_b16 v[210:211], v6 offset:34816
  v_mfma_f32_16x16x32_bf16 v[68:71], a[176:179], v[120:123], v[68:71]
  ds_read_b128 v[100:103], v2 offset:2048
  s_add_u32 m0, s45, 28672
  s_add_u32 s68, s68, 196608
  v_mfma_f32_16x16x32_bf16 v[68:71], a[188:191], v[116:119], v[68:71]
  ds_read_b64_tr_b16 v[220:221], v6 offset:36864
  buffer_load_dwordx4 v9, s[12:15], s68 offen lds
  v_mfma_f32_16x16x32_bf16 v[60:63], a[184:187], v[116:119], v[60:63]
  ds_read_b128 v[104:107], v2 offset:3072
  v_mfma_f32_16x16x32_bf16 v[60:63], a[172:175], v[120:123], v[60:63]
  s_waitcnt lgkmcnt(5)
  ds_read_b64_tr_b16 v[222:223], v6 offset:38912
  v_mfma_f32_16x16x32_bf16 v[28:31], a[192:195], v[76:79], v[28:31]
  ds_read_b64_tr_b16 v[232:233], v6 offset:40960
  s_add_u32 m0, s70, 32768
  s_add_u32 s69, s61, 32768
  v_mfma_f32_16x16x32_bf16 v[28:31], a[204:207], v[80:83], v[28:31]
  ds_read_b128 v[108:111], v2 offset:10240
  buffer_load_dwordx4 v12, s[8:11], s69 offen offset:0 sc1 lds
  v_mfma_f32_16x16x32_bf16 v[32:35], a[204:207], v[88:91], v[32:35]
  ds_read_b64_tr_b16 v[234:235], v6 offset:43008
  v_mfma_f32_16x16x32_bf16 v[32:35], a[192:195], v[84:87], v[32:35]
  ds_read_b64_tr_b16 v[244:245], v6 offset:45056
  v_mfma_f32_16x16x32_bf16 v[40:43], a[196:199], v[84:87], v[40:43]
  ds_read_b128 v[112:115], v2 offset:11264
  v_mfma_f32_16x16x32_bf16 v[40:43], a[208:211], v[88:91], v[40:43]
  ds_read_b64_tr_b16 v[246:247], v6 offset:47104
  buffer_load_dwordx4 v12, s[8:11], s69 offen offset:1024 sc1 lds
  v_mfma_f32_16x16x32_bf16 v[36:39], a[208:211], v[80:83], v[36:39]
  ds_read_b128 v[116:119], v13 offset:18432
  v_mfma_f32_16x16x32_bf16 v[36:39], a[196:199], v[76:79], v[36:39]
  v_mfma_f32_16x16x32_bf16 v[44:47], a[200:203], v[76:79], v[44:47]
  v_mfma_f32_16x16x32_bf16 v[44:47], a[212:215], v[80:83], v[44:47]
  ds_read_b128 v[120:123], v13 offset:19456
  v_mfma_f32_16x16x32_bf16 v[48:51], a[212:215], v[88:91], v[48:51]
  buffer_load_dwordx4 v12, s[8:11], s69 offen offset:2048 sc1 lds
  v_mfma_f32_16x16x32_bf16 v[48:51], a[200:203], v[84:87], v[48:51]
  s_waitcnt vmcnt(3) lgkmcnt(2)
  s_barrier
  v_mfma_f32_16x16x32_bf16 v[68:71], a[200:203], v[92:95], v[68:71]
  ds_read_b128 v[76:79], v2 offset:4096
  v_mfma_f32_16x16x32_bf16 v[68:71], a[212:215], v[96:99], v[68:71]
  ds_read_b64_tr_b16 v[164:165], v4 offset:0
  buffer_load_dwordx4 v12, s[8:11], s69 offen offset:3072 sc1 lds
  v_mfma_f32_16x16x32_bf16 v[60:63], a[208:211], v[96:99], v[60:63]
  ds_read_b128 v[80:83], v2 offset:5120
  v_mfma_f32_16x16x32_bf16 v[60:63], a[196:199], v[92:95], v[60:63]
  s_waitcnt lgkmcnt(3)
  ds_read_b64_tr_b16 v[166:167], v4 offset:2048
  v_mfma_f32_16x16x32_bf16 v[28:31], a[216:219], v[100:103], v[28:31]
  ds_read_b64_tr_b16 v[168:169], v5 offset:0
  s_add_u32 m0, s45, 81920
  s_add_u32 s68, s66, 7
  s_and_b32 s68, s68, 7
  s_mul_i32 s68, s68, 786432
  s_add_u32 s68, s68, 2048
  v_mfma_f32_16x16x32_bf16 v[28:31], a[228:231], v[104:107], v[28:31]
  ds_read_b128 v[88:91], v2 offset:12288
  buffer_load_dwordx4 v9, s[12:15], s68 offen lds
  v_mfma_f32_16x16x32_bf16 v[32:35], a[228:231], v[112:115], v[32:35]
  ds_read_b64_tr_b16 v[170:171], v5 offset:2048
  v_mfma_f32_16x16x32_bf16 v[32:35], a[216:219], v[108:111], v[32:35]
  ds_read_b64_tr_b16 v[176:177], v4 offset:4096
  v_mfma_f32_16x16x32_bf16 v[40:43], a[220:223], v[108:111], v[40:43]
  ds_read_b128 v[84:87], v2 offset:13312
  s_add_u32 m0, s45, 86016
  s_add_u32 s68, s68, 196608
  v_mfma_f32_16x16x32_bf16 v[40:43], a[232:235], v[112:115], v[40:43]
  ds_read_b64_tr_b16 v[178:179], v4 offset:6144
  buffer_load_dwordx4 v9, s[12:15], s68 offen lds
  v_mfma_f32_16x16x32_bf16 v[36:39], a[232:235], v[104:107], v[36:39]
  ds_read_b128 v[96:99], v13 offset:20480
  v_mfma_f32_16x16x32_bf16 v[36:39], a[220:223], v[100:103], v[36:39]
  ds_read_b64_tr_b16 v[180:181], v5 offset:4096
  v_mfma_f32_16x16x32_bf16 v[44:47], a[224:227], v[100:103], v[44:47]
  ds_read_b64_tr_b16 v[182:183], v5 offset:6144
  s_add_u32 m0, s45, 90112
  s_add_u32 s68, s68, 196608
  v_mfma_f32_16x16x32_bf16 v[44:47], a[236:239], v[104:107], v[44:47]
  ds_read_b128 v[92:95], v13 offset:21504
  buffer_load_dwordx4 v9, s[12:15], s68 offen lds
  v_mfma_f32_16x16x32_bf16 v[48:51], a[236:239], v[112:115], v[48:51]
  ds_read_b64_tr_b16 v[188:189], v4 offset:8192
  v_mfma_f32_16x16x32_bf16 v[48:51], a[224:227], v[108:111], v[48:51]
  ds_read_b64_tr_b16 v[190:191], v4 offset:10240
  v_mfma_f32_16x16x32_bf16 v[68:71], a[224:227], v[116:119], v[68:71]
  ds_read_b128 v[100:103], v2 offset:6144
  s_add_u32 m0, s45, 94208
  s_add_u32 s68, s68, 196608
  v_mfma_f32_16x16x32_bf16 v[68:71], a[236:239], v[120:123], v[68:71]
  ds_read_b64_tr_b16 v[192:193], v5 offset:8192
  buffer_load_dwordx4 v9, s[12:15], s68 offen lds
  v_mfma_f32_16x16x32_bf16 v[60:63], a[232:235], v[120:123], v[60:63]
  ds_read_b128 v[104:107], v2 offset:7168
  v_mfma_f32_16x16x32_bf16 v[60:63], a[220:223], v[116:119], v[60:63]
  s_waitcnt lgkmcnt(5)
  ds_read_b64_tr_b16 v[194:195], v5 offset:10240
  v_mfma_f32_16x16x32_bf16 v[28:31], a[240:243], v[76:79], v[28:31]
  ds_read_b64_tr_b16 v[200:201], v4 offset:12288
  s_add_u32 m0, s45, 98304
  s_add_u32 s68, s66, 7
  s_and_b32 s68, s68, 7
  s_mul_i32 s68, s68, 786432
  s_add_u32 s68, s68, 4096
  v_mfma_f32_16x16x32_bf16 v[28:31], v[124:127], v[80:83], v[28:31]
  ds_read_b128 v[112:115], v2 offset:14336
  buffer_load_dwordx4 v9, s[12:15], s68 offen lds
  v_mfma_f32_16x16x32_bf16 v[32:35], v[124:127], v[84:87], v[32:35]
  ds_read_b64_tr_b16 v[202:203], v4 offset:14336
  v_mfma_f32_16x16x32_bf16 v[32:35], a[240:243], v[88:91], v[32:35]
  ds_read_b64_tr_b16 v[204:205], v5 offset:12288
  v_mfma_f32_16x16x32_bf16 v[40:43], a[244:247], v[88:91], v[40:43]
  ds_read_b128 v[108:111], v2 offset:15360
  s_add_u32 m0, s45, 102400
  s_add_u32 s68, s68, 196608
  v_mfma_f32_16x16x32_bf16 v[40:43], v[128:131], v[84:87], v[40:43]
  ds_read_b64_tr_b16 v[206:207], v5 offset:14336
  buffer_load_dwordx4 v9, s[12:15], s68 offen lds
  v_mfma_f32_16x16x32_bf16 v[36:39], v[128:131], v[80:83], v[36:39]
  ds_read_b128 v[120:123], v13 offset:22528
  v_mfma_f32_16x16x32_bf16 v[36:39], a[244:247], v[76:79], v[36:39]
  v_mfma_f32_16x16x32_bf16 v[44:47], a[248:251], v[76:79], v[44:47]
  s_add_u32 m0, s45, 106496
  s_add_u32 s68, s68, 196608
  v_mfma_f32_16x16x32_bf16 v[44:47], v[132:135], v[80:83], v[44:47]
  ds_read_b128 v[116:119], v13 offset:23552
  v_mfma_f32_16x16x32_bf16 v[48:51], v[132:135], v[84:87], v[48:51]
  buffer_load_dwordx4 v9, s[12:15], s68 offen lds
  v_mfma_f32_16x16x32_bf16 v[48:51], a[248:251], v[88:91], v[48:51]
  s_waitcnt vmcnt(7) lgkmcnt(2)
  s_barrier
  v_mfma_f32_16x16x32_bf16 v[68:71], a[248:251], v[96:99], v[68:71]
  ds_read_b128 v[76:79], v1 offset:32768
  s_add_u32 m0, s45, 110592
  s_add_u32 s68, s68, 196608
  v_mfma_f32_16x16x32_bf16 v[68:71], v[132:135], v[92:95], v[68:71]
  buffer_load_dwordx4 v9, s[12:15], s68 offen lds
  v_mfma_f32_16x16x32_bf16 v[60:63], v[128:131], v[92:95], v[60:63]
  ds_read_b128 v[80:83], v1 offset:33792
  v_mfma_f32_16x16x32_bf16 v[60:63], a[244:247], v[96:99], v[60:63]
  s_waitcnt lgkmcnt(2)
  v_mfma_f32_16x16x32_bf16 v[28:31], v[136:139], v[100:103], v[28:31]
  s_add_u32 m0, s70, 49152
  s_add_u32 s69, s58, 98304
  v_mfma_f32_16x16x32_bf16 v[28:31], v[148:151], v[104:107], v[28:31]
  ds_read_b128 v[84:87], v1 offset:40960
  v_mfma_f32_16x16x32_bf16 v[32:35], v[148:151], v[108:111], v[32:35]
  buffer_load_dwordx4 v12, s[8:11], s69 offen offset:0 sc1 lds
  v_mfma_f32_16x16x32_bf16 v[32:35], v[136:139], v[112:115], v[32:35]
  v_mfma_f32_16x16x32_bf16 v[40:43], v[140:143], v[112:115], v[40:43]
  ds_read_b128 v[88:91], v1 offset:41984
  v_mfma_f32_16x16x32_bf16 v[40:43], v[152:155], v[108:111], v[40:43]
  buffer_load_dwordx4 v12, s[8:11], s69 offen offset:1024 sc1 lds
  v_mfma_f32_16x16x32_bf16 v[36:39], v[152:155], v[104:107], v[36:39]
  ds_read_b128 v[92:95], v13 offset:24576
  v_mfma_f32_16x16x32_bf16 v[36:39], v[140:143], v[100:103], v[36:39]
  v_mfma_f32_16x16x32_bf16 v[44:47], v[144:147], v[100:103], v[44:47]
  v_mfma_f32_16x16x32_bf16 v[44:47], v[156:159], v[104:107], v[44:47]
  ds_read_b128 v[96:99], v13 offset:25600
  v_mfma_f32_16x16x32_bf16 v[48:51], v[156:159], v[108:111], v[48:51]
  buffer_load_dwordx4 v12, s[8:11], s69 offen offset:2048 sc1 lds
  v_mfma_f32_16x16x32_bf16 v[48:51], v[144:147], v[112:115], v[48:51]
  s_waitcnt vmcnt(3)
  s_barrier
  v_mfma_f32_16x16x32_bf16 v[68:71], v[144:147], v[120:123], v[68:71]
  ds_read_b128 v[100:103], v1 offset:34816
  v_mfma_f32_16x16x32_bf16 v[68:71], v[156:159], v[116:119], v[68:71]
  ds_read_b64_tr_b16 v[212:213], v7 offset:16384
  buffer_load_dwordx4 v12, s[8:11], s69 offen offset:3072 sc1 lds
  v_mfma_f32_16x16x32_bf16 v[60:63], v[152:155], v[116:119], v[60:63]
  ds_read_b128 v[104:107], v1 offset:35840
  v_mfma_f32_16x16x32_bf16 v[60:63], v[140:143], v[120:123], v[60:63]
  s_waitcnt lgkmcnt(3)
  ds_read_b64_tr_b16 v[214:215], v7 offset:18432
  v_mfma_f32_16x16x32_bf16 v[28:31], v[160:163], v[76:79], v[28:31]
  ds_read_b64_tr_b16 v[216:217], v8 offset:16384
  s_add_u32 m0, s70, 114688
  s_add_u32 s69, s59, 98304
  v_mfma_f32_16x16x32_bf16 v[28:31], v[172:175], v[80:83], v[28:31]
  ds_read_b128 v[108:111], v1 offset:43008
  buffer_load_dwordx4 v12, s[8:11], s69 offen offset:0 sc1 lds
  v_mfma_f32_16x16x32_bf16 v[32:35], v[172:175], v[88:91], v[32:35]
  ds_read_b64_tr_b16 v[218:219], v8 offset:18432
  v_mfma_f32_16x16x32_bf16 v[32:35], v[160:163], v[84:87], v[32:35]
  ds_read_b64_tr_b16 v[224:225], v7 offset:20480
  v_mfma_f32_16x16x32_bf16 v[40:43], v[164:167], v[84:87], v[40:43]
  ds_read_b128 v[112:115], v1 offset:44032
  v_mfma_f32_16x16x32_bf16 v[40:43], v[176:179], v[88:91], v[40:43]
  ds_read_b64_tr_b16 v[226:227], v7 offset:22528
  buffer_load_dwordx4 v12, s[8:11], s69 offen offset:1024 sc1 lds
  v_mfma_f32_16x16x32_bf16 v[36:39], v[176:179], v[80:83], v[36:39]
  ds_read_b128 v[116:119], v13 offset:26624
  v_mfma_f32_16x16x32_bf16 v[36:39], v[164:167], v[76:79], v[36:39]
  ds_read_b64_tr_b16 v[228:229], v8 offset:20480
  v_mfma_f32_16x16x32_bf16 v[44:47], v[168:171], v[76:79], v[44:47]
  ds_read_b64_tr_b16 v[230:231], v8 offset:22528
  v_mfma_f32_16x16x32_bf16 v[44:47], v[180:183], v[80:83], v[44:47]
  ds_read_b128 v[120:123], v13 offset:27648
  buffer_load_dwordx4 v12, s[8:11], s69 offen offset:2048 sc1 lds
  v_mfma_f32_16x16x32_bf16 v[48:51], v[180:183], v[88:91], v[48:51]
  ds_read_b64_tr_b16 v[236:237], v7 offset:24576
  v_mfma_f32_16x16x32_bf16 v[48:51], v[168:171], v[84:87], v[48:51]
  ds_read_b64_tr_b16 v[238:239], v7 offset:26624
  v_mfma_f32_16x16x32_bf16 v[68:71], v[168:171], v[92:95], v[68:71]
  ds_read_b128 v[76:79], v1 offset:36864
  v_mfma_f32_16x16x32_bf16 v[68:71], v[180:183], v[96:99], v[68:71]
  ds_read_b64_tr_b16 v[240:241], v8 offset:24576
  buffer_load_dwordx4 v12, s[8:11], s69 offen offset:3072 sc1 lds
  v_mfma_f32_16x16x32_bf16 v[60:63], v[176:179], v[96:99], v[60:63]
  ds_read_b128 v[80:83], v1 offset:37888
  v_mfma_f32_16x16x32_bf16 v[60:63], v[164:167], v[92:95], v[60:63]
  s_waitcnt lgkmcnt(5)
  ds_read_b64_tr_b16 v[242:243], v8 offset:26624
  v_mfma_f32_16x16x32_bf16 v[28:31], v[184:187], v[100:103], v[28:31]
  ds_read_b64_tr_b16 v[248:249], v7 offset:28672
  s_add_u32 m0, s70, 0
  s_add_u32 s69, s60, 98304
  v_mfma_f32_16x16x32_bf16 v[28:31], v[196:199], v[104:107], v[28:31]
  ds_read_b128 v[88:91], v1 offset:45056
  buffer_load_dwordx4 v12, s[8:11], s69 offen offset:0 sc1 lds
  v_mfma_f32_16x16x32_bf16 v[32:35], v[196:199], v[112:115], v[32:35]
  ds_read_b64_tr_b16 v[250:251], v7 offset:30720
  v_mfma_f32_16x16x32_bf16 v[32:35], v[184:187], v[108:111], v[32:35]
  ds_read_b64_tr_b16 v[252:253], v8 offset:28672
  v_mfma_f32_16x16x32_bf16 v[40:43], v[188:191], v[108:111], v[40:43]
  ds_read_b128 v[84:87], v1 offset:46080
  v_mfma_f32_16x16x32_bf16 v[40:43], v[200:203], v[112:115], v[40:43]
  ds_read_b64_tr_b16 v[254:255], v8 offset:30720
  buffer_load_dwordx4 v12, s[8:11], s69 offen offset:1024 sc1 lds
  v_mfma_f32_16x16x32_bf16 v[36:39], v[200:203], v[104:107], v[36:39]
  ds_read_b128 v[96:99], v13 offset:28672
  v_mfma_f32_16x16x32_bf16 v[36:39], v[188:191], v[100:103], v[36:39]
  v_mfma_f32_16x16x32_bf16 v[44:47], v[192:195], v[100:103], v[44:47]
  v_mfma_f32_16x16x32_bf16 v[44:47], v[204:207], v[104:107], v[44:47]
  ds_read_b128 v[92:95], v13 offset:29696
  v_mfma_f32_16x16x32_bf16 v[48:51], v[204:207], v[112:115], v[48:51]
  buffer_load_dwordx4 v12, s[8:11], s69 offen offset:2048 sc1 lds
  v_mfma_f32_16x16x32_bf16 v[48:51], v[192:195], v[108:111], v[48:51]
  v_mfma_f32_16x16x32_bf16 v[68:71], v[192:195], v[116:119], v[68:71]
  ds_read_b128 v[100:103], v1 offset:38912
  s_mov_b32 s30, 7340032
  v_mfma_f32_16x16x32_bf16 v[68:71], v[204:207], v[120:123], v[68:71]
  buffer_load_dwordx4 v12, s[8:11], s69 offen offset:3072 sc1 lds
  s_mov_b32 s31, 131072
  s_mov_b32 s34, 7340032
  v_mfma_f32_16x16x32_bf16 v[60:63], v[200:203], v[120:123], v[60:63]
  ds_read_b128 v[104:107], v1 offset:39936
  s_mov_b32 s35, 131072
  v_mfma_f32_16x16x32_bf16 v[60:63], v[188:191], v[116:119], v[60:63]
  s_waitcnt lgkmcnt(2)
  s_mov_b32 s38, 7340032
  s_mov_b32 s39, 131072
  v_mfma_f32_16x16x32_bf16 v[28:31], v[208:211], v[76:79], v[28:31]
  s_add_u32 m0, s45, 16384
  s_mov_b32 s68, 0
  v_mfma_f32_16x16x32_bf16 v[28:31], v[220:223], v[80:83], v[28:31]
  ds_read_b128 v[112:115], v1 offset:47104
  s_mov_b32 s42, 4194304
  v_mfma_f32_16x16x32_bf16 v[32:35], v[220:223], v[84:87], v[32:35]
  buffer_load_dwordx4 v11, s[20:23], s68 offen nt lds
  s_mov_b32 s43, 131072
  v_add_u32 v9, s78, v1
  v_mfma_f32_16x16x32_bf16 v[32:35], v[208:211], v[88:91], v[32:35]
  s_add_u32 m0, s45, 20480
  s_add_u32 s68, s68, 393216
  v_and_b32 v4, 0xffffbfff, v4
  v_mfma_f32_16x16x32_bf16 v[40:43], v[212:215], v[88:91], v[40:43]
  ds_read_b128 v[108:111], v1 offset:48128
  v_and_b32 v5, 0xffffbfff, v5
  v_mfma_f32_16x16x32_bf16 v[40:43], v[224:227], v[84:87], v[40:43]
  buffer_load_dwordx4 v11, s[20:23], s68 offen nt lds
  v_and_b32 v7, 0xffffbfff, v7
  v_and_b32 v8, 0xffffbfff, v8
  v_mfma_f32_16x16x32_bf16 v[36:39], v[224:227], v[80:83], v[36:39]
  ds_read_b128 v[120:123], v13 offset:30720
  s_lshl_b32 s52, s44, 13
  v_mfma_f32_16x16x32_bf16 v[36:39], v[212:215], v[76:79], v[36:39]
  s_and_b32 s52, s52, 8192
  v_add_u32 v22, s52, v1
  v_add_u32 v23, s52, v2
  v_mfma_f32_16x16x32_bf16 v[44:47], v[216:219], v[76:79], v[44:47]
  s_add_u32 m0, s45, 24576
  s_add_u32 s68, s68, 393216
  v_and_b32 v14, 15, v0
  v_mfma_f32_16x16x32_bf16 v[44:47], v[228:231], v[80:83], v[44:47]
  ds_read_b128 v[116:119], v13 offset:31744
  v_lshlrev_b32 v14, 7, v14
  v_mfma_f32_16x16x32_bf16 v[48:51], v[228:231], v[84:87], v[48:51]
  buffer_load_dwordx4 v11, s[20:23], s68 offen nt lds
  s_lshl_b32 s52, s50, 4
  s_add_u32 s52, s52, s51
  v_mfma_f32_16x16x32_bf16 v[48:51], v[216:219], v[88:91], v[48:51]
  s_lshl_b32 s72, s52, 12
  s_waitcnt vmcnt(11) lgkmcnt(8)
  s_barrier
  v_mfma_f32_16x16x32_bf16 v[68:71], v[216:219], v[96:99], v[68:71]
  ds_read_b128 v[76:79], v1 offset:49152
  s_add_u32 m0, s45, 28672
  s_add_u32 s68, s68, 393216
  v_mfma_f32_16x16x32_bf16 v[68:71], v[228:231], v[92:95], v[68:71]
  buffer_load_dwordx4 v11, s[20:23], s68 offen nt lds
  s_add_u32 s72, s72, s45
  s_add_u32 s72, s72, 5242880
  v_mfma_f32_16x16x32_bf16 v[60:63], v[224:227], v[92:95], v[60:63]
  s_add_u32 s52, s52, 16
  s_and_b32 s52, s52, 255
  s_lshl_b32 s50, s52, 12
  v_mfma_f32_16x16x32_bf16 v[60:63], v[212:215], v[96:99], v[60:63]
  s_waitcnt lgkmcnt(1)
  ds_read_b128 v[80:83], v1 offset:50176
  v_mfma_f32_16x16x32_bf16 v[28:31], v[232:235], v[100:103], v[28:31]
  s_add_u32 s50, s50, s45
  s_add_u32 s50, s50, 5242880
  s_lshl_b32 s52, s52, 7
  v_mfma_f32_16x16x32_bf16 v[28:31], v[244:247], v[104:107], v[28:31]
  s_add_u32 s52, s52, 688128
  s_sub_u32 s52, s52, s77
  s_sub_u32 s77, s77, 32768
  v_mfma_f32_16x16x32_bf16 v[32:35], v[244:247], v[108:111], v[32:35]
  ds_read_b128 v[84:87], v1 offset:57344
  v_add_u32 v14, 32768, v14
  v_mfma_f32_16x16x32_bf16 v[32:35], v[232:235], v[112:115], v[32:35]
  v_writelane_b32 v14, s52, 16
  s_lshr_b32 s52, s44, 1
  v_mfma_f32_16x16x32_bf16 v[40:43], v[236:239], v[112:115], v[40:43]
  s_lshl_b32 s52, s52, 10
  s_add_u32 s51, s52, s45
  s_add_u32 s51, s51, 150528
  v_mfma_f32_16x16x32_bf16 v[40:43], v[248:251], v[108:111], v[40:43]
  ds_read_b128 v[88:91], v1 offset:58368
  v_mfma_f32_16x16x32_bf16 v[36:39], v[248:251], v[104:107], v[36:39]
  v_mfma_f32_16x16x32_bf16 v[36:39], v[236:239], v[100:103], v[36:39]
  v_mfma_f32_16x16x32_bf16 v[44:47], v[240:243], v[100:103], v[44:47]
  ds_read_b128 v[92:95], v1 offset:51200
  v_mfma_f32_16x16x32_bf16 v[44:47], v[252:255], v[104:107], v[44:47]
HOP2:
  s_cbranch_execz HOP6
  v_mfma_f32_16x16x32_bf16 v[48:51], v[252:255], v[108:111], v[48:51]
  v_mfma_f32_16x16x32_bf16 v[48:51], v[240:243], v[112:115], v[48:51]
  ds_read_b128 v[96:99], v1 offset:52224
  v_mfma_f32_16x16x32_bf16 v[68:71], v[240:243], v[120:123], v[68:71]
  v_mfma_f32_16x16x32_bf16 v[68:71], v[252:255], v[116:119], v[68:71]
  v_mfma_f32_16x16x32_bf16 v[60:63], v[248:251], v[116:119], v[60:63]
  ds_read_b128 v[100:103], v1 offset:59392
  v_mfma_f32_16x16x32_bf16 v[60:63], v[236:239], v[120:123], v[60:63]
  s_waitcnt lgkmcnt(3)
  v_mfma_f32_16x16x32_bf16 v[52:55], a[0:3], v[76:79], 0
  v_mfma_f32_16x16x32_bf16 v[52:55], a[12:15], v[80:83], v[52:55]
  ds_read_b128 v[104:107], v1 offset:60416
  v_mfma_f32_16x16x32_bf16 v[56:59], a[12:15], v[88:91], 0
  s_nop 2
  v_cvt_pk_bf16_f32 v60, v60, v61
  v_cvt_pk_bf16_f32 v61, v62, v63
  v_cvt_pk_bf16_f32 v62, v68, v69
  v_cvt_pk_bf16_f32 v63, v70, v71
  ds_write_b128 v17, v[60:63] offset:1024
  v_mfma_f32_16x16x32_bf16 v[56:59], a[0:3], v[84:87], v[56:59]
  buffer_store_dwordx4 v[60:63], v1, s[8:11], s72 offen sc1
  v_mfma_f32_16x16x32_bf16 v[64:67], a[4:7], v[84:87], 0
  ds_read_b128 v[108:111], v1 offset:53248
  v_cvt_pk_bf16_f32 v28, v28, v29
  v_mfma_f32_16x16x32_bf16 v[64:67], a[16:19], v[88:91], v[64:67]
  v_cvt_pk_bf16_f32 v29, v30, v31
  v_mfma_f32_16x16x32_bf16 v[60:63], a[16:19], v[80:83], 0
  ds_write_b64 v18, v[28:29] offset:6144
  v_mfma_f32_16x16x32_bf16 v[60:63], a[4:7], v[76:79], v[60:63]
  ds_read_b128 v[112:115], v1 offset:54272
  v_cvt_pk_bf16_f32 v36, v36, v37
  v_mfma_f32_16x16x32_bf16 v[68:71], a[8:11], v[76:79], 0
  v_cvt_pk_bf16_f32 v37, v38, v39
  v_cvt_pk_bf16_f32 v38, v44, v45
  v_mfma_f32_16x16x32_bf16 v[68:71], a[20:23], v[80:83], v[68:71]
  v_cvt_pk_bf16_f32 v39, v46, v47
  v_mfma_f32_16x16x32_bf16 v[72:75], a[20:23], v[88:91], 0
  ds_read_b128 v[76:79], v1 offset:61440
  v_mfma_f32_16x16x32_bf16 v[72:75], a[8:11], v[84:87], v[72:75]
  s_waitcnt lgkmcnt(5)
  ds_write_b128 v17, v[36:39] offset:7168
  v_mfma_f32_16x16x32_bf16 v[52:55], a[24:27], v[92:95], v[52:55]
  s_add_u32 m0, s70, 65536
  s_add_u32 s69, s61, 98304
  v_cvt_pk_bf16_f32 v32, v32, v33
  v_mfma_f32_16x16x32_bf16 v[52:55], a[36:39], v[96:99], v[52:55]
  ds_read_b128 v[80:83], v1 offset:62464
  v_cvt_pk_bf16_f32 v33, v34, v35
  v_mfma_f32_16x16x32_bf16 v[56:59], a[36:39], v[104:107], v[56:59]
  buffer_load_dwordx4 v12, s[8:11], s69 offen offset:0 sc1 lds
  ds_write_b64 v18, v[32:33] offset:12288
  v_mfma_f32_16x16x32_bf16 v[56:59], a[24:27], v[100:103], v[56:59]
  v_cvt_pk_bf16_f32 v40, v40, v41
  v_cvt_pk_bf16_f32 v41, v42, v43
  v_mfma_f32_16x16x32_bf16 v[64:67], a[28:31], v[100:103], v[64:67]
  ds_read_b128 v[88:91], v1 offset:55296
  v_cvt_pk_bf16_f32 v42, v48, v49
  v_mfma_f32_16x16x32_bf16 v[64:67], a[40:43], v[104:107], v[64:67]
  v_cvt_pk_bf16_f32 v43, v50, v51
  v_mfma_f32_16x16x32_bf16 v[60:63], a[40:43], v[96:99], v[60:63]
  buffer_load_dwordx4 v12, s[8:11], s69 offen offset:1024 sc1 lds
  ds_write_b128 v17, v[40:43] offset:13312
  v_mfma_f32_16x16x32_bf16 v[60:63], a[28:31], v[92:95], v[60:63]
  ds_read_b128 v[84:87], v1 offset:56320
  v_mfma_f32_16x16x32_bf16 v[68:71], a[32:35], v[92:95], v[68:71]
  s_bitcmp1_b32 s44, 0
  s_mov_b32 s52, 6144
  s_cselect_b32 s52, 12288, s52
  s_mov_b32 s53, 0
  s_cselect_b32 s53, 6144, s53
  v_mfma_f32_16x16x32_bf16 v[68:71], a[44:47], v[96:99], v[68:71]
  v_add_u32 v116, s52, v19
  v_add_u32 v117, s53, v19
  v_mfma_f32_16x16x32_bf16 v[72:75], a[44:47], v[104:107], v[72:75]
  ds_read_b128 v[92:95], v1 offset:63488
  v_add_u32 v118, s52, v20
  v_mfma_f32_16x16x32_bf16 v[72:75], a[32:35], v[100:103], v[72:75]
  s_waitcnt lgkmcnt(5)
  buffer_load_dwordx4 v12, s[8:11], s69 offen offset:2048 sc1 lds
  v_add_u32 v119, s53, v20
  v_mfma_f32_16x16x32_bf16 v[52:55], a[48:51], v[108:111], v[52:55]
  s_waitcnt vmcnt(12) lgkmcnt(2)
  s_barrier
  v_mfma_f32_16x16x32_bf16 v[52:55], a[60:63], v[112:115], v[52:55]
  ds_read_b128 v[96:99], v1 offset:64512
  ds_write_b16 v21, v16
  v_mfma_f32_16x16x32_bf16 v[56:59], a[60:63], v[80:83], v[56:59]
  ds_read_b128 v[28:31], v116
  v_mfma_f32_16x16x32_bf16 v[56:59], a[48:51], v[76:79], v[56:59]
  ds_read_b128 v[32:35], v117 offset:1024
  v_mfma_f32_16x16x32_bf16 v[64:67], a[52:55], v[76:79], v[64:67]
  ds_read_b128 v[104:107], v2 offset:49152
  v_mfma_f32_16x16x32_bf16 v[64:67], a[64:67], v[80:83], v[64:67]
  buffer_load_dwordx4 v12, s[8:11], s69 offen offset:3072 sc1 lds
  ds_read_b128 v[36:39], v116 offset:1024
  v_mfma_f32_16x16x32_bf16 v[60:63], a[64:67], v[112:115], v[60:63]
  ds_read_b64_tr_b16 v[40:41], v119 offset:2048
  v_mfma_f32_16x16x32_bf16 v[60:63], a[52:55], v[108:111], v[60:63]
  ds_read_b128 v[100:103], v2 offset:50176
  v_mfma_f32_16x16x32_bf16 v[68:71], a[56:59], v[108:111], v[68:71]
  s_add_u32 m0, s70, 98304
  s_add_u32 s69, s58, 163840
  v_mfma_f32_16x16x32_bf16 v[68:71], a[68:71], v[112:115], v[68:71]
  buffer_load_dwordx4 v12, s[8:11], s69 offen offset:0 sc1 lds
  ds_read_b64_tr_b16 v[42:43], v118 offset:2048
  v_mfma_f32_16x16x32_bf16 v[72:75], a[68:71], v[80:83], v[72:75]
  ds_read_b128 v[108:111], v2 offset:57344
  v_mfma_f32_16x16x32_bf16 v[72:75], a[56:59], v[76:79], v[72:75]
  s_waitcnt lgkmcnt(9)
  ds_read_b64_tr_b16 v[44:45], v119 offset:2056
  v_mfma_f32_16x16x32_bf16 v[52:55], a[72:75], v[88:91], v[52:55]
  ds_read_b64_tr_b16 v[46:47], v118 offset:2056
  v_mfma_f32_16x16x32_bf16 v[52:55], a[84:87], v[84:87], v[52:55]
  ds_read_b128 v[112:115], v2 offset:58368
  v_mfma_f32_16x16x32_bf16 v[56:59], a[84:87], v[96:99], v[56:59]
  buffer_load_dwordx4 v12, s[8:11], s69 offen offset:1024 sc1 lds
  v_mfma_f32_16x16x32_bf16 v[56:59], a[72:75], v[92:95], v[56:59]
  v_mfma_f32_16x16x32_bf16 v[64:67], a[76:79], v[92:95], v[64:67]
  ds_read_b128 v[80:83], v2 offset:51200
  v_mfma_f32_16x16x32_bf16 v[64:67], a[88:91], v[96:99], v[64:67]
  s_waitcnt lgkmcnt(2)
  v_mfma_f32_16x16x32_bf16 v[116:119], v[32:35], v[28:31], 0
  v_mfma_f32_16x16x32_bf16 v[120:123], v[36:39], v[28:31], 0
  v_mfma_f32_16x16x32_bf16 v[60:63], a[88:91], v[84:87], v[60:63]
  v_mfma_f32_16x16x32_bf16 v[60:63], a[76:79], v[88:91], v[60:63]
  ds_read_b128 v[76:79], v2 offset:52224
  v_mfma_f32_16x16x32_bf16 v[68:71], a[80:83], v[88:91], v[68:71]
  buffer_load_dwordx4 v12, s[8:11], s69 offen offset:2048 sc1 lds
  v_mfma_f32_16x16x32_bf16 v[68:71], a[92:95], v[84:87], v[68:71]
  s_nop 1
  v_cndmask_b32 v48, v116, v120, s[80:81]
  v_cndmask_b32 v49, v117, v121, s[82:83]
  v_mfma_f32_16x16x32_bf16 v[72:75], a[92:95], v[96:99], v[72:75]
  ds_read_b128 v[88:91], v2 offset:59392
  v_cndmask_b32 v50, v118, v122, s[84:85]
  v_mfma_f32_16x16x32_bf16 v[72:75], a[80:83], v[92:95], v[72:75]
  s_waitcnt lgkmcnt(3)
  v_cndmask_b32 v51, v119, v123, s[86:87]
  v_cndmask_b32 v48, v48, v49, s[88:89]
  v_mfma_f32_16x16x32_bf16 v[52:55], a[96:99], v[104:107], v[52:55]
  buffer_load_dwordx4 v12, s[8:11], s69 offen offset:3072 sc1 lds
  v_cndmask_b32 v49, v50, v51, s[88:89]
  v_mul_f32 v48, 0x3e8293ee, v48
  v_mfma_f32_16x16x32_bf16 v[52:55], a[108:111], v[100:103], v[52:55]
  ds_read_b128 v[84:87], v2 offset:60416
  v_mul_f32 v49, 0x3e8293ee, v49
  v_mfma_f32_16x16x32_bf16 v[56:59], a[108:111], v[112:115], v[56:59]
  v_mov_b32 v50, 0xce6e6b28
  v_cndmask_b32 v48, v48, v50, s[90:91]
  v_mfma_f32_16x16x32_bf16 v[56:59], a[96:99], v[108:111], v[56:59]
  s_add_u32 m0, s45, 81920
  s_mov_b32 s68, 1572864
  v_mfma_f32_16x16x32_bf16 v[64:67], a[100:103], v[108:111], v[64:67]
  ds_read_b128 v[96:99], v2 offset:53248
  v_cndmask_b32 v49, v49, v50, s[92:93]
  v_mfma_f32_16x16x32_bf16 v[64:67], a[112:115], v[112:115], v[64:67]
  buffer_load_dwordx4 v11, s[20:23], s68 offen nt lds
  v_max_f32 v50, v48, v49
  v_mov_b32 v51, v50
  v_mfma_f32_16x16x32_bf16 v[60:63], a[112:115], v[100:103], v[60:63]
  s_nop 0
  v_permlane16_swap_b32 v50, v51
  v_mfma_f32_16x16x32_bf16 v[60:63], a[100:103], v[104:107], v[60:63]
  ds_read_b128 v[92:95], v2 offset:54272
  v_max_f32 v50, v50, v51
  v_mfma_f32_16x16x32_bf16 v[68:71], a[104:107], v[104:107], v[68:71]
  v_mov_b32 v51, v50
  v_mfma_f32_16x16x32_bf16 v[68:71], a[116:119], v[100:103], v[68:71]
  s_add_u32 m0, s45, 86016
  s_add_u32 s68, s68, 393216
  v_mfma_f32_16x16x32_bf16 v[72:75], a[116:119], v[112:115], v[72:75]
  ds_read_b128 v[104:107], v2 offset:61440
  v_mfma_f32_16x16x32_bf16 v[72:75], a[104:107], v[108:111], v[72:75]
  s_waitcnt lgkmcnt(3)
  buffer_load_dwordx4 v11, s[20:23], s68 offen nt lds
  v_mfma_f32_16x16x32_bf16 v[52:55], a[120:123], v[80:83], v[52:55]
  v_permlane32_swap_b32 v50, v51
  v_mfma_f32_16x16x32_bf16 v[52:55], a[132:135], v[76:79], v[52:55]
  ds_read_b128 v[100:103], v2 offset:62464
  v_max_f32 v50, v50, v51
  v_mfma_f32_16x16x32_bf16 v[56:59], a[132:135], v[84:87], v[56:59]
  s_add_u32 m0, s45, 90112
  s_add_u32 s68, s68, 393216
  v_sub_f32 v48, v48, v50
  v_mfma_f32_16x16x32_bf16 v[56:59], a[120:123], v[88:91], v[56:59]
  buffer_load_dwordx4 v11, s[20:23], s68 offen nt lds
  v_sub_f32 v49, v49, v50
  v_mfma_f32_16x16x32_bf16 v[64:67], a[124:127], v[88:91], v[64:67]
  ds_read_b128 v[112:115], v2 offset:55296
  v_mfma_f32_16x16x32_bf16 v[64:67], a[136:139], v[84:87], v[64:67]
  v_exp_f32 v48, v48
  v_mfma_f32_16x16x32_bf16 v[60:63], a[136:139], v[76:79], v[60:63]
  s_add_u32 m0, s45, 94208
  s_add_u32 s68, s68, 393216
  v_mfma_f32_16x16x32_bf16 v[60:63], a[124:127], v[80:83], v[60:63]
  ds_read_b128 v[108:111], v2 offset:56320
  v_mfma_f32_16x16x32_bf16 v[68:71], a[128:131], v[80:83], v[68:71]
  buffer_load_dwordx4 v11, s[20:23], s68 offen nt lds
  v_exp_f32 v49, v49
  v_mfma_f32_16x16x32_bf16 v[68:71], a[140:143], v[76:79], v[68:71]
  v_add_f32 v50, v48, v49
  v_mov_b32 v51, v50
  v_mfma_f32_16x16x32_bf16 v[72:75], a[140:143], v[84:87], v[72:75]
  ds_read_b128 v[80:83], v2 offset:63488
  v_mfma_f32_16x16x32_bf16 v[72:75], a[128:131], v[88:91], v[72:75]
  s_waitcnt lgkmcnt(3)
  v_permlane16_swap_b32 v50, v51
  v_mfma_f32_16x16x32_bf16 v[52:55], a[144:147], v[96:99], v[52:55]
  v_add_f32 v50, v50, v51
  v_mov_b32 v51, v50
  v_mfma_f32_16x16x32_bf16 v[52:55], a[156:159], v[92:95], v[52:55]
  ds_read_b128 v[76:79], v2 offset:64512
  v_mfma_f32_16x16x32_bf16 v[56:59], a[156:159], v[100:103], v[56:59]
  v_permlane32_swap_b32 v50, v51
  v_mfma_f32_16x16x32_bf16 v[56:59], a[144:147], v[104:107], v[56:59]
  s_waitcnt vmcnt(8) lgkmcnt(15)
  s_barrier
  v_mfma_f32_16x16x32_bf16 v[64:67], a[148:151], v[104:107], v[64:67]
  ds_read_b128 v[84:87], v1 offset:0
  v_add_f32 v50, v50, v51
  v_mfma_f32_16x16x32_bf16 v[64:67], a[160:163], v[100:103], v[64:67]
  v_rcp_f32 v50, v50
  v_mfma_f32_16x16x32_bf16 v[60:63], a[160:163], v[92:95], v[60:63]
  v_mul_f32 v48, v48, v50
  v_mul_f32 v49, v49, v50
  v_mfma_f32_16x16x32_bf16 v[60:63], a[148:151], v[96:99], v[60:63]
  ds_read_b128 v[88:91], v1 offset:1024
  v_cvt_pk_bf16_f32 v48, v48, v48
  v_mfma_f32_16x16x32_bf16 v[68:71], a[152:155], v[96:99], v[68:71]
  v_cvt_pk_bf16_f32 v49, v49, v49
  v_and_b32 v28, v24, v48
  v_mfma_f32_16x16x32_bf16 v[68:71], a[164:167], v[92:95], v[68:71]
  v_and_b32 v29, v25, v49
  v_and_b32 v30, v26, v48
  v_mfma_f32_16x16x32_bf16 v[72:75], a[164:167], v[100:103], v[72:75]
  ds_read_b128 v[96:99], v1 offset:8192
  v_and_b32 v31, v27, v49
  v_mfma_f32_16x16x32_bf16 v[72:75], a[152:155], v[104:107], v[72:75]
  s_waitcnt lgkmcnt(3)
  v_mfma_f32_16x16x32_bf16 v[32:35], v[40:43], v[28:31], 0
  v_mfma_f32_16x16x32_bf16 v[36:39], v[44:47], v[28:31], 0
  v_mfma_f32_16x16x32_bf16 v[52:55], a[168:171], v[112:115], v[52:55]
  v_mfma_f32_16x16x32_bf16 v[52:55], a[180:183], v[108:111], v[52:55]
  ds_read_b128 v[92:95], v1 offset:9216
  v_mfma_f32_16x16x32_bf16 v[56:59], a[180:183], v[76:79], v[56:59]
  v_mfma_f32_16x16x32_bf16 v[56:59], a[168:171], v[80:83], v[56:59]
  s_nop 1
  v_cvt_pk_bf16_f32 v116, v32, v33
  v_cvt_pk_bf16_f32 v117, v34, v35
  v_mfma_f32_16x16x32_bf16 v[64:67], a[172:175], v[80:83], v[64:67]
  ds_read_b128 v[100:103], v1 offset:2048
  v_cvt_pk_bf16_f32 v118, v36, v37
  v_mfma_f32_16x16x32_bf16 v[64:67], a[184:187], v[76:79], v[64:67]
  v_cvt_pk_bf16_f32 v119, v38, v39
  v_mfma_f32_16x16x32_bf16 v[60:63], a[184:187], v[108:111], v[60:63]
  buffer_store_dwordx4 v[116:119], v1, s[8:11], s73 offen sc1
  v_mfma_f32_16x16x32_bf16 v[60:63], a[172:175], v[112:115], v[60:63]
  ds_read_b128 v[104:107], v1 offset:3072
  s_add_u32 s73, s73, 65536
  v_mfma_f32_16x16x32_bf16 v[68:71], a[176:179], v[112:115], v[68:71]
  v_mfma_f32_16x16x32_bf16 v[68:71], a[188:191], v[108:111], v[68:71]
  v_mfma_f32_16x16x32_bf16 v[72:75], a[188:191], v[76:79], v[72:75]
  ds_read_b128 v[112:115], v1 offset:10240
  v_mfma_f32_16x16x32_bf16 v[72:75], a[176:179], v[80:83], v[72:75]
  s_waitcnt lgkmcnt(3)
  v_mfma_f32_16x16x32_bf16 v[52:55], a[192:195], v[84:87], v[52:55]
  v_mfma_f32_16x16x32_bf16 v[52:55], a[204:207], v[88:91], v[52:55]
  ds_read_b128 v[108:111], v1 offset:11264
  v_mfma_f32_16x16x32_bf16 v[56:59], a[204:207], v[92:95], v[56:59]
  v_mfma_f32_16x16x32_bf16 v[56:59], a[192:195], v[96:99], v[56:59]
  v_mfma_f32_16x16x32_bf16 v[64:67], a[196:199], v[96:99], v[64:67]
  ds_read_b128 v[76:79], v1 offset:4096
  v_lshrrev_b32 v40, 4, v0
  v_lshlrev_b32 v40, 4, v40
  v_mfma_f32_16x16x32_bf16 v[64:67], a[208:211], v[92:95], v[64:67]
  v_add_u32 v41, 160768, v40
  v_mfma_f32_16x16x32_bf16 v[60:63], a[208:211], v[88:91], v[60:63]
  ds_read_b64_tr_b16 v[116:117], v3 offset:16384
  v_mfma_f32_16x16x32_bf16 v[60:63], a[196:199], v[84:87], v[60:63]
  ds_read_b128 v[80:83], v1 offset:5120
  ds_read_b64_tr_b16 v[118:119], v3 offset:18432
  v_mfma_f32_16x16x32_bf16 v[68:71], a[200:203], v[84:87], v[68:71]
  ds_read_b128 v[28:31], v41 offset:0
  v_mfma_f32_16x16x32_bf16 v[68:71], a[212:215], v[88:91], v[68:71]
  v_mfma_f32_16x16x32_bf16 v[72:75], a[212:215], v[92:95], v[72:75]
  ds_read_b128 v[84:87], v1 offset:12288
  v_mfma_f32_16x16x32_bf16 v[72:75], a[200:203], v[96:99], v[72:75]
  s_waitcnt lgkmcnt(6)
  s_add_u32 m0, s70, 32768
  s_add_u32 s69, s59, 163840
  v_mfma_f32_16x16x32_bf16 v[52:55], a[216:219], v[100:103], v[52:55]
  buffer_load_dwordx4 v12, s[8:11], s69 offen offset:0 sc1 lds
  v_mfma_f32_16x16x32_bf16 v[52:55], a[228:231], v[104:107], v[52:55]
  ds_read_b128 v[88:91], v1 offset:13312
  v_mfma_f32_16x16x32_bf16 v[56:59], a[228:231], v[108:111], v[56:59]
  v_mfma_f32_16x16x32_bf16 v[56:59], a[216:219], v[112:115], v[56:59]
  v_mfma_f32_16x16x32_bf16 v[64:67], a[220:223], v[112:115], v[64:67]
  ds_read_b128 v[92:95], v1 offset:6144
  ds_read_b64_tr_b16 v[120:121], v3 offset:20480
  v_mfma_f32_16x16x32_bf16 v[64:67], a[232:235], v[108:111], v[64:67]
  ds_read_b64_tr_b16 v[122:123], v3 offset:22528
  s_waitcnt lgkmcnt(5)
  v_mfma_f32_16x16x32_bf16 v[36:39], v[116:119], v[28:31], 0
  v_mfma_f32_16x16x32_bf16 v[60:63], a[232:235], v[104:107], v[60:63]
  buffer_load_dwordx4 v12, s[8:11], s69 offen offset:1024 sc1 lds
  ds_read_b128 v[32:35], v41 offset:64
  v_mfma_f32_16x16x32_bf16 v[60:63], a[220:223], v[100:103], v[60:63]
  ds_read_b128 v[96:99], v1 offset:7168
  v_mfma_f32_16x16x32_bf16 v[68:71], a[224:227], v[100:103], v[68:71]
  v_mfma_f32_16x16x32_bf16 v[68:71], a[236:239], v[104:107], v[68:71]
  v_mfma_f32_16x16x32_bf16 v[72:75], a[236:239], v[108:111], v[72:75]
  ds_read_b128 v[100:103], v1 offset:14336
  v_mfma_f32_16x16x32_bf16 v[72:75], a[224:227], v[112:115], v[72:75]
  s_waitcnt lgkmcnt(6)
  buffer_load_dwordx4 v12, s[8:11], s69 offen offset:2048 sc1 lds
  v_mfma_f32_16x16x32_bf16 v[52:55], a[240:243], v[76:79], v[52:55]
  v_mfma_f32_16x16x32_bf16 v[52:55], v[124:127], v[80:83], v[52:55]
  ds_read_b128 v[104:107], v1 offset:15360
  v_mfma_f32_16x16x32_bf16 v[56:59], v[124:127], v[88:91], v[56:59]
  ds_read_b64_tr_b16 v[116:117], v3 offset:24576
  v_and_b32 v42, 15, v0
  v_mfma_f32_16x16x32_bf16 v[56:59], a[240:243], v[84:87], v[56:59]
  ds_read_b64_tr_b16 v[118:119], v3 offset:26624
  buffer_load_dwordx4 v12, s[8:11], s69 offen offset:3072 sc1 lds
  s_waitcnt lgkmcnt(5)
  v_mfma_f32_16x16x32_bf16 v[36:39], v[120:123], v[32:35], v[36:39]
  v_lshl_add_u32 v40, v42, 27, v40
  s_lshr_b32 s52, s2, 2
  v_mfma_f32_16x16x32_bf16 v[64:67], a[244:247], v[84:87], v[64:67]
  ds_read_b128 v[108:111], v2 offset:0
  ds_read_b128 v[28:31], v41 offset:128
  v_mfma_f32_16x16x32_bf16 v[64:67], v[128:131], v[88:91], v[64:67]
  s_lshl_b32 s54, s52, 7
  s_lshl_b32 s52, s52, 8
  s_and_b32 s53, s2, 3
  v_mfma_f32_16x16x32_bf16 v[60:63], v[128:131], v[80:83], v[60:63]
  s_add_u32 m0, s70, 49152
  s_add_u32 s69, s60, 163840
  s_mul_i32 s79, s53, 24576
  v_mfma_f32_16x16x32_bf16 v[60:63], a[244:247], v[76:79], v[60:63]
  ds_read_b128 v[112:115], v2 offset:1024
  s_add_u32 s52, s52, s79
  v_mfma_f32_16x16x32_bf16 v[68:71], a[248:251], v[76:79], v[68:71]
  buffer_load_dwordx4 v12, s[8:11], s69 offen offset:0 sc1 lds
  s_lshl_b32 s79, s44, 6
  s_add_u32 s52, s52, s79
  v_mfma_f32_16x16x32_bf16 v[68:71], v[132:135], v[80:83], v[68:71]
  s_add_u32 s52, s52, 8192
  s_lshl_b32 s53, s53, 2
  s_add_u32 s54, s54, s53
  v_mfma_f32_16x16x32_bf16 v[72:75], v[132:135], v[88:91], v[72:75]
  ds_read_b128 v[76:79], v2 offset:8192
  s_add_u32 s54, s54, 720896
  v_mfma_f32_16x16x32_bf16 v[72:75], a[248:251], v[84:87], v[72:75]
  s_waitcnt lgkmcnt(6)
  s_cmp_eq_u32 s44, 0
  s_cselect_b32 s79, s54, 1073741824
  v_mfma_f32_16x16x32_bf16 v[52:55], v[136:139], v[92:95], v[52:55]
  ds_read_b64_tr_b16 v[120:121], v3 offset:28672
  v_mfma_f32_16x16x32_bf16 v[52:55], v[148:151], v[96:99], v[52:55]
  ds_read_b128 v[80:83], v2 offset:9216
  ds_read_b64_tr_b16 v[122:123], v3 offset:30720
  s_waitcnt lgkmcnt(5)
  v_mfma_f32_16x16x32_bf16 v[36:39], v[116:119], v[28:31], v[36:39]
  v_mfma_f32_16x16x32_bf16 v[56:59], v[148:151], v[104:107], v[56:59]
  buffer_load_dwordx4 v12, s[8:11], s69 offen offset:1024 sc1 lds
  ds_read_b128 v[32:35], v41 offset:192
  v_mfma_f32_16x16x32_bf16 v[56:59], v[136:139], v[100:103], v[56:59]
  v_mfma_f32_16x16x32_bf16 v[64:67], v[140:143], v[100:103], v[64:67]
  ds_read_b128 v[88:91], v2 offset:2048
  v_mfma_f32_16x16x32_bf16 v[64:67], v[152:155], v[104:107], v[64:67]
  v_mfma_f32_16x16x32_bf16 v[60:63], v[152:155], v[96:99], v[60:63]
  buffer_load_dwordx4 v12, s[8:11], s69 offen offset:2048 sc1 lds
  v_mfma_f32_16x16x32_bf16 v[60:63], v[140:143], v[92:95], v[60:63]
  ds_read_b128 v[84:87], v2 offset:3072
  v_mfma_f32_16x16x32_bf16 v[68:71], v[144:147], v[92:95], v[68:71]
  v_mfma_f32_16x16x32_bf16 v[68:71], v[156:159], v[96:99], v[68:71]
  s_waitcnt vmcnt(8)
  s_barrier
  v_mfma_f32_16x16x32_bf16 v[72:75], v[156:159], v[104:107], v[72:75]
  ds_read_b128 v[92:95], v2 offset:10240
  ds_read_b64_tr_b16 v[116:117], v6 offset:16384
  v_mfma_f32_16x16x32_bf16 v[72:75], v[144:147], v[100:103], v[72:75]
  s_waitcnt lgkmcnt(6)
  ds_read_b64_tr_b16 v[118:119], v6 offset:18432
  s_waitcnt lgkmcnt(5)
  v_mfma_f32_16x16x32_bf16 v[36:39], v[120:123], v[32:35], v[36:39]
  v_mfma_f32_16x16x32_bf16 v[52:55], v[160:163], v[108:111], v[52:55]
  buffer_load_dwordx4 v12, s[8:11], s69 offen offset:3072 sc1 lds
  ds_read_b128 v[28:31], v41 offset:256
  v_mfma_f32_16x16x32_bf16 v[52:55], v[172:175], v[112:115], v[52:55]
  ds_read_b128 v[96:99], v2 offset:11264
  v_mfma_f32_16x16x32_bf16 v[56:59], v[172:175], v[80:83], v[56:59]
  v_mfma_f32_16x16x32_bf16 v[56:59], v[160:163], v[76:79], v[56:59]
  s_add_u32 m0, s70, 114688
  s_add_u32 s69, s61, 163840
  v_mfma_f32_16x16x32_bf16 v[64:67], v[164:167], v[76:79], v[64:67]
  ds_read_b128 v[104:107], v2 offset:4096
  v_mfma_f32_16x16x32_bf16 v[64:67], v[176:179], v[80:83], v[64:67]
  buffer_load_dwordx4 v12, s[8:11], s69 offen offset:0 sc1 lds
  v_mfma_f32_16x16x32_bf16 v[60:63], v[176:179], v[112:115], v[60:63]
  v_mfma_f32_16x16x32_bf16 v[60:63], v[164:167], v[108:111], v[60:63]
  ds_read_b128 v[100:103], v2 offset:5120
  v_mfma_f32_16x16x32_bf16 v[68:71], v[168:171], v[108:111], v[68:71]
  ds_read_b64_tr_b16 v[120:121], v6 offset:20480
  v_mfma_f32_16x16x32_bf16 v[68:71], v[180:183], v[112:115], v[68:71]
  ds_read_b64_tr_b16 v[122:123], v6 offset:22528
  buffer_load_dwordx4 v12, s[8:11], s69 offen offset:1024 sc1 lds
  s_waitcnt lgkmcnt(5)
  v_mfma_f32_16x16x32_bf16 v[36:39], v[116:119], v[28:31], v[36:39]
  v_mfma_f32_16x16x32_bf16 v[72:75], v[180:183], v[80:83], v[72:75]
  ds_read_b128 v[108:111], v2 offset:12288
  ds_read_b128 v[32:35], v41 offset:320
  v_mfma_f32_16x16x32_bf16 v[72:75], v[168:171], v[76:79], v[72:75]
  s_waitcnt lgkmcnt(6)
  v_mfma_f32_16x16x32_bf16 v[52:55], v[184:187], v[88:91], v[52:55]
  v_mfma_f32_16x16x32_bf16 v[52:55], v[196:199], v[84:87], v[52:55]
  ds_read_b128 v[112:115], v2 offset:13312
  v_mfma_f32_16x16x32_bf16 v[56:59], v[196:199], v[96:99], v[56:59]
  buffer_load_dwordx4 v12, s[8:11], s69 offen offset:2048 sc1 lds
  v_mfma_f32_16x16x32_bf16 v[56:59], v[184:187], v[92:95], v[56:59]
  v_mfma_f32_16x16x32_bf16 v[64:67], v[188:191], v[92:95], v[64:67]
  ds_read_b128 v[80:83], v2 offset:6144
  v_mfma_f32_16x16x32_bf16 v[64:67], v[200:203], v[96:99], v[64:67]
  v_mfma_f32_16x16x32_bf16 v[60:63], v[200:203], v[84:87], v[60:63]
  ds_read_b64_tr_b16 v[116:117], v6 offset:24576
  v_mfma_f32_16x16x32_bf16 v[60:63], v[188:191], v[88:91], v[60:63]
  ds_read_b128 v[76:79], v2 offset:7168
  ds_read_b64_tr_b16 v[118:119], v6 offset:26624
  s_waitcnt lgkmcnt(5)
  v_mfma_f32_16x16x32_bf16 v[36:39], v[120:123], v[32:35], v[36:39]
  v_mfma_f32_16x16x32_bf16 v[68:71], v[192:195], v[88:91], v[68:71]
  buffer_load_dwordx4 v12, s[8:11], s69 offen offset:3072 sc1 lds
  ds_read_b128 v[28:31], v41 offset:384
  v_mfma_f32_16x16x32_bf16 v[68:71], v[204:207], v[84:87], v[68:71]
  v_mfma_f32_16x16x32_bf16 v[72:75], v[204:207], v[96:99], v[72:75]
  ds_read_b128 v[88:91], v2 offset:14336
  v_mfma_f32_16x16x32_bf16 v[72:75], v[192:195], v[92:95], v[72:75]
  s_waitcnt lgkmcnt(6)
  s_add_u32 m0, s70, 0
  s_add_u32 s69, s58, 229376
  v_mfma_f32_16x16x32_bf16 v[52:55], v[208:211], v[104:107], v[52:55]
  buffer_load_dwordx4 v12, s[8:11], s69 offen offset:0 sc1 lds
  v_mfma_f32_16x16x32_bf16 v[52:55], v[220:223], v[100:103], v[52:55]
  ds_read_b128 v[84:87], v2 offset:15360
  v_mfma_f32_16x16x32_bf16 v[56:59], v[220:223], v[112:115], v[56:59]
  v_mfma_f32_16x16x32_bf16 v[56:59], v[208:211], v[108:111], v[56:59]
  v_mfma_f32_16x16x32_bf16 v[64:67], v[212:215], v[108:111], v[64:67]
  ds_read_b128 v[96:99], v2 offset:32768
  ds_read_b64_tr_b16 v[120:121], v6 offset:28672
  v_mfma_f32_16x16x32_bf16 v[64:67], v[224:227], v[112:115], v[64:67]
  ds_read_b64_tr_b16 v[122:123], v6 offset:30720
  s_waitcnt lgkmcnt(5)
  v_mfma_f32_16x16x32_bf16 v[36:39], v[116:119], v[28:31], v[36:39]
  v_mfma_f32_16x16x32_bf16 v[60:63], v[224:227], v[100:103], v[60:63]
  buffer_load_dwordx4 v12, s[8:11], s69 offen offset:1024 sc1 lds
  ds_read_b128 v[32:35], v41 offset:448
  v_mfma_f32_16x16x32_bf16 v[60:63], v[212:215], v[104:107], v[60:63]
  ds_read_b128 v[92:95], v2 offset:33792
  v_mfma_f32_16x16x32_bf16 v[68:71], v[216:219], v[104:107], v[68:71]
  v_mfma_f32_16x16x32_bf16 v[68:71], v[228:231], v[100:103], v[68:71]
  v_mfma_f32_16x16x32_bf16 v[72:75], v[228:231], v[112:115], v[72:75]
  ds_read_b128 v[104:107], v2 offset:40960
  v_mfma_f32_16x16x32_bf16 v[72:75], v[216:219], v[108:111], v[72:75]
  s_waitcnt lgkmcnt(6)
  buffer_load_dwordx4 v12, s[8:11], s69 offen offset:2048 sc1 lds
  v_mfma_f32_16x16x32_bf16 v[52:55], v[232:235], v[80:83], v[52:55]
  v_mfma_f32_16x16x32_bf16 v[52:55], v[244:247], v[76:79], v[52:55]
  ds_read_b128 v[100:103], v2 offset:41984
  v_mfma_f32_16x16x32_bf16 v[56:59], v[244:247], v[84:87], v[56:59]
  v_mfma_f32_16x16x32_bf16 v[56:59], v[232:235], v[88:91], v[56:59]
  buffer_load_dwordx4 v12, s[8:11], s69 offen offset:3072 sc1 lds
  s_waitcnt lgkmcnt(3)
  v_mfma_f32_16x16x32_bf16 v[36:39], v[120:123], v[32:35], v[36:39]
  v_mfma_f32_16x16x32_bf16 v[64:67], v[236:239], v[88:91], v[64:67]
  ds_read_b128 v[112:115], v2 offset:34816
  v_mfma_f32_16x16x32_bf16 v[64:67], v[248:251], v[84:87], v[64:67]
  v_mfma_f32_16x16x32_bf16 v[60:63], v[248:251], v[76:79], v[60:63]
  v_mfma_f32_16x16x32_bf16 v[60:63], v[236:239], v[80:83], v[60:63]
  ds_read_b128 v[108:111], v2 offset:35840
  v_mfma_f32_16x16x32_bf16 v[68:71], v[240:243], v[80:83], v[68:71]
  s_nop 0
  buffer_store_dwordx4 v[36:39], v40, s[8:11], s52 offen sc1
  v_mfma_f32_16x16x32_bf16 v[68:71], v[252:255], v[76:79], v[68:71]
  v_mfma_f32_16x16x32_bf16 v[72:75], v[252:255], v[84:87], v[72:75]
  ds_read_b128 v[80:83], v2 offset:43008
  v_mfma_f32_16x16x32_bf16 v[72:75], v[240:243], v[88:91], v[72:75]
  s_waitcnt lgkmcnt(3)
  v_mfma_f32_16x16x32_bf16 v[28:31], a[0:3], v[96:99], 0
  v_mfma_f32_16x16x32_bf16 v[28:31], a[12:15], v[92:95], v[28:31]
  ds_read_b128 v[76:79], v2 offset:44032
  v_mfma_f32_16x16x32_bf16 v[32:35], a[12:15], v[100:103], 0
  v_mfma_f32_16x16x32_bf16 v[32:35], a[0:3], v[104:107], v[32:35]
  v_cvt_pk_bf16_f32 v52, v52, v53
  v_cvt_pk_bf16_f32 v53, v54, v55
  v_mfma_f32_16x16x32_bf16 v[40:43], a[4:7], v[104:107], 0
  ds_read_b128 v[84:87], v2 offset:36864
  v_mfma_f32_16x16x32_bf16 v[40:43], a[16:19], v[100:103], v[40:43]
  ds_write_b64 v18, v[52:53] offset:0
  v_mfma_f32_16x16x32_bf16 v[36:39], a[16:19], v[92:95], 0
  v_cvt_pk_bf16_f32 v60, v60, v61
  v_cvt_pk_bf16_f32 v61, v62, v63
  v_mfma_f32_16x16x32_bf16 v[36:39], a[4:7], v[96:99], v[36:39]
  ds_read_b128 v[88:91], v2 offset:37888
  v_cvt_pk_bf16_f32 v62, v68, v69
  v_cvt_pk_bf16_f32 v63, v70, v71
  v_mfma_f32_16x16x32_bf16 v[44:47], a[8:11], v[96:99], 0
  ds_write_b128 v17, v[60:63] offset:1024
  v_mfma_f32_16x16x32_bf16 v[44:47], a[20:23], v[92:95], v[44:47]
  v_cvt_pk_bf16_f32 v56, v56, v57
  v_cvt_pk_bf16_f32 v57, v58, v59
  v_mfma_f32_16x16x32_bf16 v[48:51], a[20:23], v[100:103], 0
  ds_read_b128 v[96:99], v2 offset:45056
  v_mfma_f32_16x16x32_bf16 v[48:51], a[8:11], v[104:107], v[48:51]
  s_waitcnt lgkmcnt(5)
  ds_write_b64 v18, v[56:57] offset:6144
  v_mfma_f32_16x16x32_bf16 v[28:31], a[24:27], v[112:115], v[28:31]
  v_cvt_pk_bf16_f32 v64, v64, v65
  v_cvt_pk_bf16_f32 v65, v66, v67
  v_mfma_f32_16x16x32_bf16 v[28:31], a[36:39], v[108:111], v[28:31]
  ds_read_b128 v[92:95], v2 offset:46080
  v_cvt_pk_bf16_f32 v66, v72, v73
  v_mfma_f32_16x16x32_bf16 v[32:35], a[36:39], v[76:79], v[32:35]
  v_cvt_pk_bf16_f32 v67, v74, v75
  v_mfma_f32_16x16x32_bf16 v[32:35], a[24:27], v[80:83], v[32:35]
  ds_write_b128 v17, v[64:67] offset:7168
  v_mfma_f32_16x16x32_bf16 v[40:43], a[28:31], v[80:83], v[40:43]
  ds_read_b128 v[100:103], v2 offset:38912
  v_mfma_f32_16x16x32_bf16 v[40:43], a[40:43], v[76:79], v[40:43]
  s_bitcmp1_b32 s44, 0
  s_mov_b32 s52, 0
  s_cselect_b32 s52, 6144, s52
  s_mov_b32 s53, 12288
  s_cselect_b32 s53, 0, s53
  v_mfma_f32_16x16x32_bf16 v[36:39], a[40:43], v[108:111], v[36:39]
  v_add_u32 v116, s52, v19
  v_add_u32 v117, s53, v19
  v_mfma_f32_16x16x32_bf16 v[36:39], a[28:31], v[112:115], v[36:39]
  ds_read_b128 v[104:107], v2 offset:39936
  v_add_u32 v118, s52, v20
  v_mfma_f32_16x16x32_bf16 v[44:47], a[32:35], v[112:115], v[44:47]
  v_add_u32 v119, s53, v20
  v_mfma_f32_16x16x32_bf16 v[44:47], a[44:47], v[108:111], v[44:47]
  s_waitcnt vmcnt(13) lgkmcnt(2)
  s_barrier
  v_mfma_f32_16x16x32_bf16 v[48:51], a[44:47], v[76:79], v[48:51]
  ds_read_b128 v[112:115], v2 offset:47104
  v_mfma_f32_16x16x32_bf16 v[48:51], a[32:35], v[80:83], v[48:51]
  s_waitcnt lgkmcnt(4)
  s_add_u32 m0, s45, 16384
  s_add_u32 s68, s67, 0
  s_and_b32 s68, s68, 7
  s_mul_i32 s68, s68, 262144
  v_mfma_f32_16x16x32_bf16 v[28:31], a[48:51], v[84:87], v[28:31]
  buffer_load_dwordx4 v10, s[16:19], s68 offen lds
  ds_read_b128 v[52:55], v116
  v_mfma_f32_16x16x32_bf16 v[28:31], a[60:63], v[88:91], v[28:31]
  ds_read_b128 v[108:111], v2 offset:48128
  v_mfma_f32_16x16x32_bf16 v[32:35], a[60:63], v[92:95], v[32:35]
HOP3:
  s_cbranch_execz HOP7
  ds_read_b128 v[56:59], v117 offset:1024
  v_mfma_f32_16x16x32_bf16 v[32:35], a[48:51], v[96:99], v[32:35]
  s_add_u32 m0, s45, 20480
  s_add_u32 s68, s68, 65536
  v_mfma_f32_16x16x32_bf16 v[40:43], a[52:55], v[96:99], v[40:43]
  ds_read_b128 v[76:79], v1 offset:32768
  v_mfma_f32_16x16x32_bf16 v[40:43], a[64:67], v[92:95], v[40:43]
  buffer_load_dwordx4 v10, s[16:19], s68 offen lds
  ds_read_b128 v[60:63], v116 offset:1024
  v_mfma_f32_16x16x32_bf16 v[36:39], a[64:67], v[88:91], v[36:39]
  ds_read_b64_tr_b16 v[64:65], v119 offset:2048
  v_mfma_f32_16x16x32_bf16 v[36:39], a[52:55], v[84:87], v[36:39]
  ds_read_b128 v[80:83], v1 offset:33792
  v_mfma_f32_16x16x32_bf16 v[44:47], a[56:59], v[84:87], v[44:47]
  s_add_u32 m0, s45, 24576
  s_add_u32 s68, s68, 65536
  v_mfma_f32_16x16x32_bf16 v[44:47], a[68:71], v[88:91], v[44:47]
  buffer_load_dwordx4 v10, s[16:19], s68 offen lds
  ds_read_b64_tr_b16 v[66:67], v118 offset:2048
  v_mfma_f32_16x16x32_bf16 v[48:51], a[68:71], v[92:95], v[48:51]
  ds_read_b128 v[84:87], v1 offset:40960
  v_mfma_f32_16x16x32_bf16 v[48:51], a[56:59], v[96:99], v[48:51]
  s_waitcnt lgkmcnt(7)
  ds_read_b64_tr_b16 v[68:69], v119 offset:2056
  v_mfma_f32_16x16x32_bf16 v[28:31], a[72:75], v[100:103], v[28:31]
  s_add_u32 m0, s45, 28672
  s_add_u32 s68, s68, 65536
  v_mfma_f32_16x16x32_bf16 v[28:31], a[84:87], v[104:107], v[28:31]
  ds_read_b128 v[88:91], v1 offset:41984
  v_mfma_f32_16x16x32_bf16 v[32:35], a[84:87], v[108:111], v[32:35]
  buffer_load_dwordx4 v10, s[16:19], s68 offen lds
  ds_read_b64_tr_b16 v[70:71], v118 offset:2056
  v_mfma_f32_16x16x32_bf16 v[32:35], a[72:75], v[112:115], v[32:35]
  v_mfma_f32_16x16x32_bf16 v[40:43], a[76:79], v[112:115], v[40:43]
  ds_read_b128 v[92:95], v1 offset:34816
  v_mfma_f32_16x16x32_bf16 v[40:43], a[88:91], v[108:111], v[40:43]
  v_mfma_f32_16x16x32_bf16 v[36:39], a[88:91], v[104:107], v[36:39]
  s_add_u32 m0, s70, 65536
  s_add_u32 s69, s59, 229376
  v_mfma_f32_16x16x32_bf16 v[36:39], a[76:79], v[100:103], v[36:39]
  ds_read_b128 v[96:99], v1 offset:35840
  s_waitcnt lgkmcnt(2)
  v_mfma_f32_16x16x32_bf16 v[116:119], v[56:59], v[52:55], 0
  v_mfma_f32_16x16x32_bf16 v[120:123], v[60:63], v[52:55], 0
  v_mfma_f32_16x16x32_bf16 v[44:47], a[80:83], v[100:103], v[44:47]
  buffer_load_dwordx4 v12, s[8:11], s69 offen offset:0 sc1 lds
  v_mfma_f32_16x16x32_bf16 v[44:47], a[92:95], v[104:107], v[44:47]
  v_mfma_f32_16x16x32_bf16 v[48:51], a[92:95], v[108:111], v[48:51]
  ds_read_b128 v[100:103], v1 offset:43008
  v_mfma_f32_16x16x32_bf16 v[48:51], a[80:83], v[112:115], v[48:51]
  s_waitcnt lgkmcnt(4)
  s_nop 0
  v_cndmask_b32 v72, v116, v120, s[80:81]
  v_cndmask_b32 v73, v117, v121, s[82:83]
  v_mfma_f32_16x16x32_bf16 v[28:31], a[96:99], v[76:79], v[28:31]
  buffer_load_dwordx4 v12, s[8:11], s69 offen offset:1024 sc1 lds
  v_cndmask_b32 v74, v118, v122, s[84:85]
  v_cndmask_b32 v75, v119, v123, s[86:87]
  v_mfma_f32_16x16x32_bf16 v[28:31], a[108:111], v[80:83], v[28:31]
  ds_read_b128 v[104:107], v1 offset:44032
  v_cndmask_b32 v72, v72, v73, s[88:89]
  v_mfma_f32_16x16x32_bf16 v[32:35], a[108:111], v[88:91], v[32:35]
  v_cndmask_b32 v73, v74, v75, s[88:89]
  v_mul_f32 v72, 0x3e8293ee, v72
  v_mfma_f32_16x16x32_bf16 v[32:35], a[96:99], v[84:87], v[32:35]
  v_mul_f32 v73, 0x3e8293ee, v73
  v_max_f32 v74, v72, v73
  v_mfma_f32_16x16x32_bf16 v[40:43], a[100:103], v[84:87], v[40:43]
  ds_read_b128 v[108:111], v1 offset:36864
  v_mov_b32 v75, v74
  v_mfma_f32_16x16x32_bf16 v[40:43], a[112:115], v[88:91], v[40:43]
  buffer_load_dwordx4 v12, s[8:11], s69 offen offset:2048 sc1 lds
  v_permlane16_swap_b32 v74, v75
  v_mfma_f32_16x16x32_bf16 v[36:39], a[112:115], v[80:83], v[36:39]
  v_max_f32 v74, v74, v75
  v_mov_b32 v75, v74
  v_mfma_f32_16x16x32_bf16 v[36:39], a[100:103], v[76:79], v[36:39]
  ds_read_b128 v[112:115], v1 offset:37888
  v_mfma_f32_16x16x32_bf16 v[44:47], a[104:107], v[76:79], v[44:47]
  v_permlane32_swap_b32 v74, v75
  v_mfma_f32_16x16x32_bf16 v[44:47], a[116:119], v[80:83], v[44:47]
  v_max_f32 v74, v74, v75
  v_sub_f32 v72, v72, v74
  v_mfma_f32_16x16x32_bf16 v[48:51], a[116:119], v[88:91], v[48:51]
  ds_read_b128 v[76:79], v1 offset:45056
  v_sub_f32 v73, v73, v74
  v_mfma_f32_16x16x32_bf16 v[48:51], a[104:107], v[84:87], v[48:51]
  s_waitcnt lgkmcnt(3)
  buffer_load_dwordx4 v12, s[8:11], s69 offen offset:3072 sc1 lds
  v_mfma_f32_16x16x32_bf16 v[28:31], a[120:123], v[92:95], v[28:31]
  v_exp_f32 v72, v72
  v_mfma_f32_16x16x32_bf16 v[28:31], a[132:135], v[96:99], v[28:31]
  ds_read_b128 v[80:83], v1 offset:46080
  v_mfma_f32_16x16x32_bf16 v[32:35], a[132:135], v[104:107], v[32:35]
  s_add_u32 m0, s45, 81920
  s_add_u32 s68, s67, 1
  s_and_b32 s68, s68, 7
  s_mul_i32 s68, s68, 262144
  v_mfma_f32_16x16x32_bf16 v[32:35], a[120:123], v[100:103], v[32:35]
  buffer_load_dwordx4 v10, s[16:19], s68 offen lds
  v_exp_f32 v73, v73
  v_mfma_f32_16x16x32_bf16 v[40:43], a[124:127], v[100:103], v[40:43]
  ds_read_b128 v[88:91], v1 offset:38912
  v_add_f32 v74, v72, v73
  v_mfma_f32_16x16x32_bf16 v[40:43], a[136:139], v[104:107], v[40:43]
  v_mov_b32 v75, v74
  v_mfma_f32_16x16x32_bf16 v[36:39], a[136:139], v[96:99], v[36:39]
  s_add_u32 m0, s45, 86016
  s_add_u32 s68, s68, 65536
  v_mfma_f32_16x16x32_bf16 v[36:39], a[124:127], v[92:95], v[36:39]
  ds_read_b128 v[84:87], v1 offset:39936
  v_mfma_f32_16x16x32_bf16 v[44:47], a[128:131], v[92:95], v[44:47]
  buffer_load_dwordx4 v10, s[16:19], s68 offen lds
  v_permlane16_swap_b32 v74, v75
  v_mfma_f32_16x16x32_bf16 v[44:47], a[140:143], v[96:99], v[44:47]
  v_add_f32 v74, v74, v75
  v_mov_b32 v75, v74
  v_mfma_f32_16x16x32_bf16 v[48:51], a[140:143], v[104:107], v[48:51]
  ds_read_b128 v[92:95], v1 offset:47104
  v_mfma_f32_16x16x32_bf16 v[48:51], a[128:131], v[100:103], v[48:51]
  s_waitcnt lgkmcnt(3)
  v_permlane32_swap_b32 v74, v75
  v_mfma_f32_16x16x32_bf16 v[28:31], a[144:147], v[108:111], v[28:31]
  s_add_u32 m0, s45, 90112
  s_add_u32 s68, s68, 65536
  v_add_f32 v74, v74, v75
  v_mfma_f32_16x16x32_bf16 v[28:31], a[156:159], v[112:115], v[28:31]
  ds_read_b128 v[96:99], v1 offset:48128
  v_mfma_f32_16x16x32_bf16 v[32:35], a[156:159], v[80:83], v[32:35]
  buffer_load_dwordx4 v10, s[16:19], s68 offen lds
  v_rcp_f32 v74, v74
  v_mfma_f32_16x16x32_bf16 v[32:35], a[144:147], v[76:79], v[32:35]
  s_waitcnt vmcnt(11)
  s_barrier
  v_mfma_f32_16x16x32_bf16 v[40:43], a[148:151], v[76:79], v[40:43]
  ds_read_b128 v[104:107], v1 offset:49152
  v_mul_f32 v72, v72, v74
  v_add_u32 v15, s46, v0
  s_mov_b64 exec, 1
  buffer_store_dword v15, v0, s[8:11], s79 offen offset:0 sc1
  s_mov_b64 exec, -1
  v_mfma_f32_16x16x32_bf16 v[40:43], a[160:163], v[80:83], v[40:43]
  s_add_u32 m0, s45, 94208
  s_add_u32 s68, s68, 65536
  v_mul_f32 v73, v73, v74
  v_mfma_f32_16x16x32_bf16 v[36:39], a[160:163], v[112:115], v[36:39]
  buffer_load_dwordx4 v10, s[16:19], s68 offen lds
  v_cvt_pk_bf16_f32 v72, v72, v72
  v_cvt_pk_bf16_f32 v73, v73, v73
  v_mfma_f32_16x16x32_bf16 v[36:39], a[148:151], v[108:111], v[36:39]
  ds_read_b128 v[100:103], v1 offset:50176
  v_and_b32 v52, v24, v72
  v_mfma_f32_16x16x32_bf16 v[44:47], a[152:155], v[108:111], v[44:47]
  v_and_b32 v53, v25, v73
  v_and_b32 v54, v26, v72
  v_mfma_f32_16x16x32_bf16 v[44:47], a[164:167], v[112:115], v[44:47]
  v_and_b32 v55, v27, v73
  v_mfma_f32_16x16x32_bf16 v[48:51], a[164:167], v[80:83], v[48:51]
  ds_read_b128 v[108:111], v1 offset:57344
  v_mfma_f32_16x16x32_bf16 v[56:59], v[64:67], v[52:55], 0
  v_mfma_f32_16x16x32_bf16 v[60:63], v[68:71], v[52:55], 0
  v_mfma_f32_16x16x32_bf16 v[48:51], a[152:155], v[76:79], v[48:51]
  s_waitcnt lgkmcnt(3)
  s_add_u32 m0, s45, 98304
  s_add_u32 s68, s67, 2
  s_and_b32 s68, s68, 7
  s_mul_i32 s68, s68, 262144
  v_mfma_f32_16x16x32_bf16 v[28:31], a[168:171], v[88:91], v[28:31]
  buffer_load_dwordx4 v10, s[16:19], s68 offen lds
  v_mfma_f32_16x16x32_bf16 v[28:31], a[180:183], v[84:87], v[28:31]
  ds_read_b128 v[112:115], v1 offset:58368
  v_mfma_f32_16x16x32_bf16 v[32:35], a[180:183], v[96:99], v[32:35]
  v_cvt_pk_bf16_f32 v116, v56, v57
  v_cvt_pk_bf16_f32 v117, v58, v59
  v_mfma_f32_16x16x32_bf16 v[32:35], a[168:171], v[92:95], v[32:35]
  s_add_u32 m0, s45, 102400
  s_add_u32 s68, s68, 65536
  v_cvt_pk_bf16_f32 v118, v60, v61
  v_mfma_f32_16x16x32_bf16 v[40:43], a[172:175], v[92:95], v[40:43]
  ds_read_b128 v[80:83], v1 offset:51200
  v_cvt_pk_bf16_f32 v119, v62, v63
  v_mfma_f32_16x16x32_bf16 v[40:43], a[184:187], v[96:99], v[40:43]
  buffer_load_dwordx4 v10, s[16:19], s68 offen lds
  buffer_store_dwordx4 v[116:119], v1, s[8:11], s73 offen sc1
  v_mfma_f32_16x16x32_bf16 v[36:39], a[184:187], v[84:87], v[36:39]
  s_add_u32 s73, s73, 65536
  v_mfma_f32_16x16x32_bf16 v[36:39], a[172:175], v[88:91], v[36:39]
  ds_read_b128 v[76:79], v1 offset:52224
  v_mfma_f32_16x16x32_bf16 v[44:47], a[176:179], v[88:91], v[44:47]
  s_add_u32 m0, s45, 106496
  s_add_u32 s68, s68, 65536
  v_mfma_f32_16x16x32_bf16 v[44:47], a[188:191], v[84:87], v[44:47]
  buffer_load_dwordx4 v10, s[16:19], s68 offen lds
  v_mfma_f32_16x16x32_bf16 v[48:51], a[188:191], v[96:99], v[48:51]
  ds_read_b128 v[88:91], v1 offset:59392
  v_mfma_f32_16x16x32_bf16 v[48:51], a[176:179], v[92:95], v[48:51]
  s_waitcnt lgkmcnt(3)
  v_mfma_f32_16x16x32_bf16 v[28:31], a[192:195], v[104:107], v[28:31]
  s_add_u32 m0, s45, 110592
  s_add_u32 s68, s68, 65536
  v_mfma_f32_16x16x32_bf16 v[28:31], a[204:207], v[100:103], v[28:31]
  ds_read_b128 v[84:87], v1 offset:60416
  v_mfma_f32_16x16x32_bf16 v[32:35], a[204:207], v[112:115], v[32:35]
  buffer_load_dwordx4 v10, s[16:19], s68 offen lds
  v_mfma_f32_16x16x32_bf16 v[32:35], a[192:195], v[108:111], v[32:35]
  s_barrier
  v_mfma_f32_16x16x32_bf16 v[40:43], a[196:199], v[108:111], v[40:43]
  ds_read_b128 v[96:99], v1 offset:53248
  v_mfma_f32_16x16x32_bf16 v[40:43], a[208:211], v[112:115], v[40:43]
  v_mfma_f32_16x16x32_bf16 v[36:39], a[208:211], v[100:103], v[36:39]
  s_add_u32 m0, s45, 32768
  s_add_u32 s68, s67, 3
  s_and_b32 s68, s68, 7
  s_mul_i32 s68, s68, 262144
  v_mfma_f32_16x16x32_bf16 v[36:39], a[196:199], v[104:107], v[36:39]
  ds_read_b128 v[92:95], v1 offset:54272
  v_lshrrev_b32 v116, 3, v0
  v_mfma_f32_16x16x32_bf16 v[44:47], a[200:203], v[104:107], v[44:47]
  buffer_load_dwordx4 v10, s[16:19], s68 offen lds
  v_bfe_u32 v117, v116, 1, 2
  v_bfe_u32 v118, v0, 1, 2
  v_mfma_f32_16x16x32_bf16 v[44:47], a[212:215], v[100:103], v[44:47]
  v_xor_b32 v117, v117, v118
  s_lshl_b32 s52, s44, 3
  v_mfma_f32_16x16x32_bf16 v[48:51], a[212:215], v[112:115], v[48:51]
  ds_read_b128 v[104:107], v1 offset:61440
  v_add_u32 v116, s52, v116
  v_mfma_f32_16x16x32_bf16 v[48:51], a[200:203], v[108:111], v[48:51]
  s_waitcnt lgkmcnt(3)
  s_add_u32 m0, s45, 36864
  s_add_u32 s68, s68, 65536
  v_mfma_f32_16x16x32_bf16 v[28:31], a[216:219], v[80:83], v[28:31]
  buffer_load_dwordx4 v10, s[16:19], s68 offen lds
  v_mul_u32_u24 v116, 7168, v116
  v_and_b32 v118, 1, v0
  v_mfma_f32_16x16x32_bf16 v[28:31], a[228:231], v[76:79], v[28:31]
  ds_read_b128 v[100:103], v1 offset:62464
  v_lshl_add_u32 v116, v118, 4, v116
  v_mfma_f32_16x16x32_bf16 v[32:35], a[228:231], v[84:87], v[32:35]
  s_and_b32 s52, s2, 7
  s_mul_i32 s52, s52, 896
  v_add_u32 v116, s52, v116
  v_mfma_f32_16x16x32_bf16 v[32:35], a[216:219], v[88:91], v[32:35]
  s_add_u32 m0, s45, 40960
  s_add_u32 s68, s68, 65536
  v_lshlrev_b32 v118, 5, v117
  v_mfma_f32_16x16x32_bf16 v[40:43], a[220:223], v[88:91], v[40:43]
  ds_read_b128 v[112:115], v1 offset:55296
  s_and_b32 s53, s2, 24
  v_mfma_f32_16x16x32_bf16 v[40:43], a[232:235], v[84:87], v[40:43]
  buffer_load_dwordx4 v10, s[16:19], s68 offen lds
  s_lshl_b32 s52, s53, 5
  v_add3_u32 v16, v116, v118, s52
  v_mfma_f32_16x16x32_bf16 v[36:39], a[232:235], v[76:79], v[36:39]
  s_lshr_b32 s52, 0x0b070602, s53
  s_and_b32 s52, s52, 15
  s_lshl_b32 s52, s52, 6
  v_mfma_f32_16x16x32_bf16 v[36:39], a[220:223], v[80:83], v[36:39]
  ds_read_b128 v[108:111], v1 offset:56320
  v_add_u32 v118, s52, v118
  v_mfma_f32_16x16x32_bf16 v[44:47], a[224:227], v[80:83], v[44:47]
  s_lshr_b32 s52, 0x15140706, s53
  s_and_b32 s52, s52, 31
  s_lshl_b32 s52, s52, 5
  v_mfma_f32_16x16x32_bf16 v[44:47], a[236:239], v[76:79], v[44:47]
  s_add_u32 m0, s45, 45056
  s_add_u32 s68, s68, 65536
  v_mov_b32 v119, s52
  v_mfma_f32_16x16x32_bf16 v[48:51], a[236:239], v[84:87], v[48:51]
  ds_read_b128 v[80:83], v1 offset:63488
  v_mfma_f32_16x16x32_bf16 v[48:51], a[224:227], v[88:91], v[48:51]
  s_waitcnt lgkmcnt(3)
  buffer_load_dwordx4 v10, s[16:19], s68 offen lds
  v_mfma_f32_16x16x32_bf16 v[28:31], a[240:243], v[96:99], v[28:31]
  v_cmp_gt_u32 vcc, 2, v117
  s_nop 1
  v_cndmask_b32 v118, v119, v118, vcc
  v_mfma_f32_16x16x32_bf16 v[28:31], v[124:127], v[92:95], v[28:31]
  ds_read_b128 v[76:79], v1 offset:64512
  v_add_u32 v11, v116, v118
  v_mfma_f32_16x16x32_bf16 v[32:35], v[124:127], v[100:103], v[32:35]
  v_add_u32 v117, 1, v117
  v_lshrrev_b32 v117, 2, v117
  v_mfma_f32_16x16x32_bf16 v[32:35], a[240:243], v[104:107], v[32:35]
  s_waitcnt vmcnt(27)
  s_barrier
  v_mfma_f32_16x16x32_bf16 v[40:43], a[244:247], v[104:107], v[40:43]
  ds_read_b128 v[84:87], v2 offset:49152
  v_lshl_add_u32 v11, v117, 30, v11
  v_mfma_f32_16x16x32_bf16 v[40:43], v[128:131], v[100:103], v[40:43]
  v_mfma_f32_16x16x32_bf16 v[36:39], v[128:131], v[92:95], v[36:39]
  v_mfma_f32_16x16x32_bf16 v[36:39], a[244:247], v[96:99], v[36:39]
  ds_read_b128 v[88:91], v2 offset:50176
  v_mfma_f32_16x16x32_bf16 v[44:47], a[248:251], v[96:99], v[44:47]
  v_mfma_f32_16x16x32_bf16 v[44:47], v[132:135], v[92:95], v[44:47]
  v_mfma_f32_16x16x32_bf16 v[48:51], v[132:135], v[100:103], v[48:51]
  ds_read_b128 v[96:99], v2 offset:57344
  v_mfma_f32_16x16x32_bf16 v[48:51], a[248:251], v[104:107], v[48:51]
  s_waitcnt lgkmcnt(3)
  v_mfma_f32_16x16x32_bf16 v[28:31], v[136:139], v[112:115], v[28:31]
  v_mfma_f32_16x16x32_bf16 v[28:31], v[148:151], v[108:111], v[28:31]
  ds_read_b128 v[92:95], v2 offset:58368
  v_mfma_f32_16x16x32_bf16 v[32:35], v[148:151], v[76:79], v[32:35]
  v_mfma_f32_16x16x32_bf16 v[32:35], v[136:139], v[80:83], v[32:35]
  v_mfma_f32_16x16x32_bf16 v[40:43], v[140:143], v[80:83], v[40:43]
  ds_read_b128 v[100:103], v2 offset:51200
  v_mfma_f32_16x16x32_bf16 v[40:43], v[152:155], v[76:79], v[40:43]
  v_mfma_f32_16x16x32_bf16 v[36:39], v[152:155], v[108:111], v[36:39]
  v_mfma_f32_16x16x32_bf16 v[36:39], v[140:143], v[112:115], v[36:39]
  ds_read_b128 v[104:107], v2 offset:52224
  v_mfma_f32_16x16x32_bf16 v[44:47], v[144:147], v[112:115], v[44:47]
  v_mfma_f32_16x16x32_bf16 v[44:47], v[156:159], v[108:111], v[44:47]
  v_mfma_f32_16x16x32_bf16 v[48:51], v[156:159], v[76:79], v[48:51]
  ds_read_b128 v[112:115], v2 offset:59392
  v_mfma_f32_16x16x32_bf16 v[48:51], v[144:147], v[80:83], v[48:51]
  s_waitcnt lgkmcnt(3)
  v_mfma_f32_16x16x32_bf16 v[28:31], v[160:163], v[84:87], v[28:31]
  v_mfma_f32_16x16x32_bf16 v[28:31], v[172:175], v[88:91], v[28:31]
  ds_read_b128 v[108:111], v2 offset:60416
  v_mfma_f32_16x16x32_bf16 v[32:35], v[172:175], v[92:95], v[32:35]
  v_mfma_f32_16x16x32_bf16 v[32:35], v[160:163], v[96:99], v[32:35]
  v_mfma_f32_16x16x32_bf16 v[40:43], v[164:167], v[96:99], v[40:43]
  ds_read_b128 v[76:79], v2 offset:53248
  v_mfma_f32_16x16x32_bf16 v[40:43], v[176:179], v[92:95], v[40:43]
  v_mfma_f32_16x16x32_bf16 v[36:39], v[176:179], v[88:91], v[36:39]
  v_mfma_f32_16x16x32_bf16 v[36:39], v[164:167], v[84:87], v[36:39]
  ds_read_b128 v[80:83], v2 offset:54272
  s_waitcnt vmcnt(6)
  s_barrier
  v_add_u32 v15, s46, v0
  v_add_u32 v15, 1, v15
  s_mov_b64 exec, 1
  buffer_store_dword v15, v0, s[8:11], s74 offen offset:0 sc1
  s_mov_b64 exec, -1
  v_mfma_f32_16x16x32_bf16 v[44:47], v[168:171], v[84:87], v[44:47]
  s_add_u32 m0, s70, 49152
  s_add_u32 s69, s60, 229376
  v_mfma_f32_16x16x32_bf16 v[44:47], v[180:183], v[88:91], v[44:47]
  buffer_load_dwordx4 v12, s[8:11], s69 offen offset:0 sc1 lds
  v_mfma_f32_16x16x32_bf16 v[48:51], v[180:183], v[92:95], v[48:51]
  ds_read_b128 v[84:87], v2 offset:61440
  v_mfma_f32_16x16x32_bf16 v[48:51], v[168:171], v[96:99], v[48:51]
  s_waitcnt lgkmcnt(3)
  v_mfma_f32_16x16x32_bf16 v[28:31], v[184:187], v[100:103], v[28:31]
  buffer_load_dwordx4 v12, s[8:11], s69 offen offset:1024 sc1 lds
  v_mfma_f32_16x16x32_bf16 v[28:31], v[196:199], v[104:107], v[28:31]
  ds_read_b128 v[88:91], v2 offset:62464
  v_mfma_f32_16x16x32_bf16 v[32:35], v[196:199], v[108:111], v[32:35]
  buffer_load_dwordx4 v12, s[8:11], s69 offen offset:2048 sc1 lds
  v_mfma_f32_16x16x32_bf16 v[32:35], v[184:187], v[112:115], v[32:35]
  v_mfma_f32_16x16x32_bf16 v[40:43], v[188:191], v[112:115], v[40:43]
  ds_read_b128 v[92:95], v2 offset:55296
  buffer_load_dwordx4 v12, s[8:11], s69 offen offset:3072 sc1 lds
  v_mfma_f32_16x16x32_bf16 v[40:43], v[200:203], v[108:111], v[40:43]
  v_mfma_f32_16x16x32_bf16 v[36:39], v[200:203], v[104:107], v[36:39]
  v_mfma_f32_16x16x32_bf16 v[36:39], v[188:191], v[100:103], v[36:39]
  ds_read_b128 v[96:99], v2 offset:56320
  v_mfma_f32_16x16x32_bf16 v[44:47], v[192:195], v[100:103], v[44:47]
  v_mfma_f32_16x16x32_bf16 v[44:47], v[204:207], v[104:107], v[44:47]
  v_mfma_f32_16x16x32_bf16 v[48:51], v[204:207], v[108:111], v[48:51]
  ds_read_b128 v[100:103], v2 offset:63488
  s_cmp_gt_u32 s44, 1
  s_cbranch_scc1 TH4_adaLN_cond__sliding_local_dilated__swiglu_ffn__prompt_kernel
  s_cmp_eq_u32 s44, 0
  s_cselect_b64 s[4:5], s[28:29], s[32:33]
  s_lshr_b32 s57, s2, 3
  s_mul_i32 s57, s57, 57344
  s_and_b32 vcc_lo, s2, 7
  s_mul_i32 vcc_lo, vcc_lo, 896
  s_add_u32 s57, s57, vcc_lo
  v_lshrrev_b32 v15, 3, v0
  v_mul_u32_u24 v15, 6144, v15
  v_lshl_add_u32 v15, v0, 7, v15
  s_mov_b32 exec_lo, 0x7f7f7f7f
  s_mov_b32 exec_hi, 0x7f7f7f7f
  buffer_load_dword a253, v15, s[4:7], s57 offen
  s_mov_b64 exec, -1
TH4_adaLN_cond__sliding_local_dilated__swiglu_ffn__prompt_kernel:
  v_mfma_f32_16x16x32_bf16 v[48:51], v[192:195], v[112:115], v[48:51]
  s_waitcnt lgkmcnt(3)
  v_mfma_f32_16x16x32_bf16 v[28:31], v[208:211], v[76:79], v[28:31]
  v_mfma_f32_16x16x32_bf16 v[28:31], v[220:223], v[80:83], v[28:31]
  ds_read_b128 v[104:107], v2 offset:64512
  v_mfma_f32_16x16x32_bf16 v[32:35], v[220:223], v[88:91], v[32:35]
  v_mfma_f32_16x16x32_bf16 v[32:35], v[208:211], v[84:87], v[32:35]
  s_waitcnt vmcnt(28)
  s_barrier
  v_mfma_f32_16x16x32_bf16 v[40:43], v[212:215], v[84:87], v[40:43]
  v_mfma_f32_16x16x32_bf16 v[40:43], v[224:227], v[88:91], v[40:43]
  v_mfma_f32_16x16x32_bf16 v[36:39], v[224:227], v[80:83], v[36:39]
  v_mfma_f32_16x16x32_bf16 v[36:39], v[212:215], v[76:79], v[36:39]
  v_mfma_f32_16x16x32_bf16 v[44:47], v[216:219], v[76:79], v[44:47]
  v_mfma_f32_16x16x32_bf16 v[44:47], v[228:231], v[80:83], v[44:47]
  v_mfma_f32_16x16x32_bf16 v[48:51], v[228:231], v[88:91], v[48:51]
  v_mfma_f32_16x16x32_bf16 v[48:51], v[216:219], v[84:87], v[48:51]
  s_waitcnt lgkmcnt(0)
  ds_read_b128 v[108:111], v1 offset:0
  v_mfma_f32_16x16x32_bf16 v[28:31], v[232:235], v[92:95], v[28:31]
  v_mfma_f32_16x16x32_bf16 v[28:31], v[244:247], v[96:99], v[28:31]
  ds_read_b128 v[112:115], v1 offset:1024
  v_mfma_f32_16x16x32_bf16 v[32:35], v[244:247], v[104:107], v[32:35]
  v_mfma_f32_16x16x32_bf16 v[32:35], v[232:235], v[100:103], v[32:35]
  ds_read_b128 v[76:79], v1 offset:8192
  v_mfma_f32_16x16x32_bf16 v[40:43], v[236:239], v[100:103], v[40:43]
  v_mfma_f32_16x16x32_bf16 v[40:43], v[248:251], v[104:107], v[40:43]
  ds_read_b128 v[80:83], v1 offset:9216
  v_mfma_f32_16x16x32_bf16 v[36:39], v[248:251], v[96:99], v[36:39]
  v_mfma_f32_16x16x32_bf16 v[36:39], v[236:239], v[92:95], v[36:39]
  ds_read_b128 v[88:91], v1 offset:2048
  v_mfma_f32_16x16x32_bf16 v[44:47], v[240:243], v[92:95], v[44:47]
  s_waitcnt vmcnt(23)
  s_barrier
  v_mfma_f32_16x16x32_bf16 v[44:47], v[252:255], v[96:99], v[44:47]
  ds_read_b128 v[84:87], v1 offset:3072
  s_add_u32 m0, s45, 114688
  s_add_u32 s68, s67, 4
  s_and_b32 s68, s68, 7
  s_mul_i32 s68, s68, 262144
  v_mfma_f32_16x16x32_bf16 v[48:51], v[252:255], v[104:107], v[48:51]
  buffer_load_dwordx4 v10, s[16:19], s68 offen lds
  v_mfma_f32_16x16x32_bf16 v[48:51], v[240:243], v[100:103], v[48:51]
  s_waitcnt lgkmcnt(2)
  ds_read_b128 v[92:95], v1 offset:10240
  v_mfma_f32_16x16x32_bf16 v[56:59], a[0:3], v[76:79], 0
  s_add_u32 m0, s45, 118784
  s_add_u32 s68, s68, 65536
  v_mfma_f32_16x16x32_bf16 v[56:59], a[12:15], v[80:83], v[56:59]
  ds_read_b128 v[96:99], v1 offset:11264
  buffer_load_dwordx4 v10, s[16:19], s68 offen lds
  v_mfma_f32_16x16x32_bf16 v[52:55], a[12:15], v[112:115], 0
  s_add_u32 m0, s45, 122880
  s_add_u32 s68, s68, 65536
  v_mfma_f32_16x16x32_bf16 v[52:55], a[0:3], v[108:111], v[52:55]
  ds_read_b128 v[104:107], v1 offset:4096
  buffer_load_dwordx4 v10, s[16:19], s68 offen lds
  v_cvt_pk_bf16_f32 v28, v28, v29
  v_cvt_pk_bf16_f32 v29, v30, v31
  ds_write_b64 v18, v[28:29] offset:12288
  v_mfma_f32_16x16x32_bf16 v[60:63], a[4:7], v[108:111], 0
  s_add_u32 m0, s45, 126976
  s_add_u32 s68, s68, 65536
  v_cvt_pk_bf16_f32 v36, v36, v37
  v_cvt_pk_bf16_f32 v37, v38, v39
  v_cvt_pk_bf16_f32 v38, v44, v45
  v_cvt_pk_bf16_f32 v39, v46, v47
  v_mfma_f32_16x16x32_bf16 v[60:63], a[16:19], v[112:115], v[60:63]
  ds_read_b128 v[100:103], v1 offset:5120
  buffer_load_dwordx4 v10, s[16:19], s68 offen lds
  ds_write_b128 v17, v[36:39] offset:13312
  v_mfma_f32_16x16x32_bf16 v[68:71], a[20:23], v[112:115], 0
  v_cvt_pk_bf16_f32 v32, v32, v33
  v_cvt_pk_bf16_f32 v33, v34, v35
  ds_write_b64 v18, v[32:33] offset:0
  v_cvt_pk_bf16_f32 v40, v40, v41
  v_mfma_f32_16x16x32_bf16 v[68:71], a[8:11], v[108:111], v[68:71]
  s_waitcnt lgkmcnt(5)
  ds_read_b128 v[76:79], v1 offset:12288
  v_cvt_pk_bf16_f32 v41, v42, v43
  v_cvt_pk_bf16_f32 v42, v48, v49
  v_cvt_pk_bf16_f32 v43, v50, v51
  v_mfma_f32_16x16x32_bf16 v[56:59], a[24:27], v[92:95], v[56:59]
  ds_read_b64_tr_b16 a[0:1], v4 offset:16384
  ds_write_b128 v17, v[40:43] offset:1024
  v_mfma_f32_16x16x32_bf16 v[56:59], a[36:39], v[96:99], v[56:59]
  ds_read_b128 v[80:83], v1 offset:13312
  ds_read_b64_tr_b16 a[2:3], v4 offset:18432
  s_bitcmp1_b32 s44, 0
  s_mov_b32 s52, 12288
  s_cselect_b32 s52, 0, s52
  s_mov_b32 s53, 6144
  s_cselect_b32 s53, 12288, s53
  v_mfma_f32_16x16x32_bf16 v[52:55], a[36:39], v[84:87], v[52:55]
  ds_read_b64_tr_b16 a[4:5], v5 offset:16384
  v_add_u32 v116, s52, v19
  v_add_u32 v117, s53, v19
  v_add_u32 v118, s52, v20
  v_add_u32 v119, s53, v20
  s_waitcnt vmcnt(18) lgkmcnt(3)
  s_barrier
  v_mfma_f32_16x16x32_bf16 v[52:55], a[24:27], v[88:91], v[52:55]
  ds_read_b128 v[112:115], v1 offset:6144
  ds_read_b64_tr_b16 a[6:7], v5 offset:18432
  ds_read_b64_tr_b16 a[8:9], v4 offset:20480
  ds_read_b128 v[28:31], v116
  v_mfma_f32_16x16x32_bf16 v[60:63], a[28:31], v[88:91], v[60:63]
  ds_read_b64_tr_b16 a[10:11], v4 offset:22528
  ds_read_b128 v[32:35], v117 offset:1024
  ds_read_b128 v[36:39], v116 offset:1024
  v_mfma_f32_16x16x32_bf16 v[60:63], a[40:43], v[84:87], v[60:63]
  ds_read_b128 v[108:111], v1 offset:7168
  ds_read_b64_tr_b16 a[12:13], v5 offset:20480
  ds_read_b64_tr_b16 v[40:41], v119 offset:2048
  ds_read_b64_tr_b16 v[42:43], v118 offset:2048
  v_mfma_f32_16x16x32_bf16 v[68:71], a[44:47], v[84:87], v[68:71]
  ds_read_b64_tr_b16 a[14:15], v5 offset:22528
  ds_read_b64_tr_b16 a[16:17], v4 offset:24576
  ds_read_b64_tr_b16 v[44:45], v119 offset:2056
  ds_read_b64_tr_b16 v[46:47], v118 offset:2056
  v_mfma_f32_16x16x32_bf16 v[68:71], a[32:35], v[88:91], v[68:71]
  s_waitcnt lgkmcnt(15)
  ds_read_b128 v[92:95], v1 offset:14336
  ds_read_b64_tr_b16 a[18:19], v4 offset:26624
  v_mfma_f32_16x16x32_bf16 v[56:59], a[48:51], v[76:79], v[56:59]
  ds_read_b64_tr_b16 a[20:21], v5 offset:24576
  v_mfma_f32_16x16x32_bf16 v[56:59], a[60:63], v[80:83], v[56:59]
  ds_read_b128 v[96:99], v1 offset:15360
  ds_read_b64_tr_b16 a[22:23], v5 offset:26624
  ds_read_b64_tr_b16 a[24:25], v4 offset:28672
  v_mfma_f32_16x16x32_bf16 v[52:55], a[60:63], v[100:103], v[52:55]
  ds_read_b64_tr_b16 a[26:27], v4 offset:30720
  v_mfma_f32_16x16x32_bf16 v[52:55], a[48:51], v[104:107], v[52:55]
  ds_read_b128 v[84:87], v2 offset:0
  ds_read_b64_tr_b16 a[28:29], v5 offset:28672
  s_waitcnt lgkmcnt(9)
  v_mfma_f32_16x16x32_bf16 v[116:119], v[32:35], v[28:31], 0
  v_mfma_f32_16x16x32_bf16 v[120:123], v[36:39], v[28:31], 0
  v_mfma_f32_16x16x32_bf16 v[60:63], a[52:55], v[104:107], v[60:63]
  ds_read_b64_tr_b16 a[30:31], v5 offset:30720
  ds_read_b64_tr_b16 a[32:33], v7 offset:16384
  v_mfma_f32_16x16x32_bf16 v[60:63], a[64:67], v[100:103], v[60:63]
  ds_read_b128 v[88:91], v2 offset:1024
  ds_read_b64_tr_b16 a[34:35], v7 offset:18432
  v_mfma_f32_16x16x32_bf16 v[68:71], a[68:71], v[100:103], v[68:71]
  ds_read_b64_tr_b16 a[36:37], v8 offset:16384
  v_mfma_f32_16x16x32_bf16 v[68:71], a[56:59], v[104:107], v[68:71]
  s_waitcnt lgkmcnt(10)
  ds_read_b128 v[76:79], v2 offset:8192
  ds_read_b64_tr_b16 a[38:39], v8 offset:18432
  ds_read_b64_tr_b16 a[40:41], v7 offset:20480
  v_cndmask_b32 v48, v116, v120, s[80:81]
  v_mfma_f32_16x16x32_bf16 v[56:59], a[72:75], v[92:95], v[56:59]
  ds_read_b64_tr_b16 a[42:43], v7 offset:22528
  v_cndmask_b32 v49, v117, v121, s[82:83]
  v_cndmask_b32 v50, v118, v122, s[84:85]
  v_cndmask_b32 v51, v119, v123, s[86:87]
  v_cndmask_b32 v48, v48, v49, s[88:89]
  v_cndmask_b32 v49, v50, v51, s[88:89]
  v_mul_f32 v48, 0x3e8293ee, v48
  v_mfma_f32_16x16x32_bf16 v[56:59], a[84:87], v[96:99], v[56:59]
  ds_read_b128 v[80:83], v2 offset:9216
  ds_read_b64_tr_b16 a[44:45], v8 offset:20480
  v_mul_f32 v49, 0x3e8293ee, v49
  v_max_f32 v50, v48, v49
  v_mov_b32 v51, v50
  v_mfma_f32_16x16x32_bf16 v[52:55], a[84:87], v[108:111], v[52:55]
  ds_read_b64_tr_b16 a[46:47], v8 offset:22528
  ds_read_b64_tr_b16 a[48:49], v7 offset:24576
  v_permlane16_swap_b32 v50, v51
  v_max_f32 v50, v50, v51
  v_mov_b32 v51, v50
  v_mfma_f32_16x16x32_bf16 v[52:55], a[72:75], v[112:115], v[52:55]
  ds_read_b128 v[100:103], v2 offset:2048
  ds_read_b64_tr_b16 a[50:51], v7 offset:26624
  v_permlane32_swap_b32 v50, v51
  v_max_f32 v50, v50, v51
  v_mfma_f32_16x16x32_bf16 v[60:63], a[76:79], v[112:115], v[60:63]
  ds_read_b64_tr_b16 a[52:53], v8 offset:24576
  s_lshl_b32 s57, s44, 28
  s_add_u32 s57, s57, s77
  buffer_load_dword v13, v14, s[8:11], s57 offen sc1
  v_sub_f32 v48, v48, v50
  v_sub_f32 v49, v49, v50
  v_mfma_f32_16x16x32_bf16 v[60:63], a[88:91], v[108:111], v[60:63]
  ds_read_b128 v[104:107], v2 offset:3072
  ds_read_b64_tr_b16 a[54:55], v8 offset:26624
  ds_read_b64_tr_b16 a[56:57], v7 offset:28672
  v_exp_f32 v48, v48
  v_mfma_f32_16x16x32_bf16 v[68:71], a[92:95], v[108:111], v[68:71]
  ds_read_b64_tr_b16 a[58:59], v7 offset:30720
  v_exp_f32 v49, v49
  s_waitcnt vmcnt(10) lgkmcnt(15)
  s_barrier
  v_mfma_f32_16x16x32_bf16 v[68:71], a[80:83], v[112:115], v[68:71]
  s_waitcnt lgkmcnt(10)
  ds_read_b128 v[92:95], v2 offset:10240
  ds_read_b64_tr_b16 a[60:61], v8 offset:28672
HOP4:
  s_cbranch_execz HOP8
  s_add_u32 m0, s45, 0
  s_add_u32 s68, s67, 5
  s_and_b32 s68, s68, 7
  s_mul_i32 s68, s68, 262144
  v_mfma_f32_16x16x32_bf16 v[56:59], a[96:99], v[76:79], v[56:59]
  ds_read_b64_tr_b16 a[62:63], v8 offset:30720
  ds_read_b64_tr_b16 a[64:65], v7 offset:32768
  buffer_load_dwordx4 v10, s[16:19], s68 offen lds
  v_add_f32 v50, v48, v49
  v_mov_b32 v51, v50
  v_mfma_f32_16x16x32_bf16 v[56:59], a[108:111], v[80:83], v[56:59]
  ds_read_b128 v[96:99], v2 offset:11264
  ds_read_b64_tr_b16 a[66:67], v7 offset:34816
  v_permlane16_swap_b32 v50, v51
  v_add_f32 v50, v50, v51
  v_mov_b32 v51, v50
  v_mfma_f32_16x16x32_bf16 v[52:55], a[108:111], v[88:91], v[52:55]
  ds_read_b64_tr_b16 a[68:69], v8 offset:32768
  s_add_u32 m0, s45, 4096
  s_add_u32 s68, s68, 65536
  v_permlane32_swap_b32 v50, v51
  v_add_f32 v50, v50, v51
  v_mfma_f32_16x16x32_bf16 v[52:55], a[96:99], v[84:87], v[52:55]
  ds_read_b128 v[108:111], v2 offset:4096
  ds_read_b64_tr_b16 a[70:71], v8 offset:34816
  ds_read_b64_tr_b16 a[72:73], v7 offset:36864
  buffer_load_dwordx4 v10, s[16:19], s68 offen lds
  v_mfma_f32_16x16x32_bf16 v[60:63], a[100:103], v[84:87], v[60:63]
  ds_read_b64_tr_b16 a[74:75], v7 offset:38912
  s_add_u32 m0, s45, 8192
  s_add_u32 s68, s68, 65536
  v_rcp_f32 v50, v50
  v_mfma_f32_16x16x32_bf16 v[60:63], a[112:115], v[88:91], v[60:63]
  ds_read_b128 v[112:115], v2 offset:5120
  ds_read_b64_tr_b16 a[76:77], v8 offset:36864
  buffer_load_dwordx4 v10, s[16:19], s68 offen lds
  v_mul_f32 v48, v48, v50
  v_mul_f32 v49, v49, v50
  v_mfma_f32_16x16x32_bf16 v[68:71], a[116:119], v[88:91], v[68:71]
  ds_read_b64_tr_b16 a[78:79], v8 offset:38912
  ds_read_b64_tr_b16 a[80:81], v7 offset:40960
  s_add_u32 m0, s45, 12288
  s_add_u32 s68, s68, 65536
  v_cvt_pk_bf16_f32 v48, v48, v48
  v_cvt_pk_bf16_f32 v49, v49, v49
  v_mfma_f32_16x16x32_bf16 v[68:71], a[104:107], v[84:87], v[68:71]
  s_waitcnt lgkmcnt(10)
  ds_read_b128 v[76:79], v2 offset:12288
  ds_read_b64_tr_b16 a[82:83], v7 offset:43008
  buffer_load_dwordx4 v10, s[16:19], s68 offen lds
  v_and_b32 v28, v24, v48
  v_and_b32 v29, v25, v49
  v_mfma_f32_16x16x32_bf16 v[56:59], a[120:123], v[92:95], v[56:59]
  ds_read_b64_tr_b16 a[84:85], v8 offset:40960
  s_add_u32 m0, s70, 16384
  s_add_u32 s69, s61, 229376
  v_and_b32 v30, v26, v48
  v_and_b32 v31, v27, v49
  v_mfma_f32_16x16x32_bf16 v[56:59], a[132:135], v[96:99], v[56:59]
  ds_read_b128 v[80:83], v2 offset:13312
  ds_read_b64_tr_b16 a[86:87], v8 offset:43008
  ds_read_b64_tr_b16 a[88:89], v7 offset:45056
  buffer_load_dwordx4 v12, s[8:11], s69 offen offset:0 sc1 lds
  v_mfma_f32_16x16x32_bf16 v[32:35], v[40:43], v[28:31], 0
  v_mfma_f32_16x16x32_bf16 v[36:39], v[44:47], v[28:31], 0
  v_mfma_f32_16x16x32_bf16 v[52:55], a[132:135], v[104:107], v[52:55]
  ds_read_b64_tr_b16 a[90:91], v7 offset:47104
  v_mfma_f32_16x16x32_bf16 v[52:55], a[120:123], v[100:103], v[52:55]
  ds_read_b128 v[88:91], v2 offset:6144
  ds_read_b64_tr_b16 a[92:93], v8 offset:45056
  buffer_load_dwordx4 v12, s[8:11], s69 offen offset:1024 sc1 lds
  v_mfma_f32_16x16x32_bf16 v[60:63], a[124:127], v[100:103], v[60:63]
  ds_read_b64_tr_b16 a[94:95], v8 offset:47104
  ds_read_b64_tr_b16 a[96:97], v4 offset:32768
  v_mfma_f32_16x16x32_bf16 v[60:63], a[136:139], v[104:107], v[60:63]
  ds_read_b128 v[84:87], v2 offset:7168
  ds_read_b64_tr_b16 a[98:99], v4 offset:34816
  v_cvt_pk_bf16_f32 v116, v32, v33
  v_cvt_pk_bf16_f32 v117, v34, v35
  v_cvt_pk_bf16_f32 v118, v36, v37
  v_mfma_f32_16x16x32_bf16 v[68:71], a[140:143], v[104:107], v[68:71]
  ds_read_b64_tr_b16 a[100:101], v5 offset:32768
  buffer_load_dwordx4 v12, s[8:11], s69 offen offset:2048 sc1 lds
  v_cvt_pk_bf16_f32 v119, v38, v39
  v_mfma_f32_16x16x32_bf16 v[68:71], a[128:131], v[100:103], v[68:71]
  s_waitcnt lgkmcnt(10)
  ds_read_b128 v[92:95], v2 offset:14336
  ds_read_b64_tr_b16 a[102:103], v5 offset:34816
  ds_read_b64_tr_b16 a[104:105], v4 offset:36864
  v_mfma_f32_16x16x32_bf16 v[56:59], a[144:147], v[76:79], v[56:59]
  ds_read_b64_tr_b16 a[106:107], v4 offset:38912
  buffer_load_dwordx4 v12, s[8:11], s69 offen offset:3072 sc1 lds
  v_mfma_f32_16x16x32_bf16 v[56:59], a[156:159], v[80:83], v[56:59]
  ds_read_b128 v[96:99], v2 offset:15360
  ds_read_b64_tr_b16 a[108:109], v5 offset:36864
  v_lshlrev_b32 v21, 7, v0
  v_add_u32 v21, 720896, v21
  buffer_store_dwordx4 v[116:119], v1, s[8:11], s73 offen sc1
  v_mfma_f32_16x16x32_bf16 v[52:55], a[156:159], v[112:115], v[52:55]
  ds_read_b64_tr_b16 a[110:111], v5 offset:38912
  ds_read_b64_tr_b16 a[112:113], v4 offset:40960
  s_waitcnt vmcnt(9)
  s_cmp_lg_u32 s44, 0
  s_cbranch_scc1 PL5_adaLN_cond__sliding_local_dilated__swiglu_ffn__prompt_kernelx
  v_subrev_u32 v13, s46, v13
  v_subrev_u32 v13, 1, v13
  v_cmp_lt_u32 vcc, 3, v13
  s_nop 4
  s_cbranch_vccz PL5_adaLN_cond__sliding_local_dilated__swiglu_ffn__prompt_kernelx
  s_mov_b32 s57, 60000
PL5_adaLN_cond__sliding_local_dilated__swiglu_ffn__prompt_kernel:
  buffer_load_dword v13, v14, s[8:11], s77 offen sc1
  s_sub_u32 s57, s57, 1
  s_cmp_eq_u32 s57, 0
  s_waitcnt vmcnt(0)
  s_cbranch_scc1 PL5_adaLN_cond__sliding_local_dilated__swiglu_ffn__prompt_kernelx
  v_subrev_u32 v13, s46, v13
  v_subrev_u32 v13, 1, v13
  v_cmp_lt_u32 vcc, 3, v13
  s_nop 4
  s_cbranch_vccnz PL5_adaLN_cond__sliding_local_dilated__swiglu_ffn__prompt_kernel
PL5_adaLN_cond__sliding_local_dilated__swiglu_ffn__prompt_kernelx:
  s_waitcnt vmcnt(5) lgkmcnt(12)
  s_barrier
  v_mfma_f32_16x16x32_bf16 v[52:55], a[144:147], v[108:111], v[52:55]
  ds_read_b128 v[104:107], v1 offset:49152
  ds_read_b64_tr_b16 a[114:115], v4 offset:43008
  s_mov_b32 m0, s51
  s_add_u32 s73, s73, 65536
  v_mfma_f32_16x16x32_bf16 v[60:63], a[148:151], v[108:111], v[60:63]
  ds_read_b64_tr_b16 a[116:117], v5 offset:40960
  s_mov_b32 s57, 32768
  v_writelane_b32 v14, s57, 16
  buffer_load_dwordx4 v1, s[8:11], s50 offen sc1 lds
  v_mfma_f32_16x16x32_bf16 v[60:63], a[160:163], v[112:115], v[60:63]
  ds_read_b128 v[100:103], v1 offset:50176
  ds_read_b64_tr_b16 a[118:119], v5 offset:43008
  ds_read_b64_tr_b16 a[120:121], v4 offset:45056
  v_mfma_f32_16x16x32_bf16 v[68:71], a[164:167], v[112:115], v[68:71]
  ds_read_b64_tr_b16 a[122:123], v4 offset:47104
  s_add_u32 m0, s45, 81920
  s_add_u32 s68, s67, 6
  s_and_b32 s68, s68, 7
  s_mul_i32 s68, s68, 262144
  v_mfma_f32_16x16x32_bf16 v[68:71], a[152:155], v[108:111], v[68:71]
  s_waitcnt lgkmcnt(10)
  ds_read_b128 v[76:79], v1 offset:57344
  ds_read_b64_tr_b16 a[124:125], v5 offset:45056
  buffer_load_dwordx4 v10, s[16:19], s68 offen lds
  v_mfma_f32_16x16x32_bf16 v[56:59], a[168:171], v[92:95], v[56:59]
  ds_read_b64_tr_b16 a[126:127], v5 offset:47104
  ds_read_b64_tr_b16 a[128:129], v7 offset:49152
  s_add_u32 m0, s45, 86016
  s_add_u32 s68, s68, 65536
  v_mfma_f32_16x16x32_bf16 v[56:59], a[180:183], v[96:99], v[56:59]
  ds_read_b128 v[80:83], v1 offset:58368
  ds_read_b64_tr_b16 a[130:131], v7 offset:51200
  buffer_load_dwordx4 v10, s[16:19], s68 offen lds
  v_mfma_f32_16x16x32_bf16 v[52:55], a[180:183], v[84:87], v[52:55]
  ds_read_b64_tr_b16 a[132:133], v8 offset:49152
  s_add_u32 m0, s45, 90112
  s_add_u32 s68, s68, 65536
  v_mfma_f32_16x16x32_bf16 v[52:55], a[168:171], v[88:91], v[52:55]
  ds_read_b128 v[112:115], v1 offset:51200
  ds_read_b64_tr_b16 a[134:135], v8 offset:51200
  ds_read_b64_tr_b16 a[136:137], v7 offset:53248
  buffer_load_dwordx4 v10, s[16:19], s68 offen lds
  v_mfma_f32_16x16x32_bf16 v[60:63], a[172:175], v[88:91], v[60:63]
  ds_read_b64_tr_b16 a[138:139], v7 offset:55296
  s_add_u32 m0, s45, 94208
  s_add_u32 s68, s68, 65536
  v_mfma_f32_16x16x32_bf16 v[60:63], a[184:187], v[84:87], v[60:63]
  ds_read_b128 v[108:111], v1 offset:52224
  ds_read_b64_tr_b16 a[140:141], v8 offset:53248
  buffer_load_dwordx4 v10, s[16:19], s68 offen lds
  v_mfma_f32_16x16x32_bf16 v[68:71], a[188:191], v[84:87], v[68:71]
  ds_read_b64_tr_b16 a[142:143], v8 offset:55296
  ds_read_b64_tr_b16 a[144:145], v7 offset:57344
  s_add_u32 m0, s70, 98304
  s_add_u32 s69, s62, 0
  v_mfma_f32_16x16x32_bf16 v[68:71], a[176:179], v[88:91], v[68:71]
  s_waitcnt lgkmcnt(10)
  ds_read_b128 v[92:95], v1 offset:59392
  ds_read_b64_tr_b16 a[146:147], v7 offset:59392
  buffer_load_dwordx4 v9, s[8:11], s69 offen offset:0 sc1 lds
  v_mfma_f32_16x16x32_bf16 v[56:59], a[192:195], v[76:79], v[56:59]
  ds_read_b64_tr_b16 a[148:149], v8 offset:57344
  v_mfma_f32_16x16x32_bf16 v[56:59], a[204:207], v[80:83], v[56:59]
  ds_read_b128 v[96:99], v1 offset:60416
  ds_read_b64_tr_b16 a[150:151], v8 offset:59392
  ds_read_b64_tr_b16 a[152:153], v7 offset:61440
  v_mfma_f32_16x16x32_bf16 v[52:55], a[204:207], v[100:103], v[52:55]
  ds_read_b64_tr_b16 a[154:155], v7 offset:63488
  buffer_load_dwordx4 v9, s[8:11], s69 offen offset:1024 sc1 lds
  v_mfma_f32_16x16x32_bf16 v[52:55], a[192:195], v[104:107], v[52:55]
  ds_read_b128 v[84:87], v1 offset:53248
  ds_read_b64_tr_b16 a[156:157], v8 offset:61440
  v_mfma_f32_16x16x32_bf16 v[60:63], a[196:199], v[104:107], v[60:63]
  ds_read_b64_tr_b16 a[158:159], v8 offset:63488
  buffer_load_dwordx4 v9, s[8:11], s69 offen offset:2048 sc1 lds
  v_mfma_f32_16x16x32_bf16 v[60:63], a[208:211], v[100:103], v[60:63]
  ds_read_b128 v[88:91], v1 offset:54272
  v_mfma_f32_16x16x32_bf16 v[68:71], a[212:215], v[100:103], v[68:71]
  ds_read_b64_tr_b16 a[160:161], v4 offset:0
  buffer_load_dwordx4 v9, s[8:11], s69 offen offset:3072 sc1 lds
  v_mfma_f32_16x16x32_bf16 v[68:71], a[200:203], v[104:107], v[68:71]
  s_waitcnt lgkmcnt(8)
  ds_read_b128 v[76:79], v1 offset:61440
  v_mfma_f32_16x16x32_bf16 v[56:59], a[216:219], v[92:95], v[56:59]
  ds_read_b64_tr_b16 a[162:163], v4 offset:2048
  v_mfma_f32_16x16x32_bf16 v[56:59], a[228:231], v[96:99], v[56:59]
  ds_read_b128 v[80:83], v1 offset:62464
  s_waitcnt vmcnt(9) lgkmcnt(15)
  s_barrier
  v_add_u32 v15, s46, v0
  v_add_u32 v15, 2, v15
  s_mov_b64 exec, 1
  buffer_store_dword v15, v0, s[8:11], s74 offen offset:0 sc1
  s_mov_b64 exec, -1
  v_mfma_f32_16x16x32_bf16 v[52:55], a[228:231], v[108:111], v[52:55]
  ds_read_b64_tr_b16 a[164:165], v5 offset:0
  s_add_u32 m0, s45, 65536
  s_add_u32 s68, s67, 7
  s_and_b32 s68, s68, 7
  s_mul_i32 s68, s68, 262144
  v_mfma_f32_16x16x32_bf16 v[52:55], a[216:219], v[112:115], v[52:55]
  ds_read_b128 v[100:103], v1 offset:55296
  buffer_load_dwordx4 v10, s[16:19], s68 offen lds
  v_mfma_f32_16x16x32_bf16 v[60:63], a[220:223], v[112:115], v[60:63]
  ds_read_b64_tr_b16 a[166:167], v5 offset:2048
  v_mfma_f32_16x16x32_bf16 v[60:63], a[232:235], v[108:111], v[60:63]
  ds_read_b128 v[104:107], v1 offset:56320
  s_add_u32 m0, s45, 69632
  s_add_u32 s68, s68, 65536
  v_mfma_f32_16x16x32_bf16 v[68:71], a[236:239], v[108:111], v[68:71]
  ds_read_b64_tr_b16 a[168:169], v4 offset:4096
  buffer_load_dwordx4 v10, s[16:19], s68 offen lds
  v_mfma_f32_16x16x32_bf16 v[68:71], a[224:227], v[112:115], v[68:71]
  s_waitcnt lgkmcnt(5)
  ds_read_b128 v[92:95], v1 offset:63488
  s_add_u32 m0, s45, 73728
  s_add_u32 s68, s68, 65536
  v_mfma_f32_16x16x32_bf16 v[56:59], a[240:243], v[76:79], v[56:59]
  ds_read_b64_tr_b16 a[170:171], v4 offset:6144
  buffer_load_dwordx4 v10, s[16:19], s68 offen lds
  v_mfma_f32_16x16x32_bf16 v[56:59], v[124:127], v[80:83], v[56:59]
  ds_read_b128 v[96:99], v1 offset:64512
  s_add_u32 m0, s45, 77824
  s_add_u32 s68, s68, 65536
  v_mfma_f32_16x16x32_bf16 v[52:55], v[124:127], v[88:91], v[52:55]
  ds_read_b64_tr_b16 a[172:173], v5 offset:4096
  buffer_load_dwordx4 v10, s[16:19], s68 offen lds
  v_mfma_f32_16x16x32_bf16 v[52:55], a[240:243], v[84:87], v[52:55]
  ds_read_b128 v[108:111], v1 offset:16384
  s_add_u32 m0, s70, 32768
  s_add_u32 s69, s63, 0
  v_mfma_f32_16x16x32_bf16 v[60:63], a[244:247], v[84:87], v[60:63]
  ds_read_b64_tr_b16 a[174:175], v5 offset:6144
  buffer_load_dwordx4 v9, s[8:11], s69 offen offset:0 sc1 lds
  v_mfma_f32_16x16x32_bf16 v[60:63], v[128:131], v[88:91], v[60:63]
  ds_read_b128 v[112:115], v1 offset:17408
  s_lshl_b32 s57, s44, 28
  buffer_load_dwordx4 v[116:119], v21, s[8:11], s57 offen sc1
  v_mfma_f32_16x16x32_bf16 v[68:71], v[132:135], v[88:91], v[68:71]
  ds_read_b64_tr_b16 a[176:177], v4 offset:8192
  buffer_load_dwordx4 v9, s[8:11], s69 offen offset:1024 sc1 lds
  v_mfma_f32_16x16x32_bf16 v[68:71], a[248:251], v[84:87], v[68:71]
  s_waitcnt lgkmcnt(5)
  ds_read_b128 v[76:79], v1 offset:24576
  v_mfma_f32_16x16x32_bf16 v[56:59], v[136:139], v[92:95], v[56:59]
  ds_read_b64_tr_b16 a[178:179], v4 offset:10240
  v_mfma_f32_16x16x32_bf16 v[56:59], v[148:151], v[96:99], v[56:59]
  ds_read_b128 v[80:83], v1 offset:25600
  buffer_load_dwordx4 v9, s[8:11], s69 offen offset:2048 sc1 lds
  v_mfma_f32_16x16x32_bf16 v[52:55], v[148:151], v[104:107], v[52:55]
  ds_read_b64_tr_b16 a[180:181], v5 offset:8192
  v_mfma_f32_16x16x32_bf16 v[52:55], v[136:139], v[100:103], v[52:55]
  ds_read_b128 v[88:91], v1 offset:18432
  buffer_load_dwordx4 v9, s[8:11], s69 offen offset:3072 sc1 lds
  s_waitcnt vmcnt(14) lgkmcnt(15)
  s_barrier
  v_mfma_f32_16x16x32_bf16 v[60:63], v[140:143], v[100:103], v[60:63]
  ds_read_b64_tr_b16 a[182:183], v5 offset:10240
  s_add_u32 m0, s70, 114688
  s_add_u32 s69, s64, 0
  v_mfma_f32_16x16x32_bf16 v[60:63], v[152:155], v[104:107], v[60:63]
  ds_read_b128 v[84:87], v1 offset:19456
  buffer_load_dwordx4 v9, s[8:11], s69 offen offset:0 sc1 lds
  v_mfma_f32_16x16x32_bf16 v[68:71], v[156:159], v[104:107], v[68:71]
  ds_read_b64_tr_b16 a[184:185], v4 offset:12288
  v_mfma_f32_16x16x32_bf16 v[68:71], v[144:147], v[100:103], v[68:71]
  s_waitcnt lgkmcnt(5)
  ds_read_b128 v[92:95], v1 offset:26624
  buffer_load_dwordx4 v9, s[8:11], s69 offen offset:1024 sc1 lds
  v_mfma_f32_16x16x32_bf16 v[56:59], v[160:163], v[76:79], v[56:59]
  ds_read_b64_tr_b16 a[186:187], v4 offset:14336
  v_mfma_f32_16x16x32_bf16 v[56:59], v[172:175], v[80:83], v[56:59]
  ds_read_b128 v[96:99], v1 offset:27648
  buffer_load_dwordx4 v9, s[8:11], s69 offen offset:2048 sc1 lds
  v_mfma_f32_16x16x32_bf16 v[52:55], v[172:175], v[112:115], v[52:55]
  ds_read_b64_tr_b16 a[188:189], v5 offset:12288
  v_mfma_f32_16x16x32_bf16 v[52:55], v[160:163], v[108:111], v[52:55]
  ds_read_b128 v[104:107], v1 offset:20480
  v_mfma_f32_16x16x32_bf16 v[60:63], v[164:167], v[108:111], v[60:63]
  ds_read_b64_tr_b16 a[190:191], v5 offset:14336
  buffer_load_dwordx4 v9, s[8:11], s69 offen offset:3072 sc1 lds
  s_add_u32 m0, s70, 49152
  s_add_u32 s69, s65, 0
  v_mfma_f32_16x16x32_bf16 v[60:63], v[176:179], v[112:115], v[60:63]
  ds_read_b128 v[100:103], v1 offset:21504
  ds_read_b64_tr_b16 a[192:193], v7 offset:16384
  v_mfma_f32_16x16x32_bf16 v[68:71], v[180:183], v[112:115], v[68:71]
  ds_read_b64_tr_b16 a[194:195], v7 offset:18432
  buffer_load_dwordx4 v9, s[8:11], s69 offen offset:0 sc1 lds
  v_mfma_f32_16x16x32_bf16 v[68:71], v[168:171], v[108:111], v[68:71]
  s_waitcnt lgkmcnt(6)
  ds_read_b128 v[76:79], v1 offset:28672
  ds_read_b64_tr_b16 a[196:197], v8 offset:16384
  v_mfma_f32_16x16x32_bf16 v[56:59], v[184:187], v[92:95], v[56:59]
  ds_read_b64_tr_b16 a[198:199], v8 offset:18432
  ds_read_b64_tr_b16 a[200:201], v7 offset:20480
  buffer_load_dwordx4 v9, s[8:11], s69 offen offset:1024 sc1 lds
  v_mfma_f32_16x16x32_bf16 v[56:59], v[196:199], v[96:99], v[56:59]
  ds_read_b128 v[80:83], v1 offset:29696
  ds_read_b64_tr_b16 a[202:203], v7 offset:22528
  v_mfma_f32_16x16x32_bf16 v[52:55], v[196:199], v[84:87], v[52:55]
  ds_read_b64_tr_b16 a[204:205], v8 offset:20480
  buffer_load_dwordx4 v9, s[8:11], s69 offen offset:2048 sc1 lds
  v_mfma_f32_16x16x32_bf16 v[52:55], v[184:187], v[88:91], v[52:55]
  ds_read_b128 v[112:115], v1 offset:22528
  ds_read_b64_tr_b16 a[206:207], v8 offset:22528
  ds_read_b64_tr_b16 a[208:209], v7 offset:24576
  v_mfma_f32_16x16x32_bf16 v[60:63], v[188:191], v[88:91], v[60:63]
  ds_read_b64_tr_b16 a[210:211], v7 offset:26624
  buffer_load_dwordx4 v9, s[8:11], s69 offen offset:3072 sc1 lds
  v_mfma_f32_16x16x32_bf16 v[60:63], v[200:203], v[84:87], v[60:63]
  ds_read_b128 v[108:111], v1 offset:23552
  ds_read_b64_tr_b16 a[212:213], v8 offset:24576
  v_mfma_f32_16x16x32_bf16 v[68:71], v[204:207], v[84:87], v[68:71]
  ds_read_b64_tr_b16 a[214:215], v8 offset:26624
  ds_read_b64_tr_b16 a[216:217], v7 offset:28672
  v_mfma_f32_16x16x32_bf16 v[68:71], v[192:195], v[88:91], v[68:71]
  s_waitcnt lgkmcnt(10)
  ds_read_b128 v[92:95], v1 offset:30720
  ds_read_b64_tr_b16 a[218:219], v7 offset:30720
  s_waitcnt vmcnt(11)
  s_cmp_lg_u32 s44, 0
  s_cbranch_scc1 PL6_adaLN_cond__sliding_local_dilated__swiglu_ffn__prompt_kernelx
  v_bitop3_b32 v116, v116, v117, s46 bitop3:0x7e
  v_bitop3_b32 v118, v118, v119, s46 bitop3:0x7e
  v_or_b32 v116, v116, v118
  v_cmp_ne_u32 vcc, 0, v116
  s_nop 4
  s_cbranch_vccz PL6_adaLN_cond__sliding_local_dilated__swiglu_ffn__prompt_kernelx
  s_mov_b32 s57, 60000
PL6_adaLN_cond__sliding_local_dilated__swiglu_ffn__prompt_kernel:
  buffer_load_dwordx4 v[116:119], v21, s[8:11], 0 offen sc1
  s_sub_u32 s57, s57, 1
  s_cmp_eq_u32 s57, 0
  s_waitcnt vmcnt(0)
  s_cbranch_scc1 PL6_adaLN_cond__sliding_local_dilated__swiglu_ffn__prompt_kernelx
  v_bitop3_b32 v116, v116, v117, s46 bitop3:0x7e
  v_bitop3_b32 v118, v118, v119, s46 bitop3:0x7e
  v_or_b32 v116, v116, v118
  v_cmp_ne_u32 vcc, 0, v116
  s_nop 4
  s_cbranch_vccnz PL6_adaLN_cond__sliding_local_dilated__swiglu_ffn__prompt_kernel
PL6_adaLN_cond__sliding_local_dilated__swiglu_ffn__prompt_kernelx:
  s_waitcnt vmcnt(8) lgkmcnt(15)
  s_barrier
  v_mfma_f32_16x16x32_bf16 v[56:59], v[208:211], v[76:79], v[56:59]
  ds_read_b128 v[84:87], v23 offset:32768
  ds_read_b64_tr_b16 a[220:221], v8 offset:28672
  s_add_u32 m0, s70, 0
  s_add_u32 s69, s62, 65536
  v_mfma_f32_16x16x32_bf16 v[56:59], v[220:223], v[80:83], v[56:59]
  ds_read_b128 v[96:99], v1 offset:31744
  ds_read_b64_tr_b16 a[222:223], v8 offset:30720
  ds_read_b64_tr_b16 a[224:225], v7 offset:0
  v_and_b32 v21, 31, v0
  v_lshlrev_b32 v21, 2, v21
  v_lshrrev_b32 v181, 5, v0
  v_lshl_add_u32 v21, v181, 13, v21
  buffer_load_dwordx4 v9, s[8:11], s69 offen offset:0 sc1 lds
  v_mfma_f32_16x16x32_bf16 v[52:55], v[220:223], v[100:103], v[52:55]
  ds_read_b128 v[88:91], v23 offset:33792
  ds_read_b64_tr_b16 a[226:227], v7 offset:2048
  v_mfma_f32_16x16x32_bf16 v[52:55], v[208:211], v[104:107], v[52:55]
  ds_read_b64_tr_b16 a[228:229], v8 offset:0
  v_mfma_f32_16x16x32_bf16 v[60:63], v[212:215], v[104:107], v[60:63]
  ds_read_b128 v[76:79], v23 offset:34816
  ds_read_b64_tr_b16 a[230:231], v8 offset:2048
  ds_read_b64_tr_b16 a[232:233], v7 offset:4096
  buffer_load_dwordx4 v9, s[8:11], s69 offen offset:1024 sc1 lds
  v_mfma_f32_16x16x32_bf16 v[60:63], v[224:227], v[100:103], v[60:63]
  ds_read_b64_tr_b16 a[234:235], v7 offset:6144
  v_mfma_f32_16x16x32_bf16 v[68:71], v[228:231], v[100:103], v[68:71]
  ds_read_b128 v[80:83], v23 offset:35840
  ds_read_b64_tr_b16 a[236:237], v8 offset:4096
  buffer_load_dwordx4 v9, s[8:11], s69 offen offset:2048 sc1 lds
  v_mfma_f32_16x16x32_bf16 v[68:71], v[216:219], v[104:107], v[68:71]
  s_waitcnt lgkmcnt(11)
  ds_read_b64_tr_b16 a[238:239], v8 offset:6144
  ds_read_b64_tr_b16 a[240:241], v7 offset:8192
  v_mfma_f32_16x16x32_bf16 v[56:59], v[232:235], v[92:95], v[56:59]
  ds_read_b128 v[100:103], v23 offset:36864
  ds_read_b64_tr_b16 a[242:243], v7 offset:10240
  buffer_load_dwordx4 v9, s[8:11], s69 offen offset:3072 sc1 lds
  v_mfma_f32_16x16x32_bf16 v[56:59], v[244:247], v[96:99], v[56:59]
  ds_read_b64_tr_b16 a[244:245], v8 offset:8192
  s_add_u32 s56, s76, 8192
  v_mfma_f32_16x16x32_bf16 v[52:55], v[244:247], v[108:111], v[52:55]
  ds_read_b128 v[104:107], v23 offset:37888
  ds_read_b64_tr_b16 a[246:247], v8 offset:10240
  ds_read_b64_tr_b16 a[248:249], v7 offset:12288
  buffer_load_dword v160, v21, s[8:11], s56 offen sc1
  s_add_u32 s56, s76, 32768
  v_mfma_f32_16x16x32_bf16 v[52:55], v[232:235], v[112:115], v[52:55]
  ds_read_b64_tr_b16 a[250:251], v7 offset:14336
  buffer_load_dword v161, v21, s[8:11], s56 offen sc1
  s_add_u32 s56, s76, 57344
  v_mfma_f32_16x16x32_bf16 v[60:63], v[236:239], v[112:115], v[60:63]
  ds_read_b128 v[92:95], v23 offset:38912
  ds_read_b64_tr_b16 v[124:125], v8 offset:12288
  buffer_load_dword v162, v21, s[8:11], s56 offen sc1
  v_mfma_f32_16x16x32_bf16 v[60:63], v[248:251], v[108:111], v[60:63]
  ds_read_b64_tr_b16 v[126:127], v8 offset:14336
  s_add_u32 s56, s76, 81920
  v_mfma_f32_16x16x32_bf16 v[68:71], v[252:255], v[108:111], v[68:71]
  ds_read_b128 v[96:99], v23 offset:39936
  buffer_load_dword v163, v21, s[8:11], s56 offen sc1
  s_add_u32 s56, s47, 41943040
  v_mfma_f32_16x16x32_bf16 v[68:71], v[240:243], v[112:115], v[68:71]
  s_waitcnt lgkmcnt(14)
  buffer_load_dwordx4 v[144:147], v1, s[8:11], s56 offen sc1
  s_add_u32 s56, s47, 42008576
  v_mfma_f32_16x16x32_bf16 v[128:131], a[0:3], v[84:87], 0
  ds_read_b128 v[108:111], v22 offset:32768
  buffer_load_dwordx4 v[148:151], v1, s[8:11], s56 offen sc1
  s_add_u32 s56, s47, 42074112
  v_mfma_f32_16x16x32_bf16 v[128:131], a[8:11], v[88:91], v[128:131]
  buffer_load_dwordx4 v[152:155], v1, s[8:11], s56 offen sc1
  s_add_u32 s56, s47, 42139648
  v_mfma_f32_16x16x32_bf16 v[132:135], a[12:15], v[88:91], 0
  ds_read_b128 v[112:115], v22 offset:33792
  s_lshr_b32 s79, s2, 6
  s_lshl_b32 s79, s79, 2
  s_add_u32 s79, s79, s44
  s_lshl_b32 s79, s79, 8
  v_mfma_f32_16x16x32_bf16 v[132:135], a[4:7], v[84:87], v[132:135]
  buffer_load_dwordx4 v[156:159], v1, s[8:11], s56 offen sc1
  v_cvt_pk_bf16_f32 v52, v52, v53
  v_cvt_pk_bf16_f32 v53, v54, v55
  v_mfma_f32_16x16x32_bf16 v[128:131], a[16:19], v[76:79], v[128:131]
  ds_read_b128 v[88:91], v22 offset:34816
  ds_write_b64 v18, v[52:53] offset:6144
  v_mfma_f32_16x16x32_bf16 v[128:131], a[24:27], v[80:83], v[128:131]
  v_cvt_pk_bf16_f32 v60, v60, v61
  v_cvt_pk_bf16_f32 v61, v62, v63
  v_cvt_pk_bf16_f32 v62, v68, v69
  v_cvt_pk_bf16_f32 v63, v70, v71
  v_mfma_f32_16x16x32_bf16 v[132:135], a[28:31], v[80:83], v[132:135]
  ds_read_b128 v[84:87], v22 offset:35840
  s_lshl_b32 s57, s44, 28
  s_add_u32 s57, s57, s77
  buffer_load_dword v13, v14, s[8:11], s57 offen sc1
  v_mfma_f32_16x16x32_bf16 v[132:135], a[20:23], v[76:79], v[132:135]
  s_waitcnt lgkmcnt(5)
  ds_write_b128 v17, v[60:63] offset:7168
  v_mfma_f32_16x16x32_bf16 v[128:131], a[32:35], v[100:103], v[128:131]
  ds_read_b128 v[80:83], v22 offset:36864
  v_cvt_pk_bf16_f32 v56, v56, v57
  v_cvt_pk_bf16_f32 v57, v58, v59
  v_mfma_f32_16x16x32_bf16 v[128:131], a[40:43], v[104:107], v[128:131]
  ds_write_b64 v18, v[56:57] offset:18432
  v_mfma_f32_16x16x32_bf16 v[132:135], a[44:47], v[104:107], v[132:135]
  ds_read_b128 v[76:79], v22 offset:37888
  v_mfma_f32_16x16x32_bf16 v[132:135], a[36:39], v[100:103], v[132:135]
  s_bitcmp1_b32 s44, 0
  s_mov_b32 s52, 6144
  s_cselect_b32 s52, 18432, s52
  s_mov_b32 s53, 0
  s_cselect_b32 s53, 6144, s53
  v_add_u32 v116, s52, v19
  v_mfma_f32_16x16x32_bf16 v[128:131], a[48:51], v[92:95], v[128:131]
  ds_read_b128 v[104:107], v22 offset:38912
  v_add_u32 v117, s53, v19
  v_add_u32 v118, s52, v20
  v_add_u32 v119, s53, v20
  v_mfma_f32_16x16x32_bf16 v[128:131], a[56:59], v[96:99], v[128:131]
  s_waitcnt vmcnt(13) lgkmcnt(2)
  s_barrier
  v_mfma_f32_16x16x32_bf16 v[132:135], a[60:63], v[96:99], v[132:135]
  ds_read_b128 v[100:103], v22 offset:39936
  s_add_u32 m0, s70, 81920
  s_add_u32 s69, s63, 65536
  ds_read_b128 v[52:55], v116
  ds_read_b128 v[56:59], v117 offset:1024
  v_mfma_f32_16x16x32_bf16 v[132:135], a[52:55], v[92:95], v[132:135]
  s_waitcnt lgkmcnt(8)
  buffer_load_dwordx4 v9, s[8:11], s69 offen offset:0 sc1 lds
  ds_read_b128 v[60:63], v116 offset:1024
  ds_read_b64_tr_b16 v[64:65], v119 offset:2048
  ds_read_b64_tr_b16 v[66:67], v118 offset:2048
  v_mfma_f32_16x16x32_bf16 v[128:131], a[64:67], v[108:111], v[128:131]
  ds_read_b128 v[96:99], v23 offset:49152
  ds_read_b64_tr_b16 v[68:69], v119 offset:2056
  ds_read_b64_tr_b16 v[70:71], v118 offset:2056
  v_mfma_f32_16x16x32_bf16 v[128:131], a[72:75], v[112:115], v[128:131]
  v_mfma_f32_16x16x32_bf16 v[132:135], a[76:79], v[112:115], v[132:135]
  ds_read_b128 v[92:95], v23 offset:50176
  v_mfma_f32_16x16x32_bf16 v[132:135], a[68:71], v[108:111], v[132:135]
  buffer_load_dwordx4 v9, s[8:11], s69 offen offset:1024 sc1 lds
  v_mfma_f32_16x16x32_bf16 v[128:131], a[80:83], v[88:91], v[128:131]
  ds_read_b128 v[112:115], v23 offset:51200
  v_mfma_f32_16x16x32_bf16 v[128:131], a[88:91], v[84:87], v[128:131]
  s_waitcnt lgkmcnt(2)
  v_mfma_f32_16x16x32_bf16 v[116:119], v[56:59], v[52:55], 0
  v_mfma_f32_16x16x32_bf16 v[120:123], v[60:63], v[52:55], 0
  v_mfma_f32_16x16x32_bf16 v[132:135], a[92:95], v[84:87], v[132:135]
  ds_read_b128 v[108:111], v23 offset:52224
  v_mfma_f32_16x16x32_bf16 v[132:135], a[84:87], v[88:91], v[132:135]
  s_waitcnt lgkmcnt(11)
  buffer_load_dwordx4 v9, s[8:11], s69 offen offset:2048 sc1 lds
  v_mfma_f32_16x16x32_bf16 v[128:131], a[96:99], v[80:83], v[128:131]
  ds_read_b128 v[84:87], v23 offset:53248
  v_mfma_f32_16x16x32_bf16 v[128:131], a[104:107], v[76:79], v[128:131]
  v_cndmask_b32 v72, v116, v120, s[80:81]
  v_cndmask_b32 v73, v117, v121, s[82:83]
  v_cndmask_b32 v74, v118, v122, s[84:85]
  v_cndmask_b32 v75, v119, v123, s[86:87]
  v_cndmask_b32 v72, v72, v73, s[88:89]
  v_cndmask_b32 v73, v74, v75, s[88:89]
  v_mul_f32 v72, 0x3e8293ee, v72
  v_mfma_f32_16x16x32_bf16 v[132:135], a[108:111], v[76:79], v[132:135]
  ds_read_b128 v[88:91], v23 offset:54272
  v_mul_f32 v73, 0x3e8293ee, v73
  v_max_f32 v74, v72, v73
  v_mov_b32 v75, v74
  v_mfma_f32_16x16x32_bf16 v[132:135], a[100:103], v[80:83], v[132:135]
  buffer_load_dwordx4 v9, s[8:11], s69 offen offset:3072 sc1 lds
  s_add_u32 m0, s70, 16384
  s_add_u32 s69, s64, 65536
  v_permlane16_swap_b32 v74, v75
  v_max_f32 v74, v74, v75
  v_mov_b32 v75, v74
  v_mfma_f32_16x16x32_bf16 v[128:131], a[112:115], v[104:107], v[128:131]
  ds_read_b128 v[76:79], v23 offset:55296
  v_permlane32_swap_b32 v74, v75
  v_max_f32 v74, v74, v75
  v_sub_f32 v72, v72, v74
  v_sub_f32 v73, v73, v74
  v_mfma_f32_16x16x32_bf16 v[128:131], a[120:123], v[100:103], v[128:131]
  buffer_load_dwordx4 v9, s[8:11], s69 offen offset:0 sc1 lds
  v_exp_f32 v72, v72
  v_exp_f32 v73, v73
  v_mfma_f32_16x16x32_bf16 v[132:135], a[124:127], v[100:103], v[132:135]
  ds_read_b128 v[80:83], v23 offset:56320
  v_add_f32 v74, v72, v73
  v_mov_b32 v75, v74
  v_mfma_f32_16x16x32_bf16 v[132:135], a[116:119], v[104:107], v[132:135]
  s_waitcnt lgkmcnt(4)
  v_permlane16_swap_b32 v74, v75
  v_add_f32 v74, v74, v75
  v_mov_b32 v75, v74
  v_mfma_f32_16x16x32_bf16 v[128:131], a[128:131], v[96:99], v[128:131]
  ds_read_b128 v[100:103], v22 offset:49152
  v_permlane32_swap_b32 v74, v75
  v_add_f32 v74, v74, v75
  v_rcp_f32 v74, v74
  v_mfma_f32_16x16x32_bf16 v[128:131], a[136:139], v[92:95], v[128:131]
  buffer_load_dwordx4 v9, s[8:11], s69 offen offset:1024 sc1 lds
  v_mul_f32 v72, v72, v74
  v_mul_f32 v73, v73, v74
  v_cvt_pk_bf16_f32 v72, v72, v72
  v_cvt_pk_bf16_f32 v73, v73, v73
  v_and_b32 v52, v24, v72
  v_and_b32 v53, v25, v73
  v_and_b32 v54, v26, v72
  v_mfma_f32_16x16x32_bf16 v[132:135], a[140:143], v[92:95], v[132:135]
  ds_read_b128 v[104:107], v22 offset:50176
HOP5:
  s_cbranch_execz HOP9
  v_and_b32 v55, v27, v73
  v_mfma_f32_16x16x32_bf16 v[132:135], a[132:135], v[96:99], v[132:135]
  s_nop 0
  v_mfma_f32_16x16x32_bf16 v[56:59], v[64:67], v[52:55], 0
  v_mfma_f32_16x16x32_bf16 v[60:63], v[68:71], v[52:55], 0
  v_mfma_f32_16x16x32_bf16 v[128:131], a[144:147], v[112:115], v[128:131]
  ds_read_b128 v[92:95], v22 offset:51200
  v_mfma_f32_16x16x32_bf16 v[128:131], a[152:155], v[108:111], v[128:131]
  buffer_load_dwordx4 v9, s[8:11], s69 offen offset:2048 sc1 lds
  v_mfma_f32_16x16x32_bf16 v[132:135], a[156:159], v[108:111], v[132:135]
  ds_read_b128 v[96:99], v22 offset:52224
  v_mfma_f32_16x16x32_bf16 v[132:135], a[148:151], v[112:115], v[132:135]
  s_waitcnt lgkmcnt(4)
  buffer_load_dwordx4 v9, s[8:11], s69 offen offset:3072 sc1 lds
  v_cvt_pk_bf16_f32 v116, v56, v57
  v_cvt_pk_bf16_f32 v117, v58, v59
  v_cvt_pk_bf16_f32 v118, v60, v61
  v_cvt_pk_bf16_f32 v119, v62, v63
  v_mfma_f32_16x16x32_bf16 v[128:131], a[160:163], v[84:87], v[128:131]
  ds_read_b128 v[108:111], v22 offset:53248
  buffer_store_dwordx4 v[116:119], v1, s[8:11], s73 offen sc1
  v_mfma_f32_16x16x32_bf16 v[128:131], a[168:171], v[88:91], v[128:131]
  s_add_u32 m0, s70, 65536
  s_add_u32 s69, s65, 65536
  s_add_u32 s73, s73, 65536
  v_mfma_f32_16x16x32_bf16 v[132:135], a[172:175], v[88:91], v[132:135]
  ds_read_b128 v[112:115], v22 offset:54272
  s_waitcnt vmcnt(14)
  v_add_f32 v160, v160, v161
  v_mfma_f32_16x16x32_bf16 v[132:135], a[164:167], v[84:87], v[132:135]
  buffer_load_dwordx4 v9, s[8:11], s69 offen offset:0 sc1 lds
  v_add_f32 v162, v162, v163
  v_add_f32 v160, v160, v162
  v_cvt_pk_bf16_f32 v160, v160, v160
  v_mfma_f32_16x16x32_bf16 v[128:131], a[176:179], v[76:79], v[128:131]
  ds_read_b128 v[88:91], v22 offset:55296
  v_lshlrev_b32 v160, 16, v160
  v_cvt_f32_u32 v181, v181
  v_mfma_f32_16x16x32_bf16 v[128:131], a[184:187], v[80:83], v[128:131]
  v_add_f32 v160, v160, v181
  v_cvt_pk_bf16_f32 v160, v160, v160
  v_lshlrev_b32 v160, 16, v160
  v_mfma_f32_16x16x32_bf16 v[132:135], a[188:191], v[80:83], v[132:135]
  ds_read_b128 v[84:87], v22 offset:56320
  buffer_load_dwordx4 v9, s[8:11], s69 offen offset:1024 sc1 lds
  s_lshl_b32 s54, s44, 8
  v_mfma_f32_16x16x32_bf16 v[132:135], a[180:183], v[76:79], v[132:135]
  s_waitcnt lgkmcnt(4)
  s_waitcnt vmcnt(11)
  s_cmp_lg_u32 s44, 0
  s_cbranch_scc1 PL7_adaLN_cond__sliding_local_dilated__swiglu_ffn__prompt_kernelx
  v_subrev_u32 v13, s46, v13
  v_subrev_u32 v13, 2, v13
  v_cmp_lt_u32 vcc, 3, v13
  s_nop 4
  s_cbranch_vccz PL7_adaLN_cond__sliding_local_dilated__swiglu_ffn__prompt_kernelx
  s_mov_b32 s57, 60000
PL7_adaLN_cond__sliding_local_dilated__swiglu_ffn__prompt_kernel:
  buffer_load_dword v13, v14, s[8:11], s77 offen sc1
  s_sub_u32 s57, s57, 1
  s_cmp_eq_u32 s57, 0
  s_waitcnt vmcnt(0)
  s_cbranch_scc1 PL7_adaLN_cond__sliding_local_dilated__swiglu_ffn__prompt_kernelx
  v_subrev_u32 v13, s46, v13
  v_subrev_u32 v13, 2, v13
  v_cmp_lt_u32 vcc, 3, v13
  s_nop 4
  s_cbranch_vccnz PL7_adaLN_cond__sliding_local_dilated__swiglu_ffn__prompt_kernel
PL7_adaLN_cond__sliding_local_dilated__swiglu_ffn__prompt_kernelx:
  s_waitcnt vmcnt(20)
  s_barrier
  v_mfma_f32_16x16x32_bf16 v[128:131], a[192:195], v[100:103], v[128:131]
  ds_read_b128 v[80:83], v22 offset:0
  s_add_u32 s54, s54, 161792
  v_lshl_add_u32 v180, v0, 2, s54
  v_mfma_f32_16x16x32_bf16 v[128:131], a[200:203], v[104:107], v[128:131]
  buffer_load_dwordx4 v9, s[8:11], s69 offen offset:2048 sc1 lds
  v_lshrrev_b32 v161, 4, v0
  v_lshl_add_u32 v181, v161, 4, s54
  v_mfma_f32_16x16x32_bf16 v[132:135], a[204:207], v[104:107], v[132:135]
  ds_read_b128 v[76:79], v22 offset:1024
  ds_write_b32 v180, v160
  v_mfma_f32_16x16x32_bf16 v[132:135], a[196:199], v[100:103], v[132:135]
  v_bfe_u32 v180, v0, 2, 2
  v_xor_b32 v180, v180, v161
  v_lshlrev_b32 v180, 27, v180
  v_mfma_f32_16x16x32_bf16 v[128:131], a[208:211], v[92:95], v[128:131]
  ds_read_b128 v[104:107], v22 offset:2048
  v_and_b32 v162, 15, v0
  v_lshl_add_u32 v180, v162, 4, v180
  v_mfma_f32_16x16x32_bf16 v[128:131], a[216:219], v[96:99], v[128:131]
  buffer_load_dwordx4 v9, s[8:11], s69 offen offset:3072 sc1 lds
  s_and_b32 s54, s44, 1
  s_lshl_b32 s54, s54, 11
  v_add_u32 v182, s54, v1
  v_mfma_f32_16x16x32_bf16 v[132:135], a[220:223], v[96:99], v[132:135]
  ds_read_b128 v[100:103], v22 offset:3072
  s_and_b32 s54, s44, 2
  s_lshl_b32 s54, s54, 9
  v_mfma_f32_16x16x32_bf16 v[132:135], a[212:215], v[92:95], v[132:135]
  s_waitcnt lgkmcnt(5)
  s_add_u32 m0, s70, 98304
  s_add_u32 s69, s62, 131072
  s_add_u32 s54, s54, 135168
  v_mfma_f32_16x16x32_bf16 v[128:131], a[224:227], v[108:111], v[128:131]
  ds_read_b128 v[96:99], v22 offset:4096
  v_add_u32 v182, s54, v182
  v_mfma_f32_16x16x32_bf16 v[128:131], a[232:235], v[112:115], v[128:131]
  buffer_load_dwordx4 v9, s[8:11], s69 offen offset:0 sc1 lds
  ds_read_b128 v[160:163], v181 offset:0
  v_mfma_f32_16x16x32_bf16 v[132:135], a[236:239], v[112:115], v[132:135]
  ds_read_b128 v[92:95], v22 offset:5120
  ds_read_b128 v[164:167], v181 offset:64
  v_mfma_f32_16x16x32_bf16 v[132:135], a[228:231], v[108:111], v[132:135]
  ds_read_b128 v[168:171], v181 offset:128
  ds_read_b128 v[172:175], v181 offset:192
  v_mfma_f32_16x16x32_bf16 v[128:131], a[240:243], v[88:91], v[128:131]
  ds_read_b128 v[112:115], v22 offset:6144
  v_lshrrev_b32 v220, 5, v0
  v_xor_b32 v220, 1, v220
  v_lshlrev_b32 v220, 12, v220
  v_mfma_f32_16x16x32_bf16 v[128:131], a[248:251], v[84:87], v[128:131]
  buffer_load_dwordx4 v9, s[8:11], s69 offen offset:1024 sc1 lds
  v_mov_b32 v176, 0x3f803f80
  v_mov_b32 v177, 0x3f803f80
  v_mov_b32 v178, 0x3f803f80
  v_mfma_f32_16x16x32_bf16 v[132:135], v[124:127], v[84:87], v[132:135]
  ds_read_b128 v[108:111], v22 offset:7168
  v_and_b32 v221, 31, v0
  v_lshl_add_u32 v220, v221, 3, v220
  v_mfma_f32_16x16x32_bf16 v[132:135], a[244:247], v[88:91], v[132:135]
  s_waitcnt lgkmcnt(8)
  v_mov_b32 v179, 0x3f803f80
  s_waitcnt vmcnt(11)
  s_barrier
  v_mfma_f32_16x16x32_bf16 v[136:139], a[0:3], v[80:83], 0
  ds_read_b128 v[84:87], v23 offset:16384
  buffer_load_dwordx4 v9, s[8:11], s69 offen offset:2048 sc1 lds
  s_mov_b32 s90, 0xcccccccc
  v_mfma_f32_16x16x32_bf16 v[136:139], a[8:11], v[76:79], v[136:139]
  s_mov_b32 s91, 0xcccccccc
  v_mfma_f32_16x16x32_bf16 v[140:143], a[12:15], v[76:79], 0
  ds_read_b128 v[88:91], v23 offset:17408
  s_waitcnt vmcnt(20) lgkmcnt(4)
  v_lshlrev_b32 v184, 16, v144
  v_mfma_f32_16x16x32_bf16 v[140:143], a[4:7], v[80:83], v[140:143]
  buffer_load_dwordx4 v9, s[8:11], s69 offen offset:3072 sc1 lds
  v_and_b32 v185, 0xffff0000, v144
  v_lshlrev_b32 v186, 16, v145
  v_and_b32 v187, 0xffff0000, v145
  v_mfma_f32_16x16x32_bf16 v[136:139], a[16:19], v[104:107], v[136:139]
  ds_read_b128 v[76:79], v23 offset:18432
  v_lshlrev_b32 v188, 16, v146
  v_and_b32 v189, 0xffff0000, v146
  v_mfma_f32_16x16x32_bf16 v[136:139], a[24:27], v[100:103], v[136:139]
  s_add_u32 m0, s70, 32768
  s_add_u32 s69, s63, 131072
  v_add_u32 v15, s46, v0
  v_add_u32 v15, 3, v15
  s_waitcnt vmcnt(8)
  s_barrier
  s_mov_b64 exec, 1
  buffer_store_dword v15, v0, s[8:11], s74 offen offset:0 sc1
  s_mov_b64 exec, -1
  v_mfma_f32_16x16x32_bf16 v[140:143], a[28:31], v[100:103], v[140:143]
  ds_read_b128 v[80:83], v23 offset:19456
  v_lshlrev_b32 v190, 16, v147
  v_and_b32 v191, 0xffff0000, v147
  v_mfma_f32_16x16x32_bf16 v[140:143], a[20:23], v[104:107], v[140:143]
  s_waitcnt lgkmcnt(4)
  buffer_load_dwordx4 v9, s[8:11], s69 offen offset:0 sc1 lds
  v_fmac_f32 v184, v160, v128
  v_fmac_f32 v185, v161, v129
  v_mfma_f32_16x16x32_bf16 v[136:139], a[32:35], v[96:99], v[136:139]
  ds_read_b128 v[100:103], v23 offset:20480
  v_fmac_f32 v186, v162, v130
  v_fmac_f32 v187, v163, v131
  v_mfma_f32_16x16x32_bf16 v[136:139], a[40:43], v[92:95], v[136:139]
  buffer_load_dwordx4 v9, s[8:11], s69 offen offset:1024 sc1 lds
  v_fmac_f32 v188, v164, v132
  v_fmac_f32 v189, v165, v133
  v_fmac_f32 v190, v166, v134
  v_mfma_f32_16x16x32_bf16 v[140:143], a[44:47], v[92:95], v[140:143]
  ds_read_b128 v[104:107], v23 offset:21504
  v_fmac_f32 v191, v167, v135
  v_mul_f32 v128, v184, v168
  v_mfma_f32_16x16x32_bf16 v[140:143], a[36:39], v[96:99], v[140:143]
  v_mul_f32 v129, v185, v169
  v_mul_f32 v130, v186, v170
  v_mul_f32 v131, v187, v171
  v_mfma_f32_16x16x32_bf16 v[136:139], a[48:51], v[112:115], v[136:139]
  ds_read_b128 v[92:95], v23 offset:22528
  v_mul_f32 v132, v188, v172
  v_mul_f32 v133, v189, v173
  v_mfma_f32_16x16x32_bf16 v[136:139], a[56:59], v[108:111], v[136:139]
  buffer_load_dwordx4 v9, s[8:11], s69 offen offset:2048 sc1 lds
  v_mul_f32 v134, v190, v174
  v_mul_f32 v135, v191, v175
  v_cvt_pk_bf16_f32 v196, v128, v129
  v_mfma_f32_16x16x32_bf16 v[140:143], a[60:63], v[108:111], v[140:143]
  ds_read_b128 v[96:99], v23 offset:23552
  v_cvt_pk_bf16_f32 v197, v130, v131
  v_cvt_pk_bf16_f32 v198, v132, v133
  v_mfma_f32_16x16x32_bf16 v[140:143], a[52:55], v[112:115], v[140:143]
  s_waitcnt lgkmcnt(4)
  v_cvt_pk_bf16_f32 v199, v134, v135
  s_waitcnt vmcnt(8)
  s_barrier
  v_mfma_f32_16x16x32_bf16 v[136:139], a[64:67], v[84:87], v[136:139]
  ds_read_b128 v[108:111], v22 offset:16384
  v_mfma_f32_16x16x32_bf16 v[136:139], a[72:75], v[88:91], v[136:139]
  buffer_load_dwordx4 v9, s[8:11], s69 offen offset:3072 sc1 lds
  s_add_u32 m0, s70, 114688
  s_add_u32 s69, s64, 131072
  v_mfma_f32_16x16x32_bf16 v[140:143], a[76:79], v[88:91], v[140:143]
  ds_read_b128 v[112:115], v22 offset:17408
  s_add_u32 s54, s47, 36700160
  buffer_store_dwordx4 v[196:199], v1, s[8:11], s54 offen sc1
  v_mfma_f32_16x16x32_bf16 v[140:143], a[68:71], v[84:87], v[140:143]
  buffer_load_dwordx4 v9, s[8:11], s69 offen offset:0 sc1 lds
  v_cvt_pk_bf16_f32 v144, v184, v185
  v_cvt_pk_bf16_f32 v145, v186, v187
  v_cvt_pk_bf16_f32 v146, v188, v189
  v_mfma_f32_16x16x32_bf16 v[136:139], a[80:83], v[76:79], v[136:139]
  ds_read_b128 v[88:91], v22 offset:18432
  v_cvt_pk_bf16_f32 v147, v190, v191
  v_mfma_f32_16x16x32_bf16 v[136:139], a[88:91], v[80:83], v[136:139]
  s_nop 0
  v_mfma_f32_16x16x32_bf16 v[224:227], v[176:179], v[144:147], 0
  v_mfma_f32_16x16x32_bf16 v[192:195], v[144:147], v[144:147], 0
  v_mfma_f32_16x16x32_bf16 v[140:143], a[92:95], v[80:83], v[140:143]
  ds_read_b128 v[84:87], v22 offset:19456
  v_mfma_f32_16x16x32_bf16 v[140:143], a[84:87], v[76:79], v[140:143]
  s_waitcnt lgkmcnt(4)
  buffer_load_dwordx4 v9, s[8:11], s69 offen offset:1024 sc1 lds
  v_mfma_f32_16x16x32_bf16 v[136:139], a[96:99], v[100:103], v[136:139]
  ds_read_b128 v[80:83], v22 offset:20480
  s_nop 0
  v_cndmask_b32 v192, v192, v193, s[88:89]
  v_cndmask_b32 v194, v194, v195, s[88:89]
  v_mfma_f32_16x16x32_bf16 v[136:139], a[104:107], v[104:107], v[136:139]
  v_cndmask_b32 v225, v192, v194, s[90:91]
  v_mfma_f32_16x16x32_bf16 v[140:143], a[108:111], v[104:107], v[140:143]
  ds_read_b128 v[76:79], v22 offset:21504
  v_mfma_f32_16x16x32_bf16 v[140:143], a[100:103], v[100:103], v[140:143]
  buffer_load_dwordx4 v9, s[8:11], s69 offen offset:2048 sc1 lds
  ds_write_b128 v182, v[144:147] offset:0
  v_mfma_f32_16x16x32_bf16 v[136:139], a[112:115], v[92:95], v[136:139]
  ds_read_b128 v[104:107], v22 offset:22528
  v_mfma_f32_16x16x32_bf16 v[136:139], a[120:123], v[96:99], v[136:139]
  v_mfma_f32_16x16x32_bf16 v[140:143], a[124:127], v[96:99], v[140:143]
  ds_read_b128 v[100:103], v22 offset:23552
  v_mfma_f32_16x16x32_bf16 v[140:143], a[116:119], v[92:95], v[140:143]
  s_waitcnt lgkmcnt(5)
  buffer_load_dwordx4 v9, s[8:11], s69 offen offset:3072 sc1 lds
  v_mfma_f32_16x16x32_bf16 v[136:139], a[128:131], v[108:111], v[136:139]
  ds_read_b128 v[96:99], v23 offset:0
  s_add_u32 m0, s70, 49152
  s_add_u32 s69, s65, 131072
  v_mfma_f32_16x16x32_bf16 v[136:139], a[136:139], v[112:115], v[136:139]
  buffer_load_dwordx4 v9, s[8:11], s69 offen offset:0 sc1 lds
  v_mfma_f32_16x16x32_bf16 v[140:143], a[140:143], v[112:115], v[140:143]
  ds_read_b128 v[92:95], v23 offset:1024
  v_mfma_f32_16x16x32_bf16 v[140:143], a[132:135], v[108:111], v[140:143]
  v_mfma_f32_16x16x32_bf16 v[136:139], a[144:147], v[88:91], v[136:139]
  ds_read_b128 v[112:115], v23 offset:2048
  v_mfma_f32_16x16x32_bf16 v[136:139], a[152:155], v[84:87], v[136:139]
  buffer_load_dwordx4 v9, s[8:11], s69 offen offset:1024 sc1 lds
  v_mfma_f32_16x16x32_bf16 v[140:143], a[156:159], v[84:87], v[140:143]
  ds_read_b128 v[108:111], v23 offset:3072
  v_mfma_f32_16x16x32_bf16 v[140:143], a[148:151], v[88:91], v[140:143]
  s_waitcnt lgkmcnt(4)
  v_mfma_f32_16x16x32_bf16 v[136:139], a[160:163], v[80:83], v[136:139]
  ds_read_b128 v[84:87], v23 offset:4096
  buffer_load_dwordx4 v9, s[8:11], s69 offen offset:2048 sc1 lds
  v_mfma_f32_16x16x32_bf16 v[136:139], a[168:171], v[76:79], v[136:139]
  s_or_b32 s57, s2, s44
  s_mov_b32 s57, 851968
  s_cselect_b32 s57, 1073741824, s57
  v_add_u32 v15, s46, v0
  s_mov_b64 exec, 1
  buffer_store_dword v15, v0, s[8:11], s57 offen offset:0 sc1
  s_mov_b64 exec, -1
  v_mfma_f32_16x16x32_bf16 v[140:143], a[172:175], v[76:79], v[140:143]
  ds_read_b128 v[88:91], v23 offset:5120
  v_mfma_f32_16x16x32_bf16 v[140:143], a[164:167], v[80:83], v[140:143]
  buffer_load_dwordx4 v9, s[8:11], s69 offen offset:3072 sc1 lds
  v_mfma_f32_16x16x32_bf16 v[136:139], a[176:179], v[104:107], v[136:139]
  ds_read_b128 v[76:79], v23 offset:6144
  s_lshl_b32 s57, s44, 28
  s_add_u32 s57, s57, s77
  buffer_load_dword v13, v14, s[8:11], s57 offen sc1
  v_mfma_f32_16x16x32_bf16 v[136:139], a[184:187], v[100:103], v[136:139]
  s_add_u32 s56, s79, 12288
  v_lshrrev_b32 v29, 2, v0
  v_bfe_u32 v28, v29, 1, 2
  v_mfma_f32_16x16x32_bf16 v[140:143], a[188:191], v[100:103], v[140:143]
  ds_read_b128 v[80:83], v23 offset:7168
  v_lshlrev_b32 v28, 5, v28
  v_mfma_f32_16x16x32_bf16 v[140:143], a[180:183], v[104:107], v[140:143]
  s_waitcnt lgkmcnt(4)
  buffer_load_dwordx2 v[212:213], v220, s[8:11], s56 offen sc1
  s_add_u32 s56, s79, 36864
  s_waitcnt vmcnt(12)
  s_barrier
  v_mfma_f32_16x16x32_bf16 v[136:139], a[192:195], v[96:99], v[136:139]
  ds_read_b128 v[100:103], v23 offset:32768
  buffer_load_dwordx2 v[214:215], v220, s[8:11], s56 offen sc1
  v_mfma_f32_16x16x32_bf16 v[136:139], a[200:203], v[92:95], v[136:139]
  s_add_u32 s56, s79, 61440
  v_lshl_add_u32 v28, v29, 7, v28
  v_and_b32 v29, 3, v0
  v_mfma_f32_16x16x32_bf16 v[140:143], a[204:207], v[92:95], v[140:143]
  ds_read_b128 v[104:107], v23 offset:33792
  buffer_load_dwordx2 v[216:217], v220, s[8:11], s56 offen sc1
  v_mfma_f32_16x16x32_bf16 v[140:143], a[196:199], v[96:99], v[140:143]
  s_add_u32 s56, s79, 86016
  v_lshl_add_u32 v2, v29, 3, v28
  v_xor_b32 v3, 32, v2
  v_mfma_f32_16x16x32_bf16 v[136:139], a[208:211], v[112:115], v[136:139]
  ds_read_b128 v[92:95], v23 offset:34816
  buffer_load_dwordx2 v[218:219], v220, s[8:11], s56 offen sc1
  s_waitcnt vmcnt(40) lgkmcnt(15)
  v_lshlrev_b32 v184, 16, v148
  v_and_b32 v185, 0xffff0000, v148
  v_mfma_f32_16x16x32_bf16 v[136:139], a[216:219], v[108:111], v[136:139]
  v_lshlrev_b32 v186, 16, v149
  v_and_b32 v187, 0xffff0000, v149
  v_lshlrev_b32 v188, 16, v150
  v_and_b32 v189, 0xffff0000, v150
  v_lshlrev_b32 v190, 16, v151
  v_mfma_f32_16x16x32_bf16 v[140:143], a[220:223], v[108:111], v[140:143]
  ds_read_b128 v[96:99], v23 offset:35840
  v_and_b32 v191, 0xffff0000, v151
  v_mfma_f32_16x16x32_bf16 v[140:143], a[212:215], v[112:115], v[140:143]
  s_waitcnt lgkmcnt(4)
  v_xor_b32 v4, 64, v2
  v_xor_b32 v5, 96, v2
  v_mfma_f32_16x16x32_bf16 v[136:139], a[224:227], v[84:87], v[136:139]
  ds_read_b128 v[108:111], v23 offset:36864
  v_add_u32 v6, 65536, v2
  v_mfma_f32_16x16x32_bf16 v[136:139], a[232:235], v[88:91], v[136:139]
  v_add_u32 v7, 65536, v3
  v_add_u32 v8, 65536, v4
  v_mfma_f32_16x16x32_bf16 v[140:143], a[236:239], v[88:91], v[140:143]
  ds_read_b128 v[112:115], v23 offset:37888
  s_lshr_b32 s52, s2, 5
  v_mfma_f32_16x16x32_bf16 v[140:143], a[228:231], v[84:87], v[140:143]
  s_lshl_b32 s52, s52, 19
  s_lshr_b32 s53, s44, 1
  s_lshl_b32 s53, s53, 18
  v_mfma_f32_16x16x32_bf16 v[136:139], a[240:243], v[76:79], v[136:139]
  ds_read_b128 v[88:91], v23 offset:38912
  s_add_u32 s52, s52, s53
  v_mfma_f32_16x16x32_bf16 v[136:139], a[248:251], v[80:83], v[136:139]
  s_and_b32 s53, s44, 1
  s_lshl_b32 s53, s53, 15
  s_add_u32 s52, s52, s53
  v_mfma_f32_16x16x32_bf16 v[140:143], v[124:127], v[80:83], v[140:143]
  ds_read_b128 v[84:87], v23 offset:39936
  s_add_u32 s24, s52, 36700160
  v_mfma_f32_16x16x32_bf16 v[140:143], a[244:247], v[76:79], v[140:143]
  s_waitcnt lgkmcnt(4)
  s_bitcmp1_b32 s2, 3
  s_cselect_b64 s[12:13], s[32:33], s[28:29]
  v_mfma_f32_16x16x32_bf16 v[128:131], a[0:3], v[100:103], 0
  ds_read_b128 v[80:83], v22 offset:32768
  s_mov_b32 s14, 7340032
  v_mfma_f32_16x16x32_bf16 v[128:131], a[8:11], v[104:107], v[128:131]
  s_mov_b32 s16, 0x03030303
  s_mov_b32 s17, 0x03030303
  s_mov_b32 s18, 0x0c0c0c0c
  v_mfma_f32_16x16x32_bf16 v[132:135], a[12:15], v[104:107], 0
  ds_read_b128 v[76:79], v22 offset:33792
  v_fmac_f32 v184, v160, v136
  v_fmac_f32 v185, v161, v137
  v_fmac_f32 v186, v162, v138
  v_fmac_f32 v187, v163, v139
  v_mfma_f32_16x16x32_bf16 v[132:135], a[4:7], v[100:103], v[132:135]
  v_fmac_f32 v188, v164, v140
  v_fmac_f32 v189, v165, v141
  v_fmac_f32 v190, v166, v142
  v_fmac_f32 v191, v167, v143
  v_mul_f32 v136, v184, v168
  v_mfma_f32_16x16x32_bf16 v[128:131], a[16:19], v[92:95], v[128:131]
  ds_read_b128 v[104:107], v22 offset:34816
  v_mul_f32 v137, v185, v169
  v_mul_f32 v138, v186, v170
  v_mul_f32 v139, v187, v171
  v_mul_f32 v140, v188, v172
  v_mfma_f32_16x16x32_bf16 v[128:131], a[24:27], v[96:99], v[128:131]
  v_mul_f32 v141, v189, v173
  v_mul_f32 v142, v190, v174
  v_mul_f32 v143, v191, v175
  v_cvt_pk_bf16_f32 v200, v136, v137
  v_cvt_pk_bf16_f32 v201, v138, v139
  v_mfma_f32_16x16x32_bf16 v[132:135], a[28:31], v[96:99], v[132:135]
  ds_read_b128 v[100:103], v22 offset:35840
  v_cvt_pk_bf16_f32 v202, v140, v141
  v_cvt_pk_bf16_f32 v203, v142, v143
  v_mfma_f32_16x16x32_bf16 v[132:135], a[20:23], v[92:95], v[132:135]
  s_waitcnt lgkmcnt(4)
  s_add_u32 s54, s47, 36765696
  buffer_store_dwordx4 v[200:203], v1, s[8:11], s54 offen sc1
  v_mfma_f32_16x16x32_bf16 v[128:131], a[32:35], v[108:111], v[128:131]
  ds_read_b128 v[96:99], v22 offset:36864
  v_cvt_pk_bf16_f32 v148, v184, v185
  v_cvt_pk_bf16_f32 v149, v186, v187
  v_cvt_pk_bf16_f32 v150, v188, v189
  v_cvt_pk_bf16_f32 v151, v190, v191
  v_mfma_f32_16x16x32_bf16 v[128:131], a[40:43], v[112:115], v[128:131]
  s_nop 0
  v_mfma_f32_16x16x32_bf16 v[226:229], v[176:179], v[148:151], 0
  v_mfma_f32_16x16x32_bf16 v[192:195], v[148:151], v[148:151], 0
  s_mov_b32 s19, 0x0c0c0c0c
  s_mov_b32 s20, 0x30303030
  s_mov_b32 s21, 0x30303030
  v_mfma_f32_16x16x32_bf16 v[132:135], a[44:47], v[112:115], v[132:135]
  ds_read_b128 v[92:95], v22 offset:37888
  s_mov_b32 s22, 0xc0c0c0c0
  v_mfma_f32_16x16x32_bf16 v[132:135], a[36:39], v[108:111], v[132:135]
  s_mov_b32 s23, 0xc0c0c0c0
  v_mfma_f32_16x16x32_bf16 v[128:131], a[48:51], v[88:91], v[128:131]
  ds_read_b128 v[112:115], v22 offset:38912
  v_cndmask_b32 v192, v192, v193, s[88:89]
  v_cndmask_b32 v194, v194, v195, s[88:89]
  v_cndmask_b32 v227, v192, v194, s[90:91]
  v_mfma_f32_16x16x32_bf16 v[128:131], a[56:59], v[84:87], v[128:131]
  buffer_store_dwordx4 v[224:227], v180, s[8:11], s48 offen offset:0 sc1
  v_mfma_f32_16x16x32_bf16 v[132:135], a[60:63], v[84:87], v[132:135]
  ds_read_b128 v[108:111], v22 offset:39936
  v_mfma_f32_16x16x32_bf16 v[132:135], a[52:55], v[88:91], v[132:135]
  s_waitcnt lgkmcnt(4)
  s_waitcnt vmcnt(6)
  s_cmp_lg_u32 s44, 0
  s_cbranch_scc1 PL8_adaLN_cond__sliding_local_dilated__swiglu_ffn__prompt_kernelx
  v_subrev_u32 v13, s46, v13
  v_subrev_u32 v13, 3, v13
  v_cmp_lt_u32 vcc, 3, v13
  s_nop 4
  s_cbranch_vccz PL8_adaLN_cond__sliding_local_dilated__swiglu_ffn__prompt_kernelx
  s_mov_b32 s57, 60000
PL8_adaLN_cond__sliding_local_dilated__swiglu_ffn__prompt_kernel:
  buffer_load_dword v13, v14, s[8:11], s77 offen sc1
  s_sub_u32 s57, s57, 1
  s_cmp_eq_u32 s57, 0
  s_waitcnt vmcnt(0)
  s_cbranch_scc1 PL8_adaLN_cond__sliding_local_dilated__swiglu_ffn__prompt_kernelx
  v_subrev_u32 v13, s46, v13
  v_subrev_u32 v13, 3, v13
  v_cmp_lt_u32 vcc, 3, v13
  s_nop 4
  s_cbranch_vccnz PL8_adaLN_cond__sliding_local_dilated__swiglu_ffn__prompt_kernel
PL8_adaLN_cond__sliding_local_dilated__swiglu_ffn__prompt_kernelx:
  s_waitcnt vmcnt(7)
  s_barrier
  v_mfma_f32_16x16x32_bf16 v[128:131], a[64:67], v[80:83], v[128:131]
  ds_read_b128 v[84:87], v23 offset:49152
  s_add_u32 m0, s70, 0
  s_add_u32 s69, s62, 196608
  ds_write_b128 v182, v[148:151] offset:4096
  v_mfma_f32_16x16x32_bf16 v[128:131], a[72:75], v[76:79], v[128:131]
  buffer_load_dwordx4 v9, s[8:11], s69 offen offset:0 sc1 lds
  v_mfma_f32_16x16x32_bf16 v[132:135], a[76:79], v[76:79], v[132:135]
  ds_read_b128 v[88:91], v23 offset:50176
  v_mfma_f32_16x16x32_bf16 v[132:135], a[68:71], v[80:83], v[132:135]
  buffer_load_dwordx4 v9, s[8:11], s69 offen offset:1024 sc1 lds
  v_mfma_f32_16x16x32_bf16 v[128:131], a[80:83], v[104:107], v[128:131]
  ds_read_b128 v[76:79], v23 offset:51200
  v_mfma_f32_16x16x32_bf16 v[128:131], a[88:91], v[100:103], v[128:131]
  buffer_load_dwordx4 v9, s[8:11], s69 offen offset:2048 sc1 lds
  v_mfma_f32_16x16x32_bf16 v[132:135], a[92:95], v[100:103], v[132:135]
  ds_read_b128 v[80:83], v23 offset:52224
  v_mfma_f32_16x16x32_bf16 v[132:135], a[84:87], v[104:107], v[132:135]
  s_waitcnt lgkmcnt(5)
  buffer_load_dwordx4 v9, s[8:11], s69 offen offset:3072 sc1 lds
  v_mfma_f32_16x16x32_bf16 v[128:131], a[96:99], v[96:99], v[128:131]
  ds_read_b128 v[100:103], v23 offset:53248
  s_add_u32 m0, s70, 81920
  s_add_u32 s69, s63, 196608
  v_mfma_f32_16x16x32_bf16 v[128:131], a[104:107], v[92:95], v[128:131]
  buffer_load_dwordx4 v9, s[8:11], s69 offen offset:0 sc1 lds
  v_mfma_f32_16x16x32_bf16 v[132:135], a[108:111], v[92:95], v[132:135]
  ds_read_b128 v[104:107], v23 offset:54272
  v_mfma_f32_16x16x32_bf16 v[132:135], a[100:103], v[96:99], v[132:135]
  buffer_load_dwordx4 v9, s[8:11], s69 offen offset:1024 sc1 lds
  v_mfma_f32_16x16x32_bf16 v[128:131], a[112:115], v[112:115], v[128:131]
  ds_read_b128 v[92:95], v23 offset:55296
  v_mfma_f32_16x16x32_bf16 v[128:131], a[120:123], v[108:111], v[128:131]
  buffer_load_dwordx4 v9, s[8:11], s69 offen offset:2048 sc1 lds
  v_mfma_f32_16x16x32_bf16 v[132:135], a[124:127], v[108:111], v[132:135]
  ds_read_b128 v[96:99], v23 offset:56320
  v_mfma_f32_16x16x32_bf16 v[132:135], a[116:119], v[112:115], v[132:135]
  s_waitcnt lgkmcnt(4)
  buffer_load_dwordx4 v9, s[8:11], s69 offen offset:3072 sc1 lds
  v_mfma_f32_16x16x32_bf16 v[128:131], a[128:131], v[84:87], v[128:131]
  ds_read_b128 v[108:111], v22 offset:49152
  s_add_u32 m0, s70, 16384
  s_add_u32 s69, s64, 196608
  v_mfma_f32_16x16x32_bf16 v[128:131], a[136:139], v[88:91], v[128:131]
  buffer_load_dwordx4 v9, s[8:11], s69 offen offset:0 sc1 lds
  v_mfma_f32_16x16x32_bf16 v[132:135], a[140:143], v[88:91], v[132:135]
  ds_read_b128 v[112:115], v22 offset:50176
  v_mfma_f32_16x16x32_bf16 v[132:135], a[132:135], v[84:87], v[132:135]
  buffer_load_dwordx4 v9, s[8:11], s69 offen offset:1024 sc1 lds
  v_mfma_f32_16x16x32_bf16 v[128:131], a[144:147], v[76:79], v[128:131]
  ds_read_b128 v[88:91], v22 offset:51200
  buffer_load_dwordx4 v9, s[8:11], s69 offen offset:2048 sc1 lds
  v_mfma_f32_16x16x32_bf16 v[128:131], a[152:155], v[80:83], v[128:131]
  v_mfma_f32_16x16x32_bf16 v[132:135], a[156:159], v[80:83], v[132:135]
  ds_read_b128 v[84:87], v22 offset:52224
  buffer_load_dwordx4 v9, s[8:11], s69 offen offset:3072 sc1 lds
  v_mfma_f32_16x16x32_bf16 v[132:135], a[148:151], v[76:79], v[132:135]
  s_waitcnt lgkmcnt(4)
  s_add_u32 m0, s70, 65536
  s_add_u32 s69, s65, 196608
  v_mfma_f32_16x16x32_bf16 v[128:131], a[160:163], v[100:103], v[128:131]
  ds_read_b128 v[80:83], v22 offset:53248
  buffer_load_dwordx4 v9, s[8:11], s69 offen offset:0 sc1 lds
  v_mfma_f32_16x16x32_bf16 v[128:131], a[168:171], v[104:107], v[128:131]
  v_mfma_f32_16x16x32_bf16 v[132:135], a[172:175], v[104:107], v[132:135]
  ds_read_b128 v[76:79], v22 offset:54272
  buffer_load_dwordx4 v9, s[8:11], s69 offen offset:1024 sc1 lds
  v_mfma_f32_16x16x32_bf16 v[132:135], a[164:167], v[100:103], v[132:135]
  v_mfma_f32_16x16x32_bf16 v[128:131], a[176:179], v[92:95], v[128:131]
  ds_read_b128 v[104:107], v22 offset:55296
  buffer_load_dwordx4 v9, s[8:11], s69 offen offset:2048 sc1 lds
  v_mfma_f32_16x16x32_bf16 v[128:131], a[184:187], v[96:99], v[128:131]
  s_waitcnt vmcnt(17)
  v_add_f32 v212, v212, v214
  v_add_f32 v216, v216, v218
  s_sub_u32 s73, s49, 524288
  v_mfma_f32_16x16x32_bf16 v[132:135], a[188:191], v[96:99], v[132:135]
  ds_read_b128 v[100:103], v22 offset:56320
  buffer_load_dwordx4 v9, s[8:11], s69 offen offset:3072 sc1 lds
  v_mfma_f32_16x16x32_bf16 v[132:135], a[180:183], v[92:95], v[132:135]
  s_waitcnt lgkmcnt(4)
  s_waitcnt vmcnt(8)
  s_barrier
  v_add_u32 v15, s46, v0
  s_mov_b64 exec, 1
  buffer_store_dword v15, v0, s[8:11], s73 offen offset:0 sc1
  s_mov_b64 exec, -1
  v_mfma_f32_16x16x32_bf16 v[128:131], a[192:195], v[108:111], v[128:131]
  ds_read_b128 v[96:99], v22 offset:0
  s_mov_b32 s55, 0
  s_add_u32 m0, s45, 98304
  v_mfma_f32_16x16x32_bf16 v[128:131], a[200:203], v[112:115], v[128:131]
  buffer_load_dwordx4 v11, s[28:31], s55 offen lds
  v_add_f32 v212, v212, v216
  v_add_f32 v213, v213, v215
  v_mfma_f32_16x16x32_bf16 v[132:135], a[204:207], v[112:115], v[132:135]
  ds_read_b128 v[92:95], v22 offset:1024
  v_add_f32 v217, v217, v219
  v_mfma_f32_16x16x32_bf16 v[132:135], a[196:199], v[108:111], v[132:135]
  v_add_f32 v213, v213, v217
  v_lshrrev_b32 v28, 5, v0
  v_mfma_f32_16x16x32_bf16 v[128:131], a[208:211], v[88:91], v[128:131]
  ds_read_b128 v[112:115], v22 offset:2048
  s_waitcnt vmcnt(59) lgkmcnt(15)
  v_lshlrev_b32 v184, 16, v152
  v_mfma_f32_16x16x32_bf16 v[128:131], a[216:219], v[84:87], v[128:131]
  s_mov_b32 s55, 0
  s_add_u32 m0, s45, 106496
  v_and_b32 v185, 0xffff0000, v152
  v_lshlrev_b32 v186, 16, v153
  v_mfma_f32_16x16x32_bf16 v[132:135], a[220:223], v[84:87], v[132:135]
  ds_read_b128 v[108:111], v22 offset:3072
  v_and_b32 v187, 0xffff0000, v153
  v_lshlrev_b32 v188, 16, v154
  v_mfma_f32_16x16x32_bf16 v[132:135], a[212:215], v[88:91], v[132:135]
  s_waitcnt lgkmcnt(4)
  buffer_load_dwordx4 v11, s[32:35], s55 offen lds
  v_and_b32 v189, 0xffff0000, v154
  v_lshlrev_b32 v190, 16, v155
  v_mfma_f32_16x16x32_bf16 v[128:131], a[224:227], v[80:83], v[128:131]
  ds_read_b128 v[84:87], v22 offset:4096
  v_and_b32 v191, 0xffff0000, v155
  v_xor_b32 v29, 1, v28
  v_mfma_f32_16x16x32_bf16 v[128:131], a[232:235], v[76:79], v[128:131]
  v_cvt_f32_u32 v29, v29
  v_cvt_pk_bf16_f32 v214, v212, v213
  v_mfma_f32_16x16x32_bf16 v[132:135], a[236:239], v[76:79], v[132:135]
  ds_read_b128 v[88:91], v22 offset:5120
  v_lshlrev_b32 v212, 16, v214
  v_mfma_f32_16x16x32_bf16 v[132:135], a[228:231], v[80:83], v[132:135]
  s_mov_b32 s55, 229376
  s_add_u32 m0, s45, 102400
  v_and_b32 v213, 0xffff0000, v214
  v_mfma_f32_16x16x32_bf16 v[128:131], a[240:243], v[104:107], v[128:131]
  ds_read_b128 v[76:79], v22 offset:6144
  v_add_f32 v212, v212, v29
  v_mfma_f32_16x16x32_bf16 v[128:131], a[248:251], v[100:103], v[128:131]
  buffer_load_dwordx4 v11, s[28:31], s55 offen lds
  v_add_f32 v213, v213, v29
  v_cvt_pk_bf16_f32 v214, v212, v213
  v_mfma_f32_16x16x32_bf16 v[132:135], v[124:127], v[100:103], v[132:135]
  ds_read_b128 v[80:83], v22 offset:7168
  v_lshlrev_b32 v212, 16, v214
  v_mfma_f32_16x16x32_bf16 v[132:135], a[244:247], v[104:107], v[132:135]
  s_waitcnt lgkmcnt(4)
  v_and_b32 v213, 0xffff0000, v214
  v_lshrrev_b32 v215, 16, v214
  v_mfma_f32_16x16x32_bf16 v[136:139], a[0:3], v[96:99], 0
  ds_read_b128 v[100:103], v23 offset:16384
  v_and_b32 v214, 0xffff, v214
  v_mfma_f32_16x16x32_bf16 v[136:139], a[8:11], v[92:95], v[136:139]
  s_mov_b32 s55, 229376
  s_add_u32 m0, s45, 110592
  s_add_u32 s52, s45, 151552
HOP6:
  s_cbranch_execz HOP10
  v_mfma_f32_16x16x32_bf16 v[140:143], a[12:15], v[92:95], 0
  ds_read_b128 v[104:107], v23 offset:17408
  v_fmac_f32 v184, v160, v128
  v_fmac_f32 v185, v161, v129
  v_mfma_f32_16x16x32_bf16 v[140:143], a[4:7], v[96:99], v[140:143]
  buffer_load_dwordx4 v11, s[32:35], s55 offen lds
  v_fmac_f32 v186, v162, v130
  v_fmac_f32 v187, v163, v131
  v_fmac_f32 v188, v164, v132
  v_mfma_f32_16x16x32_bf16 v[136:139], a[16:19], v[112:115], v[136:139]
  ds_read_b128 v[92:95], v23 offset:18432
  v_fmac_f32 v189, v165, v133
  v_fmac_f32 v190, v166, v134
  v_mfma_f32_16x16x32_bf16 v[136:139], a[24:27], v[108:111], v[136:139]
  v_fmac_f32 v191, v167, v135
  v_mul_f32 v128, v184, v168
  v_mul_f32 v129, v185, v169
  v_mfma_f32_16x16x32_bf16 v[140:143], a[28:31], v[108:111], v[140:143]
  ds_read_b128 v[96:99], v23 offset:19456
  v_mul_f32 v130, v186, v170
  v_mul_f32 v131, v187, v171
  v_mfma_f32_16x16x32_bf16 v[140:143], a[20:23], v[112:115], v[140:143]
  s_waitcnt lgkmcnt(4)
  s_mov_b32 s55, 0
  s_add_u32 m0, s45, 32768
  v_mul_f32 v132, v188, v172
  v_mfma_f32_16x16x32_bf16 v[136:139], a[32:35], v[84:87], v[136:139]
  ds_read_b128 v[108:111], v23 offset:20480
  v_mul_f32 v133, v189, v173
  v_mul_f32 v134, v190, v174
  v_mfma_f32_16x16x32_bf16 v[136:139], a[40:43], v[88:91], v[136:139]
  buffer_load_dwordx4 v16, s[28:31], s55 offen lds
  v_mul_f32 v135, v191, v175
  v_cvt_pk_bf16_f32 v204, v128, v129
  v_cvt_pk_bf16_f32 v205, v130, v131
  v_lshlrev_b32 v28, 8, v28
  v_mfma_f32_16x16x32_bf16 v[140:143], a[44:47], v[88:91], v[140:143]
  ds_read_b128 v[112:115], v23 offset:21504
  v_cvt_pk_bf16_f32 v206, v132, v133
  v_cvt_pk_bf16_f32 v207, v134, v135
  v_mfma_f32_16x16x32_bf16 v[140:143], a[36:39], v[84:87], v[140:143]
  s_add_u32 s54, s47, 36831232
  buffer_store_dwordx4 v[204:207], v1, s[8:11], s54 offen sc1
  v_mfma_f32_16x16x32_bf16 v[136:139], a[48:51], v[76:79], v[136:139]
  ds_read_b128 v[88:91], v23 offset:22528
  v_cvt_pk_bf16_f32 v152, v184, v185
  v_cvt_pk_bf16_f32 v153, v186, v187
  v_mfma_f32_16x16x32_bf16 v[136:139], a[56:59], v[80:83], v[136:139]
  s_mov_b32 s55, 0
  s_add_u32 m0, s45, 40960
  v_cvt_pk_bf16_f32 v154, v188, v189
  v_cvt_pk_bf16_f32 v155, v190, v191
  v_mfma_f32_16x16x32_bf16 v[140:143], a[60:63], v[80:83], v[140:143]
  ds_read_b128 v[84:87], v23 offset:23552
  buffer_load_dwordx4 v16, s[32:35], s55 offen lds
  v_mfma_f32_16x16x32_bf16 v[228:231], v[176:179], v[152:155], 0
  v_mfma_f32_16x16x32_bf16 v[192:195], v[152:155], v[152:155], 0
  v_lshl_add_u32 v28, v0, 3, v28
  v_add_u32 v28, s52, v28
  v_mfma_f32_16x16x32_bf16 v[140:143], a[52:55], v[76:79], v[140:143]
  s_waitcnt lgkmcnt(4)
  s_waitcnt vmcnt(8)
  s_barrier
  v_mfma_f32_16x16x32_bf16 v[136:139], a[64:67], v[100:103], v[136:139]
  ds_read_b128 v[80:83], v22 offset:16384
  v_mfma_f32_16x16x32_bf16 v[136:139], a[72:75], v[104:107], v[136:139]
  ds_write_b64 v28, v[214:215]
  v_cndmask_b32 v192, v192, v193, s[88:89]
  v_cndmask_b32 v194, v194, v195, s[88:89]
  v_cndmask_b32 v229, v192, v194, s[90:91]
  v_mfma_f32_16x16x32_bf16 v[140:143], a[76:79], v[104:107], v[140:143]
  ds_read_b128 v[76:79], v22 offset:17408
  v_mfma_f32_16x16x32_bf16 v[140:143], a[68:71], v[100:103], v[140:143]
  s_mov_b32 s55, 229376
  s_add_u32 m0, s45, 36864
  v_mfma_f32_16x16x32_bf16 v[136:139], a[80:83], v[92:95], v[136:139]
  ds_read_b128 v[104:107], v22 offset:18432
  ds_write_b128 v182, v[152:155] offset:8192
  ds_write_b64 v28, v[212:213] offset:256
  v_mfma_f32_16x16x32_bf16 v[136:139], a[88:91], v[96:99], v[136:139]
  buffer_load_dwordx4 v16, s[28:31], s55 offen lds
  v_mfma_f32_16x16x32_bf16 v[140:143], a[92:95], v[96:99], v[140:143]
  ds_read_b128 v[100:103], v22 offset:19456
  v_mfma_f32_16x16x32_bf16 v[140:143], a[84:87], v[92:95], v[140:143]
  s_waitcnt lgkmcnt(7)
  v_mfma_f32_16x16x32_bf16 v[136:139], a[96:99], v[108:111], v[136:139]
  ds_read_b128 v[96:99], v22 offset:20480
  v_mfma_f32_16x16x32_bf16 v[136:139], a[104:107], v[112:115], v[136:139]
  s_mov_b32 s55, 229376
  s_add_u32 m0, s45, 45056
  v_mfma_f32_16x16x32_bf16 v[140:143], a[108:111], v[112:115], v[140:143]
  ds_read_b128 v[92:95], v22 offset:21504
  v_mfma_f32_16x16x32_bf16 v[140:143], a[100:103], v[108:111], v[140:143]
  buffer_load_dwordx4 v16, s[32:35], s55 offen lds
  v_mfma_f32_16x16x32_bf16 v[136:139], a[112:115], v[88:91], v[136:139]
  ds_read_b128 v[112:115], v22 offset:22528
  v_mfma_f32_16x16x32_bf16 v[136:139], a[120:123], v[84:87], v[136:139]
  v_mfma_f32_16x16x32_bf16 v[140:143], a[124:127], v[84:87], v[140:143]
  ds_read_b128 v[108:111], v22 offset:23552
  v_mfma_f32_16x16x32_bf16 v[140:143], a[116:119], v[88:91], v[140:143]
  s_waitcnt lgkmcnt(4)
  s_mov_b32 s55, 458752
  s_add_u32 m0, s45, 114688
  v_mfma_f32_16x16x32_bf16 v[136:139], a[128:131], v[80:83], v[136:139]
  ds_read_b128 v[84:87], v23 offset:0
  v_mfma_f32_16x16x32_bf16 v[136:139], a[136:139], v[76:79], v[136:139]
  buffer_load_dwordx4 v11, s[28:31], s55 offen lds
  v_mfma_f32_16x16x32_bf16 v[140:143], a[140:143], v[76:79], v[140:143]
  ds_read_b128 v[88:91], v23 offset:1024
  v_mfma_f32_16x16x32_bf16 v[140:143], a[132:135], v[80:83], v[140:143]
  v_mfma_f32_16x16x32_bf16 v[136:139], a[144:147], v[104:107], v[136:139]
  ds_read_b128 v[76:79], v23 offset:2048
  v_mfma_f32_16x16x32_bf16 v[136:139], a[152:155], v[100:103], v[136:139]
  s_mov_b32 s55, 458752
  s_add_u32 m0, s45, 122880
  v_mfma_f32_16x16x32_bf16 v[140:143], a[156:159], v[100:103], v[140:143]
  ds_read_b128 v[80:83], v23 offset:3072
  v_mfma_f32_16x16x32_bf16 v[140:143], a[148:151], v[104:107], v[140:143]
  s_waitcnt lgkmcnt(4)
  buffer_load_dwordx4 v11, s[32:35], s55 offen lds
  v_mfma_f32_16x16x32_bf16 v[136:139], a[160:163], v[96:99], v[136:139]
  ds_read_b128 v[100:103], v23 offset:4096
  v_mfma_f32_16x16x32_bf16 v[136:139], a[168:171], v[92:95], v[136:139]
  v_mfma_f32_16x16x32_bf16 v[140:143], a[172:175], v[92:95], v[140:143]
  ds_read_b128 v[104:107], v23 offset:5120
  v_mfma_f32_16x16x32_bf16 v[140:143], a[164:167], v[96:99], v[140:143]
  s_mov_b32 s55, 688128
  s_add_u32 m0, s45, 118784
  v_mfma_f32_16x16x32_bf16 v[136:139], a[176:179], v[112:115], v[136:139]
  ds_read_b128 v[92:95], v23 offset:6144
  buffer_load_dwordx4 v11, s[28:31], s55 offen lds
  v_mfma_f32_16x16x32_bf16 v[136:139], a[184:187], v[108:111], v[136:139]
  s_lshr_b32 s77, s2, 5
  s_lshl_b32 s77, s77, 12
  s_add_u32 s77, s77, 229376
  v_mfma_f32_16x16x32_bf16 v[140:143], a[188:191], v[108:111], v[140:143]
  ds_read_b128 v[96:99], v23 offset:7168
  s_waitcnt vmcnt(63) lgkmcnt(15)
  v_mfma_f32_16x16x32_bf16 v[140:143], a[180:183], v[112:115], v[140:143]
  s_waitcnt lgkmcnt(4)
  v_and_b32 v14, 31, v0
  v_lshlrev_b32 v14, 7, v14
  v_mfma_f32_16x16x32_bf16 v[136:139], a[192:195], v[84:87], v[136:139]
  s_mov_b32 s55, 688128
  s_add_u32 m0, s45, 126976
  v_lshlrev_b32 v184, 16, v156
  v_mfma_f32_16x16x32_bf16 v[136:139], a[200:203], v[88:91], v[136:139]
  s_lshl_b32 s57, s44, 28
  s_add_u32 s57, s57, s77
  buffer_load_dword v13, v14, s[8:11], s57 offen sc1
  v_mfma_f32_16x16x32_bf16 v[140:143], a[204:207], v[88:91], v[140:143]
  buffer_load_dwordx4 v11, s[32:35], s55 offen lds
  v_and_b32 v185, 0xffff0000, v156
  v_lshlrev_b32 v186, 16, v157
  v_mfma_f32_16x16x32_bf16 v[140:143], a[196:199], v[84:87], v[140:143]
  v_and_b32 v187, 0xffff0000, v157
  v_lshlrev_b32 v188, 16, v158
  v_mfma_f32_16x16x32_bf16 v[136:139], a[208:211], v[76:79], v[136:139]
  v_and_b32 v189, 0xffff0000, v158
  v_lshlrev_b32 v190, 16, v159
  v_mfma_f32_16x16x32_bf16 v[136:139], a[216:219], v[80:83], v[136:139]
  v_and_b32 v191, 0xffff0000, v159
  v_mfma_f32_16x16x32_bf16 v[140:143], a[220:223], v[80:83], v[140:143]
  s_mov_b32 s55, 458752
  s_add_u32 m0, s45, 49152
  v_mfma_f32_16x16x32_bf16 v[140:143], a[212:215], v[76:79], v[140:143]
  s_waitcnt lgkmcnt(0)
  v_mfma_f32_16x16x32_bf16 v[136:139], a[224:227], v[100:103], v[136:139]
  buffer_load_dwordx4 v16, s[28:31], s55 offen lds
  v_mfma_f32_16x16x32_bf16 v[136:139], a[232:235], v[104:107], v[136:139]
  v_mfma_f32_16x16x32_bf16 v[140:143], a[236:239], v[104:107], v[140:143]
  v_mfma_f32_16x16x32_bf16 v[140:143], a[228:231], v[100:103], v[140:143]
  v_mfma_f32_16x16x32_bf16 v[136:139], a[240:243], v[92:95], v[136:139]
  v_mfma_f32_16x16x32_bf16 v[136:139], a[248:251], v[96:99], v[136:139]
  s_mov_b32 s55, 458752
  s_add_u32 m0, s45, 57344
  v_mfma_f32_16x16x32_bf16 v[140:143], v[124:127], v[96:99], v[140:143]
  buffer_load_dwordx4 v16, s[32:35], s55 offen lds
  v_mfma_f32_16x16x32_bf16 v[140:143], a[244:247], v[92:95], v[140:143]
  s_nop 2
  v_fmac_f32 v184, v160, v136
  v_fmac_f32 v185, v161, v137
  v_fmac_f32 v186, v162, v138
  v_fmac_f32 v187, v163, v139
  s_nop 0
  v_fmac_f32 v188, v164, v140
  v_fmac_f32 v189, v165, v141
  v_fmac_f32 v190, v166, v142
  v_fmac_f32 v191, v167, v143
  v_mul_f32 v136, v184, v168
  v_mul_f32 v137, v185, v169
  v_mul_f32 v138, v186, v170
  v_mul_f32 v139, v187, v171
  v_mul_f32 v140, v188, v172
  v_mul_f32 v141, v189, v173
  v_mul_f32 v142, v190, v174
  v_mul_f32 v143, v191, v175
  v_cvt_pk_bf16_f32 v208, v136, v137
  v_cvt_pk_bf16_f32 v209, v138, v139
  v_cvt_pk_bf16_f32 v210, v140, v141
  v_cvt_pk_bf16_f32 v211, v142, v143
  s_add_u32 s54, s47, 36896768
  buffer_store_dwordx4 v[208:211], v1, s[8:11], s54 offen sc1
  v_cvt_pk_bf16_f32 v156, v184, v185
  v_cvt_pk_bf16_f32 v157, v186, v187
  v_cvt_pk_bf16_f32 v158, v188, v189
  v_cvt_pk_bf16_f32 v159, v190, v191
  s_nop 1
  v_mfma_f32_16x16x32_bf16 v[230:233], v[176:179], v[156:159], 0
  v_mfma_f32_16x16x32_bf16 v[192:195], v[156:159], v[156:159], 0
  s_nop 7
  v_cndmask_b32 v192, v192, v193, s[88:89]
  v_cndmask_b32 v194, v194, v195, s[88:89]
  v_cndmask_b32 v231, v192, v194, s[90:91]
  buffer_store_dwordx4 v[228:231], v180, s[8:11], s48 offen offset:256 sc1
  ds_write_b128 v182, v[156:159] offset:12288
  s_mov_b64 exec, 0
  s_cmp_eq_u32 s44, 0
  s_cbranch_scc1 HOP12
  s_cmp_eq_u32 s44, 1
  s_cbranch_scc1 HOP13
  s_cmp_eq_u32 s44, 2
  s_cbranch_scc1 HOP14
  s_cmp_eq_u32 s44, 3
  s_cbranch_scc1 HOP15
WRET1:
  s_mov_b64 exec, -1
  s_waitcnt vmcnt(9) lgkmcnt(0)
  s_waitcnt vmcnt(5)
  s_cmp_lg_u32 s44, 0
  s_cbranch_scc1 PL9_adaLN_cond__sliding_local_dilated__swiglu_ffn__prompt_kernelx
  v_cmp_ne_u32 vcc, s46, v13
  s_nop 4
  s_cbranch_vccz PL9_adaLN_cond__sliding_local_dilated__swiglu_ffn__prompt_kernelx
  s_mov_b32 s57, 60000
PL9_adaLN_cond__sliding_local_dilated__swiglu_ffn__prompt_kernel:
  buffer_load_dword v13, v14, s[8:11], s77 offen sc1
  s_sub_u32 s57, s57, 1
  s_cmp_eq_u32 s57, 0
  s_waitcnt vmcnt(0)
  s_cbranch_scc1 PL9_adaLN_cond__sliding_local_dilated__swiglu_ffn__prompt_kernelx
  v_cmp_ne_u32 vcc, s46, v13
  s_nop 4
  s_cbranch_vccnz PL9_adaLN_cond__sliding_local_dilated__swiglu_ffn__prompt_kernel
PL9_adaLN_cond__sliding_local_dilated__swiglu_ffn__prompt_kernelx:
  s_barrier
  s_mov_b32 s63, 0
  s_add_u32 s71, s24, 0
  buffer_load_dwordx4 a[0:3], v1, s[8:11], s71 offen offset:0 sc1
  buffer_load_dwordx4 a[16:19], v1, s[8:11], s71 offen offset:1024 sc1
  s_add_u32 s71, s71, 65536
  buffer_load_dwordx4 a[4:7], v1, s[8:11], s71 offen offset:0 sc1
  buffer_load_dwordx4 a[20:23], v1, s[8:11], s71 offen offset:1024 sc1
  s_mov_b32 s64, 458752
  s_add_u32 s72, s24, 2048
  buffer_load_dwordx4 a[32:35], v1, s[8:11], s72 offen offset:0 sc1
  buffer_load_dwordx4 a[48:51], v1, s[8:11], s72 offen offset:1024 sc1
  s_add_u32 s72, s72, 65536
  buffer_load_dwordx4 a[36:39], v1, s[8:11], s72 offen offset:0 sc1
  buffer_load_dwordx4 a[52:55], v1, s[8:11], s72 offen offset:1024 sc1
  s_waitcnt vmcnt(17) lgkmcnt(0)
  v_add_u32 v9, s46, v0
  s_waitcnt vmcnt(8)
  s_barrier
  s_mov_b64 exec, 1
  buffer_store_dword v9, v0, s[8:11], s49 offen offset:0 sc1
  s_mov_b64 exec, -1
  s_mov_b32 s55, 688128
  s_add_u32 m0, s45, 53248
  s_nop 0
  buffer_load_dwordx4 v16, s[28:31], s55 offen lds
  s_mov_b32 s55, 688128
  s_add_u32 m0, s45, 61440
  s_nop 0
  buffer_load_dwordx4 v16, s[32:35], s55 offen lds
  v_mov_b32 v10, v16
  ds_read_b64_tr_b16 a[160:161], v6 offset:32768
  ds_read_b64_tr_b16 a[162:163], v6 offset:34816
  ds_read_b64_tr_b16 a[164:165], v6 offset:36864
  ds_read_b64_tr_b16 a[166:167], v6 offset:38912
  ds_read_b64_tr_b16 a[168:169], v6 offset:40960
  ds_read_b64_tr_b16 a[170:171], v6 offset:43008
  ds_read_b64_tr_b16 a[172:173], v6 offset:45056
  ds_read_b64_tr_b16 a[174:175], v6 offset:47104
  ds_read_b64_tr_b16 a[176:177], v7 offset:32768
  ds_read_b64_tr_b16 a[178:179], v7 offset:34816
  ds_read_b64_tr_b16 a[180:181], v7 offset:36864
  ds_read_b64_tr_b16 a[182:183], v7 offset:38912
  ds_read_b64_tr_b16 a[188:189], v7 offset:40960
  ds_read_b64_tr_b16 a[190:191], v7 offset:43008
  ds_read_b64_tr_b16 a[192:193], v7 offset:45056
  ds_read_b64_tr_b16 a[194:195], v7 offset:47104
  s_waitcnt vmcnt(7) lgkmcnt(8)
  v_mfma_f32_16x16x32_bf16 v[64:67], a[160:163], a[0:3], 0
  ds_read_b64_tr_b16 a[196:197], v8 offset:32768
  s_mov_b32 s65, 917504
  s_add_u32 s73, s24, 4096
  s_add_u32 m0, s45, 81920
  v_mfma_f32_16x16x32_bf16 v[64:67], a[164:167], a[16:19], v[64:67]
  ds_read_b64_tr_b16 a[198:199], v8 offset:34816
  buffer_load_dwordx4 v11, s[28:31], s65 offen lds
  v_mfma_f32_16x16x32_bf16 v[68:71], a[164:167], a[20:23], 0
  ds_read_b64_tr_b16 a[200:201], v8 offset:36864
  s_lshr_b32 s53, s2, 5
  v_mfma_f32_16x16x32_bf16 v[68:71], a[160:163], a[4:7], v[68:71]
  ds_read_b64_tr_b16 a[202:203], v8 offset:38912
  s_lshl_b32 s53, s53, 12
  v_mfma_f32_16x16x32_bf16 v[84:87], a[168:171], a[4:7], 0
  ds_read_b64_tr_b16 a[204:205], v8 offset:40960
  s_add_u32 m0, s45, 90112
  v_mfma_f32_16x16x32_bf16 v[84:87], a[172:175], a[20:23], v[84:87]
  ds_read_b64_tr_b16 a[206:207], v8 offset:43008
  buffer_load_dwordx4 v11, s[32:35], s65 offen lds
  v_mfma_f32_16x16x32_bf16 v[80:83], a[172:175], a[16:19], 0
  ds_read_b64_tr_b16 a[208:209], v8 offset:45056
  s_add_u32 s81, s53, 753664
  v_mfma_f32_16x16x32_bf16 v[80:83], a[168:171], a[0:3], v[80:83]
  s_waitcnt lgkmcnt(7)
  ds_read_b64_tr_b16 a[210:211], v8 offset:47104
  v_mfma_f32_16x16x32_bf16 v[96:99], a[176:179], a[0:3], 0
  ds_read_b64_tr_b16 a[164:165], v2 offset:32768
  s_add_u32 m0, s45, 86016
  s_add_u32 s60, s65, 229376
  v_mfma_f32_16x16x32_bf16 v[96:99], a[180:183], a[16:19], v[96:99]
  ds_read_b64_tr_b16 a[166:167], v2 offset:34816
  buffer_load_dwordx4 v11, s[28:31], s60 offen lds
  v_mfma_f32_16x16x32_bf16 v[100:103], a[180:183], a[20:23], 0
  ds_read_b64_tr_b16 a[160:161], v2 offset:36864
  v_and_b32 v15, 31, v0
  v_mfma_f32_16x16x32_bf16 v[100:103], a[176:179], a[4:7], v[100:103]
  ds_read_b64_tr_b16 a[162:163], v2 offset:38912
  v_lshlrev_b32 v15, 7, v15
  v_mfma_f32_16x16x32_bf16 v[116:119], a[188:191], a[4:7], 0
  ds_read_b64_tr_b16 a[172:173], v2 offset:40960
  s_add_u32 m0, s45, 94208
  s_add_u32 s60, s65, 229376
  v_mfma_f32_16x16x32_bf16 v[116:119], a[192:195], a[20:23], v[116:119]
  ds_read_b64_tr_b16 a[174:175], v2 offset:43008
  buffer_load_dwordx4 v11, s[32:35], s60 offen lds
  v_mfma_f32_16x16x32_bf16 v[112:115], a[192:195], a[16:19], 0
  ds_read_b64_tr_b16 a[168:169], v2 offset:45056
  s_and_b32 s52, s2, 7
  v_mfma_f32_16x16x32_bf16 v[112:115], a[188:191], a[0:3], v[112:115]
  s_waitcnt lgkmcnt(7)
  ds_read_b64_tr_b16 a[170:171], v2 offset:47104
  v_mfma_f32_16x16x32_bf16 v[32:35], a[196:199], a[0:3], 0
  ds_read_b64_tr_b16 a[180:181], v3 offset:32768
  s_add_u32 m0, s45, 0
  v_mfma_f32_16x16x32_bf16 v[32:35], a[200:203], a[16:19], v[32:35]
  ds_read_b64_tr_b16 a[182:183], v3 offset:34816
  buffer_load_dwordx4 v10, s[28:31], s65 offen lds
  v_mfma_f32_16x16x32_bf16 v[36:39], a[200:203], a[20:23], 0
  ds_read_b64_tr_b16 a[176:177], v3 offset:36864
  s_bfe_u32 s51, s2, 0x20003
  v_mfma_f32_16x16x32_bf16 v[36:39], a[196:199], a[4:7], v[36:39]
  ds_read_b64_tr_b16 a[178:179], v3 offset:38912
  s_lshr_b32 s50, s2, 5
  v_mfma_f32_16x16x32_bf16 v[52:55], a[204:207], a[4:7], 0
  ds_read_b64_tr_b16 a[192:193], v3 offset:40960
  s_add_u32 m0, s45, 8192
  v_mfma_f32_16x16x32_bf16 v[52:55], a[208:211], a[20:23], v[52:55]
  ds_read_b64_tr_b16 a[194:195], v3 offset:43008
  buffer_load_dwordx4 v10, s[32:35], s65 offen lds
  v_mfma_f32_16x16x32_bf16 v[48:51], a[208:211], a[16:19], 0
  ds_read_b64_tr_b16 a[188:189], v3 offset:45056
  s_add_u32 s56, s51, s50
  v_mfma_f32_16x16x32_bf16 v[48:51], a[204:207], a[0:3], v[48:51]
  s_waitcnt lgkmcnt(7)
  ds_read_b64_tr_b16 a[190:191], v3 offset:47104
  v_mfma_f32_16x16x32_bf16 v[128:131], a[164:167], a[0:3], 0
  ds_read_b64_tr_b16 a[200:201], v4 offset:32768
  s_add_u32 m0, s45, 4096
  s_add_u32 s60, s65, 229376
  v_mfma_f32_16x16x32_bf16 v[128:131], a[160:163], a[16:19], v[128:131]
  ds_read_b64_tr_b16 a[202:203], v4 offset:34816
  buffer_load_dwordx4 v10, s[28:31], s60 offen lds
  v_mfma_f32_16x16x32_bf16 v[132:135], a[160:163], a[20:23], 0
  ds_read_b64_tr_b16 a[196:197], v4 offset:36864
  s_and_b32 s56, s56, 3
  v_mfma_f32_16x16x32_bf16 v[132:135], a[164:167], a[4:7], v[132:135]
  ds_read_b64_tr_b16 a[198:199], v4 offset:38912
  s_lshl_b32 s53, s50, 1
  v_mfma_f32_16x16x32_bf16 v[148:151], a[172:175], a[4:7], 0
  ds_read_b64_tr_b16 a[208:209], v4 offset:40960
  s_add_u32 m0, s45, 12288
  s_add_u32 s60, s65, 229376
  v_mfma_f32_16x16x32_bf16 v[148:151], a[168:171], a[20:23], v[148:151]
  ds_read_b64_tr_b16 a[210:211], v4 offset:43008
  buffer_load_dwordx4 v10, s[32:35], s60 offen lds
  v_mfma_f32_16x16x32_bf16 v[144:147], a[168:171], a[16:19], 0
  ds_read_b64_tr_b16 a[204:205], v4 offset:45056
  s_lshr_b32 s54, s44, 1
  v_mfma_f32_16x16x32_bf16 v[144:147], a[172:175], a[0:3], v[144:147]
  s_waitcnt lgkmcnt(7)
  ds_read_b64_tr_b16 a[206:207], v4 offset:47104
  v_mfma_f32_16x16x32_bf16 v[160:163], a[180:183], a[0:3], 0
  ds_read_b64_tr_b16 a[160:161], v5 offset:32768
  v_mfma_f32_16x16x32_bf16 v[160:163], a[176:179], a[16:19], v[160:163]
  ds_read_b64_tr_b16 a[162:163], v5 offset:34816
  buffer_load_dwordx4 a[64:67], v1, s[8:11], s73 offen offset:0 sc1
  v_mfma_f32_16x16x32_bf16 v[164:167], a[176:179], a[20:23], 0
  ds_read_b64_tr_b16 a[164:165], v5 offset:36864
  s_add_u32 s53, s53, s54
  v_mfma_f32_16x16x32_bf16 v[164:167], a[180:183], a[4:7], v[164:167]
  ds_read_b64_tr_b16 a[166:167], v5 offset:38912
  s_lshl_b32 s62, s53, 3
  v_mfma_f32_16x16x32_bf16 v[180:183], a[192:195], a[4:7], 0
  ds_read_b64_tr_b16 a[168:169], v5 offset:40960
  s_and_b32 s55, s44, 1
  v_mfma_f32_16x16x32_bf16 v[180:183], a[188:191], a[20:23], v[180:183]
  ds_read_b64_tr_b16 a[170:171], v5 offset:43008
  buffer_load_dwordx4 a[80:83], v1, s[8:11], s73 offen offset:1024 sc1
  v_mfma_f32_16x16x32_bf16 v[176:179], a[188:191], a[16:19], 0
  ds_read_b64_tr_b16 a[172:173], v5 offset:45056
  s_add_u32 s62, s62, s55
  v_mfma_f32_16x16x32_bf16 v[176:179], a[192:195], a[0:3], v[176:179]
  s_waitcnt lgkmcnt(7)
  ds_read_b64_tr_b16 a[174:175], v5 offset:47104
  s_waitcnt vmcnt(10)
  s_barrier
  v_mfma_f32_16x16x32_bf16 v[192:195], a[200:203], a[0:3], 0
  ds_read_b64_tr_b16 a[176:177], v6 offset:49152
  s_lshl_b32 s82, s44, 28
  s_add_u32 s82, s82, s81
  buffer_load_dword v9, v15, s[8:11], s82 offen sc1
  s_add_u32 s73, s73, 65536
  v_mfma_f32_16x16x32_bf16 v[192:195], a[196:199], a[16:19], v[192:195]
  ds_read_b64_tr_b16 a[178:179], v6 offset:51200
  buffer_load_dwordx4 a[68:71], v1, s[8:11], s73 offen offset:0 sc1
  v_mfma_f32_16x16x32_bf16 v[196:199], a[196:199], a[20:23], 0
  ds_read_b64_tr_b16 a[180:181], v6 offset:53248
  s_lshl_b32 s79, s2, 7
  v_mfma_f32_16x16x32_bf16 v[196:199], a[200:203], a[4:7], v[196:199]
  ds_read_b64_tr_b16 a[182:183], v6 offset:55296
  s_lshl_b32 s53, s44, 28
  v_mfma_f32_16x16x32_bf16 v[212:215], a[208:211], a[4:7], 0
  ds_read_b64_tr_b16 a[188:189], v6 offset:57344
  s_add_u32 s79, s79, s53
  v_mfma_f32_16x16x32_bf16 v[212:215], a[204:207], a[20:23], v[212:215]
  ds_read_b64_tr_b16 a[190:191], v6 offset:59392
  buffer_load_dwordx4 a[84:87], v1, s[8:11], s73 offen offset:1024 sc1
  v_mfma_f32_16x16x32_bf16 v[208:211], a[204:207], a[16:19], 0
  ds_read_b64_tr_b16 a[192:193], v6 offset:61440
  s_add_u32 s79, s79, 884736
  v_mfma_f32_16x16x32_bf16 v[208:211], a[208:211], a[0:3], v[208:211]
  s_waitcnt lgkmcnt(7)
  ds_read_b64_tr_b16 a[194:195], v6 offset:63488
  v_mfma_f32_16x16x32_bf16 v[224:227], a[160:163], a[0:3], 0
  ds_read_b64_tr_b16 a[196:197], v7 offset:49152
  s_mov_b32 s66, 1376256
  s_add_u32 s74, s24, 6144
  s_add_u32 m0, s45, 65536
  v_mfma_f32_16x16x32_bf16 v[224:227], a[164:167], a[16:19], v[224:227]
  ds_read_b64_tr_b16 a[198:199], v7 offset:51200
  buffer_load_dwordx4 v11, s[28:31], s66 offen lds
  v_mfma_f32_16x16x32_bf16 v[228:231], a[164:167], a[20:23], 0
  ds_read_b64_tr_b16 a[200:201], v7 offset:53248
  s_lshl_b32 s53, s2, 2
  v_mfma_f32_16x16x32_bf16 v[228:231], a[160:163], a[4:7], v[228:231]
  ds_read_b64_tr_b16 a[202:203], v7 offset:55296
  s_add_u32 s53, s53, s44
  v_mfma_f32_16x16x32_bf16 v[244:247], a[168:171], a[4:7], 0
  ds_read_b64_tr_b16 a[204:205], v7 offset:57344
  s_add_u32 m0, s45, 73728
  v_mfma_f32_16x16x32_bf16 v[244:247], a[172:175], a[20:23], v[244:247]
  ds_read_b64_tr_b16 a[206:207], v7 offset:59392
  buffer_load_dwordx4 v11, s[32:35], s66 offen lds
  v_mfma_f32_16x16x32_bf16 v[240:243], a[172:175], a[16:19], 0
  ds_read_b64_tr_b16 a[208:209], v7 offset:61440
  s_lshl_b32 s53, s53, 7
  v_mfma_f32_16x16x32_bf16 v[240:243], a[168:171], a[0:3], v[240:243]
  s_waitcnt vmcnt(18) lgkmcnt(7)
  ds_read_b64_tr_b16 a[210:211], v7 offset:63488
  v_mfma_f32_16x16x32_bf16 v[64:67], a[176:179], a[32:35], v[64:67]
  ds_read_b64_tr_b16 a[164:165], v8 offset:49152
  s_add_u32 m0, s45, 69632
  s_add_u32 s60, s66, 229376
  v_mfma_f32_16x16x32_bf16 v[64:67], a[180:183], a[48:51], v[64:67]
  ds_read_b64_tr_b16 a[166:167], v8 offset:51200
  buffer_load_dwordx4 v11, s[28:31], s60 offen lds
  v_mfma_f32_16x16x32_bf16 v[68:71], a[180:183], a[52:55], v[68:71]
  ds_read_b64_tr_b16 a[160:161], v8 offset:53248
  s_add_u32 s80, s53, 917504
  v_mfma_f32_16x16x32_bf16 v[68:71], a[176:179], a[36:39], v[68:71]
  ds_read_b64_tr_b16 a[162:163], v8 offset:55296
  s_add_u32 s53, s45, 151552
  v_mfma_f32_16x16x32_bf16 v[84:87], a[188:191], a[36:39], v[84:87]
  ds_read_b64_tr_b16 a[172:173], v8 offset:57344
  s_add_u32 m0, s45, 77824
  s_add_u32 s60, s66, 229376
  v_mfma_f32_16x16x32_bf16 v[84:87], a[192:195], a[52:55], v[84:87]
  ds_read_b64_tr_b16 a[174:175], v8 offset:59392
  buffer_load_dwordx4 v11, s[32:35], s60 offen lds
  v_mfma_f32_16x16x32_bf16 v[80:83], a[192:195], a[48:51], v[80:83]
  ds_read_b64_tr_b16 a[168:169], v8 offset:61440
  v_bfe_u32 v24, v0, 3, 1
  v_mfma_f32_16x16x32_bf16 v[80:83], a[188:191], a[32:35], v[80:83]
  s_waitcnt lgkmcnt(7)
  ds_read_b64_tr_b16 a[170:171], v8 offset:63488
  v_mfma_f32_16x16x32_bf16 v[96:99], a[196:199], a[32:35], v[96:99]
  ds_read_b64_tr_b16 a[180:181], v2 offset:49152
  s_add_u32 m0, s45, 16384
  v_mfma_f32_16x16x32_bf16 v[96:99], a[200:203], a[48:51], v[96:99]
  ds_read_b64_tr_b16 a[182:183], v2 offset:51200
  buffer_load_dwordx4 v10, s[28:31], s66 offen lds
  v_mfma_f32_16x16x32_bf16 v[100:103], a[200:203], a[52:55], v[100:103]
  ds_read_b64_tr_b16 a[176:177], v2 offset:53248
  v_lshlrev_b32 v24, 9, v24
  v_mfma_f32_16x16x32_bf16 v[100:103], a[196:199], a[36:39], v[100:103]
  ds_read_b64_tr_b16 a[178:179], v2 offset:55296
  v_and_b32 v25, 1, v0
  v_mfma_f32_16x16x32_bf16 v[116:119], a[204:207], a[36:39], v[116:119]
  ds_read_b64_tr_b16 a[192:193], v2 offset:57344
  s_add_u32 m0, s45, 24576
  v_mfma_f32_16x16x32_bf16 v[116:119], a[208:211], a[52:55], v[116:119]
  ds_read_b64_tr_b16 a[194:195], v2 offset:59392
  buffer_load_dwordx4 v10, s[32:35], s66 offen lds
  v_mfma_f32_16x16x32_bf16 v[112:115], a[208:211], a[48:51], v[112:115]
  ds_read_b64_tr_b16 a[188:189], v2 offset:61440
  v_lshl_add_u32 v24, v25, 8, v24
  v_mfma_f32_16x16x32_bf16 v[112:115], a[204:207], a[32:35], v[112:115]
  s_waitcnt lgkmcnt(7)
  ds_read_b64_tr_b16 a[190:191], v2 offset:63488
  v_mfma_f32_16x16x32_bf16 v[32:35], a[164:167], a[32:35], v[32:35]
  ds_read_b64_tr_b16 a[200:201], v3 offset:49152
  s_add_u32 m0, s45, 20480
  s_add_u32 s60, s66, 229376
  v_mfma_f32_16x16x32_bf16 v[32:35], a[160:163], a[48:51], v[32:35]
  ds_read_b64_tr_b16 a[202:203], v3 offset:51200
  buffer_load_dwordx4 v10, s[28:31], s60 offen lds
  v_mfma_f32_16x16x32_bf16 v[36:39], a[160:163], a[52:55], v[36:39]
  ds_read_b64_tr_b16 a[196:197], v3 offset:53248
  v_lshrrev_b32 v25, 4, v0
  v_mfma_f32_16x16x32_bf16 v[36:39], a[164:167], a[36:39], v[36:39]
  ds_read_b64_tr_b16 a[198:199], v3 offset:55296
  v_lshl_add_u32 v24, v25, 6, v24
  v_mfma_f32_16x16x32_bf16 v[52:55], a[172:175], a[36:39], v[52:55]
  ds_read_b64_tr_b16 a[208:209], v3 offset:57344
  s_add_u32 m0, s45, 28672
  s_add_u32 s60, s66, 229376
  v_mfma_f32_16x16x32_bf16 v[52:55], a[168:171], a[52:55], v[52:55]
  ds_read_b64_tr_b16 a[210:211], v3 offset:59392
  buffer_load_dwordx4 v10, s[32:35], s60 offen lds
  v_mfma_f32_16x16x32_bf16 v[48:51], a[168:171], a[48:51], v[48:51]
  ds_read_b64_tr_b16 a[204:205], v3 offset:61440
  v_add_u32 v14, s53, v24
  v_mfma_f32_16x16x32_bf16 v[48:51], a[172:175], a[32:35], v[48:51]
  s_waitcnt lgkmcnt(7)
  ds_read_b64_tr_b16 a[206:207], v3 offset:63488
  v_mfma_f32_16x16x32_bf16 v[128:131], a[180:183], a[32:35], v[128:131]
  ds_read_b64_tr_b16 a[160:161], v4 offset:49152
  s_waitcnt vmcnt(10)
  s_cmp_lg_u32 s44, 0
  s_cbranch_scc1 PL10_adaLN_cond__sliding_local_dilated__swiglu_ffn__prompt_kernelx
  v_cmp_ne_u32 vcc, s46, v9
  s_nop 4
  s_cbranch_vccz PL10_adaLN_cond__sliding_local_dilated__swiglu_ffn__prompt_kernelx
  s_mov_b32 s82, 60000
PL10_adaLN_cond__sliding_local_dilated__swiglu_ffn__prompt_kernel:
  buffer_load_dword v9, v15, s[8:11], s81 offen sc1
  s_sub_u32 s82, s82, 1
  s_cmp_eq_u32 s82, 0
  s_waitcnt vmcnt(0)
  s_cbranch_scc1 PL10_adaLN_cond__sliding_local_dilated__swiglu_ffn__prompt_kernelx
  v_cmp_ne_u32 vcc, s46, v9
  s_nop 4
  s_cbranch_vccnz PL10_adaLN_cond__sliding_local_dilated__swiglu_ffn__prompt_kernel
PL10_adaLN_cond__sliding_local_dilated__swiglu_ffn__prompt_kernelx:
  s_barrier
  v_mfma_f32_16x16x32_bf16 v[128:131], a[176:179], a[48:51], v[128:131]
  ds_read_b64_tr_b16 a[162:163], v4 offset:51200
  buffer_load_dwordx4 a[96:99], v1, s[8:11], s74 offen offset:0 sc1
  v_mfma_f32_16x16x32_bf16 v[132:135], a[176:179], a[52:55], v[132:135]
  ds_read_b64_tr_b16 a[164:165], v4 offset:53248
  s_bfe_u32 s53, s2, 0x20004
  v_mfma_f32_16x16x32_bf16 v[132:135], a[180:183], a[36:39], v[132:135]
  ds_read_b64_tr_b16 a[166:167], v4 offset:55296
  s_lshl_b32 s53, s53, 8
  v_mfma_f32_16x16x32_bf16 v[148:151], a[192:195], a[36:39], v[148:151]
  ds_read_b64_tr_b16 a[168:169], v4 offset:57344
  s_add_u32 s71, s71, 65536
  v_mfma_f32_16x16x32_bf16 v[148:151], a[188:191], a[52:55], v[148:151]
  ds_read_b64_tr_b16 a[170:171], v4 offset:59392
  buffer_load_dwordx4 a[8:11], v1, s[8:11], s71 offen offset:0 sc1
  v_mfma_f32_16x16x32_bf16 v[144:147], a[188:191], a[48:51], v[144:147]
  ds_read_b64_tr_b16 a[172:173], v4 offset:61440
  v_and_b32 v24, 15, v0
  v_mfma_f32_16x16x32_bf16 v[144:147], a[192:195], a[32:35], v[144:147]
  s_waitcnt lgkmcnt(7)
  ds_read_b64_tr_b16 a[174:175], v4 offset:63488
  buffer_load_dwordx4 a[24:27], v1, s[8:11], s71 offen offset:1024 sc1
  v_mfma_f32_16x16x32_bf16 v[160:163], a[200:203], a[32:35], v[160:163]
  ds_read_b64_tr_b16 a[176:177], v5 offset:49152
HOP7:
  s_cbranch_execz HOP11
  s_add_u32 s71, s71, 65536
  v_mfma_f32_16x16x32_bf16 v[160:163], a[196:199], a[48:51], v[160:163]
  ds_read_b64_tr_b16 a[178:179], v5 offset:51200
  buffer_load_dwordx4 a[12:15], v1, s[8:11], s71 offen offset:0 sc1
  v_mfma_f32_16x16x32_bf16 v[164:167], a[196:199], a[52:55], v[164:167]
  ds_read_b64_tr_b16 a[180:181], v5 offset:53248
  v_lshl_add_u32 v24, v24, 4, s53
  v_mfma_f32_16x16x32_bf16 v[164:167], a[200:203], a[36:39], v[164:167]
  ds_read_b64_tr_b16 a[182:183], v5 offset:55296
  buffer_load_dwordx4 a[28:31], v1, s[8:11], s71 offen offset:1024 sc1
  v_mfma_f32_16x16x32_bf16 v[180:183], a[208:211], a[36:39], v[180:183]
  ds_read_b64_tr_b16 a[188:189], v5 offset:57344
  s_add_u32 s72, s72, 65536
  v_mfma_f32_16x16x32_bf16 v[180:183], a[204:207], a[52:55], v[180:183]
  ds_read_b64_tr_b16 a[190:191], v5 offset:59392
  buffer_load_dwordx4 a[40:43], v1, s[8:11], s72 offen offset:0 sc1
  v_cmp_gt_u32 vcc, 896, v24
  v_mov_b32 v26, 1073741824
  v_mul_u32_u24 v25, 114688, v25
  v_cndmask_b32 v24, v26, v24, vcc
  v_mfma_f32_16x16x32_bf16 v[176:179], a[204:207], a[48:51], v[176:179]
  ds_read_b64_tr_b16 a[192:193], v5 offset:61440
  s_lshr_b32 s53, s2, 6
  v_mfma_f32_16x16x32_bf16 v[176:179], a[208:211], a[32:35], v[176:179]
  s_waitcnt lgkmcnt(7)
  ds_read_b64_tr_b16 a[194:195], v5 offset:63488
  buffer_load_dwordx4 a[56:59], v1, s[8:11], s72 offen offset:1024 sc1
  v_mfma_f32_16x16x32_bf16 v[192:195], a[160:163], a[32:35], v[192:195]
  ds_read_b64_tr_b16 a[196:197], v6 offset:32768
  s_add_u32 s72, s72, 65536
  v_mfma_f32_16x16x32_bf16 v[192:195], a[164:167], a[48:51], v[192:195]
  ds_read_b64_tr_b16 a[198:199], v6 offset:34816
  buffer_load_dwordx4 a[44:47], v1, s[8:11], s72 offen offset:0 sc1
  v_mfma_f32_16x16x32_bf16 v[196:199], a[164:167], a[52:55], v[196:199]
  ds_read_b64_tr_b16 a[200:201], v6 offset:36864
  s_lshl_b32 s53, s53, 2
  v_mfma_f32_16x16x32_bf16 v[196:199], a[160:163], a[36:39], v[196:199]
  ds_read_b64_tr_b16 a[202:203], v6 offset:38912
  buffer_load_dwordx4 a[60:63], v1, s[8:11], s72 offen offset:1024 sc1
  v_mfma_f32_16x16x32_bf16 v[212:215], a[168:171], a[36:39], v[212:215]
  ds_read_b64_tr_b16 a[204:205], v6 offset:40960
  s_add_u32 s73, s73, 65536
  v_mfma_f32_16x16x32_bf16 v[212:215], a[172:175], a[52:55], v[212:215]
  ds_read_b64_tr_b16 a[206:207], v6 offset:43008
  buffer_load_dwordx4 a[72:75], v1, s[8:11], s73 offen offset:0 sc1
  v_mfma_f32_16x16x32_bf16 v[208:211], a[172:175], a[48:51], v[208:211]
  ds_read_b64_tr_b16 a[208:209], v6 offset:45056
  s_add_u32 s53, s53, s44
  v_mfma_f32_16x16x32_bf16 v[208:211], a[168:171], a[32:35], v[208:211]
  s_waitcnt lgkmcnt(7)
  ds_read_b64_tr_b16 a[210:211], v6 offset:47104
  v_mfma_f32_16x16x32_bf16 v[224:227], a[176:179], a[32:35], v[224:227]
  ds_read_b64_tr_b16 a[164:165], v7 offset:32768
  s_mul_i32 s53, s53, 458752
  v_mfma_f32_16x16x32_bf16 v[224:227], a[180:183], a[48:51], v[224:227]
  ds_read_b64_tr_b16 a[166:167], v7 offset:34816
  buffer_load_dwordx4 a[88:91], v1, s[8:11], s73 offen offset:1024 sc1
  v_mfma_f32_16x16x32_bf16 v[228:231], a[180:183], a[52:55], v[228:231]
  ds_read_b64_tr_b16 a[160:161], v7 offset:36864
  s_mul_i32 s54, s52, 896
  v_mfma_f32_16x16x32_bf16 v[228:231], a[176:179], a[36:39], v[228:231]
  ds_read_b64_tr_b16 a[162:163], v7 offset:38912
  s_add_u32 s53, s53, s54
  v_mfma_f32_16x16x32_bf16 v[244:247], a[188:191], a[36:39], v[244:247]
  ds_read_b64_tr_b16 a[172:173], v7 offset:40960
  s_add_u32 s73, s73, 65536
  v_mfma_f32_16x16x32_bf16 v[244:247], a[192:195], a[52:55], v[244:247]
  ds_read_b64_tr_b16 a[174:175], v7 offset:43008
  buffer_load_dwordx4 a[76:79], v1, s[8:11], s73 offen offset:0 sc1
  v_mfma_f32_16x16x32_bf16 v[240:243], a[192:195], a[48:51], v[240:243]
  ds_read_b64_tr_b16 a[168:169], v7 offset:45056
  v_add3_u32 v13, v24, v25, s53
  v_mfma_f32_16x16x32_bf16 v[240:243], a[188:191], a[32:35], v[240:243]
  s_waitcnt vmcnt(7) lgkmcnt(7)
  ds_read_b64_tr_b16 a[170:171], v7 offset:47104
  v_mfma_f32_16x16x32_bf16 v[72:75], a[196:199], a[8:11], 0
  ds_read_b64_tr_b16 a[180:181], v8 offset:32768
  s_lshl_b32 s57, s51, 12
  v_mfma_f32_16x16x32_bf16 v[72:75], a[200:203], a[24:27], v[72:75]
  ds_read_b64_tr_b16 a[182:183], v8 offset:34816
  buffer_load_dwordx4 a[92:95], v1, s[8:11], s73 offen offset:1024 sc1
  v_mfma_f32_16x16x32_bf16 v[76:79], a[200:203], a[28:31], 0
  ds_read_b64_tr_b16 a[176:177], v8 offset:36864
  s_lshl_b32 s54, s51, 3
  v_mfma_f32_16x16x32_bf16 v[76:79], a[196:199], a[12:15], v[76:79]
  ds_read_b64_tr_b16 a[178:179], v8 offset:38912
  s_lshr_b32 s53, 0x0b070602, s54
  v_mfma_f32_16x16x32_bf16 v[92:95], a[204:207], a[12:15], 0
  ds_read_b64_tr_b16 a[192:193], v8 offset:40960
  s_and_b32 s53, s53, 15
  v_mfma_f32_16x16x32_bf16 v[92:95], a[208:211], a[28:31], v[92:95]
  ds_read_b64_tr_b16 a[194:195], v8 offset:43008
  s_lshl_b32 s58, s53, 10
  v_mfma_f32_16x16x32_bf16 v[88:91], a[208:211], a[24:27], 0
  ds_read_b64_tr_b16 a[188:189], v8 offset:45056
  buffer_load_dwordx4 a[112:115], v1, s[8:11], s74 offen offset:1024 sc1
  v_mfma_f32_16x16x32_bf16 v[88:91], a[204:207], a[8:11], v[88:91]
  s_waitcnt lgkmcnt(7)
  ds_read_b64_tr_b16 a[190:191], v8 offset:47104
  v_mfma_f32_16x16x32_bf16 v[104:107], a[164:167], a[8:11], 0
  ds_read_b64_tr_b16 a[200:201], v2 offset:32768
  s_lshr_b32 s53, s51, 1
  v_mfma_f32_16x16x32_bf16 v[104:107], a[160:163], a[24:27], v[104:107]
  ds_read_b64_tr_b16 a[202:203], v2 offset:34816
  s_mul_i32 s53, s53, 7168
  v_mfma_f32_16x16x32_bf16 v[108:111], a[160:163], a[28:31], 0
  ds_read_b64_tr_b16 a[196:197], v2 offset:36864
  s_mov_b32 s61, 0
  v_mfma_f32_16x16x32_bf16 v[108:111], a[164:167], a[12:15], v[108:111]
  ds_read_b64_tr_b16 a[198:199], v2 offset:38912
  buffer_load_dwordx4 a[220:223], v13, s[12:15], s61 offen
  v_mfma_f32_16x16x32_bf16 v[124:127], a[172:175], a[12:15], 0
  ds_read_b64_tr_b16 a[208:209], v2 offset:40960
  s_mov_b32 s61, 7168
  v_mfma_f32_16x16x32_bf16 v[124:127], a[168:171], a[28:31], v[124:127]
  ds_read_b64_tr_b16 a[210:211], v2 offset:43008
  buffer_load_dwordx4 a[224:227], v13, s[12:15], s61 offen
  v_mfma_f32_16x16x32_bf16 v[120:123], a[168:171], a[24:27], 0
  ds_read_b64_tr_b16 a[204:205], v2 offset:45056
  s_mov_b32 s61, 14336
  s_and_b32 s54, s54, 8
  v_mfma_f32_16x16x32_bf16 v[120:123], a[172:175], a[8:11], v[120:123]
  s_waitcnt lgkmcnt(7)
  ds_read_b64_tr_b16 a[206:207], v2 offset:47104
  buffer_load_dwordx4 a[228:231], v13, s[12:15], s61 offen
  v_mfma_f32_16x16x32_bf16 v[40:43], a[180:183], a[8:11], 0
  ds_read_b64_tr_b16 a[160:161], v3 offset:32768
  s_mov_b32 s61, 21504
  v_mfma_f32_16x16x32_bf16 v[40:43], a[176:179], a[24:27], v[40:43]
  ds_read_b64_tr_b16 a[162:163], v3 offset:34816
  buffer_load_dwordx4 a[232:235], v13, s[12:15], s61 offen
  v_mfma_f32_16x16x32_bf16 v[44:47], a[176:179], a[28:31], 0
  ds_read_b64_tr_b16 a[164:165], v3 offset:36864
  s_add_u32 s53, s53, s54
  v_mfma_f32_16x16x32_bf16 v[44:47], a[180:183], a[12:15], v[44:47]
  ds_read_b64_tr_b16 a[166:167], v3 offset:38912
  s_add_u32 s59, s53, 3072
  v_mfma_f32_16x16x32_bf16 v[60:63], a[192:195], a[12:15], 0
  ds_read_b64_tr_b16 a[168:169], v3 offset:40960
  s_mul_i32 s53, s52, 14336
  v_mfma_f32_16x16x32_bf16 v[60:63], a[188:191], a[28:31], v[60:63]
  ds_read_b64_tr_b16 a[170:171], v3 offset:43008
  s_mul_i32 s54, s62, 131072
  v_mfma_f32_16x16x32_bf16 v[56:59], a[188:191], a[24:27], 0
  ds_read_b64_tr_b16 a[172:173], v3 offset:45056
  s_add_u32 s53, s53, s54
  v_mfma_f32_16x16x32_bf16 v[56:59], a[192:195], a[8:11], v[56:59]
  s_waitcnt lgkmcnt(7)
  ds_read_b64_tr_b16 a[174:175], v3 offset:47104
  v_mfma_f32_16x16x32_bf16 v[136:139], a[200:203], a[8:11], 0
  ds_read_b64_tr_b16 a[176:177], v4 offset:32768
  s_add_u32 s53, s53, 19922944
  v_mfma_f32_16x16x32_bf16 v[136:139], a[196:199], a[24:27], v[136:139]
  ds_read_b64_tr_b16 a[178:179], v4 offset:34816
  s_add_u32 s57, s57, s53
  v_mfma_f32_16x16x32_bf16 v[140:143], a[196:199], a[28:31], 0
  ds_read_b64_tr_b16 a[180:181], v4 offset:36864
  s_add_u32 s58, s58, s53
  v_mfma_f32_16x16x32_bf16 v[140:143], a[200:203], a[12:15], v[140:143]
  ds_read_b64_tr_b16 a[182:183], v4 offset:38912
  s_add_u32 s59, s59, s53
  v_mfma_f32_16x16x32_bf16 v[156:159], a[208:211], a[12:15], 0
  ds_read_b64_tr_b16 a[188:189], v4 offset:40960
  s_lshl_b32 s62, s50, 2
  v_mfma_f32_16x16x32_bf16 v[156:159], a[204:207], a[28:31], v[156:159]
  ds_read_b64_tr_b16 a[190:191], v4 offset:43008
  s_add_u32 s62, s62, s44
  v_mfma_f32_16x16x32_bf16 v[152:155], a[204:207], a[24:27], 0
  ds_read_b64_tr_b16 a[192:193], v4 offset:45056
  s_lshl_b32 s62, s62, 14
  v_mfma_f32_16x16x32_bf16 v[152:155], a[208:211], a[8:11], v[152:155]
  s_waitcnt lgkmcnt(7)
  ds_read_b64_tr_b16 a[194:195], v4 offset:47104
  v_mfma_f32_16x16x32_bf16 v[168:171], a[160:163], a[8:11], 0
  ds_read_b64_tr_b16 a[196:197], v5 offset:32768
  s_add_u32 s62, s62, 6291456
  v_mfma_f32_16x16x32_bf16 v[168:171], a[164:167], a[24:27], v[168:171]
  ds_read_b64_tr_b16 a[198:199], v5 offset:34816
  v_and_b32 v12, 0x300, v1
  v_mfma_f32_16x16x32_bf16 v[172:175], a[164:167], a[28:31], 0
  ds_read_b64_tr_b16 a[200:201], v5 offset:36864
  v_add_u32 v12, v12, v1
  v_mfma_f32_16x16x32_bf16 v[172:175], a[160:163], a[12:15], v[172:175]
  ds_read_b64_tr_b16 a[202:203], v5 offset:38912
  v_mfma_f32_16x16x32_bf16 v[188:191], a[168:171], a[12:15], 0
  ds_read_b64_tr_b16 a[204:205], v5 offset:40960
  v_mfma_f32_16x16x32_bf16 v[188:191], a[172:175], a[28:31], v[188:191]
  ds_read_b64_tr_b16 a[206:207], v5 offset:43008
  v_mfma_f32_16x16x32_bf16 v[184:187], a[172:175], a[24:27], 0
  ds_read_b64_tr_b16 a[208:209], v5 offset:45056
  v_mfma_f32_16x16x32_bf16 v[184:187], a[168:171], a[8:11], v[184:187]
  s_waitcnt lgkmcnt(7)
  ds_read_b64_tr_b16 a[210:211], v5 offset:47104
  v_mfma_f32_16x16x32_bf16 v[200:203], a[176:179], a[8:11], 0
  ds_read_b64_tr_b16 a[164:165], v6 offset:49152
  v_mfma_f32_16x16x32_bf16 v[200:203], a[180:183], a[24:27], v[200:203]
  ds_read_b64_tr_b16 a[166:167], v6 offset:51200
  v_mfma_f32_16x16x32_bf16 v[204:207], a[180:183], a[28:31], 0
  ds_read_b64_tr_b16 a[160:161], v6 offset:53248
  v_mfma_f32_16x16x32_bf16 v[204:207], a[176:179], a[12:15], v[204:207]
  ds_read_b64_tr_b16 a[162:163], v6 offset:55296
  v_mfma_f32_16x16x32_bf16 v[220:223], a[188:191], a[12:15], 0
  ds_read_b64_tr_b16 a[172:173], v6 offset:57344
  v_mfma_f32_16x16x32_bf16 v[220:223], a[192:195], a[28:31], v[220:223]
  ds_read_b64_tr_b16 a[174:175], v6 offset:59392
  v_mfma_f32_16x16x32_bf16 v[216:219], a[192:195], a[24:27], 0
  ds_read_b64_tr_b16 a[168:169], v6 offset:61440
  s_add_u32 s74, s74, 65536
  v_mfma_f32_16x16x32_bf16 v[216:219], a[188:191], a[8:11], v[216:219]
  s_waitcnt lgkmcnt(7)
  ds_read_b64_tr_b16 a[170:171], v6 offset:63488
  v_mfma_f32_16x16x32_bf16 v[232:235], a[196:199], a[8:11], 0
  ds_read_b64_tr_b16 a[180:181], v7 offset:49152
  buffer_load_dwordx4 a[100:103], v1, s[8:11], s74 offen offset:0 sc1
  v_mfma_f32_16x16x32_bf16 v[232:235], a[200:203], a[24:27], v[232:235]
  ds_read_b64_tr_b16 a[182:183], v7 offset:51200
  v_mfma_f32_16x16x32_bf16 v[236:239], a[200:203], a[28:31], 0
  ds_read_b64_tr_b16 a[176:177], v7 offset:53248
  v_mfma_f32_16x16x32_bf16 v[236:239], a[196:199], a[12:15], v[236:239]
  ds_read_b64_tr_b16 a[178:179], v7 offset:55296
  v_mfma_f32_16x16x32_bf16 v[252:255], a[204:207], a[12:15], 0
  ds_read_b64_tr_b16 a[192:193], v7 offset:57344
  s_barrier
  v_mfma_f32_16x16x32_bf16 v[252:255], a[208:211], a[28:31], v[252:255]
  ds_read_b64_tr_b16 a[194:195], v7 offset:59392
  buffer_load_dwordx4 a[116:119], v1, s[8:11], s74 offen offset:1024 sc1
  v_mfma_f32_16x16x32_bf16 v[248:251], a[208:211], a[24:27], 0
  ds_read_b64_tr_b16 a[188:189], v7 offset:61440
  v_mfma_f32_16x16x32_bf16 v[248:251], a[204:207], a[8:11], v[248:251]
  s_waitcnt vmcnt(11) lgkmcnt(7)
  ds_read_b64_tr_b16 a[190:191], v7 offset:63488
  v_mfma_f32_16x16x32_bf16 v[72:75], a[164:167], a[40:43], v[72:75]
  ds_read_b64_tr_b16 a[200:201], v8 offset:49152
  s_add_u32 s74, s74, 65536
  v_mfma_f32_16x16x32_bf16 v[72:75], a[160:163], a[56:59], v[72:75]
  ds_read_b64_tr_b16 a[202:203], v8 offset:51200
  buffer_load_dwordx4 a[104:107], v1, s[8:11], s74 offen offset:0 sc1
  v_mfma_f32_16x16x32_bf16 v[76:79], a[160:163], a[60:63], v[76:79]
  ds_read_b64_tr_b16 a[196:197], v8 offset:53248
  v_mfma_f32_16x16x32_bf16 v[76:79], a[164:167], a[44:47], v[76:79]
  ds_read_b64_tr_b16 a[198:199], v8 offset:55296
  v_mfma_f32_16x16x32_bf16 v[92:95], a[172:175], a[44:47], v[92:95]
  ds_read_b64_tr_b16 a[208:209], v8 offset:57344
  v_mfma_f32_16x16x32_bf16 v[92:95], a[168:171], a[60:63], v[92:95]
  ds_read_b64_tr_b16 a[210:211], v8 offset:59392
  v_mfma_f32_16x16x32_bf16 v[88:91], a[168:171], a[56:59], v[88:91]
  ds_read_b64_tr_b16 a[204:205], v8 offset:61440
  buffer_load_dwordx4 a[120:123], v1, s[8:11], s74 offen offset:1024 sc1
  v_mfma_f32_16x16x32_bf16 v[88:91], a[172:175], a[40:43], v[88:91]
  s_waitcnt lgkmcnt(7)
  ds_read_b64_tr_b16 a[206:207], v8 offset:63488
  v_mfma_f32_16x16x32_bf16 v[104:107], a[180:183], a[40:43], v[104:107]
  ds_read_b64_tr_b16 a[160:161], v2 offset:49152
  v_mfma_f32_16x16x32_bf16 v[104:107], a[176:179], a[56:59], v[104:107]
  ds_read_b64_tr_b16 a[162:163], v2 offset:51200
  v_mfma_f32_16x16x32_bf16 v[108:111], a[176:179], a[60:63], v[108:111]
  ds_read_b64_tr_b16 a[164:165], v2 offset:53248
  s_add_u32 s74, s74, 65536
  v_mfma_f32_16x16x32_bf16 v[108:111], a[180:183], a[44:47], v[108:111]
  ds_read_b64_tr_b16 a[166:167], v2 offset:55296
  buffer_load_dwordx4 a[108:111], v1, s[8:11], s74 offen offset:0 sc1
  v_mfma_f32_16x16x32_bf16 v[124:127], a[192:195], a[44:47], v[124:127]
  ds_read_b64_tr_b16 a[168:169], v2 offset:57344
  v_mfma_f32_16x16x32_bf16 v[124:127], a[188:191], a[60:63], v[124:127]
  ds_read_b64_tr_b16 a[170:171], v2 offset:59392
  v_mfma_f32_16x16x32_bf16 v[120:123], a[188:191], a[56:59], v[120:123]
  ds_read_b64_tr_b16 a[172:173], v2 offset:61440
  v_mfma_f32_16x16x32_bf16 v[120:123], a[192:195], a[40:43], v[120:123]
  s_waitcnt lgkmcnt(7)
  ds_read_b64_tr_b16 a[174:175], v2 offset:63488
  v_mfma_f32_16x16x32_bf16 v[40:43], a[200:203], a[40:43], v[40:43]
  ds_read_b64_tr_b16 a[176:177], v3 offset:49152
  buffer_load_dwordx4 a[124:127], v1, s[8:11], s74 offen offset:1024 sc1
  v_mfma_f32_16x16x32_bf16 v[40:43], a[196:199], a[56:59], v[40:43]
  ds_read_b64_tr_b16 a[178:179], v3 offset:51200
  v_mfma_f32_16x16x32_bf16 v[44:47], a[196:199], a[60:63], v[44:47]
  ds_read_b64_tr_b16 a[180:181], v3 offset:53248
  v_mfma_f32_16x16x32_bf16 v[44:47], a[200:203], a[44:47], v[44:47]
  ds_read_b64_tr_b16 a[182:183], v3 offset:55296
  v_mfma_f32_16x16x32_bf16 v[60:63], a[208:211], a[44:47], v[60:63]
  ds_read_b64_tr_b16 a[188:189], v3 offset:57344
  s_mov_b32 s61, 28672
  v_mfma_f32_16x16x32_bf16 v[60:63], a[204:207], a[60:63], v[60:63]
  ds_read_b64_tr_b16 a[190:191], v3 offset:59392
  buffer_load_dwordx4 a[236:239], v13, s[12:15], s61 offen
  v_mfma_f32_16x16x32_bf16 v[56:59], a[204:207], a[56:59], v[56:59]
  ds_read_b64_tr_b16 a[192:193], v3 offset:61440
  s_mov_b32 s61, 35840
  v_mfma_f32_16x16x32_bf16 v[56:59], a[208:211], a[40:43], v[56:59]
  s_waitcnt lgkmcnt(7)
  ds_read_b64_tr_b16 a[194:195], v3 offset:63488
  buffer_load_dwordx4 a[240:243], v13, s[12:15], s61 offen
  v_mfma_f32_16x16x32_bf16 v[136:139], a[160:163], a[40:43], v[136:139]
  ds_read_b64_tr_b16 a[196:197], v4 offset:49152
  s_mov_b32 s61, 43008
  v_mfma_f32_16x16x32_bf16 v[136:139], a[164:167], a[56:59], v[136:139]
  ds_read_b64_tr_b16 a[198:199], v4 offset:51200
  buffer_load_dwordx4 a[244:247], v13, s[12:15], s61 offen
  v_mfma_f32_16x16x32_bf16 v[140:143], a[164:167], a[60:63], v[140:143]
  ds_read_b64_tr_b16 a[200:201], v4 offset:53248
  s_mov_b32 s61, 50176
  v_mfma_f32_16x16x32_bf16 v[140:143], a[160:163], a[44:47], v[140:143]
  ds_read_b64_tr_b16 a[202:203], v4 offset:55296
  buffer_load_dwordx4 a[248:251], v13, s[12:15], s61 offen
  v_mfma_f32_16x16x32_bf16 v[156:159], a[168:171], a[44:47], v[156:159]
  ds_read_b64_tr_b16 a[204:205], v4 offset:57344
  v_mfma_f32_16x16x32_bf16 v[156:159], a[172:175], a[60:63], v[156:159]
  ds_read_b64_tr_b16 a[206:207], v4 offset:59392
  v_mfma_f32_16x16x32_bf16 v[152:155], a[172:175], a[56:59], v[152:155]
  ds_read_b64_tr_b16 a[208:209], v4 offset:61440
  v_mfma_f32_16x16x32_bf16 v[152:155], a[168:171], a[40:43], v[152:155]
  s_waitcnt lgkmcnt(7)
  ds_read_b64_tr_b16 a[210:211], v4 offset:63488
  v_mfma_f32_16x16x32_bf16 v[168:171], a[176:179], a[40:43], v[168:171]
  ds_read_b64_tr_b16 a[164:165], v5 offset:49152
  v_mfma_f32_16x16x32_bf16 v[168:171], a[180:183], a[56:59], v[168:171]
  ds_read_b64_tr_b16 a[166:167], v5 offset:51200
  v_mfma_f32_16x16x32_bf16 v[172:175], a[180:183], a[60:63], v[172:175]
  ds_read_b64_tr_b16 a[160:161], v5 offset:53248
  v_mfma_f32_16x16x32_bf16 v[172:175], a[176:179], a[44:47], v[172:175]
  ds_read_b64_tr_b16 a[162:163], v5 offset:55296
  v_mfma_f32_16x16x32_bf16 v[188:191], a[188:191], a[44:47], v[188:191]
  ds_read_b64_tr_b16 a[172:173], v5 offset:57344
  v_mfma_f32_16x16x32_bf16 v[188:191], a[192:195], a[60:63], v[188:191]
  ds_read_b64_tr_b16 a[174:175], v5 offset:59392
  s_waitcnt vmcnt(41)
  s_barrier
  v_mfma_f32_16x16x32_bf16 v[184:187], a[192:195], a[56:59], v[184:187]
  ds_read_b64_tr_b16 a[168:169], v5 offset:61440
  ds_read_b64_tr_b16 a[180:181], v6 offset:16384
  v_mfma_f32_16x16x32_bf16 v[184:187], a[188:191], a[40:43], v[184:187]
  s_waitcnt lgkmcnt(8)
  ds_read_b64_tr_b16 a[170:171], v5 offset:63488
  v_mfma_f32_16x16x32_bf16 v[200:203], a[196:199], a[40:43], v[200:203]
  ds_read_b64_tr_b16 a[182:183], v6 offset:18432
  v_mfma_f32_16x16x32_bf16 v[200:203], a[200:203], a[56:59], v[200:203]
  v_mfma_f32_16x16x32_bf16 v[204:207], a[200:203], a[60:63], v[204:207]
  ds_read_b64_tr_b16 a[176:177], v6 offset:20480
  v_mfma_f32_16x16x32_bf16 v[204:207], a[196:199], a[44:47], v[204:207]
  v_mfma_f32_16x16x32_bf16 v[220:223], a[204:207], a[44:47], v[220:223]
  ds_read_b64_tr_b16 a[178:179], v6 offset:22528
  v_mfma_f32_16x16x32_bf16 v[220:223], a[208:211], a[60:63], v[220:223]
  ds_read_b128 v[24:27], v14 offset:0
  v_mfma_f32_16x16x32_bf16 v[216:219], a[208:211], a[56:59], v[216:219]
  ds_read_b64_tr_b16 a[192:193], v6 offset:24576
  v_mfma_f32_16x16x32_bf16 v[216:219], a[204:207], a[40:43], v[216:219]
  s_waitcnt lgkmcnt(5)
  v_mfma_f32_16x16x32_bf16 v[232:235], a[164:167], a[40:43], v[232:235]
  ds_read_b64_tr_b16 a[194:195], v6 offset:26624
  v_mfma_f32_16x16x32_bf16 v[232:235], a[160:163], a[56:59], v[232:235]
  v_mfma_f32_16x16x32_bf16 v[236:239], a[160:163], a[60:63], v[236:239]
  ds_read_b64_tr_b16 a[188:189], v6 offset:28672
  v_mfma_f32_16x16x32_bf16 v[236:239], a[164:167], a[44:47], v[236:239]
  s_waitcnt vmcnt(10) lgkmcnt(3)
  v_cndmask_b32 v28, 0, v24, s[16:17]
  v_cndmask_b32 v29, 0, v24, s[18:19]
  v_mfma_f32_16x16x32_bf16 v[252:255], a[172:175], a[44:47], v[252:255]
  ds_read_b64_tr_b16 a[190:191], v6 offset:30720
  v_cndmask_b32 v30, 0, v24, s[20:21]
  v_mfma_f32_16x16x32_bf16 v[252:255], a[168:171], a[60:63], v[252:255]
  v_cndmask_b32 v31, 0, v24, s[22:23]
  v_mfma_f32_16x16x32_bf16 v[248:251], a[168:171], a[56:59], v[248:251]
  ds_read_b64_tr_b16 a[200:201], v7 offset:16384
  v_mfma_f32_16x16x32_bf16 a[184:187], v[28:31], a[220:223], 0
  v_cndmask_b32 v28, 0, v25, s[16:17]
  v_cndmask_b32 v29, 0, v25, s[18:19]
  v_mfma_f32_16x16x32_bf16 v[248:251], a[172:175], a[40:43], v[248:251]
  s_waitcnt vmcnt(15) lgkmcnt(6)
  s_mov_b32 s67, 1835008
  s_add_u32 s75, s24, 8192
  s_add_u32 m0, s45, 98304
  v_cndmask_b32 v30, 0, v25, s[20:21]
  v_mfma_f32_16x16x32_bf16 v[64:67], a[180:183], a[64:67], v[64:67]
  ds_read_b64_tr_b16 a[202:203], v7 offset:18432
  v_cndmask_b32 v31, 0, v25, s[22:23]
  v_mfma_f32_16x16x32_bf16 v[64:67], a[176:179], a[80:83], v[64:67]
  buffer_load_dwordx4 v11, s[28:31], s67 offen lds
  v_mfma_f32_16x16x32_bf16 a[184:187], v[28:31], a[224:227], a[184:187]
  v_cndmask_b32 v28, 0, v26, s[16:17]
  v_cndmask_b32 v29, 0, v26, s[18:19]
  v_mfma_f32_16x16x32_bf16 v[68:71], a[176:179], a[84:87], v[68:71]
  ds_read_b64_tr_b16 a[196:197], v7 offset:20480
  v_cndmask_b32 v30, 0, v26, s[20:21]
  v_mfma_f32_16x16x32_bf16 v[68:71], a[180:183], a[68:71], v[68:71]
  v_cndmask_b32 v31, 0, v26, s[22:23]
  v_mfma_f32_16x16x32_bf16 v[72:75], a[180:183], a[72:75], v[72:75]
  ds_read_b64_tr_b16 a[198:199], v7 offset:22528
  v_mfma_f32_16x16x32_bf16 a[184:187], v[28:31], a[228:231], a[184:187]
  v_cndmask_b32 v28, 0, v27, s[16:17]
  v_cndmask_b32 v29, 0, v27, s[18:19]
  v_mfma_f32_16x16x32_bf16 v[72:75], a[176:179], a[88:91], v[72:75]
  s_add_u32 m0, s45, 106496
  v_cndmask_b32 v30, 0, v27, s[20:21]
  v_cndmask_b32 v31, 0, v27, s[22:23]
  v_mfma_f32_16x16x32_bf16 v[76:79], a[176:179], a[92:95], v[76:79]
  ds_read_b64_tr_b16 a[160:161], v7 offset:24576
  v_mfma_f32_16x16x32_bf16 a[184:187], v[28:31], a[232:235], a[184:187]
  v_mfma_f32_16x16x32_bf16 v[76:79], a[180:183], a[76:79], v[76:79]
  s_waitcnt lgkmcnt(5)
  buffer_load_dwordx4 v11, s[32:35], s67 offen lds
  v_mfma_f32_16x16x32_bf16 v[92:95], a[192:195], a[76:79], v[92:95]
  ds_read_b64_tr_b16 a[162:163], v7 offset:26624
  v_mfma_f32_16x16x32_bf16 v[92:95], a[188:191], a[92:95], v[92:95]
  s_add_u32 m0, s45, 102400
  s_add_u32 s60, s67, 229376
  v_mfma_f32_16x16x32_bf16 v[88:91], a[188:191], a[88:91], v[88:91]
  ds_read_b64_tr_b16 a[164:165], v7 offset:28672
  v_mfma_f32_16x16x32_bf16 v[88:91], a[192:195], a[72:75], v[88:91]
  buffer_load_dwordx4 v11, s[28:31], s60 offen lds
  v_mfma_f32_16x16x32_bf16 v[84:87], a[192:195], a[68:71], v[84:87]
  ds_read_b64_tr_b16 a[166:167], v7 offset:30720
  v_mfma_f32_16x16x32_bf16 v[84:87], a[188:191], a[84:87], v[84:87]
  v_mfma_f32_16x16x32_bf16 v[80:83], a[188:191], a[80:83], v[80:83]
  ds_read_b64_tr_b16 a[168:169], v8 offset:16384
  v_mfma_f32_16x16x32_bf16 v[80:83], a[192:195], a[64:67], v[80:83]
  s_waitcnt lgkmcnt(5)
  s_add_u32 m0, s45, 110592
  s_add_u32 s60, s67, 229376
  v_mfma_f32_16x16x32_bf16 v[96:99], a[200:203], a[64:67], v[96:99]
  ds_read_b64_tr_b16 a[170:171], v8 offset:18432
  v_mfma_f32_16x16x32_bf16 v[96:99], a[196:199], a[80:83], v[96:99]
  buffer_load_dwordx4 v11, s[32:35], s60 offen lds
  v_mfma_f32_16x16x32_bf16 v[100:103], a[196:199], a[84:87], v[100:103]
  ds_read_b64_tr_b16 a[172:173], v8 offset:20480
  v_mfma_f32_16x16x32_bf16 v[100:103], a[200:203], a[68:71], v[100:103]
  s_add_u32 m0, s45, 32768
  v_mfma_f32_16x16x32_bf16 v[104:107], a[200:203], a[72:75], v[104:107]
  ds_read_b64_tr_b16 a[174:175], v8 offset:22528
  v_mfma_f32_16x16x32_bf16 v[104:107], a[196:199], a[88:91], v[104:107]
  buffer_load_dwordx4 v10, s[28:31], s67 offen lds
  v_mfma_f32_16x16x32_bf16 v[108:111], a[196:199], a[92:95], v[108:111]
  ds_read_b64_tr_b16 a[176:177], v8 offset:24576
  v_mfma_f32_16x16x32_bf16 v[108:111], a[200:203], a[76:79], v[108:111]
  s_waitcnt lgkmcnt(5)
  v_mfma_f32_16x16x32_bf16 v[124:127], a[160:163], a[76:79], v[124:127]
  ds_read_b64_tr_b16 a[178:179], v8 offset:26624
  v_mfma_f32_16x16x32_bf16 v[124:127], a[164:167], a[92:95], v[124:127]
  s_add_u32 m0, s45, 40960
  v_mfma_f32_16x16x32_bf16 v[120:123], a[164:167], a[88:91], v[120:123]
  ds_read_b64_tr_b16 a[180:181], v8 offset:28672
  v_mfma_f32_16x16x32_bf16 v[120:123], a[160:163], a[72:75], v[120:123]
  buffer_load_dwordx4 v10, s[32:35], s67 offen lds
  v_mfma_f32_16x16x32_bf16 v[116:119], a[160:163], a[68:71], v[116:119]
  ds_read_b64_tr_b16 a[182:183], v8 offset:30720
  v_mfma_f32_16x16x32_bf16 v[116:119], a[164:167], a[84:87], v[116:119]
  s_add_u32 m0, s45, 36864
  s_add_u32 s60, s67, 229376
  v_mfma_f32_16x16x32_bf16 v[112:115], a[164:167], a[80:83], v[112:115]
  ds_read_b64_tr_b16 a[164:165], v2 offset:0
  v_mfma_f32_16x16x32_bf16 v[112:115], a[160:163], a[64:67], v[112:115]
  s_waitcnt lgkmcnt(5)
  buffer_load_dwordx4 v10, s[28:31], s60 offen lds
  v_mfma_f32_16x16x32_bf16 v[32:35], a[168:171], a[64:67], v[32:35]
  ds_read_b64_tr_b16 a[166:167], v2 offset:2048
  v_mfma_f32_16x16x32_bf16 v[32:35], a[172:175], a[80:83], v[32:35]
  v_mfma_f32_16x16x32_bf16 v[36:39], a[172:175], a[84:87], v[36:39]
  ds_read_b64_tr_b16 a[160:161], v2 offset:4096
  v_mfma_f32_16x16x32_bf16 v[36:39], a[168:171], a[68:71], v[36:39]
  s_add_u32 m0, s45, 45056
  s_add_u32 s60, s67, 229376
  v_mfma_f32_16x16x32_bf16 v[40:43], a[168:171], a[72:75], v[40:43]
  ds_read_b64_tr_b16 a[162:163], v2 offset:6144
  v_mfma_f32_16x16x32_bf16 v[40:43], a[172:175], a[88:91], v[40:43]
  buffer_load_dwordx4 v10, s[32:35], s60 offen lds
  v_mfma_f32_16x16x32_bf16 v[44:47], a[172:175], a[92:95], v[44:47]
  ds_read_b64_tr_b16 a[172:173], v2 offset:8192
  v_mfma_f32_16x16x32_bf16 v[44:47], a[168:171], a[76:79], v[44:47]
  s_waitcnt lgkmcnt(5)
  s_mov_b32 s61, 57344
  v_mfma_f32_16x16x32_bf16 v[60:63], a[176:179], a[76:79], v[60:63]
  ds_read_b64_tr_b16 a[174:175], v2 offset:10240
  v_mfma_f32_16x16x32_bf16 v[60:63], a[180:183], a[92:95], v[60:63]
  buffer_load_dwordx4 a[220:223], v13, s[12:15], s61 offen
  s_mov_b32 s61, 64512
  v_mfma_f32_16x16x32_bf16 v[56:59], a[180:183], a[88:91], v[56:59]
  ds_read_b64_tr_b16 a[168:169], v2 offset:12288
  v_mfma_f32_16x16x32_bf16 v[56:59], a[176:179], a[72:75], v[56:59]
  buffer_load_dwordx4 a[224:227], v13, s[12:15], s61 offen
  s_mov_b32 s61, 71680
  v_mfma_f32_16x16x32_bf16 v[52:55], a[176:179], a[68:71], v[52:55]
  ds_read_b64_tr_b16 a[170:171], v2 offset:14336
  v_mfma_f32_16x16x32_bf16 v[52:55], a[180:183], a[84:87], v[52:55]
  buffer_load_dwordx4 a[228:231], v13, s[12:15], s61 offen
  s_mov_b32 s61, 78848
  v_mfma_f32_16x16x32_bf16 v[48:51], a[180:183], a[80:83], v[48:51]
  ds_read_b64_tr_b16 a[180:181], v3 offset:0
  v_mfma_f32_16x16x32_bf16 v[48:51], a[176:179], a[64:67], v[48:51]
  s_waitcnt lgkmcnt(5)
  buffer_load_dwordx4 a[232:235], v13, s[12:15], s61 offen
  v_mfma_f32_16x16x32_bf16 v[128:131], a[164:167], a[64:67], v[128:131]
  ds_read_b64_tr_b16 a[182:183], v3 offset:2048
  v_mfma_f32_16x16x32_bf16 v[128:131], a[160:163], a[80:83], v[128:131]
  v_mfma_f32_16x16x32_bf16 v[132:135], a[160:163], a[84:87], v[132:135]
  ds_read_b64_tr_b16 a[176:177], v3 offset:4096
  v_mfma_f32_16x16x32_bf16 v[132:135], a[164:167], a[68:71], v[132:135]
  v_mfma_f32_16x16x32_bf16 v[136:139], a[164:167], a[72:75], v[136:139]
  ds_read_b64_tr_b16 a[178:179], v3 offset:6144
  v_mfma_f32_16x16x32_bf16 v[136:139], a[160:163], a[88:91], v[136:139]
  v_mfma_f32_16x16x32_bf16 v[140:143], a[160:163], a[92:95], v[140:143]
  ds_read_b64_tr_b16 a[160:161], v3 offset:8192
  v_mfma_f32_16x16x32_bf16 v[140:143], a[164:167], a[76:79], v[140:143]
  s_waitcnt lgkmcnt(5)
  v_mfma_f32_16x16x32_bf16 v[156:159], a[172:175], a[76:79], v[156:159]
  ds_read_b64_tr_b16 a[162:163], v3 offset:10240
  v_mfma_f32_16x16x32_bf16 v[156:159], a[168:171], a[92:95], v[156:159]
  ds_read_b128 v[24:27], v14 offset:16
  v_mfma_f32_16x16x32_bf16 v[152:155], a[168:171], a[88:91], v[152:155]
  ds_read_b64_tr_b16 a[164:165], v3 offset:12288
  v_mfma_f32_16x16x32_bf16 v[152:155], a[172:175], a[72:75], v[152:155]
  v_mfma_f32_16x16x32_bf16 v[148:151], a[172:175], a[68:71], v[148:151]
  ds_read_b64_tr_b16 a[166:167], v3 offset:14336
  v_mfma_f32_16x16x32_bf16 v[148:151], a[168:171], a[84:87], v[148:151]
  v_mfma_f32_16x16x32_bf16 v[144:147], a[168:171], a[80:83], v[144:147]
  ds_read_b64_tr_b16 a[168:169], v4 offset:0
  v_mfma_f32_16x16x32_bf16 v[144:147], a[172:175], a[64:67], v[144:147]
  s_waitcnt lgkmcnt(6)
  s_waitcnt vmcnt(12) lgkmcnt(3)
  v_cndmask_b32 v28, 0, v24, s[16:17]
  v_mfma_f32_16x16x32_bf16 v[160:163], a[180:183], a[64:67], v[160:163]
  ds_read_b64_tr_b16 a[170:171], v4 offset:2048
  v_cndmask_b32 v29, 0, v24, s[18:19]
  v_mfma_f32_16x16x32_bf16 v[160:163], a[176:179], a[80:83], v[160:163]
  v_cndmask_b32 v30, 0, v24, s[20:21]
  v_cndmask_b32 v31, 0, v24, s[22:23]
  v_mfma_f32_16x16x32_bf16 v[164:167], a[176:179], a[84:87], v[164:167]
  ds_read_b64_tr_b16 a[172:173], v4 offset:4096
  v_mfma_f32_16x16x32_bf16 a[184:187], v[28:31], a[236:239], a[184:187]
  v_cndmask_b32 v28, 0, v25, s[16:17]
  v_cndmask_b32 v29, 0, v25, s[18:19]
  v_mfma_f32_16x16x32_bf16 v[164:167], a[180:183], a[68:71], v[164:167]
  v_cndmask_b32 v30, 0, v25, s[20:21]
  v_cndmask_b32 v31, 0, v25, s[22:23]
  v_mfma_f32_16x16x32_bf16 v[168:171], a[180:183], a[72:75], v[168:171]
  ds_read_b64_tr_b16 a[174:175], v4 offset:6144
  v_mfma_f32_16x16x32_bf16 a[184:187], v[28:31], a[240:243], a[184:187]
  v_cndmask_b32 v28, 0, v26, s[16:17]
  v_cndmask_b32 v29, 0, v26, s[18:19]
  v_mfma_f32_16x16x32_bf16 v[168:171], a[176:179], a[88:91], v[168:171]
HOP8:
  s_cbranch_execz WRET0
  v_cndmask_b32 v30, 0, v26, s[20:21]
  v_cndmask_b32 v31, 0, v26, s[22:23]
  v_mfma_f32_16x16x32_bf16 v[172:175], a[176:179], a[92:95], v[172:175]
  ds_read_b64_tr_b16 a[176:177], v4 offset:8192
  v_mfma_f32_16x16x32_bf16 a[184:187], v[28:31], a[244:247], a[184:187]
  v_cndmask_b32 v28, 0, v27, s[16:17]
  v_cndmask_b32 v29, 0, v27, s[18:19]
  v_mfma_f32_16x16x32_bf16 v[172:175], a[180:183], a[76:79], v[172:175]
  s_waitcnt lgkmcnt(5)
  v_cndmask_b32 v30, 0, v27, s[20:21]
  v_cndmask_b32 v31, 0, v27, s[22:23]
  v_mfma_f32_16x16x32_bf16 v[188:191], a[160:163], a[76:79], v[188:191]
  ds_read_b64_tr_b16 a[178:179], v4 offset:10240
  v_mfma_f32_16x16x32_bf16 a[184:187], v[28:31], a[248:251], a[184:187]
  v_mfma_f32_16x16x32_bf16 v[188:191], a[164:167], a[92:95], v[188:191]
  v_mfma_f32_16x16x32_bf16 v[184:187], a[164:167], a[88:91], v[184:187]
  ds_read_b64_tr_b16 a[180:181], v4 offset:12288
  v_mfma_f32_16x16x32_bf16 v[184:187], a[160:163], a[72:75], v[184:187]
  v_mfma_f32_16x16x32_bf16 v[180:183], a[160:163], a[68:71], v[180:183]
  ds_read_b64_tr_b16 a[182:183], v4 offset:14336
  s_add_u32 s61, s62, 0
  v_mfma_f32_16x16x32_bf16 v[180:183], a[164:167], a[84:87], v[180:183]
  buffer_load_dwordx4 a[188:191], v12, s[8:11], s61 offen offset:0 sc1
  v_mfma_f32_16x16x32_bf16 v[176:179], a[164:167], a[80:83], v[176:179]
  ds_read_b64_tr_b16 a[164:165], v5 offset:0
  v_mfma_f32_16x16x32_bf16 v[176:179], a[160:163], a[64:67], v[176:179]
  s_waitcnt lgkmcnt(5)
  v_mfma_f32_16x16x32_bf16 v[192:195], a[168:171], a[64:67], v[192:195]
  ds_read_b64_tr_b16 a[166:167], v5 offset:2048
  v_mfma_f32_16x16x32_bf16 v[192:195], a[172:175], a[80:83], v[192:195]
  s_add_u32 s61, s62, 0
  v_mfma_f32_16x16x32_bf16 v[196:199], a[172:175], a[84:87], v[196:199]
  ds_read_b64_tr_b16 a[160:161], v5 offset:4096
  v_mfma_f32_16x16x32_bf16 v[196:199], a[168:171], a[68:71], v[196:199]
  buffer_load_dwordx4 a[192:195], v12, s[8:11], s61 offen offset:256 sc1
  v_mfma_f32_16x16x32_bf16 v[200:203], a[168:171], a[72:75], v[200:203]
  ds_read_b64_tr_b16 a[162:163], v5 offset:6144
  v_mfma_f32_16x16x32_bf16 v[200:203], a[172:175], a[88:91], v[200:203]
  s_add_u32 s61, s62, 2048
  v_mfma_f32_16x16x32_bf16 v[204:207], a[172:175], a[92:95], v[204:207]
  ds_read_b64_tr_b16 a[172:173], v5 offset:8192
  v_mfma_f32_16x16x32_bf16 v[204:207], a[168:171], a[76:79], v[204:207]
  s_waitcnt lgkmcnt(5)
  buffer_load_dwordx4 a[196:199], v12, s[8:11], s61 offen offset:0 sc1
  v_mfma_f32_16x16x32_bf16 v[220:223], a[176:179], a[76:79], v[220:223]
  ds_read_b64_tr_b16 a[174:175], v5 offset:10240
  v_mfma_f32_16x16x32_bf16 v[220:223], a[180:183], a[92:95], v[220:223]
  v_mfma_f32_16x16x32_bf16 v[216:219], a[180:183], a[88:91], v[216:219]
  ds_read_b64_tr_b16 a[168:169], v5 offset:12288
  v_mfma_f32_16x16x32_bf16 v[216:219], a[176:179], a[72:75], v[216:219]
  s_add_u32 s61, s62, 2048
  v_mfma_f32_16x16x32_bf16 v[212:215], a[176:179], a[68:71], v[212:215]
  ds_read_b64_tr_b16 a[170:171], v5 offset:14336
  buffer_load_dwordx4 a[200:203], v12, s[8:11], s61 offen offset:256 sc1
  v_mfma_f32_16x16x32_bf16 v[212:215], a[180:183], a[84:87], v[212:215]
  s_waitcnt vmcnt(44)
  s_barrier
  v_mfma_f32_16x16x32_bf16 v[208:211], a[180:183], a[80:83], v[208:211]
  ds_read_b64_tr_b16 a[180:181], v6 offset:0
  v_mfma_f32_16x16x32_bf16 v[208:211], a[176:179], a[64:67], v[208:211]
  s_waitcnt lgkmcnt(5)
  s_add_u32 s61, s62, 4096
  v_mfma_f32_16x16x32_bf16 v[224:227], a[164:167], a[64:67], v[224:227]
  ds_read_b64_tr_b16 a[182:183], v6 offset:2048
  v_mfma_f32_16x16x32_bf16 v[224:227], a[160:163], a[80:83], v[224:227]
  buffer_load_dwordx4 a[204:207], v12, s[8:11], s61 offen offset:0 sc1
  v_mfma_f32_16x16x32_bf16 v[228:231], a[160:163], a[84:87], v[228:231]
  ds_read_b64_tr_b16 a[176:177], v6 offset:4096
  v_mfma_f32_16x16x32_bf16 v[228:231], a[164:167], a[68:71], v[228:231]
  v_mfma_f32_16x16x32_bf16 v[232:235], a[164:167], a[72:75], v[232:235]
  ds_read_b64_tr_b16 a[178:179], v6 offset:6144
  v_mfma_f32_16x16x32_bf16 v[232:235], a[160:163], a[88:91], v[232:235]
  s_add_u32 s61, s62, 4096
  v_mfma_f32_16x16x32_bf16 v[236:239], a[160:163], a[92:95], v[236:239]
  ds_read_b64_tr_b16 a[160:161], v6 offset:8192
  v_mfma_f32_16x16x32_bf16 v[236:239], a[164:167], a[76:79], v[236:239]
  s_waitcnt lgkmcnt(5)
  buffer_load_dwordx4 a[208:211], v12, s[8:11], s61 offen offset:256 sc1
  v_mfma_f32_16x16x32_bf16 v[252:255], a[172:175], a[76:79], v[252:255]
  ds_read_b64_tr_b16 a[162:163], v6 offset:10240
  v_mfma_f32_16x16x32_bf16 v[252:255], a[168:171], a[92:95], v[252:255]
  s_add_u32 s61, s62, 6144
  v_mfma_f32_16x16x32_bf16 v[248:251], a[168:171], a[88:91], v[248:251]
  ds_read_b64_tr_b16 a[164:165], v6 offset:12288
  v_mfma_f32_16x16x32_bf16 v[248:251], a[172:175], a[72:75], v[248:251]
  buffer_load_dwordx4 a[212:215], v12, s[8:11], s61 offen offset:0 sc1
  v_mfma_f32_16x16x32_bf16 v[244:247], a[172:175], a[68:71], v[244:247]
  ds_read_b64_tr_b16 a[166:167], v6 offset:14336
  v_mfma_f32_16x16x32_bf16 v[244:247], a[168:171], a[84:87], v[244:247]
  v_mfma_f32_16x16x32_bf16 v[240:243], a[168:171], a[80:83], v[240:243]
  ds_read_b64_tr_b16 a[168:169], v7 offset:0
  v_mfma_f32_16x16x32_bf16 v[240:243], a[172:175], a[64:67], v[240:243]
  s_waitcnt vmcnt(23) lgkmcnt(5)
  s_add_u32 s61, s62, 6144
  v_mfma_f32_16x16x32_bf16 v[64:67], a[180:183], a[96:99], v[64:67]
  ds_read_b64_tr_b16 a[170:171], v7 offset:2048
  v_mfma_f32_16x16x32_bf16 v[64:67], a[176:179], a[112:115], v[64:67]
  buffer_load_dwordx4 a[216:219], v12, s[8:11], s61 offen offset:256 sc1
  v_mfma_f32_16x16x32_bf16 v[68:71], a[176:179], a[116:119], v[68:71]
  ds_read_b64_tr_b16 a[172:173], v7 offset:4096
  v_mfma_f32_16x16x32_bf16 v[68:71], a[180:183], a[100:103], v[68:71]
  v_mfma_f32_16x16x32_bf16 v[72:75], a[180:183], a[104:107], v[72:75]
  ds_read_b64_tr_b16 a[174:175], v7 offset:6144
  v_mfma_f32_16x16x32_bf16 v[72:75], a[176:179], a[120:123], v[72:75]
  buffer_load_dwordx4 a[128:131], v1, s[8:11], s75 offen offset:0 sc1
  v_mfma_f32_16x16x32_bf16 v[76:79], a[176:179], a[124:127], v[76:79]
  ds_read_b64_tr_b16 a[176:177], v7 offset:8192
  v_mfma_f32_16x16x32_bf16 v[76:79], a[180:183], a[108:111], v[76:79]
  s_waitcnt lgkmcnt(5)
  v_mfma_f32_16x16x32_bf16 v[92:95], a[160:163], a[108:111], v[92:95]
  ds_read_b64_tr_b16 a[178:179], v7 offset:10240
  v_mfma_f32_16x16x32_bf16 v[92:95], a[164:167], a[124:127], v[92:95]
  v_mfma_f32_16x16x32_bf16 v[88:91], a[164:167], a[120:123], v[88:91]
  ds_read_b64_tr_b16 a[180:181], v7 offset:12288
  v_mfma_f32_16x16x32_bf16 v[88:91], a[160:163], a[104:107], v[88:91]
  buffer_load_dwordx4 a[144:147], v1, s[8:11], s75 offen offset:1024 sc1
  v_mfma_f32_16x16x32_bf16 v[84:87], a[160:163], a[100:103], v[84:87]
  ds_read_b64_tr_b16 a[182:183], v7 offset:14336
  v_mfma_f32_16x16x32_bf16 v[84:87], a[164:167], a[116:119], v[84:87]
  v_mfma_f32_16x16x32_bf16 v[80:83], a[164:167], a[112:115], v[80:83]
  ds_read_b64_tr_b16 a[164:165], v8 offset:0
  s_mov_b32 s61, 86016
  v_mfma_f32_16x16x32_bf16 v[80:83], a[160:163], a[96:99], v[80:83]
  s_waitcnt lgkmcnt(5)
  buffer_load_dwordx4 a[236:239], v13, s[12:15], s61 offen
  v_mfma_f32_16x16x32_bf16 v[96:99], a[168:171], a[96:99], v[96:99]
  ds_read_b64_tr_b16 a[166:167], v8 offset:2048
  s_mov_b32 s61, 93184
  v_mfma_f32_16x16x32_bf16 v[96:99], a[172:175], a[112:115], v[96:99]
  buffer_load_dwordx4 a[240:243], v13, s[12:15], s61 offen
  s_mov_b32 s61, 100352
  v_mfma_f32_16x16x32_bf16 v[100:103], a[172:175], a[116:119], v[100:103]
  ds_read_b64_tr_b16 a[160:161], v8 offset:4096
  v_mfma_f32_16x16x32_bf16 v[100:103], a[168:171], a[100:103], v[100:103]
  buffer_load_dwordx4 a[244:247], v13, s[12:15], s61 offen
  s_mov_b32 s61, 107520
  v_mfma_f32_16x16x32_bf16 v[104:107], a[168:171], a[104:107], v[104:107]
  ds_read_b64_tr_b16 a[162:163], v8 offset:6144
  v_mfma_f32_16x16x32_bf16 v[104:107], a[172:175], a[120:123], v[104:107]
  buffer_load_dwordx4 a[248:251], v13, s[12:15], s61 offen
  ds_read_b128 v[24:27], v14 offset:32
  v_mfma_f32_16x16x32_bf16 v[108:111], a[172:175], a[124:127], v[108:111]
  ds_read_b64_tr_b16 a[172:173], v8 offset:8192
  v_mfma_f32_16x16x32_bf16 v[108:111], a[168:171], a[108:111], v[108:111]
  s_waitcnt lgkmcnt(6)
  v_mfma_f32_16x16x32_bf16 v[124:127], a[176:179], a[108:111], v[124:127]
  ds_read_b64_tr_b16 a[174:175], v8 offset:10240
  v_mfma_f32_16x16x32_bf16 v[124:127], a[180:183], a[124:127], v[124:127]
  v_mfma_f32_16x16x32_bf16 v[120:123], a[180:183], a[120:123], v[120:123]
  ds_read_b64_tr_b16 a[168:169], v8 offset:12288
  v_mfma_f32_16x16x32_bf16 v[120:123], a[176:179], a[104:107], v[120:123]
  s_waitcnt vmcnt(14) lgkmcnt(3)
  v_cndmask_b32 v28, 0, v24, s[16:17]
  v_cndmask_b32 v29, 0, v24, s[18:19]
  v_mfma_f32_16x16x32_bf16 v[116:119], a[176:179], a[100:103], v[116:119]
  ds_read_b64_tr_b16 a[170:171], v8 offset:14336
  v_cndmask_b32 v30, 0, v24, s[20:21]
  v_mfma_f32_16x16x32_bf16 v[116:119], a[180:183], a[116:119], v[116:119]
  v_cndmask_b32 v31, 0, v24, s[22:23]
  v_mfma_f32_16x16x32_bf16 v[112:115], a[180:183], a[112:115], v[112:115]
  ds_read_b64_tr_b16 a[180:181], v2 offset:16384
  v_mfma_f32_16x16x32_bf16 a[184:187], v[28:31], a[220:223], a[184:187]
  v_cndmask_b32 v28, 0, v25, s[16:17]
  v_cndmask_b32 v29, 0, v25, s[18:19]
  v_mfma_f32_16x16x32_bf16 v[112:115], a[176:179], a[96:99], v[112:115]
  s_waitcnt lgkmcnt(6)
  v_cndmask_b32 v30, 0, v25, s[20:21]
  v_cndmask_b32 v31, 0, v25, s[22:23]
  v_mfma_f32_16x16x32_bf16 v[32:35], a[164:167], a[96:99], v[32:35]
  ds_read_b64_tr_b16 a[182:183], v2 offset:18432
  v_mfma_f32_16x16x32_bf16 a[184:187], v[28:31], a[224:227], a[184:187]
  v_cndmask_b32 v28, 0, v26, s[16:17]
  v_cndmask_b32 v29, 0, v26, s[18:19]
  v_mfma_f32_16x16x32_bf16 v[32:35], a[160:163], a[112:115], v[32:35]
  v_cndmask_b32 v30, 0, v26, s[20:21]
  v_cndmask_b32 v31, 0, v26, s[22:23]
  v_mfma_f32_16x16x32_bf16 v[36:39], a[160:163], a[116:119], v[36:39]
  ds_read_b64_tr_b16 a[176:177], v2 offset:20480
  v_mfma_f32_16x16x32_bf16 a[184:187], v[28:31], a[228:231], a[184:187]
  v_cndmask_b32 v28, 0, v27, s[16:17]
  v_cndmask_b32 v29, 0, v27, s[18:19]
  v_mfma_f32_16x16x32_bf16 v[36:39], a[164:167], a[100:103], v[36:39]
  v_cndmask_b32 v30, 0, v27, s[20:21]
  v_cndmask_b32 v31, 0, v27, s[22:23]
  v_mfma_f32_16x16x32_bf16 v[40:43], a[164:167], a[104:107], v[40:43]
  ds_read_b64_tr_b16 a[178:179], v2 offset:22528
  v_mfma_f32_16x16x32_bf16 a[184:187], v[28:31], a[232:235], a[184:187]
  v_mfma_f32_16x16x32_bf16 v[40:43], a[160:163], a[120:123], v[40:43]
  v_mfma_f32_16x16x32_bf16 v[44:47], a[160:163], a[124:127], v[44:47]
  ds_read_b64_tr_b16 a[160:161], v2 offset:24576
  v_mfma_f32_16x16x32_bf16 v[44:47], a[164:167], a[108:111], v[44:47]
  s_waitcnt lgkmcnt(5)
  v_mfma_f32_16x16x32_bf16 v[60:63], a[172:175], a[108:111], v[60:63]
  ds_read_b64_tr_b16 a[162:163], v2 offset:26624
  v_mfma_f32_16x16x32_bf16 v[60:63], a[168:171], a[124:127], v[60:63]
  v_mfma_f32_16x16x32_bf16 v[56:59], a[168:171], a[120:123], v[56:59]
  ds_read_b64_tr_b16 a[164:165], v2 offset:28672
  v_mfma_f32_16x16x32_bf16 v[56:59], a[172:175], a[104:107], v[56:59]
  v_mfma_f32_16x16x32_bf16 v[52:55], a[172:175], a[100:103], v[52:55]
  ds_read_b64_tr_b16 a[166:167], v2 offset:30720
  v_mfma_f32_16x16x32_bf16 v[52:55], a[168:171], a[116:119], v[52:55]
  v_mfma_f32_16x16x32_bf16 v[48:51], a[168:171], a[112:115], v[48:51]
  ds_read_b64_tr_b16 a[168:169], v3 offset:16384
  v_mfma_f32_16x16x32_bf16 v[48:51], a[172:175], a[96:99], v[48:51]
  s_waitcnt lgkmcnt(5)
  v_mfma_f32_16x16x32_bf16 v[128:131], a[180:183], a[96:99], v[128:131]
  ds_read_b64_tr_b16 a[170:171], v3 offset:18432
  v_mfma_f32_16x16x32_bf16 v[128:131], a[176:179], a[112:115], v[128:131]
  s_add_u32 s75, s75, 65536
  v_mfma_f32_16x16x32_bf16 v[132:135], a[176:179], a[116:119], v[132:135]
  ds_read_b64_tr_b16 a[172:173], v3 offset:20480
  v_mfma_f32_16x16x32_bf16 v[132:135], a[180:183], a[100:103], v[132:135]
  buffer_load_dwordx4 a[132:135], v1, s[8:11], s75 offen offset:0 sc1
  v_mfma_f32_16x16x32_bf16 v[136:139], a[180:183], a[104:107], v[136:139]
  ds_read_b64_tr_b16 a[174:175], v3 offset:22528
  v_mfma_f32_16x16x32_bf16 v[136:139], a[176:179], a[120:123], v[136:139]
  v_mfma_f32_16x16x32_bf16 v[140:143], a[176:179], a[124:127], v[140:143]
  ds_read_b64_tr_b16 a[176:177], v3 offset:24576
  v_mfma_f32_16x16x32_bf16 v[140:143], a[180:183], a[108:111], v[140:143]
  s_waitcnt lgkmcnt(5)
  v_mfma_f32_16x16x32_bf16 v[156:159], a[160:163], a[108:111], v[156:159]
  ds_read_b64_tr_b16 a[178:179], v3 offset:26624
  v_mfma_f32_16x16x32_bf16 v[156:159], a[164:167], a[124:127], v[156:159]
  buffer_load_dwordx4 a[148:151], v1, s[8:11], s75 offen offset:1024 sc1
  v_mfma_f32_16x16x32_bf16 v[152:155], a[164:167], a[120:123], v[152:155]
  ds_read_b64_tr_b16 a[180:181], v3 offset:28672
  v_mfma_f32_16x16x32_bf16 v[152:155], a[160:163], a[104:107], v[152:155]
  s_add_u32 s75, s75, 65536
  v_mfma_f32_16x16x32_bf16 v[148:151], a[160:163], a[100:103], v[148:151]
  ds_read_b64_tr_b16 a[182:183], v3 offset:30720
  v_mfma_f32_16x16x32_bf16 v[148:151], a[164:167], a[116:119], v[148:151]
  buffer_load_dwordx4 a[136:139], v1, s[8:11], s75 offen offset:0 sc1
  v_mfma_f32_16x16x32_bf16 v[144:147], a[164:167], a[112:115], v[144:147]
  ds_read_b64_tr_b16 a[164:165], v4 offset:16384
  v_mfma_f32_16x16x32_bf16 v[144:147], a[160:163], a[96:99], v[144:147]
  s_waitcnt lgkmcnt(5)
  v_mfma_f32_16x16x32_bf16 v[160:163], a[168:171], a[96:99], v[160:163]
  ds_read_b64_tr_b16 a[166:167], v4 offset:18432
  s_waitcnt vmcnt(9)
  v_mfma_f32_16x16x32_bf16 v[160:163], a[172:175], a[112:115], v[160:163]
  v_accvgpr_read_b32 v16, a188
  v_accvgpr_read_b32 v17, a189
  v_mfma_f32_16x16x32_bf16 v[164:167], a[172:175], a[116:119], v[164:167]
  ds_read_b64_tr_b16 a[160:161], v4 offset:20480
  v_accvgpr_read_b32 v18, a190
  v_mfma_f32_16x16x32_bf16 v[164:167], a[168:171], a[100:103], v[164:167]
  buffer_load_dwordx4 a[152:155], v1, s[8:11], s75 offen offset:1024 sc1
  v_accvgpr_read_b32 v19, a191
  v_accvgpr_read_b32 v20, a192
  v_mfma_f32_16x16x32_bf16 v[168:171], a[168:171], a[104:107], v[168:171]
  ds_read_b64_tr_b16 a[162:163], v4 offset:22528
  v_accvgpr_read_b32 v21, a193
  v_mfma_f32_16x16x32_bf16 v[168:171], a[172:175], a[120:123], v[168:171]
  s_add_u32 s75, s75, 65536
  v_accvgpr_read_b32 v22, a194
  v_accvgpr_read_b32 v23, a195
  v_mfma_f32_16x16x32_bf16 v[172:175], a[172:175], a[124:127], v[172:175]
  ds_read_b64_tr_b16 a[172:173], v4 offset:24576
  v_accvgpr_read_b32 v24, a196
  v_mfma_f32_16x16x32_bf16 v[172:175], a[168:171], a[108:111], v[172:175]
  s_waitcnt lgkmcnt(5)
  buffer_load_dwordx4 a[140:143], v1, s[8:11], s75 offen offset:0 sc1
  v_accvgpr_read_b32 v25, a197
  v_mfma_f32_16x16x32_bf16 v[188:191], a[176:179], a[108:111], v[188:191]
  ds_read_b64_tr_b16 a[174:175], v4 offset:26624
  v_accvgpr_read_b32 v26, a198
  v_mfma_f32_16x16x32_bf16 v[188:191], a[180:183], a[124:127], v[188:191]
  v_accvgpr_read_b32 v27, a199
  v_accvgpr_read_b32 v28, a200
  v_mfma_f32_16x16x32_bf16 v[184:187], a[180:183], a[120:123], v[184:187]
  ds_read_b64_tr_b16 a[168:169], v4 offset:28672
  v_accvgpr_read_b32 v29, a201
  v_mfma_f32_16x16x32_bf16 v[184:187], a[176:179], a[104:107], v[184:187]
  v_accvgpr_read_b32 v30, a202
  v_accvgpr_read_b32 v31, a203
  v_mfma_f32_16x16x32_bf16 v[180:183], a[176:179], a[100:103], v[180:183]
  ds_read_b64_tr_b16 a[170:171], v4 offset:30720
  v_add_f32 v16, v16, v24
  v_mfma_f32_16x16x32_bf16 v[180:183], a[180:183], a[116:119], v[180:183]
  buffer_load_dwordx4 a[156:159], v1, s[8:11], s75 offen offset:1024 sc1
  v_add_f32 v17, v17, v25
  v_add_f32 v18, v18, v26
  v_mfma_f32_16x16x32_bf16 v[176:179], a[180:183], a[112:115], v[176:179]
  ds_read_b64_tr_b16 a[180:181], v5 offset:16384
  v_add_f32 v19, v19, v27
  v_mfma_f32_16x16x32_bf16 v[176:179], a[176:179], a[96:99], v[176:179]
  s_waitcnt lgkmcnt(5)
  s_mov_b32 s68, 2293760
  s_add_u32 s76, s24, 10240
  s_add_u32 m0, s45, 114688
  v_add_f32 v20, v20, v28
  v_mfma_f32_16x16x32_bf16 v[192:195], a[164:167], a[96:99], v[192:195]
  ds_read_b64_tr_b16 a[182:183], v5 offset:18432
  v_add_f32 v21, v21, v29
  v_mfma_f32_16x16x32_bf16 v[192:195], a[160:163], a[112:115], v[192:195]
  buffer_load_dwordx4 v11, s[28:31], s68 offen lds
  v_add_f32 v22, v22, v30
  v_add_f32 v23, v23, v31
  v_mfma_f32_16x16x32_bf16 v[196:199], a[160:163], a[116:119], v[196:199]
  ds_read_b64_tr_b16 a[176:177], v5 offset:20480
  v_accvgpr_read_b32 v24, a204
  v_mfma_f32_16x16x32_bf16 v[196:199], a[164:167], a[100:103], v[196:199]
  v_accvgpr_read_b32 v25, a205
  v_accvgpr_read_b32 v26, a206
  v_mfma_f32_16x16x32_bf16 v[200:203], a[164:167], a[104:107], v[200:203]
  ds_read_b64_tr_b16 a[178:179], v5 offset:22528
  v_accvgpr_read_b32 v27, a207
  v_mfma_f32_16x16x32_bf16 v[200:203], a[160:163], a[120:123], v[200:203]
  s_add_u32 m0, s45, 122880
  v_accvgpr_read_b32 v28, a208
  v_accvgpr_read_b32 v29, a209
  v_mfma_f32_16x16x32_bf16 v[204:207], a[160:163], a[124:127], v[204:207]
  ds_read_b64_tr_b16 a[160:161], v5 offset:24576
  v_accvgpr_read_b32 v30, a210
  v_mfma_f32_16x16x32_bf16 v[204:207], a[164:167], a[108:111], v[204:207]
  s_waitcnt lgkmcnt(5)
  buffer_load_dwordx4 v11, s[32:35], s68 offen lds
  v_accvgpr_read_b32 v31, a211
  v_mfma_f32_16x16x32_bf16 v[220:223], a[172:175], a[108:111], v[220:223]
  ds_read_b64_tr_b16 a[162:163], v5 offset:26624
  v_add_f32 v16, v16, v24
  v_mfma_f32_16x16x32_bf16 v[220:223], a[168:171], a[124:127], v[220:223]
  s_add_u32 m0, s45, 118784
  s_add_u32 s60, s68, 229376
  v_add_f32 v17, v17, v25
  v_mfma_f32_16x16x32_bf16 v[216:219], a[168:171], a[120:123], v[216:219]
  ds_read_b64_tr_b16 a[164:165], v5 offset:28672
  v_add_f32 v18, v18, v26
  v_mfma_f32_16x16x32_bf16 v[216:219], a[172:175], a[104:107], v[216:219]
  buffer_load_dwordx4 v11, s[28:31], s60 offen lds
  v_add_f32 v19, v19, v27
  v_add_f32 v20, v20, v28
  v_mfma_f32_16x16x32_bf16 v[212:215], a[172:175], a[100:103], v[212:215]
  ds_read_b64_tr_b16 a[166:167], v5 offset:30720
  v_add_f32 v21, v21, v29
  v_mfma_f32_16x16x32_bf16 v[212:215], a[168:171], a[116:119], v[212:215]
  s_waitcnt vmcnt(27)
  s_barrier
  v_mfma_f32_16x16x32_bf16 v[208:211], a[168:171], a[112:115], v[208:211]
  ds_read_b64_tr_b16 a[168:169], v6 offset:32768
  v_add_f32 v22, v22, v30
  v_mfma_f32_16x16x32_bf16 v[208:211], a[172:175], a[96:99], v[208:211]
  s_waitcnt lgkmcnt(5)
  s_add_u32 m0, s45, 126976
  s_add_u32 s60, s68, 229376
  v_mfma_f32_16x16x32_bf16 v[224:227], a[180:183], a[96:99], v[224:227]
  ds_read_b64_tr_b16 a[170:171], v6 offset:34816
  v_add_f32 v23, v23, v31
  v_mfma_f32_16x16x32_bf16 v[224:227], a[176:179], a[112:115], v[224:227]
  buffer_load_dwordx4 v11, s[32:35], s60 offen lds
  v_accvgpr_read_b32 v24, a212
  v_accvgpr_read_b32 v25, a213
  v_mfma_f32_16x16x32_bf16 v[228:231], a[176:179], a[116:119], v[228:231]
  ds_read_b64_tr_b16 a[172:173], v6 offset:36864
  v_accvgpr_read_b32 v26, a214
  v_mfma_f32_16x16x32_bf16 v[228:231], a[180:183], a[100:103], v[228:231]
  s_add_u32 m0, s45, 49152
  v_accvgpr_read_b32 v27, a215
  v_accvgpr_read_b32 v28, a216
  v_mfma_f32_16x16x32_bf16 v[232:235], a[180:183], a[104:107], v[232:235]
  ds_read_b64_tr_b16 a[174:175], v6 offset:38912
  v_accvgpr_read_b32 v29, a217
  v_mfma_f32_16x16x32_bf16 v[232:235], a[176:179], a[120:123], v[232:235]
  buffer_load_dwordx4 v10, s[28:31], s68 offen lds
  v_accvgpr_read_b32 v30, a218
  v_accvgpr_read_b32 v31, a219
  v_mfma_f32_16x16x32_bf16 v[236:239], a[176:179], a[124:127], v[236:239]
  ds_read_b64_tr_b16 a[176:177], v6 offset:40960
  v_add_f32 v16, v16, v24
  v_mfma_f32_16x16x32_bf16 v[236:239], a[180:183], a[108:111], v[236:239]
  s_waitcnt lgkmcnt(5)
  v_add_f32 v17, v17, v25
  v_add_f32 v18, v18, v26
  v_mfma_f32_16x16x32_bf16 v[252:255], a[160:163], a[108:111], v[252:255]
  ds_read_b64_tr_b16 a[178:179], v6 offset:43008
  v_add_f32 v19, v19, v27
  v_mfma_f32_16x16x32_bf16 v[252:255], a[164:167], a[124:127], v[252:255]
  s_add_u32 m0, s45, 57344
  v_add_f32 v20, v20, v28
  v_add_f32 v21, v21, v29
  v_mfma_f32_16x16x32_bf16 v[248:251], a[164:167], a[120:123], v[248:251]
  ds_read_b64_tr_b16 a[180:181], v6 offset:45056
  v_add_f32 v22, v22, v30
  v_mfma_f32_16x16x32_bf16 v[248:251], a[160:163], a[104:107], v[248:251]
  buffer_load_dwordx4 v10, s[32:35], s68 offen lds
  v_add_f32 v23, v23, v31
  v_mfma_f32_16x16x32_bf16 v[244:247], a[160:163], a[100:103], v[244:247]
  ds_read_b64_tr_b16 a[182:183], v6 offset:47104
  v_mfma_f32_16x16x32_bf16 v[244:247], a[164:167], a[116:119], v[244:247]
  s_add_u32 m0, s45, 53248
  s_add_u32 s60, s68, 229376
  v_mfma_f32_16x16x32_bf16 v[240:243], a[164:167], a[112:115], v[240:243]
  ds_read_b64_tr_b16 a[164:165], v7 offset:32768
  v_mfma_f32_16x16x32_bf16 v[240:243], a[160:163], a[96:99], v[240:243]
  s_waitcnt vmcnt(6) lgkmcnt(5)
  buffer_load_dwordx4 v10, s[28:31], s60 offen lds
  v_mfma_f32_16x16x32_bf16 v[64:67], a[168:171], a[128:131], v[64:67]
  ds_read_b64_tr_b16 a[166:167], v7 offset:34816
  v_mfma_f32_16x16x32_bf16 v[64:67], a[172:175], a[144:147], v[64:67]
  ds_read_b128 v[24:27], v14 offset:48
  v_mfma_f32_16x16x32_bf16 v[68:71], a[172:175], a[148:151], v[68:71]
  ds_read_b64_tr_b16 a[160:161], v7 offset:36864
  v_mfma_f32_16x16x32_bf16 v[68:71], a[168:171], a[132:135], v[68:71]
  s_add_u32 m0, s45, 61440
  s_add_u32 s60, s68, 229376
  v_mfma_f32_16x16x32_bf16 v[72:75], a[168:171], a[136:139], v[72:75]
  ds_read_b64_tr_b16 a[162:163], v7 offset:38912
  v_mfma_f32_16x16x32_bf16 v[72:75], a[172:175], a[152:155], v[72:75]
  buffer_load_dwordx4 v10, s[32:35], s60 offen lds
  v_mfma_f32_16x16x32_bf16 v[76:79], a[172:175], a[156:159], v[76:79]
  ds_read_b64_tr_b16 a[172:173], v7 offset:40960
  v_mfma_f32_16x16x32_bf16 v[76:79], a[168:171], a[140:143], v[76:79]
  s_waitcnt lgkmcnt(6)
  s_waitcnt vmcnt(14) lgkmcnt(3)
  v_mfma_f32_16x16x32_bf16 v[92:95], a[176:179], a[140:143], v[92:95]
  ds_read_b64_tr_b16 a[174:175], v7 offset:43008
  v_cndmask_b32 v28, 0, v24, s[16:17]
  v_mfma_f32_16x16x32_bf16 v[92:95], a[180:183], a[156:159], v[92:95]
  buffer_load_dwordx4 a[0:3], v1, s[8:11], s76 offen offset:0 sc1
  v_cndmask_b32 v29, 0, v24, s[18:19]
  v_cndmask_b32 v30, 0, v24, s[20:21]
  v_mfma_f32_16x16x32_bf16 v[88:91], a[180:183], a[152:155], v[88:91]
  ds_read_b64_tr_b16 a[168:169], v7 offset:45056
  v_cndmask_b32 v31, 0, v24, s[22:23]
  v_mfma_f32_16x16x32_bf16 v[88:91], a[176:179], a[136:139], v[88:91]
  s_nop 0
  v_mfma_f32_16x16x32_bf16 a[184:187], v[28:31], a[236:239], a[184:187]
  v_cndmask_b32 v28, 0, v25, s[16:17]
  v_cndmask_b32 v29, 0, v25, s[18:19]
  v_mfma_f32_16x16x32_bf16 v[84:87], a[176:179], a[132:135], v[84:87]
  ds_read_b64_tr_b16 a[170:171], v7 offset:47104
  v_cndmask_b32 v30, 0, v25, s[20:21]
  v_mfma_f32_16x16x32_bf16 v[84:87], a[180:183], a[148:151], v[84:87]
  v_cndmask_b32 v31, 0, v25, s[22:23]
  v_mfma_f32_16x16x32_bf16 v[80:83], a[180:183], a[144:147], v[80:83]
  ds_read_b64_tr_b16 a[180:181], v8 offset:32768
  v_mfma_f32_16x16x32_bf16 a[184:187], v[28:31], a[240:243], a[184:187]
  v_cndmask_b32 v28, 0, v26, s[16:17]
  v_cndmask_b32 v29, 0, v26, s[18:19]
  v_mfma_f32_16x16x32_bf16 v[80:83], a[176:179], a[128:131], v[80:83]
  s_waitcnt lgkmcnt(5)
  buffer_load_dwordx4 a[16:19], v1, s[8:11], s76 offen offset:1024 sc1
  v_cndmask_b32 v30, 0, v26, s[20:21]
  v_mfma_f32_16x16x32_bf16 v[96:99], a[164:167], a[128:131], v[96:99]
  ds_read_b64_tr_b16 a[182:183], v8 offset:34816
  v_cndmask_b32 v31, 0, v26, s[22:23]
  v_mfma_f32_16x16x32_bf16 v[96:99], a[160:163], a[144:147], v[96:99]
  s_add_u32 s76, s76, 65536
  v_mfma_f32_16x16x32_bf16 a[184:187], v[28:31], a[244:247], a[184:187]
  v_cndmask_b32 v28, 0, v27, s[16:17]
  v_cndmask_b32 v29, 0, v27, s[18:19]
  v_mfma_f32_16x16x32_bf16 v[100:103], a[160:163], a[148:151], v[100:103]
  ds_read_b64_tr_b16 a[176:177], v8 offset:36864
  v_cndmask_b32 v30, 0, v27, s[20:21]
  v_mfma_f32_16x16x32_bf16 v[100:103], a[164:167], a[132:135], v[100:103]
  buffer_load_dwordx4 a[4:7], v1, s[8:11], s76 offen offset:0 sc1
  v_cndmask_b32 v31, 0, v27, s[22:23]
  v_mfma_f32_16x16x32_bf16 v[104:107], a[164:167], a[136:139], v[104:107]
  ds_read_b64_tr_b16 a[178:179], v8 offset:38912
  v_mfma_f32_16x16x32_bf16 a[184:187], v[28:31], a[248:251], a[184:187]
  v_mfma_f32_16x16x32_bf16 v[104:107], a[160:163], a[152:155], v[104:107]
  v_mfma_f32_16x16x32_bf16 v[108:111], a[160:163], a[156:159], v[108:111]
  ds_read_b64_tr_b16 a[160:161], v8 offset:40960
  v_mfma_f32_16x16x32_bf16 v[108:111], a[164:167], a[140:143], v[108:111]
  s_waitcnt lgkmcnt(5)
  s_add_u32 s61, s62, 8192
  v_mfma_f32_16x16x32_bf16 v[124:127], a[172:175], a[140:143], v[124:127]
  ds_read_b64_tr_b16 a[162:163], v8 offset:43008
  s_bfe_u32 s53, s2, 0x20004
  v_mfma_f32_16x16x32_bf16 v[124:127], a[168:171], a[156:159], v[124:127]
  buffer_load_dwordx4 a[188:191], v12, s[8:11], s61 offen offset:0 sc1
  s_lshl_b32 s53, s53, 9
  v_and_b32 v14, 15, v0
  v_mfma_f32_16x16x32_bf16 v[120:123], a[168:171], a[152:155], v[120:123]
  ds_read_b64_tr_b16 a[164:165], v8 offset:45056
  v_lshl_add_u32 v14, v14, 5, s53
  v_mfma_f32_16x16x32_bf16 v[120:123], a[172:175], a[136:139], v[120:123]
  s_add_u32 s61, s62, 8192
  v_cmp_gt_u32 vcc, 1792, v14
  v_mov_b32 v15, 134217728
  v_bfe_u32 v13, v0, 4, 1
  v_cndmask_b32 v14, v15, v14, vcc
  v_mfma_f32_16x16x32_bf16 v[116:119], a[172:175], a[132:135], v[116:119]
  ds_read_b64_tr_b16 a[166:167], v8 offset:47104
  v_lshl_add_u32 v14, v13, 4, v14
  v_mfma_f32_16x16x32_bf16 v[116:119], a[168:171], a[148:151], v[116:119]
  buffer_load_dwordx4 a[192:195], v12, s[8:11], s61 offen offset:256 sc1
  v_lshrrev_b32 v13, 5, v0
  v_mul_u32_u24 v13, 14336, v13
  v_mfma_f32_16x16x32_bf16 v[112:115], a[168:171], a[144:147], v[112:115]
  ds_read_b64_tr_b16 a[168:169], v2 offset:32768
  v_add_u32 v14, v14, v13
  v_mfma_f32_16x16x32_bf16 v[112:115], a[172:175], a[128:131], v[112:115]
  s_waitcnt lgkmcnt(5)
  s_lshr_b32 s53, s2, 6
  s_lshl_b32 s53, s53, 2
  v_mfma_f32_16x16x32_bf16 v[32:35], a[180:183], a[128:131], v[32:35]
  ds_read_b64_tr_b16 a[170:171], v2 offset:34816
  s_add_u32 s53, s53, s44
  v_mfma_f32_16x16x32_bf16 v[32:35], a[176:179], a[144:147], v[32:35]
  s_add_u32 s61, s62, 10240
  s_lshl_b32 s53, s53, 1
  s_bfe_u32 s54, s2, 0x10003
  v_mfma_f32_16x16x32_bf16 v[36:39], a[176:179], a[148:151], v[36:39]
  ds_read_b64_tr_b16 a[172:173], v2 offset:36864
  s_add_u32 s53, s53, s54
  v_mfma_f32_16x16x32_bf16 v[36:39], a[180:183], a[132:135], v[36:39]
  buffer_load_dwordx4 a[196:199], v12, s[8:11], s61 offen offset:0 sc1
  s_mul_i32 s53, s53, 28672
  s_mul_i32 s54, s52, 1792
  v_mfma_f32_16x16x32_bf16 v[40:43], a[180:183], a[136:139], v[40:43]
  ds_read_b64_tr_b16 a[174:175], v2 offset:38912
  s_add_u32 s53, s53, s54
  v_mfma_f32_16x16x32_bf16 v[40:43], a[176:179], a[152:155], v[40:43]
  s_add_u32 s61, s62, 10240
  s_add_u32 s53, s53, 46137344
  v_mfma_f32_16x16x32_bf16 v[44:47], a[176:179], a[156:159], v[44:47]
  ds_read_b64_tr_b16 a[176:177], v2 offset:40960
  v_mfma_f32_16x16x32_bf16 v[44:47], a[180:183], a[140:143], v[44:47]
  s_waitcnt lgkmcnt(5)
  buffer_load_dwordx4 a[200:203], v12, s[8:11], s61 offen offset:256 sc1
  v_mfma_f32_16x16x32_bf16 v[60:63], a[160:163], a[140:143], v[60:63]
  ds_read_b64_tr_b16 a[178:179], v2 offset:43008
  buffer_store_dwordx4 a[184:187], v14, s[8:11], s53 offen sc1
  v_mfma_f32_16x16x32_bf16 v[60:63], a[164:167], a[156:159], v[60:63]
  s_lshl_b32 s53, s52, 7
  s_add_u32 s53, s53, 884736
  v_and_b32 v13, 31, v0
  v_mfma_f32_16x16x32_bf16 v[56:59], a[164:167], a[152:155], v[56:59]
  ds_read_b64_tr_b16 a[180:181], v2 offset:45056
  v_min_u32 v15, 27, v13
  v_mfma_f32_16x16x32_bf16 v[56:59], a[160:163], a[136:139], v[56:59]
  s_add_u32 s61, s62, 12288
  v_lshl_add_u32 v13, v13, 10, s53
  v_lshlrev_b32 v15, 4, v15
  v_mfma_f32_16x16x32_bf16 v[52:55], a[160:163], a[132:135], v[52:55]
  ds_read_b64_tr_b16 a[182:183], v2 offset:47104
  s_lshl_b32 s53, s51, 9
  v_mfma_f32_16x16x32_bf16 v[52:55], a[164:167], a[148:151], v[52:55]
  buffer_load_dwordx4 a[204:207], v12, s[8:11], s61 offen offset:0 sc1
  v_mov_b32 v14, s53
  s_lshl_b32 s55, s51, 3
  v_mfma_f32_16x16x32_bf16 v[48:51], a[164:167], a[144:147], v[48:51]
  ds_read_b64_tr_b16 a[164:165], v3 offset:32768
  s_lshr_b32 s53, 0x0b070602, s55
  v_mfma_f32_16x16x32_bf16 v[48:51], a[160:163], a[128:131], v[48:51]
  s_waitcnt lgkmcnt(5)
  s_add_u32 s61, s62, 12288
  s_and_b32 s53, s53, 15
  v_mfma_f32_16x16x32_bf16 v[128:131], a[168:171], a[128:131], v[128:131]
  ds_read_b64_tr_b16 a[166:167], v3 offset:34816
HOP9:
  s_cbranch_execz WRET0
  s_lshl_b32 s53, s53, 7
  v_mfma_f32_16x16x32_bf16 v[128:131], a[172:175], a[144:147], v[128:131]
  buffer_load_dwordx4 a[208:211], v12, s[8:11], s61 offen offset:256 sc1
  s_sub_u32 s53, s53, 256
  v_mov_b32 v24, s53
  v_mfma_f32_16x16x32_bf16 v[132:135], a[172:175], a[148:151], v[132:135]
  ds_read_b64_tr_b16 a[160:161], v3 offset:36864
  v_mfma_f32_16x16x32_bf16 v[132:135], a[168:171], a[132:135], v[132:135]
  v_cmp_gt_u32 vcc, 256, v15
  s_nop 1
  v_cndmask_b32 v14, v24, v14, vcc
  v_mfma_f32_16x16x32_bf16 v[136:139], a[168:171], a[136:139], v[136:139]
  ds_read_b64_tr_b16 a[162:163], v3 offset:38912
  s_lshr_b32 s53, 0x15140706, s55
  v_mfma_f32_16x16x32_bf16 v[136:139], a[172:175], a[152:155], v[136:139]
  s_add_u32 s61, s62, 14336
  s_and_b32 s53, s53, 31
  s_lshl_b32 s53, s53, 6
  v_mfma_f32_16x16x32_bf16 v[140:143], a[172:175], a[156:159], v[140:143]
  ds_read_b64_tr_b16 a[172:173], v3 offset:40960
  s_sub_u32 s53, s53, 384
  v_mfma_f32_16x16x32_bf16 v[140:143], a[168:171], a[140:143], v[140:143]
  s_waitcnt lgkmcnt(5)
  buffer_load_dwordx4 a[212:215], v12, s[8:11], s61 offen offset:0 sc1
  v_mov_b32 v24, s53
  v_mfma_f32_16x16x32_bf16 v[156:159], a[176:179], a[140:143], v[156:159]
  ds_read_b64_tr_b16 a[174:175], v3 offset:43008
  v_mfma_f32_16x16x32_bf16 v[156:159], a[180:183], a[156:159], v[156:159]
  s_add_u32 s61, s62, 14336
  v_cmp_gt_u32 vcc, 384, v15
  s_nop 1
  v_cndmask_b32 v14, v24, v14, vcc
  v_mfma_f32_16x16x32_bf16 v[152:155], a[180:183], a[152:155], v[152:155]
  ds_read_b64_tr_b16 a[168:169], v3 offset:45056
  v_lshrrev_b32 v24, 5, v0
  v_mfma_f32_16x16x32_bf16 v[152:155], a[176:179], a[136:139], v[152:155]
  buffer_load_dwordx4 a[216:219], v12, s[8:11], s61 offen offset:256 sc1
  v_mul_u32_u24 v24, 57344, v24
  v_add3_u32 v14, v14, v15, v24
  v_mfma_f32_16x16x32_bf16 v[148:151], a[176:179], a[132:135], v[148:151]
  ds_read_b64_tr_b16 a[170:171], v3 offset:47104
  s_mul_i32 s53, s44, 14336
  v_mfma_f32_16x16x32_bf16 v[148:151], a[180:183], a[148:151], v[148:151]
  s_add_u32 s53, s53, s54
  s_add_u32 s53, s53, 46137344
  v_add_u32 v14, s53, v14
  v_mfma_f32_16x16x32_bf16 v[144:147], a[180:183], a[144:147], v[144:147]
  ds_read_b64_tr_b16 a[180:181], v4 offset:32768
  s_lshl_b32 s53, s44, 9
  v_mfma_f32_16x16x32_bf16 v[144:147], a[176:179], a[128:131], v[144:147]
  s_waitcnt lgkmcnt(5)
  s_add_u32 s53, s53, 131072
  v_add_u32 v15, s53, v15
  v_mfma_f32_16x16x32_bf16 v[160:163], a[164:167], a[128:131], v[160:163]
  ds_read_b64_tr_b16 a[182:183], v4 offset:34816
  s_and_b32 s50, s2, 4
  v_mfma_f32_16x16x32_bf16 v[160:163], a[160:163], a[144:147], v[160:163]
  buffer_load_dwordx4 a[20:23], v1, s[8:11], s76 offen offset:1024 sc1
  s_lshr_b32 s53, s2, 6
  s_add_u32 s50, s50, s53
  v_mfma_f32_16x16x32_bf16 v[164:167], a[160:163], a[148:151], v[164:167]
  ds_read_b64_tr_b16 a[176:177], v4 offset:36864
  s_bfe_u32 s51, s2, 0x30003
  v_mfma_f32_16x16x32_bf16 v[164:167], a[164:167], a[132:135], v[164:167]
  s_add_u32 s76, s76, 65536
  s_and_b32 s52, s2, 3
  s_add_u32 s90, s50, s51
  v_mfma_f32_16x16x32_bf16 v[168:171], a[164:167], a[136:139], v[168:171]
  ds_read_b64_tr_b16 a[178:179], v4 offset:38912
  s_and_b32 s90, s90, 3
  v_mfma_f32_16x16x32_bf16 v[168:171], a[160:163], a[152:155], v[168:171]
  buffer_load_dwordx4 a[8:11], v1, s[8:11], s76 offen offset:0 sc1
  s_lshl_b32 s53, s50, 4
  s_and_b32 s54, s52, 2
  v_mfma_f32_16x16x32_bf16 v[172:175], a[160:163], a[156:159], v[172:175]
  ds_read_b64_tr_b16 a[160:161], v4 offset:40960
  s_mul_i32 s88, s54, 4293918720
  v_mfma_f32_16x16x32_bf16 v[172:175], a[164:167], a[140:143], v[172:175]
  s_waitcnt lgkmcnt(5)
  s_add_u32 s88, s88, 917504
  s_lshl_b32 s54, s54, 2
  v_mfma_f32_16x16x32_bf16 v[188:191], a[172:175], a[140:143], v[188:191]
  ds_read_b64_tr_b16 a[162:163], v4 offset:43008
  s_add_u32 s53, s53, s54
  v_mfma_f32_16x16x32_bf16 v[188:191], a[168:171], a[156:159], v[188:191]
  s_lshl_b32 s54, s44, 1
  s_add_u32 s53, s53, s54
  s_mul_i32 s83, s53, 131072
  v_mfma_f32_16x16x32_bf16 v[184:187], a[168:171], a[152:155], v[184:187]
  ds_read_b64_tr_b16 a[164:165], v4 offset:45056
  s_mul_i32 s54, s52, 28672
  v_mfma_f32_16x16x32_bf16 v[184:187], a[172:175], a[136:139], v[184:187]
  buffer_load_dwordx4 a[24:27], v1, s[8:11], s76 offen offset:1024 sc1
  s_add_u32 s83, s83, s54
  s_add_u32 s83, s83, 19922944
  v_mfma_f32_16x16x32_bf16 v[180:183], a[172:175], a[132:135], v[180:183]
  ds_read_b64_tr_b16 a[166:167], v4 offset:47104
  s_lshl_b32 s84, s53, 15
  v_mfma_f32_16x16x32_bf16 v[180:183], a[168:171], a[148:151], v[180:183]
  s_add_u32 s76, s76, 65536
  s_lshl_b32 s51, s51, 1
  s_and_b32 s54, s52, 1
  v_mfma_f32_16x16x32_bf16 v[176:179], a[168:171], a[144:147], v[176:179]
  ds_read_b64_tr_b16 a[168:169], v5 offset:32768
  s_add_u32 s51, s51, s54
  v_mfma_f32_16x16x32_bf16 v[176:179], a[172:175], a[128:131], v[176:179]
  s_waitcnt lgkmcnt(5)
  buffer_load_dwordx4 a[12:15], v1, s[8:11], s76 offen offset:0 sc1
  s_lshl_b32 s53, s51, 7
  v_mfma_f32_16x16x32_bf16 v[192:195], a[180:183], a[128:131], v[192:195]
  ds_read_b64_tr_b16 a[170:171], v5 offset:34816
  s_add_u32 s84, s84, s53
  v_mfma_f32_16x16x32_bf16 v[192:195], a[176:179], a[144:147], v[192:195]
  s_lshl_b32 s87, s51, 8
  s_add_u32 s87, s87, 20480
  s_lshl_b32 s53, s50, 12
  v_mfma_f32_16x16x32_bf16 v[196:199], a[176:179], a[148:151], v[196:199]
  ds_read_b64_tr_b16 a[172:173], v5 offset:36864
  s_lshl_b32 s54, s52, 8
  v_mfma_f32_16x16x32_bf16 v[196:199], a[180:183], a[132:135], v[196:199]
  s_add_u32 s53, s53, s54
  s_add_u32 s81, s53, 688128
  s_lshl_b32 s89, s44, 12
  v_mfma_f32_16x16x32_bf16 v[200:203], a[180:183], a[136:139], v[200:203]
  ds_read_b64_tr_b16 a[174:175], v5 offset:38912
  s_add_u32 s89, s89, 135168
  v_mfma_f32_16x16x32_bf16 v[200:203], a[176:179], a[152:155], v[200:203]
  buffer_load_dwordx4 a[28:31], v1, s[8:11], s76 offen offset:1024 sc1
  s_lshl_b32 s85, s2, 16
  s_lshl_b32 s53, s44, 14
  v_mfma_f32_16x16x32_bf16 v[204:207], a[176:179], a[156:159], v[204:207]
  ds_read_b64_tr_b16 a[176:177], v5 offset:40960
  s_add_u32 s85, s85, s53
  v_mfma_f32_16x16x32_bf16 v[204:207], a[180:183], a[140:143], v[204:207]
  s_waitcnt lgkmcnt(5)
  s_mov_b32 s69, 2752512
  s_add_u32 s77, s24, 12288
  s_add_u32 m0, s45, 81920
  s_add_u32 s85, s85, 67108864
  v_mfma_f32_16x16x32_bf16 v[220:223], a[160:163], a[140:143], v[220:223]
  ds_read_b64_tr_b16 a[178:179], v5 offset:43008
  s_lshr_b32 s53, s2, 3
  v_mfma_f32_16x16x32_bf16 v[220:223], a[164:167], a[156:159], v[220:223]
  buffer_load_dwordx4 v11, s[28:31], s69 offen lds
  s_lshl_b32 s53, s53, 2
  s_add_u32 s53, s53, s44
  v_mfma_f32_16x16x32_bf16 v[216:219], a[164:167], a[152:155], v[216:219]
  ds_read_b64_tr_b16 a[180:181], v5 offset:45056
  s_mul_i32 s91, s53, 1024
  v_mfma_f32_16x16x32_bf16 v[216:219], a[160:163], a[136:139], v[216:219]
  s_mul_i32 s53, s52, 1835008
  s_add_u32 s91, s91, s53
  s_nop 0
  v_mfma_f32_16x16x32_bf16 v[212:215], a[160:163], a[132:135], v[212:215]
  ds_read_b64_tr_b16 a[182:183], v5 offset:47104
  v_mfma_f32_16x16x32_bf16 v[212:215], a[164:167], a[148:151], v[212:215]
  s_waitcnt vmcnt(18)
  s_barrier
  v_mfma_f32_16x16x32_bf16 v[208:211], a[164:167], a[144:147], v[208:211]
  ds_read_b64_tr_b16 a[164:165], v6 offset:49152
  s_add_u32 m0, s45, 90112
  v_mfma_f32_16x16x32_bf16 v[208:211], a[160:163], a[128:131], v[208:211]
  s_waitcnt lgkmcnt(5)
  buffer_load_dwordx4 v11, s[32:35], s69 offen lds
  v_mfma_f32_16x16x32_bf16 v[224:227], a[168:171], a[128:131], v[224:227]
  ds_read_b64_tr_b16 a[166:167], v6 offset:51200
  v_mfma_f32_16x16x32_bf16 v[224:227], a[172:175], a[144:147], v[224:227]
  s_add_u32 m0, s45, 86016
  s_add_u32 s60, s69, 229376
  v_mfma_f32_16x16x32_bf16 v[228:231], a[172:175], a[148:151], v[228:231]
  ds_read_b64_tr_b16 a[160:161], v6 offset:53248
  v_mfma_f32_16x16x32_bf16 v[228:231], a[168:171], a[132:135], v[228:231]
  buffer_load_dwordx4 v11, s[28:31], s60 offen lds
  v_mfma_f32_16x16x32_bf16 v[232:235], a[168:171], a[136:139], v[232:235]
  ds_read_b64_tr_b16 a[162:163], v6 offset:55296
  v_add_u32 v9, s46, v0
  s_waitcnt vmcnt(12)
  s_barrier
  s_mov_b64 exec, 1
  buffer_store_dword v9, v0, s[8:11], s79 offen offset:0 sc1
  s_mov_b64 exec, -1
  s_sub_u32 s79, s79, 196608
  v_mfma_f32_16x16x32_bf16 v[232:235], a[172:175], a[152:155], v[232:235]
  v_mfma_f32_16x16x32_bf16 v[236:239], a[172:175], a[156:159], v[236:239]
  ds_read_b64_tr_b16 a[172:173], v6 offset:57344
  v_mfma_f32_16x16x32_bf16 v[236:239], a[168:171], a[140:143], v[236:239]
  s_waitcnt lgkmcnt(5)
  s_add_u32 m0, s45, 94208
  s_add_u32 s60, s69, 229376
  v_mfma_f32_16x16x32_bf16 v[252:255], a[176:179], a[140:143], v[252:255]
  ds_read_b64_tr_b16 a[174:175], v6 offset:59392
  v_mfma_f32_16x16x32_bf16 v[252:255], a[180:183], a[156:159], v[252:255]
  buffer_load_dwordx4 v11, s[32:35], s60 offen lds
  v_mfma_f32_16x16x32_bf16 v[248:251], a[180:183], a[152:155], v[248:251]
  ds_read_b64_tr_b16 a[168:169], v6 offset:61440
  v_mfma_f32_16x16x32_bf16 v[248:251], a[176:179], a[136:139], v[248:251]
  s_add_u32 m0, s45, 0
  v_mfma_f32_16x16x32_bf16 v[244:247], a[176:179], a[132:135], v[244:247]
  ds_read_b64_tr_b16 a[170:171], v6 offset:63488
  v_mfma_f32_16x16x32_bf16 v[244:247], a[180:183], a[148:151], v[244:247]
  buffer_load_dwordx4 v10, s[28:31], s69 offen lds
  v_mfma_f32_16x16x32_bf16 v[240:243], a[180:183], a[144:147], v[240:243]
  ds_read_b64_tr_b16 a[180:181], v7 offset:49152
  v_mfma_f32_16x16x32_bf16 v[240:243], a[176:179], a[128:131], v[240:243]
  s_waitcnt vmcnt(6) lgkmcnt(5)
  v_mfma_f32_16x16x32_bf16 v[64:67], a[164:167], a[0:3], v[64:67]
  ds_read_b64_tr_b16 a[182:183], v7 offset:51200
  v_mfma_f32_16x16x32_bf16 v[64:67], a[160:163], a[16:19], v[64:67]
  s_add_u32 m0, s45, 8192
  v_mfma_f32_16x16x32_bf16 v[68:71], a[160:163], a[20:23], v[68:71]
  ds_read_b64_tr_b16 a[176:177], v7 offset:53248
  v_mfma_f32_16x16x32_bf16 v[68:71], a[164:167], a[4:7], v[68:71]
  buffer_load_dwordx4 v10, s[32:35], s69 offen lds
  v_mfma_f32_16x16x32_bf16 v[72:75], a[164:167], a[8:11], v[72:75]
  ds_read_b64_tr_b16 a[178:179], v7 offset:55296
  v_mfma_f32_16x16x32_bf16 v[72:75], a[160:163], a[24:27], v[72:75]
  s_add_u32 m0, s45, 4096
  s_add_u32 s60, s69, 229376
  v_mfma_f32_16x16x32_bf16 v[76:79], a[160:163], a[28:31], v[76:79]
  ds_read_b64_tr_b16 a[160:161], v7 offset:57344
  v_mfma_f32_16x16x32_bf16 v[76:79], a[164:167], a[12:15], v[76:79]
  s_waitcnt lgkmcnt(5)
  buffer_load_dwordx4 v10, s[28:31], s60 offen lds
  v_mfma_f32_16x16x32_bf16 v[92:95], a[172:175], a[12:15], v[92:95]
  ds_read_b64_tr_b16 a[162:163], v7 offset:59392
  v_mfma_f32_16x16x32_bf16 v[92:95], a[168:171], a[28:31], v[92:95]
  v_mfma_f32_16x16x32_bf16 v[88:91], a[168:171], a[24:27], v[88:91]
  ds_read_b64_tr_b16 a[164:165], v7 offset:61440
  s_waitcnt vmcnt(13)
  v_mfma_f32_16x16x32_bf16 v[88:91], a[172:175], a[8:11], v[88:91]
  s_add_u32 m0, s45, 12288
  s_add_u32 s60, s69, 229376
  v_accvgpr_read_b32 v24, a188
  v_mfma_f32_16x16x32_bf16 v[84:87], a[172:175], a[4:7], v[84:87]
  ds_read_b64_tr_b16 a[166:167], v7 offset:63488
  v_accvgpr_read_b32 v25, a189
  v_mfma_f32_16x16x32_bf16 v[84:87], a[168:171], a[20:23], v[84:87]
  buffer_load_dwordx4 v10, s[32:35], s60 offen lds
  v_accvgpr_read_b32 v26, a190
  v_accvgpr_read_b32 v27, a191
  v_mfma_f32_16x16x32_bf16 v[80:83], a[168:171], a[16:19], v[80:83]
  ds_read_b64_tr_b16 a[168:169], v8 offset:49152
  v_accvgpr_read_b32 v28, a192
  v_mfma_f32_16x16x32_bf16 v[80:83], a[172:175], a[0:3], v[80:83]
  s_waitcnt lgkmcnt(5)
  v_accvgpr_read_b32 v29, a193
  v_mfma_f32_16x16x32_bf16 v[96:99], a[180:183], a[0:3], v[96:99]
  ds_read_b64_tr_b16 a[170:171], v8 offset:51200
  v_accvgpr_read_b32 v30, a194
  v_mfma_f32_16x16x32_bf16 v[96:99], a[176:179], a[16:19], v[96:99]
  buffer_load_dwordx4 a[32:35], v1, s[8:11], s77 offen offset:0 sc1
  v_accvgpr_read_b32 v31, a195
  v_add_f32 v16, v16, v24
  v_mfma_f32_16x16x32_bf16 v[100:103], a[176:179], a[20:23], v[100:103]
  ds_read_b64_tr_b16 a[172:173], v8 offset:53248
  v_add_f32 v17, v17, v25
  v_mfma_f32_16x16x32_bf16 v[100:103], a[180:183], a[4:7], v[100:103]
  v_add_f32 v18, v18, v26
  v_add_f32 v19, v19, v27
  v_mfma_f32_16x16x32_bf16 v[104:107], a[180:183], a[8:11], v[104:107]
  ds_read_b64_tr_b16 a[174:175], v8 offset:55296
  v_add_f32 v20, v20, v28
  v_mfma_f32_16x16x32_bf16 v[104:107], a[176:179], a[24:27], v[104:107]
  v_add_f32 v21, v21, v29
  v_add_f32 v22, v22, v30
  v_mfma_f32_16x16x32_bf16 v[108:111], a[176:179], a[28:31], v[108:111]
  ds_read_b64_tr_b16 a[176:177], v8 offset:57344
  v_add_f32 v23, v23, v31
  v_mfma_f32_16x16x32_bf16 v[108:111], a[180:183], a[12:15], v[108:111]
  s_waitcnt lgkmcnt(5)
  buffer_load_dwordx4 a[48:51], v1, s[8:11], s77 offen offset:1024 sc1
  v_accvgpr_read_b32 v24, a196
  v_mfma_f32_16x16x32_bf16 v[124:127], a[160:163], a[12:15], v[124:127]
  ds_read_b64_tr_b16 a[178:179], v8 offset:59392
  v_accvgpr_read_b32 v25, a197
  v_mfma_f32_16x16x32_bf16 v[124:127], a[164:167], a[28:31], v[124:127]
  s_add_u32 s77, s77, 65536
  v_accvgpr_read_b32 v26, a198
  v_accvgpr_read_b32 v27, a199
  v_mfma_f32_16x16x32_bf16 v[120:123], a[164:167], a[24:27], v[120:123]
  ds_read_b64_tr_b16 a[180:181], v8 offset:61440
  v_accvgpr_read_b32 v28, a200
  v_mfma_f32_16x16x32_bf16 v[120:123], a[160:163], a[8:11], v[120:123]
  buffer_load_dwordx4 a[36:39], v1, s[8:11], s77 offen offset:0 sc1
  v_accvgpr_read_b32 v29, a201
  v_accvgpr_read_b32 v30, a202
  v_mfma_f32_16x16x32_bf16 v[116:119], a[160:163], a[4:7], v[116:119]
  ds_read_b64_tr_b16 a[182:183], v8 offset:63488
  v_accvgpr_read_b32 v31, a203
  v_mfma_f32_16x16x32_bf16 v[116:119], a[164:167], a[20:23], v[116:119]
  v_add_f32 v16, v16, v24
  v_add_f32 v17, v17, v25
  v_mfma_f32_16x16x32_bf16 v[112:115], a[164:167], a[16:19], v[112:115]
  ds_read_b64_tr_b16 a[164:165], v2 offset:49152
  v_add_f32 v18, v18, v26
  v_mfma_f32_16x16x32_bf16 v[112:115], a[160:163], a[0:3], v[112:115]
  s_waitcnt lgkmcnt(5)
  v_add_f32 v19, v19, v27
  v_add_f32 v20, v20, v28
  v_mfma_f32_16x16x32_bf16 v[32:35], a[168:171], a[0:3], v[32:35]
  ds_read_b64_tr_b16 a[166:167], v2 offset:51200
  v_add_f32 v21, v21, v29
  v_mfma_f32_16x16x32_bf16 v[32:35], a[172:175], a[16:19], v[32:35]
  buffer_load_dwordx4 a[52:55], v1, s[8:11], s77 offen offset:1024 sc1
  v_add_f32 v22, v22, v30
  v_add_f32 v23, v23, v31
  v_mfma_f32_16x16x32_bf16 v[36:39], a[172:175], a[20:23], v[36:39]
  ds_read_b64_tr_b16 a[160:161], v2 offset:53248
  v_accvgpr_read_b32 v24, a204
  v_mfma_f32_16x16x32_bf16 v[36:39], a[168:171], a[4:7], v[36:39]
  s_add_u32 s77, s77, 65536
  v_accvgpr_read_b32 v25, a205
  v_accvgpr_read_b32 v26, a206
  v_mfma_f32_16x16x32_bf16 v[40:43], a[168:171], a[8:11], v[40:43]
  ds_read_b64_tr_b16 a[162:163], v2 offset:55296
  v_accvgpr_read_b32 v27, a207
  v_mfma_f32_16x16x32_bf16 v[40:43], a[172:175], a[24:27], v[40:43]
  buffer_load_dwordx4 a[40:43], v1, s[8:11], s77 offen offset:0 sc1
  v_accvgpr_read_b32 v28, a208
  v_accvgpr_read_b32 v29, a209
  v_mfma_f32_16x16x32_bf16 v[44:47], a[172:175], a[28:31], v[44:47]
  ds_read_b64_tr_b16 a[172:173], v2 offset:57344
  v_accvgpr_read_b32 v30, a210
  v_mfma_f32_16x16x32_bf16 v[44:47], a[168:171], a[12:15], v[44:47]
  s_waitcnt lgkmcnt(5)
  v_accvgpr_read_b32 v31, a211
  v_add_f32 v16, v16, v24
  v_mfma_f32_16x16x32_bf16 v[60:63], a[176:179], a[12:15], v[60:63]
  ds_read_b64_tr_b16 a[174:175], v2 offset:59392
  v_add_f32 v17, v17, v25
  v_mfma_f32_16x16x32_bf16 v[60:63], a[180:183], a[28:31], v[60:63]
  v_add_f32 v18, v18, v26
  v_add_f32 v19, v19, v27
  v_mfma_f32_16x16x32_bf16 v[56:59], a[180:183], a[24:27], v[56:59]
  ds_read_b64_tr_b16 a[168:169], v2 offset:61440
  v_add_f32 v20, v20, v28
  v_mfma_f32_16x16x32_bf16 v[56:59], a[176:179], a[8:11], v[56:59]
  buffer_load_dwordx4 a[56:59], v1, s[8:11], s77 offen offset:1024 sc1
  v_add_f32 v21, v21, v29
  v_add_f32 v22, v22, v30
  v_mfma_f32_16x16x32_bf16 v[52:55], a[176:179], a[4:7], v[52:55]
  ds_read_b64_tr_b16 a[170:171], v2 offset:63488
  v_add_f32 v23, v23, v31
  v_mfma_f32_16x16x32_bf16 v[52:55], a[180:183], a[20:23], v[52:55]
  s_add_u32 s77, s77, 65536
  v_accvgpr_read_b32 v24, a212
  v_accvgpr_read_b32 v25, a213
  v_mfma_f32_16x16x32_bf16 v[48:51], a[180:183], a[16:19], v[48:51]
  ds_read_b64_tr_b16 a[180:181], v3 offset:49152
  v_accvgpr_read_b32 v26, a214
  v_mfma_f32_16x16x32_bf16 v[48:51], a[176:179], a[0:3], v[48:51]
  s_waitcnt lgkmcnt(5)
  buffer_load_dwordx4 a[44:47], v1, s[8:11], s77 offen offset:0 sc1
  v_accvgpr_read_b32 v27, a215
  v_mfma_f32_16x16x32_bf16 v[128:131], a[164:167], a[0:3], v[128:131]
  ds_read_b64_tr_b16 a[182:183], v3 offset:51200
  v_accvgpr_read_b32 v28, a216
  v_mfma_f32_16x16x32_bf16 v[128:131], a[160:163], a[16:19], v[128:131]
  v_accvgpr_read_b32 v29, a217
  v_accvgpr_read_b32 v30, a218
  v_mfma_f32_16x16x32_bf16 v[132:135], a[160:163], a[20:23], v[132:135]
  ds_read_b64_tr_b16 a[176:177], v3 offset:53248
  v_accvgpr_read_b32 v31, a219
  v_mfma_f32_16x16x32_bf16 v[132:135], a[164:167], a[4:7], v[132:135]
  v_add_f32 v16, v16, v24
  v_add_f32 v17, v17, v25
  v_mfma_f32_16x16x32_bf16 v[136:139], a[164:167], a[8:11], v[136:139]
  ds_read_b64_tr_b16 a[178:179], v3 offset:55296
  v_add_f32 v18, v18, v26
  v_mfma_f32_16x16x32_bf16 v[136:139], a[160:163], a[24:27], v[136:139]
  buffer_load_dwordx4 a[60:63], v1, s[8:11], s77 offen offset:1024 sc1
  v_add_f32 v19, v19, v27
  v_add_f32 v20, v20, v28
  v_mfma_f32_16x16x32_bf16 v[140:143], a[160:163], a[28:31], v[140:143]
  ds_read_b64_tr_b16 a[160:161], v3 offset:57344
  v_add_f32 v21, v21, v29
  v_mfma_f32_16x16x32_bf16 v[140:143], a[164:167], a[12:15], v[140:143]
  s_waitcnt lgkmcnt(5)
  s_mov_b32 s70, 3211264
  s_add_u32 s78, s24, 14336
  s_add_u32 m0, s45, 65536
  v_add_f32 v22, v22, v30
  v_mfma_f32_16x16x32_bf16 v[156:159], a[172:175], a[12:15], v[156:159]
  ds_read_b64_tr_b16 a[162:163], v3 offset:59392
  v_add_f32 v23, v23, v31
  v_mfma_f32_16x16x32_bf16 v[156:159], a[168:171], a[28:31], v[156:159]
  buffer_load_dwordx4 v11, s[28:31], s70 offen lds
  v_permlane32_swap_b32 v16, v20
  v_mfma_f32_16x16x32_bf16 v[152:155], a[168:171], a[24:27], v[152:155]
  ds_read_b64_tr_b16 a[164:165], v3 offset:61440
  v_mfma_f32_16x16x32_bf16 v[152:155], a[172:175], a[8:11], v[152:155]
  v_permlane32_swap_b32 v17, v21
  v_mfma_f32_16x16x32_bf16 v[148:151], a[172:175], a[4:7], v[148:151]
  ds_read_b64_tr_b16 a[166:167], v3 offset:63488
  v_mfma_f32_16x16x32_bf16 v[148:151], a[168:171], a[20:23], v[148:151]
  s_add_u32 m0, s45, 73728
  v_permlane32_swap_b32 v18, v22
  v_mfma_f32_16x16x32_bf16 v[144:147], a[168:171], a[16:19], v[144:147]
  ds_read_b64_tr_b16 a[168:169], v4 offset:49152
  v_mfma_f32_16x16x32_bf16 v[144:147], a[172:175], a[0:3], v[144:147]
  s_waitcnt lgkmcnt(5)
  buffer_load_dwordx4 v11, s[32:35], s70 offen lds
  v_mfma_f32_16x16x32_bf16 v[160:163], a[180:183], a[0:3], v[160:163]
  ds_read_b64_tr_b16 a[170:171], v4 offset:51200
  v_mfma_f32_16x16x32_bf16 v[160:163], a[176:179], a[16:19], v[160:163]
  s_add_u32 m0, s45, 69632
  s_add_u32 s60, s70, 229376
  v_mfma_f32_16x16x32_bf16 v[164:167], a[176:179], a[20:23], v[164:167]
  ds_read_b64_tr_b16 a[172:173], v4 offset:53248
  v_permlane32_swap_b32 v19, v23
  v_mfma_f32_16x16x32_bf16 v[164:167], a[180:183], a[4:7], v[164:167]
  buffer_load_dwordx4 v11, s[28:31], s60 offen lds
  v_add_f32 v16, v16, v20
  v_add_f32 v17, v17, v21
  v_mfma_f32_16x16x32_bf16 v[168:171], a[180:183], a[8:11], v[168:171]
  ds_read_b64_tr_b16 a[174:175], v4 offset:55296
  v_add_f32 v18, v18, v22
  v_mfma_f32_16x16x32_bf16 v[168:171], a[176:179], a[24:27], v[168:171]
  v_add_f32 v19, v19, v23
  v_mfma_f32_16x16x32_bf16 v[172:175], a[176:179], a[28:31], v[172:175]
  ds_read_b64_tr_b16 a[176:177], v4 offset:57344
  v_mfma_f32_16x16x32_bf16 v[172:175], a[180:183], a[12:15], v[172:175]
  s_waitcnt lgkmcnt(5)
  s_add_u32 m0, s45, 77824
  s_add_u32 s60, s70, 229376
  v_mfma_f32_16x16x32_bf16 v[188:191], a[160:163], a[12:15], v[188:191]
  ds_read_b64_tr_b16 a[178:179], v4 offset:59392
  v_mfma_f32_16x16x32_bf16 v[188:191], a[164:167], a[28:31], v[188:191]
  buffer_load_dwordx4 v11, s[32:35], s60 offen lds
  v_permlane16_swap_b32 v16, v18
  v_mfma_f32_16x16x32_bf16 v[184:187], a[164:167], a[24:27], v[184:187]
  ds_read_b64_tr_b16 a[180:181], v4 offset:61440
  v_mfma_f32_16x16x32_bf16 v[184:187], a[160:163], a[8:11], v[184:187]
  s_add_u32 m0, s45, 16384
  v_permlane16_swap_b32 v17, v19
  v_mfma_f32_16x16x32_bf16 v[180:183], a[160:163], a[4:7], v[180:183]
  ds_read_b64_tr_b16 a[182:183], v4 offset:63488
  v_add_f32 v16, v16, v18
  v_mfma_f32_16x16x32_bf16 v[180:183], a[164:167], a[20:23], v[180:183]
  buffer_load_dwordx4 v10, s[28:31], s70 offen lds
  v_add_f32 v17, v17, v19
  v_mul_f32 v16, 0x3a800000, v16
  v_mfma_f32_16x16x32_bf16 v[176:179], a[164:167], a[16:19], v[176:179]
  ds_read_b64_tr_b16 a[164:165], v5 offset:49152
  v_mul_f32 v17, 0x3a800000, v17
  v_mfma_f32_16x16x32_bf16 v[176:179], a[160:163], a[0:3], v[176:179]
  s_waitcnt lgkmcnt(5)
  v_fma_f32 v17, -v16, v16, v17
  v_max_f32 v17, 0, v17
  v_mfma_f32_16x16x32_bf16 v[192:195], a[168:171], a[0:3], v[192:195]
  ds_read_b64_tr_b16 a[166:167], v5 offset:51200
  v_cvt_pk_bf16_f32 v17, v17, v17
  v_mfma_f32_16x16x32_bf16 v[192:195], a[172:175], a[16:19], v[192:195]
  s_add_u32 m0, s45, 24576
  v_lshlrev_b32 v17, 16, v17
  v_add_f32 v17, 0x3727c5ac, v17
  v_mfma_f32_16x16x32_bf16 v[196:199], a[172:175], a[20:23], v[196:199]
  ds_read_b64_tr_b16 a[160:161], v5 offset:53248
  v_cvt_pk_bf16_f32 v17, v17, v17
  v_mfma_f32_16x16x32_bf16 v[196:199], a[168:171], a[4:7], v[196:199]
  buffer_load_dwordx4 v10, s[32:35], s70 offen lds
  v_lshlrev_b32 v17, 16, v17
  v_mfma_f32_16x16x32_bf16 v[200:203], a[168:171], a[8:11], v[200:203]
  ds_read_b64_tr_b16 a[162:163], v5 offset:55296
  v_mfma_f32_16x16x32_bf16 v[200:203], a[172:175], a[24:27], v[200:203]
  s_add_u32 m0, s45, 20480
  s_add_u32 s60, s70, 229376
  v_mfma_f32_16x16x32_bf16 v[204:207], a[172:175], a[28:31], v[204:207]
  ds_read_b64_tr_b16 a[172:173], v5 offset:57344
  v_mfma_f32_16x16x32_bf16 v[204:207], a[168:171], a[12:15], v[204:207]
  s_waitcnt lgkmcnt(5)
  buffer_load_dwordx4 v10, s[28:31], s60 offen lds
  v_mfma_f32_16x16x32_bf16 v[220:223], a[176:179], a[12:15], v[220:223]
  ds_read_b64_tr_b16 a[174:175], v5 offset:59392
  v_sqrt_f32 v17, v17
  v_mfma_f32_16x16x32_bf16 v[220:223], a[180:183], a[28:31], v[220:223]
  v_cvt_pk_bf16_f32 v16, v16, v16
  v_lshlrev_b32 v16, 16, v16
  v_mfma_f32_16x16x32_bf16 v[216:219], a[180:183], a[24:27], v[216:219]
  ds_read_b64_tr_b16 a[168:169], v5 offset:61440
  v_cvt_pk_bf16_f32 v17, v17, v17
  v_mfma_f32_16x16x32_bf16 v[216:219], a[176:179], a[8:11], v[216:219]
  s_add_u32 m0, s45, 28672
  s_add_u32 s60, s70, 229376
  v_lshlrev_b32 v17, 16, v17
  v_mfma_f32_16x16x32_bf16 v[212:215], a[176:179], a[4:7], v[212:215]
  ds_read_b64_tr_b16 a[170:171], v5 offset:63488
  buffer_load_dwordx4 v10, s[32:35], s60 offen lds
  v_mfma_f32_16x16x32_bf16 v[212:215], a[180:183], a[20:23], v[212:215]
  s_waitcnt vmcnt(16)
  s_barrier
  v_mfma_f32_16x16x32_bf16 v[208:211], a[180:183], a[16:19], v[208:211]
  ds_read_b64_tr_b16 a[180:181], v6 offset:16384
  v_sub_f32 v16, 0, v16
  v_mfma_f32_16x16x32_bf16 v[208:211], a[176:179], a[0:3], v[208:211]
  s_waitcnt lgkmcnt(5)
  v_mov_b32 v18, v16
  v_mfma_f32_16x16x32_bf16 v[224:227], a[164:167], a[0:3], v[224:227]
  ds_read_b64_tr_b16 a[182:183], v6 offset:18432
  v_mov_b32 v19, v17
  v_mfma_f32_16x16x32_bf16 v[224:227], a[160:163], a[16:19], v[224:227]
  buffer_load_dwordx4 a[64:67], v1, s[8:11], s78 offen offset:0 sc1
  v_permlane16_swap_b32 v16, v18
  v_mfma_f32_16x16x32_bf16 v[228:231], a[160:163], a[20:23], v[228:231]
  ds_read_b64_tr_b16 a[176:177], v6 offset:20480
  v_mfma_f32_16x16x32_bf16 v[228:231], a[164:167], a[4:7], v[228:231]
  v_permlane16_swap_b32 v17, v19
  v_mfma_f32_16x16x32_bf16 v[232:235], a[164:167], a[8:11], v[232:235]
  ds_read_b64_tr_b16 a[178:179], v6 offset:22528
  v_mov_b32 v20, v16
  v_mfma_f32_16x16x32_bf16 v[232:235], a[160:163], a[24:27], v[232:235]
  v_mov_b32 v21, v17
  v_mov_b32 v22, v18
  v_mfma_f32_16x16x32_bf16 v[236:239], a[160:163], a[28:31], v[236:239]
  ds_read_b64_tr_b16 a[160:161], v6 offset:24576
  v_mov_b32 v23, v19
  v_mfma_f32_16x16x32_bf16 v[236:239], a[164:167], a[12:15], v[236:239]
  s_waitcnt lgkmcnt(5)
  buffer_load_dwordx4 a[80:83], v1, s[8:11], s78 offen offset:1024 sc1
  v_mfma_f32_16x16x32_bf16 v[252:255], a[172:175], a[12:15], v[252:255]
  ds_read_b64_tr_b16 a[162:163], v6 offset:26624
  v_mfma_f32_16x16x32_bf16 v[252:255], a[168:171], a[28:31], v[252:255]
  s_add_u32 s78, s78, 65536
  v_permlane32_swap_b32 v16, v20
  v_mfma_f32_16x16x32_bf16 v[248:251], a[168:171], a[24:27], v[248:251]
  ds_read_b64_tr_b16 a[164:165], v6 offset:28672
  v_mfma_f32_16x16x32_bf16 v[248:251], a[172:175], a[8:11], v[248:251]
  buffer_load_dwordx4 a[68:71], v1, s[8:11], s78 offen offset:0 sc1
  v_permlane32_swap_b32 v17, v21
  v_mfma_f32_16x16x32_bf16 v[244:247], a[172:175], a[4:7], v[244:247]
  ds_read_b64_tr_b16 a[166:167], v6 offset:30720
  v_mfma_f32_16x16x32_bf16 v[244:247], a[168:171], a[20:23], v[244:247]
  v_permlane32_swap_b32 v18, v22
  v_mfma_f32_16x16x32_bf16 v[240:243], a[168:171], a[16:19], v[240:243]
  ds_read_b64_tr_b16 a[168:169], v7 offset:16384
  v_mfma_f32_16x16x32_bf16 v[240:243], a[172:175], a[0:3], v[240:243]
  s_waitcnt vmcnt(11) lgkmcnt(5)
  v_permlane32_swap_b32 v19, v23
  v_mfma_f32_16x16x32_bf16 v[64:67], a[180:183], a[32:35], v[64:67]
  ds_read_b64_tr_b16 a[170:171], v7 offset:18432
  v_lshrrev_b32 v12, 8, v1
  v_mfma_f32_16x16x32_bf16 v[64:67], a[176:179], a[48:51], v[64:67]
  buffer_load_dwordx4 a[84:87], v1, s[8:11], s78 offen offset:1024 sc1
  v_lshlrev_b32 v12, 4, v12
  v_add_u32 v12, 131072, v12
  v_mfma_f32_16x16x32_bf16 v[68:71], a[176:179], a[52:55], v[68:71]
  ds_read_b64_tr_b16 a[172:173], v7 offset:20480
  v_mfma_f32_16x16x32_bf16 v[68:71], a[180:183], a[36:39], v[68:71]
  s_add_u32 s78, s78, 65536
  v_mfma_f32_16x16x32_bf16 v[72:75], a[180:183], a[40:43], v[72:75]
  ds_read_b64_tr_b16 a[174:175], v7 offset:22528
  v_mfma_f32_16x16x32_bf16 v[72:75], a[176:179], a[56:59], v[72:75]
  buffer_load_dwordx4 a[72:75], v1, s[8:11], s78 offen offset:0 sc1
  v_mfma_f32_16x16x32_bf16 v[76:79], a[176:179], a[60:63], v[76:79]
  ds_read_b64_tr_b16 a[176:177], v7 offset:24576
  v_mfma_f32_16x16x32_bf16 v[76:79], a[180:183], a[44:47], v[76:79]
  s_waitcnt lgkmcnt(5)
  v_mfma_f32_16x16x32_bf16 v[92:95], a[160:163], a[44:47], v[92:95]
  ds_read_b64_tr_b16 a[178:179], v7 offset:26624
  v_mfma_f32_16x16x32_bf16 v[92:95], a[164:167], a[60:63], v[92:95]
  v_mfma_f32_16x16x32_bf16 v[88:91], a[164:167], a[56:59], v[88:91]
  ds_read_b64_tr_b16 a[180:181], v7 offset:28672
  v_mfma_f32_16x16x32_bf16 v[88:91], a[160:163], a[40:43], v[88:91]
  buffer_load_dwordx4 a[88:91], v1, s[8:11], s78 offen offset:1024 sc1
  v_mfma_f32_16x16x32_bf16 v[84:87], a[160:163], a[36:39], v[84:87]
  ds_read_b64_tr_b16 a[182:183], v7 offset:30720
  v_mfma_f32_16x16x32_bf16 v[84:87], a[164:167], a[52:55], v[84:87]
  s_add_u32 s78, s78, 65536
  v_mfma_f32_16x16x32_bf16 v[80:83], a[164:167], a[48:51], v[80:83]
  ds_read_b64_tr_b16 a[164:165], v8 offset:16384
  v_mfma_f32_16x16x32_bf16 v[80:83], a[160:163], a[32:35], v[80:83]
  s_waitcnt lgkmcnt(5)
  buffer_load_dwordx4 a[76:79], v1, s[8:11], s78 offen offset:0 sc1
  v_mfma_f32_16x16x32_bf16 v[96:99], a[168:171], a[32:35], v[96:99]
  ds_read_b64_tr_b16 a[166:167], v8 offset:18432
  v_mfma_f32_16x16x32_bf16 v[96:99], a[172:175], a[48:51], v[96:99]
  v_mfma_f32_16x16x32_bf16 v[100:103], a[172:175], a[52:55], v[100:103]
  ds_read_b64_tr_b16 a[160:161], v8 offset:20480
  v_mfma_f32_16x16x32_bf16 v[100:103], a[168:171], a[36:39], v[100:103]
  v_mfma_f32_16x16x32_bf16 v[104:107], a[168:171], a[40:43], v[104:107]
  ds_read_b64_tr_b16 a[162:163], v8 offset:22528
  v_mfma_f32_16x16x32_bf16 v[104:107], a[172:175], a[56:59], v[104:107]
  buffer_load_dwordx4 a[92:95], v1, s[8:11], s78 offen offset:1024 sc1
  v_mfma_f32_16x16x32_bf16 v[108:111], a[172:175], a[60:63], v[108:111]
HOP10:
  s_cbranch_execz WRET0
  ds_read_b64_tr_b16 a[172:173], v8 offset:24576
  v_mfma_f32_16x16x32_bf16 v[108:111], a[168:171], a[44:47], v[108:111]
  s_waitcnt lgkmcnt(5)
  s_mov_b32 s63, 3670016
  s_add_u32 s71, s24, 16384
  s_add_u32 m0, s45, 98304
  v_mfma_f32_16x16x32_bf16 v[124:127], a[176:179], a[44:47], v[124:127]
  ds_read_b64_tr_b16 a[174:175], v8 offset:26624
  v_mfma_f32_16x16x32_bf16 v[124:127], a[180:183], a[60:63], v[124:127]
  buffer_load_dwordx4 v11, s[28:31], s63 offen lds
  v_mfma_f32_16x16x32_bf16 v[120:123], a[180:183], a[56:59], v[120:123]
  ds_read_b64_tr_b16 a[168:169], v8 offset:28672
  v_mfma_f32_16x16x32_bf16 v[120:123], a[176:179], a[40:43], v[120:123]
  v_mfma_f32_16x16x32_bf16 v[116:119], a[176:179], a[36:39], v[116:119]
  ds_read_b64_tr_b16 a[170:171], v8 offset:30720
  v_mfma_f32_16x16x32_bf16 v[116:119], a[180:183], a[52:55], v[116:119]
  s_add_u32 m0, s45, 106496
  v_mfma_f32_16x16x32_bf16 v[112:115], a[180:183], a[48:51], v[112:115]
  ds_read_b64_tr_b16 a[180:181], v2 offset:0
  v_mfma_f32_16x16x32_bf16 v[112:115], a[176:179], a[32:35], v[112:115]
  s_waitcnt lgkmcnt(5)
  buffer_load_dwordx4 v11, s[32:35], s63 offen lds
  v_mfma_f32_16x16x32_bf16 v[32:35], a[164:167], a[32:35], v[32:35]
  ds_read_b64_tr_b16 a[182:183], v2 offset:2048
  v_mfma_f32_16x16x32_bf16 v[32:35], a[160:163], a[48:51], v[32:35]
  s_add_u32 m0, s45, 102400
  s_add_u32 s60, s63, 229376
  v_mfma_f32_16x16x32_bf16 v[36:39], a[160:163], a[52:55], v[36:39]
  ds_read_b64_tr_b16 a[176:177], v2 offset:4096
  v_mfma_f32_16x16x32_bf16 v[36:39], a[164:167], a[36:39], v[36:39]
  buffer_load_dwordx4 v11, s[28:31], s60 offen lds
  v_mfma_f32_16x16x32_bf16 v[40:43], a[164:167], a[40:43], v[40:43]
  ds_read_b64_tr_b16 a[178:179], v2 offset:6144
  v_mfma_f32_16x16x32_bf16 v[40:43], a[160:163], a[56:59], v[40:43]
  v_mfma_f32_16x16x32_bf16 v[44:47], a[160:163], a[60:63], v[44:47]
  ds_read_b64_tr_b16 a[160:161], v2 offset:8192
  v_mfma_f32_16x16x32_bf16 v[44:47], a[164:167], a[44:47], v[44:47]
  s_waitcnt lgkmcnt(5)
  s_add_u32 m0, s45, 110592
  s_add_u32 s60, s63, 229376
  v_mfma_f32_16x16x32_bf16 v[60:63], a[172:175], a[44:47], v[60:63]
  ds_read_b64_tr_b16 a[162:163], v2 offset:10240
  v_mfma_f32_16x16x32_bf16 v[60:63], a[168:171], a[60:63], v[60:63]
  buffer_load_dwordx4 v11, s[32:35], s60 offen lds
  v_mfma_f32_16x16x32_bf16 v[56:59], a[168:171], a[56:59], v[56:59]
  ds_read_b64_tr_b16 a[164:165], v2 offset:12288
  v_mfma_f32_16x16x32_bf16 v[56:59], a[172:175], a[40:43], v[56:59]
  s_add_u32 m0, s45, 32768
  v_mfma_f32_16x16x32_bf16 v[52:55], a[172:175], a[36:39], v[52:55]
  ds_read_b64_tr_b16 a[166:167], v2 offset:14336
  v_mfma_f32_16x16x32_bf16 v[52:55], a[168:171], a[52:55], v[52:55]
  buffer_load_dwordx4 v10, s[28:31], s63 offen lds
  v_mfma_f32_16x16x32_bf16 v[48:51], a[168:171], a[48:51], v[48:51]
  ds_read_b64_tr_b16 a[168:169], v3 offset:0
  v_mfma_f32_16x16x32_bf16 v[48:51], a[172:175], a[32:35], v[48:51]
  s_waitcnt lgkmcnt(5)
  v_mfma_f32_16x16x32_bf16 v[128:131], a[180:183], a[32:35], v[128:131]
  ds_read_b64_tr_b16 a[170:171], v3 offset:2048
  v_mfma_f32_16x16x32_bf16 v[128:131], a[176:179], a[48:51], v[128:131]
  s_add_u32 m0, s45, 40960
  v_mfma_f32_16x16x32_bf16 v[132:135], a[176:179], a[52:55], v[132:135]
  ds_read_b64_tr_b16 a[172:173], v3 offset:4096
  v_mfma_f32_16x16x32_bf16 v[132:135], a[180:183], a[36:39], v[132:135]
  buffer_load_dwordx4 v10, s[32:35], s63 offen lds
  v_mfma_f32_16x16x32_bf16 v[136:139], a[180:183], a[40:43], v[136:139]
  ds_read_b64_tr_b16 a[174:175], v3 offset:6144
  v_mfma_f32_16x16x32_bf16 v[136:139], a[176:179], a[56:59], v[136:139]
  s_lshl_b32 s82, s44, 28
  buffer_load_dword v9, v13, s[8:11], s82 offen sc1
  v_mfma_f32_16x16x32_bf16 v[140:143], a[176:179], a[60:63], v[140:143]
  ds_read_b64_tr_b16 a[176:177], v3 offset:8192
  s_add_u32 m0, s45, 36864
  s_add_u32 s60, s63, 229376
  v_mfma_f32_16x16x32_bf16 v[140:143], a[180:183], a[44:47], v[140:143]
  s_waitcnt lgkmcnt(5)
  buffer_load_dwordx4 v10, s[28:31], s60 offen lds
  v_mfma_f32_16x16x32_bf16 v[156:159], a[160:163], a[44:47], v[156:159]
  ds_read_b64_tr_b16 a[178:179], v3 offset:10240
  v_mfma_f32_16x16x32_bf16 v[156:159], a[164:167], a[60:63], v[156:159]
  v_mfma_f32_16x16x32_bf16 v[152:155], a[164:167], a[56:59], v[152:155]
  ds_read_b64_tr_b16 a[180:181], v3 offset:12288
  v_mfma_f32_16x16x32_bf16 v[152:155], a[160:163], a[40:43], v[152:155]
  s_add_u32 m0, s45, 45056
  s_add_u32 s60, s63, 229376
  v_mfma_f32_16x16x32_bf16 v[148:151], a[160:163], a[36:39], v[148:151]
  ds_read_b64_tr_b16 a[182:183], v3 offset:14336
  v_mfma_f32_16x16x32_bf16 v[148:151], a[164:167], a[52:55], v[148:151]
  buffer_load_dwordx4 v10, s[32:35], s60 offen lds
  v_mfma_f32_16x16x32_bf16 v[144:147], a[164:167], a[48:51], v[144:147]
  ds_read_b64_tr_b16 a[164:165], v4 offset:0
  v_mfma_f32_16x16x32_bf16 v[144:147], a[160:163], a[32:35], v[144:147]
  s_waitcnt lgkmcnt(5)
  v_mfma_f32_16x16x32_bf16 v[160:163], a[168:171], a[32:35], v[160:163]
  ds_read_b64_tr_b16 a[166:167], v4 offset:2048
  v_mfma_f32_16x16x32_bf16 v[160:163], a[172:175], a[48:51], v[160:163]
  buffer_load_dwordx4 a[96:99], v1, s[8:11], s71 offen offset:0 sc1
  v_mfma_f32_16x16x32_bf16 v[164:167], a[172:175], a[52:55], v[164:167]
  ds_read_b64_tr_b16 a[160:161], v4 offset:4096
  v_mfma_f32_16x16x32_bf16 v[164:167], a[168:171], a[36:39], v[164:167]
  v_mfma_f32_16x16x32_bf16 v[168:171], a[168:171], a[40:43], v[168:171]
  ds_read_b64_tr_b16 a[162:163], v4 offset:6144
  v_mfma_f32_16x16x32_bf16 v[168:171], a[172:175], a[56:59], v[168:171]
  v_mfma_f32_16x16x32_bf16 v[172:175], a[172:175], a[60:63], v[172:175]
  ds_read_b64_tr_b16 a[172:173], v4 offset:8192
  v_mfma_f32_16x16x32_bf16 v[172:175], a[168:171], a[44:47], v[172:175]
  s_waitcnt lgkmcnt(5)
  buffer_load_dwordx4 a[112:115], v1, s[8:11], s71 offen offset:1024 sc1
  v_mfma_f32_16x16x32_bf16 v[188:191], a[176:179], a[44:47], v[188:191]
  ds_read_b64_tr_b16 a[174:175], v4 offset:10240
  v_mfma_f32_16x16x32_bf16 v[188:191], a[180:183], a[60:63], v[188:191]
  s_add_u32 s71, s71, 65536
  v_mfma_f32_16x16x32_bf16 v[184:187], a[180:183], a[56:59], v[184:187]
  ds_read_b64_tr_b16 a[168:169], v4 offset:12288
  v_mfma_f32_16x16x32_bf16 v[184:187], a[176:179], a[40:43], v[184:187]
  buffer_load_dwordx4 a[100:103], v1, s[8:11], s71 offen offset:0 sc1
  v_mfma_f32_16x16x32_bf16 v[180:183], a[176:179], a[36:39], v[180:183]
  ds_read_b64_tr_b16 a[170:171], v4 offset:14336
  v_mfma_f32_16x16x32_bf16 v[180:183], a[180:183], a[52:55], v[180:183]
  v_mfma_f32_16x16x32_bf16 v[176:179], a[180:183], a[48:51], v[176:179]
  ds_read_b64_tr_b16 a[180:181], v5 offset:0
  v_mfma_f32_16x16x32_bf16 v[176:179], a[176:179], a[32:35], v[176:179]
  s_waitcnt lgkmcnt(5)
  v_mfma_f32_16x16x32_bf16 v[192:195], a[164:167], a[32:35], v[192:195]
  ds_read_b64_tr_b16 a[182:183], v5 offset:2048
  v_mfma_f32_16x16x32_bf16 v[192:195], a[160:163], a[48:51], v[192:195]
  buffer_load_dwordx4 a[116:119], v1, s[8:11], s71 offen offset:1024 sc1
  v_mfma_f32_16x16x32_bf16 v[196:199], a[160:163], a[52:55], v[196:199]
  ds_read_b64_tr_b16 a[176:177], v5 offset:4096
  v_mfma_f32_16x16x32_bf16 v[196:199], a[164:167], a[36:39], v[196:199]
  s_add_u32 s71, s71, 65536
  v_mfma_f32_16x16x32_bf16 v[200:203], a[164:167], a[40:43], v[200:203]
  ds_read_b64_tr_b16 a[178:179], v5 offset:6144
  v_mfma_f32_16x16x32_bf16 v[200:203], a[160:163], a[56:59], v[200:203]
  buffer_load_dwordx4 a[104:107], v1, s[8:11], s71 offen offset:0 sc1
  v_mfma_f32_16x16x32_bf16 v[204:207], a[160:163], a[60:63], v[204:207]
  ds_read_b64_tr_b16 a[160:161], v5 offset:8192
  v_mfma_f32_16x16x32_bf16 v[204:207], a[164:167], a[44:47], v[204:207]
  s_waitcnt lgkmcnt(5)
  v_mfma_f32_16x16x32_bf16 v[220:223], a[172:175], a[44:47], v[220:223]
  ds_read_b64_tr_b16 a[162:163], v5 offset:10240
  v_mfma_f32_16x16x32_bf16 v[220:223], a[168:171], a[60:63], v[220:223]
  v_mfma_f32_16x16x32_bf16 v[216:219], a[168:171], a[56:59], v[216:219]
  ds_read_b64_tr_b16 a[164:165], v5 offset:12288
  v_mfma_f32_16x16x32_bf16 v[216:219], a[172:175], a[40:43], v[216:219]
  buffer_load_dwordx4 a[120:123], v1, s[8:11], s71 offen offset:1024 sc1
  v_mfma_f32_16x16x32_bf16 v[212:215], a[172:175], a[36:39], v[212:215]
  ds_read_b64_tr_b16 a[166:167], v5 offset:14336
  v_mfma_f32_16x16x32_bf16 v[212:215], a[168:171], a[52:55], v[212:215]
  s_waitcnt vmcnt(8)
  s_cmp_lg_u32 s44, 0
  s_cbranch_scc1 PL11_adaLN_cond__sliding_local_dilated__swiglu_ffn__prompt_kernelx
  v_cmp_ne_u32 vcc, s46, v9
  s_nop 4
  s_cbranch_vccz PL11_adaLN_cond__sliding_local_dilated__swiglu_ffn__prompt_kernelx
  s_mov_b32 s82, 60000
PL11_adaLN_cond__sliding_local_dilated__swiglu_ffn__prompt_kernel:
  buffer_load_dword v9, v13, s[8:11], 0 offen sc1
  s_sub_u32 s82, s82, 1
  s_cmp_eq_u32 s82, 0
  s_waitcnt vmcnt(0)
  s_cbranch_scc1 PL11_adaLN_cond__sliding_local_dilated__swiglu_ffn__prompt_kernelx
  v_cmp_ne_u32 vcc, s46, v9
  s_nop 4
  s_cbranch_vccnz PL11_adaLN_cond__sliding_local_dilated__swiglu_ffn__prompt_kernel
PL11_adaLN_cond__sliding_local_dilated__swiglu_ffn__prompt_kernelx:
  s_barrier
  s_waitcnt vmcnt(23)
  s_barrier
  v_mfma_f32_16x16x32_bf16 v[208:211], a[168:171], a[48:51], v[208:211]
  ds_read_b64_tr_b16 a[168:169], v6 offset:0
  s_mov_b32 s61, 0
  v_mfma_f32_16x16x32_bf16 v[208:211], a[172:175], a[32:35], v[208:211]
  s_waitcnt lgkmcnt(5)
  buffer_load_dwordx4 a[220:223], v14, s[8:11], s61 offen sc1
  v_mfma_f32_16x16x32_bf16 v[224:227], a[180:183], a[32:35], v[224:227]
  ds_read_b64_tr_b16 a[170:171], v6 offset:2048
  v_mfma_f32_16x16x32_bf16 v[224:227], a[176:179], a[48:51], v[224:227]
  s_mov_b32 s61, 114688
  v_mfma_f32_16x16x32_bf16 v[228:231], a[176:179], a[52:55], v[228:231]
  ds_read_b64_tr_b16 a[172:173], v6 offset:4096
  buffer_load_dwordx4 a[224:227], v14, s[8:11], s61 offen sc1
  v_mfma_f32_16x16x32_bf16 v[228:231], a[180:183], a[36:39], v[228:231]
  s_mov_b32 s61, 229376
  v_mfma_f32_16x16x32_bf16 v[232:235], a[180:183], a[40:43], v[232:235]
  ds_read_b64_tr_b16 a[174:175], v6 offset:6144
  buffer_load_dwordx4 a[228:231], v14, s[8:11], s61 offen sc1
  v_mfma_f32_16x16x32_bf16 v[232:235], a[176:179], a[56:59], v[232:235]
  s_mov_b32 s61, 344064
  v_mfma_f32_16x16x32_bf16 v[236:239], a[176:179], a[60:63], v[236:239]
  ds_read_b64_tr_b16 a[176:177], v6 offset:8192
  v_mfma_f32_16x16x32_bf16 v[236:239], a[180:183], a[44:47], v[236:239]
  s_waitcnt lgkmcnt(5)
  buffer_load_dwordx4 a[232:235], v14, s[8:11], s61 offen sc1
  v_mfma_f32_16x16x32_bf16 v[252:255], a[160:163], a[44:47], v[252:255]
  ds_read_b64_tr_b16 a[178:179], v6 offset:10240
  s_mov_b32 s61, 458752
  v_mfma_f32_16x16x32_bf16 v[252:255], a[164:167], a[60:63], v[252:255]
  buffer_load_dwordx4 a[236:239], v14, s[8:11], s61 offen sc1
  v_mfma_f32_16x16x32_bf16 v[248:251], a[164:167], a[56:59], v[248:251]
  ds_read_b64_tr_b16 a[180:181], v6 offset:12288
  v_mfma_f32_16x16x32_bf16 v[248:251], a[160:163], a[40:43], v[248:251]
  s_mov_b32 s61, 573440
  v_mfma_f32_16x16x32_bf16 v[244:247], a[160:163], a[36:39], v[244:247]
  ds_read_b64_tr_b16 a[182:183], v6 offset:14336
  buffer_load_dwordx4 a[240:243], v14, s[8:11], s61 offen sc1
  v_mfma_f32_16x16x32_bf16 v[244:247], a[164:167], a[52:55], v[244:247]
  s_mov_b32 s61, 688128
  v_mfma_f32_16x16x32_bf16 v[240:243], a[164:167], a[48:51], v[240:243]
  ds_read_b64_tr_b16 a[164:165], v7 offset:0
  buffer_load_dwordx4 a[244:247], v14, s[8:11], s61 offen sc1
  v_mfma_f32_16x16x32_bf16 v[240:243], a[160:163], a[32:35], v[240:243]
  s_waitcnt vmcnt(22) lgkmcnt(5)
  s_mov_b32 s61, 802816
  v_mfma_f32_16x16x32_bf16 v[64:67], a[168:171], a[64:67], v[64:67]
  ds_read_b64_tr_b16 a[166:167], v7 offset:2048
  v_mfma_f32_16x16x32_bf16 v[64:67], a[172:175], a[80:83], v[64:67]
  buffer_load_dwordx4 a[248:251], v14, s[8:11], s61 offen sc1
  s_add_u32 s71, s71, 65536
  v_mfma_f32_16x16x32_bf16 v[68:71], a[172:175], a[84:87], v[68:71]
  ds_read_b64_tr_b16 a[160:161], v7 offset:4096
  v_mfma_f32_16x16x32_bf16 v[68:71], a[168:171], a[68:71], v[68:71]
  buffer_load_dwordx4 a[108:111], v1, s[8:11], s71 offen offset:0 sc1
  v_mfma_f32_16x16x32_bf16 v[72:75], a[168:171], a[72:75], v[72:75]
  ds_read_b64_tr_b16 a[162:163], v7 offset:6144
  v_mfma_f32_16x16x32_bf16 v[72:75], a[172:175], a[88:91], v[72:75]
  v_mfma_f32_16x16x32_bf16 v[76:79], a[172:175], a[92:95], v[76:79]
  ds_read_b64_tr_b16 a[172:173], v7 offset:8192
  v_mfma_f32_16x16x32_bf16 v[76:79], a[168:171], a[76:79], v[76:79]
  s_waitcnt lgkmcnt(5)
  v_mfma_f32_16x16x32_bf16 v[92:95], a[176:179], a[76:79], v[92:95]
  ds_read_b64_tr_b16 a[174:175], v7 offset:10240
  v_mfma_f32_16x16x32_bf16 v[92:95], a[180:183], a[92:95], v[92:95]
  buffer_load_dwordx4 a[124:127], v1, s[8:11], s71 offen offset:1024 sc1
  v_mfma_f32_16x16x32_bf16 v[88:91], a[180:183], a[88:91], v[88:91]
  ds_read_b64_tr_b16 a[168:169], v7 offset:12288
  v_mfma_f32_16x16x32_bf16 v[88:91], a[176:179], a[72:75], v[88:91]
  s_mov_b32 s64, 4128768
  s_add_u32 s72, s24, 18432
  s_add_u32 m0, s45, 114688
  v_mfma_f32_16x16x32_bf16 v[84:87], a[176:179], a[68:71], v[84:87]
  ds_read_b64_tr_b16 a[170:171], v7 offset:14336
  v_mfma_f32_16x16x32_bf16 v[84:87], a[180:183], a[84:87], v[84:87]
  buffer_load_dwordx4 v11, s[28:31], s64 offen lds
  v_mfma_f32_16x16x32_bf16 v[80:83], a[180:183], a[80:83], v[80:83]
  ds_read_b64_tr_b16 a[180:181], v8 offset:0
  v_mfma_f32_16x16x32_bf16 v[80:83], a[176:179], a[64:67], v[80:83]
  s_waitcnt lgkmcnt(5)
  v_mfma_f32_16x16x32_bf16 v[96:99], a[164:167], a[64:67], v[96:99]
  ds_read_b64_tr_b16 a[182:183], v8 offset:2048
  v_mfma_f32_16x16x32_bf16 v[96:99], a[160:163], a[80:83], v[96:99]
  s_add_u32 m0, s45, 122880
  v_mfma_f32_16x16x32_bf16 v[100:103], a[160:163], a[84:87], v[100:103]
  ds_read_b64_tr_b16 a[176:177], v8 offset:4096
  v_mfma_f32_16x16x32_bf16 v[100:103], a[164:167], a[68:71], v[100:103]
  buffer_load_dwordx4 v11, s[32:35], s64 offen lds
  v_mfma_f32_16x16x32_bf16 v[104:107], a[164:167], a[72:75], v[104:107]
  ds_read_b64_tr_b16 a[178:179], v8 offset:6144
  v_mfma_f32_16x16x32_bf16 v[104:107], a[160:163], a[88:91], v[104:107]
  s_add_u32 m0, s45, 118784
  s_add_u32 s60, s64, 229376
  v_mfma_f32_16x16x32_bf16 v[108:111], a[160:163], a[92:95], v[108:111]
  ds_read_b64_tr_b16 a[160:161], v8 offset:8192
  v_mfma_f32_16x16x32_bf16 v[108:111], a[164:167], a[76:79], v[108:111]
  s_waitcnt lgkmcnt(5)
  buffer_load_dwordx4 v11, s[28:31], s60 offen lds
  v_mfma_f32_16x16x32_bf16 v[124:127], a[172:175], a[76:79], v[124:127]
  ds_read_b64_tr_b16 a[162:163], v8 offset:10240
  v_mfma_f32_16x16x32_bf16 v[124:127], a[168:171], a[92:95], v[124:127]
  v_mfma_f32_16x16x32_bf16 v[120:123], a[168:171], a[88:91], v[120:123]
  ds_read_b64_tr_b16 a[164:165], v8 offset:12288
  v_mfma_f32_16x16x32_bf16 v[120:123], a[172:175], a[72:75], v[120:123]
  s_add_u32 m0, s45, 126976
  s_add_u32 s60, s64, 229376
  v_mfma_f32_16x16x32_bf16 v[116:119], a[172:175], a[68:71], v[116:119]
  ds_read_b64_tr_b16 a[166:167], v8 offset:14336
  v_mfma_f32_16x16x32_bf16 v[116:119], a[168:171], a[84:87], v[116:119]
  buffer_load_dwordx4 v11, s[32:35], s60 offen lds
  v_mfma_f32_16x16x32_bf16 v[112:115], a[168:171], a[80:83], v[112:115]
  ds_read_b64_tr_b16 a[168:169], v2 offset:16384
  v_mfma_f32_16x16x32_bf16 v[112:115], a[172:175], a[64:67], v[112:115]
  s_waitcnt lgkmcnt(5)
  s_add_u32 m0, s45, 49152
  v_mfma_f32_16x16x32_bf16 v[32:35], a[180:183], a[64:67], v[32:35]
  ds_read_b64_tr_b16 a[170:171], v2 offset:18432
  v_mfma_f32_16x16x32_bf16 v[32:35], a[176:179], a[80:83], v[32:35]
  buffer_load_dwordx4 v10, s[28:31], s64 offen lds
  v_mfma_f32_16x16x32_bf16 v[36:39], a[176:179], a[84:87], v[36:39]
  ds_read_b64_tr_b16 a[172:173], v2 offset:20480
  v_mfma_f32_16x16x32_bf16 v[36:39], a[180:183], a[68:71], v[36:39]
  v_mfma_f32_16x16x32_bf16 v[40:43], a[180:183], a[72:75], v[40:43]
  ds_read_b64_tr_b16 a[174:175], v2 offset:22528
  v_mfma_f32_16x16x32_bf16 v[40:43], a[176:179], a[88:91], v[40:43]
  s_add_u32 m0, s45, 57344
  v_mfma_f32_16x16x32_bf16 v[44:47], a[176:179], a[92:95], v[44:47]
  ds_read_b64_tr_b16 a[176:177], v2 offset:24576
  v_mfma_f32_16x16x32_bf16 v[44:47], a[180:183], a[76:79], v[44:47]
  s_waitcnt lgkmcnt(5)
  buffer_load_dwordx4 v10, s[32:35], s64 offen lds
  v_mfma_f32_16x16x32_bf16 v[60:63], a[160:163], a[76:79], v[60:63]
  ds_read_b64_tr_b16 a[178:179], v2 offset:26624
  v_mfma_f32_16x16x32_bf16 v[60:63], a[164:167], a[92:95], v[60:63]
  s_add_u32 m0, s45, 53248
  s_add_u32 s60, s64, 229376
  v_mfma_f32_16x16x32_bf16 v[56:59], a[164:167], a[88:91], v[56:59]
  ds_read_b64_tr_b16 a[180:181], v2 offset:28672
  v_mfma_f32_16x16x32_bf16 v[56:59], a[160:163], a[72:75], v[56:59]
  buffer_load_dwordx4 v10, s[28:31], s60 offen lds
  v_mfma_f32_16x16x32_bf16 v[52:55], a[160:163], a[68:71], v[52:55]
  ds_read_b64_tr_b16 a[182:183], v2 offset:30720
  v_mfma_f32_16x16x32_bf16 v[52:55], a[164:167], a[84:87], v[52:55]
  v_mfma_f32_16x16x32_bf16 v[48:51], a[164:167], a[80:83], v[48:51]
  ds_read_b64_tr_b16 a[164:165], v3 offset:16384
  s_waitcnt vmcnt(9)
  v_mfma_f32_16x16x32_bf16 v[48:51], a[160:163], a[64:67], v[48:51]
  s_waitcnt lgkmcnt(5)
  s_add_u32 m0, s45, 61440
  s_add_u32 s60, s64, 229376
  v_accvgpr_read_b32 v24, a220
  v_mfma_f32_16x16x32_bf16 v[128:131], a[168:171], a[64:67], v[128:131]
  ds_read_b64_tr_b16 a[166:167], v3 offset:18432
  v_accvgpr_read_b32 v25, a221
  v_mfma_f32_16x16x32_bf16 v[128:131], a[172:175], a[80:83], v[128:131]
  buffer_load_dwordx4 v10, s[32:35], s60 offen lds
  v_accvgpr_read_b32 v26, a222
  v_accvgpr_read_b32 v27, a223
  v_mfma_f32_16x16x32_bf16 v[132:135], a[172:175], a[84:87], v[132:135]
  ds_read_b64_tr_b16 a[160:161], v3 offset:20480
  v_accvgpr_read_b32 v28, a224
  v_mfma_f32_16x16x32_bf16 v[132:135], a[168:171], a[68:71], v[132:135]
  v_accvgpr_read_b32 v29, a225
  v_accvgpr_read_b32 v30, a226
  v_accvgpr_read_b32 v31, a227
  v_mfma_f32_16x16x32_bf16 v[136:139], a[168:171], a[72:75], v[136:139]
  ds_read_b64_tr_b16 a[162:163], v3 offset:22528
  v_add_f32 v24, v24, v28
  v_mfma_f32_16x16x32_bf16 v[136:139], a[172:175], a[88:91], v[136:139]
  buffer_load_dwordx4 a[128:131], v1, s[8:11], s72 offen offset:0 sc1
  v_add_f32 v25, v25, v29
  v_add_f32 v26, v26, v30
  v_mfma_f32_16x16x32_bf16 v[140:143], a[172:175], a[92:95], v[140:143]
  ds_read_b64_tr_b16 a[172:173], v3 offset:24576
  v_add_f32 v27, v27, v31
  v_mfma_f32_16x16x32_bf16 v[140:143], a[168:171], a[76:79], v[140:143]
  s_waitcnt lgkmcnt(5)
  v_accvgpr_read_b32 v28, a228
  v_accvgpr_read_b32 v29, a229
  v_accvgpr_read_b32 v30, a230
  v_mfma_f32_16x16x32_bf16 v[156:159], a[176:179], a[76:79], v[156:159]
  ds_read_b64_tr_b16 a[174:175], v3 offset:26624
  v_accvgpr_read_b32 v31, a231
  v_mfma_f32_16x16x32_bf16 v[156:159], a[180:183], a[92:95], v[156:159]
  v_add_f32 v24, v24, v28
  v_add_f32 v25, v25, v29
  v_mfma_f32_16x16x32_bf16 v[152:155], a[180:183], a[88:91], v[152:155]
  ds_read_b64_tr_b16 a[168:169], v3 offset:28672
  v_add_f32 v26, v26, v30
  v_mfma_f32_16x16x32_bf16 v[152:155], a[176:179], a[72:75], v[152:155]
  buffer_load_dwordx4 a[144:147], v1, s[8:11], s72 offen offset:1024 sc1
  v_add_f32 v27, v27, v31
  v_accvgpr_read_b32 v28, a232
  v_accvgpr_read_b32 v29, a233
  v_mfma_f32_16x16x32_bf16 v[148:151], a[176:179], a[68:71], v[148:151]
  ds_read_b64_tr_b16 a[170:171], v3 offset:30720
  v_accvgpr_read_b32 v30, a234
  v_mfma_f32_16x16x32_bf16 v[148:151], a[180:183], a[84:87], v[148:151]
  s_add_u32 s72, s72, 65536
  v_accvgpr_read_b32 v31, a235
  v_add_f32 v24, v24, v28
  v_mfma_f32_16x16x32_bf16 v[144:147], a[180:183], a[80:83], v[144:147]
  ds_read_b64_tr_b16 a[180:181], v4 offset:16384
  v_add_f32 v25, v25, v29
  v_mfma_f32_16x16x32_bf16 v[144:147], a[176:179], a[64:67], v[144:147]
  s_waitcnt lgkmcnt(5)
  buffer_load_dwordx4 a[132:135], v1, s[8:11], s72 offen offset:0 sc1
  v_add_f32 v26, v26, v30
  v_add_f32 v27, v27, v31
  v_mfma_f32_16x16x32_bf16 v[160:163], a[164:167], a[64:67], v[160:163]
  ds_read_b64_tr_b16 a[182:183], v4 offset:18432
  v_accvgpr_read_b32 v28, a236
  v_mfma_f32_16x16x32_bf16 v[160:163], a[160:163], a[80:83], v[160:163]
  v_accvgpr_read_b32 v29, a237
  v_accvgpr_read_b32 v30, a238
  v_mfma_f32_16x16x32_bf16 v[164:167], a[160:163], a[84:87], v[164:167]
  ds_read_b64_tr_b16 a[176:177], v4 offset:20480
  v_accvgpr_read_b32 v31, a239
  v_mfma_f32_16x16x32_bf16 v[164:167], a[164:167], a[68:71], v[164:167]
  v_add_f32 v24, v24, v28
  v_add_f32 v25, v25, v29
  v_add_f32 v26, v26, v30
  v_mfma_f32_16x16x32_bf16 v[168:171], a[164:167], a[72:75], v[168:171]
  ds_read_b64_tr_b16 a[178:179], v4 offset:22528
  v_add_f32 v27, v27, v31
  v_mfma_f32_16x16x32_bf16 v[168:171], a[160:163], a[88:91], v[168:171]
  buffer_load_dwordx4 a[148:151], v1, s[8:11], s72 offen offset:1024 sc1
  v_accvgpr_read_b32 v28, a240
  v_accvgpr_read_b32 v29, a241
  v_mfma_f32_16x16x32_bf16 v[172:175], a[160:163], a[92:95], v[172:175]
  ds_read_b64_tr_b16 a[160:161], v4 offset:24576
  v_accvgpr_read_b32 v30, a242
  v_mfma_f32_16x16x32_bf16 v[172:175], a[164:167], a[76:79], v[172:175]
  s_waitcnt lgkmcnt(5)
  s_add_u32 s72, s72, 65536
  v_accvgpr_read_b32 v31, a243
  v_add_f32 v24, v24, v28
  v_mfma_f32_16x16x32_bf16 v[188:191], a[172:175], a[76:79], v[188:191]
  ds_read_b64_tr_b16 a[162:163], v4 offset:26624
  v_add_f32 v25, v25, v29
  v_mfma_f32_16x16x32_bf16 v[188:191], a[168:171], a[92:95], v[188:191]
  buffer_load_dwordx4 a[136:139], v1, s[8:11], s72 offen offset:0 sc1
  v_add_f32 v26, v26, v30
  v_add_f32 v27, v27, v31
  v_mfma_f32_16x16x32_bf16 v[184:187], a[168:171], a[88:91], v[184:187]
  ds_read_b64_tr_b16 a[164:165], v4 offset:28672
  v_accvgpr_read_b32 v28, a244
  v_mfma_f32_16x16x32_bf16 v[184:187], a[172:175], a[72:75], v[184:187]
  v_accvgpr_read_b32 v29, a245
  v_accvgpr_read_b32 v30, a246
  v_accvgpr_read_b32 v31, a247
  v_mfma_f32_16x16x32_bf16 v[180:183], a[172:175], a[68:71], v[180:183]
  ds_read_b64_tr_b16 a[166:167], v4 offset:30720
  v_add_f32 v24, v24, v28
  v_mfma_f32_16x16x32_bf16 v[180:183], a[168:171], a[84:87], v[180:183]
  v_add_f32 v25, v25, v29
  v_add_f32 v26, v26, v30
  v_mfma_f32_16x16x32_bf16 v[176:179], a[168:171], a[80:83], v[176:179]
  ds_read_b64_tr_b16 a[168:169], v5 offset:16384
  v_add_f32 v27, v27, v31
  v_mfma_f32_16x16x32_bf16 v[176:179], a[172:175], a[64:67], v[176:179]
  s_waitcnt lgkmcnt(5)
  buffer_load_dwordx4 a[152:155], v1, s[8:11], s72 offen offset:1024 sc1
  v_accvgpr_read_b32 v28, a248
  v_accvgpr_read_b32 v29, a249
  v_mfma_f32_16x16x32_bf16 v[192:195], a[180:183], a[64:67], v[192:195]
  ds_read_b64_tr_b16 a[170:171], v5 offset:18432
  v_accvgpr_read_b32 v30, a250
  v_mfma_f32_16x16x32_bf16 v[192:195], a[176:179], a[80:83], v[192:195]
  s_add_u32 s72, s72, 65536
  v_accvgpr_read_b32 v31, a251
  v_add_f32 v24, v24, v28
  v_mfma_f32_16x16x32_bf16 v[196:199], a[176:179], a[84:87], v[196:199]
  ds_read_b64_tr_b16 a[172:173], v5 offset:20480
  v_add_f32 v25, v25, v29
  v_mfma_f32_16x16x32_bf16 v[196:199], a[180:183], a[68:71], v[196:199]
  buffer_load_dwordx4 a[140:143], v1, s[8:11], s72 offen offset:0 sc1
  v_add_f32 v26, v26, v30
  v_add_f32 v27, v27, v31
  v_mov_b32 v28, v24
  v_mfma_f32_16x16x32_bf16 v[200:203], a[180:183], a[72:75], v[200:203]
  ds_read_b64_tr_b16 a[174:175], v5 offset:22528
  v_mov_b32 v29, v25
  v_mfma_f32_16x16x32_bf16 v[200:203], a[176:179], a[88:91], v[200:203]
  v_mov_b32 v30, v26
  v_mov_b32 v31, v27
  v_mfma_f32_16x16x32_bf16 v[204:207], a[176:179], a[92:95], v[204:207]
  ds_read_b64_tr_b16 a[176:177], v5 offset:24576
  v_mfma_f32_16x16x32_bf16 v[204:207], a[180:183], a[76:79], v[204:207]
  s_waitcnt lgkmcnt(5)
  v_permlane32_swap_b32 v24, v28
  v_mfma_f32_16x16x32_bf16 v[220:223], a[160:163], a[76:79], v[220:223]
  ds_read_b64_tr_b16 a[178:179], v5 offset:26624
  v_mfma_f32_16x16x32_bf16 v[220:223], a[164:167], a[92:95], v[220:223]
  buffer_load_dwordx4 a[156:159], v1, s[8:11], s72 offen offset:1024 sc1
  v_permlane32_swap_b32 v25, v29
  v_mfma_f32_16x16x32_bf16 v[216:219], a[164:167], a[88:91], v[216:219]
  ds_read_b64_tr_b16 a[180:181], v5 offset:28672
  v_mfma_f32_16x16x32_bf16 v[216:219], a[160:163], a[72:75], v[216:219]
  s_mov_b32 s65, 4587520
  s_add_u32 s73, s24, 20480
  s_add_u32 m0, s45, 81920
  v_permlane32_swap_b32 v26, v30
  v_mfma_f32_16x16x32_bf16 v[212:215], a[160:163], a[68:71], v[212:215]
  ds_read_b64_tr_b16 a[182:183], v5 offset:30720
  v_mfma_f32_16x16x32_bf16 v[212:215], a[164:167], a[84:87], v[212:215]
  buffer_load_dwordx4 v11, s[28:31], s65 offen lds
  s_waitcnt vmcnt(38)
  s_barrier
  v_mfma_f32_16x16x32_bf16 v[208:211], a[164:167], a[80:83], v[208:211]
  ds_read_b64_tr_b16 a[164:165], v6 offset:32768
  v_mfma_f32_16x16x32_bf16 v[208:211], a[160:163], a[64:67], v[208:211]
  s_waitcnt lgkmcnt(5)
  v_permlane32_swap_b32 v27, v31
  v_add_f32 v24, v24, v28
  v_mfma_f32_16x16x32_bf16 v[224:227], a[168:171], a[64:67], v[224:227]
  ds_read_b64_tr_b16 a[166:167], v6 offset:34816
  v_add_f32 v25, v25, v29
  v_mfma_f32_16x16x32_bf16 v[224:227], a[172:175], a[80:83], v[224:227]
  s_add_u32 m0, s45, 90112
  v_add_f32 v26, v26, v30
  v_add_f32 v27, v27, v31
  v_mfma_f32_16x16x32_bf16 v[228:231], a[172:175], a[84:87], v[228:231]
  ds_read_b64_tr_b16 a[160:161], v6 offset:36864
  v_mfma_f32_16x16x32_bf16 v[228:231], a[168:171], a[68:71], v[228:231]
  buffer_load_dwordx4 v11, s[32:35], s65 offen lds
  s_cmp_eq_u32 s44, 1
  s_cselect_b32 s55, 0xbfb8aa3b, 1.0
  v_mul_f32 v24, s55, v24
  v_mfma_f32_16x16x32_bf16 v[232:235], a[168:171], a[72:75], v[232:235]
  ds_read_b64_tr_b16 a[162:163], v6 offset:38912
  v_xor_b32 v9, 96, v6
  v_mfma_f32_16x16x32_bf16 v[232:235], a[172:175], a[88:91], v[232:235]
  s_add_u32 m0, s45, 86016
  s_add_u32 s60, s65, 229376
  v_mul_f32 v25, s55, v25
  v_mfma_f32_16x16x32_bf16 v[236:239], a[172:175], a[92:95], v[236:239]
  ds_read_b64_tr_b16 a[172:173], v6 offset:40960
  v_mul_f32 v26, s55, v26
  v_mfma_f32_16x16x32_bf16 v[236:239], a[168:171], a[76:79], v[236:239]
  s_waitcnt lgkmcnt(5)
  buffer_load_dwordx4 v11, s[28:31], s60 offen lds
  v_mul_f32 v27, s55, v27
  v_mfma_f32_16x16x32_bf16 v[252:255], a[176:179], a[76:79], v[252:255]
  ds_read_b64_tr_b16 a[174:175], v6 offset:43008
  v_mfma_f32_16x16x32_bf16 v[252:255], a[180:183], a[92:95], v[252:255]
  ds_write_b128 v15, v[24:27]
  v_mfma_f32_16x16x32_bf16 v[248:251], a[180:183], a[88:91], v[248:251]
  ds_read_b64_tr_b16 a[168:169], v6 offset:45056
  v_mfma_f32_16x16x32_bf16 v[248:251], a[176:179], a[72:75], v[248:251]
  s_add_u32 m0, s45, 94208
  s_add_u32 s60, s65, 229376
  v_mfma_f32_16x16x32_bf16 v[244:247], a[176:179], a[68:71], v[244:247]
  ds_read_b64_tr_b16 a[170:171], v6 offset:47104
  buffer_load_dwordx4 v11, s[32:35], s60 offen lds
  s_waitcnt vmcnt(36) lgkmcnt(2)
  s_barrier
  v_mfma_f32_16x16x32_bf16 v[244:247], a[180:183], a[84:87], v[244:247]
  v_lshrrev_b32 v15, 3, v0
  v_and_b32 v13, 7, v0
  v_lshlrev_b32 v13, 7, v13
  v_mfma_f32_16x16x32_bf16 v[240:243], a[180:183], a[80:83], v[240:243]
  ds_read_b64_tr_b16 a[180:181], v7 offset:32768
  v_lshl_add_u32 v13, v15, 18, v13
  v_lshrrev_b32 v14, 2, v15
  v_mfma_f32_16x16x32_bf16 v[240:243], a[176:179], a[64:67], v[240:243]
  s_waitcnt vmcnt(20) lgkmcnt(6)
  v_lshlrev_b32 v14, 17, v14
  v_sub_u32 v14, v13, v14
  v_add_u32 v15, 5, v15
  v_mfma_f32_16x16x32_bf16 v[64:67], a[164:167], a[96:99], v[64:67]
  ds_read_b64_tr_b16 a[182:183], v7 offset:34816
  s_mov_b32 s66, 5046272
  s_add_u32 s74, s24, 22528
  s_add_u32 m0, s45, 65536
  v_lshrrev_b32 v15, 3, v15
  v_add_u32 v15, 1, v15
  v_mfma_f32_16x16x32_bf16 v[64:67], a[160:163], a[112:115], v[64:67]
  buffer_load_dwordx4 v11, s[28:31], s66 offen lds
  v_lshl_add_u32 v13, v15, 17, v13
  v_mfma_f32_16x16x32_bf16 v[68:71], a[160:163], a[116:119], v[68:71]
  ds_read_b64_tr_b16 a[176:177], v7 offset:36864
  ds_read_b128 v[24:27], v12 offset:384
  v_mfma_f32_16x16x32_bf16 v[68:71], a[164:167], a[100:103], v[68:71]
  v_mfma_f32_16x16x32_bf16 v[72:75], a[164:167], a[104:107], v[72:75]
  ds_read_b64_tr_b16 a[178:179], v7 offset:38912
  v_mfma_f32_16x16x32_bf16 v[72:75], a[160:163], a[120:123], v[72:75]
  s_add_u32 m0, s45, 73728
  ds_read_b128 v[28:31], v12 offset:1408
  v_mfma_f32_16x16x32_bf16 v[76:79], a[160:163], a[124:127], v[76:79]
  ds_read_b64_tr_b16 a[160:161], v7 offset:40960
  s_waitcnt lgkmcnt(3)
  v_mfma_f32_16x16x32_bf16 v[76:79], a[164:167], a[108:111], v[76:79]
  s_waitcnt lgkmcnt(7)
  buffer_load_dwordx4 v11, s[32:35], s66 offen lds
  v_fmac_f32 v32, v16, v24
  v_mfma_f32_16x16x32_bf16 v[92:95], a[172:175], a[108:111], v[92:95]
  ds_read_b64_tr_b16 a[162:163], v7 offset:43008
  v_fmac_f32 v33, v16, v25
  v_mfma_f32_16x16x32_bf16 v[92:95], a[168:171], a[124:127], v[92:95]
HOP11:
  s_cbranch_execz WRET0
  s_add_u32 m0, s45, 69632
  s_add_u32 s60, s66, 229376
  v_fmac_f32 v34, v16, v26
  v_mfma_f32_16x16x32_bf16 v[88:91], a[168:171], a[120:123], v[88:91]
  ds_read_b64_tr_b16 a[164:165], v7 offset:45056
  v_fmac_f32 v35, v16, v27
  v_mfma_f32_16x16x32_bf16 v[88:91], a[172:175], a[104:107], v[88:91]
  buffer_load_dwordx4 v11, s[28:31], s60 offen lds
  v_fmac_f32 v36, v18, v24
  v_fmac_f32 v37, v18, v25
  v_mfma_f32_16x16x32_bf16 v[84:87], a[172:175], a[100:103], v[84:87]
  ds_read_b64_tr_b16 a[166:167], v7 offset:47104
  v_fmac_f32 v38, v18, v26
  v_mfma_f32_16x16x32_bf16 v[84:87], a[168:171], a[116:119], v[84:87]
  v_fmac_f32 v39, v18, v27
  v_fmac_f32 v40, v20, v24
  v_mfma_f32_16x16x32_bf16 v[80:83], a[168:171], a[112:115], v[80:83]
  ds_read_b64_tr_b16 a[168:169], v8 offset:32768
  v_fmac_f32 v41, v20, v25
  v_mfma_f32_16x16x32_bf16 v[80:83], a[172:175], a[96:99], v[80:83]
  s_waitcnt lgkmcnt(6)
  s_add_u32 m0, s45, 77824
  s_add_u32 s60, s66, 229376
  v_mfma_f32_16x16x32_bf16 v[96:99], a[180:183], a[96:99], v[96:99]
  ds_read_b64_tr_b16 a[170:171], v8 offset:34816
  v_fmac_f32 v42, v20, v26
  v_mfma_f32_16x16x32_bf16 v[96:99], a[176:179], a[112:115], v[96:99]
  buffer_load_dwordx4 v11, s[32:35], s60 offen lds
  v_fmac_f32 v43, v20, v27
  v_fmac_f32 v44, v22, v24
  v_mfma_f32_16x16x32_bf16 v[100:103], a[176:179], a[116:119], v[100:103]
  ds_read_b64_tr_b16 a[172:173], v8 offset:36864
  v_fmac_f32 v45, v22, v25
  v_mfma_f32_16x16x32_bf16 v[100:103], a[180:183], a[100:103], v[100:103]
  s_add_u32 m0, s45, 0
  v_fmac_f32 v46, v22, v26
  v_fmac_f32 v47, v22, v27
  v_mfma_f32_16x16x32_bf16 v[104:107], a[180:183], a[104:107], v[104:107]
  ds_read_b64_tr_b16 a[174:175], v8 offset:38912
  v_mfma_f32_16x16x32_bf16 v[104:107], a[176:179], a[120:123], v[104:107]
  buffer_load_dwordx4 v10, s[28:31], s65 offen lds
  ds_read_b128 v[24:27], v12 offset:256
  v_mfma_f32_16x16x32_bf16 v[108:111], a[176:179], a[124:127], v[108:111]
  ds_read_b64_tr_b16 a[176:177], v8 offset:40960
  s_waitcnt lgkmcnt(10)
  v_mfma_f32_16x16x32_bf16 v[108:111], a[180:183], a[108:111], v[108:111]
  s_waitcnt lgkmcnt(6)
  v_fmac_f32 v48, v16, v28
  v_fmac_f32 v49, v16, v29
  v_mfma_f32_16x16x32_bf16 v[124:127], a[160:163], a[108:111], v[124:127]
  ds_read_b64_tr_b16 a[178:179], v8 offset:43008
  v_fmac_f32 v50, v16, v30
  v_mfma_f32_16x16x32_bf16 v[124:127], a[164:167], a[124:127], v[124:127]
  s_add_u32 m0, s45, 8192
  v_fmac_f32 v51, v16, v31
  v_fmac_f32 v52, v18, v28
  v_mfma_f32_16x16x32_bf16 v[120:123], a[164:167], a[120:123], v[120:123]
  ds_read_b64_tr_b16 a[180:181], v8 offset:45056
  v_fmac_f32 v53, v18, v29
  v_mfma_f32_16x16x32_bf16 v[120:123], a[160:163], a[104:107], v[120:123]
  buffer_load_dwordx4 v10, s[32:35], s65 offen lds
  v_fmac_f32 v54, v18, v30
  v_fmac_f32 v55, v18, v31
  v_mfma_f32_16x16x32_bf16 v[116:119], a[160:163], a[100:103], v[116:119]
  ds_read_b64_tr_b16 a[182:183], v8 offset:47104
  v_fmac_f32 v56, v20, v28
  v_mfma_f32_16x16x32_bf16 v[116:119], a[164:167], a[116:119], v[116:119]
  s_add_u32 m0, s45, 4096
  s_add_u32 s60, s65, 229376
  v_fmac_f32 v57, v20, v29
  v_mfma_f32_16x16x32_bf16 v[112:115], a[164:167], a[112:115], v[112:115]
  ds_read_b64_tr_b16 a[164:165], v2 offset:32768
  v_fmac_f32 v58, v20, v30
  v_mfma_f32_16x16x32_bf16 v[112:115], a[160:163], a[96:99], v[112:115]
  s_waitcnt lgkmcnt(6)
  buffer_load_dwordx4 v10, s[28:31], s60 offen lds
  v_fmac_f32 v59, v20, v31
  v_mfma_f32_16x16x32_bf16 v[32:35], a[168:171], a[96:99], v[32:35]
  ds_read_b64_tr_b16 a[166:167], v2 offset:34816
  v_fmac_f32 v60, v22, v28
  v_mfma_f32_16x16x32_bf16 v[32:35], a[172:175], a[112:115], v[32:35]
  v_fmac_f32 v61, v22, v29
  v_fmac_f32 v62, v22, v30
  v_mfma_f32_16x16x32_bf16 v[36:39], a[172:175], a[116:119], v[36:39]
  ds_read_b64_tr_b16 a[160:161], v2 offset:36864
  v_fmac_f32 v63, v22, v31
  v_mfma_f32_16x16x32_bf16 v[36:39], a[168:171], a[100:103], v[36:39]
  s_add_u32 m0, s45, 12288
  s_add_u32 s60, s65, 229376
  v_mfma_f32_16x16x32_bf16 v[40:43], a[168:171], a[104:107], v[40:43]
  ds_read_b64_tr_b16 a[162:163], v2 offset:38912
  v_mfma_f32_16x16x32_bf16 v[40:43], a[172:175], a[120:123], v[40:43]
  buffer_load_dwordx4 v10, s[32:35], s60 offen lds
  ds_read_b128 v[28:31], v12 offset:1280
  v_mfma_f32_16x16x32_bf16 v[44:47], a[172:175], a[124:127], v[44:47]
  ds_read_b64_tr_b16 a[172:173], v2 offset:40960
  s_waitcnt lgkmcnt(10)
  v_mfma_f32_16x16x32_bf16 v[44:47], a[168:171], a[108:111], v[44:47]
  s_waitcnt lgkmcnt(6)
  v_fmac_f32 v64, v16, v24
  v_mfma_f32_16x16x32_bf16 v[60:63], a[176:179], a[108:111], v[60:63]
  ds_read_b64_tr_b16 a[174:175], v2 offset:43008
  v_fmac_f32 v65, v16, v25
  v_mfma_f32_16x16x32_bf16 v[60:63], a[180:183], a[124:127], v[60:63]
  buffer_load_dwordx4 a[0:3], v1, s[8:11], s73 offen offset:0 sc1
  v_fmac_f32 v66, v16, v26
  v_fmac_f32 v67, v16, v27
  v_mfma_f32_16x16x32_bf16 v[56:59], a[180:183], a[120:123], v[56:59]
  ds_read_b64_tr_b16 a[168:169], v2 offset:45056
  v_fmac_f32 v68, v18, v24
  v_mfma_f32_16x16x32_bf16 v[56:59], a[176:179], a[104:107], v[56:59]
  v_fmac_f32 v69, v18, v25
  v_fmac_f32 v70, v18, v26
  v_mfma_f32_16x16x32_bf16 v[52:55], a[176:179], a[100:103], v[52:55]
  ds_read_b64_tr_b16 a[170:171], v2 offset:47104
  v_fmac_f32 v71, v18, v27
  v_mfma_f32_16x16x32_bf16 v[52:55], a[180:183], a[116:119], v[52:55]
  v_fmac_f32 v72, v20, v24
  v_fmac_f32 v73, v20, v25
  v_mfma_f32_16x16x32_bf16 v[48:51], a[180:183], a[112:115], v[48:51]
  ds_read_b64_tr_b16 a[180:181], v3 offset:32768
  v_fmac_f32 v74, v20, v26
  v_mfma_f32_16x16x32_bf16 v[48:51], a[176:179], a[96:99], v[48:51]
  s_waitcnt lgkmcnt(6)
  buffer_load_dwordx4 a[16:19], v1, s[8:11], s73 offen offset:1024 sc1
  v_fmac_f32 v75, v20, v27
  v_mfma_f32_16x16x32_bf16 v[128:131], a[164:167], a[96:99], v[128:131]
  ds_read_b64_tr_b16 a[182:183], v3 offset:34816
  v_fmac_f32 v76, v22, v24
  v_mfma_f32_16x16x32_bf16 v[128:131], a[160:163], a[112:115], v[128:131]
  s_add_u32 s73, s73, 65536
  v_fmac_f32 v77, v22, v25
  v_fmac_f32 v78, v22, v26
  v_mfma_f32_16x16x32_bf16 v[132:135], a[160:163], a[116:119], v[132:135]
  ds_read_b64_tr_b16 a[176:177], v3 offset:36864
  v_fmac_f32 v79, v22, v27
  v_mfma_f32_16x16x32_bf16 v[132:135], a[164:167], a[100:103], v[132:135]
  buffer_load_dwordx4 a[4:7], v1, s[8:11], s73 offen offset:0 sc1
  ds_read_b128 v[24:27], v12 offset:1920
  v_mfma_f32_16x16x32_bf16 v[136:139], a[164:167], a[104:107], v[136:139]
  ds_read_b64_tr_b16 a[178:179], v3 offset:38912
  s_waitcnt lgkmcnt(9)
  v_mfma_f32_16x16x32_bf16 v[136:139], a[160:163], a[120:123], v[136:139]
  v_fmac_f32 v80, v16, v28
  v_fmac_f32 v81, v16, v29
  v_mfma_f32_16x16x32_bf16 v[140:143], a[160:163], a[124:127], v[140:143]
  ds_read_b64_tr_b16 a[160:161], v3 offset:40960
  v_fmac_f32 v82, v16, v30
  v_mfma_f32_16x16x32_bf16 v[140:143], a[164:167], a[108:111], v[140:143]
  s_waitcnt lgkmcnt(6)
  v_fmac_f32 v83, v16, v31
  v_fmac_f32 v84, v18, v28
  v_mfma_f32_16x16x32_bf16 v[156:159], a[172:175], a[108:111], v[156:159]
  ds_read_b64_tr_b16 a[162:163], v3 offset:43008
  v_fmac_f32 v85, v18, v29
  v_mfma_f32_16x16x32_bf16 v[156:159], a[168:171], a[124:127], v[156:159]
  buffer_load_dwordx4 a[20:23], v1, s[8:11], s73 offen offset:1024 sc1
  v_fmac_f32 v86, v18, v30
  v_fmac_f32 v87, v18, v31
  v_mfma_f32_16x16x32_bf16 v[152:155], a[168:171], a[120:123], v[152:155]
  ds_read_b64_tr_b16 a[164:165], v3 offset:45056
  v_fmac_f32 v88, v20, v28
  v_mfma_f32_16x16x32_bf16 v[152:155], a[172:175], a[104:107], v[152:155]
  s_add_u32 s73, s73, 65536
  v_fmac_f32 v89, v20, v29
  v_fmac_f32 v90, v20, v30
  v_mfma_f32_16x16x32_bf16 v[148:151], a[172:175], a[100:103], v[148:151]
  ds_read_b64_tr_b16 a[166:167], v3 offset:47104
  v_fmac_f32 v91, v20, v31
  v_mfma_f32_16x16x32_bf16 v[148:151], a[168:171], a[116:119], v[148:151]
  buffer_load_dwordx4 a[8:11], v1, s[8:11], s73 offen offset:0 sc1
  v_fmac_f32 v92, v22, v28
  v_fmac_f32 v93, v22, v29
  v_mfma_f32_16x16x32_bf16 v[144:147], a[168:171], a[112:115], v[144:147]
  ds_read_b64_tr_b16 a[168:169], v4 offset:32768
  v_fmac_f32 v94, v22, v30
  v_mfma_f32_16x16x32_bf16 v[144:147], a[172:175], a[96:99], v[144:147]
  s_waitcnt lgkmcnt(5)
  v_fmac_f32 v95, v22, v31
  v_mfma_f32_16x16x32_bf16 v[160:163], a[180:183], a[96:99], v[160:163]
  ds_read_b64_tr_b16 a[170:171], v4 offset:34816
  v_mfma_f32_16x16x32_bf16 v[160:163], a[176:179], a[112:115], v[160:163]
  ds_read_b128 v[28:31], v12 offset:1792
  s_waitcnt lgkmcnt(8)
  v_mfma_f32_16x16x32_bf16 v[164:167], a[176:179], a[116:119], v[164:167]
  ds_read_b64_tr_b16 a[172:173], v4 offset:36864
  v_fmac_f32 v48, v17, v24
  v_mfma_f32_16x16x32_bf16 v[164:167], a[180:183], a[100:103], v[164:167]
  buffer_load_dwordx4 a[24:27], v1, s[8:11], s73 offen offset:1024 sc1
  v_fmac_f32 v49, v17, v25
  v_fmac_f32 v50, v17, v26
  v_mfma_f32_16x16x32_bf16 v[168:171], a[180:183], a[104:107], v[168:171]
  ds_read_b64_tr_b16 a[174:175], v4 offset:38912
  v_fmac_f32 v51, v17, v27
  v_mfma_f32_16x16x32_bf16 v[168:171], a[176:179], a[120:123], v[168:171]
  s_add_u32 s73, s73, 65536
  v_fmac_f32 v52, v19, v24
  v_fmac_f32 v53, v19, v25
  v_mfma_f32_16x16x32_bf16 v[172:175], a[176:179], a[124:127], v[172:175]
  ds_read_b64_tr_b16 a[176:177], v4 offset:40960
  v_fmac_f32 v54, v19, v26
  v_mfma_f32_16x16x32_bf16 v[172:175], a[180:183], a[108:111], v[172:175]
  s_waitcnt lgkmcnt(6)
  buffer_load_dwordx4 a[12:15], v1, s[8:11], s73 offen offset:0 sc1
  v_fmac_f32 v55, v19, v27
  v_mfma_f32_16x16x32_bf16 v[188:191], a[160:163], a[108:111], v[188:191]
  ds_read_b64_tr_b16 a[178:179], v4 offset:43008
  v_fmac_f32 v56, v21, v24
  v_mfma_f32_16x16x32_bf16 v[188:191], a[164:167], a[124:127], v[188:191]
  v_fmac_f32 v57, v21, v25
  v_fmac_f32 v58, v21, v26
  v_mfma_f32_16x16x32_bf16 v[184:187], a[164:167], a[120:123], v[184:187]
  ds_read_b64_tr_b16 a[180:181], v4 offset:45056
  v_fmac_f32 v59, v21, v27
  v_mfma_f32_16x16x32_bf16 v[184:187], a[160:163], a[104:107], v[184:187]
  v_fmac_f32 v60, v23, v24
  v_fmac_f32 v61, v23, v25
  v_mfma_f32_16x16x32_bf16 v[180:183], a[160:163], a[100:103], v[180:183]
  ds_read_b64_tr_b16 a[182:183], v4 offset:47104
  v_fmac_f32 v62, v23, v26
  v_mfma_f32_16x16x32_bf16 v[180:183], a[164:167], a[116:119], v[180:183]
  buffer_load_dwordx4 a[28:31], v1, s[8:11], s73 offen offset:1024 sc1
  v_fmac_f32 v63, v23, v27
  v_mfma_f32_16x16x32_bf16 v[176:179], a[164:167], a[112:115], v[176:179]
  ds_read_b64_tr_b16 a[164:165], v5 offset:32768
  v_mfma_f32_16x16x32_bf16 v[176:179], a[160:163], a[96:99], v[176:179]
  s_waitcnt lgkmcnt(5)
  v_mfma_f32_16x16x32_bf16 v[192:195], a[168:171], a[96:99], v[192:195]
  ds_read_b64_tr_b16 a[166:167], v5 offset:34816
  v_mfma_f32_16x16x32_bf16 v[192:195], a[172:175], a[112:115], v[192:195]
  buffer_load_dwordx4 a[32:35], v1, s[8:11], s74 offen offset:0 sc1
  ds_read_b128 v[24:27], v12 offset:320
  v_mfma_f32_16x16x32_bf16 v[196:199], a[172:175], a[116:119], v[196:199]
  ds_read_b64_tr_b16 a[160:161], v5 offset:36864
  s_waitcnt lgkmcnt(10)
  v_mfma_f32_16x16x32_bf16 v[196:199], a[168:171], a[100:103], v[196:199]
  v_fmac_f32 v80, v17, v28
  v_fmac_f32 v81, v17, v29
  v_mfma_f32_16x16x32_bf16 v[200:203], a[168:171], a[104:107], v[200:203]
  ds_read_b64_tr_b16 a[162:163], v5 offset:38912
  v_fmac_f32 v82, v17, v30
  v_mfma_f32_16x16x32_bf16 v[200:203], a[172:175], a[120:123], v[200:203]
  v_fmac_f32 v83, v17, v31
  v_fmac_f32 v84, v19, v28
  v_mfma_f32_16x16x32_bf16 v[204:207], a[172:175], a[124:127], v[204:207]
  ds_read_b64_tr_b16 a[172:173], v5 offset:40960
  v_fmac_f32 v85, v19, v29
  v_mfma_f32_16x16x32_bf16 v[204:207], a[168:171], a[108:111], v[204:207]
  s_waitcnt lgkmcnt(6)
  buffer_load_dwordx4 a[48:51], v1, s[8:11], s74 offen offset:1024 sc1
  v_fmac_f32 v86, v19, v30
  v_mfma_f32_16x16x32_bf16 v[220:223], a[176:179], a[108:111], v[220:223]
  ds_read_b64_tr_b16 a[174:175], v5 offset:43008
  v_fmac_f32 v87, v19, v31
  v_mfma_f32_16x16x32_bf16 v[220:223], a[180:183], a[124:127], v[220:223]
  s_add_u32 s74, s74, 65536
  v_fmac_f32 v88, v21, v28
  v_fmac_f32 v89, v21, v29
  v_mfma_f32_16x16x32_bf16 v[216:219], a[180:183], a[120:123], v[216:219]
  ds_read_b64_tr_b16 a[168:169], v5 offset:45056
  v_fmac_f32 v90, v21, v30
  v_mfma_f32_16x16x32_bf16 v[216:219], a[176:179], a[104:107], v[216:219]
  buffer_load_dwordx4 a[36:39], v1, s[8:11], s74 offen offset:0 sc1
  v_fmac_f32 v91, v21, v31
  v_fmac_f32 v92, v23, v28
  v_mfma_f32_16x16x32_bf16 v[212:215], a[176:179], a[100:103], v[212:215]
  ds_read_b64_tr_b16 a[170:171], v5 offset:47104
  v_fmac_f32 v93, v23, v29
  v_mfma_f32_16x16x32_bf16 v[212:215], a[180:183], a[116:119], v[212:215]
  s_waitcnt vmcnt(31)
  s_barrier
  v_mfma_f32_16x16x32_bf16 v[208:211], a[180:183], a[112:115], v[208:211]
  ds_read_b64_tr_b16 a[180:181], v6 offset:49152
  v_fmac_f32 v94, v23, v30
  v_mfma_f32_16x16x32_bf16 v[208:211], a[176:179], a[96:99], v[208:211]
  s_waitcnt lgkmcnt(5)
  v_fmac_f32 v95, v23, v31
  v_mfma_f32_16x16x32_bf16 v[224:227], a[164:167], a[96:99], v[224:227]
  ds_read_b64_tr_b16 a[182:183], v6 offset:51200
  v_mfma_f32_16x16x32_bf16 v[224:227], a[160:163], a[112:115], v[224:227]
  buffer_load_dwordx4 a[52:55], v1, s[8:11], s74 offen offset:1024 sc1
  ds_read_b128 v[28:31], v12 offset:1344
  v_mfma_f32_16x16x32_bf16 v[228:231], a[160:163], a[116:119], v[228:231]
  ds_read_b64_tr_b16 a[176:177], v6 offset:53248
  s_waitcnt lgkmcnt(10)
  v_mfma_f32_16x16x32_bf16 v[228:231], a[164:167], a[100:103], v[228:231]
  s_add_u32 s74, s74, 65536
  v_fmac_f32 v96, v16, v24
  v_fmac_f32 v97, v16, v25
  v_mfma_f32_16x16x32_bf16 v[232:235], a[164:167], a[104:107], v[232:235]
  ds_read_b64_tr_b16 a[178:179], v6 offset:55296
  v_fmac_f32 v98, v16, v26
  v_mfma_f32_16x16x32_bf16 v[232:235], a[160:163], a[120:123], v[232:235]
  buffer_load_dwordx4 a[40:43], v1, s[8:11], s74 offen offset:0 sc1
  v_fmac_f32 v99, v16, v27
  v_fmac_f32 v100, v18, v24
  v_mfma_f32_16x16x32_bf16 v[236:239], a[160:163], a[124:127], v[236:239]
  ds_read_b64_tr_b16 a[160:161], v6 offset:57344
  v_fmac_f32 v101, v18, v25
  v_mfma_f32_16x16x32_bf16 v[236:239], a[164:167], a[108:111], v[236:239]
  s_waitcnt lgkmcnt(6)
  v_fmac_f32 v102, v18, v26
  v_fmac_f32 v103, v18, v27
  v_mfma_f32_16x16x32_bf16 v[252:255], a[172:175], a[108:111], v[252:255]
  ds_read_b64_tr_b16 a[162:163], v6 offset:59392
  v_fmac_f32 v104, v20, v24
  v_mfma_f32_16x16x32_bf16 v[252:255], a[168:171], a[124:127], v[252:255]
  v_fmac_f32 v105, v20, v25
  v_fmac_f32 v106, v20, v26
  v_mfma_f32_16x16x32_bf16 v[248:251], a[168:171], a[120:123], v[248:251]
  ds_read_b64_tr_b16 a[164:165], v6 offset:61440
  v_fmac_f32 v107, v20, v27
  v_mfma_f32_16x16x32_bf16 v[248:251], a[172:175], a[104:107], v[248:251]
  buffer_load_dwordx4 a[56:59], v1, s[8:11], s74 offen offset:1024 sc1
  v_fmac_f32 v108, v22, v24
  v_fmac_f32 v109, v22, v25
  v_mfma_f32_16x16x32_bf16 v[244:247], a[172:175], a[100:103], v[244:247]
  ds_read_b64_tr_b16 a[166:167], v6 offset:63488
  v_fmac_f32 v110, v22, v26
  v_mfma_f32_16x16x32_bf16 v[244:247], a[168:171], a[116:119], v[244:247]
  s_add_u32 s74, s74, 65536
  v_fmac_f32 v111, v22, v27
  v_mfma_f32_16x16x32_bf16 v[240:243], a[168:171], a[112:115], v[240:243]
  ds_read_b64_tr_b16 a[168:169], v7 offset:49152
  v_mfma_f32_16x16x32_bf16 v[240:243], a[172:175], a[96:99], v[240:243]
  s_waitcnt vmcnt(26) lgkmcnt(5)
  buffer_load_dwordx4 a[44:47], v1, s[8:11], s74 offen offset:0 sc1
  v_mfma_f32_16x16x32_bf16 v[64:67], a[180:183], a[128:131], v[64:67]
  ds_read_b64_tr_b16 a[170:171], v7 offset:51200
  v_mfma_f32_16x16x32_bf16 v[64:67], a[176:179], a[144:147], v[64:67]
  ds_read_b128 v[24:27], v12 offset:0
  s_waitcnt lgkmcnt(9)
  v_mfma_f32_16x16x32_bf16 v[68:71], a[176:179], a[148:151], v[68:71]
  ds_read_b64_tr_b16 a[172:173], v7 offset:53248
  v_fmac_f32 v112, v16, v28
  v_mfma_f32_16x16x32_bf16 v[68:71], a[180:183], a[132:135], v[68:71]
  v_fmac_f32 v113, v16, v29
  v_fmac_f32 v114, v16, v30
  v_mfma_f32_16x16x32_bf16 v[72:75], a[180:183], a[136:139], v[72:75]
  ds_read_b64_tr_b16 a[174:175], v7 offset:55296
  v_fmac_f32 v115, v16, v31
  v_mfma_f32_16x16x32_bf16 v[72:75], a[176:179], a[152:155], v[72:75]
  buffer_load_dwordx4 a[60:63], v1, s[8:11], s74 offen offset:1024 sc1
  v_fmac_f32 v116, v18, v28
  v_fmac_f32 v117, v18, v29
  v_mfma_f32_16x16x32_bf16 v[76:79], a[176:179], a[156:159], v[76:79]
  ds_read_b64_tr_b16 a[176:177], v7 offset:57344
  v_fmac_f32 v118, v18, v30
  v_mfma_f32_16x16x32_bf16 v[76:79], a[180:183], a[140:143], v[76:79]
  s_waitcnt lgkmcnt(6)
  s_mov_b32 s67, 5505024
  s_add_u32 s75, s24, 24576
  s_add_u32 m0, s45, 98304
  v_fmac_f32 v119, v18, v31
  v_mfma_f32_16x16x32_bf16 v[92:95], a[160:163], a[140:143], v[92:95]
  ds_read_b64_tr_b16 a[178:179], v7 offset:59392
  v_fmac_f32 v120, v20, v28
  v_mfma_f32_16x16x32_bf16 v[92:95], a[164:167], a[156:159], v[92:95]
  buffer_load_dwordx4 v11, s[28:31], s67 offen lds
  v_fmac_f32 v121, v20, v29
  v_fmac_f32 v122, v20, v30
  v_mfma_f32_16x16x32_bf16 v[88:91], a[164:167], a[152:155], v[88:91]
  ds_read_b64_tr_b16 a[180:181], v7 offset:61440
  v_fmac_f32 v123, v20, v31
  v_mfma_f32_16x16x32_bf16 v[88:91], a[160:163], a[136:139], v[88:91]
  v_fmac_f32 v124, v22, v28
  v_fmac_f32 v125, v22, v29
  v_mfma_f32_16x16x32_bf16 v[84:87], a[160:163], a[132:135], v[84:87]
  ds_read_b64_tr_b16 a[182:183], v7 offset:63488
  v_fmac_f32 v126, v22, v30
  v_mfma_f32_16x16x32_bf16 v[84:87], a[164:167], a[148:151], v[84:87]
  s_add_u32 m0, s45, 106496
  v_fmac_f32 v127, v22, v31
  v_mfma_f32_16x16x32_bf16 v[80:83], a[164:167], a[144:147], v[80:83]
  ds_read_b64_tr_b16 a[164:165], v8 offset:49152
  v_mfma_f32_16x16x32_bf16 v[80:83], a[160:163], a[128:131], v[80:83]
  s_waitcnt lgkmcnt(5)
  buffer_load_dwordx4 v11, s[32:35], s67 offen lds
  v_mfma_f32_16x16x32_bf16 v[96:99], a[168:171], a[128:131], v[96:99]
  ds_read_b64_tr_b16 a[166:167], v8 offset:51200
  v_mfma_f32_16x16x32_bf16 v[96:99], a[172:175], a[144:147], v[96:99]
  s_add_u32 m0, s45, 102400
  s_add_u32 s60, s67, 229376
  v_mfma_f32_16x16x32_bf16 v[100:103], a[172:175], a[148:151], v[100:103]
  ds_read_b64_tr_b16 a[160:161], v8 offset:53248
  v_mfma_f32_16x16x32_bf16 v[100:103], a[168:171], a[132:135], v[100:103]
  buffer_load_dwordx4 v11, s[28:31], s60 offen lds
  ds_read_b128 v[28:31], v12 offset:1024
  v_mfma_f32_16x16x32_bf16 v[104:107], a[168:171], a[136:139], v[104:107]
  ds_read_b64_tr_b16 a[162:163], v8 offset:55296
  s_waitcnt lgkmcnt(11)
  v_mfma_f32_16x16x32_bf16 v[104:107], a[172:175], a[152:155], v[104:107]
  v_fmac_f32 v128, v16, v24
  v_fmac_f32 v129, v16, v25
  v_mfma_f32_16x16x32_bf16 v[108:111], a[172:175], a[156:159], v[108:111]
  ds_read_b64_tr_b16 a[172:173], v8 offset:57344
  v_fmac_f32 v130, v16, v26
  v_mfma_f32_16x16x32_bf16 v[108:111], a[168:171], a[140:143], v[108:111]
  s_waitcnt lgkmcnt(6)
  s_add_u32 m0, s45, 110592
  s_add_u32 s60, s67, 229376
  v_mfma_f32_16x16x32_bf16 v[124:127], a[176:179], a[140:143], v[124:127]
  ds_read_b64_tr_b16 a[174:175], v8 offset:59392
  v_fmac_f32 v131, v16, v27
  v_mfma_f32_16x16x32_bf16 v[124:127], a[180:183], a[156:159], v[124:127]
  buffer_load_dwordx4 v11, s[32:35], s60 offen lds
  v_fmac_f32 v132, v18, v24
  v_fmac_f32 v133, v18, v25
  v_mfma_f32_16x16x32_bf16 v[120:123], a[180:183], a[152:155], v[120:123]
  ds_read_b64_tr_b16 a[168:169], v8 offset:61440
  v_fmac_f32 v134, v18, v26
  v_mfma_f32_16x16x32_bf16 v[120:123], a[176:179], a[136:139], v[120:123]
  v_fmac_f32 v135, v18, v27
  v_fmac_f32 v136, v20, v24
  v_mfma_f32_16x16x32_bf16 v[116:119], a[176:179], a[132:135], v[116:119]
  ds_read_b64_tr_b16 a[170:171], v8 offset:63488
  v_fmac_f32 v137, v20, v25
  v_mfma_f32_16x16x32_bf16 v[116:119], a[180:183], a[148:151], v[116:119]
  buffer_load_dwordx4 a[64:67], v1, s[8:11], s75 offen offset:0 sc1
  v_fmac_f32 v138, v20, v26
  v_fmac_f32 v139, v20, v27
  v_mfma_f32_16x16x32_bf16 v[112:115], a[180:183], a[144:147], v[112:115]
  ds_read_b64_tr_b16 a[180:181], v2 offset:49152
  v_fmac_f32 v140, v22, v24
  v_mfma_f32_16x16x32_bf16 v[112:115], a[176:179], a[128:131], v[112:115]
  s_waitcnt lgkmcnt(5)
  v_fmac_f32 v141, v22, v25
  v_fmac_f32 v142, v22, v26
  v_mfma_f32_16x16x32_bf16 v[32:35], a[164:167], a[128:131], v[32:35]
  ds_read_b64_tr_b16 a[182:183], v2 offset:51200
  v_fmac_f32 v143, v22, v27
  v_mfma_f32_16x16x32_bf16 v[32:35], a[160:163], a[144:147], v[32:35]
  ds_read_b128 v[24:27], v12 offset:1856
  s_waitcnt lgkmcnt(8)
  v_mfma_f32_16x16x32_bf16 v[36:39], a[160:163], a[148:151], v[36:39]
  ds_read_b64_tr_b16 a[176:177], v2 offset:53248
  v_fmac_f32 v144, v16, v28
  v_mfma_f32_16x16x32_bf16 v[36:39], a[164:167], a[132:135], v[36:39]
  buffer_load_dwordx4 a[80:83], v1, s[8:11], s75 offen offset:1024 sc1
  v_fmac_f32 v145, v16, v29
  v_fmac_f32 v146, v16, v30
  v_mfma_f32_16x16x32_bf16 v[40:43], a[164:167], a[136:139], v[40:43]
  ds_read_b64_tr_b16 a[178:179], v2 offset:55296
  v_fmac_f32 v147, v16, v31
  v_mfma_f32_16x16x32_bf16 v[40:43], a[160:163], a[152:155], v[40:43]
  s_add_u32 s75, s75, 65536
  v_fmac_f32 v148, v18, v28
  v_fmac_f32 v149, v18, v29
  v_mfma_f32_16x16x32_bf16 v[44:47], a[160:163], a[156:159], v[44:47]
  ds_read_b64_tr_b16 a[160:161], v2 offset:57344
  v_fmac_f32 v150, v18, v30
  v_mfma_f32_16x16x32_bf16 v[44:47], a[164:167], a[140:143], v[44:47]
  s_waitcnt lgkmcnt(6)
  buffer_load_dwordx4 a[68:71], v1, s[8:11], s75 offen offset:0 sc1
  v_fmac_f32 v151, v18, v31
  v_mfma_f32_16x16x32_bf16 v[60:63], a[172:175], a[140:143], v[60:63]
  ds_read_b64_tr_b16 a[162:163], v2 offset:59392
  v_fmac_f32 v152, v20, v28
  v_mfma_f32_16x16x32_bf16 v[60:63], a[168:171], a[156:159], v[60:63]
  v_fmac_f32 v153, v20, v29
  v_fmac_f32 v154, v20, v30
  v_mfma_f32_16x16x32_bf16 v[56:59], a[168:171], a[152:155], v[56:59]
  ds_read_b64_tr_b16 a[164:165], v2 offset:61440
  v_fmac_f32 v155, v20, v31
  v_mfma_f32_16x16x32_bf16 v[56:59], a[172:175], a[136:139], v[56:59]
  v_fmac_f32 v156, v22, v28
  v_fmac_f32 v157, v22, v29
  v_mfma_f32_16x16x32_bf16 v[52:55], a[172:175], a[132:135], v[52:55]
  ds_read_b64_tr_b16 a[166:167], v2 offset:63488
  v_fmac_f32 v158, v22, v30
  v_mfma_f32_16x16x32_bf16 v[52:55], a[168:171], a[148:151], v[52:55]
  buffer_load_dwordx4 a[84:87], v1, s[8:11], s75 offen offset:1024 sc1
  v_fmac_f32 v159, v22, v31
  v_mfma_f32_16x16x32_bf16 v[48:51], a[168:171], a[144:147], v[48:51]
  ds_read_b64_tr_b16 a[168:169], v3 offset:49152
  v_mfma_f32_16x16x32_bf16 v[48:51], a[172:175], a[128:131], v[48:51]
  s_waitcnt lgkmcnt(5)
  s_add_u32 s75, s75, 65536
  v_mfma_f32_16x16x32_bf16 v[128:131], a[180:183], a[128:131], v[128:131]
  ds_read_b64_tr_b16 a[170:171], v3 offset:51200
  v_mfma_f32_16x16x32_bf16 v[128:131], a[176:179], a[144:147], v[128:131]
  buffer_load_dwordx4 a[72:75], v1, s[8:11], s75 offen offset:0 sc1
  ds_read_b128 v[28:31], v12 offset:128
  v_mfma_f32_16x16x32_bf16 v[132:135], a[176:179], a[148:151], v[132:135]
  ds_read_b64_tr_b16 a[172:173], v3 offset:53248
  s_waitcnt lgkmcnt(10)
  v_mfma_f32_16x16x32_bf16 v[132:135], a[180:183], a[132:135], v[132:135]
  v_fmac_f32 v112, v17, v24
  v_fmac_f32 v113, v17, v25
  v_mfma_f32_16x16x32_bf16 v[136:139], a[180:183], a[136:139], v[136:139]
  ds_read_b64_tr_b16 a[174:175], v3 offset:55296
  v_fmac_f32 v114, v17, v26
  v_mfma_f32_16x16x32_bf16 v[136:139], a[176:179], a[152:155], v[136:139]
  v_fmac_f32 v115, v17, v27
  v_fmac_f32 v116, v19, v24
  v_mfma_f32_16x16x32_bf16 v[140:143], a[176:179], a[156:159], v[140:143]
  ds_read_b64_tr_b16 a[176:177], v3 offset:57344
  v_fmac_f32 v117, v19, v25
  v_mfma_f32_16x16x32_bf16 v[140:143], a[180:183], a[140:143], v[140:143]
  s_waitcnt lgkmcnt(6)
  buffer_load_dwordx4 a[88:91], v1, s[8:11], s75 offen offset:1024 sc1
  v_fmac_f32 v118, v19, v26
  v_mfma_f32_16x16x32_bf16 v[156:159], a[160:163], a[140:143], v[156:159]
  ds_read_b64_tr_b16 a[178:179], v3 offset:59392
  v_fmac_f32 v119, v19, v27
  v_mfma_f32_16x16x32_bf16 v[156:159], a[164:167], a[156:159], v[156:159]
  s_add_u32 s75, s75, 65536
  v_fmac_f32 v120, v21, v24
  v_fmac_f32 v121, v21, v25
  v_mfma_f32_16x16x32_bf16 v[152:155], a[164:167], a[152:155], v[152:155]
  ds_read_b64_tr_b16 a[180:181], v3 offset:61440
  v_fmac_f32 v122, v21, v26
  v_mfma_f32_16x16x32_bf16 v[152:155], a[160:163], a[136:139], v[152:155]
  buffer_load_dwordx4 a[76:79], v1, s[8:11], s75 offen offset:0 sc1
  v_fmac_f32 v123, v21, v27
  v_fmac_f32 v124, v23, v24
  v_mfma_f32_16x16x32_bf16 v[148:151], a[160:163], a[132:135], v[148:151]
  ds_read_b64_tr_b16 a[182:183], v3 offset:63488
  v_fmac_f32 v125, v23, v25
  v_mfma_f32_16x16x32_bf16 v[148:151], a[164:167], a[148:151], v[148:151]
  v_fmac_f32 v126, v23, v26
  v_fmac_f32 v127, v23, v27
  v_mfma_f32_16x16x32_bf16 v[144:147], a[164:167], a[144:147], v[144:147]
  ds_read_b64_tr_b16 a[164:165], v4 offset:49152
  v_mfma_f32_16x16x32_bf16 v[144:147], a[160:163], a[128:131], v[144:147]
  s_waitcnt lgkmcnt(5)
  ds_read_b128 v[24:27], v12 offset:1536
  v_mfma_f32_16x16x32_bf16 v[160:163], a[168:171], a[128:131], v[160:163]
  ds_read_b64_tr_b16 a[166:167], v4 offset:51200
  s_waitcnt lgkmcnt(9)
  v_mfma_f32_16x16x32_bf16 v[160:163], a[172:175], a[144:147], v[160:163]
  buffer_load_dwordx4 a[92:95], v1, s[8:11], s75 offen offset:1024 sc1
  v_fmac_f32 v192, v16, v28
  v_fmac_f32 v193, v16, v29
  v_mfma_f32_16x16x32_bf16 v[164:167], a[172:175], a[148:151], v[164:167]
  ds_read_b64_tr_b16 a[160:161], v4 offset:53248
  v_fmac_f32 v194, v16, v30
  v_mfma_f32_16x16x32_bf16 v[164:167], a[168:171], a[132:135], v[164:167]
  s_mov_b32 s68, 5963776
  s_add_u32 s76, s24, 26624
  v_fmac_f32 v195, v16, v31
  v_fmac_f32 v196, v18, v28
  v_mfma_f32_16x16x32_bf16 v[168:171], a[168:171], a[136:139], v[168:171]
  ds_read_b64_tr_b16 a[162:163], v4 offset:55296
  v_fmac_f32 v197, v18, v29
  v_mfma_f32_16x16x32_bf16 v[168:171], a[172:175], a[152:155], v[168:171]
  buffer_load_dwordx4 a[96:99], v1, s[8:11], s76 offen offset:0 sc1
  v_fmac_f32 v198, v18, v30
  v_fmac_f32 v199, v18, v31
  v_mfma_f32_16x16x32_bf16 v[172:175], a[172:175], a[156:159], v[172:175]
  ds_read_b64_tr_b16 a[172:173], v4 offset:57344
  v_fmac_f32 v200, v20, v28
  v_mfma_f32_16x16x32_bf16 v[172:175], a[168:171], a[140:143], v[172:175]
  s_waitcnt lgkmcnt(6)
  v_fmac_f32 v201, v20, v29
  v_fmac_f32 v202, v20, v30
  v_mfma_f32_16x16x32_bf16 v[188:191], a[176:179], a[140:143], v[188:191]
  ds_read_b64_tr_b16 a[174:175], v4 offset:59392
  v_fmac_f32 v203, v20, v31
  v_mfma_f32_16x16x32_bf16 v[188:191], a[180:183], a[156:159], v[188:191]
  v_fmac_f32 v204, v22, v28
  v_fmac_f32 v205, v22, v29
  v_mfma_f32_16x16x32_bf16 v[184:187], a[180:183], a[152:155], v[184:187]
  ds_read_b64_tr_b16 a[168:169], v4 offset:61440
  v_fmac_f32 v206, v22, v30
  v_mfma_f32_16x16x32_bf16 v[184:187], a[176:179], a[136:139], v[184:187]
  buffer_load_dwordx4 a[112:115], v1, s[8:11], s76 offen offset:1024 sc1
  v_fmac_f32 v207, v22, v31
  v_mfma_f32_16x16x32_bf16 v[180:183], a[176:179], a[132:135], v[180:183]
  ds_read_b64_tr_b16 a[170:171], v4 offset:63488
  v_mfma_f32_16x16x32_bf16 v[180:183], a[180:183], a[148:151], v[180:183]
  s_add_u32 s76, s76, 65536
  ds_read_b128 v[28:31], v12 offset:64
  v_mfma_f32_16x16x32_bf16 v[176:179], a[180:183], a[144:147], v[176:179]
  ds_read_b64_tr_b16 a[180:181], v5 offset:49152
  s_waitcnt lgkmcnt(9)
  v_mfma_f32_16x16x32_bf16 v[176:179], a[176:179], a[128:131], v[176:179]
  s_waitcnt lgkmcnt(6)
  buffer_load_dwordx4 a[100:103], v1, s[8:11], s76 offen offset:0 sc1
  v_fmac_f32 v144, v17, v24
  v_mfma_f32_16x16x32_bf16 v[192:195], a[164:167], a[128:131], v[192:195]
  ds_read_b64_tr_b16 a[182:183], v5 offset:51200
  v_fmac_f32 v145, v17, v25
  v_mfma_f32_16x16x32_bf16 v[192:195], a[160:163], a[144:147], v[192:195]
  v_fmac_f32 v146, v17, v26
  v_fmac_f32 v147, v17, v27
  v_mfma_f32_16x16x32_bf16 v[196:199], a[160:163], a[148:151], v[196:199]
  ds_read_b64_tr_b16 a[176:177], v5 offset:53248
  v_fmac_f32 v148, v19, v24
  v_mfma_f32_16x16x32_bf16 v[196:199], a[164:167], a[132:135], v[196:199]
  v_fmac_f32 v149, v19, v25
  v_fmac_f32 v150, v19, v26
  v_mfma_f32_16x16x32_bf16 v[200:203], a[164:167], a[136:139], v[200:203]
  ds_read_b64_tr_b16 a[178:179], v5 offset:55296
  v_fmac_f32 v151, v19, v27
  v_mfma_f32_16x16x32_bf16 v[200:203], a[160:163], a[152:155], v[200:203]
  buffer_load_dwordx4 a[116:119], v1, s[8:11], s76 offen offset:1024 sc1
  v_fmac_f32 v152, v21, v24
  v_fmac_f32 v153, v21, v25
  v_mfma_f32_16x16x32_bf16 v[204:207], a[160:163], a[156:159], v[204:207]
  ds_read_b64_tr_b16 a[160:161], v5 offset:57344
  v_fmac_f32 v154, v21, v26
  v_mfma_f32_16x16x32_bf16 v[204:207], a[164:167], a[140:143], v[204:207]
  s_waitcnt lgkmcnt(6)
  s_add_u32 s76, s76, 65536
  v_fmac_f32 v155, v21, v27
  v_mfma_f32_16x16x32_bf16 v[220:223], a[172:175], a[140:143], v[220:223]
  ds_read_b64_tr_b16 a[162:163], v5 offset:59392
  v_fmac_f32 v156, v23, v24
  v_mfma_f32_16x16x32_bf16 v[220:223], a[168:171], a[156:159], v[220:223]
  buffer_load_dwordx4 a[104:107], v1, s[8:11], s76 offen offset:0 sc1
  v_fmac_f32 v157, v23, v25
  v_fmac_f32 v158, v23, v26
  v_mfma_f32_16x16x32_bf16 v[216:219], a[168:171], a[152:155], v[216:219]
  ds_read_b64_tr_b16 a[164:165], v5 offset:61440
  v_fmac_f32 v159, v23, v27
  v_mfma_f32_16x16x32_bf16 v[216:219], a[172:175], a[136:139], v[216:219]
  ds_read_b128 v[24:27], v12 offset:1088
  s_waitcnt lgkmcnt(8)
  v_mfma_f32_16x16x32_bf16 v[212:215], a[172:175], a[132:135], v[212:215]
  ds_read_b64_tr_b16 a[166:167], v5 offset:63488
  v_fmac_f32 v160, v16, v28
  v_mfma_f32_16x16x32_bf16 v[212:215], a[168:171], a[148:151], v[212:215]
  s_waitcnt vmcnt(33)
  s_barrier
  v_mfma_f32_16x16x32_bf16 v[208:211], a[168:171], a[144:147], v[208:211]
  ds_read_b64_tr_b16 a[168:169], v6 offset:16384
  v_fmac_f32 v161, v16, v29
  v_mfma_f32_16x16x32_bf16 v[208:211], a[172:175], a[128:131], v[208:211]
  s_waitcnt lgkmcnt(6)
  buffer_load_dwordx4 a[120:123], v1, s[8:11], s76 offen offset:1024 sc1
  v_fmac_f32 v162, v16, v30
  v_mfma_f32_16x16x32_bf16 v[224:227], a[180:183], a[128:131], v[224:227]
  ds_read_b64_tr_b16 a[170:171], v6 offset:18432
  v_fmac_f32 v163, v16, v31
  v_mfma_f32_16x16x32_bf16 v[224:227], a[176:179], a[144:147], v[224:227]
  s_add_u32 m0, s45, 114688
  v_fmac_f32 v164, v18, v28
  v_fmac_f32 v165, v18, v29
HOP12:
  s_cbranch_execz HOP16
  v_mfma_f32_16x16x32_bf16 v[228:231], a[176:179], a[148:151], v[228:231]
  ds_read_b64_tr_b16 a[172:173], v6 offset:20480
  v_fmac_f32 v166, v18, v30
  v_mfma_f32_16x16x32_bf16 v[228:231], a[180:183], a[132:135], v[228:231]
  buffer_load_dwordx4 v11, s[28:31], s68 offen lds
  v_fmac_f32 v167, v18, v31
  v_fmac_f32 v168, v20, v28
  v_mfma_f32_16x16x32_bf16 v[232:235], a[180:183], a[136:139], v[232:235]
  ds_read_b64_tr_b16 a[174:175], v6 offset:22528
  v_fmac_f32 v169, v20, v29
  v_mfma_f32_16x16x32_bf16 v[232:235], a[176:179], a[152:155], v[232:235]
  v_fmac_f32 v170, v20, v30
  v_fmac_f32 v171, v20, v31
  v_mfma_f32_16x16x32_bf16 v[236:239], a[176:179], a[156:159], v[236:239]
  ds_read_b64_tr_b16 a[176:177], v6 offset:24576
  v_fmac_f32 v172, v22, v28
  v_mfma_f32_16x16x32_bf16 v[236:239], a[180:183], a[140:143], v[236:239]
  s_waitcnt lgkmcnt(5)
  s_add_u32 m0, s45, 122880
  v_fmac_f32 v173, v22, v29
  v_mfma_f32_16x16x32_bf16 v[252:255], a[160:163], a[140:143], v[252:255]
  ds_read_b64_tr_b16 a[178:179], v6 offset:26624
  v_fmac_f32 v174, v22, v30
  v_mfma_f32_16x16x32_bf16 v[252:255], a[164:167], a[156:159], v[252:255]
  buffer_load_dwordx4 v11, s[32:35], s68 offen lds
  v_fmac_f32 v175, v22, v31
  v_mfma_f32_16x16x32_bf16 v[248:251], a[164:167], a[152:155], v[248:251]
  ds_read_b64_tr_b16 a[180:181], v6 offset:28672
  v_mfma_f32_16x16x32_bf16 v[248:251], a[160:163], a[136:139], v[248:251]
  s_add_u32 m0, s45, 118784
  s_add_u32 s60, s68, 229376
  v_mfma_f32_16x16x32_bf16 v[244:247], a[160:163], a[132:135], v[244:247]
  ds_read_b64_tr_b16 a[182:183], v6 offset:30720
  v_mfma_f32_16x16x32_bf16 v[244:247], a[164:167], a[148:151], v[244:247]
  buffer_load_dwordx4 v11, s[28:31], s60 offen lds
  ds_read_b128 v[28:31], v12 offset:1600
  v_mfma_f32_16x16x32_bf16 v[240:243], a[164:167], a[144:147], v[240:243]
  ds_read_b64_tr_b16 a[164:165], v7 offset:16384
  s_waitcnt lgkmcnt(11)
  v_mfma_f32_16x16x32_bf16 v[240:243], a[160:163], a[128:131], v[240:243]
  s_waitcnt vmcnt(29) lgkmcnt(6)
  v_fmac_f32 v176, v16, v24
  v_fmac_f32 v177, v16, v25
  v_mfma_f32_16x16x32_bf16 v[64:67], a[168:171], a[0:3], v[64:67]
  ds_read_b64_tr_b16 a[166:167], v7 offset:18432
  v_fmac_f32 v178, v16, v26
  v_mfma_f32_16x16x32_bf16 v[64:67], a[172:175], a[16:19], v[64:67]
  s_add_u32 m0, s45, 126976
  s_add_u32 s60, s68, 229376
  v_fmac_f32 v179, v16, v27
  v_mfma_f32_16x16x32_bf16 v[68:71], a[172:175], a[20:23], v[68:71]
  ds_read_b64_tr_b16 a[160:161], v7 offset:20480
  v_fmac_f32 v180, v18, v24
  v_mfma_f32_16x16x32_bf16 v[68:71], a[168:171], a[4:7], v[68:71]
  buffer_load_dwordx4 v11, s[32:35], s60 offen lds
  v_fmac_f32 v181, v18, v25
  v_fmac_f32 v182, v18, v26
  v_mfma_f32_16x16x32_bf16 v[72:75], a[168:171], a[8:11], v[72:75]
  ds_read_b64_tr_b16 a[162:163], v7 offset:22528
  v_fmac_f32 v183, v18, v27
  v_mfma_f32_16x16x32_bf16 v[72:75], a[172:175], a[24:27], v[72:75]
  s_add_u32 s76, s76, 65536
  v_fmac_f32 v184, v20, v24
  v_fmac_f32 v185, v20, v25
  v_mfma_f32_16x16x32_bf16 v[76:79], a[172:175], a[28:31], v[76:79]
  ds_read_b64_tr_b16 a[172:173], v7 offset:24576
  v_fmac_f32 v186, v20, v26
  v_mfma_f32_16x16x32_bf16 v[76:79], a[168:171], a[12:15], v[76:79]
  s_waitcnt lgkmcnt(6)
  buffer_load_dwordx4 a[108:111], v1, s[8:11], s76 offen offset:0 sc1
  v_fmac_f32 v187, v20, v27
  v_mfma_f32_16x16x32_bf16 v[92:95], a[176:179], a[12:15], v[92:95]
  ds_read_b64_tr_b16 a[174:175], v7 offset:26624
  v_fmac_f32 v188, v22, v24
  v_mfma_f32_16x16x32_bf16 v[92:95], a[180:183], a[28:31], v[92:95]
  v_fmac_f32 v189, v22, v25
  v_fmac_f32 v190, v22, v26
  v_mfma_f32_16x16x32_bf16 v[88:91], a[180:183], a[24:27], v[88:91]
  ds_read_b64_tr_b16 a[168:169], v7 offset:28672
  v_fmac_f32 v191, v22, v27
  v_mfma_f32_16x16x32_bf16 v[88:91], a[176:179], a[8:11], v[88:91]
  ds_read_b128 v[24:27], v12 offset:1152
  s_waitcnt lgkmcnt(8)
  v_mfma_f32_16x16x32_bf16 v[84:87], a[176:179], a[4:7], v[84:87]
  ds_read_b64_tr_b16 a[170:171], v7 offset:30720
  v_fmac_f32 v176, v17, v28
  v_mfma_f32_16x16x32_bf16 v[84:87], a[180:183], a[20:23], v[84:87]
  buffer_load_dwordx4 a[124:127], v1, s[8:11], s76 offen offset:1024 sc1
  v_fmac_f32 v177, v17, v29
  v_fmac_f32 v178, v17, v30
  v_mfma_f32_16x16x32_bf16 v[80:83], a[180:183], a[16:19], v[80:83]
  ds_read_b64_tr_b16 a[180:181], v8 offset:16384
  v_fmac_f32 v179, v17, v31
  v_mfma_f32_16x16x32_bf16 v[80:83], a[176:179], a[0:3], v[80:83]
  s_waitcnt lgkmcnt(6)
  s_mov_b32 s69, 6422528
  s_add_u32 s77, s24, 28672
  v_fmac_f32 v180, v19, v28
  v_mfma_f32_16x16x32_bf16 v[96:99], a[164:167], a[0:3], v[96:99]
  ds_read_b64_tr_b16 a[182:183], v8 offset:18432
  v_fmac_f32 v181, v19, v29
  v_mfma_f32_16x16x32_bf16 v[96:99], a[160:163], a[16:19], v[96:99]
  buffer_load_dwordx4 a[128:131], v1, s[8:11], s77 offen offset:0 sc1
  v_fmac_f32 v182, v19, v30
  v_fmac_f32 v183, v19, v31
  v_mfma_f32_16x16x32_bf16 v[100:103], a[160:163], a[20:23], v[100:103]
  ds_read_b64_tr_b16 a[176:177], v8 offset:20480
  v_fmac_f32 v184, v21, v28
  v_mfma_f32_16x16x32_bf16 v[100:103], a[164:167], a[4:7], v[100:103]
  v_fmac_f32 v185, v21, v29
  v_fmac_f32 v186, v21, v30
  v_mfma_f32_16x16x32_bf16 v[104:107], a[164:167], a[8:11], v[104:107]
  ds_read_b64_tr_b16 a[178:179], v8 offset:22528
  v_fmac_f32 v187, v21, v31
  v_mfma_f32_16x16x32_bf16 v[104:107], a[160:163], a[24:27], v[104:107]
  v_fmac_f32 v188, v23, v28
  v_fmac_f32 v189, v23, v29
  v_mfma_f32_16x16x32_bf16 v[108:111], a[160:163], a[28:31], v[108:111]
  ds_read_b64_tr_b16 a[160:161], v8 offset:24576
  v_fmac_f32 v190, v23, v30
  v_mfma_f32_16x16x32_bf16 v[108:111], a[164:167], a[12:15], v[108:111]
  s_waitcnt lgkmcnt(5)
  buffer_load_dwordx4 a[144:147], v1, s[8:11], s77 offen offset:1024 sc1
  v_fmac_f32 v191, v23, v31
  v_mfma_f32_16x16x32_bf16 v[124:127], a[172:175], a[12:15], v[124:127]
  ds_read_b64_tr_b16 a[162:163], v8 offset:26624
  v_mfma_f32_16x16x32_bf16 v[124:127], a[168:171], a[28:31], v[124:127]
  s_add_u32 s77, s77, 65536
  ds_read_b128 v[28:31], v12 offset:1664
  v_mfma_f32_16x16x32_bf16 v[120:123], a[168:171], a[24:27], v[120:123]
  ds_read_b64_tr_b16 a[164:165], v8 offset:28672
  s_waitcnt lgkmcnt(9)
  v_mfma_f32_16x16x32_bf16 v[120:123], a[172:175], a[8:11], v[120:123]
  buffer_load_dwordx4 a[132:135], v1, s[8:11], s77 offen offset:0 sc1
  v_fmac_f32 v208, v16, v24
  v_fmac_f32 v209, v16, v25
  v_mfma_f32_16x16x32_bf16 v[116:119], a[172:175], a[4:7], v[116:119]
  ds_read_b64_tr_b16 a[166:167], v8 offset:30720
  v_fmac_f32 v210, v16, v26
  v_mfma_f32_16x16x32_bf16 v[116:119], a[168:171], a[20:23], v[116:119]
  v_fmac_f32 v211, v16, v27
  v_fmac_f32 v212, v18, v24
  v_mfma_f32_16x16x32_bf16 v[112:115], a[168:171], a[16:19], v[112:115]
  ds_read_b64_tr_b16 a[168:169], v6 offset:0
  v_fmac_f32 v213, v18, v25
  v_mfma_f32_16x16x32_bf16 v[112:115], a[172:175], a[0:3], v[112:115]
  s_waitcnt lgkmcnt(6)
  v_fmac_f32 v214, v18, v26
  v_fmac_f32 v215, v18, v27
  v_mfma_f32_16x16x32_bf16 v[32:35], a[180:183], a[0:3], v[32:35]
  ds_read_b64_tr_b16 a[170:171], v6 offset:2048
  v_fmac_f32 v216, v20, v24
  v_mfma_f32_16x16x32_bf16 v[32:35], a[176:179], a[16:19], v[32:35]
  buffer_load_dwordx4 a[148:151], v1, s[8:11], s77 offen offset:1024 sc1
  v_fmac_f32 v217, v20, v25
  v_fmac_f32 v218, v20, v26
  v_mfma_f32_16x16x32_bf16 v[36:39], a[176:179], a[20:23], v[36:39]
  ds_read_b64_tr_b16 a[172:173], v6 offset:4096
  v_fmac_f32 v219, v20, v27
  v_mfma_f32_16x16x32_bf16 v[36:39], a[180:183], a[4:7], v[36:39]
  s_add_u32 s77, s77, 65536
  v_fmac_f32 v220, v22, v24
  v_fmac_f32 v221, v22, v25
  v_mfma_f32_16x16x32_bf16 v[40:43], a[180:183], a[8:11], v[40:43]
  ds_read_b64_tr_b16 a[174:175], v6 offset:6144
  v_fmac_f32 v222, v22, v26
  v_mfma_f32_16x16x32_bf16 v[40:43], a[176:179], a[24:27], v[40:43]
  buffer_load_dwordx4 a[136:139], v1, s[8:11], s77 offen offset:0 sc1
  v_fmac_f32 v223, v22, v27
  v_mfma_f32_16x16x32_bf16 v[44:47], a[176:179], a[28:31], v[44:47]
  ds_read_b64_tr_b16 a[176:177], v6 offset:8192
  v_mfma_f32_16x16x32_bf16 v[44:47], a[180:183], a[12:15], v[44:47]
  s_waitcnt lgkmcnt(5)
  ds_read_b128 v[24:27], v12 offset:192
  v_mfma_f32_16x16x32_bf16 v[60:63], a[160:163], a[12:15], v[60:63]
  ds_read_b64_tr_b16 a[178:179], v6 offset:10240
  s_waitcnt lgkmcnt(9)
  v_mfma_f32_16x16x32_bf16 v[60:63], a[164:167], a[28:31], v[60:63]
  v_fmac_f32 v208, v17, v28
  v_fmac_f32 v209, v17, v29
  v_mfma_f32_16x16x32_bf16 v[56:59], a[164:167], a[24:27], v[56:59]
  ds_read_b64_tr_b16 a[180:181], v6 offset:12288
  v_fmac_f32 v210, v17, v30
  v_mfma_f32_16x16x32_bf16 v[56:59], a[160:163], a[8:11], v[56:59]
  buffer_load_dwordx4 a[152:155], v1, s[8:11], s77 offen offset:1024 sc1
  v_fmac_f32 v211, v17, v31
  v_fmac_f32 v212, v19, v28
  v_mfma_f32_16x16x32_bf16 v[52:55], a[160:163], a[4:7], v[52:55]
  ds_read_b64_tr_b16 a[182:183], v6 offset:14336
  v_fmac_f32 v213, v19, v29
  v_mfma_f32_16x16x32_bf16 v[52:55], a[164:167], a[20:23], v[52:55]
  s_add_u32 s77, s77, 65536
  v_fmac_f32 v214, v19, v30
  v_fmac_f32 v215, v19, v31
  v_mfma_f32_16x16x32_bf16 v[48:51], a[164:167], a[16:19], v[48:51]
  ds_read_b64_tr_b16 a[164:165], v7 offset:0
  v_fmac_f32 v216, v21, v28
  v_mfma_f32_16x16x32_bf16 v[48:51], a[160:163], a[0:3], v[48:51]
  s_waitcnt vmcnt(30) lgkmcnt(6)
  buffer_load_dwordx4 a[140:143], v1, s[8:11], s77 offen offset:0 sc1
  v_fmac_f32 v217, v21, v29
  v_mfma_f32_16x16x32_bf16 v[64:67], a[168:171], a[32:35], v[64:67]
  ds_read_b64_tr_b16 a[166:167], v7 offset:2048
  v_fmac_f32 v218, v21, v30
  v_mfma_f32_16x16x32_bf16 v[64:67], a[172:175], a[48:51], v[64:67]
  v_fmac_f32 v219, v21, v31
  v_fmac_f32 v220, v23, v28
  v_mfma_f32_16x16x32_bf16 v[68:71], a[172:175], a[52:55], v[68:71]
  ds_read_b64_tr_b16 a[160:161], v7 offset:4096
  v_fmac_f32 v221, v23, v29
  v_mfma_f32_16x16x32_bf16 v[68:71], a[168:171], a[36:39], v[68:71]
  v_fmac_f32 v222, v23, v30
  v_fmac_f32 v223, v23, v31
  v_mfma_f32_16x16x32_bf16 v[72:75], a[168:171], a[40:43], v[72:75]
  ds_read_b64_tr_b16 a[162:163], v7 offset:6144
  v_mfma_f32_16x16x32_bf16 v[72:75], a[172:175], a[56:59], v[72:75]
  buffer_load_dwordx4 a[156:159], v1, s[8:11], s77 offen offset:1024 sc1
  ds_read_b128 v[28:31], v12 offset:1216
  v_mfma_f32_16x16x32_bf16 v[76:79], a[172:175], a[60:63], v[76:79]
  ds_read_b64_tr_b16 a[172:173], v7 offset:8192
  s_waitcnt lgkmcnt(9)
  v_mfma_f32_16x16x32_bf16 v[76:79], a[168:171], a[44:47], v[76:79]
  s_waitcnt lgkmcnt(6)
  s_mov_b32 s70, 6881280
  s_add_u32 s78, s24, 30720
  v_fmac_f32 v224, v16, v24
  v_mfma_f32_16x16x32_bf16 v[92:95], a[176:179], a[44:47], v[92:95]
  ds_read_b64_tr_b16 a[174:175], v7 offset:10240
  v_fmac_f32 v225, v16, v25
  v_mfma_f32_16x16x32_bf16 v[92:95], a[180:183], a[60:63], v[92:95]
  buffer_load_dwordx4 a[188:191], v1, s[8:11], s78 offen offset:0 sc1
  v_fmac_f32 v226, v16, v26
  v_fmac_f32 v227, v16, v27
  v_mfma_f32_16x16x32_bf16 v[88:91], a[180:183], a[56:59], v[88:91]
  ds_read_b64_tr_b16 a[168:169], v7 offset:12288
  v_fmac_f32 v228, v18, v24
  v_mfma_f32_16x16x32_bf16 v[88:91], a[176:179], a[40:43], v[88:91]
  v_fmac_f32 v229, v18, v25
  v_fmac_f32 v230, v18, v26
  v_mfma_f32_16x16x32_bf16 v[84:87], a[176:179], a[36:39], v[84:87]
  ds_read_b64_tr_b16 a[170:171], v7 offset:14336
  v_fmac_f32 v231, v18, v27
  v_mfma_f32_16x16x32_bf16 v[84:87], a[180:183], a[52:55], v[84:87]
  v_fmac_f32 v232, v20, v24
  v_fmac_f32 v233, v20, v25
  v_mfma_f32_16x16x32_bf16 v[80:83], a[180:183], a[48:51], v[80:83]
  ds_read_b64_tr_b16 a[180:181], v8 offset:0
  v_fmac_f32 v234, v20, v26
  v_mfma_f32_16x16x32_bf16 v[80:83], a[176:179], a[32:35], v[80:83]
  s_waitcnt lgkmcnt(6)
  buffer_load_dwordx4 a[204:207], v1, s[8:11], s78 offen offset:1024 sc1
  v_fmac_f32 v235, v20, v27
  v_mfma_f32_16x16x32_bf16 v[96:99], a[164:167], a[32:35], v[96:99]
  ds_read_b64_tr_b16 a[182:183], v8 offset:2048
  v_fmac_f32 v236, v22, v24
  v_mfma_f32_16x16x32_bf16 v[96:99], a[160:163], a[48:51], v[96:99]
  s_add_u32 s78, s78, 65536
  v_fmac_f32 v237, v22, v25
  v_fmac_f32 v238, v22, v26
  v_mfma_f32_16x16x32_bf16 v[100:103], a[160:163], a[52:55], v[100:103]
  ds_read_b64_tr_b16 a[176:177], v8 offset:4096
  v_fmac_f32 v239, v22, v27
  v_mfma_f32_16x16x32_bf16 v[100:103], a[164:167], a[36:39], v[100:103]
  buffer_load_dwordx4 a[192:195], v1, s[8:11], s78 offen offset:0 sc1
  ds_read_b128 v[24:27], v12 offset:1728
  v_mfma_f32_16x16x32_bf16 v[104:107], a[164:167], a[40:43], v[104:107]
  ds_read_b64_tr_b16 a[178:179], v8 offset:6144
  s_waitcnt lgkmcnt(9)
  v_mfma_f32_16x16x32_bf16 v[104:107], a[160:163], a[56:59], v[104:107]
  v_fmac_f32 v240, v16, v28
  v_fmac_f32 v241, v16, v29
  v_mfma_f32_16x16x32_bf16 v[108:111], a[160:163], a[60:63], v[108:111]
  ds_read_b64_tr_b16 a[160:161], v8 offset:8192
  v_fmac_f32 v242, v16, v30
  v_mfma_f32_16x16x32_bf16 v[108:111], a[164:167], a[44:47], v[108:111]
  s_waitcnt lgkmcnt(6)
  v_fmac_f32 v243, v16, v31
  v_fmac_f32 v244, v18, v28
  v_mfma_f32_16x16x32_bf16 v[124:127], a[172:175], a[44:47], v[124:127]
  ds_read_b64_tr_b16 a[162:163], v8 offset:10240
  v_fmac_f32 v245, v18, v29
  v_mfma_f32_16x16x32_bf16 v[124:127], a[168:171], a[60:63], v[124:127]
  buffer_load_dwordx4 a[208:211], v1, s[8:11], s78 offen offset:1024 sc1
  v_fmac_f32 v246, v18, v30
  v_fmac_f32 v247, v18, v31
  v_mfma_f32_16x16x32_bf16 v[120:123], a[168:171], a[56:59], v[120:123]
  ds_read_b64_tr_b16 a[164:165], v8 offset:12288
  v_fmac_f32 v248, v20, v28
  v_mfma_f32_16x16x32_bf16 v[120:123], a[172:175], a[40:43], v[120:123]
  s_add_u32 s78, s78, 65536
  v_fmac_f32 v249, v20, v29
  v_fmac_f32 v250, v20, v30
  v_mfma_f32_16x16x32_bf16 v[116:119], a[172:175], a[36:39], v[116:119]
  ds_read_b64_tr_b16 a[166:167], v8 offset:14336
  v_fmac_f32 v251, v20, v31
  v_mfma_f32_16x16x32_bf16 v[116:119], a[168:171], a[52:55], v[116:119]
  buffer_load_dwordx4 a[196:199], v1, s[8:11], s78 offen offset:0 sc1
  v_fmac_f32 v252, v22, v28
  v_fmac_f32 v253, v22, v29
  v_mfma_f32_16x16x32_bf16 v[112:115], a[168:171], a[48:51], v[112:115]
  ds_read_b64_tr_b16 a[168:169], v2 offset:0
  v_fmac_f32 v254, v22, v30
  v_mfma_f32_16x16x32_bf16 v[112:115], a[172:175], a[32:35], v[112:115]
  s_waitcnt lgkmcnt(5)
  v_fmac_f32 v255, v22, v31
  v_mfma_f32_16x16x32_bf16 v[32:35], a[180:183], a[32:35], v[32:35]
  ds_read_b64_tr_b16 a[170:171], v2 offset:2048
  s_waitcnt lgkmcnt(7)
  v_mfma_f32_16x16x32_bf16 v[32:35], a[176:179], a[48:51], v[32:35]
  v_fmac_f32 v240, v17, v24
  v_fmac_f32 v241, v17, v25
  v_mfma_f32_16x16x32_bf16 v[36:39], a[176:179], a[52:55], v[36:39]
  ds_read_b64_tr_b16 a[172:173], v2 offset:4096
  v_fmac_f32 v242, v17, v26
  v_mfma_f32_16x16x32_bf16 v[36:39], a[180:183], a[36:39], v[36:39]
  buffer_load_dwordx4 a[212:215], v1, s[8:11], s78 offen offset:1024 sc1
  v_fmac_f32 v243, v17, v27
  v_fmac_f32 v244, v19, v24
  v_mfma_f32_16x16x32_bf16 v[40:43], a[180:183], a[40:43], v[40:43]
  ds_read_b64_tr_b16 a[174:175], v2 offset:6144
  v_fmac_f32 v245, v19, v25
  v_mfma_f32_16x16x32_bf16 v[40:43], a[176:179], a[56:59], v[40:43]
  s_add_u32 s78, s78, 65536
  v_fmac_f32 v246, v19, v26
  v_fmac_f32 v247, v19, v27
  v_mfma_f32_16x16x32_bf16 v[44:47], a[176:179], a[60:63], v[44:47]
  ds_read_b64_tr_b16 a[176:177], v2 offset:8192
  v_fmac_f32 v248, v21, v24
  v_mfma_f32_16x16x32_bf16 v[44:47], a[180:183], a[44:47], v[44:47]
  s_waitcnt lgkmcnt(5)
  buffer_load_dwordx4 a[200:203], v1, s[8:11], s78 offen offset:0 sc1
  v_fmac_f32 v249, v21, v25
  v_mfma_f32_16x16x32_bf16 v[60:63], a[160:163], a[44:47], v[60:63]
  ds_read_b64_tr_b16 a[178:179], v2 offset:10240
  s_barrier
  v_mfma_f32_16x16x32_bf16 v[60:63], a[164:167], a[60:63], v[60:63]
  v_fmac_f32 v250, v21, v26
  v_fmac_f32 v251, v21, v27
  v_mfma_f32_16x16x32_bf16 v[56:59], a[164:167], a[56:59], v[56:59]
  ds_read_b64_tr_b16 a[180:181], v2 offset:12288
  v_fmac_f32 v252, v23, v24
  v_mfma_f32_16x16x32_bf16 v[56:59], a[160:163], a[40:43], v[56:59]
  s_add_u32 m0, s45, 81920
  v_fmac_f32 v253, v23, v25
  v_fmac_f32 v254, v23, v26
  v_mfma_f32_16x16x32_bf16 v[52:55], a[160:163], a[36:39], v[52:55]
  ds_read_b64_tr_b16 a[182:183], v2 offset:14336
  v_fmac_f32 v255, v23, v27
  v_mfma_f32_16x16x32_bf16 v[52:55], a[164:167], a[52:55], v[52:55]
  buffer_load_dwordx4 v11, s[28:31], s69 offen lds
  ds_read_b128 v[28:31], v12 offset:896
  v_mfma_f32_16x16x32_bf16 v[48:51], a[164:167], a[48:51], v[48:51]
  ds_read_b64_tr_b16 a[164:165], v3 offset:0
  v_mfma_f32_16x16x32_bf16 v[48:51], a[160:163], a[32:35], v[48:51]
  s_waitcnt lgkmcnt(6)
  s_add_u32 m0, s45, 90112
  v_mfma_f32_16x16x32_bf16 v[128:131], a[168:171], a[0:3], v[128:131]
  ds_read_b64_tr_b16 a[166:167], v3 offset:2048
  v_mfma_f32_16x16x32_bf16 v[128:131], a[172:175], a[16:19], v[128:131]
  buffer_load_dwordx4 v11, s[32:35], s69 offen lds
  v_rcp_f32 v16, v17
  v_mfma_f32_16x16x32_bf16 v[132:135], a[172:175], a[20:23], v[132:135]
  ds_read_b64_tr_b16 a[160:161], v3 offset:4096
  v_mfma_f32_16x16x32_bf16 v[132:135], a[168:171], a[4:7], v[132:135]
  v_rcp_f32 v18, v19
  v_mfma_f32_16x16x32_bf16 v[136:139], a[168:171], a[8:11], v[136:139]
  ds_read_b64_tr_b16 a[162:163], v3 offset:6144
  v_mfma_f32_16x16x32_bf16 v[136:139], a[172:175], a[24:27], v[136:139]
  s_add_u32 m0, s45, 86016
  s_add_u32 s60, s69, 229376
  v_mfma_f32_16x16x32_bf16 v[140:143], a[172:175], a[28:31], v[140:143]
  ds_read_b64_tr_b16 a[172:173], v3 offset:8192
  v_mfma_f32_16x16x32_bf16 v[140:143], a[168:171], a[12:15], v[140:143]
  s_waitcnt lgkmcnt(6)
  buffer_load_dwordx4 v11, s[28:31], s60 offen lds
  v_mfma_f32_16x16x32_bf16 v[156:159], a[176:179], a[12:15], v[156:159]
  ds_read_b64_tr_b16 a[174:175], v3 offset:10240
  v_rcp_f32 v20, v21
  v_mfma_f32_16x16x32_bf16 v[156:159], a[180:183], a[28:31], v[156:159]
  s_add_u32 m0, s45, 94208
  s_add_u32 s60, s69, 229376
  v_mfma_f32_16x16x32_bf16 v[152:155], a[180:183], a[24:27], v[152:155]
  ds_read_b64_tr_b16 a[168:169], v3 offset:12288
  v_mfma_f32_16x16x32_bf16 v[152:155], a[176:179], a[8:11], v[152:155]
  buffer_load_dwordx4 v11, s[32:35], s60 offen lds
  v_rcp_f32 v22, v23
  v_mfma_f32_16x16x32_bf16 v[148:151], a[176:179], a[4:7], v[148:151]
  ds_read_b64_tr_b16 a[170:171], v3 offset:14336
  v_mul_f32 v17, 0xbfb8aa3b, v17
  v_mfma_f32_16x16x32_bf16 v[148:151], a[180:183], a[20:23], v[148:151]
  v_mul_f32 v19, 0xbfb8aa3b, v19
  v_mul_f32 v21, 0xbfb8aa3b, v21
  v_mfma_f32_16x16x32_bf16 v[144:147], a[180:183], a[16:19], v[144:147]
  ds_read_b64_tr_b16 a[180:181], v4 offset:0
  v_mul_f32 v23, 0xbfb8aa3b, v23
  v_mfma_f32_16x16x32_bf16 v[144:147], a[176:179], a[0:3], v[144:147]
  s_waitcnt lgkmcnt(5)
  s_add_u32 m0, s45, 65536
  v_mul_f32 v16, 0xbfb8aa3b, v16
  v_mfma_f32_16x16x32_bf16 v[160:163], a[164:167], a[0:3], v[160:163]
  ds_read_b64_tr_b16 a[182:183], v4 offset:2048
  v_mul_f32 v18, 0xbfb8aa3b, v18
  v_mfma_f32_16x16x32_bf16 v[160:163], a[160:163], a[16:19], v[160:163]
  buffer_load_dwordx4 v11, s[28:31], s70 offen lds
  v_mul_f32 v20, 0xbfb8aa3b, v20
  v_mul_f32 v22, 0xbfb8aa3b, v22
  v_mfma_f32_16x16x32_bf16 v[164:167], a[160:163], a[20:23], v[164:167]
  ds_read_b64_tr_b16 a[176:177], v4 offset:4096
  v_mfma_f32_16x16x32_bf16 v[164:167], a[164:167], a[4:7], v[164:167]
  s_add_u32 m0, s45, 73728
  v_mfma_f32_16x16x32_bf16 v[168:171], a[164:167], a[8:11], v[168:171]
  ds_read_b64_tr_b16 a[178:179], v4 offset:6144
  v_mfma_f32_16x16x32_bf16 v[168:171], a[160:163], a[24:27], v[168:171]
  buffer_load_dwordx4 v11, s[32:35], s70 offen lds
  v_mfma_f32_16x16x32_bf16 v[172:175], a[160:163], a[28:31], v[172:175]
  ds_read_b64_tr_b16 a[160:161], v4 offset:8192
  v_mfma_f32_16x16x32_bf16 v[172:175], a[164:167], a[12:15], v[172:175]
  s_waitcnt lgkmcnt(5)
  v_mfma_f32_16x16x32_bf16 v[188:191], a[172:175], a[12:15], v[188:191]
  ds_read_b64_tr_b16 a[162:163], v4 offset:10240
  v_mfma_f32_16x16x32_bf16 v[188:191], a[168:171], a[28:31], v[188:191]
  s_add_u32 m0, s45, 69632
  s_add_u32 s60, s70, 229376
  v_mfma_f32_16x16x32_bf16 v[184:187], a[168:171], a[24:27], v[184:187]
  ds_read_b64_tr_b16 a[164:165], v4 offset:12288
  v_mfma_f32_16x16x32_bf16 v[184:187], a[172:175], a[8:11], v[184:187]
  buffer_load_dwordx4 v11, s[28:31], s60 offen lds
  v_mfma_f32_16x16x32_bf16 v[180:183], a[172:175], a[4:7], v[180:183]
  ds_read_b64_tr_b16 a[166:167], v4 offset:14336
  v_mfma_f32_16x16x32_bf16 v[180:183], a[168:171], a[20:23], v[180:183]
  s_add_u32 m0, s45, 77824
  s_add_u32 s60, s70, 229376
  v_mfma_f32_16x16x32_bf16 v[176:179], a[168:171], a[16:19], v[176:179]
  ds_read_b64_tr_b16 a[168:169], v5 offset:0
  v_mfma_f32_16x16x32_bf16 v[176:179], a[172:175], a[0:3], v[176:179]
  s_waitcnt lgkmcnt(5)
  buffer_load_dwordx4 v11, s[32:35], s60 offen lds
  v_mfma_f32_16x16x32_bf16 v[192:195], a[180:183], a[0:3], v[192:195]
  ds_read_b64_tr_b16 a[170:171], v5 offset:2048
  v_mfma_f32_16x16x32_bf16 v[192:195], a[176:179], a[16:19], v[192:195]
  v_mfma_f32_16x16x32_bf16 v[196:199], a[176:179], a[20:23], v[196:199]
  ds_read_b64_tr_b16 a[172:173], v5 offset:4096
  v_mfma_f32_16x16x32_bf16 v[196:199], a[180:183], a[4:7], v[196:199]
  v_mfma_f32_16x16x32_bf16 v[200:203], a[180:183], a[8:11], v[200:203]
  ds_read_b64_tr_b16 a[174:175], v5 offset:6144
  v_mfma_f32_16x16x32_bf16 v[200:203], a[176:179], a[24:27], v[200:203]
  buffer_load_dwordx4 a[216:219], v1, s[8:11], s78 offen offset:1024 sc1
  v_mfma_f32_16x16x32_bf16 v[204:207], a[176:179], a[28:31], v[204:207]
  ds_read_b64_tr_b16 a[176:177], v5 offset:8192
  v_mfma_f32_16x16x32_bf16 v[204:207], a[180:183], a[12:15], v[204:207]
  s_waitcnt lgkmcnt(5)
  s_add_u32 m0, s45, 16384
  v_mfma_f32_16x16x32_bf16 v[220:223], a[160:163], a[12:15], v[220:223]
  ds_read_b64_tr_b16 a[178:179], v5 offset:10240
  v_mfma_f32_16x16x32_bf16 v[220:223], a[164:167], a[28:31], v[220:223]
  buffer_load_dwordx4 v10, s[28:31], s66 offen lds
  v_mfma_f32_16x16x32_bf16 v[216:219], a[164:167], a[24:27], v[216:219]
  ds_read_b64_tr_b16 a[180:181], v5 offset:12288
  v_mfma_f32_16x16x32_bf16 v[216:219], a[160:163], a[8:11], v[216:219]
  v_mfma_f32_16x16x32_bf16 v[212:215], a[160:163], a[4:7], v[212:215]
  ds_read_b64_tr_b16 a[182:183], v5 offset:14336
  v_mfma_f32_16x16x32_bf16 v[212:215], a[164:167], a[20:23], v[212:215]
  s_waitcnt vmcnt(27)
  s_barrier
  v_mfma_f32_16x16x32_bf16 v[208:211], a[164:167], a[16:19], v[208:211]
  ds_read_b64_tr_b16 a[164:165], v8 offset:32768
  s_add_u32 m0, s45, 24576
  v_mfma_f32_16x16x32_bf16 v[208:211], a[160:163], a[0:3], v[208:211]
  s_waitcnt lgkmcnt(5)
  buffer_load_dwordx4 v10, s[32:35], s66 offen lds
  v_mfma_f32_16x16x32_bf16 v[224:227], a[168:171], a[0:3], v[224:227]
  ds_read_b64_tr_b16 a[166:167], v8 offset:34816
  v_mfma_f32_16x16x32_bf16 v[224:227], a[172:175], a[16:19], v[224:227]
  s_add_u32 m0, s45, 20480
  s_add_u32 s60, s66, 229376
  v_mfma_f32_16x16x32_bf16 v[228:231], a[172:175], a[20:23], v[228:231]
  ds_read_b64_tr_b16 a[160:161], v8 offset:36864
  v_mfma_f32_16x16x32_bf16 v[228:231], a[168:171], a[4:7], v[228:231]
  buffer_load_dwordx4 v10, s[28:31], s60 offen lds
  v_mfma_f32_16x16x32_bf16 v[232:235], a[168:171], a[8:11], v[232:235]
  ds_read_b64_tr_b16 a[162:163], v8 offset:38912
  v_mfma_f32_16x16x32_bf16 v[232:235], a[172:175], a[24:27], v[232:235]
  v_mfma_f32_16x16x32_bf16 v[236:239], a[172:175], a[28:31], v[236:239]
  ds_read_b64_tr_b16 a[172:173], v8 offset:40960
  v_mfma_f32_16x16x32_bf16 v[236:239], a[168:171], a[12:15], v[236:239]
  s_waitcnt lgkmcnt(5)
  s_add_u32 m0, s45, 28672
  s_add_u32 s60, s66, 229376
  v_mfma_f32_16x16x32_bf16 v[252:255], a[176:179], a[12:15], v[252:255]
  ds_read_b64_tr_b16 a[174:175], v8 offset:43008
  v_mfma_f32_16x16x32_bf16 v[252:255], a[180:183], a[28:31], v[252:255]
  buffer_load_dwordx4 v10, s[32:35], s60 offen lds
  v_mfma_f32_16x16x32_bf16 v[248:251], a[180:183], a[24:27], v[248:251]
  ds_read_b64_tr_b16 a[168:169], v8 offset:45056
  v_mfma_f32_16x16x32_bf16 v[248:251], a[176:179], a[8:11], v[248:251]
  s_add_u32 m0, s45, 32768
  v_mfma_f32_16x16x32_bf16 v[244:247], a[176:179], a[4:7], v[244:247]
  ds_read_b64_tr_b16 a[170:171], v8 offset:47104
  v_mfma_f32_16x16x32_bf16 v[244:247], a[180:183], a[20:23], v[244:247]
  buffer_load_dwordx4 v10, s[28:31], s67 offen lds
  v_mfma_f32_16x16x32_bf16 v[240:243], a[180:183], a[16:19], v[240:243]
  ds_read_b64_tr_b16 a[180:181], v8 offset:49152
  v_mfma_f32_16x16x32_bf16 v[240:243], a[176:179], a[0:3], v[240:243]
  s_waitcnt vmcnt(41) lgkmcnt(5)
  v_mfma_f32_16x16x32_bf16 v[32:35], a[164:167], a[64:67], v[32:35]
  ds_read_b64_tr_b16 a[182:183], v8 offset:51200
  v_mfma_f32_16x16x32_bf16 v[32:35], a[160:163], a[80:83], v[32:35]
  s_add_u32 m0, s45, 40960
  v_mfma_f32_16x16x32_bf16 v[36:39], a[160:163], a[84:87], v[36:39]
  ds_read_b64_tr_b16 a[176:177], v8 offset:53248
  v_mfma_f32_16x16x32_bf16 v[36:39], a[164:167], a[68:71], v[36:39]
  buffer_load_dwordx4 v10, s[32:35], s67 offen lds
  v_mfma_f32_16x16x32_bf16 v[40:43], a[164:167], a[72:75], v[40:43]
  ds_read_b64_tr_b16 a[178:179], v8 offset:55296
  v_mfma_f32_16x16x32_bf16 v[40:43], a[160:163], a[88:91], v[40:43]
  s_add_u32 m0, s45, 36864
  s_add_u32 s60, s67, 229376
  v_mfma_f32_16x16x32_bf16 v[44:47], a[160:163], a[92:95], v[44:47]
  ds_read_b64_tr_b16 a[160:161], v8 offset:57344
  v_mfma_f32_16x16x32_bf16 v[44:47], a[164:167], a[76:79], v[44:47]
  s_waitcnt lgkmcnt(5)
  buffer_load_dwordx4 v10, s[28:31], s60 offen lds
  v_mfma_f32_16x16x32_bf16 v[60:63], a[172:175], a[76:79], v[60:63]
  ds_read_b64_tr_b16 a[162:163], v8 offset:59392
  v_mfma_f32_16x16x32_bf16 v[60:63], a[168:171], a[92:95], v[60:63]
  s_add_u32 m0, s45, 45056
  s_add_u32 s60, s67, 229376
  v_mfma_f32_16x16x32_bf16 v[56:59], a[168:171], a[88:91], v[56:59]
  ds_read_b64_tr_b16 a[164:165], v8 offset:61440
  v_mfma_f32_16x16x32_bf16 v[56:59], a[172:175], a[72:75], v[56:59]
  buffer_load_dwordx4 v10, s[32:35], s60 offen lds
  v_mfma_f32_16x16x32_bf16 v[52:55], a[172:175], a[68:71], v[52:55]
  ds_read_b64_tr_b16 a[166:167], v8 offset:63488
  v_mfma_f32_16x16x32_bf16 v[52:55], a[168:171], a[84:87], v[52:55]
  s_waitcnt vmcnt(9)
  s_barrier
  v_mfma_f32_16x16x32_bf16 v[48:51], a[168:171], a[80:83], v[48:51]
  ds_read_b64_tr_b16 a[168:169], v8 offset:16384
  s_add_u32 m0, s45, 49152
  v_mfma_f32_16x16x32_bf16 v[48:51], a[172:175], a[64:67], v[48:51]
  s_waitcnt vmcnt(32) lgkmcnt(5)
  buffer_load_dwordx4 v10, s[28:31], s68 offen lds
  v_mfma_f32_16x16x32_bf16 v[32:35], a[180:183], a[96:99], v[32:35]
  ds_read_b64_tr_b16 a[170:171], v8 offset:18432
  v_mfma_f32_16x16x32_bf16 v[32:35], a[176:179], a[112:115], v[32:35]
  s_add_u32 m0, s45, 57344
  v_mfma_f32_16x16x32_bf16 v[36:39], a[176:179], a[116:119], v[36:39]
  ds_read_b64_tr_b16 a[172:173], v8 offset:20480
  v_mfma_f32_16x16x32_bf16 v[36:39], a[180:183], a[100:103], v[36:39]
  buffer_load_dwordx4 v10, s[32:35], s68 offen lds
  v_mfma_f32_16x16x32_bf16 v[40:43], a[180:183], a[104:107], v[40:43]
  ds_read_b64_tr_b16 a[174:175], v8 offset:22528
  v_mfma_f32_16x16x32_bf16 v[40:43], a[176:179], a[120:123], v[40:43]
  s_add_u32 m0, s45, 53248
  s_add_u32 s60, s68, 229376
  v_mfma_f32_16x16x32_bf16 v[44:47], a[176:179], a[124:127], v[44:47]
  ds_read_b64_tr_b16 a[176:177], v8 offset:24576
  v_mfma_f32_16x16x32_bf16 v[44:47], a[180:183], a[108:111], v[44:47]
  s_waitcnt lgkmcnt(5)
  buffer_load_dwordx4 v10, s[28:31], s60 offen lds
  v_mfma_f32_16x16x32_bf16 v[60:63], a[160:163], a[108:111], v[60:63]
  ds_read_b64_tr_b16 a[178:179], v8 offset:26624
  v_mfma_f32_16x16x32_bf16 v[60:63], a[164:167], a[124:127], v[60:63]
  s_add_u32 m0, s45, 61440
  s_add_u32 s60, s68, 229376
  v_mfma_f32_16x16x32_bf16 v[56:59], a[164:167], a[120:123], v[56:59]
  ds_read_b64_tr_b16 a[180:181], v8 offset:28672
  v_mfma_f32_16x16x32_bf16 v[56:59], a[160:163], a[104:107], v[56:59]
  buffer_load_dwordx4 v10, s[32:35], s60 offen lds
  v_mfma_f32_16x16x32_bf16 v[52:55], a[160:163], a[100:103], v[52:55]
  ds_read_b64_tr_b16 a[182:183], v8 offset:30720
  v_mfma_f32_16x16x32_bf16 v[52:55], a[164:167], a[116:119], v[52:55]
  s_add_u32 m0, s45, 0
  v_mfma_f32_16x16x32_bf16 v[48:51], a[164:167], a[112:115], v[48:51]
  ds_read_b64_tr_b16 a[164:165], v8 offset:0
  v_mfma_f32_16x16x32_bf16 v[48:51], a[160:163], a[96:99], v[48:51]
  s_waitcnt vmcnt(28) lgkmcnt(5)
  buffer_load_dwordx4 v10, s[28:31], s69 offen lds
  v_mfma_f32_16x16x32_bf16 v[32:35], a[168:171], a[128:131], v[32:35]
  ds_read_b64_tr_b16 a[166:167], v8 offset:2048
  v_mfma_f32_16x16x32_bf16 v[32:35], a[172:175], a[144:147], v[32:35]
  s_add_u32 m0, s45, 8192
  v_mfma_f32_16x16x32_bf16 v[36:39], a[172:175], a[148:151], v[36:39]
  ds_read_b64_tr_b16 a[160:161], v8 offset:4096
  v_mfma_f32_16x16x32_bf16 v[36:39], a[168:171], a[132:135], v[36:39]
  buffer_load_dwordx4 v10, s[32:35], s69 offen lds
  v_mfma_f32_16x16x32_bf16 v[40:43], a[168:171], a[136:139], v[40:43]
  ds_read_b64_tr_b16 a[162:163], v8 offset:6144
  v_mfma_f32_16x16x32_bf16 v[40:43], a[172:175], a[152:155], v[40:43]
  s_add_u32 m0, s45, 4096
  s_add_u32 s60, s69, 229376
  v_mfma_f32_16x16x32_bf16 v[44:47], a[172:175], a[156:159], v[44:47]
  ds_read_b64_tr_b16 a[172:173], v8 offset:8192
  v_mfma_f32_16x16x32_bf16 v[44:47], a[168:171], a[140:143], v[44:47]
HOP13:
  s_cbranch_execz HOP17
  s_waitcnt lgkmcnt(5)
  buffer_load_dwordx4 v10, s[28:31], s60 offen lds
  v_mfma_f32_16x16x32_bf16 v[60:63], a[176:179], a[140:143], v[60:63]
  ds_read_b64_tr_b16 a[174:175], v8 offset:10240
  v_mfma_f32_16x16x32_bf16 v[60:63], a[180:183], a[156:159], v[60:63]
  s_add_u32 m0, s45, 12288
  s_add_u32 s60, s69, 229376
  v_mfma_f32_16x16x32_bf16 v[56:59], a[180:183], a[152:155], v[56:59]
  ds_read_b64_tr_b16 a[168:169], v8 offset:12288
  v_mfma_f32_16x16x32_bf16 v[56:59], a[176:179], a[136:139], v[56:59]
  buffer_load_dwordx4 v10, s[32:35], s60 offen lds
  v_mfma_f32_16x16x32_bf16 v[52:55], a[176:179], a[132:135], v[52:55]
  ds_read_b64_tr_b16 a[170:171], v8 offset:14336
  v_mfma_f32_16x16x32_bf16 v[52:55], a[180:183], a[148:151], v[52:55]
  v_mfma_f32_16x16x32_bf16 v[48:51], a[180:183], a[144:147], v[48:51]
  ds_read_b64_tr_b16 a[180:181], v6 offset:32768
  v_mfma_f32_16x16x32_bf16 v[48:51], a[176:179], a[128:131], v[48:51]
  s_waitcnt vmcnt(16) lgkmcnt(5)
  v_mfma_f32_16x16x32_bf16 v[32:35], a[164:167], a[188:191], v[32:35]
  ds_read_b64_tr_b16 a[182:183], v6 offset:34816
  v_mfma_f32_16x16x32_bf16 v[32:35], a[160:163], a[204:207], v[32:35]
  v_mfma_f32_16x16x32_bf16 v[36:39], a[160:163], a[208:211], v[36:39]
  ds_read_b64_tr_b16 a[176:177], v6 offset:36864
  v_mfma_f32_16x16x32_bf16 v[36:39], a[164:167], a[192:195], v[36:39]
  v_mfma_f32_16x16x32_bf16 v[40:43], a[164:167], a[196:199], v[40:43]
  ds_read_b64_tr_b16 a[178:179], v6 offset:38912
  v_mfma_f32_16x16x32_bf16 v[40:43], a[160:163], a[212:215], v[40:43]
  v_mfma_f32_16x16x32_bf16 v[44:47], a[160:163], a[216:219], v[44:47]
  ds_read_b64_tr_b16 a[160:161], v6 offset:40960
  v_mfma_f32_16x16x32_bf16 v[44:47], a[164:167], a[200:203], v[44:47]
  s_waitcnt lgkmcnt(5)
  v_mfma_f32_16x16x32_bf16 v[60:63], a[172:175], a[200:203], v[60:63]
  ds_read_b64_tr_b16 a[162:163], v6 offset:43008
  v_mfma_f32_16x16x32_bf16 v[60:63], a[168:171], a[216:219], v[60:63]
  v_mfma_f32_16x16x32_bf16 v[56:59], a[168:171], a[212:215], v[56:59]
  ds_read_b64_tr_b16 a[164:165], v6 offset:45056
  v_mfma_f32_16x16x32_bf16 v[56:59], a[172:175], a[196:199], v[56:59]
  v_mfma_f32_16x16x32_bf16 v[52:55], a[172:175], a[192:195], v[52:55]
  ds_read_b64_tr_b16 a[166:167], v6 offset:47104
  v_mfma_f32_16x16x32_bf16 v[52:55], a[168:171], a[208:211], v[52:55]
  v_mfma_f32_16x16x32_bf16 v[48:51], a[168:171], a[204:207], v[48:51]
  ds_read_b64_tr_b16 a[168:169], v6 offset:49152
  v_mfma_f32_16x16x32_bf16 v[48:51], a[172:175], a[188:191], v[48:51]
  s_waitcnt lgkmcnt(5)
  v_mfma_f32_16x16x32_bf16 v[64:67], a[180:183], a[64:67], v[64:67]
  ds_read_b64_tr_b16 a[170:171], v6 offset:51200
  v_mfma_f32_16x16x32_bf16 v[64:67], a[176:179], a[80:83], v[64:67]
  v_mfma_f32_16x16x32_bf16 v[68:71], a[176:179], a[84:87], v[68:71]
  ds_read_b64_tr_b16 a[172:173], v6 offset:53248
  s_waitcnt lgkmcnt(15)
  v_fma_f32 v32, v32, v16, v28
  v_mfma_f32_16x16x32_bf16 v[68:71], a[180:183], a[68:71], v[68:71]
  v_exp_f32 v24, v32
  v_fma_f32 v33, v33, v16, v29
  v_mfma_f32_16x16x32_bf16 v[72:75], a[180:183], a[72:75], v[72:75]
  ds_read_b64_tr_b16 a[174:175], v6 offset:55296
  v_exp_f32 v25, v33
  v_mfma_f32_16x16x32_bf16 v[72:75], a[176:179], a[88:91], v[72:75]
  v_fma_f32 v34, v34, v16, v30
  v_fma_f32 v35, v35, v16, v31
  v_mfma_f32_16x16x32_bf16 v[76:79], a[176:179], a[92:95], v[76:79]
  ds_read_b64_tr_b16 a[176:177], v6 offset:57344
  v_exp_f32 v26, v34
  v_mfma_f32_16x16x32_bf16 v[76:79], a[180:183], a[76:79], v[76:79]
  s_waitcnt lgkmcnt(5)
  v_exp_f32 v27, v35
  v_mul_f32 v48, v32, v48
  v_mfma_f32_16x16x32_bf16 v[92:95], a[160:163], a[76:79], v[92:95]
  ds_read_b64_tr_b16 a[178:179], v6 offset:59392
  v_mul_f32 v49, v33, v49
  v_mul_f32 v50, v34, v50
  v_mfma_f32_16x16x32_bf16 v[92:95], a[164:167], a[92:95], v[92:95]
  v_mul_f32 v51, v35, v51
  v_fma_f32 v24, v24, v17, v17
  v_fma_f32 v25, v25, v17, v17
  v_mfma_f32_16x16x32_bf16 v[88:91], a[164:167], a[88:91], v[88:91]
  ds_read_b64_tr_b16 a[180:181], v6 offset:61440
  v_fma_f32 v26, v26, v17, v17
  v_mfma_f32_16x16x32_bf16 v[88:91], a[160:163], a[72:75], v[88:91]
  v_rcp_f32 v24, v24
  v_fma_f32 v27, v27, v17, v17
  v_mfma_f32_16x16x32_bf16 v[84:87], a[160:163], a[68:71], v[84:87]
  ds_read_b64_tr_b16 a[182:183], v6 offset:63488
  v_rcp_f32 v25, v25
  v_mfma_f32_16x16x32_bf16 v[84:87], a[164:167], a[84:87], v[84:87]
  v_rcp_f32 v26, v26
  v_mul_f32 v48, v48, v24
  v_mfma_f32_16x16x32_bf16 v[80:83], a[164:167], a[80:83], v[80:83]
  ds_read_b64_tr_b16 a[164:165], v6 offset:16384
  v_rcp_f32 v27, v27
  v_mfma_f32_16x16x32_bf16 v[80:83], a[160:163], a[64:67], v[80:83]
  s_waitcnt lgkmcnt(5)
  v_mul_f32 v49, v49, v25
  v_mul_f32 v50, v50, v26
  v_mul_f32 v51, v51, v27
  v_mfma_f32_16x16x32_bf16 v[64:67], a[168:171], a[96:99], v[64:67]
  ds_read_b64_tr_b16 a[166:167], v6 offset:18432
  v_cvt_pk_bf16_f32 v32, v48, v49
  v_mfma_f32_16x16x32_bf16 v[64:67], a[172:175], a[112:115], v[64:67]
  v_cvt_pk_bf16_f32 v33, v50, v51
  v_fma_f32 v36, v36, v18, v28
  v_fma_f32 v37, v37, v18, v29
  v_mfma_f32_16x16x32_bf16 v[68:71], a[172:175], a[116:119], v[68:71]
  ds_read_b64_tr_b16 a[160:161], v6 offset:20480
  v_exp_f32 v24, v36
  v_mfma_f32_16x16x32_bf16 v[68:71], a[168:171], a[100:103], v[68:71]
  buffer_store_dwordx2 v[32:33], v1, s[8:11], s59 offen sc1
  v_mfma_f32_16x16x32_bf16 v[72:75], a[168:171], a[104:107], v[72:75]
  ds_read_b64_tr_b16 a[162:163], v6 offset:22528
  v_exp_f32 v25, v37
  v_mfma_f32_16x16x32_bf16 v[72:75], a[172:175], a[120:123], v[72:75]
  v_fma_f32 v38, v38, v18, v30
  v_fma_f32 v39, v39, v18, v31
  v_mfma_f32_16x16x32_bf16 v[76:79], a[172:175], a[124:127], v[76:79]
  ds_read_b64_tr_b16 a[172:173], v6 offset:24576
  s_bfm_b64 exec, 48, 0
  buffer_load_dword a253, v13, s[36:39], s91 offen
  s_mov_b64 exec, -1
  v_mfma_f32_16x16x32_bf16 v[76:79], a[168:171], a[108:111], v[76:79]
  s_waitcnt lgkmcnt(5)
  v_exp_f32 v26, v38
  v_mul_f32 v52, v36, v52
  v_mfma_f32_16x16x32_bf16 v[92:95], a[176:179], a[108:111], v[92:95]
  ds_read_b64_tr_b16 a[174:175], v6 offset:26624
  v_exp_f32 v27, v39
  v_mfma_f32_16x16x32_bf16 v[92:95], a[180:183], a[124:127], v[92:95]
  v_mul_f32 v53, v37, v53
  v_mul_f32 v54, v38, v54
  v_mul_f32 v55, v39, v55
  v_mfma_f32_16x16x32_bf16 v[88:91], a[180:183], a[120:123], v[88:91]
  ds_read_b64_tr_b16 a[168:169], v6 offset:28672
  v_fma_f32 v24, v24, v19, v19
  v_mfma_f32_16x16x32_bf16 v[88:91], a[176:179], a[104:107], v[88:91]
  v_rcp_f32 v24, v24
  v_fma_f32 v25, v25, v19, v19
  v_mfma_f32_16x16x32_bf16 v[84:87], a[176:179], a[100:103], v[84:87]
  ds_read_b64_tr_b16 a[170:171], v6 offset:30720
  v_rcp_f32 v25, v25
  v_mfma_f32_16x16x32_bf16 v[84:87], a[180:183], a[116:119], v[84:87]
  v_fma_f32 v26, v26, v19, v19
  v_rcp_f32 v26, v26
  v_mfma_f32_16x16x32_bf16 v[80:83], a[180:183], a[112:115], v[80:83]
  ds_read_b64_tr_b16 a[180:181], v6 offset:0
  v_fma_f32 v27, v27, v19, v19
  v_mul_f32 v52, v52, v24
  v_mfma_f32_16x16x32_bf16 v[80:83], a[176:179], a[96:99], v[80:83]
  s_waitcnt lgkmcnt(5)
  v_rcp_f32 v27, v27
  v_mul_f32 v53, v53, v25
  v_mfma_f32_16x16x32_bf16 v[64:67], a[164:167], a[128:131], v[64:67]
  ds_read_b64_tr_b16 a[182:183], v6 offset:2048
  v_mul_f32 v54, v54, v26
  v_mfma_f32_16x16x32_bf16 v[64:67], a[160:163], a[144:147], v[64:67]
  v_mul_f32 v55, v55, v27
  v_cvt_pk_bf16_f32 v36, v52, v53
  v_cvt_pk_bf16_f32 v37, v54, v55
  v_mfma_f32_16x16x32_bf16 v[68:71], a[160:163], a[148:151], v[68:71]
  ds_read_b64_tr_b16 a[176:177], v6 offset:4096
  v_fma_f32 v40, v40, v20, v28
  v_fma_f32 v41, v41, v20, v29
  v_mfma_f32_16x16x32_bf16 v[68:71], a[164:167], a[132:135], v[68:71]
  s_add_u32 s55, s59, 262144
  buffer_store_dwordx2 v[36:37], v1, s[8:11], s55 offen sc1
  v_mfma_f32_16x16x32_bf16 v[72:75], a[164:167], a[136:139], v[72:75]
  ds_read_b64_tr_b16 a[178:179], v6 offset:6144
  v_exp_f32 v24, v40
  v_mfma_f32_16x16x32_bf16 v[72:75], a[160:163], a[152:155], v[72:75]
  v_exp_f32 v25, v41
  v_mfma_f32_16x16x32_bf16 v[76:79], a[160:163], a[156:159], v[76:79]
  ds_read_b64_tr_b16 a[160:161], v6 offset:8192
  v_fma_f32 v42, v42, v20, v30
  v_fma_f32 v43, v43, v20, v31
  v_mfma_f32_16x16x32_bf16 v[76:79], a[164:167], a[140:143], v[76:79]
  s_waitcnt lgkmcnt(5)
  v_exp_f32 v26, v42
  v_mul_f32 v56, v40, v56
  v_mfma_f32_16x16x32_bf16 v[92:95], a[172:175], a[140:143], v[92:95]
  ds_read_b64_tr_b16 a[162:163], v6 offset:10240
  v_exp_f32 v27, v43
  v_mfma_f32_16x16x32_bf16 v[92:95], a[168:171], a[156:159], v[92:95]
  v_mul_f32 v57, v41, v57
  v_mul_f32 v58, v42, v58
  v_mul_f32 v59, v43, v59
  v_mfma_f32_16x16x32_bf16 v[88:91], a[168:171], a[152:155], v[88:91]
  ds_read_b64_tr_b16 a[164:165], v6 offset:12288
  v_fma_f32 v24, v24, v21, v21
  v_mfma_f32_16x16x32_bf16 v[88:91], a[172:175], a[136:139], v[88:91]
  v_rcp_f32 v24, v24
  v_fma_f32 v25, v25, v21, v21
  v_mfma_f32_16x16x32_bf16 v[84:87], a[172:175], a[132:135], v[84:87]
  ds_read_b64_tr_b16 a[166:167], v6 offset:14336
  v_rcp_f32 v25, v25
  v_mfma_f32_16x16x32_bf16 v[84:87], a[168:171], a[148:151], v[84:87]
  v_fma_f32 v26, v26, v21, v21
  v_rcp_f32 v26, v26
  v_mfma_f32_16x16x32_bf16 v[80:83], a[168:171], a[144:147], v[80:83]
  ds_read_b64_tr_b16 a[168:169], v7 offset:32768
  v_fma_f32 v27, v27, v21, v21
  v_mul_f32 v56, v56, v24
  v_mfma_f32_16x16x32_bf16 v[80:83], a[172:175], a[128:131], v[80:83]
  s_waitcnt lgkmcnt(5)
  v_rcp_f32 v27, v27
  v_mul_f32 v57, v57, v25
  v_mfma_f32_16x16x32_bf16 v[64:67], a[180:183], a[188:191], v[64:67]
  ds_read_b64_tr_b16 a[170:171], v7 offset:34816
  v_mul_f32 v58, v58, v26
  v_mfma_f32_16x16x32_bf16 v[64:67], a[176:179], a[204:207], v[64:67]
  v_mul_f32 v59, v59, v27
  v_cvt_pk_bf16_f32 v40, v56, v57
  v_cvt_pk_bf16_f32 v41, v58, v59
  v_mfma_f32_16x16x32_bf16 v[68:71], a[176:179], a[208:211], v[68:71]
  ds_read_b64_tr_b16 a[172:173], v7 offset:36864
  v_fma_f32 v44, v44, v22, v28
  v_fma_f32 v45, v45, v22, v29
  v_mfma_f32_16x16x32_bf16 v[68:71], a[180:183], a[192:195], v[68:71]
  s_add_u32 s55, s59, 524288
  buffer_store_dwordx2 v[40:41], v1, s[8:11], s55 offen sc1
  v_mfma_f32_16x16x32_bf16 v[72:75], a[180:183], a[196:199], v[72:75]
  ds_read_b64_tr_b16 a[174:175], v7 offset:38912
  v_exp_f32 v24, v44
  v_mfma_f32_16x16x32_bf16 v[72:75], a[176:179], a[212:215], v[72:75]
  v_exp_f32 v25, v45
  v_mfma_f32_16x16x32_bf16 v[76:79], a[176:179], a[216:219], v[76:79]
  ds_read_b64_tr_b16 a[176:177], v7 offset:40960
  v_fma_f32 v46, v46, v22, v30
  v_fma_f32 v47, v47, v22, v31
  v_mfma_f32_16x16x32_bf16 v[76:79], a[180:183], a[200:203], v[76:79]
  s_waitcnt lgkmcnt(5)
  v_exp_f32 v26, v46
  v_mul_f32 v60, v44, v60
  v_mfma_f32_16x16x32_bf16 v[92:95], a[160:163], a[200:203], v[92:95]
  ds_read_b64_tr_b16 a[178:179], v7 offset:43008
  v_exp_f32 v27, v47
  v_mfma_f32_16x16x32_bf16 v[92:95], a[164:167], a[216:219], v[92:95]
  v_mul_f32 v61, v45, v61
  v_mul_f32 v62, v46, v62
  v_mul_f32 v63, v47, v63
  v_mfma_f32_16x16x32_bf16 v[88:91], a[164:167], a[212:215], v[88:91]
  ds_read_b64_tr_b16 a[180:181], v7 offset:45056
  v_fma_f32 v24, v24, v23, v23
  v_mfma_f32_16x16x32_bf16 v[88:91], a[160:163], a[196:199], v[88:91]
  v_rcp_f32 v24, v24
  v_fma_f32 v25, v25, v23, v23
  v_mfma_f32_16x16x32_bf16 v[84:87], a[160:163], a[192:195], v[84:87]
  ds_read_b64_tr_b16 a[182:183], v7 offset:47104
  v_rcp_f32 v25, v25
  v_mfma_f32_16x16x32_bf16 v[84:87], a[164:167], a[208:211], v[84:87]
  v_fma_f32 v26, v26, v23, v23
  v_rcp_f32 v26, v26
  v_mfma_f32_16x16x32_bf16 v[80:83], a[164:167], a[204:207], v[80:83]
  ds_read_b64_tr_b16 a[164:165], v7 offset:49152
  v_fma_f32 v27, v27, v23, v23
  v_mul_f32 v60, v60, v24
  v_mfma_f32_16x16x32_bf16 v[80:83], a[160:163], a[188:191], v[80:83]
  s_waitcnt lgkmcnt(5)
  v_rcp_f32 v27, v27
  v_mul_f32 v61, v61, v25
  v_mfma_f32_16x16x32_bf16 v[96:99], a[168:171], a[64:67], v[96:99]
  ds_read_b64_tr_b16 a[166:167], v7 offset:51200
  v_mul_f32 v62, v62, v26
  v_mfma_f32_16x16x32_bf16 v[96:99], a[172:175], a[80:83], v[96:99]
  v_mul_f32 v63, v63, v27
  v_cvt_pk_bf16_f32 v44, v60, v61
  v_cvt_pk_bf16_f32 v45, v62, v63
  v_mfma_f32_16x16x32_bf16 v[100:103], a[172:175], a[84:87], v[100:103]
  ds_read_b64_tr_b16 a[160:161], v7 offset:53248
  ds_read_b128 v[60:63], v12 offset:768
  v_mfma_f32_16x16x32_bf16 v[100:103], a[168:171], a[68:71], v[100:103]
  s_add_u32 s55, s59, 786432
  buffer_store_dwordx2 v[44:45], v1, s[8:11], s55 offen sc1
  v_mfma_f32_16x16x32_bf16 v[104:107], a[168:171], a[72:75], v[104:107]
  ds_read_b64_tr_b16 a[162:163], v7 offset:55296
  v_mfma_f32_16x16x32_bf16 v[104:107], a[172:175], a[88:91], v[104:107]
  v_mfma_f32_16x16x32_bf16 v[108:111], a[172:175], a[92:95], v[108:111]
  ds_read_b64_tr_b16 a[172:173], v7 offset:57344
  v_mfma_f32_16x16x32_bf16 v[108:111], a[168:171], a[76:79], v[108:111]
  s_waitcnt lgkmcnt(6)
  v_mfma_f32_16x16x32_bf16 v[124:127], a[176:179], a[76:79], v[124:127]
  ds_read_b64_tr_b16 a[174:175], v7 offset:59392
  s_waitcnt lgkmcnt(3)
  v_fma_f32 v64, v64, v16, v60
  v_mfma_f32_16x16x32_bf16 v[124:127], a[180:183], a[92:95], v[124:127]
  v_exp_f32 v24, v64
  v_mfma_f32_16x16x32_bf16 v[120:123], a[180:183], a[88:91], v[120:123]
  ds_read_b64_tr_b16 a[168:169], v7 offset:61440
  v_fma_f32 v65, v65, v16, v61
  v_fma_f32 v66, v66, v16, v62
  v_mfma_f32_16x16x32_bf16 v[120:123], a[176:179], a[72:75], v[120:123]
  v_exp_f32 v25, v65
  v_mfma_f32_16x16x32_bf16 v[116:119], a[176:179], a[68:71], v[116:119]
  ds_read_b64_tr_b16 a[170:171], v7 offset:63488
  v_exp_f32 v26, v66
  v_mfma_f32_16x16x32_bf16 v[116:119], a[180:183], a[84:87], v[116:119]
  v_fma_f32 v67, v67, v16, v63
  v_fma_f32 v68, v68, v18, v60
  v_mfma_f32_16x16x32_bf16 v[112:115], a[180:183], a[80:83], v[112:115]
  ds_read_b64_tr_b16 a[180:181], v7 offset:16384
  v_exp_f32 v27, v67
  v_mfma_f32_16x16x32_bf16 v[112:115], a[176:179], a[64:67], v[112:115]
  s_waitcnt lgkmcnt(5)
  v_exp_f32 v28, v68
  v_fma_f32 v69, v69, v18, v61
  v_mfma_f32_16x16x32_bf16 v[96:99], a[164:167], a[96:99], v[96:99]
  ds_read_b64_tr_b16 a[182:183], v7 offset:18432
  v_fma_f32 v70, v70, v18, v62
  v_mfma_f32_16x16x32_bf16 v[96:99], a[160:163], a[112:115], v[96:99]
  v_exp_f32 v29, v69
  v_fma_f32 v71, v71, v18, v63
  v_mfma_f32_16x16x32_bf16 v[100:103], a[160:163], a[116:119], v[100:103]
  ds_read_b64_tr_b16 a[176:177], v7 offset:20480
  v_mul_f32 v80, v64, v80
  v_mfma_f32_16x16x32_bf16 v[100:103], a[164:167], a[100:103], v[100:103]
  v_mul_f32 v81, v65, v81
  v_mul_f32 v82, v66, v82
  v_mul_f32 v83, v67, v83
  v_mfma_f32_16x16x32_bf16 v[104:107], a[164:167], a[104:107], v[104:107]
  ds_read_b64_tr_b16 a[178:179], v7 offset:22528
  v_mul_f32 v84, v68, v84
  v_mfma_f32_16x16x32_bf16 v[104:107], a[160:163], a[120:123], v[104:107]
  v_lshrrev_b32 v48, 3, v0
  v_bfe_u32 v49, v48, 1, 2
  v_bfe_u32 v50, v0, 1, 2
  v_mfma_f32_16x16x32_bf16 v[108:111], a[160:163], a[124:127], v[108:111]
  ds_read_b64_tr_b16 a[160:161], v7 offset:24576
  v_xor_b32 v49, v49, v50
  v_mfma_f32_16x16x32_bf16 v[108:111], a[164:167], a[108:111], v[108:111]
  s_waitcnt lgkmcnt(5)
  v_lshlrev_b32 v49, 5, v49
  v_and_b32 v50, 1, v0
  v_lshl_add_u32 v49, v50, 4, v49
  v_mfma_f32_16x16x32_bf16 v[124:127], a[172:175], a[108:111], v[124:127]
  ds_read_b64_tr_b16 a[162:163], v7 offset:26624
  v_exp_f32 v30, v70
  v_mfma_f32_16x16x32_bf16 v[124:127], a[168:171], a[124:127], v[124:127]
  s_lshl_b32 s53, s44, 3
  v_exp_f32 v31, v71
  v_mfma_f32_16x16x32_bf16 v[120:123], a[168:171], a[120:123], v[120:123]
  ds_read_b64_tr_b16 a[164:165], v7 offset:28672
  v_add_u32 v48, s53, v48
  v_lshl_add_u32 v48, v48, 11, v49
  v_mfma_f32_16x16x32_bf16 v[120:123], a[172:175], a[104:107], v[120:123]
  s_mul_i32 s53, s52, 1835008
  s_lshl_b32 s54, s51, 7
  s_add_u32 s53, s53, s54
  v_mfma_f32_16x16x32_bf16 v[116:119], a[172:175], a[100:103], v[116:119]
  ds_read_b64_tr_b16 a[166:167], v7 offset:30720
  v_add_u32 v33, s53, v48
  v_xor_b32 v32, 128, v33
  v_mfma_f32_16x16x32_bf16 v[116:119], a[168:171], a[116:119], v[116:119]
  v_and_b32 v48, 3, v0
  v_bfe_u32 v49, v0, 2, 1
  v_mfma_f32_16x16x32_bf16 v[112:115], a[168:171], a[112:115], v[112:115]
  ds_read_b64_tr_b16 a[168:169], v7 offset:0
  v_lshl_add_u32 v48, v48, 3, v49
  v_lshlrev_b32 v37, 7, v48
  v_mfma_f32_16x16x32_bf16 v[112:115], a[172:175], a[96:99], v[112:115]
  s_waitcnt lgkmcnt(5)
  v_mul_f32 v85, v69, v85
  v_mul_f32 v86, v70, v86
  v_mul_f32 v87, v71, v87
  v_mfma_f32_16x16x32_bf16 v[96:99], a[180:183], a[128:131], v[96:99]
  ds_read_b64_tr_b16 a[170:171], v7 offset:2048
  v_fma_f32 v24, v24, v17, v17
  v_mfma_f32_16x16x32_bf16 v[96:99], a[176:179], a[144:147], v[96:99]
  v_rcp_f32 v24, v24
  v_fma_f32 v25, v25, v17, v17
  v_mfma_f32_16x16x32_bf16 v[100:103], a[176:179], a[148:151], v[100:103]
  ds_read_b64_tr_b16 a[172:173], v7 offset:4096
  v_fma_f32 v26, v26, v17, v17
  v_mfma_f32_16x16x32_bf16 v[100:103], a[180:183], a[132:135], v[100:103]
  v_rcp_f32 v25, v25
  v_fma_f32 v27, v27, v17, v17
  v_mfma_f32_16x16x32_bf16 v[104:107], a[180:183], a[136:139], v[104:107]
  ds_read_b64_tr_b16 a[174:175], v7 offset:6144
  v_fma_f32 v28, v28, v19, v19
  v_mfma_f32_16x16x32_bf16 v[104:107], a[176:179], a[152:155], v[104:107]
  v_rcp_f32 v26, v26
  v_fma_f32 v29, v29, v19, v19
  v_mfma_f32_16x16x32_bf16 v[108:111], a[176:179], a[156:159], v[108:111]
  ds_read_b64_tr_b16 a[176:177], v7 offset:8192
  v_fma_f32 v30, v30, v19, v19
  v_mfma_f32_16x16x32_bf16 v[108:111], a[180:183], a[140:143], v[108:111]
  s_waitcnt lgkmcnt(5)
  v_rcp_f32 v27, v27
  v_fma_f32 v31, v31, v19, v19
  v_mfma_f32_16x16x32_bf16 v[124:127], a[160:163], a[140:143], v[124:127]
  ds_read_b64_tr_b16 a[178:179], v7 offset:10240
  v_rcp_f32 v28, v28
  v_mfma_f32_16x16x32_bf16 v[124:127], a[164:167], a[156:159], v[124:127]
  v_rcp_f32 v29, v29
  v_mfma_f32_16x16x32_bf16 v[120:123], a[164:167], a[152:155], v[120:123]
  ds_read_b64_tr_b16 a[180:181], v7 offset:12288
  v_rcp_f32 v30, v30
  v_mfma_f32_16x16x32_bf16 v[120:123], a[160:163], a[136:139], v[120:123]
  v_rcp_f32 v31, v31
  v_mfma_f32_16x16x32_bf16 v[116:119], a[160:163], a[132:135], v[116:119]
  ds_read_b64_tr_b16 a[182:183], v7 offset:14336
  v_mul_f32 v80, v80, v24
  v_mul_f32 v81, v81, v25
  v_mfma_f32_16x16x32_bf16 v[116:119], a[164:167], a[148:151], v[116:119]
  s_waitcnt vmcnt(17)
  s_barrier
  v_mfma_f32_16x16x32_bf16 v[112:115], a[164:167], a[144:147], v[112:115]
  ds_read_b64_tr_b16 a[164:165], v2 offset:16384
  s_add_u32 m0, s45, 98304
  v_mul_f32 v82, v82, v26
  v_mfma_f32_16x16x32_bf16 v[112:115], a[160:163], a[128:131], v[112:115]
  s_waitcnt lgkmcnt(5)
  buffer_load_dwordx4 v10, s[28:31], s70 offen lds
  v_mul_f32 v83, v83, v27
  v_mul_f32 v84, v84, v28
  v_mfma_f32_16x16x32_bf16 v[96:99], a[168:171], a[188:191], v[96:99]
  ds_read_b64_tr_b16 a[166:167], v2 offset:18432
  v_mul_f32 v85, v85, v29
  v_mfma_f32_16x16x32_bf16 v[96:99], a[172:175], a[204:207], v[96:99]
  s_add_u32 m0, s45, 106496
  v_mul_f32 v86, v86, v30
  v_mul_f32 v87, v87, v31
  v_cvt_pk_bf16_f32 v64, v80, v81
  v_mfma_f32_16x16x32_bf16 v[100:103], a[172:175], a[208:211], v[100:103]
  ds_read_b64_tr_b16 a[160:161], v2 offset:20480
  v_cvt_pk_bf16_f32 v65, v82, v83
  v_mfma_f32_16x16x32_bf16 v[100:103], a[168:171], a[192:195], v[100:103]
  buffer_load_dwordx4 v10, s[32:35], s70 offen lds
  v_cvt_pk_bf16_f32 v68, v84, v85
  v_cvt_pk_bf16_f32 v69, v86, v87
  v_fma_f32 v72, v72, v20, v60
  v_mfma_f32_16x16x32_bf16 v[104:107], a[168:171], a[196:199], v[104:107]
  ds_read_b64_tr_b16 a[162:163], v2 offset:22528
  v_fma_f32 v73, v73, v20, v61
  v_mfma_f32_16x16x32_bf16 v[104:107], a[172:175], a[212:215], v[104:107]
  s_add_u32 m0, s45, 102400
  s_add_u32 s60, s70, 229376
  v_exp_f32 v24, v72
  v_mfma_f32_16x16x32_bf16 v[108:111], a[172:175], a[216:219], v[108:111]
  ds_read_b64_tr_b16 a[172:173], v2 offset:24576
  v_fma_f32 v74, v74, v20, v62
  v_mfma_f32_16x16x32_bf16 v[108:111], a[168:171], a[200:203], v[108:111]
  s_waitcnt lgkmcnt(5)
  buffer_load_dwordx4 v10, s[28:31], s60 offen lds
  v_exp_f32 v25, v73
  v_mfma_f32_16x16x32_bf16 v[124:127], a[176:179], a[200:203], v[124:127]
  ds_read_b64_tr_b16 a[174:175], v2 offset:26624
  s_waitcnt vmcnt(8)
  s_barrier
  v_mfma_f32_16x16x32_bf16 v[124:127], a[180:183], a[216:219], v[124:127]
  s_add_u32 m0, s45, 110592
  s_add_u32 s60, s70, 229376
  v_fma_f32 v75, v75, v20, v63
  v_mfma_f32_16x16x32_bf16 v[120:123], a[180:183], a[212:215], v[120:123]
  ds_read_b64_tr_b16 a[168:169], v2 offset:28672
  v_exp_f32 v26, v74
  v_mfma_f32_16x16x32_bf16 v[120:123], a[176:179], a[196:199], v[120:123]
  buffer_load_dwordx4 v10, s[32:35], s60 offen lds
  v_exp_f32 v27, v75
  v_mfma_f32_16x16x32_bf16 v[116:119], a[176:179], a[192:195], v[116:119]
  ds_read_b64_tr_b16 a[170:171], v2 offset:30720
  v_fma_f32 v76, v76, v22, v60
  v_fma_f32 v77, v77, v22, v61
  v_mfma_f32_16x16x32_bf16 v[116:119], a[180:183], a[208:211], v[116:119]
  v_exp_f32 v28, v76
  v_mfma_f32_16x16x32_bf16 v[112:115], a[180:183], a[204:207], v[112:115]
  ds_read_b64_tr_b16 a[180:181], v3 offset:16384
  v_exp_f32 v29, v77
  v_mfma_f32_16x16x32_bf16 v[112:115], a[176:179], a[188:191], v[112:115]
  s_waitcnt lgkmcnt(5)
  v_fma_f32 v78, v78, v22, v62
  v_exp_f32 v30, v78
  v_mfma_f32_16x16x32_bf16 v[128:131], a[164:167], a[32:35], v[128:131]
  ds_read_b64_tr_b16 a[182:183], v3 offset:18432
  v_fma_f32 v79, v79, v22, v63
  v_mfma_f32_16x16x32_bf16 v[128:131], a[160:163], a[48:51], v[128:131]
  v_exp_f32 v31, v79
  v_mul_f32 v88, v72, v88
  v_mfma_f32_16x16x32_bf16 v[132:135], a[160:163], a[52:55], v[132:135]
  ds_read_b64_tr_b16 a[176:177], v3 offset:20480
  v_mul_f32 v89, v73, v89
  v_mfma_f32_16x16x32_bf16 v[132:135], a[164:167], a[36:39], v[132:135]
  ds_read_b128 v[60:63], v12 offset:832
  v_mul_f32 v90, v74, v90
  v_mul_f32 v91, v75, v91
  v_mfma_f32_16x16x32_bf16 v[136:139], a[164:167], a[40:43], v[136:139]
  ds_read_b64_tr_b16 a[178:179], v3 offset:22528
  v_mul_f32 v92, v76, v92
  v_mfma_f32_16x16x32_bf16 v[136:139], a[160:163], a[56:59], v[136:139]
  v_mul_f32 v93, v77, v93
  v_mul_f32 v94, v78, v94
  v_mul_f32 v95, v79, v95
  v_mfma_f32_16x16x32_bf16 v[140:143], a[160:163], a[60:63], v[140:143]
  ds_read_b64_tr_b16 a[160:161], v3 offset:24576
  v_fma_f32 v24, v24, v21, v21
  v_mfma_f32_16x16x32_bf16 v[140:143], a[164:167], a[44:47], v[140:143]
  s_waitcnt lgkmcnt(6)
  v_rcp_f32 v24, v24
  v_fma_f32 v25, v25, v21, v21
  v_mfma_f32_16x16x32_bf16 v[156:159], a[172:175], a[44:47], v[156:159]
  ds_read_b64_tr_b16 a[162:163], v3 offset:26624
  v_rcp_f32 v25, v25
  v_mfma_f32_16x16x32_bf16 v[156:159], a[168:171], a[60:63], v[156:159]
  v_fma_f32 v26, v26, v21, v21
  v_fma_f32 v27, v27, v21, v21
  v_mfma_f32_16x16x32_bf16 v[152:155], a[168:171], a[56:59], v[152:155]
  ds_read_b64_tr_b16 a[164:165], v3 offset:28672
  v_rcp_f32 v26, v26
  v_mfma_f32_16x16x32_bf16 v[152:155], a[172:175], a[40:43], v[152:155]
  v_rcp_f32 v27, v27
  v_mfma_f32_16x16x32_bf16 v[148:151], a[172:175], a[36:39], v[148:151]
  ds_read_b64_tr_b16 a[166:167], v3 offset:30720
  v_fma_f32 v28, v28, v23, v23
  v_fma_f32 v29, v29, v23, v23
  v_mfma_f32_16x16x32_bf16 v[148:151], a[168:171], a[52:55], v[148:151]
  v_rcp_f32 v28, v28
  v_mfma_f32_16x16x32_bf16 v[144:147], a[168:171], a[48:51], v[144:147]
  ds_read_b64_tr_b16 a[168:169], v4 offset:16384
  v_rcp_f32 v29, v29
  v_mfma_f32_16x16x32_bf16 v[144:147], a[172:175], a[32:35], v[144:147]
  s_waitcnt lgkmcnt(5)
  v_fma_f32 v30, v30, v23, v23
  v_rcp_f32 v30, v30
  v_mfma_f32_16x16x32_bf16 v[160:163], a[180:183], a[32:35], v[160:163]
  ds_read_b64_tr_b16 a[170:171], v4 offset:18432
  v_fma_f32 v31, v31, v23, v23
  v_mfma_f32_16x16x32_bf16 v[160:163], a[176:179], a[48:51], v[160:163]
  v_rcp_f32 v31, v31
  v_mul_f32 v88, v88, v24
  v_mfma_f32_16x16x32_bf16 v[164:167], a[176:179], a[52:55], v[164:167]
  ds_read_b64_tr_b16 a[172:173], v4 offset:20480
  v_mul_f32 v89, v89, v25
  v_mfma_f32_16x16x32_bf16 v[164:167], a[180:183], a[36:39], v[164:167]
  v_mul_f32 v90, v90, v26
  v_mul_f32 v91, v91, v27
  v_mul_f32 v92, v92, v28
  v_mfma_f32_16x16x32_bf16 v[168:171], a[180:183], a[40:43], v[168:171]
  ds_read_b64_tr_b16 a[174:175], v4 offset:22528
  v_mul_f32 v93, v93, v29
  v_mfma_f32_16x16x32_bf16 v[168:171], a[176:179], a[56:59], v[168:171]
  v_mul_f32 v94, v94, v30
  v_mul_f32 v95, v95, v31
  v_cvt_pk_bf16_f32 v72, v88, v89
  v_mfma_f32_16x16x32_bf16 v[172:175], a[176:179], a[60:63], v[172:175]
  ds_read_b64_tr_b16 a[176:177], v4 offset:24576
  v_cvt_pk_bf16_f32 v73, v90, v91
  v_mfma_f32_16x16x32_bf16 v[172:175], a[180:183], a[44:47], v[172:175]
  s_waitcnt lgkmcnt(5)
  v_cvt_pk_bf16_f32 v76, v92, v93
  v_cvt_pk_bf16_f32 v77, v94, v95
  v_mfma_f32_16x16x32_bf16 v[188:191], a[160:163], a[44:47], v[188:191]
  ds_read_b64_tr_b16 a[178:179], v4 offset:26624
  s_cmp_eq_u32 s90, 0
  s_cselect_b32 s71, 8, 1
  s_lshl_b32 s63, s71, 17
  s_lshl_b32 s71, s71, 11
  s_add_u32 s71, s71, s83
  s_add_u32 m0, s45, 114688
  s_waitcnt lgkmcnt(11)
  v_mfma_f32_16x16x32_bf16 v[188:191], a[164:167], a[60:63], v[188:191]
  buffer_load_dwordx4 v32, s[36:39], s63 offen lds
  v_fma_f32 v96, v96, v16, v60
  v_exp_f32 v24, v96
  v_mfma_f32_16x16x32_bf16 v[184:187], a[164:167], a[56:59], v[184:187]
  ds_read_b64_tr_b16 a[180:181], v4 offset:28672
  v_fma_f32 v97, v97, v16, v61
  v_fma_f32 v98, v98, v16, v62
  v_mfma_f32_16x16x32_bf16 v[184:187], a[160:163], a[40:43], v[184:187]
  s_add_u32 m0, s45, 118784
  s_add_u32 s60, s63, 65536
  v_exp_f32 v25, v97
  v_mfma_f32_16x16x32_bf16 v[180:183], a[160:163], a[36:39], v[180:183]
  ds_read_b64_tr_b16 a[182:183], v4 offset:30720
  v_exp_f32 v26, v98
  v_mfma_f32_16x16x32_bf16 v[180:183], a[164:167], a[52:55], v[180:183]
  buffer_load_dwordx4 v32, s[36:39], s60 offen lds
  v_fma_f32 v99, v99, v16, v63
  v_exp_f32 v27, v99
  v_mfma_f32_16x16x32_bf16 v[176:179], a[164:167], a[48:51], v[176:179]
  ds_read_b64_tr_b16 a[164:165], v5 offset:16384
  v_fma_f32 v100, v100, v18, v60
  v_fma_f32 v101, v101, v18, v61
  v_mfma_f32_16x16x32_bf16 v[176:179], a[160:163], a[32:35], v[176:179]
  s_waitcnt lgkmcnt(5)
  s_add_u32 m0, s45, 122880
  v_exp_f32 v28, v100
  v_mfma_f32_16x16x32_bf16 v[192:195], a[168:171], a[32:35], v[192:195]
  ds_read_b64_tr_b16 a[166:167], v5 offset:18432
  v_fma_f32 v102, v102, v18, v62
  v_mfma_f32_16x16x32_bf16 v[192:195], a[172:175], a[48:51], v[192:195]
  buffer_load_dwordx4 v33, s[36:39], s63 offen lds
  v_exp_f32 v29, v101
  v_fma_f32 v103, v103, v18, v63
  v_mfma_f32_16x16x32_bf16 v[196:199], a[172:175], a[52:55], v[196:199]
  ds_read_b64_tr_b16 a[160:161], v5 offset:20480
  v_exp_f32 v30, v102
  v_mfma_f32_16x16x32_bf16 v[196:199], a[168:171], a[36:39], v[196:199]
  s_add_u32 m0, s45, 126976
  s_add_u32 s60, s63, 65536
  v_exp_f32 v31, v103
  v_mfma_f32_16x16x32_bf16 v[200:203], a[168:171], a[40:43], v[200:203]
  ds_read_b64_tr_b16 a[162:163], v5 offset:22528
  v_mul_f32 v112, v96, v112
  v_mul_f32 v113, v97, v113
  v_mfma_f32_16x16x32_bf16 v[200:203], a[172:175], a[56:59], v[200:203]
  buffer_load_dwordx4 v33, s[36:39], s60 offen lds
  v_mul_f32 v114, v98, v114
  v_mul_f32 v115, v99, v115
  v_mul_f32 v116, v100, v116
  v_mfma_f32_16x16x32_bf16 v[204:207], a[172:175], a[60:63], v[204:207]
  ds_read_b64_tr_b16 a[172:173], v5 offset:24576
HOP14:
  s_cbranch_execz HOP18
  v_mul_f32 v117, v101, v117
  v_mul_f32 v118, v102, v118
  v_mfma_f32_16x16x32_bf16 v[204:207], a[168:171], a[44:47], v[204:207]
  s_waitcnt lgkmcnt(5)
  s_cmp_eq_u32 s90, 1
  s_cselect_b32 s72, 10, 3
  s_lshl_b32 s64, s72, 17
  s_lshl_b32 s72, s72, 11
  s_add_u32 s72, s72, s83
  s_add_u32 m0, s45, 81920
  v_mul_f32 v119, v103, v119
  v_fma_f32 v24, v24, v17, v17
  v_mfma_f32_16x16x32_bf16 v[220:223], a[176:179], a[44:47], v[220:223]
  ds_read_b64_tr_b16 a[174:175], v5 offset:26624
  v_rcp_f32 v24, v24
  v_mfma_f32_16x16x32_bf16 v[220:223], a[180:183], a[60:63], v[220:223]
  buffer_load_dwordx4 v32, s[36:39], s64 offen lds
  v_fma_f32 v25, v25, v17, v17
  v_rcp_f32 v25, v25
  v_mfma_f32_16x16x32_bf16 v[216:219], a[180:183], a[56:59], v[216:219]
  ds_read_b64_tr_b16 a[168:169], v5 offset:28672
  v_fma_f32 v26, v26, v17, v17
  v_fma_f32 v27, v27, v17, v17
  v_mfma_f32_16x16x32_bf16 v[216:219], a[176:179], a[40:43], v[216:219]
  s_add_u32 m0, s45, 86016
  s_add_u32 s60, s64, 65536
  v_rcp_f32 v26, v26
  v_mfma_f32_16x16x32_bf16 v[212:215], a[176:179], a[36:39], v[212:215]
  ds_read_b64_tr_b16 a[170:171], v5 offset:30720
  v_rcp_f32 v27, v27
  v_mfma_f32_16x16x32_bf16 v[212:215], a[180:183], a[52:55], v[212:215]
  buffer_load_dwordx4 v32, s[36:39], s60 offen lds
  v_fma_f32 v28, v28, v19, v19
  v_rcp_f32 v28, v28
  v_mfma_f32_16x16x32_bf16 v[208:211], a[180:183], a[48:51], v[208:211]
  ds_read_b64_tr_b16 a[180:181], v2 offset:32768
  v_fma_f32 v29, v29, v19, v19
  v_fma_f32 v30, v30, v19, v19
  v_mfma_f32_16x16x32_bf16 v[208:211], a[176:179], a[32:35], v[208:211]
  s_waitcnt lgkmcnt(5)
  s_add_u32 m0, s45, 90112
  v_rcp_f32 v29, v29
  v_mfma_f32_16x16x32_bf16 v[224:227], a[164:167], a[32:35], v[224:227]
  ds_read_b64_tr_b16 a[182:183], v2 offset:34816
  v_fma_f32 v31, v31, v19, v19
  v_mfma_f32_16x16x32_bf16 v[224:227], a[160:163], a[48:51], v[224:227]
  buffer_load_dwordx4 v33, s[36:39], s64 offen lds
  v_rcp_f32 v30, v30
  v_mul_f32 v112, v112, v24
  v_mfma_f32_16x16x32_bf16 v[228:231], a[160:163], a[52:55], v[228:231]
  ds_read_b64_tr_b16 a[176:177], v2 offset:36864
  v_rcp_f32 v31, v31
  v_mfma_f32_16x16x32_bf16 v[228:231], a[164:167], a[36:39], v[228:231]
  s_add_u32 m0, s45, 94208
  s_add_u32 s60, s64, 65536
  v_mul_f32 v113, v113, v25
  v_mul_f32 v114, v114, v26
  v_mfma_f32_16x16x32_bf16 v[232:235], a[164:167], a[40:43], v[232:235]
  ds_read_b64_tr_b16 a[178:179], v2 offset:38912
  v_mul_f32 v115, v115, v27
  v_mul_f32 v116, v116, v28
  v_mfma_f32_16x16x32_bf16 v[232:235], a[160:163], a[56:59], v[232:235]
  buffer_load_dwordx4 v33, s[36:39], s60 offen lds
  v_mul_f32 v117, v117, v29
  v_mul_f32 v118, v118, v30
  v_mul_f32 v119, v119, v31
  v_mfma_f32_16x16x32_bf16 v[236:239], a[160:163], a[60:63], v[236:239]
  ds_read_b64_tr_b16 a[160:161], v2 offset:40960
  v_cvt_pk_bf16_f32 v66, v112, v113
  v_cvt_pk_bf16_f32 v67, v114, v115
  v_mfma_f32_16x16x32_bf16 v[236:239], a[164:167], a[44:47], v[236:239]
  s_waitcnt lgkmcnt(5)
  s_cmp_eq_u32 s90, 2
  s_cselect_b32 s73, 12, 5
  s_lshl_b32 s65, s73, 17
  s_lshl_b32 s73, s73, 11
  s_add_u32 s73, s73, s83
  s_add_u32 m0, s45, 65536
  v_cvt_pk_bf16_f32 v70, v116, v117
  v_cvt_pk_bf16_f32 v71, v118, v119
  v_mfma_f32_16x16x32_bf16 v[252:255], a[172:175], a[44:47], v[252:255]
  ds_read_b64_tr_b16 a[162:163], v2 offset:43008
  v_fma_f32 v104, v104, v20, v60
  v_fma_f32 v105, v105, v20, v61
  v_mfma_f32_16x16x32_bf16 v[252:255], a[168:171], a[60:63], v[252:255]
  buffer_load_dwordx4 v32, s[36:39], s65 offen lds
  buffer_store_dwordx4 v[64:67], v1, s[8:11], s58 offen offset:0 sc1
  v_mfma_f32_16x16x32_bf16 v[248:251], a[168:171], a[56:59], v[248:251]
  ds_read_b64_tr_b16 a[164:165], v2 offset:45056
  v_exp_f32 v24, v104
  v_mfma_f32_16x16x32_bf16 v[248:251], a[172:175], a[40:43], v[248:251]
  s_add_u32 m0, s45, 69632
  s_add_u32 s60, s65, 65536
  v_exp_f32 v25, v105
  v_mfma_f32_16x16x32_bf16 v[244:247], a[172:175], a[36:39], v[244:247]
  ds_read_b64_tr_b16 a[166:167], v2 offset:47104
  s_add_u32 s55, s58, 262144
  buffer_store_dwordx4 v[68:71], v1, s[8:11], s55 offen offset:0 sc1
  v_mfma_f32_16x16x32_bf16 v[244:247], a[168:171], a[52:55], v[244:247]
  buffer_load_dwordx4 v32, s[36:39], s60 offen lds
  v_fma_f32 v106, v106, v20, v62
  v_exp_f32 v26, v106
  v_mfma_f32_16x16x32_bf16 v[240:243], a[168:171], a[48:51], v[240:243]
  ds_read_b64_tr_b16 a[168:169], v2 offset:49152
  v_fma_f32 v107, v107, v20, v63
  v_fma_f32 v108, v108, v22, v60
  v_mfma_f32_16x16x32_bf16 v[240:243], a[172:175], a[32:35], v[240:243]
  s_waitcnt lgkmcnt(5)
  s_add_u32 m0, s45, 73728
  v_exp_f32 v27, v107
  v_mfma_f32_16x16x32_bf16 v[128:131], a[180:183], a[64:67], v[128:131]
  ds_read_b64_tr_b16 a[170:171], v2 offset:51200
  v_fma_f32 v109, v109, v22, v61
  v_mfma_f32_16x16x32_bf16 v[128:131], a[176:179], a[80:83], v[128:131]
  buffer_load_dwordx4 v33, s[36:39], s65 offen lds
  v_exp_f32 v28, v108
  v_fma_f32 v110, v110, v22, v62
  v_mfma_f32_16x16x32_bf16 v[132:135], a[176:179], a[84:87], v[132:135]
  ds_read_b64_tr_b16 a[172:173], v2 offset:53248
  v_exp_f32 v29, v109
  v_mfma_f32_16x16x32_bf16 v[132:135], a[180:183], a[68:71], v[132:135]
  s_add_u32 m0, s45, 77824
  s_add_u32 s60, s65, 65536
  v_exp_f32 v30, v110
  v_mfma_f32_16x16x32_bf16 v[136:139], a[180:183], a[72:75], v[136:139]
  ds_read_b64_tr_b16 a[174:175], v2 offset:55296
  v_fma_f32 v111, v111, v22, v63
  v_mul_f32 v120, v104, v120
  v_mfma_f32_16x16x32_bf16 v[136:139], a[176:179], a[88:91], v[136:139]
  buffer_load_dwordx4 v33, s[36:39], s60 offen lds
  v_exp_f32 v31, v111
  v_mul_f32 v121, v105, v121
  v_mfma_f32_16x16x32_bf16 v[140:143], a[176:179], a[92:95], v[140:143]
  ds_read_b64_tr_b16 a[176:177], v2 offset:57344
  ds_read_b128 v[60:63], v12 offset:512
  v_mfma_f32_16x16x32_bf16 v[140:143], a[180:183], a[76:79], v[140:143]
  s_waitcnt lgkmcnt(6)
  v_mul_f32 v122, v106, v122
  v_mul_f32 v123, v107, v123
  v_mul_f32 v124, v108, v124
  v_mfma_f32_16x16x32_bf16 v[156:159], a[160:163], a[76:79], v[156:159]
  ds_read_b64_tr_b16 a[178:179], v2 offset:59392
  v_mul_f32 v125, v109, v125
  v_mul_f32 v126, v110, v126
  v_mfma_f32_16x16x32_bf16 v[156:159], a[164:167], a[92:95], v[156:159]
  v_mul_f32 v127, v111, v127
  v_fma_f32 v24, v24, v21, v21
  v_fma_f32 v25, v25, v21, v21
  v_mfma_f32_16x16x32_bf16 v[152:155], a[164:167], a[88:91], v[152:155]
  ds_read_b64_tr_b16 a[180:181], v2 offset:61440
  v_rcp_f32 v24, v24
  v_mfma_f32_16x16x32_bf16 v[152:155], a[160:163], a[72:75], v[152:155]
  v_rcp_f32 v25, v25
  v_fma_f32 v26, v26, v21, v21
  v_mfma_f32_16x16x32_bf16 v[148:151], a[160:163], a[68:71], v[148:151]
  ds_read_b64_tr_b16 a[182:183], v2 offset:63488
  v_rcp_f32 v26, v26
  v_mfma_f32_16x16x32_bf16 v[148:151], a[164:167], a[84:87], v[148:151]
  v_fma_f32 v27, v27, v21, v21
  v_rcp_f32 v27, v27
  v_mfma_f32_16x16x32_bf16 v[144:147], a[164:167], a[80:83], v[144:147]
  ds_read_b64_tr_b16 a[164:165], v2 offset:0
  v_fma_f32 v28, v28, v23, v23
  v_fma_f32 v29, v29, v23, v23
  v_mfma_f32_16x16x32_bf16 v[144:147], a[160:163], a[64:67], v[144:147]
  s_waitcnt lgkmcnt(6)
  v_rcp_f32 v28, v28
  v_fma_f32 v30, v30, v23, v23
  v_mfma_f32_16x16x32_bf16 v[128:131], a[168:171], a[96:99], v[128:131]
  ds_read_b64_tr_b16 a[166:167], v2 offset:2048
  v_fma_f32 v31, v31, v23, v23
  v_mfma_f32_16x16x32_bf16 v[128:131], a[172:175], a[112:115], v[128:131]
  v_rcp_f32 v29, v29
  v_mul_f32 v120, v120, v24
  v_mfma_f32_16x16x32_bf16 v[132:135], a[172:175], a[116:119], v[132:135]
  ds_read_b64_tr_b16 a[160:161], v2 offset:4096
  v_rcp_f32 v30, v30
  v_mfma_f32_16x16x32_bf16 v[132:135], a[168:171], a[100:103], v[132:135]
  v_rcp_f32 v31, v31
  v_mul_f32 v121, v121, v25
  v_mfma_f32_16x16x32_bf16 v[136:139], a[168:171], a[104:107], v[136:139]
  ds_read_b64_tr_b16 a[162:163], v2 offset:6144
  v_mul_f32 v122, v122, v26
  v_mul_f32 v123, v123, v27
  v_mfma_f32_16x16x32_bf16 v[136:139], a[172:175], a[120:123], v[136:139]
  v_mul_f32 v124, v124, v28
  v_mul_f32 v125, v125, v29
  v_mul_f32 v126, v126, v30
  v_mfma_f32_16x16x32_bf16 v[140:143], a[172:175], a[124:127], v[140:143]
  ds_read_b64_tr_b16 a[172:173], v2 offset:8192
  v_mul_f32 v127, v127, v31
  v_cvt_pk_bf16_f32 v74, v120, v121
  v_mfma_f32_16x16x32_bf16 v[140:143], a[168:171], a[108:111], v[140:143]
  s_waitcnt lgkmcnt(5)
  v_cvt_pk_bf16_f32 v75, v122, v123
  v_cvt_pk_bf16_f32 v78, v124, v125
  v_cvt_pk_bf16_f32 v79, v126, v127
  v_mfma_f32_16x16x32_bf16 v[156:159], a[176:179], a[108:111], v[156:159]
  ds_read_b64_tr_b16 a[174:175], v2 offset:10240
  v_mfma_f32_16x16x32_bf16 v[156:159], a[180:183], a[124:127], v[156:159]
  s_add_u32 s55, s58, 524288
  buffer_store_dwordx4 v[72:75], v1, s[8:11], s55 offen offset:0 sc1
  v_mfma_f32_16x16x32_bf16 v[152:155], a[180:183], a[120:123], v[152:155]
  ds_read_b64_tr_b16 a[168:169], v2 offset:12288
  v_mfma_f32_16x16x32_bf16 v[152:155], a[176:179], a[104:107], v[152:155]
  s_add_u32 s55, s58, 786432
  buffer_store_dwordx4 v[76:79], v1, s[8:11], s55 offen offset:0 sc1
  v_mfma_f32_16x16x32_bf16 v[148:151], a[176:179], a[100:103], v[148:151]
  ds_read_b64_tr_b16 a[170:171], v2 offset:14336
  v_mfma_f32_16x16x32_bf16 v[148:151], a[180:183], a[116:119], v[148:151]
  s_waitcnt vmcnt(16)
  s_barrier
  v_mfma_f32_16x16x32_bf16 v[144:147], a[180:183], a[112:115], v[144:147]
  ds_read_b64_tr_b16 a[180:181], v6 offset:32768
  s_cmp_eq_u32 s90, 0
  s_cselect_b32 s74, 1, 8
  s_lshl_b32 s66, s74, 17
  s_lshl_b32 s74, s74, 11
  s_add_u32 s74, s74, s83
  s_add_u32 m0, s45, 16384
  v_mfma_f32_16x16x32_bf16 v[144:147], a[176:179], a[96:99], v[144:147]
  s_waitcnt lgkmcnt(5)
  buffer_load_dwordx4 v32, s[36:39], s66 offen lds
  v_mfma_f32_16x16x32_bf16 v[128:131], a[164:167], a[128:131], v[128:131]
  ds_read_b64_tr_b16 a[182:183], v6 offset:34816
  v_mfma_f32_16x16x32_bf16 v[128:131], a[160:163], a[144:147], v[128:131]
  s_add_u32 m0, s45, 20480
  s_add_u32 s60, s66, 65536
  v_mfma_f32_16x16x32_bf16 v[132:135], a[160:163], a[148:151], v[132:135]
  ds_read_b64_tr_b16 a[176:177], v6 offset:36864
  v_mfma_f32_16x16x32_bf16 v[132:135], a[164:167], a[132:135], v[132:135]
  buffer_load_dwordx4 v32, s[36:39], s60 offen lds
  v_mfma_f32_16x16x32_bf16 v[136:139], a[164:167], a[136:139], v[136:139]
  ds_read_b64_tr_b16 a[178:179], v6 offset:38912
  v_mfma_f32_16x16x32_bf16 v[136:139], a[160:163], a[152:155], v[136:139]
  s_add_u32 m0, s45, 24576
  v_mfma_f32_16x16x32_bf16 v[140:143], a[160:163], a[156:159], v[140:143]
  ds_read_b64_tr_b16 a[160:161], v6 offset:40960
  v_mfma_f32_16x16x32_bf16 v[140:143], a[164:167], a[140:143], v[140:143]
  s_waitcnt lgkmcnt(5)
  buffer_load_dwordx4 v33, s[36:39], s66 offen lds
  v_mfma_f32_16x16x32_bf16 v[156:159], a[172:175], a[140:143], v[156:159]
  ds_read_b64_tr_b16 a[162:163], v6 offset:43008
  v_mfma_f32_16x16x32_bf16 v[156:159], a[168:171], a[156:159], v[156:159]
  s_add_u32 m0, s45, 28672
  s_add_u32 s60, s66, 65536
  v_mfma_f32_16x16x32_bf16 v[152:155], a[168:171], a[152:155], v[152:155]
  ds_read_b64_tr_b16 a[164:165], v6 offset:45056
  v_mfma_f32_16x16x32_bf16 v[152:155], a[172:175], a[136:139], v[152:155]
  buffer_load_dwordx4 v33, s[36:39], s60 offen lds
  v_mfma_f32_16x16x32_bf16 v[148:151], a[172:175], a[132:135], v[148:151]
  ds_read_b64_tr_b16 a[166:167], v6 offset:47104
  v_mfma_f32_16x16x32_bf16 v[148:151], a[168:171], a[148:151], v[148:151]
  v_mfma_f32_16x16x32_bf16 v[144:147], a[168:171], a[144:147], v[144:147]
  ds_read_b64_tr_b16 a[168:169], v3 offset:32768
  buffer_load_dword a253, v14, s[36:39], s91 offen
  v_mfma_f32_16x16x32_bf16 v[144:147], a[172:175], a[128:131], v[144:147]
  s_waitcnt lgkmcnt(5)
  v_mfma_f32_16x16x32_bf16 v[128:131], a[180:183], a[188:191], v[128:131]
  ds_read_b64_tr_b16 a[170:171], v3 offset:34816
  v_mfma_f32_16x16x32_bf16 v[128:131], a[176:179], a[204:207], v[128:131]
  v_mfma_f32_16x16x32_bf16 v[132:135], a[176:179], a[208:211], v[132:135]
  ds_read_b64_tr_b16 a[172:173], v3 offset:36864
  v_mfma_f32_16x16x32_bf16 v[132:135], a[180:183], a[192:195], v[132:135]
  v_mfma_f32_16x16x32_bf16 v[136:139], a[180:183], a[196:199], v[136:139]
  ds_read_b64_tr_b16 a[174:175], v3 offset:38912
  v_mfma_f32_16x16x32_bf16 v[136:139], a[176:179], a[212:215], v[136:139]
  v_mfma_f32_16x16x32_bf16 v[140:143], a[176:179], a[216:219], v[140:143]
  ds_read_b64_tr_b16 a[176:177], v3 offset:40960
  v_mfma_f32_16x16x32_bf16 v[140:143], a[180:183], a[200:203], v[140:143]
  s_waitcnt lgkmcnt(5)
  v_mfma_f32_16x16x32_bf16 v[156:159], a[160:163], a[200:203], v[156:159]
  ds_read_b64_tr_b16 a[178:179], v3 offset:43008
  v_mfma_f32_16x16x32_bf16 v[156:159], a[164:167], a[216:219], v[156:159]
  v_mfma_f32_16x16x32_bf16 v[152:155], a[164:167], a[212:215], v[152:155]
  ds_read_b64_tr_b16 a[180:181], v3 offset:45056
  v_mfma_f32_16x16x32_bf16 v[152:155], a[160:163], a[196:199], v[152:155]
  v_mfma_f32_16x16x32_bf16 v[148:151], a[160:163], a[192:195], v[148:151]
  ds_read_b64_tr_b16 a[182:183], v3 offset:47104
  v_mfma_f32_16x16x32_bf16 v[148:151], a[164:167], a[208:211], v[148:151]
  v_mfma_f32_16x16x32_bf16 v[144:147], a[164:167], a[204:207], v[144:147]
  ds_read_b64_tr_b16 a[164:165], v3 offset:49152
  v_mfma_f32_16x16x32_bf16 v[144:147], a[160:163], a[188:191], v[144:147]
  s_waitcnt lgkmcnt(5)
  v_mfma_f32_16x16x32_bf16 v[160:163], a[168:171], a[64:67], v[160:163]
  ds_read_b64_tr_b16 a[166:167], v3 offset:51200
  v_mfma_f32_16x16x32_bf16 v[160:163], a[172:175], a[80:83], v[160:163]
  v_mfma_f32_16x16x32_bf16 v[164:167], a[172:175], a[84:87], v[164:167]
  ds_read_b64_tr_b16 a[160:161], v3 offset:53248
  s_waitcnt lgkmcnt(15)
  v_mfma_f32_16x16x32_bf16 v[164:167], a[168:171], a[68:71], v[164:167]
  v_fma_f32 v128, v128, v16, v60
  v_fma_f32 v129, v129, v16, v61
  v_mfma_f32_16x16x32_bf16 v[168:171], a[168:171], a[72:75], v[168:171]
  ds_read_b64_tr_b16 a[162:163], v3 offset:55296
  v_fma_f32 v130, v130, v16, v62
  v_mfma_f32_16x16x32_bf16 v[168:171], a[172:175], a[88:91], v[168:171]
  v_exp_f32 v24, v128
  v_mfma_f32_16x16x32_bf16 v[172:175], a[172:175], a[92:95], v[172:175]
  ds_read_b64_tr_b16 a[172:173], v3 offset:57344
  v_fma_f32 v131, v131, v16, v63
  v_mfma_f32_16x16x32_bf16 v[172:175], a[168:171], a[76:79], v[172:175]
  s_waitcnt lgkmcnt(5)
  v_exp_f32 v25, v129
  v_mfma_f32_16x16x32_bf16 v[188:191], a[176:179], a[76:79], v[188:191]
  ds_read_b64_tr_b16 a[174:175], v3 offset:59392
  v_fma_f32 v132, v132, v18, v60
  v_mfma_f32_16x16x32_bf16 v[188:191], a[180:183], a[92:95], v[188:191]
  v_exp_f32 v26, v130
  v_mfma_f32_16x16x32_bf16 v[184:187], a[180:183], a[88:91], v[184:187]
  ds_read_b64_tr_b16 a[168:169], v3 offset:61440
  v_fma_f32 v133, v133, v18, v61
  v_mfma_f32_16x16x32_bf16 v[184:187], a[176:179], a[72:75], v[184:187]
  v_exp_f32 v27, v131
  v_mfma_f32_16x16x32_bf16 v[180:183], a[176:179], a[68:71], v[180:183]
  ds_read_b64_tr_b16 a[170:171], v3 offset:63488
  v_fma_f32 v134, v134, v18, v62
  v_mfma_f32_16x16x32_bf16 v[180:183], a[180:183], a[84:87], v[180:183]
  v_exp_f32 v28, v132
  v_mfma_f32_16x16x32_bf16 v[176:179], a[180:183], a[80:83], v[176:179]
  ds_read_b64_tr_b16 a[180:181], v3 offset:0
  v_fma_f32 v135, v135, v18, v63
  v_mfma_f32_16x16x32_bf16 v[176:179], a[176:179], a[64:67], v[176:179]
  s_waitcnt lgkmcnt(5)
  v_exp_f32 v29, v133
  v_mul_f32 v144, v128, v144
  v_mfma_f32_16x16x32_bf16 v[160:163], a[164:167], a[96:99], v[160:163]
  ds_read_b64_tr_b16 a[182:183], v3 offset:2048
  v_mul_f32 v145, v129, v145
  v_mfma_f32_16x16x32_bf16 v[160:163], a[160:163], a[112:115], v[160:163]
  v_exp_f32 v30, v134
  v_mfma_f32_16x16x32_bf16 v[164:167], a[160:163], a[116:119], v[164:167]
  ds_read_b64_tr_b16 a[176:177], v3 offset:4096
  v_mul_f32 v146, v130, v146
  v_mfma_f32_16x16x32_bf16 v[164:167], a[164:167], a[100:103], v[164:167]
  v_exp_f32 v31, v135
  v_mfma_f32_16x16x32_bf16 v[168:171], a[164:167], a[104:107], v[168:171]
  ds_read_b64_tr_b16 a[178:179], v3 offset:6144
  v_add_u32 v38, s46, v0
  s_waitcnt vmcnt(5)
  s_barrier
  s_mov_b64 exec, 1
  buffer_store_dword v38, v0, s[8:11], s79 offen offset:0 sc1
  s_mov_b64 exec, -1
  v_mfma_f32_16x16x32_bf16 v[168:171], a[160:163], a[120:123], v[168:171]
  v_mul_f32 v147, v131, v147
  v_mul_f32 v148, v132, v148
  v_mfma_f32_16x16x32_bf16 v[172:175], a[160:163], a[124:127], v[172:175]
  ds_read_b64_tr_b16 a[160:161], v3 offset:8192
  v_mul_f32 v149, v133, v149
  v_mfma_f32_16x16x32_bf16 v[172:175], a[164:167], a[108:111], v[172:175]
  s_waitcnt lgkmcnt(5)
  v_mul_f32 v150, v134, v150
  v_mul_f32 v151, v135, v151
  v_mfma_f32_16x16x32_bf16 v[188:191], a[172:175], a[108:111], v[188:191]
  ds_read_b64_tr_b16 a[162:163], v3 offset:10240
  v_fma_f32 v24, v24, v17, v17
  v_mfma_f32_16x16x32_bf16 v[188:191], a[168:171], a[124:127], v[188:191]
  v_rcp_f32 v24, v24
  v_mfma_f32_16x16x32_bf16 v[184:187], a[168:171], a[120:123], v[184:187]
  ds_read_b64_tr_b16 a[164:165], v3 offset:12288
  v_fma_f32 v25, v25, v17, v17
  v_mfma_f32_16x16x32_bf16 v[184:187], a[172:175], a[104:107], v[184:187]
  v_rcp_f32 v25, v25
  v_mfma_f32_16x16x32_bf16 v[180:183], a[172:175], a[100:103], v[180:183]
  ds_read_b64_tr_b16 a[166:167], v3 offset:14336
  v_fma_f32 v26, v26, v17, v17
  v_mfma_f32_16x16x32_bf16 v[180:183], a[168:171], a[116:119], v[180:183]
  v_rcp_f32 v26, v26
  v_mfma_f32_16x16x32_bf16 v[176:179], a[168:171], a[112:115], v[176:179]
  ds_read_b64_tr_b16 a[168:169], v7 offset:32768
  v_fma_f32 v27, v27, v17, v17
  v_mfma_f32_16x16x32_bf16 v[176:179], a[172:175], a[96:99], v[176:179]
  s_waitcnt lgkmcnt(5)
  v_rcp_f32 v27, v27
  v_fma_f32 v28, v28, v19, v19
  v_mfma_f32_16x16x32_bf16 v[160:163], a[180:183], a[128:131], v[160:163]
  ds_read_b64_tr_b16 a[170:171], v7 offset:34816
  v_fma_f32 v29, v29, v19, v19
  v_mfma_f32_16x16x32_bf16 v[160:163], a[176:179], a[144:147], v[160:163]
  v_rcp_f32 v28, v28
  v_mfma_f32_16x16x32_bf16 v[164:167], a[176:179], a[148:151], v[164:167]
  ds_read_b64_tr_b16 a[172:173], v7 offset:36864
  v_fma_f32 v30, v30, v19, v19
  v_mfma_f32_16x16x32_bf16 v[164:167], a[180:183], a[132:135], v[164:167]
  v_rcp_f32 v29, v29
  v_mfma_f32_16x16x32_bf16 v[168:171], a[180:183], a[136:139], v[168:171]
  ds_read_b64_tr_b16 a[174:175], v7 offset:38912
  v_fma_f32 v31, v31, v19, v19
  v_mfma_f32_16x16x32_bf16 v[168:171], a[176:179], a[152:155], v[168:171]
  v_rcp_f32 v30, v30
  v_mfma_f32_16x16x32_bf16 v[172:175], a[176:179], a[156:159], v[172:175]
  ds_read_b64_tr_b16 a[176:177], v7 offset:40960
  v_mul_f32 v144, v144, v24
  v_mfma_f32_16x16x32_bf16 v[172:175], a[180:183], a[140:143], v[172:175]
  s_waitcnt lgkmcnt(5)
  v_rcp_f32 v31, v31
  v_mfma_f32_16x16x32_bf16 v[188:191], a[160:163], a[140:143], v[188:191]
  ds_read_b64_tr_b16 a[178:179], v7 offset:43008
  v_mul_f32 v145, v145, v25
  v_mfma_f32_16x16x32_bf16 v[188:191], a[164:167], a[156:159], v[188:191]
  v_mul_f32 v146, v146, v26
  v_mul_f32 v147, v147, v27
  v_mfma_f32_16x16x32_bf16 v[184:187], a[164:167], a[152:155], v[184:187]
  ds_read_b64_tr_b16 a[180:181], v7 offset:45056
  v_mul_f32 v148, v148, v28
  v_mfma_f32_16x16x32_bf16 v[184:187], a[160:163], a[136:139], v[184:187]
  v_mul_f32 v149, v149, v29
  v_mul_f32 v150, v150, v30
  v_mfma_f32_16x16x32_bf16 v[180:183], a[160:163], a[132:135], v[180:183]
  ds_read_b64_tr_b16 a[182:183], v7 offset:47104
  v_mul_f32 v151, v151, v31
  v_mfma_f32_16x16x32_bf16 v[180:183], a[164:167], a[148:151], v[180:183]
  v_cvt_pk_bf16_f32 v128, v144, v145
  v_cvt_pk_bf16_f32 v129, v146, v147
  v_mfma_f32_16x16x32_bf16 v[176:179], a[164:167], a[144:147], v[176:179]
  ds_read_b64_tr_b16 a[164:165], v4 offset:32768
  v_cvt_pk_bf16_f32 v132, v148, v149
  v_mfma_f32_16x16x32_bf16 v[176:179], a[160:163], a[128:131], v[176:179]
  s_waitcnt lgkmcnt(5)
  v_cvt_pk_bf16_f32 v133, v150, v151
  v_fma_f32 v136, v136, v20, v60
  v_fma_f32 v137, v137, v20, v61
  v_mfma_f32_16x16x32_bf16 v[160:163], a[168:171], a[188:191], v[160:163]
  ds_read_b64_tr_b16 a[166:167], v4 offset:34816
  v_fma_f32 v138, v138, v20, v62
  v_mfma_f32_16x16x32_bf16 v[160:163], a[172:175], a[204:207], v[160:163]
  v_exp_f32 v24, v136
  v_mfma_f32_16x16x32_bf16 v[164:167], a[172:175], a[208:211], v[164:167]
  ds_read_b64_tr_b16 a[160:161], v4 offset:36864
  v_fma_f32 v139, v139, v20, v63
  v_mfma_f32_16x16x32_bf16 v[164:167], a[168:171], a[192:195], v[164:167]
  v_exp_f32 v25, v137
  v_mfma_f32_16x16x32_bf16 v[168:171], a[168:171], a[196:199], v[168:171]
  ds_read_b64_tr_b16 a[162:163], v4 offset:38912
  v_fma_f32 v140, v140, v22, v60
  v_mfma_f32_16x16x32_bf16 v[168:171], a[172:175], a[212:215], v[168:171]
  v_exp_f32 v26, v138
  v_mfma_f32_16x16x32_bf16 v[172:175], a[172:175], a[216:219], v[172:175]
  ds_read_b64_tr_b16 a[172:173], v4 offset:40960
  v_fma_f32 v141, v141, v22, v61
  v_mfma_f32_16x16x32_bf16 v[172:175], a[168:171], a[200:203], v[172:175]
  s_waitcnt lgkmcnt(5)
  v_exp_f32 v27, v139
  v_mfma_f32_16x16x32_bf16 v[188:191], a[176:179], a[200:203], v[188:191]
  ds_read_b64_tr_b16 a[174:175], v4 offset:43008
  v_fma_f32 v142, v142, v22, v62
  v_mfma_f32_16x16x32_bf16 v[188:191], a[180:183], a[216:219], v[188:191]
  v_exp_f32 v28, v140
  v_mfma_f32_16x16x32_bf16 v[184:187], a[180:183], a[212:215], v[184:187]
  ds_read_b64_tr_b16 a[168:169], v4 offset:45056
  v_fma_f32 v143, v143, v22, v63
  v_mfma_f32_16x16x32_bf16 v[184:187], a[176:179], a[196:199], v[184:187]
  v_exp_f32 v29, v141
  v_mfma_f32_16x16x32_bf16 v[180:183], a[176:179], a[192:195], v[180:183]
  ds_read_b64_tr_b16 a[170:171], v4 offset:47104
  v_mul_f32 v152, v136, v152
  v_mfma_f32_16x16x32_bf16 v[180:183], a[180:183], a[208:211], v[180:183]
  v_exp_f32 v30, v142
  v_mfma_f32_16x16x32_bf16 v[176:179], a[180:183], a[204:207], v[176:179]
  ds_read_b64_tr_b16 a[180:181], v4 offset:49152
  v_mul_f32 v153, v137, v153
  v_mfma_f32_16x16x32_bf16 v[176:179], a[176:179], a[188:191], v[176:179]
  s_waitcnt lgkmcnt(5)
  v_exp_f32 v31, v143
  v_mul_f32 v154, v138, v154
  v_mfma_f32_16x16x32_bf16 v[192:195], a[164:167], a[64:67], v[192:195]
  ds_read_b64_tr_b16 a[182:183], v4 offset:51200
  ds_read_b128 v[60:63], v12 offset:576
  v_mfma_f32_16x16x32_bf16 v[192:195], a[160:163], a[80:83], v[192:195]
  v_mul_f32 v155, v139, v155
  v_mul_f32 v156, v140, v156
  v_mfma_f32_16x16x32_bf16 v[196:199], a[160:163], a[84:87], v[196:199]
  ds_read_b64_tr_b16 a[176:177], v4 offset:53248
  v_mul_f32 v157, v141, v157
  v_mfma_f32_16x16x32_bf16 v[196:199], a[164:167], a[68:71], v[196:199]
  v_mul_f32 v158, v142, v158
  v_mul_f32 v159, v143, v159
  v_mfma_f32_16x16x32_bf16 v[200:203], a[164:167], a[72:75], v[200:203]
  ds_read_b64_tr_b16 a[178:179], v4 offset:55296
  v_fma_f32 v24, v24, v21, v21
  v_mfma_f32_16x16x32_bf16 v[200:203], a[160:163], a[88:91], v[200:203]
  v_rcp_f32 v24, v24
  v_mfma_f32_16x16x32_bf16 v[204:207], a[160:163], a[92:95], v[204:207]
  ds_read_b64_tr_b16 a[160:161], v4 offset:57344
  v_fma_f32 v25, v25, v21, v21
  v_mfma_f32_16x16x32_bf16 v[204:207], a[164:167], a[76:79], v[204:207]
  s_waitcnt lgkmcnt(6)
  v_rcp_f32 v25, v25
  v_mfma_f32_16x16x32_bf16 v[220:223], a[172:175], a[76:79], v[220:223]
  ds_read_b64_tr_b16 a[162:163], v4 offset:59392
  v_fma_f32 v26, v26, v21, v21
  v_mfma_f32_16x16x32_bf16 v[220:223], a[168:171], a[92:95], v[220:223]
  v_rcp_f32 v26, v26
  v_mfma_f32_16x16x32_bf16 v[216:219], a[168:171], a[88:91], v[216:219]
  ds_read_b64_tr_b16 a[164:165], v4 offset:61440
  v_fma_f32 v27, v27, v21, v21
  v_mfma_f32_16x16x32_bf16 v[216:219], a[172:175], a[72:75], v[216:219]
  v_rcp_f32 v27, v27
  v_mfma_f32_16x16x32_bf16 v[212:215], a[172:175], a[68:71], v[212:215]
  ds_read_b64_tr_b16 a[166:167], v4 offset:63488
  v_fma_f32 v28, v28, v23, v23
  v_mfma_f32_16x16x32_bf16 v[212:215], a[168:171], a[84:87], v[212:215]
  v_rcp_f32 v28, v28
  v_mfma_f32_16x16x32_bf16 v[208:211], a[168:171], a[80:83], v[208:211]
  ds_read_b64_tr_b16 a[168:169], v4 offset:0
  v_fma_f32 v29, v29, v23, v23
  v_mfma_f32_16x16x32_bf16 v[208:211], a[172:175], a[64:67], v[208:211]
  s_waitcnt lgkmcnt(5)
  v_rcp_f32 v29, v29
  v_fma_f32 v30, v30, v23, v23
  v_mfma_f32_16x16x32_bf16 v[192:195], a[180:183], a[96:99], v[192:195]
  ds_read_b64_tr_b16 a[170:171], v4 offset:2048
  v_fma_f32 v31, v31, v23, v23
  v_mfma_f32_16x16x32_bf16 v[192:195], a[176:179], a[112:115], v[192:195]
  v_rcp_f32 v30, v30
  v_mfma_f32_16x16x32_bf16 v[196:199], a[176:179], a[116:119], v[196:199]
  ds_read_b64_tr_b16 a[172:173], v4 offset:4096
  v_mul_f32 v152, v152, v24
  v_mfma_f32_16x16x32_bf16 v[196:199], a[180:183], a[100:103], v[196:199]
  v_rcp_f32 v31, v31
  v_mfma_f32_16x16x32_bf16 v[200:203], a[180:183], a[104:107], v[200:203]
  ds_read_b64_tr_b16 a[174:175], v4 offset:6144
  v_mul_f32 v153, v153, v25
  v_mfma_f32_16x16x32_bf16 v[200:203], a[176:179], a[120:123], v[200:203]
  v_mul_f32 v154, v154, v26
  v_mul_f32 v155, v155, v27
  v_mfma_f32_16x16x32_bf16 v[204:207], a[176:179], a[124:127], v[204:207]
  ds_read_b64_tr_b16 a[176:177], v4 offset:8192
  v_mul_f32 v156, v156, v28
  v_mfma_f32_16x16x32_bf16 v[204:207], a[180:183], a[108:111], v[204:207]
  s_waitcnt lgkmcnt(5)
  v_mul_f32 v157, v157, v29
  v_mul_f32 v158, v158, v30
  v_mfma_f32_16x16x32_bf16 v[220:223], a[160:163], a[108:111], v[220:223]
  ds_read_b64_tr_b16 a[178:179], v4 offset:10240
  v_mul_f32 v159, v159, v31
  v_mfma_f32_16x16x32_bf16 v[220:223], a[164:167], a[124:127], v[220:223]
  v_cvt_pk_bf16_f32 v136, v152, v153
  v_cvt_pk_bf16_f32 v137, v154, v155
  v_mfma_f32_16x16x32_bf16 v[216:219], a[164:167], a[120:123], v[216:219]
  ds_read_b64_tr_b16 a[180:181], v4 offset:12288
  v_cvt_pk_bf16_f32 v140, v156, v157
  v_mfma_f32_16x16x32_bf16 v[216:219], a[160:163], a[104:107], v[216:219]
  v_cvt_pk_bf16_f32 v141, v158, v159
  v_mfma_f32_16x16x32_bf16 v[212:215], a[160:163], a[100:103], v[212:215]
  ds_read_b64_tr_b16 a[182:183], v4 offset:14336
  s_lshl_b32 s82, s44, 28
  s_add_u32 s82, s82, s81
  buffer_load_dword v36, v37, s[8:11], s82 offen sc1
  v_mfma_f32_16x16x32_bf16 v[212:215], a[164:167], a[116:119], v[212:215]
  s_waitcnt lgkmcnt(14)
  v_fma_f32 v160, v160, v16, v60
  v_fma_f32 v161, v161, v16, v61
  v_mfma_f32_16x16x32_bf16 v[208:211], a[164:167], a[112:115], v[208:211]
  ds_read_b64_tr_b16 a[164:165], v8 offset:32768
  v_fma_f32 v162, v162, v16, v62
  v_mfma_f32_16x16x32_bf16 v[208:211], a[160:163], a[96:99], v[208:211]
  s_waitcnt lgkmcnt(5)
  v_exp_f32 v24, v160
  v_fma_f32 v163, v163, v16, v63
  v_mfma_f32_16x16x32_bf16 v[192:195], a[168:171], a[128:131], v[192:195]
  ds_read_b64_tr_b16 a[166:167], v8 offset:34816
  v_fma_f32 v164, v164, v18, v60
  v_mfma_f32_16x16x32_bf16 v[192:195], a[172:175], a[144:147], v[192:195]
  v_exp_f32 v25, v161
  v_mfma_f32_16x16x32_bf16 v[196:199], a[172:175], a[148:151], v[196:199]
  ds_read_b64_tr_b16 a[160:161], v8 offset:36864
  v_fma_f32 v165, v165, v18, v61
  v_mfma_f32_16x16x32_bf16 v[196:199], a[168:171], a[132:135], v[196:199]
  v_exp_f32 v26, v162
  v_fma_f32 v166, v166, v18, v62
  v_mfma_f32_16x16x32_bf16 v[200:203], a[168:171], a[136:139], v[200:203]
  ds_read_b64_tr_b16 a[162:163], v8 offset:38912
  v_fma_f32 v167, v167, v18, v63
  v_mfma_f32_16x16x32_bf16 v[200:203], a[172:175], a[152:155], v[200:203]
  v_exp_f32 v27, v163
  v_mfma_f32_16x16x32_bf16 v[204:207], a[172:175], a[156:159], v[204:207]
  ds_read_b64_tr_b16 a[172:173], v8 offset:40960
  v_mul_f32 v176, v160, v176
  v_mfma_f32_16x16x32_bf16 v[204:207], a[168:171], a[140:143], v[204:207]
  s_waitcnt lgkmcnt(5)
  v_exp_f32 v28, v164
  v_mul_f32 v177, v161, v177
  v_mfma_f32_16x16x32_bf16 v[220:223], a[176:179], a[140:143], v[220:223]
  ds_read_b64_tr_b16 a[174:175], v8 offset:43008
  v_mul_f32 v178, v162, v178
  v_mfma_f32_16x16x32_bf16 v[220:223], a[180:183], a[156:159], v[220:223]
  v_exp_f32 v29, v165
  v_mfma_f32_16x16x32_bf16 v[216:219], a[180:183], a[152:155], v[216:219]
  ds_read_b64_tr_b16 a[168:169], v8 offset:45056
  v_mul_f32 v179, v163, v179
  v_mfma_f32_16x16x32_bf16 v[216:219], a[176:179], a[136:139], v[216:219]
  v_exp_f32 v30, v166
  v_mul_f32 v180, v164, v180
  v_mfma_f32_16x16x32_bf16 v[212:215], a[176:179], a[132:135], v[212:215]
  ds_read_b64_tr_b16 a[170:171], v8 offset:47104
  v_mul_f32 v181, v165, v181
  v_mfma_f32_16x16x32_bf16 v[212:215], a[180:183], a[148:151], v[212:215]
  v_exp_f32 v31, v167
  v_mfma_f32_16x16x32_bf16 v[208:211], a[180:183], a[144:147], v[208:211]
HOP15:
  s_cbranch_execz HOP19
  ds_read_b64_tr_b16 a[180:181], v5 offset:32768
  v_mul_f32 v182, v166, v182
  v_mfma_f32_16x16x32_bf16 v[208:211], a[176:179], a[128:131], v[208:211]
  s_waitcnt lgkmcnt(5)
  v_mul_f32 v183, v167, v183
  v_fma_f32 v24, v24, v17, v17
  v_fma_f32 v25, v25, v17, v17
  v_mfma_f32_16x16x32_bf16 v[192:195], a[164:167], a[188:191], v[192:195]
  ds_read_b64_tr_b16 a[182:183], v5 offset:34816
  v_fma_f32 v26, v26, v17, v17
  v_mfma_f32_16x16x32_bf16 v[192:195], a[160:163], a[204:207], v[192:195]
  v_rcp_f32 v24, v24
  v_mfma_f32_16x16x32_bf16 v[196:199], a[160:163], a[208:211], v[196:199]
  ds_read_b64_tr_b16 a[176:177], v5 offset:36864
  v_fma_f32 v27, v27, v17, v17
  v_mfma_f32_16x16x32_bf16 v[196:199], a[164:167], a[192:195], v[196:199]
  v_rcp_f32 v25, v25
  v_fma_f32 v28, v28, v19, v19
  v_mfma_f32_16x16x32_bf16 v[200:203], a[164:167], a[196:199], v[200:203]
  ds_read_b64_tr_b16 a[178:179], v5 offset:38912
  v_fma_f32 v29, v29, v19, v19
  v_mfma_f32_16x16x32_bf16 v[200:203], a[160:163], a[212:215], v[200:203]
  v_rcp_f32 v26, v26
  v_mfma_f32_16x16x32_bf16 v[204:207], a[160:163], a[216:219], v[204:207]
  ds_read_b64_tr_b16 a[160:161], v5 offset:40960
  v_fma_f32 v30, v30, v19, v19
  v_mfma_f32_16x16x32_bf16 v[204:207], a[164:167], a[200:203], v[204:207]
  s_waitcnt lgkmcnt(5)
  v_rcp_f32 v27, v27
  v_fma_f32 v31, v31, v19, v19
  v_mfma_f32_16x16x32_bf16 v[220:223], a[172:175], a[200:203], v[220:223]
  ds_read_b64_tr_b16 a[162:163], v5 offset:43008
  v_mul_f32 v176, v176, v24
  v_mfma_f32_16x16x32_bf16 v[220:223], a[168:171], a[216:219], v[220:223]
  v_rcp_f32 v28, v28
  v_mfma_f32_16x16x32_bf16 v[216:219], a[168:171], a[212:215], v[216:219]
  ds_read_b64_tr_b16 a[164:165], v5 offset:45056
  v_mul_f32 v177, v177, v25
  v_mfma_f32_16x16x32_bf16 v[216:219], a[172:175], a[196:199], v[216:219]
  v_rcp_f32 v29, v29
  v_mul_f32 v178, v178, v26
  v_mfma_f32_16x16x32_bf16 v[212:215], a[172:175], a[192:195], v[212:215]
  ds_read_b64_tr_b16 a[166:167], v5 offset:47104
  v_mul_f32 v179, v179, v27
  v_mfma_f32_16x16x32_bf16 v[212:215], a[168:171], a[208:211], v[212:215]
  v_rcp_f32 v30, v30
  v_mfma_f32_16x16x32_bf16 v[208:211], a[168:171], a[204:207], v[208:211]
  ds_read_b64_tr_b16 a[168:169], v5 offset:49152
  v_mul_f32 v180, v180, v28
  v_mfma_f32_16x16x32_bf16 v[208:211], a[172:175], a[188:191], v[208:211]
  s_waitcnt lgkmcnt(5)
  v_rcp_f32 v31, v31
  v_mul_f32 v181, v181, v29
  v_mfma_f32_16x16x32_bf16 v[224:227], a[180:183], a[64:67], v[224:227]
  ds_read_b64_tr_b16 a[170:171], v5 offset:51200
  v_mul_f32 v182, v182, v30
  v_mfma_f32_16x16x32_bf16 v[224:227], a[176:179], a[80:83], v[224:227]
  v_mul_f32 v183, v183, v31
  v_cvt_pk_bf16_f32 v130, v176, v177
  v_mfma_f32_16x16x32_bf16 v[228:231], a[176:179], a[84:87], v[228:231]
  ds_read_b64_tr_b16 a[172:173], v5 offset:53248
  v_cvt_pk_bf16_f32 v131, v178, v179
  v_mfma_f32_16x16x32_bf16 v[228:231], a[180:183], a[68:71], v[228:231]
  buffer_store_dwordx4 v[128:131], v1, s[8:11], s57 offen offset:0 sc1
  v_mfma_f32_16x16x32_bf16 v[232:235], a[180:183], a[72:75], v[232:235]
  ds_read_b64_tr_b16 a[174:175], v5 offset:55296
  s_waitcnt vmcnt(1)
  s_cmp_lg_u32 s44, 0
  s_cbranch_scc1 PL12_adaLN_cond__sliding_local_dilated__swiglu_ffn__prompt_kernelx
  v_cmp_ne_u32 vcc, s46, v36
  s_nop 4
  s_cbranch_vccz PL12_adaLN_cond__sliding_local_dilated__swiglu_ffn__prompt_kernelx
  s_mov_b32 s82, 60000
PL12_adaLN_cond__sliding_local_dilated__swiglu_ffn__prompt_kernel:
  buffer_load_dword v36, v37, s[8:11], s81 offen sc1
  s_sub_u32 s82, s82, 1
  s_cmp_eq_u32 s82, 0
  s_waitcnt vmcnt(0)
  s_cbranch_scc1 PL12_adaLN_cond__sliding_local_dilated__swiglu_ffn__prompt_kernelx
  v_cmp_ne_u32 vcc, s46, v36
  s_nop 4
  s_cbranch_vccnz PL12_adaLN_cond__sliding_local_dilated__swiglu_ffn__prompt_kernel
PL12_adaLN_cond__sliding_local_dilated__swiglu_ffn__prompt_kernelx:
  s_barrier
  v_mfma_f32_16x16x32_bf16 v[232:235], a[176:179], a[88:91], v[232:235]
  v_cvt_pk_bf16_f32 v134, v180, v181
  v_cvt_pk_bf16_f32 v135, v182, v183
  v_mfma_f32_16x16x32_bf16 v[236:239], a[176:179], a[92:95], v[236:239]
  ds_read_b64_tr_b16 a[176:177], v5 offset:57344
  v_fma_f32 v168, v168, v20, v60
  v_mfma_f32_16x16x32_bf16 v[236:239], a[180:183], a[76:79], v[236:239]
  s_waitcnt lgkmcnt(5)
  buffer_load_dwordx4 a[220:223], v1, s[8:11], s71 offen offset:0 sc1
  v_exp_f32 v24, v168
  v_mfma_f32_16x16x32_bf16 v[252:255], a[160:163], a[76:79], v[252:255]
  ds_read_b64_tr_b16 a[178:179], v5 offset:59392
  s_add_u32 s55, s57, 262144
  buffer_store_dwordx4 v[132:135], v1, s[8:11], s55 offen offset:0 sc1
  v_mfma_f32_16x16x32_bf16 v[252:255], a[164:167], a[92:95], v[252:255]
  v_fma_f32 v169, v169, v20, v61
  v_fma_f32 v170, v170, v20, v62
  v_mfma_f32_16x16x32_bf16 v[248:251], a[164:167], a[88:91], v[248:251]
  ds_read_b64_tr_b16 a[180:181], v5 offset:61440
  v_fma_f32 v171, v171, v20, v63
  v_mfma_f32_16x16x32_bf16 v[248:251], a[160:163], a[72:75], v[248:251]
  buffer_load_dwordx4 a[236:239], v1, s[8:11], s71 offen offset:1024 sc1
  v_exp_f32 v25, v169
  v_fma_f32 v172, v172, v22, v60
  v_mfma_f32_16x16x32_bf16 v[244:247], a[160:163], a[68:71], v[244:247]
  ds_read_b64_tr_b16 a[182:183], v5 offset:63488
  v_fma_f32 v173, v173, v22, v61
  v_mfma_f32_16x16x32_bf16 v[244:247], a[164:167], a[84:87], v[244:247]
  s_add_u32 s71, s71, 131072
  v_exp_f32 v26, v170
  v_mfma_f32_16x16x32_bf16 v[240:243], a[164:167], a[80:83], v[240:243]
  ds_read_b64_tr_b16 a[164:165], v5 offset:0
  v_fma_f32 v174, v174, v22, v62
  v_mfma_f32_16x16x32_bf16 v[240:243], a[160:163], a[64:67], v[240:243]
  s_waitcnt lgkmcnt(5)
  buffer_load_dwordx4 a[224:227], v1, s[8:11], s71 offen offset:0 sc1
  v_exp_f32 v27, v171
  v_mfma_f32_16x16x32_bf16 v[224:227], a[168:171], a[96:99], v[224:227]
  ds_read_b64_tr_b16 a[166:167], v5 offset:2048
  v_fma_f32 v175, v175, v22, v63
  v_mfma_f32_16x16x32_bf16 v[224:227], a[172:175], a[112:115], v[224:227]
  v_exp_f32 v28, v172
  v_mfma_f32_16x16x32_bf16 v[228:231], a[172:175], a[116:119], v[228:231]
  ds_read_b64_tr_b16 a[160:161], v5 offset:4096
  v_mul_f32 v184, v168, v184
  v_mfma_f32_16x16x32_bf16 v[228:231], a[168:171], a[100:103], v[228:231]
  buffer_load_dwordx4 a[240:243], v1, s[8:11], s71 offen offset:1024 sc1
  v_exp_f32 v29, v173
  v_mul_f32 v185, v169, v185
  v_mfma_f32_16x16x32_bf16 v[232:235], a[168:171], a[104:107], v[232:235]
  ds_read_b64_tr_b16 a[162:163], v5 offset:6144
  v_mul_f32 v186, v170, v186
  v_mfma_f32_16x16x32_bf16 v[232:235], a[172:175], a[120:123], v[232:235]
  s_add_u32 s71, s71, s88
  v_exp_f32 v30, v174
  v_mfma_f32_16x16x32_bf16 v[236:239], a[172:175], a[124:127], v[236:239]
  ds_read_b64_tr_b16 a[172:173], v5 offset:8192
  ds_read_b128 v[60:63], v12 offset:640
  v_mfma_f32_16x16x32_bf16 v[236:239], a[168:171], a[108:111], v[236:239]
  s_waitcnt lgkmcnt(6)
  buffer_load_dwordx4 a[228:231], v1, s[8:11], s71 offen offset:0 sc1
  v_exp_f32 v31, v175
  v_mfma_f32_16x16x32_bf16 v[252:255], a[176:179], a[108:111], v[252:255]
  ds_read_b64_tr_b16 a[174:175], v5 offset:10240
  v_mul_f32 v187, v171, v187
  v_mfma_f32_16x16x32_bf16 v[252:255], a[180:183], a[124:127], v[252:255]
  v_mul_f32 v188, v172, v188
  v_mul_f32 v189, v173, v189
  v_mfma_f32_16x16x32_bf16 v[248:251], a[180:183], a[120:123], v[248:251]
  ds_read_b64_tr_b16 a[168:169], v5 offset:12288
  v_mul_f32 v190, v174, v190
  v_mfma_f32_16x16x32_bf16 v[248:251], a[176:179], a[104:107], v[248:251]
  buffer_load_dwordx4 a[244:247], v1, s[8:11], s71 offen offset:1024 sc1
  v_mul_f32 v191, v175, v191
  v_fma_f32 v24, v24, v21, v21
  v_fma_f32 v25, v25, v21, v21
  v_mfma_f32_16x16x32_bf16 v[244:247], a[176:179], a[100:103], v[244:247]
  ds_read_b64_tr_b16 a[170:171], v5 offset:14336
  v_fma_f32 v26, v26, v21, v21
  v_mfma_f32_16x16x32_bf16 v[244:247], a[180:183], a[116:119], v[244:247]
  s_add_u32 s71, s71, 131072
  v_rcp_f32 v24, v24
  v_mfma_f32_16x16x32_bf16 v[240:243], a[180:183], a[112:115], v[240:243]
  ds_read_b64_tr_b16 a[180:181], v9 offset:32768
  v_fma_f32 v27, v27, v21, v21
  v_mfma_f32_16x16x32_bf16 v[240:243], a[176:179], a[96:99], v[240:243]
  s_waitcnt lgkmcnt(6)
  buffer_load_dwordx4 a[232:235], v1, s[8:11], s71 offen offset:0 sc1
  v_rcp_f32 v25, v25
  v_mfma_f32_16x16x32_bf16 v[224:227], a[164:167], a[128:131], v[224:227]
  ds_read_b64_tr_b16 a[182:183], v9 offset:34816
  v_fma_f32 v28, v28, v23, v23
  v_mfma_f32_16x16x32_bf16 v[224:227], a[160:163], a[144:147], v[224:227]
  v_rcp_f32 v26, v26
  v_mfma_f32_16x16x32_bf16 v[228:231], a[160:163], a[148:151], v[228:231]
  ds_read_b64_tr_b16 a[176:177], v9 offset:36864
  v_fma_f32 v29, v29, v23, v23
  v_mfma_f32_16x16x32_bf16 v[228:231], a[164:167], a[132:135], v[228:231]
  buffer_load_dwordx4 a[248:251], v1, s[8:11], s71 offen offset:1024 sc1
  v_rcp_f32 v27, v27
  v_fma_f32 v30, v30, v23, v23
  v_mfma_f32_16x16x32_bf16 v[232:235], a[164:167], a[136:139], v[232:235]
  ds_read_b64_tr_b16 a[178:179], v9 offset:38912
  v_fma_f32 v31, v31, v23, v23
  v_mfma_f32_16x16x32_bf16 v[232:235], a[160:163], a[152:155], v[232:235]
  v_rcp_f32 v28, v28
  v_mfma_f32_16x16x32_bf16 v[236:239], a[160:163], a[156:159], v[236:239]
  ds_read_b64_tr_b16 a[160:161], v9 offset:40960
  v_mul_f32 v184, v184, v24
  v_mfma_f32_16x16x32_bf16 v[236:239], a[164:167], a[140:143], v[236:239]
  s_waitcnt lgkmcnt(5)
  buffer_load_dwordx4 a[0:3], v1, s[8:11], s72 offen offset:0 sc1
  v_rcp_f32 v29, v29
  v_mfma_f32_16x16x32_bf16 v[252:255], a[172:175], a[140:143], v[252:255]
  ds_read_b64_tr_b16 a[162:163], v9 offset:43008
  v_mul_f32 v185, v185, v25
  v_mfma_f32_16x16x32_bf16 v[252:255], a[168:171], a[156:159], v[252:255]
  v_rcp_f32 v30, v30
  v_mfma_f32_16x16x32_bf16 v[248:251], a[168:171], a[152:155], v[248:251]
  ds_read_b64_tr_b16 a[164:165], v9 offset:45056
  v_mul_f32 v186, v186, v26
  v_mfma_f32_16x16x32_bf16 v[248:251], a[172:175], a[136:139], v[248:251]
  buffer_load_dwordx4 a[16:19], v1, s[8:11], s72 offen offset:1024 sc1
  v_rcp_f32 v31, v31
  v_mul_f32 v187, v187, v27
  v_mfma_f32_16x16x32_bf16 v[244:247], a[172:175], a[132:135], v[244:247]
  ds_read_b64_tr_b16 a[166:167], v9 offset:47104
  v_mul_f32 v188, v188, v28
  v_mfma_f32_16x16x32_bf16 v[244:247], a[168:171], a[148:151], v[244:247]
  s_waitcnt vmcnt(33)
  s_barrier
  v_mfma_f32_16x16x32_bf16 v[240:243], a[168:171], a[144:147], v[240:243]
  ds_read_b64_tr_b16 a[168:169], v6 offset:49152
  s_add_u32 s72, s72, 131072
  v_mfma_f32_16x16x32_bf16 v[240:243], a[172:175], a[128:131], v[240:243]
  s_waitcnt lgkmcnt(5)
  buffer_load_dwordx4 a[4:7], v1, s[8:11], s72 offen offset:0 sc1
  v_mul_f32 v189, v189, v29
  v_mul_f32 v190, v190, v30
  v_mfma_f32_16x16x32_bf16 v[224:227], a[180:183], a[188:191], v[224:227]
  ds_read_b64_tr_b16 a[170:171], v6 offset:51200
  v_mul_f32 v191, v191, v31
  v_mfma_f32_16x16x32_bf16 v[224:227], a[176:179], a[204:207], v[224:227]
  v_cvt_pk_bf16_f32 v138, v184, v185
  v_cvt_pk_bf16_f32 v139, v186, v187
  v_mfma_f32_16x16x32_bf16 v[228:231], a[176:179], a[208:211], v[228:231]
  ds_read_b64_tr_b16 a[172:173], v6 offset:53248
  v_cvt_pk_bf16_f32 v142, v188, v189
  v_mfma_f32_16x16x32_bf16 v[228:231], a[180:183], a[192:195], v[228:231]
  buffer_load_dwordx4 a[20:23], v1, s[8:11], s72 offen offset:1024 sc1
  s_add_u32 s55, s57, 524288
  buffer_store_dwordx4 v[136:139], v1, s[8:11], s55 offen offset:0 sc1
  v_mfma_f32_16x16x32_bf16 v[232:235], a[180:183], a[196:199], v[232:235]
  ds_read_b64_tr_b16 a[174:175], v6 offset:55296
  v_cvt_pk_bf16_f32 v143, v190, v191
  v_mfma_f32_16x16x32_bf16 v[232:235], a[176:179], a[212:215], v[232:235]
  s_add_u32 s72, s72, s88
  s_add_u32 s55, s57, 786432
  buffer_store_dwordx4 v[140:143], v1, s[8:11], s55 offen offset:0 sc1
  v_mfma_f32_16x16x32_bf16 v[236:239], a[176:179], a[216:219], v[236:239]
  ds_read_b64_tr_b16 a[176:177], v7 offset:49152
  s_waitcnt lgkmcnt(15)
  v_mfma_f32_16x16x32_bf16 v[236:239], a[180:183], a[200:203], v[236:239]
  s_waitcnt lgkmcnt(5)
  buffer_load_dwordx4 a[8:11], v1, s[8:11], s72 offen offset:0 sc1
  v_fma_f32 v192, v192, v16, v60
  v_fma_f32 v193, v193, v16, v61
  v_mfma_f32_16x16x32_bf16 v[252:255], a[160:163], a[200:203], v[252:255]
  ds_read_b64_tr_b16 a[178:179], v7 offset:51200
  v_fma_f32 v194, v194, v16, v62
  v_mfma_f32_16x16x32_bf16 v[252:255], a[164:167], a[216:219], v[252:255]
  s_waitcnt vmcnt(32)
  s_barrier
  v_mfma_f32_16x16x32_bf16 v[248:251], a[164:167], a[212:215], v[248:251]
  ds_read_b64_tr_b16 a[180:181], v7 offset:53248
  v_exp_f32 v24, v192
  v_mfma_f32_16x16x32_bf16 v[248:251], a[160:163], a[196:199], v[248:251]
  buffer_load_dwordx4 a[24:27], v1, s[8:11], s72 offen offset:1024 sc1
  v_exp_f32 v25, v193
  v_mfma_f32_16x16x32_bf16 v[244:247], a[160:163], a[192:195], v[244:247]
  ds_read_b64_tr_b16 a[182:183], v7 offset:55296
  v_fma_f32 v195, v195, v16, v63
  v_mfma_f32_16x16x32_bf16 v[244:247], a[164:167], a[208:211], v[244:247]
  s_add_u32 s72, s72, 131072
  v_exp_f32 v26, v194
  v_fma_f32 v196, v196, v18, v60
  v_mfma_f32_16x16x32_bf16 v[240:243], a[164:167], a[204:207], v[240:243]
  ds_read_b64_tr_b16 a[164:165], v8 offset:49152
  v_fma_f32 v197, v197, v18, v61
  v_mfma_f32_16x16x32_bf16 v[240:243], a[160:163], a[188:191], v[240:243]
  s_waitcnt vmcnt(8) lgkmcnt(5)
  buffer_load_dwordx4 a[12:15], v1, s[8:11], s72 offen offset:0 sc1
  v_exp_f32 v27, v195
  v_mfma_f32_16x16x32_bf16 v[64:67], a[168:171], a[220:223], 0
  ds_read_b64_tr_b16 a[166:167], v8 offset:51200
  v_fma_f32 v198, v198, v18, v62
  v_mfma_f32_16x16x32_bf16 v[64:67], a[172:175], a[236:239], v[64:67]
  v_exp_f32 v28, v196
  v_mfma_f32_16x16x32_bf16 v[68:71], a[172:175], a[240:243], 0
  ds_read_b64_tr_b16 a[160:161], v8 offset:53248
  v_exp_f32 v29, v197
  v_mfma_f32_16x16x32_bf16 v[68:71], a[168:171], a[224:227], v[68:71]
  buffer_load_dwordx4 a[28:31], v1, s[8:11], s72 offen offset:1024 sc1
  v_exp_f32 v30, v198
  v_mfma_f32_16x16x32_bf16 v[72:75], a[168:171], a[228:231], 0
  ds_read_b64_tr_b16 a[162:163], v8 offset:55296
  v_fma_f32 v199, v199, v18, v63
  v_mfma_f32_16x16x32_bf16 v[72:75], a[172:175], a[244:247], v[72:75]
  v_exp_f32 v31, v199
  v_mul_f32 v208, v192, v208
  v_mfma_f32_16x16x32_bf16 v[76:79], a[172:175], a[248:251], 0
  ds_read_b64_tr_b16 a[172:173], v9 offset:49152
  v_mul_f32 v209, v193, v209
  v_mfma_f32_16x16x32_bf16 v[76:79], a[168:171], a[232:235], v[76:79]
  s_waitcnt lgkmcnt(5)
  buffer_load_dwordx4 a[32:35], v1, s[8:11], s73 offen offset:0 sc1
  v_mul_f32 v210, v194, v210
  v_mul_f32 v211, v195, v211
  v_mfma_f32_16x16x32_bf16 v[92:95], a[176:179], a[232:235], 0
  ds_read_b64_tr_b16 a[174:175], v9 offset:51200
  v_mul_f32 v212, v196, v212
  v_mfma_f32_16x16x32_bf16 v[92:95], a[180:183], a[248:251], v[92:95]
  v_mul_f32 v213, v197, v213
  v_mul_f32 v214, v198, v214
  v_mfma_f32_16x16x32_bf16 v[88:91], a[180:183], a[244:247], 0
  ds_read_b64_tr_b16 a[168:169], v9 offset:53248
  v_mul_f32 v215, v199, v215
  v_fma_f32 v24, v24, v17, v17
  v_mfma_f32_16x16x32_bf16 v[88:91], a[176:179], a[228:231], v[88:91]
  buffer_load_dwordx4 a[48:51], v1, s[8:11], s73 offen offset:1024 sc1
  v_rcp_f32 v24, v24
  v_mfma_f32_16x16x32_bf16 v[84:87], a[176:179], a[224:227], 0
  ds_read_b64_tr_b16 a[170:171], v9 offset:55296
  v_fma_f32 v25, v25, v17, v17
  v_mfma_f32_16x16x32_bf16 v[84:87], a[180:183], a[240:243], v[84:87]
  v_rcp_f32 v25, v25
  v_fma_f32 v26, v26, v17, v17
  v_mfma_f32_16x16x32_bf16 v[80:83], a[180:183], a[236:239], 0
  ds_read_b64_tr_b16 a[180:181], v6 offset:57344
  v_fma_f32 v27, v27, v17, v17
  v_mfma_f32_16x16x32_bf16 v[80:83], a[176:179], a[220:223], v[80:83]
  s_waitcnt lgkmcnt(5)
  s_add_u32 s73, s73, 131072
  v_rcp_f32 v26, v26
  v_mfma_f32_16x16x32_bf16 v[96:99], a[164:167], a[220:223], 0
  ds_read_b64_tr_b16 a[182:183], v6 offset:59392
  v_fma_f32 v28, v28, v19, v19
  v_mfma_f32_16x16x32_bf16 v[96:99], a[160:163], a[236:239], v[96:99]
  buffer_load_dwordx4 a[36:39], v1, s[8:11], s73 offen offset:0 sc1
  v_rcp_f32 v27, v27
  v_mfma_f32_16x16x32_bf16 v[100:103], a[160:163], a[240:243], 0
  ds_read_b64_tr_b16 a[176:177], v6 offset:61440
  v_rcp_f32 v28, v28
  v_mfma_f32_16x16x32_bf16 v[100:103], a[164:167], a[224:227], v[100:103]
  v_fma_f32 v29, v29, v19, v19
  v_fma_f32 v30, v30, v19, v19
  v_mfma_f32_16x16x32_bf16 v[104:107], a[164:167], a[228:231], 0
  ds_read_b64_tr_b16 a[178:179], v6 offset:63488
  v_fma_f32 v31, v31, v19, v19
  v_mfma_f32_16x16x32_bf16 v[104:107], a[160:163], a[244:247], v[104:107]
  buffer_load_dwordx4 a[52:55], v1, s[8:11], s73 offen offset:1024 sc1
  v_rcp_f32 v29, v29
  v_mul_f32 v208, v208, v24
  v_mfma_f32_16x16x32_bf16 v[108:111], a[160:163], a[248:251], 0
  ds_read_b64_tr_b16 a[160:161], v7 offset:57344
  v_mul_f32 v209, v209, v25
  v_mfma_f32_16x16x32_bf16 v[108:111], a[164:167], a[232:235], v[108:111]
  s_waitcnt lgkmcnt(5)
  s_add_u32 s73, s73, s88
  v_rcp_f32 v30, v30
  v_mfma_f32_16x16x32_bf16 v[124:127], a[172:175], a[232:235], 0
  ds_read_b64_tr_b16 a[162:163], v7 offset:59392
  v_mul_f32 v210, v210, v26
  v_mfma_f32_16x16x32_bf16 v[124:127], a[168:171], a[248:251], v[124:127]
  buffer_load_dwordx4 a[40:43], v1, s[8:11], s73 offen offset:0 sc1
  v_rcp_f32 v31, v31
  v_mfma_f32_16x16x32_bf16 v[120:123], a[168:171], a[244:247], 0
  ds_read_b64_tr_b16 a[164:165], v7 offset:61440
  v_mul_f32 v211, v211, v27
  v_mul_f32 v212, v212, v28
  v_mfma_f32_16x16x32_bf16 v[120:123], a[172:175], a[228:231], v[120:123]
  v_mul_f32 v213, v213, v29
  v_mul_f32 v214, v214, v30
  v_mfma_f32_16x16x32_bf16 v[116:119], a[172:175], a[224:227], 0
  ds_read_b64_tr_b16 a[166:167], v7 offset:63488
  v_mul_f32 v215, v215, v31
  v_mfma_f32_16x16x32_bf16 v[116:119], a[168:171], a[240:243], v[116:119]
  buffer_load_dwordx4 a[56:59], v1, s[8:11], s73 offen offset:1024 sc1
  v_cvt_pk_bf16_f32 v192, v208, v209
  v_cvt_pk_bf16_f32 v193, v210, v211
  v_cvt_pk_bf16_f32 v196, v212, v213
  v_mfma_f32_16x16x32_bf16 v[112:115], a[168:171], a[236:239], 0
  ds_read_b64_tr_b16 a[168:169], v8 offset:57344
  v_cvt_pk_bf16_f32 v197, v214, v215
  v_mfma_f32_16x16x32_bf16 v[112:115], a[172:175], a[220:223], v[112:115]
  s_waitcnt lgkmcnt(5)
  v_fma_f32 v200, v200, v20, v60
  v_exp_f32 v24, v200
  v_mfma_f32_16x16x32_bf16 v[128:131], a[180:183], a[220:223], 0
  ds_read_b64_tr_b16 a[170:171], v8 offset:59392
  v_fma_f32 v201, v201, v20, v61
  v_mfma_f32_16x16x32_bf16 v[128:131], a[176:179], a[236:239], v[128:131]
  s_add_u32 s73, s73, 131072
  v_exp_f32 v25, v201
  v_mfma_f32_16x16x32_bf16 v[132:135], a[176:179], a[240:243], 0
  ds_read_b64_tr_b16 a[172:173], v8 offset:61440
  v_fma_f32 v202, v202, v20, v62
  v_fma_f32 v203, v203, v20, v63
  v_mfma_f32_16x16x32_bf16 v[132:135], a[180:183], a[224:227], v[132:135]
  buffer_load_dwordx4 a[44:47], v1, s[8:11], s73 offen offset:0 sc1
  v_exp_f32 v26, v202
  v_mfma_f32_16x16x32_bf16 v[136:139], a[180:183], a[228:231], 0
  ds_read_b64_tr_b16 a[174:175], v8 offset:63488
  v_fma_f32 v204, v204, v22, v60
  v_mfma_f32_16x16x32_bf16 v[136:139], a[176:179], a[244:247], v[136:139]
  v_exp_f32 v27, v203
  v_fma_f32 v205, v205, v22, v61
  v_mfma_f32_16x16x32_bf16 v[140:143], a[176:179], a[248:251], 0
  ds_read_b64_tr_b16 a[176:177], v9 offset:57344
  v_fma_f32 v206, v206, v22, v62
  v_mfma_f32_16x16x32_bf16 v[140:143], a[180:183], a[232:235], v[140:143]
  s_waitcnt lgkmcnt(5)
  buffer_load_dwordx4 a[60:63], v1, s[8:11], s73 offen offset:1024 sc1
  v_exp_f32 v28, v204
  v_mfma_f32_16x16x32_bf16 v[156:159], a[160:163], a[232:235], 0
  ds_read_b64_tr_b16 a[178:179], v9 offset:59392
  v_fma_f32 v207, v207, v22, v63
  v_mfma_f32_16x16x32_bf16 v[156:159], a[164:167], a[248:251], v[156:159]
  v_exp_f32 v29, v205
  v_mfma_f32_16x16x32_bf16 v[152:155], a[164:167], a[244:247], 0
  ds_read_b64_tr_b16 a[180:181], v9 offset:61440
  v_exp_f32 v30, v206
  v_mfma_f32_16x16x32_bf16 v[152:155], a[160:163], a[228:231], v[152:155]
  buffer_load_dwordx4 a[64:67], v1, s[8:11], s74 offen offset:0 sc1
  v_exp_f32 v31, v207
  v_mfma_f32_16x16x32_bf16 v[148:151], a[160:163], a[224:227], 0
  ds_read_b64_tr_b16 a[182:183], v9 offset:63488
  v_mul_f32 v216, v200, v216
  v_mfma_f32_16x16x32_bf16 v[148:151], a[164:167], a[240:243], v[148:151]
  ds_read_b128 v[60:63], v12 offset:704
  v_mul_f32 v217, v201, v217
  v_mul_f32 v218, v202, v218
  v_mfma_f32_16x16x32_bf16 v[144:147], a[164:167], a[236:239], 0
  ds_read_b64_tr_b16 a[164:165], v6 offset:16384
  v_mul_f32 v219, v203, v219
  v_mfma_f32_16x16x32_bf16 v[144:147], a[160:163], a[220:223], v[144:147]
  s_waitcnt lgkmcnt(6)
  buffer_load_dwordx4 a[80:83], v1, s[8:11], s74 offen offset:1024 sc1
  v_mul_f32 v220, v204, v220
  v_mul_f32 v221, v205, v221
  v_mfma_f32_16x16x32_bf16 v[160:163], a[168:171], a[220:223], 0
  ds_read_b64_tr_b16 a[166:167], v6 offset:18432
  v_mul_f32 v222, v206, v222
  v_mfma_f32_16x16x32_bf16 v[160:163], a[172:175], a[236:239], v[160:163]
  v_mul_f32 v223, v207, v223
  v_fma_f32 v24, v24, v21, v21
  v_mfma_f32_16x16x32_bf16 v[164:167], a[172:175], a[240:243], 0
  ds_read_b64_tr_b16 a[160:161], v6 offset:20480
  v_rcp_f32 v24, v24
  v_mfma_f32_16x16x32_bf16 v[164:167], a[168:171], a[224:227], v[164:167]
  s_add_u32 s74, s74, 131072
  v_fma_f32 v25, v25, v21, v21
  v_fma_f32 v26, v26, v21, v21
  v_mfma_f32_16x16x32_bf16 v[168:171], a[168:171], a[228:231], 0
  ds_read_b64_tr_b16 a[162:163], v6 offset:22528
  v_fma_f32 v27, v27, v21, v21
  v_mfma_f32_16x16x32_bf16 v[168:171], a[172:175], a[244:247], v[168:171]
  buffer_load_dwordx4 a[68:71], v1, s[8:11], s74 offen offset:0 sc1
  v_rcp_f32 v25, v25
  v_fma_f32 v28, v28, v23, v23
  v_mfma_f32_16x16x32_bf16 v[172:175], a[172:175], a[248:251], 0
  ds_read_b64_tr_b16 a[172:173], v7 offset:16384
  v_fma_f32 v29, v29, v23, v23
  v_mfma_f32_16x16x32_bf16 v[172:175], a[168:171], a[232:235], v[172:175]
  s_waitcnt lgkmcnt(6)
  v_rcp_f32 v26, v26
  v_fma_f32 v30, v30, v23, v23
  v_mfma_f32_16x16x32_bf16 v[188:191], a[176:179], a[232:235], 0
  ds_read_b64_tr_b16 a[174:175], v7 offset:18432
  v_fma_f32 v31, v31, v23, v23
  v_mfma_f32_16x16x32_bf16 v[188:191], a[180:183], a[248:251], v[188:191]
  buffer_load_dwordx4 a[84:87], v1, s[8:11], s74 offen offset:1024 sc1
  v_rcp_f32 v27, v27
  v_mfma_f32_16x16x32_bf16 v[184:187], a[180:183], a[244:247], 0
  ds_read_b64_tr_b16 a[168:169], v7 offset:20480
  v_rcp_f32 v28, v28
  v_mfma_f32_16x16x32_bf16 v[184:187], a[176:179], a[228:231], v[184:187]
  s_add_u32 s74, s74, s88
  v_rcp_f32 v29, v29
  v_mfma_f32_16x16x32_bf16 v[180:183], a[176:179], a[224:227], 0
  ds_read_b64_tr_b16 a[170:171], v7 offset:22528
  v_mul_f32 v216, v216, v24
  v_mfma_f32_16x16x32_bf16 v[180:183], a[180:183], a[240:243], v[180:183]
  buffer_load_dwordx4 a[72:75], v1, s[8:11], s74 offen offset:0 sc1
  v_rcp_f32 v30, v30
  v_mul_f32 v217, v217, v25
  v_mfma_f32_16x16x32_bf16 v[176:179], a[180:183], a[236:239], 0
  ds_read_b64_tr_b16 a[180:181], v8 offset:16384
  v_mul_f32 v218, v218, v26
  v_mfma_f32_16x16x32_bf16 v[176:179], a[176:179], a[220:223], v[176:179]
  s_waitcnt vmcnt(13) lgkmcnt(5)
  v_rcp_f32 v31, v31
  v_mul_f32 v219, v219, v27
  v_mfma_f32_16x16x32_bf16 v[64:67], a[164:167], a[0:3], v[64:67]
  ds_read_b64_tr_b16 a[182:183], v8 offset:18432
  v_mul_f32 v220, v220, v28
  v_mfma_f32_16x16x32_bf16 v[64:67], a[160:163], a[16:19], v[64:67]
  buffer_load_dwordx4 a[88:91], v1, s[8:11], s74 offen offset:1024 sc1
  v_mul_f32 v221, v221, v29
  v_mul_f32 v222, v222, v30
  v_mfma_f32_16x16x32_bf16 v[68:71], a[160:163], a[20:23], v[68:71]
  ds_read_b64_tr_b16 a[176:177], v8 offset:20480
  v_mul_f32 v223, v223, v31
  v_cvt_pk_bf16_f32 v200, v216, v217
  v_mfma_f32_16x16x32_bf16 v[68:71], a[164:167], a[4:7], v[68:71]
  v_cvt_pk_bf16_f32 v201, v218, v219
  v_cvt_pk_bf16_f32 v204, v220, v221
  v_mfma_f32_16x16x32_bf16 v[72:75], a[164:167], a[8:11], v[72:75]
  ds_read_b64_tr_b16 a[178:179], v8 offset:22528
  v_cvt_pk_bf16_f32 v205, v222, v223
  v_mfma_f32_16x16x32_bf16 v[72:75], a[160:163], a[24:27], v[72:75]
  s_add_u32 s74, s74, 131072
  v_mfma_f32_16x16x32_bf16 v[76:79], a[160:163], a[28:31], v[76:79]
  ds_read_b64_tr_b16 a[160:161], v9 offset:16384
  s_waitcnt lgkmcnt(13)
  v_fma_f32 v224, v224, v16, v60
  v_mfma_f32_16x16x32_bf16 v[76:79], a[164:167], a[12:15], v[76:79]
  s_waitcnt lgkmcnt(5)
  buffer_load_dwordx4 a[76:79], v1, s[8:11], s74 offen offset:0 sc1
  v_exp_f32 v24, v224
  v_mfma_f32_16x16x32_bf16 v[92:95], a[172:175], a[12:15], v[92:95]
  ds_read_b64_tr_b16 a[162:163], v9 offset:18432
  v_fma_f32 v225, v225, v16, v61
  v_fma_f32 v226, v226, v16, v62
  v_mfma_f32_16x16x32_bf16 v[92:95], a[168:171], a[28:31], v[92:95]
  v_exp_f32 v25, v225
  v_fma_f32 v227, v227, v16, v63
  v_mfma_f32_16x16x32_bf16 v[88:91], a[168:171], a[24:27], v[88:91]
  ds_read_b64_tr_b16 a[164:165], v9 offset:20480
  v_fma_f32 v228, v228, v18, v60
  v_mfma_f32_16x16x32_bf16 v[88:91], a[172:175], a[8:11], v[88:91]
  buffer_load_dwordx4 a[92:95], v1, s[8:11], s74 offen offset:1024 sc1
  v_exp_f32 v26, v226
  v_fma_f32 v229, v229, v18, v61
  v_mfma_f32_16x16x32_bf16 v[84:87], a[172:175], a[4:7], v[84:87]
  ds_read_b64_tr_b16 a[166:167], v9 offset:22528
  v_exp_f32 v27, v227
  v_mfma_f32_16x16x32_bf16 v[84:87], a[168:171], a[20:23], v[84:87]
  s_cmp_eq_u32 s90, 1
  s_cselect_b32 s75, 3, 10
  s_lshl_b32 s67, s75, 17
  s_lshl_b32 s75, s75, 11
  s_add_u32 s75, s75, s83
  s_add_u32 m0, s45, 32768
  v_exp_f32 v28, v228
  v_fma_f32 v230, v230, v18, v62
  v_mfma_f32_16x16x32_bf16 v[80:83], a[168:171], a[16:19], v[80:83]
  ds_read_b64_tr_b16 a[168:169], v6 offset:24576
  v_exp_f32 v29, v229
  v_mfma_f32_16x16x32_bf16 v[80:83], a[172:175], a[0:3], v[80:83]
  s_waitcnt lgkmcnt(5)
  buffer_load_dwordx4 v32, s[36:39], s67 offen lds
  v_exp_f32 v30, v230
  v_mfma_f32_16x16x32_bf16 v[96:99], a[180:183], a[0:3], v[96:99]
  ds_read_b64_tr_b16 a[170:171], v6 offset:26624
  v_fma_f32 v231, v231, v18, v63
  v_mfma_f32_16x16x32_bf16 v[96:99], a[176:179], a[16:19], v[96:99]
  s_add_u32 m0, s45, 36864
  s_add_u32 s60, s67, 65536
  v_exp_f32 v31, v231
  v_mfma_f32_16x16x32_bf16 v[100:103], a[176:179], a[20:23], v[100:103]
  ds_read_b64_tr_b16 a[172:173], v6 offset:28672
  v_mul_f32 v240, v224, v240
  v_mul_f32 v241, v225, v241
  v_mfma_f32_16x16x32_bf16 v[100:103], a[180:183], a[4:7], v[100:103]
  buffer_load_dwordx4 v32, s[36:39], s60 offen lds
  v_mul_f32 v242, v226, v242
  v_mul_f32 v243, v227, v243
  v_mul_f32 v244, v228, v244
  v_mfma_f32_16x16x32_bf16 v[104:107], a[180:183], a[8:11], v[104:107]
  ds_read_b64_tr_b16 a[174:175], v6 offset:30720
  v_mul_f32 v245, v229, v245
  v_mul_f32 v246, v230, v246
  v_mfma_f32_16x16x32_bf16 v[104:107], a[176:179], a[24:27], v[104:107]
  v_mul_f32 v247, v231, v247
  v_fma_f32 v24, v24, v17, v17
  v_mfma_f32_16x16x32_bf16 v[108:111], a[176:179], a[28:31], v[108:111]
  ds_read_b64_tr_b16 a[176:177], v7 offset:24576
  v_rcp_f32 v24, v24
  v_mfma_f32_16x16x32_bf16 v[108:111], a[180:183], a[12:15], v[108:111]
  s_waitcnt lgkmcnt(5)
  s_add_u32 m0, s45, 40960
  v_fma_f32 v25, v25, v17, v17
  v_fma_f32 v26, v26, v17, v17
  v_mfma_f32_16x16x32_bf16 v[124:127], a[160:163], a[12:15], v[124:127]
  ds_read_b64_tr_b16 a[178:179], v7 offset:26624
  v_rcp_f32 v25, v25
  v_mfma_f32_16x16x32_bf16 v[124:127], a[164:167], a[28:31], v[124:127]
  buffer_load_dwordx4 v33, s[36:39], s67 offen lds
  v_rcp_f32 v26, v26
  v_fma_f32 v27, v27, v17, v17
  v_mfma_f32_16x16x32_bf16 v[120:123], a[164:167], a[24:27], v[120:123]
  ds_read_b64_tr_b16 a[180:181], v7 offset:28672
  v_fma_f32 v28, v28, v19, v19
  v_mfma_f32_16x16x32_bf16 v[120:123], a[160:163], a[8:11], v[120:123]
  s_add_u32 m0, s45, 45056
  s_add_u32 s60, s67, 65536
  v_rcp_f32 v27, v27
  v_mfma_f32_16x16x32_bf16 v[116:119], a[160:163], a[4:7], v[116:119]
  ds_read_b64_tr_b16 a[182:183], v7 offset:30720
  v_rcp_f32 v28, v28
  v_mfma_f32_16x16x32_bf16 v[116:119], a[164:167], a[20:23], v[116:119]
  buffer_load_dwordx4 v33, s[36:39], s60 offen lds
  v_fma_f32 v29, v29, v19, v19
  v_rcp_f32 v29, v29
  v_mfma_f32_16x16x32_bf16 v[112:115], a[164:167], a[16:19], v[112:115]
  ds_read_b64_tr_b16 a[164:165], v8 offset:24576
  v_fma_f32 v30, v30, v19, v19
  v_fma_f32 v31, v31, v19, v19
  v_mfma_f32_16x16x32_bf16 v[112:115], a[160:163], a[0:3], v[112:115]
  s_waitcnt lgkmcnt(5)
  s_cmp_eq_u32 s90, 2
  s_cselect_b32 s76, 5, 12
  s_lshl_b32 s68, s76, 17
  s_lshl_b32 s76, s76, 11
  s_add_u32 s76, s76, s83
HOP16:
  s_cbranch_execz WRET1
  s_add_u32 m0, s45, 49152
  v_rcp_f32 v30, v30
  v_mfma_f32_16x16x32_bf16 v[128:131], a[168:171], a[0:3], v[128:131]
  ds_read_b64_tr_b16 a[166:167], v8 offset:26624
  v_mul_f32 v240, v240, v24
  v_mfma_f32_16x16x32_bf16 v[128:131], a[172:175], a[16:19], v[128:131]
  buffer_load_dwordx4 v32, s[36:39], s68 offen lds
  v_rcp_f32 v31, v31
  v_mul_f32 v241, v241, v25
  v_mfma_f32_16x16x32_bf16 v[132:135], a[172:175], a[20:23], v[132:135]
  ds_read_b64_tr_b16 a[160:161], v8 offset:28672
  v_mul_f32 v242, v242, v26
  v_mul_f32 v243, v243, v27
  v_mfma_f32_16x16x32_bf16 v[132:135], a[168:171], a[4:7], v[132:135]
  s_add_u32 m0, s45, 53248
  s_add_u32 s60, s68, 65536
  v_mul_f32 v244, v244, v28
  v_mul_f32 v245, v245, v29
  v_mfma_f32_16x16x32_bf16 v[136:139], a[168:171], a[8:11], v[136:139]
  ds_read_b64_tr_b16 a[162:163], v8 offset:30720
  v_mul_f32 v246, v246, v30
  v_mul_f32 v247, v247, v31
  v_mfma_f32_16x16x32_bf16 v[136:139], a[172:175], a[24:27], v[136:139]
  buffer_load_dwordx4 v32, s[36:39], s60 offen lds
  v_cvt_pk_bf16_f32 v194, v240, v241
  v_cvt_pk_bf16_f32 v195, v242, v243
  v_mfma_f32_16x16x32_bf16 v[140:143], a[172:175], a[28:31], v[140:143]
  ds_read_b64_tr_b16 a[172:173], v9 offset:24576
  v_cvt_pk_bf16_f32 v198, v244, v245
  v_cvt_pk_bf16_f32 v199, v246, v247
  v_mfma_f32_16x16x32_bf16 v[140:143], a[168:171], a[12:15], v[140:143]
  s_waitcnt lgkmcnt(5)
  buffer_store_dwordx4 v[192:195], v1, s[8:11], s57 offen offset:1024 sc1
  v_mfma_f32_16x16x32_bf16 v[156:159], a[176:179], a[12:15], v[156:159]
  ds_read_b64_tr_b16 a[174:175], v9 offset:26624
  v_fma_f32 v232, v232, v20, v60
  v_fma_f32 v233, v233, v20, v61
  v_mfma_f32_16x16x32_bf16 v[156:159], a[180:183], a[28:31], v[156:159]
  s_add_u32 m0, s45, 57344
  s_add_u32 s55, s57, 262144
  buffer_store_dwordx4 v[196:199], v1, s[8:11], s55 offen offset:1024 sc1
  v_mfma_f32_16x16x32_bf16 v[152:155], a[180:183], a[24:27], v[152:155]
  ds_read_b64_tr_b16 a[168:169], v9 offset:28672
  v_fma_f32 v234, v234, v20, v62
  v_mfma_f32_16x16x32_bf16 v[152:155], a[176:179], a[8:11], v[152:155]
  buffer_load_dwordx4 v33, s[36:39], s68 offen lds
  v_exp_f32 v24, v232
  v_fma_f32 v235, v235, v20, v63
  v_mfma_f32_16x16x32_bf16 v[148:151], a[176:179], a[4:7], v[148:151]
  ds_read_b64_tr_b16 a[170:171], v9 offset:30720
  v_exp_f32 v25, v233
  v_mfma_f32_16x16x32_bf16 v[148:151], a[180:183], a[20:23], v[148:151]
  v_fma_f32 v236, v236, v22, v60
  s_waitcnt vmcnt(48)
  s_barrier
  v_mfma_f32_16x16x32_bf16 v[144:147], a[180:183], a[16:19], v[144:147]
  ds_read_b64_tr_b16 a[180:181], v6 offset:0
  s_add_u32 m0, s45, 61440
  s_add_u32 s60, s68, 65536
  v_mfma_f32_16x16x32_bf16 v[144:147], a[176:179], a[0:3], v[144:147]
  s_waitcnt lgkmcnt(5)
  buffer_load_dwordx4 v33, s[36:39], s60 offen lds
  v_exp_f32 v26, v234
  v_mfma_f32_16x16x32_bf16 v[160:163], a[164:167], a[0:3], v[160:163]
  ds_read_b64_tr_b16 a[182:183], v6 offset:2048
  v_fma_f32 v237, v237, v22, v61
  v_mfma_f32_16x16x32_bf16 v[160:163], a[160:163], a[16:19], v[160:163]
  v_exp_f32 v27, v235
  v_fma_f32 v238, v238, v22, v62
  v_mfma_f32_16x16x32_bf16 v[164:167], a[160:163], a[20:23], v[164:167]
  ds_read_b64_tr_b16 a[176:177], v6 offset:4096
  v_exp_f32 v28, v236
  v_mfma_f32_16x16x32_bf16 v[164:167], a[164:167], a[4:7], v[164:167]
  buffer_load_dwordx4 a[96:99], v1, s[8:11], s75 offen offset:0 sc1
  v_exp_f32 v29, v237
  v_fma_f32 v239, v239, v22, v63
  v_mfma_f32_16x16x32_bf16 v[168:171], a[164:167], a[8:11], v[168:171]
  ds_read_b64_tr_b16 a[178:179], v6 offset:6144
  v_exp_f32 v30, v238
  v_mfma_f32_16x16x32_bf16 v[168:171], a[160:163], a[24:27], v[168:171]
  v_exp_f32 v31, v239
  v_mfma_f32_16x16x32_bf16 v[172:175], a[160:163], a[28:31], v[172:175]
  ds_read_b64_tr_b16 a[160:161], v7 offset:0
  v_mul_f32 v248, v232, v248
  v_mul_f32 v249, v233, v249
  v_mfma_f32_16x16x32_bf16 v[172:175], a[164:167], a[12:15], v[172:175]
  s_waitcnt lgkmcnt(5)
  buffer_load_dwordx4 a[112:115], v1, s[8:11], s75 offen offset:1024 sc1
  v_mul_f32 v250, v234, v250
  v_mul_f32 v251, v235, v251
  v_mfma_f32_16x16x32_bf16 v[188:191], a[172:175], a[12:15], v[188:191]
  ds_read_b64_tr_b16 a[162:163], v7 offset:2048
  v_mul_f32 v252, v236, v252
  v_mul_f32 v253, v237, v253
  v_mfma_f32_16x16x32_bf16 v[188:191], a[168:171], a[28:31], v[188:191]
  v_mul_f32 v254, v238, v254
  v_mul_f32 v255, v239, v255
  v_fma_f32 v24, v24, v21, v21
  v_mfma_f32_16x16x32_bf16 v[184:187], a[168:171], a[24:27], v[184:187]
  ds_read_b64_tr_b16 a[164:165], v7 offset:4096
  v_fma_f32 v25, v25, v21, v21
  v_mfma_f32_16x16x32_bf16 v[184:187], a[172:175], a[8:11], v[184:187]
  s_add_u32 s75, s75, 131072
  v_rcp_f32 v24, v24
  v_fma_f32 v26, v26, v21, v21
  v_mfma_f32_16x16x32_bf16 v[180:183], a[172:175], a[4:7], v[180:183]
  ds_read_b64_tr_b16 a[166:167], v7 offset:6144
  v_rcp_f32 v25, v25
  v_mfma_f32_16x16x32_bf16 v[180:183], a[168:171], a[20:23], v[180:183]
  buffer_load_dwordx4 a[100:103], v1, s[8:11], s75 offen offset:0 sc1
  v_rcp_f32 v26, v26
  v_fma_f32 v27, v27, v21, v21
  v_mfma_f32_16x16x32_bf16 v[176:179], a[168:171], a[16:19], v[176:179]
  ds_read_b64_tr_b16 a[168:169], v8 offset:0
  v_rcp_f32 v27, v27
  v_mfma_f32_16x16x32_bf16 v[176:179], a[172:175], a[0:3], v[176:179]
  s_waitcnt vmcnt(21) lgkmcnt(5)
  v_fma_f32 v28, v28, v23, v23
  v_rcp_f32 v28, v28
  v_mfma_f32_16x16x32_bf16 v[64:67], a[180:183], a[32:35], v[64:67]
  ds_read_b64_tr_b16 a[170:171], v8 offset:2048
  v_fma_f32 v29, v29, v23, v23
  v_mfma_f32_16x16x32_bf16 v[64:67], a[176:179], a[48:51], v[64:67]
  buffer_load_dwordx4 a[116:119], v1, s[8:11], s75 offen offset:1024 sc1
  v_rcp_f32 v29, v29
  v_fma_f32 v30, v30, v23, v23
  v_mfma_f32_16x16x32_bf16 v[68:71], a[176:179], a[52:55], v[68:71]
  ds_read_b64_tr_b16 a[172:173], v8 offset:4096
  v_rcp_f32 v30, v30
  v_mfma_f32_16x16x32_bf16 v[68:71], a[180:183], a[36:39], v[68:71]
  s_add_u32 s75, s75, s88
  v_fma_f32 v31, v31, v23, v23
  v_rcp_f32 v31, v31
  v_mfma_f32_16x16x32_bf16 v[72:75], a[180:183], a[40:43], v[72:75]
  ds_read_b64_tr_b16 a[174:175], v8 offset:6144
  v_mul_f32 v248, v248, v24
  v_mul_f32 v249, v249, v25
  v_mfma_f32_16x16x32_bf16 v[72:75], a[176:179], a[56:59], v[72:75]
  buffer_load_dwordx4 a[104:107], v1, s[8:11], s75 offen offset:0 sc1
  v_mul_f32 v250, v250, v26
  v_mul_f32 v251, v251, v27
  v_mfma_f32_16x16x32_bf16 v[76:79], a[176:179], a[60:63], v[76:79]
  ds_read_b64_tr_b16 a[176:177], v9 offset:0
  v_mul_f32 v252, v252, v28
  v_mul_f32 v253, v253, v29
  v_mfma_f32_16x16x32_bf16 v[76:79], a[180:183], a[44:47], v[76:79]
  s_waitcnt lgkmcnt(5)
  v_mul_f32 v254, v254, v30
  v_mul_f32 v255, v255, v31
  v_cvt_pk_bf16_f32 v202, v248, v249
  v_mfma_f32_16x16x32_bf16 v[92:95], a[160:163], a[44:47], v[92:95]
  ds_read_b64_tr_b16 a[178:179], v9 offset:2048
  v_cvt_pk_bf16_f32 v203, v250, v251
  v_cvt_pk_bf16_f32 v206, v252, v253
  v_mfma_f32_16x16x32_bf16 v[92:95], a[164:167], a[60:63], v[92:95]
  buffer_load_dwordx4 a[120:123], v1, s[8:11], s75 offen offset:1024 sc1
  s_add_u32 s55, s57, 524288
  buffer_store_dwordx4 v[200:203], v1, s[8:11], s55 offen offset:1024 sc1
  v_mfma_f32_16x16x32_bf16 v[88:91], a[164:167], a[56:59], v[88:91]
  ds_read_b64_tr_b16 a[180:181], v9 offset:4096
  v_cvt_pk_bf16_f32 v207, v254, v255
  v_mfma_f32_16x16x32_bf16 v[88:91], a[160:163], a[40:43], v[88:91]
  s_add_u32 s55, s57, 786432
  buffer_store_dwordx4 v[204:207], v1, s[8:11], s55 offen offset:1024 sc1
  v_mfma_f32_16x16x32_bf16 v[84:87], a[160:163], a[36:39], v[84:87]
  ds_read_b64_tr_b16 a[182:183], v9 offset:6144
  s_sub_u32 s79, s79, 491520
  v_mfma_f32_16x16x32_bf16 v[84:87], a[164:167], a[52:55], v[84:87]
  s_add_u32 s75, s75, 131072
  v_mfma_f32_16x16x32_bf16 v[80:83], a[164:167], a[48:51], v[80:83]
  ds_read_b64_tr_b16 a[164:165], v6 offset:8192
  v_mfma_f32_16x16x32_bf16 v[80:83], a[160:163], a[32:35], v[80:83]
  s_waitcnt lgkmcnt(5)
  buffer_load_dwordx4 a[108:111], v1, s[8:11], s75 offen offset:0 sc1
  v_mfma_f32_16x16x32_bf16 v[96:99], a[168:171], a[32:35], v[96:99]
  ds_read_b64_tr_b16 a[166:167], v6 offset:10240
  v_mfma_f32_16x16x32_bf16 v[96:99], a[172:175], a[48:51], v[96:99]
  v_mfma_f32_16x16x32_bf16 v[100:103], a[172:175], a[52:55], v[100:103]
  ds_read_b64_tr_b16 a[160:161], v6 offset:12288
  v_mfma_f32_16x16x32_bf16 v[100:103], a[168:171], a[36:39], v[100:103]
  buffer_load_dwordx4 a[124:127], v1, s[8:11], s75 offen offset:1024 sc1
  v_mfma_f32_16x16x32_bf16 v[104:107], a[168:171], a[40:43], v[104:107]
  ds_read_b64_tr_b16 a[162:163], v6 offset:14336
  v_mfma_f32_16x16x32_bf16 v[104:107], a[172:175], a[56:59], v[104:107]
  v_mfma_f32_16x16x32_bf16 v[108:111], a[172:175], a[60:63], v[108:111]
  ds_read_b64_tr_b16 a[172:173], v7 offset:8192
  v_mfma_f32_16x16x32_bf16 v[108:111], a[168:171], a[44:47], v[108:111]
  s_waitcnt lgkmcnt(5)
  buffer_load_dwordx4 a[128:131], v1, s[8:11], s76 offen offset:0 sc1
  v_mfma_f32_16x16x32_bf16 v[124:127], a[176:179], a[44:47], v[124:127]
  ds_read_b64_tr_b16 a[174:175], v7 offset:10240
  v_mfma_f32_16x16x32_bf16 v[124:127], a[180:183], a[60:63], v[124:127]
  v_mfma_f32_16x16x32_bf16 v[120:123], a[180:183], a[56:59], v[120:123]
  ds_read_b64_tr_b16 a[168:169], v7 offset:12288
  v_mfma_f32_16x16x32_bf16 v[120:123], a[176:179], a[40:43], v[120:123]
  buffer_load_dwordx4 a[144:147], v1, s[8:11], s76 offen offset:1024 sc1
  v_mfma_f32_16x16x32_bf16 v[116:119], a[176:179], a[36:39], v[116:119]
  ds_read_b64_tr_b16 a[170:171], v7 offset:14336
  v_mfma_f32_16x16x32_bf16 v[116:119], a[180:183], a[52:55], v[116:119]
  v_mfma_f32_16x16x32_bf16 v[112:115], a[180:183], a[48:51], v[112:115]
  ds_read_b64_tr_b16 a[180:181], v8 offset:8192
  v_mfma_f32_16x16x32_bf16 v[112:115], a[176:179], a[32:35], v[112:115]
  s_waitcnt lgkmcnt(5)
  s_add_u32 s76, s76, 131072
  v_mfma_f32_16x16x32_bf16 v[128:131], a[164:167], a[32:35], v[128:131]
  ds_read_b64_tr_b16 a[182:183], v8 offset:10240
  v_mfma_f32_16x16x32_bf16 v[128:131], a[160:163], a[48:51], v[128:131]
  buffer_load_dwordx4 a[132:135], v1, s[8:11], s76 offen offset:0 sc1
  v_mfma_f32_16x16x32_bf16 v[132:135], a[160:163], a[52:55], v[132:135]
  ds_read_b64_tr_b16 a[176:177], v8 offset:12288
  v_mfma_f32_16x16x32_bf16 v[132:135], a[164:167], a[36:39], v[132:135]
  v_mfma_f32_16x16x32_bf16 v[136:139], a[164:167], a[40:43], v[136:139]
  ds_read_b64_tr_b16 a[178:179], v8 offset:14336
  v_mfma_f32_16x16x32_bf16 v[136:139], a[160:163], a[56:59], v[136:139]
  buffer_load_dwordx4 a[148:151], v1, s[8:11], s76 offen offset:1024 sc1
  v_mfma_f32_16x16x32_bf16 v[140:143], a[160:163], a[60:63], v[140:143]
  ds_read_b64_tr_b16 a[160:161], v9 offset:8192
  v_mfma_f32_16x16x32_bf16 v[140:143], a[164:167], a[44:47], v[140:143]
  s_waitcnt lgkmcnt(5)
  s_add_u32 s76, s76, s88
  v_mfma_f32_16x16x32_bf16 v[156:159], a[172:175], a[44:47], v[156:159]
  ds_read_b64_tr_b16 a[162:163], v9 offset:10240
  v_mfma_f32_16x16x32_bf16 v[156:159], a[168:171], a[60:63], v[156:159]
  buffer_load_dwordx4 a[136:139], v1, s[8:11], s76 offen offset:0 sc1
  v_mfma_f32_16x16x32_bf16 v[152:155], a[168:171], a[56:59], v[152:155]
  ds_read_b64_tr_b16 a[164:165], v9 offset:12288
  v_mfma_f32_16x16x32_bf16 v[152:155], a[172:175], a[40:43], v[152:155]
  v_mfma_f32_16x16x32_bf16 v[148:151], a[172:175], a[36:39], v[148:151]
  ds_read_b64_tr_b16 a[166:167], v9 offset:14336
  v_mfma_f32_16x16x32_bf16 v[148:151], a[168:171], a[52:55], v[148:151]
  buffer_load_dwordx4 a[152:155], v1, s[8:11], s76 offen offset:1024 sc1
  v_mfma_f32_16x16x32_bf16 v[144:147], a[168:171], a[48:51], v[144:147]
  ds_read_b64_tr_b16 a[168:169], v2 offset:16384
  v_mfma_f32_16x16x32_bf16 v[144:147], a[172:175], a[32:35], v[144:147]
  s_waitcnt lgkmcnt(5)
  v_mfma_f32_16x16x32_bf16 v[160:163], a[180:183], a[32:35], v[160:163]
  ds_read_b64_tr_b16 a[170:171], v2 offset:18432
  v_mfma_f32_16x16x32_bf16 v[160:163], a[176:179], a[48:51], v[160:163]
  s_add_u32 s76, s76, 131072
  v_mfma_f32_16x16x32_bf16 v[164:167], a[176:179], a[52:55], v[164:167]
  ds_read_b64_tr_b16 a[172:173], v2 offset:20480
  v_mfma_f32_16x16x32_bf16 v[164:167], a[180:183], a[36:39], v[164:167]
  buffer_load_dwordx4 a[140:143], v1, s[8:11], s76 offen offset:0 sc1
  v_mfma_f32_16x16x32_bf16 v[168:171], a[180:183], a[40:43], v[168:171]
  ds_read_b64_tr_b16 a[174:175], v2 offset:22528
  v_mfma_f32_16x16x32_bf16 v[168:171], a[176:179], a[56:59], v[168:171]
  v_mfma_f32_16x16x32_bf16 v[172:175], a[176:179], a[60:63], v[172:175]
  ds_read_b64_tr_b16 a[176:177], v3 offset:16384
  v_mfma_f32_16x16x32_bf16 v[172:175], a[180:183], a[44:47], v[172:175]
  s_waitcnt lgkmcnt(5)
  buffer_load_dwordx4 a[156:159], v1, s[8:11], s76 offen offset:1024 sc1
  v_mfma_f32_16x16x32_bf16 v[188:191], a[160:163], a[44:47], v[188:191]
  ds_read_b64_tr_b16 a[178:179], v3 offset:18432
  v_mfma_f32_16x16x32_bf16 v[188:191], a[164:167], a[60:63], v[188:191]
  s_cmp_eq_u32 s90, 0
  s_cselect_b32 s77, 7, 0
  s_lshl_b32 s69, s77, 17
  s_lshl_b32 s77, s77, 11
  s_add_u32 s77, s77, s83
  s_add_u32 m0, s45, 0
  v_mfma_f32_16x16x32_bf16 v[184:187], a[164:167], a[56:59], v[184:187]
  ds_read_b64_tr_b16 a[180:181], v3 offset:20480
  v_mfma_f32_16x16x32_bf16 v[184:187], a[160:163], a[40:43], v[184:187]
  buffer_load_dwordx4 v32, s[36:39], s69 offen lds
  v_mfma_f32_16x16x32_bf16 v[180:183], a[160:163], a[36:39], v[180:183]
  ds_read_b64_tr_b16 a[182:183], v3 offset:22528
  v_mfma_f32_16x16x32_bf16 v[180:183], a[164:167], a[52:55], v[180:183]
  s_add_u32 m0, s45, 4096
  s_add_u32 s60, s69, 65536
  v_mfma_f32_16x16x32_bf16 v[176:179], a[164:167], a[48:51], v[176:179]
  ds_read_b64_tr_b16 a[164:165], v4 offset:16384
  v_mfma_f32_16x16x32_bf16 v[176:179], a[160:163], a[32:35], v[176:179]
  s_waitcnt vmcnt(29) lgkmcnt(5)
  buffer_load_dwordx4 v32, s[36:39], s60 offen lds
  v_mfma_f32_16x16x32_bf16 v[64:67], a[168:171], a[64:67], v[64:67]
  ds_read_b64_tr_b16 a[166:167], v4 offset:18432
  v_mfma_f32_16x16x32_bf16 v[64:67], a[172:175], a[80:83], v[64:67]
  v_mfma_f32_16x16x32_bf16 v[68:71], a[172:175], a[84:87], v[68:71]
  ds_read_b64_tr_b16 a[160:161], v4 offset:20480
  v_mfma_f32_16x16x32_bf16 v[68:71], a[168:171], a[68:71], v[68:71]
  s_add_u32 m0, s45, 8192
  v_mfma_f32_16x16x32_bf16 v[72:75], a[168:171], a[72:75], v[72:75]
  ds_read_b64_tr_b16 a[162:163], v4 offset:22528
  v_mfma_f32_16x16x32_bf16 v[72:75], a[172:175], a[88:91], v[72:75]
  buffer_load_dwordx4 v33, s[36:39], s69 offen lds
  v_mfma_f32_16x16x32_bf16 v[76:79], a[172:175], a[92:95], v[76:79]
  ds_read_b64_tr_b16 a[172:173], v5 offset:16384
  v_mfma_f32_16x16x32_bf16 v[76:79], a[168:171], a[76:79], v[76:79]
  s_waitcnt lgkmcnt(5)
  s_add_u32 m0, s45, 12288
  s_add_u32 s60, s69, 65536
  v_mfma_f32_16x16x32_bf16 v[92:95], a[176:179], a[76:79], v[92:95]
  ds_read_b64_tr_b16 a[174:175], v5 offset:18432
  v_mfma_f32_16x16x32_bf16 v[92:95], a[180:183], a[92:95], v[92:95]
  buffer_load_dwordx4 v33, s[36:39], s60 offen lds
  v_add_u32 v38, s46, v0
  s_waitcnt vmcnt(14)
  s_barrier
  s_mov_b64 exec, 1
  buffer_store_dword v38, v0, s[8:11], s79 offen offset:0 sc1
  s_mov_b64 exec, -1
  v_mfma_f32_16x16x32_bf16 v[88:91], a[180:183], a[88:91], v[88:91]
  ds_read_b64_tr_b16 a[168:169], v5 offset:20480
  s_lshl_b32 s53, s44, 8
  v_mfma_f32_16x16x32_bf16 v[88:91], a[176:179], a[72:75], v[88:91]
  s_cmp_eq_u32 s90, 1
  s_cselect_b32 s78, 9, 2
  s_lshl_b32 s70, s78, 17
  s_lshl_b32 s78, s78, 11
  s_add_u32 s78, s78, s83
  s_add_u32 m0, s45, 98304
  s_add_u32 s53, s53, 133120
  v_lshrrev_b32 v49, 4, v0
  v_mfma_f32_16x16x32_bf16 v[84:87], a[176:179], a[68:71], v[84:87]
  ds_read_b64_tr_b16 a[170:171], v5 offset:22528
  v_lshl_add_u32 v46, v49, 4, s53
  v_mfma_f32_16x16x32_bf16 v[84:87], a[180:183], a[84:87], v[84:87]
  buffer_load_dwordx4 v32, s[36:39], s70 offen lds
  v_lshlrev_b32 v47, 2, v0
  v_add_u32 v45, s53, v47
  v_mfma_f32_16x16x32_bf16 v[80:83], a[180:183], a[80:83], v[80:83]
  ds_read_b64_tr_b16 a[180:181], v2 offset:24576
  v_lshrrev_b32 v48, 3, v0
  v_mfma_f32_16x16x32_bf16 v[80:83], a[176:179], a[64:67], v[80:83]
  s_waitcnt lgkmcnt(5)
  s_add_u32 m0, s45, 102400
  s_add_u32 s60, s70, 65536
  v_mfma_f32_16x16x32_bf16 v[96:99], a[164:167], a[64:67], v[96:99]
  ds_read_b64_tr_b16 a[182:183], v2 offset:26624
  v_and_b32 v50, 7, v0
  v_mfma_f32_16x16x32_bf16 v[96:99], a[160:163], a[80:83], v[96:99]
  buffer_load_dwordx4 v32, s[36:39], s60 offen lds
  v_xor_b32 v51, v50, v48
  v_lshlrev_b32 v51, 4, v51
  v_mfma_f32_16x16x32_bf16 v[100:103], a[160:163], a[84:87], v[100:103]
  ds_read_b64_tr_b16 a[176:177], v2 offset:28672
  v_lshl_add_u32 v40, v48, 11, v51
  v_mfma_f32_16x16x32_bf16 v[100:103], a[164:167], a[68:71], v[100:103]
  v_bfe_u32 v48, v0, 4, 1
  v_lshrrev_b32 v51, 5, v0
  v_mfma_f32_16x16x32_bf16 v[104:107], a[164:167], a[72:75], v[104:107]
  ds_read_b64_tr_b16 a[178:179], v2 offset:30720
  v_lshl_add_u32 v48, v48, 1, v51
  v_mfma_f32_16x16x32_bf16 v[104:107], a[160:163], a[88:91], v[104:107]
  s_cmp_eq_u32 s90, 2
  s_cselect_b32 s71, 11, 4
  s_lshl_b32 s63, s71, 17
  s_lshl_b32 s71, s71, 11
  s_add_u32 s71, s71, s83
  s_add_u32 m0, s45, 114688
  v_xor_b32 v48, v48, v50
  v_lshlrev_b32 v48, 4, v48
  v_mfma_f32_16x16x32_bf16 v[108:111], a[160:163], a[92:95], v[108:111]
  ds_read_b64_tr_b16 a[160:161], v3 offset:24576
  v_and_b32 v50, 15, v0
  v_mfma_f32_16x16x32_bf16 v[108:111], a[164:167], a[76:79], v[108:111]
  s_waitcnt lgkmcnt(5)
  buffer_load_dwordx4 v32, s[36:39], s63 offen lds
  v_lshl_add_u32 v48, v50, 7, v48
  v_mfma_f32_16x16x32_bf16 v[124:127], a[172:175], a[76:79], v[124:127]
  ds_read_b64_tr_b16 a[162:163], v3 offset:26624
  v_add_u32 v42, s89, v48
  v_mfma_f32_16x16x32_bf16 v[124:127], a[168:171], a[92:95], v[124:127]
  s_add_u32 m0, s45, 118784
  s_add_u32 s60, s63, 65536
  v_xor_b32 v43, 64, v42
  v_mfma_f32_16x16x32_bf16 v[120:123], a[168:171], a[88:91], v[120:123]
  ds_read_b64_tr_b16 a[164:165], v3 offset:28672
  v_add_u32 v44, s89, v1
  v_mfma_f32_16x16x32_bf16 v[120:123], a[172:175], a[72:75], v[120:123]
  buffer_load_dwordx4 v32, s[36:39], s60 offen lds
  v_bfe_u32 v48, v0, 2, 2
  v_lshrrev_b32 v49, 4, v0
  v_mfma_f32_16x16x32_bf16 v[116:119], a[172:175], a[68:71], v[116:119]
  ds_read_b64_tr_b16 a[166:167], v3 offset:30720
  v_and_b32 v50, 1, v0
  v_mfma_f32_16x16x32_bf16 v[116:119], a[168:171], a[84:87], v[116:119]
  s_cmp_eq_u32 s90, 3
  s_cselect_b32 s72, 13, 6
  s_lshl_b32 s64, s72, 17
  s_lshl_b32 s72, s72, 11
  s_add_u32 s72, s72, s83
  s_add_u32 m0, s45, 81920
  v_lshlrev_b32 v50, 4, v50
  v_mov_b32 v51, 0xffff
  v_mfma_f32_16x16x32_bf16 v[112:115], a[168:171], a[80:83], v[112:115]
  ds_read_b64_tr_b16 a[168:169], v4 offset:24576
  v_lshlrev_b32 v50, v50, v51
  v_mfma_f32_16x16x32_bf16 v[112:115], a[172:175], a[64:67], v[112:115]
  s_waitcnt lgkmcnt(5)
  buffer_load_dwordx4 v32, s[36:39], s64 offen lds
  v_cmp_eq_u32 vcc, v48, v49
  v_mov_b32 v60, 0
  v_mov_b32 v61, 0
  v_cndmask_b32 v48, 0, v50, vcc
  v_mfma_f32_16x16x32_bf16 v[128:131], a[180:183], a[64:67], v[128:131]
  ds_read_b64_tr_b16 a[170:171], v4 offset:26624
  v_and_b32 v49, 2, v0
  v_mfma_f32_16x16x32_bf16 v[128:131], a[176:179], a[80:83], v[128:131]
  s_add_u32 m0, s45, 86016
  s_add_u32 s60, s64, 65536
  v_cmp_eq_u32 vcc, 0, v49
  v_mov_b32 v54, 0
  v_mov_b32 v55, 0
  v_cndmask_b32 v50, 0, v48, vcc
  v_mfma_f32_16x16x32_bf16 v[132:135], a[176:179], a[84:87], v[132:135]
  ds_read_b64_tr_b16 a[172:173], v4 offset:28672
  v_sub_u32 v51, v48, v50
  v_mfma_f32_16x16x32_bf16 v[132:135], a[180:183], a[68:71], v[132:135]
  buffer_load_dwordx4 v32, s[36:39], s60 offen lds
  v_mfma_f32_16x16x32_bf16 v[136:139], a[180:183], a[72:75], v[136:139]
  ds_read_b64_tr_b16 a[174:175], v4 offset:30720
  v_mfma_f32_16x16x32_bf16 v[136:139], a[176:179], a[88:91], v[136:139]
  v_mfma_f32_16x16x32_bf16 v[140:143], a[176:179], a[92:95], v[140:143]
  ds_read_b64_tr_b16 a[176:177], v5 offset:24576
  v_mfma_f32_16x16x32_bf16 v[140:143], a[180:183], a[76:79], v[140:143]
  s_waitcnt lgkmcnt(5)
  s_add_u32 m0, s45, 106496
  v_mfma_f32_16x16x32_bf16 v[156:159], a[160:163], a[76:79], v[156:159]
  ds_read_b64_tr_b16 a[178:179], v5 offset:26624
  v_mfma_f32_16x16x32_bf16 v[156:159], a[164:167], a[92:95], v[156:159]
  buffer_load_dwordx4 v33, s[36:39], s70 offen lds
  v_mfma_f32_16x16x32_bf16 v[152:155], a[164:167], a[88:91], v[152:155]
  ds_read_b64_tr_b16 a[180:181], v5 offset:28672
  v_mfma_f32_16x16x32_bf16 v[152:155], a[160:163], a[72:75], v[152:155]
  s_add_u32 m0, s45, 110592
  s_add_u32 s60, s70, 65536
  v_mfma_f32_16x16x32_bf16 v[148:151], a[160:163], a[68:71], v[148:151]
  ds_read_b64_tr_b16 a[182:183], v5 offset:30720
  buffer_load_dwordx4 v33, s[36:39], s60 offen lds
  v_mfma_f32_16x16x32_bf16 v[148:151], a[164:167], a[84:87], v[148:151]
  s_waitcnt vmcnt(31)
  s_barrier
  v_mfma_f32_16x16x32_bf16 v[144:147], a[164:167], a[80:83], v[144:147]
  ds_read_b64_tr_b16 a[164:165], v2 offset:32768
  v_mfma_f32_16x16x32_bf16 v[144:147], a[160:163], a[64:67], v[144:147]
  s_waitcnt lgkmcnt(5)
  s_cmp_eq_u32 s90, 0
  s_cselect_b32 s73, 0, 7
  s_lshl_b32 s65, s73, 17
  s_lshl_b32 s73, s73, 11
  s_add_u32 s73, s73, s83
  s_add_u32 m0, s45, 65536
  v_mfma_f32_16x16x32_bf16 v[160:163], a[168:171], a[64:67], v[160:163]
  ds_read_b64_tr_b16 a[166:167], v2 offset:34816
  v_mfma_f32_16x16x32_bf16 v[160:163], a[172:175], a[80:83], v[160:163]
  buffer_load_dwordx4 v32, s[36:39], s65 offen lds
  v_mfma_f32_16x16x32_bf16 v[164:167], a[172:175], a[84:87], v[164:167]
  ds_read_b64_tr_b16 a[160:161], v2 offset:36864
  v_mfma_f32_16x16x32_bf16 v[164:167], a[168:171], a[68:71], v[164:167]
  s_add_u32 m0, s45, 69632
  s_add_u32 s60, s65, 65536
  v_mfma_f32_16x16x32_bf16 v[168:171], a[168:171], a[72:75], v[168:171]
  ds_read_b64_tr_b16 a[162:163], v2 offset:38912
  v_mfma_f32_16x16x32_bf16 v[168:171], a[172:175], a[88:91], v[168:171]
  buffer_load_dwordx4 v32, s[36:39], s60 offen lds
  v_mfma_f32_16x16x32_bf16 v[172:175], a[172:175], a[92:95], v[172:175]
  ds_read_b64_tr_b16 a[172:173], v3 offset:32768
  v_mfma_f32_16x16x32_bf16 v[172:175], a[168:171], a[76:79], v[172:175]
  s_waitcnt lgkmcnt(5)
  v_mfma_f32_16x16x32_bf16 v[188:191], a[176:179], a[76:79], v[188:191]
  ds_read_b64_tr_b16 a[174:175], v3 offset:34816
  v_mfma_f32_16x16x32_bf16 v[188:191], a[180:183], a[92:95], v[188:191]
  s_add_u32 s61, s87, 0
  v_mfma_f32_16x16x32_bf16 v[184:187], a[180:183], a[88:91], v[184:187]
  ds_read_b64_tr_b16 a[168:169], v3 offset:36864
  v_mfma_f32_16x16x32_bf16 v[184:187], a[176:179], a[72:75], v[184:187]
  buffer_load_dword v240, v47, s[8:11], s61 offen sc1
  v_mfma_f32_16x16x32_bf16 v[180:183], a[176:179], a[68:71], v[180:183]
  ds_read_b64_tr_b16 a[170:171], v3 offset:38912
  v_mfma_f32_16x16x32_bf16 v[180:183], a[180:183], a[84:87], v[180:183]
  s_add_u32 s61, s87, 24576
  v_mfma_f32_16x16x32_bf16 v[176:179], a[180:183], a[80:83], v[176:179]
  ds_read_b64_tr_b16 a[180:181], v4 offset:32768
  v_mfma_f32_16x16x32_bf16 v[176:179], a[176:179], a[64:67], v[176:179]
  s_waitcnt vmcnt(24) lgkmcnt(5)
  buffer_load_dword v241, v47, s[8:11], s61 offen sc1
  v_mfma_f32_16x16x32_bf16 v[64:67], a[164:167], a[96:99], v[64:67]
  ds_read_b64_tr_b16 a[182:183], v4 offset:34816
  v_mfma_f32_16x16x32_bf16 v[64:67], a[160:163], a[112:115], v[64:67]
  s_add_u32 s61, s87, 49152
  v_mfma_f32_16x16x32_bf16 v[68:71], a[160:163], a[116:119], v[68:71]
  ds_read_b64_tr_b16 a[176:177], v4 offset:36864
  v_mfma_f32_16x16x32_bf16 v[68:71], a[164:167], a[100:103], v[68:71]
  buffer_load_dword v242, v47, s[8:11], s61 offen sc1
  v_mfma_f32_16x16x32_bf16 v[72:75], a[164:167], a[104:107], v[72:75]
  ds_read_b64_tr_b16 a[178:179], v4 offset:38912
  v_mfma_f32_16x16x32_bf16 v[72:75], a[160:163], a[120:123], v[72:75]
  s_add_u32 s61, s87, 73728
  v_mfma_f32_16x16x32_bf16 v[76:79], a[160:163], a[124:127], v[76:79]
  ds_read_b64_tr_b16 a[160:161], v5 offset:32768
  v_mfma_f32_16x16x32_bf16 v[76:79], a[164:167], a[108:111], v[76:79]
  s_waitcnt lgkmcnt(5)
  buffer_load_dword v243, v47, s[8:11], s61 offen sc1
  v_mfma_f32_16x16x32_bf16 v[92:95], a[172:175], a[108:111], v[92:95]
  ds_read_b64_tr_b16 a[162:163], v5 offset:34816
  v_mfma_f32_16x16x32_bf16 v[92:95], a[168:171], a[124:127], v[92:95]
  v_mfma_f32_16x16x32_bf16 v[88:91], a[168:171], a[120:123], v[88:91]
  ds_read_b64_tr_b16 a[164:165], v5 offset:36864
  v_mfma_f32_16x16x32_bf16 v[88:91], a[172:175], a[104:107], v[88:91]
  s_cmp_eq_u32 s90, 1
  s_cselect_b32 s74, 2, 9
  s_lshl_b32 s66, s74, 17
  s_lshl_b32 s74, s74, 11
  s_add_u32 s74, s74, s83
  s_add_u32 m0, s45, 16384
  v_mfma_f32_16x16x32_bf16 v[84:87], a[172:175], a[100:103], v[84:87]
  ds_read_b64_tr_b16 a[166:167], v5 offset:38912
  v_mfma_f32_16x16x32_bf16 v[84:87], a[168:171], a[116:119], v[84:87]
  buffer_load_dwordx4 v32, s[36:39], s66 offen lds
  v_mfma_f32_16x16x32_bf16 v[80:83], a[168:171], a[112:115], v[80:83]
  ds_read_b64_tr_b16 a[168:169], v2 offset:40960
  v_mfma_f32_16x16x32_bf16 v[80:83], a[172:175], a[96:99], v[80:83]
  s_waitcnt lgkmcnt(5)
  s_add_u32 m0, s45, 20480
  s_add_u32 s60, s66, 65536
  v_mfma_f32_16x16x32_bf16 v[96:99], a[180:183], a[96:99], v[96:99]
  ds_read_b64_tr_b16 a[170:171], v2 offset:43008
  v_mfma_f32_16x16x32_bf16 v[96:99], a[176:179], a[112:115], v[96:99]
  s_sub_u32 s81, s81, 491520
  buffer_load_dwordx4 v32, s[36:39], s60 offen lds
  v_mfma_f32_16x16x32_bf16 v[100:103], a[176:179], a[116:119], v[100:103]
  ds_read_b64_tr_b16 a[172:173], v2 offset:45056
  s_lshl_b32 s82, s44, 28
  s_add_u32 s82, s82, s81
  buffer_load_dword v36, v37, s[8:11], s82 offen sc1
  v_mfma_f32_16x16x32_bf16 v[100:103], a[180:183], a[100:103], v[100:103]
  s_add_u32 m0, s45, 122880
  v_mfma_f32_16x16x32_bf16 v[104:107], a[180:183], a[104:107], v[104:107]
  ds_read_b64_tr_b16 a[174:175], v2 offset:47104
  v_mfma_f32_16x16x32_bf16 v[104:107], a[176:179], a[120:123], v[104:107]
  buffer_load_dwordx4 v33, s[36:39], s63 offen lds
  v_mfma_f32_16x16x32_bf16 v[108:111], a[176:179], a[124:127], v[108:111]
  ds_read_b64_tr_b16 a[176:177], v3 offset:40960
  v_mfma_f32_16x16x32_bf16 v[108:111], a[180:183], a[108:111], v[108:111]
  s_waitcnt lgkmcnt(5)
  s_add_u32 m0, s45, 126976
  s_add_u32 s60, s63, 65536
  v_mfma_f32_16x16x32_bf16 v[124:127], a[160:163], a[108:111], v[124:127]
  ds_read_b64_tr_b16 a[178:179], v3 offset:43008
  v_mfma_f32_16x16x32_bf16 v[124:127], a[164:167], a[124:127], v[124:127]
  buffer_load_dwordx4 v33, s[36:39], s60 offen lds
  v_mfma_f32_16x16x32_bf16 v[120:123], a[164:167], a[120:123], v[120:123]
  ds_read_b64_tr_b16 a[180:181], v3 offset:45056
  v_mfma_f32_16x16x32_bf16 v[120:123], a[160:163], a[104:107], v[120:123]
  v_mfma_f32_16x16x32_bf16 v[116:119], a[160:163], a[100:103], v[116:119]
  ds_read_b64_tr_b16 a[182:183], v3 offset:47104
  v_mfma_f32_16x16x32_bf16 v[116:119], a[164:167], a[116:119], v[116:119]
  s_add_u32 m0, s45, 90112
  v_mfma_f32_16x16x32_bf16 v[112:115], a[164:167], a[112:115], v[112:115]
  ds_read_b64_tr_b16 a[164:165], v4 offset:40960
  v_mfma_f32_16x16x32_bf16 v[112:115], a[160:163], a[96:99], v[112:115]
  s_waitcnt lgkmcnt(5)
  buffer_load_dwordx4 v33, s[36:39], s64 offen lds
  v_mfma_f32_16x16x32_bf16 v[128:131], a[168:171], a[96:99], v[128:131]
  ds_read_b64_tr_b16 a[166:167], v4 offset:43008
  v_mfma_f32_16x16x32_bf16 v[128:131], a[172:175], a[112:115], v[128:131]
  s_add_u32 m0, s45, 94208
  s_add_u32 s60, s64, 65536
  v_mfma_f32_16x16x32_bf16 v[132:135], a[172:175], a[116:119], v[132:135]
  ds_read_b64_tr_b16 a[160:161], v4 offset:45056
  v_mfma_f32_16x16x32_bf16 v[132:135], a[168:171], a[100:103], v[132:135]
  buffer_load_dwordx4 v33, s[36:39], s60 offen lds
  v_mfma_f32_16x16x32_bf16 v[136:139], a[168:171], a[104:107], v[136:139]
  ds_read_b64_tr_b16 a[162:163], v4 offset:47104
  v_mfma_f32_16x16x32_bf16 v[136:139], a[172:175], a[120:123], v[136:139]
  s_add_u32 m0, s45, 73728
  v_mfma_f32_16x16x32_bf16 v[140:143], a[172:175], a[124:127], v[140:143]
  ds_read_b64_tr_b16 a[172:173], v5 offset:40960
  v_mfma_f32_16x16x32_bf16 v[140:143], a[168:171], a[108:111], v[140:143]
  s_waitcnt lgkmcnt(5)
  buffer_load_dwordx4 v33, s[36:39], s65 offen lds
  v_mfma_f32_16x16x32_bf16 v[156:159], a[176:179], a[108:111], v[156:159]
  ds_read_b64_tr_b16 a[174:175], v5 offset:43008
  v_mfma_f32_16x16x32_bf16 v[156:159], a[180:183], a[124:127], v[156:159]
  s_add_u32 m0, s45, 77824
  s_add_u32 s60, s65, 65536
  v_mfma_f32_16x16x32_bf16 v[152:155], a[180:183], a[120:123], v[152:155]
  ds_read_b64_tr_b16 a[168:169], v5 offset:45056
  v_mfma_f32_16x16x32_bf16 v[152:155], a[176:179], a[104:107], v[152:155]
  buffer_load_dwordx4 v33, s[36:39], s60 offen lds
  v_mfma_f32_16x16x32_bf16 v[148:151], a[176:179], a[100:103], v[148:151]
HOP17:
  s_cbranch_execz WRET1
  ds_read_b64_tr_b16 a[170:171], v5 offset:47104
  v_mfma_f32_16x16x32_bf16 v[148:151], a[180:183], a[116:119], v[148:151]
  v_mfma_f32_16x16x32_bf16 v[144:147], a[180:183], a[112:115], v[144:147]
  ds_read_b64_tr_b16 a[180:181], v2 offset:49152
  v_mfma_f32_16x16x32_bf16 v[144:147], a[176:179], a[96:99], v[144:147]
  s_waitcnt lgkmcnt(5)
  v_mfma_f32_16x16x32_bf16 v[160:163], a[164:167], a[96:99], v[160:163]
  ds_read_b64_tr_b16 a[182:183], v2 offset:51200
  v_mfma_f32_16x16x32_bf16 v[160:163], a[160:163], a[112:115], v[160:163]
  v_mfma_f32_16x16x32_bf16 v[164:167], a[160:163], a[116:119], v[164:167]
  ds_read_b64_tr_b16 a[176:177], v2 offset:53248
  v_mfma_f32_16x16x32_bf16 v[164:167], a[164:167], a[100:103], v[164:167]
  v_mfma_f32_16x16x32_bf16 v[168:171], a[164:167], a[104:107], v[168:171]
  ds_read_b64_tr_b16 a[178:179], v2 offset:55296
  v_mfma_f32_16x16x32_bf16 v[168:171], a[160:163], a[120:123], v[168:171]
  v_mfma_f32_16x16x32_bf16 v[172:175], a[160:163], a[124:127], v[172:175]
  ds_read_b64_tr_b16 a[160:161], v3 offset:49152
  v_mfma_f32_16x16x32_bf16 v[172:175], a[164:167], a[108:111], v[172:175]
  s_waitcnt lgkmcnt(5)
  v_mfma_f32_16x16x32_bf16 v[188:191], a[172:175], a[108:111], v[188:191]
  ds_read_b64_tr_b16 a[162:163], v3 offset:51200
  v_mfma_f32_16x16x32_bf16 v[188:191], a[168:171], a[124:127], v[188:191]
  v_mfma_f32_16x16x32_bf16 v[184:187], a[168:171], a[120:123], v[184:187]
  ds_read_b64_tr_b16 a[164:165], v3 offset:53248
  s_waitcnt vmcnt(6)
  s_cmp_lg_u32 s44, 0
  s_cbranch_scc1 PL13_adaLN_cond__sliding_local_dilated__swiglu_ffn__prompt_kernelx
  v_cmp_ne_u32 vcc, s46, v36
  s_nop 4
  s_cbranch_vccz PL13_adaLN_cond__sliding_local_dilated__swiglu_ffn__prompt_kernelx
  s_mov_b32 s82, 60000
PL13_adaLN_cond__sliding_local_dilated__swiglu_ffn__prompt_kernel:
  buffer_load_dword v36, v37, s[8:11], s81 offen sc1
  s_sub_u32 s82, s82, 1
  s_cmp_eq_u32 s82, 0
  s_waitcnt vmcnt(0)
  s_cbranch_scc1 PL13_adaLN_cond__sliding_local_dilated__swiglu_ffn__prompt_kernelx
  v_cmp_ne_u32 vcc, s46, v36
  s_nop 4
  s_cbranch_vccnz PL13_adaLN_cond__sliding_local_dilated__swiglu_ffn__prompt_kernel
PL13_adaLN_cond__sliding_local_dilated__swiglu_ffn__prompt_kernelx:
  s_barrier
  v_mfma_f32_16x16x32_bf16 v[184:187], a[172:175], a[104:107], v[184:187]
  v_mfma_f32_16x16x32_bf16 v[180:183], a[172:175], a[100:103], v[180:183]
  ds_read_b64_tr_b16 a[166:167], v3 offset:55296
  v_mfma_f32_16x16x32_bf16 v[180:183], a[168:171], a[116:119], v[180:183]
  buffer_load_dwordx4 a[188:191], v1, s[8:11], s77 offen offset:0 sc1
  v_mfma_f32_16x16x32_bf16 v[176:179], a[168:171], a[112:115], v[176:179]
  ds_read_b64_tr_b16 a[168:169], v4 offset:49152
  v_mfma_f32_16x16x32_bf16 v[176:179], a[172:175], a[96:99], v[176:179]
  s_waitcnt vmcnt(29) lgkmcnt(5)
  v_mfma_f32_16x16x32_bf16 v[64:67], a[180:183], a[128:131], v[64:67]
  ds_read_b64_tr_b16 a[170:171], v4 offset:51200
  v_mfma_f32_16x16x32_bf16 v[64:67], a[176:179], a[144:147], v[64:67]
  buffer_load_dwordx4 a[204:207], v1, s[8:11], s77 offen offset:1024 sc1
  v_mfma_f32_16x16x32_bf16 v[68:71], a[176:179], a[148:151], v[68:71]
  ds_read_b64_tr_b16 a[172:173], v4 offset:53248
  v_mfma_f32_16x16x32_bf16 v[68:71], a[180:183], a[132:135], v[68:71]
  s_add_u32 s77, s77, 131072
  v_mfma_f32_16x16x32_bf16 v[72:75], a[180:183], a[136:139], v[72:75]
  ds_read_b64_tr_b16 a[174:175], v4 offset:55296
  v_mfma_f32_16x16x32_bf16 v[72:75], a[176:179], a[152:155], v[72:75]
  buffer_load_dwordx4 a[192:195], v1, s[8:11], s77 offen offset:0 sc1
  v_mfma_f32_16x16x32_bf16 v[76:79], a[176:179], a[156:159], v[76:79]
  ds_read_b64_tr_b16 a[176:177], v5 offset:49152
  v_mfma_f32_16x16x32_bf16 v[76:79], a[180:183], a[140:143], v[76:79]
  s_waitcnt lgkmcnt(5)
  v_mfma_f32_16x16x32_bf16 v[92:95], a[160:163], a[140:143], v[92:95]
  ds_read_b64_tr_b16 a[178:179], v5 offset:51200
  v_mfma_f32_16x16x32_bf16 v[92:95], a[164:167], a[156:159], v[92:95]
  v_mfma_f32_16x16x32_bf16 v[88:91], a[164:167], a[152:155], v[88:91]
  ds_read_b64_tr_b16 a[180:181], v5 offset:53248
  v_mfma_f32_16x16x32_bf16 v[88:91], a[160:163], a[136:139], v[88:91]
  buffer_load_dwordx4 a[208:211], v1, s[8:11], s77 offen offset:1024 sc1
  v_mfma_f32_16x16x32_bf16 v[84:87], a[160:163], a[132:135], v[84:87]
  ds_read_b64_tr_b16 a[182:183], v5 offset:55296
  v_mfma_f32_16x16x32_bf16 v[84:87], a[164:167], a[148:151], v[84:87]
  s_add_u32 s77, s77, s88
  v_mfma_f32_16x16x32_bf16 v[80:83], a[164:167], a[144:147], v[80:83]
  ds_read_b64_tr_b16 a[164:165], v2 offset:57344
  v_mfma_f32_16x16x32_bf16 v[80:83], a[160:163], a[128:131], v[80:83]
  s_waitcnt lgkmcnt(5)
  buffer_load_dwordx4 a[196:199], v1, s[8:11], s77 offen offset:0 sc1
  v_mfma_f32_16x16x32_bf16 v[96:99], a[168:171], a[128:131], v[96:99]
  ds_read_b64_tr_b16 a[166:167], v2 offset:59392
  v_mfma_f32_16x16x32_bf16 v[96:99], a[172:175], a[144:147], v[96:99]
  v_mfma_f32_16x16x32_bf16 v[100:103], a[172:175], a[148:151], v[100:103]
  ds_read_b64_tr_b16 a[160:161], v2 offset:61440
  v_mfma_f32_16x16x32_bf16 v[100:103], a[168:171], a[132:135], v[100:103]
  buffer_load_dwordx4 a[212:215], v1, s[8:11], s77 offen offset:1024 sc1
  v_mfma_f32_16x16x32_bf16 v[104:107], a[168:171], a[136:139], v[104:107]
  ds_read_b64_tr_b16 a[162:163], v2 offset:63488
  v_mfma_f32_16x16x32_bf16 v[104:107], a[172:175], a[152:155], v[104:107]
  s_add_u32 s77, s77, 131072
  v_mfma_f32_16x16x32_bf16 v[108:111], a[172:175], a[156:159], v[108:111]
  ds_read_b64_tr_b16 a[172:173], v3 offset:57344
  v_mfma_f32_16x16x32_bf16 v[108:111], a[168:171], a[140:143], v[108:111]
  s_waitcnt lgkmcnt(5)
  buffer_load_dwordx4 a[200:203], v1, s[8:11], s77 offen offset:0 sc1
  v_mfma_f32_16x16x32_bf16 v[124:127], a[176:179], a[140:143], v[124:127]
  ds_read_b64_tr_b16 a[174:175], v3 offset:59392
  v_mfma_f32_16x16x32_bf16 v[124:127], a[180:183], a[156:159], v[124:127]
  v_mfma_f32_16x16x32_bf16 v[120:123], a[180:183], a[152:155], v[120:123]
  ds_read_b64_tr_b16 a[168:169], v3 offset:61440
  v_mfma_f32_16x16x32_bf16 v[120:123], a[176:179], a[136:139], v[120:123]
  v_mfma_f32_16x16x32_bf16 v[116:119], a[176:179], a[132:135], v[116:119]
  ds_read_b64_tr_b16 a[170:171], v3 offset:63488
  v_mfma_f32_16x16x32_bf16 v[116:119], a[180:183], a[148:151], v[116:119]
  buffer_load_dwordx4 a[216:219], v1, s[8:11], s77 offen offset:1024 sc1
  v_mfma_f32_16x16x32_bf16 v[112:115], a[180:183], a[144:147], v[112:115]
  ds_read_b64_tr_b16 a[180:181], v4 offset:57344
  v_mfma_f32_16x16x32_bf16 v[112:115], a[176:179], a[128:131], v[112:115]
  s_waitcnt lgkmcnt(5)
  v_mfma_f32_16x16x32_bf16 v[128:131], a[164:167], a[128:131], v[128:131]
  ds_read_b64_tr_b16 a[182:183], v4 offset:59392
  v_mfma_f32_16x16x32_bf16 v[128:131], a[160:163], a[144:147], v[128:131]
  buffer_load_dwordx4 a[220:223], v1, s[8:11], s78 offen offset:0 sc1
  v_mfma_f32_16x16x32_bf16 v[132:135], a[160:163], a[148:151], v[132:135]
  ds_read_b64_tr_b16 a[176:177], v4 offset:61440
  v_mfma_f32_16x16x32_bf16 v[132:135], a[164:167], a[132:135], v[132:135]
  v_mfma_f32_16x16x32_bf16 v[136:139], a[164:167], a[136:139], v[136:139]
  ds_read_b64_tr_b16 a[178:179], v4 offset:63488
  v_mfma_f32_16x16x32_bf16 v[136:139], a[160:163], a[152:155], v[136:139]
  buffer_load_dwordx4 a[236:239], v1, s[8:11], s78 offen offset:1024 sc1
  v_mfma_f32_16x16x32_bf16 v[140:143], a[160:163], a[156:159], v[140:143]
  ds_read_b64_tr_b16 a[160:161], v5 offset:57344
  v_mfma_f32_16x16x32_bf16 v[140:143], a[164:167], a[140:143], v[140:143]
  s_waitcnt lgkmcnt(5)
  s_add_u32 s78, s78, 131072
  v_mfma_f32_16x16x32_bf16 v[156:159], a[172:175], a[140:143], v[156:159]
  ds_read_b64_tr_b16 a[162:163], v5 offset:59392
  v_mfma_f32_16x16x32_bf16 v[156:159], a[168:171], a[156:159], v[156:159]
  buffer_load_dwordx4 a[224:227], v1, s[8:11], s78 offen offset:0 sc1
  ds_read_b128 v[192:195], v44 offset:0
  v_mfma_f32_16x16x32_bf16 v[152:155], a[168:171], a[152:155], v[152:155]
  ds_read_b64_tr_b16 a[164:165], v5 offset:61440
  v_mfma_f32_16x16x32_bf16 v[152:155], a[172:175], a[136:139], v[152:155]
  ds_read_b128 v[196:199], v44 offset:1024
  v_mfma_f32_16x16x32_bf16 v[148:151], a[172:175], a[132:135], v[148:151]
  ds_read_b64_tr_b16 a[166:167], v5 offset:63488
  v_mfma_f32_16x16x32_bf16 v[148:151], a[168:171], a[148:151], v[148:151]
  s_waitcnt vmcnt(35)
  s_barrier
  v_mfma_f32_16x16x32_bf16 v[144:147], a[168:171], a[144:147], v[144:147]
  ds_read_b64_tr_b16 a[168:169], v2 offset:0
  v_mfma_f32_16x16x32_bf16 v[144:147], a[172:175], a[128:131], v[144:147]
  s_waitcnt lgkmcnt(7)
  buffer_load_dwordx4 a[240:243], v1, s[8:11], s78 offen offset:1024 sc1
  v_mfma_f32_16x16x32_bf16 v[160:163], a[180:183], a[128:131], v[160:163]
  ds_read_b64_tr_b16 a[170:171], v2 offset:2048
  ds_read_b128 v[200:203], v44 offset:2048
  v_mfma_f32_16x16x32_bf16 v[160:163], a[176:179], a[144:147], v[160:163]
  s_add_u32 s78, s78, s88
  ds_read_b128 v[204:207], v44 offset:3072
  v_mfma_f32_16x16x32_bf16 v[164:167], a[176:179], a[148:151], v[164:167]
  ds_read_b64_tr_b16 a[172:173], v2 offset:4096
  s_waitcnt vmcnt(21)
  v_mfma_f32_16x16x32_bf16 v[164:167], a[180:183], a[132:135], v[164:167]
  buffer_load_dwordx4 a[228:231], v1, s[8:11], s78 offen offset:0 sc1
  v_add_f32 v240, v240, v241
  v_add_f32 v242, v242, v243
  v_mfma_f32_16x16x32_bf16 v[168:171], a[180:183], a[136:139], v[168:171]
  ds_read_b64_tr_b16 a[174:175], v2 offset:6144
  v_add_f32 v240, v240, v242
  v_mfma_f32_16x16x32_bf16 v[168:171], a[176:179], a[152:155], v[168:171]
  v_cvt_pk_bf16_f32 v240, v240, v240
  v_lshlrev_b32 v240, 16, v240
  v_mfma_f32_16x16x32_bf16 v[172:175], a[176:179], a[156:159], v[172:175]
  ds_read_b64_tr_b16 a[176:177], v3 offset:0
  v_mfma_f32_16x16x32_bf16 v[172:175], a[180:183], a[140:143], v[172:175]
  s_waitcnt lgkmcnt(7)
  buffer_load_dwordx4 a[244:247], v1, s[8:11], s78 offen offset:1024 sc1
  v_mfma_f32_16x16x32_bf16 v[188:191], a[160:163], a[140:143], v[188:191]
  ds_read_b64_tr_b16 a[178:179], v3 offset:2048
  v_mfma_f32_16x16x32_bf16 v[188:191], a[164:167], a[156:159], v[188:191]
  s_add_u32 s78, s78, 131072
  ds_write_b32 v45, v240
  v_mfma_f32_16x16x32_bf16 v[184:187], a[164:167], a[152:155], v[184:187]
  ds_read_b64_tr_b16 a[180:181], v3 offset:4096
  v_mfma_f32_16x16x32_bf16 v[184:187], a[160:163], a[136:139], v[184:187]
  buffer_load_dwordx4 a[232:235], v1, s[8:11], s78 offen offset:0 sc1
  ds_read_b128 v[240:243], v46 offset:0
  v_mfma_f32_16x16x32_bf16 v[180:183], a[160:163], a[132:135], v[180:183]
  ds_read_b64_tr_b16 a[182:183], v3 offset:6144
  v_mfma_f32_16x16x32_bf16 v[180:183], a[164:167], a[148:151], v[180:183]
  ds_read_b128 v[244:247], v46 offset:64
  v_mfma_f32_16x16x32_bf16 v[176:179], a[164:167], a[144:147], v[176:179]
  ds_read_b64_tr_b16 a[164:165], v4 offset:0
  v_mfma_f32_16x16x32_bf16 v[176:179], a[160:163], a[128:131], v[176:179]
  s_waitcnt vmcnt(7) lgkmcnt(8)
  ds_read_b128 v[248:251], v46 offset:128
  v_mfma_f32_16x16x32_bf16 v[64:67], a[168:171], a[188:191], v[64:67]
  ds_read_b64_tr_b16 a[166:167], v4 offset:2048
  v_mfma_f32_16x16x32_bf16 v[64:67], a[172:175], a[204:207], v[64:67]
  buffer_load_dwordx4 a[248:251], v1, s[8:11], s78 offen offset:1024 sc1
  ds_read_b128 v[252:255], v46 offset:192
  v_mfma_f32_16x16x32_bf16 v[68:71], a[172:175], a[208:211], v[68:71]
  ds_read_b64_tr_b16 a[160:161], v4 offset:4096
  s_waitcnt lgkmcnt(14)
  v_mfma_f32_16x16x32_bf16 v[68:71], a[168:171], a[192:195], v[68:71]
  v_lshlrev_b32 v208, 16, v192
  v_and_b32 v209, 0xffff0000, v192
  v_mfma_f32_16x16x32_bf16 v[72:75], a[168:171], a[196:199], v[72:75]
  ds_read_b64_tr_b16 a[162:163], v4 offset:6144
  v_lshlrev_b32 v210, 16, v193
  v_mfma_f32_16x16x32_bf16 v[72:75], a[172:175], a[212:215], v[72:75]
  buffer_load_dwordx4 a[0:3], v1, s[8:11], s71 offen offset:0 sc1
  v_and_b32 v211, 0xffff0000, v193
  v_lshlrev_b32 v212, 16, v194
  v_mfma_f32_16x16x32_bf16 v[76:79], a[172:175], a[216:219], v[76:79]
  ds_read_b64_tr_b16 a[172:173], v5 offset:0
  v_and_b32 v213, 0xffff0000, v194
  v_mfma_f32_16x16x32_bf16 v[76:79], a[168:171], a[200:203], v[76:79]
  s_waitcnt lgkmcnt(8)
  v_lshlrev_b32 v214, 16, v195
  v_and_b32 v215, 0xffff0000, v195
  v_mfma_f32_16x16x32_bf16 v[92:95], a[176:179], a[200:203], v[92:95]
  ds_read_b64_tr_b16 a[174:175], v5 offset:2048
  v_lshlrev_b32 v216, 16, v196
  v_mfma_f32_16x16x32_bf16 v[92:95], a[180:183], a[216:219], v[92:95]
  buffer_load_dwordx4 a[16:19], v1, s[8:11], s71 offen offset:1024 sc1
  v_and_b32 v217, 0xffff0000, v196
  v_lshlrev_b32 v218, 16, v197
  v_mfma_f32_16x16x32_bf16 v[88:91], a[180:183], a[212:215], v[88:91]
  ds_read_b64_tr_b16 a[168:169], v5 offset:4096
  v_and_b32 v219, 0xffff0000, v197
  v_mfma_f32_16x16x32_bf16 v[88:91], a[176:179], a[196:199], v[88:91]
  s_add_u32 s71, s71, 131072
  v_lshlrev_b32 v220, 16, v198
  v_and_b32 v221, 0xffff0000, v198
  v_mfma_f32_16x16x32_bf16 v[84:87], a[176:179], a[192:195], v[84:87]
  ds_read_b64_tr_b16 a[170:171], v5 offset:6144
  v_lshlrev_b32 v222, 16, v199
  v_mfma_f32_16x16x32_bf16 v[84:87], a[180:183], a[208:211], v[84:87]
  buffer_load_dwordx4 a[4:7], v1, s[8:11], s71 offen offset:0 sc1
  v_and_b32 v223, 0xffff0000, v199
  v_lshlrev_b32 v224, 16, v200
  v_mfma_f32_16x16x32_bf16 v[80:83], a[180:183], a[204:207], v[80:83]
  ds_read_b64_tr_b16 a[180:181], v2 offset:8192
  v_and_b32 v225, 0xffff0000, v200
  v_mfma_f32_16x16x32_bf16 v[80:83], a[176:179], a[188:191], v[80:83]
  s_waitcnt lgkmcnt(5)
  v_lshlrev_b32 v226, 16, v201
  v_and_b32 v227, 0xffff0000, v201
  v_mfma_f32_16x16x32_bf16 v[96:99], a[164:167], a[188:191], v[96:99]
  ds_read_b64_tr_b16 a[182:183], v2 offset:10240
  v_lshlrev_b32 v228, 16, v202
  v_mfma_f32_16x16x32_bf16 v[96:99], a[160:163], a[204:207], v[96:99]
  v_and_b32 v229, 0xffff0000, v202
  v_lshlrev_b32 v230, 16, v203
  v_mfma_f32_16x16x32_bf16 v[100:103], a[160:163], a[208:211], v[100:103]
  ds_read_b64_tr_b16 a[176:177], v2 offset:12288
  v_and_b32 v231, 0xffff0000, v203
  v_mfma_f32_16x16x32_bf16 v[100:103], a[164:167], a[192:195], v[100:103]
  buffer_load_dwordx4 a[20:23], v1, s[8:11], s71 offen offset:1024 sc1
  v_lshlrev_b32 v232, 16, v204
  v_and_b32 v233, 0xffff0000, v204
  v_mfma_f32_16x16x32_bf16 v[104:107], a[164:167], a[196:199], v[104:107]
  ds_read_b64_tr_b16 a[178:179], v2 offset:14336
  v_lshlrev_b32 v234, 16, v205
  v_mfma_f32_16x16x32_bf16 v[104:107], a[160:163], a[212:215], v[104:107]
  s_add_u32 s71, s71, s88
  v_and_b32 v235, 0xffff0000, v205
  v_lshlrev_b32 v236, 16, v206
  v_mfma_f32_16x16x32_bf16 v[108:111], a[160:163], a[216:219], v[108:111]
  ds_read_b64_tr_b16 a[160:161], v3 offset:8192
  v_and_b32 v237, 0xffff0000, v206
  v_mfma_f32_16x16x32_bf16 v[108:111], a[164:167], a[200:203], v[108:111]
  s_waitcnt lgkmcnt(5)
  buffer_load_dwordx4 a[8:11], v1, s[8:11], s71 offen offset:0 sc1
  v_lshlrev_b32 v238, 16, v207
  v_mfma_f32_16x16x32_bf16 v[124:127], a[172:175], a[200:203], v[124:127]
  ds_read_b64_tr_b16 a[162:163], v3 offset:10240
  v_and_b32 v239, 0xffff0000, v207
  v_mfma_f32_16x16x32_bf16 v[124:127], a[168:171], a[216:219], v[124:127]
  v_mov_b32 v37, 0
  s_waitcnt lgkmcnt(12)
  v_mfma_f32_16x16x32_bf16 v[120:123], a[168:171], a[212:215], v[120:123]
  ds_read_b64_tr_b16 a[164:165], v3 offset:12288
  v_cvt_pk_bf16_f32 v52, v240, v241
  v_mfma_f32_16x16x32_bf16 v[120:123], a[172:175], a[196:199], v[120:123]
  buffer_load_dwordx4 a[24:27], v1, s[8:11], s71 offen offset:1024 sc1
  v_and_b32 v52, v52, v50
  v_cvt_pk_bf16_f32 v53, v242, v243
  v_mfma_f32_16x16x32_bf16 v[116:119], a[172:175], a[192:195], v[116:119]
  ds_read_b64_tr_b16 a[166:167], v3 offset:14336
  v_and_b32 v53, v53, v51
  v_mfma_f32_16x16x32_bf16 v[116:119], a[168:171], a[208:211], v[116:119]
  s_add_u32 s71, s71, 131072
  v_cvt_pk_bf16_f32 v56, v244, v245
  v_and_b32 v56, v56, v50
  v_mfma_f32_16x16x32_bf16 v[112:115], a[168:171], a[204:207], v[112:115]
  ds_read_b64_tr_b16 a[168:169], v4 offset:8192
  v_cvt_pk_bf16_f32 v57, v246, v247
  v_mfma_f32_16x16x32_bf16 v[112:115], a[172:175], a[188:191], v[112:115]
  s_waitcnt lgkmcnt(5)
  buffer_load_dwordx4 a[12:15], v1, s[8:11], s71 offen offset:0 sc1
  v_and_b32 v57, v57, v51
  v_mfma_f32_16x16x32_bf16 v[128:131], a[180:183], a[188:191], v[128:131]
  ds_read_b64_tr_b16 a[170:171], v4 offset:10240
  v_cvt_pk_bf16_f32 v58, v248, v249
  v_mfma_f32_16x16x32_bf16 v[128:131], a[176:179], a[204:207], v[128:131]
  v_and_b32 v58, v58, v50
  v_cvt_pk_bf16_f32 v59, v250, v251
  v_mfma_f32_16x16x32_bf16 v[132:135], a[176:179], a[208:211], v[132:135]
  ds_read_b64_tr_b16 a[172:173], v4 offset:12288
  v_and_b32 v59, v59, v51
  v_mfma_f32_16x16x32_bf16 v[132:135], a[180:183], a[192:195], v[132:135]
  v_cvt_pk_bf16_f32 v62, v252, v253
  v_and_b32 v62, v62, v50
  v_mfma_f32_16x16x32_bf16 v[136:139], a[180:183], a[196:199], v[136:139]
  ds_read_b64_tr_b16 a[174:175], v4 offset:14336
  v_cvt_pk_bf16_f32 v63, v254, v255
  v_mfma_f32_16x16x32_bf16 v[136:139], a[176:179], a[212:215], v[136:139]
  buffer_load_dwordx4 a[28:31], v1, s[8:11], s71 offen offset:1024 sc1
  v_and_b32 v63, v63, v51
  v_mfma_f32_16x16x32_bf16 v[140:143], a[176:179], a[216:219], v[140:143]
  ds_read_b64_tr_b16 a[176:177], v5 offset:8192
  v_mfma_f32_16x16x32_bf16 v[140:143], a[180:183], a[200:203], v[140:143]
  s_waitcnt lgkmcnt(5)
  s_cmp_eq_u32 s90, 2
  s_cselect_b32 s75, 4, 11
  s_lshl_b32 s67, s75, 17
  s_lshl_b32 s75, s75, 11
  s_add_u32 s75, s75, s83
  s_add_u32 m0, s45, 32768
  v_mfma_f32_16x16x32_bf16 v[156:159], a[160:163], a[200:203], v[156:159]
  ds_read_b64_tr_b16 a[178:179], v5 offset:10240
  v_mfma_f32_16x16x32_bf16 v[156:159], a[164:167], a[216:219], v[156:159]
  buffer_load_dwordx4 v32, s[36:39], s67 offen lds
  v_mfma_f32_16x16x32_bf16 v[152:155], a[164:167], a[212:215], v[152:155]
  ds_read_b64_tr_b16 a[180:181], v5 offset:12288
  v_mfma_f32_16x16x32_bf16 v[152:155], a[160:163], a[196:199], v[152:155]
  s_add_u32 m0, s45, 36864
  s_add_u32 s60, s67, 65536
  v_mfma_f32_16x16x32_bf16 v[148:151], a[160:163], a[192:195], v[148:151]
  ds_read_b64_tr_b16 a[182:183], v5 offset:14336
  v_mfma_f32_16x16x32_bf16 v[148:151], a[164:167], a[208:211], v[148:151]
  buffer_load_dwordx4 v32, s[36:39], s60 offen lds
  s_waitcnt vmcnt(45)
  s_barrier
  v_mfma_f32_16x16x32_bf16 v[144:147], a[164:167], a[204:207], v[144:147]
  ds_read_b64_tr_b16 a[164:165], v6 offset:32768
  v_mfma_f32_16x16x32_bf16 v[144:147], a[160:163], a[188:191], v[144:147]
  s_waitcnt lgkmcnt(5)
  s_cmp_eq_u32 s90, 3
  s_cselect_b32 s76, 6, 13
  s_lshl_b32 s68, s76, 17
  s_lshl_b32 s76, s76, 11
  s_add_u32 s76, s76, s83
  s_add_u32 m0, s45, 49152
  v_mfma_f32_16x16x32_bf16 v[160:163], a[168:171], a[188:191], v[160:163]
  ds_read_b64_tr_b16 a[166:167], v6 offset:34816
  v_mfma_f32_16x16x32_bf16 v[160:163], a[172:175], a[204:207], v[160:163]
  buffer_load_dwordx4 v32, s[36:39], s68 offen lds
  v_mfma_f32_16x16x32_bf16 v[164:167], a[172:175], a[208:211], v[164:167]
  ds_read_b64_tr_b16 a[160:161], v6 offset:36864
  v_mfma_f32_16x16x32_bf16 v[164:167], a[168:171], a[192:195], v[164:167]
  v_mfma_f32_16x16x32_bf16 v[168:171], a[168:171], a[196:199], v[168:171]
  ds_read_b64_tr_b16 a[162:163], v6 offset:38912
  v_mfma_f32_16x16x32_bf16 v[168:171], a[172:175], a[212:215], v[168:171]
  s_add_u32 m0, s45, 53248
  s_add_u32 s60, s68, 65536
  v_mfma_f32_16x16x32_bf16 v[172:175], a[172:175], a[216:219], v[172:175]
  ds_read_b64_tr_b16 a[172:173], v7 offset:32768
  v_mfma_f32_16x16x32_bf16 v[172:175], a[168:171], a[200:203], v[172:175]
  s_waitcnt lgkmcnt(5)
  buffer_load_dwordx4 v32, s[36:39], s60 offen lds
  v_mfma_f32_16x16x32_bf16 v[188:191], a[176:179], a[200:203], v[188:191]
  ds_read_b64_tr_b16 a[174:175], v7 offset:34816
  v_mfma_f32_16x16x32_bf16 v[188:191], a[180:183], a[216:219], v[188:191]
  v_mfma_f32_16x16x32_bf16 v[184:187], a[180:183], a[212:215], v[184:187]
  ds_read_b64_tr_b16 a[168:169], v7 offset:36864
  v_mfma_f32_16x16x32_bf16 v[184:187], a[176:179], a[196:199], v[184:187]
  buffer_load_dwordx4 a[32:35], v1, s[8:11], s72 offen offset:0 sc1
  v_mfma_f32_16x16x32_bf16 v[180:183], a[176:179], a[192:195], v[180:183]
  ds_read_b64_tr_b16 a[170:171], v7 offset:38912
  v_mfma_f32_16x16x32_bf16 v[180:183], a[180:183], a[208:211], v[180:183]
  v_mfma_f32_16x16x32_bf16 v[176:179], a[180:183], a[204:207], v[176:179]
  ds_read_b64_tr_b16 a[180:181], v8 offset:32768
  v_mfma_f32_16x16x32_bf16 v[176:179], a[176:179], a[188:191], v[176:179]
  s_waitcnt vmcnt(13) lgkmcnt(5)
  buffer_load_dwordx4 a[48:51], v1, s[8:11], s72 offen offset:1024 sc1
  v_mfma_f32_16x16x32_bf16 v[64:67], a[164:167], a[220:223], v[64:67]
  ds_read_b64_tr_b16 a[182:183], v8 offset:34816
  v_mfma_f32_16x16x32_bf16 v[64:67], a[160:163], a[236:239], v[64:67]
  s_add_u32 s72, s72, 131072
  v_mfma_f32_16x16x32_bf16 v[68:71], a[160:163], a[240:243], v[68:71]
  ds_read_b64_tr_b16 a[176:177], v8 offset:36864
  v_mfma_f32_16x16x32_bf16 v[68:71], a[164:167], a[224:227], v[68:71]
  buffer_load_dwordx4 a[36:39], v1, s[8:11], s72 offen offset:0 sc1
  v_mfma_f32_16x16x32_bf16 v[72:75], a[164:167], a[228:231], v[72:75]
  ds_read_b64_tr_b16 a[178:179], v8 offset:38912
  v_mfma_f32_16x16x32_bf16 v[72:75], a[160:163], a[244:247], v[72:75]
  v_mfma_f32_16x16x32_bf16 v[76:79], a[160:163], a[248:251], v[76:79]
  ds_read_b64_tr_b16 a[160:161], v9 offset:32768
  v_mfma_f32_16x16x32_bf16 v[76:79], a[164:167], a[232:235], v[76:79]
  s_waitcnt lgkmcnt(5)
  v_mfma_f32_16x16x32_bf16 v[92:95], a[172:175], a[232:235], v[92:95]
  ds_read_b64_tr_b16 a[162:163], v9 offset:34816
  v_mfma_f32_16x16x32_bf16 v[92:95], a[168:171], a[248:251], v[92:95]
  buffer_load_dwordx4 a[52:55], v1, s[8:11], s72 offen offset:1024 sc1
  v_mfma_f32_16x16x32_bf16 v[88:91], a[168:171], a[244:247], v[88:91]
  ds_read_b64_tr_b16 a[164:165], v9 offset:36864
  v_mfma_f32_16x16x32_bf16 v[88:91], a[172:175], a[228:231], v[88:91]
  s_add_u32 s72, s72, s88
  v_mfma_f32_16x16x32_bf16 v[84:87], a[172:175], a[224:227], v[84:87]
  ds_read_b64_tr_b16 a[166:167], v9 offset:38912
  v_mfma_f32_16x16x32_bf16 v[84:87], a[168:171], a[240:243], v[84:87]
  buffer_load_dwordx4 a[40:43], v1, s[8:11], s72 offen offset:0 sc1
  v_mfma_f32_16x16x32_bf16 v[80:83], a[168:171], a[236:239], v[80:83]
  ds_read_b64_tr_b16 a[168:169], v6 offset:49152
  v_mfma_f32_16x16x32_bf16 v[80:83], a[172:175], a[220:223], v[80:83]
  s_waitcnt lgkmcnt(5)
  v_mfma_f32_16x16x32_bf16 v[96:99], a[180:183], a[220:223], v[96:99]
  ds_read_b64_tr_b16 a[170:171], v6 offset:51200
  v_mfma_f32_16x16x32_bf16 v[96:99], a[176:179], a[236:239], v[96:99]
  buffer_load_dwordx4 a[56:59], v1, s[8:11], s72 offen offset:1024 sc1
  v_mfma_f32_16x16x32_bf16 v[100:103], a[176:179], a[240:243], v[100:103]
  ds_read_b64_tr_b16 a[172:173], v6 offset:53248
  v_mfma_f32_16x16x32_bf16 v[100:103], a[180:183], a[224:227], v[100:103]
  s_add_u32 s72, s72, 131072
  v_mfma_f32_16x16x32_bf16 v[104:107], a[180:183], a[228:231], v[104:107]
  ds_read_b64_tr_b16 a[174:175], v6 offset:55296
  v_mfma_f32_16x16x32_bf16 v[104:107], a[176:179], a[244:247], v[104:107]
  buffer_load_dwordx4 a[44:47], v1, s[8:11], s72 offen offset:0 sc1
  v_mfma_f32_16x16x32_bf16 v[108:111], a[176:179], a[248:251], v[108:111]
  ds_read_b64_tr_b16 a[176:177], v7 offset:49152
  v_mfma_f32_16x16x32_bf16 v[108:111], a[180:183], a[232:235], v[108:111]
  s_waitcnt lgkmcnt(5)
  v_mfma_f32_16x16x32_bf16 v[124:127], a[160:163], a[232:235], v[124:127]
  ds_read_b64_tr_b16 a[178:179], v7 offset:51200
  v_mfma_f32_16x16x32_bf16 v[124:127], a[164:167], a[248:251], v[124:127]
  v_mfma_f32_16x16x32_bf16 v[120:123], a[164:167], a[244:247], v[120:123]
  ds_read_b64_tr_b16 a[180:181], v7 offset:53248
  v_mfma_f32_16x16x32_bf16 v[120:123], a[160:163], a[228:231], v[120:123]
  buffer_load_dwordx4 a[60:63], v1, s[8:11], s72 offen offset:1024 sc1
  v_mfma_f32_16x16x32_bf16 v[116:119], a[160:163], a[224:227], v[116:119]
  ds_read_b64_tr_b16 a[182:183], v7 offset:55296
  v_mfma_f32_16x16x32_bf16 v[116:119], a[164:167], a[240:243], v[116:119]
  v_mfma_f32_16x16x32_bf16 v[112:115], a[164:167], a[236:239], v[112:115]
  ds_read_b64_tr_b16 a[164:165], v8 offset:49152
  v_mfma_f32_16x16x32_bf16 v[112:115], a[160:163], a[220:223], v[112:115]
  s_waitcnt vmcnt(12) lgkmcnt(5)
  buffer_load_dwordx4 a[64:67], v1, s[8:11], s73 offen offset:0 sc1
  v_mfma_f32_16x16x32_bf16 v[64:67], a[168:171], a[0:3], v[64:67]
  ds_read_b64_tr_b16 a[166:167], v8 offset:51200
  v_mfma_f32_16x16x32_bf16 v[64:67], a[172:175], a[16:19], v[64:67]
  v_mfma_f32_16x16x32_bf16 v[68:71], a[172:175], a[20:23], v[68:71]
  ds_read_b64_tr_b16 a[160:161], v8 offset:53248
  v_mfma_f32_16x16x32_bf16 v[68:71], a[168:171], a[4:7], v[68:71]
  buffer_load_dwordx4 a[80:83], v1, s[8:11], s73 offen offset:1024 sc1
  v_mfma_f32_16x16x32_bf16 v[72:75], a[168:171], a[8:11], v[72:75]
  ds_read_b64_tr_b16 a[162:163], v8 offset:55296
  v_mfma_f32_16x16x32_bf16 v[72:75], a[172:175], a[24:27], v[72:75]
  s_add_u32 s73, s73, 131072
  v_mfma_f32_16x16x32_bf16 v[76:79], a[172:175], a[28:31], v[76:79]
  ds_read_b64_tr_b16 a[172:173], v9 offset:49152
  v_mfma_f32_16x16x32_bf16 v[76:79], a[168:171], a[12:15], v[76:79]
  s_waitcnt lgkmcnt(5)
  buffer_load_dwordx4 a[68:71], v1, s[8:11], s73 offen offset:0 sc1
  v_mfma_f32_16x16x32_bf16 v[92:95], a[176:179], a[12:15], v[92:95]
  ds_read_b64_tr_b16 a[174:175], v9 offset:51200
  v_mfma_f32_16x16x32_bf16 v[92:95], a[180:183], a[28:31], v[92:95]
  v_mfma_f32_16x16x32_bf16 v[88:91], a[180:183], a[24:27], v[88:91]
  ds_read_b64_tr_b16 a[168:169], v9 offset:53248
  v_mfma_f32_16x16x32_bf16 v[88:91], a[176:179], a[8:11], v[88:91]
  v_mfma_f32_16x16x32_bf16 v[84:87], a[176:179], a[4:7], v[84:87]
  ds_read_b64_tr_b16 a[170:171], v9 offset:55296
  buffer_load_dwordx4 a[84:87], v1, s[8:11], s73 offen offset:1024 sc1
  v_mfma_f32_16x16x32_bf16 v[84:87], a[180:183], a[20:23], v[84:87]
  s_waitcnt vmcnt(12)
  s_barrier
  v_mfma_f32_16x16x32_bf16 v[80:83], a[180:183], a[16:19], v[80:83]
  ds_read_b64_tr_b16 a[180:181], v6 offset:16384
  v_mfma_f32_16x16x32_bf16 v[80:83], a[176:179], a[0:3], v[80:83]
  s_waitcnt lgkmcnt(5)
  s_add_u32 s73, s73, s88
  v_mfma_f32_16x16x32_bf16 v[96:99], a[164:167], a[0:3], v[96:99]
  ds_read_b64_tr_b16 a[182:183], v6 offset:18432
  v_mfma_f32_16x16x32_bf16 v[96:99], a[160:163], a[16:19], v[96:99]
  buffer_load_dwordx4 a[72:75], v1, s[8:11], s73 offen offset:0 sc1
  v_mfma_f32_16x16x32_bf16 v[100:103], a[160:163], a[20:23], v[100:103]
  ds_read_b64_tr_b16 a[176:177], v6 offset:20480
  v_mfma_f32_16x16x32_bf16 v[100:103], a[164:167], a[4:7], v[100:103]
  v_mfma_f32_16x16x32_bf16 v[104:107], a[164:167], a[8:11], v[104:107]
  ds_read_b64_tr_b16 a[178:179], v6 offset:22528
  v_mfma_f32_16x16x32_bf16 v[104:107], a[160:163], a[24:27], v[104:107]
  buffer_load_dwordx4 a[88:91], v1, s[8:11], s73 offen offset:1024 sc1
  v_mfma_f32_16x16x32_bf16 v[108:111], a[160:163], a[28:31], v[108:111]
  ds_read_b64_tr_b16 a[160:161], v7 offset:16384
  v_mfma_f32_16x16x32_bf16 v[108:111], a[164:167], a[12:15], v[108:111]
  s_waitcnt lgkmcnt(5)
  s_add_u32 s73, s73, 131072
  v_mfma_f32_16x16x32_bf16 v[124:127], a[172:175], a[12:15], v[124:127]
  ds_read_b64_tr_b16 a[162:163], v7 offset:18432
  v_mfma_f32_16x16x32_bf16 v[124:127], a[168:171], a[28:31], v[124:127]
  buffer_load_dwordx4 a[76:79], v1, s[8:11], s73 offen offset:0 sc1
  v_mfma_f32_16x16x32_bf16 v[120:123], a[168:171], a[24:27], v[120:123]
  ds_read_b64_tr_b16 a[164:165], v7 offset:20480
  v_mfma_f32_16x16x32_bf16 v[120:123], a[172:175], a[8:11], v[120:123]
  v_mfma_f32_16x16x32_bf16 v[116:119], a[172:175], a[4:7], v[116:119]
  ds_read_b64_tr_b16 a[166:167], v7 offset:22528
  v_mfma_f32_16x16x32_bf16 v[116:119], a[168:171], a[20:23], v[116:119]
  v_mfma_f32_16x16x32_bf16 v[112:115], a[168:171], a[16:19], v[112:115]
  ds_read_b64_tr_b16 a[168:169], v8 offset:16384
  v_mfma_f32_16x16x32_bf16 v[112:115], a[172:175], a[0:3], v[112:115]
  s_waitcnt vmcnt(7) lgkmcnt(5)
  buffer_load_dwordx4 a[92:95], v1, s[8:11], s73 offen offset:1024 sc1
  v_mfma_f32_16x16x32_bf16 v[64:67], a[180:183], a[32:35], v[64:67]
  ds_read_b64_tr_b16 a[170:171], v8 offset:18432
  v_mfma_f32_16x16x32_bf16 v[64:67], a[176:179], a[48:51], v[64:67]
  v_mfma_f32_16x16x32_bf16 v[68:71], a[176:179], a[52:55], v[68:71]
  ds_read_b64_tr_b16 a[172:173], v8 offset:20480
  v_mfma_f32_16x16x32_bf16 v[68:71], a[180:183], a[36:39], v[68:71]
  buffer_load_dwordx4 a[96:99], v1, s[8:11], s74 offen offset:0 sc1
  v_mfma_f32_16x16x32_bf16 v[72:75], a[180:183], a[40:43], v[72:75]
  ds_read_b64_tr_b16 a[174:175], v8 offset:22528
  v_mfma_f32_16x16x32_bf16 v[72:75], a[176:179], a[56:59], v[72:75]
  v_mfma_f32_16x16x32_bf16 v[76:79], a[176:179], a[60:63], v[76:79]
  ds_read_b64_tr_b16 a[176:177], v9 offset:16384
  v_mfma_f32_16x16x32_bf16 v[76:79], a[180:183], a[44:47], v[76:79]
  s_waitcnt lgkmcnt(5)
  buffer_load_dwordx4 a[112:115], v1, s[8:11], s74 offen offset:1024 sc1
  v_mfma_f32_16x16x32_bf16 v[92:95], a[160:163], a[44:47], v[92:95]
  ds_read_b64_tr_b16 a[178:179], v9 offset:18432
  v_mfma_f32_16x16x32_bf16 v[92:95], a[164:167], a[60:63], v[92:95]
  s_add_u32 s74, s74, 131072
  v_mfma_f32_16x16x32_bf16 v[88:91], a[164:167], a[56:59], v[88:91]
  ds_read_b64_tr_b16 a[180:181], v9 offset:20480
  v_mfma_f32_16x16x32_bf16 v[88:91], a[160:163], a[40:43], v[88:91]
  buffer_load_dwordx4 a[100:103], v1, s[8:11], s74 offen offset:0 sc1
  v_mfma_f32_16x16x32_bf16 v[84:87], a[160:163], a[36:39], v[84:87]
  ds_read_b64_tr_b16 a[182:183], v9 offset:22528
  v_mfma_f32_16x16x32_bf16 v[84:87], a[164:167], a[52:55], v[84:87]
  v_mfma_f32_16x16x32_bf16 v[80:83], a[164:167], a[48:51], v[80:83]
  ds_read_b64_tr_b16 a[164:165], v6 offset:0
  v_mfma_f32_16x16x32_bf16 v[80:83], a[160:163], a[32:35], v[80:83]
  s_waitcnt lgkmcnt(5)
  v_mfma_f32_16x16x32_bf16 v[96:99], a[168:171], a[32:35], v[96:99]
  ds_read_b64_tr_b16 a[166:167], v6 offset:2048
  v_mfma_f32_16x16x32_bf16 v[96:99], a[172:175], a[48:51], v[96:99]
  buffer_load_dwordx4 a[116:119], v1, s[8:11], s74 offen offset:1024 sc1
  v_mfma_f32_16x16x32_bf16 v[100:103], a[172:175], a[52:55], v[100:103]
  ds_read_b64_tr_b16 a[160:161], v6 offset:4096
  v_mfma_f32_16x16x32_bf16 v[100:103], a[168:171], a[36:39], v[100:103]
  s_add_u32 s74, s74, s88
  v_mfma_f32_16x16x32_bf16 v[104:107], a[168:171], a[40:43], v[104:107]
  ds_read_b64_tr_b16 a[162:163], v6 offset:6144
  v_mfma_f32_16x16x32_bf16 v[104:107], a[172:175], a[56:59], v[104:107]
  buffer_load_dwordx4 a[104:107], v1, s[8:11], s74 offen offset:0 sc1
  v_mfma_f32_16x16x32_bf16 v[108:111], a[172:175], a[60:63], v[108:111]
  ds_read_b64_tr_b16 a[172:173], v7 offset:0
  v_mfma_f32_16x16x32_bf16 v[108:111], a[168:171], a[44:47], v[108:111]
  s_waitcnt lgkmcnt(5)
  v_mfma_f32_16x16x32_bf16 v[124:127], a[176:179], a[44:47], v[124:127]
  ds_read_b64_tr_b16 a[174:175], v7 offset:2048
  v_mfma_f32_16x16x32_bf16 v[124:127], a[180:183], a[60:63], v[124:127]
  buffer_load_dwordx4 a[120:123], v1, s[8:11], s74 offen offset:1024 sc1
  v_mfma_f32_16x16x32_bf16 v[120:123], a[180:183], a[56:59], v[120:123]
  ds_read_b64_tr_b16 a[168:169], v7 offset:4096
  v_mfma_f32_16x16x32_bf16 v[120:123], a[176:179], a[40:43], v[120:123]
  s_add_u32 s74, s74, 131072
HOP18:
  s_cbranch_execz WRET1
  v_mfma_f32_16x16x32_bf16 v[116:119], a[176:179], a[36:39], v[116:119]
  ds_read_b64_tr_b16 a[170:171], v7 offset:6144
  v_mfma_f32_16x16x32_bf16 v[116:119], a[180:183], a[52:55], v[116:119]
  buffer_load_dwordx4 a[108:111], v1, s[8:11], s74 offen offset:0 sc1
  v_mfma_f32_16x16x32_bf16 v[112:115], a[180:183], a[48:51], v[112:115]
  ds_read_b64_tr_b16 a[180:181], v8 offset:0
  v_mfma_f32_16x16x32_bf16 v[112:115], a[176:179], a[32:35], v[112:115]
  s_waitcnt vmcnt(7) lgkmcnt(5)
  v_mfma_f32_16x16x32_bf16 v[64:67], a[164:167], a[64:67], v[64:67]
  ds_read_b64_tr_b16 a[182:183], v8 offset:2048
  v_mfma_f32_16x16x32_bf16 v[64:67], a[160:163], a[80:83], v[64:67]
  v_mfma_f32_16x16x32_bf16 v[68:71], a[160:163], a[84:87], v[68:71]
  ds_read_b64_tr_b16 a[176:177], v8 offset:4096
  v_mfma_f32_16x16x32_bf16 v[68:71], a[164:167], a[68:71], v[68:71]
  buffer_load_dwordx4 a[124:127], v1, s[8:11], s74 offen offset:1024 sc1
  v_mfma_f32_16x16x32_bf16 v[72:75], a[164:167], a[72:75], v[72:75]
  ds_read_b64_tr_b16 a[178:179], v8 offset:6144
  v_mfma_f32_16x16x32_bf16 v[72:75], a[160:163], a[88:91], v[72:75]
  v_mfma_f32_16x16x32_bf16 v[76:79], a[160:163], a[92:95], v[76:79]
  ds_read_b64_tr_b16 a[160:161], v9 offset:0
  v_mfma_f32_16x16x32_bf16 v[76:79], a[164:167], a[76:79], v[76:79]
  s_waitcnt lgkmcnt(5)
  buffer_load_dwordx4 a[128:131], v1, s[8:11], s75 offen offset:0 sc1
  v_mfma_f32_16x16x32_bf16 v[92:95], a[172:175], a[76:79], v[92:95]
  ds_read_b64_tr_b16 a[162:163], v9 offset:2048
  v_mfma_f32_16x16x32_bf16 v[92:95], a[168:171], a[92:95], v[92:95]
  v_mfma_f32_16x16x32_bf16 v[88:91], a[168:171], a[88:91], v[88:91]
  ds_read_b64_tr_b16 a[164:165], v9 offset:4096
  v_mfma_f32_16x16x32_bf16 v[88:91], a[172:175], a[72:75], v[88:91]
  buffer_load_dwordx4 a[144:147], v1, s[8:11], s75 offen offset:1024 sc1
  v_mfma_f32_16x16x32_bf16 v[84:87], a[172:175], a[68:71], v[84:87]
  ds_read_b64_tr_b16 a[166:167], v9 offset:6144
  v_mfma_f32_16x16x32_bf16 v[84:87], a[168:171], a[84:87], v[84:87]
  s_add_u32 s75, s75, 131072
  v_mfma_f32_16x16x32_bf16 v[80:83], a[168:171], a[80:83], v[80:83]
  ds_read_b64_tr_b16 a[168:169], v2 offset:16384
  v_mfma_f32_16x16x32_bf16 v[80:83], a[172:175], a[64:67], v[80:83]
  s_waitcnt lgkmcnt(5)
  buffer_load_dwordx4 a[132:135], v1, s[8:11], s75 offen offset:0 sc1
  v_mfma_f32_16x16x32_bf16 v[96:99], a[180:183], a[64:67], v[96:99]
  ds_read_b64_tr_b16 a[170:171], v2 offset:18432
  v_mfma_f32_16x16x32_bf16 v[96:99], a[176:179], a[80:83], v[96:99]
  v_mfma_f32_16x16x32_bf16 v[100:103], a[176:179], a[84:87], v[100:103]
  ds_read_b64_tr_b16 a[172:173], v2 offset:20480
  v_mfma_f32_16x16x32_bf16 v[100:103], a[180:183], a[68:71], v[100:103]
  v_mfma_f32_16x16x32_bf16 v[104:107], a[180:183], a[72:75], v[104:107]
  ds_read_b64_tr_b16 a[174:175], v2 offset:22528
  v_mfma_f32_16x16x32_bf16 v[104:107], a[176:179], a[88:91], v[104:107]
  buffer_load_dwordx4 a[148:151], v1, s[8:11], s75 offen offset:1024 sc1
  v_mfma_f32_16x16x32_bf16 v[108:111], a[176:179], a[92:95], v[108:111]
  ds_read_b64_tr_b16 a[176:177], v3 offset:16384
  v_mfma_f32_16x16x32_bf16 v[108:111], a[180:183], a[76:79], v[108:111]
  s_waitcnt lgkmcnt(5)
  s_add_u32 s75, s75, s88
  v_mfma_f32_16x16x32_bf16 v[124:127], a[160:163], a[76:79], v[124:127]
  ds_read_b64_tr_b16 a[178:179], v3 offset:18432
  v_mfma_f32_16x16x32_bf16 v[124:127], a[164:167], a[92:95], v[124:127]
  buffer_load_dwordx4 a[136:139], v1, s[8:11], s75 offen offset:0 sc1
  v_mfma_f32_16x16x32_bf16 v[120:123], a[164:167], a[88:91], v[120:123]
  ds_read_b64_tr_b16 a[180:181], v3 offset:20480
  v_mfma_f32_16x16x32_bf16 v[120:123], a[160:163], a[72:75], v[120:123]
  v_mfma_f32_16x16x32_bf16 v[116:119], a[160:163], a[68:71], v[116:119]
  ds_read_b64_tr_b16 a[182:183], v3 offset:22528
  v_mfma_f32_16x16x32_bf16 v[116:119], a[164:167], a[84:87], v[116:119]
  buffer_load_dwordx4 a[152:155], v1, s[8:11], s75 offen offset:1024 sc1
  v_mfma_f32_16x16x32_bf16 v[112:115], a[164:167], a[80:83], v[112:115]
  ds_read_b64_tr_b16 a[164:165], v4 offset:16384
  v_mfma_f32_16x16x32_bf16 v[112:115], a[160:163], a[64:67], v[112:115]
  s_waitcnt vmcnt(6) lgkmcnt(5)
  s_add_u32 s75, s75, 131072
  v_mfma_f32_16x16x32_bf16 v[64:67], a[168:171], a[96:99], v[64:67]
  ds_read_b64_tr_b16 a[166:167], v4 offset:18432
  v_mfma_f32_16x16x32_bf16 v[64:67], a[172:175], a[112:115], v[64:67]
  buffer_load_dwordx4 a[140:143], v1, s[8:11], s75 offen offset:0 sc1
  v_mfma_f32_16x16x32_bf16 v[68:71], a[172:175], a[116:119], v[68:71]
  ds_read_b64_tr_b16 a[160:161], v4 offset:20480
  v_mfma_f32_16x16x32_bf16 v[68:71], a[168:171], a[100:103], v[68:71]
  v_mfma_f32_16x16x32_bf16 v[72:75], a[168:171], a[104:107], v[72:75]
  ds_read_b64_tr_b16 a[162:163], v4 offset:22528
  v_mfma_f32_16x16x32_bf16 v[72:75], a[172:175], a[120:123], v[72:75]
  v_mfma_f32_16x16x32_bf16 v[76:79], a[172:175], a[124:127], v[76:79]
  ds_read_b64_tr_b16 a[172:173], v5 offset:16384
  v_mfma_f32_16x16x32_bf16 v[76:79], a[168:171], a[108:111], v[76:79]
  s_waitcnt lgkmcnt(5)
  buffer_load_dwordx4 a[156:159], v1, s[8:11], s75 offen offset:1024 sc1
  v_mfma_f32_16x16x32_bf16 v[92:95], a[176:179], a[108:111], v[92:95]
  ds_read_b64_tr_b16 a[174:175], v5 offset:18432
  v_mfma_f32_16x16x32_bf16 v[92:95], a[180:183], a[124:127], v[92:95]
  v_mfma_f32_16x16x32_bf16 v[88:91], a[180:183], a[120:123], v[88:91]
  ds_read_b64_tr_b16 a[168:169], v5 offset:20480
  v_mfma_f32_16x16x32_bf16 v[88:91], a[176:179], a[104:107], v[88:91]
  buffer_load_dwordx4 a[188:191], v1, s[8:11], s76 offen offset:0 sc1
  v_mfma_f32_16x16x32_bf16 v[84:87], a[176:179], a[100:103], v[84:87]
  ds_read_b64_tr_b16 a[170:171], v5 offset:22528
  v_mfma_f32_16x16x32_bf16 v[84:87], a[180:183], a[116:119], v[84:87]
  v_mfma_f32_16x16x32_bf16 v[80:83], a[180:183], a[112:115], v[80:83]
  ds_read_b64_tr_b16 a[180:181], v2 offset:32768
  v_mfma_f32_16x16x32_bf16 v[80:83], a[176:179], a[96:99], v[80:83]
  s_waitcnt lgkmcnt(5)
  buffer_load_dwordx4 a[204:207], v1, s[8:11], s76 offen offset:1024 sc1
  v_mfma_f32_16x16x32_bf16 v[96:99], a[164:167], a[96:99], v[96:99]
  ds_read_b64_tr_b16 a[182:183], v2 offset:34816
  v_mfma_f32_16x16x32_bf16 v[96:99], a[160:163], a[112:115], v[96:99]
  s_add_u32 s76, s76, 131072
  v_mfma_f32_16x16x32_bf16 v[100:103], a[160:163], a[116:119], v[100:103]
  ds_read_b64_tr_b16 a[176:177], v2 offset:36864
  v_mfma_f32_16x16x32_bf16 v[100:103], a[164:167], a[100:103], v[100:103]
  buffer_load_dwordx4 a[192:195], v1, s[8:11], s76 offen offset:0 sc1
  v_mfma_f32_16x16x32_bf16 v[104:107], a[164:167], a[104:107], v[104:107]
  ds_read_b64_tr_b16 a[178:179], v2 offset:38912
  v_mfma_f32_16x16x32_bf16 v[104:107], a[160:163], a[120:123], v[104:107]
  v_mfma_f32_16x16x32_bf16 v[108:111], a[160:163], a[124:127], v[108:111]
  ds_read_b64_tr_b16 a[160:161], v3 offset:32768
  v_mfma_f32_16x16x32_bf16 v[108:111], a[164:167], a[108:111], v[108:111]
  s_waitcnt lgkmcnt(5)
  v_mfma_f32_16x16x32_bf16 v[124:127], a[172:175], a[108:111], v[124:127]
  ds_read_b64_tr_b16 a[162:163], v3 offset:34816
  v_mfma_f32_16x16x32_bf16 v[124:127], a[168:171], a[124:127], v[124:127]
  buffer_load_dwordx4 a[208:211], v1, s[8:11], s76 offen offset:1024 sc1
  v_mfma_f32_16x16x32_bf16 v[120:123], a[168:171], a[120:123], v[120:123]
  ds_read_b64_tr_b16 a[164:165], v3 offset:36864
  v_mfma_f32_16x16x32_bf16 v[120:123], a[172:175], a[104:107], v[120:123]
  s_add_u32 s76, s76, s88
  v_mfma_f32_16x16x32_bf16 v[116:119], a[172:175], a[100:103], v[116:119]
  ds_read_b64_tr_b16 a[166:167], v3 offset:38912
  v_mfma_f32_16x16x32_bf16 v[116:119], a[168:171], a[116:119], v[116:119]
  buffer_load_dwordx4 a[196:199], v1, s[8:11], s76 offen offset:0 sc1
  v_mfma_f32_16x16x32_bf16 v[112:115], a[168:171], a[112:115], v[112:115]
  ds_read_b64_tr_b16 a[168:169], v4 offset:32768
  v_mfma_f32_16x16x32_bf16 v[112:115], a[172:175], a[96:99], v[112:115]
  s_waitcnt vmcnt(5) lgkmcnt(5)
  v_mfma_f32_16x16x32_bf16 v[64:67], a[180:183], a[128:131], v[64:67]
  ds_read_b64_tr_b16 a[170:171], v4 offset:34816
  v_mfma_f32_16x16x32_bf16 v[64:67], a[176:179], a[144:147], v[64:67]
  buffer_load_dwordx4 a[212:215], v1, s[8:11], s76 offen offset:1024 sc1
  v_mfma_f32_16x16x32_bf16 v[68:71], a[176:179], a[148:151], v[68:71]
  ds_read_b64_tr_b16 a[172:173], v4 offset:36864
  v_mfma_f32_16x16x32_bf16 v[68:71], a[180:183], a[132:135], v[68:71]
  s_add_u32 s76, s76, 131072
  v_mfma_f32_16x16x32_bf16 v[72:75], a[180:183], a[136:139], v[72:75]
  ds_read_b64_tr_b16 a[174:175], v4 offset:38912
  v_mfma_f32_16x16x32_bf16 v[72:75], a[176:179], a[152:155], v[72:75]
  buffer_load_dwordx4 a[200:203], v1, s[8:11], s76 offen offset:0 sc1
  v_mfma_f32_16x16x32_bf16 v[76:79], a[176:179], a[156:159], v[76:79]
  ds_read_b64_tr_b16 a[176:177], v5 offset:32768
  v_mfma_f32_16x16x32_bf16 v[76:79], a[180:183], a[140:143], v[76:79]
  s_waitcnt lgkmcnt(5)
  v_mfma_f32_16x16x32_bf16 v[92:95], a[160:163], a[140:143], v[92:95]
  ds_read_b64_tr_b16 a[178:179], v5 offset:34816
  v_mfma_f32_16x16x32_bf16 v[92:95], a[164:167], a[156:159], v[92:95]
  v_mfma_f32_16x16x32_bf16 v[88:91], a[164:167], a[152:155], v[88:91]
  ds_read_b64_tr_b16 a[180:181], v5 offset:36864
  v_mfma_f32_16x16x32_bf16 v[88:91], a[160:163], a[136:139], v[88:91]
  buffer_load_dwordx4 a[216:219], v1, s[8:11], s76 offen offset:1024 sc1
  v_mfma_f32_16x16x32_bf16 v[84:87], a[160:163], a[132:135], v[84:87]
  ds_read_b64_tr_b16 a[182:183], v5 offset:38912
  v_mfma_f32_16x16x32_bf16 v[84:87], a[164:167], a[148:151], v[84:87]
  s_add_u32 m0, s45, 24576
  v_mfma_f32_16x16x32_bf16 v[80:83], a[164:167], a[144:147], v[80:83]
  ds_read_b64_tr_b16 a[164:165], v2 offset:49152
  v_mfma_f32_16x16x32_bf16 v[80:83], a[160:163], a[128:131], v[80:83]
  s_waitcnt lgkmcnt(5)
  buffer_load_dwordx4 v33, s[36:39], s66 offen lds
  v_mfma_f32_16x16x32_bf16 v[96:99], a[168:171], a[128:131], v[96:99]
  ds_read_b64_tr_b16 a[166:167], v2 offset:51200
  v_mfma_f32_16x16x32_bf16 v[96:99], a[172:175], a[144:147], v[96:99]
  s_add_u32 m0, s45, 28672
  s_add_u32 s60, s66, 65536
  v_mfma_f32_16x16x32_bf16 v[100:103], a[172:175], a[148:151], v[100:103]
  ds_read_b64_tr_b16 a[160:161], v2 offset:53248
  v_mfma_f32_16x16x32_bf16 v[100:103], a[168:171], a[132:135], v[100:103]
  buffer_load_dwordx4 v33, s[36:39], s60 offen lds
  v_mfma_f32_16x16x32_bf16 v[104:107], a[168:171], a[136:139], v[104:107]
  ds_read_b64_tr_b16 a[162:163], v2 offset:55296
  v_mfma_f32_16x16x32_bf16 v[104:107], a[172:175], a[152:155], v[104:107]
  s_add_u32 m0, s45, 40960
  v_mfma_f32_16x16x32_bf16 v[108:111], a[172:175], a[156:159], v[108:111]
  ds_read_b64_tr_b16 a[172:173], v3 offset:49152
  v_mfma_f32_16x16x32_bf16 v[108:111], a[168:171], a[140:143], v[108:111]
  s_waitcnt lgkmcnt(5)
  buffer_load_dwordx4 v33, s[36:39], s67 offen lds
  v_mfma_f32_16x16x32_bf16 v[124:127], a[176:179], a[140:143], v[124:127]
  ds_read_b64_tr_b16 a[174:175], v3 offset:51200
  v_mfma_f32_16x16x32_bf16 v[124:127], a[180:183], a[156:159], v[124:127]
  v_mfma_f32_16x16x32_bf16 v[120:123], a[180:183], a[152:155], v[120:123]
  ds_read_b64_tr_b16 a[168:169], v3 offset:53248
  v_mfma_f32_16x16x32_bf16 v[120:123], a[176:179], a[136:139], v[120:123]
  s_add_u32 m0, s45, 45056
  s_add_u32 s60, s67, 65536
  v_mfma_f32_16x16x32_bf16 v[116:119], a[176:179], a[132:135], v[116:119]
  ds_read_b64_tr_b16 a[170:171], v3 offset:55296
  v_mfma_f32_16x16x32_bf16 v[116:119], a[180:183], a[148:151], v[116:119]
  buffer_load_dwordx4 v33, s[36:39], s60 offen lds
  v_mfma_f32_16x16x32_bf16 v[112:115], a[180:183], a[144:147], v[112:115]
  ds_read_b64_tr_b16 a[180:181], v4 offset:49152
  v_mfma_f32_16x16x32_bf16 v[112:115], a[176:179], a[128:131], v[112:115]
  s_waitcnt vmcnt(4) lgkmcnt(5)
  s_add_u32 m0, s45, 57344
  v_mfma_f32_16x16x32_bf16 v[64:67], a[164:167], a[188:191], v[64:67]
  ds_read_b64_tr_b16 a[182:183], v4 offset:51200
  v_mfma_f32_16x16x32_bf16 v[64:67], a[160:163], a[204:207], v[64:67]
  buffer_load_dwordx4 v33, s[36:39], s68 offen lds
  v_mfma_f32_16x16x32_bf16 v[68:71], a[160:163], a[208:211], v[68:71]
  ds_read_b64_tr_b16 a[176:177], v4 offset:53248
  v_mfma_f32_16x16x32_bf16 v[68:71], a[164:167], a[192:195], v[68:71]
  s_add_u32 m0, s45, 61440
  s_add_u32 s60, s68, 65536
  v_mfma_f32_16x16x32_bf16 v[72:75], a[164:167], a[196:199], v[72:75]
  ds_read_b64_tr_b16 a[178:179], v4 offset:55296
  v_mfma_f32_16x16x32_bf16 v[72:75], a[160:163], a[212:215], v[72:75]
  buffer_load_dwordx4 v33, s[36:39], s60 offen lds
  v_mfma_f32_16x16x32_bf16 v[76:79], a[160:163], a[216:219], v[76:79]
  ds_read_b64_tr_b16 a[160:161], v5 offset:49152
  v_mfma_f32_16x16x32_bf16 v[76:79], a[164:167], a[200:203], v[76:79]
  s_waitcnt lgkmcnt(5)
  v_mfma_f32_16x16x32_bf16 v[92:95], a[172:175], a[200:203], v[92:95]
  ds_read_b64_tr_b16 a[162:163], v5 offset:51200
  v_mfma_f32_16x16x32_bf16 v[92:95], a[168:171], a[216:219], v[92:95]
  v_mfma_f32_16x16x32_bf16 v[88:91], a[168:171], a[212:215], v[88:91]
  ds_read_b64_tr_b16 a[164:165], v5 offset:53248
  v_cvt_pk_bf16_f32 v72, v72, v73
  v_mfma_f32_16x16x32_bf16 v[88:91], a[172:175], a[196:199], v[88:91]
  v_cvt_pk_bf16_f32 v73, v74, v75
  v_cvt_pk_bf16_f32 v76, v76, v77
  v_mfma_f32_16x16x32_bf16 v[84:87], a[172:175], a[192:195], v[84:87]
  ds_read_b64_tr_b16 a[166:167], v5 offset:55296
  v_cvt_pk_bf16_f32 v77, v78, v79
  v_mfma_f32_16x16x32_bf16 v[84:87], a[168:171], a[208:211], v[84:87]
  v_cvt_pk_bf16_f32 v64, v64, v65
  v_cvt_pk_bf16_f32 v65, v66, v67
  v_mfma_f32_16x16x32_bf16 v[80:83], a[168:171], a[204:207], v[80:83]
  v_cvt_pk_bf16_f32 v68, v68, v69
  v_cvt_pk_bf16_f32 v69, v70, v71
  v_mfma_f32_16x16x32_bf16 v[80:83], a[172:175], a[188:191], v[80:83]
  s_waitcnt lgkmcnt(4)
  s_waitcnt vmcnt(0)
  s_barrier
  v_mfma_f32_16x16x32_bf16 v[96:99], a[180:183], a[188:191], v[96:99]
  ds_read_b64_tr_b16 v[16:17], v6 offset:40960
  v_mfma_f32_16x16x32_bf16 v[96:99], a[176:179], a[204:207], v[96:99]
  ds_read_b64_tr_b16 v[18:19], v6 offset:43008
  v_mfma_f32_16x16x32_bf16 v[100:103], a[176:179], a[208:211], v[100:103]
  ds_read_b64_tr_b16 v[20:21], v6 offset:45056
  v_cvt_pk_bf16_f32 v74, v88, v89
  v_mfma_f32_16x16x32_bf16 v[100:103], a[180:183], a[192:195], v[100:103]
  ds_read_b64_tr_b16 v[22:23], v6 offset:47104
  v_cvt_pk_bf16_f32 v75, v90, v91
  v_mfma_f32_16x16x32_bf16 v[104:107], a[180:183], a[196:199], v[104:107]
  ds_read_b64_tr_b16 v[24:25], v7 offset:40960
  v_mfma_f32_16x16x32_bf16 v[104:107], a[176:179], a[212:215], v[104:107]
  ds_read_b64_tr_b16 v[26:27], v7 offset:43008
  v_mfma_f32_16x16x32_bf16 v[108:111], a[176:179], a[216:219], v[108:111]
  ds_read_b64_tr_b16 v[28:29], v7 offset:45056
  s_add_u32 s86, s85, 0
  buffer_store_dwordx4 v[72:75], v1, s[8:11], s86 offen offset:0 sc1
  v_mfma_f32_16x16x32_bf16 v[108:111], a[180:183], a[200:203], v[108:111]
  s_waitcnt lgkmcnt(7)
  ds_read_b64_tr_b16 v[30:31], v7 offset:47104
  v_mfma_f32_16x16x32_bf16 v[124:127], a[160:163], a[200:203], v[124:127]
  ds_read_b64_tr_b16 a[168:169], v8 offset:40960
  v_cvt_pk_bf16_f32 v78, v92, v93
  v_mfma_f32_16x16x32_bf16 v[124:127], a[164:167], a[216:219], v[124:127]
  ds_read_b64_tr_b16 a[170:171], v8 offset:43008
  v_cvt_pk_bf16_f32 v79, v94, v95
  v_mfma_f32_16x16x32_bf16 v[120:123], a[164:167], a[212:215], v[120:123]
  ds_read_b64_tr_b16 a[172:173], v8 offset:45056
  v_mfma_f32_16x16x32_bf16 v[120:123], a[160:163], a[196:199], v[120:123]
  ds_read_b64_tr_b16 a[174:175], v8 offset:47104
  v_mfma_f32_16x16x32_bf16 v[116:119], a[160:163], a[192:195], v[116:119]
  ds_read_b64_tr_b16 a[176:177], v9 offset:40960
  s_add_u32 s86, s85, 0
  buffer_store_dwordx4 v[76:79], v1, s[8:11], s86 offen offset:2048 sc1
  v_mfma_f32_16x16x32_bf16 v[116:119], a[164:167], a[208:211], v[116:119]
  ds_read_b64_tr_b16 a[178:179], v9 offset:43008
  v_mfma_f32_16x16x32_bf16 v[112:115], a[164:167], a[204:207], v[112:115]
  ds_read_b64_tr_b16 a[180:181], v9 offset:45056
  v_cvt_pk_bf16_f32 v66, v80, v81
  v_mfma_f32_16x16x32_bf16 v[112:115], a[160:163], a[188:191], v[112:115]
  s_waitcnt lgkmcnt(7)
  ds_read_b64_tr_b16 a[182:183], v9 offset:47104
  v_mfma_f32_16x16x32_bf16 v[136:139], v[16:19], a[228:231], v[136:139]
  ds_read_b64_tr_b16 a[164:165], v6 offset:57344
  v_cvt_pk_bf16_f32 v67, v82, v83
  v_mfma_f32_16x16x32_bf16 v[136:139], v[20:23], a[244:247], v[136:139]
  ds_read_b64_tr_b16 a[166:167], v6 offset:59392
  v_mfma_f32_16x16x32_bf16 v[140:143], v[20:23], a[248:251], v[140:143]
  ds_read_b64_tr_b16 a[160:161], v6 offset:61440
  v_mfma_f32_16x16x32_bf16 v[140:143], v[16:19], a[232:235], v[140:143]
  ds_read_b64_tr_b16 a[162:163], v6 offset:63488
  s_add_u32 s86, s85, 4096
  buffer_store_dwordx4 v[64:67], v1, s[8:11], s86 offen offset:0 sc1
  v_mfma_f32_16x16x32_bf16 v[156:159], v[24:27], a[232:235], v[156:159]
  ds_read_b64_tr_b16 v[20:21], v7 offset:57344
  v_mfma_f32_16x16x32_bf16 v[156:159], v[28:31], a[248:251], v[156:159]
  ds_read_b64_tr_b16 v[22:23], v7 offset:59392
  v_cvt_pk_bf16_f32 v70, v84, v85
  v_mfma_f32_16x16x32_bf16 v[152:155], v[28:31], a[244:247], v[152:155]
  ds_read_b64_tr_b16 v[16:17], v7 offset:61440
  v_cvt_pk_bf16_f32 v71, v86, v87
  v_mfma_f32_16x16x32_bf16 v[152:155], v[24:27], a[228:231], v[152:155]
  s_waitcnt lgkmcnt(7)
  ds_read_b64_tr_b16 v[18:19], v7 offset:63488
  v_mfma_f32_16x16x32_bf16 v[168:171], a[168:171], a[228:231], v[168:171]
  ds_read_b64_tr_b16 v[28:29], v8 offset:57344
  v_mfma_f32_16x16x32_bf16 v[168:171], a[172:175], a[244:247], v[168:171]
  ds_read_b64_tr_b16 v[30:31], v8 offset:59392
  s_add_u32 s86, s85, 4096
  buffer_store_dwordx4 v[68:71], v1, s[8:11], s86 offen offset:2048 sc1
  v_mfma_f32_16x16x32_bf16 v[172:175], a[172:175], a[248:251], v[172:175]
  ds_read_b64_tr_b16 v[24:25], v8 offset:61440
  v_mfma_f32_16x16x32_bf16 v[172:175], a[168:171], a[232:235], v[172:175]
  ds_read_b64_tr_b16 v[26:27], v8 offset:63488
  v_cvt_pk_bf16_f32 v104, v104, v105
  v_mfma_f32_16x16x32_bf16 v[188:191], a[176:179], a[232:235], v[188:191]
  ds_read_b64_tr_b16 a[172:173], v9 offset:57344
  v_cvt_pk_bf16_f32 v105, v106, v107
  v_mfma_f32_16x16x32_bf16 v[188:191], a[180:183], a[248:251], v[188:191]
  ds_read_b64_tr_b16 a[174:175], v9 offset:59392
  v_cvt_pk_bf16_f32 v108, v108, v109
  v_mfma_f32_16x16x32_bf16 v[184:187], a[180:183], a[244:247], v[184:187]
  ds_read_b64_tr_b16 a[168:169], v9 offset:61440
  v_cvt_pk_bf16_f32 v109, v110, v111
  v_mfma_f32_16x16x32_bf16 v[184:187], a[176:179], a[228:231], v[184:187]
  s_waitcnt lgkmcnt(7)
  ds_read_b64_tr_b16 a[170:171], v9 offset:63488
  v_mfma_f32_16x16x32_bf16 v[136:139], a[164:167], a[8:11], v[136:139]
  ds_read_b64_tr_b16 a[180:181], v6 offset:24576
  v_cvt_pk_bf16_f32 v96, v96, v97
  v_mfma_f32_16x16x32_bf16 v[136:139], a[160:163], a[24:27], v[136:139]
  ds_read_b64_tr_b16 a[182:183], v6 offset:26624
  v_cvt_pk_bf16_f32 v97, v98, v99
  v_mfma_f32_16x16x32_bf16 v[140:143], a[160:163], a[28:31], v[140:143]
  ds_read_b64_tr_b16 a[176:177], v6 offset:28672
  v_cvt_pk_bf16_f32 v100, v100, v101
  v_mfma_f32_16x16x32_bf16 v[140:143], a[164:167], a[12:15], v[140:143]
  ds_read_b64_tr_b16 a[178:179], v6 offset:30720
  v_cvt_pk_bf16_f32 v101, v102, v103
  v_mfma_f32_16x16x32_bf16 v[156:159], v[20:23], a[12:15], v[156:159]
  ds_read_b64_tr_b16 a[160:161], v7 offset:24576
  v_cvt_pk_bf16_f32 v106, v120, v121
  v_mfma_f32_16x16x32_bf16 v[156:159], v[16:19], a[28:31], v[156:159]
  ds_read_b64_tr_b16 a[162:163], v7 offset:26624
  v_cvt_pk_bf16_f32 v107, v122, v123
  v_mfma_f32_16x16x32_bf16 v[152:155], v[16:19], a[24:27], v[152:155]
  ds_read_b64_tr_b16 a[164:165], v7 offset:28672
  v_mfma_f32_16x16x32_bf16 v[152:155], v[20:23], a[8:11], v[152:155]
  s_waitcnt lgkmcnt(7)
  ds_read_b64_tr_b16 a[166:167], v7 offset:30720
  v_mfma_f32_16x16x32_bf16 v[168:171], v[28:31], a[8:11], v[168:171]
  ds_read_b64_tr_b16 v[16:17], v8 offset:24576
  s_add_u32 s86, s85, 0
  buffer_store_dwordx4 v[104:107], v1, s[8:11], s86 offen offset:1024 sc1
  v_mfma_f32_16x16x32_bf16 v[168:171], v[24:27], a[24:27], v[168:171]
  ds_read_b64_tr_b16 v[18:19], v8 offset:26624
  v_mfma_f32_16x16x32_bf16 v[172:175], v[24:27], a[28:31], v[172:175]
  ds_read_b64_tr_b16 v[20:21], v8 offset:28672
  v_cvt_pk_bf16_f32 v110, v124, v125
  v_mfma_f32_16x16x32_bf16 v[172:175], v[28:31], a[12:15], v[172:175]
  ds_read_b64_tr_b16 v[22:23], v8 offset:30720
  v_cvt_pk_bf16_f32 v111, v126, v127
  v_mfma_f32_16x16x32_bf16 v[188:191], a[172:175], a[12:15], v[188:191]
  ds_read_b64_tr_b16 v[24:25], v9 offset:24576
  v_mfma_f32_16x16x32_bf16 v[188:191], a[168:171], a[28:31], v[188:191]
  ds_read_b64_tr_b16 v[26:27], v9 offset:26624
  v_mfma_f32_16x16x32_bf16 v[184:187], a[168:171], a[24:27], v[184:187]
  ds_read_b64_tr_b16 v[28:29], v9 offset:28672
  s_add_u32 s86, s85, 0
  buffer_store_dwordx4 v[108:111], v1, s[8:11], s86 offen offset:3072 sc1
  v_mfma_f32_16x16x32_bf16 v[184:187], a[172:175], a[8:11], v[184:187]
  s_waitcnt lgkmcnt(7)
  ds_read_b64_tr_b16 v[30:31], v9 offset:30720
  v_mfma_f32_16x16x32_bf16 v[136:139], a[180:183], a[40:43], v[136:139]
  ds_read_b64_tr_b16 a[168:169], v6 offset:8192
  v_cvt_pk_bf16_f32 v98, v112, v113
  v_mfma_f32_16x16x32_bf16 v[136:139], a[176:179], a[56:59], v[136:139]
  ds_read_b64_tr_b16 a[170:171], v6 offset:10240
  v_cvt_pk_bf16_f32 v99, v114, v115
  v_mfma_f32_16x16x32_bf16 v[140:143], a[176:179], a[60:63], v[140:143]
  ds_read_b64_tr_b16 a[172:173], v6 offset:12288
  v_mfma_f32_16x16x32_bf16 v[140:143], a[180:183], a[44:47], v[140:143]
  ds_read_b64_tr_b16 a[174:175], v6 offset:14336
  v_mfma_f32_16x16x32_bf16 v[156:159], a[160:163], a[44:47], v[156:159]
  ds_read_b64_tr_b16 a[176:177], v7 offset:8192
  s_add_u32 s86, s85, 4096
  buffer_store_dwordx4 v[96:99], v1, s[8:11], s86 offen offset:1024 sc1
  v_mfma_f32_16x16x32_bf16 v[156:159], a[164:167], a[60:63], v[156:159]
  ds_read_b64_tr_b16 a[178:179], v7 offset:10240
  v_mfma_f32_16x16x32_bf16 v[152:155], a[164:167], a[56:59], v[152:155]
  ds_read_b64_tr_b16 a[180:181], v7 offset:12288
  v_cvt_pk_bf16_f32 v102, v116, v117
  v_mfma_f32_16x16x32_bf16 v[152:155], a[160:163], a[40:43], v[152:155]
  s_waitcnt lgkmcnt(7)
  ds_read_b64_tr_b16 a[182:183], v7 offset:14336
  v_mfma_f32_16x16x32_bf16 v[168:171], v[16:19], a[40:43], v[168:171]
  ds_read_b64_tr_b16 a[164:165], v8 offset:8192
  v_cvt_pk_bf16_f32 v103, v118, v119
  v_mfma_f32_16x16x32_bf16 v[168:171], v[20:23], a[56:59], v[168:171]
  ds_read_b64_tr_b16 a[166:167], v8 offset:10240
  v_mfma_f32_16x16x32_bf16 v[172:175], v[20:23], a[60:63], v[172:175]
  ds_read_b64_tr_b16 a[160:161], v8 offset:12288
  v_mfma_f32_16x16x32_bf16 v[172:175], v[16:19], a[44:47], v[172:175]
  ds_read_b64_tr_b16 a[162:163], v8 offset:14336
  s_add_u32 s86, s85, 4096
  buffer_store_dwordx4 v[100:103], v1, s[8:11], s86 offen offset:3072 sc1
  v_mfma_f32_16x16x32_bf16 v[188:191], v[24:27], a[44:47], v[188:191]
  ds_read_b64_tr_b16 v[20:21], v9 offset:8192
  v_mfma_f32_16x16x32_bf16 v[188:191], v[28:31], a[60:63], v[188:191]
  ds_read_b64_tr_b16 v[22:23], v9 offset:10240
  v_mfma_f32_16x16x32_bf16 v[184:187], v[28:31], a[56:59], v[184:187]
  ds_read_b64_tr_b16 v[16:17], v9 offset:12288
  v_mfma_f32_16x16x32_bf16 v[184:187], v[24:27], a[40:43], v[184:187]
  s_waitcnt lgkmcnt(7)
  ds_read_b64_tr_b16 v[18:19], v9 offset:14336
  v_mfma_f32_16x16x32_bf16 v[136:139], a[168:171], a[72:75], v[136:139]
  ds_read_b64_tr_b16 v[28:29], v2 offset:24576
  v_mfma_f32_16x16x32_bf16 v[136:139], a[172:175], a[88:91], v[136:139]
  ds_read_b64_tr_b16 v[30:31], v2 offset:26624
  v_mfma_f32_16x16x32_bf16 v[140:143], a[172:175], a[92:95], v[140:143]
  ds_read_b64_tr_b16 v[24:25], v2 offset:28672
  v_mfma_f32_16x16x32_bf16 v[140:143], a[168:171], a[76:79], v[140:143]
  ds_read_b64_tr_b16 v[26:27], v2 offset:30720
  v_mfma_f32_16x16x32_bf16 v[156:159], a[176:179], a[76:79], v[156:159]
  ds_read_b64_tr_b16 a[172:173], v3 offset:24576
  v_mfma_f32_16x16x32_bf16 v[156:159], a[180:183], a[92:95], v[156:159]
  ds_read_b64_tr_b16 a[174:175], v3 offset:26624
  v_mfma_f32_16x16x32_bf16 v[152:155], a[180:183], a[88:91], v[152:155]
  ds_read_b64_tr_b16 a[168:169], v3 offset:28672
  v_mfma_f32_16x16x32_bf16 v[152:155], a[176:179], a[72:75], v[152:155]
  s_waitcnt lgkmcnt(7)
  ds_read_b64_tr_b16 a[170:171], v3 offset:30720
  v_mfma_f32_16x16x32_bf16 v[168:171], a[164:167], a[72:75], v[168:171]
  ds_read_b64_tr_b16 a[180:181], v4 offset:24576
  v_mfma_f32_16x16x32_bf16 v[168:171], a[160:163], a[88:91], v[168:171]
  ds_read_b64_tr_b16 a[182:183], v4 offset:26624
  v_mfma_f32_16x16x32_bf16 v[172:175], a[160:163], a[92:95], v[172:175]
  ds_read_b64_tr_b16 a[176:177], v4 offset:28672
  v_mfma_f32_16x16x32_bf16 v[172:175], a[164:167], a[76:79], v[172:175]
  ds_read_b64_tr_b16 a[178:179], v4 offset:30720
  v_mfma_f32_16x16x32_bf16 v[188:191], v[20:23], a[76:79], v[188:191]
  ds_read_b64_tr_b16 a[160:161], v5 offset:24576
  v_mfma_f32_16x16x32_bf16 v[188:191], v[16:19], a[92:95], v[188:191]
  ds_read_b64_tr_b16 a[162:163], v5 offset:26624
  v_mfma_f32_16x16x32_bf16 v[184:187], v[16:19], a[88:91], v[184:187]
  ds_read_b64_tr_b16 a[164:165], v5 offset:28672
  v_mfma_f32_16x16x32_bf16 v[184:187], v[20:23], a[72:75], v[184:187]
  s_waitcnt lgkmcnt(7)
  ds_read_b64_tr_b16 a[166:167], v5 offset:30720
  v_mfma_f32_16x16x32_bf16 v[136:139], v[28:31], a[104:107], v[136:139]
  ds_read_b64_tr_b16 v[16:17], v2 offset:40960
  v_mfma_f32_16x16x32_bf16 v[136:139], v[24:27], a[120:123], v[136:139]
  ds_read_b64_tr_b16 v[18:19], v2 offset:43008
  v_mfma_f32_16x16x32_bf16 v[140:143], v[24:27], a[124:127], v[140:143]
  ds_read_b64_tr_b16 v[20:21], v2 offset:45056
  v_mfma_f32_16x16x32_bf16 v[140:143], v[28:31], a[108:111], v[140:143]
  ds_read_b64_tr_b16 v[22:23], v2 offset:47104
  v_mfma_f32_16x16x32_bf16 v[156:159], a[172:175], a[108:111], v[156:159]
  ds_read_b64_tr_b16 v[24:25], v3 offset:40960
  v_mfma_f32_16x16x32_bf16 v[156:159], a[168:171], a[124:127], v[156:159]
  ds_read_b64_tr_b16 v[26:27], v3 offset:43008
  v_mfma_f32_16x16x32_bf16 v[152:155], a[168:171], a[120:123], v[152:155]
  ds_read_b64_tr_b16 v[28:29], v3 offset:45056
  v_mfma_f32_16x16x32_bf16 v[152:155], a[172:175], a[104:107], v[152:155]
  s_waitcnt lgkmcnt(7)
  ds_read_b64_tr_b16 v[30:31], v3 offset:47104
  v_mfma_f32_16x16x32_bf16 v[168:171], a[180:183], a[104:107], v[168:171]
  ds_read_b64_tr_b16 a[168:169], v4 offset:40960
  v_mfma_f32_16x16x32_bf16 v[168:171], a[176:179], a[120:123], v[168:171]
  ds_read_b64_tr_b16 a[170:171], v4 offset:43008
  v_mfma_f32_16x16x32_bf16 v[172:175], a[176:179], a[124:127], v[172:175]
  ds_read_b64_tr_b16 a[172:173], v4 offset:45056
  v_mfma_f32_16x16x32_bf16 v[172:175], a[180:183], a[108:111], v[172:175]
  ds_read_b64_tr_b16 a[174:175], v4 offset:47104
  v_mfma_f32_16x16x32_bf16 v[188:191], a[160:163], a[108:111], v[188:191]
  ds_read_b64_tr_b16 a[176:177], v5 offset:40960
  v_mfma_f32_16x16x32_bf16 v[188:191], a[164:167], a[124:127], v[188:191]
  ds_read_b64_tr_b16 a[178:179], v5 offset:43008
  v_mfma_f32_16x16x32_bf16 v[184:187], a[164:167], a[120:123], v[184:187]
  ds_read_b64_tr_b16 a[180:181], v5 offset:45056
  v_mfma_f32_16x16x32_bf16 v[184:187], a[160:163], a[104:107], v[184:187]
  s_waitcnt lgkmcnt(7)
  ds_read_b64_tr_b16 a[182:183], v5 offset:47104
  v_mfma_f32_16x16x32_bf16 v[136:139], v[16:19], a[136:139], v[136:139]
  ds_read_b64_tr_b16 a[164:165], v2 offset:57344
  v_mfma_f32_16x16x32_bf16 v[136:139], v[20:23], a[152:155], v[136:139]
  ds_read_b64_tr_b16 a[166:167], v2 offset:59392
  v_mfma_f32_16x16x32_bf16 v[140:143], v[20:23], a[156:159], v[140:143]
  ds_read_b64_tr_b16 a[160:161], v2 offset:61440
  v_mfma_f32_16x16x32_bf16 v[140:143], v[16:19], a[140:143], v[140:143]
  ds_read_b64_tr_b16 a[162:163], v2 offset:63488
  v_mfma_f32_16x16x32_bf16 v[156:159], v[24:27], a[140:143], v[156:159]
  ds_read_b64_tr_b16 v[20:21], v3 offset:57344
  v_add_u32 v38, s46, v0
  s_waitcnt vmcnt(0)
  s_mov_b64 exec, 1
  buffer_store_dword v38, v0, s[8:11], s80 offen offset:0 sc1
  s_mov_b64 exec, -1
  v_mfma_f32_16x16x32_bf16 v[156:159], v[28:31], a[156:159], v[156:159]
  ds_read_b64_tr_b16 v[22:23], v3 offset:59392
  v_mfma_f32_16x16x32_bf16 v[152:155], v[28:31], a[152:155], v[152:155]
  ds_read_b64_tr_b16 v[16:17], v3 offset:61440
  v_mfma_f32_16x16x32_bf16 v[152:155], v[24:27], a[136:139], v[152:155]
  s_waitcnt lgkmcnt(7)
  ds_read_b64_tr_b16 v[18:19], v3 offset:63488
  v_mfma_f32_16x16x32_bf16 v[168:171], a[168:171], a[136:139], v[168:171]
  ds_read_b64_tr_b16 v[28:29], v4 offset:57344
  v_mfma_f32_16x16x32_bf16 v[168:171], a[172:175], a[152:155], v[168:171]
  ds_read_b64_tr_b16 v[30:31], v4 offset:59392
  v_mfma_f32_16x16x32_bf16 v[172:175], a[172:175], a[156:159], v[172:175]
  ds_read_b64_tr_b16 v[24:25], v4 offset:61440
  v_mfma_f32_16x16x32_bf16 v[172:175], a[168:171], a[140:143], v[172:175]
  ds_read_b64_tr_b16 v[26:27], v4 offset:63488
  v_mfma_f32_16x16x32_bf16 v[188:191], a[176:179], a[140:143], v[188:191]
  ds_read_b64_tr_b16 a[172:173], v5 offset:57344
  v_mfma_f32_16x16x32_bf16 v[188:191], a[180:183], a[156:159], v[188:191]
  ds_read_b64_tr_b16 a[174:175], v5 offset:59392
  v_mfma_f32_16x16x32_bf16 v[184:187], a[180:183], a[152:155], v[184:187]
  ds_read_b64_tr_b16 a[168:169], v5 offset:61440
  v_mfma_f32_16x16x32_bf16 v[184:187], a[176:179], a[136:139], v[184:187]
  s_waitcnt lgkmcnt(7)
  ds_read_b64_tr_b16 a[170:171], v5 offset:63488
  v_mfma_f32_16x16x32_bf16 v[136:139], a[164:167], a[196:199], v[136:139]
  ds_read_b64_tr_b16 a[180:181], v6 offset:40960
  v_mfma_f32_16x16x32_bf16 v[136:139], a[160:163], a[212:215], v[136:139]
  ds_read_b64_tr_b16 a[182:183], v6 offset:43008
  v_mfma_f32_16x16x32_bf16 v[140:143], a[160:163], a[216:219], v[140:143]
  ds_read_b64_tr_b16 a[176:177], v6 offset:45056
  v_mfma_f32_16x16x32_bf16 v[140:143], a[164:167], a[200:203], v[140:143]
  ds_read_b64_tr_b16 a[178:179], v6 offset:47104
  v_mfma_f32_16x16x32_bf16 v[156:159], v[20:23], a[200:203], v[156:159]
  ds_read_b64_tr_b16 a[160:161], v7 offset:40960
  v_mfma_f32_16x16x32_bf16 v[156:159], v[16:19], a[216:219], v[156:159]
  ds_read_b64_tr_b16 a[162:163], v7 offset:43008
HOP19:
  s_cbranch_execz WRET1
  v_mfma_f32_16x16x32_bf16 v[152:155], v[16:19], a[212:215], v[152:155]
  ds_read_b64_tr_b16 a[164:165], v7 offset:45056
  v_cvt_pk_bf16_f32 v136, v136, v137
  v_cvt_pk_bf16_f32 v137, v138, v139
  v_cvt_pk_bf16_f32 v140, v140, v141
  v_cvt_pk_bf16_f32 v141, v142, v143
  v_mfma_f32_16x16x32_bf16 v[152:155], v[20:23], a[196:199], v[152:155]
  s_waitcnt lgkmcnt(7)
  ds_read_b64_tr_b16 a[166:167], v7 offset:47104
  v_mfma_f32_16x16x32_bf16 v[168:171], v[28:31], a[196:199], v[168:171]
  ds_read_b64_tr_b16 v[16:17], v8 offset:40960
  v_mfma_f32_16x16x32_bf16 v[168:171], v[24:27], a[212:215], v[168:171]
  ds_read_b64_tr_b16 v[18:19], v8 offset:43008
  v_mfma_f32_16x16x32_bf16 v[172:175], v[24:27], a[216:219], v[172:175]
  ds_read_b64_tr_b16 v[20:21], v8 offset:45056
  v_cvt_pk_bf16_f32 v138, v152, v153
  v_cvt_pk_bf16_f32 v139, v154, v155
  v_mfma_f32_16x16x32_bf16 v[172:175], v[28:31], a[200:203], v[172:175]
  ds_read_b64_tr_b16 v[22:23], v8 offset:47104
  v_mfma_f32_16x16x32_bf16 v[188:191], a[172:175], a[200:203], v[188:191]
  ds_read_b64_tr_b16 v[24:25], v9 offset:40960
  v_mfma_f32_16x16x32_bf16 v[188:191], a[168:171], a[216:219], v[188:191]
  ds_read_b64_tr_b16 v[26:27], v9 offset:43008
  s_add_u32 s86, s85, 8192
  buffer_store_dwordx4 v[136:139], v1, s[8:11], s86 offen offset:0 sc1
  v_mfma_f32_16x16x32_bf16 v[184:187], a[168:171], a[212:215], v[184:187]
  ds_read_b64_tr_b16 v[28:29], v9 offset:45056
  v_cvt_pk_bf16_f32 v142, v156, v157
  v_cvt_pk_bf16_f32 v143, v158, v159
  v_mfma_f32_16x16x32_bf16 v[184:187], a[172:175], a[196:199], v[184:187]
  s_waitcnt lgkmcnt(7)
  ds_read_b64_tr_b16 v[30:31], v9 offset:47104
  v_mfma_f32_16x16x32_bf16 v[128:131], a[180:183], a[220:223], v[128:131]
  ds_read_b64_tr_b16 a[168:169], v6 offset:57344
  v_mfma_f32_16x16x32_bf16 v[128:131], a[176:179], a[236:239], v[128:131]
  ds_read_b64_tr_b16 a[170:171], v6 offset:59392
  s_add_u32 s86, s85, 8192
  buffer_store_dwordx4 v[140:143], v1, s[8:11], s86 offen offset:2048 sc1
  v_mfma_f32_16x16x32_bf16 v[132:135], a[176:179], a[240:243], v[132:135]
  ds_read_b64_tr_b16 a[172:173], v6 offset:61440
  v_cvt_pk_bf16_f32 v168, v168, v169
  v_cvt_pk_bf16_f32 v169, v170, v171
  v_cvt_pk_bf16_f32 v172, v172, v173
  v_cvt_pk_bf16_f32 v173, v174, v175
  v_mfma_f32_16x16x32_bf16 v[132:135], a[180:183], a[224:227], v[132:135]
  ds_read_b64_tr_b16 a[174:175], v6 offset:63488
  v_cvt_pk_bf16_f32 v170, v184, v185
  v_cvt_pk_bf16_f32 v171, v186, v187
  v_mfma_f32_16x16x32_bf16 v[148:151], a[160:163], a[224:227], v[148:151]
  ds_read_b64_tr_b16 a[176:177], v7 offset:57344
  v_mfma_f32_16x16x32_bf16 v[148:151], a[164:167], a[240:243], v[148:151]
  ds_read_b64_tr_b16 a[178:179], v7 offset:59392
  v_mfma_f32_16x16x32_bf16 v[144:147], a[164:167], a[236:239], v[144:147]
  ds_read_b64_tr_b16 a[180:181], v7 offset:61440
  s_add_u32 s86, s85, 8192
  buffer_store_dwordx4 v[168:171], v1, s[8:11], s86 offen offset:1024 sc1
  v_mfma_f32_16x16x32_bf16 v[144:147], a[160:163], a[220:223], v[144:147]
  s_waitcnt lgkmcnt(7)
  ds_read_b64_tr_b16 a[182:183], v7 offset:63488
  v_cvt_pk_bf16_f32 v174, v188, v189
  v_cvt_pk_bf16_f32 v175, v190, v191
  v_mfma_f32_16x16x32_bf16 v[160:163], v[16:19], a[220:223], v[160:163]
  ds_read_b64_tr_b16 a[164:165], v8 offset:57344
  v_mfma_f32_16x16x32_bf16 v[160:163], v[20:23], a[236:239], v[160:163]
  ds_read_b64_tr_b16 a[166:167], v8 offset:59392
  v_mfma_f32_16x16x32_bf16 v[164:167], v[20:23], a[240:243], v[164:167]
  ds_read_b64_tr_b16 a[160:161], v8 offset:61440
  s_add_u32 s86, s85, 8192
  buffer_store_dwordx4 v[172:175], v1, s[8:11], s86 offen offset:3072 sc1
  v_mfma_f32_16x16x32_bf16 v[164:167], v[16:19], a[224:227], v[164:167]
  ds_read_b64_tr_b16 a[162:163], v8 offset:63488
  v_mfma_f32_16x16x32_bf16 v[180:183], v[24:27], a[224:227], v[180:183]
  ds_read_b64_tr_b16 v[20:21], v9 offset:57344
  v_mfma_f32_16x16x32_bf16 v[180:183], v[28:31], a[240:243], v[180:183]
  ds_read_b64_tr_b16 v[22:23], v9 offset:59392
  v_mfma_f32_16x16x32_bf16 v[176:179], v[28:31], a[236:239], v[176:179]
  ds_read_b64_tr_b16 v[16:17], v9 offset:61440
  v_mfma_f32_16x16x32_bf16 v[176:179], v[24:27], a[220:223], v[176:179]
  s_waitcnt lgkmcnt(7)
  ds_read_b64_tr_b16 v[18:19], v9 offset:63488
  v_mfma_f32_16x16x32_bf16 v[128:131], a[168:171], a[0:3], v[128:131]
  ds_read_b64_tr_b16 v[28:29], v6 offset:24576
  v_mfma_f32_16x16x32_bf16 v[128:131], a[172:175], a[16:19], v[128:131]
  ds_read_b64_tr_b16 v[30:31], v6 offset:26624
  v_mfma_f32_16x16x32_bf16 v[132:135], a[172:175], a[20:23], v[132:135]
  ds_read_b64_tr_b16 v[24:25], v6 offset:28672
  v_mfma_f32_16x16x32_bf16 v[132:135], a[168:171], a[4:7], v[132:135]
  ds_read_b64_tr_b16 v[26:27], v6 offset:30720
  v_mfma_f32_16x16x32_bf16 v[148:151], a[176:179], a[4:7], v[148:151]
  ds_read_b64_tr_b16 a[172:173], v7 offset:24576
  v_mfma_f32_16x16x32_bf16 v[148:151], a[180:183], a[20:23], v[148:151]
  ds_read_b64_tr_b16 a[174:175], v7 offset:26624
  v_mfma_f32_16x16x32_bf16 v[144:147], a[180:183], a[16:19], v[144:147]
  ds_read_b64_tr_b16 a[168:169], v7 offset:28672
  v_mfma_f32_16x16x32_bf16 v[144:147], a[176:179], a[0:3], v[144:147]
  s_waitcnt lgkmcnt(7)
  ds_read_b64_tr_b16 a[170:171], v7 offset:30720
  v_mfma_f32_16x16x32_bf16 v[160:163], a[164:167], a[0:3], v[160:163]
  ds_read_b64_tr_b16 a[180:181], v8 offset:24576
  v_mfma_f32_16x16x32_bf16 v[160:163], a[160:163], a[16:19], v[160:163]
  ds_read_b64_tr_b16 a[182:183], v8 offset:26624
  v_mfma_f32_16x16x32_bf16 v[164:167], a[160:163], a[20:23], v[164:167]
  ds_read_b64_tr_b16 a[176:177], v8 offset:28672
  v_mfma_f32_16x16x32_bf16 v[164:167], a[164:167], a[4:7], v[164:167]
  ds_read_b64_tr_b16 a[178:179], v8 offset:30720
  v_mfma_f32_16x16x32_bf16 v[180:183], v[20:23], a[4:7], v[180:183]
  ds_read_b64_tr_b16 a[160:161], v9 offset:24576
  v_mfma_f32_16x16x32_bf16 v[180:183], v[16:19], a[20:23], v[180:183]
  ds_read_b64_tr_b16 a[162:163], v9 offset:26624
  v_mfma_f32_16x16x32_bf16 v[176:179], v[16:19], a[16:19], v[176:179]
  ds_read_b64_tr_b16 a[164:165], v9 offset:28672
  v_mfma_f32_16x16x32_bf16 v[176:179], v[20:23], a[0:3], v[176:179]
  s_waitcnt lgkmcnt(7)
  ds_read_b64_tr_b16 a[166:167], v9 offset:30720
  v_mfma_f32_16x16x32_bf16 v[128:131], v[28:31], a[32:35], v[128:131]
  ds_read_b64_tr_b16 v[16:17], v6 offset:8192
  v_mfma_f32_16x16x32_bf16 v[128:131], v[24:27], a[48:51], v[128:131]
  ds_read_b64_tr_b16 v[18:19], v6 offset:10240
  v_mfma_f32_16x16x32_bf16 v[132:135], v[24:27], a[52:55], v[132:135]
  ds_read_b64_tr_b16 v[20:21], v6 offset:12288
  v_mfma_f32_16x16x32_bf16 v[132:135], v[28:31], a[36:39], v[132:135]
  ds_read_b64_tr_b16 v[22:23], v6 offset:14336
  v_mfma_f32_16x16x32_bf16 v[148:151], a[172:175], a[36:39], v[148:151]
  ds_read_b64_tr_b16 v[24:25], v7 offset:8192
  v_mfma_f32_16x16x32_bf16 v[148:151], a[168:171], a[52:55], v[148:151]
  ds_read_b64_tr_b16 v[26:27], v7 offset:10240
  s_xor_b32 s83, s80, 1536
  s_add_u32 s83, s83, 0
  buffer_load_dword v34, v37, s[8:11], s83 offen sc1
  v_mfma_f32_16x16x32_bf16 v[144:147], a[168:171], a[48:51], v[144:147]
  ds_read_b64_tr_b16 v[28:29], v7 offset:12288
  s_xor_b32 s90, s80, 512
  s_add_u32 s90, s90, 0
  buffer_load_dword v39, v37, s[8:11], s90 offen sc1
  v_mfma_f32_16x16x32_bf16 v[144:147], a[172:175], a[32:35], v[144:147]
  s_waitcnt lgkmcnt(7)
  ds_read_b64_tr_b16 v[30:31], v7 offset:14336
  v_mfma_f32_16x16x32_bf16 v[160:163], a[180:183], a[32:35], v[160:163]
  ds_read_b64_tr_b16 a[168:169], v8 offset:8192
  v_mfma_f32_16x16x32_bf16 v[160:163], a[176:179], a[48:51], v[160:163]
  ds_read_b64_tr_b16 a[170:171], v8 offset:10240
  v_mfma_f32_16x16x32_bf16 v[164:167], a[176:179], a[52:55], v[164:167]
  ds_read_b64_tr_b16 a[172:173], v8 offset:12288
  v_mfma_f32_16x16x32_bf16 v[164:167], a[180:183], a[36:39], v[164:167]
  ds_read_b64_tr_b16 a[174:175], v8 offset:14336
  v_mfma_f32_16x16x32_bf16 v[180:183], a[160:163], a[36:39], v[180:183]
  ds_read_b64_tr_b16 a[176:177], v9 offset:8192
  v_mfma_f32_16x16x32_bf16 v[180:183], a[164:167], a[52:55], v[180:183]
  ds_read_b64_tr_b16 a[178:179], v9 offset:10240
  v_mfma_f32_16x16x32_bf16 v[176:179], a[164:167], a[48:51], v[176:179]
  ds_read_b64_tr_b16 a[180:181], v9 offset:12288
  v_mfma_f32_16x16x32_bf16 v[176:179], a[160:163], a[32:35], v[176:179]
  s_waitcnt lgkmcnt(7)
  ds_read_b64_tr_b16 a[182:183], v9 offset:14336
  v_add_u32 v38, s46, v0
  s_waitcnt vmcnt(2)
  s_mov_b64 exec, 1
  buffer_store_dword v38, v0, s[8:11], s80 offen offset:16 sc1
  s_mov_b64 exec, -1
  v_mfma_f32_16x16x32_bf16 v[128:131], v[16:19], a[64:67], v[128:131]
  ds_read_b64_tr_b16 a[164:165], v2 offset:24576
  v_mfma_f32_16x16x32_bf16 v[128:131], v[20:23], a[80:83], v[128:131]
  ds_read_b64_tr_b16 a[166:167], v2 offset:26624
  v_mfma_f32_16x16x32_bf16 v[132:135], v[20:23], a[84:87], v[132:135]
  ds_read_b64_tr_b16 a[160:161], v2 offset:28672
  v_mfma_f32_16x16x32_bf16 v[132:135], v[16:19], a[68:71], v[132:135]
  ds_read_b64_tr_b16 a[162:163], v2 offset:30720
  s_xor_b32 s81, s80, 1024
  s_add_u32 s81, s81, 16
  buffer_load_dword v36, v37, s[8:11], s81 offen sc1
  v_mfma_f32_16x16x32_bf16 v[148:151], v[24:27], a[68:71], v[148:151]
  ds_read_b64_tr_b16 v[20:21], v3 offset:24576
  v_mfma_f32_16x16x32_bf16 v[148:151], v[28:31], a[84:87], v[148:151]
  ds_read_b64_tr_b16 v[22:23], v3 offset:26624
  v_mfma_f32_16x16x32_bf16 v[144:147], v[28:31], a[80:83], v[144:147]
  ds_read_b64_tr_b16 v[16:17], v3 offset:28672
  v_mfma_f32_16x16x32_bf16 v[144:147], v[24:27], a[64:67], v[144:147]
  s_waitcnt lgkmcnt(7)
  ds_read_b64_tr_b16 v[18:19], v3 offset:30720
  v_mfma_f32_16x16x32_bf16 v[160:163], a[168:171], a[64:67], v[160:163]
  ds_read_b64_tr_b16 v[28:29], v4 offset:24576
  v_mfma_f32_16x16x32_bf16 v[160:163], a[172:175], a[80:83], v[160:163]
  ds_read_b64_tr_b16 v[30:31], v4 offset:26624
  v_mfma_f32_16x16x32_bf16 v[164:167], a[172:175], a[84:87], v[164:167]
  ds_read_b64_tr_b16 v[24:25], v4 offset:28672
  v_mfma_f32_16x16x32_bf16 v[164:167], a[168:171], a[68:71], v[164:167]
  ds_read_b64_tr_b16 v[26:27], v4 offset:30720
  v_mfma_f32_16x16x32_bf16 v[180:183], a[176:179], a[68:71], v[180:183]
  ds_read_b64_tr_b16 a[172:173], v5 offset:24576
  v_mfma_f32_16x16x32_bf16 v[180:183], a[180:183], a[84:87], v[180:183]
  ds_read_b64_tr_b16 a[174:175], v5 offset:26624
  v_mfma_f32_16x16x32_bf16 v[176:179], a[180:183], a[80:83], v[176:179]
  ds_read_b64_tr_b16 a[168:169], v5 offset:28672
  v_mfma_f32_16x16x32_bf16 v[176:179], a[176:179], a[64:67], v[176:179]
  s_waitcnt lgkmcnt(7)
  ds_read_b64_tr_b16 a[170:171], v5 offset:30720
  v_mfma_f32_16x16x32_bf16 v[128:131], a[164:167], a[96:99], v[128:131]
  ds_read_b64_tr_b16 a[180:181], v2 offset:40960
  v_mfma_f32_16x16x32_bf16 v[128:131], a[160:163], a[112:115], v[128:131]
  ds_read_b64_tr_b16 a[182:183], v2 offset:43008
  s_waitcnt vmcnt(3)
  v_cmp_ne_u32 vcc, s46, v34
  s_nop 4
  s_cbranch_vccz PL14_adaLN_cond__sliding_local_dilated__swiglu_ffn__prompt_kernelx
  s_mov_b32 s82, 60000
PL14_adaLN_cond__sliding_local_dilated__swiglu_ffn__prompt_kernel:
  buffer_load_dword v34, v37, s[8:11], s83 offen sc1
  s_sub_u32 s82, s82, 1
  s_cmp_eq_u32 s82, 0
  s_waitcnt vmcnt(0)
  s_cbranch_scc1 PL14_adaLN_cond__sliding_local_dilated__swiglu_ffn__prompt_kernelx
  v_cmp_ne_u32 vcc, s46, v34
  s_nop 4
  s_cbranch_vccnz PL14_adaLN_cond__sliding_local_dilated__swiglu_ffn__prompt_kernel
PL14_adaLN_cond__sliding_local_dilated__swiglu_ffn__prompt_kernelx:
  v_mfma_f32_16x16x32_bf16 v[132:135], a[160:163], a[116:119], v[132:135]
  ds_read_b64_tr_b16 a[176:177], v2 offset:45056
  s_xor_b32 s55, s85, 196608
  s_add_u32 s55, s55, 0
  buffer_load_dwordx4 v[88:91], v1, s[8:11], s55 offen offset:0 sc1
  v_mfma_f32_16x16x32_bf16 v[132:135], a[164:167], a[100:103], v[132:135]
  ds_read_b64_tr_b16 a[178:179], v2 offset:47104
  s_xor_b32 s55, s85, 196608
  s_add_u32 s55, s55, 0
  buffer_load_dwordx4 v[120:123], v1, s[8:11], s55 offen offset:1024 sc1
  v_mfma_f32_16x16x32_bf16 v[148:151], v[20:23], a[100:103], v[148:151]
  ds_read_b64_tr_b16 a[160:161], v3 offset:40960
  s_xor_b32 s55, s85, 196608
  s_add_u32 s55, s55, 0
  buffer_load_dwordx4 v[92:95], v1, s[8:11], s55 offen offset:2048 sc1
  v_mfma_f32_16x16x32_bf16 v[148:151], v[16:19], a[116:119], v[148:151]
  ds_read_b64_tr_b16 a[162:163], v3 offset:43008
  s_xor_b32 s55, s85, 196608
  s_add_u32 s55, s55, 0
  buffer_load_dwordx4 v[124:127], v1, s[8:11], s55 offen offset:3072 sc1
  v_mfma_f32_16x16x32_bf16 v[144:147], v[16:19], a[112:115], v[144:147]
  ds_read_b64_tr_b16 a[164:165], v3 offset:45056
  s_waitcnt vmcnt(6)
  v_cmp_ne_u32 vcc, s46, v39
  s_nop 4
  s_cbranch_vccz PL15_adaLN_cond__sliding_local_dilated__swiglu_ffn__prompt_kernelx
  s_mov_b32 s82, 60000
PL15_adaLN_cond__sliding_local_dilated__swiglu_ffn__prompt_kernel:
  buffer_load_dword v39, v37, s[8:11], s90 offen sc1
  s_sub_u32 s82, s82, 1
  s_cmp_eq_u32 s82, 0
  s_waitcnt vmcnt(0)
  s_cbranch_scc1 PL15_adaLN_cond__sliding_local_dilated__swiglu_ffn__prompt_kernelx
  v_cmp_ne_u32 vcc, s46, v39
  s_nop 4
  s_cbranch_vccnz PL15_adaLN_cond__sliding_local_dilated__swiglu_ffn__prompt_kernel
PL15_adaLN_cond__sliding_local_dilated__swiglu_ffn__prompt_kernelx:
  v_mfma_f32_16x16x32_bf16 v[144:147], v[20:23], a[96:99], v[144:147]
  s_waitcnt lgkmcnt(7)
  ds_read_b64_tr_b16 a[166:167], v3 offset:47104
  s_xor_b32 s55, s85, 65536
  s_add_u32 s55, s55, 4096
  buffer_load_dwordx4 v[80:83], v1, s[8:11], s55 offen offset:0 sc1
  v_mfma_f32_16x16x32_bf16 v[160:163], v[28:31], a[96:99], v[160:163]
  ds_read_b64_tr_b16 v[16:17], v4 offset:40960
  s_xor_b32 s55, s85, 65536
  s_add_u32 s55, s55, 4096
  buffer_load_dwordx4 v[112:115], v1, s[8:11], s55 offen offset:1024 sc1
  v_mfma_f32_16x16x32_bf16 v[160:163], v[24:27], a[112:115], v[160:163]
  ds_read_b64_tr_b16 v[18:19], v4 offset:43008
  s_xor_b32 s55, s85, 65536
  s_add_u32 s55, s55, 4096
  buffer_load_dwordx4 v[84:87], v1, s[8:11], s55 offen offset:2048 sc1
  v_mfma_f32_16x16x32_bf16 v[164:167], v[24:27], a[116:119], v[164:167]
  ds_read_b64_tr_b16 v[20:21], v4 offset:45056
  s_xor_b32 s55, s85, 65536
  s_add_u32 s55, s55, 4096
  buffer_load_dwordx4 v[116:119], v1, s[8:11], s55 offen offset:3072 sc1
  v_mfma_f32_16x16x32_bf16 v[164:167], v[28:31], a[100:103], v[164:167]
  ds_read_b64_tr_b16 v[22:23], v4 offset:47104
  v_mfma_f32_16x16x32_bf16 v[180:183], a[172:175], a[100:103], v[180:183]
  ds_read_b64_tr_b16 v[24:25], v5 offset:40960
  v_mfma_f32_16x16x32_bf16 v[180:183], a[168:171], a[116:119], v[180:183]
  ds_read_b64_tr_b16 v[26:27], v5 offset:43008
  s_waitcnt vmcnt(8)
  v_cmp_ne_u32 vcc, s46, v36
  s_mov_b32 s86, 0
  s_nop 3
  s_cbranch_vccnz XL16_adaLN_cond__sliding_local_dilated__swiglu_ffn__prompt_kernel
  s_xor_b32 s55, s85, 131072
  s_add_u32 s55, s55, 8192
  buffer_load_dwordx4 v[152:155], v1, s[8:11], s55 offen offset:0 sc1
  buffer_load_dwordx4 v[184:187], v1, s[8:11], s55 offen offset:1024 sc1
  buffer_load_dwordx4 v[156:159], v1, s[8:11], s55 offen offset:2048 sc1
  buffer_load_dwordx4 v[188:191], v1, s[8:11], s55 offen offset:3072 sc1
  s_mov_b32 s86, 1
XL16_adaLN_cond__sliding_local_dilated__swiglu_ffn__prompt_kernel:
  v_mfma_f32_16x16x32_bf16 v[176:179], a[168:171], a[112:115], v[176:179]
  ds_read_b64_tr_b16 v[28:29], v5 offset:45056
  v_mfma_f32_16x16x32_bf16 v[176:179], a[172:175], a[96:99], v[176:179]
  s_waitcnt lgkmcnt(7)
  ds_read_b64_tr_b16 v[30:31], v5 offset:47104
  v_mfma_f32_16x16x32_bf16 v[128:131], a[180:183], a[128:131], v[128:131]
  ds_read_b64_tr_b16 a[168:169], v2 offset:57344
  v_mfma_f32_16x16x32_bf16 v[128:131], a[176:179], a[144:147], v[128:131]
  ds_read_b64_tr_b16 a[170:171], v2 offset:59392
  v_mfma_f32_16x16x32_bf16 v[132:135], a[176:179], a[148:151], v[132:135]
  ds_read_b64_tr_b16 a[172:173], v2 offset:61440
  v_mfma_f32_16x16x32_bf16 v[132:135], a[180:183], a[132:135], v[132:135]
  ds_read_b64_tr_b16 a[174:175], v2 offset:63488
  v_mfma_f32_16x16x32_bf16 v[148:151], a[160:163], a[132:135], v[148:151]
  ds_read_b64_tr_b16 a[176:177], v3 offset:57344
  v_mfma_f32_16x16x32_bf16 v[148:151], a[164:167], a[148:151], v[148:151]
  ds_read_b64_tr_b16 a[178:179], v3 offset:59392
  v_mfma_f32_16x16x32_bf16 v[144:147], a[164:167], a[144:147], v[144:147]
  ds_read_b64_tr_b16 a[180:181], v3 offset:61440
  v_mfma_f32_16x16x32_bf16 v[144:147], a[160:163], a[128:131], v[144:147]
  s_waitcnt lgkmcnt(7)
  ds_read_b64_tr_b16 a[182:183], v3 offset:63488
  v_mfma_f32_16x16x32_bf16 v[160:163], v[16:19], a[128:131], v[160:163]
  ds_read_b64_tr_b16 a[164:165], v4 offset:57344
  v_mfma_f32_16x16x32_bf16 v[160:163], v[20:23], a[144:147], v[160:163]
  ds_read_b64_tr_b16 a[166:167], v4 offset:59392
  v_mfma_f32_16x16x32_bf16 v[164:167], v[20:23], a[148:151], v[164:167]
  ds_read_b64_tr_b16 a[160:161], v4 offset:61440
  v_mfma_f32_16x16x32_bf16 v[164:167], v[16:19], a[132:135], v[164:167]
  ds_read_b64_tr_b16 a[162:163], v4 offset:63488
  v_mfma_f32_16x16x32_bf16 v[180:183], v[24:27], a[132:135], v[180:183]
  ds_read_b64_tr_b16 v[20:21], v5 offset:57344
  v_mfma_f32_16x16x32_bf16 v[180:183], v[28:31], a[148:151], v[180:183]
  ds_read_b64_tr_b16 v[22:23], v5 offset:59392
  v_mfma_f32_16x16x32_bf16 v[176:179], v[28:31], a[144:147], v[176:179]
  ds_read_b64_tr_b16 v[16:17], v5 offset:61440
  v_mfma_f32_16x16x32_bf16 v[176:179], v[24:27], a[128:131], v[176:179]
  s_waitcnt lgkmcnt(7)
  ds_read_b64_tr_b16 v[18:19], v5 offset:63488
  v_mfma_f32_16x16x32_bf16 v[128:131], a[168:171], a[188:191], v[128:131]
  v_mfma_f32_16x16x32_bf16 v[128:131], a[172:175], a[204:207], v[128:131]
  v_mfma_f32_16x16x32_bf16 v[132:135], a[172:175], a[208:211], v[132:135]
  v_mfma_f32_16x16x32_bf16 v[132:135], a[168:171], a[192:195], v[132:135]
  v_mfma_f32_16x16x32_bf16 v[148:151], a[176:179], a[192:195], v[148:151]
  v_mfma_f32_16x16x32_bf16 v[148:151], a[180:183], a[208:211], v[148:151]
  v_mfma_f32_16x16x32_bf16 v[144:147], a[180:183], a[204:207], v[144:147]
  v_mfma_f32_16x16x32_bf16 v[144:147], a[176:179], a[188:191], v[144:147]
  s_waitcnt lgkmcnt(0)
  v_mfma_f32_16x16x32_bf16 v[160:163], a[164:167], a[188:191], v[160:163]
  v_mfma_f32_16x16x32_bf16 v[160:163], a[160:163], a[204:207], v[160:163]
  v_mfma_f32_16x16x32_bf16 v[164:167], a[160:163], a[208:211], v[164:167]
  v_mfma_f32_16x16x32_bf16 v[164:167], a[164:167], a[192:195], v[164:167]
  v_mfma_f32_16x16x32_bf16 v[180:183], v[20:23], a[192:195], v[180:183]
  v_mfma_f32_16x16x32_bf16 v[180:183], v[16:19], a[208:211], v[180:183]
  v_mfma_f32_16x16x32_bf16 v[176:179], v[16:19], a[204:207], v[176:179]
  v_mfma_f32_16x16x32_bf16 v[176:179], v[20:23], a[188:191], v[176:179]
  s_waitcnt vmcnt(0)
  v_mfma_f32_16x16x32_bf16 v[208:211], v[52:55], v[88:91], v[208:211]
  v_mfma_f32_16x16x32_bf16 v[212:215], v[54:57], v[88:91], v[212:215]
  v_mfma_f32_16x16x32_bf16 v[216:219], v[58:61], v[120:123], v[216:219]
  v_mfma_f32_16x16x32_bf16 v[220:223], v[60:63], v[120:123], v[220:223]
  v_mfma_f32_16x16x32_bf16 v[224:227], v[52:55], v[92:95], v[224:227]
  v_mfma_f32_16x16x32_bf16 v[228:231], v[54:57], v[92:95], v[228:231]
  v_mfma_f32_16x16x32_bf16 v[232:235], v[58:61], v[124:127], v[232:235]
  v_mfma_f32_16x16x32_bf16 v[236:239], v[60:63], v[124:127], v[236:239]
  v_mfma_f32_16x16x32_bf16 v[208:211], v[52:55], v[80:83], v[208:211]
  v_mfma_f32_16x16x32_bf16 v[212:215], v[54:57], v[80:83], v[212:215]
  v_mfma_f32_16x16x32_bf16 v[216:219], v[58:61], v[112:115], v[216:219]
  v_mfma_f32_16x16x32_bf16 v[220:223], v[60:63], v[112:115], v[220:223]
  v_mfma_f32_16x16x32_bf16 v[224:227], v[52:55], v[84:87], v[224:227]
  v_mfma_f32_16x16x32_bf16 v[228:231], v[54:57], v[84:87], v[228:231]
  v_mfma_f32_16x16x32_bf16 v[232:235], v[58:61], v[116:119], v[232:235]
  v_mfma_f32_16x16x32_bf16 v[236:239], v[60:63], v[116:119], v[236:239]
  s_nop 0
  v_fmac_f32 v208, v240, v128
  v_fmac_f32 v209, v241, v129
  v_fmac_f32 v210, v242, v130
  v_fmac_f32 v211, v243, v131
  v_fmac_f32 v212, v244, v144
  v_fmac_f32 v213, v245, v145
  v_fmac_f32 v214, v246, v146
  v_fmac_f32 v215, v247, v147
  v_fmac_f32 v224, v240, v132
  v_fmac_f32 v225, v241, v133
  v_fmac_f32 v226, v242, v134
  v_fmac_f32 v227, v243, v135
  v_fmac_f32 v228, v244, v148
  v_fmac_f32 v229, v245, v149
  v_fmac_f32 v230, v246, v150
  v_fmac_f32 v231, v247, v151
  v_fmac_f32 v216, v248, v160
  v_fmac_f32 v217, v249, v161
  v_fmac_f32 v218, v250, v162
  v_fmac_f32 v219, v251, v163
  v_fmac_f32 v220, v252, v176
  v_fmac_f32 v221, v253, v177
  v_fmac_f32 v222, v254, v178
  v_fmac_f32 v223, v255, v179
  v_fmac_f32 v232, v248, v164
  v_fmac_f32 v233, v249, v165
  v_fmac_f32 v234, v250, v166
  v_fmac_f32 v235, v251, v167
  v_fmac_f32 v236, v252, v180
  v_fmac_f32 v237, v253, v181
  v_fmac_f32 v238, v254, v182
  v_fmac_f32 v239, v255, v183
  s_cmp_eq_u32 s86, 1
  s_cbranch_scc1 XA17_adaLN_cond__sliding_local_dilated__swiglu_ffn__prompt_kernelx
  s_mov_b32 s82, 60000
XA17_adaLN_cond__sliding_local_dilated__swiglu_ffn__prompt_kernel:
  buffer_load_dword v36, v37, s[8:11], s81 offen sc1
  s_sub_u32 s82, s82, 1
  s_cmp_eq_u32 s82, 0
  s_waitcnt vmcnt(0)
  s_cbranch_scc1 XA17_adaLN_cond__sliding_local_dilated__swiglu_ffn__prompt_kernely
  v_cmp_ne_u32 vcc, s46, v36
  s_nop 4
  s_cbranch_vccnz XA17_adaLN_cond__sliding_local_dilated__swiglu_ffn__prompt_kernel
XA17_adaLN_cond__sliding_local_dilated__swiglu_ffn__prompt_kernely:
  s_xor_b32 s55, s85, 131072
  s_add_u32 s55, s55, 8192
  buffer_load_dwordx4 v[152:155], v1, s[8:11], s55 offen offset:0 sc1
  buffer_load_dwordx4 v[184:187], v1, s[8:11], s55 offen offset:1024 sc1
  buffer_load_dwordx4 v[156:159], v1, s[8:11], s55 offen offset:2048 sc1
  buffer_load_dwordx4 v[188:191], v1, s[8:11], s55 offen offset:3072 sc1
XA17_adaLN_cond__sliding_local_dilated__swiglu_ffn__prompt_kernelx:
  s_waitcnt vmcnt(3)
  v_mfma_f32_16x16x32_bf16 v[208:211], v[52:55], v[152:155], v[208:211]
  v_mfma_f32_16x16x32_bf16 v[212:215], v[54:57], v[152:155], v[212:215]
  s_waitcnt vmcnt(2)
  v_mfma_f32_16x16x32_bf16 v[216:219], v[58:61], v[184:187], v[216:219]
  v_mfma_f32_16x16x32_bf16 v[220:223], v[60:63], v[184:187], v[220:223]
  s_waitcnt vmcnt(1)
  v_mfma_f32_16x16x32_bf16 v[224:227], v[52:55], v[156:159], v[224:227]
  v_mfma_f32_16x16x32_bf16 v[228:231], v[54:57], v[156:159], v[228:231]
  s_waitcnt vmcnt(0)
  v_mfma_f32_16x16x32_bf16 v[232:235], v[58:61], v[188:191], v[232:235]
  v_mfma_f32_16x16x32_bf16 v[236:239], v[60:63], v[188:191], v[236:239]
  v_cvt_pk_bf16_f32 v192, v208, v209
  v_cvt_pk_bf16_f32 v193, v210, v211
  v_cvt_pk_bf16_f32 v194, v212, v213
  v_cvt_pk_bf16_f32 v195, v214, v215
  s_nop 0
  v_permlane16_swap_b32 v192, v194
  v_permlane16_swap_b32 v193, v195
  ds_write_b128 v42, v[192:195] offset:0
  v_cvt_pk_bf16_f32 v196, v216, v217
  v_cvt_pk_bf16_f32 v197, v218, v219
  v_cvt_pk_bf16_f32 v198, v220, v221
  v_cvt_pk_bf16_f32 v199, v222, v223
  s_nop 0
  v_permlane16_swap_b32 v196, v198
  v_permlane16_swap_b32 v197, v199
  ds_write_b128 v43, v[196:199] offset:0
  ds_read_b128 v[208:211], v44 offset:0
  ds_read_b128 v[212:215], v44 offset:1024
  v_cvt_pk_bf16_f32 v200, v224, v225
  v_cvt_pk_bf16_f32 v201, v226, v227
  v_cvt_pk_bf16_f32 v202, v228, v229
  v_cvt_pk_bf16_f32 v203, v230, v231
  s_nop 0
  v_permlane16_swap_b32 v200, v202
  v_permlane16_swap_b32 v201, v203
  ds_write_b128 v42, v[200:203] offset:2048
  v_cvt_pk_bf16_f32 v204, v232, v233
  v_cvt_pk_bf16_f32 v205, v234, v235
  v_cvt_pk_bf16_f32 v206, v236, v237
  v_cvt_pk_bf16_f32 v207, v238, v239
  s_nop 0
  v_permlane16_swap_b32 v204, v206
  v_permlane16_swap_b32 v205, v207
  ds_write_b128 v43, v[204:207] offset:2048
  ds_read_b128 v[224:227], v44 offset:2048
  ds_read_b128 v[228:231], v44 offset:3072
  s_waitcnt lgkmcnt(5)
  buffer_store_dwordx4 v[208:211], v40, s[40:43], s84 offen sc1
  s_add_u32 s84, s84, 16384
  s_waitcnt lgkmcnt(4)
  buffer_store_dwordx4 v[212:215], v40, s[40:43], s84 offen sc1
  s_add_u32 s84, s84, 16384
  s_waitcnt lgkmcnt(1)
  buffer_store_dwordx4 v[224:227], v40, s[40:43], s84 offen sc1
  s_add_u32 s84, s84, 16384
  s_waitcnt lgkmcnt(0)
  buffer_store_dwordx4 v[228:231], v40, s[40:43], s84 offen sc1
E_adaLN_cond__sliding_local_dilated__swiglu_ffn__prompt_kernel:
X_adaLN_cond__sliding_local_dilated__swiglu_ffn__prompt_kernel:
  s_endpgm
code_end:
.fill 2048, 4, 0xBF800000
.section .rodata,"a"
.p2align 6
.amdhsa_kernel adaLN_cond__sliding_local_dilated__swiglu_ffn__prompt_kernel
  .amdhsa_next_free_vgpr 512
  .amdhsa_next_free_sgpr 102
  .amdhsa_accum_offset 256
  .amdhsa_group_segment_fixed_size 0
  .amdhsa_kernarg_size 96
  .amdhsa_user_sgpr_count 2
  .amdhsa_user_sgpr_kernarg_segment_ptr 1
  .amdhsa_system_sgpr_workgroup_id_x 1
  .amdhsa_float_denorm_mode_32 3
.end_amdhsa_kernel
```
